```python
import torch

def _softmax(x, axis=-1):
    return torch.softmax(x, dim=axis)

def _gelu(x):
    return torch.nn.functional.gelu(x, approximate='tanh')

def _silu(x):
    return torch.nn.functional.silu(x)

def _sigmoid(x):
    return torch.sigmoid(x)

def _layernorm(x, axis=-1, eps=1e-05):
    m = x.mean(dim=axis, keepdim=True)
    v = x.var(dim=axis, keepdim=True, unbiased=False)
    return (x - m) / torch.sqrt(v + eps)

def _scatter_add(tgt, idx, src, axis=0):
    return tgt.clone().index_add_(axis, idx, src)

def _segment_sum(src, seg, n):
    out = torch.zeros((n,) + src.shape[1:], dtype=src.dtype)
    return out.index_add_(0, seg, src)

def _pad(x, pw):
    flat = tuple((v for pair in reversed(pw) for v in pair))
    return torch.nn.functional.pad(x, flat)
kernel_name = 'recurrent_scan__memory_aug_recurrent_mem_tr__mixer_s_mlp__prompt'

def setup_inputs():

    _w = lambda a: (lambda t: t.to(torch.bfloat16) if t.is_floating_point() else t)(torch.as_tensor(a))

    def _A_setup():
        B, S, Dm = (1, 2048, 1024)
        H, Dh = (32, 128)
        M, seg = (8, 32)
        seg = min(seg, S)
        S = S // seg * seg
        return {'x': _w((lambda *s: torch.randn(*s, dtype=torch.bfloat16) * 0.05)(B, S, Dm)), 'mem0': _w((lambda *s: torch.randn(*s, dtype=torch.bfloat16) * 0.2)(B, M, Dm)), 'Wq': _w((lambda *s: torch.randn(*s, dtype=torch.bfloat16) * 1.6)(Dm, H, Dh) * Dm ** (-0.5)), 'Wk': _w((lambda *s: torch.randn(*s, dtype=torch.bfloat16) * 1.6)(Dm, H, Dh) * Dm ** (-0.5)), 'Wv': _w((lambda *s: torch.randn(*s, dtype=torch.bfloat16) * 0.2)(Dm, H, Dh) * Dm ** (-0.5)), 'Wo': _w((lambda *s: torch.randn(*s, dtype=torch.bfloat16) * 0.2)(H, Dh, Dm) * (H * Dh) ** (-0.5)), 'seg_len': seg}
    _A_in = _A_setup()

    def _B_setup():
        B, S, D, F = (1, 2048, 1024, 3584)
        return {'x': _w((lambda *s: torch.randn(*s, dtype=torch.bfloat16) * 0.05)(B, S, D)), 'w1': _w((lambda *s: torch.randn(*s, dtype=torch.bfloat16) * 3.2)(D, D) * D ** (-0.5)), 'w2': _w((lambda *s: torch.randn(*s, dtype=torch.bfloat16) * 3.2)(D, D) * D ** (-0.5)), 'w3': _w((lambda *s: torch.randn(*s, dtype=torch.bfloat16) * 3.2)(D, F) * D ** (-0.5)), 'w4': _w((lambda *s: torch.randn(*s, dtype=torch.bfloat16) * 3.2)(F, D) * F ** (-0.5))}
    _B_in = _B_setup()
    return {'A_x': _A_in['x'], 'A_mem0': _A_in['mem0'], 'A_Wq': _A_in['Wq'], 'A_Wk': _A_in['Wk'], 'A_Wv': _A_in['Wv'], 'A_Wo': _A_in['Wo'], 'A_seg_len': _A_in['seg_len'], 'B_x': _B_in['x'], 'B_w1': _B_in['w1'], 'B_w2': _B_in['w2'], 'B_w3': _B_in['w3'], 'B_w4': _B_in['w4']}

def reference(A_x, A_mem0, A_Wq, A_Wk, A_Wv, A_Wo, A_seg_len, B_x, B_w1, B_w2, B_w3, B_w4):

    def _A_ref(x, mem0, Wq, Wk, Wv, Wo, seg_len):
        B, S, Dm = x.shape
        H, Dh = (Wq.shape[1], Wq.shape[2])
        M = mem0.shape[1]
        scale = Dh ** (-0.5)
        n_seg = S // seg_len
        L = M + seg_len
        idx = torch.arange(L)
        mask = (idx[:, None] < M) | (idx[:, None] >= idx[None, :])
        mem = mem0
        outs = []
        for s in range(n_seg):
            xs = x[:, s * seg_len:(s + 1) * seg_len, :].clone()
            h = torch.concatenate([mem, xs], axis=1)
            q = torch.einsum('btd,dhe->bhte', h, Wq)
            k = torch.einsum('btd,dhe->bhte', h, Wk)
            v = torch.einsum('btd,dhe->bhte', h, Wv)
            scores = torch.einsum('bhqe,bhke->bhqk', q, k) * scale
            scores = torch.where(mask[None, None], scores, -1000000000.0)
            p = _softmax(scores, axis=-1)
            o = torch.einsum('bhqk,bhke->bhqe', p, v)
            o = torch.einsum('bhte,hed->btd', o, Wo)
            mem = o[:, :M, :].clone()
            outs.append(o[:, M:, :])
        return torch.concatenate(outs, axis=1)

    def _B_ref(x, w1, w2, w3, w4):
        B, S, D = x.shape
        h = _gelu(_layernorm(x, axis=-1) @ w1)
        c = D // 4
        g0 = _pad(h[:, :, 0 * c:1 * c], ((0, 0), (1, 0), (0, 0)))[:, :S, :]
        g1 = _pad(h[:, :, 1 * c:2 * c], ((0, 0), (0, 1), (0, 0)))[:, 1:, :]
        g2 = _pad(h[:, :, 2 * c:3 * c], ((0, 0), (2, 0), (0, 0)))[:, :S, :]
        g3 = _pad(h[:, :, 3 * c:], ((0, 0), (0, 2), (0, 0)))[:, 2:, :]
        hs = torch.concatenate([g0, g1, g2, g3], axis=-1) @ w2
        x1 = x + hs
        h2 = _gelu(_layernorm(x1, axis=-1) @ w3) @ w4
        return x1 + h2
    x = A_x
    xn = _layernorm(x, axis=-1)
    s = _A_ref(xn, A_mem0, A_Wq, A_Wk, A_Wv, A_Wo, A_seg_len)
    g = _silu(_B_ref(xn, B_w1, B_w2, B_w3, B_w4))
    return x + s * g
```

```asm
; @launch kernel=main_kernel grid=(256,1,1) block=(256,1,1) lds=163840
.amdgcn_target "amdgcn-amd-amdhsa--gfx950"
.text
.text
.globl main_kernel
.p2align 8
.type main_kernel,@function
main_kernel:
    s_load_dwordx4 s[20:23], s[0:1], 104
    s_load_dwordx8 s[40:47], s[0:1], 16
    s_load_dwordx8 s[64:71], s[0:1], 64
    s_load_dwordx2 s[72:73], s[0:1], 0
    s_load_dwordx2 s[74:75], s[0:1], 96
    s_load_dwordx2 s[76:77], s[0:1], 8
    s_cmp_ge_u32 s2, 256
    s_cbranch_scc1 main_kernel_end
    v_lshrrev_b32 v126, 6, v0
    v_and_b32 v94, 63, v0
    v_and_b32 v250, 63, v0
    v_readfirstlane_b32 s14, v126
    s_mov_b32 s29, 0x80000
    s_waitcnt lgkmcnt(0)
    s_mov_b32 s60, s20
    s_and_b32 s61, s21, 0xffff
    s_mov_b32 s62, 0x100
    s_mov_b32 s63, 0x20000
    s_mov_b32 s4, s22
    s_and_b32 s5, s23, 0xffff
    s_mov_b32 s6, 0x10000000
    s_mov_b32 s7, 0x20000
    s_cmp_lg_u32 s14, 0
    s_cbranch_scc1 main_kernel_slot_wait
    s_getreg_b32 s12, hwreg(HW_REG_XCC_ID, 0, 4)
    s_and_b32 s12, s12, 7
    s_lshl_b32 s32, s12, 5
    v_mov_b32 v126, 0
    v_mov_b32 v127, 1
    s_mov_b64 exec, 1
    buffer_atomic_add v127, v126, s[60:63], s32 offen sc0 sc1
    s_waitcnt vmcnt(0)
    s_mov_b64 exec, -1
    v_readfirstlane_b32 s13, v127
    s_nop 3
    s_cmp_lt_u32 s13, 32
    s_cbranch_scc1 main_kernel_slot_pub
    v_and_b32 v126, 7, v94
    v_lshlrev_b32 v126, 5, v126
main_kernel_ovf_cnt:
    buffer_load_dword v127, v126, s[60:63], 0 offen sc1
    s_waitcnt vmcnt(0)
    v_readlane_b32 s48, v127, 0
    v_readlane_b32 s49, v127, 1
    v_readlane_b32 s50, v127, 2
    v_readlane_b32 s51, v127, 3
    v_readlane_b32 s52, v127, 4
    v_readlane_b32 s53, v127, 5
    v_readlane_b32 s54, v127, 6
    v_readlane_b32 s55, v127, 7
    s_nop 3
    s_add_u32 s33, s48, s49
    s_add_u32 s33, s33, s50
    s_add_u32 s33, s33, s51
    s_add_u32 s33, s33, s52
    s_add_u32 s33, s33, s53
    s_add_u32 s33, s33, s54
    s_add_u32 s33, s33, s55
    s_cmp_ge_u32 s33, 256
    s_cbranch_scc1 main_kernel_ovf_cnt_ok
    s_sub_u32 s29, s29, 1
    s_cbranch_scc1 main_kernel_end
    s_sleep 4
    s_branch main_kernel_ovf_cnt
main_kernel_ovf_cnt_ok:
    v_mov_b32 v126, 0
    v_mov_b32 v127, 1
    s_mov_b64 exec, 1
    buffer_atomic_add v127, v126, s[60:63], 0 offen offset:8 sc0 sc1
    s_waitcnt vmcnt(0)
    s_mov_b64 exec, -1
    v_readfirstlane_b32 s33, v127
    s_nop 3
    s_min_u32 s34, s48, 32
    s_sub_u32 s35, 32, s34
    s_mov_b32 s12, 0
    s_add_u32 s13, s34, s33
    s_cmp_lt_u32 s33, s35
    s_cbranch_scc1 main_kernel_slot_pub
    s_sub_u32 s33, s33, s35
    s_min_u32 s34, s49, 32
    s_sub_u32 s35, 32, s34
    s_mov_b32 s12, 1
    s_add_u32 s13, s34, s33
    s_cmp_lt_u32 s33, s35
    s_cbranch_scc1 main_kernel_slot_pub
    s_sub_u32 s33, s33, s35
    s_min_u32 s34, s50, 32
    s_sub_u32 s35, 32, s34
    s_mov_b32 s12, 2
    s_add_u32 s13, s34, s33
    s_cmp_lt_u32 s33, s35
    s_cbranch_scc1 main_kernel_slot_pub
    s_sub_u32 s33, s33, s35
    s_min_u32 s34, s51, 32
    s_sub_u32 s35, 32, s34
    s_mov_b32 s12, 3
    s_add_u32 s13, s34, s33
    s_cmp_lt_u32 s33, s35
    s_cbranch_scc1 main_kernel_slot_pub
    s_sub_u32 s33, s33, s35
    s_min_u32 s34, s52, 32
    s_sub_u32 s35, 32, s34
    s_mov_b32 s12, 4
    s_add_u32 s13, s34, s33
    s_cmp_lt_u32 s33, s35
    s_cbranch_scc1 main_kernel_slot_pub
    s_sub_u32 s33, s33, s35
    s_min_u32 s34, s53, 32
    s_sub_u32 s35, 32, s34
    s_mov_b32 s12, 5
    s_add_u32 s13, s34, s33
    s_cmp_lt_u32 s33, s35
    s_cbranch_scc1 main_kernel_slot_pub
    s_sub_u32 s33, s33, s35
    s_min_u32 s34, s54, 32
    s_sub_u32 s35, 32, s34
    s_mov_b32 s12, 6
    s_add_u32 s13, s34, s33
    s_cmp_lt_u32 s33, s35
    s_cbranch_scc1 main_kernel_slot_pub
    s_sub_u32 s33, s33, s35
    s_min_u32 s34, s55, 32
    s_sub_u32 s35, 32, s34
    s_mov_b32 s12, 7
    s_add_u32 s13, s34, s33
    s_cmp_lt_u32 s33, s35
    s_cbranch_scc1 main_kernel_slot_pub
    s_sub_u32 s33, s33, s35
    s_mov_b32 s12, 8
    s_mov_b32 s13, 0
main_kernel_slot_pub:
    v_mov_b32 v126, 0
    v_mov_b32 v127, s12
    v_mov_b32 v95, s13
    ds_write_b32 v126, v127
    ds_write_b32 v126, v95 offset:4
    s_waitcnt lgkmcnt(0)
main_kernel_slot_wait:
    s_barrier
    v_mov_b32 v126, 0
    ds_read_b32 v127, v126
    ds_read_b32 v95, v126 offset:4
    s_waitcnt lgkmcnt(0)
    v_readfirstlane_b32 s12, v127
    v_readfirstlane_b32 s13, v95
    s_nop 3
    s_barrier
    s_cmp_ge_u32 s12, 8
    s_cbranch_scc1 main_kernel_end
    s_cmp_lt_u32 s12, 2
    s_cbranch_scc1 main_kernel_chain
    s_mov_b32 s96, s72
    s_and_b32 s97, s73, 0xffff
    s_mov_b32 s98, 0x400000
    s_mov_b32 s99, 0x20000
    s_mov_b32 s92, s74
    s_and_b32 s93, s75, 0xffff
    s_mov_b32 s94, 0x400000
    s_mov_b32 s95, 0x20000
    v_lshlrev_b32 v1, 4, v0
    v_lshlrev_b32 v251, 4, v250
    v_mov_b32 v4, 0
    v_mov_b32 v8, -1
    v_mov_b32 v5, 0
    v_mov_b32 v9, -1
    v_mov_b32 v6, 0
    v_mov_b32 v10, -1
    v_mov_b32 v7, 0
    v_mov_b32 v11, -1
    v_mul_u32_u24 v12, 128, v0
    s_lshl_b32 s15, s12, 4
    s_and_b32 s32, s12, 1
    s_lshl_b32 s32, s32, 5
    s_cmp_lt_u32 s12, 4
    s_cselect_b32 s15, s32, s15
    s_cselect_b32 s32, 32, 16
    s_add_u32 s15, s15, s13
    s_sub_u32 s16, s15, 80
    s_sub_u32 s27, s12, 2
    s_mov_b32 s52, 0
    s_cmp_lt_u32 s13, s32
    s_cbranch_scc1 main_kernel_s_ln
    s_cmp_lg_u32 s13, 16
    s_cbranch_scc1 main_kernel_s_fill
    s_lshl_b32 s32, s16, 11
    s_add_u32 s32, s32, 0x8400000
    buffer_store_dwordx4 v[4:7], v1, s[4:7], s32 offen sc1
    s_add_u32 s32, s32, 4096
    buffer_store_dwordx4 v[4:7], v1, s[4:7], s32 offen sc1
    s_add_u32 s32, s32, 4096
    buffer_store_dwordx4 v[4:7], v1, s[4:7], s32 offen sc1
    s_add_u32 s32, s32, 4096
    buffer_store_dwordx4 v[4:7], v1, s[4:7], s32 offen sc1
    s_add_u32 s32, s32, 4096
    buffer_store_dwordx4 v[4:7], v1, s[4:7], s32 offen sc1
    s_add_u32 s32, s32, 4096
    buffer_store_dwordx4 v[4:7], v1, s[4:7], s32 offen sc1
    s_add_u32 s32, s32, 4096
    buffer_store_dwordx4 v[4:7], v1, s[4:7], s32 offen sc1
    s_add_u32 s32, s32, 4096
    buffer_store_dwordx4 v[4:7], v1, s[4:7], s32 offen sc1
    s_add_u32 s32, s32, 4096
    v_bfe_u32 v2, v0, 2, 1
    s_lshr_b32 s32, s14, 1
    v_and_b32 v2, s32, v2
    s_bitcmp1_b32 s14, 0
    s_cselect_b32 s32, 15, 0
    s_cselect_b32 s33, 4161536, 0
    v_xor_b32 v2, s32, v2
    v_lshlrev_b32 v2, 4, v2
    v_and_b32 v3, 3, v0
    v_lshl_add_u32 v2, v3, 8, v2
    v_lshrrev_b32 v3, 3, v0
    v_lshl_add_u32 v2, v3, 10, v2
    s_add_u32 s33, s33, 0x4808000
    buffer_store_dwordx4 v[4:7], v2, s[4:7], s33 offen sc1
    s_waitcnt vmcnt(0)
    s_barrier
    s_cmp_lg_u32 s14, 0
    s_cbranch_scc1 main_kernel_s_fill
    v_mov_b32 v2, 1
    s_mov_b64 exec, 1
    buffer_atomic_add v2, v4, s[60:63], 0 offen offset:12 sc1
    s_mov_b64 exec, -1
    s_branch main_kernel_s_fill
main_kernel_s_ln:
    v_and_b32 v3, 15, v250
    v_and_b32 v2, 48, v250
    v_lshl_add_u32 v3, v3, 11, v2
    s_lshl_b32 s34, s15, 15
    s_lshl_b32 s32, s14, 9
    s_add_u32 s32, s34, s32
    buffer_load_dwordx4 v[32:35], v3, s[96:99], s32 offen offset:0
    buffer_load_dwordx4 v[36:39], v3, s[96:99], s32 offen offset:64
    buffer_load_dwordx4 v[40:43], v3, s[96:99], s32 offen offset:128
    buffer_load_dwordx4 v[44:47], v3, s[96:99], s32 offen offset:192
    buffer_load_dwordx4 v[48:51], v3, s[96:99], s32 offen offset:256
    buffer_load_dwordx4 v[52:55], v3, s[96:99], s32 offen offset:320
    buffer_load_dwordx4 v[56:59], v3, s[96:99], s32 offen offset:384
    buffer_load_dwordx4 v[60:63], v3, s[96:99], s32 offen offset:448
    v_and_b32 v255, 15, v250
    v_lshlrev_b32 v254, 6, v255
    v_add_u32 v254, 132096, v254
    v_lshrrev_b32 v255, 4, v250
    v_lshl_add_u32 v253, v255, 2, v254
    v_lshl_add_u32 v253, s14, 4, v253
    s_lshl_b32 s32, s14, 13
    s_add_u32 s34, s34, s32
    s_waitcnt vmcnt(0)
    v_permlane16_swap_b32 v32, v34
    v_permlane16_swap_b32 v33, v35
    v_permlane16_swap_b32 v36, v38
    v_permlane16_swap_b32 v37, v39
    v_permlane16_swap_b32 v40, v42
    v_permlane16_swap_b32 v41, v43
    v_permlane16_swap_b32 v44, v46
    v_permlane16_swap_b32 v45, v47
    v_permlane16_swap_b32 v48, v50
    v_permlane16_swap_b32 v49, v51
    v_permlane16_swap_b32 v52, v54
    v_permlane16_swap_b32 v53, v55
    v_permlane16_swap_b32 v56, v58
    v_permlane16_swap_b32 v57, v59
    v_permlane16_swap_b32 v60, v62
    v_permlane16_swap_b32 v61, v63
    v_permlane32_swap_b32 v32, v34
    v_permlane32_swap_b32 v33, v35
    v_permlane32_swap_b32 v36, v38
    v_permlane32_swap_b32 v37, v39
    v_permlane32_swap_b32 v40, v42
    v_permlane32_swap_b32 v41, v43
    v_permlane32_swap_b32 v44, v46
    v_permlane32_swap_b32 v45, v47
    v_permlane32_swap_b32 v48, v50
    v_permlane32_swap_b32 v49, v51
    v_permlane32_swap_b32 v52, v54
    v_permlane32_swap_b32 v53, v55
    v_permlane32_swap_b32 v56, v58
    v_permlane32_swap_b32 v57, v59
    v_permlane32_swap_b32 v60, v62
    v_permlane32_swap_b32 v61, v63
    s_lshr_b32 s32, s15, 3
    s_lshl_b32 s32, s32, 9
    s_and_b32 s33, s15, 7
    s_lshl_b32 s33, s33, 4
    s_add_u32 s32, s32, s33
    s_add_u32 s16, s32, 0x8416000
    v_lshlrev_b32 v64, 16, v32
    v_and_b32 v65, 0xffff0000, v32
    v_lshlrev_b32 v66, 16, v33
    v_and_b32 v67, 0xffff0000, v33
    v_lshlrev_b32 v68, 16, v34
    v_and_b32 v69, 0xffff0000, v34
    v_lshlrev_b32 v70, 16, v35
    v_and_b32 v71, 0xffff0000, v35
    v_lshlrev_b32 v72, 16, v36
    v_and_b32 v73, 0xffff0000, v36
    v_lshlrev_b32 v74, 16, v37
    v_and_b32 v75, 0xffff0000, v37
    v_lshlrev_b32 v76, 16, v38
    v_and_b32 v77, 0xffff0000, v38
    v_lshlrev_b32 v78, 16, v39
    v_and_b32 v79, 0xffff0000, v39
    v_lshlrev_b32 v80, 16, v40
    v_and_b32 v81, 0xffff0000, v40
    v_lshlrev_b32 v82, 16, v41
    v_and_b32 v83, 0xffff0000, v41
    v_lshlrev_b32 v84, 16, v42
    v_and_b32 v85, 0xffff0000, v42
    v_lshlrev_b32 v86, 16, v43
    v_and_b32 v87, 0xffff0000, v43
    v_lshlrev_b32 v88, 16, v44
    v_and_b32 v89, 0xffff0000, v44
    v_lshlrev_b32 v90, 16, v45
    v_and_b32 v91, 0xffff0000, v45
    v_lshlrev_b32 v92, 16, v46
    v_and_b32 v93, 0xffff0000, v46
    v_lshlrev_b32 v94, 16, v47
    v_and_b32 v95, 0xffff0000, v47
    v_lshlrev_b32 v96, 16, v48
    v_and_b32 v97, 0xffff0000, v48
    v_lshlrev_b32 v98, 16, v49
    v_and_b32 v99, 0xffff0000, v49
    v_lshlrev_b32 v100, 16, v50
    v_and_b32 v101, 0xffff0000, v50
    v_lshlrev_b32 v102, 16, v51
    v_and_b32 v103, 0xffff0000, v51
    v_lshlrev_b32 v104, 16, v52
    v_and_b32 v105, 0xffff0000, v52
    v_lshlrev_b32 v106, 16, v53
    v_and_b32 v107, 0xffff0000, v53
    v_lshlrev_b32 v108, 16, v54
    v_and_b32 v109, 0xffff0000, v54
    v_lshlrev_b32 v110, 16, v55
    v_and_b32 v111, 0xffff0000, v55
    v_lshlrev_b32 v112, 16, v56
    v_and_b32 v113, 0xffff0000, v56
    v_lshlrev_b32 v114, 16, v57
    v_and_b32 v115, 0xffff0000, v57
    v_lshlrev_b32 v116, 16, v58
    v_and_b32 v117, 0xffff0000, v58
    v_lshlrev_b32 v118, 16, v59
    v_and_b32 v119, 0xffff0000, v59
    v_lshlrev_b32 v120, 16, v60
    v_and_b32 v121, 0xffff0000, v60
    v_lshlrev_b32 v122, 16, v61
    v_and_b32 v123, 0xffff0000, v61
    v_lshlrev_b32 v124, 16, v62
    v_and_b32 v125, 0xffff0000, v62
    v_lshlrev_b32 v126, 16, v63
    v_and_b32 v127, 0xffff0000, v63
    v_pk_add_f32 v[16:17], v[64:65], v[72:73]
    v_pk_add_f32 v[18:19], v[66:67], v[74:75]
    v_pk_add_f32 v[20:21], v[68:69], v[76:77]
    v_pk_add_f32 v[22:23], v[70:71], v[78:79]
    v_pk_add_f32 v[16:17], v[16:17], v[80:81]
    v_pk_add_f32 v[18:19], v[18:19], v[82:83]
    v_pk_add_f32 v[20:21], v[20:21], v[84:85]
    v_pk_add_f32 v[22:23], v[22:23], v[86:87]
    v_pk_add_f32 v[16:17], v[16:17], v[88:89]
    v_pk_add_f32 v[18:19], v[18:19], v[90:91]
    v_pk_add_f32 v[20:21], v[20:21], v[92:93]
    v_pk_add_f32 v[22:23], v[22:23], v[94:95]
    v_pk_add_f32 v[16:17], v[16:17], v[96:97]
    v_pk_add_f32 v[18:19], v[18:19], v[98:99]
    v_pk_add_f32 v[20:21], v[20:21], v[100:101]
    v_pk_add_f32 v[22:23], v[22:23], v[102:103]
    v_pk_add_f32 v[16:17], v[16:17], v[104:105]
    v_pk_add_f32 v[18:19], v[18:19], v[106:107]
    v_pk_add_f32 v[20:21], v[20:21], v[108:109]
    v_pk_add_f32 v[22:23], v[22:23], v[110:111]
    v_pk_add_f32 v[16:17], v[16:17], v[112:113]
    v_pk_add_f32 v[18:19], v[18:19], v[114:115]
    v_pk_add_f32 v[20:21], v[20:21], v[116:117]
    v_pk_add_f32 v[22:23], v[22:23], v[118:119]
    v_pk_add_f32 v[16:17], v[16:17], v[120:121]
    v_pk_add_f32 v[18:19], v[18:19], v[122:123]
    v_pk_add_f32 v[20:21], v[20:21], v[124:125]
    v_pk_add_f32 v[22:23], v[22:23], v[126:127]
    v_pk_add_f32 v[16:17], v[16:17], v[18:19]
    v_pk_add_f32 v[20:21], v[20:21], v[22:23]
    v_pk_add_f32 v[16:17], v[16:17], v[20:21]
    v_add_f32 v16, v16, v17
    ds_write_b32 v253, v16 offset:0
    s_waitcnt lgkmcnt(0)
    s_barrier
    ds_read_b128 v[16:19], v254 offset:0
    ds_read_b128 v[20:23], v254 offset:16
    ds_read_b128 v[24:27], v254 offset:32
    ds_read_b128 v[28:31], v254 offset:48
    s_waitcnt lgkmcnt(2)
    v_pk_add_f32 v[16:17], v[16:17], v[18:19]
    v_pk_add_f32 v[20:21], v[20:21], v[22:23]
    s_waitcnt lgkmcnt(0)
    v_pk_add_f32 v[24:25], v[24:25], v[26:27]
    v_pk_add_f32 v[28:29], v[28:29], v[30:31]
    v_pk_add_f32 v[16:17], v[16:17], v[20:21]
    v_pk_add_f32 v[24:25], v[24:25], v[28:29]
    v_pk_add_f32 v[16:17], v[16:17], v[24:25]
    v_add_f32 v16, v16, v17
    v_mul_f32 v16, 0xba800000, v16
    v_mov_b32 v17, v16
    v_pk_add_f32 v[64:65], v[64:65], v[16:17]
    v_pk_add_f32 v[66:67], v[66:67], v[16:17]
    v_pk_add_f32 v[68:69], v[68:69], v[16:17]
    v_pk_add_f32 v[70:71], v[70:71], v[16:17]
    v_pk_add_f32 v[72:73], v[72:73], v[16:17]
    v_pk_add_f32 v[74:75], v[74:75], v[16:17]
    v_pk_add_f32 v[76:77], v[76:77], v[16:17]
    v_pk_add_f32 v[78:79], v[78:79], v[16:17]
    v_pk_add_f32 v[80:81], v[80:81], v[16:17]
    v_pk_add_f32 v[82:83], v[82:83], v[16:17]
    v_pk_add_f32 v[84:85], v[84:85], v[16:17]
    v_pk_add_f32 v[86:87], v[86:87], v[16:17]
    v_pk_add_f32 v[88:89], v[88:89], v[16:17]
    v_pk_add_f32 v[90:91], v[90:91], v[16:17]
    v_pk_add_f32 v[92:93], v[92:93], v[16:17]
    v_pk_add_f32 v[94:95], v[94:95], v[16:17]
    v_pk_add_f32 v[96:97], v[96:97], v[16:17]
    v_pk_add_f32 v[98:99], v[98:99], v[16:17]
    v_pk_add_f32 v[100:101], v[100:101], v[16:17]
    v_pk_add_f32 v[102:103], v[102:103], v[16:17]
    v_pk_add_f32 v[104:105], v[104:105], v[16:17]
    v_pk_add_f32 v[106:107], v[106:107], v[16:17]
    v_pk_add_f32 v[108:109], v[108:109], v[16:17]
    v_pk_add_f32 v[110:111], v[110:111], v[16:17]
    v_pk_add_f32 v[112:113], v[112:113], v[16:17]
    v_pk_add_f32 v[114:115], v[114:115], v[16:17]
    v_pk_add_f32 v[116:117], v[116:117], v[16:17]
    v_pk_add_f32 v[118:119], v[118:119], v[16:17]
    v_pk_add_f32 v[120:121], v[120:121], v[16:17]
    v_pk_add_f32 v[122:123], v[122:123], v[16:17]
    v_pk_add_f32 v[124:125], v[124:125], v[16:17]
    v_pk_add_f32 v[126:127], v[126:127], v[16:17]
    v_pk_mul_f32 v[16:17], v[64:65], v[64:65]
    v_pk_mul_f32 v[18:19], v[66:67], v[66:67]
    v_pk_mul_f32 v[20:21], v[68:69], v[68:69]
    v_pk_mul_f32 v[22:23], v[70:71], v[70:71]
    v_pk_fma_f32 v[16:17], v[72:73], v[72:73], v[16:17]
    v_pk_fma_f32 v[18:19], v[74:75], v[74:75], v[18:19]
    v_pk_fma_f32 v[20:21], v[76:77], v[76:77], v[20:21]
    v_pk_fma_f32 v[22:23], v[78:79], v[78:79], v[22:23]
    v_pk_fma_f32 v[16:17], v[80:81], v[80:81], v[16:17]
    v_pk_fma_f32 v[18:19], v[82:83], v[82:83], v[18:19]
    v_pk_fma_f32 v[20:21], v[84:85], v[84:85], v[20:21]
    v_pk_fma_f32 v[22:23], v[86:87], v[86:87], v[22:23]
    v_pk_fma_f32 v[16:17], v[88:89], v[88:89], v[16:17]
    v_pk_fma_f32 v[18:19], v[90:91], v[90:91], v[18:19]
    v_pk_fma_f32 v[20:21], v[92:93], v[92:93], v[20:21]
    v_pk_fma_f32 v[22:23], v[94:95], v[94:95], v[22:23]
    v_pk_fma_f32 v[16:17], v[96:97], v[96:97], v[16:17]
    v_pk_fma_f32 v[18:19], v[98:99], v[98:99], v[18:19]
    v_pk_fma_f32 v[20:21], v[100:101], v[100:101], v[20:21]
    v_pk_fma_f32 v[22:23], v[102:103], v[102:103], v[22:23]
    v_pk_fma_f32 v[16:17], v[104:105], v[104:105], v[16:17]
    v_pk_fma_f32 v[18:19], v[106:107], v[106:107], v[18:19]
    v_pk_fma_f32 v[20:21], v[108:109], v[108:109], v[20:21]
    v_pk_fma_f32 v[22:23], v[110:111], v[110:111], v[22:23]
    v_pk_fma_f32 v[16:17], v[112:113], v[112:113], v[16:17]
    v_pk_fma_f32 v[18:19], v[114:115], v[114:115], v[18:19]
    v_pk_fma_f32 v[20:21], v[116:117], v[116:117], v[20:21]
    v_pk_fma_f32 v[22:23], v[118:119], v[118:119], v[22:23]
    v_pk_fma_f32 v[16:17], v[120:121], v[120:121], v[16:17]
    v_pk_fma_f32 v[18:19], v[122:123], v[122:123], v[18:19]
    v_pk_fma_f32 v[20:21], v[124:125], v[124:125], v[20:21]
    v_pk_fma_f32 v[22:23], v[126:127], v[126:127], v[22:23]
    v_pk_add_f32 v[16:17], v[16:17], v[18:19]
    v_pk_add_f32 v[20:21], v[20:21], v[22:23]
    v_pk_add_f32 v[16:17], v[16:17], v[20:21]
    v_add_f32 v16, v16, v17
    ds_write_b32 v253, v16 offset:1024
    s_waitcnt lgkmcnt(0)
    s_barrier
    ds_read_b128 v[16:19], v254 offset:1024
    ds_read_b128 v[20:23], v254 offset:1040
    ds_read_b128 v[24:27], v254 offset:1056
    ds_read_b128 v[28:31], v254 offset:1072
    s_waitcnt lgkmcnt(2)
    v_pk_add_f32 v[16:17], v[16:17], v[18:19]
    v_pk_add_f32 v[20:21], v[20:21], v[22:23]
    s_waitcnt lgkmcnt(0)
    v_pk_add_f32 v[24:25], v[24:25], v[26:27]
    v_pk_add_f32 v[28:29], v[28:29], v[30:31]
    v_pk_add_f32 v[16:17], v[16:17], v[20:21]
    v_pk_add_f32 v[24:25], v[24:25], v[28:29]
    v_pk_add_f32 v[16:17], v[16:17], v[24:25]
    v_add_f32 v16, v16, v17
    v_mov_b32 v17, 0x3727c5ac
    v_fmac_f32 v17, 0x3a800000, v16
    v_rsq_f32 v16, v17
    s_nop 0
    v_mov_b32 v17, v16
    v_pk_mul_f32 v[64:65], v[64:65], v[16:17]
    v_pk_mul_f32 v[66:67], v[66:67], v[16:17]
    v_pk_mul_f32 v[68:69], v[68:69], v[16:17]
    v_pk_mul_f32 v[70:71], v[70:71], v[16:17]
    v_pk_mul_f32 v[72:73], v[72:73], v[16:17]
    v_pk_mul_f32 v[74:75], v[74:75], v[16:17]
    v_pk_mul_f32 v[76:77], v[76:77], v[16:17]
    v_pk_mul_f32 v[78:79], v[78:79], v[16:17]
    v_pk_mul_f32 v[80:81], v[80:81], v[16:17]
    v_pk_mul_f32 v[82:83], v[82:83], v[16:17]
    v_pk_mul_f32 v[84:85], v[84:85], v[16:17]
    v_pk_mul_f32 v[86:87], v[86:87], v[16:17]
    v_pk_mul_f32 v[88:89], v[88:89], v[16:17]
    v_pk_mul_f32 v[90:91], v[90:91], v[16:17]
    v_pk_mul_f32 v[92:93], v[92:93], v[16:17]
    v_pk_mul_f32 v[94:95], v[94:95], v[16:17]
    v_pk_mul_f32 v[96:97], v[96:97], v[16:17]
    v_pk_mul_f32 v[98:99], v[98:99], v[16:17]
    v_pk_mul_f32 v[100:101], v[100:101], v[16:17]
    v_pk_mul_f32 v[102:103], v[102:103], v[16:17]
    v_pk_mul_f32 v[104:105], v[104:105], v[16:17]
    v_pk_mul_f32 v[106:107], v[106:107], v[16:17]
    v_pk_mul_f32 v[108:109], v[108:109], v[16:17]
    v_pk_mul_f32 v[110:111], v[110:111], v[16:17]
    v_pk_mul_f32 v[112:113], v[112:113], v[16:17]
    v_pk_mul_f32 v[114:115], v[114:115], v[16:17]
    v_pk_mul_f32 v[116:117], v[116:117], v[16:17]
    v_pk_mul_f32 v[118:119], v[118:119], v[16:17]
    v_pk_mul_f32 v[120:121], v[120:121], v[16:17]
    v_pk_mul_f32 v[122:123], v[122:123], v[16:17]
    v_pk_mul_f32 v[124:125], v[124:125], v[16:17]
    v_pk_mul_f32 v[126:127], v[126:127], v[16:17]
    v_cvt_pk_bf16_f32 v128, v64, v65
    v_cvt_pk_bf16_f32 v129, v66, v67
    v_cvt_pk_bf16_f32 v130, v68, v69
    v_cvt_pk_bf16_f32 v131, v70, v71
    v_cvt_pk_bf16_f32 v132, v72, v73
    v_cvt_pk_bf16_f32 v133, v74, v75
    v_cvt_pk_bf16_f32 v134, v76, v77
    v_cvt_pk_bf16_f32 v135, v78, v79
    v_cvt_pk_bf16_f32 v136, v80, v81
    v_cvt_pk_bf16_f32 v137, v82, v83
    v_cvt_pk_bf16_f32 v138, v84, v85
    v_cvt_pk_bf16_f32 v139, v86, v87
    v_cvt_pk_bf16_f32 v140, v88, v89
    v_cvt_pk_bf16_f32 v141, v90, v91
    v_cvt_pk_bf16_f32 v142, v92, v93
    v_cvt_pk_bf16_f32 v143, v94, v95
    v_cvt_pk_bf16_f32 v144, v96, v97
    v_cvt_pk_bf16_f32 v145, v98, v99
    v_cvt_pk_bf16_f32 v146, v100, v101
    v_cvt_pk_bf16_f32 v147, v102, v103
    v_cvt_pk_bf16_f32 v148, v104, v105
    v_cvt_pk_bf16_f32 v149, v106, v107
    v_cvt_pk_bf16_f32 v150, v108, v109
    v_cvt_pk_bf16_f32 v151, v110, v111
    v_cvt_pk_bf16_f32 v152, v112, v113
    v_cvt_pk_bf16_f32 v153, v114, v115
    v_cvt_pk_bf16_f32 v154, v116, v117
    v_cvt_pk_bf16_f32 v155, v118, v119
    v_cvt_pk_bf16_f32 v156, v120, v121
    v_cvt_pk_bf16_f32 v157, v122, v123
    v_cvt_pk_bf16_f32 v158, v124, v125
    v_cvt_pk_bf16_f32 v159, v126, v127
    s_add_u32 s32, s34, 0x0
    s_add_u32 s33, s32, 4096
    buffer_store_dwordx4 v[128:131], v251, s[4:7], s32 offen offset:0 sc1
    buffer_store_dwordx4 v[132:135], v251, s[4:7], s32 offen offset:1024 sc1
    buffer_store_dwordx4 v[136:139], v251, s[4:7], s32 offen offset:2048 sc1
    buffer_store_dwordx4 v[140:143], v251, s[4:7], s32 offen offset:3072 sc1
    buffer_store_dwordx4 v[144:147], v251, s[4:7], s33 offen offset:0 sc1
    buffer_store_dwordx4 v[148:151], v251, s[4:7], s33 offen offset:1024 sc1
    buffer_store_dwordx4 v[152:155], v251, s[4:7], s33 offen offset:2048 sc1
    buffer_store_dwordx4 v[156:159], v251, s[4:7], s33 offen offset:3072 sc1
    buffer_load_dword v2, v4, s[60:63], 0 offen offset:12 sc1
    v_lshlrev_b32 v64, 16, v128
    v_and_b32 v65, 0xffff0000, v128
    v_lshlrev_b32 v66, 16, v129
    v_and_b32 v67, 0xffff0000, v129
    v_lshlrev_b32 v68, 16, v130
    v_and_b32 v69, 0xffff0000, v130
    v_lshlrev_b32 v70, 16, v131
    v_and_b32 v71, 0xffff0000, v131
    v_lshlrev_b32 v72, 16, v132
    v_and_b32 v73, 0xffff0000, v132
    v_lshlrev_b32 v74, 16, v133
    v_and_b32 v75, 0xffff0000, v133
    v_lshlrev_b32 v76, 16, v134
    v_and_b32 v77, 0xffff0000, v134
    v_lshlrev_b32 v78, 16, v135
    v_and_b32 v79, 0xffff0000, v135
    v_lshlrev_b32 v80, 16, v136
    v_and_b32 v81, 0xffff0000, v136
    v_lshlrev_b32 v82, 16, v137
    v_and_b32 v83, 0xffff0000, v137
    v_lshlrev_b32 v84, 16, v138
    v_and_b32 v85, 0xffff0000, v138
    v_lshlrev_b32 v86, 16, v139
    v_and_b32 v87, 0xffff0000, v139
    v_lshlrev_b32 v88, 16, v140
    v_and_b32 v89, 0xffff0000, v140
    v_lshlrev_b32 v90, 16, v141
    v_and_b32 v91, 0xffff0000, v141
    v_lshlrev_b32 v92, 16, v142
    v_and_b32 v93, 0xffff0000, v142
    v_lshlrev_b32 v94, 16, v143
    v_and_b32 v95, 0xffff0000, v143
    v_lshlrev_b32 v96, 16, v144
    v_and_b32 v97, 0xffff0000, v144
    v_lshlrev_b32 v98, 16, v145
    v_and_b32 v99, 0xffff0000, v145
    v_lshlrev_b32 v100, 16, v146
    v_and_b32 v101, 0xffff0000, v146
    v_lshlrev_b32 v102, 16, v147
    v_and_b32 v103, 0xffff0000, v147
    v_lshlrev_b32 v104, 16, v148
    v_and_b32 v105, 0xffff0000, v148
    v_lshlrev_b32 v106, 16, v149
    v_and_b32 v107, 0xffff0000, v149
    v_lshlrev_b32 v108, 16, v150
    v_and_b32 v109, 0xffff0000, v150
    v_lshlrev_b32 v110, 16, v151
    v_and_b32 v111, 0xffff0000, v151
    v_lshlrev_b32 v112, 16, v152
    v_and_b32 v113, 0xffff0000, v152
    v_lshlrev_b32 v114, 16, v153
    v_and_b32 v115, 0xffff0000, v153
    v_lshlrev_b32 v116, 16, v154
    v_and_b32 v117, 0xffff0000, v154
    v_lshlrev_b32 v118, 16, v155
    v_and_b32 v119, 0xffff0000, v155
    v_lshlrev_b32 v120, 16, v156
    v_and_b32 v121, 0xffff0000, v156
    v_lshlrev_b32 v122, 16, v157
    v_and_b32 v123, 0xffff0000, v157
    v_lshlrev_b32 v124, 16, v158
    v_and_b32 v125, 0xffff0000, v158
    v_lshlrev_b32 v126, 16, v159
    v_and_b32 v127, 0xffff0000, v159
    v_pk_add_f32 v[16:17], v[64:65], v[72:73]
    v_pk_add_f32 v[18:19], v[66:67], v[74:75]
    v_pk_add_f32 v[20:21], v[68:69], v[76:77]
    v_pk_add_f32 v[22:23], v[70:71], v[78:79]
    v_pk_add_f32 v[16:17], v[16:17], v[80:81]
    v_pk_add_f32 v[18:19], v[18:19], v[82:83]
    v_pk_add_f32 v[20:21], v[20:21], v[84:85]
    v_pk_add_f32 v[22:23], v[22:23], v[86:87]
    v_pk_add_f32 v[16:17], v[16:17], v[88:89]
    v_pk_add_f32 v[18:19], v[18:19], v[90:91]
    v_pk_add_f32 v[20:21], v[20:21], v[92:93]
    v_pk_add_f32 v[22:23], v[22:23], v[94:95]
    v_pk_add_f32 v[16:17], v[16:17], v[96:97]
    v_pk_add_f32 v[18:19], v[18:19], v[98:99]
    v_pk_add_f32 v[20:21], v[20:21], v[100:101]
    v_pk_add_f32 v[22:23], v[22:23], v[102:103]
    v_pk_add_f32 v[16:17], v[16:17], v[104:105]
    v_pk_add_f32 v[18:19], v[18:19], v[106:107]
    v_pk_add_f32 v[20:21], v[20:21], v[108:109]
    v_pk_add_f32 v[22:23], v[22:23], v[110:111]
    v_pk_add_f32 v[16:17], v[16:17], v[112:113]
    v_pk_add_f32 v[18:19], v[18:19], v[114:115]
    v_pk_add_f32 v[20:21], v[20:21], v[116:117]
    v_pk_add_f32 v[22:23], v[22:23], v[118:119]
    v_pk_add_f32 v[16:17], v[16:17], v[120:121]
    v_pk_add_f32 v[18:19], v[18:19], v[122:123]
    v_pk_add_f32 v[20:21], v[20:21], v[124:125]
    v_pk_add_f32 v[22:23], v[22:23], v[126:127]
    v_pk_add_f32 v[16:17], v[16:17], v[18:19]
    v_pk_add_f32 v[20:21], v[20:21], v[22:23]
    v_pk_add_f32 v[16:17], v[16:17], v[20:21]
    v_add_f32 v16, v16, v17
    ds_write_b32 v253, v16 offset:0
    s_waitcnt lgkmcnt(0)
    s_barrier
    ds_read_b128 v[16:19], v254 offset:0
    ds_read_b128 v[20:23], v254 offset:16
    ds_read_b128 v[24:27], v254 offset:32
    ds_read_b128 v[28:31], v254 offset:48
    s_waitcnt lgkmcnt(2)
    v_pk_add_f32 v[16:17], v[16:17], v[18:19]
    v_pk_add_f32 v[20:21], v[20:21], v[22:23]
    s_waitcnt lgkmcnt(0)
    v_pk_add_f32 v[24:25], v[24:25], v[26:27]
    v_pk_add_f32 v[28:29], v[28:29], v[30:31]
    v_pk_add_f32 v[16:17], v[16:17], v[20:21]
    v_pk_add_f32 v[24:25], v[24:25], v[28:29]
    v_pk_add_f32 v[16:17], v[16:17], v[24:25]
    v_add_f32 v16, v16, v17
    v_mul_f32 v16, 0xba800000, v16
    v_mov_b32 v17, v16
    v_pk_add_f32 v[64:65], v[64:65], v[16:17]
    v_pk_add_f32 v[66:67], v[66:67], v[16:17]
    v_pk_add_f32 v[68:69], v[68:69], v[16:17]
    v_pk_add_f32 v[70:71], v[70:71], v[16:17]
    v_pk_add_f32 v[72:73], v[72:73], v[16:17]
    v_pk_add_f32 v[74:75], v[74:75], v[16:17]
    v_pk_add_f32 v[76:77], v[76:77], v[16:17]
    v_pk_add_f32 v[78:79], v[78:79], v[16:17]
    v_pk_add_f32 v[80:81], v[80:81], v[16:17]
    v_pk_add_f32 v[82:83], v[82:83], v[16:17]
    v_pk_add_f32 v[84:85], v[84:85], v[16:17]
    v_pk_add_f32 v[86:87], v[86:87], v[16:17]
    v_pk_add_f32 v[88:89], v[88:89], v[16:17]
    v_pk_add_f32 v[90:91], v[90:91], v[16:17]
    v_pk_add_f32 v[92:93], v[92:93], v[16:17]
    v_pk_add_f32 v[94:95], v[94:95], v[16:17]
    v_pk_add_f32 v[96:97], v[96:97], v[16:17]
    v_pk_add_f32 v[98:99], v[98:99], v[16:17]
    v_pk_add_f32 v[100:101], v[100:101], v[16:17]
    v_pk_add_f32 v[102:103], v[102:103], v[16:17]
    v_pk_add_f32 v[104:105], v[104:105], v[16:17]
    v_pk_add_f32 v[106:107], v[106:107], v[16:17]
    v_pk_add_f32 v[108:109], v[108:109], v[16:17]
    v_pk_add_f32 v[110:111], v[110:111], v[16:17]
    v_pk_add_f32 v[112:113], v[112:113], v[16:17]
    v_pk_add_f32 v[114:115], v[114:115], v[16:17]
    v_pk_add_f32 v[116:117], v[116:117], v[16:17]
    v_pk_add_f32 v[118:119], v[118:119], v[16:17]
    v_pk_add_f32 v[120:121], v[120:121], v[16:17]
    v_pk_add_f32 v[122:123], v[122:123], v[16:17]
    v_pk_add_f32 v[124:125], v[124:125], v[16:17]
    v_pk_add_f32 v[126:127], v[126:127], v[16:17]
    v_pk_mul_f32 v[16:17], v[64:65], v[64:65]
    v_pk_mul_f32 v[18:19], v[66:67], v[66:67]
    v_pk_mul_f32 v[20:21], v[68:69], v[68:69]
    v_pk_mul_f32 v[22:23], v[70:71], v[70:71]
    v_pk_fma_f32 v[16:17], v[72:73], v[72:73], v[16:17]
    v_pk_fma_f32 v[18:19], v[74:75], v[74:75], v[18:19]
    v_pk_fma_f32 v[20:21], v[76:77], v[76:77], v[20:21]
    v_pk_fma_f32 v[22:23], v[78:79], v[78:79], v[22:23]
    v_pk_fma_f32 v[16:17], v[80:81], v[80:81], v[16:17]
    v_pk_fma_f32 v[18:19], v[82:83], v[82:83], v[18:19]
    v_pk_fma_f32 v[20:21], v[84:85], v[84:85], v[20:21]
    v_pk_fma_f32 v[22:23], v[86:87], v[86:87], v[22:23]
    v_pk_fma_f32 v[16:17], v[88:89], v[88:89], v[16:17]
    v_pk_fma_f32 v[18:19], v[90:91], v[90:91], v[18:19]
    v_pk_fma_f32 v[20:21], v[92:93], v[92:93], v[20:21]
    v_pk_fma_f32 v[22:23], v[94:95], v[94:95], v[22:23]
    v_pk_fma_f32 v[16:17], v[96:97], v[96:97], v[16:17]
    v_pk_fma_f32 v[18:19], v[98:99], v[98:99], v[18:19]
    v_pk_fma_f32 v[20:21], v[100:101], v[100:101], v[20:21]
    v_pk_fma_f32 v[22:23], v[102:103], v[102:103], v[22:23]
    v_pk_fma_f32 v[16:17], v[104:105], v[104:105], v[16:17]
    v_pk_fma_f32 v[18:19], v[106:107], v[106:107], v[18:19]
    v_pk_fma_f32 v[20:21], v[108:109], v[108:109], v[20:21]
    v_pk_fma_f32 v[22:23], v[110:111], v[110:111], v[22:23]
    v_pk_fma_f32 v[16:17], v[112:113], v[112:113], v[16:17]
    v_pk_fma_f32 v[18:19], v[114:115], v[114:115], v[18:19]
    v_pk_fma_f32 v[20:21], v[116:117], v[116:117], v[20:21]
    v_pk_fma_f32 v[22:23], v[118:119], v[118:119], v[22:23]
    v_pk_fma_f32 v[16:17], v[120:121], v[120:121], v[16:17]
    v_pk_fma_f32 v[18:19], v[122:123], v[122:123], v[18:19]
    v_pk_fma_f32 v[20:21], v[124:125], v[124:125], v[20:21]
    v_pk_fma_f32 v[22:23], v[126:127], v[126:127], v[22:23]
    v_pk_add_f32 v[16:17], v[16:17], v[18:19]
    v_pk_add_f32 v[20:21], v[20:21], v[22:23]
    v_pk_add_f32 v[16:17], v[16:17], v[20:21]
    v_add_f32 v16, v16, v17
    ds_write_b32 v253, v16 offset:1024
    s_waitcnt lgkmcnt(0)
    s_waitcnt vmcnt(0)
    s_barrier
    s_cmp_lg_u32 s14, 0
    s_cbranch_scc1 main_kernel_s_nf
    v_cmp_gt_u32 vcc, 4, v2
    s_cbranch_vccz main_kernel_s_wa1_ok
    v_mov_b32 v2, 0
main_kernel_s_wa1:
    buffer_load_dword v3, v2, s[60:63], 0 offen offset:12 sc1
    s_waitcnt vmcnt(0)
    v_cmp_gt_u32 vcc, 4, v3
    s_cbranch_vccz main_kernel_s_wa1_ok
    s_sleep 4
    s_sub_u32 s29, s29, 1
    s_cbranch_scc0 main_kernel_s_wa1
    s_branch main_kernel_end
main_kernel_s_wa1_ok:
    s_mov_b64 exec, 1
    buffer_store_dword v8, v4, s[4:7], s16 offen sc1
    s_mov_b64 exec, -1
main_kernel_s_nf:
    ds_read_b128 v[16:19], v254 offset:1024
    ds_read_b128 v[20:23], v254 offset:1040
    ds_read_b128 v[24:27], v254 offset:1056
    ds_read_b128 v[28:31], v254 offset:1072
    s_waitcnt lgkmcnt(2)
    v_pk_add_f32 v[16:17], v[16:17], v[18:19]
    v_pk_add_f32 v[20:21], v[20:21], v[22:23]
    s_waitcnt lgkmcnt(0)
    v_pk_add_f32 v[24:25], v[24:25], v[26:27]
    v_pk_add_f32 v[28:29], v[28:29], v[30:31]
    v_pk_add_f32 v[16:17], v[16:17], v[20:21]
    v_pk_add_f32 v[24:25], v[24:25], v[28:29]
    v_pk_add_f32 v[16:17], v[16:17], v[24:25]
    v_add_f32 v16, v16, v17
    v_mov_b32 v17, 0x3727c5ac
    v_fmac_f32 v17, 0x3a800000, v16
    v_rsq_f32 v16, v17
    s_nop 0
    v_mov_b32 v17, v16
    v_pk_mul_f32 v[64:65], v[64:65], v[16:17]
    v_pk_mul_f32 v[66:67], v[66:67], v[16:17]
    v_pk_mul_f32 v[68:69], v[68:69], v[16:17]
    v_pk_mul_f32 v[70:71], v[70:71], v[16:17]
    v_pk_mul_f32 v[72:73], v[72:73], v[16:17]
    v_pk_mul_f32 v[74:75], v[74:75], v[16:17]
    v_pk_mul_f32 v[76:77], v[76:77], v[16:17]
    v_pk_mul_f32 v[78:79], v[78:79], v[16:17]
    v_pk_mul_f32 v[80:81], v[80:81], v[16:17]
    v_pk_mul_f32 v[82:83], v[82:83], v[16:17]
    v_pk_mul_f32 v[84:85], v[84:85], v[16:17]
    v_pk_mul_f32 v[86:87], v[86:87], v[16:17]
    v_pk_mul_f32 v[88:89], v[88:89], v[16:17]
    v_pk_mul_f32 v[90:91], v[90:91], v[16:17]
    v_pk_mul_f32 v[92:93], v[92:93], v[16:17]
    v_pk_mul_f32 v[94:95], v[94:95], v[16:17]
    v_pk_mul_f32 v[96:97], v[96:97], v[16:17]
    v_pk_mul_f32 v[98:99], v[98:99], v[16:17]
    v_pk_mul_f32 v[100:101], v[100:101], v[16:17]
    v_pk_mul_f32 v[102:103], v[102:103], v[16:17]
    v_pk_mul_f32 v[104:105], v[104:105], v[16:17]
    v_pk_mul_f32 v[106:107], v[106:107], v[16:17]
    v_pk_mul_f32 v[108:109], v[108:109], v[16:17]
    v_pk_mul_f32 v[110:111], v[110:111], v[16:17]
    v_pk_mul_f32 v[112:113], v[112:113], v[16:17]
    v_pk_mul_f32 v[114:115], v[114:115], v[16:17]
    v_pk_mul_f32 v[116:117], v[116:117], v[16:17]
    v_pk_mul_f32 v[118:119], v[118:119], v[16:17]
    v_pk_mul_f32 v[120:121], v[120:121], v[16:17]
    v_pk_mul_f32 v[122:123], v[122:123], v[16:17]
    v_pk_mul_f32 v[124:125], v[124:125], v[16:17]
    v_pk_mul_f32 v[126:127], v[126:127], v[16:17]
    v_cvt_pk_bf16_f32 v32, v64, v65
    v_cvt_pk_bf16_f32 v33, v66, v67
    v_cvt_pk_bf16_f32 v34, v68, v69
    v_cvt_pk_bf16_f32 v35, v70, v71
    v_cvt_pk_bf16_f32 v36, v72, v73
    v_cvt_pk_bf16_f32 v37, v74, v75
    v_cvt_pk_bf16_f32 v38, v76, v77
    v_cvt_pk_bf16_f32 v39, v78, v79
    v_cvt_pk_bf16_f32 v40, v80, v81
    v_cvt_pk_bf16_f32 v41, v82, v83
    v_cvt_pk_bf16_f32 v42, v84, v85
    v_cvt_pk_bf16_f32 v43, v86, v87
    v_cvt_pk_bf16_f32 v44, v88, v89
    v_cvt_pk_bf16_f32 v45, v90, v91
    v_cvt_pk_bf16_f32 v46, v92, v93
    v_cvt_pk_bf16_f32 v47, v94, v95
    v_cvt_pk_bf16_f32 v48, v96, v97
    v_cvt_pk_bf16_f32 v49, v98, v99
    v_cvt_pk_bf16_f32 v50, v100, v101
    v_cvt_pk_bf16_f32 v51, v102, v103
    v_cvt_pk_bf16_f32 v52, v104, v105
    v_cvt_pk_bf16_f32 v53, v106, v107
    v_cvt_pk_bf16_f32 v54, v108, v109
    v_cvt_pk_bf16_f32 v55, v110, v111
    v_cvt_pk_bf16_f32 v56, v112, v113
    v_cvt_pk_bf16_f32 v57, v114, v115
    v_cvt_pk_bf16_f32 v58, v116, v117
    v_cvt_pk_bf16_f32 v59, v118, v119
    v_cvt_pk_bf16_f32 v60, v120, v121
    v_cvt_pk_bf16_f32 v61, v122, v123
    v_cvt_pk_bf16_f32 v62, v124, v125
    v_cvt_pk_bf16_f32 v63, v126, v127
    s_add_u32 s32, s34, 0x400000
    s_add_u32 s33, s32, 4096
    buffer_store_dwordx4 v[32:35], v251, s[4:7], s32 offen offset:0 sc1
    buffer_store_dwordx4 v[36:39], v251, s[4:7], s32 offen offset:1024 sc1
    buffer_store_dwordx4 v[40:43], v251, s[4:7], s32 offen offset:2048 sc1
    buffer_store_dwordx4 v[44:47], v251, s[4:7], s32 offen offset:3072 sc1
    buffer_store_dwordx4 v[48:51], v251, s[4:7], s33 offen offset:0 sc1
    buffer_store_dwordx4 v[52:55], v251, s[4:7], s33 offen offset:1024 sc1
    buffer_store_dwordx4 v[56:59], v251, s[4:7], s33 offen offset:2048 sc1
    buffer_store_dwordx4 v[60:63], v251, s[4:7], s33 offen offset:3072 sc1
    s_add_u32 s16, s16, 4
    s_branch main_kernel_s_wa2_ok
main_kernel_s_fill:
    s_lshl_b32 s32, s16, 14
    s_add_u32 s34, s32, 0x6c00000
    buffer_store_dwordx4 v[8:11], v1, s[4:7], s34 offen sc1
    s_add_u32 s34, s32, 0x6c01000
    buffer_store_dwordx4 v[8:11], v1, s[4:7], s34 offen sc1
    s_add_u32 s34, s32, 0x6c02000
    buffer_store_dwordx4 v[8:11], v1, s[4:7], s34 offen sc1
    s_add_u32 s34, s32, 0x6c03000
    buffer_store_dwordx4 v[8:11], v1, s[4:7], s34 offen sc1
    s_lshl_b32 s32, s16, 14
    s_add_u32 s34, s32, 0x8c00000
    buffer_store_dwordx4 v[8:11], v1, s[4:7], s34 offen sc1
    s_add_u32 s34, s32, 0x8c01000
    buffer_store_dwordx4 v[8:11], v1, s[4:7], s34 offen sc1
    s_add_u32 s34, s32, 0x8c02000
    buffer_store_dwordx4 v[8:11], v1, s[4:7], s34 offen sc1
    s_add_u32 s34, s32, 0x8c03000
    buffer_store_dwordx4 v[8:11], v1, s[4:7], s34 offen sc1
    s_add_u32 s34, s32, 0x8d00000
    buffer_store_dwordx4 v[8:11], v1, s[4:7], s34 offen sc1
    s_add_u32 s34, s32, 0x8d01000
    buffer_store_dwordx4 v[8:11], v1, s[4:7], s34 offen sc1
    s_add_u32 s34, s32, 0x8d02000
    buffer_store_dwordx4 v[8:11], v1, s[4:7], s34 offen sc1
    s_add_u32 s34, s32, 0x8d03000
    buffer_store_dwordx4 v[8:11], v1, s[4:7], s34 offen sc1
    s_lshl_b32 s32, s16, 2
    s_lshl_b32 s32, s16, 12
    s_add_u32 s33, s32, 0x8c00000
    s_add_u32 s34, s32, 0x6e00000
    buffer_store_dwordx4 v[8:11], v1, s[4:7], s34 offen sc1
    s_add_u32 s32, s32, 0x8000000
    buffer_store_dwordx4 v[8:11], v1, s[4:7], s32 offen sc1
    s_lshl_b32 s16, s16, 2
    s_add_u32 s16, s16, 0x841f000
    s_cmp_lg_u32 s16, 0x841f034
    s_cbranch_scc1 main_kernel_s_fd
    s_mov_b32 s8, s76
    s_and_b32 s9, s77, 0xffff
    s_mov_b32 s10, 0x4000
    s_mov_b32 s11, 0x20000
    v_and_b32 v2, 7, v0
    v_lshlrev_b32 v2, 11, v2
    v_lshrrev_b32 v3, 6, v0
    v_lshl_add_u32 v2, v3, 7, v2
    v_bfe_u32 v3, v0, 4, 2
    v_lshl_add_u32 v2, v3, 5, v2
    v_bfe_u32 v3, v0, 3, 1
    v_lshl_add_u32 v2, v3, 4, v2
    buffer_load_dwordx4 v[16:19], v2, s[8:11], 0 offen offset:0
    buffer_load_dwordx4 v[20:23], v2, s[8:11], 0 offen offset:512
    buffer_load_dwordx4 v[24:27], v2, s[8:11], 0 offen offset:1024
    buffer_load_dwordx4 v[28:31], v2, s[8:11], 0 offen offset:1536
    s_mov_b32 s32, 0x6d00000
    s_waitcnt vmcnt(0)
    buffer_store_dwordx4 v[16:19], v1, s[4:7], s32 offen sc1
    s_add_u32 s32, s32, 4096
    buffer_store_dwordx4 v[20:23], v1, s[4:7], s32 offen sc1
    s_add_u32 s32, s32, 4096
    buffer_store_dwordx4 v[24:27], v1, s[4:7], s32 offen sc1
    s_add_u32 s32, s32, 4096
    buffer_store_dwordx4 v[28:31], v1, s[4:7], s32 offen sc1
    s_add_u32 s32, s32, 4096
    buffer_store_dwordx4 v[8:11], v1, s[4:7], s32 offen sc1
    s_add_u32 s32, s32, 4096
    buffer_store_dwordx4 v[8:11], v1, s[4:7], s32 offen sc1
    s_add_u32 s32, s32, 4096
    buffer_store_dwordx4 v[8:11], v1, s[4:7], s32 offen sc1
    s_add_u32 s32, s32, 4096
    buffer_store_dwordx4 v[8:11], v1, s[4:7], s32 offen sc1
    s_add_u32 s32, s32, 4096
    v_xor_b32 v2, 0, v1
    v_mov_b32 v2, 0
main_kernel_s_wa3:
    buffer_load_dword v3, v2, s[60:63], 0 offen offset:12 sc1
    s_waitcnt vmcnt(0)
    v_cmp_gt_u32 vcc, 4, v3
    s_cbranch_vccz main_kernel_s_wa3_ok
    s_sleep 4
    s_sub_u32 s29, s29, 1
    s_cbranch_scc0 main_kernel_s_wa3
    s_branch main_kernel_end
main_kernel_s_wa3_ok:
    v_lshlrev_b32 v2, 8, v250
    s_mov_b32 s32, 0x8418100
    s_mov_b64 exec, 15
    buffer_store_dwordx4 v[8:11], v2, s[4:7], s32 offen sc1
    s_mov_b64 exec, -1
main_kernel_s_fd:
    s_cmp_lg_u32 s14, 0
    s_cbranch_scc1 main_kernel_s_wa2_ok
    v_mov_b32 v2, 0
main_kernel_s_wa2:
    buffer_load_dword v3, v2, s[60:63], 0 offen offset:12 sc1
    s_waitcnt vmcnt(0)
    v_cmp_gt_u32 vcc, 4, v3
    s_cbranch_vccz main_kernel_s_wa2_ok
    s_sleep 4
    s_sub_u32 s29, s29, 1
    s_cbranch_scc0 main_kernel_s_wa2
    s_branch main_kernel_end
main_kernel_s_wa2_ok:
    s_waitcnt vmcnt(0)
    s_barrier
    s_cmp_lg_u32 s14, 0
    s_cbranch_scc1 main_kernel_s_end
    s_mov_b64 exec, 1
    buffer_store_dword v8, v4, s[4:7], s16 offen sc1
    s_mov_b64 exec, -1
main_kernel_s_end:
    s_lshl_b32 s32, s12, 5
    s_add_u32 s32, s32, s13
    s_sub_u32 s32, s32, 96
    s_cmp_lt_u32 s32, 16
    s_cbranch_scc1 main_kernel_att
    s_branch main_kernel_worker
main_kernel_end:
    s_endpgm
main_kernel_chain:
    s_lshl_b32 s36, s14, 15
    s_add_u32 s36, s36, 32768
    v_lshlrev_b32 v116, 4, v94
    v_add_u32 v113, s36, v116
    v_lshrrev_b32 v126, 4, v94
    v_and_b32 v127, 15, v94
    v_lshlrev_b32 v95, 2, v126
    v_xor_b32 v127, v127, v95
    v_lshlrev_b32 v127, 4, v127
    v_and_b32 v95, 1, v126
    v_lshrrev_b32 v126, 1, v126
    v_lshl_add_u32 v127, v126, 15, v127
    v_lshl_add_u32 v65, v95, 13, v127
    v_lshl_add_u32 v66, v95, 11, v127
    s_lshr_b32 s32, s14, 1
    s_lshl_b32 s32, s32, 5
    v_xor_b32 v64, s32, v65
    v_bfe_u32 v127, v94, 2, 1
    v_bfe_u32 v95, v94, 4, 1
    v_lshl_add_u32 v78, v95, 1, v127
    v_lshl_add_u32 v126, v126, 3, v78
    v_and_b32 v127, 3, v94
    v_lshlrev_b32 v127, 3, v127
    v_lshl_add_u32 v71, v126, 8, v127
    v_bfe_u32 v95, v94, 3, 1
    v_lshl_add_u32 v71, v95, 5, v71
    v_xor_b32 v126, s14, v78
    v_lshl_add_u32 v126, v126, 6, v71
    v_add_u32 v69, 32768, v126
    v_add_u32 v70, 0x10000, v69
    v_lshl_add_u32 v126, v78, 6, v71
    v_add_u32 v80, s36, v126
    s_lshl_b32 s32, s14, 5
    s_add_u32 s32, s32, 32768
    v_xor_b32 v126, s32, v126
    v_lshl_add_u32 v67, v95, 16, v126
    v_xor_b32 v68, 0x80, v67
    v_xor_b32 v81, 64, v80
    v_xor_b32 v82, 128, v80
    v_xor_b32 v83, 192, v80
    v_and_b32 v126, 7, v94
    v_lshl_add_u32 v126, s13, 3, v126
    v_lshlrev_b32 v77, 10, v126
    s_lshl_b32 s32, s12, 22
    s_lshl_b32 s33, s13, 8
    s_add_u32 s32, s32, s33
    s_lshl_b32 s33, s14, 18
    s_add_u32 s35, s32, s33
    s_bitset0_b32 s33, 19
    s_add_u32 s34, s32, s33
    s_lshl_b32 s3, s13, 18
    s_lshl2_add_u32 s32, s12, s14
    s_lshl_b32 s32, s32, 8
    s_add_u32 s3, s3, s32
    s_cmp_lt_u32 s14, 2
    s_cbranch_scc1 main_kernel_c_pq
    s_mov_b64 s[40:41], s[42:43]
main_kernel_c_pq:
    v_min_u32 v73, 8, v94
    v_lshlrev_b32 v73, 5, v73
    v_mov_b32 v126, 12
    v_cmp_gt_u32 vcc, 8, v94
    v_lshlrev_b32 v74, 2, v94
    v_add_u32 v74, 0x841f000, v74
    v_cndmask_b32 v73, v126, v73, vcc
    v_and_b32 v75, 1, v94
    s_lshl_b32 s32, s13, 8
    s_add_u32 s32, s32, 0x8406000
    v_lshl_add_u32 v75, v75, 13, s32
    s_mov_b32 s8, s44
    s_and_b32 s9, s45, 0xffff
    s_mov_b32 s10, 0x800000
    s_mov_b32 s11, 0x20000
    s_sub_u32 s39, 511, s44
    s_and_b32 s39, s39, 0x380
    s_andn2_b32 s32, s35, 0x1fff
    s_add_u32 s39, s39, s32
    s_add_u32 s32, s39, 0x0
    buffer_load_dword v86, v77, s[8:11], s32 offen
    s_add_u32 s32, s35, 0x0
    s_add_u32 m0, s36, 0
    s_nop 0
    buffer_load_dwordx4 v65, s[8:11], s32 offen lds
    s_add_u32 s32, s35, 0x4000
    s_add_u32 m0, s36, 1024
    s_nop 0
    buffer_load_dwordx4 v65, s[8:11], s32 offen lds
    s_add_u32 s32, s35, 0x10000
    s_add_u32 m0, s36, 2048
    s_nop 0
    buffer_load_dwordx4 v65, s[8:11], s32 offen lds
    s_add_u32 s32, s35, 0x14000
    s_add_u32 m0, s36, 3072
    s_nop 0
    buffer_load_dwordx4 v65, s[8:11], s32 offen lds
    s_add_u32 s32, s35, 0x20000
    s_add_u32 m0, s36, 4096
    s_nop 0
    buffer_load_dwordx4 v65, s[8:11], s32 offen lds
    s_add_u32 s32, s35, 0x24000
    s_add_u32 m0, s36, 5120
    s_nop 0
    buffer_load_dwordx4 v65, s[8:11], s32 offen lds
    s_add_u32 s32, s35, 0x30000
    s_add_u32 m0, s36, 6144
    s_nop 0
    buffer_load_dwordx4 v65, s[8:11], s32 offen lds
    s_add_u32 s32, s35, 0x34000
    s_add_u32 m0, s36, 7168
    s_nop 0
    buffer_load_dwordx4 v65, s[8:11], s32 offen lds
    s_add_u32 s32, s39, 0x100000
    buffer_load_dword v86, v77, s[8:11], s32 offen
    s_add_u32 s32, s35, 0x100000
    s_add_u32 m0, s36, 8192
    s_nop 0
    buffer_load_dwordx4 v65, s[8:11], s32 offen lds
    s_add_u32 s32, s35, 0x104000
    s_add_u32 m0, s36, 9216
    s_nop 0
    buffer_load_dwordx4 v65, s[8:11], s32 offen lds
    s_add_u32 s32, s35, 0x110000
    s_add_u32 m0, s36, 10240
    s_nop 0
    buffer_load_dwordx4 v65, s[8:11], s32 offen lds
    s_add_u32 s32, s35, 0x114000
    s_add_u32 m0, s36, 11264
    s_nop 0
    buffer_load_dwordx4 v65, s[8:11], s32 offen lds
    s_add_u32 s32, s35, 0x120000
    s_add_u32 m0, s36, 12288
    s_nop 0
    buffer_load_dwordx4 v65, s[8:11], s32 offen lds
    s_add_u32 s32, s35, 0x124000
    s_add_u32 m0, s36, 13312
    s_nop 0
    buffer_load_dwordx4 v65, s[8:11], s32 offen lds
    s_add_u32 s32, s35, 0x130000
    s_add_u32 m0, s36, 14336
    s_nop 0
    buffer_load_dwordx4 v65, s[8:11], s32 offen lds
    s_add_u32 s32, s35, 0x134000
    s_add_u32 m0, s36, 15360
    s_nop 0
    buffer_load_dwordx4 v65, s[8:11], s32 offen lds
    s_mov_b32 s8, s40
    s_and_b32 s9, s41, 0xffff
    s_mov_b32 s10, 0x800000
    s_mov_b32 s11, 0x20000
    s_sub_u32 s39, 511, s40
    s_and_b32 s39, s39, 0x380
    s_andn2_b32 s32, s34, 0x1fff
    s_add_u32 s39, s39, s32
    s_add_u32 s32, s39, 0x0
    buffer_load_dword v86, v77, s[8:11], s32 offen
    s_add_u32 s32, s34, 0x0
    s_add_u32 m0, s36, 16384
    s_nop 0
    buffer_load_dwordx4 v64, s[8:11], s32 offen lds
    s_add_u32 s32, s34, 0x4000
    s_add_u32 m0, s36, 17408
    s_nop 0
    buffer_load_dwordx4 v64, s[8:11], s32 offen lds
    s_add_u32 s32, s34, 0x10000
    s_add_u32 m0, s36, 18432
    s_nop 0
    buffer_load_dwordx4 v64, s[8:11], s32 offen lds
    s_add_u32 s32, s34, 0x14000
    s_add_u32 m0, s36, 19456
    s_nop 0
    buffer_load_dwordx4 v64, s[8:11], s32 offen lds
    s_add_u32 s32, s34, 0x20000
    s_add_u32 m0, s36, 20480
    s_nop 0
    buffer_load_dwordx4 v64, s[8:11], s32 offen lds
    s_add_u32 s32, s34, 0x24000
    s_add_u32 m0, s36, 21504
    s_nop 0
    buffer_load_dwordx4 v64, s[8:11], s32 offen lds
    s_add_u32 s32, s34, 0x30000
    s_add_u32 m0, s36, 22528
    s_nop 0
    buffer_load_dwordx4 v64, s[8:11], s32 offen lds
    s_add_u32 s32, s34, 0x34000
    s_add_u32 m0, s36, 23552
    s_nop 0
    buffer_load_dwordx4 v64, s[8:11], s32 offen lds
    s_add_u32 s32, s39, 0x80000
    buffer_load_dword v86, v77, s[8:11], s32 offen
    s_add_u32 s32, s34, 0x80000
    s_add_u32 m0, s36, 24576
    s_nop 0
    buffer_load_dwordx4 v64, s[8:11], s32 offen lds
    s_add_u32 s32, s34, 0x84000
    s_add_u32 m0, s36, 25600
    s_nop 0
    buffer_load_dwordx4 v64, s[8:11], s32 offen lds
    s_add_u32 s32, s34, 0x90000
    s_add_u32 m0, s36, 26624
    s_nop 0
    buffer_load_dwordx4 v64, s[8:11], s32 offen lds
    s_add_u32 s32, s34, 0x94000
    s_add_u32 m0, s36, 27648
    s_nop 0
    buffer_load_dwordx4 v64, s[8:11], s32 offen lds
    s_add_u32 s32, s34, 0xa0000
    s_add_u32 m0, s36, 28672
    s_nop 0
    buffer_load_dwordx4 v64, s[8:11], s32 offen lds
    s_add_u32 s32, s34, 0xa4000
    s_add_u32 m0, s36, 29696
    s_nop 0
    buffer_load_dwordx4 v64, s[8:11], s32 offen lds
    s_add_u32 s32, s34, 0xb0000
    s_add_u32 m0, s36, 30720
    s_nop 0
    buffer_load_dwordx4 v64, s[8:11], s32 offen lds
    s_add_u32 s32, s34, 0xb4000
    s_add_u32 m0, s36, 31744
    s_nop 0
    buffer_load_dwordx4 v64, s[8:11], s32 offen lds
    s_waitcnt vmcnt(27)
    s_barrier
    ds_read_b64_tr_b16 v[128:129], v69 offset:0
    ds_read_b64_tr_b16 v[130:131], v69 offset:1024
    ds_read_b64_tr_b16 v[132:133], v69 offset:4096
    ds_read_b64_tr_b16 v[134:135], v69 offset:5120
    ds_read_b64_tr_b16 v[136:137], v69 offset:32768
    ds_read_b64_tr_b16 v[138:139], v69 offset:33792
    ds_read_b64_tr_b16 v[140:141], v69 offset:36864
    ds_read_b64_tr_b16 v[142:143], v69 offset:37888
    ds_read_b64_tr_b16 v[144:145], v70 offset:0
    ds_read_b64_tr_b16 v[146:147], v70 offset:1024
    ds_read_b64_tr_b16 v[148:149], v70 offset:4096
    ds_read_b64_tr_b16 v[150:151], v70 offset:5120
    ds_read_b64_tr_b16 v[152:153], v70 offset:32768
    ds_read_b64_tr_b16 v[154:155], v70 offset:33792
    ds_read_b64_tr_b16 v[156:157], v70 offset:36864
    ds_read_b64_tr_b16 v[158:159], v70 offset:37888
    s_waitcnt lgkmcnt(0)
    s_waitcnt vmcnt(18)
    s_barrier
    s_add_u32 s32, s39, 0x100000
    buffer_load_dword v86, v77, s[8:11], s32 offen
    s_add_u32 s32, s34, 0x100000
    s_add_u32 m0, s36, 0
    s_nop 0
    buffer_load_dwordx4 v64, s[8:11], s32 offen lds
    s_add_u32 s32, s34, 0x104000
    s_add_u32 m0, s36, 1024
    s_nop 0
    buffer_load_dwordx4 v64, s[8:11], s32 offen lds
    s_add_u32 s32, s34, 0x110000
    s_add_u32 m0, s36, 2048
    s_nop 0
    buffer_load_dwordx4 v64, s[8:11], s32 offen lds
    s_add_u32 s32, s34, 0x114000
    s_add_u32 m0, s36, 3072
    s_nop 0
    buffer_load_dwordx4 v64, s[8:11], s32 offen lds
    s_add_u32 s32, s34, 0x120000
    s_add_u32 m0, s36, 4096
    s_nop 0
    buffer_load_dwordx4 v64, s[8:11], s32 offen lds
    s_add_u32 s32, s34, 0x124000
    s_add_u32 m0, s36, 5120
    s_nop 0
    buffer_load_dwordx4 v64, s[8:11], s32 offen lds
    s_add_u32 s32, s34, 0x130000
    s_add_u32 m0, s36, 6144
    s_nop 0
    buffer_load_dwordx4 v64, s[8:11], s32 offen lds
    s_add_u32 s32, s34, 0x134000
    s_add_u32 m0, s36, 7168
    s_nop 0
    buffer_load_dwordx4 v64, s[8:11], s32 offen lds
    ds_read_b64_tr_b16 v[160:161], v69 offset:8192
    ds_read_b64_tr_b16 v[162:163], v69 offset:9216
    ds_read_b64_tr_b16 v[164:165], v69 offset:12288
    ds_read_b64_tr_b16 v[166:167], v69 offset:13312
    ds_read_b64_tr_b16 v[168:169], v69 offset:40960
    ds_read_b64_tr_b16 v[170:171], v69 offset:41984
    ds_read_b64_tr_b16 v[172:173], v69 offset:45056
    ds_read_b64_tr_b16 v[174:175], v69 offset:46080
    ds_read_b64_tr_b16 v[176:177], v70 offset:8192
    ds_read_b64_tr_b16 v[178:179], v70 offset:9216
    ds_read_b64_tr_b16 v[180:181], v70 offset:12288
    ds_read_b64_tr_b16 v[182:183], v70 offset:13312
    ds_read_b64_tr_b16 v[184:185], v70 offset:40960
    ds_read_b64_tr_b16 v[186:187], v70 offset:41984
    ds_read_b64_tr_b16 v[188:189], v70 offset:45056
    ds_read_b64_tr_b16 v[190:191], v70 offset:46080
    s_waitcnt lgkmcnt(0)
    s_waitcnt vmcnt(18)
    s_barrier
    s_add_u32 s32, s39, 0x180000
    buffer_load_dword v86, v77, s[8:11], s32 offen
    s_add_u32 s32, s34, 0x180000
    s_add_u32 m0, s36, 8192
    s_nop 0
    buffer_load_dwordx4 v64, s[8:11], s32 offen lds
    s_add_u32 s32, s34, 0x184000
    s_add_u32 m0, s36, 9216
    s_nop 0
    buffer_load_dwordx4 v64, s[8:11], s32 offen lds
    s_add_u32 s32, s34, 0x190000
    s_add_u32 m0, s36, 10240
    s_nop 0
    buffer_load_dwordx4 v64, s[8:11], s32 offen lds
    s_add_u32 s32, s34, 0x194000
    s_add_u32 m0, s36, 11264
    s_nop 0
    buffer_load_dwordx4 v64, s[8:11], s32 offen lds
    s_add_u32 s32, s34, 0x1a0000
    s_add_u32 m0, s36, 12288
    s_nop 0
    buffer_load_dwordx4 v64, s[8:11], s32 offen lds
    s_add_u32 s32, s34, 0x1a4000
    s_add_u32 m0, s36, 13312
    s_nop 0
    buffer_load_dwordx4 v64, s[8:11], s32 offen lds
    s_add_u32 s32, s34, 0x1b0000
    s_add_u32 m0, s36, 14336
    s_nop 0
    buffer_load_dwordx4 v64, s[8:11], s32 offen lds
    s_add_u32 s32, s34, 0x1b4000
    s_add_u32 m0, s36, 15360
    s_nop 0
    buffer_load_dwordx4 v64, s[8:11], s32 offen lds
    ds_read_b64_tr_b16 a[0:1], v67 offset:16384
    ds_read_b64_tr_b16 a[2:3], v67 offset:17408
    ds_read_b64_tr_b16 a[4:5], v67 offset:20480
    ds_read_b64_tr_b16 a[6:7], v67 offset:21504
    ds_read_b64_tr_b16 a[8:9], v67 offset:49152
    ds_read_b64_tr_b16 a[10:11], v67 offset:50176
    ds_read_b64_tr_b16 a[12:13], v67 offset:53248
    ds_read_b64_tr_b16 a[14:15], v67 offset:54272
    ds_read_b64_tr_b16 a[128:129], v68 offset:16384
    ds_read_b64_tr_b16 a[130:131], v68 offset:17408
    ds_read_b64_tr_b16 a[132:133], v68 offset:20480
    ds_read_b64_tr_b16 a[134:135], v68 offset:21504
    ds_read_b64_tr_b16 a[136:137], v68 offset:49152
    ds_read_b64_tr_b16 a[138:139], v68 offset:50176
    ds_read_b64_tr_b16 a[140:141], v68 offset:53248
    ds_read_b64_tr_b16 a[142:143], v68 offset:54272
    s_waitcnt lgkmcnt(0)
    s_waitcnt vmcnt(18)
    s_barrier
    s_add_u32 s32, s39, 0x200000
    buffer_load_dword v86, v77, s[8:11], s32 offen
    s_add_u32 s32, s34, 0x200000
    s_add_u32 m0, s36, 16384
    s_nop 0
    buffer_load_dwordx4 v64, s[8:11], s32 offen lds
    s_add_u32 s32, s34, 0x204000
    s_add_u32 m0, s36, 17408
    s_nop 0
    buffer_load_dwordx4 v64, s[8:11], s32 offen lds
    s_add_u32 s32, s34, 0x210000
    s_add_u32 m0, s36, 18432
    s_nop 0
    buffer_load_dwordx4 v64, s[8:11], s32 offen lds
    s_add_u32 s32, s34, 0x214000
    s_add_u32 m0, s36, 19456
    s_nop 0
    buffer_load_dwordx4 v64, s[8:11], s32 offen lds
    s_add_u32 s32, s34, 0x220000
    s_add_u32 m0, s36, 20480
    s_nop 0
    buffer_load_dwordx4 v64, s[8:11], s32 offen lds
    s_add_u32 s32, s34, 0x224000
    s_add_u32 m0, s36, 21504
    s_nop 0
    buffer_load_dwordx4 v64, s[8:11], s32 offen lds
    s_add_u32 s32, s34, 0x230000
    s_add_u32 m0, s36, 22528
    s_nop 0
    buffer_load_dwordx4 v64, s[8:11], s32 offen lds
    s_add_u32 s32, s34, 0x234000
    s_add_u32 m0, s36, 23552
    s_nop 0
    buffer_load_dwordx4 v64, s[8:11], s32 offen lds
    ds_read_b64_tr_b16 a[16:17], v67 offset:24576
    ds_read_b64_tr_b16 a[18:19], v67 offset:25600
    ds_read_b64_tr_b16 a[20:21], v67 offset:28672
    ds_read_b64_tr_b16 a[22:23], v67 offset:29696
    ds_read_b64_tr_b16 a[24:25], v67 offset:57344
    ds_read_b64_tr_b16 a[26:27], v67 offset:58368
    ds_read_b64_tr_b16 a[28:29], v67 offset:61440
    ds_read_b64_tr_b16 a[30:31], v67 offset:62464
    ds_read_b64_tr_b16 a[144:145], v68 offset:24576
    ds_read_b64_tr_b16 a[146:147], v68 offset:25600
    ds_read_b64_tr_b16 a[148:149], v68 offset:28672
    ds_read_b64_tr_b16 a[150:151], v68 offset:29696
    ds_read_b64_tr_b16 a[152:153], v68 offset:57344
    ds_read_b64_tr_b16 a[154:155], v68 offset:58368
    ds_read_b64_tr_b16 a[156:157], v68 offset:61440
    ds_read_b64_tr_b16 a[158:159], v68 offset:62464
    s_waitcnt lgkmcnt(0)
    s_waitcnt vmcnt(18)
    s_barrier
    s_add_u32 s32, s39, 0x280000
    buffer_load_dword v86, v77, s[8:11], s32 offen
    s_add_u32 s32, s34, 0x280000
    s_add_u32 m0, s36, 24576
    s_nop 0
    buffer_load_dwordx4 v64, s[8:11], s32 offen lds
    s_add_u32 s32, s34, 0x284000
    s_add_u32 m0, s36, 25600
    s_nop 0
    buffer_load_dwordx4 v64, s[8:11], s32 offen lds
    s_add_u32 s32, s34, 0x290000
    s_add_u32 m0, s36, 26624
    s_nop 0
    buffer_load_dwordx4 v64, s[8:11], s32 offen lds
    s_add_u32 s32, s34, 0x294000
    s_add_u32 m0, s36, 27648
    s_nop 0
    buffer_load_dwordx4 v64, s[8:11], s32 offen lds
    s_add_u32 s32, s34, 0x2a0000
    s_add_u32 m0, s36, 28672
    s_nop 0
    buffer_load_dwordx4 v64, s[8:11], s32 offen lds
    s_add_u32 s32, s34, 0x2a4000
    s_add_u32 m0, s36, 29696
    s_nop 0
    buffer_load_dwordx4 v64, s[8:11], s32 offen lds
    s_add_u32 s32, s34, 0x2b0000
    s_add_u32 m0, s36, 30720
    s_nop 0
    buffer_load_dwordx4 v64, s[8:11], s32 offen lds
    s_add_u32 s32, s34, 0x2b4000
    s_add_u32 m0, s36, 31744
    s_nop 0
    buffer_load_dwordx4 v64, s[8:11], s32 offen lds
    ds_read_b64_tr_b16 a[32:33], v67 offset:0
    ds_read_b64_tr_b16 a[34:35], v67 offset:1024
    ds_read_b64_tr_b16 a[36:37], v67 offset:4096
    ds_read_b64_tr_b16 a[38:39], v67 offset:5120
    ds_read_b64_tr_b16 a[40:41], v67 offset:32768
    ds_read_b64_tr_b16 a[42:43], v67 offset:33792
    ds_read_b64_tr_b16 a[44:45], v67 offset:36864
    ds_read_b64_tr_b16 a[46:47], v67 offset:37888
    ds_read_b64_tr_b16 a[160:161], v68 offset:0
    ds_read_b64_tr_b16 a[162:163], v68 offset:1024
    ds_read_b64_tr_b16 a[164:165], v68 offset:4096
    ds_read_b64_tr_b16 a[166:167], v68 offset:5120
    ds_read_b64_tr_b16 a[168:169], v68 offset:32768
    ds_read_b64_tr_b16 a[170:171], v68 offset:33792
    ds_read_b64_tr_b16 a[172:173], v68 offset:36864
    ds_read_b64_tr_b16 a[174:175], v68 offset:37888
    s_waitcnt lgkmcnt(0)
    s_waitcnt vmcnt(18)
    s_barrier
    s_add_u32 s32, s39, 0x300000
    buffer_load_dword v86, v77, s[8:11], s32 offen
    s_add_u32 s32, s34, 0x300000
    s_add_u32 m0, s36, 0
    s_nop 0
    buffer_load_dwordx4 v64, s[8:11], s32 offen lds
    s_add_u32 s32, s34, 0x304000
    s_add_u32 m0, s36, 1024
    s_nop 0
    buffer_load_dwordx4 v64, s[8:11], s32 offen lds
    s_add_u32 s32, s34, 0x310000
    s_add_u32 m0, s36, 2048
    s_nop 0
    buffer_load_dwordx4 v64, s[8:11], s32 offen lds
    s_add_u32 s32, s34, 0x314000
    s_add_u32 m0, s36, 3072
    s_nop 0
    buffer_load_dwordx4 v64, s[8:11], s32 offen lds
    s_add_u32 s32, s34, 0x320000
    s_add_u32 m0, s36, 4096
    s_nop 0
    buffer_load_dwordx4 v64, s[8:11], s32 offen lds
    s_add_u32 s32, s34, 0x324000
    s_add_u32 m0, s36, 5120
    s_nop 0
    buffer_load_dwordx4 v64, s[8:11], s32 offen lds
    s_add_u32 s32, s34, 0x330000
    s_add_u32 m0, s36, 6144
    s_nop 0
    buffer_load_dwordx4 v64, s[8:11], s32 offen lds
    s_add_u32 s32, s34, 0x334000
    s_add_u32 m0, s36, 7168
    s_nop 0
    buffer_load_dwordx4 v64, s[8:11], s32 offen lds
    ds_read_b64_tr_b16 a[48:49], v67 offset:8192
    ds_read_b64_tr_b16 a[50:51], v67 offset:9216
    ds_read_b64_tr_b16 a[52:53], v67 offset:12288
    ds_read_b64_tr_b16 a[54:55], v67 offset:13312
    ds_read_b64_tr_b16 a[56:57], v67 offset:40960
    ds_read_b64_tr_b16 a[58:59], v67 offset:41984
    ds_read_b64_tr_b16 a[60:61], v67 offset:45056
    ds_read_b64_tr_b16 a[62:63], v67 offset:46080
    ds_read_b64_tr_b16 a[176:177], v68 offset:8192
    ds_read_b64_tr_b16 a[178:179], v68 offset:9216
    ds_read_b64_tr_b16 a[180:181], v68 offset:12288
    ds_read_b64_tr_b16 a[182:183], v68 offset:13312
    ds_read_b64_tr_b16 a[184:185], v68 offset:40960
    ds_read_b64_tr_b16 a[186:187], v68 offset:41984
    ds_read_b64_tr_b16 a[188:189], v68 offset:45056
    ds_read_b64_tr_b16 a[190:191], v68 offset:46080
    s_waitcnt lgkmcnt(0)
    s_waitcnt vmcnt(18)
    s_barrier
    s_add_u32 s32, s39, 0x380000
    buffer_load_dword v86, v77, s[8:11], s32 offen
    s_add_u32 s32, s34, 0x380000
    s_add_u32 m0, s36, 8192
    s_nop 0
    buffer_load_dwordx4 v64, s[8:11], s32 offen lds
    s_add_u32 s32, s34, 0x384000
    s_add_u32 m0, s36, 9216
    s_nop 0
    buffer_load_dwordx4 v64, s[8:11], s32 offen lds
    s_add_u32 s32, s34, 0x390000
    s_add_u32 m0, s36, 10240
    s_nop 0
    buffer_load_dwordx4 v64, s[8:11], s32 offen lds
    s_add_u32 s32, s34, 0x394000
    s_add_u32 m0, s36, 11264
    s_nop 0
    buffer_load_dwordx4 v64, s[8:11], s32 offen lds
    s_add_u32 s32, s34, 0x3a0000
    s_add_u32 m0, s36, 12288
    s_nop 0
    buffer_load_dwordx4 v64, s[8:11], s32 offen lds
    s_add_u32 s32, s34, 0x3a4000
    s_add_u32 m0, s36, 13312
    s_nop 0
    buffer_load_dwordx4 v64, s[8:11], s32 offen lds
    s_add_u32 s32, s34, 0x3b0000
    s_add_u32 m0, s36, 14336
    s_nop 0
    buffer_load_dwordx4 v64, s[8:11], s32 offen lds
    s_add_u32 s32, s34, 0x3b4000
    s_add_u32 m0, s36, 15360
    s_nop 0
    buffer_load_dwordx4 v64, s[8:11], s32 offen lds
    ds_read_b64_tr_b16 a[64:65], v67 offset:16384
    ds_read_b64_tr_b16 a[66:67], v67 offset:17408
    ds_read_b64_tr_b16 a[68:69], v67 offset:20480
    ds_read_b64_tr_b16 a[70:71], v67 offset:21504
    ds_read_b64_tr_b16 a[72:73], v67 offset:49152
    ds_read_b64_tr_b16 a[74:75], v67 offset:50176
    ds_read_b64_tr_b16 a[76:77], v67 offset:53248
    ds_read_b64_tr_b16 a[78:79], v67 offset:54272
    ds_read_b64_tr_b16 a[192:193], v68 offset:16384
    ds_read_b64_tr_b16 a[194:195], v68 offset:17408
    ds_read_b64_tr_b16 a[196:197], v68 offset:20480
    ds_read_b64_tr_b16 a[198:199], v68 offset:21504
    ds_read_b64_tr_b16 a[200:201], v68 offset:49152
    ds_read_b64_tr_b16 a[202:203], v68 offset:50176
    ds_read_b64_tr_b16 a[204:205], v68 offset:53248
    ds_read_b64_tr_b16 a[206:207], v68 offset:54272
    s_waitcnt lgkmcnt(0)
    buffer_load_dword v72, v73, s[60:63], 0 offen sc1
    buffer_load_dwordx2 v[84:85], off, s[60:63], 0 offset:16 sc1
    s_waitcnt vmcnt(20)
    s_barrier
    s_mov_b32 s8, s46
    s_and_b32 s9, s47, 0xffff
    s_mov_b32 s10, 0x800000
    s_mov_b32 s11, 0x20000
    s_add_u32 s32, s3, 0x0
    s_add_u32 m0, s36, 16384
    s_nop 0
    buffer_load_dwordx4 v66, s[8:11], s32 offen lds
    s_add_u32 s32, s3, 0x1000
    s_add_u32 m0, s36, 17408
    s_nop 0
    buffer_load_dwordx4 v66, s[8:11], s32 offen lds
    s_add_u32 s32, s3, 0x2000
    s_add_u32 m0, s36, 18432
    s_nop 0
    buffer_load_dwordx4 v66, s[8:11], s32 offen lds
    s_add_u32 s32, s3, 0x3000
    s_add_u32 m0, s36, 19456
    s_nop 0
    buffer_load_dwordx4 v66, s[8:11], s32 offen lds
    s_add_u32 s32, s3, 0x4000
    s_add_u32 m0, s36, 20480
    s_nop 0
    buffer_load_dwordx4 v66, s[8:11], s32 offen lds
    s_add_u32 s32, s3, 0x5000
    s_add_u32 m0, s36, 21504
    s_nop 0
    buffer_load_dwordx4 v66, s[8:11], s32 offen lds
    s_add_u32 s32, s3, 0x6000
    s_add_u32 m0, s36, 22528
    s_nop 0
    buffer_load_dwordx4 v66, s[8:11], s32 offen lds
    s_add_u32 s32, s3, 0x7000
    s_add_u32 m0, s36, 23552
    s_nop 0
    buffer_load_dwordx4 v66, s[8:11], s32 offen lds
    ds_read_b64_tr_b16 a[80:81], v67 offset:24576
    ds_read_b64_tr_b16 a[82:83], v67 offset:25600
    ds_read_b64_tr_b16 a[84:85], v67 offset:28672
    ds_read_b64_tr_b16 a[86:87], v67 offset:29696
    ds_read_b64_tr_b16 a[88:89], v67 offset:57344
    ds_read_b64_tr_b16 a[90:91], v67 offset:58368
    ds_read_b64_tr_b16 a[92:93], v67 offset:61440
    ds_read_b64_tr_b16 a[94:95], v67 offset:62464
    ds_read_b64_tr_b16 a[208:209], v68 offset:24576
    ds_read_b64_tr_b16 a[210:211], v68 offset:25600
    ds_read_b64_tr_b16 a[212:213], v68 offset:28672
    ds_read_b64_tr_b16 a[214:215], v68 offset:29696
    ds_read_b64_tr_b16 a[216:217], v68 offset:57344
    ds_read_b64_tr_b16 a[218:219], v68 offset:58368
    ds_read_b64_tr_b16 a[220:221], v68 offset:61440
    ds_read_b64_tr_b16 a[222:223], v68 offset:62464
    s_waitcnt lgkmcnt(0)
    s_waitcnt vmcnt(19)
    s_barrier
    s_add_u32 s32, s3, 0x10000
    s_add_u32 m0, s36, 24576
    s_nop 0
    buffer_load_dwordx4 v66, s[8:11], s32 offen lds
    s_add_u32 s32, s3, 0x11000
    s_add_u32 m0, s36, 25600
    s_nop 0
    buffer_load_dwordx4 v66, s[8:11], s32 offen lds
    s_add_u32 s32, s3, 0x12000
    s_add_u32 m0, s36, 26624
    s_nop 0
    buffer_load_dwordx4 v66, s[8:11], s32 offen lds
    s_add_u32 s32, s3, 0x13000
    s_add_u32 m0, s36, 27648
    s_nop 0
    buffer_load_dwordx4 v66, s[8:11], s32 offen lds
    s_add_u32 s32, s3, 0x14000
    s_add_u32 m0, s36, 28672
    s_nop 0
    buffer_load_dwordx4 v66, s[8:11], s32 offen lds
    s_add_u32 s32, s3, 0x15000
    s_add_u32 m0, s36, 29696
    s_nop 0
    buffer_load_dwordx4 v66, s[8:11], s32 offen lds
    s_add_u32 s32, s3, 0x16000
    s_add_u32 m0, s36, 30720
    s_nop 0
    buffer_load_dwordx4 v66, s[8:11], s32 offen lds
    s_add_u32 s32, s3, 0x17000
    s_add_u32 m0, s36, 31744
    s_nop 0
    buffer_load_dwordx4 v66, s[8:11], s32 offen lds
    ds_read_b64_tr_b16 a[96:97], v67 offset:0
    ds_read_b64_tr_b16 a[98:99], v67 offset:1024
    ds_read_b64_tr_b16 a[100:101], v67 offset:4096
    ds_read_b64_tr_b16 a[102:103], v67 offset:5120
    ds_read_b64_tr_b16 a[104:105], v67 offset:32768
    ds_read_b64_tr_b16 a[106:107], v67 offset:33792
    ds_read_b64_tr_b16 a[108:109], v67 offset:36864
    ds_read_b64_tr_b16 a[110:111], v67 offset:37888
    ds_read_b64_tr_b16 a[224:225], v68 offset:0
    ds_read_b64_tr_b16 a[226:227], v68 offset:1024
    ds_read_b64_tr_b16 a[228:229], v68 offset:4096
    ds_read_b64_tr_b16 a[230:231], v68 offset:5120
    ds_read_b64_tr_b16 a[232:233], v68 offset:32768
    ds_read_b64_tr_b16 a[234:235], v68 offset:33792
    ds_read_b64_tr_b16 a[236:237], v68 offset:36864
    ds_read_b64_tr_b16 a[238:239], v68 offset:37888
    s_waitcnt lgkmcnt(0)
    s_waitcnt vmcnt(18)
    s_barrier
    s_mov_b32 s8, s44
    s_and_b32 s9, s45, 0xffff
    s_mov_b32 s10, 0x800000
    s_mov_b32 s11, 0x20000
    s_sub_u32 s39, 511, s44
    s_and_b32 s39, s39, 0x380
    s_andn2_b32 s32, s35, 0x1fff
    s_add_u32 s39, s39, s32
    s_add_u32 s32, s39, 0x200000
    buffer_load_dword v86, v77, s[8:11], s32 offen
    s_add_u32 s32, s35, 0x200000
    s_add_u32 m0, s36, 0
    s_nop 0
    buffer_load_dwordx4 v65, s[8:11], s32 offen lds
    s_add_u32 s32, s35, 0x204000
    s_add_u32 m0, s36, 1024
    s_nop 0
    buffer_load_dwordx4 v65, s[8:11], s32 offen lds
    s_add_u32 s32, s35, 0x210000
    s_add_u32 m0, s36, 2048
    s_nop 0
    buffer_load_dwordx4 v65, s[8:11], s32 offen lds
    s_add_u32 s32, s35, 0x214000
    s_add_u32 m0, s36, 3072
    s_nop 0
    buffer_load_dwordx4 v65, s[8:11], s32 offen lds
    s_add_u32 s32, s35, 0x220000
    s_add_u32 m0, s36, 4096
    s_nop 0
    buffer_load_dwordx4 v65, s[8:11], s32 offen lds
    s_add_u32 s32, s35, 0x224000
    s_add_u32 m0, s36, 5120
    s_nop 0
    buffer_load_dwordx4 v65, s[8:11], s32 offen lds
    s_add_u32 s32, s35, 0x230000
    s_add_u32 m0, s36, 6144
    s_nop 0
    buffer_load_dwordx4 v65, s[8:11], s32 offen lds
    s_add_u32 s32, s35, 0x234000
    s_add_u32 m0, s36, 7168
    s_nop 0
    buffer_load_dwordx4 v65, s[8:11], s32 offen lds
    ds_read_b64_tr_b16 a[112:113], v67 offset:8192
    ds_read_b64_tr_b16 a[114:115], v67 offset:9216
    ds_read_b64_tr_b16 a[116:117], v67 offset:12288
    ds_read_b64_tr_b16 a[118:119], v67 offset:13312
    ds_read_b64_tr_b16 a[120:121], v67 offset:40960
    ds_read_b64_tr_b16 a[122:123], v67 offset:41984
    ds_read_b64_tr_b16 a[124:125], v67 offset:45056
    ds_read_b64_tr_b16 a[126:127], v67 offset:46080
    ds_read_b64_tr_b16 a[240:241], v68 offset:8192
    ds_read_b64_tr_b16 a[242:243], v68 offset:9216
    ds_read_b64_tr_b16 a[244:245], v68 offset:12288
    ds_read_b64_tr_b16 a[246:247], v68 offset:13312
    ds_read_b64_tr_b16 a[248:249], v68 offset:40960
    ds_read_b64_tr_b16 a[250:251], v68 offset:41984
    ds_read_b64_tr_b16 a[252:253], v68 offset:45056
    ds_read_b64_tr_b16 a[254:255], v68 offset:46080
    s_waitcnt lgkmcnt(0)
    s_waitcnt vmcnt(17)
    s_barrier
    s_add_u32 s32, s39, 0x300000
    buffer_load_dword v86, v77, s[8:11], s32 offen
    s_add_u32 s32, s35, 0x300000
    s_add_u32 m0, s36, 8192
    s_nop 0
    buffer_load_dwordx4 v65, s[8:11], s32 offen lds
    s_add_u32 s32, s35, 0x304000
    s_add_u32 m0, s36, 9216
    s_nop 0
    buffer_load_dwordx4 v65, s[8:11], s32 offen lds
    s_add_u32 s32, s35, 0x310000
    s_add_u32 m0, s36, 10240
    s_nop 0
    buffer_load_dwordx4 v65, s[8:11], s32 offen lds
    s_add_u32 s32, s35, 0x314000
    s_add_u32 m0, s36, 11264
    s_nop 0
    buffer_load_dwordx4 v65, s[8:11], s32 offen lds
    s_add_u32 s32, s35, 0x320000
    s_add_u32 m0, s36, 12288
    s_nop 0
    buffer_load_dwordx4 v65, s[8:11], s32 offen lds
    s_add_u32 s32, s35, 0x324000
    s_add_u32 m0, s36, 13312
    s_nop 0
    buffer_load_dwordx4 v65, s[8:11], s32 offen lds
    s_add_u32 s32, s35, 0x330000
    s_add_u32 m0, s36, 14336
    s_nop 0
    buffer_load_dwordx4 v65, s[8:11], s32 offen lds
    s_add_u32 s32, s35, 0x334000
    s_add_u32 m0, s36, 15360
    s_nop 0
    buffer_load_dwordx4 v65, s[8:11], s32 offen lds
    v_readlane_b32 s48, v72, 0
    v_readlane_b32 s49, v72, 1
    v_readlane_b32 s50, v72, 2
    v_readlane_b32 s51, v72, 3
    v_readlane_b32 s52, v72, 4
    v_readlane_b32 s53, v72, 5
    v_readlane_b32 s54, v72, 6
    v_readlane_b32 s55, v72, 7
    v_readlane_b32 s38, v72, 8
    s_nop 3
    s_add_u32 s33, s48, s49
    s_add_u32 s33, s33, s50
    s_add_u32 s33, s33, s51
    s_add_u32 s33, s33, s52
    s_add_u32 s33, s33, s53
    s_add_u32 s33, s33, s54
    s_add_u32 s33, s33, s55
    s_cmp_ge_u32 s38, 4
    s_cselect_b32 s33, s33, 0
    s_cmp_ge_u32 s33, 256
    s_cselect_b32 s38, 0, 1
    ds_read_b64_tr_b16 v[192:193], v80 offset:16384
    ds_read_b64_tr_b16 v[194:195], v80 offset:17408
    ds_read_b64_tr_b16 v[196:197], v80 offset:20480
    ds_read_b64_tr_b16 v[198:199], v80 offset:21504
    ds_read_b64_tr_b16 v[208:209], v81 offset:16384
    ds_read_b64_tr_b16 v[210:211], v81 offset:17408
    ds_read_b64_tr_b16 v[212:213], v81 offset:20480
    ds_read_b64_tr_b16 v[214:215], v81 offset:21504
    ds_read_b64_tr_b16 v[224:225], v82 offset:16384
    ds_read_b64_tr_b16 v[226:227], v82 offset:17408
    ds_read_b64_tr_b16 v[228:229], v82 offset:20480
    ds_read_b64_tr_b16 v[230:231], v82 offset:21504
    ds_read_b64_tr_b16 v[240:241], v83 offset:16384
    ds_read_b64_tr_b16 v[242:243], v83 offset:17408
    ds_read_b64_tr_b16 v[244:245], v83 offset:20480
    ds_read_b64_tr_b16 v[246:247], v83 offset:21504
    s_waitcnt lgkmcnt(0)
    s_waitcnt vmcnt(18)
    s_barrier
    s_mov_b32 s8, s46
    s_and_b32 s9, s47, 0xffff
    s_mov_b32 s10, 0x800000
    s_mov_b32 s11, 0x20000
    s_add_u32 s32, s3, 0x20000
    s_add_u32 m0, s36, 16384
    s_nop 0
    buffer_load_dwordx4 v66, s[8:11], s32 offen lds
    s_add_u32 s32, s3, 0x21000
    s_add_u32 m0, s36, 17408
    s_nop 0
    buffer_load_dwordx4 v66, s[8:11], s32 offen lds
    s_add_u32 s32, s3, 0x22000
    s_add_u32 m0, s36, 18432
    s_nop 0
    buffer_load_dwordx4 v66, s[8:11], s32 offen lds
    s_add_u32 s32, s3, 0x23000
    s_add_u32 m0, s36, 19456
    s_nop 0
    buffer_load_dwordx4 v66, s[8:11], s32 offen lds
    s_add_u32 s32, s3, 0x24000
    s_add_u32 m0, s36, 20480
    s_nop 0
    buffer_load_dwordx4 v66, s[8:11], s32 offen lds
    s_add_u32 s32, s3, 0x25000
    s_add_u32 m0, s36, 21504
    s_nop 0
    buffer_load_dwordx4 v66, s[8:11], s32 offen lds
    s_add_u32 s32, s3, 0x26000
    s_add_u32 m0, s36, 22528
    s_nop 0
    buffer_load_dwordx4 v66, s[8:11], s32 offen lds
    s_add_u32 s32, s3, 0x27000
    s_add_u32 m0, s36, 23552
    s_nop 0
    buffer_load_dwordx4 v66, s[8:11], s32 offen lds
    ds_read_b64_tr_b16 v[200:201], v80 offset:24576
    ds_read_b64_tr_b16 v[202:203], v80 offset:25600
    ds_read_b64_tr_b16 v[204:205], v80 offset:28672
    ds_read_b64_tr_b16 v[206:207], v80 offset:29696
    ds_read_b64_tr_b16 v[216:217], v81 offset:24576
    ds_read_b64_tr_b16 v[218:219], v81 offset:25600
    ds_read_b64_tr_b16 v[220:221], v81 offset:28672
    ds_read_b64_tr_b16 v[222:223], v81 offset:29696
    ds_read_b64_tr_b16 v[232:233], v82 offset:24576
    ds_read_b64_tr_b16 v[234:235], v82 offset:25600
    ds_read_b64_tr_b16 v[236:237], v82 offset:28672
    ds_read_b64_tr_b16 v[238:239], v82 offset:29696
    ds_read_b64_tr_b16 v[248:249], v83 offset:24576
    ds_read_b64_tr_b16 v[250:251], v83 offset:25600
    ds_read_b64_tr_b16 v[252:253], v83 offset:28672
    ds_read_b64_tr_b16 v[254:255], v83 offset:29696
    s_waitcnt lgkmcnt(0)
    s_waitcnt vmcnt(17)
    s_barrier
    s_add_u32 s32, s3, 0x30000
    s_add_u32 m0, s36, 24576
    s_nop 0
    buffer_load_dwordx4 v66, s[8:11], s32 offen lds
    s_add_u32 s32, s3, 0x31000
    s_add_u32 m0, s36, 25600
    s_nop 0
    buffer_load_dwordx4 v66, s[8:11], s32 offen lds
    s_add_u32 s32, s3, 0x32000
    s_add_u32 m0, s36, 26624
    s_nop 0
    buffer_load_dwordx4 v66, s[8:11], s32 offen lds
    s_add_u32 s32, s3, 0x33000
    s_add_u32 m0, s36, 27648
    s_nop 0
    buffer_load_dwordx4 v66, s[8:11], s32 offen lds
    s_add_u32 s32, s3, 0x34000
    s_add_u32 m0, s36, 28672
    s_nop 0
    buffer_load_dwordx4 v66, s[8:11], s32 offen lds
    s_add_u32 s32, s3, 0x35000
    s_add_u32 m0, s36, 29696
    s_nop 0
    buffer_load_dwordx4 v66, s[8:11], s32 offen lds
    s_add_u32 s32, s3, 0x36000
    s_add_u32 m0, s36, 30720
    s_nop 0
    buffer_load_dwordx4 v66, s[8:11], s32 offen lds
    s_add_u32 s32, s3, 0x37000
    s_add_u32 m0, s36, 31744
    s_nop 0
    buffer_load_dwordx4 v66, s[8:11], s32 offen lds
    ds_read_b64_tr_b16 v[0:1], v69 offset:0
    ds_read_b64_tr_b16 v[2:3], v69 offset:1024
    ds_read_b64_tr_b16 v[4:5], v69 offset:4096
    ds_read_b64_tr_b16 v[6:7], v69 offset:5120
    ds_read_b64_tr_b16 v[8:9], v69 offset:32768
    ds_read_b64_tr_b16 v[10:11], v69 offset:33792
    ds_read_b64_tr_b16 v[12:13], v69 offset:36864
    ds_read_b64_tr_b16 v[14:15], v69 offset:37888
    ds_read_b64_tr_b16 v[16:17], v70 offset:0
    ds_read_b64_tr_b16 v[18:19], v70 offset:1024
    ds_read_b64_tr_b16 v[20:21], v70 offset:4096
    ds_read_b64_tr_b16 v[22:23], v70 offset:5120
    ds_read_b64_tr_b16 v[24:25], v70 offset:32768
    ds_read_b64_tr_b16 v[26:27], v70 offset:33792
    ds_read_b64_tr_b16 v[28:29], v70 offset:36864
    ds_read_b64_tr_b16 v[30:31], v70 offset:37888
    s_waitcnt lgkmcnt(0)
    v_and_b32 v64, 15, v94
    v_lshrrev_b32 v65, 4, v94
    v_mov_b32 v66, 0x3c00
    v_mov_b32 v67, 0x3c000000
    v_cmp_eq_u32 vcc, 0, v64
    s_nop 1
    v_cndmask_b32 v127, 0, v66, vcc
    v_cmp_eq_u32 vcc, 1, v64
    s_nop 1
    v_cndmask_b32 v106, v127, v67, vcc
    v_cmp_eq_u32 vcc, 2, v64
    s_nop 1
    v_cndmask_b32 v127, 0, v66, vcc
    v_cmp_eq_u32 vcc, 3, v64
    s_nop 1
    v_cndmask_b32 v107, v127, v67, vcc
    v_cmp_eq_u32 vcc, 4, v64
    s_nop 1
    v_cndmask_b32 v127, 0, v66, vcc
    v_cmp_eq_u32 vcc, 5, v64
    s_nop 1
    v_cndmask_b32 v108, v127, v67, vcc
    v_cmp_eq_u32 vcc, 6, v64
    s_nop 1
    v_cndmask_b32 v127, 0, v66, vcc
    v_cmp_eq_u32 vcc, 7, v64
    s_nop 1
    v_cndmask_b32 v109, v127, v67, vcc
    v_mov_b32 v66, 0x3f80
    v_mov_b32 v67, 0x3f800000
    v_and_b32 v126, 1, v65
    v_lshrrev_b32 v68, 1, v65
    v_lshl_add_u32 v126, v126, 2, v68
    v_sub_u32 v68, v64, v126
    v_cmp_eq_u32 vcc, 0, v68
    s_nop 1
    v_cndmask_b32 v127, 0, v66, vcc
    v_cmp_eq_u32 vcc, 2, v68
    s_nop 1
    v_cndmask_b32 v102, v127, v67, vcc
    v_cmp_eq_u32 vcc, 0, v68
    s_nop 1
    v_cndmask_b32 v127, 0, v66, vcc
    v_cmp_eq_u32 vcc, 2, v68
    s_nop 1
    v_cndmask_b32 v103, v127, v67, vcc
    v_cmp_eq_u32 vcc, 8, v68
    s_nop 1
    v_cndmask_b32 v127, 0, v66, vcc
    v_cmp_eq_u32 vcc, 10, v68
    s_nop 1
    v_cndmask_b32 v104, v127, v67, vcc
    v_cmp_eq_u32 vcc, 8, v68
    s_nop 1
    v_cndmask_b32 v127, 0, v66, vcc
    v_cmp_eq_u32 vcc, 10, v68
    s_nop 1
    v_cndmask_b32 v105, v127, v67, vcc
    v_mov_b32 v100, 0x3f003f00
    v_mov_b32 v101, 0x3f003f00
    v_and_b32 v126, 7, v64
    v_lshlrev_b32 v126, 4, v126
    v_lshl_add_u32 v114, v65, 7, v126
    v_lshrrev_b32 v126, 3, v64
    v_lshl_add_u32 v119, v126, 3, v114
    v_lshl_add_u32 v118, v126, 11, v114
    v_lshl_add_u32 v118, s14, 9, v118
    v_lshlrev_b32 v126, 4, v64
    v_lshl_add_u32 v120, v65, 13, v126
    v_lshlrev_b32 v123, 3, v94
    s_lshl_b32 s32, s14, 10
    s_add_u32 s32, s32, 16384
    v_and_b32 v126, 32, v94
    v_lshlrev_b32 v126, 1, v126
    v_xor_b32 v126, v126, v123
    v_add_u32 v124, s32, v126
    v_lshrrev_b32 v126, 2, v64
    v_lshrrev_b32 v127, 1, v65
    v_lshl_add_u32 v126, v126, 1, v127
    v_and_b32 v127, 3, v64
    v_lshl_add_u32 v126, v126, 2, v127
    v_and_b32 v127, 1, v65
    v_lshl_add_u32 v126, v126, 1, v127
    v_lshlrev_b32 v126, 3, v126
    v_mov_b32 v95, 0x7f000000
    v_mov_b32 v66, 0x4444
    v_mov_b32 v67, 0xeeee
    v_cmp_gt_u32 vcc, 8, v64
    s_nop 1
    v_cndmask_b32 v122, v95, v126, vcc
    v_cndmask_b32 v125, v114, v95, vcc
    v_cndmask_b32 v110, v67, v66, vcc
    v_lshrrev_b32 v126, 2, v94
    v_lshlrev_b32 v126, 3, v126
    v_and_b32 v127, 2, v94
    v_lshlrev_b32 v127, 5, v127
    v_xor_b32 v126, v126, v127
    v_and_b32 v127, 3, v94
    v_lshl_add_u32 v115, v127, 7, v126
    s_mov_b32 s37, 0x3f80
    s_mov_b32 s57, 0x3f800000
    s_and_b32 s32, s14, 1
    s_lshr_b32 s33, s14, 1
    s_lshl2_add_u32 s32, s32, s33
    s_lshl_b32 s59, s32, 9
    s_mov_b32 s17, 0
    s_mov_b32 s0, 0x00ff00ff
    s_mov_b32 s1, s0
    s_mov_b64 s[44:45], s[0:1]
    s_lshl_b32 s32, s12, 18
    s_lshl2_add_u32 s33, s13, s14
    s_lshl_b32 s34, s33, 11
    s_add_u32 s28, s34, 0x2800000
    s_add_u32 s21, s32, s34
    s_add_u32 s21, s21, 0x6c00000
    s_lshl_b32 s34, s13, 8
    s_add_u32 s23, s32, s34
    s_add_u32 s23, s23, 0x6c80000
    s_lshl_b32 s32, s12, 13
    s_add_u32 s25, s32, 0x6d00000
    s_add_u32 s24, s25, s34
    s_lshl_b32 s34, s33, 9
    s_add_u32 s26, s34, 0x8000000
    s_add_u32 s31, s34, 0x6e00000
    s_cmp_eq_u32 s12, 0
    s_cselect_b32 s26, s26, s31
    s_lshl_b32 s32, s12, 7
    s_add_u32 s32, s32, s33
    s_cmp_eq_u32 s32, 1
    s_mov_b32 s39, 0x7f000000
    s_cselect_b32 s39, 0x841ec04, s39
    s_lshl_b32 s27, s13, 12
    s_lshl_b32 s36, s14, 11
    s_and_b32 s33, s36, 2048
    s_add_u32 s27, s27, s33
    s_lshr_b32 s33, s14, 1
    s_lshl_b32 s33, s33, 17
    s_add_u32 s27, s27, s33
    s_add_u32 s27, s27, 0x1800000
    s_add_u32 s36, s36, 24576
    v_add_u32 v112, 24576, v116
    s_lshl_b32 s32, s12, 12
    s_add_u32 s32, s32, 0x841c000
    s_lshl2_add_u32 s46, s13, s32
    v_lshl_add_u32 v117, v123, 25, v114
    s_and_b32 s33, s13, 3
    s_lshl_b32 s33, s33, 7
    s_add_u32 s47, s32, s33
    s_cmp_eq_u32 s14, 0
    s_cselect_b32 s47, s47, 0x7f000000
    s_cselect_b32 s11, -1, 0
    s_mov_b32 s30, 0x3e0293ee
    v_mov_b32 v121, 0x7f000000
    v_and_b32 v127, 1, v94
    s_mov_b32 exec_lo, 0
    s_mov_b32 exec_hi, 0x300
    s_lshl_b32 s32, s13, 8
    s_add_u32 s32, s32, 0x8406000
    v_lshl_add_u32 v121, v127, 13, s32
    s_mov_b32 exec_hi, 0x3c00
    s_mov_b32 s32, 0x841760c
    v_lshl_add_u32 v121, v64, 8, s32
    s_mov_b64 exec, -1
    s_waitcnt vmcnt(16)
    s_barrier
    ds_write_b128 v113, v[0:3] offset:0
    ds_write_b128 v113, v[4:7] offset:1024
    ds_write_b128 v113, v[8:11] offset:2048
    ds_write_b128 v113, v[12:15] offset:3072
    ds_write_b128 v113, v[16:19] offset:4096
    ds_write_b128 v113, v[20:23] offset:5120
    ds_write_b128 v113, v[24:27] offset:6144
    ds_write_b128 v113, v[28:31] offset:7168
    ds_read_b64_tr_b16 v[32:33], v69 offset:8192
    ds_read_b64_tr_b16 v[34:35], v69 offset:9216
    ds_read_b64_tr_b16 v[36:37], v69 offset:12288
    ds_read_b64_tr_b16 v[38:39], v69 offset:13312
    ds_read_b64_tr_b16 v[40:41], v69 offset:40960
    ds_read_b64_tr_b16 v[42:43], v69 offset:41984
    ds_read_b64_tr_b16 v[44:45], v69 offset:45056
    ds_read_b64_tr_b16 v[46:47], v69 offset:46080
    ds_read_b64_tr_b16 v[48:49], v70 offset:8192
    ds_read_b64_tr_b16 v[50:51], v70 offset:9216
    ds_read_b64_tr_b16 v[52:53], v70 offset:12288
    ds_read_b64_tr_b16 v[54:55], v70 offset:13312
    ds_read_b64_tr_b16 v[56:57], v70 offset:40960
    ds_read_b64_tr_b16 v[58:59], v70 offset:41984
    ds_read_b64_tr_b16 v[60:61], v70 offset:45056
    ds_read_b64_tr_b16 v[62:63], v70 offset:46080
    s_waitcnt lgkmcnt(0)
    s_waitcnt vmcnt(8)
    s_barrier
    ds_write_b128 v113, v[32:35] offset:8192
    ds_write_b128 v113, v[36:39] offset:9216
    ds_write_b128 v113, v[40:43] offset:10240
    ds_write_b128 v113, v[44:47] offset:11264
    ds_write_b128 v113, v[48:51] offset:12288
    ds_write_b128 v113, v[52:55] offset:13312
    ds_write_b128 v113, v[56:59] offset:14336
    ds_write_b128 v113, v[60:63] offset:15360
    buffer_load_dword v76, v74, s[4:7], 0 offen sc1
    buffer_load_dword v79, v75, s[4:7], 0 offen sc1
    ds_read_b64_tr_b16 v[0:1], v80 offset:16384
    ds_read_b64_tr_b16 v[2:3], v80 offset:17408
    ds_read_b64_tr_b16 v[4:5], v80 offset:20480
    ds_read_b64_tr_b16 v[6:7], v80 offset:21504
    ds_read_b64_tr_b16 v[8:9], v81 offset:16384
    ds_read_b64_tr_b16 v[10:11], v81 offset:17408
    ds_read_b64_tr_b16 v[12:13], v81 offset:20480
    ds_read_b64_tr_b16 v[14:15], v81 offset:21504
    ds_read_b64_tr_b16 v[16:17], v82 offset:16384
    ds_read_b64_tr_b16 v[18:19], v82 offset:17408
    ds_read_b64_tr_b16 v[20:21], v82 offset:20480
    ds_read_b64_tr_b16 v[22:23], v82 offset:21504
    ds_read_b64_tr_b16 v[24:25], v83 offset:16384
    ds_read_b64_tr_b16 v[26:27], v83 offset:17408
    ds_read_b64_tr_b16 v[28:29], v83 offset:20480
    ds_read_b64_tr_b16 v[30:31], v83 offset:21504
    s_waitcnt lgkmcnt(0)
    ds_write_b128 v113, v[0:3] offset:16384
    ds_write_b128 v113, v[4:7] offset:17408
    ds_write_b128 v113, v[8:11] offset:18432
    ds_write_b128 v113, v[12:15] offset:19456
    ds_write_b128 v113, v[16:19] offset:20480
    ds_write_b128 v113, v[20:23] offset:21504
    ds_write_b128 v113, v[24:27] offset:22528
    ds_write_b128 v113, v[28:31] offset:23552
    s_waitcnt lgkmcnt(0)
    s_waitcnt vmcnt(2)
    s_waitcnt vmcnt(0)
    v_min_u32 v76, v76, v79
    v_cmp_eq_u32 vcc, 0, v76
    s_cmp_eq_u32 s38, 0
    s_cbranch_scc0 main_kernel_c_sl0
    s_cbranch_vccnz main_kernel_c_sl1
    s_branch main_kernel_c_kv0_ok
main_kernel_c_sl0:
    v_and_b32 v126, 7, v94
    v_lshlrev_b32 v126, 5, v126
main_kernel_c_mode_cnt:
    buffer_load_dword v127, v126, s[60:63], 0 offen sc1
    s_waitcnt vmcnt(0)
    v_readlane_b32 s48, v127, 0
    v_readlane_b32 s49, v127, 1
    v_readlane_b32 s50, v127, 2
    v_readlane_b32 s51, v127, 3
    v_readlane_b32 s52, v127, 4
    v_readlane_b32 s53, v127, 5
    v_readlane_b32 s54, v127, 6
    v_readlane_b32 s55, v127, 7
    s_nop 3
    s_add_u32 s33, s48, s49
    s_add_u32 s33, s33, s50
    s_add_u32 s33, s33, s51
    s_add_u32 s33, s33, s52
    s_add_u32 s33, s33, s53
    s_add_u32 s33, s33, s54
    s_add_u32 s33, s33, s55
    s_cmp_ge_u32 s33, 256
    s_cbranch_scc1 main_kernel_c_mode_cnt_ok
    s_sub_u32 s29, s29, 1
    s_cbranch_scc1 main_kernel_end
    s_sleep 4
    s_branch main_kernel_c_mode_cnt
main_kernel_c_mode_cnt_ok:
    v_mov_b32 v126, 0
main_kernel_c_wa:
    buffer_load_dword v127, v126, s[60:63], 0 offen offset:12 sc1
    s_waitcnt vmcnt(0)
    v_cmp_gt_u32 vcc, 4, v127
    s_cbranch_vccz main_kernel_c_wa_ok
    s_sleep 4
    s_sub_u32 s29, s29, 1
    s_cbranch_scc0 main_kernel_c_wa
    s_branch main_kernel_end
main_kernel_c_wa_ok:
main_kernel_c_sl1:
    v_lshlrev_b32 v126, 2, v94
    s_mov_b32 s32, 0x841f000
main_kernel_c_wf:
    buffer_load_dword v0, v126, s[4:7], s32 offen sc1
    s_waitcnt vmcnt(0)
    v_cmp_eq_u32 vcc, 0, v0
    s_cbranch_vccz main_kernel_c_wf_ok
    s_sleep 4
    s_sub_u32 s29, s29, 1
    s_cbranch_scc0 main_kernel_c_wf
    s_branch main_kernel_end
main_kernel_c_wf_ok:
    s_mov_b32 exec_lo, 0
    s_mov_b32 exec_hi, 0x300
    v_subrev_u32 v127, 0, v121
main_kernel_c_kv0:
    buffer_load_dword v126, v127, s[4:7], 0 offen sc1
    s_waitcnt vmcnt(0)
    v_cmp_eq_u32 vcc, 0, v126
    s_cbranch_vccz main_kernel_c_kv0_ok
    s_sleep 2
    s_sub_u32 s29, s29, 1
    s_cbranch_scc0 main_kernel_c_kv0
    s_branch main_kernel_end
main_kernel_c_kv0_ok:
    s_mov_b32 exec_lo, 0
    s_mov_b32 exec_hi, 0x100
    v_add_u32 v121, 4, v121
    s_mov_b64 exec, -1
    v_add_u32 v121, 4, v121
    v_lshlrev_b32 v126, 3, v116
    v_and_b32 v126, 0x780, v126
    s_mov_b32 m0, s36
    buffer_load_dword v111, v126, s[4:7], s21 offen sc1
    buffer_load_dwordx4 v116, s[4:7], s27 offen offset:0 sc1 lds
    buffer_load_dwordx4 v116, s[4:7], s27 offen offset:1024 sc1 lds
    s_lshl_b32 s32, s14, 11
    s_add_u32 m0, s32, 0
    s_add_u32 s32, s32, s25
    buffer_load_dwordx4 v116, s[4:7], s32 offen offset:0 sc1 lds
    buffer_load_dwordx4 v116, s[4:7], s32 offen offset:1024 sc1 lds
    s_add_u32 s27, s27, 0x40000
    ds_read_b64_tr_b16 v[32:33], v80 offset:24576
    ds_read_b64_tr_b16 v[34:35], v80 offset:25600
    ds_read_b64_tr_b16 v[36:37], v80 offset:28672
    ds_read_b64_tr_b16 v[38:39], v80 offset:29696
    ds_read_b64_tr_b16 v[40:41], v81 offset:24576
    ds_read_b64_tr_b16 v[42:43], v81 offset:25600
    ds_read_b64_tr_b16 v[44:45], v81 offset:28672
    ds_read_b64_tr_b16 v[46:47], v81 offset:29696
    ds_read_b64_tr_b16 v[48:49], v82 offset:24576
    ds_read_b64_tr_b16 v[50:51], v82 offset:25600
    ds_read_b64_tr_b16 v[52:53], v82 offset:28672
    ds_read_b64_tr_b16 v[54:55], v82 offset:29696
    ds_read_b64_tr_b16 v[56:57], v83 offset:24576
    ds_read_b64_tr_b16 v[58:59], v83 offset:25600
    ds_read_b64_tr_b16 v[60:61], v83 offset:28672
    ds_read_b64_tr_b16 v[62:63], v83 offset:29696
    s_waitcnt lgkmcnt(0)
    ds_write_b128 v113, v[32:35] offset:24576
    ds_write_b128 v113, v[36:39] offset:25600
    ds_write_b128 v113, v[40:43] offset:26624
    ds_write_b128 v113, v[44:47] offset:27648
    ds_write_b128 v113, v[48:51] offset:28672
    ds_write_b128 v113, v[52:55] offset:29696
    ds_write_b128 v113, v[56:59] offset:30720
    ds_write_b128 v113, v[60:63] offset:31744
    s_waitcnt lgkmcnt(0)
main_kernel_c_nb:
    v_readfirstlane_b32 s33, v84
    v_readfirstlane_b32 s32, v85
    s_nop 3
    s_and_b32 s34, s32, s33
    s_cbranch_scc1 main_kernel_c_nb_ok
    buffer_load_dwordx2 v[84:85], off, s[60:63], 0 offset:16 sc1
    s_sub_u32 s29, s29, 1
    s_cbranch_scc1 main_kernel_end
    s_waitcnt vmcnt(0)
    s_branch main_kernel_c_nb
main_kernel_c_nb_ok:
    s_and_b32 s33, s33, 1
    s_lshl_b32 s32, s12, 5
    s_add_u32 s32, s32, s13
    s_lshl1_add_u32 s32, s32, s33
    s_lshl2_add_u32 s32, s32, s14
    s_lshl_b32 s32, s32, 11
    s_add_u32 s18, s32, 0x8c00000
    s_xor_b32 s19, s18, 0x80000
    v_mov_b32 v64, 0
    v_mov_b32 v65, 0
    v_mov_b32 v66, 0
    v_mov_b32 v67, 0
    v_mov_b32 v68, 0
    v_mov_b32 v69, 0
    v_mov_b32 v70, 0
    v_mov_b32 v71, 0
    v_mov_b32 v96, 0
    v_mov_b32 v97, 0
    v_mov_b32 v98, 0
    v_mov_b32 v99, 0
    s_xor_b32 s36, s36, 0x4000
    s_waitcnt vmcnt(0)
    buffer_store_dword v64, off, s[4:7], s18 offset:1536 sc1
    s_mov_b32 m0, s36
    buffer_load_dwordx4 v[88:91], v116, s[4:7], s28 offen offset:0 sc1
    buffer_load_dwordx4 v116, s[4:7], s27 offen offset:0 sc1 lds
    buffer_load_dwordx4 v[92:95], v116, s[4:7], s28 offen offset:1024 sc1
    s_barrier
    s_memrealtime s[32:33]
    s_waitcnt lgkmcnt(0)
    s_mul_i32 s32, s32, 22
    s_sub_u32 s20, s32, 0x40000
    s_mov_b32 s9, 0
    s_mov_b32 s10, 0
    s_memtime s[52:53]
    s_waitcnt lgkmcnt(0)
    s_sub_u32 s38, s52, s32
    s_sub_u32 s3, s52, 0x4000
    v_mov_b32 v126, s38
    ds_write_b32 v123, v126 offset:20992
    s_waitcnt lgkmcnt(0)
    s_min_u32 s32, s48, s49
    s_cmp_ge_u32 s32, 32
    s_cbranch_scc0 main_kernel_cs_top
    .p2align 6
main_kernel_cf_top:
    s_barrier
main_kernel_cf_mrd:
    ds_read_b128 v[0:3], v114 offset:0
    ds_read_b128 v[4:7], v114 offset:512
    ds_read_b128 v[8:11], v114 offset:1024
    ds_read_b128 v[12:15], v114 offset:1536
    ds_read_b128 v[16:19], v114 offset:2048
    s_waitcnt lgkmcnt(4)
    v_smfmac_f32_16x16x64_bf16 v[96:99], v[0:3], a[0:7], v110
    ds_read_b128 v[20:23], v114 offset:2560
    s_waitcnt lgkmcnt(4)
    v_smfmac_f32_16x16x64_bf16 v[96:99], v[4:7], a[8:15], v110
    ds_read_b128 v[24:27], v114 offset:3072
    s_waitcnt lgkmcnt(4)
    s_bfe_u32 s22, s17, 0x10001
    v_smfmac_f32_16x16x64_bf16 v[96:99], v[8:11], a[16:23], v110
    ds_read_b128 v[28:31], v114 offset:3584
    s_waitcnt lgkmcnt(4)
    v_smfmac_f32_16x16x64_bf16 v[96:99], v[12:15], a[24:31], v110
    ds_read_b128 v[32:35], v114 offset:4096
    s_waitcnt lgkmcnt(4)
    v_smfmac_f32_16x16x64_bf16 v[96:99], v[16:19], a[32:39], v110
    ds_read_b128 v[36:39], v114 offset:4608
    s_waitcnt lgkmcnt(4)
    v_smfmac_f32_16x16x64_bf16 v[96:99], v[20:23], a[40:47], v110
    ds_read_b128 v[40:43], v114 offset:5120
    s_waitcnt lgkmcnt(4)
    v_smfmac_f32_16x16x64_bf16 v[96:99], v[24:27], a[48:55], v110
    ds_read_b128 v[44:47], v114 offset:5632
    s_waitcnt lgkmcnt(4)
    v_smfmac_f32_16x16x64_bf16 v[96:99], v[28:31], a[56:63], v110
    ds_read_b128 v[48:51], v114 offset:6144
    s_waitcnt lgkmcnt(4)
    v_smfmac_f32_16x16x64_bf16 v[96:99], v[32:35], a[64:71], v110
    ds_read_b128 v[52:55], v114 offset:6656
    s_waitcnt lgkmcnt(4)
    v_smfmac_f32_16x16x64_bf16 v[96:99], v[36:39], a[72:79], v110
    ds_read_b128 v[56:59], v114 offset:7168
    s_waitcnt lgkmcnt(4)
    v_smfmac_f32_16x16x64_bf16 v[96:99], v[40:43], a[80:87], v110
    ds_read_b128 v[60:63], v114 offset:7680
    s_waitcnt lgkmcnt(4)
    v_smfmac_f32_16x16x64_bf16 v[96:99], v[44:47], a[88:95], v110
    s_waitcnt lgkmcnt(3)
    buffer_load_dword v111, v121, s[4:7], 0 offen sc1
    v_smfmac_f32_16x16x64_bf16 v[96:99], v[48:51], a[96:103], v110
    s_waitcnt lgkmcnt(2)
    ds_read_b128 v[80:83], v113 offset:0
    v_smfmac_f32_16x16x64_bf16 v[96:99], v[52:55], a[104:111], v110
    s_waitcnt lgkmcnt(2)
    ds_read_b128 v[84:87], v113 offset:1024
    v_smfmac_f32_16x16x64_bf16 v[96:99], v[56:59], a[112:119], v110
    s_waitcnt lgkmcnt(2)
    v_smfmac_f32_16x16x64_bf16 v[96:99], v[60:63], a[120:127], v110
    v_smfmac_f32_16x16x64_bf16 v[68:71], v[0:3], a[128:135], v110
    ds_read_b128 v[72:75], v113 offset:2048
    v_smfmac_f32_16x16x64_bf16 v[68:71], v[4:7], a[136:143], v110
    s_nop 1
    v_pk_add_f32 v[126:127], v[96:97], v[98:99]
    ds_read_b128 v[76:79], v113 offset:3072
    v_smfmac_f32_16x16x64_bf16 v[68:71], v[8:11], a[144:151], v110
    v_cmp_u_f32 vcc, v126, v127
    v_smfmac_f32_16x16x64_bf16 v[68:71], v[12:15], a[152:159], v110
    v_cvt_pk_bf16_f32 v126, v96, v97
    v_smfmac_f32_16x16x64_bf16 v[68:71], v[16:19], a[160:167], v110
    v_cvt_pk_bf16_f32 v127, v98, v99
    s_and_b64 s[42:43], vcc, s[44:45]
    s_cbranch_scc1 main_kernel_cf_m_f
    v_smfmac_f32_16x16x64_bf16 v[68:71], v[20:23], a[168:175], v110
    v_bfi_b32 v126, 1, s22, v126
    buffer_store_dwordx2 v[126:127], v123, s[4:7], s18 offen sc1
    v_smfmac_f32_16x16x64_bf16 v[68:71], v[24:27], a[176:183], v110
    s_mov_b64 s[44:45], s[0:1]
    v_smfmac_f32_16x16x64_bf16 v[68:71], v[28:31], a[184:191], v110
    s_add_u32 s17, s17, 1
    s_bfe_u32 s40, s17, 0x10001
    v_smfmac_f32_16x16x64_bf16 v[68:71], v[32:35], a[192:199], v110
    s_add_u32 s28, s28, 0x40000
    s_mov_b32 m0, s36
    v_smfmac_f32_16x16x64_bf16 v[68:71], v[36:39], a[200:207], v110
    s_add_u32 s34, s3, 2130
    v_smfmac_f32_16x16x64_bf16 v[68:71], v[40:43], a[208:215], v110
    v_smfmac_f32_16x16x64_bf16 v[68:71], v[44:47], a[216:223], v110
    v_smfmac_f32_16x16x64_bf16 v[68:71], v[48:51], a[224:231], v110
    v_smfmac_f32_16x16x64_bf16 v[68:71], v[52:55], a[232:239], v110
    v_smfmac_f32_16x16x64_bf16 v[68:71], v[56:59], a[240:247], v110
    v_smfmac_f32_16x16x64_bf16 v[68:71], v[60:63], a[248:255], v110
    s_waitcnt lgkmcnt(2)
    v_smfmac_f32_16x16x64_bf16 v[64:67], v[32:35], v[80:87], v110
    s_waitcnt lgkmcnt(0)
    s_nop 3
    v_cvt_pk_bf16_f32 v126, v68, v69
    v_cvt_pk_bf16_f32 v127, v70, v71
    v_bfi_b32 v126, 1, s22, v126
    buffer_store_dwordx2 v[126:127], v123, s[4:7], s18 offen offset:512 sc1
    ds_read_b128 v[80:83], v113 offset:4096
    v_smfmac_f32_16x16x64_bf16 v[64:67], v[36:39], v[72:79], v110
    ds_read_b128 v[84:87], v113 offset:5120
    v_smfmac_f32_16x16x64_bf16 v[64:67], v[0:3], v[128:135], v110
    ds_read_b128 v[72:75], v113 offset:6144
    v_smfmac_f32_16x16x64_bf16 v[64:67], v[4:7], v[136:143], v110
    ds_read_b128 v[76:79], v113 offset:7168
    v_smfmac_f32_16x16x64_bf16 v[64:67], v[8:11], v[144:151], v110
    ds_read_b128 v[32:35], v113 offset:8192
    v_smfmac_f32_16x16x64_bf16 v[64:67], v[12:15], v[152:159], v110
    ds_read_b128 v[36:39], v113 offset:9216
    v_smfmac_f32_16x16x64_bf16 v[64:67], v[16:19], v[160:167], v110
    ds_read_b128 v[0:3], v113 offset:10240
    s_memtime s[52:53]
    v_smfmac_f32_16x16x64_bf16 v[64:67], v[20:23], v[168:175], v110
    ds_read_b128 v[4:7], v113 offset:11264
    s_memtime s[52:53]
    s_xor_b32 s32, s9, s22
    s_bitcmp1_b32 s32, 0
    s_cbranch_scc1 main_kernel_cf_t_p
main_kernel_cf_t_ok:
    s_sub_u32 s32, s9, s10
    v_smfmac_f32_16x16x64_bf16 v[64:67], v[24:27], v[176:183], v110
    ds_read_b128 v[8:11], v113 offset:12288
    s_memtime s[52:53]
    s_max_i32 s32, s32, 0
    s_min_i32 s32, s32, 0x4000
    v_smfmac_f32_16x16x64_bf16 v[64:67], v[28:31], v[184:191], v110
    s_waitcnt lgkmcnt(7)
    ds_read_b128 v[12:15], v113 offset:13312
    s_memtime s[52:53]
    s_add_u32 s34, s34, s32
    s_and_b32 s34, s34, s11
    v_smfmac_f32_16x16x64_bf16 v[64:67], v[40:43], v[80:87], v110
    s_waitcnt lgkmcnt(6)
    ds_read_b128 v[16:19], v113 offset:14336
    s_cmp_lt_u32 s52, s34
    s_cbranch_scc1 main_kernel_cf_t_w
main_kernel_cf_t_go:
    s_barrier
    buffer_load_dwordx2 v[126:127], v123, s[4:7], s19 offen offset:0 sc1
    v_smfmac_f32_16x16x64_bf16 v[64:67], v[44:47], v[72:79], v110
    s_waitcnt lgkmcnt(5)
    ds_read_b128 v[20:23], v113 offset:15360
    v_smfmac_f32_16x16x64_bf16 v[64:67], v[48:51], v[32:39], v110
    s_waitcnt lgkmcnt(4)
    v_smfmac_f32_16x16x64_bf16 v[64:67], v[52:55], v[0:7], v110
    s_waitcnt lgkmcnt(2)
    ds_read_b128 v[24:27], v112 offset:6144
    ds_read_b128 v[28:31], v112 offset:7168
    v_smfmac_f32_16x16x64_bf16 v[64:67], v[56:59], v[8:15], v110
    s_waitcnt lgkmcnt(2)
    ds_read_b128 v[0:3], v112 offset:0
    ds_read_b128 v[4:7], v112 offset:1024
    v_smfmac_f32_16x16x64_bf16 v[64:67], v[60:63], v[16:23], v110
    ds_read_b128 v[8:11], v112 offset:2048
    ds_read_b128 v[12:15], v112 offset:3072
    ds_read_b128 v[16:19], v112 offset:4096
    ds_read_b128 v[20:23], v112 offset:5120
    v_mov_b32 v76, 0
    v_mov_b32 v77, 0
    v_mov_b32 v78, 0
    s_nop 0
    v_permlane32_swap_b32 v64, v65
    v_permlane32_swap_b32 v66, v67
    v_cvt_pk_bf16_f32 v84, v64, v66
    v_cvt_pk_bf16_f32 v85, v65, v67
    v_bfi_b32 v84, 1, s22, v84
    buffer_load_dwordx2 v[42:43], v123, s[4:7], s19 offen offset:512 sc1
    v_mov_b32 v79, 0
    v_mov_b32 v80, 0
    v_mov_b32 v81, 0
    v_mov_b32 v82, 0
    v_mov_b32 v83, 0
    v_mov_b32 v60, 0
    v_mov_b32 v60, 0
    v_mov_b32 v60, 0
    v_mov_b32 v60, 0
    v_mov_b32 v60, 0
    v_mov_b32 v60, 0
    v_mov_b32 v60, 0
    buffer_store_dwordx2 v[84:85], v123, s[4:7], s18 offen offset:1024 sc1
    v_mov_b32 v60, 0
    v_mov_b32 v60, 0
    v_mov_b32 v60, 0
    v_mov_b32 v60, 0
    v_mov_b32 v60, 0
    v_mov_b32 v60, 0
    v_mov_b32 v60, 0
    v_mov_b32 v60, 0
    v_mov_b32 v60, 0
    v_mov_b32 v60, 0
    v_mov_b32 v60, 0
    v_mov_b32 v60, 0
    v_mov_b32 v60, 0
    v_mov_b32 v60, 0
    v_mov_b32 v60, 0
    v_mov_b32 v60, 0
    v_mov_b32 v60, 0
    v_mov_b32 v60, 0
    v_mov_b32 v60, 0
    v_mov_b32 v60, 0
    v_mov_b32 v60, 0
    v_mov_b32 v60, 0
    v_mov_b32 v60, 0
    v_mov_b32 v60, 0
    v_mov_b32 v60, 0
    v_mov_b32 v60, 0
    v_mov_b32 v60, 0
    v_mov_b32 v60, 0
    v_mov_b32 v60, 0
    v_mov_b32 v60, 0
    v_mov_b32 v60, 0
    v_mov_b32 v60, 0
    v_mov_b32 v60, 0
    v_mov_b32 v60, 0
    v_mov_b32 v60, 0
    v_mov_b32 v60, 0
    v_mov_b32 v60, 0
    v_mov_b32 v60, 0
    s_waitcnt vmcnt(2)
main_kernel_cf_z0:
    v_dot2_f32_bf16 v44, v126, s37, v96
    v_dot2_f32_bf16 v45, v126, s57, v97
    v_dot2_f32_bf16 v46, v127, s37, v98
    v_dot2_f32_bf16 v47, v127, s57, v99
    v_bitop3_b32 v60, v126, s22, 1 bitop3:0x28
    v_cvt_pk_bf16_f32 v44, v44, v45
    v_cmp_ne_u32 vcc, 0, v60
    v_cvt_pk_bf16_f32 v45, v46, v47
    ds_write_b64 v124, v[44:45] offset:0
    buffer_load_dwordx2 v[64:65], v123, s[4:7], s19 offen offset:512 sc1
    v_cmp_eq_u32 s[42:43], 0, v111
    s_cbranch_vccnz main_kernel_cf_z0_f
    v_mov_b32 v96, 0x3f803f80
    v_mov_b32 v97, 0x3f803f80
    v_mov_b32 v98, 0x3f803f80
    v_mov_b32 v99, 0x3f803f80
    s_and_b32 s32, s43, 0x3f00
    s_cbranch_scc1 main_kernel_cf_kvw
main_kernel_cf_kvok:
    s_waitcnt lgkmcnt(0)
    s_barrier
    ds_read_b64_tr_b16 v[48:49], v115 offset:16384
    ds_read_b64_tr_b16 v[50:51], v115 offset:17408
    ds_read_b64_tr_b16 v[52:53], v115 offset:18432
    ds_read_b64_tr_b16 v[54:55], v115 offset:19456
    s_waitcnt vmcnt(2)
    s_memtime s[52:53]
    v_dot2_f32_bf16 v44, v42, s37, v68
    v_dot2_f32_bf16 v45, v42, s57, v69
    v_dot2_f32_bf16 v46, v43, s37, v70
    v_dot2_f32_bf16 v47, v43, s57, v71
    v_bitop3_b32 v60, v42, s22, 1 bitop3:0x28
    v_cvt_pk_bf16_f32 v44, v44, v45
    v_cmp_ne_u32 vcc, 0, v60
    v_cvt_pk_bf16_f32 v45, v46, v47
    ds_write_b64 v124, v[44:45] offset:512
    s_waitcnt lgkmcnt(3)
    v_mfma_f32_16x16x32_bf16 v[32:35], v[0:3], v[48:51], 0
    v_mfma_f32_16x16x32_bf16 v[36:39], v[16:19], v[48:51], 0
    s_cbranch_vccnz main_kernel_cf_z1_f
main_kernel_cf_z_ok:
    v_mfma_f32_16x16x32_bf16 v[72:75], v[48:51], v[48:51], 0
    s_waitcnt lgkmcnt(1)
    s_sub_u32 s32, s52, s38
    v_mov_b32 v46, s32
    v_mfma_f32_16x16x32_bf16 v[32:35], v[4:7], v[52:55], v[32:35]
    buffer_load_dwordx2 v[86:87], v123, s[4:7], s19 offen offset:1024 sc1
    buffer_store_dword v46, v117, s[4:7], s46 offen
    s_cmp_eq_u32 s17, 64
    s_waitcnt lgkmcnt(0)
    s_barrier
    ds_read_b64_tr_b16 v[56:57], v115 offset:16896
    ds_read_b64_tr_b16 v[58:59], v115 offset:17920
    ds_read_b64_tr_b16 v[60:61], v115 offset:18944
    ds_read_b64_tr_b16 v[62:63], v115 offset:19968
    s_cbranch_scc1 main_kernel_cf_last
    v_bfe_u32 v47, v123, 1, 7
    buffer_load_dwordx2 v[126:127], v123, s[4:7], s19 offen offset:1024 sc1
    buffer_load_dwordx4 v116, s[4:7], s27 offen offset:1024 sc1 lds
    v_mfma_f32_16x16x32_bf16 v[36:39], v[20:23], v[52:55], v[36:39]
    v_mfma_f32_16x16x32_bf16 v[72:75], v[52:55], v[52:55], v[72:75]
    s_waitcnt lgkmcnt(2)
    v_mfma_f32_16x16x32_bf16 v[72:75], v[56:59], v[56:59], v[72:75]
    v_mfma_f32_16x16x32_bf16 v[32:35], v[8:11], v[56:59], v[32:35]
    s_waitcnt lgkmcnt(0)
    v_mfma_f32_16x16x32_bf16 v[72:75], v[60:63], v[60:63], v[72:75]
    ds_read_b128 v[0:3], v113 offset:16384
    v_mfma_f32_16x16x32_bf16 v[32:35], v[12:15], v[60:63], v[32:35]
    ds_read_b128 v[16:19], v113 offset:18432
    v_mfma_f32_16x16x32_bf16 v[36:39], v[24:27], v[56:59], v[36:39]
    ds_read_b128 v[4:7], v113 offset:17408
    s_nop 0
    v_permlane32_swap_b32 v72, v73
    v_permlane32_swap_b32 v74, v75
    v_mfma_f32_16x16x32_bf16 v[36:39], v[28:31], v[60:63], v[36:39]
    ds_read_b128 v[20:23], v113 offset:19456
    v_mul_f32 v73, s30, v73
    v_mul_f32 v75, s30, v75
    v_exp_f32 v32, v32
    ds_read_b128 v[8:11], v113 offset:24576
    v_exp_f32 v33, v33
    ds_read_b128 v[12:15], v113 offset:25600
    v_exp_f32 v73, v73
    ds_read_b128 v[24:27], v113 offset:26624
    v_exp_f32 v75, v75
    ds_read_b128 v[28:31], v113 offset:27648
    v_exp_f32 v34, v34
    v_cvt_pk_bf16_f32 v72, v73, v75
    v_cvt_pk_bf16_f32 v73, v73, v75
    v_exp_f32 v35, v35
    s_waitcnt vmcnt(4)
    v_mfma_f32_16x16x16_bf16 v[40:43], v[100:101], v[72:73], 0
    v_exp_f32 v36, v36
    v_cvt_pk_bf16_f32 v32, v32, v33
    v_exp_f32 v37, v37
    v_cvt_pk_bf16_f32 v33, v34, v35
    v_exp_f32 v38, v38
    v_exp_f32 v39, v39
    v_cvt_pk_bf16_f32 v34, v36, v37
    v_cvt_pk_bf16_f32 v35, v38, v39
    s_nop 1
    v_mfma_f32_16x16x32_bf16 v[40:43], v[96:99], v[32:35], v[40:43]
    v_mfma_f32_16x16x32_bf16 v[64:67], v[88:91], v[32:35], 0
    v_mfma_f32_16x16x32_bf16 v[68:71], v[92:95], v[32:35], 0
    s_waitcnt vmcnt(3)
main_kernel_cf_v_ok:
    v_bitop3_b32 v44, v86, s22, 1 bitop3:0x28
    v_swap_b32 v85, v86
    v_cmp_ne_u32 vcc, 0, v44
main_kernel_cf_d_ok:
    s_nop 0
    v_mfma_f32_16x16x16_bf16 v[64:67], v[84:85], v[72:73], v[64:67]
    v_mfma_f32_16x16x16_bf16 v[68:71], v[86:87], v[72:73], v[68:71]
    s_cbranch_vccnz main_kernel_cf_v_f
    v_rcp_f32 v42, v40
    v_subrev_u32 v41, 0x21800000, v41
    v_cmp_lt_u32 vcc, 0x3c000000, v41
    s_nop 0
    v_pk_mul_f32 v[64:65], v[64:65], v[42:43] op_sel_hi:[1,0]
    v_pk_mul_f32 v[66:67], v[66:67], v[42:43] op_sel_hi:[1,0]
    v_cvt_pk_bf16_f32 v44, v64, v65
    v_pk_mul_f32 v[68:69], v[68:69], v[42:43] op_sel_hi:[1,0]
    v_cvt_pk_bf16_f32 v45, v66, v67
    v_pk_mul_f32 v[70:71], v[70:71], v[42:43] op_sel_hi:[1,0]
    v_cvt_pk_bf16_f32 v46, v68, v69
    v_cvt_pk_bf16_f32 v47, v70, v71
    ds_write_b128 v118, v[44:47]
    s_and_b64 s[42:43], vcc, s[44:45]
    s_cbranch_scc1 main_kernel_cf_d_f
    s_mov_b64 s[44:45], s[0:1]
    v_mov_b32 v64, 0
    v_mov_b32 v65, 0
    v_mov_b32 v66, 0
    v_mov_b32 v67, 0
    v_mov_b32 v68, 0
    v_mov_b32 v69, 0
    v_mov_b32 v70, 0
    v_mov_b32 v71, 0
    v_bfe_u32 v90, v123, 1, 7
    s_xor_b32 s23, s23, 0x80000
    s_waitcnt lgkmcnt(0)
    s_barrier
    ds_read_b128 v[56:59], v114 offset:1024
    ds_read_b128 v[60:63], v114 offset:1536
    ds_read_b128 v[48:51], v114 offset:0
    ds_read_b128 v[52:55], v114 offset:512
    s_xor_b32 s18, s18, 0x100000
    s_xor_b32 s19, s18, 0x80000
    s_xor_b32 s25, s25, 0x4000
    s_add_u32 s27, s27, 0x40000
    v_add_u32 v121, 4, v121
    v_xor_b32 v112, 0x4000, v112
    s_xor_b32 s36, s36, 0x4000
    s_mov_b32 m0, 0
    s_mov_b32 s54, s24
    s_xor_b32 s24, s24, 0x4000
    s_add_u32 s55, s25, 4096
    v_mov_b32 v89, s17
    s_mov_b32 s15, 0
    s_add_u32 s56, s19, 1536
    s_xor_b32 s9, s11, s40
    s_add_u32 s16, s20, s38
    s_waitcnt lgkmcnt(3)
    v_smfmac_f32_16x16x64_bf16 v[76:79], v[56:59], v[0:7], v110
    s_waitcnt lgkmcnt(2)
    ds_read_b128 v[0:3], v113 offset:20480
    v_smfmac_f32_16x16x64_bf16 v[76:79], v[60:63], v[8:15], v110
    s_waitcnt lgkmcnt(2)
    ds_read_b128 v[4:7], v113 offset:21504
    v_smfmac_f32_16x16x64_bf16 v[76:79], v[48:51], v[192:199], v110
    s_waitcnt lgkmcnt(2)
    ds_read_b128 v[8:11], v113 offset:28672
    v_smfmac_f32_16x16x64_bf16 v[76:79], v[52:55], v[200:207], v110
    ds_read_b128 v[12:15], v113 offset:29696
    buffer_load_dword v111, v90, s[4:7], s47 offen sc1
    v_smfmac_f32_16x16x64_bf16 v[80:83], v[56:59], v[16:23], v110
    ds_read_b128 v[16:19], v113 offset:22528
    v_smfmac_f32_16x16x64_bf16 v[80:83], v[60:63], v[24:31], v110
    ds_read_b128 v[20:23], v113 offset:23552
    v_smfmac_f32_16x16x64_bf16 v[80:83], v[48:51], v[208:215], v110
    ds_read_b128 v[24:27], v113 offset:30720
    v_cvt_pk_f16_f32 v40, v76, v77
    v_smfmac_f32_16x16x64_bf16 v[80:83], v[52:55], v[216:223], v110
    ds_read_b128 v[28:31], v113 offset:31744
    v_cvt_pk_f16_f32 v41, v78, v79
    v_smfmac_f32_16x16x64_bf16 v[64:67], v[48:51], v[224:231], v110
    v_bfi_b32 v40, 1, s22, v40
    v_smfmac_f32_16x16x64_bf16 v[64:67], v[52:55], v[232:239], v110
    s_waitcnt lgkmcnt(6)
    buffer_load_dword v111, v90, s[4:7], s47 offen sc1
    v_smfmac_f32_16x16x64_bf16 v[64:67], v[56:59], v[0:7], v110
    s_waitcnt lgkmcnt(4)
    buffer_store_dwordx2 v[40:41], v119, s[4:7], s21 offen offset:0
    v_cvt_pk_f16_f32 v42, v80, v81
    v_smfmac_f32_16x16x64_bf16 v[64:67], v[60:63], v[8:15], v110
    v_cvt_pk_f16_f32 v43, v82, v83
    v_smfmac_f32_16x16x64_bf16 v[68:71], v[48:51], v[240:247], v110
    v_bfi_b32 v42, 1, s22, v42
    v_smfmac_f32_16x16x64_bf16 v[68:71], v[52:55], v[248:255], v110
    s_waitcnt lgkmcnt(2)
    v_smfmac_f32_16x16x64_bf16 v[68:71], v[56:59], v[16:23], v110
    s_waitcnt lgkmcnt(0)
    buffer_store_dwordx2 v[42:43], v119, s[4:7], s21 offen offset:512
    v_cvt_pk_f16_f32 v44, v64, v65
    v_smfmac_f32_16x16x64_bf16 v[68:71], v[60:63], v[24:31], v110
    v_cvt_pk_f16_f32 v45, v66, v67
    v_bfi_b32 v44, 1, s22, v44
    s_cmp_lg_u32 s14, 0
    buffer_store_dwordx2 v[44:45], v119, s[4:7], s21 offen offset:1024
    s_nop 3
    v_cvt_pk_f16_f32 v46, v68, v69
    v_cvt_pk_f16_f32 v47, v70, v71
    v_bfi_b32 v46, 1, s22, v46
    buffer_store_dwordx2 v[46:47], v119, s[4:7], s21 offen offset:1536
    s_cbranch_scc1 main_kernel_cf_wx
    s_waitcnt vmcnt(5)
    s_xor_b32 s21, s21, 0x80000
main_kernel_cf_rgo:
    v_subrev_u32 v32, s20, v111
    s_memtime s[52:53]
    v_cmp_lt_u32 vcc, 0x100000, v32
    v_max_u32_dpp v32, v32, v32 row_shr:1 row_mask:0xf bank_mask:0xf
    s_nop 0
    s_nop 0
    v_max_u32_dpp v32, v32, v32 row_shr:2 row_mask:0xf bank_mask:0xf
    s_nop 0
    s_cbranch_vccnz main_kernel_cf_fsp
main_kernel_cf_fok:
    s_nop 0
    v_max_u32_dpp v32, v32, v32 row_shr:4 row_mask:0xf bank_mask:0xf
    s_memtime s[52:53]
    s_nop 0
    v_max_u32_dpp v32, v32, v32 row_shr:8 row_mask:0xf bank_mask:0xf
    s_memtime s[52:53]
    s_nop 0
    v_max_u32_dpp v32, v32, v32 row_bcast:15 row_mask:0xa bank_mask:0xf
    s_memtime s[52:53]
    s_sub_u32 s33, s52, s16
    v_readlane_b32 s32, v32, 31
    s_add_u32 s33, s33, 0x400
    s_memtime s[52:53]
    s_add_u32 s34, s16, 1650
    s_memtime s[52:53]
    s_min_u32 s32, s32, s33
    s_max_u32 s32, s32, s15
    s_add_u32 s34, s34, s32
    s_mov_b32 s35, 200
main_kernel_cf_fw:
    s_memtime s[52:53]
    s_cmp_ge_u32 s52, s34
    s_cbranch_scc1 main_kernel_cf_fgo
    s_memtime s[52:53]
    s_cmp_ge_u32 s52, s34
    s_cbranch_scc1 main_kernel_cf_fgo
    s_memtime s[52:53]
    s_cmp_ge_u32 s52, s34
    s_cbranch_scc1 main_kernel_cf_fgo
    s_memtime s[52:53]
    s_cmp_ge_u32 s52, s34
    s_cbranch_scc1 main_kernel_cf_fgo
    s_memtime s[52:53]
    s_cmp_ge_u32 s52, s34
    s_cbranch_scc1 main_kernel_cf_fgo
    s_memtime s[52:53]
    s_cmp_ge_u32 s52, s34
    s_cbranch_scc1 main_kernel_cf_fgo
    s_memtime s[52:53]
    s_cmp_ge_u32 s52, s34
    s_cbranch_scc1 main_kernel_cf_fgo
    s_memtime s[52:53]
    s_cmp_ge_u32 s52, s34
    s_cbranch_scc1 main_kernel_cf_fgo
    s_sub_u32 s35, s35, 1
    s_cbranch_scc0 main_kernel_cf_fw
main_kernel_cf_fgo:
    buffer_load_dwordx4 v[0:3], v120, s[4:7], s23 offen sc1
    s_add_u32 s35, s23, 0x8000
    buffer_load_dwordx4 v[4:7], v120, s[4:7], s35 offen sc1
    s_add_u32 s35, s23, 0x10000
    buffer_load_dwordx4 v[8:11], v120, s[4:7], s35 offen sc1
    ds_read_b32 v33, v123 offset:20992
    s_add_u32 s35, s23, 0x18000
    buffer_load_dwordx4 v[12:15], v120, s[4:7], s35 offen sc1
    s_add_u32 s35, s23, 0x20000
    buffer_load_dwordx4 v[16:19], v120, s[4:7], s35 offen sc1
    s_add_u32 s35, s23, 0x28000
    buffer_load_dwordx4 v[20:23], v120, s[4:7], s35 offen sc1
    s_add_u32 s35, s23, 0x30000
    buffer_load_dwordx4 v[24:27], v120, s[4:7], s35 offen sc1
    s_add_u32 s35, s23, 0x38000
    buffer_load_dwordx4 v[28:31], v120, s[4:7], s35 offen sc1
    s_mov_b64 exec, 1
    s_waitcnt lgkmcnt(0)
    v_sub_u32 v33, s34, v33
    v_bfi_b32 v33, 1, s40, v33
    buffer_store_dword v33, off, s[4:7], s18 offset:1536 sc1
    v_readfirstlane_b32 s10, v33
    s_mov_b64 exec, -1
    s_waitcnt vmcnt(8)
    v_mfma_f32_16x16x32_f16 v[76:79], v[0:3], v[106:109], 0
    v_xor_b32 v36, s22, v0
    v_bitop3_b32 v36, v2, s22, v36 bitop3:0xbe
    s_waitcnt vmcnt(7)
    v_mfma_f32_16x16x32_f16 v[76:79], v[4:7], v[106:109], v[76:79]
    v_bitop3_b32 v36, v4, s22, v36 bitop3:0xbe
    v_bitop3_b32 v36, v6, s22, v36 bitop3:0xbe
    s_waitcnt vmcnt(6)
    v_mfma_f32_16x16x32_f16 v[76:79], v[8:11], v[106:109], v[76:79]
    v_bitop3_b32 v36, v8, s22, v36 bitop3:0xbe
    v_bitop3_b32 v36, v10, s22, v36 bitop3:0xbe
    s_waitcnt vmcnt(5)
    v_mfma_f32_16x16x32_f16 v[76:79], v[12:15], v[106:109], v[76:79]
    v_bitop3_b32 v36, v12, s22, v36 bitop3:0xbe
    v_bitop3_b32 v36, v14, s22, v36 bitop3:0xbe
    s_waitcnt vmcnt(4)
    v_mfma_f32_16x16x32_f16 v[76:79], v[16:19], v[106:109], v[76:79]
    v_bitop3_b32 v36, v16, s22, v36 bitop3:0xbe
    v_bitop3_b32 v36, v18, s22, v36 bitop3:0xbe
    s_waitcnt vmcnt(3)
    v_mfma_f32_16x16x32_f16 v[76:79], v[20:23], v[106:109], v[76:79]
    v_bitop3_b32 v36, v20, s22, v36 bitop3:0xbe
    v_bitop3_b32 v36, v22, s22, v36 bitop3:0xbe
    s_waitcnt vmcnt(2)
    v_mfma_f32_16x16x32_f16 v[76:79], v[24:27], v[106:109], v[76:79]
    v_bitop3_b32 v36, v24, s22, v36 bitop3:0xbe
    v_bitop3_b32 v36, v26, s22, v36 bitop3:0xbe
    s_waitcnt vmcnt(1)
    v_mfma_f32_16x16x32_f16 v[76:79], v[28:31], v[106:109], v[76:79]
    v_bitop3_b32 v36, v28, s22, v36 bitop3:0xbe
    v_bitop3_b32 v36, v30, s22, v36 bitop3:0xbe
    v_and_b32 v36, 1, v36
    v_cmp_ne_u32 vcc, 0, v36
    s_nop 3
    v_cvt_pk_bf16_f32 v126, v76, v77
    v_cvt_pk_bf16_f32 v127, v78, v79
    s_cbranch_vccnz main_kernel_cf_r_f
    buffer_store_dwordx2 v[126:127], v122, s[4:7], s24 offen
    s_sub_u32 s20, s34, s38
    s_mov_b32 s3, s34
    buffer_store_dword v89, v117, s[4:7], s46 offen offset:512
    v_mov_b32 v32, -1
    v_mov_b32 v33, -1
    v_mov_b32 v64, 0
    v_mov_b32 v65, 0
    v_mov_b32 v66, 0
    v_mov_b32 v67, 0
    v_mov_b32 v68, 0
    v_mov_b32 v69, 0
    v_mov_b32 v70, 0
    v_mov_b32 v71, 0
    v_mov_b32 v96, 0
    v_mov_b32 v97, 0
    v_mov_b32 v98, 0
    v_mov_b32 v99, 0
    buffer_store_dwordx2 v[32:33], v122, s[4:7], s54 offen
    s_cmp_eq_u32 s12, 0
    v_add_u32 v56, s59, v115
    s_cbranch_scc0 main_kernel_cf_vma
    ds_read_b64_tr_b16 v[80:81], v56 offset:16384
    ds_read_b64_tr_b16 v[82:83], v56 offset:17408
    s_waitcnt lgkmcnt(0)
    s_nop 15
    s_nop 15
    s_nop 5
    s_buffer_load_dword s9, s[4:7], s56 glc
    buffer_load_dword v111, v90, s[4:7], s47 offen offset:512 sc1
    buffer_load_dwordx4 v116, s[4:7], s25 offen offset:0 sc1 lds
    buffer_load_dwordx4 v116, s[4:7], s25 offen offset:1024 sc1 lds
    buffer_load_dwordx4 v116, s[4:7], s25 offen offset:2048 sc1 lds
    buffer_load_dwordx4 v116, s[4:7], s25 offen offset:3072 sc1 lds
    s_mov_b32 m0, 4096
    s_nop 0
    buffer_load_dwordx4 v116, s[4:7], s55 offen offset:0 sc1 lds
    buffer_load_dwordx4 v116, s[4:7], s55 offen offset:1024 sc1 lds
    buffer_load_dwordx4 v116, s[4:7], s55 offen offset:2048 sc1 lds
    buffer_load_dwordx4 v116, s[4:7], s55 offen offset:3072 sc1 lds
    v_mov_b32 v34, v90
    s_mov_b32 m0, s36
    s_barrier
    ds_read_b32 v35, v123 offset:20480
    buffer_load_dwordx4 v[88:91], v116, s[4:7], s28 offen offset:0 sc1
    buffer_load_dwordx4 v[92:95], v116, s[4:7], s28 offen offset:1024 sc1
    buffer_load_dwordx4 v116, s[4:7], s27 offen offset:0 sc1 lds
    buffer_store_dwordx4 v[80:83], v125, s[4:7], s26 offen sc1
    s_branch main_kernel_cf_kva
main_kernel_cf_vma:
    v_mfma_f32_16x16x32_bf16 v[56:59], v[102:105], v[84:87], 0
    s_nop 7
    v_cvt_pk_bf16_f32 v80, v56, v57
    v_cvt_pk_bf16_f32 v81, v58, v59
    s_nop 15
    s_nop 15
    s_nop 5
    s_buffer_load_dword s9, s[4:7], s56 glc
    buffer_load_dword v111, v90, s[4:7], s47 offen offset:512 sc1
    buffer_load_dwordx4 v116, s[4:7], s25 offen offset:0 sc1 lds
    buffer_load_dwordx4 v116, s[4:7], s25 offen offset:1024 sc1 lds
    buffer_load_dwordx4 v116, s[4:7], s25 offen offset:2048 sc1 lds
    buffer_load_dwordx4 v116, s[4:7], s25 offen offset:3072 sc1 lds
    s_mov_b32 m0, 4096
    s_nop 0
    buffer_load_dwordx4 v116, s[4:7], s55 offen offset:0 sc1 lds
    buffer_load_dwordx4 v116, s[4:7], s55 offen offset:1024 sc1 lds
    buffer_load_dwordx4 v116, s[4:7], s55 offen offset:2048 sc1 lds
    buffer_load_dwordx4 v116, s[4:7], s55 offen offset:3072 sc1 lds
    v_mov_b32 v34, v90
    s_mov_b32 m0, s36
    s_barrier
    ds_read_b32 v35, v123 offset:20480
    buffer_load_dwordx4 v[88:91], v116, s[4:7], s28 offen offset:0 sc1
    buffer_load_dwordx4 v[92:95], v116, s[4:7], s28 offen offset:1024 sc1
    buffer_load_dwordx4 v116, s[4:7], s27 offen offset:0 sc1 lds
    buffer_store_dwordx2 v[80:81], v123, s[4:7], s26 offen sc1
main_kernel_cf_kva:
    s_add_u32 s26, s26, 0x10000
    s_waitcnt vmcnt(12)
    v_cmp_gt_i32 vcc, s17, v111
    v_readfirstlane_b32 s38, v35
    s_cbranch_vccnz main_kernel_cf_mc_f
    s_waitcnt vmcnt(4)
    s_branch main_kernel_cf_top
main_kernel_cf_wx:
    s_cmp_lg_u32 s14, 1
    s_cbranch_scc1 main_kernel_cf_wy
    s_memrealtime s[32:33]
    s_nop 0
    s_nop 0
    s_memrealtime s[32:33]
    s_nop 0
    s_nop 0
    s_memrealtime s[32:33]
    s_nop 0
    s_nop 0
    s_memrealtime s[32:33]
    s_nop 0
    s_nop 0
    s_memrealtime s[32:33]
    s_nop 0
    s_nop 0
    s_memrealtime s[32:33]
    s_nop 0
    s_nop 0
    s_memrealtime s[32:33]
    s_nop 0
    s_nop 0
    s_memrealtime s[32:33]
    s_nop 0
    s_nop 0
    s_memrealtime s[32:33]
    s_nop 0
    s_nop 0
    s_memrealtime s[32:33]
    s_nop 0
    s_nop 0
    s_memrealtime s[32:33]
    s_nop 0
    s_nop 0
    s_memrealtime s[32:33]
    s_nop 0
    s_nop 0
    s_mov_b32 s34, s32
    s_memrealtime s[32:33]
    s_cmp_lg_u32 s32, s34
    s_cbranch_scc1 main_kernel_cf_e1
    s_memrealtime s[32:33]
    s_cmp_lg_u32 s32, s34
    s_cbranch_scc1 main_kernel_cf_e1
    s_memrealtime s[32:33]
    s_cmp_lg_u32 s32, s34
    s_cbranch_scc1 main_kernel_cf_e1
    s_memrealtime s[32:33]
    s_cmp_lg_u32 s32, s34
    s_cbranch_scc1 main_kernel_cf_e1
    s_memrealtime s[32:33]
    s_cmp_lg_u32 s32, s34
    s_cbranch_scc1 main_kernel_cf_e1
    s_memrealtime s[32:33]
    s_cmp_lg_u32 s32, s34
    s_cbranch_scc1 main_kernel_cf_e1
    s_memrealtime s[32:33]
    s_cmp_lg_u32 s32, s34
    s_cbranch_scc1 main_kernel_cf_e1
    s_memrealtime s[32:33]
    s_cmp_lg_u32 s32, s34
    s_cbranch_scc1 main_kernel_cf_e1
    s_memrealtime s[32:33]
    s_cmp_lg_u32 s32, s34
    s_cbranch_scc1 main_kernel_cf_e1
    s_memrealtime s[32:33]
    s_cmp_lg_u32 s32, s34
    s_cbranch_scc1 main_kernel_cf_e1
    s_memrealtime s[32:33]
    s_cmp_lg_u32 s32, s34
    s_cbranch_scc1 main_kernel_cf_e1
    s_memrealtime s[32:33]
    s_cmp_lg_u32 s32, s34
    s_cbranch_scc1 main_kernel_cf_e1
main_kernel_cf_e1:
    s_memtime s[52:53]
    s_mul_i32 s34, s32, 22
    s_waitcnt lgkmcnt(0)
    s_sub_u32 s32, s52, s34
    s_sub_u32 s33, s32, s38
    s_ashr_i32 s34, s33, 1
    s_add_u32 s34, s34, s32
    v_mov_b32 v34, s34
    v_mov_b32 v33, s32
    ds_write2st64_b32 v123, v33, v34 offset0:80 offset1:82
    v_add_u32 v37, s33, v34
main_kernel_cf_wy:
    s_xor_b32 s21, s21, 0x80000
    v_mov_b32 v64, 0
    v_mov_b32 v65, 0
    v_mov_b32 v66, 0
    v_mov_b32 v67, 0
    v_mov_b32 v68, 0
    v_mov_b32 v69, 0
    v_mov_b32 v70, 0
    v_mov_b32 v71, 0
    v_mov_b32 v96, 0
    v_mov_b32 v97, 0
    v_mov_b32 v98, 0
    v_mov_b32 v99, 0
    s_cmp_eq_u32 s12, 0
    v_add_u32 v56, s59, v115
    s_cbranch_scc0 main_kernel_cf_vmb
    ds_read_b64_tr_b16 v[80:81], v56 offset:16384
    ds_read_b64_tr_b16 v[82:83], v56 offset:17408
    s_waitcnt lgkmcnt(0)
    s_waitcnt vmcnt(0)
    s_mov_b32 m0, s36
    s_barrier
    ds_read_b32 v35, v123 offset:20480
    ds_write_b32 v124, v37 offset:3584
    buffer_load_dwordx4 v[88:91], v116, s[4:7], s28 offen offset:0 sc1
    buffer_load_dwordx4 v[92:95], v116, s[4:7], s28 offen offset:1024 sc1
    buffer_load_dwordx4 v116, s[4:7], s27 offen offset:0 sc1 lds
    buffer_store_dwordx4 v[80:83], v125, s[4:7], s26 offen sc1
    s_branch main_kernel_cf_kvb
main_kernel_cf_vmb:
    v_mfma_f32_16x16x32_bf16 v[56:59], v[102:105], v[84:87], 0
    s_nop 7
    v_cvt_pk_bf16_f32 v80, v56, v57
    v_cvt_pk_bf16_f32 v81, v58, v59
    s_waitcnt vmcnt(0)
    s_mov_b32 m0, s36
    s_barrier
    ds_read_b32 v35, v123 offset:20480
    ds_write_b32 v124, v37 offset:3584
    buffer_load_dwordx4 v[88:91], v116, s[4:7], s28 offen offset:0 sc1
    buffer_load_dwordx4 v[92:95], v116, s[4:7], s28 offen offset:1024 sc1
    buffer_load_dwordx4 v116, s[4:7], s27 offen offset:0 sc1 lds
    buffer_store_dwordx2 v[80:81], v123, s[4:7], s26 offen sc1
main_kernel_cf_kvb:
    s_add_u32 s26, s26, 0x10000
    s_mov_b64 exec, 1
    buffer_store_dword v100, off, s[4:7], s39 sc1
    s_mov_b64 exec, -1
    s_add_u32 s39, s39, 4
    s_waitcnt lgkmcnt(0)
    v_readfirstlane_b32 s38, v35
    v_mov_b32 v35, 0
    v_mov_b32 v35, 0
    v_mov_b32 v35, 0
    v_mov_b32 v35, 0
    v_mov_b32 v35, 0
    v_mov_b32 v35, 0
main_kernel_cf_end:
    s_branch main_kernel_cf_top
main_kernel_cf_mc_f:
    s_mov_b32 m0, 0
    s_sub_u32 s29, s29, 1
    s_cbranch_scc1 main_kernel_end
    buffer_load_dword v111, v34, s[4:7], s47 offen offset:512 sc1
    buffer_load_dwordx4 v116, s[4:7], s25 offen offset:0 sc1 lds
    buffer_load_dwordx4 v116, s[4:7], s25 offen offset:1024 sc1 lds
    buffer_load_dwordx4 v116, s[4:7], s25 offen offset:2048 sc1 lds
    buffer_load_dwordx4 v116, s[4:7], s25 offen offset:3072 sc1 lds
    s_mov_b32 m0, 4096
    s_nop 0
    buffer_load_dwordx4 v116, s[4:7], s55 offen offset:0 sc1 lds
    buffer_load_dwordx4 v116, s[4:7], s55 offen offset:1024 sc1 lds
    buffer_load_dwordx4 v116, s[4:7], s55 offen offset:2048 sc1 lds
    buffer_load_dwordx4 v116, s[4:7], s55 offen offset:3072 sc1 lds
    s_waitcnt vmcnt(8)
    v_cmp_gt_i32 vcc, s17, v111
    v_readfirstlane_b32 s38, v35
    s_cbranch_vccnz main_kernel_cf_mc_f
    s_waitcnt vmcnt(0)
    s_branch main_kernel_cf_end
main_kernel_cf_t_w:
    s_mov_b32 s35, 200
main_kernel_cf_t_s:
    s_memtime s[52:53]
    s_cmp_ge_u32 s52, s34
    s_cbranch_scc1 main_kernel_cf_t_go
    s_memtime s[52:53]
    s_cmp_ge_u32 s52, s34
    s_cbranch_scc1 main_kernel_cf_t_go
    s_memtime s[52:53]
    s_cmp_ge_u32 s52, s34
    s_cbranch_scc1 main_kernel_cf_t_go
    s_memtime s[52:53]
    s_cmp_ge_u32 s52, s34
    s_cbranch_scc1 main_kernel_cf_t_go
    s_memtime s[52:53]
    s_cmp_ge_u32 s52, s34
    s_cbranch_scc1 main_kernel_cf_t_go
    s_memtime s[52:53]
    s_cmp_ge_u32 s52, s34
    s_cbranch_scc1 main_kernel_cf_t_go
    s_memtime s[52:53]
    s_cmp_ge_u32 s52, s34
    s_cbranch_scc1 main_kernel_cf_t_go
    s_memtime s[52:53]
    s_cmp_ge_u32 s52, s34
    s_cbranch_scc1 main_kernel_cf_t_go
    s_sub_u32 s35, s35, 1
    s_cbranch_scc0 main_kernel_cf_t_s
    s_branch main_kernel_cf_t_go
main_kernel_cf_t_p:
    s_waitcnt lgkmcnt(0)
    s_xor_b32 s32, s9, s22
    s_bitcmp1_b32 s32, 0
    s_cbranch_scc0 main_kernel_cf_t_ok
    s_buffer_load_dword s9, s[4:7], s56 glc
    s_sub_u32 s29, s29, 1
    s_cbranch_scc1 main_kernel_end
    s_branch main_kernel_cf_t_p
main_kernel_cf_z0_f:
    buffer_load_dwordx2 v[126:127], v123, s[4:7], s19 offen offset:0 sc1
    s_sub_u32 s29, s29, 1
    s_cbranch_scc1 main_kernel_end
    s_waitcnt vmcnt(0)
    s_branch main_kernel_cf_z0
main_kernel_cf_z2_f:
    buffer_load_dwordx2 v[64:65], v123, s[4:7], s19 offen offset:512 sc1
    s_sub_u32 s29, s29, 1
    s_cbranch_scc1 main_kernel_end
    s_waitcnt vmcnt(0)
main_kernel_cf_z1_f:
    s_waitcnt vmcnt(0)
    s_memtime s[52:53]
    v_dot2_f32_bf16 v44, v64, s37, v68
    v_dot2_f32_bf16 v45, v64, s57, v69
    v_dot2_f32_bf16 v46, v65, s37, v70
    v_dot2_f32_bf16 v47, v65, s57, v71
    v_bitop3_b32 v60, v64, s22, 1 bitop3:0x28
    v_cvt_pk_bf16_f32 v44, v44, v45
    v_cmp_ne_u32 vcc, 0, v60
    v_cvt_pk_bf16_f32 v45, v46, v47
    ds_write_b64 v124, v[44:45] offset:512
    s_cbranch_vccnz main_kernel_cf_z2_f
    s_branch main_kernel_cf_z_ok
main_kernel_cf_kvw:
    s_cmp_eq_u32 s17, 64
    s_cbranch_scc1 main_kernel_cf_kvok
    s_waitcnt vmcnt(0)
    s_mov_b32 exec_lo, 0
    s_mov_b32 exec_hi, 0x3f00
    v_subrev_u32 v127, 0, v121
main_kernel_cf_kvp:
    buffer_load_dword v126, v127, s[4:7], 0 offen sc1
    s_waitcnt vmcnt(0)
    v_cmp_eq_u32 vcc, 0, v126
    s_cbranch_vccz main_kernel_cf_kvp_ok
    s_sleep 2
    s_sub_u32 s29, s29, 1
    s_cbranch_scc0 main_kernel_cf_kvp
    s_branch main_kernel_end
main_kernel_cf_kvp_ok:
    s_mov_b64 exec, -1
    s_branch main_kernel_cf_kvok
main_kernel_cf_last:
    buffer_load_dwordx2 v[86:87], v123, s[4:7], s19 offen offset:1024 sc1
    s_sub_u32 s29, s29, 1
    s_cbranch_scc1 main_kernel_end
    s_waitcnt vmcnt(0) lgkmcnt(0)
    v_bitop3_b32 v44, v86, s22, 1 bitop3:0x28
    v_cmp_ne_u32 vcc, 0, v44
    s_cbranch_vccnz main_kernel_cf_last
    v_swap_b32 v85, v86
    s_cmp_eq_u32 s12, 0
    v_add_u32 v56, s59, v115
    s_cbranch_scc0 main_kernel_cf_vmc
    ds_read_b64_tr_b16 v[80:81], v56 offset:16384
    ds_read_b64_tr_b16 v[82:83], v56 offset:17408
    s_waitcnt lgkmcnt(0)
    buffer_store_dwordx4 v[80:83], v125, s[4:7], s26 offen sc1
    s_branch main_kernel_cf_kvc
main_kernel_cf_vmc:
    v_mfma_f32_16x16x32_bf16 v[56:59], v[102:105], v[84:87], 0
    s_nop 7
    v_cvt_pk_bf16_f32 v80, v56, v57
    v_cvt_pk_bf16_f32 v81, v58, v59
    buffer_store_dwordx2 v[80:81], v123, s[4:7], s26 offen sc1
main_kernel_cf_kvc:
    s_add_u32 s26, s26, 0x10000
    s_branch main_kernel_end
main_kernel_cf_m_f:
main_kernel_cf_m_t:
    ds_read_b128 v[0:3], v116 offset:0
    ds_read_b128 v[4:7], v116 offset:1024
    ds_read_b128 v[8:11], v116 offset:2048
    ds_read_b128 v[12:15], v116 offset:3072
    ds_read_b128 v[16:19], v116 offset:4096
    ds_read_b128 v[20:23], v116 offset:5120
    ds_read_b128 v[24:27], v116 offset:6144
    ds_read_b128 v[28:31], v116 offset:7168
    s_waitcnt lgkmcnt(0)
    v_max_u32 v126, v0, v2
    v_max3_u32 v126, v126, v4, v6
    v_max3_u32 v126, v126, v8, v10
    v_max3_u32 v126, v126, v12, v14
    v_max3_u32 v126, v126, v16, v18
    v_max3_u32 v126, v126, v20, v22
    v_max3_u32 v126, v126, v24, v26
    v_max3_u32 v126, v126, v28, v30
    v_cmp_eq_u32 vcc, -1, v126
    s_cbranch_vccz main_kernel_cf_m_g
    s_barrier
    s_lshl_b32 s32, s14, 11
    s_add_u32 m0, s32, 0
    s_add_u32 s32, s32, s25
    buffer_load_dwordx4 v116, s[4:7], s32 offen offset:0 sc1 lds
    buffer_load_dwordx4 v116, s[4:7], s32 offen offset:1024 sc1 lds
    s_sub_u32 s29, s29, 1
    s_cbranch_scc1 main_kernel_end
    s_waitcnt vmcnt(0)
    s_barrier
    s_branch main_kernel_cf_m_t
main_kernel_cf_m_g:
    s_mov_b64 s[44:45], 0
    v_mov_b32 v64, 0
    v_mov_b32 v65, 0
    v_mov_b32 v66, 0
    v_mov_b32 v67, 0
    v_mov_b32 v68, 0
    v_mov_b32 v69, 0
    v_mov_b32 v70, 0
    v_mov_b32 v71, 0
    v_mov_b32 v96, 0
    v_mov_b32 v97, 0
    v_mov_b32 v98, 0
    v_mov_b32 v99, 0
    s_branch main_kernel_cf_mrd
main_kernel_cf_v_f:
    v_swap_b32 v85, v86
    s_nop 7
    s_waitcnt vmcnt(1)
main_kernel_cf_v_t:
    s_memtime s[52:53]
    v_bitop3_b32 v44, v126, s22, 1 bitop3:0x28
    v_cmp_ne_u32 vcc, 0, v44
    s_sub_u32 s29, s29, 1
    s_cbranch_scc1 main_kernel_end
    s_cbranch_vccnz main_kernel_cf_v_g
    v_mfma_f32_16x16x32_bf16 v[64:67], v[88:91], v[32:35], 0
    v_mfma_f32_16x16x32_bf16 v[68:71], v[92:95], v[32:35], 0
    v_mov_b32 v86, v126
    v_mov_b32 v87, v127
    s_waitcnt lgkmcnt(0)
    s_sub_u32 s32, s52, s38
    s_add_u32 s32, s32, -550
    v_mov_b32 v46, s32
    buffer_store_dword v46, v117, s[4:7], s46 offen
    s_branch main_kernel_cf_v_ok
main_kernel_cf_v_g:
    buffer_load_dwordx2 v[126:127], v123, s[4:7], s19 offen offset:1024 sc1
    s_waitcnt lgkmcnt(0)
    s_sub_u32 s32, s52, s38
    s_add_u32 s32, s32, -50
    v_mov_b32 v46, s32
    buffer_store_dword v46, v117, s[4:7], s46 offen
    s_waitcnt vmcnt(0)
    s_branch main_kernel_cf_v_t
main_kernel_cf_d_f:
    s_memtime s[52:53]
    s_waitcnt vmcnt(1) lgkmcnt(0)
    s_sub_u32 s32, s52, s38
    s_add_u32 s32, s32, 300
    v_mov_b32 v46, s32
    buffer_store_dword v46, v117, s[4:7], s46 offen
    ds_read_b128 v[0:3], v112 offset:0
    ds_read_b128 v[4:7], v112 offset:1024
    ds_read_b128 v[8:11], v112 offset:2048
    ds_read_b128 v[12:15], v112 offset:3072
    ds_read_b128 v[16:19], v112 offset:4096
    ds_read_b128 v[20:23], v112 offset:5120
    ds_read_b128 v[24:27], v112 offset:6144
    ds_read_b128 v[28:31], v112 offset:7168
    s_waitcnt lgkmcnt(0)
    v_mfma_f32_16x16x32_bf16 v[32:35], v[0:3], v[48:51], 0
    v_mfma_f32_16x16x32_bf16 v[36:39], v[16:19], v[48:51], 0
    v_mfma_f32_16x16x32_bf16 v[72:75], v[48:51], v[48:51], 0
    v_mfma_f32_16x16x32_bf16 v[32:35], v[4:7], v[52:55], v[32:35]
    v_mfma_f32_16x16x32_bf16 v[36:39], v[20:23], v[52:55], v[36:39]
    v_mfma_f32_16x16x32_bf16 v[72:75], v[52:55], v[52:55], v[72:75]
    v_mfma_f32_16x16x32_bf16 v[32:35], v[8:11], v[56:59], v[32:35]
    v_mfma_f32_16x16x32_bf16 v[36:39], v[24:27], v[56:59], v[36:39]
    v_mfma_f32_16x16x32_bf16 v[72:75], v[56:59], v[56:59], v[72:75]
    v_mfma_f32_16x16x32_bf16 v[32:35], v[12:15], v[60:63], v[32:35]
    v_mfma_f32_16x16x32_bf16 v[36:39], v[28:31], v[60:63], v[36:39]
    v_mfma_f32_16x16x32_bf16 v[72:75], v[60:63], v[60:63], v[72:75]
    s_nop 7
    ds_read_b128 v[0:3], v113 offset:16384
    ds_read_b128 v[16:19], v113 offset:18432
    ds_read_b128 v[4:7], v113 offset:17408
    ds_read_b128 v[20:23], v113 offset:19456
    ds_read_b128 v[8:11], v113 offset:24576
    ds_read_b128 v[24:27], v113 offset:26624
    ds_read_b128 v[12:15], v113 offset:25600
    ds_read_b128 v[28:31], v113 offset:27648
    v_permlane32_swap_b32 v72, v73
    v_permlane32_swap_b32 v74, v75
    v_mul_f32 v73, s30, v73
    v_mul_f32 v75, s30, v75
    v_max_f32 v126, v73, v75
    v_max3_f32 v126, v126, v32, v33
    v_max3_f32 v126, v126, v34, v35
    v_max3_f32 v126, v126, v36, v37
    v_max3_f32 v126, v126, v38, v39
    v_mov_b32 v127, v126
    s_nop 1
    v_permlane32_swap_b32 v126, v127
    v_max_f32 v126, v126, v127
    v_mov_b32 v127, v126
    s_nop 1
    v_permlane16_swap_b32 v126, v127
    v_max_f32 v126, v126, v127
    v_sub_f32 v32, v32, v126
    v_sub_f32 v33, v33, v126
    v_sub_f32 v34, v34, v126
    v_sub_f32 v35, v35, v126
    v_sub_f32 v36, v36, v126
    v_sub_f32 v37, v37, v126
    v_sub_f32 v38, v38, v126
    v_sub_f32 v39, v39, v126
    v_sub_f32 v73, v73, v126
    v_sub_f32 v75, v75, v126
    v_exp_f32 v32, v32
    v_exp_f32 v33, v33
    v_exp_f32 v34, v34
    v_exp_f32 v35, v35
    v_exp_f32 v36, v36
    v_exp_f32 v37, v37
    v_exp_f32 v38, v38
    v_exp_f32 v39, v39
    v_exp_f32 v73, v73
    v_exp_f32 v75, v75
    v_cvt_pk_bf16_f32 v32, v32, v33
    v_cvt_pk_bf16_f32 v33, v34, v35
    v_cvt_pk_bf16_f32 v34, v36, v37
    v_cvt_pk_bf16_f32 v35, v38, v39
    v_cvt_pk_bf16_f32 v72, v73, v75
    v_cvt_pk_bf16_f32 v73, v73, v75
    s_nop 1
    v_mfma_f32_16x16x32_bf16 v[64:67], v[88:91], v[32:35], 0
    v_mfma_f32_16x16x32_bf16 v[68:71], v[92:95], v[32:35], 0
    v_mfma_f32_16x16x32_bf16 v[40:43], v[96:99], v[32:35], 0
    v_mfma_f32_16x16x16_bf16 v[40:43], v[100:101], v[72:73], v[40:43]
    s_mov_b64 s[44:45], 0
    s_mov_b64 vcc, 0
    s_nop 7
    s_branch main_kernel_cf_d_ok
main_kernel_cf_fsp:
    s_mov_b32 s35, 40
main_kernel_cf_fsl:
    buffer_load_dword v111, v90, s[4:7], s47 offen sc1
    s_waitcnt vmcnt(1)
    v_subrev_u32 v32, s20, v111
    v_cmp_lt_u32 vcc, 0x100000, v32
    s_cbranch_vccz main_kernel_cf_rgo
    s_sub_u32 s35, s35, 1
    s_cbranch_scc0 main_kernel_cf_fsl
    v_mov_b32 v32, 0
    s_branch main_kernel_cf_fok
main_kernel_cf_r_f:
    s_memtime s[52:53]
    buffer_load_dword v111, v90, s[4:7], s47 offen sc1
    s_waitcnt lgkmcnt(0)
    s_sub_u32 s15, s52, s16
    s_add_u32 s15, s15, -1500
    s_waitcnt vmcnt(0)
    s_sub_u32 s29, s29, 1
    s_cbranch_scc1 main_kernel_end
    s_branch main_kernel_cf_rgo
    .p2align 6
main_kernel_cs_top:
    s_barrier
main_kernel_cs_mrd:
    ds_read_b128 v[0:3], v114 offset:0
    ds_read_b128 v[4:7], v114 offset:512
    ds_read_b128 v[8:11], v114 offset:1024
    ds_read_b128 v[12:15], v114 offset:1536
    ds_read_b128 v[16:19], v114 offset:2048
    s_waitcnt lgkmcnt(4)
    v_smfmac_f32_16x16x64_bf16 v[96:99], v[0:3], a[0:7], v110
    ds_read_b128 v[20:23], v114 offset:2560
    s_waitcnt lgkmcnt(4)
    v_smfmac_f32_16x16x64_bf16 v[96:99], v[4:7], a[8:15], v110
    ds_read_b128 v[24:27], v114 offset:3072
    s_waitcnt lgkmcnt(4)
    s_bfe_u32 s22, s17, 0x10001
    v_smfmac_f32_16x16x64_bf16 v[96:99], v[8:11], a[16:23], v110
    ds_read_b128 v[28:31], v114 offset:3584
    s_waitcnt lgkmcnt(4)
    v_smfmac_f32_16x16x64_bf16 v[96:99], v[12:15], a[24:31], v110
    ds_read_b128 v[32:35], v114 offset:4096
    s_waitcnt lgkmcnt(4)
    v_smfmac_f32_16x16x64_bf16 v[96:99], v[16:19], a[32:39], v110
    ds_read_b128 v[36:39], v114 offset:4608
    s_waitcnt lgkmcnt(4)
    v_smfmac_f32_16x16x64_bf16 v[96:99], v[20:23], a[40:47], v110
    ds_read_b128 v[40:43], v114 offset:5120
    s_waitcnt lgkmcnt(4)
    v_smfmac_f32_16x16x64_bf16 v[96:99], v[24:27], a[48:55], v110
    ds_read_b128 v[44:47], v114 offset:5632
    s_waitcnt lgkmcnt(4)
    v_smfmac_f32_16x16x64_bf16 v[96:99], v[28:31], a[56:63], v110
    ds_read_b128 v[48:51], v114 offset:6144
    s_waitcnt lgkmcnt(4)
    v_smfmac_f32_16x16x64_bf16 v[96:99], v[32:35], a[64:71], v110
    ds_read_b128 v[52:55], v114 offset:6656
    s_waitcnt lgkmcnt(4)
    v_smfmac_f32_16x16x64_bf16 v[96:99], v[36:39], a[72:79], v110
    ds_read_b128 v[56:59], v114 offset:7168
    s_waitcnt lgkmcnt(4)
    v_smfmac_f32_16x16x64_bf16 v[96:99], v[40:43], a[80:87], v110
    ds_read_b128 v[60:63], v114 offset:7680
    s_waitcnt lgkmcnt(4)
    v_smfmac_f32_16x16x64_bf16 v[96:99], v[44:47], a[88:95], v110
    s_waitcnt lgkmcnt(3)
    buffer_load_dword v111, v121, s[4:7], 0 offen sc1
    v_smfmac_f32_16x16x64_bf16 v[96:99], v[48:51], a[96:103], v110
    s_waitcnt lgkmcnt(2)
    ds_read_b128 v[80:83], v113 offset:0
    v_smfmac_f32_16x16x64_bf16 v[96:99], v[52:55], a[104:111], v110
    s_waitcnt lgkmcnt(2)
    ds_read_b128 v[84:87], v113 offset:1024
    v_smfmac_f32_16x16x64_bf16 v[96:99], v[56:59], a[112:119], v110
    s_waitcnt lgkmcnt(2)
    v_smfmac_f32_16x16x64_bf16 v[96:99], v[60:63], a[120:127], v110
    v_smfmac_f32_16x16x64_bf16 v[68:71], v[0:3], a[128:135], v110
    ds_read_b128 v[72:75], v113 offset:2048
    v_smfmac_f32_16x16x64_bf16 v[68:71], v[4:7], a[136:143], v110
    s_nop 1
    v_pk_add_f32 v[126:127], v[96:97], v[98:99]
    ds_read_b128 v[76:79], v113 offset:3072
    v_smfmac_f32_16x16x64_bf16 v[68:71], v[8:11], a[144:151], v110
    v_cmp_u_f32 vcc, v126, v127
    v_smfmac_f32_16x16x64_bf16 v[68:71], v[12:15], a[152:159], v110
    v_cvt_pk_bf16_f32 v126, v96, v97
    v_smfmac_f32_16x16x64_bf16 v[68:71], v[16:19], a[160:167], v110
    v_cvt_pk_bf16_f32 v127, v98, v99
    s_and_b64 s[42:43], vcc, s[44:45]
    s_cbranch_scc1 main_kernel_cs_m_f
    v_smfmac_f32_16x16x64_bf16 v[68:71], v[20:23], a[168:175], v110
    v_bfi_b32 v126, 1, s22, v126
    buffer_store_dwordx2 v[126:127], v123, s[4:7], s18 offen sc1
    v_smfmac_f32_16x16x64_bf16 v[68:71], v[24:27], a[176:183], v110
    s_mov_b64 s[44:45], s[0:1]
    v_smfmac_f32_16x16x64_bf16 v[68:71], v[28:31], a[184:191], v110
    s_add_u32 s17, s17, 1
    s_bfe_u32 s40, s17, 0x10001
    v_smfmac_f32_16x16x64_bf16 v[68:71], v[32:35], a[192:199], v110
    s_add_u32 s28, s28, 0x40000
    s_mov_b32 m0, s36
    v_smfmac_f32_16x16x64_bf16 v[68:71], v[36:39], a[200:207], v110
    s_add_u32 s34, s3, 2130
    v_smfmac_f32_16x16x64_bf16 v[68:71], v[40:43], a[208:215], v110
    v_smfmac_f32_16x16x64_bf16 v[68:71], v[44:47], a[216:223], v110
    v_smfmac_f32_16x16x64_bf16 v[68:71], v[48:51], a[224:231], v110
    v_smfmac_f32_16x16x64_bf16 v[68:71], v[52:55], a[232:239], v110
    v_smfmac_f32_16x16x64_bf16 v[68:71], v[56:59], a[240:247], v110
    v_smfmac_f32_16x16x64_bf16 v[68:71], v[60:63], a[248:255], v110
    s_waitcnt lgkmcnt(2)
    v_smfmac_f32_16x16x64_bf16 v[64:67], v[32:35], v[80:87], v110
    s_waitcnt lgkmcnt(0)
    s_nop 3
    v_cvt_pk_bf16_f32 v126, v68, v69
    v_cvt_pk_bf16_f32 v127, v70, v71
    v_bfi_b32 v126, 1, s22, v126
    buffer_store_dwordx2 v[126:127], v123, s[4:7], s18 offen offset:512 sc1
    ds_read_b128 v[80:83], v113 offset:4096
    v_smfmac_f32_16x16x64_bf16 v[64:67], v[36:39], v[72:79], v110
    ds_read_b128 v[84:87], v113 offset:5120
    v_smfmac_f32_16x16x64_bf16 v[64:67], v[0:3], v[128:135], v110
    ds_read_b128 v[72:75], v113 offset:6144
    v_smfmac_f32_16x16x64_bf16 v[64:67], v[4:7], v[136:143], v110
    ds_read_b128 v[76:79], v113 offset:7168
    v_smfmac_f32_16x16x64_bf16 v[64:67], v[8:11], v[144:151], v110
    ds_read_b128 v[32:35], v113 offset:8192
    v_smfmac_f32_16x16x64_bf16 v[64:67], v[12:15], v[152:159], v110
    ds_read_b128 v[36:39], v113 offset:9216
    v_smfmac_f32_16x16x64_bf16 v[64:67], v[16:19], v[160:167], v110
    ds_read_b128 v[0:3], v113 offset:10240
    s_memtime s[52:53]
    v_smfmac_f32_16x16x64_bf16 v[64:67], v[20:23], v[168:175], v110
    ds_read_b128 v[4:7], v113 offset:11264
    s_memtime s[52:53]
    s_xor_b32 s32, s9, s22
    s_bitcmp1_b32 s32, 0
    s_cbranch_scc1 main_kernel_cs_t_p
main_kernel_cs_t_ok:
    s_sub_u32 s32, s9, s10
    v_smfmac_f32_16x16x64_bf16 v[64:67], v[24:27], v[176:183], v110
    ds_read_b128 v[8:11], v113 offset:12288
    s_memtime s[52:53]
    s_max_i32 s32, s32, 0
    s_min_i32 s32, s32, 0x4000
    v_smfmac_f32_16x16x64_bf16 v[64:67], v[28:31], v[184:191], v110
    s_waitcnt lgkmcnt(7)
    ds_read_b128 v[12:15], v113 offset:13312
    s_memtime s[52:53]
    s_add_u32 s34, s34, s32
    s_and_b32 s34, s34, s11
    v_smfmac_f32_16x16x64_bf16 v[64:67], v[40:43], v[80:87], v110
    s_waitcnt lgkmcnt(6)
    ds_read_b128 v[16:19], v113 offset:14336
    s_cmp_lt_u32 s52, s34
    s_cbranch_scc1 main_kernel_cs_t_w
main_kernel_cs_t_go:
    s_barrier
    buffer_load_dwordx2 v[126:127], v123, s[4:7], s19 offen offset:0 sc1
    v_smfmac_f32_16x16x64_bf16 v[64:67], v[44:47], v[72:79], v110
    s_waitcnt lgkmcnt(5)
    ds_read_b128 v[20:23], v113 offset:15360
    v_smfmac_f32_16x16x64_bf16 v[64:67], v[48:51], v[32:39], v110
    s_waitcnt lgkmcnt(4)
    v_smfmac_f32_16x16x64_bf16 v[64:67], v[52:55], v[0:7], v110
    s_waitcnt lgkmcnt(2)
    ds_read_b128 v[24:27], v112 offset:6144
    ds_read_b128 v[28:31], v112 offset:7168
    v_smfmac_f32_16x16x64_bf16 v[64:67], v[56:59], v[8:15], v110
    s_waitcnt lgkmcnt(2)
    ds_read_b128 v[0:3], v112 offset:0
    ds_read_b128 v[4:7], v112 offset:1024
    v_smfmac_f32_16x16x64_bf16 v[64:67], v[60:63], v[16:23], v110
    ds_read_b128 v[8:11], v112 offset:2048
    ds_read_b128 v[12:15], v112 offset:3072
    ds_read_b128 v[16:19], v112 offset:4096
    ds_read_b128 v[20:23], v112 offset:5120
    v_mov_b32 v76, 0
    v_mov_b32 v77, 0
    v_mov_b32 v78, 0
    s_nop 0
    v_permlane32_swap_b32 v64, v65
    v_permlane32_swap_b32 v66, v67
    v_cvt_pk_bf16_f32 v84, v64, v66
    v_cvt_pk_bf16_f32 v85, v65, v67
    v_bfi_b32 v84, 1, s22, v84
    buffer_load_dwordx2 v[42:43], v123, s[4:7], s19 offen offset:512 sc1
    v_mov_b32 v79, 0
    v_mov_b32 v80, 0
    v_mov_b32 v81, 0
    v_mov_b32 v82, 0
    v_mov_b32 v83, 0
    v_mov_b32 v60, 0
    v_mov_b32 v60, 0
    v_mov_b32 v60, 0
    v_mov_b32 v60, 0
    v_mov_b32 v60, 0
    v_mov_b32 v60, 0
    v_mov_b32 v60, 0
    buffer_store_dwordx2 v[84:85], v123, s[4:7], s18 offen offset:1024 sc1
    v_mov_b32 v60, 0
    v_mov_b32 v60, 0
    v_mov_b32 v60, 0
    v_mov_b32 v60, 0
    v_mov_b32 v60, 0
    v_mov_b32 v60, 0
    v_mov_b32 v60, 0
    v_mov_b32 v60, 0
    v_mov_b32 v60, 0
    v_mov_b32 v60, 0
    v_mov_b32 v60, 0
    v_mov_b32 v60, 0
    v_mov_b32 v60, 0
    v_mov_b32 v60, 0
    v_mov_b32 v60, 0
    v_mov_b32 v60, 0
    v_mov_b32 v60, 0
    v_mov_b32 v60, 0
    v_mov_b32 v60, 0
    v_mov_b32 v60, 0
    v_mov_b32 v60, 0
    v_mov_b32 v60, 0
    v_mov_b32 v60, 0
    v_mov_b32 v60, 0
    v_mov_b32 v60, 0
    v_mov_b32 v60, 0
    v_mov_b32 v60, 0
    v_mov_b32 v60, 0
    v_mov_b32 v60, 0
    v_mov_b32 v60, 0
    v_mov_b32 v60, 0
    v_mov_b32 v60, 0
    v_mov_b32 v60, 0
    v_mov_b32 v60, 0
    v_mov_b32 v60, 0
    v_mov_b32 v60, 0
    v_mov_b32 v60, 0
    v_mov_b32 v60, 0
    s_waitcnt vmcnt(2)
main_kernel_cs_z0:
    v_dot2_f32_bf16 v44, v126, s37, v96
    v_dot2_f32_bf16 v45, v126, s57, v97
    v_dot2_f32_bf16 v46, v127, s37, v98
    v_dot2_f32_bf16 v47, v127, s57, v99
    v_bitop3_b32 v60, v126, s22, 1 bitop3:0x28
    v_cvt_pk_bf16_f32 v44, v44, v45
    v_cmp_ne_u32 vcc, 0, v60
    v_cvt_pk_bf16_f32 v45, v46, v47
    ds_write_b64 v124, v[44:45] offset:0
    buffer_load_dwordx2 v[64:65], v123, s[4:7], s19 offen offset:512 sc1
    v_cmp_eq_u32 s[42:43], 0, v111
    s_cbranch_vccnz main_kernel_cs_z0_f
    v_mov_b32 v96, 0x3f803f80
    v_mov_b32 v97, 0x3f803f80
    v_mov_b32 v98, 0x3f803f80
    v_mov_b32 v99, 0x3f803f80
    s_and_b32 s32, s43, 0x3f00
    s_cbranch_scc1 main_kernel_cs_kvw
main_kernel_cs_kvok:
    s_waitcnt lgkmcnt(0)
    s_barrier
    ds_read_b64_tr_b16 v[48:49], v115 offset:16384
    ds_read_b64_tr_b16 v[50:51], v115 offset:17408
    ds_read_b64_tr_b16 v[52:53], v115 offset:18432
    ds_read_b64_tr_b16 v[54:55], v115 offset:19456
    s_waitcnt vmcnt(2)
    s_memtime s[52:53]
    v_dot2_f32_bf16 v44, v42, s37, v68
    v_dot2_f32_bf16 v45, v42, s57, v69
    v_dot2_f32_bf16 v46, v43, s37, v70
    v_dot2_f32_bf16 v47, v43, s57, v71
    v_bitop3_b32 v60, v42, s22, 1 bitop3:0x28
    v_cvt_pk_bf16_f32 v44, v44, v45
    v_cmp_ne_u32 vcc, 0, v60
    v_cvt_pk_bf16_f32 v45, v46, v47
    ds_write_b64 v124, v[44:45] offset:512
    s_waitcnt lgkmcnt(3)
    v_mfma_f32_16x16x32_bf16 v[32:35], v[0:3], v[48:51], 0
    v_mfma_f32_16x16x32_bf16 v[36:39], v[16:19], v[48:51], 0
    s_cbranch_vccnz main_kernel_cs_z1_f
main_kernel_cs_z_ok:
    v_mfma_f32_16x16x32_bf16 v[72:75], v[48:51], v[48:51], 0
    s_waitcnt lgkmcnt(1)
    s_sub_u32 s32, s52, s38
    v_mov_b32 v46, s32
    v_mfma_f32_16x16x32_bf16 v[32:35], v[4:7], v[52:55], v[32:35]
    buffer_load_dwordx2 v[86:87], v123, s[4:7], s19 offen offset:1024 sc1
    buffer_store_dword v46, v117, s[4:7], s46 offen sc1
    s_cmp_eq_u32 s17, 64
    s_waitcnt lgkmcnt(0)
    s_barrier
    ds_read_b64_tr_b16 v[56:57], v115 offset:16896
    ds_read_b64_tr_b16 v[58:59], v115 offset:17920
    ds_read_b64_tr_b16 v[60:61], v115 offset:18944
    ds_read_b64_tr_b16 v[62:63], v115 offset:19968
    s_cbranch_scc1 main_kernel_cs_last
    v_bfe_u32 v47, v123, 1, 7
    buffer_load_dwordx2 v[126:127], v123, s[4:7], s19 offen offset:1024 sc1
    buffer_load_dwordx4 v116, s[4:7], s27 offen offset:1024 sc1 lds
    v_mfma_f32_16x16x32_bf16 v[36:39], v[20:23], v[52:55], v[36:39]
    v_mfma_f32_16x16x32_bf16 v[72:75], v[52:55], v[52:55], v[72:75]
    s_waitcnt lgkmcnt(2)
    v_mfma_f32_16x16x32_bf16 v[72:75], v[56:59], v[56:59], v[72:75]
    v_mfma_f32_16x16x32_bf16 v[32:35], v[8:11], v[56:59], v[32:35]
    s_waitcnt lgkmcnt(0)
    v_mfma_f32_16x16x32_bf16 v[72:75], v[60:63], v[60:63], v[72:75]
    ds_read_b128 v[0:3], v113 offset:16384
    v_mfma_f32_16x16x32_bf16 v[32:35], v[12:15], v[60:63], v[32:35]
    ds_read_b128 v[16:19], v113 offset:18432
    v_mfma_f32_16x16x32_bf16 v[36:39], v[24:27], v[56:59], v[36:39]
    ds_read_b128 v[4:7], v113 offset:17408
    s_nop 0
    v_permlane32_swap_b32 v72, v73
    v_permlane32_swap_b32 v74, v75
    v_mfma_f32_16x16x32_bf16 v[36:39], v[28:31], v[60:63], v[36:39]
    ds_read_b128 v[20:23], v113 offset:19456
    v_mul_f32 v73, s30, v73
    v_mul_f32 v75, s30, v75
    v_exp_f32 v32, v32
    ds_read_b128 v[8:11], v113 offset:24576
    v_exp_f32 v33, v33
    ds_read_b128 v[12:15], v113 offset:25600
    v_exp_f32 v73, v73
    ds_read_b128 v[24:27], v113 offset:26624
    v_exp_f32 v75, v75
    ds_read_b128 v[28:31], v113 offset:27648
    v_exp_f32 v34, v34
    v_cvt_pk_bf16_f32 v72, v73, v75
    v_cvt_pk_bf16_f32 v73, v73, v75
    v_exp_f32 v35, v35
    s_waitcnt vmcnt(4)
    v_mfma_f32_16x16x16_bf16 v[40:43], v[100:101], v[72:73], 0
    v_exp_f32 v36, v36
    v_cvt_pk_bf16_f32 v32, v32, v33
    v_exp_f32 v37, v37
    v_cvt_pk_bf16_f32 v33, v34, v35
    v_exp_f32 v38, v38
    v_exp_f32 v39, v39
    v_cvt_pk_bf16_f32 v34, v36, v37
    v_cvt_pk_bf16_f32 v35, v38, v39
    s_nop 1
    v_mfma_f32_16x16x32_bf16 v[40:43], v[96:99], v[32:35], v[40:43]
    v_mfma_f32_16x16x32_bf16 v[64:67], v[88:91], v[32:35], 0
    v_mfma_f32_16x16x32_bf16 v[68:71], v[92:95], v[32:35], 0
    s_waitcnt vmcnt(3)
main_kernel_cs_v_ok:
    v_bitop3_b32 v44, v86, s22, 1 bitop3:0x28
    v_swap_b32 v85, v86
    v_cmp_ne_u32 vcc, 0, v44
main_kernel_cs_d_ok:
    s_nop 0
    v_mfma_f32_16x16x16_bf16 v[64:67], v[84:85], v[72:73], v[64:67]
    v_mfma_f32_16x16x16_bf16 v[68:71], v[86:87], v[72:73], v[68:71]
    s_cbranch_vccnz main_kernel_cs_v_f
    v_rcp_f32 v42, v40
    v_subrev_u32 v41, 0x21800000, v41
    v_cmp_lt_u32 vcc, 0x3c000000, v41
    s_nop 0
    v_pk_mul_f32 v[64:65], v[64:65], v[42:43] op_sel_hi:[1,0]
    v_pk_mul_f32 v[66:67], v[66:67], v[42:43] op_sel_hi:[1,0]
    v_cvt_pk_bf16_f32 v44, v64, v65
    v_pk_mul_f32 v[68:69], v[68:69], v[42:43] op_sel_hi:[1,0]
    v_cvt_pk_bf16_f32 v45, v66, v67
    v_pk_mul_f32 v[70:71], v[70:71], v[42:43] op_sel_hi:[1,0]
    v_cvt_pk_bf16_f32 v46, v68, v69
    v_cvt_pk_bf16_f32 v47, v70, v71
    ds_write_b128 v118, v[44:47]
    s_and_b64 s[42:43], vcc, s[44:45]
    s_cbranch_scc1 main_kernel_cs_d_f
    s_mov_b64 s[44:45], s[0:1]
    v_mov_b32 v64, 0
    v_mov_b32 v65, 0
    v_mov_b32 v66, 0
    v_mov_b32 v67, 0
    v_mov_b32 v68, 0
    v_mov_b32 v69, 0
    v_mov_b32 v70, 0
    v_mov_b32 v71, 0
    v_bfe_u32 v90, v123, 1, 7
    s_xor_b32 s23, s23, 0x80000
    s_waitcnt lgkmcnt(0)
    s_barrier
    ds_read_b128 v[56:59], v114 offset:1024
    ds_read_b128 v[60:63], v114 offset:1536
    ds_read_b128 v[48:51], v114 offset:0
    ds_read_b128 v[52:55], v114 offset:512
    s_xor_b32 s18, s18, 0x100000
    s_xor_b32 s19, s18, 0x80000
    s_xor_b32 s25, s25, 0x4000
    s_add_u32 s27, s27, 0x40000
    v_add_u32 v121, 4, v121
    v_xor_b32 v112, 0x4000, v112
    s_xor_b32 s36, s36, 0x4000
    s_mov_b32 m0, 0
    s_mov_b32 s54, s24
    s_xor_b32 s24, s24, 0x4000
    s_add_u32 s55, s25, 4096
    v_mov_b32 v89, s17
    s_mov_b32 s15, 0
    s_add_u32 s56, s19, 1536
    s_xor_b32 s9, s11, s40
    s_add_u32 s16, s20, s38
    s_waitcnt lgkmcnt(3)
    v_smfmac_f32_16x16x64_bf16 v[76:79], v[56:59], v[0:7], v110
    s_waitcnt lgkmcnt(2)
    ds_read_b128 v[0:3], v113 offset:20480
    v_smfmac_f32_16x16x64_bf16 v[76:79], v[60:63], v[8:15], v110
    s_waitcnt lgkmcnt(2)
    ds_read_b128 v[4:7], v113 offset:21504
    v_smfmac_f32_16x16x64_bf16 v[76:79], v[48:51], v[192:199], v110
    s_waitcnt lgkmcnt(2)
    ds_read_b128 v[8:11], v113 offset:28672
    v_smfmac_f32_16x16x64_bf16 v[76:79], v[52:55], v[200:207], v110
    ds_read_b128 v[12:15], v113 offset:29696
    buffer_load_dword v111, v90, s[4:7], s47 offen sc1
    v_smfmac_f32_16x16x64_bf16 v[80:83], v[56:59], v[16:23], v110
    ds_read_b128 v[16:19], v113 offset:22528
    v_smfmac_f32_16x16x64_bf16 v[80:83], v[60:63], v[24:31], v110
    ds_read_b128 v[20:23], v113 offset:23552
    v_smfmac_f32_16x16x64_bf16 v[80:83], v[48:51], v[208:215], v110
    ds_read_b128 v[24:27], v113 offset:30720
    v_cvt_pk_f16_f32 v40, v76, v77
    v_smfmac_f32_16x16x64_bf16 v[80:83], v[52:55], v[216:223], v110
    ds_read_b128 v[28:31], v113 offset:31744
    v_cvt_pk_f16_f32 v41, v78, v79
    v_smfmac_f32_16x16x64_bf16 v[64:67], v[48:51], v[224:231], v110
    v_bfi_b32 v40, 1, s22, v40
    v_smfmac_f32_16x16x64_bf16 v[64:67], v[52:55], v[232:239], v110
    s_waitcnt lgkmcnt(6)
    buffer_load_dword v111, v90, s[4:7], s47 offen sc1
    v_smfmac_f32_16x16x64_bf16 v[64:67], v[56:59], v[0:7], v110
    s_waitcnt lgkmcnt(4)
    buffer_store_dwordx2 v[40:41], v119, s[4:7], s21 offen offset:0 sc1
    v_cvt_pk_f16_f32 v42, v80, v81
    v_smfmac_f32_16x16x64_bf16 v[64:67], v[60:63], v[8:15], v110
    v_cvt_pk_f16_f32 v43, v82, v83
    v_smfmac_f32_16x16x64_bf16 v[68:71], v[48:51], v[240:247], v110
    v_bfi_b32 v42, 1, s22, v42
    v_smfmac_f32_16x16x64_bf16 v[68:71], v[52:55], v[248:255], v110
    s_waitcnt lgkmcnt(2)
    v_smfmac_f32_16x16x64_bf16 v[68:71], v[56:59], v[16:23], v110
    s_waitcnt lgkmcnt(0)
    buffer_store_dwordx2 v[42:43], v119, s[4:7], s21 offen offset:512 sc1
    v_cvt_pk_f16_f32 v44, v64, v65
    v_smfmac_f32_16x16x64_bf16 v[68:71], v[60:63], v[24:31], v110
    v_cvt_pk_f16_f32 v45, v66, v67
    v_bfi_b32 v44, 1, s22, v44
    s_cmp_lg_u32 s14, 0
    buffer_store_dwordx2 v[44:45], v119, s[4:7], s21 offen offset:1024 sc1
    s_nop 3
    v_cvt_pk_f16_f32 v46, v68, v69
    v_cvt_pk_f16_f32 v47, v70, v71
    v_bfi_b32 v46, 1, s22, v46
    buffer_store_dwordx2 v[46:47], v119, s[4:7], s21 offen offset:1536 sc1
    s_cbranch_scc1 main_kernel_cs_wx
    s_waitcnt vmcnt(5)
    s_xor_b32 s21, s21, 0x80000
main_kernel_cs_rgo:
    v_subrev_u32 v32, s20, v111
    s_memtime s[52:53]
    v_cmp_lt_u32 vcc, 0x100000, v32
    v_max_u32_dpp v32, v32, v32 row_shr:1 row_mask:0xf bank_mask:0xf
    s_nop 0
    s_nop 0
    v_max_u32_dpp v32, v32, v32 row_shr:2 row_mask:0xf bank_mask:0xf
    s_nop 0
    s_cbranch_vccnz main_kernel_cs_fsp
main_kernel_cs_fok:
    s_nop 0
    v_max_u32_dpp v32, v32, v32 row_shr:4 row_mask:0xf bank_mask:0xf
    s_memtime s[52:53]
    s_nop 0
    v_max_u32_dpp v32, v32, v32 row_shr:8 row_mask:0xf bank_mask:0xf
    s_memtime s[52:53]
    s_nop 0
    v_max_u32_dpp v32, v32, v32 row_bcast:15 row_mask:0xa bank_mask:0xf
    s_memtime s[52:53]
    s_sub_u32 s33, s52, s16
    v_readlane_b32 s32, v32, 31
    s_add_u32 s33, s33, 0x400
    s_memtime s[52:53]
    s_add_u32 s34, s16, 1650
    s_memtime s[52:53]
    s_min_u32 s32, s32, s33
    s_max_u32 s32, s32, s15
    s_add_u32 s34, s34, s32
    s_mov_b32 s35, 200
main_kernel_cs_fw:
    s_memtime s[52:53]
    s_cmp_ge_u32 s52, s34
    s_cbranch_scc1 main_kernel_cs_fgo
    s_memtime s[52:53]
    s_cmp_ge_u32 s52, s34
    s_cbranch_scc1 main_kernel_cs_fgo
    s_memtime s[52:53]
    s_cmp_ge_u32 s52, s34
    s_cbranch_scc1 main_kernel_cs_fgo
    s_memtime s[52:53]
    s_cmp_ge_u32 s52, s34
    s_cbranch_scc1 main_kernel_cs_fgo
    s_memtime s[52:53]
    s_cmp_ge_u32 s52, s34
    s_cbranch_scc1 main_kernel_cs_fgo
    s_memtime s[52:53]
    s_cmp_ge_u32 s52, s34
    s_cbranch_scc1 main_kernel_cs_fgo
    s_memtime s[52:53]
    s_cmp_ge_u32 s52, s34
    s_cbranch_scc1 main_kernel_cs_fgo
    s_memtime s[52:53]
    s_cmp_ge_u32 s52, s34
    s_cbranch_scc1 main_kernel_cs_fgo
    s_sub_u32 s35, s35, 1
    s_cbranch_scc0 main_kernel_cs_fw
main_kernel_cs_fgo:
    buffer_load_dwordx4 v[0:3], v120, s[4:7], s23 offen sc1
    s_add_u32 s35, s23, 0x8000
    buffer_load_dwordx4 v[4:7], v120, s[4:7], s35 offen sc1
    s_add_u32 s35, s23, 0x10000
    buffer_load_dwordx4 v[8:11], v120, s[4:7], s35 offen sc1
    ds_read_b32 v33, v123 offset:20992
    s_add_u32 s35, s23, 0x18000
    buffer_load_dwordx4 v[12:15], v120, s[4:7], s35 offen sc1
    s_add_u32 s35, s23, 0x20000
    buffer_load_dwordx4 v[16:19], v120, s[4:7], s35 offen sc1
    s_add_u32 s35, s23, 0x28000
    buffer_load_dwordx4 v[20:23], v120, s[4:7], s35 offen sc1
    s_add_u32 s35, s23, 0x30000
    buffer_load_dwordx4 v[24:27], v120, s[4:7], s35 offen sc1
    s_add_u32 s35, s23, 0x38000
    buffer_load_dwordx4 v[28:31], v120, s[4:7], s35 offen sc1
    s_mov_b64 exec, 1
    s_waitcnt lgkmcnt(0)
    v_sub_u32 v33, s34, v33
    v_bfi_b32 v33, 1, s40, v33
    buffer_store_dword v33, off, s[4:7], s18 offset:1536 sc1
    v_readfirstlane_b32 s10, v33
    s_mov_b64 exec, -1
    s_waitcnt vmcnt(8)
    v_mfma_f32_16x16x32_f16 v[76:79], v[0:3], v[106:109], 0
    v_xor_b32 v36, s22, v0
    v_bitop3_b32 v36, v2, s22, v36 bitop3:0xbe
    s_waitcnt vmcnt(7)
    v_mfma_f32_16x16x32_f16 v[76:79], v[4:7], v[106:109], v[76:79]
    v_bitop3_b32 v36, v4, s22, v36 bitop3:0xbe
    v_bitop3_b32 v36, v6, s22, v36 bitop3:0xbe
    s_waitcnt vmcnt(6)
    v_mfma_f32_16x16x32_f16 v[76:79], v[8:11], v[106:109], v[76:79]
    v_bitop3_b32 v36, v8, s22, v36 bitop3:0xbe
    v_bitop3_b32 v36, v10, s22, v36 bitop3:0xbe
    s_waitcnt vmcnt(5)
    v_mfma_f32_16x16x32_f16 v[76:79], v[12:15], v[106:109], v[76:79]
    v_bitop3_b32 v36, v12, s22, v36 bitop3:0xbe
    v_bitop3_b32 v36, v14, s22, v36 bitop3:0xbe
    s_waitcnt vmcnt(4)
    v_mfma_f32_16x16x32_f16 v[76:79], v[16:19], v[106:109], v[76:79]
    v_bitop3_b32 v36, v16, s22, v36 bitop3:0xbe
    v_bitop3_b32 v36, v18, s22, v36 bitop3:0xbe
    s_waitcnt vmcnt(3)
    v_mfma_f32_16x16x32_f16 v[76:79], v[20:23], v[106:109], v[76:79]
    v_bitop3_b32 v36, v20, s22, v36 bitop3:0xbe
    v_bitop3_b32 v36, v22, s22, v36 bitop3:0xbe
    s_waitcnt vmcnt(2)
    v_mfma_f32_16x16x32_f16 v[76:79], v[24:27], v[106:109], v[76:79]
    v_bitop3_b32 v36, v24, s22, v36 bitop3:0xbe
    v_bitop3_b32 v36, v26, s22, v36 bitop3:0xbe
    s_waitcnt vmcnt(1)
    v_mfma_f32_16x16x32_f16 v[76:79], v[28:31], v[106:109], v[76:79]
    v_bitop3_b32 v36, v28, s22, v36 bitop3:0xbe
    v_bitop3_b32 v36, v30, s22, v36 bitop3:0xbe
    v_and_b32 v36, 1, v36
    v_cmp_ne_u32 vcc, 0, v36
    s_nop 3
    v_cvt_pk_bf16_f32 v126, v76, v77
    v_cvt_pk_bf16_f32 v127, v78, v79
    s_cbranch_vccnz main_kernel_cs_r_f
    buffer_store_dwordx2 v[126:127], v122, s[4:7], s24 offen sc1
    s_sub_u32 s20, s34, s38
    s_mov_b32 s3, s34
    buffer_store_dword v89, v117, s[4:7], s46 offen offset:512 sc1
    v_mov_b32 v32, -1
    v_mov_b32 v33, -1
    v_mov_b32 v64, 0
    v_mov_b32 v65, 0
    v_mov_b32 v66, 0
    v_mov_b32 v67, 0
    v_mov_b32 v68, 0
    v_mov_b32 v69, 0
    v_mov_b32 v70, 0
    v_mov_b32 v71, 0
    v_mov_b32 v96, 0
    v_mov_b32 v97, 0
    v_mov_b32 v98, 0
    v_mov_b32 v99, 0
    buffer_store_dwordx2 v[32:33], v122, s[4:7], s54 offen sc1
    s_cmp_eq_u32 s12, 0
    v_add_u32 v56, s59, v115
    s_cbranch_scc0 main_kernel_cs_vma
    ds_read_b64_tr_b16 v[80:81], v56 offset:16384
    ds_read_b64_tr_b16 v[82:83], v56 offset:17408
    s_waitcnt lgkmcnt(0)
    s_nop 15
    s_nop 15
    s_nop 5
    s_buffer_load_dword s9, s[4:7], s56 glc
    buffer_load_dword v111, v90, s[4:7], s47 offen offset:512 sc1
    buffer_load_dwordx4 v116, s[4:7], s25 offen offset:0 sc1 lds
    buffer_load_dwordx4 v116, s[4:7], s25 offen offset:1024 sc1 lds
    buffer_load_dwordx4 v116, s[4:7], s25 offen offset:2048 sc1 lds
    buffer_load_dwordx4 v116, s[4:7], s25 offen offset:3072 sc1 lds
    s_mov_b32 m0, 4096
    s_nop 0
    buffer_load_dwordx4 v116, s[4:7], s55 offen offset:0 sc1 lds
    buffer_load_dwordx4 v116, s[4:7], s55 offen offset:1024 sc1 lds
    buffer_load_dwordx4 v116, s[4:7], s55 offen offset:2048 sc1 lds
    buffer_load_dwordx4 v116, s[4:7], s55 offen offset:3072 sc1 lds
    v_mov_b32 v34, v90
    s_mov_b32 m0, s36
    s_barrier
    ds_read_b32 v35, v123 offset:20480
    buffer_load_dwordx4 v[88:91], v116, s[4:7], s28 offen offset:0 sc1
    buffer_load_dwordx4 v[92:95], v116, s[4:7], s28 offen offset:1024 sc1
    buffer_load_dwordx4 v116, s[4:7], s27 offen offset:0 sc1 lds
    buffer_store_dwordx4 v[80:83], v125, s[4:7], s26 offen sc1
    s_branch main_kernel_cs_kva
main_kernel_cs_vma:
    v_mfma_f32_16x16x32_bf16 v[56:59], v[102:105], v[84:87], 0
    s_nop 7
    v_cvt_pk_bf16_f32 v80, v56, v57
    v_cvt_pk_bf16_f32 v81, v58, v59
    s_nop 15
    s_nop 15
    s_nop 5
    s_buffer_load_dword s9, s[4:7], s56 glc
    buffer_load_dword v111, v90, s[4:7], s47 offen offset:512 sc1
    buffer_load_dwordx4 v116, s[4:7], s25 offen offset:0 sc1 lds
    buffer_load_dwordx4 v116, s[4:7], s25 offen offset:1024 sc1 lds
    buffer_load_dwordx4 v116, s[4:7], s25 offen offset:2048 sc1 lds
    buffer_load_dwordx4 v116, s[4:7], s25 offen offset:3072 sc1 lds
    s_mov_b32 m0, 4096
    s_nop 0
    buffer_load_dwordx4 v116, s[4:7], s55 offen offset:0 sc1 lds
    buffer_load_dwordx4 v116, s[4:7], s55 offen offset:1024 sc1 lds
    buffer_load_dwordx4 v116, s[4:7], s55 offen offset:2048 sc1 lds
    buffer_load_dwordx4 v116, s[4:7], s55 offen offset:3072 sc1 lds
    v_mov_b32 v34, v90
    s_mov_b32 m0, s36
    s_barrier
    ds_read_b32 v35, v123 offset:20480
    buffer_load_dwordx4 v[88:91], v116, s[4:7], s28 offen offset:0 sc1
    buffer_load_dwordx4 v[92:95], v116, s[4:7], s28 offen offset:1024 sc1
    buffer_load_dwordx4 v116, s[4:7], s27 offen offset:0 sc1 lds
    buffer_store_dwordx2 v[80:81], v123, s[4:7], s26 offen sc1
main_kernel_cs_kva:
    s_add_u32 s26, s26, 0x10000
    s_waitcnt vmcnt(12)
    v_cmp_gt_i32 vcc, s17, v111
    v_readfirstlane_b32 s38, v35
    s_cbranch_vccnz main_kernel_cs_mc_f
    s_waitcnt vmcnt(4)
    s_branch main_kernel_cs_top
main_kernel_cs_wx:
    s_cmp_lg_u32 s14, 1
    s_cbranch_scc1 main_kernel_cs_wy
    s_memrealtime s[32:33]
    s_nop 0
    s_nop 0
    s_memrealtime s[32:33]
    s_nop 0
    s_nop 0
    s_memrealtime s[32:33]
    s_nop 0
    s_nop 0
    s_memrealtime s[32:33]
    s_nop 0
    s_nop 0
    s_memrealtime s[32:33]
    s_nop 0
    s_nop 0
    s_memrealtime s[32:33]
    s_nop 0
    s_nop 0
    s_memrealtime s[32:33]
    s_nop 0
    s_nop 0
    s_memrealtime s[32:33]
    s_nop 0
    s_nop 0
    s_memrealtime s[32:33]
    s_nop 0
    s_nop 0
    s_memrealtime s[32:33]
    s_nop 0
    s_nop 0
    s_memrealtime s[32:33]
    s_nop 0
    s_nop 0
    s_memrealtime s[32:33]
    s_nop 0
    s_nop 0
    s_mov_b32 s34, s32
    s_memrealtime s[32:33]
    s_cmp_lg_u32 s32, s34
    s_cbranch_scc1 main_kernel_cs_e1
    s_memrealtime s[32:33]
    s_cmp_lg_u32 s32, s34
    s_cbranch_scc1 main_kernel_cs_e1
    s_memrealtime s[32:33]
    s_cmp_lg_u32 s32, s34
    s_cbranch_scc1 main_kernel_cs_e1
    s_memrealtime s[32:33]
    s_cmp_lg_u32 s32, s34
    s_cbranch_scc1 main_kernel_cs_e1
    s_memrealtime s[32:33]
    s_cmp_lg_u32 s32, s34
    s_cbranch_scc1 main_kernel_cs_e1
    s_memrealtime s[32:33]
    s_cmp_lg_u32 s32, s34
    s_cbranch_scc1 main_kernel_cs_e1
    s_memrealtime s[32:33]
    s_cmp_lg_u32 s32, s34
    s_cbranch_scc1 main_kernel_cs_e1
    s_memrealtime s[32:33]
    s_cmp_lg_u32 s32, s34
    s_cbranch_scc1 main_kernel_cs_e1
    s_memrealtime s[32:33]
    s_cmp_lg_u32 s32, s34
    s_cbranch_scc1 main_kernel_cs_e1
    s_memrealtime s[32:33]
    s_cmp_lg_u32 s32, s34
    s_cbranch_scc1 main_kernel_cs_e1
    s_memrealtime s[32:33]
    s_cmp_lg_u32 s32, s34
    s_cbranch_scc1 main_kernel_cs_e1
    s_memrealtime s[32:33]
    s_cmp_lg_u32 s32, s34
    s_cbranch_scc1 main_kernel_cs_e1
main_kernel_cs_e1:
    s_memtime s[52:53]
    s_mul_i32 s34, s32, 22
    s_waitcnt lgkmcnt(0)
    s_sub_u32 s32, s52, s34
    s_sub_u32 s33, s32, s38
    s_ashr_i32 s34, s33, 1
    s_add_u32 s34, s34, s32
    v_mov_b32 v34, s34
    v_mov_b32 v33, s32
    ds_write2st64_b32 v123, v33, v34 offset0:80 offset1:82
    v_add_u32 v37, s33, v34
main_kernel_cs_wy:
    s_xor_b32 s21, s21, 0x80000
    v_mov_b32 v64, 0
    v_mov_b32 v65, 0
    v_mov_b32 v66, 0
    v_mov_b32 v67, 0
    v_mov_b32 v68, 0
    v_mov_b32 v69, 0
    v_mov_b32 v70, 0
    v_mov_b32 v71, 0
    v_mov_b32 v96, 0
    v_mov_b32 v97, 0
    v_mov_b32 v98, 0
    v_mov_b32 v99, 0
    s_cmp_eq_u32 s12, 0
    v_add_u32 v56, s59, v115
    s_cbranch_scc0 main_kernel_cs_vmb
    ds_read_b64_tr_b16 v[80:81], v56 offset:16384
    ds_read_b64_tr_b16 v[82:83], v56 offset:17408
    s_waitcnt lgkmcnt(0)
    s_waitcnt vmcnt(0)
    s_mov_b32 m0, s36
    s_barrier
    ds_read_b32 v35, v123 offset:20480
    ds_write_b32 v124, v37 offset:3584
    buffer_load_dwordx4 v[88:91], v116, s[4:7], s28 offen offset:0 sc1
    buffer_load_dwordx4 v[92:95], v116, s[4:7], s28 offen offset:1024 sc1
    buffer_load_dwordx4 v116, s[4:7], s27 offen offset:0 sc1 lds
    buffer_store_dwordx4 v[80:83], v125, s[4:7], s26 offen sc1
    s_branch main_kernel_cs_kvb
main_kernel_cs_vmb:
    v_mfma_f32_16x16x32_bf16 v[56:59], v[102:105], v[84:87], 0
    s_nop 7
    v_cvt_pk_bf16_f32 v80, v56, v57
    v_cvt_pk_bf16_f32 v81, v58, v59
    s_waitcnt vmcnt(0)
    s_mov_b32 m0, s36
    s_barrier
    ds_read_b32 v35, v123 offset:20480
    ds_write_b32 v124, v37 offset:3584
    buffer_load_dwordx4 v[88:91], v116, s[4:7], s28 offen offset:0 sc1
    buffer_load_dwordx4 v[92:95], v116, s[4:7], s28 offen offset:1024 sc1
    buffer_load_dwordx4 v116, s[4:7], s27 offen offset:0 sc1 lds
    buffer_store_dwordx2 v[80:81], v123, s[4:7], s26 offen sc1
main_kernel_cs_kvb:
    s_add_u32 s26, s26, 0x10000
    s_mov_b64 exec, 1
    buffer_store_dword v100, off, s[4:7], s39 sc1
    s_mov_b64 exec, -1
    s_add_u32 s39, s39, 4
    s_waitcnt lgkmcnt(0)
    v_readfirstlane_b32 s38, v35
    v_mov_b32 v35, 0
    v_mov_b32 v35, 0
    v_mov_b32 v35, 0
    v_mov_b32 v35, 0
    v_mov_b32 v35, 0
    v_mov_b32 v35, 0
main_kernel_cs_end:
    s_branch main_kernel_cs_top
main_kernel_cs_mc_f:
    s_mov_b32 m0, 0
    s_sub_u32 s29, s29, 1
    s_cbranch_scc1 main_kernel_end
    buffer_load_dword v111, v34, s[4:7], s47 offen offset:512 sc1
    buffer_load_dwordx4 v116, s[4:7], s25 offen offset:0 sc1 lds
    buffer_load_dwordx4 v116, s[4:7], s25 offen offset:1024 sc1 lds
    buffer_load_dwordx4 v116, s[4:7], s25 offen offset:2048 sc1 lds
    buffer_load_dwordx4 v116, s[4:7], s25 offen offset:3072 sc1 lds
    s_mov_b32 m0, 4096
    s_nop 0
    buffer_load_dwordx4 v116, s[4:7], s55 offen offset:0 sc1 lds
    buffer_load_dwordx4 v116, s[4:7], s55 offen offset:1024 sc1 lds
    buffer_load_dwordx4 v116, s[4:7], s55 offen offset:2048 sc1 lds
    buffer_load_dwordx4 v116, s[4:7], s55 offen offset:3072 sc1 lds
    s_waitcnt vmcnt(8)
    v_cmp_gt_i32 vcc, s17, v111
    v_readfirstlane_b32 s38, v35
    s_cbranch_vccnz main_kernel_cs_mc_f
    s_waitcnt vmcnt(0)
    s_branch main_kernel_cs_end
main_kernel_cs_t_w:
    s_mov_b32 s35, 200
main_kernel_cs_t_s:
    s_memtime s[52:53]
    s_cmp_ge_u32 s52, s34
    s_cbranch_scc1 main_kernel_cs_t_go
    s_memtime s[52:53]
    s_cmp_ge_u32 s52, s34
    s_cbranch_scc1 main_kernel_cs_t_go
    s_memtime s[52:53]
    s_cmp_ge_u32 s52, s34
    s_cbranch_scc1 main_kernel_cs_t_go
    s_memtime s[52:53]
    s_cmp_ge_u32 s52, s34
    s_cbranch_scc1 main_kernel_cs_t_go
    s_memtime s[52:53]
    s_cmp_ge_u32 s52, s34
    s_cbranch_scc1 main_kernel_cs_t_go
    s_memtime s[52:53]
    s_cmp_ge_u32 s52, s34
    s_cbranch_scc1 main_kernel_cs_t_go
    s_memtime s[52:53]
    s_cmp_ge_u32 s52, s34
    s_cbranch_scc1 main_kernel_cs_t_go
    s_memtime s[52:53]
    s_cmp_ge_u32 s52, s34
    s_cbranch_scc1 main_kernel_cs_t_go
    s_sub_u32 s35, s35, 1
    s_cbranch_scc0 main_kernel_cs_t_s
    s_branch main_kernel_cs_t_go
main_kernel_cs_t_p:
    s_waitcnt lgkmcnt(0)
    s_xor_b32 s32, s9, s22
    s_bitcmp1_b32 s32, 0
    s_cbranch_scc0 main_kernel_cs_t_ok
    s_buffer_load_dword s9, s[4:7], s56 glc
    s_sub_u32 s29, s29, 1
    s_cbranch_scc1 main_kernel_end
    s_branch main_kernel_cs_t_p
main_kernel_cs_z0_f:
    buffer_load_dwordx2 v[126:127], v123, s[4:7], s19 offen offset:0 sc1
    s_sub_u32 s29, s29, 1
    s_cbranch_scc1 main_kernel_end
    s_waitcnt vmcnt(0)
    s_branch main_kernel_cs_z0
main_kernel_cs_z2_f:
    buffer_load_dwordx2 v[64:65], v123, s[4:7], s19 offen offset:512 sc1
    s_sub_u32 s29, s29, 1
    s_cbranch_scc1 main_kernel_end
    s_waitcnt vmcnt(0)
main_kernel_cs_z1_f:
    s_waitcnt vmcnt(0)
    s_memtime s[52:53]
    v_dot2_f32_bf16 v44, v64, s37, v68
    v_dot2_f32_bf16 v45, v64, s57, v69
    v_dot2_f32_bf16 v46, v65, s37, v70
    v_dot2_f32_bf16 v47, v65, s57, v71
    v_bitop3_b32 v60, v64, s22, 1 bitop3:0x28
    v_cvt_pk_bf16_f32 v44, v44, v45
    v_cmp_ne_u32 vcc, 0, v60
    v_cvt_pk_bf16_f32 v45, v46, v47
    ds_write_b64 v124, v[44:45] offset:512
    s_cbranch_vccnz main_kernel_cs_z2_f
    s_branch main_kernel_cs_z_ok
main_kernel_cs_kvw:
    s_cmp_eq_u32 s17, 64
    s_cbranch_scc1 main_kernel_cs_kvok
    s_waitcnt vmcnt(0)
    s_mov_b32 exec_lo, 0
    s_mov_b32 exec_hi, 0x3f00
    v_subrev_u32 v127, 0, v121
main_kernel_cs_kvp:
    buffer_load_dword v126, v127, s[4:7], 0 offen sc1
    s_waitcnt vmcnt(0)
    v_cmp_eq_u32 vcc, 0, v126
    s_cbranch_vccz main_kernel_cs_kvp_ok
    s_sleep 2
    s_sub_u32 s29, s29, 1
    s_cbranch_scc0 main_kernel_cs_kvp
    s_branch main_kernel_end
main_kernel_cs_kvp_ok:
    s_mov_b64 exec, -1
    s_branch main_kernel_cs_kvok
main_kernel_cs_last:
    buffer_load_dwordx2 v[86:87], v123, s[4:7], s19 offen offset:1024 sc1
    s_sub_u32 s29, s29, 1
    s_cbranch_scc1 main_kernel_end
    s_waitcnt vmcnt(0) lgkmcnt(0)
    v_bitop3_b32 v44, v86, s22, 1 bitop3:0x28
    v_cmp_ne_u32 vcc, 0, v44
    s_cbranch_vccnz main_kernel_cs_last
    v_swap_b32 v85, v86
    s_cmp_eq_u32 s12, 0
    v_add_u32 v56, s59, v115
    s_cbranch_scc0 main_kernel_cs_vmc
    ds_read_b64_tr_b16 v[80:81], v56 offset:16384
    ds_read_b64_tr_b16 v[82:83], v56 offset:17408
    s_waitcnt lgkmcnt(0)
    buffer_store_dwordx4 v[80:83], v125, s[4:7], s26 offen sc1
    s_branch main_kernel_cs_kvc
main_kernel_cs_vmc:
    v_mfma_f32_16x16x32_bf16 v[56:59], v[102:105], v[84:87], 0
    s_nop 7
    v_cvt_pk_bf16_f32 v80, v56, v57
    v_cvt_pk_bf16_f32 v81, v58, v59
    buffer_store_dwordx2 v[80:81], v123, s[4:7], s26 offen sc1
main_kernel_cs_kvc:
    s_add_u32 s26, s26, 0x10000
    s_branch main_kernel_end
main_kernel_cs_m_f:
main_kernel_cs_m_t:
    ds_read_b128 v[0:3], v116 offset:0
    ds_read_b128 v[4:7], v116 offset:1024
    ds_read_b128 v[8:11], v116 offset:2048
    ds_read_b128 v[12:15], v116 offset:3072
    ds_read_b128 v[16:19], v116 offset:4096
    ds_read_b128 v[20:23], v116 offset:5120
    ds_read_b128 v[24:27], v116 offset:6144
    ds_read_b128 v[28:31], v116 offset:7168
    s_waitcnt lgkmcnt(0)
    v_max_u32 v126, v0, v2
    v_max3_u32 v126, v126, v4, v6
    v_max3_u32 v126, v126, v8, v10
    v_max3_u32 v126, v126, v12, v14
    v_max3_u32 v126, v126, v16, v18
    v_max3_u32 v126, v126, v20, v22
    v_max3_u32 v126, v126, v24, v26
    v_max3_u32 v126, v126, v28, v30
    v_cmp_eq_u32 vcc, -1, v126
    s_cbranch_vccz main_kernel_cs_m_g
    s_barrier
    s_lshl_b32 s32, s14, 11
    s_add_u32 m0, s32, 0
    s_add_u32 s32, s32, s25
    buffer_load_dwordx4 v116, s[4:7], s32 offen offset:0 sc1 lds
    buffer_load_dwordx4 v116, s[4:7], s32 offen offset:1024 sc1 lds
    s_sub_u32 s29, s29, 1
    s_cbranch_scc1 main_kernel_end
    s_waitcnt vmcnt(0)
    s_barrier
    s_branch main_kernel_cs_m_t
main_kernel_cs_m_g:
    s_mov_b64 s[44:45], 0
    v_mov_b32 v64, 0
    v_mov_b32 v65, 0
    v_mov_b32 v66, 0
    v_mov_b32 v67, 0
    v_mov_b32 v68, 0
    v_mov_b32 v69, 0
    v_mov_b32 v70, 0
    v_mov_b32 v71, 0
    v_mov_b32 v96, 0
    v_mov_b32 v97, 0
    v_mov_b32 v98, 0
    v_mov_b32 v99, 0
    s_branch main_kernel_cs_mrd
main_kernel_cs_v_f:
    v_swap_b32 v85, v86
    s_nop 7
    s_waitcnt vmcnt(1)
main_kernel_cs_v_t:
    s_memtime s[52:53]
    v_bitop3_b32 v44, v126, s22, 1 bitop3:0x28
    v_cmp_ne_u32 vcc, 0, v44
    s_sub_u32 s29, s29, 1
    s_cbranch_scc1 main_kernel_end
    s_cbranch_vccnz main_kernel_cs_v_g
    v_mfma_f32_16x16x32_bf16 v[64:67], v[88:91], v[32:35], 0
    v_mfma_f32_16x16x32_bf16 v[68:71], v[92:95], v[32:35], 0
    v_mov_b32 v86, v126
    v_mov_b32 v87, v127
    s_waitcnt lgkmcnt(0)
    s_sub_u32 s32, s52, s38
    s_add_u32 s32, s32, -550
    v_mov_b32 v46, s32
    buffer_store_dword v46, v117, s[4:7], s46 offen sc1
    s_branch main_kernel_cs_v_ok
main_kernel_cs_v_g:
    buffer_load_dwordx2 v[126:127], v123, s[4:7], s19 offen offset:1024 sc1
    s_waitcnt lgkmcnt(0)
    s_sub_u32 s32, s52, s38
    s_add_u32 s32, s32, -50
    v_mov_b32 v46, s32
    buffer_store_dword v46, v117, s[4:7], s46 offen sc1
    s_waitcnt vmcnt(0)
    s_branch main_kernel_cs_v_t
main_kernel_cs_d_f:
    s_memtime s[52:53]
    s_waitcnt vmcnt(1) lgkmcnt(0)
    s_sub_u32 s32, s52, s38
    s_add_u32 s32, s32, 300
    v_mov_b32 v46, s32
    buffer_store_dword v46, v117, s[4:7], s46 offen sc1
    ds_read_b128 v[0:3], v112 offset:0
    ds_read_b128 v[4:7], v112 offset:1024
    ds_read_b128 v[8:11], v112 offset:2048
    ds_read_b128 v[12:15], v112 offset:3072
    ds_read_b128 v[16:19], v112 offset:4096
    ds_read_b128 v[20:23], v112 offset:5120
    ds_read_b128 v[24:27], v112 offset:6144
    ds_read_b128 v[28:31], v112 offset:7168
    s_waitcnt lgkmcnt(0)
    v_mfma_f32_16x16x32_bf16 v[32:35], v[0:3], v[48:51], 0
    v_mfma_f32_16x16x32_bf16 v[36:39], v[16:19], v[48:51], 0
    v_mfma_f32_16x16x32_bf16 v[72:75], v[48:51], v[48:51], 0
    v_mfma_f32_16x16x32_bf16 v[32:35], v[4:7], v[52:55], v[32:35]
    v_mfma_f32_16x16x32_bf16 v[36:39], v[20:23], v[52:55], v[36:39]
    v_mfma_f32_16x16x32_bf16 v[72:75], v[52:55], v[52:55], v[72:75]
    v_mfma_f32_16x16x32_bf16 v[32:35], v[8:11], v[56:59], v[32:35]
    v_mfma_f32_16x16x32_bf16 v[36:39], v[24:27], v[56:59], v[36:39]
    v_mfma_f32_16x16x32_bf16 v[72:75], v[56:59], v[56:59], v[72:75]
    v_mfma_f32_16x16x32_bf16 v[32:35], v[12:15], v[60:63], v[32:35]
    v_mfma_f32_16x16x32_bf16 v[36:39], v[28:31], v[60:63], v[36:39]
    v_mfma_f32_16x16x32_bf16 v[72:75], v[60:63], v[60:63], v[72:75]
    s_nop 7
    ds_read_b128 v[0:3], v113 offset:16384
    ds_read_b128 v[16:19], v113 offset:18432
    ds_read_b128 v[4:7], v113 offset:17408
    ds_read_b128 v[20:23], v113 offset:19456
    ds_read_b128 v[8:11], v113 offset:24576
    ds_read_b128 v[24:27], v113 offset:26624
    ds_read_b128 v[12:15], v113 offset:25600
    ds_read_b128 v[28:31], v113 offset:27648
    v_permlane32_swap_b32 v72, v73
    v_permlane32_swap_b32 v74, v75
    v_mul_f32 v73, s30, v73
    v_mul_f32 v75, s30, v75
    v_max_f32 v126, v73, v75
    v_max3_f32 v126, v126, v32, v33
    v_max3_f32 v126, v126, v34, v35
    v_max3_f32 v126, v126, v36, v37
    v_max3_f32 v126, v126, v38, v39
    v_mov_b32 v127, v126
    s_nop 1
    v_permlane32_swap_b32 v126, v127
    v_max_f32 v126, v126, v127
    v_mov_b32 v127, v126
    s_nop 1
    v_permlane16_swap_b32 v126, v127
    v_max_f32 v126, v126, v127
    v_sub_f32 v32, v32, v126
    v_sub_f32 v33, v33, v126
    v_sub_f32 v34, v34, v126
    v_sub_f32 v35, v35, v126
    v_sub_f32 v36, v36, v126
    v_sub_f32 v37, v37, v126
    v_sub_f32 v38, v38, v126
    v_sub_f32 v39, v39, v126
    v_sub_f32 v73, v73, v126
    v_sub_f32 v75, v75, v126
    v_exp_f32 v32, v32
    v_exp_f32 v33, v33
    v_exp_f32 v34, v34
    v_exp_f32 v35, v35
    v_exp_f32 v36, v36
    v_exp_f32 v37, v37
    v_exp_f32 v38, v38
    v_exp_f32 v39, v39
    v_exp_f32 v73, v73
    v_exp_f32 v75, v75
    v_cvt_pk_bf16_f32 v32, v32, v33
    v_cvt_pk_bf16_f32 v33, v34, v35
    v_cvt_pk_bf16_f32 v34, v36, v37
    v_cvt_pk_bf16_f32 v35, v38, v39
    v_cvt_pk_bf16_f32 v72, v73, v75
    v_cvt_pk_bf16_f32 v73, v73, v75
    s_nop 1
    v_mfma_f32_16x16x32_bf16 v[64:67], v[88:91], v[32:35], 0
    v_mfma_f32_16x16x32_bf16 v[68:71], v[92:95], v[32:35], 0
    v_mfma_f32_16x16x32_bf16 v[40:43], v[96:99], v[32:35], 0
    v_mfma_f32_16x16x16_bf16 v[40:43], v[100:101], v[72:73], v[40:43]
    s_mov_b64 s[44:45], 0
    s_mov_b64 vcc, 0
    s_nop 7
    s_branch main_kernel_cs_d_ok
main_kernel_cs_fsp:
    s_mov_b32 s35, 40
main_kernel_cs_fsl:
    buffer_load_dword v111, v90, s[4:7], s47 offen sc1
    s_waitcnt vmcnt(1)
    v_subrev_u32 v32, s20, v111
    v_cmp_lt_u32 vcc, 0x100000, v32
    s_cbranch_vccz main_kernel_cs_rgo
    s_sub_u32 s35, s35, 1
    s_cbranch_scc0 main_kernel_cs_fsl
    v_mov_b32 v32, 0
    s_branch main_kernel_cs_fok
main_kernel_cs_r_f:
    s_memtime s[52:53]
    buffer_load_dword v111, v90, s[4:7], s47 offen sc1
    s_waitcnt lgkmcnt(0)
    s_sub_u32 s15, s52, s16
    s_add_u32 s15, s15, -1500
    s_waitcnt vmcnt(0)
    s_sub_u32 s29, s29, 1
    s_cbranch_scc1 main_kernel_end
    s_branch main_kernel_cs_rgo
main_kernel_att:
    s_cmp_gt_u32 s13, 1
    s_cbranch_scc1 main_kernel_p_end
    s_cmp_lg_u32 s14, 0
    s_cbranch_scc1 main_kernel_p_bar
    s_lshl_b32 s32, s13, 21
    s_add_u32 s32, s32, 0x8c00000
    v_lshlrev_b32 v2, 2, v250
    v_mov_b32 v3, -1
    s_mov_b64 s[20:21], -1
    s_mov_b32 s34, 12
    s_mov_b32 exec_hi, 0
    s_waitcnt vmcnt(0)
main_kernel_p_lp:
    s_memtime s[16:17]
    s_waitcnt lgkmcnt(0)
    buffer_store_dword v3, v2, s[4:7], s32 offen sc1
    s_waitcnt vmcnt(0)
    s_memtime s[18:19]
    s_xor_b32 s32, s32, 0x2000
    s_waitcnt lgkmcnt(0)
    s_sub_u32 s33, s18, s16
    s_min_u32 s20, s20, s33
    s_memtime s[16:17]
    s_waitcnt lgkmcnt(0)
    buffer_store_dword v3, v2, s[4:7], s32 offen sc1
    s_waitcnt vmcnt(0)
    s_memtime s[18:19]
    s_xor_b32 s32, s32, 0x2000
    s_waitcnt lgkmcnt(0)
    s_sub_u32 s33, s18, s16
    s_min_u32 s21, s21, s33
    s_add_u32 s32, s32, 128
    s_sub_u32 s34, s34, 1
    s_cmp_lg_u32 s34, 0
    s_cbranch_scc1 main_kernel_p_lp
    s_cmp_lt_u32 s21, s20
    s_cselect_b32 s32, 3, 2
    s_lshl_b32 s33, s13, 2
    v_mov_b32 v3, s32
    s_mov_b64 exec, 1
    buffer_store_dword v3, off, s[60:63], s33 offset:16 sc1
    s_mov_b64 exec, -1
main_kernel_p_bar:
    s_barrier
main_kernel_p_end:
    v_lshlrev_b32 v0, 2, v250
    s_mov_b32 s32, 0x841f000
main_kernel_awf:
    buffer_load_dword v2, v0, s[4:7], s32 offen sc1
    s_waitcnt vmcnt(0)
    v_cmp_eq_u32 vcc, 0, v2
    s_cbranch_vccz main_kernel_awf_ok
    s_sleep 4
    s_sub_u32 s29, s29, 1
    s_cbranch_scc0 main_kernel_awf
    s_branch main_kernel_end
main_kernel_awf_ok:
main_kernel_att2:
    s_lshl_b32 s28, s13, 1
    s_lshr_b32 s31, s14, 1
    s_add_u32 s28, s28, s31
    s_and_b32 s30, s14, 1
    v_lshlrev_b32 v204, 4, v250
    v_and_b32 v200, 15, v250
    v_lshrrev_b32 v201, 4, v250
    v_and_b32 v202, 7, v250
    v_lshl_add_u32 v202, v201, 3, v202
    v_lshlrev_b32 v205, 4, v202
    v_bfe_u32 v206, v204, 1, 8
    v_min_u32 v207, 2, v250
    v_lshlrev_b32 v207, 13, v207
    s_lshl_b32 s31, s28, 8
    s_sub_u32 s31, 80912, s31
    s_cmp_eq_u32 s12, 7
    s_cselect_b32 s25, 61, 0
    s_cselect_b32 s32, 16, 0
    s_sub_u32 s31, s31, s32
    s_mov_b64 exec, 0xf0
    v_lshl_add_u32 v207, v250, 8, s31
    s_mov_b64 exec, -1
    v_mov_b32 v208, 1
    v_mov_b32 v209, 0
    s_lshl_b32 s31, s30, 4
    v_add_u32 v200, s31, v200
    v_lshlrev_b32 v202, 2, v201
    v_sub_u32 v200, v200, v202
    v_mov_b32 v202, 0xf149f2ca
    v_cmp_le_i32 vcc, 0, v200
    s_nop 1
    v_cndmask_b32 v124, v202, 0, vcc
    v_cmp_le_i32 vcc, 1, v200
    s_nop 1
    v_cndmask_b32 v125, v202, 0, vcc
    v_cmp_le_i32 vcc, 2, v200
    s_nop 1
    v_cndmask_b32 v126, v202, 0, vcc
    v_cmp_le_i32 vcc, 3, v200
    s_nop 1
    v_cndmask_b32 v127, v202, 0, vcc
    v_cmp_le_i32 vcc, 16, v200
    s_nop 1
    v_cndmask_b32 v128, v202, 0, vcc
    v_cmp_le_i32 vcc, 17, v200
    s_nop 1
    v_cndmask_b32 v129, v202, 0, vcc
    v_cmp_le_i32 vcc, 18, v200
    s_nop 1
    v_cndmask_b32 v130, v202, 0, vcc
    v_cmp_le_i32 vcc, 19, v200
    s_nop 1
    v_cndmask_b32 v131, v202, 0, vcc
    v_cmp_le_u32 vcc, 2, v201
    s_nop 1
    v_cndmask_b32 v132, v202, 0, vcc
    v_mov_b32 v180, 0x3f803f80
    v_cndmask_b32 v133, v202, 0, vcc
    v_mov_b32 v181, 0x3f803f80
    v_cndmask_b32 v134, v202, 0, vcc
    v_mov_b32 v182, 0x3f803f80
    v_cndmask_b32 v135, v202, 0, vcc
    v_mov_b32 v183, 0x3f803f80
    s_mov_b32 s26, 0x3e0293ee
    s_mov_b32 s27, 0xbe0293ee
    s_lshl_b32 s31, s28, 12
    s_add_u32 s16, s31, 0x1800000
    s_add_u32 s17, s16, 131072
    s_lshl_b32 s32, s30, 17
    s_add_u32 s31, s31, s32
    s_add_u32 s15, s31, 0x800000
    s_add_u32 s22, s31, 0x3800000
    s_lshl_b32 s31, s28, 13
    s_add_u32 s18, s31, 0x2800000
    s_add_u32 s19, s18, 4096
    s_lshl_b32 s31, s28, 11
    s_add_u32 s20, s31, 0x8000000
    s_add_u32 s21, s31, 0x6e00000
    s_lshl_b32 s31, s28, 8
    s_add_u32 s23, s31, 0x8404000
    s_lshl_b32 s31, s28, 3
    s_lshl_b32 s32, s30, 2
    s_add_u32 s31, s31, s32
    s_add_u32 s24, s31, 0x8400000
    v_and_b32 v210, 1, v250
    v_lshlrev_b32 v210, 2, v210
    s_mov_b32 s33, 0x841ec00
    s_lshl_b32 s31, s25, 18
    s_add_u32 s15, s15, s31
    s_add_u32 s16, s16, s31
    s_add_u32 s17, s17, s31
    s_add_u32 s18, s18, s31
    s_add_u32 s19, s19, s31
    s_add_u32 s22, s22, s31
    s_lshl_b32 s31, s25, 16
    s_add_u32 s20, s20, s31
    s_add_u32 s21, s21, s31
    s_lshl_b32 s31, s25, 8
    s_add_u32 s24, s24, s31
    s_lshl_b32 s31, s25, 2
    s_add_u32 s23, s23, s31
    s_add_u32 s33, s33, s31
    s_cmp_eq_u32 s25, 0
    s_cbranch_scc1 main_kernel_a_fp
    s_sub_u32 s32, s24, 1280
main_kernel_a_gp:
    buffer_load_dword v200, v209, s[4:7], s32 offen sc1
    s_waitcnt vmcnt(0)
    v_cmp_eq_u32 vcc, 0, v200
    s_and_b32 s31, vcc_lo, 1
    s_cbranch_scc0 main_kernel_a_fp
    s_sleep 32
    s_sub_u32 s29, s29, 1
    s_cbranch_scc0 main_kernel_a_gp
    s_branch main_kernel_end
main_kernel_a_fp:
    buffer_load_dword v200, v207, s[4:7], s23 offen sc1
    s_waitcnt vmcnt(0)
    v_cmp_eq_u32 vcc, 0, v200
    s_and_b32 s31, vcc_lo, -1
    s_cbranch_scc0 main_kernel_a_fok
    s_sleep 8
    s_sub_u32 s29, s29, 1
    s_cbranch_scc0 main_kernel_a_fp
    s_branch main_kernel_end
main_kernel_a_fok:
    buffer_load_dwordx4 v[0:3], v204, s[4:7], s15 offen offset:0 sc1
    buffer_load_dwordx4 v[16:19], v204, s[4:7], s16 offen offset:0 sc1
    buffer_load_dwordx4 v[32:35], v204, s[4:7], s17 offen offset:0 sc1
    buffer_load_dwordx4 v[4:7], v204, s[4:7], s15 offen offset:1024 sc1
    buffer_load_dwordx4 v[20:23], v204, s[4:7], s16 offen offset:1024 sc1
    buffer_load_dwordx4 v[36:39], v204, s[4:7], s17 offen offset:1024 sc1
    buffer_load_dwordx4 v[8:11], v204, s[4:7], s15 offen offset:2048 sc1
    buffer_load_dwordx4 v[24:27], v204, s[4:7], s16 offen offset:2048 sc1
    buffer_load_dwordx4 v[40:43], v204, s[4:7], s17 offen offset:2048 sc1
    buffer_load_dwordx4 v[12:15], v204, s[4:7], s15 offen offset:3072 sc1
    buffer_load_dwordx4 v[28:31], v204, s[4:7], s16 offen offset:3072 sc1
    buffer_load_dwordx4 v[44:47], v204, s[4:7], s17 offen offset:3072 sc1
    buffer_load_dword v211, v210, s[4:7], s33 offen sc1
    buffer_load_dwordx4 v[48:51], v204, s[4:7], s18 offen offset:0 sc1
    buffer_load_dwordx4 v[52:55], v204, s[4:7], s18 offen offset:1024 sc1
    buffer_load_dwordx4 v[56:59], v204, s[4:7], s18 offen offset:2048 sc1
    buffer_load_dwordx4 v[60:63], v204, s[4:7], s18 offen offset:3072 sc1
    buffer_load_dwordx4 v[64:67], v204, s[4:7], s19 offen offset:0 sc1
    buffer_load_dwordx4 v[68:71], v204, s[4:7], s19 offen offset:1024 sc1
    buffer_load_dwordx4 v[72:75], v204, s[4:7], s19 offen offset:2048 sc1
    buffer_load_dwordx4 v[76:79], v204, s[4:7], s19 offen offset:3072 sc1
    s_waitcnt vmcnt(0)
main_kernel_a_top:
    s_cmp_ge_u32 s25, 60
    s_cselect_b32 s38, 2, 1
    s_lshl_b32 s34, s38, 18
    s_lshl_b32 s35, s38, 16
    s_lshl_b32 s36, s38, 8
    s_lshl_b32 s37, s38, 2
    s_waitcnt vmcnt(19)
    v_mfma_f32_16x16x32_bf16 v[112:115], v[16:19], v[0:3], v[124:127]
    v_mfma_f32_16x16x32_bf16 v[116:119], v[32:35], v[0:3], v[128:131]
    s_waitcnt vmcnt(16)
    v_mfma_f32_16x16x32_bf16 v[112:115], v[20:23], v[4:7], v[112:115]
    v_mfma_f32_16x16x32_bf16 v[116:119], v[36:39], v[4:7], v[116:119]
    s_waitcnt vmcnt(13)
    v_mfma_f32_16x16x32_bf16 v[112:115], v[24:27], v[8:11], v[112:115]
    v_mfma_f32_16x16x32_bf16 v[116:119], v[40:43], v[8:11], v[116:119]
    s_waitcnt vmcnt(10)
    v_mfma_f32_16x16x32_bf16 v[112:115], v[28:31], v[12:15], v[112:115]
    v_mfma_f32_16x16x32_bf16 v[116:119], v[44:47], v[12:15], v[116:119]
    s_add_u32 s15, s15, s34
    s_add_u32 s16, s16, s34
    s_add_u32 s17, s17, s34
    s_add_u32 s18, s18, s34
    s_add_u32 s19, s19, s34
    s_add_u32 s23, s23, s37
    s_waitcnt vmcnt(9)
    v_cmp_eq_u32 vcc, 0, v211
    s_nop 0
    v_max3_f32 v202, v112, v113, v114
    s_nop 1
    v_max3_f32 v202, v202, v115, v116
    v_max3_f32 v202, v202, v117, v118
    v_max_f32 v202, v202, v119
    s_cmp_ge_u32 s25, 56
    s_cselect_b32 s32, 1, 2
    s_and_b32 s31, vcc_lo, s32
    s_cbranch_scc0 main_kernel_a_mp
main_kernel_a_pp:
    buffer_load_dword v200, v210, s[4:7], s33 offen sc1
    s_waitcnt vmcnt(0)
    v_cmp_eq_u32 vcc, 0, v200
    s_and_b32 s31, vcc_lo, s32
    s_cbranch_scc0 main_kernel_a_pok
    s_sleep 2
    s_sub_u32 s29, s29, 1
    s_cbranch_scc0 main_kernel_a_pp
    s_branch main_kernel_end
main_kernel_a_pok:
    s_cmp_eq_u32 s32, 2
    s_cbranch_scc1 main_kernel_a_mp
    s_sleep 2
    s_cmp_eq_u32 s25, 63
    s_cbranch_scc1 main_kernel_a_mp
    s_sleep 40
main_kernel_a_mp:
    buffer_load_dwordx4 v[80:83], v205, s[4:7], s20 offen offset:0 sc1
    buffer_load_dwordx4 v[84:87], v205, s[4:7], s20 offen offset:512 sc1
    buffer_load_dwordx4 v[88:91], v205, s[4:7], s20 offen offset:1024 sc1
    buffer_load_dwordx4 v[92:95], v205, s[4:7], s20 offen offset:1536 sc1
    buffer_load_dwordx2 v[96:97], v206, s[4:7], s21 offen offset:0 sc1
    buffer_load_dwordx2 v[98:99], v206, s[4:7], s21 offen offset:256 sc1
    buffer_load_dwordx2 v[100:101], v206, s[4:7], s21 offen offset:512 sc1
    buffer_load_dwordx2 v[102:103], v206, s[4:7], s21 offen offset:768 sc1
    buffer_load_dwordx2 v[104:105], v206, s[4:7], s21 offen offset:1024 sc1
    buffer_load_dwordx2 v[106:107], v206, s[4:7], s21 offen offset:1280 sc1
    buffer_load_dwordx2 v[108:109], v206, s[4:7], s21 offen offset:1536 sc1
    buffer_load_dwordx2 v[110:111], v206, s[4:7], s21 offen offset:1792 sc1
    buffer_load_dword v211, v207, s[4:7], s23 offen sc1
    s_waitcnt vmcnt(12)
    v_mfma_f32_16x16x32_bf16 v[120:123], v[80:83], v[0:3], v[132:135]
    v_max3_u32 v200, v80, v81, v82
    v_max_u32 v200, v200, v83
    s_waitcnt vmcnt(11)
    v_mfma_f32_16x16x32_bf16 v[120:123], v[84:87], v[4:7], v[120:123]
    v_max3_u32 v200, v200, v84, v85
    v_max3_u32 v200, v200, v86, v87
    s_waitcnt vmcnt(10)
    v_mfma_f32_16x16x32_bf16 v[120:123], v[88:91], v[8:11], v[120:123]
    v_max3_u32 v200, v200, v88, v89
    v_max3_u32 v200, v200, v90, v91
    s_waitcnt vmcnt(9)
    v_mfma_f32_16x16x32_bf16 v[120:123], v[92:95], v[12:15], v[120:123]
    v_max3_u32 v200, v200, v92, v93
    v_max3_u32 v200, v200, v94, v95
    s_waitcnt vmcnt(7)
    v_max3_u32 v200, v200, v96, v97
    v_max3_u32 v200, v200, v98, v99
    s_waitcnt vmcnt(5)
    v_max3_u32 v200, v200, v100, v101
    v_max3_u32 v200, v200, v102, v103
    s_waitcnt vmcnt(3)
    v_max3_u32 v200, v200, v104, v105
    v_max3_u32 v200, v200, v106, v107
    s_waitcnt vmcnt(1)
    v_max3_u32 v200, v200, v108, v109
    v_max3_u32 v200, v200, v110, v111
    v_cmp_eq_u32 vcc, -1, v200
    s_cbranch_vccz main_kernel_a_mok
    s_sleep 1
    s_sub_u32 s29, s29, 1
    s_cbranch_scc0 main_kernel_a_mp
    s_branch main_kernel_end
main_kernel_a_mok:
    v_mul_f32 v120, s26, v120
    v_mul_f32 v121, s26, v121
    v_mul_f32 v122, s26, v122
    v_mul_f32 v123, s26, v123
    v_max3_f32 v200, v202, v120, v121
    v_max3_f32 v200, v200, v122, v123
    v_mov_b32 v201, v200
    s_add_u32 s20, s20, s35
    s_add_u32 s21, s21, s35
    v_permlane32_swap_b32 v200, v201
    v_max_f32 v200, v200, v201
    v_mov_b32 v201, v200
    s_nop 1
    v_permlane16_swap_b32 v200, v201
    v_max_f32 v200, v200, v201
    v_sub_f32 v112, v112, v200
    v_sub_f32 v113, v113, v200
    v_sub_f32 v114, v114, v200
    v_sub_f32 v115, v115, v200
    v_sub_f32 v116, v116, v200
    v_sub_f32 v117, v117, v200
    v_sub_f32 v118, v118, v200
    v_sub_f32 v119, v119, v200
    v_sub_f32 v120, v120, v200
    v_sub_f32 v121, v121, v200
    v_sub_f32 v122, v122, v200
    v_sub_f32 v123, v123, v200
    v_exp_f32 v112, v112
    v_exp_f32 v113, v113
    v_exp_f32 v114, v114
    v_cvt_pk_bf16_f32 v136, v112, v113
    v_exp_f32 v115, v115
    v_exp_f32 v116, v116
    v_cvt_pk_bf16_f32 v137, v114, v115
    v_exp_f32 v117, v117
    v_exp_f32 v118, v118
    v_cvt_pk_bf16_f32 v138, v116, v117
    v_exp_f32 v119, v119
    v_exp_f32 v120, v120
    v_cvt_pk_bf16_f32 v139, v118, v119
    v_exp_f32 v121, v121
    v_exp_f32 v122, v122
    v_cvt_pk_bf16_f32 v140, v120, v121
    v_exp_f32 v123, v123
    s_nop 0
    v_cvt_pk_bf16_f32 v141, v122, v123
    v_mfma_f32_16x16x32_bf16 v[144:147], v[180:183], v[136:139], 0
    v_mfma_f32_16x16x32_bf16 v[148:151], v[48:51], v[136:139], 0
    v_mfma_f32_16x16x16_bf16 v[144:147], v[180:181], v[140:141], v[144:147]
    v_mfma_f32_16x16x32_bf16 v[152:155], v[52:55], v[136:139], 0
    v_mfma_f32_16x16x32_bf16 v[156:159], v[56:59], v[136:139], 0
    v_mfma_f32_16x16x32_bf16 v[160:163], v[60:63], v[136:139], 0
    v_mfma_f32_16x16x32_bf16 v[164:167], v[64:67], v[136:139], 0
    v_mfma_f32_16x16x32_bf16 v[168:171], v[68:71], v[136:139], 0
    v_mfma_f32_16x16x32_bf16 v[172:175], v[72:75], v[136:139], 0
    v_mfma_f32_16x16x32_bf16 v[176:179], v[76:79], v[136:139], 0
    v_rcp_f32 v200, v144
    v_mfma_f32_16x16x16_bf16 v[148:151], v[96:97], v[140:141], v[148:151]
    v_mfma_f32_16x16x16_bf16 v[152:155], v[98:99], v[140:141], v[152:155]
    v_mfma_f32_16x16x16_bf16 v[156:159], v[100:101], v[140:141], v[156:159]
    v_mfma_f32_16x16x16_bf16 v[160:163], v[102:103], v[140:141], v[160:163]
    v_mfma_f32_16x16x16_bf16 v[164:167], v[104:105], v[140:141], v[164:167]
    v_mfma_f32_16x16x16_bf16 v[168:171], v[106:107], v[140:141], v[168:171]
    v_mfma_f32_16x16x16_bf16 v[172:175], v[108:109], v[140:141], v[172:175]
    v_mfma_f32_16x16x16_bf16 v[176:179], v[110:111], v[140:141], v[176:179]
    v_mov_b32 v201, v200
    s_waitcnt vmcnt(0)
    v_cmp_eq_u32 vcc, 0, v211
    v_pk_mul_f32 v[148:149], v[148:149], v[200:201]
    v_pk_mul_f32 v[150:151], v[150:151], v[200:201]
    v_pk_mul_f32 v[152:153], v[152:153], v[200:201]
    v_pk_mul_f32 v[154:155], v[154:155], v[200:201]
    v_cvt_pk_bf16_f32 v184, v148, v149
    v_cvt_pk_bf16_f32 v185, v150, v151
    v_cvt_pk_bf16_f32 v186, v152, v153
    v_cvt_pk_bf16_f32 v187, v154, v155
    buffer_store_dwordx4 v[184:187], v204, s[4:7], s22 offen offset:0 sc1
    v_pk_mul_f32 v[156:157], v[156:157], v[200:201]
    v_pk_mul_f32 v[158:159], v[158:159], v[200:201]
    v_pk_mul_f32 v[160:161], v[160:161], v[200:201]
    v_pk_mul_f32 v[162:163], v[162:163], v[200:201]
    v_cvt_pk_bf16_f32 v188, v156, v157
    v_cvt_pk_bf16_f32 v189, v158, v159
    v_cvt_pk_bf16_f32 v190, v160, v161
    v_cvt_pk_bf16_f32 v191, v162, v163
    buffer_store_dwordx4 v[188:191], v204, s[4:7], s22 offen offset:1024 sc1
    v_pk_mul_f32 v[164:165], v[164:165], v[200:201]
    v_pk_mul_f32 v[166:167], v[166:167], v[200:201]
    v_pk_mul_f32 v[168:169], v[168:169], v[200:201]
    v_pk_mul_f32 v[170:171], v[170:171], v[200:201]
    v_cvt_pk_bf16_f32 v192, v164, v165
    v_cvt_pk_bf16_f32 v193, v166, v167
    v_cvt_pk_bf16_f32 v194, v168, v169
    v_cvt_pk_bf16_f32 v195, v170, v171
    buffer_store_dwordx4 v[192:195], v204, s[4:7], s22 offen offset:2048 sc1
    s_nop 0
    v_pk_mul_f32 v[172:173], v[172:173], v[200:201]
    v_pk_mul_f32 v[174:175], v[174:175], v[200:201]
    v_pk_mul_f32 v[176:177], v[176:177], v[200:201]
    v_pk_mul_f32 v[178:179], v[178:179], v[200:201]
    v_cvt_pk_bf16_f32 v196, v172, v173
    v_cvt_pk_bf16_f32 v197, v174, v175
    v_cvt_pk_bf16_f32 v198, v176, v177
    v_cvt_pk_bf16_f32 v199, v178, v179
    buffer_store_dwordx4 v[196:199], v204, s[4:7], s22 offen offset:3072 sc1
    s_add_u32 s22, s22, s34
    s_add_u32 s33, s33, s37
    s_add_u32 s25, s25, s38
    s_cmp_ge_u32 s25, 64
    s_cbranch_scc1 main_kernel_a_last
    s_cbranch_vccnz main_kernel_a_slow
    s_cmp_gt_u32 s25, 60
    s_cbranch_scc1 main_kernel_a_slow
    buffer_load_dwordx4 v[0:3], v204, s[4:7], s15 offen offset:0 sc1
    buffer_load_dwordx4 v[16:19], v204, s[4:7], s16 offen offset:0 sc1
    buffer_load_dwordx4 v[32:35], v204, s[4:7], s17 offen offset:0 sc1
    buffer_load_dwordx4 v[4:7], v204, s[4:7], s15 offen offset:1024 sc1
    buffer_load_dwordx4 v[20:23], v204, s[4:7], s16 offen offset:1024 sc1
    buffer_load_dwordx4 v[36:39], v204, s[4:7], s17 offen offset:1024 sc1
    buffer_load_dwordx4 v[8:11], v204, s[4:7], s15 offen offset:2048 sc1
    buffer_load_dwordx4 v[24:27], v204, s[4:7], s16 offen offset:2048 sc1
    buffer_load_dwordx4 v[40:43], v204, s[4:7], s17 offen offset:2048 sc1
    buffer_load_dwordx4 v[12:15], v204, s[4:7], s15 offen offset:3072 sc1
    buffer_load_dwordx4 v[28:31], v204, s[4:7], s16 offen offset:3072 sc1
    buffer_load_dwordx4 v[44:47], v204, s[4:7], s17 offen offset:3072 sc1
    buffer_load_dword v211, v210, s[4:7], s33 offen sc1
    buffer_load_dwordx4 v[48:51], v204, s[4:7], s18 offen offset:0 sc1
    buffer_load_dwordx4 v[52:55], v204, s[4:7], s18 offen offset:1024 sc1
    buffer_load_dwordx4 v[56:59], v204, s[4:7], s18 offen offset:2048 sc1
    buffer_load_dwordx4 v[60:63], v204, s[4:7], s18 offen offset:3072 sc1
    buffer_load_dwordx4 v[64:67], v204, s[4:7], s19 offen offset:0 sc1
    buffer_load_dwordx4 v[68:71], v204, s[4:7], s19 offen offset:1024 sc1
    buffer_load_dwordx4 v[72:75], v204, s[4:7], s19 offen offset:2048 sc1
    buffer_load_dwordx4 v[76:79], v204, s[4:7], s19 offen offset:3072 sc1
    s_waitcnt vmcnt(21)
    s_mov_b64 exec, 1
    buffer_store_dword v208, v209, s[4:7], s24 offen sc1
    s_mov_b64 exec, -1
    s_add_u32 s24, s24, s36
    s_branch main_kernel_a_top
main_kernel_a_slow:
    s_waitcnt vmcnt(0)
    s_mov_b64 exec, 1
    buffer_store_dword v208, v209, s[4:7], s24 offen sc1
    s_mov_b64 exec, -1
    s_add_u32 s24, s24, s36
    s_branch main_kernel_a_fp
main_kernel_a_last:
    s_waitcnt vmcnt(0)
    s_mov_b64 exec, 1
    buffer_store_dword v208, v209, s[4:7], s24 offen sc1
    s_mov_b64 exec, -1
    s_add_u32 s24, s24, s36
    s_branch main_kernel_end
main_kernel_wo:
    s_mov_b32 s8, s46
    s_and_b32 s9, s47, 0xffff
    s_mov_b32 s10, 0x800000
    s_mov_b32 s11, 0x20000
    v_lshlrev_b32 v170, 4, v250
    s_lshr_b32 s23, s12, 2
    s_sub_u32 s21, s12, 5
    s_cselect_b32 s23, s23, s21
    s_cselect_b32 s18, 48, 63
    v_lshrrev_b32 v178, 2, v250
    v_and_b32 v179, 3, v250
    v_lshlrev_b32 v0, 11, v178
    v_lshl_add_u32 v0, v179, 4, v0
    s_lshl_b32 s19, s14, 15
    v_lshl_add_u32 v1, v178, 6, s19
    v_lshl_add_u32 v1, v179, 3, v1
    s_lshl_b32 s20, s14, 21
    s_lshl_b32 s21, s13, 6
    s_add_u32 s20, s20, s21
    s_add_u32 s21, s20, 0x0
    s_add_u32 m0, s19, 0
    s_nop 0
    buffer_load_dwordx4 v0, s[8:11], s21 offen lds
    s_add_u32 s21, s20, 0x8000
    s_add_u32 m0, s19, 1024
    s_nop 0
    buffer_load_dwordx4 v0, s[8:11], s21 offen lds
    s_add_u32 s21, s20, 0x10000
    s_add_u32 m0, s19, 2048
    s_nop 0
    buffer_load_dwordx4 v0, s[8:11], s21 offen lds
    s_add_u32 s21, s20, 0x18000
    s_add_u32 m0, s19, 3072
    s_nop 0
    buffer_load_dwordx4 v0, s[8:11], s21 offen lds
    s_add_u32 s21, s20, 0x20000
    s_add_u32 m0, s19, 4096
    s_nop 0
    buffer_load_dwordx4 v0, s[8:11], s21 offen lds
    s_add_u32 s21, s20, 0x28000
    s_add_u32 m0, s19, 5120
    s_nop 0
    buffer_load_dwordx4 v0, s[8:11], s21 offen lds
    s_add_u32 s21, s20, 0x30000
    s_add_u32 m0, s19, 6144
    s_nop 0
    buffer_load_dwordx4 v0, s[8:11], s21 offen lds
    s_add_u32 s21, s20, 0x38000
    s_add_u32 m0, s19, 7168
    s_nop 0
    buffer_load_dwordx4 v0, s[8:11], s21 offen lds
    s_add_u32 s21, s20, 0x40000
    s_add_u32 m0, s19, 8192
    s_nop 0
    buffer_load_dwordx4 v0, s[8:11], s21 offen lds
    s_add_u32 s21, s20, 0x48000
    s_add_u32 m0, s19, 9216
    s_nop 0
    buffer_load_dwordx4 v0, s[8:11], s21 offen lds
    s_add_u32 s21, s20, 0x50000
    s_add_u32 m0, s19, 10240
    s_nop 0
    buffer_load_dwordx4 v0, s[8:11], s21 offen lds
    s_add_u32 s21, s20, 0x58000
    s_add_u32 m0, s19, 11264
    s_nop 0
    buffer_load_dwordx4 v0, s[8:11], s21 offen lds
    s_add_u32 s21, s20, 0x60000
    s_add_u32 m0, s19, 12288
    s_nop 0
    buffer_load_dwordx4 v0, s[8:11], s21 offen lds
    s_add_u32 s21, s20, 0x68000
    s_add_u32 m0, s19, 13312
    s_nop 0
    buffer_load_dwordx4 v0, s[8:11], s21 offen lds
    s_add_u32 s21, s20, 0x70000
    s_add_u32 m0, s19, 14336
    s_nop 0
    buffer_load_dwordx4 v0, s[8:11], s21 offen lds
    s_add_u32 s21, s20, 0x78000
    s_add_u32 m0, s19, 15360
    s_nop 0
    buffer_load_dwordx4 v0, s[8:11], s21 offen lds
    s_add_u32 s21, s20, 0x80000
    s_add_u32 m0, s19, 16384
    s_nop 0
    buffer_load_dwordx4 v0, s[8:11], s21 offen lds
    s_add_u32 s21, s20, 0x88000
    s_add_u32 m0, s19, 17408
    s_nop 0
    buffer_load_dwordx4 v0, s[8:11], s21 offen lds
    s_add_u32 s21, s20, 0x90000
    s_add_u32 m0, s19, 18432
    s_nop 0
    buffer_load_dwordx4 v0, s[8:11], s21 offen lds
    s_add_u32 s21, s20, 0x98000
    s_add_u32 m0, s19, 19456
    s_nop 0
    buffer_load_dwordx4 v0, s[8:11], s21 offen lds
    s_add_u32 s21, s20, 0xa0000
    s_add_u32 m0, s19, 20480
    s_nop 0
    buffer_load_dwordx4 v0, s[8:11], s21 offen lds
    s_add_u32 s21, s20, 0xa8000
    s_add_u32 m0, s19, 21504
    s_nop 0
    buffer_load_dwordx4 v0, s[8:11], s21 offen lds
    s_add_u32 s21, s20, 0xb0000
    s_add_u32 m0, s19, 22528
    s_nop 0
    buffer_load_dwordx4 v0, s[8:11], s21 offen lds
    s_add_u32 s21, s20, 0xb8000
    s_add_u32 m0, s19, 23552
    s_nop 0
    buffer_load_dwordx4 v0, s[8:11], s21 offen lds
    s_add_u32 s21, s20, 0xc0000
    s_add_u32 m0, s19, 24576
    s_nop 0
    buffer_load_dwordx4 v0, s[8:11], s21 offen lds
    s_add_u32 s21, s20, 0xc8000
    s_add_u32 m0, s19, 25600
    s_nop 0
    buffer_load_dwordx4 v0, s[8:11], s21 offen lds
    s_add_u32 s21, s20, 0xd0000
    s_add_u32 m0, s19, 26624
    s_nop 0
    buffer_load_dwordx4 v0, s[8:11], s21 offen lds
    s_add_u32 s21, s20, 0xd8000
    s_add_u32 m0, s19, 27648
    s_nop 0
    buffer_load_dwordx4 v0, s[8:11], s21 offen lds
    s_add_u32 s21, s20, 0xe0000
    s_add_u32 m0, s19, 28672
    s_nop 0
    buffer_load_dwordx4 v0, s[8:11], s21 offen lds
    s_add_u32 s21, s20, 0xe8000
    s_add_u32 m0, s19, 29696
    s_nop 0
    buffer_load_dwordx4 v0, s[8:11], s21 offen lds
    s_add_u32 s21, s20, 0xf0000
    s_add_u32 m0, s19, 30720
    s_nop 0
    buffer_load_dwordx4 v0, s[8:11], s21 offen lds
    s_add_u32 s21, s20, 0xf8000
    s_add_u32 m0, s19, 31744
    s_nop 0
    buffer_load_dwordx4 v0, s[8:11], s21 offen lds
    v_and_b32 v178, 15, v250
    v_lshrrev_b32 v179, 4, v250
    v_lshlrev_b32 v175, 11, v178
    v_lshl_add_u32 v175, v179, 3, v175
    s_lshl_b32 s21, s14, 11
    s_add_u32 s21, s21, 131072
    v_add_u32 v176, s21, v170
    s_lshl_b32 s21, s14, 10
    s_add_u32 s21, s21, 131072
    v_add_u32 v177, s21, v170
    s_lshr_b32 s21, s13, 2
    s_lshl_b32 s21, s21, 8
    s_add_u32 s21, s21, 0x8412000
    s_lshl2_add_u32 s21, s18, s21
    v_mov_b32 v172, s21
    v_mov_b32 v173, 4
    s_lshl_b32 s21, s14, 4
    s_add_u32 s21, s21, s23
    s_lshl_b32 s21, s21, 2
    s_add_u32 s21, s21, 0x8400000
    s_lshl_b32 s22, s18, 8
    s_add_u32 s21, s21, s22
    s_mov_b64 exec, 0xff
    v_lshl_add_u32 v172, v250, 3, s21
    v_mov_b32 v173, 0x100
    s_mov_b64 exec, -1
    s_lshl_b32 s15, s14, 15
    s_lshl_b32 s21, s23, 17
    s_add_u32 s15, s15, s21
    s_add_u32 s15, s15, 0x3800000
    s_lshl_b32 s21, s18, 18
    s_add_u32 s15, s15, s21
    s_lshl_b32 s21, s23, 15
    s_lshl_b32 s22, s18, 16
    s_add_u32 s21, s21, s22
    s_and_b32 s22, s14, 1
    s_lshl_b32 s16, s13, 1
    s_add_u32 s16, s16, s22
    s_lshl_b32 s16, s16, 5
    s_add_u32 s16, s16, s21
    s_lshl_b32 s17, s13, 7
    s_add_u32 s17, s17, s22
    s_lshl_b32 s17, s17, 3
    s_add_u32 s17, s17, s21
    s_add_u32 s17, s17, 0x6400000
    s_waitcnt vmcnt(24)
    ds_read_b64_tr_b16 a[0:1], v1 offset:0
    ds_read_b64_tr_b16 a[2:3], v1 offset:1024
    ds_read_b64_tr_b16 a[128:129], v1 offset:32
    ds_read_b64_tr_b16 a[130:131], v1 offset:1056
    ds_read_b64_tr_b16 a[4:5], v1 offset:2048
    ds_read_b64_tr_b16 a[6:7], v1 offset:3072
    ds_read_b64_tr_b16 a[132:133], v1 offset:2080
    ds_read_b64_tr_b16 a[134:135], v1 offset:3104
    ds_read_b64_tr_b16 a[8:9], v1 offset:4096
    ds_read_b64_tr_b16 a[10:11], v1 offset:5120
    ds_read_b64_tr_b16 a[136:137], v1 offset:4128
    ds_read_b64_tr_b16 a[138:139], v1 offset:5152
    ds_read_b64_tr_b16 a[12:13], v1 offset:6144
    ds_read_b64_tr_b16 a[14:15], v1 offset:7168
    ds_read_b64_tr_b16 a[140:141], v1 offset:6176
    ds_read_b64_tr_b16 a[142:143], v1 offset:7200
    s_waitcnt lgkmcnt(0)
    s_add_u32 s21, s20, 0x100000
    s_add_u32 m0, s19, 0
    s_nop 0
    buffer_load_dwordx4 v0, s[8:11], s21 offen lds
    s_add_u32 s21, s20, 0x108000
    s_add_u32 m0, s19, 1024
    s_nop 0
    buffer_load_dwordx4 v0, s[8:11], s21 offen lds
    s_add_u32 s21, s20, 0x110000
    s_add_u32 m0, s19, 2048
    s_nop 0
    buffer_load_dwordx4 v0, s[8:11], s21 offen lds
    s_add_u32 s21, s20, 0x118000
    s_add_u32 m0, s19, 3072
    s_nop 0
    buffer_load_dwordx4 v0, s[8:11], s21 offen lds
    s_add_u32 s21, s20, 0x120000
    s_add_u32 m0, s19, 4096
    s_nop 0
    buffer_load_dwordx4 v0, s[8:11], s21 offen lds
    s_add_u32 s21, s20, 0x128000
    s_add_u32 m0, s19, 5120
    s_nop 0
    buffer_load_dwordx4 v0, s[8:11], s21 offen lds
    s_add_u32 s21, s20, 0x130000
    s_add_u32 m0, s19, 6144
    s_nop 0
    buffer_load_dwordx4 v0, s[8:11], s21 offen lds
    s_add_u32 s21, s20, 0x138000
    s_add_u32 m0, s19, 7168
    s_nop 0
    buffer_load_dwordx4 v0, s[8:11], s21 offen lds
    s_waitcnt vmcnt(24)
    ds_read_b64_tr_b16 a[16:17], v1 offset:8192
    ds_read_b64_tr_b16 a[18:19], v1 offset:9216
    ds_read_b64_tr_b16 a[144:145], v1 offset:8224
    ds_read_b64_tr_b16 a[146:147], v1 offset:9248
    ds_read_b64_tr_b16 a[20:21], v1 offset:10240
    ds_read_b64_tr_b16 a[22:23], v1 offset:11264
    ds_read_b64_tr_b16 a[148:149], v1 offset:10272
    ds_read_b64_tr_b16 a[150:151], v1 offset:11296
    ds_read_b64_tr_b16 a[24:25], v1 offset:12288
    ds_read_b64_tr_b16 a[26:27], v1 offset:13312
    ds_read_b64_tr_b16 a[152:153], v1 offset:12320
    ds_read_b64_tr_b16 a[154:155], v1 offset:13344
    ds_read_b64_tr_b16 a[28:29], v1 offset:14336
    ds_read_b64_tr_b16 a[30:31], v1 offset:15360
    ds_read_b64_tr_b16 a[156:157], v1 offset:14368
    ds_read_b64_tr_b16 a[158:159], v1 offset:15392
    s_waitcnt lgkmcnt(0)
    s_add_u32 s21, s20, 0x140000
    s_add_u32 m0, s19, 8192
    s_nop 0
    buffer_load_dwordx4 v0, s[8:11], s21 offen lds
    s_add_u32 s21, s20, 0x148000
    s_add_u32 m0, s19, 9216
    s_nop 0
    buffer_load_dwordx4 v0, s[8:11], s21 offen lds
    s_add_u32 s21, s20, 0x150000
    s_add_u32 m0, s19, 10240
    s_nop 0
    buffer_load_dwordx4 v0, s[8:11], s21 offen lds
    s_add_u32 s21, s20, 0x158000
    s_add_u32 m0, s19, 11264
    s_nop 0
    buffer_load_dwordx4 v0, s[8:11], s21 offen lds
    s_add_u32 s21, s20, 0x160000
    s_add_u32 m0, s19, 12288
    s_nop 0
    buffer_load_dwordx4 v0, s[8:11], s21 offen lds
    s_add_u32 s21, s20, 0x168000
    s_add_u32 m0, s19, 13312
    s_nop 0
    buffer_load_dwordx4 v0, s[8:11], s21 offen lds
    s_add_u32 s21, s20, 0x170000
    s_add_u32 m0, s19, 14336
    s_nop 0
    buffer_load_dwordx4 v0, s[8:11], s21 offen lds
    s_add_u32 s21, s20, 0x178000
    s_add_u32 m0, s19, 15360
    s_nop 0
    buffer_load_dwordx4 v0, s[8:11], s21 offen lds
    s_waitcnt vmcnt(24)
    ds_read_b64_tr_b16 a[32:33], v1 offset:16384
    ds_read_b64_tr_b16 a[34:35], v1 offset:17408
    ds_read_b64_tr_b16 a[160:161], v1 offset:16416
    ds_read_b64_tr_b16 a[162:163], v1 offset:17440
    ds_read_b64_tr_b16 a[36:37], v1 offset:18432
    ds_read_b64_tr_b16 a[38:39], v1 offset:19456
    ds_read_b64_tr_b16 a[164:165], v1 offset:18464
    ds_read_b64_tr_b16 a[166:167], v1 offset:19488
    ds_read_b64_tr_b16 a[40:41], v1 offset:20480
    ds_read_b64_tr_b16 a[42:43], v1 offset:21504
    ds_read_b64_tr_b16 a[168:169], v1 offset:20512
    ds_read_b64_tr_b16 a[170:171], v1 offset:21536
    ds_read_b64_tr_b16 a[44:45], v1 offset:22528
    ds_read_b64_tr_b16 a[46:47], v1 offset:23552
    ds_read_b64_tr_b16 a[172:173], v1 offset:22560
    ds_read_b64_tr_b16 a[174:175], v1 offset:23584
    s_waitcnt lgkmcnt(0)
    s_add_u32 s21, s20, 0x180000
    s_add_u32 m0, s19, 16384
    s_nop 0
    buffer_load_dwordx4 v0, s[8:11], s21 offen lds
    s_add_u32 s21, s20, 0x188000
    s_add_u32 m0, s19, 17408
    s_nop 0
    buffer_load_dwordx4 v0, s[8:11], s21 offen lds
    s_add_u32 s21, s20, 0x190000
    s_add_u32 m0, s19, 18432
    s_nop 0
    buffer_load_dwordx4 v0, s[8:11], s21 offen lds
    s_add_u32 s21, s20, 0x198000
    s_add_u32 m0, s19, 19456
    s_nop 0
    buffer_load_dwordx4 v0, s[8:11], s21 offen lds
    s_add_u32 s21, s20, 0x1a0000
    s_add_u32 m0, s19, 20480
    s_nop 0
    buffer_load_dwordx4 v0, s[8:11], s21 offen lds
    s_add_u32 s21, s20, 0x1a8000
    s_add_u32 m0, s19, 21504
    s_nop 0
    buffer_load_dwordx4 v0, s[8:11], s21 offen lds
    s_add_u32 s21, s20, 0x1b0000
    s_add_u32 m0, s19, 22528
    s_nop 0
    buffer_load_dwordx4 v0, s[8:11], s21 offen lds
    s_add_u32 s21, s20, 0x1b8000
    s_add_u32 m0, s19, 23552
    s_nop 0
    buffer_load_dwordx4 v0, s[8:11], s21 offen lds
    s_waitcnt vmcnt(24)
    ds_read_b64_tr_b16 a[48:49], v1 offset:24576
    ds_read_b64_tr_b16 a[50:51], v1 offset:25600
    ds_read_b64_tr_b16 a[176:177], v1 offset:24608
    ds_read_b64_tr_b16 a[178:179], v1 offset:25632
    ds_read_b64_tr_b16 a[52:53], v1 offset:26624
    ds_read_b64_tr_b16 a[54:55], v1 offset:27648
    ds_read_b64_tr_b16 a[180:181], v1 offset:26656
    ds_read_b64_tr_b16 a[182:183], v1 offset:27680
    ds_read_b64_tr_b16 a[56:57], v1 offset:28672
    ds_read_b64_tr_b16 a[58:59], v1 offset:29696
    ds_read_b64_tr_b16 a[184:185], v1 offset:28704
    ds_read_b64_tr_b16 a[186:187], v1 offset:29728
    ds_read_b64_tr_b16 a[60:61], v1 offset:30720
    ds_read_b64_tr_b16 a[62:63], v1 offset:31744
    ds_read_b64_tr_b16 a[188:189], v1 offset:30752
    ds_read_b64_tr_b16 a[190:191], v1 offset:31776
    s_waitcnt lgkmcnt(0)
    s_add_u32 s21, s20, 0x1c0000
    s_add_u32 m0, s19, 24576
    s_nop 0
    buffer_load_dwordx4 v0, s[8:11], s21 offen lds
    s_add_u32 s21, s20, 0x1c8000
    s_add_u32 m0, s19, 25600
    s_nop 0
    buffer_load_dwordx4 v0, s[8:11], s21 offen lds
    s_add_u32 s21, s20, 0x1d0000
    s_add_u32 m0, s19, 26624
    s_nop 0
    buffer_load_dwordx4 v0, s[8:11], s21 offen lds
    s_add_u32 s21, s20, 0x1d8000
    s_add_u32 m0, s19, 27648
    s_nop 0
    buffer_load_dwordx4 v0, s[8:11], s21 offen lds
    s_add_u32 s21, s20, 0x1e0000
    s_add_u32 m0, s19, 28672
    s_nop 0
    buffer_load_dwordx4 v0, s[8:11], s21 offen lds
    s_add_u32 s21, s20, 0x1e8000
    s_add_u32 m0, s19, 29696
    s_nop 0
    buffer_load_dwordx4 v0, s[8:11], s21 offen lds
    s_add_u32 s21, s20, 0x1f0000
    s_add_u32 m0, s19, 30720
    s_nop 0
    buffer_load_dwordx4 v0, s[8:11], s21 offen lds
    s_add_u32 s21, s20, 0x1f8000
    s_add_u32 m0, s19, 31744
    s_nop 0
    buffer_load_dwordx4 v0, s[8:11], s21 offen lds
    s_waitcnt vmcnt(24)
    ds_read_b64_tr_b16 a[64:65], v1 offset:0
    ds_read_b64_tr_b16 a[66:67], v1 offset:1024
    ds_read_b64_tr_b16 a[192:193], v1 offset:32
    ds_read_b64_tr_b16 a[194:195], v1 offset:1056
    ds_read_b64_tr_b16 a[68:69], v1 offset:2048
    ds_read_b64_tr_b16 a[70:71], v1 offset:3072
    ds_read_b64_tr_b16 a[196:197], v1 offset:2080
    ds_read_b64_tr_b16 a[198:199], v1 offset:3104
    ds_read_b64_tr_b16 a[72:73], v1 offset:4096
    ds_read_b64_tr_b16 a[74:75], v1 offset:5120
    ds_read_b64_tr_b16 a[200:201], v1 offset:4128
    ds_read_b64_tr_b16 a[202:203], v1 offset:5152
    ds_read_b64_tr_b16 a[76:77], v1 offset:6144
    ds_read_b64_tr_b16 a[78:79], v1 offset:7168
    ds_read_b64_tr_b16 a[204:205], v1 offset:6176
    ds_read_b64_tr_b16 a[206:207], v1 offset:7200
    s_waitcnt lgkmcnt(0)
    s_waitcnt vmcnt(16)
    ds_read_b64_tr_b16 a[80:81], v1 offset:8192
    ds_read_b64_tr_b16 a[82:83], v1 offset:9216
    ds_read_b64_tr_b16 a[208:209], v1 offset:8224
    ds_read_b64_tr_b16 a[210:211], v1 offset:9248
    ds_read_b64_tr_b16 a[84:85], v1 offset:10240
    ds_read_b64_tr_b16 a[86:87], v1 offset:11264
    ds_read_b64_tr_b16 a[212:213], v1 offset:10272
    ds_read_b64_tr_b16 a[214:215], v1 offset:11296
    ds_read_b64_tr_b16 a[88:89], v1 offset:12288
    ds_read_b64_tr_b16 a[90:91], v1 offset:13312
    ds_read_b64_tr_b16 a[216:217], v1 offset:12320
    ds_read_b64_tr_b16 a[218:219], v1 offset:13344
    ds_read_b64_tr_b16 a[92:93], v1 offset:14336
    ds_read_b64_tr_b16 a[94:95], v1 offset:15360
    ds_read_b64_tr_b16 a[220:221], v1 offset:14368
    ds_read_b64_tr_b16 a[222:223], v1 offset:15392
    s_waitcnt lgkmcnt(0)
    s_waitcnt vmcnt(8)
    ds_read_b64_tr_b16 a[96:97], v1 offset:16384
    ds_read_b64_tr_b16 a[98:99], v1 offset:17408
    ds_read_b64_tr_b16 a[224:225], v1 offset:16416
    ds_read_b64_tr_b16 a[226:227], v1 offset:17440
    ds_read_b64_tr_b16 a[100:101], v1 offset:18432
    ds_read_b64_tr_b16 a[102:103], v1 offset:19456
    ds_read_b64_tr_b16 a[228:229], v1 offset:18464
    ds_read_b64_tr_b16 a[230:231], v1 offset:19488
    ds_read_b64_tr_b16 a[104:105], v1 offset:20480
    ds_read_b64_tr_b16 a[106:107], v1 offset:21504
    ds_read_b64_tr_b16 a[232:233], v1 offset:20512
    ds_read_b64_tr_b16 a[234:235], v1 offset:21536
    ds_read_b64_tr_b16 a[108:109], v1 offset:22528
    ds_read_b64_tr_b16 a[110:111], v1 offset:23552
    ds_read_b64_tr_b16 a[236:237], v1 offset:22560
    ds_read_b64_tr_b16 a[238:239], v1 offset:23584
    s_waitcnt lgkmcnt(0)
    s_waitcnt vmcnt(0)
    ds_read_b64_tr_b16 a[112:113], v1 offset:24576
    ds_read_b64_tr_b16 a[114:115], v1 offset:25600
    ds_read_b64_tr_b16 a[240:241], v1 offset:24608
    ds_read_b64_tr_b16 a[242:243], v1 offset:25632
    ds_read_b64_tr_b16 a[116:117], v1 offset:26624
    ds_read_b64_tr_b16 a[118:119], v1 offset:27648
    ds_read_b64_tr_b16 a[244:245], v1 offset:26656
    ds_read_b64_tr_b16 a[246:247], v1 offset:27680
    ds_read_b64_tr_b16 a[120:121], v1 offset:28672
    ds_read_b64_tr_b16 a[122:123], v1 offset:29696
    ds_read_b64_tr_b16 a[248:249], v1 offset:28704
    ds_read_b64_tr_b16 a[250:251], v1 offset:29728
    ds_read_b64_tr_b16 a[124:125], v1 offset:30720
    ds_read_b64_tr_b16 a[126:127], v1 offset:31744
    ds_read_b64_tr_b16 a[252:253], v1 offset:30752
    ds_read_b64_tr_b16 a[254:255], v1 offset:31776
    s_waitcnt lgkmcnt(0)
    s_cmp_lt_u32 s12, 5
    s_cbranch_scc1 main_kernel_o_top
    v_mul_u32_u24 v178, 2, v173
    v_sub_u32 v171, v172, v178
main_kernel_o_gp:
    buffer_load_dword v174, v171, s[4:7], 0 offen sc1
    s_waitcnt vmcnt(0)
    v_cmp_eq_u32 vcc, 0, v174
    s_cbranch_vccz main_kernel_o_top
    s_sleep 32
    s_sub_u32 s29, s29, 1
    s_cbranch_scc0 main_kernel_o_gp
    s_branch main_kernel_end
main_kernel_o_top:
    buffer_load_dword v174, v172, s[4:7], 0 offen sc1
    s_waitcnt vmcnt(0)
    v_cmp_eq_u32 vcc, 0, v174
    s_cbranch_vccz main_kernel_o_go
    s_sleep 1
    s_sub_u32 s29, s29, 1
    s_cbranch_scc0 main_kernel_o_top
    s_branch main_kernel_end
main_kernel_o_go:
    buffer_load_dwordx4 v[0:3], v170, s[4:7], s15 offen offset:0 sc1
    buffer_load_dwordx4 v[4:7], v170, s[4:7], s15 offen offset:1024 sc1
    buffer_load_dwordx4 v[8:11], v170, s[4:7], s15 offen offset:2048 sc1
    buffer_load_dwordx4 v[12:15], v170, s[4:7], s15 offen offset:3072 sc1
    s_add_u32 s15, s15, 4096
    buffer_load_dwordx4 v[16:19], v170, s[4:7], s15 offen offset:0 sc1
    buffer_load_dwordx4 v[20:23], v170, s[4:7], s15 offen offset:1024 sc1
    buffer_load_dwordx4 v[24:27], v170, s[4:7], s15 offen offset:2048 sc1
    buffer_load_dwordx4 v[28:31], v170, s[4:7], s15 offen offset:3072 sc1
    s_add_u32 s15, s15, 4096
    buffer_load_dwordx4 v[32:35], v170, s[4:7], s15 offen offset:0 sc1
    buffer_load_dwordx4 v[36:39], v170, s[4:7], s15 offen offset:1024 sc1
    buffer_load_dwordx4 v[40:43], v170, s[4:7], s15 offen offset:2048 sc1
    buffer_load_dwordx4 v[44:47], v170, s[4:7], s15 offen offset:3072 sc1
    s_add_u32 s15, s15, 4096
    buffer_load_dwordx4 v[48:51], v170, s[4:7], s15 offen offset:0 sc1
    buffer_load_dwordx4 v[52:55], v170, s[4:7], s15 offen offset:1024 sc1
    buffer_load_dwordx4 v[56:59], v170, s[4:7], s15 offen offset:2048 sc1
    buffer_load_dwordx4 v[60:63], v170, s[4:7], s15 offen offset:3072 sc1
    s_add_u32 s15, s15, 4096
    buffer_load_dwordx2 v[160:161], v175, s[96:99], s16 offen
    buffer_load_dwordx2 v[162:163], v170, s[4:7], s17 offen sc1
    buffer_load_dwordx4 v[64:67], v170, s[4:7], s15 offen offset:0 sc1
    buffer_load_dwordx4 v[68:71], v170, s[4:7], s15 offen offset:1024 sc1
    buffer_load_dwordx4 v[72:75], v170, s[4:7], s15 offen offset:2048 sc1
    buffer_load_dwordx4 v[76:79], v170, s[4:7], s15 offen offset:3072 sc1
    s_add_u32 s15, s15, 4096
    buffer_load_dwordx4 v[80:83], v170, s[4:7], s15 offen offset:0 sc1
    buffer_load_dwordx4 v[84:87], v170, s[4:7], s15 offen offset:1024 sc1
    buffer_load_dwordx4 v[88:91], v170, s[4:7], s15 offen offset:2048 sc1
    buffer_load_dwordx4 v[92:95], v170, s[4:7], s15 offen offset:3072 sc1
    s_add_u32 s15, s15, 4096
    buffer_load_dwordx4 v[96:99], v170, s[4:7], s15 offen offset:0 sc1
    buffer_load_dwordx4 v[100:103], v170, s[4:7], s15 offen offset:1024 sc1
    buffer_load_dwordx4 v[104:107], v170, s[4:7], s15 offen offset:2048 sc1
    buffer_load_dwordx4 v[108:111], v170, s[4:7], s15 offen offset:3072 sc1
    s_add_u32 s15, s15, 4096
    buffer_load_dwordx4 v[112:115], v170, s[4:7], s15 offen offset:0 sc1
    buffer_load_dwordx4 v[116:119], v170, s[4:7], s15 offen offset:1024 sc1
    buffer_load_dwordx4 v[120:123], v170, s[4:7], s15 offen offset:2048 sc1
    buffer_load_dwordx4 v[124:127], v170, s[4:7], s15 offen offset:3072 sc1
    s_add_u32 s15, s15, 233472
    v_add_u32 v172, v172, v173
    s_add_u32 s17, s17, 65536
    s_add_u32 s18, s18, 1
    s_waitcnt vmcnt(33)
    v_mfma_f32_16x16x32_bf16 v[128:131], a[0:3], v[0:3], 0
    v_mfma_f32_16x16x32_bf16 v[132:135], a[128:131], v[0:3], 0
    s_waitcnt vmcnt(32)
    v_mfma_f32_16x16x32_bf16 v[128:131], a[4:7], v[4:7], v[128:131]
    v_mfma_f32_16x16x32_bf16 v[132:135], a[132:135], v[4:7], v[132:135]
    s_waitcnt vmcnt(31)
    v_mfma_f32_16x16x32_bf16 v[128:131], a[8:11], v[8:11], v[128:131]
    v_mfma_f32_16x16x32_bf16 v[132:135], a[136:139], v[8:11], v[132:135]
    s_waitcnt vmcnt(30)
    v_mfma_f32_16x16x32_bf16 v[128:131], a[12:15], v[12:15], v[128:131]
    v_mfma_f32_16x16x32_bf16 v[132:135], a[140:143], v[12:15], v[132:135]
    s_waitcnt vmcnt(29)
    v_mfma_f32_16x16x32_bf16 v[128:131], a[16:19], v[16:19], v[128:131]
    v_mfma_f32_16x16x32_bf16 v[132:135], a[144:147], v[16:19], v[132:135]
    s_waitcnt vmcnt(28)
    v_mfma_f32_16x16x32_bf16 v[128:131], a[20:23], v[20:23], v[128:131]
    v_mfma_f32_16x16x32_bf16 v[132:135], a[148:151], v[20:23], v[132:135]
    s_waitcnt vmcnt(27)
    v_mfma_f32_16x16x32_bf16 v[128:131], a[24:27], v[24:27], v[128:131]
    v_mfma_f32_16x16x32_bf16 v[132:135], a[152:155], v[24:27], v[132:135]
    s_waitcnt vmcnt(26)
    v_mfma_f32_16x16x32_bf16 v[128:131], a[28:31], v[28:31], v[128:131]
    v_mfma_f32_16x16x32_bf16 v[132:135], a[156:159], v[28:31], v[132:135]
    s_waitcnt vmcnt(25)
    v_mfma_f32_16x16x32_bf16 v[128:131], a[32:35], v[32:35], v[128:131]
    v_mfma_f32_16x16x32_bf16 v[132:135], a[160:163], v[32:35], v[132:135]
    s_waitcnt vmcnt(24)
    v_mfma_f32_16x16x32_bf16 v[128:131], a[36:39], v[36:39], v[128:131]
    v_mfma_f32_16x16x32_bf16 v[132:135], a[164:167], v[36:39], v[132:135]
    s_waitcnt vmcnt(23)
    v_mfma_f32_16x16x32_bf16 v[128:131], a[40:43], v[40:43], v[128:131]
    v_mfma_f32_16x16x32_bf16 v[132:135], a[168:171], v[40:43], v[132:135]
    s_waitcnt vmcnt(22)
    v_mfma_f32_16x16x32_bf16 v[128:131], a[44:47], v[44:47], v[128:131]
    v_mfma_f32_16x16x32_bf16 v[132:135], a[172:175], v[44:47], v[132:135]
    s_waitcnt vmcnt(21)
    v_mfma_f32_16x16x32_bf16 v[128:131], a[48:51], v[48:51], v[128:131]
    v_mfma_f32_16x16x32_bf16 v[132:135], a[176:179], v[48:51], v[132:135]
    s_waitcnt vmcnt(20)
    v_mfma_f32_16x16x32_bf16 v[128:131], a[52:55], v[52:55], v[128:131]
    v_mfma_f32_16x16x32_bf16 v[132:135], a[180:183], v[52:55], v[132:135]
    s_waitcnt vmcnt(19)
    v_mfma_f32_16x16x32_bf16 v[128:131], a[56:59], v[56:59], v[128:131]
    v_mfma_f32_16x16x32_bf16 v[132:135], a[184:187], v[56:59], v[132:135]
    s_waitcnt vmcnt(18)
    v_mfma_f32_16x16x32_bf16 v[128:131], a[60:63], v[60:63], v[128:131]
    v_mfma_f32_16x16x32_bf16 v[132:135], a[188:191], v[60:63], v[132:135]
    s_waitcnt vmcnt(15)
    v_mfma_f32_16x16x32_bf16 v[128:131], a[64:67], v[64:67], v[128:131]
    v_mfma_f32_16x16x32_bf16 v[132:135], a[192:195], v[64:67], v[132:135]
    s_waitcnt vmcnt(14)
    v_mfma_f32_16x16x32_bf16 v[128:131], a[68:71], v[68:71], v[128:131]
    v_mfma_f32_16x16x32_bf16 v[132:135], a[196:199], v[68:71], v[132:135]
    s_waitcnt vmcnt(13)
    v_mfma_f32_16x16x32_bf16 v[128:131], a[72:75], v[72:75], v[128:131]
    v_mfma_f32_16x16x32_bf16 v[132:135], a[200:203], v[72:75], v[132:135]
    s_waitcnt vmcnt(12)
    v_mfma_f32_16x16x32_bf16 v[128:131], a[76:79], v[76:79], v[128:131]
    v_mfma_f32_16x16x32_bf16 v[132:135], a[204:207], v[76:79], v[132:135]
    s_waitcnt vmcnt(11)
    v_mfma_f32_16x16x32_bf16 v[128:131], a[80:83], v[80:83], v[128:131]
    v_mfma_f32_16x16x32_bf16 v[132:135], a[208:211], v[80:83], v[132:135]
    v_lshlrev_b32 v164, 16, v160
    v_and_b32 v165, 0xffff0000, v160
    v_lshlrev_b32 v166, 16, v161
    v_and_b32 v167, 0xffff0000, v161
    v_lshlrev_b32 v160, 16, v162
    v_and_b32 v161, 0xffff0000, v162
    v_lshlrev_b32 v162, 16, v163
    v_and_b32 v163, 0xffff0000, v163
    s_waitcnt vmcnt(10)
    v_mfma_f32_16x16x32_bf16 v[128:131], a[84:87], v[84:87], v[128:131]
    v_mfma_f32_16x16x32_bf16 v[132:135], a[212:215], v[84:87], v[132:135]
    s_waitcnt vmcnt(9)
    v_mfma_f32_16x16x32_bf16 v[128:131], a[88:91], v[88:91], v[128:131]
    v_mfma_f32_16x16x32_bf16 v[132:135], a[216:219], v[88:91], v[132:135]
    s_waitcnt vmcnt(8)
    v_mfma_f32_16x16x32_bf16 v[128:131], a[92:95], v[92:95], v[128:131]
    v_mfma_f32_16x16x32_bf16 v[132:135], a[220:223], v[92:95], v[132:135]
    s_waitcnt vmcnt(7)
    v_mfma_f32_16x16x32_bf16 v[128:131], a[96:99], v[96:99], v[128:131]
    v_mfma_f32_16x16x32_bf16 v[132:135], a[224:227], v[96:99], v[132:135]
    s_waitcnt vmcnt(6)
    v_mfma_f32_16x16x32_bf16 v[128:131], a[100:103], v[100:103], v[128:131]
    v_mfma_f32_16x16x32_bf16 v[132:135], a[228:231], v[100:103], v[132:135]
    s_waitcnt vmcnt(5)
    v_mfma_f32_16x16x32_bf16 v[128:131], a[104:107], v[104:107], v[128:131]
    v_mfma_f32_16x16x32_bf16 v[132:135], a[232:235], v[104:107], v[132:135]
    s_waitcnt vmcnt(4)
    v_mfma_f32_16x16x32_bf16 v[128:131], a[108:111], v[108:111], v[128:131]
    v_mfma_f32_16x16x32_bf16 v[132:135], a[236:239], v[108:111], v[132:135]
    s_waitcnt vmcnt(3)
    v_mfma_f32_16x16x32_bf16 v[128:131], a[112:115], v[112:115], v[128:131]
    v_mfma_f32_16x16x32_bf16 v[132:135], a[240:243], v[112:115], v[132:135]
    s_waitcnt vmcnt(2)
    v_mfma_f32_16x16x32_bf16 v[128:131], a[116:119], v[116:119], v[128:131]
    v_mfma_f32_16x16x32_bf16 v[132:135], a[244:247], v[116:119], v[132:135]
    s_waitcnt vmcnt(1)
    v_mfma_f32_16x16x32_bf16 v[128:131], a[120:123], v[120:123], v[128:131]
    v_mfma_f32_16x16x32_bf16 v[132:135], a[248:251], v[120:123], v[132:135]
    s_waitcnt vmcnt(0)
    v_mfma_f32_16x16x32_bf16 v[128:131], a[124:127], v[124:127], v[128:131]
    v_mfma_f32_16x16x32_bf16 v[132:135], a[252:255], v[124:127], v[132:135]
    s_cmp_ge_u32 s14, 2
    s_nop 5
    ds_write_b128 v176, v[128:131] offset:0
    ds_write_b128 v176, v[132:135] offset:1024
    v_xor_b32 v176, 0x4000, v176
    s_waitcnt lgkmcnt(0)
    s_barrier
    s_cbranch_scc1 main_kernel_o_nx
    ds_read_b128 v[144:147], v177 offset:0
    ds_read_b128 v[148:151], v177 offset:2048
    ds_read_b128 v[152:155], v177 offset:4096
    ds_read_b128 v[156:159], v177 offset:6144
    v_xor_b32 v177, 0x4000, v177
    s_waitcnt lgkmcnt(2)
    v_pk_add_f32 v[144:145], v[144:145], v[148:149]
    v_pk_add_f32 v[146:147], v[146:147], v[150:151]
    s_waitcnt lgkmcnt(0)
    v_pk_add_f32 v[152:153], v[152:153], v[156:157]
    v_pk_add_f32 v[154:155], v[154:155], v[158:159]
    v_pk_add_f32 v[144:145], v[144:145], v[152:153]
    v_pk_add_f32 v[146:147], v[146:147], v[154:155]
    v_pk_fma_f32 v[144:145], v[144:145], v[160:161], v[164:165]
    v_pk_fma_f32 v[146:147], v[146:147], v[162:163], v[166:167]
    v_cvt_pk_bf16_f32 v148, v144, v145
    v_cvt_pk_bf16_f32 v149, v146, v147
    buffer_store_dwordx2 v[148:149], v175, s[92:95], s16 offen
main_kernel_o_nx:
    s_add_u32 s16, s16, 65536
    s_cmp_le_u32 s18, 62
    s_cbranch_scc1 main_kernel_o_top
    v_add_u32 v172, v172, v173
    s_add_u32 s17, s17, 65536
    s_add_u32 s16, s16, 65536
    s_add_u32 s15, s15, 262144
    s_add_u32 s18, s18, 1
    s_cmp_lt_u32 s18, 64
    s_cbranch_scc1 main_kernel_o_top
    s_branch main_kernel_end
main_kernel_end2:
    s_endpgm
main_kernel_worker:
    v_lshlrev_b32 v251, 4, v250
    v_mov_b32 v240, 0xc0135761
    v_mov_b32 v241, 0xc0135761
    v_mov_b32 v242, 0xbdd2d3e8
    v_mov_b32 v243, 0xbdd2d3e8
    v_mov_b32 v244, 0x3f800000
    v_mov_b32 v245, 0x3f800000
    v_mov_b32 v246, 0xbfb8aa3b
    v_mov_b32 v247, 0xbfb8aa3b
    s_lshr_b32 s37, s14, 1
    s_and_b32 s38, s14, 1
    v_mov_b32 v252, 0
    s_mov_b32 s8, s40
    s_and_b32 s9, s41, 0xffff
    s_mov_b32 s10, 0x0
    s_mov_b32 s11, 0x20000
    s_mov_b32 s57, 0
    s_mov_b32 s56, 0x7f000000
    v_mov_b32 v249, 0
main_kernel_w_next:
    s_cmp_lg_u32 s14, 0
    s_cbranch_scc1 main_kernel_w_bar
main_kernel_w_try:
    s_lshl_b32 s32, s27, 8
    s_add_u32 s32, s32, 0x841e000
    v_mov_b32 v254, 1
    s_mov_b64 exec, 1
    buffer_atomic_add v254, off, s[4:7], s32 sc0 sc1
    s_mov_b64 exec, -1
    s_waitcnt vmcnt(0)
    v_readfirstlane_b32 s28, v254
    s_cmp_eq_u32 s57, 0
    s_cbranch_scc1 main_kernel_w_fl1
    s_waitcnt vmcnt(0)
    s_barrier
    v_mov_b32 v4, 1
    v_mov_b32 v5, 1
    v_mov_b32 v6, 1
    v_mov_b32 v7, 1
    s_bfm_b64 exec, s57, 0
    buffer_store_dwordx4 v[4:7], v249, s[4:7], s56 offen sc1
    s_mov_b64 exec, -1
    s_mov_b32 s57, 0
main_kernel_w_fl1:
    s_nop 3
main_kernel_w_have:
    s_cmp_lg_u32 s27, 0
    s_cbranch_scc1 main_kernel_w_q1
    s_cmp_lt_u32 s28, 104
    s_cbranch_scc0 main_kernel_w_d_1
    s_cmp_lt_u32 s28, 32
    s_cbranch_scc0 main_kernel_w_d_2
    s_cmp_lt_u32 s28, 16
    s_cbranch_scc0 main_kernel_w_d_3
    s_cmp_lt_u32 s28, 8
    s_cbranch_scc0 main_kernel_w_d_4
    s_mov_b32 s36, 0x4005800
    s_branch main_kernel_w_dec
main_kernel_w_d_4:
    s_mov_b32 s36, 0x66090008
    s_branch main_kernel_w_dec
main_kernel_w_d_3:
    s_cmp_lt_u32 s28, 24
    s_cbranch_scc0 main_kernel_w_d_5
    s_mov_b32 s36, 0x67090810
    s_branch main_kernel_w_dec
main_kernel_w_d_5:
    s_mov_b32 s36, 0x40068818
    s_branch main_kernel_w_dec
main_kernel_w_d_2:
    s_cmp_lt_u32 s28, 56
    s_cbranch_scc0 main_kernel_w_d_6
    s_cmp_lt_u32 s28, 40
    s_cbranch_scc0 main_kernel_w_d_7
    s_mov_b32 s36, 0x4045020
    s_branch main_kernel_w_dec
main_kernel_w_d_7:
    s_mov_b32 s36, 0x44008028
    s_branch main_kernel_w_dec
main_kernel_w_d_6:
    s_cmp_lt_u32 s28, 72
    s_cbranch_scc0 main_kernel_w_d_8
    s_mov_b32 s36, 0x8085038
    s_branch main_kernel_w_dec
main_kernel_w_d_8:
    s_cmp_lt_u32 s28, 88
    s_cbranch_scc0 main_kernel_w_d_9
    s_mov_b32 s36, 0x40c2048
    s_branch main_kernel_w_dec
main_kernel_w_d_9:
    s_mov_b32 s36, 0x48089058
    s_branch main_kernel_w_dec
main_kernel_w_d_1:
    s_cmp_lt_u32 s28, 156
    s_cbranch_scc0 main_kernel_w_d_10
    s_cmp_lt_u32 s28, 120
    s_cbranch_scc0 main_kernel_w_d_11
    s_cmp_lt_u32 s28, 112
    s_cbranch_scc0 main_kernel_w_d_12
    s_mov_b32 s36, 0x65090068
    s_branch main_kernel_w_dec
main_kernel_w_d_12:
    s_mov_b32 s36, 0x64110870
    s_branch main_kernel_w_dec
main_kernel_w_d_11:
    s_cmp_lt_u32 s28, 134
    s_cbranch_scc0 main_kernel_w_d_13
    s_mov_b32 s36, 0x65878
    s_branch main_kernel_w_dec
main_kernel_w_d_13:
    s_cmp_lt_u32 s28, 150
    s_cbranch_scc0 main_kernel_w_d_14
    s_mov_b32 s36, 0x4808b086
    s_branch main_kernel_w_dec
main_kernel_w_d_14:
    s_mov_b32 s36, 0x66013096
    s_branch main_kernel_w_dec
main_kernel_w_d_10:
    s_cmp_lt_u32 s28, 180
    s_cbranch_scc0 main_kernel_w_d_15
    s_cmp_lt_u32 s28, 164
    s_cbranch_scc0 main_kernel_w_d_16
    s_mov_b32 s36, 0x6509309c
    s_branch main_kernel_w_dec
main_kernel_w_d_16:
    s_mov_b32 s36, 0x4900b0a4
    s_branch main_kernel_w_dec
main_kernel_w_d_15:
    s_cmp_lt_u32 s28, 196
    s_cbranch_scc0 main_kernel_w_d_17
    s_mov_b32 s36, 0x481888b4
    s_branch main_kernel_w_dec
main_kernel_w_d_17:
    s_cmp_lt_u32 s28, 212
    s_cbranch_scc0 main_kernel_w_d_18
    s_mov_b32 s36, 0x88038c4
    s_branch main_kernel_w_dec
main_kernel_w_d_18:
    s_mov_b32 s36, 0xffffffff
    s_branch main_kernel_w_dec
main_kernel_w_q1:
    s_cmp_lg_u32 s27, 1
    s_cbranch_scc1 main_kernel_w_q2
    s_cmp_lt_u32 s28, 52
    s_cbranch_scc0 main_kernel_w_d_19
    s_cmp_lt_u32 s28, 28
    s_cbranch_scc0 main_kernel_w_d_20
    s_cmp_lt_u32 s28, 4
    s_cbranch_scc0 main_kernel_w_d_21
    s_mov_b32 s36, 0x25000
    s_branch main_kernel_w_dec
main_kernel_w_d_21:
    s_cmp_lt_u32 s28, 20
    s_cbranch_scc0 main_kernel_w_d_22
    s_mov_b32 s36, 0x48189804
    s_branch main_kernel_w_dec
main_kernel_w_d_22:
    s_mov_b32 s36, 0x66091014
    s_branch main_kernel_w_dec
main_kernel_w_d_20:
    s_cmp_lt_u32 s28, 36
    s_cbranch_scc0 main_kernel_w_d_23
    s_mov_b32 s36, 0x4206881c
    s_branch main_kernel_w_dec
main_kernel_w_d_23:
    s_cmp_lt_u32 s28, 44
    s_cbranch_scc0 main_kernel_w_d_24
    s_mov_b32 s36, 0x64090024
    s_branch main_kernel_w_dec
main_kernel_w_d_24:
    s_mov_b32 s36, 0x6511002c
    s_branch main_kernel_w_dec
main_kernel_w_d_19:
    s_cmp_lt_u32 s28, 78
    s_cbranch_scc0 main_kernel_w_d_25
    s_cmp_lt_u32 s28, 60
    s_cbranch_scc0 main_kernel_w_d_26
    s_mov_b32 s36, 0x66110834
    s_branch main_kernel_w_dec
main_kernel_w_d_26:
    s_cmp_lt_u32 s28, 66
    s_cbranch_scc0 main_kernel_w_d_27
    s_mov_b32 s36, 0x66d1303c
    s_branch main_kernel_w_dec
main_kernel_w_d_27:
    s_mov_b32 s36, 0x4ad8b042
    s_branch main_kernel_w_dec
main_kernel_w_d_25:
    s_cmp_lt_u32 s28, 102
    s_cbranch_scc0 main_kernel_w_d_28
    s_cmp_lt_u32 s28, 94
    s_cbranch_scc0 main_kernel_w_d_29
    s_mov_b32 s36, 0x898384e
    s_branch main_kernel_w_dec
main_kernel_w_d_29:
    s_mov_b32 s36, 0x14405e
    s_branch main_kernel_w_dec
main_kernel_w_d_28:
    s_cmp_lt_u32 s28, 110
    s_cbranch_scc0 main_kernel_w_d_30
    s_mov_b32 s36, 0x164066
    s_branch main_kernel_w_dec
main_kernel_w_d_30:
    s_mov_b32 s36, 0xffffffff
    s_branch main_kernel_w_dec
main_kernel_w_q2:
    s_cmp_lg_u32 s27, 2
    s_cbranch_scc1 main_kernel_w_q3
    s_cmp_lt_u32 s28, 118
    s_cbranch_scc0 main_kernel_w_d_31
    s_cmp_lt_u32 s28, 48
    s_cbranch_scc0 main_kernel_w_d_32
    s_cmp_lt_u32 s28, 16
    s_cbranch_scc0 main_kernel_w_d_33
    s_cmp_lt_u32 s28, 8
    s_cbranch_scc0 main_kernel_w_d_34
    s_mov_b32 s36, 0x800
    s_branch main_kernel_w_dec
main_kernel_w_d_34:
    s_mov_b32 s36, 0x1008
    s_branch main_kernel_w_dec
main_kernel_w_d_33:
    s_cmp_lt_u32 s28, 24
    s_cbranch_scc0 main_kernel_w_d_35
    s_mov_b32 s36, 0x44028810
    s_branch main_kernel_w_dec
main_kernel_w_d_35:
    s_cmp_lt_u32 s28, 32
    s_cbranch_scc0 main_kernel_w_d_36
    s_mov_b32 s36, 0x44029018
    s_branch main_kernel_w_dec
main_kernel_w_d_36:
    s_mov_b32 s36, 0x48089820
    s_branch main_kernel_w_dec
main_kernel_w_d_32:
    s_cmp_lt_u32 s28, 72
    s_cbranch_scc0 main_kernel_w_d_37
    s_cmp_lt_u32 s28, 56
    s_cbranch_scc0 main_kernel_w_d_38
    s_mov_b32 s36, 0x40069030
    s_branch main_kernel_w_dec
main_kernel_w_d_38:
    s_mov_b32 s36, 0x44048038
    s_branch main_kernel_w_dec
main_kernel_w_d_37:
    s_cmp_lt_u32 s28, 88
    s_cbranch_scc0 main_kernel_w_d_39
    s_mov_b32 s36, 0x4142048
    s_branch main_kernel_w_dec
main_kernel_w_d_39:
    s_cmp_lt_u32 s28, 104
    s_cbranch_scc0 main_kernel_w_d_40
    s_mov_b32 s36, 0x4082058
    s_branch main_kernel_w_dec
main_kernel_w_d_40:
    s_mov_b32 s36, 0x45868
    s_branch main_kernel_w_dec
main_kernel_w_d_31:
    s_cmp_lt_u32 s28, 190
    s_cbranch_scc0 main_kernel_w_d_41
    s_cmp_lt_u32 s28, 150
    s_cbranch_scc0 main_kernel_w_d_42
    s_cmp_lt_u32 s28, 134
    s_cbranch_scc0 main_kernel_w_d_43
    s_mov_b32 s36, 0x8185076
    s_branch main_kernel_w_dec
main_kernel_w_d_43:
    s_mov_b32 s36, 0x4042086
    s_branch main_kernel_w_dec
main_kernel_w_d_42:
    s_cmp_lt_u32 s28, 166
    s_cbranch_scc0 main_kernel_w_d_44
    s_mov_b32 s36, 0x41c2096
    s_branch main_kernel_w_dec
main_kernel_w_d_44:
    s_cmp_lt_u32 s28, 182
    s_cbranch_scc0 main_kernel_w_d_45
    s_mov_b32 s36, 0x80028a6
    s_branch main_kernel_w_dec
main_kernel_w_d_45:
    s_mov_b32 s36, 0x671108b6
    s_branch main_kernel_w_dec
main_kernel_w_d_41:
    s_cmp_lt_u32 s28, 220
    s_cbranch_scc0 main_kernel_w_d_46
    s_cmp_lt_u32 s28, 206
    s_cbranch_scc0 main_kernel_w_d_47
    s_mov_b32 s36, 0x4800b0be
    s_branch main_kernel_w_dec
main_kernel_w_d_47:
    s_cmp_lt_u32 s28, 212
    s_cbranch_scc0 main_kernel_w_d_48
    s_mov_b32 s36, 0x661130ce
    s_branch main_kernel_w_dec
main_kernel_w_d_48:
    s_mov_b32 s36, 0x651900d4
    s_branch main_kernel_w_dec
main_kernel_w_d_46:
    s_cmp_lt_u32 s28, 236
    s_cbranch_scc0 main_kernel_w_d_49
    s_mov_b32 s36, 0x4818b0dc
    s_branch main_kernel_w_dec
main_kernel_w_d_49:
    s_cmp_lt_u32 s28, 252
    s_cbranch_scc0 main_kernel_w_d_50
    s_mov_b32 s36, 0x89038ec
    s_branch main_kernel_w_dec
main_kernel_w_d_50:
    s_mov_b32 s36, 0xffffffff
    s_branch main_kernel_w_dec
main_kernel_w_q3:
    s_cmp_lg_u32 s27, 3
    s_cbranch_scc1 main_kernel_w_q4
    s_cmp_lt_u32 s28, 160
    s_cbranch_scc0 main_kernel_w_d_51
    s_cmp_lt_u32 s28, 64
    s_cbranch_scc0 main_kernel_w_d_52
    s_cmp_lt_u32 s28, 24
    s_cbranch_scc0 main_kernel_w_d_53
    s_cmp_lt_u32 s28, 8
    s_cbranch_scc0 main_kernel_w_d_54
    s_mov_b32 s36, 0x1000800
    s_branch main_kernel_w_dec
main_kernel_w_d_54:
    s_cmp_lt_u32 s28, 16
    s_cbranch_scc0 main_kernel_w_d_55
    s_mov_b32 s36, 0x1001008
    s_branch main_kernel_w_dec
main_kernel_w_d_55:
    s_mov_b32 s36, 0x45028810
    s_branch main_kernel_w_dec
main_kernel_w_d_53:
    s_cmp_lt_u32 s28, 32
    s_cbranch_scc0 main_kernel_w_d_56
    s_mov_b32 s36, 0x45029018
    s_branch main_kernel_w_dec
main_kernel_w_d_56:
    s_cmp_lt_u32 s28, 48
    s_cbranch_scc0 main_kernel_w_d_57
    s_mov_b32 s36, 0x48009820
    s_branch main_kernel_w_dec
main_kernel_w_d_57:
    s_mov_b32 s36, 0x4b089030
    s_branch main_kernel_w_dec
main_kernel_w_d_52:
    s_cmp_lt_u32 s28, 104
    s_cbranch_scc0 main_kernel_w_d_58
    s_cmp_lt_u32 s28, 80
    s_cbranch_scc0 main_kernel_w_d_59
    s_mov_b32 s36, 0x4b088040
    s_branch main_kernel_w_dec
main_kernel_w_d_59:
    s_cmp_lt_u32 s28, 96
    s_cbranch_scc0 main_kernel_w_d_60
    s_mov_b32 s36, 0x4102050
    s_branch main_kernel_w_dec
main_kernel_w_d_60:
    s_mov_b32 s36, 0x67191060
    s_branch main_kernel_w_dec
main_kernel_w_d_58:
    s_cmp_lt_u32 s28, 128
    s_cbranch_scc0 main_kernel_w_d_61
    s_cmp_lt_u32 s28, 120
    s_cbranch_scc0 main_kernel_w_d_62
    s_mov_b32 s36, 0x4182068
    s_branch main_kernel_w_dec
main_kernel_w_d_62:
    s_mov_b32 s36, 0x64191078
    s_branch main_kernel_w_dec
main_kernel_w_d_61:
    s_cmp_lt_u32 s28, 144
    s_cbranch_scc0 main_kernel_w_d_63
    s_mov_b32 s36, 0x48109080
    s_branch main_kernel_w_dec
main_kernel_w_d_63:
    s_mov_b32 s36, 0x8182890
    s_branch main_kernel_w_dec
main_kernel_w_d_51:
    s_cmp_lt_u32 s28, 222
    s_cbranch_scc0 main_kernel_w_d_64
    s_cmp_lt_u32 s28, 182
    s_cbranch_scc0 main_kernel_w_d_65
    s_cmp_lt_u32 s28, 166
    s_cbranch_scc0 main_kernel_w_d_66
    s_mov_b32 s36, 0x66c130a0
    s_branch main_kernel_w_dec
main_kernel_w_d_66:
    s_cmp_lt_u32 s28, 174
    s_cbranch_scc0 main_kernel_w_d_67
    s_mov_b32 s36, 0x661900a6
    s_branch main_kernel_w_dec
main_kernel_w_d_67:
    s_mov_b32 s36, 0x651130ae
    s_branch main_kernel_w_dec
main_kernel_w_d_65:
    s_cmp_lt_u32 s28, 190
    s_cbranch_scc0 main_kernel_w_d_68
    s_mov_b32 s36, 0x651930b6
    s_branch main_kernel_w_dec
main_kernel_w_d_68:
    s_cmp_lt_u32 s28, 206
    s_cbranch_scc0 main_kernel_w_d_69
    s_mov_b32 s36, 0x81038be
    s_branch main_kernel_w_dec
main_kernel_w_d_69:
    s_mov_b32 s36, 0x88838ce
    s_branch main_kernel_w_dec
main_kernel_w_d_64:
    s_cmp_lt_u32 s28, 246
    s_cbranch_scc0 main_kernel_w_d_70
    s_cmp_lt_u32 s28, 230
    s_cbranch_scc0 main_kernel_w_d_71
    s_mov_b32 s36, 0x840de
    s_branch main_kernel_w_dec
main_kernel_w_d_71:
    s_cmp_lt_u32 s28, 238
    s_cbranch_scc0 main_kernel_w_d_72
    s_mov_b32 s36, 0x1240e6
    s_branch main_kernel_w_dec
main_kernel_w_d_72:
    s_mov_b32 s36, 0xe40ee
    s_branch main_kernel_w_dec
main_kernel_w_d_70:
    s_cmp_lt_u32 s28, 262
    s_cbranch_scc0 main_kernel_w_d_73
    s_cmp_lt_u32 s28, 254
    s_cbranch_scc0 main_kernel_w_d_74
    s_mov_b32 s36, 0x240f6
    s_branch main_kernel_w_dec
main_kernel_w_d_74:
    s_mov_b32 s36, 0x1040fe
    s_branch main_kernel_w_dec
main_kernel_w_d_73:
    s_cmp_lt_u32 s28, 270
    s_cbranch_scc0 main_kernel_w_d_75
    s_mov_b32 s36, 0x4106
    s_branch main_kernel_w_dec
main_kernel_w_d_75:
    s_mov_b32 s36, 0xffffffff
    s_branch main_kernel_w_dec
main_kernel_w_q4:
    s_cmp_lg_u32 s27, 4
    s_cbranch_scc1 main_kernel_w_q5
    s_cmp_lt_u32 s28, 128
    s_cbranch_scc0 main_kernel_w_d_76
    s_cmp_lt_u32 s28, 56
    s_cbranch_scc0 main_kernel_w_d_77
    s_cmp_lt_u32 s28, 24
    s_cbranch_scc0 main_kernel_w_d_78
    s_cmp_lt_u32 s28, 8
    s_cbranch_scc0 main_kernel_w_d_79
    s_mov_b32 s36, 0x2000800
    s_branch main_kernel_w_dec
main_kernel_w_d_79:
    s_cmp_lt_u32 s28, 16
    s_cbranch_scc0 main_kernel_w_d_80
    s_mov_b32 s36, 0x2001008
    s_branch main_kernel_w_dec
main_kernel_w_d_80:
    s_mov_b32 s36, 0x46028810
    s_branch main_kernel_w_dec
main_kernel_w_d_78:
    s_cmp_lt_u32 s28, 32
    s_cbranch_scc0 main_kernel_w_d_81
    s_mov_b32 s36, 0x46029018
    s_branch main_kernel_w_dec
main_kernel_w_d_81:
    s_cmp_lt_u32 s28, 48
    s_cbranch_scc0 main_kernel_w_d_82
    s_mov_b32 s36, 0x48109820
    s_branch main_kernel_w_dec
main_kernel_w_d_82:
    s_mov_b32 s36, 0x42069030
    s_branch main_kernel_w_dec
main_kernel_w_d_77:
    s_cmp_lt_u32 s28, 88
    s_cbranch_scc0 main_kernel_w_d_83
    s_cmp_lt_u32 s28, 64
    s_cbranch_scc0 main_kernel_w_d_84
    s_mov_b32 s36, 0x65091038
    s_branch main_kernel_w_dec
main_kernel_w_d_84:
    s_cmp_lt_u32 s28, 72
    s_cbranch_scc0 main_kernel_w_d_85
    s_mov_b32 s36, 0x65090840
    s_branch main_kernel_w_dec
main_kernel_w_d_85:
    s_mov_b32 s36, 0x48088848
    s_branch main_kernel_w_dec
main_kernel_w_d_83:
    s_cmp_lt_u32 s28, 104
    s_cbranch_scc0 main_kernel_w_d_86
    s_mov_b32 s36, 0x49108858
    s_branch main_kernel_w_dec
main_kernel_w_d_86:
    s_cmp_lt_u32 s28, 120
    s_cbranch_scc0 main_kernel_w_d_87
    s_mov_b32 s36, 0x4a108068
    s_branch main_kernel_w_dec
main_kernel_w_d_87:
    s_mov_b32 s36, 0x64110078
    s_branch main_kernel_w_dec
main_kernel_w_d_76:
    s_cmp_lt_u32 s28, 190
    s_cbranch_scc0 main_kernel_w_d_88
    s_cmp_lt_u32 s28, 150
    s_cbranch_scc0 main_kernel_w_d_89
    s_cmp_lt_u32 s28, 136
    s_cbranch_scc0 main_kernel_w_d_90
    s_mov_b32 s36, 0x65191080
    s_branch main_kernel_w_dec
main_kernel_w_d_90:
    s_cmp_lt_u32 s28, 142
    s_cbranch_scc0 main_kernel_w_d_91
    s_mov_b32 s36, 0x66c93088
    s_branch main_kernel_w_dec
main_kernel_w_d_91:
    s_mov_b32 s36, 0x6411308e
    s_branch main_kernel_w_dec
main_kernel_w_d_89:
    s_cmp_lt_u32 s28, 166
    s_cbranch_scc0 main_kernel_w_d_92
    s_mov_b32 s36, 0x49188896
    s_branch main_kernel_w_dec
main_kernel_w_d_92:
    s_cmp_lt_u32 s28, 182
    s_cbranch_scc0 main_kernel_w_d_93
    s_mov_b32 s36, 0x80038a6
    s_branch main_kernel_w_dec
main_kernel_w_d_93:
    s_mov_b32 s36, 0x671908b6
    s_branch main_kernel_w_dec
main_kernel_w_d_88:
    s_cmp_lt_u32 s28, 214
    s_cbranch_scc0 main_kernel_w_d_94
    s_cmp_lt_u32 s28, 198
    s_cbranch_scc0 main_kernel_w_d_95
    s_mov_b32 s36, 0x641900be
    s_branch main_kernel_w_dec
main_kernel_w_d_95:
    s_cmp_lt_u32 s28, 206
    s_cbranch_scc0 main_kernel_w_d_96
    s_mov_b32 s36, 0x440c6
    s_branch main_kernel_w_dec
main_kernel_w_d_96:
    s_mov_b32 s36, 0x640ce
    s_branch main_kernel_w_dec
main_kernel_w_d_94:
    s_cmp_lt_u32 s28, 222
    s_cbranch_scc0 main_kernel_w_d_97
    s_mov_b32 s36, 0xc40d6
    s_branch main_kernel_w_dec
main_kernel_w_d_97:
    s_cmp_lt_u32 s28, 230
    s_cbranch_scc0 main_kernel_w_d_98
    s_mov_b32 s36, 0xa40de
    s_branch main_kernel_w_dec
main_kernel_w_d_98:
    s_mov_b32 s36, 0xffffffff
    s_branch main_kernel_w_dec
main_kernel_w_q5:
    s_cmp_lt_u32 s28, 112
    s_cbranch_scc0 main_kernel_w_d_99
    s_cmp_lt_u32 s28, 40
    s_cbranch_scc0 main_kernel_w_d_100
    s_cmp_lt_u32 s28, 16
    s_cbranch_scc0 main_kernel_w_d_101
    s_cmp_lt_u32 s28, 8
    s_cbranch_scc0 main_kernel_w_d_102
    s_mov_b32 s36, 0x3000800
    s_branch main_kernel_w_dec
main_kernel_w_d_102:
    s_mov_b32 s36, 0x3001008
    s_branch main_kernel_w_dec
main_kernel_w_d_101:
    s_cmp_lt_u32 s28, 24
    s_cbranch_scc0 main_kernel_w_d_103
    s_mov_b32 s36, 0x47028810
    s_branch main_kernel_w_dec
main_kernel_w_d_103:
    s_cmp_lt_u32 s28, 32
    s_cbranch_scc0 main_kernel_w_d_104
    s_mov_b32 s36, 0x47029018
    s_branch main_kernel_w_dec
main_kernel_w_d_104:
    s_mov_b32 s36, 0x66190820
    s_branch main_kernel_w_dec
main_kernel_w_d_100:
    s_cmp_lt_u32 s28, 80
    s_cbranch_scc0 main_kernel_w_d_105
    s_cmp_lt_u32 s28, 48
    s_cbranch_scc0 main_kernel_w_d_106
    s_mov_b32 s36, 0x66090828
    s_branch main_kernel_w_dec
main_kernel_w_d_106:
    s_cmp_lt_u32 s28, 64
    s_cbranch_scc0 main_kernel_w_d_107
    s_mov_b32 s36, 0x46008030
    s_branch main_kernel_w_dec
main_kernel_w_d_107:
    s_mov_b32 s36, 0x4002040
    s_branch main_kernel_w_dec
main_kernel_w_d_105:
    s_cmp_lt_u32 s28, 96
    s_cbranch_scc0 main_kernel_w_d_108
    s_mov_b32 s36, 0x46048050
    s_branch main_kernel_w_dec
main_kernel_w_d_108:
    s_cmp_lt_u32 s28, 104
    s_cbranch_scc0 main_kernel_w_d_109
    s_mov_b32 s36, 0x66191060
    s_branch main_kernel_w_dec
main_kernel_w_d_109:
    s_mov_b32 s36, 0x67111068
    s_branch main_kernel_w_dec
main_kernel_w_d_99:
    s_cmp_lt_u32 s28, 184
    s_cbranch_scc0 main_kernel_w_d_110
    s_cmp_lt_u32 s28, 152
    s_cbranch_scc0 main_kernel_w_d_111
    s_cmp_lt_u32 s28, 128
    s_cbranch_scc0 main_kernel_w_d_112
    s_mov_b32 s36, 0x8082870
    s_branch main_kernel_w_dec
main_kernel_w_d_112:
    s_cmp_lt_u32 s28, 144
    s_cbranch_scc0 main_kernel_w_d_113
    s_mov_b32 s36, 0x8105080
    s_branch main_kernel_w_dec
main_kernel_w_d_113:
    s_mov_b32 s36, 0x67110090
    s_branch main_kernel_w_dec
main_kernel_w_d_111:
    s_cmp_lt_u32 s28, 168
    s_cbranch_scc0 main_kernel_w_d_114
    s_mov_b32 s36, 0x8102898
    s_branch main_kernel_w_dec
main_kernel_w_d_114:
    s_cmp_lt_u32 s28, 176
    s_cbranch_scc0 main_kernel_w_d_115
    s_mov_b32 s36, 0x661110a8
    s_branch main_kernel_w_dec
main_kernel_w_d_115:
    s_mov_b32 s36, 0x651110b0
    s_branch main_kernel_w_dec
main_kernel_w_d_110:
    s_cmp_lt_u32 s28, 218
    s_cbranch_scc0 main_kernel_w_d_116
    s_cmp_lt_u32 s28, 190
    s_cbranch_scc0 main_kernel_w_d_117
    s_mov_b32 s36, 0x660930b8
    s_branch main_kernel_w_dec
main_kernel_w_d_117:
    s_cmp_lt_u32 s28, 206
    s_cbranch_scc0 main_kernel_w_d_118
    s_mov_b32 s36, 0x4b1880be
    s_branch main_kernel_w_dec
main_kernel_w_d_118:
    s_mov_b32 s36, 0x4a18b0ce
    s_branch main_kernel_w_dec
main_kernel_w_d_116:
    s_cmp_lt_u32 s28, 234
    s_cbranch_scc0 main_kernel_w_d_119
    s_mov_b32 s36, 0x80838da
    s_branch main_kernel_w_dec
main_kernel_w_d_119:
    s_cmp_lt_u32 s28, 250
    s_cbranch_scc0 main_kernel_w_d_120
    s_mov_b32 s36, 0x81838ea
    s_branch main_kernel_w_dec
main_kernel_w_d_120:
    s_mov_b32 s36, 0xffffffff
    s_branch main_kernel_w_dec
main_kernel_w_dec:
    s_cmp_lg_u32 s36, -1
    s_cbranch_scc1 main_kernel_w_got
    s_add_u32 s27, s27, 1
    s_cmp_ge_u32 s27, 6
    s_cselect_b32 s27, 0, s27
    s_add_u32 s52, s52, 1
    s_lshl_b32 s32, 1, s12
    s_and_b32 s32, s32, 116
    s_cselect_b32 s36, -2, -1
    s_cbranch_scc1 main_kernel_w_pub
    s_lshl_b32 s32, s12, 5
    s_add_u32 s32, s32, s13
    s_sub_u32 s32, s32, 224
    s_cmp_lt_u32 s32, 16
    s_cselect_b32 s52, 6, s52
    s_cmp_lt_u32 s52, 6
    s_cbranch_scc1 main_kernel_w_try
    s_lshl_b32 s32, s12, 5
    s_add_u32 s32, s32, s13
    s_sub_u32 s32, s32, 160
    s_cmp_lt_u32 s32, 80
    s_cselect_b32 s36, -3, -1
    s_cmp_lt_u32 s32, 64
    s_cselect_b32 s36, -2, s36
    s_branch main_kernel_w_pub
main_kernel_w_got:
    s_and_b32 s32, s36, 0x7ff
    s_sub_u32 s28, s28, s32
    s_bfe_u32 s32, s36, 0x3001a
    s_lshr_b32 s25, s28, s32
    s_lshl_b32 s33, s25, s32
    s_sub_u32 s24, s28, s33
    s_bfe_u32 s34, s36, 0x1001d
    s_lshl_b32 s24, s24, s34
    s_bfe_u32 s35, s36, 0x1001e
    s_lshl_b32 s25, s25, s35
    s_bfe_u32 s32, s36, 0x40011
    s_add_u32 s24, s24, s32
    s_bfe_u32 s32, s36, 0x50015
    s_add_u32 s25, s25, s32
    s_bfe_u32 s23, s36, 0x4000b
    s_bfe_u32 s36, s36, 0x6000b
    s_lshl_b32 s32, s24, 8
    s_or_b32 s36, s36, s32
    s_lshl_b32 s32, s25, 16
    s_or_b32 s36, s36, s32
    s_cmp_eq_u32 s23, 8
    s_cbranch_scc1 main_kernel_w_dwo
    s_cmp_ge_u32 s23, 10
    s_cbranch_scc1 main_kernel_w_pub
    s_mov_b32 s48, s24
    s_add_u32 s49, s24, s34
    s_mov_b32 s50, 4
    s_mov_b32 s51, 7
    s_cmp_lg_u32 s23, 4
    s_cbranch_scc1 main_kernel_w_dp1
    s_sub_u32 s48, s48, 1
    s_max_i32 s48, s48, 0
    s_add_u32 s49, s49, 1
    s_min_u32 s49, s49, 15
main_kernel_w_dp1:
    s_cmp_eq_u32 s23, 6
    s_cselect_b32 s51, 3, s51
    s_cmp_eq_u32 s23, 7
    s_cselect_b32 s51, 27, s51
    s_cselect_b32 s50, 5, s50
    v_lshrrev_b32 v253, s50, v250
    v_lshlrev_b32 v254, s50, v253
    v_sub_u32 v254, v250, v254
    v_min_u32 v254, s51, v254
    v_add_u32 v253, s48, v253
    v_min_u32 v253, s49, v253
    v_lshlrev_b32 v253, 9, v253
    v_lshl_add_u32 v253, v254, 4, v253
    s_cmp_lt_u32 s23, 4
    s_cselect_b32 s39, 10, s23
    s_lshl_b32 s39, s39, 13
    s_cmp_eq_u32 s23, 3
    s_cselect_b32 s32, 4, 0
    s_add_u32 s39, s39, s32
    s_add_u32 s39, s39, 0x8402000
main_kernel_w_poll:
    buffer_load_dword v254, v253, s[4:7], s39 offen sc1
    s_waitcnt vmcnt(0)
    v_cmp_eq_u32 vcc, 0, v254
    s_cmp_eq_u32 s57, 0
    s_cbranch_scc1 main_kernel_w_fl2
    s_waitcnt vmcnt(0)
    s_barrier
    v_mov_b32 v4, 1
    v_mov_b32 v5, 1
    v_mov_b32 v6, 1
    v_mov_b32 v7, 1
    s_bfm_b64 exec, s57, 0
    buffer_store_dwordx4 v[4:7], v249, s[4:7], s56 offen sc1
    s_mov_b64 exec, -1
    s_mov_b32 s57, 0
main_kernel_w_fl2:
    s_cbranch_vccz main_kernel_w_pub
    s_sleep 8
    s_sub_u32 s29, s29, 1
    s_cbranch_scc0 main_kernel_w_poll
    s_mov_b32 s36, -1
    s_branch main_kernel_w_pub
main_kernel_w_dwo:
    s_lshl_b32 s39, s24, 10
    s_add_u32 s39, s39, 0x8400000
main_kernel_w_pollo:
    buffer_load_dwordx4 v[0:3], v251, s[4:7], s39 offen sc1
    s_waitcnt vmcnt(0)
    v_min3_u32 v0, v0, v1, v2
    v_min_u32 v0, v0, v3
    v_cmp_eq_u32 vcc, 0, v0
    s_cmp_eq_u32 s57, 0
    s_cbranch_scc1 main_kernel_w_fl3
    s_waitcnt vmcnt(0)
    s_barrier
    v_mov_b32 v4, 1
    v_mov_b32 v5, 1
    v_mov_b32 v6, 1
    v_mov_b32 v7, 1
    s_bfm_b64 exec, s57, 0
    buffer_store_dwordx4 v[4:7], v249, s[4:7], s56 offen sc1
    s_mov_b64 exec, -1
    s_mov_b32 s57, 0
main_kernel_w_fl3:
    s_cbranch_vccz main_kernel_w_oko
    s_sleep 16
    s_sub_u32 s29, s29, 1
    s_cbranch_scc0 main_kernel_w_pollo
    s_mov_b32 s36, -1
    s_branch main_kernel_w_pub
main_kernel_w_oko:
    v_min_u32 v253, s35, v250
    v_add_u32 v253, s25, v253
    v_lshlrev_b32 v253, 8, v253
    s_lshl_b32 s39, s24, 4
    s_add_u32 s39, s39, 0x8412000
    s_branch main_kernel_w_poll
main_kernel_w_pub:
    s_cmp_eq_u32 s57, 0
    s_cbranch_scc1 main_kernel_w_fl4
    s_waitcnt vmcnt(0)
    s_barrier
    v_mov_b32 v4, 1
    v_mov_b32 v5, 1
    v_mov_b32 v6, 1
    v_mov_b32 v7, 1
    s_bfm_b64 exec, s57, 0
    buffer_store_dwordx4 v[4:7], v249, s[4:7], s56 offen sc1
    s_mov_b64 exec, -1
    s_mov_b32 s57, 0
main_kernel_w_fl4:
    v_mov_b32 v253, 131072
    v_mov_b32 v254, s36
    ds_write_b32 v253, v254
    s_waitcnt lgkmcnt(0)
main_kernel_w_bar:
    s_barrier
    v_mov_b32 v253, 131072
    ds_read_b32 v254, v253
    s_waitcnt lgkmcnt(0)
    v_readfirstlane_b32 s36, v254
    s_nop 3
    s_cmp_eq_u32 s36, -1
    s_cbranch_scc1 main_kernel_end2
    s_cmp_eq_u32 s36, -2
    s_cbranch_scc1 main_kernel_wo
    s_cmp_eq_u32 s36, -3
    s_cbranch_scc1 main_kernel_att2
    s_mov_b32 s55, -1
    s_and_b32 s23, s36, 15
    s_bfe_u32 s54, s36, 0x20004
    s_bfe_u32 s24, s36, 0x80008
    s_lshr_b32 s25, s36, 16
    s_cmp_eq_u32 s23, 5
    s_cbranch_scc1 main_kernel_w_ln2
    s_cmp_eq_u32 s23, 10
    s_cbranch_scc1 main_kernel_w_fill
    s_cmp_eq_u32 s23, 11
    s_cbranch_scc1 main_kernel_w_pref
    s_cmp_eq_u32 s54, 1
    s_cbranch_scc1 main_kernel_w_c1_task
    s_cmp_eq_u32 s54, 2
    s_cbranch_scc1 main_kernel_w_c2_task
main_kernel_w_c0_task:
    s_cmp_eq_u32 s23, 1
    s_cbranch_scc1 main_kernel_w_c0_set1
    s_cmp_eq_u32 s23, 2
    s_cbranch_scc1 main_kernel_w_c0_set2
    s_cmp_eq_u32 s23, 4
    s_cbranch_scc1 main_kernel_w_c0_set4
    s_cmp_eq_u32 s23, 7
    s_cbranch_scc1 main_kernel_w_c0_set7
    s_cmp_eq_u32 s23, 8
    s_cbranch_scc1 main_kernel_w_c0_set8
    s_branch main_kernel_w_done
main_kernel_w_c0_set1:
    s_lshl_b32 s32, s25, 8
    s_add_u32 s8, s42, s32
    s_addc_u32 s9, s43, 0
    s_and_b32 s9, s9, 0xffff
    s_sub_u32 s10, 0x800000, s32
    s_mov_b32 s11, 0x20000
    s_mov_b32 s30, 8192
    s_mov_b32 s31, 32768
    s_mul_i32 s16, s24, 262144
    s_add_u32 s16, s16, 0x0
    s_mov_b32 s18, 3
    s_lshl_b32 s32, s24, 3
    s_mul_i32 s33, s38, 4
    s_add_u32 s32, s32, s33
    s_mul_i32 s32, s32, 131072
    s_lshl_b32 s33, s25, 12
    s_add_u32 s32, s32, s33
    s_mul_i32 s33, s37, 2048
    s_add_u32 s32, s32, s33
    s_add_u32 s21, s32, 0x1800000
    s_mov_b32 s22, 131072
    s_mov_b32 s26, -1
    s_branch main_kernel_w_c0_go
main_kernel_w_c0_set2:
    s_lshl_b32 s32, s25, 8
    s_add_u32 s8, s44, s32
    s_addc_u32 s9, s45, 0
    s_and_b32 s9, s9, 0xffff
    s_sub_u32 s10, 0x800000, s32
    s_mov_b32 s11, 0x20000
    s_mov_b32 s30, 8192
    s_mov_b32 s31, 32768
    s_mul_i32 s16, s24, 262144
    s_add_u32 s16, s16, 0x0
    s_mov_b32 s18, 3
    s_lshl_b32 s32, s24, 2
    s_mul_i32 s33, s38, 2
    s_add_u32 s32, s32, s33
    s_lshl_b32 s32, s32, 18
    s_lshl_b32 s33, s25, 13
    s_add_u32 s32, s32, s33
    s_mul_i32 s33, s37, 4096
    s_add_u32 s32, s32, s33
    s_add_u32 s21, s32, 0x2800000
    s_branch main_kernel_w_c0_gov
main_kernel_w_c0_set4:
    s_lshl_b32 s32, s25, 8
    s_add_u32 s8, s66, s32
    s_addc_u32 s9, s67, 0
    s_and_b32 s9, s9, 0xffff
    s_sub_u32 s10, 0x200000, s32
    s_mov_b32 s11, 0x20000
    s_mov_b32 s30, 2048
    s_mov_b32 s31, 32768
    s_mul_i32 s16, s24, 262144
    s_add_u32 s16, s16, 0x4808000
    s_mov_b32 s18, 3
    s_lshl_b32 s32, s24, 3
    s_mul_i32 s33, s38, 4
    s_add_u32 s32, s32, s33
    s_mul_i32 s32, s32, 32768
    s_lshl_b32 s33, s25, 12
    s_add_u32 s32, s32, s33
    s_mul_i32 s33, s37, 2048
    s_add_u32 s32, s32, s33
    s_add_u32 s21, s32, 0x5000000
    s_mov_b32 s22, 32768
    s_add_u32 s26, s32, 0x0
    s_branch main_kernel_w_c0_go
main_kernel_w_c0_set7:
    s_lshl_b32 s32, s25, 8
    s_add_u32 s8, s70, s32
    s_addc_u32 s9, s71, 0
    s_and_b32 s9, s9, 0xffff
    s_sub_u32 s10, 0x700000, s32
    s_mov_b32 s11, 0x20000
    s_mov_b32 s30, 2048
    s_mov_b32 s31, 114688
    s_mul_i32 s16, s24, 917504
    s_add_u32 s16, s16, 0x5400000
    s_mov_b32 s18, 13
    s_lshl_b32 s32, s24, 3
    s_mul_i32 s33, s38, 4
    s_add_u32 s32, s32, s33
    s_mul_i32 s32, s32, 32768
    s_lshl_b32 s33, s25, 12
    s_add_u32 s32, s32, s33
    s_mul_i32 s33, s37, 2048
    s_add_u32 s32, s32, s33
    s_add_u32 s21, s32, 0x6400000
    s_mov_b32 s22, 32768
    s_add_u32 s26, s32, 0x5000000
    s_branch main_kernel_w_c0_go
main_kernel_w_c0_set8:
    s_lshl_b32 s32, s25, 8
    s_add_u32 s8, s46, s32
    s_addc_u32 s9, s47, 0
    s_and_b32 s9, s9, 0xffff
    s_sub_u32 s10, 0x800000, s32
    s_mov_b32 s11, 0x20000
    s_mov_b32 s30, 2048
    s_mov_b32 s31, 131072
    s_mul_i32 s16, s24, 1048576
    s_add_u32 s16, s16, 0x3800000
    s_mov_b32 s18, 15
    s_lshl_b32 s32, s24, 3
    s_mul_i32 s33, s38, 4
    s_add_u32 s32, s32, s33
    s_mul_i32 s32, s32, 32768
    s_lshl_b32 s33, s25, 8
    s_add_u32 s34, s32, s33
    s_mul_i32 s33, s37, 128
    s_add_u32 s34, s34, s33
    s_lshl_b32 s33, s25, 12
    s_add_u32 s32, s32, s33
    s_mul_i32 s33, s37, 2048
    s_add_u32 s32, s32, s33
    s_add_u32 s21, s32, 0x0
    s_mov_b32 s22, 32768
    s_add_u32 s26, s32, 0x6400000
    s_mov_b32 s21, s34
    v_and_b32 v253, 15, v250
    v_and_b32 v254, 48, v250
    v_lshl_add_u32 v252, v253, 11, v254
    s_branch main_kernel_w_c0_go
main_kernel_w_c0_go:
    v_lshrrev_b32 v0, 4, v250
    v_bfe_u32 v1, v250, 2, 2
    v_lshl_add_u32 v4, v0, 2, v1
    v_and_b32 v5, 7, v4
    v_mul_u32_u24 v4, 256, v4
    v_and_b32 v6, 3, v250
    v_lshl_add_u32 v4, v6, 3, v4
    s_mul_i32 s32, s37, 4
    v_xor_b32 v5, s32, v5
    v_lshl_add_u32 v128, v5, 5, v4
    v_xor_b32 v129, 32, v128
    v_xor_b32 v130, 64, v128
    v_xor_b32 v131, 96, v128
    s_mul_i32 s32, s38, 8192
    s_add_u32 s32, s32, 65536
    v_add_u32 v136, s32, v251
    v_lshrrev_b32 v2, 4, v250
    v_and_b32 v3, 15, v250
    s_mul_i32 s32, s14, 16
    v_add_u32 v4, s32, v2
    v_add_u32 v5, 0, v4
    v_and_b32 v6, 7, v5
    v_lshlrev_b32 v6, 1, v6
    v_xor_b32 v6, v6, v3
    v_mul_lo_u32 v5, v5, s30
    v_lshl_add_u32 v5, v6, 4, v5
    v_subrev_u32 v137, 0, v5
    v_add_u32 v5, 4, v4
    v_and_b32 v6, 7, v5
    v_lshlrev_b32 v6, 1, v6
    v_xor_b32 v6, v6, v3
    v_mul_lo_u32 v5, v5, s30
    v_lshl_add_u32 v5, v6, 4, v5
    v_subrev_u32 v138, 1024, v5
    v_add_u32 v5, 8, v4
    v_and_b32 v6, 7, v5
    v_lshlrev_b32 v6, 1, v6
    v_xor_b32 v6, v6, v3
    v_mul_lo_u32 v5, v5, s30
    v_lshl_add_u32 v5, v6, 4, v5
    v_subrev_u32 v139, 2048, v5
    v_add_u32 v5, 12, v4
    v_and_b32 v6, 7, v5
    v_lshlrev_b32 v6, 1, v6
    v_xor_b32 v6, v6, v3
    v_mul_lo_u32 v5, v5, s30
    v_lshl_add_u32 v5, v6, 4, v5
    v_subrev_u32 v140, 3072, v5
    s_mul_i32 s32, s14, 2
    s_mul_i32 s32, s32, s31
    v_add_u32 v141, s32, v251
    s_add_u32 s32, s32, s31
    s_sub_u32 s32, s32, 2048
    v_add_u32 v142, s32, v251
    s_mul_i32 s19, s14, 4096
    s_mul_i32 s20, s14, 4096
    s_add_u32 s20, s20, 65536
    s_mul_i32 s17, s30, 64
    s_mov_b32 s15, 0
    s_add_u32 m0, s20, 0
    s_nop 0
    buffer_load_dwordx4 v141, s[4:7], s16 offen offset:0 sc1 lds
    buffer_load_dwordx4 v141, s[4:7], s16 offen offset:1024 sc1 lds
    buffer_load_dwordx4 v142, s[4:7], s16 offen offset:2048 sc1 lds
    buffer_load_dwordx4 v142, s[4:7], s16 offen offset:3072 sc1 lds
    s_add_u32 s16, s16, 2048
    s_add_u32 m0, s19, 0
    s_nop 0
    buffer_load_dwordx4 v137, s[8:11], s15 offen offset:0 lds
    buffer_load_dwordx4 v138, s[8:11], s15 offen offset:1024 lds
    buffer_load_dwordx4 v139, s[8:11], s15 offen offset:2048 lds
    buffer_load_dwordx4 v140, s[8:11], s15 offen offset:3072 lds
    s_add_u32 s15, s15, s17
    s_add_u32 m0, s20, 16384
    s_nop 0
    buffer_load_dwordx4 v141, s[4:7], s16 offen offset:0 sc1 lds
    buffer_load_dwordx4 v141, s[4:7], s16 offen offset:1024 sc1 lds
    buffer_load_dwordx4 v142, s[4:7], s16 offen offset:2048 sc1 lds
    buffer_load_dwordx4 v142, s[4:7], s16 offen offset:3072 sc1 lds
    s_add_u32 s16, s16, 2048
    s_add_u32 m0, s19, 16384
    s_nop 0
    buffer_load_dwordx4 v137, s[8:11], s15 offen offset:0 lds
    buffer_load_dwordx4 v138, s[8:11], s15 offen offset:1024 lds
    buffer_load_dwordx4 v139, s[8:11], s15 offen offset:2048 lds
    buffer_load_dwordx4 v140, s[8:11], s15 offen offset:3072 lds
    s_add_u32 s15, s15, s17
    s_add_u32 m0, s20, 32768
    s_nop 0
    buffer_load_dwordx4 v141, s[4:7], s16 offen offset:0 sc1 lds
    buffer_load_dwordx4 v141, s[4:7], s16 offen offset:1024 sc1 lds
    buffer_load_dwordx4 v142, s[4:7], s16 offen offset:2048 sc1 lds
    buffer_load_dwordx4 v142, s[4:7], s16 offen offset:3072 sc1 lds
    s_add_u32 s16, s16, 2048
    s_add_u32 m0, s19, 32768
    s_nop 0
    buffer_load_dwordx4 v137, s[8:11], s15 offen offset:0 lds
    buffer_load_dwordx4 v138, s[8:11], s15 offen offset:1024 lds
    buffer_load_dwordx4 v139, s[8:11], s15 offen offset:2048 lds
    buffer_load_dwordx4 v140, s[8:11], s15 offen offset:3072 lds
    s_add_u32 s15, s15, s17
    s_add_u32 m0, s20, 49152
    s_nop 0
    buffer_load_dwordx4 v141, s[4:7], s16 offen offset:0 sc1 lds
    buffer_load_dwordx4 v141, s[4:7], s16 offen offset:1024 sc1 lds
    buffer_load_dwordx4 v142, s[4:7], s16 offen offset:2048 sc1 lds
    buffer_load_dwordx4 v142, s[4:7], s16 offen offset:3072 sc1 lds
    s_add_u32 s16, s16, 2048
    v_mov_b32 v64, 0
    v_mov_b32 v65, 0
    v_mov_b32 v66, 0
    v_mov_b32 v67, 0
    v_mov_b32 v68, 0
    v_mov_b32 v69, 0
    v_mov_b32 v70, 0
    v_mov_b32 v71, 0
    v_mov_b32 v72, 0
    v_mov_b32 v73, 0
    v_mov_b32 v74, 0
    v_mov_b32 v75, 0
    v_mov_b32 v76, 0
    v_mov_b32 v77, 0
    v_mov_b32 v78, 0
    v_mov_b32 v79, 0
    v_mov_b32 v80, 0
    v_mov_b32 v81, 0
    v_mov_b32 v82, 0
    v_mov_b32 v83, 0
    v_mov_b32 v84, 0
    v_mov_b32 v85, 0
    v_mov_b32 v86, 0
    v_mov_b32 v87, 0
    v_mov_b32 v88, 0
    v_mov_b32 v89, 0
    v_mov_b32 v90, 0
    v_mov_b32 v91, 0
    v_mov_b32 v92, 0
    v_mov_b32 v93, 0
    v_mov_b32 v94, 0
    v_mov_b32 v95, 0
    v_mov_b32 v96, 0
    v_mov_b32 v97, 0
    v_mov_b32 v98, 0
    v_mov_b32 v99, 0
    v_mov_b32 v100, 0
    v_mov_b32 v101, 0
    v_mov_b32 v102, 0
    v_mov_b32 v103, 0
    v_mov_b32 v104, 0
    v_mov_b32 v105, 0
    v_mov_b32 v106, 0
    v_mov_b32 v107, 0
    v_mov_b32 v108, 0
    v_mov_b32 v109, 0
    v_mov_b32 v110, 0
    v_mov_b32 v111, 0
    v_mov_b32 v112, 0
    v_mov_b32 v113, 0
    v_mov_b32 v114, 0
    v_mov_b32 v115, 0
    v_mov_b32 v116, 0
    v_mov_b32 v117, 0
    v_mov_b32 v118, 0
    v_mov_b32 v119, 0
    v_mov_b32 v120, 0
    v_mov_b32 v121, 0
    v_mov_b32 v122, 0
    v_mov_b32 v123, 0
    v_mov_b32 v124, 0
    v_mov_b32 v125, 0
    v_mov_b32 v126, 0
    v_mov_b32 v127, 0
    s_waitcnt vmcnt(20)
    s_barrier
    ds_read_b128 v[16:19], v136 offset:0
    ds_read_b64_tr_b16 v[0:1], v128 offset:0
    ds_read_b64_tr_b16 v[2:3], v128 offset:4096
    ds_read_b64_tr_b16 v[4:5], v129 offset:0
    ds_read_b64_tr_b16 v[6:7], v129 offset:4096
    ds_read_b64_tr_b16 v[8:9], v130 offset:0
    ds_read_b64_tr_b16 v[10:11], v130 offset:4096
    ds_read_b64_tr_b16 v[12:13], v131 offset:0
    ds_read_b64_tr_b16 v[14:15], v131 offset:4096
    ds_read_b128 v[20:23], v136 offset:2048
    ds_read_b128 v[24:27], v136 offset:4096
    ds_read_b128 v[28:31], v136 offset:6144
main_kernel_w_c0_n_loop:
    s_waitcnt lgkmcnt(0)
    ds_read_b128 v[48:51], v136 offset:1024
    s_add_u32 m0, s19, 49152
    s_nop 0
    v_mfma_f32_16x16x32_bf16 v[64:67], v[0:3], v[16:19], v[64:67]
    ds_read_b64_tr_b16 v[32:33], v128 offset:8192
    v_mfma_f32_16x16x32_bf16 v[68:71], v[4:7], v[16:19], v[68:71]
    ds_read_b64_tr_b16 v[34:35], v128 offset:12288
    buffer_load_dwordx4 v137, s[8:11], s15 offen offset:0 lds
    v_mfma_f32_16x16x32_bf16 v[72:75], v[8:11], v[16:19], v[72:75]
    ds_read_b64_tr_b16 v[36:37], v129 offset:8192
    v_mfma_f32_16x16x32_bf16 v[76:79], v[12:15], v[16:19], v[76:79]
    ds_read_b64_tr_b16 v[38:39], v129 offset:12288
    v_mfma_f32_16x16x32_bf16 v[80:83], v[0:3], v[20:23], v[80:83]
    ds_read_b64_tr_b16 v[40:41], v130 offset:8192
    buffer_load_dwordx4 v138, s[8:11], s15 offen offset:1024 lds
    v_mfma_f32_16x16x32_bf16 v[84:87], v[4:7], v[20:23], v[84:87]
    ds_read_b64_tr_b16 v[42:43], v130 offset:12288
    v_mfma_f32_16x16x32_bf16 v[88:91], v[8:11], v[20:23], v[88:91]
    ds_read_b64_tr_b16 v[44:45], v131 offset:8192
    v_mfma_f32_16x16x32_bf16 v[92:95], v[12:15], v[20:23], v[92:95]
    ds_read_b64_tr_b16 v[46:47], v131 offset:12288
    buffer_load_dwordx4 v139, s[8:11], s15 offen offset:2048 lds
    v_mfma_f32_16x16x32_bf16 v[96:99], v[0:3], v[24:27], v[96:99]
    ds_read_b128 v[52:55], v136 offset:3072
    v_mfma_f32_16x16x32_bf16 v[100:103], v[4:7], v[24:27], v[100:103]
    ds_read_b128 v[56:59], v136 offset:5120
    buffer_load_dwordx4 v140, s[8:11], s15 offen offset:3072 lds
    v_mfma_f32_16x16x32_bf16 v[104:107], v[8:11], v[24:27], v[104:107]
    ds_read_b128 v[60:63], v136 offset:7168
    v_mfma_f32_16x16x32_bf16 v[108:111], v[12:15], v[24:27], v[108:111]
    v_mfma_f32_16x16x32_bf16 v[112:115], v[0:3], v[28:31], v[112:115]
    s_add_u32 s15, s15, s17
    v_mfma_f32_16x16x32_bf16 v[116:119], v[4:7], v[28:31], v[116:119]
    v_mfma_f32_16x16x32_bf16 v[120:123], v[8:11], v[28:31], v[120:123]
    v_mfma_f32_16x16x32_bf16 v[124:127], v[12:15], v[28:31], v[124:127]
    s_waitcnt lgkmcnt(0)
    v_mfma_f32_16x16x32_bf16 v[64:67], v[32:35], v[48:51], v[64:67]
    s_waitcnt vmcnt(16)
    s_barrier
    ds_read_b128 v[16:19], v136 offset:16384
    s_add_u32 m0, s20, 0
    s_nop 0
    v_mfma_f32_16x16x32_bf16 v[68:71], v[36:39], v[48:51], v[68:71]
    ds_read_b64_tr_b16 v[0:1], v128 offset:16384
    v_mfma_f32_16x16x32_bf16 v[72:75], v[40:43], v[48:51], v[72:75]
    ds_read_b64_tr_b16 v[2:3], v128 offset:20480
    buffer_load_dwordx4 v141, s[4:7], s16 offen offset:0 sc1 lds
    v_mfma_f32_16x16x32_bf16 v[76:79], v[44:47], v[48:51], v[76:79]
    ds_read_b64_tr_b16 v[4:5], v129 offset:16384
    v_mfma_f32_16x16x32_bf16 v[80:83], v[32:35], v[52:55], v[80:83]
    ds_read_b64_tr_b16 v[6:7], v129 offset:20480
    v_mfma_f32_16x16x32_bf16 v[84:87], v[36:39], v[52:55], v[84:87]
    ds_read_b64_tr_b16 v[8:9], v130 offset:16384
    buffer_load_dwordx4 v141, s[4:7], s16 offen offset:1024 sc1 lds
    v_mfma_f32_16x16x32_bf16 v[88:91], v[40:43], v[52:55], v[88:91]
    ds_read_b64_tr_b16 v[10:11], v130 offset:20480
    v_mfma_f32_16x16x32_bf16 v[92:95], v[44:47], v[52:55], v[92:95]
    ds_read_b64_tr_b16 v[12:13], v131 offset:16384
    buffer_load_dwordx4 v142, s[4:7], s16 offen offset:2048 sc1 lds
    v_mfma_f32_16x16x32_bf16 v[96:99], v[32:35], v[56:59], v[96:99]
    ds_read_b64_tr_b16 v[14:15], v131 offset:20480
    v_mfma_f32_16x16x32_bf16 v[100:103], v[36:39], v[56:59], v[100:103]
    ds_read_b128 v[20:23], v136 offset:18432
    v_mfma_f32_16x16x32_bf16 v[104:107], v[40:43], v[56:59], v[104:107]
    ds_read_b128 v[24:27], v136 offset:20480
    buffer_load_dwordx4 v142, s[4:7], s16 offen offset:3072 sc1 lds
    v_mfma_f32_16x16x32_bf16 v[108:111], v[44:47], v[56:59], v[108:111]
    ds_read_b128 v[28:31], v136 offset:22528
    v_mfma_f32_16x16x32_bf16 v[112:115], v[32:35], v[60:63], v[112:115]
    s_add_u32 s16, s16, 2048
    v_mfma_f32_16x16x32_bf16 v[116:119], v[36:39], v[60:63], v[116:119]
    v_mfma_f32_16x16x32_bf16 v[120:123], v[40:43], v[60:63], v[120:123]
    v_mfma_f32_16x16x32_bf16 v[124:127], v[44:47], v[60:63], v[124:127]
    s_waitcnt lgkmcnt(0)
    ds_read_b128 v[48:51], v136 offset:17408
    s_add_u32 m0, s19, 0
    s_nop 0
    v_mfma_f32_16x16x32_bf16 v[64:67], v[0:3], v[16:19], v[64:67]
    ds_read_b64_tr_b16 v[32:33], v128 offset:24576
    v_mfma_f32_16x16x32_bf16 v[68:71], v[4:7], v[16:19], v[68:71]
    ds_read_b64_tr_b16 v[34:35], v128 offset:28672
    buffer_load_dwordx4 v137, s[8:11], s15 offen offset:0 lds
    v_mfma_f32_16x16x32_bf16 v[72:75], v[8:11], v[16:19], v[72:75]
    ds_read_b64_tr_b16 v[36:37], v129 offset:24576
    v_mfma_f32_16x16x32_bf16 v[76:79], v[12:15], v[16:19], v[76:79]
    ds_read_b64_tr_b16 v[38:39], v129 offset:28672
    v_mfma_f32_16x16x32_bf16 v[80:83], v[0:3], v[20:23], v[80:83]
    ds_read_b64_tr_b16 v[40:41], v130 offset:24576
    buffer_load_dwordx4 v138, s[8:11], s15 offen offset:1024 lds
    v_mfma_f32_16x16x32_bf16 v[84:87], v[4:7], v[20:23], v[84:87]
    ds_read_b64_tr_b16 v[42:43], v130 offset:28672
    v_mfma_f32_16x16x32_bf16 v[88:91], v[8:11], v[20:23], v[88:91]
    ds_read_b64_tr_b16 v[44:45], v131 offset:24576
    v_mfma_f32_16x16x32_bf16 v[92:95], v[12:15], v[20:23], v[92:95]
    ds_read_b64_tr_b16 v[46:47], v131 offset:28672
    buffer_load_dwordx4 v139, s[8:11], s15 offen offset:2048 lds
    v_mfma_f32_16x16x32_bf16 v[96:99], v[0:3], v[24:27], v[96:99]
    ds_read_b128 v[52:55], v136 offset:19456
    v_mfma_f32_16x16x32_bf16 v[100:103], v[4:7], v[24:27], v[100:103]
    ds_read_b128 v[56:59], v136 offset:21504
    buffer_load_dwordx4 v140, s[8:11], s15 offen offset:3072 lds
    v_mfma_f32_16x16x32_bf16 v[104:107], v[8:11], v[24:27], v[104:107]
    ds_read_b128 v[60:63], v136 offset:23552
    v_mfma_f32_16x16x32_bf16 v[108:111], v[12:15], v[24:27], v[108:111]
    v_mfma_f32_16x16x32_bf16 v[112:115], v[0:3], v[28:31], v[112:115]
    s_add_u32 s15, s15, s17
    v_mfma_f32_16x16x32_bf16 v[116:119], v[4:7], v[28:31], v[116:119]
    v_mfma_f32_16x16x32_bf16 v[120:123], v[8:11], v[28:31], v[120:123]
    v_mfma_f32_16x16x32_bf16 v[124:127], v[12:15], v[28:31], v[124:127]
    s_waitcnt lgkmcnt(0)
    v_mfma_f32_16x16x32_bf16 v[64:67], v[32:35], v[48:51], v[64:67]
    s_waitcnt vmcnt(16)
    s_barrier
    ds_read_b128 v[16:19], v136 offset:32768
    s_add_u32 m0, s20, 16384
    s_nop 0
    v_mfma_f32_16x16x32_bf16 v[68:71], v[36:39], v[48:51], v[68:71]
    ds_read_b64_tr_b16 v[0:1], v128 offset:32768
    v_mfma_f32_16x16x32_bf16 v[72:75], v[40:43], v[48:51], v[72:75]
    ds_read_b64_tr_b16 v[2:3], v128 offset:36864
    buffer_load_dwordx4 v141, s[4:7], s16 offen offset:0 sc1 lds
    v_mfma_f32_16x16x32_bf16 v[76:79], v[44:47], v[48:51], v[76:79]
    ds_read_b64_tr_b16 v[4:5], v129 offset:32768
    v_mfma_f32_16x16x32_bf16 v[80:83], v[32:35], v[52:55], v[80:83]
    ds_read_b64_tr_b16 v[6:7], v129 offset:36864
    v_mfma_f32_16x16x32_bf16 v[84:87], v[36:39], v[52:55], v[84:87]
    ds_read_b64_tr_b16 v[8:9], v130 offset:32768
    buffer_load_dwordx4 v141, s[4:7], s16 offen offset:1024 sc1 lds
    v_mfma_f32_16x16x32_bf16 v[88:91], v[40:43], v[52:55], v[88:91]
    ds_read_b64_tr_b16 v[10:11], v130 offset:36864
    v_mfma_f32_16x16x32_bf16 v[92:95], v[44:47], v[52:55], v[92:95]
    ds_read_b64_tr_b16 v[12:13], v131 offset:32768
    buffer_load_dwordx4 v142, s[4:7], s16 offen offset:2048 sc1 lds
    v_mfma_f32_16x16x32_bf16 v[96:99], v[32:35], v[56:59], v[96:99]
    ds_read_b64_tr_b16 v[14:15], v131 offset:36864
    v_mfma_f32_16x16x32_bf16 v[100:103], v[36:39], v[56:59], v[100:103]
    ds_read_b128 v[20:23], v136 offset:34816
    v_mfma_f32_16x16x32_bf16 v[104:107], v[40:43], v[56:59], v[104:107]
    ds_read_b128 v[24:27], v136 offset:36864
    buffer_load_dwordx4 v142, s[4:7], s16 offen offset:3072 sc1 lds
    v_mfma_f32_16x16x32_bf16 v[108:111], v[44:47], v[56:59], v[108:111]
    ds_read_b128 v[28:31], v136 offset:38912
    v_mfma_f32_16x16x32_bf16 v[112:115], v[32:35], v[60:63], v[112:115]
    s_add_u32 s16, s16, 2048
    v_mfma_f32_16x16x32_bf16 v[116:119], v[36:39], v[60:63], v[116:119]
    v_mfma_f32_16x16x32_bf16 v[120:123], v[40:43], v[60:63], v[120:123]
    v_mfma_f32_16x16x32_bf16 v[124:127], v[44:47], v[60:63], v[124:127]
    s_waitcnt lgkmcnt(0)
    ds_read_b128 v[48:51], v136 offset:33792
    s_add_u32 m0, s19, 16384
    s_nop 0
    v_mfma_f32_16x16x32_bf16 v[64:67], v[0:3], v[16:19], v[64:67]
    ds_read_b64_tr_b16 v[32:33], v128 offset:40960
    v_mfma_f32_16x16x32_bf16 v[68:71], v[4:7], v[16:19], v[68:71]
    ds_read_b64_tr_b16 v[34:35], v128 offset:45056
    buffer_load_dwordx4 v137, s[8:11], s15 offen offset:0 lds
    v_mfma_f32_16x16x32_bf16 v[72:75], v[8:11], v[16:19], v[72:75]
    ds_read_b64_tr_b16 v[36:37], v129 offset:40960
    v_mfma_f32_16x16x32_bf16 v[76:79], v[12:15], v[16:19], v[76:79]
    ds_read_b64_tr_b16 v[38:39], v129 offset:45056
    v_mfma_f32_16x16x32_bf16 v[80:83], v[0:3], v[20:23], v[80:83]
    ds_read_b64_tr_b16 v[40:41], v130 offset:40960
    buffer_load_dwordx4 v138, s[8:11], s15 offen offset:1024 lds
    v_mfma_f32_16x16x32_bf16 v[84:87], v[4:7], v[20:23], v[84:87]
    ds_read_b64_tr_b16 v[42:43], v130 offset:45056
    v_mfma_f32_16x16x32_bf16 v[88:91], v[8:11], v[20:23], v[88:91]
    ds_read_b64_tr_b16 v[44:45], v131 offset:40960
    v_mfma_f32_16x16x32_bf16 v[92:95], v[12:15], v[20:23], v[92:95]
    ds_read_b64_tr_b16 v[46:47], v131 offset:45056
    buffer_load_dwordx4 v139, s[8:11], s15 offen offset:2048 lds
    v_mfma_f32_16x16x32_bf16 v[96:99], v[0:3], v[24:27], v[96:99]
    ds_read_b128 v[52:55], v136 offset:35840
    v_mfma_f32_16x16x32_bf16 v[100:103], v[4:7], v[24:27], v[100:103]
    ds_read_b128 v[56:59], v136 offset:37888
    buffer_load_dwordx4 v140, s[8:11], s15 offen offset:3072 lds
    v_mfma_f32_16x16x32_bf16 v[104:107], v[8:11], v[24:27], v[104:107]
    ds_read_b128 v[60:63], v136 offset:39936
    v_mfma_f32_16x16x32_bf16 v[108:111], v[12:15], v[24:27], v[108:111]
    v_mfma_f32_16x16x32_bf16 v[112:115], v[0:3], v[28:31], v[112:115]
    s_add_u32 s15, s15, s17
    v_mfma_f32_16x16x32_bf16 v[116:119], v[4:7], v[28:31], v[116:119]
    v_mfma_f32_16x16x32_bf16 v[120:123], v[8:11], v[28:31], v[120:123]
    v_mfma_f32_16x16x32_bf16 v[124:127], v[12:15], v[28:31], v[124:127]
    s_waitcnt lgkmcnt(0)
    v_mfma_f32_16x16x32_bf16 v[64:67], v[32:35], v[48:51], v[64:67]
    s_waitcnt vmcnt(16)
    s_barrier
    ds_read_b128 v[16:19], v136 offset:49152
    s_add_u32 m0, s20, 32768
    s_nop 0
    v_mfma_f32_16x16x32_bf16 v[68:71], v[36:39], v[48:51], v[68:71]
    ds_read_b64_tr_b16 v[0:1], v128 offset:49152
    v_mfma_f32_16x16x32_bf16 v[72:75], v[40:43], v[48:51], v[72:75]
    ds_read_b64_tr_b16 v[2:3], v128 offset:53248
    buffer_load_dwordx4 v141, s[4:7], s16 offen offset:0 sc1 lds
    v_mfma_f32_16x16x32_bf16 v[76:79], v[44:47], v[48:51], v[76:79]
    ds_read_b64_tr_b16 v[4:5], v129 offset:49152
    v_mfma_f32_16x16x32_bf16 v[80:83], v[32:35], v[52:55], v[80:83]
    ds_read_b64_tr_b16 v[6:7], v129 offset:53248
    v_mfma_f32_16x16x32_bf16 v[84:87], v[36:39], v[52:55], v[84:87]
    ds_read_b64_tr_b16 v[8:9], v130 offset:49152
    buffer_load_dwordx4 v141, s[4:7], s16 offen offset:1024 sc1 lds
    v_mfma_f32_16x16x32_bf16 v[88:91], v[40:43], v[52:55], v[88:91]
    ds_read_b64_tr_b16 v[10:11], v130 offset:53248
    v_mfma_f32_16x16x32_bf16 v[92:95], v[44:47], v[52:55], v[92:95]
    ds_read_b64_tr_b16 v[12:13], v131 offset:49152
    buffer_load_dwordx4 v142, s[4:7], s16 offen offset:2048 sc1 lds
    v_mfma_f32_16x16x32_bf16 v[96:99], v[32:35], v[56:59], v[96:99]
    ds_read_b64_tr_b16 v[14:15], v131 offset:53248
    v_mfma_f32_16x16x32_bf16 v[100:103], v[36:39], v[56:59], v[100:103]
    ds_read_b128 v[20:23], v136 offset:51200
    v_mfma_f32_16x16x32_bf16 v[104:107], v[40:43], v[56:59], v[104:107]
    ds_read_b128 v[24:27], v136 offset:53248
    buffer_load_dwordx4 v142, s[4:7], s16 offen offset:3072 sc1 lds
    v_mfma_f32_16x16x32_bf16 v[108:111], v[44:47], v[56:59], v[108:111]
    ds_read_b128 v[28:31], v136 offset:55296
    v_mfma_f32_16x16x32_bf16 v[112:115], v[32:35], v[60:63], v[112:115]
    s_add_u32 s16, s16, 2048
    v_mfma_f32_16x16x32_bf16 v[116:119], v[36:39], v[60:63], v[116:119]
    v_mfma_f32_16x16x32_bf16 v[120:123], v[40:43], v[60:63], v[120:123]
    v_mfma_f32_16x16x32_bf16 v[124:127], v[44:47], v[60:63], v[124:127]
    s_waitcnt lgkmcnt(0)
    ds_read_b128 v[48:51], v136 offset:50176
    s_add_u32 m0, s19, 32768
    s_nop 0
    v_mfma_f32_16x16x32_bf16 v[64:67], v[0:3], v[16:19], v[64:67]
    ds_read_b64_tr_b16 v[32:33], v128 offset:57344
    v_mfma_f32_16x16x32_bf16 v[68:71], v[4:7], v[16:19], v[68:71]
    ds_read_b64_tr_b16 v[34:35], v128 offset:61440
    buffer_load_dwordx4 v137, s[8:11], s15 offen offset:0 lds
    v_mfma_f32_16x16x32_bf16 v[72:75], v[8:11], v[16:19], v[72:75]
    ds_read_b64_tr_b16 v[36:37], v129 offset:57344
    v_mfma_f32_16x16x32_bf16 v[76:79], v[12:15], v[16:19], v[76:79]
    ds_read_b64_tr_b16 v[38:39], v129 offset:61440
    v_mfma_f32_16x16x32_bf16 v[80:83], v[0:3], v[20:23], v[80:83]
    ds_read_b64_tr_b16 v[40:41], v130 offset:57344
    buffer_load_dwordx4 v138, s[8:11], s15 offen offset:1024 lds
    v_mfma_f32_16x16x32_bf16 v[84:87], v[4:7], v[20:23], v[84:87]
    ds_read_b64_tr_b16 v[42:43], v130 offset:61440
    v_mfma_f32_16x16x32_bf16 v[88:91], v[8:11], v[20:23], v[88:91]
    ds_read_b64_tr_b16 v[44:45], v131 offset:57344
    v_mfma_f32_16x16x32_bf16 v[92:95], v[12:15], v[20:23], v[92:95]
    ds_read_b64_tr_b16 v[46:47], v131 offset:61440
    buffer_load_dwordx4 v139, s[8:11], s15 offen offset:2048 lds
    v_mfma_f32_16x16x32_bf16 v[96:99], v[0:3], v[24:27], v[96:99]
    ds_read_b128 v[52:55], v136 offset:52224
    v_mfma_f32_16x16x32_bf16 v[100:103], v[4:7], v[24:27], v[100:103]
    ds_read_b128 v[56:59], v136 offset:54272
    buffer_load_dwordx4 v140, s[8:11], s15 offen offset:3072 lds
    v_mfma_f32_16x16x32_bf16 v[104:107], v[8:11], v[24:27], v[104:107]
    ds_read_b128 v[60:63], v136 offset:56320
    v_mfma_f32_16x16x32_bf16 v[108:111], v[12:15], v[24:27], v[108:111]
    v_mfma_f32_16x16x32_bf16 v[112:115], v[0:3], v[28:31], v[112:115]
    s_add_u32 s15, s15, s17
    v_mfma_f32_16x16x32_bf16 v[116:119], v[4:7], v[28:31], v[116:119]
    v_mfma_f32_16x16x32_bf16 v[120:123], v[8:11], v[28:31], v[120:123]
    v_mfma_f32_16x16x32_bf16 v[124:127], v[12:15], v[28:31], v[124:127]
    s_waitcnt lgkmcnt(0)
    v_mfma_f32_16x16x32_bf16 v[64:67], v[32:35], v[48:51], v[64:67]
    s_waitcnt vmcnt(16)
    s_barrier
    ds_read_b128 v[16:19], v136 offset:0
    s_add_u32 m0, s20, 49152
    s_nop 0
    v_mfma_f32_16x16x32_bf16 v[68:71], v[36:39], v[48:51], v[68:71]
    ds_read_b64_tr_b16 v[0:1], v128 offset:0
    v_mfma_f32_16x16x32_bf16 v[72:75], v[40:43], v[48:51], v[72:75]
    ds_read_b64_tr_b16 v[2:3], v128 offset:4096
    buffer_load_dwordx4 v141, s[4:7], s16 offen offset:0 sc1 lds
    v_mfma_f32_16x16x32_bf16 v[76:79], v[44:47], v[48:51], v[76:79]
    ds_read_b64_tr_b16 v[4:5], v129 offset:0
    v_mfma_f32_16x16x32_bf16 v[80:83], v[32:35], v[52:55], v[80:83]
    ds_read_b64_tr_b16 v[6:7], v129 offset:4096
    v_mfma_f32_16x16x32_bf16 v[84:87], v[36:39], v[52:55], v[84:87]
    ds_read_b64_tr_b16 v[8:9], v130 offset:0
    buffer_load_dwordx4 v141, s[4:7], s16 offen offset:1024 sc1 lds
    v_mfma_f32_16x16x32_bf16 v[88:91], v[40:43], v[52:55], v[88:91]
    ds_read_b64_tr_b16 v[10:11], v130 offset:4096
    v_mfma_f32_16x16x32_bf16 v[92:95], v[44:47], v[52:55], v[92:95]
    ds_read_b64_tr_b16 v[12:13], v131 offset:0
    buffer_load_dwordx4 v142, s[4:7], s16 offen offset:2048 sc1 lds
    v_mfma_f32_16x16x32_bf16 v[96:99], v[32:35], v[56:59], v[96:99]
    ds_read_b64_tr_b16 v[14:15], v131 offset:4096
    v_mfma_f32_16x16x32_bf16 v[100:103], v[36:39], v[56:59], v[100:103]
    ds_read_b128 v[20:23], v136 offset:2048
    v_mfma_f32_16x16x32_bf16 v[104:107], v[40:43], v[56:59], v[104:107]
    ds_read_b128 v[24:27], v136 offset:4096
    buffer_load_dwordx4 v142, s[4:7], s16 offen offset:3072 sc1 lds
    v_mfma_f32_16x16x32_bf16 v[108:111], v[44:47], v[56:59], v[108:111]
    ds_read_b128 v[28:31], v136 offset:6144
    v_mfma_f32_16x16x32_bf16 v[112:115], v[32:35], v[60:63], v[112:115]
    s_add_u32 s16, s16, 2048
    v_mfma_f32_16x16x32_bf16 v[116:119], v[36:39], v[60:63], v[116:119]
    v_mfma_f32_16x16x32_bf16 v[120:123], v[40:43], v[60:63], v[120:123]
    v_mfma_f32_16x16x32_bf16 v[124:127], v[44:47], v[60:63], v[124:127]
    s_sub_u32 s18, s18, 1
    s_cmp_lg_u32 s18, 0
    s_cbranch_scc1 main_kernel_w_c0_n_loop
    s_cmp_lg_u32 s14, 0
    s_cbranch_scc1 main_kernel_w_c0_n_nt
    s_lshl_b32 s32, s27, 8
    s_add_u32 s32, s32, 0x841e000
    v_mov_b32 v255, 1
    s_mov_b64 exec, 1
    buffer_atomic_add v255, off, s[4:7], s32 sc0 sc1
    s_mov_b64 exec, -1
main_kernel_w_c0_n_nt:
    s_waitcnt lgkmcnt(0)
    ds_read_b128 v[48:51], v136 offset:1024
    s_add_u32 m0, s19, 49152
    s_nop 0
    v_mfma_f32_16x16x32_bf16 v[64:67], v[0:3], v[16:19], v[64:67]
    ds_read_b64_tr_b16 v[32:33], v128 offset:8192
    v_mfma_f32_16x16x32_bf16 v[68:71], v[4:7], v[16:19], v[68:71]
    ds_read_b64_tr_b16 v[34:35], v128 offset:12288
    buffer_load_dwordx4 v137, s[8:11], s15 offen offset:0 lds
    v_mfma_f32_16x16x32_bf16 v[72:75], v[8:11], v[16:19], v[72:75]
    ds_read_b64_tr_b16 v[36:37], v129 offset:8192
    v_mfma_f32_16x16x32_bf16 v[76:79], v[12:15], v[16:19], v[76:79]
    ds_read_b64_tr_b16 v[38:39], v129 offset:12288
    v_mfma_f32_16x16x32_bf16 v[80:83], v[0:3], v[20:23], v[80:83]
    ds_read_b64_tr_b16 v[40:41], v130 offset:8192
    buffer_load_dwordx4 v138, s[8:11], s15 offen offset:1024 lds
    v_mfma_f32_16x16x32_bf16 v[84:87], v[4:7], v[20:23], v[84:87]
    ds_read_b64_tr_b16 v[42:43], v130 offset:12288
    v_mfma_f32_16x16x32_bf16 v[88:91], v[8:11], v[20:23], v[88:91]
    ds_read_b64_tr_b16 v[44:45], v131 offset:8192
    v_mfma_f32_16x16x32_bf16 v[92:95], v[12:15], v[20:23], v[92:95]
    ds_read_b64_tr_b16 v[46:47], v131 offset:12288
    buffer_load_dwordx4 v139, s[8:11], s15 offen offset:2048 lds
    v_mfma_f32_16x16x32_bf16 v[96:99], v[0:3], v[24:27], v[96:99]
    ds_read_b128 v[52:55], v136 offset:3072
    v_mfma_f32_16x16x32_bf16 v[100:103], v[4:7], v[24:27], v[100:103]
    ds_read_b128 v[56:59], v136 offset:5120
    buffer_load_dwordx4 v140, s[8:11], s15 offen offset:3072 lds
    v_mfma_f32_16x16x32_bf16 v[104:107], v[8:11], v[24:27], v[104:107]
    ds_read_b128 v[60:63], v136 offset:7168
    v_mfma_f32_16x16x32_bf16 v[108:111], v[12:15], v[24:27], v[108:111]
    v_mfma_f32_16x16x32_bf16 v[112:115], v[0:3], v[28:31], v[112:115]
    s_add_u32 s15, s15, s17
    v_mfma_f32_16x16x32_bf16 v[116:119], v[4:7], v[28:31], v[116:119]
    v_mfma_f32_16x16x32_bf16 v[120:123], v[8:11], v[28:31], v[120:123]
    v_mfma_f32_16x16x32_bf16 v[124:127], v[12:15], v[28:31], v[124:127]
    s_waitcnt lgkmcnt(0)
    v_mfma_f32_16x16x32_bf16 v[64:67], v[32:35], v[48:51], v[64:67]
    s_waitcnt vmcnt(16)
    s_barrier
    ds_read_b128 v[16:19], v136 offset:16384
    v_mfma_f32_16x16x32_bf16 v[68:71], v[36:39], v[48:51], v[68:71]
    ds_read_b64_tr_b16 v[0:1], v128 offset:16384
    v_mfma_f32_16x16x32_bf16 v[72:75], v[40:43], v[48:51], v[72:75]
    ds_read_b64_tr_b16 v[2:3], v128 offset:20480
    v_mfma_f32_16x16x32_bf16 v[76:79], v[44:47], v[48:51], v[76:79]
    ds_read_b64_tr_b16 v[4:5], v129 offset:16384
    v_mfma_f32_16x16x32_bf16 v[80:83], v[32:35], v[52:55], v[80:83]
    ds_read_b64_tr_b16 v[6:7], v129 offset:20480
    v_mfma_f32_16x16x32_bf16 v[84:87], v[36:39], v[52:55], v[84:87]
    ds_read_b64_tr_b16 v[8:9], v130 offset:16384
    v_mfma_f32_16x16x32_bf16 v[88:91], v[40:43], v[52:55], v[88:91]
    ds_read_b64_tr_b16 v[10:11], v130 offset:20480
    v_mfma_f32_16x16x32_bf16 v[92:95], v[44:47], v[52:55], v[92:95]
    ds_read_b64_tr_b16 v[12:13], v131 offset:16384
    v_mfma_f32_16x16x32_bf16 v[96:99], v[32:35], v[56:59], v[96:99]
    ds_read_b64_tr_b16 v[14:15], v131 offset:20480
    v_mfma_f32_16x16x32_bf16 v[100:103], v[36:39], v[56:59], v[100:103]
    ds_read_b128 v[20:23], v136 offset:18432
    v_mfma_f32_16x16x32_bf16 v[104:107], v[40:43], v[56:59], v[104:107]
    ds_read_b128 v[24:27], v136 offset:20480
    v_mfma_f32_16x16x32_bf16 v[108:111], v[44:47], v[56:59], v[108:111]
    ds_read_b128 v[28:31], v136 offset:22528
    v_mfma_f32_16x16x32_bf16 v[112:115], v[32:35], v[60:63], v[112:115]
    v_mfma_f32_16x16x32_bf16 v[116:119], v[36:39], v[60:63], v[116:119]
    v_mfma_f32_16x16x32_bf16 v[120:123], v[40:43], v[60:63], v[120:123]
    v_mfma_f32_16x16x32_bf16 v[124:127], v[44:47], v[60:63], v[124:127]
    s_waitcnt lgkmcnt(0)
    ds_read_b128 v[48:51], v136 offset:17408
    v_mfma_f32_16x16x32_bf16 v[64:67], v[0:3], v[16:19], v[64:67]
    ds_read_b64_tr_b16 v[32:33], v128 offset:24576
    v_mfma_f32_16x16x32_bf16 v[68:71], v[4:7], v[16:19], v[68:71]
    ds_read_b64_tr_b16 v[34:35], v128 offset:28672
    v_mfma_f32_16x16x32_bf16 v[72:75], v[8:11], v[16:19], v[72:75]
    ds_read_b64_tr_b16 v[36:37], v129 offset:24576
    v_mfma_f32_16x16x32_bf16 v[76:79], v[12:15], v[16:19], v[76:79]
    ds_read_b64_tr_b16 v[38:39], v129 offset:28672
    v_mfma_f32_16x16x32_bf16 v[80:83], v[0:3], v[20:23], v[80:83]
    ds_read_b64_tr_b16 v[40:41], v130 offset:24576
    v_mfma_f32_16x16x32_bf16 v[84:87], v[4:7], v[20:23], v[84:87]
    ds_read_b64_tr_b16 v[42:43], v130 offset:28672
    v_mfma_f32_16x16x32_bf16 v[88:91], v[8:11], v[20:23], v[88:91]
    ds_read_b64_tr_b16 v[44:45], v131 offset:24576
    v_mfma_f32_16x16x32_bf16 v[92:95], v[12:15], v[20:23], v[92:95]
    ds_read_b64_tr_b16 v[46:47], v131 offset:28672
    v_mfma_f32_16x16x32_bf16 v[96:99], v[0:3], v[24:27], v[96:99]
    ds_read_b128 v[52:55], v136 offset:19456
    v_mfma_f32_16x16x32_bf16 v[100:103], v[4:7], v[24:27], v[100:103]
    ds_read_b128 v[56:59], v136 offset:21504
    v_mfma_f32_16x16x32_bf16 v[104:107], v[8:11], v[24:27], v[104:107]
    ds_read_b128 v[60:63], v136 offset:23552
    v_mfma_f32_16x16x32_bf16 v[108:111], v[12:15], v[24:27], v[108:111]
    v_mfma_f32_16x16x32_bf16 v[112:115], v[0:3], v[28:31], v[112:115]
    v_mfma_f32_16x16x32_bf16 v[116:119], v[4:7], v[28:31], v[116:119]
    v_mfma_f32_16x16x32_bf16 v[120:123], v[8:11], v[28:31], v[120:123]
    v_mfma_f32_16x16x32_bf16 v[124:127], v[12:15], v[28:31], v[124:127]
    s_waitcnt lgkmcnt(0)
    v_mfma_f32_16x16x32_bf16 v[64:67], v[32:35], v[48:51], v[64:67]
    s_waitcnt vmcnt(8)
    s_barrier
    ds_read_b128 v[16:19], v136 offset:32768
    v_mfma_f32_16x16x32_bf16 v[68:71], v[36:39], v[48:51], v[68:71]
    ds_read_b64_tr_b16 v[0:1], v128 offset:32768
    v_mfma_f32_16x16x32_bf16 v[72:75], v[40:43], v[48:51], v[72:75]
    ds_read_b64_tr_b16 v[2:3], v128 offset:36864
    v_mfma_f32_16x16x32_bf16 v[76:79], v[44:47], v[48:51], v[76:79]
    ds_read_b64_tr_b16 v[4:5], v129 offset:32768
    v_mfma_f32_16x16x32_bf16 v[80:83], v[32:35], v[52:55], v[80:83]
    ds_read_b64_tr_b16 v[6:7], v129 offset:36864
    v_mfma_f32_16x16x32_bf16 v[84:87], v[36:39], v[52:55], v[84:87]
    ds_read_b64_tr_b16 v[8:9], v130 offset:32768
    v_mfma_f32_16x16x32_bf16 v[88:91], v[40:43], v[52:55], v[88:91]
    ds_read_b64_tr_b16 v[10:11], v130 offset:36864
    v_mfma_f32_16x16x32_bf16 v[92:95], v[44:47], v[52:55], v[92:95]
    ds_read_b64_tr_b16 v[12:13], v131 offset:32768
    v_mfma_f32_16x16x32_bf16 v[96:99], v[32:35], v[56:59], v[96:99]
    ds_read_b64_tr_b16 v[14:15], v131 offset:36864
    v_mfma_f32_16x16x32_bf16 v[100:103], v[36:39], v[56:59], v[100:103]
    ds_read_b128 v[20:23], v136 offset:34816
    v_mfma_f32_16x16x32_bf16 v[104:107], v[40:43], v[56:59], v[104:107]
    ds_read_b128 v[24:27], v136 offset:36864
    v_mfma_f32_16x16x32_bf16 v[108:111], v[44:47], v[56:59], v[108:111]
    ds_read_b128 v[28:31], v136 offset:38912
    v_mfma_f32_16x16x32_bf16 v[112:115], v[32:35], v[60:63], v[112:115]
    v_mfma_f32_16x16x32_bf16 v[116:119], v[36:39], v[60:63], v[116:119]
    v_mfma_f32_16x16x32_bf16 v[120:123], v[40:43], v[60:63], v[120:123]
    v_mfma_f32_16x16x32_bf16 v[124:127], v[44:47], v[60:63], v[124:127]
    s_waitcnt lgkmcnt(0)
    ds_read_b128 v[48:51], v136 offset:33792
    v_mfma_f32_16x16x32_bf16 v[64:67], v[0:3], v[16:19], v[64:67]
    ds_read_b64_tr_b16 v[32:33], v128 offset:40960
    v_mfma_f32_16x16x32_bf16 v[68:71], v[4:7], v[16:19], v[68:71]
    ds_read_b64_tr_b16 v[34:35], v128 offset:45056
    v_mfma_f32_16x16x32_bf16 v[72:75], v[8:11], v[16:19], v[72:75]
    ds_read_b64_tr_b16 v[36:37], v129 offset:40960
    v_mfma_f32_16x16x32_bf16 v[76:79], v[12:15], v[16:19], v[76:79]
    ds_read_b64_tr_b16 v[38:39], v129 offset:45056
    v_mfma_f32_16x16x32_bf16 v[80:83], v[0:3], v[20:23], v[80:83]
    ds_read_b64_tr_b16 v[40:41], v130 offset:40960
    v_mfma_f32_16x16x32_bf16 v[84:87], v[4:7], v[20:23], v[84:87]
    ds_read_b64_tr_b16 v[42:43], v130 offset:45056
    v_mfma_f32_16x16x32_bf16 v[88:91], v[8:11], v[20:23], v[88:91]
    ds_read_b64_tr_b16 v[44:45], v131 offset:40960
    v_mfma_f32_16x16x32_bf16 v[92:95], v[12:15], v[20:23], v[92:95]
    ds_read_b64_tr_b16 v[46:47], v131 offset:45056
    v_mfma_f32_16x16x32_bf16 v[96:99], v[0:3], v[24:27], v[96:99]
    ds_read_b128 v[52:55], v136 offset:35840
    v_mfma_f32_16x16x32_bf16 v[100:103], v[4:7], v[24:27], v[100:103]
    ds_read_b128 v[56:59], v136 offset:37888
    v_mfma_f32_16x16x32_bf16 v[104:107], v[8:11], v[24:27], v[104:107]
    ds_read_b128 v[60:63], v136 offset:39936
    v_mfma_f32_16x16x32_bf16 v[108:111], v[12:15], v[24:27], v[108:111]
    v_mfma_f32_16x16x32_bf16 v[112:115], v[0:3], v[28:31], v[112:115]
    v_mfma_f32_16x16x32_bf16 v[116:119], v[4:7], v[28:31], v[116:119]
    v_mfma_f32_16x16x32_bf16 v[120:123], v[8:11], v[28:31], v[120:123]
    v_mfma_f32_16x16x32_bf16 v[124:127], v[12:15], v[28:31], v[124:127]
    s_waitcnt lgkmcnt(0)
    v_mfma_f32_16x16x32_bf16 v[64:67], v[32:35], v[48:51], v[64:67]
    s_waitcnt vmcnt(0)
    s_barrier
    ds_read_b128 v[16:19], v136 offset:49152
    v_mfma_f32_16x16x32_bf16 v[68:71], v[36:39], v[48:51], v[68:71]
    ds_read_b64_tr_b16 v[0:1], v128 offset:49152
    v_mfma_f32_16x16x32_bf16 v[72:75], v[40:43], v[48:51], v[72:75]
    ds_read_b64_tr_b16 v[2:3], v128 offset:53248
    v_mfma_f32_16x16x32_bf16 v[76:79], v[44:47], v[48:51], v[76:79]
    ds_read_b64_tr_b16 v[4:5], v129 offset:49152
    v_mfma_f32_16x16x32_bf16 v[80:83], v[32:35], v[52:55], v[80:83]
    ds_read_b64_tr_b16 v[6:7], v129 offset:53248
    v_mfma_f32_16x16x32_bf16 v[84:87], v[36:39], v[52:55], v[84:87]
    ds_read_b64_tr_b16 v[8:9], v130 offset:49152
    v_mfma_f32_16x16x32_bf16 v[88:91], v[40:43], v[52:55], v[88:91]
    ds_read_b64_tr_b16 v[10:11], v130 offset:53248
    v_mfma_f32_16x16x32_bf16 v[92:95], v[44:47], v[52:55], v[92:95]
    ds_read_b64_tr_b16 v[12:13], v131 offset:49152
    v_mfma_f32_16x16x32_bf16 v[96:99], v[32:35], v[56:59], v[96:99]
    ds_read_b64_tr_b16 v[14:15], v131 offset:53248
    v_mfma_f32_16x16x32_bf16 v[100:103], v[36:39], v[56:59], v[100:103]
    ds_read_b128 v[20:23], v136 offset:51200
    v_mfma_f32_16x16x32_bf16 v[104:107], v[40:43], v[56:59], v[104:107]
    ds_read_b128 v[24:27], v136 offset:53248
    v_mfma_f32_16x16x32_bf16 v[108:111], v[44:47], v[56:59], v[108:111]
    ds_read_b128 v[28:31], v136 offset:55296
    v_mfma_f32_16x16x32_bf16 v[112:115], v[32:35], v[60:63], v[112:115]
    v_mfma_f32_16x16x32_bf16 v[116:119], v[36:39], v[60:63], v[116:119]
    v_mfma_f32_16x16x32_bf16 v[120:123], v[40:43], v[60:63], v[120:123]
    v_mfma_f32_16x16x32_bf16 v[124:127], v[44:47], v[60:63], v[124:127]
    v_readfirstlane_b32 s55, v255
    s_cmp_eq_u32 s26, -1
    s_cbranch_scc1 main_kernel_w_c0_nores
    s_add_u32 s32, s26, 0
    buffer_load_dwordx4 v[192:195], v251, s[4:7], s32 offen offset:0 sc1
    buffer_load_dwordx4 v[196:199], v251, s[4:7], s32 offen offset:1024 sc1
    s_add_u32 s32, s26, 32768
    buffer_load_dwordx4 v[200:203], v251, s[4:7], s32 offen offset:0 sc1
    buffer_load_dwordx4 v[204:207], v251, s[4:7], s32 offen offset:1024 sc1
    s_add_u32 s32, s26, 65536
    buffer_load_dwordx4 v[208:211], v251, s[4:7], s32 offen offset:0 sc1
    buffer_load_dwordx4 v[212:215], v251, s[4:7], s32 offen offset:1024 sc1
    s_add_u32 s32, s26, 98304
    buffer_load_dwordx4 v[216:219], v251, s[4:7], s32 offen offset:0 sc1
    buffer_load_dwordx4 v[220:223], v251, s[4:7], s32 offen offset:1024 sc1
main_kernel_w_c0_nores:
    s_waitcnt lgkmcnt(0)
    ds_read_b128 v[48:51], v136 offset:50176
    v_mfma_f32_16x16x32_bf16 v[64:67], v[0:3], v[16:19], v[64:67]
    ds_read_b64_tr_b16 v[32:33], v128 offset:57344
    v_mfma_f32_16x16x32_bf16 v[68:71], v[4:7], v[16:19], v[68:71]
    ds_read_b64_tr_b16 v[34:35], v128 offset:61440
    v_mfma_f32_16x16x32_bf16 v[72:75], v[8:11], v[16:19], v[72:75]
    ds_read_b64_tr_b16 v[36:37], v129 offset:57344
    v_mfma_f32_16x16x32_bf16 v[76:79], v[12:15], v[16:19], v[76:79]
    ds_read_b64_tr_b16 v[38:39], v129 offset:61440
    v_mfma_f32_16x16x32_bf16 v[80:83], v[0:3], v[20:23], v[80:83]
    ds_read_b64_tr_b16 v[40:41], v130 offset:57344
    v_mfma_f32_16x16x32_bf16 v[84:87], v[4:7], v[20:23], v[84:87]
    ds_read_b64_tr_b16 v[42:43], v130 offset:61440
    v_mfma_f32_16x16x32_bf16 v[88:91], v[8:11], v[20:23], v[88:91]
    ds_read_b64_tr_b16 v[44:45], v131 offset:57344
    v_mfma_f32_16x16x32_bf16 v[92:95], v[12:15], v[20:23], v[92:95]
    ds_read_b64_tr_b16 v[46:47], v131 offset:61440
    v_mfma_f32_16x16x32_bf16 v[96:99], v[0:3], v[24:27], v[96:99]
    ds_read_b128 v[52:55], v136 offset:52224
    v_mfma_f32_16x16x32_bf16 v[100:103], v[4:7], v[24:27], v[100:103]
    ds_read_b128 v[56:59], v136 offset:54272
    v_mfma_f32_16x16x32_bf16 v[104:107], v[8:11], v[24:27], v[104:107]
    ds_read_b128 v[60:63], v136 offset:56320
    v_mfma_f32_16x16x32_bf16 v[108:111], v[12:15], v[24:27], v[108:111]
    v_mfma_f32_16x16x32_bf16 v[112:115], v[0:3], v[28:31], v[112:115]
    v_mfma_f32_16x16x32_bf16 v[116:119], v[4:7], v[28:31], v[116:119]
    v_mfma_f32_16x16x32_bf16 v[120:123], v[8:11], v[28:31], v[120:123]
    v_mfma_f32_16x16x32_bf16 v[124:127], v[12:15], v[28:31], v[124:127]
    s_waitcnt lgkmcnt(0)
    v_mfma_f32_16x16x32_bf16 v[64:67], v[32:35], v[48:51], v[64:67]
    v_mfma_f32_16x16x32_bf16 v[68:71], v[36:39], v[48:51], v[68:71]
    v_mfma_f32_16x16x32_bf16 v[72:75], v[40:43], v[48:51], v[72:75]
    v_mfma_f32_16x16x32_bf16 v[76:79], v[44:47], v[48:51], v[76:79]
    v_mfma_f32_16x16x32_bf16 v[80:83], v[32:35], v[52:55], v[80:83]
    v_mfma_f32_16x16x32_bf16 v[84:87], v[36:39], v[52:55], v[84:87]
    v_mfma_f32_16x16x32_bf16 v[88:91], v[40:43], v[52:55], v[88:91]
    v_mfma_f32_16x16x32_bf16 v[92:95], v[44:47], v[52:55], v[92:95]
    v_mfma_f32_16x16x32_bf16 v[96:99], v[32:35], v[56:59], v[96:99]
    v_mfma_f32_16x16x32_bf16 v[100:103], v[36:39], v[56:59], v[100:103]
    v_mfma_f32_16x16x32_bf16 v[104:107], v[40:43], v[56:59], v[104:107]
    v_mfma_f32_16x16x32_bf16 v[108:111], v[44:47], v[56:59], v[108:111]
    v_mfma_f32_16x16x32_bf16 v[112:115], v[32:35], v[60:63], v[112:115]
    v_mfma_f32_16x16x32_bf16 v[116:119], v[36:39], v[60:63], v[116:119]
    v_mfma_f32_16x16x32_bf16 v[120:123], v[40:43], v[60:63], v[120:123]
    v_mfma_f32_16x16x32_bf16 v[124:127], v[44:47], v[60:63], v[124:127]
    s_nop 7
    s_cmp_eq_u32 s23, 4
    s_cbranch_scc1 main_kernel_w_c0_eadd
    s_cmp_eq_u32 s23, 7
    s_cbranch_scc1 main_kernel_w_c0_esilu
    s_cmp_eq_u32 s23, 8
    s_cbranch_scc1 main_kernel_w_c0_efin
main_kernel_w_c0_escl:
    s_mov_b32 s53, s21
    v_mul_f32 v64, 0x3e0293ee, v64
    v_mul_f32 v65, 0x3e0293ee, v65
    v_mul_f32 v66, 0x3e0293ee, v66
    v_mul_f32 v67, 0x3e0293ee, v67
    v_mul_f32 v68, 0x3e0293ee, v68
    v_mul_f32 v69, 0x3e0293ee, v69
    v_mul_f32 v70, 0x3e0293ee, v70
    v_mul_f32 v71, 0x3e0293ee, v71
    v_cvt_pk_bf16_f32 v16, v64, v65
    v_cvt_pk_bf16_f32 v17, v66, v67
    v_cvt_pk_bf16_f32 v18, v68, v69
    v_cvt_pk_bf16_f32 v19, v70, v71
    buffer_store_dwordx4 v[16:19], v251, s[4:7], s53 offen offset:0 sc1
    v_mul_f32 v72, 0x3e0293ee, v72
    v_mul_f32 v73, 0x3e0293ee, v73
    v_mul_f32 v74, 0x3e0293ee, v74
    v_mul_f32 v75, 0x3e0293ee, v75
    v_mul_f32 v76, 0x3e0293ee, v76
    v_mul_f32 v77, 0x3e0293ee, v77
    v_mul_f32 v78, 0x3e0293ee, v78
    v_mul_f32 v79, 0x3e0293ee, v79
    v_cvt_pk_bf16_f32 v36, v72, v73
    v_cvt_pk_bf16_f32 v37, v74, v75
    v_cvt_pk_bf16_f32 v38, v76, v77
    v_cvt_pk_bf16_f32 v39, v78, v79
    buffer_store_dwordx4 v[36:39], v251, s[4:7], s53 offen offset:1024 sc1
    s_add_u32 s53, s53, s22
    v_mul_f32 v80, 0x3e0293ee, v80
    v_mul_f32 v81, 0x3e0293ee, v81
    v_mul_f32 v82, 0x3e0293ee, v82
    v_mul_f32 v83, 0x3e0293ee, v83
    v_mul_f32 v84, 0x3e0293ee, v84
    v_mul_f32 v85, 0x3e0293ee, v85
    v_mul_f32 v86, 0x3e0293ee, v86
    v_mul_f32 v87, 0x3e0293ee, v87
    v_cvt_pk_bf16_f32 v56, v80, v81
    v_cvt_pk_bf16_f32 v57, v82, v83
    v_cvt_pk_bf16_f32 v58, v84, v85
    v_cvt_pk_bf16_f32 v59, v86, v87
    buffer_store_dwordx4 v[56:59], v251, s[4:7], s53 offen offset:0 sc1
    v_mul_f32 v88, 0x3e0293ee, v88
    v_mul_f32 v89, 0x3e0293ee, v89
    v_mul_f32 v90, 0x3e0293ee, v90
    v_mul_f32 v91, 0x3e0293ee, v91
    v_mul_f32 v92, 0x3e0293ee, v92
    v_mul_f32 v93, 0x3e0293ee, v93
    v_mul_f32 v94, 0x3e0293ee, v94
    v_mul_f32 v95, 0x3e0293ee, v95
    v_cvt_pk_bf16_f32 v16, v88, v89
    v_cvt_pk_bf16_f32 v17, v90, v91
    v_cvt_pk_bf16_f32 v18, v92, v93
    v_cvt_pk_bf16_f32 v19, v94, v95
    buffer_store_dwordx4 v[16:19], v251, s[4:7], s53 offen offset:1024 sc1
    s_add_u32 s53, s53, s22
    v_mul_f32 v96, 0x3e0293ee, v96
    v_mul_f32 v97, 0x3e0293ee, v97
    v_mul_f32 v98, 0x3e0293ee, v98
    v_mul_f32 v99, 0x3e0293ee, v99
    v_mul_f32 v100, 0x3e0293ee, v100
    v_mul_f32 v101, 0x3e0293ee, v101
    v_mul_f32 v102, 0x3e0293ee, v102
    v_mul_f32 v103, 0x3e0293ee, v103
    v_cvt_pk_bf16_f32 v36, v96, v97
    v_cvt_pk_bf16_f32 v37, v98, v99
    v_cvt_pk_bf16_f32 v38, v100, v101
    v_cvt_pk_bf16_f32 v39, v102, v103
    buffer_store_dwordx4 v[36:39], v251, s[4:7], s53 offen offset:0 sc1
    v_mul_f32 v104, 0x3e0293ee, v104
    v_mul_f32 v105, 0x3e0293ee, v105
    v_mul_f32 v106, 0x3e0293ee, v106
    v_mul_f32 v107, 0x3e0293ee, v107
    v_mul_f32 v108, 0x3e0293ee, v108
    v_mul_f32 v109, 0x3e0293ee, v109
    v_mul_f32 v110, 0x3e0293ee, v110
    v_mul_f32 v111, 0x3e0293ee, v111
    v_cvt_pk_bf16_f32 v56, v104, v105
    v_cvt_pk_bf16_f32 v57, v106, v107
    v_cvt_pk_bf16_f32 v58, v108, v109
    v_cvt_pk_bf16_f32 v59, v110, v111
    buffer_store_dwordx4 v[56:59], v251, s[4:7], s53 offen offset:1024 sc1
    s_add_u32 s53, s53, s22
    v_mul_f32 v112, 0x3e0293ee, v112
    v_mul_f32 v113, 0x3e0293ee, v113
    v_mul_f32 v114, 0x3e0293ee, v114
    v_mul_f32 v115, 0x3e0293ee, v115
    v_mul_f32 v116, 0x3e0293ee, v116
    v_mul_f32 v117, 0x3e0293ee, v117
    v_mul_f32 v118, 0x3e0293ee, v118
    v_mul_f32 v119, 0x3e0293ee, v119
    v_cvt_pk_bf16_f32 v16, v112, v113
    v_cvt_pk_bf16_f32 v17, v114, v115
    v_cvt_pk_bf16_f32 v18, v116, v117
    v_cvt_pk_bf16_f32 v19, v118, v119
    buffer_store_dwordx4 v[16:19], v251, s[4:7], s53 offen offset:0 sc1
    v_mul_f32 v120, 0x3e0293ee, v120
    v_mul_f32 v121, 0x3e0293ee, v121
    v_mul_f32 v122, 0x3e0293ee, v122
    v_mul_f32 v123, 0x3e0293ee, v123
    v_mul_f32 v124, 0x3e0293ee, v124
    v_mul_f32 v125, 0x3e0293ee, v125
    v_mul_f32 v126, 0x3e0293ee, v126
    v_mul_f32 v127, 0x3e0293ee, v127
    v_cvt_pk_bf16_f32 v36, v120, v121
    v_cvt_pk_bf16_f32 v37, v122, v123
    v_cvt_pk_bf16_f32 v38, v124, v125
    v_cvt_pk_bf16_f32 v39, v126, v127
    buffer_store_dwordx4 v[36:39], v251, s[4:7], s53 offen offset:1024 sc1
    s_branch main_kernel_w_done
main_kernel_w_c0_eadd:
    s_mov_b32 s53, s21
    s_waitcnt vmcnt(7)
    v_lshlrev_b32 v8, 16, v192
    v_and_b32 v9, 0xffff0000, v192
    v_lshlrev_b32 v10, 16, v193
    v_and_b32 v11, 0xffff0000, v193
    v_lshlrev_b32 v12, 16, v194
    v_and_b32 v13, 0xffff0000, v194
    v_lshlrev_b32 v14, 16, v195
    v_and_b32 v15, 0xffff0000, v195
    v_pk_add_f32 v[64:65], v[64:65], v[8:9]
    v_pk_add_f32 v[66:67], v[66:67], v[10:11]
    v_pk_add_f32 v[68:69], v[68:69], v[12:13]
    v_pk_add_f32 v[70:71], v[70:71], v[14:15]
    v_cvt_pk_bf16_f32 v16, v64, v65
    v_cvt_pk_bf16_f32 v17, v66, v67
    v_cvt_pk_bf16_f32 v18, v68, v69
    v_cvt_pk_bf16_f32 v19, v70, v71
    buffer_store_dwordx4 v[16:19], v251, s[4:7], s53 offen offset:0 sc1
    s_waitcnt vmcnt(7)
    v_lshlrev_b32 v28, 16, v196
    v_and_b32 v29, 0xffff0000, v196
    v_lshlrev_b32 v30, 16, v197
    v_and_b32 v31, 0xffff0000, v197
    v_lshlrev_b32 v32, 16, v198
    v_and_b32 v33, 0xffff0000, v198
    v_lshlrev_b32 v34, 16, v199
    v_and_b32 v35, 0xffff0000, v199
    v_pk_add_f32 v[72:73], v[72:73], v[28:29]
    v_pk_add_f32 v[74:75], v[74:75], v[30:31]
    v_pk_add_f32 v[76:77], v[76:77], v[32:33]
    v_pk_add_f32 v[78:79], v[78:79], v[34:35]
    v_cvt_pk_bf16_f32 v36, v72, v73
    v_cvt_pk_bf16_f32 v37, v74, v75
    v_cvt_pk_bf16_f32 v38, v76, v77
    v_cvt_pk_bf16_f32 v39, v78, v79
    buffer_store_dwordx4 v[36:39], v251, s[4:7], s53 offen offset:1024 sc1
    s_add_u32 s53, s53, s22
    s_waitcnt vmcnt(7)
    v_lshlrev_b32 v48, 16, v200
    v_and_b32 v49, 0xffff0000, v200
    v_lshlrev_b32 v50, 16, v201
    v_and_b32 v51, 0xffff0000, v201
    v_lshlrev_b32 v52, 16, v202
    v_and_b32 v53, 0xffff0000, v202
    v_lshlrev_b32 v54, 16, v203
    v_and_b32 v55, 0xffff0000, v203
    v_pk_add_f32 v[80:81], v[80:81], v[48:49]
    v_pk_add_f32 v[82:83], v[82:83], v[50:51]
    v_pk_add_f32 v[84:85], v[84:85], v[52:53]
    v_pk_add_f32 v[86:87], v[86:87], v[54:55]
    v_cvt_pk_bf16_f32 v56, v80, v81
    v_cvt_pk_bf16_f32 v57, v82, v83
    v_cvt_pk_bf16_f32 v58, v84, v85
    v_cvt_pk_bf16_f32 v59, v86, v87
    buffer_store_dwordx4 v[56:59], v251, s[4:7], s53 offen offset:0 sc1
    s_waitcnt vmcnt(7)
    v_lshlrev_b32 v8, 16, v204
    v_and_b32 v9, 0xffff0000, v204
    v_lshlrev_b32 v10, 16, v205
    v_and_b32 v11, 0xffff0000, v205
    v_lshlrev_b32 v12, 16, v206
    v_and_b32 v13, 0xffff0000, v206
    v_lshlrev_b32 v14, 16, v207
    v_and_b32 v15, 0xffff0000, v207
    v_pk_add_f32 v[88:89], v[88:89], v[8:9]
    v_pk_add_f32 v[90:91], v[90:91], v[10:11]
    v_pk_add_f32 v[92:93], v[92:93], v[12:13]
    v_pk_add_f32 v[94:95], v[94:95], v[14:15]
    v_cvt_pk_bf16_f32 v16, v88, v89
    v_cvt_pk_bf16_f32 v17, v90, v91
    v_cvt_pk_bf16_f32 v18, v92, v93
    v_cvt_pk_bf16_f32 v19, v94, v95
    buffer_store_dwordx4 v[16:19], v251, s[4:7], s53 offen offset:1024 sc1
    s_add_u32 s53, s53, s22
    s_waitcnt vmcnt(7)
    v_lshlrev_b32 v28, 16, v208
    v_and_b32 v29, 0xffff0000, v208
    v_lshlrev_b32 v30, 16, v209
    v_and_b32 v31, 0xffff0000, v209
    v_lshlrev_b32 v32, 16, v210
    v_and_b32 v33, 0xffff0000, v210
    v_lshlrev_b32 v34, 16, v211
    v_and_b32 v35, 0xffff0000, v211
    v_pk_add_f32 v[96:97], v[96:97], v[28:29]
    v_pk_add_f32 v[98:99], v[98:99], v[30:31]
    v_pk_add_f32 v[100:101], v[100:101], v[32:33]
    v_pk_add_f32 v[102:103], v[102:103], v[34:35]
    v_cvt_pk_bf16_f32 v36, v96, v97
    v_cvt_pk_bf16_f32 v37, v98, v99
    v_cvt_pk_bf16_f32 v38, v100, v101
    v_cvt_pk_bf16_f32 v39, v102, v103
    buffer_store_dwordx4 v[36:39], v251, s[4:7], s53 offen offset:0 sc1
    s_waitcnt vmcnt(7)
    v_lshlrev_b32 v48, 16, v212
    v_and_b32 v49, 0xffff0000, v212
    v_lshlrev_b32 v50, 16, v213
    v_and_b32 v51, 0xffff0000, v213
    v_lshlrev_b32 v52, 16, v214
    v_and_b32 v53, 0xffff0000, v214
    v_lshlrev_b32 v54, 16, v215
    v_and_b32 v55, 0xffff0000, v215
    v_pk_add_f32 v[104:105], v[104:105], v[48:49]
    v_pk_add_f32 v[106:107], v[106:107], v[50:51]
    v_pk_add_f32 v[108:109], v[108:109], v[52:53]
    v_pk_add_f32 v[110:111], v[110:111], v[54:55]
    v_cvt_pk_bf16_f32 v56, v104, v105
    v_cvt_pk_bf16_f32 v57, v106, v107
    v_cvt_pk_bf16_f32 v58, v108, v109
    v_cvt_pk_bf16_f32 v59, v110, v111
    buffer_store_dwordx4 v[56:59], v251, s[4:7], s53 offen offset:1024 sc1
    s_add_u32 s53, s53, s22
    s_waitcnt vmcnt(7)
    v_lshlrev_b32 v8, 16, v216
    v_and_b32 v9, 0xffff0000, v216
    v_lshlrev_b32 v10, 16, v217
    v_and_b32 v11, 0xffff0000, v217
    v_lshlrev_b32 v12, 16, v218
    v_and_b32 v13, 0xffff0000, v218
    v_lshlrev_b32 v14, 16, v219
    v_and_b32 v15, 0xffff0000, v219
    v_pk_add_f32 v[112:113], v[112:113], v[8:9]
    v_pk_add_f32 v[114:115], v[114:115], v[10:11]
    v_pk_add_f32 v[116:117], v[116:117], v[12:13]
    v_pk_add_f32 v[118:119], v[118:119], v[14:15]
    v_cvt_pk_bf16_f32 v16, v112, v113
    v_cvt_pk_bf16_f32 v17, v114, v115
    v_cvt_pk_bf16_f32 v18, v116, v117
    v_cvt_pk_bf16_f32 v19, v118, v119
    buffer_store_dwordx4 v[16:19], v251, s[4:7], s53 offen offset:0 sc1
    s_waitcnt vmcnt(7)
    v_lshlrev_b32 v28, 16, v220
    v_and_b32 v29, 0xffff0000, v220
    v_lshlrev_b32 v30, 16, v221
    v_and_b32 v31, 0xffff0000, v221
    v_lshlrev_b32 v32, 16, v222
    v_and_b32 v33, 0xffff0000, v222
    v_lshlrev_b32 v34, 16, v223
    v_and_b32 v35, 0xffff0000, v223
    v_pk_add_f32 v[120:121], v[120:121], v[28:29]
    v_pk_add_f32 v[122:123], v[122:123], v[30:31]
    v_pk_add_f32 v[124:125], v[124:125], v[32:33]
    v_pk_add_f32 v[126:127], v[126:127], v[34:35]
    v_cvt_pk_bf16_f32 v36, v120, v121
    v_cvt_pk_bf16_f32 v37, v122, v123
    v_cvt_pk_bf16_f32 v38, v124, v125
    v_cvt_pk_bf16_f32 v39, v126, v127
    buffer_store_dwordx4 v[36:39], v251, s[4:7], s53 offen offset:1024 sc1
    s_branch main_kernel_w_done
main_kernel_w_c0_esilu:
    s_mov_b32 s53, s21
    s_waitcnt vmcnt(7)
    v_lshlrev_b32 v8, 16, v192
    v_and_b32 v9, 0xffff0000, v192
    v_lshlrev_b32 v10, 16, v193
    v_and_b32 v11, 0xffff0000, v193
    v_lshlrev_b32 v12, 16, v194
    v_and_b32 v13, 0xffff0000, v194
    v_lshlrev_b32 v14, 16, v195
    v_and_b32 v15, 0xffff0000, v195
    v_pk_add_f32 v[64:65], v[64:65], v[8:9]
    v_pk_add_f32 v[66:67], v[66:67], v[10:11]
    v_pk_add_f32 v[68:69], v[68:69], v[12:13]
    v_pk_add_f32 v[70:71], v[70:71], v[14:15]
    v_pk_mul_f32 v[8:9], v[64:65], v[246:247]
    v_pk_mul_f32 v[10:11], v[66:67], v[246:247]
    v_pk_mul_f32 v[12:13], v[68:69], v[246:247]
    v_pk_mul_f32 v[14:15], v[70:71], v[246:247]
    v_exp_f32 v8, v8
    v_exp_f32 v9, v9
    v_exp_f32 v10, v10
    v_exp_f32 v11, v11
    v_exp_f32 v12, v12
    v_exp_f32 v13, v13
    v_exp_f32 v14, v14
    v_exp_f32 v15, v15
    v_pk_add_f32 v[8:9], v[8:9], v[244:245]
    v_pk_add_f32 v[10:11], v[10:11], v[244:245]
    v_pk_add_f32 v[12:13], v[12:13], v[244:245]
    v_pk_add_f32 v[14:15], v[14:15], v[244:245]
    v_rcp_f32 v8, v8
    v_rcp_f32 v9, v9
    v_rcp_f32 v10, v10
    v_rcp_f32 v11, v11
    v_rcp_f32 v12, v12
    v_rcp_f32 v13, v13
    v_rcp_f32 v14, v14
    v_rcp_f32 v15, v15
    v_pk_mul_f32 v[64:65], v[8:9], v[64:65]
    v_pk_mul_f32 v[66:67], v[10:11], v[66:67]
    v_pk_mul_f32 v[68:69], v[12:13], v[68:69]
    v_pk_mul_f32 v[70:71], v[14:15], v[70:71]
    v_cvt_pk_bf16_f32 v16, v64, v65
    v_cvt_pk_bf16_f32 v17, v66, v67
    v_cvt_pk_bf16_f32 v18, v68, v69
    v_cvt_pk_bf16_f32 v19, v70, v71
    buffer_store_dwordx4 v[16:19], v251, s[4:7], s53 offen offset:0 sc1
    s_waitcnt vmcnt(7)
    v_lshlrev_b32 v28, 16, v196
    v_and_b32 v29, 0xffff0000, v196
    v_lshlrev_b32 v30, 16, v197
    v_and_b32 v31, 0xffff0000, v197
    v_lshlrev_b32 v32, 16, v198
    v_and_b32 v33, 0xffff0000, v198
    v_lshlrev_b32 v34, 16, v199
    v_and_b32 v35, 0xffff0000, v199
    v_pk_add_f32 v[72:73], v[72:73], v[28:29]
    v_pk_add_f32 v[74:75], v[74:75], v[30:31]
    v_pk_add_f32 v[76:77], v[76:77], v[32:33]
    v_pk_add_f32 v[78:79], v[78:79], v[34:35]
    v_pk_mul_f32 v[28:29], v[72:73], v[246:247]
    v_pk_mul_f32 v[30:31], v[74:75], v[246:247]
    v_pk_mul_f32 v[32:33], v[76:77], v[246:247]
    v_pk_mul_f32 v[34:35], v[78:79], v[246:247]
    v_exp_f32 v28, v28
    v_exp_f32 v29, v29
    v_exp_f32 v30, v30
    v_exp_f32 v31, v31
    v_exp_f32 v32, v32
    v_exp_f32 v33, v33
    v_exp_f32 v34, v34
    v_exp_f32 v35, v35
    v_pk_add_f32 v[28:29], v[28:29], v[244:245]
    v_pk_add_f32 v[30:31], v[30:31], v[244:245]
    v_pk_add_f32 v[32:33], v[32:33], v[244:245]
    v_pk_add_f32 v[34:35], v[34:35], v[244:245]
    v_rcp_f32 v28, v28
    v_rcp_f32 v29, v29
    v_rcp_f32 v30, v30
    v_rcp_f32 v31, v31
    v_rcp_f32 v32, v32
    v_rcp_f32 v33, v33
    v_rcp_f32 v34, v34
    v_rcp_f32 v35, v35
    v_pk_mul_f32 v[72:73], v[28:29], v[72:73]
    v_pk_mul_f32 v[74:75], v[30:31], v[74:75]
    v_pk_mul_f32 v[76:77], v[32:33], v[76:77]
    v_pk_mul_f32 v[78:79], v[34:35], v[78:79]
    v_cvt_pk_bf16_f32 v36, v72, v73
    v_cvt_pk_bf16_f32 v37, v74, v75
    v_cvt_pk_bf16_f32 v38, v76, v77
    v_cvt_pk_bf16_f32 v39, v78, v79
    buffer_store_dwordx4 v[36:39], v251, s[4:7], s53 offen offset:1024 sc1
    s_add_u32 s53, s53, s22
    s_waitcnt vmcnt(7)
    v_lshlrev_b32 v48, 16, v200
    v_and_b32 v49, 0xffff0000, v200
    v_lshlrev_b32 v50, 16, v201
    v_and_b32 v51, 0xffff0000, v201
    v_lshlrev_b32 v52, 16, v202
    v_and_b32 v53, 0xffff0000, v202
    v_lshlrev_b32 v54, 16, v203
    v_and_b32 v55, 0xffff0000, v203
    v_pk_add_f32 v[80:81], v[80:81], v[48:49]
    v_pk_add_f32 v[82:83], v[82:83], v[50:51]
    v_pk_add_f32 v[84:85], v[84:85], v[52:53]
    v_pk_add_f32 v[86:87], v[86:87], v[54:55]
    v_pk_mul_f32 v[48:49], v[80:81], v[246:247]
    v_pk_mul_f32 v[50:51], v[82:83], v[246:247]
    v_pk_mul_f32 v[52:53], v[84:85], v[246:247]
    v_pk_mul_f32 v[54:55], v[86:87], v[246:247]
    v_exp_f32 v48, v48
    v_exp_f32 v49, v49
    v_exp_f32 v50, v50
    v_exp_f32 v51, v51
    v_exp_f32 v52, v52
    v_exp_f32 v53, v53
    v_exp_f32 v54, v54
    v_exp_f32 v55, v55
    v_pk_add_f32 v[48:49], v[48:49], v[244:245]
    v_pk_add_f32 v[50:51], v[50:51], v[244:245]
    v_pk_add_f32 v[52:53], v[52:53], v[244:245]
    v_pk_add_f32 v[54:55], v[54:55], v[244:245]
    v_rcp_f32 v48, v48
    v_rcp_f32 v49, v49
    v_rcp_f32 v50, v50
    v_rcp_f32 v51, v51
    v_rcp_f32 v52, v52
    v_rcp_f32 v53, v53
    v_rcp_f32 v54, v54
    v_rcp_f32 v55, v55
    v_pk_mul_f32 v[80:81], v[48:49], v[80:81]
    v_pk_mul_f32 v[82:83], v[50:51], v[82:83]
    v_pk_mul_f32 v[84:85], v[52:53], v[84:85]
    v_pk_mul_f32 v[86:87], v[54:55], v[86:87]
    v_cvt_pk_bf16_f32 v56, v80, v81
    v_cvt_pk_bf16_f32 v57, v82, v83
    v_cvt_pk_bf16_f32 v58, v84, v85
    v_cvt_pk_bf16_f32 v59, v86, v87
    buffer_store_dwordx4 v[56:59], v251, s[4:7], s53 offen offset:0 sc1
    s_waitcnt vmcnt(7)
    v_lshlrev_b32 v8, 16, v204
    v_and_b32 v9, 0xffff0000, v204
    v_lshlrev_b32 v10, 16, v205
    v_and_b32 v11, 0xffff0000, v205
    v_lshlrev_b32 v12, 16, v206
    v_and_b32 v13, 0xffff0000, v206
    v_lshlrev_b32 v14, 16, v207
    v_and_b32 v15, 0xffff0000, v207
    v_pk_add_f32 v[88:89], v[88:89], v[8:9]
    v_pk_add_f32 v[90:91], v[90:91], v[10:11]
    v_pk_add_f32 v[92:93], v[92:93], v[12:13]
    v_pk_add_f32 v[94:95], v[94:95], v[14:15]
    v_pk_mul_f32 v[8:9], v[88:89], v[246:247]
    v_pk_mul_f32 v[10:11], v[90:91], v[246:247]
    v_pk_mul_f32 v[12:13], v[92:93], v[246:247]
    v_pk_mul_f32 v[14:15], v[94:95], v[246:247]
    v_exp_f32 v8, v8
    v_exp_f32 v9, v9
    v_exp_f32 v10, v10
    v_exp_f32 v11, v11
    v_exp_f32 v12, v12
    v_exp_f32 v13, v13
    v_exp_f32 v14, v14
    v_exp_f32 v15, v15
    v_pk_add_f32 v[8:9], v[8:9], v[244:245]
    v_pk_add_f32 v[10:11], v[10:11], v[244:245]
    v_pk_add_f32 v[12:13], v[12:13], v[244:245]
    v_pk_add_f32 v[14:15], v[14:15], v[244:245]
    v_rcp_f32 v8, v8
    v_rcp_f32 v9, v9
    v_rcp_f32 v10, v10
    v_rcp_f32 v11, v11
    v_rcp_f32 v12, v12
    v_rcp_f32 v13, v13
    v_rcp_f32 v14, v14
    v_rcp_f32 v15, v15
    v_pk_mul_f32 v[88:89], v[8:9], v[88:89]
    v_pk_mul_f32 v[90:91], v[10:11], v[90:91]
    v_pk_mul_f32 v[92:93], v[12:13], v[92:93]
    v_pk_mul_f32 v[94:95], v[14:15], v[94:95]
    v_cvt_pk_bf16_f32 v16, v88, v89
    v_cvt_pk_bf16_f32 v17, v90, v91
    v_cvt_pk_bf16_f32 v18, v92, v93
    v_cvt_pk_bf16_f32 v19, v94, v95
    buffer_store_dwordx4 v[16:19], v251, s[4:7], s53 offen offset:1024 sc1
    s_add_u32 s53, s53, s22
    s_waitcnt vmcnt(7)
    v_lshlrev_b32 v28, 16, v208
    v_and_b32 v29, 0xffff0000, v208
    v_lshlrev_b32 v30, 16, v209
    v_and_b32 v31, 0xffff0000, v209
    v_lshlrev_b32 v32, 16, v210
    v_and_b32 v33, 0xffff0000, v210
    v_lshlrev_b32 v34, 16, v211
    v_and_b32 v35, 0xffff0000, v211
    v_pk_add_f32 v[96:97], v[96:97], v[28:29]
    v_pk_add_f32 v[98:99], v[98:99], v[30:31]
    v_pk_add_f32 v[100:101], v[100:101], v[32:33]
    v_pk_add_f32 v[102:103], v[102:103], v[34:35]
    v_pk_mul_f32 v[28:29], v[96:97], v[246:247]
    v_pk_mul_f32 v[30:31], v[98:99], v[246:247]
    v_pk_mul_f32 v[32:33], v[100:101], v[246:247]
    v_pk_mul_f32 v[34:35], v[102:103], v[246:247]
    v_exp_f32 v28, v28
    v_exp_f32 v29, v29
    v_exp_f32 v30, v30
    v_exp_f32 v31, v31
    v_exp_f32 v32, v32
    v_exp_f32 v33, v33
    v_exp_f32 v34, v34
    v_exp_f32 v35, v35
    v_pk_add_f32 v[28:29], v[28:29], v[244:245]
    v_pk_add_f32 v[30:31], v[30:31], v[244:245]
    v_pk_add_f32 v[32:33], v[32:33], v[244:245]
    v_pk_add_f32 v[34:35], v[34:35], v[244:245]
    v_rcp_f32 v28, v28
    v_rcp_f32 v29, v29
    v_rcp_f32 v30, v30
    v_rcp_f32 v31, v31
    v_rcp_f32 v32, v32
    v_rcp_f32 v33, v33
    v_rcp_f32 v34, v34
    v_rcp_f32 v35, v35
    v_pk_mul_f32 v[96:97], v[28:29], v[96:97]
    v_pk_mul_f32 v[98:99], v[30:31], v[98:99]
    v_pk_mul_f32 v[100:101], v[32:33], v[100:101]
    v_pk_mul_f32 v[102:103], v[34:35], v[102:103]
    v_cvt_pk_bf16_f32 v36, v96, v97
    v_cvt_pk_bf16_f32 v37, v98, v99
    v_cvt_pk_bf16_f32 v38, v100, v101
    v_cvt_pk_bf16_f32 v39, v102, v103
    buffer_store_dwordx4 v[36:39], v251, s[4:7], s53 offen offset:0 sc1
    s_waitcnt vmcnt(7)
    v_lshlrev_b32 v48, 16, v212
    v_and_b32 v49, 0xffff0000, v212
    v_lshlrev_b32 v50, 16, v213
    v_and_b32 v51, 0xffff0000, v213
    v_lshlrev_b32 v52, 16, v214
    v_and_b32 v53, 0xffff0000, v214
    v_lshlrev_b32 v54, 16, v215
    v_and_b32 v55, 0xffff0000, v215
    v_pk_add_f32 v[104:105], v[104:105], v[48:49]
    v_pk_add_f32 v[106:107], v[106:107], v[50:51]
    v_pk_add_f32 v[108:109], v[108:109], v[52:53]
    v_pk_add_f32 v[110:111], v[110:111], v[54:55]
    v_pk_mul_f32 v[48:49], v[104:105], v[246:247]
    v_pk_mul_f32 v[50:51], v[106:107], v[246:247]
    v_pk_mul_f32 v[52:53], v[108:109], v[246:247]
    v_pk_mul_f32 v[54:55], v[110:111], v[246:247]
    v_exp_f32 v48, v48
    v_exp_f32 v49, v49
    v_exp_f32 v50, v50
    v_exp_f32 v51, v51
    v_exp_f32 v52, v52
    v_exp_f32 v53, v53
    v_exp_f32 v54, v54
    v_exp_f32 v55, v55
    v_pk_add_f32 v[48:49], v[48:49], v[244:245]
    v_pk_add_f32 v[50:51], v[50:51], v[244:245]
    v_pk_add_f32 v[52:53], v[52:53], v[244:245]
    v_pk_add_f32 v[54:55], v[54:55], v[244:245]
    v_rcp_f32 v48, v48
    v_rcp_f32 v49, v49
    v_rcp_f32 v50, v50
    v_rcp_f32 v51, v51
    v_rcp_f32 v52, v52
    v_rcp_f32 v53, v53
    v_rcp_f32 v54, v54
    v_rcp_f32 v55, v55
    v_pk_mul_f32 v[104:105], v[48:49], v[104:105]
    v_pk_mul_f32 v[106:107], v[50:51], v[106:107]
    v_pk_mul_f32 v[108:109], v[52:53], v[108:109]
    v_pk_mul_f32 v[110:111], v[54:55], v[110:111]
    v_cvt_pk_bf16_f32 v56, v104, v105
    v_cvt_pk_bf16_f32 v57, v106, v107
    v_cvt_pk_bf16_f32 v58, v108, v109
    v_cvt_pk_bf16_f32 v59, v110, v111
    buffer_store_dwordx4 v[56:59], v251, s[4:7], s53 offen offset:1024 sc1
    s_add_u32 s53, s53, s22
    s_waitcnt vmcnt(7)
    v_lshlrev_b32 v8, 16, v216
    v_and_b32 v9, 0xffff0000, v216
    v_lshlrev_b32 v10, 16, v217
    v_and_b32 v11, 0xffff0000, v217
    v_lshlrev_b32 v12, 16, v218
    v_and_b32 v13, 0xffff0000, v218
    v_lshlrev_b32 v14, 16, v219
    v_and_b32 v15, 0xffff0000, v219
    v_pk_add_f32 v[112:113], v[112:113], v[8:9]
    v_pk_add_f32 v[114:115], v[114:115], v[10:11]
    v_pk_add_f32 v[116:117], v[116:117], v[12:13]
    v_pk_add_f32 v[118:119], v[118:119], v[14:15]
    v_pk_mul_f32 v[8:9], v[112:113], v[246:247]
    v_pk_mul_f32 v[10:11], v[114:115], v[246:247]
    v_pk_mul_f32 v[12:13], v[116:117], v[246:247]
    v_pk_mul_f32 v[14:15], v[118:119], v[246:247]
    v_exp_f32 v8, v8
    v_exp_f32 v9, v9
    v_exp_f32 v10, v10
    v_exp_f32 v11, v11
    v_exp_f32 v12, v12
    v_exp_f32 v13, v13
    v_exp_f32 v14, v14
    v_exp_f32 v15, v15
    v_pk_add_f32 v[8:9], v[8:9], v[244:245]
    v_pk_add_f32 v[10:11], v[10:11], v[244:245]
    v_pk_add_f32 v[12:13], v[12:13], v[244:245]
    v_pk_add_f32 v[14:15], v[14:15], v[244:245]
    v_rcp_f32 v8, v8
    v_rcp_f32 v9, v9
    v_rcp_f32 v10, v10
    v_rcp_f32 v11, v11
    v_rcp_f32 v12, v12
    v_rcp_f32 v13, v13
    v_rcp_f32 v14, v14
    v_rcp_f32 v15, v15
    v_pk_mul_f32 v[112:113], v[8:9], v[112:113]
    v_pk_mul_f32 v[114:115], v[10:11], v[114:115]
    v_pk_mul_f32 v[116:117], v[12:13], v[116:117]
    v_pk_mul_f32 v[118:119], v[14:15], v[118:119]
    v_cvt_pk_bf16_f32 v16, v112, v113
    v_cvt_pk_bf16_f32 v17, v114, v115
    v_cvt_pk_bf16_f32 v18, v116, v117
    v_cvt_pk_bf16_f32 v19, v118, v119
    buffer_store_dwordx4 v[16:19], v251, s[4:7], s53 offen offset:0 sc1
    s_waitcnt vmcnt(7)
    v_lshlrev_b32 v28, 16, v220
    v_and_b32 v29, 0xffff0000, v220
    v_lshlrev_b32 v30, 16, v221
    v_and_b32 v31, 0xffff0000, v221
    v_lshlrev_b32 v32, 16, v222
    v_and_b32 v33, 0xffff0000, v222
    v_lshlrev_b32 v34, 16, v223
    v_and_b32 v35, 0xffff0000, v223
    v_pk_add_f32 v[120:121], v[120:121], v[28:29]
    v_pk_add_f32 v[122:123], v[122:123], v[30:31]
    v_pk_add_f32 v[124:125], v[124:125], v[32:33]
    v_pk_add_f32 v[126:127], v[126:127], v[34:35]
    v_pk_mul_f32 v[28:29], v[120:121], v[246:247]
    v_pk_mul_f32 v[30:31], v[122:123], v[246:247]
    v_pk_mul_f32 v[32:33], v[124:125], v[246:247]
    v_pk_mul_f32 v[34:35], v[126:127], v[246:247]
    v_exp_f32 v28, v28
    v_exp_f32 v29, v29
    v_exp_f32 v30, v30
    v_exp_f32 v31, v31
    v_exp_f32 v32, v32
    v_exp_f32 v33, v33
    v_exp_f32 v34, v34
    v_exp_f32 v35, v35
    v_pk_add_f32 v[28:29], v[28:29], v[244:245]
    v_pk_add_f32 v[30:31], v[30:31], v[244:245]
    v_pk_add_f32 v[32:33], v[32:33], v[244:245]
    v_pk_add_f32 v[34:35], v[34:35], v[244:245]
    v_rcp_f32 v28, v28
    v_rcp_f32 v29, v29
    v_rcp_f32 v30, v30
    v_rcp_f32 v31, v31
    v_rcp_f32 v32, v32
    v_rcp_f32 v33, v33
    v_rcp_f32 v34, v34
    v_rcp_f32 v35, v35
    v_pk_mul_f32 v[120:121], v[28:29], v[120:121]
    v_pk_mul_f32 v[122:123], v[30:31], v[122:123]
    v_pk_mul_f32 v[124:125], v[32:33], v[124:125]
    v_pk_mul_f32 v[126:127], v[34:35], v[126:127]
    v_cvt_pk_bf16_f32 v36, v120, v121
    v_cvt_pk_bf16_f32 v37, v122, v123
    v_cvt_pk_bf16_f32 v38, v124, v125
    v_cvt_pk_bf16_f32 v39, v126, v127
    buffer_store_dwordx4 v[36:39], v251, s[4:7], s53 offen offset:1024 sc1
    s_branch main_kernel_w_done
main_kernel_w_c0_efin:
    s_mov_b32 s53, s21
    s_add_u32 s32, s21, 0
    buffer_load_dwordx4 v[160:163], v252, s[96:99], s32 offen offset:0
    buffer_load_dwordx4 v[164:167], v252, s[96:99], s32 offen offset:64
    s_add_u32 s32, s21, 32768
    buffer_load_dwordx4 v[168:171], v252, s[96:99], s32 offen offset:0
    buffer_load_dwordx4 v[172:175], v252, s[96:99], s32 offen offset:64
    s_add_u32 s32, s21, 65536
    buffer_load_dwordx4 v[176:179], v252, s[96:99], s32 offen offset:0
    buffer_load_dwordx4 v[180:183], v252, s[96:99], s32 offen offset:64
    s_add_u32 s32, s21, 98304
    buffer_load_dwordx4 v[184:187], v252, s[96:99], s32 offen offset:0
    buffer_load_dwordx4 v[188:191], v252, s[96:99], s32 offen offset:64
    s_waitcnt vmcnt(7)
    v_permlane16_swap_b32 v160, v162
    v_permlane16_swap_b32 v161, v163
    v_lshlrev_b32 v8, 16, v192
    v_and_b32 v9, 0xffff0000, v192
    v_lshlrev_b32 v10, 16, v193
    v_and_b32 v11, 0xffff0000, v193
    v_lshlrev_b32 v12, 16, v194
    v_and_b32 v13, 0xffff0000, v194
    v_lshlrev_b32 v14, 16, v195
    v_and_b32 v15, 0xffff0000, v195
    v_permlane32_swap_b32 v160, v162
    v_permlane32_swap_b32 v161, v163
    v_lshlrev_b32 v16, 16, v160
    v_and_b32 v17, 0xffff0000, v160
    v_lshlrev_b32 v18, 16, v161
    v_and_b32 v19, 0xffff0000, v161
    v_lshlrev_b32 v20, 16, v162
    v_and_b32 v21, 0xffff0000, v162
    v_lshlrev_b32 v22, 16, v163
    v_and_b32 v23, 0xffff0000, v163
    v_pk_fma_f32 v[8:9], v[64:65], v[8:9], v[16:17]
    v_pk_fma_f32 v[10:11], v[66:67], v[10:11], v[18:19]
    v_pk_fma_f32 v[12:13], v[68:69], v[12:13], v[20:21]
    v_pk_fma_f32 v[14:15], v[70:71], v[14:15], v[22:23]
    v_cvt_pk_bf16_f32 v24, v8, v9
    v_cvt_pk_bf16_f32 v25, v10, v11
    v_cvt_pk_bf16_f32 v26, v12, v13
    v_cvt_pk_bf16_f32 v27, v14, v15
    s_nop 0
    v_permlane32_swap_b32 v24, v26
    v_permlane32_swap_b32 v25, v27
    s_nop 0
    v_permlane16_swap_b32 v24, v26
    v_permlane16_swap_b32 v25, v27
    buffer_store_dwordx4 v[24:27], v252, s[92:95], s53 offen offset:0
    s_waitcnt vmcnt(7)
    v_permlane16_swap_b32 v164, v166
    v_permlane16_swap_b32 v165, v167
    v_lshlrev_b32 v36, 16, v196
    v_and_b32 v37, 0xffff0000, v196
    v_lshlrev_b32 v38, 16, v197
    v_and_b32 v39, 0xffff0000, v197
    v_lshlrev_b32 v40, 16, v198
    v_and_b32 v41, 0xffff0000, v198
    v_lshlrev_b32 v42, 16, v199
    v_and_b32 v43, 0xffff0000, v199
    v_permlane32_swap_b32 v164, v166
    v_permlane32_swap_b32 v165, v167
    v_lshlrev_b32 v44, 16, v164
    v_and_b32 v45, 0xffff0000, v164
    v_lshlrev_b32 v46, 16, v165
    v_and_b32 v47, 0xffff0000, v165
    v_lshlrev_b32 v48, 16, v166
    v_and_b32 v49, 0xffff0000, v166
    v_lshlrev_b32 v50, 16, v167
    v_and_b32 v51, 0xffff0000, v167
    v_pk_fma_f32 v[36:37], v[72:73], v[36:37], v[44:45]
    v_pk_fma_f32 v[38:39], v[74:75], v[38:39], v[46:47]
    v_pk_fma_f32 v[40:41], v[76:77], v[40:41], v[48:49]
    v_pk_fma_f32 v[42:43], v[78:79], v[42:43], v[50:51]
    v_cvt_pk_bf16_f32 v52, v36, v37
    v_cvt_pk_bf16_f32 v53, v38, v39
    v_cvt_pk_bf16_f32 v54, v40, v41
    v_cvt_pk_bf16_f32 v55, v42, v43
    s_nop 0
    v_permlane32_swap_b32 v52, v54
    v_permlane32_swap_b32 v53, v55
    s_nop 0
    v_permlane16_swap_b32 v52, v54
    v_permlane16_swap_b32 v53, v55
    buffer_store_dwordx4 v[52:55], v252, s[92:95], s53 offen offset:64
    s_add_u32 s53, s53, 32768
    s_waitcnt vmcnt(7)
    v_permlane16_swap_b32 v168, v170
    v_permlane16_swap_b32 v169, v171
    v_lshlrev_b32 v8, 16, v200
    v_and_b32 v9, 0xffff0000, v200
    v_lshlrev_b32 v10, 16, v201
    v_and_b32 v11, 0xffff0000, v201
    v_lshlrev_b32 v12, 16, v202
    v_and_b32 v13, 0xffff0000, v202
    v_lshlrev_b32 v14, 16, v203
    v_and_b32 v15, 0xffff0000, v203
    v_permlane32_swap_b32 v168, v170
    v_permlane32_swap_b32 v169, v171
    v_lshlrev_b32 v16, 16, v168
    v_and_b32 v17, 0xffff0000, v168
    v_lshlrev_b32 v18, 16, v169
    v_and_b32 v19, 0xffff0000, v169
    v_lshlrev_b32 v20, 16, v170
    v_and_b32 v21, 0xffff0000, v170
    v_lshlrev_b32 v22, 16, v171
    v_and_b32 v23, 0xffff0000, v171
    v_pk_fma_f32 v[8:9], v[80:81], v[8:9], v[16:17]
    v_pk_fma_f32 v[10:11], v[82:83], v[10:11], v[18:19]
    v_pk_fma_f32 v[12:13], v[84:85], v[12:13], v[20:21]
    v_pk_fma_f32 v[14:15], v[86:87], v[14:15], v[22:23]
    v_cvt_pk_bf16_f32 v24, v8, v9
    v_cvt_pk_bf16_f32 v25, v10, v11
    v_cvt_pk_bf16_f32 v26, v12, v13
    v_cvt_pk_bf16_f32 v27, v14, v15
    s_nop 0
    v_permlane32_swap_b32 v24, v26
    v_permlane32_swap_b32 v25, v27
    s_nop 0
    v_permlane16_swap_b32 v24, v26
    v_permlane16_swap_b32 v25, v27
    buffer_store_dwordx4 v[24:27], v252, s[92:95], s53 offen offset:0
    s_waitcnt vmcnt(7)
    v_permlane16_swap_b32 v172, v174
    v_permlane16_swap_b32 v173, v175
    v_lshlrev_b32 v36, 16, v204
    v_and_b32 v37, 0xffff0000, v204
    v_lshlrev_b32 v38, 16, v205
    v_and_b32 v39, 0xffff0000, v205
    v_lshlrev_b32 v40, 16, v206
    v_and_b32 v41, 0xffff0000, v206
    v_lshlrev_b32 v42, 16, v207
    v_and_b32 v43, 0xffff0000, v207
    v_permlane32_swap_b32 v172, v174
    v_permlane32_swap_b32 v173, v175
    v_lshlrev_b32 v44, 16, v172
    v_and_b32 v45, 0xffff0000, v172
    v_lshlrev_b32 v46, 16, v173
    v_and_b32 v47, 0xffff0000, v173
    v_lshlrev_b32 v48, 16, v174
    v_and_b32 v49, 0xffff0000, v174
    v_lshlrev_b32 v50, 16, v175
    v_and_b32 v51, 0xffff0000, v175
    v_pk_fma_f32 v[36:37], v[88:89], v[36:37], v[44:45]
    v_pk_fma_f32 v[38:39], v[90:91], v[38:39], v[46:47]
    v_pk_fma_f32 v[40:41], v[92:93], v[40:41], v[48:49]
    v_pk_fma_f32 v[42:43], v[94:95], v[42:43], v[50:51]
    v_cvt_pk_bf16_f32 v52, v36, v37
    v_cvt_pk_bf16_f32 v53, v38, v39
    v_cvt_pk_bf16_f32 v54, v40, v41
    v_cvt_pk_bf16_f32 v55, v42, v43
    s_nop 0
    v_permlane32_swap_b32 v52, v54
    v_permlane32_swap_b32 v53, v55
    s_nop 0
    v_permlane16_swap_b32 v52, v54
    v_permlane16_swap_b32 v53, v55
    buffer_store_dwordx4 v[52:55], v252, s[92:95], s53 offen offset:64
    s_add_u32 s53, s53, 32768
    s_waitcnt vmcnt(7)
    v_permlane16_swap_b32 v176, v178
    v_permlane16_swap_b32 v177, v179
    v_lshlrev_b32 v8, 16, v208
    v_and_b32 v9, 0xffff0000, v208
    v_lshlrev_b32 v10, 16, v209
    v_and_b32 v11, 0xffff0000, v209
    v_lshlrev_b32 v12, 16, v210
    v_and_b32 v13, 0xffff0000, v210
    v_lshlrev_b32 v14, 16, v211
    v_and_b32 v15, 0xffff0000, v211
    v_permlane32_swap_b32 v176, v178
    v_permlane32_swap_b32 v177, v179
    v_lshlrev_b32 v16, 16, v176
    v_and_b32 v17, 0xffff0000, v176
    v_lshlrev_b32 v18, 16, v177
    v_and_b32 v19, 0xffff0000, v177
    v_lshlrev_b32 v20, 16, v178
    v_and_b32 v21, 0xffff0000, v178
    v_lshlrev_b32 v22, 16, v179
    v_and_b32 v23, 0xffff0000, v179
    v_pk_fma_f32 v[8:9], v[96:97], v[8:9], v[16:17]
    v_pk_fma_f32 v[10:11], v[98:99], v[10:11], v[18:19]
    v_pk_fma_f32 v[12:13], v[100:101], v[12:13], v[20:21]
    v_pk_fma_f32 v[14:15], v[102:103], v[14:15], v[22:23]
    v_cvt_pk_bf16_f32 v24, v8, v9
    v_cvt_pk_bf16_f32 v25, v10, v11
    v_cvt_pk_bf16_f32 v26, v12, v13
    v_cvt_pk_bf16_f32 v27, v14, v15
    s_nop 0
    v_permlane32_swap_b32 v24, v26
    v_permlane32_swap_b32 v25, v27
    s_nop 0
    v_permlane16_swap_b32 v24, v26
    v_permlane16_swap_b32 v25, v27
    buffer_store_dwordx4 v[24:27], v252, s[92:95], s53 offen offset:0
    s_waitcnt vmcnt(7)
    v_permlane16_swap_b32 v180, v182
    v_permlane16_swap_b32 v181, v183
    v_lshlrev_b32 v36, 16, v212
    v_and_b32 v37, 0xffff0000, v212
    v_lshlrev_b32 v38, 16, v213
    v_and_b32 v39, 0xffff0000, v213
    v_lshlrev_b32 v40, 16, v214
    v_and_b32 v41, 0xffff0000, v214
    v_lshlrev_b32 v42, 16, v215
    v_and_b32 v43, 0xffff0000, v215
    v_permlane32_swap_b32 v180, v182
    v_permlane32_swap_b32 v181, v183
    v_lshlrev_b32 v44, 16, v180
    v_and_b32 v45, 0xffff0000, v180
    v_lshlrev_b32 v46, 16, v181
    v_and_b32 v47, 0xffff0000, v181
    v_lshlrev_b32 v48, 16, v182
    v_and_b32 v49, 0xffff0000, v182
    v_lshlrev_b32 v50, 16, v183
    v_and_b32 v51, 0xffff0000, v183
    v_pk_fma_f32 v[36:37], v[104:105], v[36:37], v[44:45]
    v_pk_fma_f32 v[38:39], v[106:107], v[38:39], v[46:47]
    v_pk_fma_f32 v[40:41], v[108:109], v[40:41], v[48:49]
    v_pk_fma_f32 v[42:43], v[110:111], v[42:43], v[50:51]
    v_cvt_pk_bf16_f32 v52, v36, v37
    v_cvt_pk_bf16_f32 v53, v38, v39
    v_cvt_pk_bf16_f32 v54, v40, v41
    v_cvt_pk_bf16_f32 v55, v42, v43
    s_nop 0
    v_permlane32_swap_b32 v52, v54
    v_permlane32_swap_b32 v53, v55
    s_nop 0
    v_permlane16_swap_b32 v52, v54
    v_permlane16_swap_b32 v53, v55
    buffer_store_dwordx4 v[52:55], v252, s[92:95], s53 offen offset:64
    s_add_u32 s53, s53, 32768
    s_waitcnt vmcnt(7)
    v_permlane16_swap_b32 v184, v186
    v_permlane16_swap_b32 v185, v187
    v_lshlrev_b32 v8, 16, v216
    v_and_b32 v9, 0xffff0000, v216
    v_lshlrev_b32 v10, 16, v217
    v_and_b32 v11, 0xffff0000, v217
    v_lshlrev_b32 v12, 16, v218
    v_and_b32 v13, 0xffff0000, v218
    v_lshlrev_b32 v14, 16, v219
    v_and_b32 v15, 0xffff0000, v219
    v_permlane32_swap_b32 v184, v186
    v_permlane32_swap_b32 v185, v187
    v_lshlrev_b32 v16, 16, v184
    v_and_b32 v17, 0xffff0000, v184
    v_lshlrev_b32 v18, 16, v185
    v_and_b32 v19, 0xffff0000, v185
    v_lshlrev_b32 v20, 16, v186
    v_and_b32 v21, 0xffff0000, v186
    v_lshlrev_b32 v22, 16, v187
    v_and_b32 v23, 0xffff0000, v187
    v_pk_fma_f32 v[8:9], v[112:113], v[8:9], v[16:17]
    v_pk_fma_f32 v[10:11], v[114:115], v[10:11], v[18:19]
    v_pk_fma_f32 v[12:13], v[116:117], v[12:13], v[20:21]
    v_pk_fma_f32 v[14:15], v[118:119], v[14:15], v[22:23]
    v_cvt_pk_bf16_f32 v24, v8, v9
    v_cvt_pk_bf16_f32 v25, v10, v11
    v_cvt_pk_bf16_f32 v26, v12, v13
    v_cvt_pk_bf16_f32 v27, v14, v15
    s_nop 0
    v_permlane32_swap_b32 v24, v26
    v_permlane32_swap_b32 v25, v27
    s_nop 0
    v_permlane16_swap_b32 v24, v26
    v_permlane16_swap_b32 v25, v27
    buffer_store_dwordx4 v[24:27], v252, s[92:95], s53 offen offset:0
    s_waitcnt vmcnt(7)
    v_permlane16_swap_b32 v188, v190
    v_permlane16_swap_b32 v189, v191
    v_lshlrev_b32 v36, 16, v220
    v_and_b32 v37, 0xffff0000, v220
    v_lshlrev_b32 v38, 16, v221
    v_and_b32 v39, 0xffff0000, v221
    v_lshlrev_b32 v40, 16, v222
    v_and_b32 v41, 0xffff0000, v222
    v_lshlrev_b32 v42, 16, v223
    v_and_b32 v43, 0xffff0000, v223
    v_permlane32_swap_b32 v188, v190
    v_permlane32_swap_b32 v189, v191
    v_lshlrev_b32 v44, 16, v188
    v_and_b32 v45, 0xffff0000, v188
    v_lshlrev_b32 v46, 16, v189
    v_and_b32 v47, 0xffff0000, v189
    v_lshlrev_b32 v48, 16, v190
    v_and_b32 v49, 0xffff0000, v190
    v_lshlrev_b32 v50, 16, v191
    v_and_b32 v51, 0xffff0000, v191
    v_pk_fma_f32 v[36:37], v[120:121], v[36:37], v[44:45]
    v_pk_fma_f32 v[38:39], v[122:123], v[38:39], v[46:47]
    v_pk_fma_f32 v[40:41], v[124:125], v[40:41], v[48:49]
    v_pk_fma_f32 v[42:43], v[126:127], v[42:43], v[50:51]
    v_cvt_pk_bf16_f32 v52, v36, v37
    v_cvt_pk_bf16_f32 v53, v38, v39
    v_cvt_pk_bf16_f32 v54, v40, v41
    v_cvt_pk_bf16_f32 v55, v42, v43
    s_nop 0
    v_permlane32_swap_b32 v52, v54
    v_permlane32_swap_b32 v53, v55
    s_nop 0
    v_permlane16_swap_b32 v52, v54
    v_permlane16_swap_b32 v53, v55
    buffer_store_dwordx4 v[52:55], v252, s[92:95], s53 offen offset:64
    s_branch main_kernel_w_done
main_kernel_w_c0_gov:
    v_lshrrev_b32 v0, 4, v250
    v_bfe_u32 v1, v250, 2, 2
    v_lshl_add_u32 v4, v0, 2, v1
    v_and_b32 v5, 7, v4
    v_mul_u32_u24 v4, 256, v4
    v_and_b32 v6, 3, v250
    v_lshl_add_u32 v4, v6, 3, v4
    s_mul_i32 s32, s37, 4
    v_xor_b32 v5, s32, v5
    v_lshl_add_u32 v128, v5, 5, v4
    v_xor_b32 v129, 32, v128
    v_xor_b32 v130, 64, v128
    v_xor_b32 v131, 96, v128
    s_mul_i32 s32, s38, 8192
    s_add_u32 s32, s32, 65536
    v_add_u32 v136, s32, v251
    v_lshrrev_b32 v2, 4, v250
    v_and_b32 v3, 15, v250
    s_mul_i32 s32, s14, 16
    v_add_u32 v4, s32, v2
    v_add_u32 v5, 0, v4
    v_and_b32 v6, 7, v5
    v_lshlrev_b32 v6, 1, v6
    v_xor_b32 v6, v6, v3
    v_mul_lo_u32 v5, v5, s30
    v_lshl_add_u32 v5, v6, 4, v5
    v_subrev_u32 v137, 0, v5
    v_add_u32 v5, 4, v4
    v_and_b32 v6, 7, v5
    v_lshlrev_b32 v6, 1, v6
    v_xor_b32 v6, v6, v3
    v_mul_lo_u32 v5, v5, s30
    v_lshl_add_u32 v5, v6, 4, v5
    v_subrev_u32 v138, 1024, v5
    v_add_u32 v5, 8, v4
    v_and_b32 v6, 7, v5
    v_lshlrev_b32 v6, 1, v6
    v_xor_b32 v6, v6, v3
    v_mul_lo_u32 v5, v5, s30
    v_lshl_add_u32 v5, v6, 4, v5
    v_subrev_u32 v139, 2048, v5
    v_add_u32 v5, 12, v4
    v_and_b32 v6, 7, v5
    v_lshlrev_b32 v6, 1, v6
    v_xor_b32 v6, v6, v3
    v_mul_lo_u32 v5, v5, s30
    v_lshl_add_u32 v5, v6, 4, v5
    v_subrev_u32 v140, 3072, v5
    s_mul_i32 s32, s14, 2
    s_mul_i32 s32, s32, s31
    v_add_u32 v141, s32, v251
    s_add_u32 s32, s32, s31
    s_sub_u32 s32, s32, 2048
    v_add_u32 v142, s32, v251
    s_mul_i32 s19, s14, 4096
    s_mul_i32 s20, s14, 4096
    s_add_u32 s20, s20, 65536
    s_mul_i32 s17, s30, 64
    s_mov_b32 s15, 0
    s_add_u32 m0, s20, 0
    s_nop 0
    buffer_load_dwordx4 v141, s[4:7], s16 offen offset:0 sc1 lds
    buffer_load_dwordx4 v141, s[4:7], s16 offen offset:1024 sc1 lds
    buffer_load_dwordx4 v142, s[4:7], s16 offen offset:2048 sc1 lds
    buffer_load_dwordx4 v142, s[4:7], s16 offen offset:3072 sc1 lds
    s_add_u32 s16, s16, 2048
    s_add_u32 m0, s19, 0
    s_nop 0
    buffer_load_dwordx4 v137, s[8:11], s15 offen offset:0 lds
    buffer_load_dwordx4 v138, s[8:11], s15 offen offset:1024 lds
    buffer_load_dwordx4 v139, s[8:11], s15 offen offset:2048 lds
    buffer_load_dwordx4 v140, s[8:11], s15 offen offset:3072 lds
    s_add_u32 s15, s15, s17
    s_add_u32 m0, s20, 16384
    s_nop 0
    buffer_load_dwordx4 v141, s[4:7], s16 offen offset:0 sc1 lds
    buffer_load_dwordx4 v141, s[4:7], s16 offen offset:1024 sc1 lds
    buffer_load_dwordx4 v142, s[4:7], s16 offen offset:2048 sc1 lds
    buffer_load_dwordx4 v142, s[4:7], s16 offen offset:3072 sc1 lds
    s_add_u32 s16, s16, 2048
    s_add_u32 m0, s19, 16384
    s_nop 0
    buffer_load_dwordx4 v137, s[8:11], s15 offen offset:0 lds
    buffer_load_dwordx4 v138, s[8:11], s15 offen offset:1024 lds
    buffer_load_dwordx4 v139, s[8:11], s15 offen offset:2048 lds
    buffer_load_dwordx4 v140, s[8:11], s15 offen offset:3072 lds
    s_add_u32 s15, s15, s17
    s_add_u32 m0, s20, 32768
    s_nop 0
    buffer_load_dwordx4 v141, s[4:7], s16 offen offset:0 sc1 lds
    buffer_load_dwordx4 v141, s[4:7], s16 offen offset:1024 sc1 lds
    buffer_load_dwordx4 v142, s[4:7], s16 offen offset:2048 sc1 lds
    buffer_load_dwordx4 v142, s[4:7], s16 offen offset:3072 sc1 lds
    s_add_u32 s16, s16, 2048
    s_add_u32 m0, s19, 32768
    s_nop 0
    buffer_load_dwordx4 v137, s[8:11], s15 offen offset:0 lds
    buffer_load_dwordx4 v138, s[8:11], s15 offen offset:1024 lds
    buffer_load_dwordx4 v139, s[8:11], s15 offen offset:2048 lds
    buffer_load_dwordx4 v140, s[8:11], s15 offen offset:3072 lds
    s_add_u32 s15, s15, s17
    s_add_u32 m0, s20, 49152
    s_nop 0
    buffer_load_dwordx4 v141, s[4:7], s16 offen offset:0 sc1 lds
    buffer_load_dwordx4 v141, s[4:7], s16 offen offset:1024 sc1 lds
    buffer_load_dwordx4 v142, s[4:7], s16 offen offset:2048 sc1 lds
    buffer_load_dwordx4 v142, s[4:7], s16 offen offset:3072 sc1 lds
    s_add_u32 s16, s16, 2048
    v_mov_b32 v64, 0
    v_mov_b32 v65, 0
    v_mov_b32 v66, 0
    v_mov_b32 v67, 0
    v_mov_b32 v68, 0
    v_mov_b32 v69, 0
    v_mov_b32 v70, 0
    v_mov_b32 v71, 0
    v_mov_b32 v72, 0
    v_mov_b32 v73, 0
    v_mov_b32 v74, 0
    v_mov_b32 v75, 0
    v_mov_b32 v76, 0
    v_mov_b32 v77, 0
    v_mov_b32 v78, 0
    v_mov_b32 v79, 0
    v_mov_b32 v80, 0
    v_mov_b32 v81, 0
    v_mov_b32 v82, 0
    v_mov_b32 v83, 0
    v_mov_b32 v84, 0
    v_mov_b32 v85, 0
    v_mov_b32 v86, 0
    v_mov_b32 v87, 0
    v_mov_b32 v88, 0
    v_mov_b32 v89, 0
    v_mov_b32 v90, 0
    v_mov_b32 v91, 0
    v_mov_b32 v92, 0
    v_mov_b32 v93, 0
    v_mov_b32 v94, 0
    v_mov_b32 v95, 0
    v_mov_b32 v96, 0
    v_mov_b32 v97, 0
    v_mov_b32 v98, 0
    v_mov_b32 v99, 0
    v_mov_b32 v100, 0
    v_mov_b32 v101, 0
    v_mov_b32 v102, 0
    v_mov_b32 v103, 0
    v_mov_b32 v104, 0
    v_mov_b32 v105, 0
    v_mov_b32 v106, 0
    v_mov_b32 v107, 0
    v_mov_b32 v108, 0
    v_mov_b32 v109, 0
    v_mov_b32 v110, 0
    v_mov_b32 v111, 0
    v_mov_b32 v112, 0
    v_mov_b32 v113, 0
    v_mov_b32 v114, 0
    v_mov_b32 v115, 0
    v_mov_b32 v116, 0
    v_mov_b32 v117, 0
    v_mov_b32 v118, 0
    v_mov_b32 v119, 0
    v_mov_b32 v120, 0
    v_mov_b32 v121, 0
    v_mov_b32 v122, 0
    v_mov_b32 v123, 0
    v_mov_b32 v124, 0
    v_mov_b32 v125, 0
    v_mov_b32 v126, 0
    v_mov_b32 v127, 0
    s_waitcnt vmcnt(20)
    s_barrier
    ds_read_b128 v[16:19], v136 offset:0
    ds_read_b64_tr_b16 v[0:1], v128 offset:0
    ds_read_b64_tr_b16 v[2:3], v128 offset:4096
    ds_read_b64_tr_b16 v[4:5], v129 offset:0
    ds_read_b64_tr_b16 v[6:7], v129 offset:4096
    ds_read_b64_tr_b16 v[8:9], v130 offset:0
    ds_read_b64_tr_b16 v[10:11], v130 offset:4096
    ds_read_b64_tr_b16 v[12:13], v131 offset:0
    ds_read_b64_tr_b16 v[14:15], v131 offset:4096
    ds_read_b128 v[20:23], v136 offset:2048
    ds_read_b128 v[24:27], v136 offset:4096
    ds_read_b128 v[28:31], v136 offset:6144
main_kernel_w_c0_v_loop:
    s_waitcnt lgkmcnt(0)
    ds_read_b128 v[48:51], v136 offset:1024
    s_add_u32 m0, s19, 49152
    s_nop 0
    v_mfma_f32_16x16x32_bf16 v[64:67], v[16:19], v[0:3], v[64:67]
    ds_read_b64_tr_b16 v[32:33], v128 offset:8192
    v_mfma_f32_16x16x32_bf16 v[68:71], v[16:19], v[4:7], v[68:71]
    ds_read_b64_tr_b16 v[34:35], v128 offset:12288
    buffer_load_dwordx4 v137, s[8:11], s15 offen offset:0 lds
    v_mfma_f32_16x16x32_bf16 v[72:75], v[16:19], v[8:11], v[72:75]
    ds_read_b64_tr_b16 v[36:37], v129 offset:8192
    v_mfma_f32_16x16x32_bf16 v[76:79], v[16:19], v[12:15], v[76:79]
    ds_read_b64_tr_b16 v[38:39], v129 offset:12288
    v_mfma_f32_16x16x32_bf16 v[80:83], v[20:23], v[0:3], v[80:83]
    ds_read_b64_tr_b16 v[40:41], v130 offset:8192
    buffer_load_dwordx4 v138, s[8:11], s15 offen offset:1024 lds
    v_mfma_f32_16x16x32_bf16 v[84:87], v[20:23], v[4:7], v[84:87]
    ds_read_b64_tr_b16 v[42:43], v130 offset:12288
    v_mfma_f32_16x16x32_bf16 v[88:91], v[20:23], v[8:11], v[88:91]
    ds_read_b64_tr_b16 v[44:45], v131 offset:8192
    v_mfma_f32_16x16x32_bf16 v[92:95], v[20:23], v[12:15], v[92:95]
    ds_read_b64_tr_b16 v[46:47], v131 offset:12288
    buffer_load_dwordx4 v139, s[8:11], s15 offen offset:2048 lds
    v_mfma_f32_16x16x32_bf16 v[96:99], v[24:27], v[0:3], v[96:99]
    ds_read_b128 v[52:55], v136 offset:3072
    v_mfma_f32_16x16x32_bf16 v[100:103], v[24:27], v[4:7], v[100:103]
    ds_read_b128 v[56:59], v136 offset:5120
    buffer_load_dwordx4 v140, s[8:11], s15 offen offset:3072 lds
    v_mfma_f32_16x16x32_bf16 v[104:107], v[24:27], v[8:11], v[104:107]
    ds_read_b128 v[60:63], v136 offset:7168
    v_mfma_f32_16x16x32_bf16 v[108:111], v[24:27], v[12:15], v[108:111]
    v_mfma_f32_16x16x32_bf16 v[112:115], v[28:31], v[0:3], v[112:115]
    s_add_u32 s15, s15, s17
    v_mfma_f32_16x16x32_bf16 v[116:119], v[28:31], v[4:7], v[116:119]
    v_mfma_f32_16x16x32_bf16 v[120:123], v[28:31], v[8:11], v[120:123]
    v_mfma_f32_16x16x32_bf16 v[124:127], v[28:31], v[12:15], v[124:127]
    s_waitcnt lgkmcnt(0)
    v_mfma_f32_16x16x32_bf16 v[64:67], v[48:51], v[32:35], v[64:67]
    s_waitcnt vmcnt(16)
    s_barrier
    ds_read_b128 v[16:19], v136 offset:16384
    s_add_u32 m0, s20, 0
    s_nop 0
    v_mfma_f32_16x16x32_bf16 v[68:71], v[48:51], v[36:39], v[68:71]
    ds_read_b64_tr_b16 v[0:1], v128 offset:16384
    v_mfma_f32_16x16x32_bf16 v[72:75], v[48:51], v[40:43], v[72:75]
    ds_read_b64_tr_b16 v[2:3], v128 offset:20480
    buffer_load_dwordx4 v141, s[4:7], s16 offen offset:0 sc1 lds
    v_mfma_f32_16x16x32_bf16 v[76:79], v[48:51], v[44:47], v[76:79]
    ds_read_b64_tr_b16 v[4:5], v129 offset:16384
    v_mfma_f32_16x16x32_bf16 v[80:83], v[52:55], v[32:35], v[80:83]
    ds_read_b64_tr_b16 v[6:7], v129 offset:20480
    v_mfma_f32_16x16x32_bf16 v[84:87], v[52:55], v[36:39], v[84:87]
    ds_read_b64_tr_b16 v[8:9], v130 offset:16384
    buffer_load_dwordx4 v141, s[4:7], s16 offen offset:1024 sc1 lds
    v_mfma_f32_16x16x32_bf16 v[88:91], v[52:55], v[40:43], v[88:91]
    ds_read_b64_tr_b16 v[10:11], v130 offset:20480
    v_mfma_f32_16x16x32_bf16 v[92:95], v[52:55], v[44:47], v[92:95]
    ds_read_b64_tr_b16 v[12:13], v131 offset:16384
    buffer_load_dwordx4 v142, s[4:7], s16 offen offset:2048 sc1 lds
    v_mfma_f32_16x16x32_bf16 v[96:99], v[56:59], v[32:35], v[96:99]
    ds_read_b64_tr_b16 v[14:15], v131 offset:20480
    v_mfma_f32_16x16x32_bf16 v[100:103], v[56:59], v[36:39], v[100:103]
    ds_read_b128 v[20:23], v136 offset:18432
    v_mfma_f32_16x16x32_bf16 v[104:107], v[56:59], v[40:43], v[104:107]
    ds_read_b128 v[24:27], v136 offset:20480
    buffer_load_dwordx4 v142, s[4:7], s16 offen offset:3072 sc1 lds
    v_mfma_f32_16x16x32_bf16 v[108:111], v[56:59], v[44:47], v[108:111]
    ds_read_b128 v[28:31], v136 offset:22528
    v_mfma_f32_16x16x32_bf16 v[112:115], v[60:63], v[32:35], v[112:115]
    s_add_u32 s16, s16, 2048
    v_mfma_f32_16x16x32_bf16 v[116:119], v[60:63], v[36:39], v[116:119]
    v_mfma_f32_16x16x32_bf16 v[120:123], v[60:63], v[40:43], v[120:123]
    v_mfma_f32_16x16x32_bf16 v[124:127], v[60:63], v[44:47], v[124:127]
    s_waitcnt lgkmcnt(0)
    ds_read_b128 v[48:51], v136 offset:17408
    s_add_u32 m0, s19, 0
    s_nop 0
    v_mfma_f32_16x16x32_bf16 v[64:67], v[16:19], v[0:3], v[64:67]
    ds_read_b64_tr_b16 v[32:33], v128 offset:24576
    v_mfma_f32_16x16x32_bf16 v[68:71], v[16:19], v[4:7], v[68:71]
    ds_read_b64_tr_b16 v[34:35], v128 offset:28672
    buffer_load_dwordx4 v137, s[8:11], s15 offen offset:0 lds
    v_mfma_f32_16x16x32_bf16 v[72:75], v[16:19], v[8:11], v[72:75]
    ds_read_b64_tr_b16 v[36:37], v129 offset:24576
    v_mfma_f32_16x16x32_bf16 v[76:79], v[16:19], v[12:15], v[76:79]
    ds_read_b64_tr_b16 v[38:39], v129 offset:28672
    v_mfma_f32_16x16x32_bf16 v[80:83], v[20:23], v[0:3], v[80:83]
    ds_read_b64_tr_b16 v[40:41], v130 offset:24576
    buffer_load_dwordx4 v138, s[8:11], s15 offen offset:1024 lds
    v_mfma_f32_16x16x32_bf16 v[84:87], v[20:23], v[4:7], v[84:87]
    ds_read_b64_tr_b16 v[42:43], v130 offset:28672
    v_mfma_f32_16x16x32_bf16 v[88:91], v[20:23], v[8:11], v[88:91]
    ds_read_b64_tr_b16 v[44:45], v131 offset:24576
    v_mfma_f32_16x16x32_bf16 v[92:95], v[20:23], v[12:15], v[92:95]
    ds_read_b64_tr_b16 v[46:47], v131 offset:28672
    buffer_load_dwordx4 v139, s[8:11], s15 offen offset:2048 lds
    v_mfma_f32_16x16x32_bf16 v[96:99], v[24:27], v[0:3], v[96:99]
    ds_read_b128 v[52:55], v136 offset:19456
    v_mfma_f32_16x16x32_bf16 v[100:103], v[24:27], v[4:7], v[100:103]
    ds_read_b128 v[56:59], v136 offset:21504
    buffer_load_dwordx4 v140, s[8:11], s15 offen offset:3072 lds
    v_mfma_f32_16x16x32_bf16 v[104:107], v[24:27], v[8:11], v[104:107]
    ds_read_b128 v[60:63], v136 offset:23552
    v_mfma_f32_16x16x32_bf16 v[108:111], v[24:27], v[12:15], v[108:111]
    v_mfma_f32_16x16x32_bf16 v[112:115], v[28:31], v[0:3], v[112:115]
    s_add_u32 s15, s15, s17
    v_mfma_f32_16x16x32_bf16 v[116:119], v[28:31], v[4:7], v[116:119]
    v_mfma_f32_16x16x32_bf16 v[120:123], v[28:31], v[8:11], v[120:123]
    v_mfma_f32_16x16x32_bf16 v[124:127], v[28:31], v[12:15], v[124:127]
    s_waitcnt lgkmcnt(0)
    v_mfma_f32_16x16x32_bf16 v[64:67], v[48:51], v[32:35], v[64:67]
    s_waitcnt vmcnt(16)
    s_barrier
    ds_read_b128 v[16:19], v136 offset:32768
    s_add_u32 m0, s20, 16384
    s_nop 0
    v_mfma_f32_16x16x32_bf16 v[68:71], v[48:51], v[36:39], v[68:71]
    ds_read_b64_tr_b16 v[0:1], v128 offset:32768
    v_mfma_f32_16x16x32_bf16 v[72:75], v[48:51], v[40:43], v[72:75]
    ds_read_b64_tr_b16 v[2:3], v128 offset:36864
    buffer_load_dwordx4 v141, s[4:7], s16 offen offset:0 sc1 lds
    v_mfma_f32_16x16x32_bf16 v[76:79], v[48:51], v[44:47], v[76:79]
    ds_read_b64_tr_b16 v[4:5], v129 offset:32768
    v_mfma_f32_16x16x32_bf16 v[80:83], v[52:55], v[32:35], v[80:83]
    ds_read_b64_tr_b16 v[6:7], v129 offset:36864
    v_mfma_f32_16x16x32_bf16 v[84:87], v[52:55], v[36:39], v[84:87]
    ds_read_b64_tr_b16 v[8:9], v130 offset:32768
    buffer_load_dwordx4 v141, s[4:7], s16 offen offset:1024 sc1 lds
    v_mfma_f32_16x16x32_bf16 v[88:91], v[52:55], v[40:43], v[88:91]
    ds_read_b64_tr_b16 v[10:11], v130 offset:36864
    v_mfma_f32_16x16x32_bf16 v[92:95], v[52:55], v[44:47], v[92:95]
    ds_read_b64_tr_b16 v[12:13], v131 offset:32768
    buffer_load_dwordx4 v142, s[4:7], s16 offen offset:2048 sc1 lds
    v_mfma_f32_16x16x32_bf16 v[96:99], v[56:59], v[32:35], v[96:99]
    ds_read_b64_tr_b16 v[14:15], v131 offset:36864
    v_mfma_f32_16x16x32_bf16 v[100:103], v[56:59], v[36:39], v[100:103]
    ds_read_b128 v[20:23], v136 offset:34816
    v_mfma_f32_16x16x32_bf16 v[104:107], v[56:59], v[40:43], v[104:107]
    ds_read_b128 v[24:27], v136 offset:36864
    buffer_load_dwordx4 v142, s[4:7], s16 offen offset:3072 sc1 lds
    v_mfma_f32_16x16x32_bf16 v[108:111], v[56:59], v[44:47], v[108:111]
    ds_read_b128 v[28:31], v136 offset:38912
    v_mfma_f32_16x16x32_bf16 v[112:115], v[60:63], v[32:35], v[112:115]
    s_add_u32 s16, s16, 2048
    v_mfma_f32_16x16x32_bf16 v[116:119], v[60:63], v[36:39], v[116:119]
    v_mfma_f32_16x16x32_bf16 v[120:123], v[60:63], v[40:43], v[120:123]
    v_mfma_f32_16x16x32_bf16 v[124:127], v[60:63], v[44:47], v[124:127]
    s_waitcnt lgkmcnt(0)
    ds_read_b128 v[48:51], v136 offset:33792
    s_add_u32 m0, s19, 16384
    s_nop 0
    v_mfma_f32_16x16x32_bf16 v[64:67], v[16:19], v[0:3], v[64:67]
    ds_read_b64_tr_b16 v[32:33], v128 offset:40960
    v_mfma_f32_16x16x32_bf16 v[68:71], v[16:19], v[4:7], v[68:71]
    ds_read_b64_tr_b16 v[34:35], v128 offset:45056
    buffer_load_dwordx4 v137, s[8:11], s15 offen offset:0 lds
    v_mfma_f32_16x16x32_bf16 v[72:75], v[16:19], v[8:11], v[72:75]
    ds_read_b64_tr_b16 v[36:37], v129 offset:40960
    v_mfma_f32_16x16x32_bf16 v[76:79], v[16:19], v[12:15], v[76:79]
    ds_read_b64_tr_b16 v[38:39], v129 offset:45056
    v_mfma_f32_16x16x32_bf16 v[80:83], v[20:23], v[0:3], v[80:83]
    ds_read_b64_tr_b16 v[40:41], v130 offset:40960
    buffer_load_dwordx4 v138, s[8:11], s15 offen offset:1024 lds
    v_mfma_f32_16x16x32_bf16 v[84:87], v[20:23], v[4:7], v[84:87]
    ds_read_b64_tr_b16 v[42:43], v130 offset:45056
    v_mfma_f32_16x16x32_bf16 v[88:91], v[20:23], v[8:11], v[88:91]
    ds_read_b64_tr_b16 v[44:45], v131 offset:40960
    v_mfma_f32_16x16x32_bf16 v[92:95], v[20:23], v[12:15], v[92:95]
    ds_read_b64_tr_b16 v[46:47], v131 offset:45056
    buffer_load_dwordx4 v139, s[8:11], s15 offen offset:2048 lds
    v_mfma_f32_16x16x32_bf16 v[96:99], v[24:27], v[0:3], v[96:99]
    ds_read_b128 v[52:55], v136 offset:35840
    v_mfma_f32_16x16x32_bf16 v[100:103], v[24:27], v[4:7], v[100:103]
    ds_read_b128 v[56:59], v136 offset:37888
    buffer_load_dwordx4 v140, s[8:11], s15 offen offset:3072 lds
    v_mfma_f32_16x16x32_bf16 v[104:107], v[24:27], v[8:11], v[104:107]
    ds_read_b128 v[60:63], v136 offset:39936
    v_mfma_f32_16x16x32_bf16 v[108:111], v[24:27], v[12:15], v[108:111]
    v_mfma_f32_16x16x32_bf16 v[112:115], v[28:31], v[0:3], v[112:115]
    s_add_u32 s15, s15, s17
    v_mfma_f32_16x16x32_bf16 v[116:119], v[28:31], v[4:7], v[116:119]
    v_mfma_f32_16x16x32_bf16 v[120:123], v[28:31], v[8:11], v[120:123]
    v_mfma_f32_16x16x32_bf16 v[124:127], v[28:31], v[12:15], v[124:127]
    s_waitcnt lgkmcnt(0)
    v_mfma_f32_16x16x32_bf16 v[64:67], v[48:51], v[32:35], v[64:67]
    s_waitcnt vmcnt(16)
    s_barrier
    ds_read_b128 v[16:19], v136 offset:49152
    s_add_u32 m0, s20, 32768
    s_nop 0
    v_mfma_f32_16x16x32_bf16 v[68:71], v[48:51], v[36:39], v[68:71]
    ds_read_b64_tr_b16 v[0:1], v128 offset:49152
    v_mfma_f32_16x16x32_bf16 v[72:75], v[48:51], v[40:43], v[72:75]
    ds_read_b64_tr_b16 v[2:3], v128 offset:53248
    buffer_load_dwordx4 v141, s[4:7], s16 offen offset:0 sc1 lds
    v_mfma_f32_16x16x32_bf16 v[76:79], v[48:51], v[44:47], v[76:79]
    ds_read_b64_tr_b16 v[4:5], v129 offset:49152
    v_mfma_f32_16x16x32_bf16 v[80:83], v[52:55], v[32:35], v[80:83]
    ds_read_b64_tr_b16 v[6:7], v129 offset:53248
    v_mfma_f32_16x16x32_bf16 v[84:87], v[52:55], v[36:39], v[84:87]
    ds_read_b64_tr_b16 v[8:9], v130 offset:49152
    buffer_load_dwordx4 v141, s[4:7], s16 offen offset:1024 sc1 lds
    v_mfma_f32_16x16x32_bf16 v[88:91], v[52:55], v[40:43], v[88:91]
    ds_read_b64_tr_b16 v[10:11], v130 offset:53248
    v_mfma_f32_16x16x32_bf16 v[92:95], v[52:55], v[44:47], v[92:95]
    ds_read_b64_tr_b16 v[12:13], v131 offset:49152
    buffer_load_dwordx4 v142, s[4:7], s16 offen offset:2048 sc1 lds
    v_mfma_f32_16x16x32_bf16 v[96:99], v[56:59], v[32:35], v[96:99]
    ds_read_b64_tr_b16 v[14:15], v131 offset:53248
    v_mfma_f32_16x16x32_bf16 v[100:103], v[56:59], v[36:39], v[100:103]
    ds_read_b128 v[20:23], v136 offset:51200
    v_mfma_f32_16x16x32_bf16 v[104:107], v[56:59], v[40:43], v[104:107]
    ds_read_b128 v[24:27], v136 offset:53248
    buffer_load_dwordx4 v142, s[4:7], s16 offen offset:3072 sc1 lds
    v_mfma_f32_16x16x32_bf16 v[108:111], v[56:59], v[44:47], v[108:111]
    ds_read_b128 v[28:31], v136 offset:55296
    v_mfma_f32_16x16x32_bf16 v[112:115], v[60:63], v[32:35], v[112:115]
    s_add_u32 s16, s16, 2048
    v_mfma_f32_16x16x32_bf16 v[116:119], v[60:63], v[36:39], v[116:119]
    v_mfma_f32_16x16x32_bf16 v[120:123], v[60:63], v[40:43], v[120:123]
    v_mfma_f32_16x16x32_bf16 v[124:127], v[60:63], v[44:47], v[124:127]
    s_waitcnt lgkmcnt(0)
    ds_read_b128 v[48:51], v136 offset:50176
    s_add_u32 m0, s19, 32768
    s_nop 0
    v_mfma_f32_16x16x32_bf16 v[64:67], v[16:19], v[0:3], v[64:67]
    ds_read_b64_tr_b16 v[32:33], v128 offset:57344
    v_mfma_f32_16x16x32_bf16 v[68:71], v[16:19], v[4:7], v[68:71]
    ds_read_b64_tr_b16 v[34:35], v128 offset:61440
    buffer_load_dwordx4 v137, s[8:11], s15 offen offset:0 lds
    v_mfma_f32_16x16x32_bf16 v[72:75], v[16:19], v[8:11], v[72:75]
    ds_read_b64_tr_b16 v[36:37], v129 offset:57344
    v_mfma_f32_16x16x32_bf16 v[76:79], v[16:19], v[12:15], v[76:79]
    ds_read_b64_tr_b16 v[38:39], v129 offset:61440
    v_mfma_f32_16x16x32_bf16 v[80:83], v[20:23], v[0:3], v[80:83]
    ds_read_b64_tr_b16 v[40:41], v130 offset:57344
    buffer_load_dwordx4 v138, s[8:11], s15 offen offset:1024 lds
    v_mfma_f32_16x16x32_bf16 v[84:87], v[20:23], v[4:7], v[84:87]
    ds_read_b64_tr_b16 v[42:43], v130 offset:61440
    v_mfma_f32_16x16x32_bf16 v[88:91], v[20:23], v[8:11], v[88:91]
    ds_read_b64_tr_b16 v[44:45], v131 offset:57344
    v_mfma_f32_16x16x32_bf16 v[92:95], v[20:23], v[12:15], v[92:95]
    ds_read_b64_tr_b16 v[46:47], v131 offset:61440
    buffer_load_dwordx4 v139, s[8:11], s15 offen offset:2048 lds
    v_mfma_f32_16x16x32_bf16 v[96:99], v[24:27], v[0:3], v[96:99]
    ds_read_b128 v[52:55], v136 offset:52224
    v_mfma_f32_16x16x32_bf16 v[100:103], v[24:27], v[4:7], v[100:103]
    ds_read_b128 v[56:59], v136 offset:54272
    buffer_load_dwordx4 v140, s[8:11], s15 offen offset:3072 lds
    v_mfma_f32_16x16x32_bf16 v[104:107], v[24:27], v[8:11], v[104:107]
    ds_read_b128 v[60:63], v136 offset:56320
    v_mfma_f32_16x16x32_bf16 v[108:111], v[24:27], v[12:15], v[108:111]
    v_mfma_f32_16x16x32_bf16 v[112:115], v[28:31], v[0:3], v[112:115]
    s_add_u32 s15, s15, s17
    v_mfma_f32_16x16x32_bf16 v[116:119], v[28:31], v[4:7], v[116:119]
    v_mfma_f32_16x16x32_bf16 v[120:123], v[28:31], v[8:11], v[120:123]
    v_mfma_f32_16x16x32_bf16 v[124:127], v[28:31], v[12:15], v[124:127]
    s_waitcnt lgkmcnt(0)
    v_mfma_f32_16x16x32_bf16 v[64:67], v[48:51], v[32:35], v[64:67]
    s_waitcnt vmcnt(16)
    s_barrier
    ds_read_b128 v[16:19], v136 offset:0
    s_add_u32 m0, s20, 49152
    s_nop 0
    v_mfma_f32_16x16x32_bf16 v[68:71], v[48:51], v[36:39], v[68:71]
    ds_read_b64_tr_b16 v[0:1], v128 offset:0
    v_mfma_f32_16x16x32_bf16 v[72:75], v[48:51], v[40:43], v[72:75]
    ds_read_b64_tr_b16 v[2:3], v128 offset:4096
    buffer_load_dwordx4 v141, s[4:7], s16 offen offset:0 sc1 lds
    v_mfma_f32_16x16x32_bf16 v[76:79], v[48:51], v[44:47], v[76:79]
    ds_read_b64_tr_b16 v[4:5], v129 offset:0
    v_mfma_f32_16x16x32_bf16 v[80:83], v[52:55], v[32:35], v[80:83]
    ds_read_b64_tr_b16 v[6:7], v129 offset:4096
    v_mfma_f32_16x16x32_bf16 v[84:87], v[52:55], v[36:39], v[84:87]
    ds_read_b64_tr_b16 v[8:9], v130 offset:0
    buffer_load_dwordx4 v141, s[4:7], s16 offen offset:1024 sc1 lds
    v_mfma_f32_16x16x32_bf16 v[88:91], v[52:55], v[40:43], v[88:91]
    ds_read_b64_tr_b16 v[10:11], v130 offset:4096
    v_mfma_f32_16x16x32_bf16 v[92:95], v[52:55], v[44:47], v[92:95]
    ds_read_b64_tr_b16 v[12:13], v131 offset:0
    buffer_load_dwordx4 v142, s[4:7], s16 offen offset:2048 sc1 lds
    v_mfma_f32_16x16x32_bf16 v[96:99], v[56:59], v[32:35], v[96:99]
    ds_read_b64_tr_b16 v[14:15], v131 offset:4096
    v_mfma_f32_16x16x32_bf16 v[100:103], v[56:59], v[36:39], v[100:103]
    ds_read_b128 v[20:23], v136 offset:2048
    v_mfma_f32_16x16x32_bf16 v[104:107], v[56:59], v[40:43], v[104:107]
    ds_read_b128 v[24:27], v136 offset:4096
    buffer_load_dwordx4 v142, s[4:7], s16 offen offset:3072 sc1 lds
    v_mfma_f32_16x16x32_bf16 v[108:111], v[56:59], v[44:47], v[108:111]
    ds_read_b128 v[28:31], v136 offset:6144
    v_mfma_f32_16x16x32_bf16 v[112:115], v[60:63], v[32:35], v[112:115]
    s_add_u32 s16, s16, 2048
    v_mfma_f32_16x16x32_bf16 v[116:119], v[60:63], v[36:39], v[116:119]
    v_mfma_f32_16x16x32_bf16 v[120:123], v[60:63], v[40:43], v[120:123]
    v_mfma_f32_16x16x32_bf16 v[124:127], v[60:63], v[44:47], v[124:127]
    s_sub_u32 s18, s18, 1
    s_cmp_lg_u32 s18, 0
    s_cbranch_scc1 main_kernel_w_c0_v_loop
    s_cmp_lg_u32 s14, 0
    s_cbranch_scc1 main_kernel_w_c0_v_nt
    s_lshl_b32 s32, s27, 8
    s_add_u32 s32, s32, 0x841e000
    v_mov_b32 v255, 1
    s_mov_b64 exec, 1
    buffer_atomic_add v255, off, s[4:7], s32 sc0 sc1
    s_mov_b64 exec, -1
main_kernel_w_c0_v_nt:
    s_waitcnt lgkmcnt(0)
    ds_read_b128 v[48:51], v136 offset:1024
    s_add_u32 m0, s19, 49152
    s_nop 0
    v_mfma_f32_16x16x32_bf16 v[64:67], v[16:19], v[0:3], v[64:67]
    ds_read_b64_tr_b16 v[32:33], v128 offset:8192
    v_mfma_f32_16x16x32_bf16 v[68:71], v[16:19], v[4:7], v[68:71]
    ds_read_b64_tr_b16 v[34:35], v128 offset:12288
    buffer_load_dwordx4 v137, s[8:11], s15 offen offset:0 lds
    v_mfma_f32_16x16x32_bf16 v[72:75], v[16:19], v[8:11], v[72:75]
    ds_read_b64_tr_b16 v[36:37], v129 offset:8192
    v_mfma_f32_16x16x32_bf16 v[76:79], v[16:19], v[12:15], v[76:79]
    ds_read_b64_tr_b16 v[38:39], v129 offset:12288
    v_mfma_f32_16x16x32_bf16 v[80:83], v[20:23], v[0:3], v[80:83]
    ds_read_b64_tr_b16 v[40:41], v130 offset:8192
    buffer_load_dwordx4 v138, s[8:11], s15 offen offset:1024 lds
    v_mfma_f32_16x16x32_bf16 v[84:87], v[20:23], v[4:7], v[84:87]
    ds_read_b64_tr_b16 v[42:43], v130 offset:12288
    v_mfma_f32_16x16x32_bf16 v[88:91], v[20:23], v[8:11], v[88:91]
    ds_read_b64_tr_b16 v[44:45], v131 offset:8192
    v_mfma_f32_16x16x32_bf16 v[92:95], v[20:23], v[12:15], v[92:95]
    ds_read_b64_tr_b16 v[46:47], v131 offset:12288
    buffer_load_dwordx4 v139, s[8:11], s15 offen offset:2048 lds
    v_mfma_f32_16x16x32_bf16 v[96:99], v[24:27], v[0:3], v[96:99]
    ds_read_b128 v[52:55], v136 offset:3072
    v_mfma_f32_16x16x32_bf16 v[100:103], v[24:27], v[4:7], v[100:103]
    ds_read_b128 v[56:59], v136 offset:5120
    buffer_load_dwordx4 v140, s[8:11], s15 offen offset:3072 lds
    v_mfma_f32_16x16x32_bf16 v[104:107], v[24:27], v[8:11], v[104:107]
    ds_read_b128 v[60:63], v136 offset:7168
    v_mfma_f32_16x16x32_bf16 v[108:111], v[24:27], v[12:15], v[108:111]
    v_mfma_f32_16x16x32_bf16 v[112:115], v[28:31], v[0:3], v[112:115]
    s_add_u32 s15, s15, s17
    v_mfma_f32_16x16x32_bf16 v[116:119], v[28:31], v[4:7], v[116:119]
    v_mfma_f32_16x16x32_bf16 v[120:123], v[28:31], v[8:11], v[120:123]
    v_mfma_f32_16x16x32_bf16 v[124:127], v[28:31], v[12:15], v[124:127]
    s_waitcnt lgkmcnt(0)
    v_mfma_f32_16x16x32_bf16 v[64:67], v[48:51], v[32:35], v[64:67]
    s_waitcnt vmcnt(16)
    s_barrier
    ds_read_b128 v[16:19], v136 offset:16384
    v_mfma_f32_16x16x32_bf16 v[68:71], v[48:51], v[36:39], v[68:71]
    ds_read_b64_tr_b16 v[0:1], v128 offset:16384
    v_mfma_f32_16x16x32_bf16 v[72:75], v[48:51], v[40:43], v[72:75]
    ds_read_b64_tr_b16 v[2:3], v128 offset:20480
    v_mfma_f32_16x16x32_bf16 v[76:79], v[48:51], v[44:47], v[76:79]
    ds_read_b64_tr_b16 v[4:5], v129 offset:16384
    v_mfma_f32_16x16x32_bf16 v[80:83], v[52:55], v[32:35], v[80:83]
    ds_read_b64_tr_b16 v[6:7], v129 offset:20480
    v_mfma_f32_16x16x32_bf16 v[84:87], v[52:55], v[36:39], v[84:87]
    ds_read_b64_tr_b16 v[8:9], v130 offset:16384
    v_mfma_f32_16x16x32_bf16 v[88:91], v[52:55], v[40:43], v[88:91]
    ds_read_b64_tr_b16 v[10:11], v130 offset:20480
    v_mfma_f32_16x16x32_bf16 v[92:95], v[52:55], v[44:47], v[92:95]
    ds_read_b64_tr_b16 v[12:13], v131 offset:16384
    v_mfma_f32_16x16x32_bf16 v[96:99], v[56:59], v[32:35], v[96:99]
    ds_read_b64_tr_b16 v[14:15], v131 offset:20480
    v_mfma_f32_16x16x32_bf16 v[100:103], v[56:59], v[36:39], v[100:103]
    ds_read_b128 v[20:23], v136 offset:18432
    v_mfma_f32_16x16x32_bf16 v[104:107], v[56:59], v[40:43], v[104:107]
    ds_read_b128 v[24:27], v136 offset:20480
    v_mfma_f32_16x16x32_bf16 v[108:111], v[56:59], v[44:47], v[108:111]
    ds_read_b128 v[28:31], v136 offset:22528
    v_mfma_f32_16x16x32_bf16 v[112:115], v[60:63], v[32:35], v[112:115]
    v_mfma_f32_16x16x32_bf16 v[116:119], v[60:63], v[36:39], v[116:119]
    v_mfma_f32_16x16x32_bf16 v[120:123], v[60:63], v[40:43], v[120:123]
    v_mfma_f32_16x16x32_bf16 v[124:127], v[60:63], v[44:47], v[124:127]
    s_waitcnt lgkmcnt(0)
    ds_read_b128 v[48:51], v136 offset:17408
    v_mfma_f32_16x16x32_bf16 v[64:67], v[16:19], v[0:3], v[64:67]
    ds_read_b64_tr_b16 v[32:33], v128 offset:24576
    v_mfma_f32_16x16x32_bf16 v[68:71], v[16:19], v[4:7], v[68:71]
    ds_read_b64_tr_b16 v[34:35], v128 offset:28672
    v_mfma_f32_16x16x32_bf16 v[72:75], v[16:19], v[8:11], v[72:75]
    ds_read_b64_tr_b16 v[36:37], v129 offset:24576
    v_mfma_f32_16x16x32_bf16 v[76:79], v[16:19], v[12:15], v[76:79]
    ds_read_b64_tr_b16 v[38:39], v129 offset:28672
    v_mfma_f32_16x16x32_bf16 v[80:83], v[20:23], v[0:3], v[80:83]
    ds_read_b64_tr_b16 v[40:41], v130 offset:24576
    v_mfma_f32_16x16x32_bf16 v[84:87], v[20:23], v[4:7], v[84:87]
    ds_read_b64_tr_b16 v[42:43], v130 offset:28672
    v_mfma_f32_16x16x32_bf16 v[88:91], v[20:23], v[8:11], v[88:91]
    ds_read_b64_tr_b16 v[44:45], v131 offset:24576
    v_mfma_f32_16x16x32_bf16 v[92:95], v[20:23], v[12:15], v[92:95]
    ds_read_b64_tr_b16 v[46:47], v131 offset:28672
    v_mfma_f32_16x16x32_bf16 v[96:99], v[24:27], v[0:3], v[96:99]
    ds_read_b128 v[52:55], v136 offset:19456
    v_mfma_f32_16x16x32_bf16 v[100:103], v[24:27], v[4:7], v[100:103]
    ds_read_b128 v[56:59], v136 offset:21504
    v_mfma_f32_16x16x32_bf16 v[104:107], v[24:27], v[8:11], v[104:107]
    ds_read_b128 v[60:63], v136 offset:23552
    v_mfma_f32_16x16x32_bf16 v[108:111], v[24:27], v[12:15], v[108:111]
    v_mfma_f32_16x16x32_bf16 v[112:115], v[28:31], v[0:3], v[112:115]
    v_mfma_f32_16x16x32_bf16 v[116:119], v[28:31], v[4:7], v[116:119]
    v_mfma_f32_16x16x32_bf16 v[120:123], v[28:31], v[8:11], v[120:123]
    v_mfma_f32_16x16x32_bf16 v[124:127], v[28:31], v[12:15], v[124:127]
    s_waitcnt lgkmcnt(0)
    v_mfma_f32_16x16x32_bf16 v[64:67], v[48:51], v[32:35], v[64:67]
    s_waitcnt vmcnt(8)
    s_barrier
    ds_read_b128 v[16:19], v136 offset:32768
    v_mfma_f32_16x16x32_bf16 v[68:71], v[48:51], v[36:39], v[68:71]
    ds_read_b64_tr_b16 v[0:1], v128 offset:32768
    v_mfma_f32_16x16x32_bf16 v[72:75], v[48:51], v[40:43], v[72:75]
    ds_read_b64_tr_b16 v[2:3], v128 offset:36864
    v_mfma_f32_16x16x32_bf16 v[76:79], v[48:51], v[44:47], v[76:79]
    ds_read_b64_tr_b16 v[4:5], v129 offset:32768
    v_mfma_f32_16x16x32_bf16 v[80:83], v[52:55], v[32:35], v[80:83]
    ds_read_b64_tr_b16 v[6:7], v129 offset:36864
    v_mfma_f32_16x16x32_bf16 v[84:87], v[52:55], v[36:39], v[84:87]
    ds_read_b64_tr_b16 v[8:9], v130 offset:32768
    v_mfma_f32_16x16x32_bf16 v[88:91], v[52:55], v[40:43], v[88:91]
    ds_read_b64_tr_b16 v[10:11], v130 offset:36864
    v_mfma_f32_16x16x32_bf16 v[92:95], v[52:55], v[44:47], v[92:95]
    ds_read_b64_tr_b16 v[12:13], v131 offset:32768
    v_mfma_f32_16x16x32_bf16 v[96:99], v[56:59], v[32:35], v[96:99]
    ds_read_b64_tr_b16 v[14:15], v131 offset:36864
    v_mfma_f32_16x16x32_bf16 v[100:103], v[56:59], v[36:39], v[100:103]
    ds_read_b128 v[20:23], v136 offset:34816
    v_mfma_f32_16x16x32_bf16 v[104:107], v[56:59], v[40:43], v[104:107]
    ds_read_b128 v[24:27], v136 offset:36864
    v_mfma_f32_16x16x32_bf16 v[108:111], v[56:59], v[44:47], v[108:111]
    ds_read_b128 v[28:31], v136 offset:38912
    v_mfma_f32_16x16x32_bf16 v[112:115], v[60:63], v[32:35], v[112:115]
    v_mfma_f32_16x16x32_bf16 v[116:119], v[60:63], v[36:39], v[116:119]
    v_mfma_f32_16x16x32_bf16 v[120:123], v[60:63], v[40:43], v[120:123]
    v_mfma_f32_16x16x32_bf16 v[124:127], v[60:63], v[44:47], v[124:127]
    s_waitcnt lgkmcnt(0)
    ds_read_b128 v[48:51], v136 offset:33792
    v_mfma_f32_16x16x32_bf16 v[64:67], v[16:19], v[0:3], v[64:67]
    ds_read_b64_tr_b16 v[32:33], v128 offset:40960
    v_mfma_f32_16x16x32_bf16 v[68:71], v[16:19], v[4:7], v[68:71]
    ds_read_b64_tr_b16 v[34:35], v128 offset:45056
    v_mfma_f32_16x16x32_bf16 v[72:75], v[16:19], v[8:11], v[72:75]
    ds_read_b64_tr_b16 v[36:37], v129 offset:40960
    v_mfma_f32_16x16x32_bf16 v[76:79], v[16:19], v[12:15], v[76:79]
    ds_read_b64_tr_b16 v[38:39], v129 offset:45056
    v_mfma_f32_16x16x32_bf16 v[80:83], v[20:23], v[0:3], v[80:83]
    ds_read_b64_tr_b16 v[40:41], v130 offset:40960
    v_mfma_f32_16x16x32_bf16 v[84:87], v[20:23], v[4:7], v[84:87]
    ds_read_b64_tr_b16 v[42:43], v130 offset:45056
    v_mfma_f32_16x16x32_bf16 v[88:91], v[20:23], v[8:11], v[88:91]
    ds_read_b64_tr_b16 v[44:45], v131 offset:40960
    v_mfma_f32_16x16x32_bf16 v[92:95], v[20:23], v[12:15], v[92:95]
    ds_read_b64_tr_b16 v[46:47], v131 offset:45056
    v_mfma_f32_16x16x32_bf16 v[96:99], v[24:27], v[0:3], v[96:99]
    ds_read_b128 v[52:55], v136 offset:35840
    v_mfma_f32_16x16x32_bf16 v[100:103], v[24:27], v[4:7], v[100:103]
    ds_read_b128 v[56:59], v136 offset:37888
    v_mfma_f32_16x16x32_bf16 v[104:107], v[24:27], v[8:11], v[104:107]
    ds_read_b128 v[60:63], v136 offset:39936
    v_mfma_f32_16x16x32_bf16 v[108:111], v[24:27], v[12:15], v[108:111]
    v_mfma_f32_16x16x32_bf16 v[112:115], v[28:31], v[0:3], v[112:115]
    v_mfma_f32_16x16x32_bf16 v[116:119], v[28:31], v[4:7], v[116:119]
    v_mfma_f32_16x16x32_bf16 v[120:123], v[28:31], v[8:11], v[120:123]
    v_mfma_f32_16x16x32_bf16 v[124:127], v[28:31], v[12:15], v[124:127]
    s_waitcnt lgkmcnt(0)
    v_mfma_f32_16x16x32_bf16 v[64:67], v[48:51], v[32:35], v[64:67]
    s_waitcnt vmcnt(0)
    s_barrier
    ds_read_b128 v[16:19], v136 offset:49152
    v_mfma_f32_16x16x32_bf16 v[68:71], v[48:51], v[36:39], v[68:71]
    ds_read_b64_tr_b16 v[0:1], v128 offset:49152
    v_mfma_f32_16x16x32_bf16 v[72:75], v[48:51], v[40:43], v[72:75]
    ds_read_b64_tr_b16 v[2:3], v128 offset:53248
    v_mfma_f32_16x16x32_bf16 v[76:79], v[48:51], v[44:47], v[76:79]
    ds_read_b64_tr_b16 v[4:5], v129 offset:49152
    v_mfma_f32_16x16x32_bf16 v[80:83], v[52:55], v[32:35], v[80:83]
    ds_read_b64_tr_b16 v[6:7], v129 offset:53248
    v_mfma_f32_16x16x32_bf16 v[84:87], v[52:55], v[36:39], v[84:87]
    ds_read_b64_tr_b16 v[8:9], v130 offset:49152
    v_mfma_f32_16x16x32_bf16 v[88:91], v[52:55], v[40:43], v[88:91]
    ds_read_b64_tr_b16 v[10:11], v130 offset:53248
    v_mfma_f32_16x16x32_bf16 v[92:95], v[52:55], v[44:47], v[92:95]
    ds_read_b64_tr_b16 v[12:13], v131 offset:49152
    v_mfma_f32_16x16x32_bf16 v[96:99], v[56:59], v[32:35], v[96:99]
    ds_read_b64_tr_b16 v[14:15], v131 offset:53248
    v_mfma_f32_16x16x32_bf16 v[100:103], v[56:59], v[36:39], v[100:103]
    ds_read_b128 v[20:23], v136 offset:51200
    v_mfma_f32_16x16x32_bf16 v[104:107], v[56:59], v[40:43], v[104:107]
    ds_read_b128 v[24:27], v136 offset:53248
    v_mfma_f32_16x16x32_bf16 v[108:111], v[56:59], v[44:47], v[108:111]
    ds_read_b128 v[28:31], v136 offset:55296
    v_mfma_f32_16x16x32_bf16 v[112:115], v[60:63], v[32:35], v[112:115]
    v_mfma_f32_16x16x32_bf16 v[116:119], v[60:63], v[36:39], v[116:119]
    v_mfma_f32_16x16x32_bf16 v[120:123], v[60:63], v[40:43], v[120:123]
    v_mfma_f32_16x16x32_bf16 v[124:127], v[60:63], v[44:47], v[124:127]
    v_readfirstlane_b32 s55, v255
    s_waitcnt lgkmcnt(0)
    ds_read_b128 v[48:51], v136 offset:50176
    v_mfma_f32_16x16x32_bf16 v[64:67], v[16:19], v[0:3], v[64:67]
    ds_read_b64_tr_b16 v[32:33], v128 offset:57344
    v_mfma_f32_16x16x32_bf16 v[68:71], v[16:19], v[4:7], v[68:71]
    ds_read_b64_tr_b16 v[34:35], v128 offset:61440
    v_mfma_f32_16x16x32_bf16 v[72:75], v[16:19], v[8:11], v[72:75]
    ds_read_b64_tr_b16 v[36:37], v129 offset:57344
    v_mfma_f32_16x16x32_bf16 v[76:79], v[16:19], v[12:15], v[76:79]
    ds_read_b64_tr_b16 v[38:39], v129 offset:61440
    v_mfma_f32_16x16x32_bf16 v[80:83], v[20:23], v[0:3], v[80:83]
    ds_read_b64_tr_b16 v[40:41], v130 offset:57344
    v_mfma_f32_16x16x32_bf16 v[84:87], v[20:23], v[4:7], v[84:87]
    ds_read_b64_tr_b16 v[42:43], v130 offset:61440
    v_mfma_f32_16x16x32_bf16 v[88:91], v[20:23], v[8:11], v[88:91]
    ds_read_b64_tr_b16 v[44:45], v131 offset:57344
    v_mfma_f32_16x16x32_bf16 v[92:95], v[20:23], v[12:15], v[92:95]
    ds_read_b64_tr_b16 v[46:47], v131 offset:61440
    v_mfma_f32_16x16x32_bf16 v[96:99], v[24:27], v[0:3], v[96:99]
    ds_read_b128 v[52:55], v136 offset:52224
    v_mfma_f32_16x16x32_bf16 v[100:103], v[24:27], v[4:7], v[100:103]
    ds_read_b128 v[56:59], v136 offset:54272
    v_mfma_f32_16x16x32_bf16 v[104:107], v[24:27], v[8:11], v[104:107]
    ds_read_b128 v[60:63], v136 offset:56320
    v_mfma_f32_16x16x32_bf16 v[108:111], v[24:27], v[12:15], v[108:111]
    v_mfma_f32_16x16x32_bf16 v[112:115], v[28:31], v[0:3], v[112:115]
    v_mfma_f32_16x16x32_bf16 v[116:119], v[28:31], v[4:7], v[116:119]
    v_mfma_f32_16x16x32_bf16 v[120:123], v[28:31], v[8:11], v[120:123]
    v_mfma_f32_16x16x32_bf16 v[124:127], v[28:31], v[12:15], v[124:127]
    s_waitcnt lgkmcnt(0)
    v_mfma_f32_16x16x32_bf16 v[64:67], v[48:51], v[32:35], v[64:67]
    v_mfma_f32_16x16x32_bf16 v[68:71], v[48:51], v[36:39], v[68:71]
    v_mfma_f32_16x16x32_bf16 v[72:75], v[48:51], v[40:43], v[72:75]
    v_mfma_f32_16x16x32_bf16 v[76:79], v[48:51], v[44:47], v[76:79]
    v_mfma_f32_16x16x32_bf16 v[80:83], v[52:55], v[32:35], v[80:83]
    v_mfma_f32_16x16x32_bf16 v[84:87], v[52:55], v[36:39], v[84:87]
    v_mfma_f32_16x16x32_bf16 v[88:91], v[52:55], v[40:43], v[88:91]
    v_mfma_f32_16x16x32_bf16 v[92:95], v[52:55], v[44:47], v[92:95]
    v_mfma_f32_16x16x32_bf16 v[96:99], v[56:59], v[32:35], v[96:99]
    v_mfma_f32_16x16x32_bf16 v[100:103], v[56:59], v[36:39], v[100:103]
    v_mfma_f32_16x16x32_bf16 v[104:107], v[56:59], v[40:43], v[104:107]
    v_mfma_f32_16x16x32_bf16 v[108:111], v[56:59], v[44:47], v[108:111]
    v_mfma_f32_16x16x32_bf16 v[112:115], v[60:63], v[32:35], v[112:115]
    v_mfma_f32_16x16x32_bf16 v[116:119], v[60:63], v[36:39], v[116:119]
    v_mfma_f32_16x16x32_bf16 v[120:123], v[60:63], v[40:43], v[120:123]
    v_mfma_f32_16x16x32_bf16 v[124:127], v[60:63], v[44:47], v[124:127]
    s_nop 7
    s_mov_b32 s53, s21
    v_cvt_pk_bf16_f32 v8, v64, v65
    v_cvt_pk_bf16_f32 v9, v66, v67
    v_cvt_pk_bf16_f32 v10, v80, v81
    v_cvt_pk_bf16_f32 v11, v82, v83
    buffer_store_dwordx4 v[8:11], v251, s[4:7], s53 offen offset:0 sc1
    v_cvt_pk_bf16_f32 v24, v68, v69
    v_cvt_pk_bf16_f32 v25, v70, v71
    v_cvt_pk_bf16_f32 v26, v84, v85
    v_cvt_pk_bf16_f32 v27, v86, v87
    buffer_store_dwordx4 v[24:27], v251, s[4:7], s53 offen offset:1024 sc1
    v_cvt_pk_bf16_f32 v40, v72, v73
    v_cvt_pk_bf16_f32 v41, v74, v75
    v_cvt_pk_bf16_f32 v42, v88, v89
    v_cvt_pk_bf16_f32 v43, v90, v91
    buffer_store_dwordx4 v[40:43], v251, s[4:7], s53 offen offset:2048 sc1
    v_cvt_pk_bf16_f32 v56, v76, v77
    v_cvt_pk_bf16_f32 v57, v78, v79
    v_cvt_pk_bf16_f32 v58, v92, v93
    v_cvt_pk_bf16_f32 v59, v94, v95
    buffer_store_dwordx4 v[56:59], v251, s[4:7], s53 offen offset:3072 sc1
    s_add_u32 s53, s53, 262144
    v_cvt_pk_bf16_f32 v8, v96, v97
    v_cvt_pk_bf16_f32 v9, v98, v99
    v_cvt_pk_bf16_f32 v10, v112, v113
    v_cvt_pk_bf16_f32 v11, v114, v115
    buffer_store_dwordx4 v[8:11], v251, s[4:7], s53 offen offset:0 sc1
    v_cvt_pk_bf16_f32 v24, v100, v101
    v_cvt_pk_bf16_f32 v25, v102, v103
    v_cvt_pk_bf16_f32 v26, v116, v117
    v_cvt_pk_bf16_f32 v27, v118, v119
    buffer_store_dwordx4 v[24:27], v251, s[4:7], s53 offen offset:1024 sc1
    v_cvt_pk_bf16_f32 v40, v104, v105
    v_cvt_pk_bf16_f32 v41, v106, v107
    v_cvt_pk_bf16_f32 v42, v120, v121
    v_cvt_pk_bf16_f32 v43, v122, v123
    buffer_store_dwordx4 v[40:43], v251, s[4:7], s53 offen offset:2048 sc1
    v_cvt_pk_bf16_f32 v56, v108, v109
    v_cvt_pk_bf16_f32 v57, v110, v111
    v_cvt_pk_bf16_f32 v58, v124, v125
    v_cvt_pk_bf16_f32 v59, v126, v127
    buffer_store_dwordx4 v[56:59], v251, s[4:7], s53 offen offset:3072 sc1
    s_add_u32 s53, s53, 262144
    s_branch main_kernel_w_done
main_kernel_w_c1_task:
    s_cmp_eq_u32 s23, 0
    s_cbranch_scc1 main_kernel_w_c1_set0
    s_cmp_eq_u32 s23, 1
    s_cbranch_scc1 main_kernel_w_c1_set1
    s_cmp_eq_u32 s23, 2
    s_cbranch_scc1 main_kernel_w_c1_set2
    s_cmp_eq_u32 s23, 3
    s_cbranch_scc1 main_kernel_w_c1_set3
    s_cmp_eq_u32 s23, 6
    s_cbranch_scc1 main_kernel_w_c1_set6
    s_branch main_kernel_w_done
main_kernel_w_c1_set0:
    s_lshl_b32 s32, s25, 8
    s_add_u32 s8, s40, s32
    s_addc_u32 s9, s41, 0
    s_and_b32 s9, s9, 0xffff
    s_sub_u32 s10, 0x800000, s32
    s_mov_b32 s11, 0x20000
    s_mov_b32 s30, 8192
    s_mov_b32 s31, 32768
    s_mul_i32 s16, s24, 262144
    s_add_u32 s16, s16, 0x0
    s_mov_b32 s18, 7
    s_lshl_b32 s32, s24, 3
    s_mul_i32 s33, s38, 4
    s_add_u32 s32, s32, s33
    s_mul_i32 s32, s32, 131072
    s_lshl_b32 s33, s25, 12
    s_add_u32 s32, s32, s33
    s_mul_i32 s33, s37, 4096
    s_add_u32 s32, s32, s33
    s_add_u32 s21, s32, 0x800000
    s_mov_b32 s22, 131072
    s_mov_b32 s26, -1
    s_branch main_kernel_w_c1_go
main_kernel_w_c1_set1:
    s_lshl_b32 s32, s25, 8
    s_add_u32 s8, s42, s32
    s_addc_u32 s9, s43, 0
    s_and_b32 s9, s9, 0xffff
    s_sub_u32 s10, 0x800000, s32
    s_mov_b32 s11, 0x20000
    s_mov_b32 s30, 8192
    s_mov_b32 s31, 32768
    s_mul_i32 s16, s24, 262144
    s_add_u32 s16, s16, 0x0
    s_mov_b32 s18, 7
    s_lshl_b32 s32, s24, 3
    s_mul_i32 s33, s38, 4
    s_add_u32 s32, s32, s33
    s_mul_i32 s32, s32, 131072
    s_lshl_b32 s33, s25, 12
    s_add_u32 s32, s32, s33
    s_mul_i32 s33, s37, 4096
    s_add_u32 s32, s32, s33
    s_add_u32 s21, s32, 0x1800000
    s_mov_b32 s22, 131072
    s_mov_b32 s26, -1
    s_branch main_kernel_w_c1_go
main_kernel_w_c1_set2:
    s_lshl_b32 s32, s25, 8
    s_add_u32 s8, s44, s32
    s_addc_u32 s9, s45, 0
    s_and_b32 s9, s9, 0xffff
    s_sub_u32 s10, 0x800000, s32
    s_mov_b32 s11, 0x20000
    s_mov_b32 s30, 8192
    s_mov_b32 s31, 32768
    s_mul_i32 s16, s24, 262144
    s_add_u32 s16, s16, 0x0
    s_mov_b32 s18, 7
    s_lshl_b32 s32, s24, 2
    s_mul_i32 s33, s38, 2
    s_add_u32 s32, s32, s33
    s_lshl_b32 s32, s32, 18
    s_lshl_b32 s33, s25, 13
    s_add_u32 s32, s32, s33
    s_mul_i32 s33, s37, 8192
    s_add_u32 s32, s32, s33
    s_add_u32 s21, s32, 0x2800000
    s_branch main_kernel_w_c1_gov
main_kernel_w_c1_set3:
    s_lshl_b32 s32, s25, 8
    s_add_u32 s8, s64, s32
    s_addc_u32 s9, s65, 0
    s_and_b32 s9, s9, 0xffff
    s_sub_u32 s10, 0x200000, s32
    s_mov_b32 s11, 0x20000
    s_mov_b32 s30, 2048
    s_mov_b32 s31, 32768
    s_mul_i32 s16, s24, 262144
    s_add_u32 s16, s16, 0x400000
    s_mov_b32 s18, 7
    s_lshl_b32 s32, s24, 3
    s_mul_i32 s33, s38, 4
    s_add_u32 s32, s32, s33
    s_mul_i32 s32, s32, 32768
    s_lshl_b32 s33, s25, 12
    s_add_u32 s32, s32, s33
    s_mul_i32 s33, s37, 4096
    s_add_u32 s32, s32, s33
    s_add_u32 s21, s32, 0x4800000
    s_mov_b32 s22, 32768
    s_mov_b32 s26, -1
    s_lshr_b32 s32, s25, 2
    s_add_u32 s32, s32, 1
    s_sub_u32 s33, 0, s32
    s_bitcmp1_b32 s25, 1
    s_cselect_b32 s32, s33, s32
    s_add_u32 s32, s32, 16
    v_and_b32 v253, 15, v250
    v_add_u32 v253, s32, v253
    v_lshrrev_b32 v254, 4, v253
    v_lshlrev_b32 v254, 15, v254
    v_and_b32 v253, 15, v253
    v_lshl_add_u32 v254, v253, 4, v254
    v_and_b32 v253, 0x300, v251
    v_add_u32 v252, v253, v254
    s_branch main_kernel_w_c1_go
main_kernel_w_c1_set6:
    s_lshl_b32 s32, s25, 8
    s_add_u32 s8, s68, s32
    s_addc_u32 s9, s69, 0
    s_and_b32 s9, s9, 0xffff
    s_sub_u32 s10, 0x700000, s32
    s_mov_b32 s11, 0x20000
    s_mov_b32 s30, 7168
    s_mov_b32 s31, 32768
    s_mul_i32 s16, s24, 262144
    s_add_u32 s16, s16, 0x6800000
    s_mov_b32 s18, 7
    s_lshl_b32 s32, s24, 3
    s_mul_i32 s33, s38, 4
    s_add_u32 s32, s32, s33
    s_mul_i32 s32, s32, 114688
    s_lshl_b32 s33, s25, 12
    s_add_u32 s32, s32, s33
    s_mul_i32 s33, s37, 4096
    s_add_u32 s32, s32, s33
    s_add_u32 s21, s32, 0x5400000
    s_mov_b32 s22, 114688
    s_mov_b32 s26, -1
    s_branch main_kernel_w_c1_go
main_kernel_w_c1_go:
    v_lshrrev_b32 v0, 4, v250
    v_bfe_u32 v1, v250, 2, 2
    v_lshl_add_u32 v4, v0, 2, v1
    v_and_b32 v5, 7, v4
    v_mul_u32_u24 v4, 512, v4
    v_and_b32 v6, 3, v250
    v_lshl_add_u32 v4, v6, 3, v4
    s_mul_i32 s32, s37, 8
    v_xor_b32 v5, s32, v5
    v_lshl_add_u32 v128, v5, 5, v4
    v_xor_b32 v129, 32, v128
    v_xor_b32 v130, 64, v128
    v_xor_b32 v131, 96, v128
    v_xor_b32 v132, 128, v128
    v_xor_b32 v133, 160, v128
    v_xor_b32 v134, 192, v128
    v_xor_b32 v135, 224, v128
    s_mul_i32 s32, s38, 4096
    s_add_u32 s32, s32, 65536
    v_add_u32 v136, s32, v251
    v_lshrrev_b32 v2, 5, v250
    v_and_b32 v3, 31, v250
    s_mul_i32 s32, s14, 8
    v_add_u32 v4, s32, v2
    v_add_u32 v5, 0, v4
    v_and_b32 v6, 7, v5
    v_lshlrev_b32 v6, 1, v6
    v_xor_b32 v6, v6, v3
    v_mul_lo_u32 v5, v5, s30
    v_lshl_add_u32 v5, v6, 4, v5
    v_subrev_u32 v137, 0, v5
    v_add_u32 v5, 2, v4
    v_and_b32 v6, 7, v5
    v_lshlrev_b32 v6, 1, v6
    v_xor_b32 v6, v6, v3
    v_mul_lo_u32 v5, v5, s30
    v_lshl_add_u32 v5, v6, 4, v5
    v_subrev_u32 v138, 1024, v5
    v_add_u32 v5, 4, v4
    v_and_b32 v6, 7, v5
    v_lshlrev_b32 v6, 1, v6
    v_xor_b32 v6, v6, v3
    v_mul_lo_u32 v5, v5, s30
    v_lshl_add_u32 v5, v6, 4, v5
    v_subrev_u32 v139, 2048, v5
    v_add_u32 v5, 6, v4
    v_and_b32 v6, 7, v5
    v_lshlrev_b32 v6, 1, v6
    v_xor_b32 v6, v6, v3
    v_mul_lo_u32 v5, v5, s30
    v_lshl_add_u32 v5, v6, 4, v5
    v_subrev_u32 v140, 3072, v5
    s_mul_i32 s32, s14, 2
    s_mul_i32 s32, s32, s31
    v_add_u32 v141, s32, v251
    s_add_u32 s32, s32, s31
    s_sub_u32 s32, s32, 1024
    v_add_u32 v142, s32, v251
    s_mul_i32 s19, s14, 4096
    s_mul_i32 s20, s14, 2048
    s_add_u32 s20, s20, 65536
    s_mul_i32 s17, s30, 32
    s_mov_b32 s15, 0
    s_add_u32 m0, s20, 0
    s_nop 0
    buffer_load_dwordx4 v141, s[4:7], s16 offen offset:0 sc1 lds
    buffer_load_dwordx4 v142, s[4:7], s16 offen offset:1024 sc1 lds
    s_add_u32 s16, s16, 1024
    s_add_u32 m0, s19, 0
    s_nop 0
    buffer_load_dwordx4 v137, s[8:11], s15 offen offset:0 lds
    buffer_load_dwordx4 v138, s[8:11], s15 offen offset:1024 lds
    buffer_load_dwordx4 v139, s[8:11], s15 offen offset:2048 lds
    buffer_load_dwordx4 v140, s[8:11], s15 offen offset:3072 lds
    s_add_u32 s15, s15, s17
    s_add_u32 m0, s20, 8192
    s_nop 0
    buffer_load_dwordx4 v141, s[4:7], s16 offen offset:0 sc1 lds
    buffer_load_dwordx4 v142, s[4:7], s16 offen offset:1024 sc1 lds
    s_add_u32 s16, s16, 1024
    s_add_u32 m0, s19, 16384
    s_nop 0
    buffer_load_dwordx4 v137, s[8:11], s15 offen offset:0 lds
    buffer_load_dwordx4 v138, s[8:11], s15 offen offset:1024 lds
    buffer_load_dwordx4 v139, s[8:11], s15 offen offset:2048 lds
    buffer_load_dwordx4 v140, s[8:11], s15 offen offset:3072 lds
    s_add_u32 s15, s15, s17
    s_add_u32 m0, s20, 16384
    s_nop 0
    buffer_load_dwordx4 v141, s[4:7], s16 offen offset:0 sc1 lds
    buffer_load_dwordx4 v142, s[4:7], s16 offen offset:1024 sc1 lds
    s_add_u32 s16, s16, 1024
    s_add_u32 m0, s19, 32768
    s_nop 0
    buffer_load_dwordx4 v137, s[8:11], s15 offen offset:0 lds
    buffer_load_dwordx4 v138, s[8:11], s15 offen offset:1024 lds
    buffer_load_dwordx4 v139, s[8:11], s15 offen offset:2048 lds
    buffer_load_dwordx4 v140, s[8:11], s15 offen offset:3072 lds
    s_add_u32 s15, s15, s17
    s_add_u32 m0, s20, 24576
    s_nop 0
    buffer_load_dwordx4 v141, s[4:7], s16 offen offset:0 sc1 lds
    buffer_load_dwordx4 v142, s[4:7], s16 offen offset:1024 sc1 lds
    s_add_u32 s16, s16, 1024
    s_add_u32 m0, s19, 49152
    s_nop 0
    buffer_load_dwordx4 v137, s[8:11], s15 offen offset:0 lds
    buffer_load_dwordx4 v138, s[8:11], s15 offen offset:1024 lds
    buffer_load_dwordx4 v139, s[8:11], s15 offen offset:2048 lds
    buffer_load_dwordx4 v140, s[8:11], s15 offen offset:3072 lds
    s_add_u32 s15, s15, s17
    v_accvgpr_write_b32 a0, 0
    v_accvgpr_write_b32 a1, 0
    v_accvgpr_write_b32 a2, 0
    v_accvgpr_write_b32 a3, 0
    v_accvgpr_write_b32 a4, 0
    v_accvgpr_write_b32 a5, 0
    v_accvgpr_write_b32 a6, 0
    v_accvgpr_write_b32 a7, 0
    v_accvgpr_write_b32 a8, 0
    v_accvgpr_write_b32 a9, 0
    v_accvgpr_write_b32 a10, 0
    v_accvgpr_write_b32 a11, 0
    v_accvgpr_write_b32 a12, 0
    v_accvgpr_write_b32 a13, 0
    v_accvgpr_write_b32 a14, 0
    v_accvgpr_write_b32 a15, 0
    v_accvgpr_write_b32 a16, 0
    v_accvgpr_write_b32 a17, 0
    v_accvgpr_write_b32 a18, 0
    v_accvgpr_write_b32 a19, 0
    v_accvgpr_write_b32 a20, 0
    v_accvgpr_write_b32 a21, 0
    v_accvgpr_write_b32 a22, 0
    v_accvgpr_write_b32 a23, 0
    v_accvgpr_write_b32 a24, 0
    v_accvgpr_write_b32 a25, 0
    v_accvgpr_write_b32 a26, 0
    v_accvgpr_write_b32 a27, 0
    v_accvgpr_write_b32 a28, 0
    v_accvgpr_write_b32 a29, 0
    v_accvgpr_write_b32 a30, 0
    v_accvgpr_write_b32 a31, 0
    v_accvgpr_write_b32 a32, 0
    v_accvgpr_write_b32 a33, 0
    v_accvgpr_write_b32 a34, 0
    v_accvgpr_write_b32 a35, 0
    v_accvgpr_write_b32 a36, 0
    v_accvgpr_write_b32 a37, 0
    v_accvgpr_write_b32 a38, 0
    v_accvgpr_write_b32 a39, 0
    v_accvgpr_write_b32 a40, 0
    v_accvgpr_write_b32 a41, 0
    v_accvgpr_write_b32 a42, 0
    v_accvgpr_write_b32 a43, 0
    v_accvgpr_write_b32 a44, 0
    v_accvgpr_write_b32 a45, 0
    v_accvgpr_write_b32 a46, 0
    v_accvgpr_write_b32 a47, 0
    v_accvgpr_write_b32 a48, 0
    v_accvgpr_write_b32 a49, 0
    v_accvgpr_write_b32 a50, 0
    v_accvgpr_write_b32 a51, 0
    v_accvgpr_write_b32 a52, 0
    v_accvgpr_write_b32 a53, 0
    v_accvgpr_write_b32 a54, 0
    v_accvgpr_write_b32 a55, 0
    v_accvgpr_write_b32 a56, 0
    v_accvgpr_write_b32 a57, 0
    v_accvgpr_write_b32 a58, 0
    v_accvgpr_write_b32 a59, 0
    v_accvgpr_write_b32 a60, 0
    v_accvgpr_write_b32 a61, 0
    v_accvgpr_write_b32 a62, 0
    v_accvgpr_write_b32 a63, 0
    v_accvgpr_write_b32 a64, 0
    v_accvgpr_write_b32 a65, 0
    v_accvgpr_write_b32 a66, 0
    v_accvgpr_write_b32 a67, 0
    v_accvgpr_write_b32 a68, 0
    v_accvgpr_write_b32 a69, 0
    v_accvgpr_write_b32 a70, 0
    v_accvgpr_write_b32 a71, 0
    v_accvgpr_write_b32 a72, 0
    v_accvgpr_write_b32 a73, 0
    v_accvgpr_write_b32 a74, 0
    v_accvgpr_write_b32 a75, 0
    v_accvgpr_write_b32 a76, 0
    v_accvgpr_write_b32 a77, 0
    v_accvgpr_write_b32 a78, 0
    v_accvgpr_write_b32 a79, 0
    v_accvgpr_write_b32 a80, 0
    v_accvgpr_write_b32 a81, 0
    v_accvgpr_write_b32 a82, 0
    v_accvgpr_write_b32 a83, 0
    v_accvgpr_write_b32 a84, 0
    v_accvgpr_write_b32 a85, 0
    v_accvgpr_write_b32 a86, 0
    v_accvgpr_write_b32 a87, 0
    v_accvgpr_write_b32 a88, 0
    v_accvgpr_write_b32 a89, 0
    v_accvgpr_write_b32 a90, 0
    v_accvgpr_write_b32 a91, 0
    v_accvgpr_write_b32 a92, 0
    v_accvgpr_write_b32 a93, 0
    v_accvgpr_write_b32 a94, 0
    v_accvgpr_write_b32 a95, 0
    v_accvgpr_write_b32 a96, 0
    v_accvgpr_write_b32 a97, 0
    v_accvgpr_write_b32 a98, 0
    v_accvgpr_write_b32 a99, 0
    v_accvgpr_write_b32 a100, 0
    v_accvgpr_write_b32 a101, 0
    v_accvgpr_write_b32 a102, 0
    v_accvgpr_write_b32 a103, 0
    v_accvgpr_write_b32 a104, 0
    v_accvgpr_write_b32 a105, 0
    v_accvgpr_write_b32 a106, 0
    v_accvgpr_write_b32 a107, 0
    v_accvgpr_write_b32 a108, 0
    v_accvgpr_write_b32 a109, 0
    v_accvgpr_write_b32 a110, 0
    v_accvgpr_write_b32 a111, 0
    v_accvgpr_write_b32 a112, 0
    v_accvgpr_write_b32 a113, 0
    v_accvgpr_write_b32 a114, 0
    v_accvgpr_write_b32 a115, 0
    v_accvgpr_write_b32 a116, 0
    v_accvgpr_write_b32 a117, 0
    v_accvgpr_write_b32 a118, 0
    v_accvgpr_write_b32 a119, 0
    v_accvgpr_write_b32 a120, 0
    v_accvgpr_write_b32 a121, 0
    v_accvgpr_write_b32 a122, 0
    v_accvgpr_write_b32 a123, 0
    v_accvgpr_write_b32 a124, 0
    v_accvgpr_write_b32 a125, 0
    v_accvgpr_write_b32 a126, 0
    v_accvgpr_write_b32 a127, 0
    s_waitcnt vmcnt(18)
    s_barrier
    ds_read_b128 v[32:35], v136 offset:0
    ds_read_b64_tr_b16 v[0:1], v128 offset:0
    ds_read_b64_tr_b16 v[2:3], v128 offset:8192
    ds_read_b64_tr_b16 v[4:5], v129 offset:0
    ds_read_b64_tr_b16 v[6:7], v129 offset:8192
    ds_read_b64_tr_b16 v[8:9], v130 offset:0
    ds_read_b64_tr_b16 v[10:11], v130 offset:8192
    ds_read_b64_tr_b16 v[12:13], v131 offset:0
    ds_read_b64_tr_b16 v[14:15], v131 offset:8192
    ds_read_b64_tr_b16 v[16:17], v132 offset:0
    ds_read_b64_tr_b16 v[18:19], v132 offset:8192
    ds_read_b64_tr_b16 v[20:21], v133 offset:0
    ds_read_b64_tr_b16 v[22:23], v133 offset:8192
    ds_read_b64_tr_b16 v[24:25], v134 offset:0
    ds_read_b64_tr_b16 v[26:27], v134 offset:8192
    ds_read_b64_tr_b16 v[28:29], v135 offset:0
    ds_read_b64_tr_b16 v[30:31], v135 offset:8192
    ds_read_b128 v[36:39], v136 offset:1024
    ds_read_b128 v[40:43], v136 offset:2048
    ds_read_b128 v[44:47], v136 offset:3072
main_kernel_w_c1_n_loop:
    s_waitcnt lgkmcnt(0)
    v_mfma_f32_16x16x32_bf16 a[0:3], v[0:3], v[32:35], a[0:3]
    s_waitcnt vmcnt(12)
    s_barrier
    ds_read_b128 v[80:83], v136 offset:8192
    s_add_u32 m0, s20, 0
    s_nop 0
    v_mfma_f32_16x16x32_bf16 a[4:7], v[4:7], v[32:35], a[4:7]
    ds_read_b64_tr_b16 v[48:49], v128 offset:16384
    v_mfma_f32_16x16x32_bf16 a[8:11], v[8:11], v[32:35], a[8:11]
    ds_read_b64_tr_b16 v[50:51], v128 offset:24576
    v_mfma_f32_16x16x32_bf16 a[12:15], v[12:15], v[32:35], a[12:15]
    ds_read_b64_tr_b16 v[52:53], v129 offset:16384
    buffer_load_dwordx4 v141, s[4:7], s16 offen offset:0 sc1 lds
    v_mfma_f32_16x16x32_bf16 a[16:19], v[16:19], v[32:35], a[16:19]
    ds_read_b64_tr_b16 v[54:55], v129 offset:24576
    v_mfma_f32_16x16x32_bf16 a[20:23], v[20:23], v[32:35], a[20:23]
    ds_read_b64_tr_b16 v[56:57], v130 offset:16384
    v_mfma_f32_16x16x32_bf16 a[24:27], v[24:27], v[32:35], a[24:27]
    ds_read_b64_tr_b16 v[58:59], v130 offset:24576
    buffer_load_dwordx4 v142, s[4:7], s16 offen offset:1024 sc1 lds
    v_mfma_f32_16x16x32_bf16 a[28:31], v[28:31], v[32:35], a[28:31]
    ds_read_b64_tr_b16 v[60:61], v131 offset:16384
    v_mfma_f32_16x16x32_bf16 a[32:35], v[0:3], v[36:39], a[32:35]
    ds_read_b64_tr_b16 v[62:63], v131 offset:24576
    v_mfma_f32_16x16x32_bf16 a[36:39], v[4:7], v[36:39], a[36:39]
    ds_read_b64_tr_b16 v[64:65], v132 offset:16384
    s_add_u32 s16, s16, 1024
    v_mfma_f32_16x16x32_bf16 a[40:43], v[8:11], v[36:39], a[40:43]
    ds_read_b64_tr_b16 v[66:67], v132 offset:24576
    v_mfma_f32_16x16x32_bf16 a[44:47], v[12:15], v[36:39], a[44:47]
    ds_read_b64_tr_b16 v[68:69], v133 offset:16384
    v_mfma_f32_16x16x32_bf16 a[48:51], v[16:19], v[36:39], a[48:51]
    ds_read_b64_tr_b16 v[70:71], v133 offset:24576
    s_add_u32 m0, s19, 0
    s_nop 0
    v_mfma_f32_16x16x32_bf16 a[52:55], v[20:23], v[36:39], a[52:55]
    ds_read_b64_tr_b16 v[72:73], v134 offset:16384
    v_mfma_f32_16x16x32_bf16 a[56:59], v[24:27], v[36:39], a[56:59]
    ds_read_b64_tr_b16 v[74:75], v134 offset:24576
    v_mfma_f32_16x16x32_bf16 a[60:63], v[28:31], v[36:39], a[60:63]
    ds_read_b64_tr_b16 v[76:77], v135 offset:16384
    buffer_load_dwordx4 v137, s[8:11], s15 offen offset:0 lds
    v_mfma_f32_16x16x32_bf16 a[64:67], v[0:3], v[40:43], a[64:67]
    ds_read_b64_tr_b16 v[78:79], v135 offset:24576
    v_mfma_f32_16x16x32_bf16 a[68:71], v[4:7], v[40:43], a[68:71]
    ds_read_b128 v[84:87], v136 offset:9216
    v_mfma_f32_16x16x32_bf16 a[72:75], v[8:11], v[40:43], a[72:75]
    ds_read_b128 v[88:91], v136 offset:10240
    buffer_load_dwordx4 v138, s[8:11], s15 offen offset:1024 lds
    v_mfma_f32_16x16x32_bf16 a[76:79], v[12:15], v[40:43], a[76:79]
    ds_read_b128 v[92:95], v136 offset:11264
    v_mfma_f32_16x16x32_bf16 a[80:83], v[16:19], v[40:43], a[80:83]
    v_mfma_f32_16x16x32_bf16 a[84:87], v[20:23], v[40:43], a[84:87]
    buffer_load_dwordx4 v139, s[8:11], s15 offen offset:2048 lds
    v_mfma_f32_16x16x32_bf16 a[88:91], v[24:27], v[40:43], a[88:91]
    v_mfma_f32_16x16x32_bf16 a[92:95], v[28:31], v[40:43], a[92:95]
    v_mfma_f32_16x16x32_bf16 a[96:99], v[0:3], v[44:47], a[96:99]
    buffer_load_dwordx4 v140, s[8:11], s15 offen offset:3072 lds
    v_mfma_f32_16x16x32_bf16 a[100:103], v[4:7], v[44:47], a[100:103]
    v_mfma_f32_16x16x32_bf16 a[104:107], v[8:11], v[44:47], a[104:107]
    v_mfma_f32_16x16x32_bf16 a[108:111], v[12:15], v[44:47], a[108:111]
    s_add_u32 s15, s15, s17
    v_mfma_f32_16x16x32_bf16 a[112:115], v[16:19], v[44:47], a[112:115]
    v_mfma_f32_16x16x32_bf16 a[116:119], v[20:23], v[44:47], a[116:119]
    v_mfma_f32_16x16x32_bf16 a[120:123], v[24:27], v[44:47], a[120:123]
    v_mfma_f32_16x16x32_bf16 a[124:127], v[28:31], v[44:47], a[124:127]
    s_waitcnt lgkmcnt(0)
    v_mfma_f32_16x16x32_bf16 a[0:3], v[48:51], v[80:83], a[0:3]
    s_waitcnt vmcnt(12)
    s_barrier
    ds_read_b128 v[32:35], v136 offset:16384
    s_add_u32 m0, s20, 8192
    s_nop 0
    v_mfma_f32_16x16x32_bf16 a[4:7], v[52:55], v[80:83], a[4:7]
    ds_read_b64_tr_b16 v[0:1], v128 offset:32768
    v_mfma_f32_16x16x32_bf16 a[8:11], v[56:59], v[80:83], a[8:11]
    ds_read_b64_tr_b16 v[2:3], v128 offset:40960
    v_mfma_f32_16x16x32_bf16 a[12:15], v[60:63], v[80:83], a[12:15]
    ds_read_b64_tr_b16 v[4:5], v129 offset:32768
    buffer_load_dwordx4 v141, s[4:7], s16 offen offset:0 sc1 lds
    v_mfma_f32_16x16x32_bf16 a[16:19], v[64:67], v[80:83], a[16:19]
    ds_read_b64_tr_b16 v[6:7], v129 offset:40960
    v_mfma_f32_16x16x32_bf16 a[20:23], v[68:71], v[80:83], a[20:23]
    ds_read_b64_tr_b16 v[8:9], v130 offset:32768
    v_mfma_f32_16x16x32_bf16 a[24:27], v[72:75], v[80:83], a[24:27]
    ds_read_b64_tr_b16 v[10:11], v130 offset:40960
    buffer_load_dwordx4 v142, s[4:7], s16 offen offset:1024 sc1 lds
    v_mfma_f32_16x16x32_bf16 a[28:31], v[76:79], v[80:83], a[28:31]
    ds_read_b64_tr_b16 v[12:13], v131 offset:32768
    v_mfma_f32_16x16x32_bf16 a[32:35], v[48:51], v[84:87], a[32:35]
    ds_read_b64_tr_b16 v[14:15], v131 offset:40960
    v_mfma_f32_16x16x32_bf16 a[36:39], v[52:55], v[84:87], a[36:39]
    ds_read_b64_tr_b16 v[16:17], v132 offset:32768
    s_add_u32 s16, s16, 1024
    v_mfma_f32_16x16x32_bf16 a[40:43], v[56:59], v[84:87], a[40:43]
    ds_read_b64_tr_b16 v[18:19], v132 offset:40960
    v_mfma_f32_16x16x32_bf16 a[44:47], v[60:63], v[84:87], a[44:47]
    ds_read_b64_tr_b16 v[20:21], v133 offset:32768
    v_mfma_f32_16x16x32_bf16 a[48:51], v[64:67], v[84:87], a[48:51]
    ds_read_b64_tr_b16 v[22:23], v133 offset:40960
    s_add_u32 m0, s19, 16384
    s_nop 0
    v_mfma_f32_16x16x32_bf16 a[52:55], v[68:71], v[84:87], a[52:55]
    ds_read_b64_tr_b16 v[24:25], v134 offset:32768
    v_mfma_f32_16x16x32_bf16 a[56:59], v[72:75], v[84:87], a[56:59]
    ds_read_b64_tr_b16 v[26:27], v134 offset:40960
    v_mfma_f32_16x16x32_bf16 a[60:63], v[76:79], v[84:87], a[60:63]
    ds_read_b64_tr_b16 v[28:29], v135 offset:32768
    buffer_load_dwordx4 v137, s[8:11], s15 offen offset:0 lds
    v_mfma_f32_16x16x32_bf16 a[64:67], v[48:51], v[88:91], a[64:67]
    ds_read_b64_tr_b16 v[30:31], v135 offset:40960
    v_mfma_f32_16x16x32_bf16 a[68:71], v[52:55], v[88:91], a[68:71]
    ds_read_b128 v[36:39], v136 offset:17408
    v_mfma_f32_16x16x32_bf16 a[72:75], v[56:59], v[88:91], a[72:75]
    ds_read_b128 v[40:43], v136 offset:18432
    buffer_load_dwordx4 v138, s[8:11], s15 offen offset:1024 lds
    v_mfma_f32_16x16x32_bf16 a[76:79], v[60:63], v[88:91], a[76:79]
    ds_read_b128 v[44:47], v136 offset:19456
    v_mfma_f32_16x16x32_bf16 a[80:83], v[64:67], v[88:91], a[80:83]
    v_mfma_f32_16x16x32_bf16 a[84:87], v[68:71], v[88:91], a[84:87]
    buffer_load_dwordx4 v139, s[8:11], s15 offen offset:2048 lds
    v_mfma_f32_16x16x32_bf16 a[88:91], v[72:75], v[88:91], a[88:91]
    v_mfma_f32_16x16x32_bf16 a[92:95], v[76:79], v[88:91], a[92:95]
    v_mfma_f32_16x16x32_bf16 a[96:99], v[48:51], v[92:95], a[96:99]
    buffer_load_dwordx4 v140, s[8:11], s15 offen offset:3072 lds
    v_mfma_f32_16x16x32_bf16 a[100:103], v[52:55], v[92:95], a[100:103]
    v_mfma_f32_16x16x32_bf16 a[104:107], v[56:59], v[92:95], a[104:107]
    v_mfma_f32_16x16x32_bf16 a[108:111], v[60:63], v[92:95], a[108:111]
    s_add_u32 s15, s15, s17
    v_mfma_f32_16x16x32_bf16 a[112:115], v[64:67], v[92:95], a[112:115]
    v_mfma_f32_16x16x32_bf16 a[116:119], v[68:71], v[92:95], a[116:119]
    v_mfma_f32_16x16x32_bf16 a[120:123], v[72:75], v[92:95], a[120:123]
    v_mfma_f32_16x16x32_bf16 a[124:127], v[76:79], v[92:95], a[124:127]
    s_waitcnt lgkmcnt(0)
    v_mfma_f32_16x16x32_bf16 a[0:3], v[0:3], v[32:35], a[0:3]
    s_waitcnt vmcnt(12)
    s_barrier
    ds_read_b128 v[80:83], v136 offset:24576
    s_add_u32 m0, s20, 16384
    s_nop 0
    v_mfma_f32_16x16x32_bf16 a[4:7], v[4:7], v[32:35], a[4:7]
    ds_read_b64_tr_b16 v[48:49], v128 offset:49152
    v_mfma_f32_16x16x32_bf16 a[8:11], v[8:11], v[32:35], a[8:11]
    ds_read_b64_tr_b16 v[50:51], v128 offset:57344
    v_mfma_f32_16x16x32_bf16 a[12:15], v[12:15], v[32:35], a[12:15]
    ds_read_b64_tr_b16 v[52:53], v129 offset:49152
    buffer_load_dwordx4 v141, s[4:7], s16 offen offset:0 sc1 lds
    v_mfma_f32_16x16x32_bf16 a[16:19], v[16:19], v[32:35], a[16:19]
    ds_read_b64_tr_b16 v[54:55], v129 offset:57344
    v_mfma_f32_16x16x32_bf16 a[20:23], v[20:23], v[32:35], a[20:23]
    ds_read_b64_tr_b16 v[56:57], v130 offset:49152
    v_mfma_f32_16x16x32_bf16 a[24:27], v[24:27], v[32:35], a[24:27]
    ds_read_b64_tr_b16 v[58:59], v130 offset:57344
    buffer_load_dwordx4 v142, s[4:7], s16 offen offset:1024 sc1 lds
    v_mfma_f32_16x16x32_bf16 a[28:31], v[28:31], v[32:35], a[28:31]
    ds_read_b64_tr_b16 v[60:61], v131 offset:49152
    v_mfma_f32_16x16x32_bf16 a[32:35], v[0:3], v[36:39], a[32:35]
    ds_read_b64_tr_b16 v[62:63], v131 offset:57344
    v_mfma_f32_16x16x32_bf16 a[36:39], v[4:7], v[36:39], a[36:39]
    ds_read_b64_tr_b16 v[64:65], v132 offset:49152
    s_add_u32 s16, s16, 1024
    v_mfma_f32_16x16x32_bf16 a[40:43], v[8:11], v[36:39], a[40:43]
    ds_read_b64_tr_b16 v[66:67], v132 offset:57344
    v_mfma_f32_16x16x32_bf16 a[44:47], v[12:15], v[36:39], a[44:47]
    ds_read_b64_tr_b16 v[68:69], v133 offset:49152
    v_mfma_f32_16x16x32_bf16 a[48:51], v[16:19], v[36:39], a[48:51]
    ds_read_b64_tr_b16 v[70:71], v133 offset:57344
    s_add_u32 m0, s19, 32768
    s_nop 0
    v_mfma_f32_16x16x32_bf16 a[52:55], v[20:23], v[36:39], a[52:55]
    ds_read_b64_tr_b16 v[72:73], v134 offset:49152
    v_mfma_f32_16x16x32_bf16 a[56:59], v[24:27], v[36:39], a[56:59]
    ds_read_b64_tr_b16 v[74:75], v134 offset:57344
    v_mfma_f32_16x16x32_bf16 a[60:63], v[28:31], v[36:39], a[60:63]
    ds_read_b64_tr_b16 v[76:77], v135 offset:49152
    buffer_load_dwordx4 v137, s[8:11], s15 offen offset:0 lds
    v_mfma_f32_16x16x32_bf16 a[64:67], v[0:3], v[40:43], a[64:67]
    ds_read_b64_tr_b16 v[78:79], v135 offset:57344
    v_mfma_f32_16x16x32_bf16 a[68:71], v[4:7], v[40:43], a[68:71]
    ds_read_b128 v[84:87], v136 offset:25600
    v_mfma_f32_16x16x32_bf16 a[72:75], v[8:11], v[40:43], a[72:75]
    ds_read_b128 v[88:91], v136 offset:26624
    buffer_load_dwordx4 v138, s[8:11], s15 offen offset:1024 lds
    v_mfma_f32_16x16x32_bf16 a[76:79], v[12:15], v[40:43], a[76:79]
    ds_read_b128 v[92:95], v136 offset:27648
    v_mfma_f32_16x16x32_bf16 a[80:83], v[16:19], v[40:43], a[80:83]
    v_mfma_f32_16x16x32_bf16 a[84:87], v[20:23], v[40:43], a[84:87]
    buffer_load_dwordx4 v139, s[8:11], s15 offen offset:2048 lds
    v_mfma_f32_16x16x32_bf16 a[88:91], v[24:27], v[40:43], a[88:91]
    v_mfma_f32_16x16x32_bf16 a[92:95], v[28:31], v[40:43], a[92:95]
    v_mfma_f32_16x16x32_bf16 a[96:99], v[0:3], v[44:47], a[96:99]
    buffer_load_dwordx4 v140, s[8:11], s15 offen offset:3072 lds
    v_mfma_f32_16x16x32_bf16 a[100:103], v[4:7], v[44:47], a[100:103]
    v_mfma_f32_16x16x32_bf16 a[104:107], v[8:11], v[44:47], a[104:107]
    v_mfma_f32_16x16x32_bf16 a[108:111], v[12:15], v[44:47], a[108:111]
    s_add_u32 s15, s15, s17
    v_mfma_f32_16x16x32_bf16 a[112:115], v[16:19], v[44:47], a[112:115]
    v_mfma_f32_16x16x32_bf16 a[116:119], v[20:23], v[44:47], a[116:119]
    v_mfma_f32_16x16x32_bf16 a[120:123], v[24:27], v[44:47], a[120:123]
    v_mfma_f32_16x16x32_bf16 a[124:127], v[28:31], v[44:47], a[124:127]
    s_waitcnt lgkmcnt(0)
    v_mfma_f32_16x16x32_bf16 a[0:3], v[48:51], v[80:83], a[0:3]
    s_waitcnt vmcnt(12)
    s_barrier
    ds_read_b128 v[32:35], v136 offset:0
    s_add_u32 m0, s20, 24576
    s_nop 0
    v_mfma_f32_16x16x32_bf16 a[4:7], v[52:55], v[80:83], a[4:7]
    ds_read_b64_tr_b16 v[0:1], v128 offset:0
    v_mfma_f32_16x16x32_bf16 a[8:11], v[56:59], v[80:83], a[8:11]
    ds_read_b64_tr_b16 v[2:3], v128 offset:8192
    v_mfma_f32_16x16x32_bf16 a[12:15], v[60:63], v[80:83], a[12:15]
    ds_read_b64_tr_b16 v[4:5], v129 offset:0
    buffer_load_dwordx4 v141, s[4:7], s16 offen offset:0 sc1 lds
    v_mfma_f32_16x16x32_bf16 a[16:19], v[64:67], v[80:83], a[16:19]
    ds_read_b64_tr_b16 v[6:7], v129 offset:8192
    v_mfma_f32_16x16x32_bf16 a[20:23], v[68:71], v[80:83], a[20:23]
    ds_read_b64_tr_b16 v[8:9], v130 offset:0
    v_mfma_f32_16x16x32_bf16 a[24:27], v[72:75], v[80:83], a[24:27]
    ds_read_b64_tr_b16 v[10:11], v130 offset:8192
    buffer_load_dwordx4 v142, s[4:7], s16 offen offset:1024 sc1 lds
    v_mfma_f32_16x16x32_bf16 a[28:31], v[76:79], v[80:83], a[28:31]
    ds_read_b64_tr_b16 v[12:13], v131 offset:0
    v_mfma_f32_16x16x32_bf16 a[32:35], v[48:51], v[84:87], a[32:35]
    ds_read_b64_tr_b16 v[14:15], v131 offset:8192
    v_mfma_f32_16x16x32_bf16 a[36:39], v[52:55], v[84:87], a[36:39]
    ds_read_b64_tr_b16 v[16:17], v132 offset:0
    s_add_u32 s16, s16, 1024
    v_mfma_f32_16x16x32_bf16 a[40:43], v[56:59], v[84:87], a[40:43]
    ds_read_b64_tr_b16 v[18:19], v132 offset:8192
    v_mfma_f32_16x16x32_bf16 a[44:47], v[60:63], v[84:87], a[44:47]
    ds_read_b64_tr_b16 v[20:21], v133 offset:0
    v_mfma_f32_16x16x32_bf16 a[48:51], v[64:67], v[84:87], a[48:51]
    ds_read_b64_tr_b16 v[22:23], v133 offset:8192
    s_add_u32 m0, s19, 49152
    s_nop 0
    v_mfma_f32_16x16x32_bf16 a[52:55], v[68:71], v[84:87], a[52:55]
    ds_read_b64_tr_b16 v[24:25], v134 offset:0
    v_mfma_f32_16x16x32_bf16 a[56:59], v[72:75], v[84:87], a[56:59]
    ds_read_b64_tr_b16 v[26:27], v134 offset:8192
    v_mfma_f32_16x16x32_bf16 a[60:63], v[76:79], v[84:87], a[60:63]
    ds_read_b64_tr_b16 v[28:29], v135 offset:0
    buffer_load_dwordx4 v137, s[8:11], s15 offen offset:0 lds
    v_mfma_f32_16x16x32_bf16 a[64:67], v[48:51], v[88:91], a[64:67]
    ds_read_b64_tr_b16 v[30:31], v135 offset:8192
    v_mfma_f32_16x16x32_bf16 a[68:71], v[52:55], v[88:91], a[68:71]
    ds_read_b128 v[36:39], v136 offset:1024
    v_mfma_f32_16x16x32_bf16 a[72:75], v[56:59], v[88:91], a[72:75]
    ds_read_b128 v[40:43], v136 offset:2048
    buffer_load_dwordx4 v138, s[8:11], s15 offen offset:1024 lds
    v_mfma_f32_16x16x32_bf16 a[76:79], v[60:63], v[88:91], a[76:79]
    ds_read_b128 v[44:47], v136 offset:3072
    v_mfma_f32_16x16x32_bf16 a[80:83], v[64:67], v[88:91], a[80:83]
    v_mfma_f32_16x16x32_bf16 a[84:87], v[68:71], v[88:91], a[84:87]
    buffer_load_dwordx4 v139, s[8:11], s15 offen offset:2048 lds
    v_mfma_f32_16x16x32_bf16 a[88:91], v[72:75], v[88:91], a[88:91]
    v_mfma_f32_16x16x32_bf16 a[92:95], v[76:79], v[88:91], a[92:95]
    v_mfma_f32_16x16x32_bf16 a[96:99], v[48:51], v[92:95], a[96:99]
    buffer_load_dwordx4 v140, s[8:11], s15 offen offset:3072 lds
    v_mfma_f32_16x16x32_bf16 a[100:103], v[52:55], v[92:95], a[100:103]
    v_mfma_f32_16x16x32_bf16 a[104:107], v[56:59], v[92:95], a[104:107]
    v_mfma_f32_16x16x32_bf16 a[108:111], v[60:63], v[92:95], a[108:111]
    s_add_u32 s15, s15, s17
    v_mfma_f32_16x16x32_bf16 a[112:115], v[64:67], v[92:95], a[112:115]
    v_mfma_f32_16x16x32_bf16 a[116:119], v[68:71], v[92:95], a[116:119]
    v_mfma_f32_16x16x32_bf16 a[120:123], v[72:75], v[92:95], a[120:123]
    v_mfma_f32_16x16x32_bf16 a[124:127], v[76:79], v[92:95], a[124:127]
    s_sub_u32 s18, s18, 1
    s_cmp_lg_u32 s18, 0
    s_cbranch_scc1 main_kernel_w_c1_n_loop
    s_cmp_lg_u32 s14, 0
    s_cbranch_scc1 main_kernel_w_c1_n_nt
    s_lshl_b32 s32, s27, 8
    s_add_u32 s32, s32, 0x841e000
    v_mov_b32 v255, 1
    s_mov_b64 exec, 1
    buffer_atomic_add v255, off, s[4:7], s32 sc0 sc1
    s_mov_b64 exec, -1
main_kernel_w_c1_n_nt:
    s_waitcnt lgkmcnt(0)
    v_mfma_f32_16x16x32_bf16 a[0:3], v[0:3], v[32:35], a[0:3]
    s_waitcnt vmcnt(12)
    s_barrier
    ds_read_b128 v[80:83], v136 offset:8192
    v_mfma_f32_16x16x32_bf16 a[4:7], v[4:7], v[32:35], a[4:7]
    ds_read_b64_tr_b16 v[48:49], v128 offset:16384
    v_mfma_f32_16x16x32_bf16 a[8:11], v[8:11], v[32:35], a[8:11]
    ds_read_b64_tr_b16 v[50:51], v128 offset:24576
    v_mfma_f32_16x16x32_bf16 a[12:15], v[12:15], v[32:35], a[12:15]
    ds_read_b64_tr_b16 v[52:53], v129 offset:16384
    v_mfma_f32_16x16x32_bf16 a[16:19], v[16:19], v[32:35], a[16:19]
    ds_read_b64_tr_b16 v[54:55], v129 offset:24576
    v_mfma_f32_16x16x32_bf16 a[20:23], v[20:23], v[32:35], a[20:23]
    ds_read_b64_tr_b16 v[56:57], v130 offset:16384
    v_mfma_f32_16x16x32_bf16 a[24:27], v[24:27], v[32:35], a[24:27]
    ds_read_b64_tr_b16 v[58:59], v130 offset:24576
    v_mfma_f32_16x16x32_bf16 a[28:31], v[28:31], v[32:35], a[28:31]
    ds_read_b64_tr_b16 v[60:61], v131 offset:16384
    v_mfma_f32_16x16x32_bf16 a[32:35], v[0:3], v[36:39], a[32:35]
    ds_read_b64_tr_b16 v[62:63], v131 offset:24576
    v_mfma_f32_16x16x32_bf16 a[36:39], v[4:7], v[36:39], a[36:39]
    ds_read_b64_tr_b16 v[64:65], v132 offset:16384
    v_mfma_f32_16x16x32_bf16 a[40:43], v[8:11], v[36:39], a[40:43]
    ds_read_b64_tr_b16 v[66:67], v132 offset:24576
    v_mfma_f32_16x16x32_bf16 a[44:47], v[12:15], v[36:39], a[44:47]
    ds_read_b64_tr_b16 v[68:69], v133 offset:16384
    v_mfma_f32_16x16x32_bf16 a[48:51], v[16:19], v[36:39], a[48:51]
    ds_read_b64_tr_b16 v[70:71], v133 offset:24576
    v_mfma_f32_16x16x32_bf16 a[52:55], v[20:23], v[36:39], a[52:55]
    ds_read_b64_tr_b16 v[72:73], v134 offset:16384
    v_mfma_f32_16x16x32_bf16 a[56:59], v[24:27], v[36:39], a[56:59]
    ds_read_b64_tr_b16 v[74:75], v134 offset:24576
    v_mfma_f32_16x16x32_bf16 a[60:63], v[28:31], v[36:39], a[60:63]
    ds_read_b64_tr_b16 v[76:77], v135 offset:16384
    v_mfma_f32_16x16x32_bf16 a[64:67], v[0:3], v[40:43], a[64:67]
    ds_read_b64_tr_b16 v[78:79], v135 offset:24576
    v_mfma_f32_16x16x32_bf16 a[68:71], v[4:7], v[40:43], a[68:71]
    ds_read_b128 v[84:87], v136 offset:9216
    v_mfma_f32_16x16x32_bf16 a[72:75], v[8:11], v[40:43], a[72:75]
    ds_read_b128 v[88:91], v136 offset:10240
    v_mfma_f32_16x16x32_bf16 a[76:79], v[12:15], v[40:43], a[76:79]
    ds_read_b128 v[92:95], v136 offset:11264
    v_mfma_f32_16x16x32_bf16 a[80:83], v[16:19], v[40:43], a[80:83]
    v_mfma_f32_16x16x32_bf16 a[84:87], v[20:23], v[40:43], a[84:87]
    v_mfma_f32_16x16x32_bf16 a[88:91], v[24:27], v[40:43], a[88:91]
    v_mfma_f32_16x16x32_bf16 a[92:95], v[28:31], v[40:43], a[92:95]
    v_mfma_f32_16x16x32_bf16 a[96:99], v[0:3], v[44:47], a[96:99]
    v_mfma_f32_16x16x32_bf16 a[100:103], v[4:7], v[44:47], a[100:103]
    v_mfma_f32_16x16x32_bf16 a[104:107], v[8:11], v[44:47], a[104:107]
    v_mfma_f32_16x16x32_bf16 a[108:111], v[12:15], v[44:47], a[108:111]
    v_mfma_f32_16x16x32_bf16 a[112:115], v[16:19], v[44:47], a[112:115]
    v_mfma_f32_16x16x32_bf16 a[116:119], v[20:23], v[44:47], a[116:119]
    v_mfma_f32_16x16x32_bf16 a[120:123], v[24:27], v[44:47], a[120:123]
    v_mfma_f32_16x16x32_bf16 a[124:127], v[28:31], v[44:47], a[124:127]
    s_waitcnt lgkmcnt(0)
    v_mfma_f32_16x16x32_bf16 a[0:3], v[48:51], v[80:83], a[0:3]
    s_waitcnt vmcnt(6)
    s_barrier
    ds_read_b128 v[32:35], v136 offset:16384
    v_mfma_f32_16x16x32_bf16 a[4:7], v[52:55], v[80:83], a[4:7]
    ds_read_b64_tr_b16 v[0:1], v128 offset:32768
    v_mfma_f32_16x16x32_bf16 a[8:11], v[56:59], v[80:83], a[8:11]
    ds_read_b64_tr_b16 v[2:3], v128 offset:40960
    v_mfma_f32_16x16x32_bf16 a[12:15], v[60:63], v[80:83], a[12:15]
    ds_read_b64_tr_b16 v[4:5], v129 offset:32768
    v_mfma_f32_16x16x32_bf16 a[16:19], v[64:67], v[80:83], a[16:19]
    ds_read_b64_tr_b16 v[6:7], v129 offset:40960
    v_mfma_f32_16x16x32_bf16 a[20:23], v[68:71], v[80:83], a[20:23]
    ds_read_b64_tr_b16 v[8:9], v130 offset:32768
    v_mfma_f32_16x16x32_bf16 a[24:27], v[72:75], v[80:83], a[24:27]
    ds_read_b64_tr_b16 v[10:11], v130 offset:40960
    v_mfma_f32_16x16x32_bf16 a[28:31], v[76:79], v[80:83], a[28:31]
    ds_read_b64_tr_b16 v[12:13], v131 offset:32768
    v_mfma_f32_16x16x32_bf16 a[32:35], v[48:51], v[84:87], a[32:35]
    ds_read_b64_tr_b16 v[14:15], v131 offset:40960
    v_mfma_f32_16x16x32_bf16 a[36:39], v[52:55], v[84:87], a[36:39]
    ds_read_b64_tr_b16 v[16:17], v132 offset:32768
    v_mfma_f32_16x16x32_bf16 a[40:43], v[56:59], v[84:87], a[40:43]
    ds_read_b64_tr_b16 v[18:19], v132 offset:40960
    v_mfma_f32_16x16x32_bf16 a[44:47], v[60:63], v[84:87], a[44:47]
    ds_read_b64_tr_b16 v[20:21], v133 offset:32768
    v_mfma_f32_16x16x32_bf16 a[48:51], v[64:67], v[84:87], a[48:51]
    ds_read_b64_tr_b16 v[22:23], v133 offset:40960
    v_mfma_f32_16x16x32_bf16 a[52:55], v[68:71], v[84:87], a[52:55]
    ds_read_b64_tr_b16 v[24:25], v134 offset:32768
    v_mfma_f32_16x16x32_bf16 a[56:59], v[72:75], v[84:87], a[56:59]
    ds_read_b64_tr_b16 v[26:27], v134 offset:40960
    v_mfma_f32_16x16x32_bf16 a[60:63], v[76:79], v[84:87], a[60:63]
    ds_read_b64_tr_b16 v[28:29], v135 offset:32768
    v_mfma_f32_16x16x32_bf16 a[64:67], v[48:51], v[88:91], a[64:67]
    ds_read_b64_tr_b16 v[30:31], v135 offset:40960
    v_mfma_f32_16x16x32_bf16 a[68:71], v[52:55], v[88:91], a[68:71]
    ds_read_b128 v[36:39], v136 offset:17408
    v_mfma_f32_16x16x32_bf16 a[72:75], v[56:59], v[88:91], a[72:75]
    ds_read_b128 v[40:43], v136 offset:18432
    v_mfma_f32_16x16x32_bf16 a[76:79], v[60:63], v[88:91], a[76:79]
    ds_read_b128 v[44:47], v136 offset:19456
    v_mfma_f32_16x16x32_bf16 a[80:83], v[64:67], v[88:91], a[80:83]
    v_mfma_f32_16x16x32_bf16 a[84:87], v[68:71], v[88:91], a[84:87]
    v_mfma_f32_16x16x32_bf16 a[88:91], v[72:75], v[88:91], a[88:91]
    v_mfma_f32_16x16x32_bf16 a[92:95], v[76:79], v[88:91], a[92:95]
    v_mfma_f32_16x16x32_bf16 a[96:99], v[48:51], v[92:95], a[96:99]
    v_mfma_f32_16x16x32_bf16 a[100:103], v[52:55], v[92:95], a[100:103]
    v_mfma_f32_16x16x32_bf16 a[104:107], v[56:59], v[92:95], a[104:107]
    v_mfma_f32_16x16x32_bf16 a[108:111], v[60:63], v[92:95], a[108:111]
    v_mfma_f32_16x16x32_bf16 a[112:115], v[64:67], v[92:95], a[112:115]
    v_mfma_f32_16x16x32_bf16 a[116:119], v[68:71], v[92:95], a[116:119]
    v_mfma_f32_16x16x32_bf16 a[120:123], v[72:75], v[92:95], a[120:123]
    v_mfma_f32_16x16x32_bf16 a[124:127], v[76:79], v[92:95], a[124:127]
    s_waitcnt lgkmcnt(0)
    v_mfma_f32_16x16x32_bf16 a[0:3], v[0:3], v[32:35], a[0:3]
    s_waitcnt vmcnt(0)
    s_barrier
    ds_read_b128 v[80:83], v136 offset:24576
    v_mfma_f32_16x16x32_bf16 a[4:7], v[4:7], v[32:35], a[4:7]
    ds_read_b64_tr_b16 v[48:49], v128 offset:49152
    v_mfma_f32_16x16x32_bf16 a[8:11], v[8:11], v[32:35], a[8:11]
    ds_read_b64_tr_b16 v[50:51], v128 offset:57344
    v_mfma_f32_16x16x32_bf16 a[12:15], v[12:15], v[32:35], a[12:15]
    ds_read_b64_tr_b16 v[52:53], v129 offset:49152
    v_mfma_f32_16x16x32_bf16 a[16:19], v[16:19], v[32:35], a[16:19]
    ds_read_b64_tr_b16 v[54:55], v129 offset:57344
    v_mfma_f32_16x16x32_bf16 a[20:23], v[20:23], v[32:35], a[20:23]
    ds_read_b64_tr_b16 v[56:57], v130 offset:49152
    v_mfma_f32_16x16x32_bf16 a[24:27], v[24:27], v[32:35], a[24:27]
    ds_read_b64_tr_b16 v[58:59], v130 offset:57344
    v_mfma_f32_16x16x32_bf16 a[28:31], v[28:31], v[32:35], a[28:31]
    ds_read_b64_tr_b16 v[60:61], v131 offset:49152
    v_mfma_f32_16x16x32_bf16 a[32:35], v[0:3], v[36:39], a[32:35]
    ds_read_b64_tr_b16 v[62:63], v131 offset:57344
    v_mfma_f32_16x16x32_bf16 a[36:39], v[4:7], v[36:39], a[36:39]
    ds_read_b64_tr_b16 v[64:65], v132 offset:49152
    v_mfma_f32_16x16x32_bf16 a[40:43], v[8:11], v[36:39], a[40:43]
    ds_read_b64_tr_b16 v[66:67], v132 offset:57344
    v_mfma_f32_16x16x32_bf16 a[44:47], v[12:15], v[36:39], a[44:47]
    ds_read_b64_tr_b16 v[68:69], v133 offset:49152
    v_mfma_f32_16x16x32_bf16 a[48:51], v[16:19], v[36:39], a[48:51]
    ds_read_b64_tr_b16 v[70:71], v133 offset:57344
    v_mfma_f32_16x16x32_bf16 a[52:55], v[20:23], v[36:39], a[52:55]
    ds_read_b64_tr_b16 v[72:73], v134 offset:49152
    v_mfma_f32_16x16x32_bf16 a[56:59], v[24:27], v[36:39], a[56:59]
    ds_read_b64_tr_b16 v[74:75], v134 offset:57344
    v_mfma_f32_16x16x32_bf16 a[60:63], v[28:31], v[36:39], a[60:63]
    ds_read_b64_tr_b16 v[76:77], v135 offset:49152
    v_mfma_f32_16x16x32_bf16 a[64:67], v[0:3], v[40:43], a[64:67]
    ds_read_b64_tr_b16 v[78:79], v135 offset:57344
    v_mfma_f32_16x16x32_bf16 a[68:71], v[4:7], v[40:43], a[68:71]
    ds_read_b128 v[84:87], v136 offset:25600
    v_mfma_f32_16x16x32_bf16 a[72:75], v[8:11], v[40:43], a[72:75]
    ds_read_b128 v[88:91], v136 offset:26624
    v_mfma_f32_16x16x32_bf16 a[76:79], v[12:15], v[40:43], a[76:79]
    ds_read_b128 v[92:95], v136 offset:27648
    v_mfma_f32_16x16x32_bf16 a[80:83], v[16:19], v[40:43], a[80:83]
    v_mfma_f32_16x16x32_bf16 a[84:87], v[20:23], v[40:43], a[84:87]
    v_mfma_f32_16x16x32_bf16 a[88:91], v[24:27], v[40:43], a[88:91]
    v_mfma_f32_16x16x32_bf16 a[92:95], v[28:31], v[40:43], a[92:95]
    v_mfma_f32_16x16x32_bf16 a[96:99], v[0:3], v[44:47], a[96:99]
    v_mfma_f32_16x16x32_bf16 a[100:103], v[4:7], v[44:47], a[100:103]
    v_mfma_f32_16x16x32_bf16 a[104:107], v[8:11], v[44:47], a[104:107]
    v_mfma_f32_16x16x32_bf16 a[108:111], v[12:15], v[44:47], a[108:111]
    v_mfma_f32_16x16x32_bf16 a[112:115], v[16:19], v[44:47], a[112:115]
    v_mfma_f32_16x16x32_bf16 a[116:119], v[20:23], v[44:47], a[116:119]
    v_mfma_f32_16x16x32_bf16 a[120:123], v[24:27], v[44:47], a[120:123]
    v_mfma_f32_16x16x32_bf16 a[124:127], v[28:31], v[44:47], a[124:127]
    v_readfirstlane_b32 s55, v255
    s_waitcnt lgkmcnt(0)
    v_mfma_f32_16x16x32_bf16 a[0:3], v[48:51], v[80:83], a[0:3]
    v_mfma_f32_16x16x32_bf16 a[4:7], v[52:55], v[80:83], a[4:7]
    v_mfma_f32_16x16x32_bf16 a[8:11], v[56:59], v[80:83], a[8:11]
    v_mfma_f32_16x16x32_bf16 a[12:15], v[60:63], v[80:83], a[12:15]
    v_mfma_f32_16x16x32_bf16 a[16:19], v[64:67], v[80:83], a[16:19]
    v_mfma_f32_16x16x32_bf16 a[20:23], v[68:71], v[80:83], a[20:23]
    v_mfma_f32_16x16x32_bf16 a[24:27], v[72:75], v[80:83], a[24:27]
    v_mfma_f32_16x16x32_bf16 a[28:31], v[76:79], v[80:83], a[28:31]
    v_mfma_f32_16x16x32_bf16 a[32:35], v[48:51], v[84:87], a[32:35]
    v_mfma_f32_16x16x32_bf16 a[36:39], v[52:55], v[84:87], a[36:39]
    v_mfma_f32_16x16x32_bf16 a[40:43], v[56:59], v[84:87], a[40:43]
    v_mfma_f32_16x16x32_bf16 a[44:47], v[60:63], v[84:87], a[44:47]
    v_mfma_f32_16x16x32_bf16 a[48:51], v[64:67], v[84:87], a[48:51]
    v_mfma_f32_16x16x32_bf16 a[52:55], v[68:71], v[84:87], a[52:55]
    v_mfma_f32_16x16x32_bf16 a[56:59], v[72:75], v[84:87], a[56:59]
    v_mfma_f32_16x16x32_bf16 a[60:63], v[76:79], v[84:87], a[60:63]
    v_mfma_f32_16x16x32_bf16 a[64:67], v[48:51], v[88:91], a[64:67]
    v_mfma_f32_16x16x32_bf16 a[68:71], v[52:55], v[88:91], a[68:71]
    v_mfma_f32_16x16x32_bf16 a[72:75], v[56:59], v[88:91], a[72:75]
    v_mfma_f32_16x16x32_bf16 a[76:79], v[60:63], v[88:91], a[76:79]
    v_mfma_f32_16x16x32_bf16 a[80:83], v[64:67], v[88:91], a[80:83]
    v_mfma_f32_16x16x32_bf16 a[84:87], v[68:71], v[88:91], a[84:87]
    v_mfma_f32_16x16x32_bf16 a[88:91], v[72:75], v[88:91], a[88:91]
    v_mfma_f32_16x16x32_bf16 a[92:95], v[76:79], v[88:91], a[92:95]
    v_mfma_f32_16x16x32_bf16 a[96:99], v[48:51], v[92:95], a[96:99]
    v_mfma_f32_16x16x32_bf16 a[100:103], v[52:55], v[92:95], a[100:103]
    v_mfma_f32_16x16x32_bf16 a[104:107], v[56:59], v[92:95], a[104:107]
    v_mfma_f32_16x16x32_bf16 a[108:111], v[60:63], v[92:95], a[108:111]
    v_mfma_f32_16x16x32_bf16 a[112:115], v[64:67], v[92:95], a[112:115]
    v_mfma_f32_16x16x32_bf16 a[116:119], v[68:71], v[92:95], a[116:119]
    v_mfma_f32_16x16x32_bf16 a[120:123], v[72:75], v[92:95], a[120:123]
    v_mfma_f32_16x16x32_bf16 a[124:127], v[76:79], v[92:95], a[124:127]
    s_nop 7
    s_cmp_eq_u32 s23, 1
    s_cbranch_scc1 main_kernel_w_c1_escl
    s_cmp_eq_u32 s23, 3
    s_cbranch_scc1 main_kernel_w_c1_egelus
    s_cmp_eq_u32 s23, 6
    s_cbranch_scc1 main_kernel_w_c1_egelu
main_kernel_w_c1_eplain:
    s_mov_b32 s53, s21
    v_accvgpr_read_b32 v0, a0
    v_accvgpr_read_b32 v1, a1
    v_accvgpr_read_b32 v2, a2
    v_accvgpr_read_b32 v3, a3
    v_accvgpr_read_b32 v4, a4
    v_accvgpr_read_b32 v5, a5
    v_accvgpr_read_b32 v6, a6
    v_accvgpr_read_b32 v7, a7
    v_cvt_pk_bf16_f32 v16, v0, v1
    v_cvt_pk_bf16_f32 v17, v2, v3
    v_cvt_pk_bf16_f32 v18, v4, v5
    v_cvt_pk_bf16_f32 v19, v6, v7
    buffer_store_dwordx4 v[16:19], v251, s[4:7], s53 offen offset:0 sc1
    v_accvgpr_read_b32 v20, a8
    v_accvgpr_read_b32 v21, a9
    v_accvgpr_read_b32 v22, a10
    v_accvgpr_read_b32 v23, a11
    v_accvgpr_read_b32 v24, a12
    v_accvgpr_read_b32 v25, a13
    v_accvgpr_read_b32 v26, a14
    v_accvgpr_read_b32 v27, a15
    v_cvt_pk_bf16_f32 v36, v20, v21
    v_cvt_pk_bf16_f32 v37, v22, v23
    v_cvt_pk_bf16_f32 v38, v24, v25
    v_cvt_pk_bf16_f32 v39, v26, v27
    buffer_store_dwordx4 v[36:39], v251, s[4:7], s53 offen offset:1024 sc1
    v_accvgpr_read_b32 v40, a16
    v_accvgpr_read_b32 v41, a17
    v_accvgpr_read_b32 v42, a18
    v_accvgpr_read_b32 v43, a19
    v_accvgpr_read_b32 v44, a20
    v_accvgpr_read_b32 v45, a21
    v_accvgpr_read_b32 v46, a22
    v_accvgpr_read_b32 v47, a23
    v_cvt_pk_bf16_f32 v56, v40, v41
    v_cvt_pk_bf16_f32 v57, v42, v43
    v_cvt_pk_bf16_f32 v58, v44, v45
    v_cvt_pk_bf16_f32 v59, v46, v47
    buffer_store_dwordx4 v[56:59], v251, s[4:7], s53 offen offset:2048 sc1
    v_accvgpr_read_b32 v0, a24
    v_accvgpr_read_b32 v1, a25
    v_accvgpr_read_b32 v2, a26
    v_accvgpr_read_b32 v3, a27
    v_accvgpr_read_b32 v4, a28
    v_accvgpr_read_b32 v5, a29
    v_accvgpr_read_b32 v6, a30
    v_accvgpr_read_b32 v7, a31
    v_cvt_pk_bf16_f32 v16, v0, v1
    v_cvt_pk_bf16_f32 v17, v2, v3
    v_cvt_pk_bf16_f32 v18, v4, v5
    v_cvt_pk_bf16_f32 v19, v6, v7
    buffer_store_dwordx4 v[16:19], v251, s[4:7], s53 offen offset:3072 sc1
    s_add_u32 s53, s53, s22
    v_accvgpr_read_b32 v20, a32
    v_accvgpr_read_b32 v21, a33
    v_accvgpr_read_b32 v22, a34
    v_accvgpr_read_b32 v23, a35
    v_accvgpr_read_b32 v24, a36
    v_accvgpr_read_b32 v25, a37
    v_accvgpr_read_b32 v26, a38
    v_accvgpr_read_b32 v27, a39
    v_cvt_pk_bf16_f32 v36, v20, v21
    v_cvt_pk_bf16_f32 v37, v22, v23
    v_cvt_pk_bf16_f32 v38, v24, v25
    v_cvt_pk_bf16_f32 v39, v26, v27
    buffer_store_dwordx4 v[36:39], v251, s[4:7], s53 offen offset:0 sc1
    v_accvgpr_read_b32 v40, a40
    v_accvgpr_read_b32 v41, a41
    v_accvgpr_read_b32 v42, a42
    v_accvgpr_read_b32 v43, a43
    v_accvgpr_read_b32 v44, a44
    v_accvgpr_read_b32 v45, a45
    v_accvgpr_read_b32 v46, a46
    v_accvgpr_read_b32 v47, a47
    v_cvt_pk_bf16_f32 v56, v40, v41
    v_cvt_pk_bf16_f32 v57, v42, v43
    v_cvt_pk_bf16_f32 v58, v44, v45
    v_cvt_pk_bf16_f32 v59, v46, v47
    buffer_store_dwordx4 v[56:59], v251, s[4:7], s53 offen offset:1024 sc1
    v_accvgpr_read_b32 v0, a48
    v_accvgpr_read_b32 v1, a49
    v_accvgpr_read_b32 v2, a50
    v_accvgpr_read_b32 v3, a51
    v_accvgpr_read_b32 v4, a52
    v_accvgpr_read_b32 v5, a53
    v_accvgpr_read_b32 v6, a54
    v_accvgpr_read_b32 v7, a55
    v_cvt_pk_bf16_f32 v16, v0, v1
    v_cvt_pk_bf16_f32 v17, v2, v3
    v_cvt_pk_bf16_f32 v18, v4, v5
    v_cvt_pk_bf16_f32 v19, v6, v7
    buffer_store_dwordx4 v[16:19], v251, s[4:7], s53 offen offset:2048 sc1
    v_accvgpr_read_b32 v20, a56
    v_accvgpr_read_b32 v21, a57
    v_accvgpr_read_b32 v22, a58
    v_accvgpr_read_b32 v23, a59
    v_accvgpr_read_b32 v24, a60
    v_accvgpr_read_b32 v25, a61
    v_accvgpr_read_b32 v26, a62
    v_accvgpr_read_b32 v27, a63
    v_cvt_pk_bf16_f32 v36, v20, v21
    v_cvt_pk_bf16_f32 v37, v22, v23
    v_cvt_pk_bf16_f32 v38, v24, v25
    v_cvt_pk_bf16_f32 v39, v26, v27
    buffer_store_dwordx4 v[36:39], v251, s[4:7], s53 offen offset:3072 sc1
    s_add_u32 s53, s53, s22
    v_accvgpr_read_b32 v40, a64
    v_accvgpr_read_b32 v41, a65
    v_accvgpr_read_b32 v42, a66
    v_accvgpr_read_b32 v43, a67
    v_accvgpr_read_b32 v44, a68
    v_accvgpr_read_b32 v45, a69
    v_accvgpr_read_b32 v46, a70
    v_accvgpr_read_b32 v47, a71
    v_cvt_pk_bf16_f32 v56, v40, v41
    v_cvt_pk_bf16_f32 v57, v42, v43
    v_cvt_pk_bf16_f32 v58, v44, v45
    v_cvt_pk_bf16_f32 v59, v46, v47
    buffer_store_dwordx4 v[56:59], v251, s[4:7], s53 offen offset:0 sc1
    v_accvgpr_read_b32 v0, a72
    v_accvgpr_read_b32 v1, a73
    v_accvgpr_read_b32 v2, a74
    v_accvgpr_read_b32 v3, a75
    v_accvgpr_read_b32 v4, a76
    v_accvgpr_read_b32 v5, a77
    v_accvgpr_read_b32 v6, a78
    v_accvgpr_read_b32 v7, a79
    v_cvt_pk_bf16_f32 v16, v0, v1
    v_cvt_pk_bf16_f32 v17, v2, v3
    v_cvt_pk_bf16_f32 v18, v4, v5
    v_cvt_pk_bf16_f32 v19, v6, v7
    buffer_store_dwordx4 v[16:19], v251, s[4:7], s53 offen offset:1024 sc1
    v_accvgpr_read_b32 v20, a80
    v_accvgpr_read_b32 v21, a81
    v_accvgpr_read_b32 v22, a82
    v_accvgpr_read_b32 v23, a83
    v_accvgpr_read_b32 v24, a84
    v_accvgpr_read_b32 v25, a85
    v_accvgpr_read_b32 v26, a86
    v_accvgpr_read_b32 v27, a87
    v_cvt_pk_bf16_f32 v36, v20, v21
    v_cvt_pk_bf16_f32 v37, v22, v23
    v_cvt_pk_bf16_f32 v38, v24, v25
    v_cvt_pk_bf16_f32 v39, v26, v27
    buffer_store_dwordx4 v[36:39], v251, s[4:7], s53 offen offset:2048 sc1
    v_accvgpr_read_b32 v40, a88
    v_accvgpr_read_b32 v41, a89
    v_accvgpr_read_b32 v42, a90
    v_accvgpr_read_b32 v43, a91
    v_accvgpr_read_b32 v44, a92
    v_accvgpr_read_b32 v45, a93
    v_accvgpr_read_b32 v46, a94
    v_accvgpr_read_b32 v47, a95
    v_cvt_pk_bf16_f32 v56, v40, v41
    v_cvt_pk_bf16_f32 v57, v42, v43
    v_cvt_pk_bf16_f32 v58, v44, v45
    v_cvt_pk_bf16_f32 v59, v46, v47
    buffer_store_dwordx4 v[56:59], v251, s[4:7], s53 offen offset:3072 sc1
    s_add_u32 s53, s53, s22
    v_accvgpr_read_b32 v0, a96
    v_accvgpr_read_b32 v1, a97
    v_accvgpr_read_b32 v2, a98
    v_accvgpr_read_b32 v3, a99
    v_accvgpr_read_b32 v4, a100
    v_accvgpr_read_b32 v5, a101
    v_accvgpr_read_b32 v6, a102
    v_accvgpr_read_b32 v7, a103
    v_cvt_pk_bf16_f32 v16, v0, v1
    v_cvt_pk_bf16_f32 v17, v2, v3
    v_cvt_pk_bf16_f32 v18, v4, v5
    v_cvt_pk_bf16_f32 v19, v6, v7
    buffer_store_dwordx4 v[16:19], v251, s[4:7], s53 offen offset:0 sc1
    v_accvgpr_read_b32 v20, a104
    v_accvgpr_read_b32 v21, a105
    v_accvgpr_read_b32 v22, a106
    v_accvgpr_read_b32 v23, a107
    v_accvgpr_read_b32 v24, a108
    v_accvgpr_read_b32 v25, a109
    v_accvgpr_read_b32 v26, a110
    v_accvgpr_read_b32 v27, a111
    v_cvt_pk_bf16_f32 v36, v20, v21
    v_cvt_pk_bf16_f32 v37, v22, v23
    v_cvt_pk_bf16_f32 v38, v24, v25
    v_cvt_pk_bf16_f32 v39, v26, v27
    buffer_store_dwordx4 v[36:39], v251, s[4:7], s53 offen offset:1024 sc1
    v_accvgpr_read_b32 v40, a112
    v_accvgpr_read_b32 v41, a113
    v_accvgpr_read_b32 v42, a114
    v_accvgpr_read_b32 v43, a115
    v_accvgpr_read_b32 v44, a116
    v_accvgpr_read_b32 v45, a117
    v_accvgpr_read_b32 v46, a118
    v_accvgpr_read_b32 v47, a119
    v_cvt_pk_bf16_f32 v56, v40, v41
    v_cvt_pk_bf16_f32 v57, v42, v43
    v_cvt_pk_bf16_f32 v58, v44, v45
    v_cvt_pk_bf16_f32 v59, v46, v47
    buffer_store_dwordx4 v[56:59], v251, s[4:7], s53 offen offset:2048 sc1
    v_accvgpr_read_b32 v0, a120
    v_accvgpr_read_b32 v1, a121
    v_accvgpr_read_b32 v2, a122
    v_accvgpr_read_b32 v3, a123
    v_accvgpr_read_b32 v4, a124
    v_accvgpr_read_b32 v5, a125
    v_accvgpr_read_b32 v6, a126
    v_accvgpr_read_b32 v7, a127
    v_cvt_pk_bf16_f32 v16, v0, v1
    v_cvt_pk_bf16_f32 v17, v2, v3
    v_cvt_pk_bf16_f32 v18, v4, v5
    v_cvt_pk_bf16_f32 v19, v6, v7
    buffer_store_dwordx4 v[16:19], v251, s[4:7], s53 offen offset:3072 sc1
    s_branch main_kernel_w_done
main_kernel_w_c1_escl:
    s_mov_b32 s53, s21
    v_accvgpr_read_b32 v0, a0
    v_accvgpr_read_b32 v1, a1
    v_accvgpr_read_b32 v2, a2
    v_accvgpr_read_b32 v3, a3
    v_accvgpr_read_b32 v4, a4
    v_accvgpr_read_b32 v5, a5
    v_accvgpr_read_b32 v6, a6
    v_accvgpr_read_b32 v7, a7
    v_mul_f32 v0, 0x3e0293ee, v0
    v_mul_f32 v1, 0x3e0293ee, v1
    v_mul_f32 v2, 0x3e0293ee, v2
    v_mul_f32 v3, 0x3e0293ee, v3
    v_mul_f32 v4, 0x3e0293ee, v4
    v_mul_f32 v5, 0x3e0293ee, v5
    v_mul_f32 v6, 0x3e0293ee, v6
    v_mul_f32 v7, 0x3e0293ee, v7
    v_cvt_pk_bf16_f32 v16, v0, v1
    v_cvt_pk_bf16_f32 v17, v2, v3
    v_cvt_pk_bf16_f32 v18, v4, v5
    v_cvt_pk_bf16_f32 v19, v6, v7
    buffer_store_dwordx4 v[16:19], v251, s[4:7], s53 offen offset:0 sc1
    v_accvgpr_read_b32 v20, a8
    v_accvgpr_read_b32 v21, a9
    v_accvgpr_read_b32 v22, a10
    v_accvgpr_read_b32 v23, a11
    v_accvgpr_read_b32 v24, a12
    v_accvgpr_read_b32 v25, a13
    v_accvgpr_read_b32 v26, a14
    v_accvgpr_read_b32 v27, a15
    v_mul_f32 v20, 0x3e0293ee, v20
    v_mul_f32 v21, 0x3e0293ee, v21
    v_mul_f32 v22, 0x3e0293ee, v22
    v_mul_f32 v23, 0x3e0293ee, v23
    v_mul_f32 v24, 0x3e0293ee, v24
    v_mul_f32 v25, 0x3e0293ee, v25
    v_mul_f32 v26, 0x3e0293ee, v26
    v_mul_f32 v27, 0x3e0293ee, v27
    v_cvt_pk_bf16_f32 v36, v20, v21
    v_cvt_pk_bf16_f32 v37, v22, v23
    v_cvt_pk_bf16_f32 v38, v24, v25
    v_cvt_pk_bf16_f32 v39, v26, v27
    buffer_store_dwordx4 v[36:39], v251, s[4:7], s53 offen offset:1024 sc1
    v_accvgpr_read_b32 v40, a16
    v_accvgpr_read_b32 v41, a17
    v_accvgpr_read_b32 v42, a18
    v_accvgpr_read_b32 v43, a19
    v_accvgpr_read_b32 v44, a20
    v_accvgpr_read_b32 v45, a21
    v_accvgpr_read_b32 v46, a22
    v_accvgpr_read_b32 v47, a23
    v_mul_f32 v40, 0x3e0293ee, v40
    v_mul_f32 v41, 0x3e0293ee, v41
    v_mul_f32 v42, 0x3e0293ee, v42
    v_mul_f32 v43, 0x3e0293ee, v43
    v_mul_f32 v44, 0x3e0293ee, v44
    v_mul_f32 v45, 0x3e0293ee, v45
    v_mul_f32 v46, 0x3e0293ee, v46
    v_mul_f32 v47, 0x3e0293ee, v47
    v_cvt_pk_bf16_f32 v56, v40, v41
    v_cvt_pk_bf16_f32 v57, v42, v43
    v_cvt_pk_bf16_f32 v58, v44, v45
    v_cvt_pk_bf16_f32 v59, v46, v47
    buffer_store_dwordx4 v[56:59], v251, s[4:7], s53 offen offset:2048 sc1
    v_accvgpr_read_b32 v0, a24
    v_accvgpr_read_b32 v1, a25
    v_accvgpr_read_b32 v2, a26
    v_accvgpr_read_b32 v3, a27
    v_accvgpr_read_b32 v4, a28
    v_accvgpr_read_b32 v5, a29
    v_accvgpr_read_b32 v6, a30
    v_accvgpr_read_b32 v7, a31
    v_mul_f32 v0, 0x3e0293ee, v0
    v_mul_f32 v1, 0x3e0293ee, v1
    v_mul_f32 v2, 0x3e0293ee, v2
    v_mul_f32 v3, 0x3e0293ee, v3
    v_mul_f32 v4, 0x3e0293ee, v4
    v_mul_f32 v5, 0x3e0293ee, v5
    v_mul_f32 v6, 0x3e0293ee, v6
    v_mul_f32 v7, 0x3e0293ee, v7
    v_cvt_pk_bf16_f32 v16, v0, v1
    v_cvt_pk_bf16_f32 v17, v2, v3
    v_cvt_pk_bf16_f32 v18, v4, v5
    v_cvt_pk_bf16_f32 v19, v6, v7
    buffer_store_dwordx4 v[16:19], v251, s[4:7], s53 offen offset:3072 sc1
    s_add_u32 s53, s53, s22
    v_accvgpr_read_b32 v20, a32
    v_accvgpr_read_b32 v21, a33
    v_accvgpr_read_b32 v22, a34
    v_accvgpr_read_b32 v23, a35
    v_accvgpr_read_b32 v24, a36
    v_accvgpr_read_b32 v25, a37
    v_accvgpr_read_b32 v26, a38
    v_accvgpr_read_b32 v27, a39
    v_mul_f32 v20, 0x3e0293ee, v20
    v_mul_f32 v21, 0x3e0293ee, v21
    v_mul_f32 v22, 0x3e0293ee, v22
    v_mul_f32 v23, 0x3e0293ee, v23
    v_mul_f32 v24, 0x3e0293ee, v24
    v_mul_f32 v25, 0x3e0293ee, v25
    v_mul_f32 v26, 0x3e0293ee, v26
    v_mul_f32 v27, 0x3e0293ee, v27
    v_cvt_pk_bf16_f32 v36, v20, v21
    v_cvt_pk_bf16_f32 v37, v22, v23
    v_cvt_pk_bf16_f32 v38, v24, v25
    v_cvt_pk_bf16_f32 v39, v26, v27
    buffer_store_dwordx4 v[36:39], v251, s[4:7], s53 offen offset:0 sc1
    v_accvgpr_read_b32 v40, a40
    v_accvgpr_read_b32 v41, a41
    v_accvgpr_read_b32 v42, a42
    v_accvgpr_read_b32 v43, a43
    v_accvgpr_read_b32 v44, a44
    v_accvgpr_read_b32 v45, a45
    v_accvgpr_read_b32 v46, a46
    v_accvgpr_read_b32 v47, a47
    v_mul_f32 v40, 0x3e0293ee, v40
    v_mul_f32 v41, 0x3e0293ee, v41
    v_mul_f32 v42, 0x3e0293ee, v42
    v_mul_f32 v43, 0x3e0293ee, v43
    v_mul_f32 v44, 0x3e0293ee, v44
    v_mul_f32 v45, 0x3e0293ee, v45
    v_mul_f32 v46, 0x3e0293ee, v46
    v_mul_f32 v47, 0x3e0293ee, v47
    v_cvt_pk_bf16_f32 v56, v40, v41
    v_cvt_pk_bf16_f32 v57, v42, v43
    v_cvt_pk_bf16_f32 v58, v44, v45
    v_cvt_pk_bf16_f32 v59, v46, v47
    buffer_store_dwordx4 v[56:59], v251, s[4:7], s53 offen offset:1024 sc1
    v_accvgpr_read_b32 v0, a48
    v_accvgpr_read_b32 v1, a49
    v_accvgpr_read_b32 v2, a50
    v_accvgpr_read_b32 v3, a51
    v_accvgpr_read_b32 v4, a52
    v_accvgpr_read_b32 v5, a53
    v_accvgpr_read_b32 v6, a54
    v_accvgpr_read_b32 v7, a55
    v_mul_f32 v0, 0x3e0293ee, v0
    v_mul_f32 v1, 0x3e0293ee, v1
    v_mul_f32 v2, 0x3e0293ee, v2
    v_mul_f32 v3, 0x3e0293ee, v3
    v_mul_f32 v4, 0x3e0293ee, v4
    v_mul_f32 v5, 0x3e0293ee, v5
    v_mul_f32 v6, 0x3e0293ee, v6
    v_mul_f32 v7, 0x3e0293ee, v7
    v_cvt_pk_bf16_f32 v16, v0, v1
    v_cvt_pk_bf16_f32 v17, v2, v3
    v_cvt_pk_bf16_f32 v18, v4, v5
    v_cvt_pk_bf16_f32 v19, v6, v7
    buffer_store_dwordx4 v[16:19], v251, s[4:7], s53 offen offset:2048 sc1
    v_accvgpr_read_b32 v20, a56
    v_accvgpr_read_b32 v21, a57
    v_accvgpr_read_b32 v22, a58
    v_accvgpr_read_b32 v23, a59
    v_accvgpr_read_b32 v24, a60
    v_accvgpr_read_b32 v25, a61
    v_accvgpr_read_b32 v26, a62
    v_accvgpr_read_b32 v27, a63
    v_mul_f32 v20, 0x3e0293ee, v20
    v_mul_f32 v21, 0x3e0293ee, v21
    v_mul_f32 v22, 0x3e0293ee, v22
    v_mul_f32 v23, 0x3e0293ee, v23
    v_mul_f32 v24, 0x3e0293ee, v24
    v_mul_f32 v25, 0x3e0293ee, v25
    v_mul_f32 v26, 0x3e0293ee, v26
    v_mul_f32 v27, 0x3e0293ee, v27
    v_cvt_pk_bf16_f32 v36, v20, v21
    v_cvt_pk_bf16_f32 v37, v22, v23
    v_cvt_pk_bf16_f32 v38, v24, v25
    v_cvt_pk_bf16_f32 v39, v26, v27
    buffer_store_dwordx4 v[36:39], v251, s[4:7], s53 offen offset:3072 sc1
    s_add_u32 s53, s53, s22
    v_accvgpr_read_b32 v40, a64
    v_accvgpr_read_b32 v41, a65
    v_accvgpr_read_b32 v42, a66
    v_accvgpr_read_b32 v43, a67
    v_accvgpr_read_b32 v44, a68
    v_accvgpr_read_b32 v45, a69
    v_accvgpr_read_b32 v46, a70
    v_accvgpr_read_b32 v47, a71
    v_mul_f32 v40, 0x3e0293ee, v40
    v_mul_f32 v41, 0x3e0293ee, v41
    v_mul_f32 v42, 0x3e0293ee, v42
    v_mul_f32 v43, 0x3e0293ee, v43
    v_mul_f32 v44, 0x3e0293ee, v44
    v_mul_f32 v45, 0x3e0293ee, v45
    v_mul_f32 v46, 0x3e0293ee, v46
    v_mul_f32 v47, 0x3e0293ee, v47
    v_cvt_pk_bf16_f32 v56, v40, v41
    v_cvt_pk_bf16_f32 v57, v42, v43
    v_cvt_pk_bf16_f32 v58, v44, v45
    v_cvt_pk_bf16_f32 v59, v46, v47
    buffer_store_dwordx4 v[56:59], v251, s[4:7], s53 offen offset:0 sc1
    v_accvgpr_read_b32 v0, a72
    v_accvgpr_read_b32 v1, a73
    v_accvgpr_read_b32 v2, a74
    v_accvgpr_read_b32 v3, a75
    v_accvgpr_read_b32 v4, a76
    v_accvgpr_read_b32 v5, a77
    v_accvgpr_read_b32 v6, a78
    v_accvgpr_read_b32 v7, a79
    v_mul_f32 v0, 0x3e0293ee, v0
    v_mul_f32 v1, 0x3e0293ee, v1
    v_mul_f32 v2, 0x3e0293ee, v2
    v_mul_f32 v3, 0x3e0293ee, v3
    v_mul_f32 v4, 0x3e0293ee, v4
    v_mul_f32 v5, 0x3e0293ee, v5
    v_mul_f32 v6, 0x3e0293ee, v6
    v_mul_f32 v7, 0x3e0293ee, v7
    v_cvt_pk_bf16_f32 v16, v0, v1
    v_cvt_pk_bf16_f32 v17, v2, v3
    v_cvt_pk_bf16_f32 v18, v4, v5
    v_cvt_pk_bf16_f32 v19, v6, v7
    buffer_store_dwordx4 v[16:19], v251, s[4:7], s53 offen offset:1024 sc1
    v_accvgpr_read_b32 v20, a80
    v_accvgpr_read_b32 v21, a81
    v_accvgpr_read_b32 v22, a82
    v_accvgpr_read_b32 v23, a83
    v_accvgpr_read_b32 v24, a84
    v_accvgpr_read_b32 v25, a85
    v_accvgpr_read_b32 v26, a86
    v_accvgpr_read_b32 v27, a87
    v_mul_f32 v20, 0x3e0293ee, v20
    v_mul_f32 v21, 0x3e0293ee, v21
    v_mul_f32 v22, 0x3e0293ee, v22
    v_mul_f32 v23, 0x3e0293ee, v23
    v_mul_f32 v24, 0x3e0293ee, v24
    v_mul_f32 v25, 0x3e0293ee, v25
    v_mul_f32 v26, 0x3e0293ee, v26
    v_mul_f32 v27, 0x3e0293ee, v27
    v_cvt_pk_bf16_f32 v36, v20, v21
    v_cvt_pk_bf16_f32 v37, v22, v23
    v_cvt_pk_bf16_f32 v38, v24, v25
    v_cvt_pk_bf16_f32 v39, v26, v27
    buffer_store_dwordx4 v[36:39], v251, s[4:7], s53 offen offset:2048 sc1
    v_accvgpr_read_b32 v40, a88
    v_accvgpr_read_b32 v41, a89
    v_accvgpr_read_b32 v42, a90
    v_accvgpr_read_b32 v43, a91
    v_accvgpr_read_b32 v44, a92
    v_accvgpr_read_b32 v45, a93
    v_accvgpr_read_b32 v46, a94
    v_accvgpr_read_b32 v47, a95
    v_mul_f32 v40, 0x3e0293ee, v40
    v_mul_f32 v41, 0x3e0293ee, v41
    v_mul_f32 v42, 0x3e0293ee, v42
    v_mul_f32 v43, 0x3e0293ee, v43
    v_mul_f32 v44, 0x3e0293ee, v44
    v_mul_f32 v45, 0x3e0293ee, v45
    v_mul_f32 v46, 0x3e0293ee, v46
    v_mul_f32 v47, 0x3e0293ee, v47
    v_cvt_pk_bf16_f32 v56, v40, v41
    v_cvt_pk_bf16_f32 v57, v42, v43
    v_cvt_pk_bf16_f32 v58, v44, v45
    v_cvt_pk_bf16_f32 v59, v46, v47
    buffer_store_dwordx4 v[56:59], v251, s[4:7], s53 offen offset:3072 sc1
    s_add_u32 s53, s53, s22
    v_accvgpr_read_b32 v0, a96
    v_accvgpr_read_b32 v1, a97
    v_accvgpr_read_b32 v2, a98
    v_accvgpr_read_b32 v3, a99
    v_accvgpr_read_b32 v4, a100
    v_accvgpr_read_b32 v5, a101
    v_accvgpr_read_b32 v6, a102
    v_accvgpr_read_b32 v7, a103
    v_mul_f32 v0, 0x3e0293ee, v0
    v_mul_f32 v1, 0x3e0293ee, v1
    v_mul_f32 v2, 0x3e0293ee, v2
    v_mul_f32 v3, 0x3e0293ee, v3
    v_mul_f32 v4, 0x3e0293ee, v4
    v_mul_f32 v5, 0x3e0293ee, v5
    v_mul_f32 v6, 0x3e0293ee, v6
    v_mul_f32 v7, 0x3e0293ee, v7
    v_cvt_pk_bf16_f32 v16, v0, v1
    v_cvt_pk_bf16_f32 v17, v2, v3
    v_cvt_pk_bf16_f32 v18, v4, v5
    v_cvt_pk_bf16_f32 v19, v6, v7
    buffer_store_dwordx4 v[16:19], v251, s[4:7], s53 offen offset:0 sc1
    v_accvgpr_read_b32 v20, a104
    v_accvgpr_read_b32 v21, a105
    v_accvgpr_read_b32 v22, a106
    v_accvgpr_read_b32 v23, a107
    v_accvgpr_read_b32 v24, a108
    v_accvgpr_read_b32 v25, a109
    v_accvgpr_read_b32 v26, a110
    v_accvgpr_read_b32 v27, a111
    v_mul_f32 v20, 0x3e0293ee, v20
    v_mul_f32 v21, 0x3e0293ee, v21
    v_mul_f32 v22, 0x3e0293ee, v22
    v_mul_f32 v23, 0x3e0293ee, v23
    v_mul_f32 v24, 0x3e0293ee, v24
    v_mul_f32 v25, 0x3e0293ee, v25
    v_mul_f32 v26, 0x3e0293ee, v26
    v_mul_f32 v27, 0x3e0293ee, v27
    v_cvt_pk_bf16_f32 v36, v20, v21
    v_cvt_pk_bf16_f32 v37, v22, v23
    v_cvt_pk_bf16_f32 v38, v24, v25
    v_cvt_pk_bf16_f32 v39, v26, v27
    buffer_store_dwordx4 v[36:39], v251, s[4:7], s53 offen offset:1024 sc1
    v_accvgpr_read_b32 v40, a112
    v_accvgpr_read_b32 v41, a113
    v_accvgpr_read_b32 v42, a114
    v_accvgpr_read_b32 v43, a115
    v_accvgpr_read_b32 v44, a116
    v_accvgpr_read_b32 v45, a117
    v_accvgpr_read_b32 v46, a118
    v_accvgpr_read_b32 v47, a119
    v_mul_f32 v40, 0x3e0293ee, v40
    v_mul_f32 v41, 0x3e0293ee, v41
    v_mul_f32 v42, 0x3e0293ee, v42
    v_mul_f32 v43, 0x3e0293ee, v43
    v_mul_f32 v44, 0x3e0293ee, v44
    v_mul_f32 v45, 0x3e0293ee, v45
    v_mul_f32 v46, 0x3e0293ee, v46
    v_mul_f32 v47, 0x3e0293ee, v47
    v_cvt_pk_bf16_f32 v56, v40, v41
    v_cvt_pk_bf16_f32 v57, v42, v43
    v_cvt_pk_bf16_f32 v58, v44, v45
    v_cvt_pk_bf16_f32 v59, v46, v47
    buffer_store_dwordx4 v[56:59], v251, s[4:7], s53 offen offset:2048 sc1
    v_accvgpr_read_b32 v0, a120
    v_accvgpr_read_b32 v1, a121
    v_accvgpr_read_b32 v2, a122
    v_accvgpr_read_b32 v3, a123
    v_accvgpr_read_b32 v4, a124
    v_accvgpr_read_b32 v5, a125
    v_accvgpr_read_b32 v6, a126
    v_accvgpr_read_b32 v7, a127
    v_mul_f32 v0, 0x3e0293ee, v0
    v_mul_f32 v1, 0x3e0293ee, v1
    v_mul_f32 v2, 0x3e0293ee, v2
    v_mul_f32 v3, 0x3e0293ee, v3
    v_mul_f32 v4, 0x3e0293ee, v4
    v_mul_f32 v5, 0x3e0293ee, v5
    v_mul_f32 v6, 0x3e0293ee, v6
    v_mul_f32 v7, 0x3e0293ee, v7
    v_cvt_pk_bf16_f32 v16, v0, v1
    v_cvt_pk_bf16_f32 v17, v2, v3
    v_cvt_pk_bf16_f32 v18, v4, v5
    v_cvt_pk_bf16_f32 v19, v6, v7
    buffer_store_dwordx4 v[16:19], v251, s[4:7], s53 offen offset:3072 sc1
    s_branch main_kernel_w_done
main_kernel_w_c1_egelus:
    s_mov_b32 s53, s21
    v_accvgpr_read_b32 v0, a0
    v_accvgpr_read_b32 v1, a1
    v_accvgpr_read_b32 v2, a2
    v_accvgpr_read_b32 v3, a3
    v_accvgpr_read_b32 v4, a4
    v_accvgpr_read_b32 v5, a5
    v_accvgpr_read_b32 v6, a6
    v_accvgpr_read_b32 v7, a7
    v_pk_mul_f32 v[8:9], v[0:1], v[0:1]
    v_pk_mul_f32 v[10:11], v[2:3], v[2:3]
    v_pk_mul_f32 v[12:13], v[4:5], v[4:5]
    v_pk_mul_f32 v[14:15], v[6:7], v[6:7]
    v_pk_fma_f32 v[8:9], v[8:9], v[242:243], v[240:241]
    v_pk_fma_f32 v[10:11], v[10:11], v[242:243], v[240:241]
    v_pk_fma_f32 v[12:13], v[12:13], v[242:243], v[240:241]
    v_pk_fma_f32 v[14:15], v[14:15], v[242:243], v[240:241]
    v_pk_mul_f32 v[8:9], v[8:9], v[0:1]
    v_pk_mul_f32 v[10:11], v[10:11], v[2:3]
    v_pk_mul_f32 v[12:13], v[12:13], v[4:5]
    v_pk_mul_f32 v[14:15], v[14:15], v[6:7]
    v_exp_f32 v8, v8
    v_exp_f32 v9, v9
    v_exp_f32 v10, v10
    v_exp_f32 v11, v11
    v_exp_f32 v12, v12
    v_exp_f32 v13, v13
    v_exp_f32 v14, v14
    v_exp_f32 v15, v15
    v_pk_add_f32 v[8:9], v[8:9], v[244:245]
    v_pk_add_f32 v[10:11], v[10:11], v[244:245]
    v_pk_add_f32 v[12:13], v[12:13], v[244:245]
    v_pk_add_f32 v[14:15], v[14:15], v[244:245]
    v_rcp_f32 v8, v8
    v_rcp_f32 v9, v9
    v_rcp_f32 v10, v10
    v_rcp_f32 v11, v11
    v_rcp_f32 v12, v12
    v_rcp_f32 v13, v13
    v_rcp_f32 v14, v14
    v_rcp_f32 v15, v15
    v_pk_mul_f32 v[0:1], v[8:9], v[0:1]
    v_pk_mul_f32 v[2:3], v[10:11], v[2:3]
    v_pk_mul_f32 v[4:5], v[12:13], v[4:5]
    v_pk_mul_f32 v[6:7], v[14:15], v[6:7]
    v_cvt_pk_bf16_f32 v16, v0, v1
    v_cvt_pk_bf16_f32 v17, v2, v3
    v_cvt_pk_bf16_f32 v18, v4, v5
    v_cvt_pk_bf16_f32 v19, v6, v7
    buffer_store_dwordx4 v[16:19], v252, s[4:7], s53 offen offset:0 sc1
    v_accvgpr_read_b32 v20, a8
    v_accvgpr_read_b32 v21, a9
    v_accvgpr_read_b32 v22, a10
    v_accvgpr_read_b32 v23, a11
    v_accvgpr_read_b32 v24, a12
    v_accvgpr_read_b32 v25, a13
    v_accvgpr_read_b32 v26, a14
    v_accvgpr_read_b32 v27, a15
    v_pk_mul_f32 v[28:29], v[20:21], v[20:21]
    v_pk_mul_f32 v[30:31], v[22:23], v[22:23]
    v_pk_mul_f32 v[32:33], v[24:25], v[24:25]
    v_pk_mul_f32 v[34:35], v[26:27], v[26:27]
    v_pk_fma_f32 v[28:29], v[28:29], v[242:243], v[240:241]
    v_pk_fma_f32 v[30:31], v[30:31], v[242:243], v[240:241]
    v_pk_fma_f32 v[32:33], v[32:33], v[242:243], v[240:241]
    v_pk_fma_f32 v[34:35], v[34:35], v[242:243], v[240:241]
    v_pk_mul_f32 v[28:29], v[28:29], v[20:21]
    v_pk_mul_f32 v[30:31], v[30:31], v[22:23]
    v_pk_mul_f32 v[32:33], v[32:33], v[24:25]
    v_pk_mul_f32 v[34:35], v[34:35], v[26:27]
    v_exp_f32 v28, v28
    v_exp_f32 v29, v29
    v_exp_f32 v30, v30
    v_exp_f32 v31, v31
    v_exp_f32 v32, v32
    v_exp_f32 v33, v33
    v_exp_f32 v34, v34
    v_exp_f32 v35, v35
    v_pk_add_f32 v[28:29], v[28:29], v[244:245]
    v_pk_add_f32 v[30:31], v[30:31], v[244:245]
    v_pk_add_f32 v[32:33], v[32:33], v[244:245]
    v_pk_add_f32 v[34:35], v[34:35], v[244:245]
    v_rcp_f32 v28, v28
    v_rcp_f32 v29, v29
    v_rcp_f32 v30, v30
    v_rcp_f32 v31, v31
    v_rcp_f32 v32, v32
    v_rcp_f32 v33, v33
    v_rcp_f32 v34, v34
    v_rcp_f32 v35, v35
    v_pk_mul_f32 v[20:21], v[28:29], v[20:21]
    v_pk_mul_f32 v[22:23], v[30:31], v[22:23]
    v_pk_mul_f32 v[24:25], v[32:33], v[24:25]
    v_pk_mul_f32 v[26:27], v[34:35], v[26:27]
    v_cvt_pk_bf16_f32 v36, v20, v21
    v_cvt_pk_bf16_f32 v37, v22, v23
    v_cvt_pk_bf16_f32 v38, v24, v25
    v_cvt_pk_bf16_f32 v39, v26, v27
    buffer_store_dwordx4 v[36:39], v252, s[4:7], s53 offen offset:1024 sc1
    v_accvgpr_read_b32 v40, a16
    v_accvgpr_read_b32 v41, a17
    v_accvgpr_read_b32 v42, a18
    v_accvgpr_read_b32 v43, a19
    v_accvgpr_read_b32 v44, a20
    v_accvgpr_read_b32 v45, a21
    v_accvgpr_read_b32 v46, a22
    v_accvgpr_read_b32 v47, a23
    v_pk_mul_f32 v[48:49], v[40:41], v[40:41]
    v_pk_mul_f32 v[50:51], v[42:43], v[42:43]
    v_pk_mul_f32 v[52:53], v[44:45], v[44:45]
    v_pk_mul_f32 v[54:55], v[46:47], v[46:47]
    v_pk_fma_f32 v[48:49], v[48:49], v[242:243], v[240:241]
    v_pk_fma_f32 v[50:51], v[50:51], v[242:243], v[240:241]
    v_pk_fma_f32 v[52:53], v[52:53], v[242:243], v[240:241]
    v_pk_fma_f32 v[54:55], v[54:55], v[242:243], v[240:241]
    v_pk_mul_f32 v[48:49], v[48:49], v[40:41]
    v_pk_mul_f32 v[50:51], v[50:51], v[42:43]
    v_pk_mul_f32 v[52:53], v[52:53], v[44:45]
    v_pk_mul_f32 v[54:55], v[54:55], v[46:47]
    v_exp_f32 v48, v48
    v_exp_f32 v49, v49
    v_exp_f32 v50, v50
    v_exp_f32 v51, v51
    v_exp_f32 v52, v52
    v_exp_f32 v53, v53
    v_exp_f32 v54, v54
    v_exp_f32 v55, v55
    v_pk_add_f32 v[48:49], v[48:49], v[244:245]
    v_pk_add_f32 v[50:51], v[50:51], v[244:245]
    v_pk_add_f32 v[52:53], v[52:53], v[244:245]
    v_pk_add_f32 v[54:55], v[54:55], v[244:245]
    v_rcp_f32 v48, v48
    v_rcp_f32 v49, v49
    v_rcp_f32 v50, v50
    v_rcp_f32 v51, v51
    v_rcp_f32 v52, v52
    v_rcp_f32 v53, v53
    v_rcp_f32 v54, v54
    v_rcp_f32 v55, v55
    v_pk_mul_f32 v[40:41], v[48:49], v[40:41]
    v_pk_mul_f32 v[42:43], v[50:51], v[42:43]
    v_pk_mul_f32 v[44:45], v[52:53], v[44:45]
    v_pk_mul_f32 v[46:47], v[54:55], v[46:47]
    v_cvt_pk_bf16_f32 v56, v40, v41
    v_cvt_pk_bf16_f32 v57, v42, v43
    v_cvt_pk_bf16_f32 v58, v44, v45
    v_cvt_pk_bf16_f32 v59, v46, v47
    buffer_store_dwordx4 v[56:59], v252, s[4:7], s53 offen offset:2048 sc1
    v_accvgpr_read_b32 v0, a24
    v_accvgpr_read_b32 v1, a25
    v_accvgpr_read_b32 v2, a26
    v_accvgpr_read_b32 v3, a27
    v_accvgpr_read_b32 v4, a28
    v_accvgpr_read_b32 v5, a29
    v_accvgpr_read_b32 v6, a30
    v_accvgpr_read_b32 v7, a31
    v_pk_mul_f32 v[8:9], v[0:1], v[0:1]
    v_pk_mul_f32 v[10:11], v[2:3], v[2:3]
    v_pk_mul_f32 v[12:13], v[4:5], v[4:5]
    v_pk_mul_f32 v[14:15], v[6:7], v[6:7]
    v_pk_fma_f32 v[8:9], v[8:9], v[242:243], v[240:241]
    v_pk_fma_f32 v[10:11], v[10:11], v[242:243], v[240:241]
    v_pk_fma_f32 v[12:13], v[12:13], v[242:243], v[240:241]
    v_pk_fma_f32 v[14:15], v[14:15], v[242:243], v[240:241]
    v_pk_mul_f32 v[8:9], v[8:9], v[0:1]
    v_pk_mul_f32 v[10:11], v[10:11], v[2:3]
    v_pk_mul_f32 v[12:13], v[12:13], v[4:5]
    v_pk_mul_f32 v[14:15], v[14:15], v[6:7]
    v_exp_f32 v8, v8
    v_exp_f32 v9, v9
    v_exp_f32 v10, v10
    v_exp_f32 v11, v11
    v_exp_f32 v12, v12
    v_exp_f32 v13, v13
    v_exp_f32 v14, v14
    v_exp_f32 v15, v15
    v_pk_add_f32 v[8:9], v[8:9], v[244:245]
    v_pk_add_f32 v[10:11], v[10:11], v[244:245]
    v_pk_add_f32 v[12:13], v[12:13], v[244:245]
    v_pk_add_f32 v[14:15], v[14:15], v[244:245]
    v_rcp_f32 v8, v8
    v_rcp_f32 v9, v9
    v_rcp_f32 v10, v10
    v_rcp_f32 v11, v11
    v_rcp_f32 v12, v12
    v_rcp_f32 v13, v13
    v_rcp_f32 v14, v14
    v_rcp_f32 v15, v15
    v_pk_mul_f32 v[0:1], v[8:9], v[0:1]
    v_pk_mul_f32 v[2:3], v[10:11], v[2:3]
    v_pk_mul_f32 v[4:5], v[12:13], v[4:5]
    v_pk_mul_f32 v[6:7], v[14:15], v[6:7]
    v_cvt_pk_bf16_f32 v16, v0, v1
    v_cvt_pk_bf16_f32 v17, v2, v3
    v_cvt_pk_bf16_f32 v18, v4, v5
    v_cvt_pk_bf16_f32 v19, v6, v7
    buffer_store_dwordx4 v[16:19], v252, s[4:7], s53 offen offset:3072 sc1
    s_add_u32 s53, s53, s22
    v_accvgpr_read_b32 v20, a32
    v_accvgpr_read_b32 v21, a33
    v_accvgpr_read_b32 v22, a34
    v_accvgpr_read_b32 v23, a35
    v_accvgpr_read_b32 v24, a36
    v_accvgpr_read_b32 v25, a37
    v_accvgpr_read_b32 v26, a38
    v_accvgpr_read_b32 v27, a39
    v_pk_mul_f32 v[28:29], v[20:21], v[20:21]
    v_pk_mul_f32 v[30:31], v[22:23], v[22:23]
    v_pk_mul_f32 v[32:33], v[24:25], v[24:25]
    v_pk_mul_f32 v[34:35], v[26:27], v[26:27]
    v_pk_fma_f32 v[28:29], v[28:29], v[242:243], v[240:241]
    v_pk_fma_f32 v[30:31], v[30:31], v[242:243], v[240:241]
    v_pk_fma_f32 v[32:33], v[32:33], v[242:243], v[240:241]
    v_pk_fma_f32 v[34:35], v[34:35], v[242:243], v[240:241]
    v_pk_mul_f32 v[28:29], v[28:29], v[20:21]
    v_pk_mul_f32 v[30:31], v[30:31], v[22:23]
    v_pk_mul_f32 v[32:33], v[32:33], v[24:25]
    v_pk_mul_f32 v[34:35], v[34:35], v[26:27]
    v_exp_f32 v28, v28
    v_exp_f32 v29, v29
    v_exp_f32 v30, v30
    v_exp_f32 v31, v31
    v_exp_f32 v32, v32
    v_exp_f32 v33, v33
    v_exp_f32 v34, v34
    v_exp_f32 v35, v35
    v_pk_add_f32 v[28:29], v[28:29], v[244:245]
    v_pk_add_f32 v[30:31], v[30:31], v[244:245]
    v_pk_add_f32 v[32:33], v[32:33], v[244:245]
    v_pk_add_f32 v[34:35], v[34:35], v[244:245]
    v_rcp_f32 v28, v28
    v_rcp_f32 v29, v29
    v_rcp_f32 v30, v30
    v_rcp_f32 v31, v31
    v_rcp_f32 v32, v32
    v_rcp_f32 v33, v33
    v_rcp_f32 v34, v34
    v_rcp_f32 v35, v35
    v_pk_mul_f32 v[20:21], v[28:29], v[20:21]
    v_pk_mul_f32 v[22:23], v[30:31], v[22:23]
    v_pk_mul_f32 v[24:25], v[32:33], v[24:25]
    v_pk_mul_f32 v[26:27], v[34:35], v[26:27]
    v_cvt_pk_bf16_f32 v36, v20, v21
    v_cvt_pk_bf16_f32 v37, v22, v23
    v_cvt_pk_bf16_f32 v38, v24, v25
    v_cvt_pk_bf16_f32 v39, v26, v27
    buffer_store_dwordx4 v[36:39], v252, s[4:7], s53 offen offset:0 sc1
    v_accvgpr_read_b32 v40, a40
    v_accvgpr_read_b32 v41, a41
    v_accvgpr_read_b32 v42, a42
    v_accvgpr_read_b32 v43, a43
    v_accvgpr_read_b32 v44, a44
    v_accvgpr_read_b32 v45, a45
    v_accvgpr_read_b32 v46, a46
    v_accvgpr_read_b32 v47, a47
    v_pk_mul_f32 v[48:49], v[40:41], v[40:41]
    v_pk_mul_f32 v[50:51], v[42:43], v[42:43]
    v_pk_mul_f32 v[52:53], v[44:45], v[44:45]
    v_pk_mul_f32 v[54:55], v[46:47], v[46:47]
    v_pk_fma_f32 v[48:49], v[48:49], v[242:243], v[240:241]
    v_pk_fma_f32 v[50:51], v[50:51], v[242:243], v[240:241]
    v_pk_fma_f32 v[52:53], v[52:53], v[242:243], v[240:241]
    v_pk_fma_f32 v[54:55], v[54:55], v[242:243], v[240:241]
    v_pk_mul_f32 v[48:49], v[48:49], v[40:41]
    v_pk_mul_f32 v[50:51], v[50:51], v[42:43]
    v_pk_mul_f32 v[52:53], v[52:53], v[44:45]
    v_pk_mul_f32 v[54:55], v[54:55], v[46:47]
    v_exp_f32 v48, v48
    v_exp_f32 v49, v49
    v_exp_f32 v50, v50
    v_exp_f32 v51, v51
    v_exp_f32 v52, v52
    v_exp_f32 v53, v53
    v_exp_f32 v54, v54
    v_exp_f32 v55, v55
    v_pk_add_f32 v[48:49], v[48:49], v[244:245]
    v_pk_add_f32 v[50:51], v[50:51], v[244:245]
    v_pk_add_f32 v[52:53], v[52:53], v[244:245]
    v_pk_add_f32 v[54:55], v[54:55], v[244:245]
    v_rcp_f32 v48, v48
    v_rcp_f32 v49, v49
    v_rcp_f32 v50, v50
    v_rcp_f32 v51, v51
    v_rcp_f32 v52, v52
    v_rcp_f32 v53, v53
    v_rcp_f32 v54, v54
    v_rcp_f32 v55, v55
    v_pk_mul_f32 v[40:41], v[48:49], v[40:41]
    v_pk_mul_f32 v[42:43], v[50:51], v[42:43]
    v_pk_mul_f32 v[44:45], v[52:53], v[44:45]
    v_pk_mul_f32 v[46:47], v[54:55], v[46:47]
    v_cvt_pk_bf16_f32 v56, v40, v41
    v_cvt_pk_bf16_f32 v57, v42, v43
    v_cvt_pk_bf16_f32 v58, v44, v45
    v_cvt_pk_bf16_f32 v59, v46, v47
    buffer_store_dwordx4 v[56:59], v252, s[4:7], s53 offen offset:1024 sc1
    v_accvgpr_read_b32 v0, a48
    v_accvgpr_read_b32 v1, a49
    v_accvgpr_read_b32 v2, a50
    v_accvgpr_read_b32 v3, a51
    v_accvgpr_read_b32 v4, a52
    v_accvgpr_read_b32 v5, a53
    v_accvgpr_read_b32 v6, a54
    v_accvgpr_read_b32 v7, a55
    v_pk_mul_f32 v[8:9], v[0:1], v[0:1]
    v_pk_mul_f32 v[10:11], v[2:3], v[2:3]
    v_pk_mul_f32 v[12:13], v[4:5], v[4:5]
    v_pk_mul_f32 v[14:15], v[6:7], v[6:7]
    v_pk_fma_f32 v[8:9], v[8:9], v[242:243], v[240:241]
    v_pk_fma_f32 v[10:11], v[10:11], v[242:243], v[240:241]
    v_pk_fma_f32 v[12:13], v[12:13], v[242:243], v[240:241]
    v_pk_fma_f32 v[14:15], v[14:15], v[242:243], v[240:241]
    v_pk_mul_f32 v[8:9], v[8:9], v[0:1]
    v_pk_mul_f32 v[10:11], v[10:11], v[2:3]
    v_pk_mul_f32 v[12:13], v[12:13], v[4:5]
    v_pk_mul_f32 v[14:15], v[14:15], v[6:7]
    v_exp_f32 v8, v8
    v_exp_f32 v9, v9
    v_exp_f32 v10, v10
    v_exp_f32 v11, v11
    v_exp_f32 v12, v12
    v_exp_f32 v13, v13
    v_exp_f32 v14, v14
    v_exp_f32 v15, v15
    v_pk_add_f32 v[8:9], v[8:9], v[244:245]
    v_pk_add_f32 v[10:11], v[10:11], v[244:245]
    v_pk_add_f32 v[12:13], v[12:13], v[244:245]
    v_pk_add_f32 v[14:15], v[14:15], v[244:245]
    v_rcp_f32 v8, v8
    v_rcp_f32 v9, v9
    v_rcp_f32 v10, v10
    v_rcp_f32 v11, v11
    v_rcp_f32 v12, v12
    v_rcp_f32 v13, v13
    v_rcp_f32 v14, v14
    v_rcp_f32 v15, v15
    v_pk_mul_f32 v[0:1], v[8:9], v[0:1]
    v_pk_mul_f32 v[2:3], v[10:11], v[2:3]
    v_pk_mul_f32 v[4:5], v[12:13], v[4:5]
    v_pk_mul_f32 v[6:7], v[14:15], v[6:7]
    v_cvt_pk_bf16_f32 v16, v0, v1
    v_cvt_pk_bf16_f32 v17, v2, v3
    v_cvt_pk_bf16_f32 v18, v4, v5
    v_cvt_pk_bf16_f32 v19, v6, v7
    buffer_store_dwordx4 v[16:19], v252, s[4:7], s53 offen offset:2048 sc1
    v_accvgpr_read_b32 v20, a56
    v_accvgpr_read_b32 v21, a57
    v_accvgpr_read_b32 v22, a58
    v_accvgpr_read_b32 v23, a59
    v_accvgpr_read_b32 v24, a60
    v_accvgpr_read_b32 v25, a61
    v_accvgpr_read_b32 v26, a62
    v_accvgpr_read_b32 v27, a63
    v_pk_mul_f32 v[28:29], v[20:21], v[20:21]
    v_pk_mul_f32 v[30:31], v[22:23], v[22:23]
    v_pk_mul_f32 v[32:33], v[24:25], v[24:25]
    v_pk_mul_f32 v[34:35], v[26:27], v[26:27]
    v_pk_fma_f32 v[28:29], v[28:29], v[242:243], v[240:241]
    v_pk_fma_f32 v[30:31], v[30:31], v[242:243], v[240:241]
    v_pk_fma_f32 v[32:33], v[32:33], v[242:243], v[240:241]
    v_pk_fma_f32 v[34:35], v[34:35], v[242:243], v[240:241]
    v_pk_mul_f32 v[28:29], v[28:29], v[20:21]
    v_pk_mul_f32 v[30:31], v[30:31], v[22:23]
    v_pk_mul_f32 v[32:33], v[32:33], v[24:25]
    v_pk_mul_f32 v[34:35], v[34:35], v[26:27]
    v_exp_f32 v28, v28
    v_exp_f32 v29, v29
    v_exp_f32 v30, v30
    v_exp_f32 v31, v31
    v_exp_f32 v32, v32
    v_exp_f32 v33, v33
    v_exp_f32 v34, v34
    v_exp_f32 v35, v35
    v_pk_add_f32 v[28:29], v[28:29], v[244:245]
    v_pk_add_f32 v[30:31], v[30:31], v[244:245]
    v_pk_add_f32 v[32:33], v[32:33], v[244:245]
    v_pk_add_f32 v[34:35], v[34:35], v[244:245]
    v_rcp_f32 v28, v28
    v_rcp_f32 v29, v29
    v_rcp_f32 v30, v30
    v_rcp_f32 v31, v31
    v_rcp_f32 v32, v32
    v_rcp_f32 v33, v33
    v_rcp_f32 v34, v34
    v_rcp_f32 v35, v35
    v_pk_mul_f32 v[20:21], v[28:29], v[20:21]
    v_pk_mul_f32 v[22:23], v[30:31], v[22:23]
    v_pk_mul_f32 v[24:25], v[32:33], v[24:25]
    v_pk_mul_f32 v[26:27], v[34:35], v[26:27]
    v_cvt_pk_bf16_f32 v36, v20, v21
    v_cvt_pk_bf16_f32 v37, v22, v23
    v_cvt_pk_bf16_f32 v38, v24, v25
    v_cvt_pk_bf16_f32 v39, v26, v27
    buffer_store_dwordx4 v[36:39], v252, s[4:7], s53 offen offset:3072 sc1
    s_add_u32 s53, s53, s22
    v_accvgpr_read_b32 v40, a64
    v_accvgpr_read_b32 v41, a65
    v_accvgpr_read_b32 v42, a66
    v_accvgpr_read_b32 v43, a67
    v_accvgpr_read_b32 v44, a68
    v_accvgpr_read_b32 v45, a69
    v_accvgpr_read_b32 v46, a70
    v_accvgpr_read_b32 v47, a71
    v_pk_mul_f32 v[48:49], v[40:41], v[40:41]
    v_pk_mul_f32 v[50:51], v[42:43], v[42:43]
    v_pk_mul_f32 v[52:53], v[44:45], v[44:45]
    v_pk_mul_f32 v[54:55], v[46:47], v[46:47]
    v_pk_fma_f32 v[48:49], v[48:49], v[242:243], v[240:241]
    v_pk_fma_f32 v[50:51], v[50:51], v[242:243], v[240:241]
    v_pk_fma_f32 v[52:53], v[52:53], v[242:243], v[240:241]
    v_pk_fma_f32 v[54:55], v[54:55], v[242:243], v[240:241]
    v_pk_mul_f32 v[48:49], v[48:49], v[40:41]
    v_pk_mul_f32 v[50:51], v[50:51], v[42:43]
    v_pk_mul_f32 v[52:53], v[52:53], v[44:45]
    v_pk_mul_f32 v[54:55], v[54:55], v[46:47]
    v_exp_f32 v48, v48
    v_exp_f32 v49, v49
    v_exp_f32 v50, v50
    v_exp_f32 v51, v51
    v_exp_f32 v52, v52
    v_exp_f32 v53, v53
    v_exp_f32 v54, v54
    v_exp_f32 v55, v55
    v_pk_add_f32 v[48:49], v[48:49], v[244:245]
    v_pk_add_f32 v[50:51], v[50:51], v[244:245]
    v_pk_add_f32 v[52:53], v[52:53], v[244:245]
    v_pk_add_f32 v[54:55], v[54:55], v[244:245]
    v_rcp_f32 v48, v48
    v_rcp_f32 v49, v49
    v_rcp_f32 v50, v50
    v_rcp_f32 v51, v51
    v_rcp_f32 v52, v52
    v_rcp_f32 v53, v53
    v_rcp_f32 v54, v54
    v_rcp_f32 v55, v55
    v_pk_mul_f32 v[40:41], v[48:49], v[40:41]
    v_pk_mul_f32 v[42:43], v[50:51], v[42:43]
    v_pk_mul_f32 v[44:45], v[52:53], v[44:45]
    v_pk_mul_f32 v[46:47], v[54:55], v[46:47]
    v_cvt_pk_bf16_f32 v56, v40, v41
    v_cvt_pk_bf16_f32 v57, v42, v43
    v_cvt_pk_bf16_f32 v58, v44, v45
    v_cvt_pk_bf16_f32 v59, v46, v47
    buffer_store_dwordx4 v[56:59], v252, s[4:7], s53 offen offset:0 sc1
    v_accvgpr_read_b32 v0, a72
    v_accvgpr_read_b32 v1, a73
    v_accvgpr_read_b32 v2, a74
    v_accvgpr_read_b32 v3, a75
    v_accvgpr_read_b32 v4, a76
    v_accvgpr_read_b32 v5, a77
    v_accvgpr_read_b32 v6, a78
    v_accvgpr_read_b32 v7, a79
    v_pk_mul_f32 v[8:9], v[0:1], v[0:1]
    v_pk_mul_f32 v[10:11], v[2:3], v[2:3]
    v_pk_mul_f32 v[12:13], v[4:5], v[4:5]
    v_pk_mul_f32 v[14:15], v[6:7], v[6:7]
    v_pk_fma_f32 v[8:9], v[8:9], v[242:243], v[240:241]
    v_pk_fma_f32 v[10:11], v[10:11], v[242:243], v[240:241]
    v_pk_fma_f32 v[12:13], v[12:13], v[242:243], v[240:241]
    v_pk_fma_f32 v[14:15], v[14:15], v[242:243], v[240:241]
    v_pk_mul_f32 v[8:9], v[8:9], v[0:1]
    v_pk_mul_f32 v[10:11], v[10:11], v[2:3]
    v_pk_mul_f32 v[12:13], v[12:13], v[4:5]
    v_pk_mul_f32 v[14:15], v[14:15], v[6:7]
    v_exp_f32 v8, v8
    v_exp_f32 v9, v9
    v_exp_f32 v10, v10
    v_exp_f32 v11, v11
    v_exp_f32 v12, v12
    v_exp_f32 v13, v13
    v_exp_f32 v14, v14
    v_exp_f32 v15, v15
    v_pk_add_f32 v[8:9], v[8:9], v[244:245]
    v_pk_add_f32 v[10:11], v[10:11], v[244:245]
    v_pk_add_f32 v[12:13], v[12:13], v[244:245]
    v_pk_add_f32 v[14:15], v[14:15], v[244:245]
    v_rcp_f32 v8, v8
    v_rcp_f32 v9, v9
    v_rcp_f32 v10, v10
    v_rcp_f32 v11, v11
    v_rcp_f32 v12, v12
    v_rcp_f32 v13, v13
    v_rcp_f32 v14, v14
    v_rcp_f32 v15, v15
    v_pk_mul_f32 v[0:1], v[8:9], v[0:1]
    v_pk_mul_f32 v[2:3], v[10:11], v[2:3]
    v_pk_mul_f32 v[4:5], v[12:13], v[4:5]
    v_pk_mul_f32 v[6:7], v[14:15], v[6:7]
    v_cvt_pk_bf16_f32 v16, v0, v1
    v_cvt_pk_bf16_f32 v17, v2, v3
    v_cvt_pk_bf16_f32 v18, v4, v5
    v_cvt_pk_bf16_f32 v19, v6, v7
    buffer_store_dwordx4 v[16:19], v252, s[4:7], s53 offen offset:1024 sc1
    v_accvgpr_read_b32 v20, a80
    v_accvgpr_read_b32 v21, a81
    v_accvgpr_read_b32 v22, a82
    v_accvgpr_read_b32 v23, a83
    v_accvgpr_read_b32 v24, a84
    v_accvgpr_read_b32 v25, a85
    v_accvgpr_read_b32 v26, a86
    v_accvgpr_read_b32 v27, a87
    v_pk_mul_f32 v[28:29], v[20:21], v[20:21]
    v_pk_mul_f32 v[30:31], v[22:23], v[22:23]
    v_pk_mul_f32 v[32:33], v[24:25], v[24:25]
    v_pk_mul_f32 v[34:35], v[26:27], v[26:27]
    v_pk_fma_f32 v[28:29], v[28:29], v[242:243], v[240:241]
    v_pk_fma_f32 v[30:31], v[30:31], v[242:243], v[240:241]
    v_pk_fma_f32 v[32:33], v[32:33], v[242:243], v[240:241]
    v_pk_fma_f32 v[34:35], v[34:35], v[242:243], v[240:241]
    v_pk_mul_f32 v[28:29], v[28:29], v[20:21]
    v_pk_mul_f32 v[30:31], v[30:31], v[22:23]
    v_pk_mul_f32 v[32:33], v[32:33], v[24:25]
    v_pk_mul_f32 v[34:35], v[34:35], v[26:27]
    v_exp_f32 v28, v28
    v_exp_f32 v29, v29
    v_exp_f32 v30, v30
    v_exp_f32 v31, v31
    v_exp_f32 v32, v32
    v_exp_f32 v33, v33
    v_exp_f32 v34, v34
    v_exp_f32 v35, v35
    v_pk_add_f32 v[28:29], v[28:29], v[244:245]
    v_pk_add_f32 v[30:31], v[30:31], v[244:245]
    v_pk_add_f32 v[32:33], v[32:33], v[244:245]
    v_pk_add_f32 v[34:35], v[34:35], v[244:245]
    v_rcp_f32 v28, v28
    v_rcp_f32 v29, v29
    v_rcp_f32 v30, v30
    v_rcp_f32 v31, v31
    v_rcp_f32 v32, v32
    v_rcp_f32 v33, v33
    v_rcp_f32 v34, v34
    v_rcp_f32 v35, v35
    v_pk_mul_f32 v[20:21], v[28:29], v[20:21]
    v_pk_mul_f32 v[22:23], v[30:31], v[22:23]
    v_pk_mul_f32 v[24:25], v[32:33], v[24:25]
    v_pk_mul_f32 v[26:27], v[34:35], v[26:27]
    v_cvt_pk_bf16_f32 v36, v20, v21
    v_cvt_pk_bf16_f32 v37, v22, v23
    v_cvt_pk_bf16_f32 v38, v24, v25
    v_cvt_pk_bf16_f32 v39, v26, v27
    buffer_store_dwordx4 v[36:39], v252, s[4:7], s53 offen offset:2048 sc1
    v_accvgpr_read_b32 v40, a88
    v_accvgpr_read_b32 v41, a89
    v_accvgpr_read_b32 v42, a90
    v_accvgpr_read_b32 v43, a91
    v_accvgpr_read_b32 v44, a92
    v_accvgpr_read_b32 v45, a93
    v_accvgpr_read_b32 v46, a94
    v_accvgpr_read_b32 v47, a95
    v_pk_mul_f32 v[48:49], v[40:41], v[40:41]
    v_pk_mul_f32 v[50:51], v[42:43], v[42:43]
    v_pk_mul_f32 v[52:53], v[44:45], v[44:45]
    v_pk_mul_f32 v[54:55], v[46:47], v[46:47]
    v_pk_fma_f32 v[48:49], v[48:49], v[242:243], v[240:241]
    v_pk_fma_f32 v[50:51], v[50:51], v[242:243], v[240:241]
    v_pk_fma_f32 v[52:53], v[52:53], v[242:243], v[240:241]
    v_pk_fma_f32 v[54:55], v[54:55], v[242:243], v[240:241]
    v_pk_mul_f32 v[48:49], v[48:49], v[40:41]
    v_pk_mul_f32 v[50:51], v[50:51], v[42:43]
    v_pk_mul_f32 v[52:53], v[52:53], v[44:45]
    v_pk_mul_f32 v[54:55], v[54:55], v[46:47]
    v_exp_f32 v48, v48
    v_exp_f32 v49, v49
    v_exp_f32 v50, v50
    v_exp_f32 v51, v51
    v_exp_f32 v52, v52
    v_exp_f32 v53, v53
    v_exp_f32 v54, v54
    v_exp_f32 v55, v55
    v_pk_add_f32 v[48:49], v[48:49], v[244:245]
    v_pk_add_f32 v[50:51], v[50:51], v[244:245]
    v_pk_add_f32 v[52:53], v[52:53], v[244:245]
    v_pk_add_f32 v[54:55], v[54:55], v[244:245]
    v_rcp_f32 v48, v48
    v_rcp_f32 v49, v49
    v_rcp_f32 v50, v50
    v_rcp_f32 v51, v51
    v_rcp_f32 v52, v52
    v_rcp_f32 v53, v53
    v_rcp_f32 v54, v54
    v_rcp_f32 v55, v55
    v_pk_mul_f32 v[40:41], v[48:49], v[40:41]
    v_pk_mul_f32 v[42:43], v[50:51], v[42:43]
    v_pk_mul_f32 v[44:45], v[52:53], v[44:45]
    v_pk_mul_f32 v[46:47], v[54:55], v[46:47]
    v_cvt_pk_bf16_f32 v56, v40, v41
    v_cvt_pk_bf16_f32 v57, v42, v43
    v_cvt_pk_bf16_f32 v58, v44, v45
    v_cvt_pk_bf16_f32 v59, v46, v47
    buffer_store_dwordx4 v[56:59], v252, s[4:7], s53 offen offset:3072 sc1
    s_add_u32 s53, s53, s22
    v_accvgpr_read_b32 v0, a96
    v_accvgpr_read_b32 v1, a97
    v_accvgpr_read_b32 v2, a98
    v_accvgpr_read_b32 v3, a99
    v_accvgpr_read_b32 v4, a100
    v_accvgpr_read_b32 v5, a101
    v_accvgpr_read_b32 v6, a102
    v_accvgpr_read_b32 v7, a103
    v_pk_mul_f32 v[8:9], v[0:1], v[0:1]
    v_pk_mul_f32 v[10:11], v[2:3], v[2:3]
    v_pk_mul_f32 v[12:13], v[4:5], v[4:5]
    v_pk_mul_f32 v[14:15], v[6:7], v[6:7]
    v_pk_fma_f32 v[8:9], v[8:9], v[242:243], v[240:241]
    v_pk_fma_f32 v[10:11], v[10:11], v[242:243], v[240:241]
    v_pk_fma_f32 v[12:13], v[12:13], v[242:243], v[240:241]
    v_pk_fma_f32 v[14:15], v[14:15], v[242:243], v[240:241]
    v_pk_mul_f32 v[8:9], v[8:9], v[0:1]
    v_pk_mul_f32 v[10:11], v[10:11], v[2:3]
    v_pk_mul_f32 v[12:13], v[12:13], v[4:5]
    v_pk_mul_f32 v[14:15], v[14:15], v[6:7]
    v_exp_f32 v8, v8
    v_exp_f32 v9, v9
    v_exp_f32 v10, v10
    v_exp_f32 v11, v11
    v_exp_f32 v12, v12
    v_exp_f32 v13, v13
    v_exp_f32 v14, v14
    v_exp_f32 v15, v15
    v_pk_add_f32 v[8:9], v[8:9], v[244:245]
    v_pk_add_f32 v[10:11], v[10:11], v[244:245]
    v_pk_add_f32 v[12:13], v[12:13], v[244:245]
    v_pk_add_f32 v[14:15], v[14:15], v[244:245]
    v_rcp_f32 v8, v8
    v_rcp_f32 v9, v9
    v_rcp_f32 v10, v10
    v_rcp_f32 v11, v11
    v_rcp_f32 v12, v12
    v_rcp_f32 v13, v13
    v_rcp_f32 v14, v14
    v_rcp_f32 v15, v15
    v_pk_mul_f32 v[0:1], v[8:9], v[0:1]
    v_pk_mul_f32 v[2:3], v[10:11], v[2:3]
    v_pk_mul_f32 v[4:5], v[12:13], v[4:5]
    v_pk_mul_f32 v[6:7], v[14:15], v[6:7]
    v_cvt_pk_bf16_f32 v16, v0, v1
    v_cvt_pk_bf16_f32 v17, v2, v3
    v_cvt_pk_bf16_f32 v18, v4, v5
    v_cvt_pk_bf16_f32 v19, v6, v7
    buffer_store_dwordx4 v[16:19], v252, s[4:7], s53 offen offset:0 sc1
    v_accvgpr_read_b32 v20, a104
    v_accvgpr_read_b32 v21, a105
    v_accvgpr_read_b32 v22, a106
    v_accvgpr_read_b32 v23, a107
    v_accvgpr_read_b32 v24, a108
    v_accvgpr_read_b32 v25, a109
    v_accvgpr_read_b32 v26, a110
    v_accvgpr_read_b32 v27, a111
    v_pk_mul_f32 v[28:29], v[20:21], v[20:21]
    v_pk_mul_f32 v[30:31], v[22:23], v[22:23]
    v_pk_mul_f32 v[32:33], v[24:25], v[24:25]
    v_pk_mul_f32 v[34:35], v[26:27], v[26:27]
    v_pk_fma_f32 v[28:29], v[28:29], v[242:243], v[240:241]
    v_pk_fma_f32 v[30:31], v[30:31], v[242:243], v[240:241]
    v_pk_fma_f32 v[32:33], v[32:33], v[242:243], v[240:241]
    v_pk_fma_f32 v[34:35], v[34:35], v[242:243], v[240:241]
    v_pk_mul_f32 v[28:29], v[28:29], v[20:21]
    v_pk_mul_f32 v[30:31], v[30:31], v[22:23]
    v_pk_mul_f32 v[32:33], v[32:33], v[24:25]
    v_pk_mul_f32 v[34:35], v[34:35], v[26:27]
    v_exp_f32 v28, v28
    v_exp_f32 v29, v29
    v_exp_f32 v30, v30
    v_exp_f32 v31, v31
    v_exp_f32 v32, v32
    v_exp_f32 v33, v33
    v_exp_f32 v34, v34
    v_exp_f32 v35, v35
    v_pk_add_f32 v[28:29], v[28:29], v[244:245]
    v_pk_add_f32 v[30:31], v[30:31], v[244:245]
    v_pk_add_f32 v[32:33], v[32:33], v[244:245]
    v_pk_add_f32 v[34:35], v[34:35], v[244:245]
    v_rcp_f32 v28, v28
    v_rcp_f32 v29, v29
    v_rcp_f32 v30, v30
    v_rcp_f32 v31, v31
    v_rcp_f32 v32, v32
    v_rcp_f32 v33, v33
    v_rcp_f32 v34, v34
    v_rcp_f32 v35, v35
    v_pk_mul_f32 v[20:21], v[28:29], v[20:21]
    v_pk_mul_f32 v[22:23], v[30:31], v[22:23]
    v_pk_mul_f32 v[24:25], v[32:33], v[24:25]
    v_pk_mul_f32 v[26:27], v[34:35], v[26:27]
    v_cvt_pk_bf16_f32 v36, v20, v21
    v_cvt_pk_bf16_f32 v37, v22, v23
    v_cvt_pk_bf16_f32 v38, v24, v25
    v_cvt_pk_bf16_f32 v39, v26, v27
    buffer_store_dwordx4 v[36:39], v252, s[4:7], s53 offen offset:1024 sc1
    v_accvgpr_read_b32 v40, a112
    v_accvgpr_read_b32 v41, a113
    v_accvgpr_read_b32 v42, a114
    v_accvgpr_read_b32 v43, a115
    v_accvgpr_read_b32 v44, a116
    v_accvgpr_read_b32 v45, a117
    v_accvgpr_read_b32 v46, a118
    v_accvgpr_read_b32 v47, a119
    v_pk_mul_f32 v[48:49], v[40:41], v[40:41]
    v_pk_mul_f32 v[50:51], v[42:43], v[42:43]
    v_pk_mul_f32 v[52:53], v[44:45], v[44:45]
    v_pk_mul_f32 v[54:55], v[46:47], v[46:47]
    v_pk_fma_f32 v[48:49], v[48:49], v[242:243], v[240:241]
    v_pk_fma_f32 v[50:51], v[50:51], v[242:243], v[240:241]
    v_pk_fma_f32 v[52:53], v[52:53], v[242:243], v[240:241]
    v_pk_fma_f32 v[54:55], v[54:55], v[242:243], v[240:241]
    v_pk_mul_f32 v[48:49], v[48:49], v[40:41]
    v_pk_mul_f32 v[50:51], v[50:51], v[42:43]
    v_pk_mul_f32 v[52:53], v[52:53], v[44:45]
    v_pk_mul_f32 v[54:55], v[54:55], v[46:47]
    v_exp_f32 v48, v48
    v_exp_f32 v49, v49
    v_exp_f32 v50, v50
    v_exp_f32 v51, v51
    v_exp_f32 v52, v52
    v_exp_f32 v53, v53
    v_exp_f32 v54, v54
    v_exp_f32 v55, v55
    v_pk_add_f32 v[48:49], v[48:49], v[244:245]
    v_pk_add_f32 v[50:51], v[50:51], v[244:245]
    v_pk_add_f32 v[52:53], v[52:53], v[244:245]
    v_pk_add_f32 v[54:55], v[54:55], v[244:245]
    v_rcp_f32 v48, v48
    v_rcp_f32 v49, v49
    v_rcp_f32 v50, v50
    v_rcp_f32 v51, v51
    v_rcp_f32 v52, v52
    v_rcp_f32 v53, v53
    v_rcp_f32 v54, v54
    v_rcp_f32 v55, v55
    v_pk_mul_f32 v[40:41], v[48:49], v[40:41]
    v_pk_mul_f32 v[42:43], v[50:51], v[42:43]
    v_pk_mul_f32 v[44:45], v[52:53], v[44:45]
    v_pk_mul_f32 v[46:47], v[54:55], v[46:47]
    v_cvt_pk_bf16_f32 v56, v40, v41
    v_cvt_pk_bf16_f32 v57, v42, v43
    v_cvt_pk_bf16_f32 v58, v44, v45
    v_cvt_pk_bf16_f32 v59, v46, v47
    buffer_store_dwordx4 v[56:59], v252, s[4:7], s53 offen offset:2048 sc1
    v_accvgpr_read_b32 v0, a120
    v_accvgpr_read_b32 v1, a121
    v_accvgpr_read_b32 v2, a122
    v_accvgpr_read_b32 v3, a123
    v_accvgpr_read_b32 v4, a124
    v_accvgpr_read_b32 v5, a125
    v_accvgpr_read_b32 v6, a126
    v_accvgpr_read_b32 v7, a127
    v_pk_mul_f32 v[8:9], v[0:1], v[0:1]
    v_pk_mul_f32 v[10:11], v[2:3], v[2:3]
    v_pk_mul_f32 v[12:13], v[4:5], v[4:5]
    v_pk_mul_f32 v[14:15], v[6:7], v[6:7]
    v_pk_fma_f32 v[8:9], v[8:9], v[242:243], v[240:241]
    v_pk_fma_f32 v[10:11], v[10:11], v[242:243], v[240:241]
    v_pk_fma_f32 v[12:13], v[12:13], v[242:243], v[240:241]
    v_pk_fma_f32 v[14:15], v[14:15], v[242:243], v[240:241]
    v_pk_mul_f32 v[8:9], v[8:9], v[0:1]
    v_pk_mul_f32 v[10:11], v[10:11], v[2:3]
    v_pk_mul_f32 v[12:13], v[12:13], v[4:5]
    v_pk_mul_f32 v[14:15], v[14:15], v[6:7]
    v_exp_f32 v8, v8
    v_exp_f32 v9, v9
    v_exp_f32 v10, v10
    v_exp_f32 v11, v11
    v_exp_f32 v12, v12
    v_exp_f32 v13, v13
    v_exp_f32 v14, v14
    v_exp_f32 v15, v15
    v_pk_add_f32 v[8:9], v[8:9], v[244:245]
    v_pk_add_f32 v[10:11], v[10:11], v[244:245]
    v_pk_add_f32 v[12:13], v[12:13], v[244:245]
    v_pk_add_f32 v[14:15], v[14:15], v[244:245]
    v_rcp_f32 v8, v8
    v_rcp_f32 v9, v9
    v_rcp_f32 v10, v10
    v_rcp_f32 v11, v11
    v_rcp_f32 v12, v12
    v_rcp_f32 v13, v13
    v_rcp_f32 v14, v14
    v_rcp_f32 v15, v15
    v_pk_mul_f32 v[0:1], v[8:9], v[0:1]
    v_pk_mul_f32 v[2:3], v[10:11], v[2:3]
    v_pk_mul_f32 v[4:5], v[12:13], v[4:5]
    v_pk_mul_f32 v[6:7], v[14:15], v[6:7]
    v_cvt_pk_bf16_f32 v16, v0, v1
    v_cvt_pk_bf16_f32 v17, v2, v3
    v_cvt_pk_bf16_f32 v18, v4, v5
    v_cvt_pk_bf16_f32 v19, v6, v7
    buffer_store_dwordx4 v[16:19], v252, s[4:7], s53 offen offset:3072 sc1
    s_branch main_kernel_w_done
main_kernel_w_c1_egelu:
    s_mov_b32 s53, s21
    v_accvgpr_read_b32 v0, a0
    v_accvgpr_read_b32 v1, a1
    v_accvgpr_read_b32 v2, a2
    v_accvgpr_read_b32 v3, a3
    v_accvgpr_read_b32 v4, a4
    v_accvgpr_read_b32 v5, a5
    v_accvgpr_read_b32 v6, a6
    v_accvgpr_read_b32 v7, a7
    v_pk_mul_f32 v[8:9], v[0:1], v[0:1]
    v_pk_mul_f32 v[10:11], v[2:3], v[2:3]
    v_pk_mul_f32 v[12:13], v[4:5], v[4:5]
    v_pk_mul_f32 v[14:15], v[6:7], v[6:7]
    v_pk_fma_f32 v[8:9], v[8:9], v[242:243], v[240:241]
    v_pk_fma_f32 v[10:11], v[10:11], v[242:243], v[240:241]
    v_pk_fma_f32 v[12:13], v[12:13], v[242:243], v[240:241]
    v_pk_fma_f32 v[14:15], v[14:15], v[242:243], v[240:241]
    v_pk_mul_f32 v[8:9], v[8:9], v[0:1]
    v_pk_mul_f32 v[10:11], v[10:11], v[2:3]
    v_pk_mul_f32 v[12:13], v[12:13], v[4:5]
    v_pk_mul_f32 v[14:15], v[14:15], v[6:7]
    v_exp_f32 v8, v8
    v_exp_f32 v9, v9
    v_exp_f32 v10, v10
    v_exp_f32 v11, v11
    v_exp_f32 v12, v12
    v_exp_f32 v13, v13
    v_exp_f32 v14, v14
    v_exp_f32 v15, v15
    v_pk_add_f32 v[8:9], v[8:9], v[244:245]
    v_pk_add_f32 v[10:11], v[10:11], v[244:245]
    v_pk_add_f32 v[12:13], v[12:13], v[244:245]
    v_pk_add_f32 v[14:15], v[14:15], v[244:245]
    v_rcp_f32 v8, v8
    v_rcp_f32 v9, v9
    v_rcp_f32 v10, v10
    v_rcp_f32 v11, v11
    v_rcp_f32 v12, v12
    v_rcp_f32 v13, v13
    v_rcp_f32 v14, v14
    v_rcp_f32 v15, v15
    v_pk_mul_f32 v[0:1], v[8:9], v[0:1]
    v_pk_mul_f32 v[2:3], v[10:11], v[2:3]
    v_pk_mul_f32 v[4:5], v[12:13], v[4:5]
    v_pk_mul_f32 v[6:7], v[14:15], v[6:7]
    v_cvt_pk_bf16_f32 v16, v0, v1
    v_cvt_pk_bf16_f32 v17, v2, v3
    v_cvt_pk_bf16_f32 v18, v4, v5
    v_cvt_pk_bf16_f32 v19, v6, v7
    buffer_store_dwordx4 v[16:19], v251, s[4:7], s53 offen offset:0 sc1
    v_accvgpr_read_b32 v20, a8
    v_accvgpr_read_b32 v21, a9
    v_accvgpr_read_b32 v22, a10
    v_accvgpr_read_b32 v23, a11
    v_accvgpr_read_b32 v24, a12
    v_accvgpr_read_b32 v25, a13
    v_accvgpr_read_b32 v26, a14
    v_accvgpr_read_b32 v27, a15
    v_pk_mul_f32 v[28:29], v[20:21], v[20:21]
    v_pk_mul_f32 v[30:31], v[22:23], v[22:23]
    v_pk_mul_f32 v[32:33], v[24:25], v[24:25]
    v_pk_mul_f32 v[34:35], v[26:27], v[26:27]
    v_pk_fma_f32 v[28:29], v[28:29], v[242:243], v[240:241]
    v_pk_fma_f32 v[30:31], v[30:31], v[242:243], v[240:241]
    v_pk_fma_f32 v[32:33], v[32:33], v[242:243], v[240:241]
    v_pk_fma_f32 v[34:35], v[34:35], v[242:243], v[240:241]
    v_pk_mul_f32 v[28:29], v[28:29], v[20:21]
    v_pk_mul_f32 v[30:31], v[30:31], v[22:23]
    v_pk_mul_f32 v[32:33], v[32:33], v[24:25]
    v_pk_mul_f32 v[34:35], v[34:35], v[26:27]
    v_exp_f32 v28, v28
    v_exp_f32 v29, v29
    v_exp_f32 v30, v30
    v_exp_f32 v31, v31
    v_exp_f32 v32, v32
    v_exp_f32 v33, v33
    v_exp_f32 v34, v34
    v_exp_f32 v35, v35
    v_pk_add_f32 v[28:29], v[28:29], v[244:245]
    v_pk_add_f32 v[30:31], v[30:31], v[244:245]
    v_pk_add_f32 v[32:33], v[32:33], v[244:245]
    v_pk_add_f32 v[34:35], v[34:35], v[244:245]
    v_rcp_f32 v28, v28
    v_rcp_f32 v29, v29
    v_rcp_f32 v30, v30
    v_rcp_f32 v31, v31
    v_rcp_f32 v32, v32
    v_rcp_f32 v33, v33
    v_rcp_f32 v34, v34
    v_rcp_f32 v35, v35
    v_pk_mul_f32 v[20:21], v[28:29], v[20:21]
    v_pk_mul_f32 v[22:23], v[30:31], v[22:23]
    v_pk_mul_f32 v[24:25], v[32:33], v[24:25]
    v_pk_mul_f32 v[26:27], v[34:35], v[26:27]
    v_cvt_pk_bf16_f32 v36, v20, v21
    v_cvt_pk_bf16_f32 v37, v22, v23
    v_cvt_pk_bf16_f32 v38, v24, v25
    v_cvt_pk_bf16_f32 v39, v26, v27
    buffer_store_dwordx4 v[36:39], v251, s[4:7], s53 offen offset:1024 sc1
    v_accvgpr_read_b32 v40, a16
    v_accvgpr_read_b32 v41, a17
    v_accvgpr_read_b32 v42, a18
    v_accvgpr_read_b32 v43, a19
    v_accvgpr_read_b32 v44, a20
    v_accvgpr_read_b32 v45, a21
    v_accvgpr_read_b32 v46, a22
    v_accvgpr_read_b32 v47, a23
    v_pk_mul_f32 v[48:49], v[40:41], v[40:41]
    v_pk_mul_f32 v[50:51], v[42:43], v[42:43]
    v_pk_mul_f32 v[52:53], v[44:45], v[44:45]
    v_pk_mul_f32 v[54:55], v[46:47], v[46:47]
    v_pk_fma_f32 v[48:49], v[48:49], v[242:243], v[240:241]
    v_pk_fma_f32 v[50:51], v[50:51], v[242:243], v[240:241]
    v_pk_fma_f32 v[52:53], v[52:53], v[242:243], v[240:241]
    v_pk_fma_f32 v[54:55], v[54:55], v[242:243], v[240:241]
    v_pk_mul_f32 v[48:49], v[48:49], v[40:41]
    v_pk_mul_f32 v[50:51], v[50:51], v[42:43]
    v_pk_mul_f32 v[52:53], v[52:53], v[44:45]
    v_pk_mul_f32 v[54:55], v[54:55], v[46:47]
    v_exp_f32 v48, v48
    v_exp_f32 v49, v49
    v_exp_f32 v50, v50
    v_exp_f32 v51, v51
    v_exp_f32 v52, v52
    v_exp_f32 v53, v53
    v_exp_f32 v54, v54
    v_exp_f32 v55, v55
    v_pk_add_f32 v[48:49], v[48:49], v[244:245]
    v_pk_add_f32 v[50:51], v[50:51], v[244:245]
    v_pk_add_f32 v[52:53], v[52:53], v[244:245]
    v_pk_add_f32 v[54:55], v[54:55], v[244:245]
    v_rcp_f32 v48, v48
    v_rcp_f32 v49, v49
    v_rcp_f32 v50, v50
    v_rcp_f32 v51, v51
    v_rcp_f32 v52, v52
    v_rcp_f32 v53, v53
    v_rcp_f32 v54, v54
    v_rcp_f32 v55, v55
    v_pk_mul_f32 v[40:41], v[48:49], v[40:41]
    v_pk_mul_f32 v[42:43], v[50:51], v[42:43]
    v_pk_mul_f32 v[44:45], v[52:53], v[44:45]
    v_pk_mul_f32 v[46:47], v[54:55], v[46:47]
    v_cvt_pk_bf16_f32 v56, v40, v41
    v_cvt_pk_bf16_f32 v57, v42, v43
    v_cvt_pk_bf16_f32 v58, v44, v45
    v_cvt_pk_bf16_f32 v59, v46, v47
    buffer_store_dwordx4 v[56:59], v251, s[4:7], s53 offen offset:2048 sc1
    v_accvgpr_read_b32 v0, a24
    v_accvgpr_read_b32 v1, a25
    v_accvgpr_read_b32 v2, a26
    v_accvgpr_read_b32 v3, a27
    v_accvgpr_read_b32 v4, a28
    v_accvgpr_read_b32 v5, a29
    v_accvgpr_read_b32 v6, a30
    v_accvgpr_read_b32 v7, a31
    v_pk_mul_f32 v[8:9], v[0:1], v[0:1]
    v_pk_mul_f32 v[10:11], v[2:3], v[2:3]
    v_pk_mul_f32 v[12:13], v[4:5], v[4:5]
    v_pk_mul_f32 v[14:15], v[6:7], v[6:7]
    v_pk_fma_f32 v[8:9], v[8:9], v[242:243], v[240:241]
    v_pk_fma_f32 v[10:11], v[10:11], v[242:243], v[240:241]
    v_pk_fma_f32 v[12:13], v[12:13], v[242:243], v[240:241]
    v_pk_fma_f32 v[14:15], v[14:15], v[242:243], v[240:241]
    v_pk_mul_f32 v[8:9], v[8:9], v[0:1]
    v_pk_mul_f32 v[10:11], v[10:11], v[2:3]
    v_pk_mul_f32 v[12:13], v[12:13], v[4:5]
    v_pk_mul_f32 v[14:15], v[14:15], v[6:7]
    v_exp_f32 v8, v8
    v_exp_f32 v9, v9
    v_exp_f32 v10, v10
    v_exp_f32 v11, v11
    v_exp_f32 v12, v12
    v_exp_f32 v13, v13
    v_exp_f32 v14, v14
    v_exp_f32 v15, v15
    v_pk_add_f32 v[8:9], v[8:9], v[244:245]
    v_pk_add_f32 v[10:11], v[10:11], v[244:245]
    v_pk_add_f32 v[12:13], v[12:13], v[244:245]
    v_pk_add_f32 v[14:15], v[14:15], v[244:245]
    v_rcp_f32 v8, v8
    v_rcp_f32 v9, v9
    v_rcp_f32 v10, v10
    v_rcp_f32 v11, v11
    v_rcp_f32 v12, v12
    v_rcp_f32 v13, v13
    v_rcp_f32 v14, v14
    v_rcp_f32 v15, v15
    v_pk_mul_f32 v[0:1], v[8:9], v[0:1]
    v_pk_mul_f32 v[2:3], v[10:11], v[2:3]
    v_pk_mul_f32 v[4:5], v[12:13], v[4:5]
    v_pk_mul_f32 v[6:7], v[14:15], v[6:7]
    v_cvt_pk_bf16_f32 v16, v0, v1
    v_cvt_pk_bf16_f32 v17, v2, v3
    v_cvt_pk_bf16_f32 v18, v4, v5
    v_cvt_pk_bf16_f32 v19, v6, v7
    buffer_store_dwordx4 v[16:19], v251, s[4:7], s53 offen offset:3072 sc1
    s_add_u32 s53, s53, s22
    v_accvgpr_read_b32 v20, a32
    v_accvgpr_read_b32 v21, a33
    v_accvgpr_read_b32 v22, a34
    v_accvgpr_read_b32 v23, a35
    v_accvgpr_read_b32 v24, a36
    v_accvgpr_read_b32 v25, a37
    v_accvgpr_read_b32 v26, a38
    v_accvgpr_read_b32 v27, a39
    v_pk_mul_f32 v[28:29], v[20:21], v[20:21]
    v_pk_mul_f32 v[30:31], v[22:23], v[22:23]
    v_pk_mul_f32 v[32:33], v[24:25], v[24:25]
    v_pk_mul_f32 v[34:35], v[26:27], v[26:27]
    v_pk_fma_f32 v[28:29], v[28:29], v[242:243], v[240:241]
    v_pk_fma_f32 v[30:31], v[30:31], v[242:243], v[240:241]
    v_pk_fma_f32 v[32:33], v[32:33], v[242:243], v[240:241]
    v_pk_fma_f32 v[34:35], v[34:35], v[242:243], v[240:241]
    v_pk_mul_f32 v[28:29], v[28:29], v[20:21]
    v_pk_mul_f32 v[30:31], v[30:31], v[22:23]
    v_pk_mul_f32 v[32:33], v[32:33], v[24:25]
    v_pk_mul_f32 v[34:35], v[34:35], v[26:27]
    v_exp_f32 v28, v28
    v_exp_f32 v29, v29
    v_exp_f32 v30, v30
    v_exp_f32 v31, v31
    v_exp_f32 v32, v32
    v_exp_f32 v33, v33
    v_exp_f32 v34, v34
    v_exp_f32 v35, v35
    v_pk_add_f32 v[28:29], v[28:29], v[244:245]
    v_pk_add_f32 v[30:31], v[30:31], v[244:245]
    v_pk_add_f32 v[32:33], v[32:33], v[244:245]
    v_pk_add_f32 v[34:35], v[34:35], v[244:245]
    v_rcp_f32 v28, v28
    v_rcp_f32 v29, v29
    v_rcp_f32 v30, v30
    v_rcp_f32 v31, v31
    v_rcp_f32 v32, v32
    v_rcp_f32 v33, v33
    v_rcp_f32 v34, v34
    v_rcp_f32 v35, v35
    v_pk_mul_f32 v[20:21], v[28:29], v[20:21]
    v_pk_mul_f32 v[22:23], v[30:31], v[22:23]
    v_pk_mul_f32 v[24:25], v[32:33], v[24:25]
    v_pk_mul_f32 v[26:27], v[34:35], v[26:27]
    v_cvt_pk_bf16_f32 v36, v20, v21
    v_cvt_pk_bf16_f32 v37, v22, v23
    v_cvt_pk_bf16_f32 v38, v24, v25
    v_cvt_pk_bf16_f32 v39, v26, v27
    buffer_store_dwordx4 v[36:39], v251, s[4:7], s53 offen offset:0 sc1
    v_accvgpr_read_b32 v40, a40
    v_accvgpr_read_b32 v41, a41
    v_accvgpr_read_b32 v42, a42
    v_accvgpr_read_b32 v43, a43
    v_accvgpr_read_b32 v44, a44
    v_accvgpr_read_b32 v45, a45
    v_accvgpr_read_b32 v46, a46
    v_accvgpr_read_b32 v47, a47
    v_pk_mul_f32 v[48:49], v[40:41], v[40:41]
    v_pk_mul_f32 v[50:51], v[42:43], v[42:43]
    v_pk_mul_f32 v[52:53], v[44:45], v[44:45]
    v_pk_mul_f32 v[54:55], v[46:47], v[46:47]
    v_pk_fma_f32 v[48:49], v[48:49], v[242:243], v[240:241]
    v_pk_fma_f32 v[50:51], v[50:51], v[242:243], v[240:241]
    v_pk_fma_f32 v[52:53], v[52:53], v[242:243], v[240:241]
    v_pk_fma_f32 v[54:55], v[54:55], v[242:243], v[240:241]
    v_pk_mul_f32 v[48:49], v[48:49], v[40:41]
    v_pk_mul_f32 v[50:51], v[50:51], v[42:43]
    v_pk_mul_f32 v[52:53], v[52:53], v[44:45]
    v_pk_mul_f32 v[54:55], v[54:55], v[46:47]
    v_exp_f32 v48, v48
    v_exp_f32 v49, v49
    v_exp_f32 v50, v50
    v_exp_f32 v51, v51
    v_exp_f32 v52, v52
    v_exp_f32 v53, v53
    v_exp_f32 v54, v54
    v_exp_f32 v55, v55
    v_pk_add_f32 v[48:49], v[48:49], v[244:245]
    v_pk_add_f32 v[50:51], v[50:51], v[244:245]
    v_pk_add_f32 v[52:53], v[52:53], v[244:245]
    v_pk_add_f32 v[54:55], v[54:55], v[244:245]
    v_rcp_f32 v48, v48
    v_rcp_f32 v49, v49
    v_rcp_f32 v50, v50
    v_rcp_f32 v51, v51
    v_rcp_f32 v52, v52
    v_rcp_f32 v53, v53
    v_rcp_f32 v54, v54
    v_rcp_f32 v55, v55
    v_pk_mul_f32 v[40:41], v[48:49], v[40:41]
    v_pk_mul_f32 v[42:43], v[50:51], v[42:43]
    v_pk_mul_f32 v[44:45], v[52:53], v[44:45]
    v_pk_mul_f32 v[46:47], v[54:55], v[46:47]
    v_cvt_pk_bf16_f32 v56, v40, v41
    v_cvt_pk_bf16_f32 v57, v42, v43
    v_cvt_pk_bf16_f32 v58, v44, v45
    v_cvt_pk_bf16_f32 v59, v46, v47
    buffer_store_dwordx4 v[56:59], v251, s[4:7], s53 offen offset:1024 sc1
    v_accvgpr_read_b32 v0, a48
    v_accvgpr_read_b32 v1, a49
    v_accvgpr_read_b32 v2, a50
    v_accvgpr_read_b32 v3, a51
    v_accvgpr_read_b32 v4, a52
    v_accvgpr_read_b32 v5, a53
    v_accvgpr_read_b32 v6, a54
    v_accvgpr_read_b32 v7, a55
    v_pk_mul_f32 v[8:9], v[0:1], v[0:1]
    v_pk_mul_f32 v[10:11], v[2:3], v[2:3]
    v_pk_mul_f32 v[12:13], v[4:5], v[4:5]
    v_pk_mul_f32 v[14:15], v[6:7], v[6:7]
    v_pk_fma_f32 v[8:9], v[8:9], v[242:243], v[240:241]
    v_pk_fma_f32 v[10:11], v[10:11], v[242:243], v[240:241]
    v_pk_fma_f32 v[12:13], v[12:13], v[242:243], v[240:241]
    v_pk_fma_f32 v[14:15], v[14:15], v[242:243], v[240:241]
    v_pk_mul_f32 v[8:9], v[8:9], v[0:1]
    v_pk_mul_f32 v[10:11], v[10:11], v[2:3]
    v_pk_mul_f32 v[12:13], v[12:13], v[4:5]
    v_pk_mul_f32 v[14:15], v[14:15], v[6:7]
    v_exp_f32 v8, v8
    v_exp_f32 v9, v9
    v_exp_f32 v10, v10
    v_exp_f32 v11, v11
    v_exp_f32 v12, v12
    v_exp_f32 v13, v13
    v_exp_f32 v14, v14
    v_exp_f32 v15, v15
    v_pk_add_f32 v[8:9], v[8:9], v[244:245]
    v_pk_add_f32 v[10:11], v[10:11], v[244:245]
    v_pk_add_f32 v[12:13], v[12:13], v[244:245]
    v_pk_add_f32 v[14:15], v[14:15], v[244:245]
    v_rcp_f32 v8, v8
    v_rcp_f32 v9, v9
    v_rcp_f32 v10, v10
    v_rcp_f32 v11, v11
    v_rcp_f32 v12, v12
    v_rcp_f32 v13, v13
    v_rcp_f32 v14, v14
    v_rcp_f32 v15, v15
    v_pk_mul_f32 v[0:1], v[8:9], v[0:1]
    v_pk_mul_f32 v[2:3], v[10:11], v[2:3]
    v_pk_mul_f32 v[4:5], v[12:13], v[4:5]
    v_pk_mul_f32 v[6:7], v[14:15], v[6:7]
    v_cvt_pk_bf16_f32 v16, v0, v1
    v_cvt_pk_bf16_f32 v17, v2, v3
    v_cvt_pk_bf16_f32 v18, v4, v5
    v_cvt_pk_bf16_f32 v19, v6, v7
    buffer_store_dwordx4 v[16:19], v251, s[4:7], s53 offen offset:2048 sc1
    v_accvgpr_read_b32 v20, a56
    v_accvgpr_read_b32 v21, a57
    v_accvgpr_read_b32 v22, a58
    v_accvgpr_read_b32 v23, a59
    v_accvgpr_read_b32 v24, a60
    v_accvgpr_read_b32 v25, a61
    v_accvgpr_read_b32 v26, a62
    v_accvgpr_read_b32 v27, a63
    v_pk_mul_f32 v[28:29], v[20:21], v[20:21]
    v_pk_mul_f32 v[30:31], v[22:23], v[22:23]
    v_pk_mul_f32 v[32:33], v[24:25], v[24:25]
    v_pk_mul_f32 v[34:35], v[26:27], v[26:27]
    v_pk_fma_f32 v[28:29], v[28:29], v[242:243], v[240:241]
    v_pk_fma_f32 v[30:31], v[30:31], v[242:243], v[240:241]
    v_pk_fma_f32 v[32:33], v[32:33], v[242:243], v[240:241]
    v_pk_fma_f32 v[34:35], v[34:35], v[242:243], v[240:241]
    v_pk_mul_f32 v[28:29], v[28:29], v[20:21]
    v_pk_mul_f32 v[30:31], v[30:31], v[22:23]
    v_pk_mul_f32 v[32:33], v[32:33], v[24:25]
    v_pk_mul_f32 v[34:35], v[34:35], v[26:27]
    v_exp_f32 v28, v28
    v_exp_f32 v29, v29
    v_exp_f32 v30, v30
    v_exp_f32 v31, v31
    v_exp_f32 v32, v32
    v_exp_f32 v33, v33
    v_exp_f32 v34, v34
    v_exp_f32 v35, v35
    v_pk_add_f32 v[28:29], v[28:29], v[244:245]
    v_pk_add_f32 v[30:31], v[30:31], v[244:245]
    v_pk_add_f32 v[32:33], v[32:33], v[244:245]
    v_pk_add_f32 v[34:35], v[34:35], v[244:245]
    v_rcp_f32 v28, v28
    v_rcp_f32 v29, v29
    v_rcp_f32 v30, v30
    v_rcp_f32 v31, v31
    v_rcp_f32 v32, v32
    v_rcp_f32 v33, v33
    v_rcp_f32 v34, v34
    v_rcp_f32 v35, v35
    v_pk_mul_f32 v[20:21], v[28:29], v[20:21]
    v_pk_mul_f32 v[22:23], v[30:31], v[22:23]
    v_pk_mul_f32 v[24:25], v[32:33], v[24:25]
    v_pk_mul_f32 v[26:27], v[34:35], v[26:27]
    v_cvt_pk_bf16_f32 v36, v20, v21
    v_cvt_pk_bf16_f32 v37, v22, v23
    v_cvt_pk_bf16_f32 v38, v24, v25
    v_cvt_pk_bf16_f32 v39, v26, v27
    buffer_store_dwordx4 v[36:39], v251, s[4:7], s53 offen offset:3072 sc1
    s_add_u32 s53, s53, s22
    v_accvgpr_read_b32 v40, a64
    v_accvgpr_read_b32 v41, a65
    v_accvgpr_read_b32 v42, a66
    v_accvgpr_read_b32 v43, a67
    v_accvgpr_read_b32 v44, a68
    v_accvgpr_read_b32 v45, a69
    v_accvgpr_read_b32 v46, a70
    v_accvgpr_read_b32 v47, a71
    v_pk_mul_f32 v[48:49], v[40:41], v[40:41]
    v_pk_mul_f32 v[50:51], v[42:43], v[42:43]
    v_pk_mul_f32 v[52:53], v[44:45], v[44:45]
    v_pk_mul_f32 v[54:55], v[46:47], v[46:47]
    v_pk_fma_f32 v[48:49], v[48:49], v[242:243], v[240:241]
    v_pk_fma_f32 v[50:51], v[50:51], v[242:243], v[240:241]
    v_pk_fma_f32 v[52:53], v[52:53], v[242:243], v[240:241]
    v_pk_fma_f32 v[54:55], v[54:55], v[242:243], v[240:241]
    v_pk_mul_f32 v[48:49], v[48:49], v[40:41]
    v_pk_mul_f32 v[50:51], v[50:51], v[42:43]
    v_pk_mul_f32 v[52:53], v[52:53], v[44:45]
    v_pk_mul_f32 v[54:55], v[54:55], v[46:47]
    v_exp_f32 v48, v48
    v_exp_f32 v49, v49
    v_exp_f32 v50, v50
    v_exp_f32 v51, v51
    v_exp_f32 v52, v52
    v_exp_f32 v53, v53
    v_exp_f32 v54, v54
    v_exp_f32 v55, v55
    v_pk_add_f32 v[48:49], v[48:49], v[244:245]
    v_pk_add_f32 v[50:51], v[50:51], v[244:245]
    v_pk_add_f32 v[52:53], v[52:53], v[244:245]
    v_pk_add_f32 v[54:55], v[54:55], v[244:245]
    v_rcp_f32 v48, v48
    v_rcp_f32 v49, v49
    v_rcp_f32 v50, v50
    v_rcp_f32 v51, v51
    v_rcp_f32 v52, v52
    v_rcp_f32 v53, v53
    v_rcp_f32 v54, v54
    v_rcp_f32 v55, v55
    v_pk_mul_f32 v[40:41], v[48:49], v[40:41]
    v_pk_mul_f32 v[42:43], v[50:51], v[42:43]
    v_pk_mul_f32 v[44:45], v[52:53], v[44:45]
    v_pk_mul_f32 v[46:47], v[54:55], v[46:47]
    v_cvt_pk_bf16_f32 v56, v40, v41
    v_cvt_pk_bf16_f32 v57, v42, v43
    v_cvt_pk_bf16_f32 v58, v44, v45
    v_cvt_pk_bf16_f32 v59, v46, v47
    buffer_store_dwordx4 v[56:59], v251, s[4:7], s53 offen offset:0 sc1
    v_accvgpr_read_b32 v0, a72
    v_accvgpr_read_b32 v1, a73
    v_accvgpr_read_b32 v2, a74
    v_accvgpr_read_b32 v3, a75
    v_accvgpr_read_b32 v4, a76
    v_accvgpr_read_b32 v5, a77
    v_accvgpr_read_b32 v6, a78
    v_accvgpr_read_b32 v7, a79
    v_pk_mul_f32 v[8:9], v[0:1], v[0:1]
    v_pk_mul_f32 v[10:11], v[2:3], v[2:3]
    v_pk_mul_f32 v[12:13], v[4:5], v[4:5]
    v_pk_mul_f32 v[14:15], v[6:7], v[6:7]
    v_pk_fma_f32 v[8:9], v[8:9], v[242:243], v[240:241]
    v_pk_fma_f32 v[10:11], v[10:11], v[242:243], v[240:241]
    v_pk_fma_f32 v[12:13], v[12:13], v[242:243], v[240:241]
    v_pk_fma_f32 v[14:15], v[14:15], v[242:243], v[240:241]
    v_pk_mul_f32 v[8:9], v[8:9], v[0:1]
    v_pk_mul_f32 v[10:11], v[10:11], v[2:3]
    v_pk_mul_f32 v[12:13], v[12:13], v[4:5]
    v_pk_mul_f32 v[14:15], v[14:15], v[6:7]
    v_exp_f32 v8, v8
    v_exp_f32 v9, v9
    v_exp_f32 v10, v10
    v_exp_f32 v11, v11
    v_exp_f32 v12, v12
    v_exp_f32 v13, v13
    v_exp_f32 v14, v14
    v_exp_f32 v15, v15
    v_pk_add_f32 v[8:9], v[8:9], v[244:245]
    v_pk_add_f32 v[10:11], v[10:11], v[244:245]
    v_pk_add_f32 v[12:13], v[12:13], v[244:245]
    v_pk_add_f32 v[14:15], v[14:15], v[244:245]
    v_rcp_f32 v8, v8
    v_rcp_f32 v9, v9
    v_rcp_f32 v10, v10
    v_rcp_f32 v11, v11
    v_rcp_f32 v12, v12
    v_rcp_f32 v13, v13
    v_rcp_f32 v14, v14
    v_rcp_f32 v15, v15
    v_pk_mul_f32 v[0:1], v[8:9], v[0:1]
    v_pk_mul_f32 v[2:3], v[10:11], v[2:3]
    v_pk_mul_f32 v[4:5], v[12:13], v[4:5]
    v_pk_mul_f32 v[6:7], v[14:15], v[6:7]
    v_cvt_pk_bf16_f32 v16, v0, v1
    v_cvt_pk_bf16_f32 v17, v2, v3
    v_cvt_pk_bf16_f32 v18, v4, v5
    v_cvt_pk_bf16_f32 v19, v6, v7
    buffer_store_dwordx4 v[16:19], v251, s[4:7], s53 offen offset:1024 sc1
    v_accvgpr_read_b32 v20, a80
    v_accvgpr_read_b32 v21, a81
    v_accvgpr_read_b32 v22, a82
    v_accvgpr_read_b32 v23, a83
    v_accvgpr_read_b32 v24, a84
    v_accvgpr_read_b32 v25, a85
    v_accvgpr_read_b32 v26, a86
    v_accvgpr_read_b32 v27, a87
    v_pk_mul_f32 v[28:29], v[20:21], v[20:21]
    v_pk_mul_f32 v[30:31], v[22:23], v[22:23]
    v_pk_mul_f32 v[32:33], v[24:25], v[24:25]
    v_pk_mul_f32 v[34:35], v[26:27], v[26:27]
    v_pk_fma_f32 v[28:29], v[28:29], v[242:243], v[240:241]
    v_pk_fma_f32 v[30:31], v[30:31], v[242:243], v[240:241]
    v_pk_fma_f32 v[32:33], v[32:33], v[242:243], v[240:241]
    v_pk_fma_f32 v[34:35], v[34:35], v[242:243], v[240:241]
    v_pk_mul_f32 v[28:29], v[28:29], v[20:21]
    v_pk_mul_f32 v[30:31], v[30:31], v[22:23]
    v_pk_mul_f32 v[32:33], v[32:33], v[24:25]
    v_pk_mul_f32 v[34:35], v[34:35], v[26:27]
    v_exp_f32 v28, v28
    v_exp_f32 v29, v29
    v_exp_f32 v30, v30
    v_exp_f32 v31, v31
    v_exp_f32 v32, v32
    v_exp_f32 v33, v33
    v_exp_f32 v34, v34
    v_exp_f32 v35, v35
    v_pk_add_f32 v[28:29], v[28:29], v[244:245]
    v_pk_add_f32 v[30:31], v[30:31], v[244:245]
    v_pk_add_f32 v[32:33], v[32:33], v[244:245]
    v_pk_add_f32 v[34:35], v[34:35], v[244:245]
    v_rcp_f32 v28, v28
    v_rcp_f32 v29, v29
    v_rcp_f32 v30, v30
    v_rcp_f32 v31, v31
    v_rcp_f32 v32, v32
    v_rcp_f32 v33, v33
    v_rcp_f32 v34, v34
    v_rcp_f32 v35, v35
    v_pk_mul_f32 v[20:21], v[28:29], v[20:21]
    v_pk_mul_f32 v[22:23], v[30:31], v[22:23]
    v_pk_mul_f32 v[24:25], v[32:33], v[24:25]
    v_pk_mul_f32 v[26:27], v[34:35], v[26:27]
    v_cvt_pk_bf16_f32 v36, v20, v21
    v_cvt_pk_bf16_f32 v37, v22, v23
    v_cvt_pk_bf16_f32 v38, v24, v25
    v_cvt_pk_bf16_f32 v39, v26, v27
    buffer_store_dwordx4 v[36:39], v251, s[4:7], s53 offen offset:2048 sc1
    v_accvgpr_read_b32 v40, a88
    v_accvgpr_read_b32 v41, a89
    v_accvgpr_read_b32 v42, a90
    v_accvgpr_read_b32 v43, a91
    v_accvgpr_read_b32 v44, a92
    v_accvgpr_read_b32 v45, a93
    v_accvgpr_read_b32 v46, a94
    v_accvgpr_read_b32 v47, a95
    v_pk_mul_f32 v[48:49], v[40:41], v[40:41]
    v_pk_mul_f32 v[50:51], v[42:43], v[42:43]
    v_pk_mul_f32 v[52:53], v[44:45], v[44:45]
    v_pk_mul_f32 v[54:55], v[46:47], v[46:47]
    v_pk_fma_f32 v[48:49], v[48:49], v[242:243], v[240:241]
    v_pk_fma_f32 v[50:51], v[50:51], v[242:243], v[240:241]
    v_pk_fma_f32 v[52:53], v[52:53], v[242:243], v[240:241]
    v_pk_fma_f32 v[54:55], v[54:55], v[242:243], v[240:241]
    v_pk_mul_f32 v[48:49], v[48:49], v[40:41]
    v_pk_mul_f32 v[50:51], v[50:51], v[42:43]
    v_pk_mul_f32 v[52:53], v[52:53], v[44:45]
    v_pk_mul_f32 v[54:55], v[54:55], v[46:47]
    v_exp_f32 v48, v48
    v_exp_f32 v49, v49
    v_exp_f32 v50, v50
    v_exp_f32 v51, v51
    v_exp_f32 v52, v52
    v_exp_f32 v53, v53
    v_exp_f32 v54, v54
    v_exp_f32 v55, v55
    v_pk_add_f32 v[48:49], v[48:49], v[244:245]
    v_pk_add_f32 v[50:51], v[50:51], v[244:245]
    v_pk_add_f32 v[52:53], v[52:53], v[244:245]
    v_pk_add_f32 v[54:55], v[54:55], v[244:245]
    v_rcp_f32 v48, v48
    v_rcp_f32 v49, v49
    v_rcp_f32 v50, v50
    v_rcp_f32 v51, v51
    v_rcp_f32 v52, v52
    v_rcp_f32 v53, v53
    v_rcp_f32 v54, v54
    v_rcp_f32 v55, v55
    v_pk_mul_f32 v[40:41], v[48:49], v[40:41]
    v_pk_mul_f32 v[42:43], v[50:51], v[42:43]
    v_pk_mul_f32 v[44:45], v[52:53], v[44:45]
    v_pk_mul_f32 v[46:47], v[54:55], v[46:47]
    v_cvt_pk_bf16_f32 v56, v40, v41
    v_cvt_pk_bf16_f32 v57, v42, v43
    v_cvt_pk_bf16_f32 v58, v44, v45
    v_cvt_pk_bf16_f32 v59, v46, v47
    buffer_store_dwordx4 v[56:59], v251, s[4:7], s53 offen offset:3072 sc1
    s_add_u32 s53, s53, s22
    v_accvgpr_read_b32 v0, a96
    v_accvgpr_read_b32 v1, a97
    v_accvgpr_read_b32 v2, a98
    v_accvgpr_read_b32 v3, a99
    v_accvgpr_read_b32 v4, a100
    v_accvgpr_read_b32 v5, a101
    v_accvgpr_read_b32 v6, a102
    v_accvgpr_read_b32 v7, a103
    v_pk_mul_f32 v[8:9], v[0:1], v[0:1]
    v_pk_mul_f32 v[10:11], v[2:3], v[2:3]
    v_pk_mul_f32 v[12:13], v[4:5], v[4:5]
    v_pk_mul_f32 v[14:15], v[6:7], v[6:7]
    v_pk_fma_f32 v[8:9], v[8:9], v[242:243], v[240:241]
    v_pk_fma_f32 v[10:11], v[10:11], v[242:243], v[240:241]
    v_pk_fma_f32 v[12:13], v[12:13], v[242:243], v[240:241]
    v_pk_fma_f32 v[14:15], v[14:15], v[242:243], v[240:241]
    v_pk_mul_f32 v[8:9], v[8:9], v[0:1]
    v_pk_mul_f32 v[10:11], v[10:11], v[2:3]
    v_pk_mul_f32 v[12:13], v[12:13], v[4:5]
    v_pk_mul_f32 v[14:15], v[14:15], v[6:7]
    v_exp_f32 v8, v8
    v_exp_f32 v9, v9
    v_exp_f32 v10, v10
    v_exp_f32 v11, v11
    v_exp_f32 v12, v12
    v_exp_f32 v13, v13
    v_exp_f32 v14, v14
    v_exp_f32 v15, v15
    v_pk_add_f32 v[8:9], v[8:9], v[244:245]
    v_pk_add_f32 v[10:11], v[10:11], v[244:245]
    v_pk_add_f32 v[12:13], v[12:13], v[244:245]
    v_pk_add_f32 v[14:15], v[14:15], v[244:245]
    v_rcp_f32 v8, v8
    v_rcp_f32 v9, v9
    v_rcp_f32 v10, v10
    v_rcp_f32 v11, v11
    v_rcp_f32 v12, v12
    v_rcp_f32 v13, v13
    v_rcp_f32 v14, v14
    v_rcp_f32 v15, v15
    v_pk_mul_f32 v[0:1], v[8:9], v[0:1]
    v_pk_mul_f32 v[2:3], v[10:11], v[2:3]
    v_pk_mul_f32 v[4:5], v[12:13], v[4:5]
    v_pk_mul_f32 v[6:7], v[14:15], v[6:7]
    v_cvt_pk_bf16_f32 v16, v0, v1
    v_cvt_pk_bf16_f32 v17, v2, v3
    v_cvt_pk_bf16_f32 v18, v4, v5
    v_cvt_pk_bf16_f32 v19, v6, v7
    buffer_store_dwordx4 v[16:19], v251, s[4:7], s53 offen offset:0 sc1
    v_accvgpr_read_b32 v20, a104
    v_accvgpr_read_b32 v21, a105
    v_accvgpr_read_b32 v22, a106
    v_accvgpr_read_b32 v23, a107
    v_accvgpr_read_b32 v24, a108
    v_accvgpr_read_b32 v25, a109
    v_accvgpr_read_b32 v26, a110
    v_accvgpr_read_b32 v27, a111
    v_pk_mul_f32 v[28:29], v[20:21], v[20:21]
    v_pk_mul_f32 v[30:31], v[22:23], v[22:23]
    v_pk_mul_f32 v[32:33], v[24:25], v[24:25]
    v_pk_mul_f32 v[34:35], v[26:27], v[26:27]
    v_pk_fma_f32 v[28:29], v[28:29], v[242:243], v[240:241]
    v_pk_fma_f32 v[30:31], v[30:31], v[242:243], v[240:241]
    v_pk_fma_f32 v[32:33], v[32:33], v[242:243], v[240:241]
    v_pk_fma_f32 v[34:35], v[34:35], v[242:243], v[240:241]
    v_pk_mul_f32 v[28:29], v[28:29], v[20:21]
    v_pk_mul_f32 v[30:31], v[30:31], v[22:23]
    v_pk_mul_f32 v[32:33], v[32:33], v[24:25]
    v_pk_mul_f32 v[34:35], v[34:35], v[26:27]
    v_exp_f32 v28, v28
    v_exp_f32 v29, v29
    v_exp_f32 v30, v30
    v_exp_f32 v31, v31
    v_exp_f32 v32, v32
    v_exp_f32 v33, v33
    v_exp_f32 v34, v34
    v_exp_f32 v35, v35
    v_pk_add_f32 v[28:29], v[28:29], v[244:245]
    v_pk_add_f32 v[30:31], v[30:31], v[244:245]
    v_pk_add_f32 v[32:33], v[32:33], v[244:245]
    v_pk_add_f32 v[34:35], v[34:35], v[244:245]
    v_rcp_f32 v28, v28
    v_rcp_f32 v29, v29
    v_rcp_f32 v30, v30
    v_rcp_f32 v31, v31
    v_rcp_f32 v32, v32
    v_rcp_f32 v33, v33
    v_rcp_f32 v34, v34
    v_rcp_f32 v35, v35
    v_pk_mul_f32 v[20:21], v[28:29], v[20:21]
    v_pk_mul_f32 v[22:23], v[30:31], v[22:23]
    v_pk_mul_f32 v[24:25], v[32:33], v[24:25]
    v_pk_mul_f32 v[26:27], v[34:35], v[26:27]
    v_cvt_pk_bf16_f32 v36, v20, v21
    v_cvt_pk_bf16_f32 v37, v22, v23
    v_cvt_pk_bf16_f32 v38, v24, v25
    v_cvt_pk_bf16_f32 v39, v26, v27
    buffer_store_dwordx4 v[36:39], v251, s[4:7], s53 offen offset:1024 sc1
    v_accvgpr_read_b32 v40, a112
    v_accvgpr_read_b32 v41, a113
    v_accvgpr_read_b32 v42, a114
    v_accvgpr_read_b32 v43, a115
    v_accvgpr_read_b32 v44, a116
    v_accvgpr_read_b32 v45, a117
    v_accvgpr_read_b32 v46, a118
    v_accvgpr_read_b32 v47, a119
    v_pk_mul_f32 v[48:49], v[40:41], v[40:41]
    v_pk_mul_f32 v[50:51], v[42:43], v[42:43]
    v_pk_mul_f32 v[52:53], v[44:45], v[44:45]
    v_pk_mul_f32 v[54:55], v[46:47], v[46:47]
    v_pk_fma_f32 v[48:49], v[48:49], v[242:243], v[240:241]
    v_pk_fma_f32 v[50:51], v[50:51], v[242:243], v[240:241]
    v_pk_fma_f32 v[52:53], v[52:53], v[242:243], v[240:241]
    v_pk_fma_f32 v[54:55], v[54:55], v[242:243], v[240:241]
    v_pk_mul_f32 v[48:49], v[48:49], v[40:41]
    v_pk_mul_f32 v[50:51], v[50:51], v[42:43]
    v_pk_mul_f32 v[52:53], v[52:53], v[44:45]
    v_pk_mul_f32 v[54:55], v[54:55], v[46:47]
    v_exp_f32 v48, v48
    v_exp_f32 v49, v49
    v_exp_f32 v50, v50
    v_exp_f32 v51, v51
    v_exp_f32 v52, v52
    v_exp_f32 v53, v53
    v_exp_f32 v54, v54
    v_exp_f32 v55, v55
    v_pk_add_f32 v[48:49], v[48:49], v[244:245]
    v_pk_add_f32 v[50:51], v[50:51], v[244:245]
    v_pk_add_f32 v[52:53], v[52:53], v[244:245]
    v_pk_add_f32 v[54:55], v[54:55], v[244:245]
    v_rcp_f32 v48, v48
    v_rcp_f32 v49, v49
    v_rcp_f32 v50, v50
    v_rcp_f32 v51, v51
    v_rcp_f32 v52, v52
    v_rcp_f32 v53, v53
    v_rcp_f32 v54, v54
    v_rcp_f32 v55, v55
    v_pk_mul_f32 v[40:41], v[48:49], v[40:41]
    v_pk_mul_f32 v[42:43], v[50:51], v[42:43]
    v_pk_mul_f32 v[44:45], v[52:53], v[44:45]
    v_pk_mul_f32 v[46:47], v[54:55], v[46:47]
    v_cvt_pk_bf16_f32 v56, v40, v41
    v_cvt_pk_bf16_f32 v57, v42, v43
    v_cvt_pk_bf16_f32 v58, v44, v45
    v_cvt_pk_bf16_f32 v59, v46, v47
    buffer_store_dwordx4 v[56:59], v251, s[4:7], s53 offen offset:2048 sc1
    v_accvgpr_read_b32 v0, a120
    v_accvgpr_read_b32 v1, a121
    v_accvgpr_read_b32 v2, a122
    v_accvgpr_read_b32 v3, a123
    v_accvgpr_read_b32 v4, a124
    v_accvgpr_read_b32 v5, a125
    v_accvgpr_read_b32 v6, a126
    v_accvgpr_read_b32 v7, a127
    v_pk_mul_f32 v[8:9], v[0:1], v[0:1]
    v_pk_mul_f32 v[10:11], v[2:3], v[2:3]
    v_pk_mul_f32 v[12:13], v[4:5], v[4:5]
    v_pk_mul_f32 v[14:15], v[6:7], v[6:7]
    v_pk_fma_f32 v[8:9], v[8:9], v[242:243], v[240:241]
    v_pk_fma_f32 v[10:11], v[10:11], v[242:243], v[240:241]
    v_pk_fma_f32 v[12:13], v[12:13], v[242:243], v[240:241]
    v_pk_fma_f32 v[14:15], v[14:15], v[242:243], v[240:241]
    v_pk_mul_f32 v[8:9], v[8:9], v[0:1]
    v_pk_mul_f32 v[10:11], v[10:11], v[2:3]
    v_pk_mul_f32 v[12:13], v[12:13], v[4:5]
    v_pk_mul_f32 v[14:15], v[14:15], v[6:7]
    v_exp_f32 v8, v8
    v_exp_f32 v9, v9
    v_exp_f32 v10, v10
    v_exp_f32 v11, v11
    v_exp_f32 v12, v12
    v_exp_f32 v13, v13
    v_exp_f32 v14, v14
    v_exp_f32 v15, v15
    v_pk_add_f32 v[8:9], v[8:9], v[244:245]
    v_pk_add_f32 v[10:11], v[10:11], v[244:245]
    v_pk_add_f32 v[12:13], v[12:13], v[244:245]
    v_pk_add_f32 v[14:15], v[14:15], v[244:245]
    v_rcp_f32 v8, v8
    v_rcp_f32 v9, v9
    v_rcp_f32 v10, v10
    v_rcp_f32 v11, v11
    v_rcp_f32 v12, v12
    v_rcp_f32 v13, v13
    v_rcp_f32 v14, v14
    v_rcp_f32 v15, v15
    v_pk_mul_f32 v[0:1], v[8:9], v[0:1]
    v_pk_mul_f32 v[2:3], v[10:11], v[2:3]
    v_pk_mul_f32 v[4:5], v[12:13], v[4:5]
    v_pk_mul_f32 v[6:7], v[14:15], v[6:7]
    v_cvt_pk_bf16_f32 v16, v0, v1
    v_cvt_pk_bf16_f32 v17, v2, v3
    v_cvt_pk_bf16_f32 v18, v4, v5
    v_cvt_pk_bf16_f32 v19, v6, v7
    buffer_store_dwordx4 v[16:19], v251, s[4:7], s53 offen offset:3072 sc1
    s_branch main_kernel_w_done
main_kernel_w_c1_gov:
    v_lshrrev_b32 v0, 4, v250
    v_bfe_u32 v1, v250, 2, 2
    v_lshl_add_u32 v4, v0, 2, v1
    v_and_b32 v5, 7, v4
    v_mul_u32_u24 v4, 512, v4
    v_and_b32 v6, 3, v250
    v_lshl_add_u32 v4, v6, 3, v4
    s_mul_i32 s32, s37, 8
    v_xor_b32 v5, s32, v5
    v_lshl_add_u32 v128, v5, 5, v4
    v_xor_b32 v129, 32, v128
    v_xor_b32 v130, 64, v128
    v_xor_b32 v131, 96, v128
    v_xor_b32 v132, 128, v128
    v_xor_b32 v133, 160, v128
    v_xor_b32 v134, 192, v128
    v_xor_b32 v135, 224, v128
    s_mul_i32 s32, s38, 4096
    s_add_u32 s32, s32, 65536
    v_add_u32 v136, s32, v251
    v_lshrrev_b32 v2, 5, v250
    v_and_b32 v3, 31, v250
    s_mul_i32 s32, s14, 8
    v_add_u32 v4, s32, v2
    v_add_u32 v5, 0, v4
    v_and_b32 v6, 7, v5
    v_lshlrev_b32 v6, 1, v6
    v_xor_b32 v6, v6, v3
    v_mul_lo_u32 v5, v5, s30
    v_lshl_add_u32 v5, v6, 4, v5
    v_subrev_u32 v137, 0, v5
    v_add_u32 v5, 2, v4
    v_and_b32 v6, 7, v5
    v_lshlrev_b32 v6, 1, v6
    v_xor_b32 v6, v6, v3
    v_mul_lo_u32 v5, v5, s30
    v_lshl_add_u32 v5, v6, 4, v5
    v_subrev_u32 v138, 1024, v5
    v_add_u32 v5, 4, v4
    v_and_b32 v6, 7, v5
    v_lshlrev_b32 v6, 1, v6
    v_xor_b32 v6, v6, v3
    v_mul_lo_u32 v5, v5, s30
    v_lshl_add_u32 v5, v6, 4, v5
    v_subrev_u32 v139, 2048, v5
    v_add_u32 v5, 6, v4
    v_and_b32 v6, 7, v5
    v_lshlrev_b32 v6, 1, v6
    v_xor_b32 v6, v6, v3
    v_mul_lo_u32 v5, v5, s30
    v_lshl_add_u32 v5, v6, 4, v5
    v_subrev_u32 v140, 3072, v5
    s_mul_i32 s32, s14, 2
    s_mul_i32 s32, s32, s31
    v_add_u32 v141, s32, v251
    s_add_u32 s32, s32, s31
    s_sub_u32 s32, s32, 1024
    v_add_u32 v142, s32, v251
    s_mul_i32 s19, s14, 4096
    s_mul_i32 s20, s14, 2048
    s_add_u32 s20, s20, 65536
    s_mul_i32 s17, s30, 32
    s_mov_b32 s15, 0
    s_add_u32 m0, s20, 0
    s_nop 0
    buffer_load_dwordx4 v141, s[4:7], s16 offen offset:0 sc1 lds
    buffer_load_dwordx4 v142, s[4:7], s16 offen offset:1024 sc1 lds
    s_add_u32 s16, s16, 1024
    s_add_u32 m0, s19, 0
    s_nop 0
    buffer_load_dwordx4 v137, s[8:11], s15 offen offset:0 lds
    buffer_load_dwordx4 v138, s[8:11], s15 offen offset:1024 lds
    buffer_load_dwordx4 v139, s[8:11], s15 offen offset:2048 lds
    buffer_load_dwordx4 v140, s[8:11], s15 offen offset:3072 lds
    s_add_u32 s15, s15, s17
    s_add_u32 m0, s20, 8192
    s_nop 0
    buffer_load_dwordx4 v141, s[4:7], s16 offen offset:0 sc1 lds
    buffer_load_dwordx4 v142, s[4:7], s16 offen offset:1024 sc1 lds
    s_add_u32 s16, s16, 1024
    s_add_u32 m0, s19, 16384
    s_nop 0
    buffer_load_dwordx4 v137, s[8:11], s15 offen offset:0 lds
    buffer_load_dwordx4 v138, s[8:11], s15 offen offset:1024 lds
    buffer_load_dwordx4 v139, s[8:11], s15 offen offset:2048 lds
    buffer_load_dwordx4 v140, s[8:11], s15 offen offset:3072 lds
    s_add_u32 s15, s15, s17
    s_add_u32 m0, s20, 16384
    s_nop 0
    buffer_load_dwordx4 v141, s[4:7], s16 offen offset:0 sc1 lds
    buffer_load_dwordx4 v142, s[4:7], s16 offen offset:1024 sc1 lds
    s_add_u32 s16, s16, 1024
    s_add_u32 m0, s19, 32768
    s_nop 0
    buffer_load_dwordx4 v137, s[8:11], s15 offen offset:0 lds
    buffer_load_dwordx4 v138, s[8:11], s15 offen offset:1024 lds
    buffer_load_dwordx4 v139, s[8:11], s15 offen offset:2048 lds
    buffer_load_dwordx4 v140, s[8:11], s15 offen offset:3072 lds
    s_add_u32 s15, s15, s17
    s_add_u32 m0, s20, 24576
    s_nop 0
    buffer_load_dwordx4 v141, s[4:7], s16 offen offset:0 sc1 lds
    buffer_load_dwordx4 v142, s[4:7], s16 offen offset:1024 sc1 lds
    s_add_u32 s16, s16, 1024
    s_add_u32 m0, s19, 49152
    s_nop 0
    buffer_load_dwordx4 v137, s[8:11], s15 offen offset:0 lds
    buffer_load_dwordx4 v138, s[8:11], s15 offen offset:1024 lds
    buffer_load_dwordx4 v139, s[8:11], s15 offen offset:2048 lds
    buffer_load_dwordx4 v140, s[8:11], s15 offen offset:3072 lds
    s_add_u32 s15, s15, s17
    v_accvgpr_write_b32 a0, 0
    v_accvgpr_write_b32 a1, 0
    v_accvgpr_write_b32 a2, 0
    v_accvgpr_write_b32 a3, 0
    v_accvgpr_write_b32 a4, 0
    v_accvgpr_write_b32 a5, 0
    v_accvgpr_write_b32 a6, 0
    v_accvgpr_write_b32 a7, 0
    v_accvgpr_write_b32 a8, 0
    v_accvgpr_write_b32 a9, 0
    v_accvgpr_write_b32 a10, 0
    v_accvgpr_write_b32 a11, 0
    v_accvgpr_write_b32 a12, 0
    v_accvgpr_write_b32 a13, 0
    v_accvgpr_write_b32 a14, 0
    v_accvgpr_write_b32 a15, 0
    v_accvgpr_write_b32 a16, 0
    v_accvgpr_write_b32 a17, 0
    v_accvgpr_write_b32 a18, 0
    v_accvgpr_write_b32 a19, 0
    v_accvgpr_write_b32 a20, 0
    v_accvgpr_write_b32 a21, 0
    v_accvgpr_write_b32 a22, 0
    v_accvgpr_write_b32 a23, 0
    v_accvgpr_write_b32 a24, 0
    v_accvgpr_write_b32 a25, 0
    v_accvgpr_write_b32 a26, 0
    v_accvgpr_write_b32 a27, 0
    v_accvgpr_write_b32 a28, 0
    v_accvgpr_write_b32 a29, 0
    v_accvgpr_write_b32 a30, 0
    v_accvgpr_write_b32 a31, 0
    v_accvgpr_write_b32 a32, 0
    v_accvgpr_write_b32 a33, 0
    v_accvgpr_write_b32 a34, 0
    v_accvgpr_write_b32 a35, 0
    v_accvgpr_write_b32 a36, 0
    v_accvgpr_write_b32 a37, 0
    v_accvgpr_write_b32 a38, 0
    v_accvgpr_write_b32 a39, 0
    v_accvgpr_write_b32 a40, 0
    v_accvgpr_write_b32 a41, 0
    v_accvgpr_write_b32 a42, 0
    v_accvgpr_write_b32 a43, 0
    v_accvgpr_write_b32 a44, 0
    v_accvgpr_write_b32 a45, 0
    v_accvgpr_write_b32 a46, 0
    v_accvgpr_write_b32 a47, 0
    v_accvgpr_write_b32 a48, 0
    v_accvgpr_write_b32 a49, 0
    v_accvgpr_write_b32 a50, 0
    v_accvgpr_write_b32 a51, 0
    v_accvgpr_write_b32 a52, 0
    v_accvgpr_write_b32 a53, 0
    v_accvgpr_write_b32 a54, 0
    v_accvgpr_write_b32 a55, 0
    v_accvgpr_write_b32 a56, 0
    v_accvgpr_write_b32 a57, 0
    v_accvgpr_write_b32 a58, 0
    v_accvgpr_write_b32 a59, 0
    v_accvgpr_write_b32 a60, 0
    v_accvgpr_write_b32 a61, 0
    v_accvgpr_write_b32 a62, 0
    v_accvgpr_write_b32 a63, 0
    v_accvgpr_write_b32 a64, 0
    v_accvgpr_write_b32 a65, 0
    v_accvgpr_write_b32 a66, 0
    v_accvgpr_write_b32 a67, 0
    v_accvgpr_write_b32 a68, 0
    v_accvgpr_write_b32 a69, 0
    v_accvgpr_write_b32 a70, 0
    v_accvgpr_write_b32 a71, 0
    v_accvgpr_write_b32 a72, 0
    v_accvgpr_write_b32 a73, 0
    v_accvgpr_write_b32 a74, 0
    v_accvgpr_write_b32 a75, 0
    v_accvgpr_write_b32 a76, 0
    v_accvgpr_write_b32 a77, 0
    v_accvgpr_write_b32 a78, 0
    v_accvgpr_write_b32 a79, 0
    v_accvgpr_write_b32 a80, 0
    v_accvgpr_write_b32 a81, 0
    v_accvgpr_write_b32 a82, 0
    v_accvgpr_write_b32 a83, 0
    v_accvgpr_write_b32 a84, 0
    v_accvgpr_write_b32 a85, 0
    v_accvgpr_write_b32 a86, 0
    v_accvgpr_write_b32 a87, 0
    v_accvgpr_write_b32 a88, 0
    v_accvgpr_write_b32 a89, 0
    v_accvgpr_write_b32 a90, 0
    v_accvgpr_write_b32 a91, 0
    v_accvgpr_write_b32 a92, 0
    v_accvgpr_write_b32 a93, 0
    v_accvgpr_write_b32 a94, 0
    v_accvgpr_write_b32 a95, 0
    v_accvgpr_write_b32 a96, 0
    v_accvgpr_write_b32 a97, 0
    v_accvgpr_write_b32 a98, 0
    v_accvgpr_write_b32 a99, 0
    v_accvgpr_write_b32 a100, 0
    v_accvgpr_write_b32 a101, 0
    v_accvgpr_write_b32 a102, 0
    v_accvgpr_write_b32 a103, 0
    v_accvgpr_write_b32 a104, 0
    v_accvgpr_write_b32 a105, 0
    v_accvgpr_write_b32 a106, 0
    v_accvgpr_write_b32 a107, 0
    v_accvgpr_write_b32 a108, 0
    v_accvgpr_write_b32 a109, 0
    v_accvgpr_write_b32 a110, 0
    v_accvgpr_write_b32 a111, 0
    v_accvgpr_write_b32 a112, 0
    v_accvgpr_write_b32 a113, 0
    v_accvgpr_write_b32 a114, 0
    v_accvgpr_write_b32 a115, 0
    v_accvgpr_write_b32 a116, 0
    v_accvgpr_write_b32 a117, 0
    v_accvgpr_write_b32 a118, 0
    v_accvgpr_write_b32 a119, 0
    v_accvgpr_write_b32 a120, 0
    v_accvgpr_write_b32 a121, 0
    v_accvgpr_write_b32 a122, 0
    v_accvgpr_write_b32 a123, 0
    v_accvgpr_write_b32 a124, 0
    v_accvgpr_write_b32 a125, 0
    v_accvgpr_write_b32 a126, 0
    v_accvgpr_write_b32 a127, 0
    s_waitcnt vmcnt(18)
    s_barrier
    ds_read_b128 v[32:35], v136 offset:0
    ds_read_b64_tr_b16 v[0:1], v128 offset:0
    ds_read_b64_tr_b16 v[2:3], v128 offset:8192
    ds_read_b64_tr_b16 v[4:5], v129 offset:0
    ds_read_b64_tr_b16 v[6:7], v129 offset:8192
    ds_read_b64_tr_b16 v[8:9], v130 offset:0
    ds_read_b64_tr_b16 v[10:11], v130 offset:8192
    ds_read_b64_tr_b16 v[12:13], v131 offset:0
    ds_read_b64_tr_b16 v[14:15], v131 offset:8192
    ds_read_b64_tr_b16 v[16:17], v132 offset:0
    ds_read_b64_tr_b16 v[18:19], v132 offset:8192
    ds_read_b64_tr_b16 v[20:21], v133 offset:0
    ds_read_b64_tr_b16 v[22:23], v133 offset:8192
    ds_read_b64_tr_b16 v[24:25], v134 offset:0
    ds_read_b64_tr_b16 v[26:27], v134 offset:8192
    ds_read_b64_tr_b16 v[28:29], v135 offset:0
    ds_read_b64_tr_b16 v[30:31], v135 offset:8192
    ds_read_b128 v[36:39], v136 offset:1024
    ds_read_b128 v[40:43], v136 offset:2048
    ds_read_b128 v[44:47], v136 offset:3072
main_kernel_w_c1_v_loop:
    s_waitcnt lgkmcnt(0)
    v_mfma_f32_16x16x32_bf16 a[0:3], v[32:35], v[0:3], a[0:3]
    s_waitcnt vmcnt(12)
    s_barrier
    ds_read_b128 v[80:83], v136 offset:8192
    s_add_u32 m0, s20, 0
    s_nop 0
    v_mfma_f32_16x16x32_bf16 a[4:7], v[32:35], v[4:7], a[4:7]
    ds_read_b64_tr_b16 v[48:49], v128 offset:16384
    v_mfma_f32_16x16x32_bf16 a[8:11], v[32:35], v[8:11], a[8:11]
    ds_read_b64_tr_b16 v[50:51], v128 offset:24576
    v_mfma_f32_16x16x32_bf16 a[12:15], v[32:35], v[12:15], a[12:15]
    ds_read_b64_tr_b16 v[52:53], v129 offset:16384
    buffer_load_dwordx4 v141, s[4:7], s16 offen offset:0 sc1 lds
    v_mfma_f32_16x16x32_bf16 a[16:19], v[32:35], v[16:19], a[16:19]
    ds_read_b64_tr_b16 v[54:55], v129 offset:24576
    v_mfma_f32_16x16x32_bf16 a[20:23], v[32:35], v[20:23], a[20:23]
    ds_read_b64_tr_b16 v[56:57], v130 offset:16384
    v_mfma_f32_16x16x32_bf16 a[24:27], v[32:35], v[24:27], a[24:27]
    ds_read_b64_tr_b16 v[58:59], v130 offset:24576
    buffer_load_dwordx4 v142, s[4:7], s16 offen offset:1024 sc1 lds
    v_mfma_f32_16x16x32_bf16 a[28:31], v[32:35], v[28:31], a[28:31]
    ds_read_b64_tr_b16 v[60:61], v131 offset:16384
    v_mfma_f32_16x16x32_bf16 a[32:35], v[36:39], v[0:3], a[32:35]
    ds_read_b64_tr_b16 v[62:63], v131 offset:24576
    v_mfma_f32_16x16x32_bf16 a[36:39], v[36:39], v[4:7], a[36:39]
    ds_read_b64_tr_b16 v[64:65], v132 offset:16384
    s_add_u32 s16, s16, 1024
    v_mfma_f32_16x16x32_bf16 a[40:43], v[36:39], v[8:11], a[40:43]
    ds_read_b64_tr_b16 v[66:67], v132 offset:24576
    v_mfma_f32_16x16x32_bf16 a[44:47], v[36:39], v[12:15], a[44:47]
    ds_read_b64_tr_b16 v[68:69], v133 offset:16384
    v_mfma_f32_16x16x32_bf16 a[48:51], v[36:39], v[16:19], a[48:51]
    ds_read_b64_tr_b16 v[70:71], v133 offset:24576
    s_add_u32 m0, s19, 0
    s_nop 0
    v_mfma_f32_16x16x32_bf16 a[52:55], v[36:39], v[20:23], a[52:55]
    ds_read_b64_tr_b16 v[72:73], v134 offset:16384
    v_mfma_f32_16x16x32_bf16 a[56:59], v[36:39], v[24:27], a[56:59]
    ds_read_b64_tr_b16 v[74:75], v134 offset:24576
    v_mfma_f32_16x16x32_bf16 a[60:63], v[36:39], v[28:31], a[60:63]
    ds_read_b64_tr_b16 v[76:77], v135 offset:16384
    buffer_load_dwordx4 v137, s[8:11], s15 offen offset:0 lds
    v_mfma_f32_16x16x32_bf16 a[64:67], v[40:43], v[0:3], a[64:67]
    ds_read_b64_tr_b16 v[78:79], v135 offset:24576
    v_mfma_f32_16x16x32_bf16 a[68:71], v[40:43], v[4:7], a[68:71]
    ds_read_b128 v[84:87], v136 offset:9216
    v_mfma_f32_16x16x32_bf16 a[72:75], v[40:43], v[8:11], a[72:75]
    ds_read_b128 v[88:91], v136 offset:10240
    buffer_load_dwordx4 v138, s[8:11], s15 offen offset:1024 lds
    v_mfma_f32_16x16x32_bf16 a[76:79], v[40:43], v[12:15], a[76:79]
    ds_read_b128 v[92:95], v136 offset:11264
    v_mfma_f32_16x16x32_bf16 a[80:83], v[40:43], v[16:19], a[80:83]
    v_mfma_f32_16x16x32_bf16 a[84:87], v[40:43], v[20:23], a[84:87]
    buffer_load_dwordx4 v139, s[8:11], s15 offen offset:2048 lds
    v_mfma_f32_16x16x32_bf16 a[88:91], v[40:43], v[24:27], a[88:91]
    v_mfma_f32_16x16x32_bf16 a[92:95], v[40:43], v[28:31], a[92:95]
    v_mfma_f32_16x16x32_bf16 a[96:99], v[44:47], v[0:3], a[96:99]
    buffer_load_dwordx4 v140, s[8:11], s15 offen offset:3072 lds
    v_mfma_f32_16x16x32_bf16 a[100:103], v[44:47], v[4:7], a[100:103]
    v_mfma_f32_16x16x32_bf16 a[104:107], v[44:47], v[8:11], a[104:107]
    v_mfma_f32_16x16x32_bf16 a[108:111], v[44:47], v[12:15], a[108:111]
    s_add_u32 s15, s15, s17
    v_mfma_f32_16x16x32_bf16 a[112:115], v[44:47], v[16:19], a[112:115]
    v_mfma_f32_16x16x32_bf16 a[116:119], v[44:47], v[20:23], a[116:119]
    v_mfma_f32_16x16x32_bf16 a[120:123], v[44:47], v[24:27], a[120:123]
    v_mfma_f32_16x16x32_bf16 a[124:127], v[44:47], v[28:31], a[124:127]
    s_waitcnt lgkmcnt(0)
    v_mfma_f32_16x16x32_bf16 a[0:3], v[80:83], v[48:51], a[0:3]
    s_waitcnt vmcnt(12)
    s_barrier
    ds_read_b128 v[32:35], v136 offset:16384
    s_add_u32 m0, s20, 8192
    s_nop 0
    v_mfma_f32_16x16x32_bf16 a[4:7], v[80:83], v[52:55], a[4:7]
    ds_read_b64_tr_b16 v[0:1], v128 offset:32768
    v_mfma_f32_16x16x32_bf16 a[8:11], v[80:83], v[56:59], a[8:11]
    ds_read_b64_tr_b16 v[2:3], v128 offset:40960
    v_mfma_f32_16x16x32_bf16 a[12:15], v[80:83], v[60:63], a[12:15]
    ds_read_b64_tr_b16 v[4:5], v129 offset:32768
    buffer_load_dwordx4 v141, s[4:7], s16 offen offset:0 sc1 lds
    v_mfma_f32_16x16x32_bf16 a[16:19], v[80:83], v[64:67], a[16:19]
    ds_read_b64_tr_b16 v[6:7], v129 offset:40960
    v_mfma_f32_16x16x32_bf16 a[20:23], v[80:83], v[68:71], a[20:23]
    ds_read_b64_tr_b16 v[8:9], v130 offset:32768
    v_mfma_f32_16x16x32_bf16 a[24:27], v[80:83], v[72:75], a[24:27]
    ds_read_b64_tr_b16 v[10:11], v130 offset:40960
    buffer_load_dwordx4 v142, s[4:7], s16 offen offset:1024 sc1 lds
    v_mfma_f32_16x16x32_bf16 a[28:31], v[80:83], v[76:79], a[28:31]
    ds_read_b64_tr_b16 v[12:13], v131 offset:32768
    v_mfma_f32_16x16x32_bf16 a[32:35], v[84:87], v[48:51], a[32:35]
    ds_read_b64_tr_b16 v[14:15], v131 offset:40960
    v_mfma_f32_16x16x32_bf16 a[36:39], v[84:87], v[52:55], a[36:39]
    ds_read_b64_tr_b16 v[16:17], v132 offset:32768
    s_add_u32 s16, s16, 1024
    v_mfma_f32_16x16x32_bf16 a[40:43], v[84:87], v[56:59], a[40:43]
    ds_read_b64_tr_b16 v[18:19], v132 offset:40960
    v_mfma_f32_16x16x32_bf16 a[44:47], v[84:87], v[60:63], a[44:47]
    ds_read_b64_tr_b16 v[20:21], v133 offset:32768
    v_mfma_f32_16x16x32_bf16 a[48:51], v[84:87], v[64:67], a[48:51]
    ds_read_b64_tr_b16 v[22:23], v133 offset:40960
    s_add_u32 m0, s19, 16384
    s_nop 0
    v_mfma_f32_16x16x32_bf16 a[52:55], v[84:87], v[68:71], a[52:55]
    ds_read_b64_tr_b16 v[24:25], v134 offset:32768
    v_mfma_f32_16x16x32_bf16 a[56:59], v[84:87], v[72:75], a[56:59]
    ds_read_b64_tr_b16 v[26:27], v134 offset:40960
    v_mfma_f32_16x16x32_bf16 a[60:63], v[84:87], v[76:79], a[60:63]
    ds_read_b64_tr_b16 v[28:29], v135 offset:32768
    buffer_load_dwordx4 v137, s[8:11], s15 offen offset:0 lds
    v_mfma_f32_16x16x32_bf16 a[64:67], v[88:91], v[48:51], a[64:67]
    ds_read_b64_tr_b16 v[30:31], v135 offset:40960
    v_mfma_f32_16x16x32_bf16 a[68:71], v[88:91], v[52:55], a[68:71]
    ds_read_b128 v[36:39], v136 offset:17408
    v_mfma_f32_16x16x32_bf16 a[72:75], v[88:91], v[56:59], a[72:75]
    ds_read_b128 v[40:43], v136 offset:18432
    buffer_load_dwordx4 v138, s[8:11], s15 offen offset:1024 lds
    v_mfma_f32_16x16x32_bf16 a[76:79], v[88:91], v[60:63], a[76:79]
    ds_read_b128 v[44:47], v136 offset:19456
    v_mfma_f32_16x16x32_bf16 a[80:83], v[88:91], v[64:67], a[80:83]
    v_mfma_f32_16x16x32_bf16 a[84:87], v[88:91], v[68:71], a[84:87]
    buffer_load_dwordx4 v139, s[8:11], s15 offen offset:2048 lds
    v_mfma_f32_16x16x32_bf16 a[88:91], v[88:91], v[72:75], a[88:91]
    v_mfma_f32_16x16x32_bf16 a[92:95], v[88:91], v[76:79], a[92:95]
    v_mfma_f32_16x16x32_bf16 a[96:99], v[92:95], v[48:51], a[96:99]
    buffer_load_dwordx4 v140, s[8:11], s15 offen offset:3072 lds
    v_mfma_f32_16x16x32_bf16 a[100:103], v[92:95], v[52:55], a[100:103]
    v_mfma_f32_16x16x32_bf16 a[104:107], v[92:95], v[56:59], a[104:107]
    v_mfma_f32_16x16x32_bf16 a[108:111], v[92:95], v[60:63], a[108:111]
    s_add_u32 s15, s15, s17
    v_mfma_f32_16x16x32_bf16 a[112:115], v[92:95], v[64:67], a[112:115]
    v_mfma_f32_16x16x32_bf16 a[116:119], v[92:95], v[68:71], a[116:119]
    v_mfma_f32_16x16x32_bf16 a[120:123], v[92:95], v[72:75], a[120:123]
    v_mfma_f32_16x16x32_bf16 a[124:127], v[92:95], v[76:79], a[124:127]
    s_waitcnt lgkmcnt(0)
    v_mfma_f32_16x16x32_bf16 a[0:3], v[32:35], v[0:3], a[0:3]
    s_waitcnt vmcnt(12)
    s_barrier
    ds_read_b128 v[80:83], v136 offset:24576
    s_add_u32 m0, s20, 16384
    s_nop 0
    v_mfma_f32_16x16x32_bf16 a[4:7], v[32:35], v[4:7], a[4:7]
    ds_read_b64_tr_b16 v[48:49], v128 offset:49152
    v_mfma_f32_16x16x32_bf16 a[8:11], v[32:35], v[8:11], a[8:11]
    ds_read_b64_tr_b16 v[50:51], v128 offset:57344
    v_mfma_f32_16x16x32_bf16 a[12:15], v[32:35], v[12:15], a[12:15]
    ds_read_b64_tr_b16 v[52:53], v129 offset:49152
    buffer_load_dwordx4 v141, s[4:7], s16 offen offset:0 sc1 lds
    v_mfma_f32_16x16x32_bf16 a[16:19], v[32:35], v[16:19], a[16:19]
    ds_read_b64_tr_b16 v[54:55], v129 offset:57344
    v_mfma_f32_16x16x32_bf16 a[20:23], v[32:35], v[20:23], a[20:23]
    ds_read_b64_tr_b16 v[56:57], v130 offset:49152
    v_mfma_f32_16x16x32_bf16 a[24:27], v[32:35], v[24:27], a[24:27]
    ds_read_b64_tr_b16 v[58:59], v130 offset:57344
    buffer_load_dwordx4 v142, s[4:7], s16 offen offset:1024 sc1 lds
    v_mfma_f32_16x16x32_bf16 a[28:31], v[32:35], v[28:31], a[28:31]
    ds_read_b64_tr_b16 v[60:61], v131 offset:49152
    v_mfma_f32_16x16x32_bf16 a[32:35], v[36:39], v[0:3], a[32:35]
    ds_read_b64_tr_b16 v[62:63], v131 offset:57344
    v_mfma_f32_16x16x32_bf16 a[36:39], v[36:39], v[4:7], a[36:39]
    ds_read_b64_tr_b16 v[64:65], v132 offset:49152
    s_add_u32 s16, s16, 1024
    v_mfma_f32_16x16x32_bf16 a[40:43], v[36:39], v[8:11], a[40:43]
    ds_read_b64_tr_b16 v[66:67], v132 offset:57344
    v_mfma_f32_16x16x32_bf16 a[44:47], v[36:39], v[12:15], a[44:47]
    ds_read_b64_tr_b16 v[68:69], v133 offset:49152
    v_mfma_f32_16x16x32_bf16 a[48:51], v[36:39], v[16:19], a[48:51]
    ds_read_b64_tr_b16 v[70:71], v133 offset:57344
    s_add_u32 m0, s19, 32768
    s_nop 0
    v_mfma_f32_16x16x32_bf16 a[52:55], v[36:39], v[20:23], a[52:55]
    ds_read_b64_tr_b16 v[72:73], v134 offset:49152
    v_mfma_f32_16x16x32_bf16 a[56:59], v[36:39], v[24:27], a[56:59]
    ds_read_b64_tr_b16 v[74:75], v134 offset:57344
    v_mfma_f32_16x16x32_bf16 a[60:63], v[36:39], v[28:31], a[60:63]
    ds_read_b64_tr_b16 v[76:77], v135 offset:49152
    buffer_load_dwordx4 v137, s[8:11], s15 offen offset:0 lds
    v_mfma_f32_16x16x32_bf16 a[64:67], v[40:43], v[0:3], a[64:67]
    ds_read_b64_tr_b16 v[78:79], v135 offset:57344
    v_mfma_f32_16x16x32_bf16 a[68:71], v[40:43], v[4:7], a[68:71]
    ds_read_b128 v[84:87], v136 offset:25600
    v_mfma_f32_16x16x32_bf16 a[72:75], v[40:43], v[8:11], a[72:75]
    ds_read_b128 v[88:91], v136 offset:26624
    buffer_load_dwordx4 v138, s[8:11], s15 offen offset:1024 lds
    v_mfma_f32_16x16x32_bf16 a[76:79], v[40:43], v[12:15], a[76:79]
    ds_read_b128 v[92:95], v136 offset:27648
    v_mfma_f32_16x16x32_bf16 a[80:83], v[40:43], v[16:19], a[80:83]
    v_mfma_f32_16x16x32_bf16 a[84:87], v[40:43], v[20:23], a[84:87]
    buffer_load_dwordx4 v139, s[8:11], s15 offen offset:2048 lds
    v_mfma_f32_16x16x32_bf16 a[88:91], v[40:43], v[24:27], a[88:91]
    v_mfma_f32_16x16x32_bf16 a[92:95], v[40:43], v[28:31], a[92:95]
    v_mfma_f32_16x16x32_bf16 a[96:99], v[44:47], v[0:3], a[96:99]
    buffer_load_dwordx4 v140, s[8:11], s15 offen offset:3072 lds
    v_mfma_f32_16x16x32_bf16 a[100:103], v[44:47], v[4:7], a[100:103]
    v_mfma_f32_16x16x32_bf16 a[104:107], v[44:47], v[8:11], a[104:107]
    v_mfma_f32_16x16x32_bf16 a[108:111], v[44:47], v[12:15], a[108:111]
    s_add_u32 s15, s15, s17
    v_mfma_f32_16x16x32_bf16 a[112:115], v[44:47], v[16:19], a[112:115]
    v_mfma_f32_16x16x32_bf16 a[116:119], v[44:47], v[20:23], a[116:119]
    v_mfma_f32_16x16x32_bf16 a[120:123], v[44:47], v[24:27], a[120:123]
    v_mfma_f32_16x16x32_bf16 a[124:127], v[44:47], v[28:31], a[124:127]
    s_waitcnt lgkmcnt(0)
    v_mfma_f32_16x16x32_bf16 a[0:3], v[80:83], v[48:51], a[0:3]
    s_waitcnt vmcnt(12)
    s_barrier
    ds_read_b128 v[32:35], v136 offset:0
    s_add_u32 m0, s20, 24576
    s_nop 0
    v_mfma_f32_16x16x32_bf16 a[4:7], v[80:83], v[52:55], a[4:7]
    ds_read_b64_tr_b16 v[0:1], v128 offset:0
    v_mfma_f32_16x16x32_bf16 a[8:11], v[80:83], v[56:59], a[8:11]
    ds_read_b64_tr_b16 v[2:3], v128 offset:8192
    v_mfma_f32_16x16x32_bf16 a[12:15], v[80:83], v[60:63], a[12:15]
    ds_read_b64_tr_b16 v[4:5], v129 offset:0
    buffer_load_dwordx4 v141, s[4:7], s16 offen offset:0 sc1 lds
    v_mfma_f32_16x16x32_bf16 a[16:19], v[80:83], v[64:67], a[16:19]
    ds_read_b64_tr_b16 v[6:7], v129 offset:8192
    v_mfma_f32_16x16x32_bf16 a[20:23], v[80:83], v[68:71], a[20:23]
    ds_read_b64_tr_b16 v[8:9], v130 offset:0
    v_mfma_f32_16x16x32_bf16 a[24:27], v[80:83], v[72:75], a[24:27]
    ds_read_b64_tr_b16 v[10:11], v130 offset:8192
    buffer_load_dwordx4 v142, s[4:7], s16 offen offset:1024 sc1 lds
    v_mfma_f32_16x16x32_bf16 a[28:31], v[80:83], v[76:79], a[28:31]
    ds_read_b64_tr_b16 v[12:13], v131 offset:0
    v_mfma_f32_16x16x32_bf16 a[32:35], v[84:87], v[48:51], a[32:35]
    ds_read_b64_tr_b16 v[14:15], v131 offset:8192
    v_mfma_f32_16x16x32_bf16 a[36:39], v[84:87], v[52:55], a[36:39]
    ds_read_b64_tr_b16 v[16:17], v132 offset:0
    s_add_u32 s16, s16, 1024
    v_mfma_f32_16x16x32_bf16 a[40:43], v[84:87], v[56:59], a[40:43]
    ds_read_b64_tr_b16 v[18:19], v132 offset:8192
    v_mfma_f32_16x16x32_bf16 a[44:47], v[84:87], v[60:63], a[44:47]
    ds_read_b64_tr_b16 v[20:21], v133 offset:0
    v_mfma_f32_16x16x32_bf16 a[48:51], v[84:87], v[64:67], a[48:51]
    ds_read_b64_tr_b16 v[22:23], v133 offset:8192
    s_add_u32 m0, s19, 49152
    s_nop 0
    v_mfma_f32_16x16x32_bf16 a[52:55], v[84:87], v[68:71], a[52:55]
    ds_read_b64_tr_b16 v[24:25], v134 offset:0
    v_mfma_f32_16x16x32_bf16 a[56:59], v[84:87], v[72:75], a[56:59]
    ds_read_b64_tr_b16 v[26:27], v134 offset:8192
    v_mfma_f32_16x16x32_bf16 a[60:63], v[84:87], v[76:79], a[60:63]
    ds_read_b64_tr_b16 v[28:29], v135 offset:0
    buffer_load_dwordx4 v137, s[8:11], s15 offen offset:0 lds
    v_mfma_f32_16x16x32_bf16 a[64:67], v[88:91], v[48:51], a[64:67]
    ds_read_b64_tr_b16 v[30:31], v135 offset:8192
    v_mfma_f32_16x16x32_bf16 a[68:71], v[88:91], v[52:55], a[68:71]
    ds_read_b128 v[36:39], v136 offset:1024
    v_mfma_f32_16x16x32_bf16 a[72:75], v[88:91], v[56:59], a[72:75]
    ds_read_b128 v[40:43], v136 offset:2048
    buffer_load_dwordx4 v138, s[8:11], s15 offen offset:1024 lds
    v_mfma_f32_16x16x32_bf16 a[76:79], v[88:91], v[60:63], a[76:79]
    ds_read_b128 v[44:47], v136 offset:3072
    v_mfma_f32_16x16x32_bf16 a[80:83], v[88:91], v[64:67], a[80:83]
    v_mfma_f32_16x16x32_bf16 a[84:87], v[88:91], v[68:71], a[84:87]
    buffer_load_dwordx4 v139, s[8:11], s15 offen offset:2048 lds
    v_mfma_f32_16x16x32_bf16 a[88:91], v[88:91], v[72:75], a[88:91]
    v_mfma_f32_16x16x32_bf16 a[92:95], v[88:91], v[76:79], a[92:95]
    v_mfma_f32_16x16x32_bf16 a[96:99], v[92:95], v[48:51], a[96:99]
    buffer_load_dwordx4 v140, s[8:11], s15 offen offset:3072 lds
    v_mfma_f32_16x16x32_bf16 a[100:103], v[92:95], v[52:55], a[100:103]
    v_mfma_f32_16x16x32_bf16 a[104:107], v[92:95], v[56:59], a[104:107]
    v_mfma_f32_16x16x32_bf16 a[108:111], v[92:95], v[60:63], a[108:111]
    s_add_u32 s15, s15, s17
    v_mfma_f32_16x16x32_bf16 a[112:115], v[92:95], v[64:67], a[112:115]
    v_mfma_f32_16x16x32_bf16 a[116:119], v[92:95], v[68:71], a[116:119]
    v_mfma_f32_16x16x32_bf16 a[120:123], v[92:95], v[72:75], a[120:123]
    v_mfma_f32_16x16x32_bf16 a[124:127], v[92:95], v[76:79], a[124:127]
    s_sub_u32 s18, s18, 1
    s_cmp_lg_u32 s18, 0
    s_cbranch_scc1 main_kernel_w_c1_v_loop
    s_cmp_lg_u32 s14, 0
    s_cbranch_scc1 main_kernel_w_c1_v_nt
    s_lshl_b32 s32, s27, 8
    s_add_u32 s32, s32, 0x841e000
    v_mov_b32 v255, 1
    s_mov_b64 exec, 1
    buffer_atomic_add v255, off, s[4:7], s32 sc0 sc1
    s_mov_b64 exec, -1
main_kernel_w_c1_v_nt:
    s_waitcnt lgkmcnt(0)
    v_mfma_f32_16x16x32_bf16 a[0:3], v[32:35], v[0:3], a[0:3]
    s_waitcnt vmcnt(12)
    s_barrier
    ds_read_b128 v[80:83], v136 offset:8192
    v_mfma_f32_16x16x32_bf16 a[4:7], v[32:35], v[4:7], a[4:7]
    ds_read_b64_tr_b16 v[48:49], v128 offset:16384
    v_mfma_f32_16x16x32_bf16 a[8:11], v[32:35], v[8:11], a[8:11]
    ds_read_b64_tr_b16 v[50:51], v128 offset:24576
    v_mfma_f32_16x16x32_bf16 a[12:15], v[32:35], v[12:15], a[12:15]
    ds_read_b64_tr_b16 v[52:53], v129 offset:16384
    v_mfma_f32_16x16x32_bf16 a[16:19], v[32:35], v[16:19], a[16:19]
    ds_read_b64_tr_b16 v[54:55], v129 offset:24576
    v_mfma_f32_16x16x32_bf16 a[20:23], v[32:35], v[20:23], a[20:23]
    ds_read_b64_tr_b16 v[56:57], v130 offset:16384
    v_mfma_f32_16x16x32_bf16 a[24:27], v[32:35], v[24:27], a[24:27]
    ds_read_b64_tr_b16 v[58:59], v130 offset:24576
    v_mfma_f32_16x16x32_bf16 a[28:31], v[32:35], v[28:31], a[28:31]
    ds_read_b64_tr_b16 v[60:61], v131 offset:16384
    v_mfma_f32_16x16x32_bf16 a[32:35], v[36:39], v[0:3], a[32:35]
    ds_read_b64_tr_b16 v[62:63], v131 offset:24576
    v_mfma_f32_16x16x32_bf16 a[36:39], v[36:39], v[4:7], a[36:39]
    ds_read_b64_tr_b16 v[64:65], v132 offset:16384
    v_mfma_f32_16x16x32_bf16 a[40:43], v[36:39], v[8:11], a[40:43]
    ds_read_b64_tr_b16 v[66:67], v132 offset:24576
    v_mfma_f32_16x16x32_bf16 a[44:47], v[36:39], v[12:15], a[44:47]
    ds_read_b64_tr_b16 v[68:69], v133 offset:16384
    v_mfma_f32_16x16x32_bf16 a[48:51], v[36:39], v[16:19], a[48:51]
    ds_read_b64_tr_b16 v[70:71], v133 offset:24576
    v_mfma_f32_16x16x32_bf16 a[52:55], v[36:39], v[20:23], a[52:55]
    ds_read_b64_tr_b16 v[72:73], v134 offset:16384
    v_mfma_f32_16x16x32_bf16 a[56:59], v[36:39], v[24:27], a[56:59]
    ds_read_b64_tr_b16 v[74:75], v134 offset:24576
    v_mfma_f32_16x16x32_bf16 a[60:63], v[36:39], v[28:31], a[60:63]
    ds_read_b64_tr_b16 v[76:77], v135 offset:16384
    v_mfma_f32_16x16x32_bf16 a[64:67], v[40:43], v[0:3], a[64:67]
    ds_read_b64_tr_b16 v[78:79], v135 offset:24576
    v_mfma_f32_16x16x32_bf16 a[68:71], v[40:43], v[4:7], a[68:71]
    ds_read_b128 v[84:87], v136 offset:9216
    v_mfma_f32_16x16x32_bf16 a[72:75], v[40:43], v[8:11], a[72:75]
    ds_read_b128 v[88:91], v136 offset:10240
    v_mfma_f32_16x16x32_bf16 a[76:79], v[40:43], v[12:15], a[76:79]
    ds_read_b128 v[92:95], v136 offset:11264
    v_mfma_f32_16x16x32_bf16 a[80:83], v[40:43], v[16:19], a[80:83]
    v_mfma_f32_16x16x32_bf16 a[84:87], v[40:43], v[20:23], a[84:87]
    v_mfma_f32_16x16x32_bf16 a[88:91], v[40:43], v[24:27], a[88:91]
    v_mfma_f32_16x16x32_bf16 a[92:95], v[40:43], v[28:31], a[92:95]
    v_mfma_f32_16x16x32_bf16 a[96:99], v[44:47], v[0:3], a[96:99]
    v_mfma_f32_16x16x32_bf16 a[100:103], v[44:47], v[4:7], a[100:103]
    v_mfma_f32_16x16x32_bf16 a[104:107], v[44:47], v[8:11], a[104:107]
    v_mfma_f32_16x16x32_bf16 a[108:111], v[44:47], v[12:15], a[108:111]
    v_mfma_f32_16x16x32_bf16 a[112:115], v[44:47], v[16:19], a[112:115]
    v_mfma_f32_16x16x32_bf16 a[116:119], v[44:47], v[20:23], a[116:119]
    v_mfma_f32_16x16x32_bf16 a[120:123], v[44:47], v[24:27], a[120:123]
    v_mfma_f32_16x16x32_bf16 a[124:127], v[44:47], v[28:31], a[124:127]
    s_waitcnt lgkmcnt(0)
    v_mfma_f32_16x16x32_bf16 a[0:3], v[80:83], v[48:51], a[0:3]
    s_waitcnt vmcnt(6)
    s_barrier
    ds_read_b128 v[32:35], v136 offset:16384
    v_mfma_f32_16x16x32_bf16 a[4:7], v[80:83], v[52:55], a[4:7]
    ds_read_b64_tr_b16 v[0:1], v128 offset:32768
    v_mfma_f32_16x16x32_bf16 a[8:11], v[80:83], v[56:59], a[8:11]
    ds_read_b64_tr_b16 v[2:3], v128 offset:40960
    v_mfma_f32_16x16x32_bf16 a[12:15], v[80:83], v[60:63], a[12:15]
    ds_read_b64_tr_b16 v[4:5], v129 offset:32768
    v_mfma_f32_16x16x32_bf16 a[16:19], v[80:83], v[64:67], a[16:19]
    ds_read_b64_tr_b16 v[6:7], v129 offset:40960
    v_mfma_f32_16x16x32_bf16 a[20:23], v[80:83], v[68:71], a[20:23]
    ds_read_b64_tr_b16 v[8:9], v130 offset:32768
    v_mfma_f32_16x16x32_bf16 a[24:27], v[80:83], v[72:75], a[24:27]
    ds_read_b64_tr_b16 v[10:11], v130 offset:40960
    v_mfma_f32_16x16x32_bf16 a[28:31], v[80:83], v[76:79], a[28:31]
    ds_read_b64_tr_b16 v[12:13], v131 offset:32768
    v_mfma_f32_16x16x32_bf16 a[32:35], v[84:87], v[48:51], a[32:35]
    ds_read_b64_tr_b16 v[14:15], v131 offset:40960
    v_mfma_f32_16x16x32_bf16 a[36:39], v[84:87], v[52:55], a[36:39]
    ds_read_b64_tr_b16 v[16:17], v132 offset:32768
    v_mfma_f32_16x16x32_bf16 a[40:43], v[84:87], v[56:59], a[40:43]
    ds_read_b64_tr_b16 v[18:19], v132 offset:40960
    v_mfma_f32_16x16x32_bf16 a[44:47], v[84:87], v[60:63], a[44:47]
    ds_read_b64_tr_b16 v[20:21], v133 offset:32768
    v_mfma_f32_16x16x32_bf16 a[48:51], v[84:87], v[64:67], a[48:51]
    ds_read_b64_tr_b16 v[22:23], v133 offset:40960
    v_mfma_f32_16x16x32_bf16 a[52:55], v[84:87], v[68:71], a[52:55]
    ds_read_b64_tr_b16 v[24:25], v134 offset:32768
    v_mfma_f32_16x16x32_bf16 a[56:59], v[84:87], v[72:75], a[56:59]
    ds_read_b64_tr_b16 v[26:27], v134 offset:40960
    v_mfma_f32_16x16x32_bf16 a[60:63], v[84:87], v[76:79], a[60:63]
    ds_read_b64_tr_b16 v[28:29], v135 offset:32768
    v_mfma_f32_16x16x32_bf16 a[64:67], v[88:91], v[48:51], a[64:67]
    ds_read_b64_tr_b16 v[30:31], v135 offset:40960
    v_mfma_f32_16x16x32_bf16 a[68:71], v[88:91], v[52:55], a[68:71]
    ds_read_b128 v[36:39], v136 offset:17408
    v_mfma_f32_16x16x32_bf16 a[72:75], v[88:91], v[56:59], a[72:75]
    ds_read_b128 v[40:43], v136 offset:18432
    v_mfma_f32_16x16x32_bf16 a[76:79], v[88:91], v[60:63], a[76:79]
    ds_read_b128 v[44:47], v136 offset:19456
    v_mfma_f32_16x16x32_bf16 a[80:83], v[88:91], v[64:67], a[80:83]
    v_mfma_f32_16x16x32_bf16 a[84:87], v[88:91], v[68:71], a[84:87]
    v_mfma_f32_16x16x32_bf16 a[88:91], v[88:91], v[72:75], a[88:91]
    v_mfma_f32_16x16x32_bf16 a[92:95], v[88:91], v[76:79], a[92:95]
    v_mfma_f32_16x16x32_bf16 a[96:99], v[92:95], v[48:51], a[96:99]
    v_mfma_f32_16x16x32_bf16 a[100:103], v[92:95], v[52:55], a[100:103]
    v_mfma_f32_16x16x32_bf16 a[104:107], v[92:95], v[56:59], a[104:107]
    v_mfma_f32_16x16x32_bf16 a[108:111], v[92:95], v[60:63], a[108:111]
    v_mfma_f32_16x16x32_bf16 a[112:115], v[92:95], v[64:67], a[112:115]
    v_mfma_f32_16x16x32_bf16 a[116:119], v[92:95], v[68:71], a[116:119]
    v_mfma_f32_16x16x32_bf16 a[120:123], v[92:95], v[72:75], a[120:123]
    v_mfma_f32_16x16x32_bf16 a[124:127], v[92:95], v[76:79], a[124:127]
    s_waitcnt lgkmcnt(0)
    v_mfma_f32_16x16x32_bf16 a[0:3], v[32:35], v[0:3], a[0:3]
    s_waitcnt vmcnt(0)
    s_barrier
    ds_read_b128 v[80:83], v136 offset:24576
    v_mfma_f32_16x16x32_bf16 a[4:7], v[32:35], v[4:7], a[4:7]
    ds_read_b64_tr_b16 v[48:49], v128 offset:49152
    v_mfma_f32_16x16x32_bf16 a[8:11], v[32:35], v[8:11], a[8:11]
    ds_read_b64_tr_b16 v[50:51], v128 offset:57344
    v_mfma_f32_16x16x32_bf16 a[12:15], v[32:35], v[12:15], a[12:15]
    ds_read_b64_tr_b16 v[52:53], v129 offset:49152
    v_mfma_f32_16x16x32_bf16 a[16:19], v[32:35], v[16:19], a[16:19]
    ds_read_b64_tr_b16 v[54:55], v129 offset:57344
    v_mfma_f32_16x16x32_bf16 a[20:23], v[32:35], v[20:23], a[20:23]
    ds_read_b64_tr_b16 v[56:57], v130 offset:49152
    v_mfma_f32_16x16x32_bf16 a[24:27], v[32:35], v[24:27], a[24:27]
    ds_read_b64_tr_b16 v[58:59], v130 offset:57344
    v_mfma_f32_16x16x32_bf16 a[28:31], v[32:35], v[28:31], a[28:31]
    ds_read_b64_tr_b16 v[60:61], v131 offset:49152
    v_mfma_f32_16x16x32_bf16 a[32:35], v[36:39], v[0:3], a[32:35]
    ds_read_b64_tr_b16 v[62:63], v131 offset:57344
    v_mfma_f32_16x16x32_bf16 a[36:39], v[36:39], v[4:7], a[36:39]
    ds_read_b64_tr_b16 v[64:65], v132 offset:49152
    v_mfma_f32_16x16x32_bf16 a[40:43], v[36:39], v[8:11], a[40:43]
    ds_read_b64_tr_b16 v[66:67], v132 offset:57344
    v_mfma_f32_16x16x32_bf16 a[44:47], v[36:39], v[12:15], a[44:47]
    ds_read_b64_tr_b16 v[68:69], v133 offset:49152
    v_mfma_f32_16x16x32_bf16 a[48:51], v[36:39], v[16:19], a[48:51]
    ds_read_b64_tr_b16 v[70:71], v133 offset:57344
    v_mfma_f32_16x16x32_bf16 a[52:55], v[36:39], v[20:23], a[52:55]
    ds_read_b64_tr_b16 v[72:73], v134 offset:49152
    v_mfma_f32_16x16x32_bf16 a[56:59], v[36:39], v[24:27], a[56:59]
    ds_read_b64_tr_b16 v[74:75], v134 offset:57344
    v_mfma_f32_16x16x32_bf16 a[60:63], v[36:39], v[28:31], a[60:63]
    ds_read_b64_tr_b16 v[76:77], v135 offset:49152
    v_mfma_f32_16x16x32_bf16 a[64:67], v[40:43], v[0:3], a[64:67]
    ds_read_b64_tr_b16 v[78:79], v135 offset:57344
    v_mfma_f32_16x16x32_bf16 a[68:71], v[40:43], v[4:7], a[68:71]
    ds_read_b128 v[84:87], v136 offset:25600
    v_mfma_f32_16x16x32_bf16 a[72:75], v[40:43], v[8:11], a[72:75]
    ds_read_b128 v[88:91], v136 offset:26624
    v_mfma_f32_16x16x32_bf16 a[76:79], v[40:43], v[12:15], a[76:79]
    ds_read_b128 v[92:95], v136 offset:27648
    v_mfma_f32_16x16x32_bf16 a[80:83], v[40:43], v[16:19], a[80:83]
    v_mfma_f32_16x16x32_bf16 a[84:87], v[40:43], v[20:23], a[84:87]
    v_mfma_f32_16x16x32_bf16 a[88:91], v[40:43], v[24:27], a[88:91]
    v_mfma_f32_16x16x32_bf16 a[92:95], v[40:43], v[28:31], a[92:95]
    v_mfma_f32_16x16x32_bf16 a[96:99], v[44:47], v[0:3], a[96:99]
    v_mfma_f32_16x16x32_bf16 a[100:103], v[44:47], v[4:7], a[100:103]
    v_mfma_f32_16x16x32_bf16 a[104:107], v[44:47], v[8:11], a[104:107]
    v_mfma_f32_16x16x32_bf16 a[108:111], v[44:47], v[12:15], a[108:111]
    v_mfma_f32_16x16x32_bf16 a[112:115], v[44:47], v[16:19], a[112:115]
    v_mfma_f32_16x16x32_bf16 a[116:119], v[44:47], v[20:23], a[116:119]
    v_mfma_f32_16x16x32_bf16 a[120:123], v[44:47], v[24:27], a[120:123]
    v_mfma_f32_16x16x32_bf16 a[124:127], v[44:47], v[28:31], a[124:127]
    v_readfirstlane_b32 s55, v255
    s_waitcnt lgkmcnt(0)
    v_mfma_f32_16x16x32_bf16 a[0:3], v[80:83], v[48:51], a[0:3]
    v_mfma_f32_16x16x32_bf16 a[4:7], v[80:83], v[52:55], a[4:7]
    v_mfma_f32_16x16x32_bf16 a[8:11], v[80:83], v[56:59], a[8:11]
    v_mfma_f32_16x16x32_bf16 a[12:15], v[80:83], v[60:63], a[12:15]
    v_mfma_f32_16x16x32_bf16 a[16:19], v[80:83], v[64:67], a[16:19]
    v_mfma_f32_16x16x32_bf16 a[20:23], v[80:83], v[68:71], a[20:23]
    v_mfma_f32_16x16x32_bf16 a[24:27], v[80:83], v[72:75], a[24:27]
    v_mfma_f32_16x16x32_bf16 a[28:31], v[80:83], v[76:79], a[28:31]
    v_mfma_f32_16x16x32_bf16 a[32:35], v[84:87], v[48:51], a[32:35]
    v_mfma_f32_16x16x32_bf16 a[36:39], v[84:87], v[52:55], a[36:39]
    v_mfma_f32_16x16x32_bf16 a[40:43], v[84:87], v[56:59], a[40:43]
    v_mfma_f32_16x16x32_bf16 a[44:47], v[84:87], v[60:63], a[44:47]
    v_mfma_f32_16x16x32_bf16 a[48:51], v[84:87], v[64:67], a[48:51]
    v_mfma_f32_16x16x32_bf16 a[52:55], v[84:87], v[68:71], a[52:55]
    v_mfma_f32_16x16x32_bf16 a[56:59], v[84:87], v[72:75], a[56:59]
    v_mfma_f32_16x16x32_bf16 a[60:63], v[84:87], v[76:79], a[60:63]
    v_mfma_f32_16x16x32_bf16 a[64:67], v[88:91], v[48:51], a[64:67]
    v_mfma_f32_16x16x32_bf16 a[68:71], v[88:91], v[52:55], a[68:71]
    v_mfma_f32_16x16x32_bf16 a[72:75], v[88:91], v[56:59], a[72:75]
    v_mfma_f32_16x16x32_bf16 a[76:79], v[88:91], v[60:63], a[76:79]
    v_mfma_f32_16x16x32_bf16 a[80:83], v[88:91], v[64:67], a[80:83]
    v_mfma_f32_16x16x32_bf16 a[84:87], v[88:91], v[68:71], a[84:87]
    v_mfma_f32_16x16x32_bf16 a[88:91], v[88:91], v[72:75], a[88:91]
    v_mfma_f32_16x16x32_bf16 a[92:95], v[88:91], v[76:79], a[92:95]
    v_mfma_f32_16x16x32_bf16 a[96:99], v[92:95], v[48:51], a[96:99]
    v_mfma_f32_16x16x32_bf16 a[100:103], v[92:95], v[52:55], a[100:103]
    v_mfma_f32_16x16x32_bf16 a[104:107], v[92:95], v[56:59], a[104:107]
    v_mfma_f32_16x16x32_bf16 a[108:111], v[92:95], v[60:63], a[108:111]
    v_mfma_f32_16x16x32_bf16 a[112:115], v[92:95], v[64:67], a[112:115]
    v_mfma_f32_16x16x32_bf16 a[116:119], v[92:95], v[68:71], a[116:119]
    v_mfma_f32_16x16x32_bf16 a[120:123], v[92:95], v[72:75], a[120:123]
    v_mfma_f32_16x16x32_bf16 a[124:127], v[92:95], v[76:79], a[124:127]
    s_nop 7
    s_mov_b32 s53, s21
    v_accvgpr_read_b32 v0, a0
    v_accvgpr_read_b32 v1, a1
    v_accvgpr_read_b32 v2, a2
    v_accvgpr_read_b32 v3, a3
    v_accvgpr_read_b32 v4, a32
    v_accvgpr_read_b32 v5, a33
    v_accvgpr_read_b32 v6, a34
    v_accvgpr_read_b32 v7, a35
    v_cvt_pk_bf16_f32 v8, v0, v1
    v_cvt_pk_bf16_f32 v9, v2, v3
    v_cvt_pk_bf16_f32 v10, v4, v5
    v_cvt_pk_bf16_f32 v11, v6, v7
    buffer_store_dwordx4 v[8:11], v251, s[4:7], s53 offen offset:0 sc1
    v_accvgpr_read_b32 v16, a4
    v_accvgpr_read_b32 v17, a5
    v_accvgpr_read_b32 v18, a6
    v_accvgpr_read_b32 v19, a7
    v_accvgpr_read_b32 v20, a36
    v_accvgpr_read_b32 v21, a37
    v_accvgpr_read_b32 v22, a38
    v_accvgpr_read_b32 v23, a39
    v_cvt_pk_bf16_f32 v24, v16, v17
    v_cvt_pk_bf16_f32 v25, v18, v19
    v_cvt_pk_bf16_f32 v26, v20, v21
    v_cvt_pk_bf16_f32 v27, v22, v23
    buffer_store_dwordx4 v[24:27], v251, s[4:7], s53 offen offset:1024 sc1
    v_accvgpr_read_b32 v32, a8
    v_accvgpr_read_b32 v33, a9
    v_accvgpr_read_b32 v34, a10
    v_accvgpr_read_b32 v35, a11
    v_accvgpr_read_b32 v36, a40
    v_accvgpr_read_b32 v37, a41
    v_accvgpr_read_b32 v38, a42
    v_accvgpr_read_b32 v39, a43
    v_cvt_pk_bf16_f32 v40, v32, v33
    v_cvt_pk_bf16_f32 v41, v34, v35
    v_cvt_pk_bf16_f32 v42, v36, v37
    v_cvt_pk_bf16_f32 v43, v38, v39
    buffer_store_dwordx4 v[40:43], v251, s[4:7], s53 offen offset:2048 sc1
    v_accvgpr_read_b32 v48, a12
    v_accvgpr_read_b32 v49, a13
    v_accvgpr_read_b32 v50, a14
    v_accvgpr_read_b32 v51, a15
    v_accvgpr_read_b32 v52, a44
    v_accvgpr_read_b32 v53, a45
    v_accvgpr_read_b32 v54, a46
    v_accvgpr_read_b32 v55, a47
    v_cvt_pk_bf16_f32 v56, v48, v49
    v_cvt_pk_bf16_f32 v57, v50, v51
    v_cvt_pk_bf16_f32 v58, v52, v53
    v_cvt_pk_bf16_f32 v59, v54, v55
    buffer_store_dwordx4 v[56:59], v251, s[4:7], s53 offen offset:3072 sc1
    s_add_u32 s53, s53, 4096
    v_accvgpr_read_b32 v0, a16
    v_accvgpr_read_b32 v1, a17
    v_accvgpr_read_b32 v2, a18
    v_accvgpr_read_b32 v3, a19
    v_accvgpr_read_b32 v4, a48
    v_accvgpr_read_b32 v5, a49
    v_accvgpr_read_b32 v6, a50
    v_accvgpr_read_b32 v7, a51
    v_cvt_pk_bf16_f32 v8, v0, v1
    v_cvt_pk_bf16_f32 v9, v2, v3
    v_cvt_pk_bf16_f32 v10, v4, v5
    v_cvt_pk_bf16_f32 v11, v6, v7
    buffer_store_dwordx4 v[8:11], v251, s[4:7], s53 offen offset:0 sc1
    v_accvgpr_read_b32 v16, a20
    v_accvgpr_read_b32 v17, a21
    v_accvgpr_read_b32 v18, a22
    v_accvgpr_read_b32 v19, a23
    v_accvgpr_read_b32 v20, a52
    v_accvgpr_read_b32 v21, a53
    v_accvgpr_read_b32 v22, a54
    v_accvgpr_read_b32 v23, a55
    v_cvt_pk_bf16_f32 v24, v16, v17
    v_cvt_pk_bf16_f32 v25, v18, v19
    v_cvt_pk_bf16_f32 v26, v20, v21
    v_cvt_pk_bf16_f32 v27, v22, v23
    buffer_store_dwordx4 v[24:27], v251, s[4:7], s53 offen offset:1024 sc1
    v_accvgpr_read_b32 v32, a24
    v_accvgpr_read_b32 v33, a25
    v_accvgpr_read_b32 v34, a26
    v_accvgpr_read_b32 v35, a27
    v_accvgpr_read_b32 v36, a56
    v_accvgpr_read_b32 v37, a57
    v_accvgpr_read_b32 v38, a58
    v_accvgpr_read_b32 v39, a59
    v_cvt_pk_bf16_f32 v40, v32, v33
    v_cvt_pk_bf16_f32 v41, v34, v35
    v_cvt_pk_bf16_f32 v42, v36, v37
    v_cvt_pk_bf16_f32 v43, v38, v39
    buffer_store_dwordx4 v[40:43], v251, s[4:7], s53 offen offset:2048 sc1
    v_accvgpr_read_b32 v48, a28
    v_accvgpr_read_b32 v49, a29
    v_accvgpr_read_b32 v50, a30
    v_accvgpr_read_b32 v51, a31
    v_accvgpr_read_b32 v52, a60
    v_accvgpr_read_b32 v53, a61
    v_accvgpr_read_b32 v54, a62
    v_accvgpr_read_b32 v55, a63
    v_cvt_pk_bf16_f32 v56, v48, v49
    v_cvt_pk_bf16_f32 v57, v50, v51
    v_cvt_pk_bf16_f32 v58, v52, v53
    v_cvt_pk_bf16_f32 v59, v54, v55
    buffer_store_dwordx4 v[56:59], v251, s[4:7], s53 offen offset:3072 sc1
    s_add_u32 s53, s53, 258048
    v_accvgpr_read_b32 v0, a64
    v_accvgpr_read_b32 v1, a65
    v_accvgpr_read_b32 v2, a66
    v_accvgpr_read_b32 v3, a67
    v_accvgpr_read_b32 v4, a96
    v_accvgpr_read_b32 v5, a97
    v_accvgpr_read_b32 v6, a98
    v_accvgpr_read_b32 v7, a99
    v_cvt_pk_bf16_f32 v8, v0, v1
    v_cvt_pk_bf16_f32 v9, v2, v3
    v_cvt_pk_bf16_f32 v10, v4, v5
    v_cvt_pk_bf16_f32 v11, v6, v7
    buffer_store_dwordx4 v[8:11], v251, s[4:7], s53 offen offset:0 sc1
    v_accvgpr_read_b32 v16, a68
    v_accvgpr_read_b32 v17, a69
    v_accvgpr_read_b32 v18, a70
    v_accvgpr_read_b32 v19, a71
    v_accvgpr_read_b32 v20, a100
    v_accvgpr_read_b32 v21, a101
    v_accvgpr_read_b32 v22, a102
    v_accvgpr_read_b32 v23, a103
    v_cvt_pk_bf16_f32 v24, v16, v17
    v_cvt_pk_bf16_f32 v25, v18, v19
    v_cvt_pk_bf16_f32 v26, v20, v21
    v_cvt_pk_bf16_f32 v27, v22, v23
    buffer_store_dwordx4 v[24:27], v251, s[4:7], s53 offen offset:1024 sc1
    v_accvgpr_read_b32 v32, a72
    v_accvgpr_read_b32 v33, a73
    v_accvgpr_read_b32 v34, a74
    v_accvgpr_read_b32 v35, a75
    v_accvgpr_read_b32 v36, a104
    v_accvgpr_read_b32 v37, a105
    v_accvgpr_read_b32 v38, a106
    v_accvgpr_read_b32 v39, a107
    v_cvt_pk_bf16_f32 v40, v32, v33
    v_cvt_pk_bf16_f32 v41, v34, v35
    v_cvt_pk_bf16_f32 v42, v36, v37
    v_cvt_pk_bf16_f32 v43, v38, v39
    buffer_store_dwordx4 v[40:43], v251, s[4:7], s53 offen offset:2048 sc1
    v_accvgpr_read_b32 v48, a76
    v_accvgpr_read_b32 v49, a77
    v_accvgpr_read_b32 v50, a78
    v_accvgpr_read_b32 v51, a79
    v_accvgpr_read_b32 v52, a108
    v_accvgpr_read_b32 v53, a109
    v_accvgpr_read_b32 v54, a110
    v_accvgpr_read_b32 v55, a111
    v_cvt_pk_bf16_f32 v56, v48, v49
    v_cvt_pk_bf16_f32 v57, v50, v51
    v_cvt_pk_bf16_f32 v58, v52, v53
    v_cvt_pk_bf16_f32 v59, v54, v55
    buffer_store_dwordx4 v[56:59], v251, s[4:7], s53 offen offset:3072 sc1
    s_add_u32 s53, s53, 4096
    v_accvgpr_read_b32 v0, a80
    v_accvgpr_read_b32 v1, a81
    v_accvgpr_read_b32 v2, a82
    v_accvgpr_read_b32 v3, a83
    v_accvgpr_read_b32 v4, a112
    v_accvgpr_read_b32 v5, a113
    v_accvgpr_read_b32 v6, a114
    v_accvgpr_read_b32 v7, a115
    v_cvt_pk_bf16_f32 v8, v0, v1
    v_cvt_pk_bf16_f32 v9, v2, v3
    v_cvt_pk_bf16_f32 v10, v4, v5
    v_cvt_pk_bf16_f32 v11, v6, v7
    buffer_store_dwordx4 v[8:11], v251, s[4:7], s53 offen offset:0 sc1
    v_accvgpr_read_b32 v16, a84
    v_accvgpr_read_b32 v17, a85
    v_accvgpr_read_b32 v18, a86
    v_accvgpr_read_b32 v19, a87
    v_accvgpr_read_b32 v20, a116
    v_accvgpr_read_b32 v21, a117
    v_accvgpr_read_b32 v22, a118
    v_accvgpr_read_b32 v23, a119
    v_cvt_pk_bf16_f32 v24, v16, v17
    v_cvt_pk_bf16_f32 v25, v18, v19
    v_cvt_pk_bf16_f32 v26, v20, v21
    v_cvt_pk_bf16_f32 v27, v22, v23
    buffer_store_dwordx4 v[24:27], v251, s[4:7], s53 offen offset:1024 sc1
    v_accvgpr_read_b32 v32, a88
    v_accvgpr_read_b32 v33, a89
    v_accvgpr_read_b32 v34, a90
    v_accvgpr_read_b32 v35, a91
    v_accvgpr_read_b32 v36, a120
    v_accvgpr_read_b32 v37, a121
    v_accvgpr_read_b32 v38, a122
    v_accvgpr_read_b32 v39, a123
    v_cvt_pk_bf16_f32 v40, v32, v33
    v_cvt_pk_bf16_f32 v41, v34, v35
    v_cvt_pk_bf16_f32 v42, v36, v37
    v_cvt_pk_bf16_f32 v43, v38, v39
    buffer_store_dwordx4 v[40:43], v251, s[4:7], s53 offen offset:2048 sc1
    v_accvgpr_read_b32 v48, a92
    v_accvgpr_read_b32 v49, a93
    v_accvgpr_read_b32 v50, a94
    v_accvgpr_read_b32 v51, a95
    v_accvgpr_read_b32 v52, a124
    v_accvgpr_read_b32 v53, a125
    v_accvgpr_read_b32 v54, a126
    v_accvgpr_read_b32 v55, a127
    v_cvt_pk_bf16_f32 v56, v48, v49
    v_cvt_pk_bf16_f32 v57, v50, v51
    v_cvt_pk_bf16_f32 v58, v52, v53
    v_cvt_pk_bf16_f32 v59, v54, v55
    buffer_store_dwordx4 v[56:59], v251, s[4:7], s53 offen offset:3072 sc1
    s_add_u32 s53, s53, 258048
    s_branch main_kernel_w_done
main_kernel_w_c2_task:
    s_cmp_eq_u32 s23, 0
    s_cbranch_scc1 main_kernel_w_c2_set0
    s_cmp_eq_u32 s23, 1
    s_cbranch_scc1 main_kernel_w_c2_set1
    s_cmp_eq_u32 s23, 2
    s_cbranch_scc1 main_kernel_w_c2_set2
    s_cmp_eq_u32 s23, 6
    s_cbranch_scc1 main_kernel_w_c2_set6
    s_branch main_kernel_w_done
main_kernel_w_c2_set0:
    s_lshl_b32 s32, s25, 8
    s_add_u32 s8, s40, s32
    s_addc_u32 s9, s41, 0
    s_and_b32 s9, s9, 0xffff
    s_sub_u32 s10, 0x800000, s32
    s_mov_b32 s11, 0x20000
    s_mov_b32 s30, 8192
    s_mov_b32 s31, 32768
    s_mul_i32 s16, s24, 262144
    s_add_u32 s16, s16, 0x0
    s_mov_b32 s18, 7
    s_lshl_b32 s32, s24, 3
    s_mul_i32 s33, s38, 8
    s_add_u32 s32, s32, s33
    s_mul_i32 s32, s32, 131072
    s_lshl_b32 s33, s25, 12
    s_add_u32 s32, s32, s33
    s_mul_i32 s33, s37, 4096
    s_add_u32 s32, s32, s33
    s_add_u32 s21, s32, 0x800000
    s_mov_b32 s22, 131072
    s_mov_b32 s26, -1
    s_branch main_kernel_w_c2_go
main_kernel_w_c2_set1:
    s_lshl_b32 s32, s25, 8
    s_add_u32 s8, s42, s32
    s_addc_u32 s9, s43, 0
    s_and_b32 s9, s9, 0xffff
    s_sub_u32 s10, 0x800000, s32
    s_mov_b32 s11, 0x20000
    s_mov_b32 s30, 8192
    s_mov_b32 s31, 32768
    s_mul_i32 s16, s24, 262144
    s_add_u32 s16, s16, 0x0
    s_mov_b32 s18, 7
    s_lshl_b32 s32, s24, 3
    s_mul_i32 s33, s38, 8
    s_add_u32 s32, s32, s33
    s_mul_i32 s32, s32, 131072
    s_lshl_b32 s33, s25, 12
    s_add_u32 s32, s32, s33
    s_mul_i32 s33, s37, 4096
    s_add_u32 s32, s32, s33
    s_add_u32 s21, s32, 0x1800000
    s_mov_b32 s22, 131072
    s_mov_b32 s26, -1
    s_branch main_kernel_w_c2_go
main_kernel_w_c2_set2:
    s_lshl_b32 s32, s25, 8
    s_add_u32 s8, s44, s32
    s_addc_u32 s9, s45, 0
    s_and_b32 s9, s9, 0xffff
    s_sub_u32 s10, 0x800000, s32
    s_mov_b32 s11, 0x20000
    s_mov_b32 s30, 8192
    s_mov_b32 s31, 32768
    s_mul_i32 s16, s24, 262144
    s_add_u32 s16, s16, 0x0
    s_mov_b32 s18, 7
    s_lshl_b32 s32, s24, 2
    s_mul_i32 s33, s38, 4
    s_add_u32 s32, s32, s33
    s_lshl_b32 s32, s32, 18
    s_lshl_b32 s33, s25, 13
    s_add_u32 s32, s32, s33
    s_mul_i32 s33, s37, 8192
    s_add_u32 s32, s32, s33
    s_add_u32 s21, s32, 0x2800000
    s_branch main_kernel_w_c2_gov
main_kernel_w_c2_set6:
    s_lshl_b32 s32, s25, 8
    s_add_u32 s8, s68, s32
    s_addc_u32 s9, s69, 0
    s_and_b32 s9, s9, 0xffff
    s_sub_u32 s10, 0x700000, s32
    s_mov_b32 s11, 0x20000
    s_mov_b32 s30, 7168
    s_mov_b32 s31, 32768
    s_mul_i32 s16, s24, 262144
    s_add_u32 s16, s16, 0x6800000
    s_mov_b32 s18, 7
    s_lshl_b32 s32, s24, 3
    s_mul_i32 s33, s38, 8
    s_add_u32 s32, s32, s33
    s_mul_i32 s32, s32, 114688
    s_lshl_b32 s33, s25, 12
    s_add_u32 s32, s32, s33
    s_mul_i32 s33, s37, 4096
    s_add_u32 s32, s32, s33
    s_add_u32 s21, s32, 0x5400000
    s_mov_b32 s22, 114688
    s_mov_b32 s26, -1
    s_branch main_kernel_w_c2_go
main_kernel_w_c2_go:
    v_lshrrev_b32 v0, 4, v250
    v_bfe_u32 v1, v250, 2, 2
    v_lshl_add_u32 v4, v0, 2, v1
    v_and_b32 v5, 7, v4
    v_mul_u32_u24 v4, 512, v4
    v_and_b32 v6, 3, v250
    v_lshl_add_u32 v4, v6, 3, v4
    s_mul_i32 s32, s37, 8
    v_xor_b32 v5, s32, v5
    v_lshl_add_u32 v128, v5, 5, v4
    v_xor_b32 v129, 32, v128
    v_xor_b32 v130, 64, v128
    v_xor_b32 v131, 96, v128
    v_xor_b32 v132, 128, v128
    v_xor_b32 v133, 160, v128
    v_xor_b32 v134, 192, v128
    v_xor_b32 v135, 224, v128
    s_mul_i32 s32, s38, 8192
    s_add_u32 s32, s32, 65536
    v_add_u32 v136, s32, v251
    v_lshrrev_b32 v2, 5, v250
    v_and_b32 v3, 31, v250
    s_mul_i32 s32, s14, 8
    v_add_u32 v4, s32, v2
    v_add_u32 v5, 0, v4
    v_and_b32 v6, 7, v5
    v_lshlrev_b32 v6, 1, v6
    v_xor_b32 v6, v6, v3
    v_mul_lo_u32 v5, v5, s30
    v_lshl_add_u32 v5, v6, 4, v5
    v_subrev_u32 v137, 0, v5
    v_add_u32 v5, 2, v4
    v_and_b32 v6, 7, v5
    v_lshlrev_b32 v6, 1, v6
    v_xor_b32 v6, v6, v3
    v_mul_lo_u32 v5, v5, s30
    v_lshl_add_u32 v5, v6, 4, v5
    v_subrev_u32 v138, 1024, v5
    v_add_u32 v5, 4, v4
    v_and_b32 v6, 7, v5
    v_lshlrev_b32 v6, 1, v6
    v_xor_b32 v6, v6, v3
    v_mul_lo_u32 v5, v5, s30
    v_lshl_add_u32 v5, v6, 4, v5
    v_subrev_u32 v139, 2048, v5
    v_add_u32 v5, 6, v4
    v_and_b32 v6, 7, v5
    v_lshlrev_b32 v6, 1, v6
    v_xor_b32 v6, v6, v3
    v_mul_lo_u32 v5, v5, s30
    v_lshl_add_u32 v5, v6, 4, v5
    v_subrev_u32 v140, 3072, v5
    s_mul_i32 s32, s14, 4
    s_mul_i32 s32, s32, s31
    v_add_u32 v141, s32, v251
    s_add_u32 s32, s32, s31
    s_sub_u32 s32, s32, 1024
    v_add_u32 v142, s32, v251
    s_add_u32 s32, s32, s31
    s_sub_u32 s32, s32, 1024
    v_add_u32 v143, s32, v251
    s_add_u32 s32, s32, s31
    s_sub_u32 s32, s32, 1024
    v_add_u32 v144, s32, v251
    s_mul_i32 s19, s14, 4096
    s_mul_i32 s20, s14, 4096
    s_add_u32 s20, s20, 65536
    s_mul_i32 s17, s30, 32
    s_mov_b32 s15, 0
    s_add_u32 m0, s20, 0
    s_nop 0
    buffer_load_dwordx4 v141, s[4:7], s16 offen offset:0 sc1 lds
    buffer_load_dwordx4 v142, s[4:7], s16 offen offset:1024 sc1 lds
    buffer_load_dwordx4 v143, s[4:7], s16 offen offset:2048 sc1 lds
    buffer_load_dwordx4 v144, s[4:7], s16 offen offset:3072 sc1 lds
    s_add_u32 s16, s16, 1024
    s_add_u32 m0, s19, 0
    s_nop 0
    buffer_load_dwordx4 v137, s[8:11], s15 offen offset:0 lds
    buffer_load_dwordx4 v138, s[8:11], s15 offen offset:1024 lds
    buffer_load_dwordx4 v139, s[8:11], s15 offen offset:2048 lds
    buffer_load_dwordx4 v140, s[8:11], s15 offen offset:3072 lds
    s_add_u32 s15, s15, s17
    s_add_u32 m0, s20, 16384
    s_nop 0
    buffer_load_dwordx4 v141, s[4:7], s16 offen offset:0 sc1 lds
    buffer_load_dwordx4 v142, s[4:7], s16 offen offset:1024 sc1 lds
    buffer_load_dwordx4 v143, s[4:7], s16 offen offset:2048 sc1 lds
    buffer_load_dwordx4 v144, s[4:7], s16 offen offset:3072 sc1 lds
    s_add_u32 s16, s16, 1024
    s_add_u32 m0, s19, 16384
    s_nop 0
    buffer_load_dwordx4 v137, s[8:11], s15 offen offset:0 lds
    buffer_load_dwordx4 v138, s[8:11], s15 offen offset:1024 lds
    buffer_load_dwordx4 v139, s[8:11], s15 offen offset:2048 lds
    buffer_load_dwordx4 v140, s[8:11], s15 offen offset:3072 lds
    s_add_u32 s15, s15, s17
    s_add_u32 m0, s20, 32768
    s_nop 0
    buffer_load_dwordx4 v141, s[4:7], s16 offen offset:0 sc1 lds
    buffer_load_dwordx4 v142, s[4:7], s16 offen offset:1024 sc1 lds
    buffer_load_dwordx4 v143, s[4:7], s16 offen offset:2048 sc1 lds
    buffer_load_dwordx4 v144, s[4:7], s16 offen offset:3072 sc1 lds
    s_add_u32 s16, s16, 1024
    s_add_u32 m0, s19, 32768
    s_nop 0
    buffer_load_dwordx4 v137, s[8:11], s15 offen offset:0 lds
    buffer_load_dwordx4 v138, s[8:11], s15 offen offset:1024 lds
    buffer_load_dwordx4 v139, s[8:11], s15 offen offset:2048 lds
    buffer_load_dwordx4 v140, s[8:11], s15 offen offset:3072 lds
    s_add_u32 s15, s15, s17
    s_add_u32 m0, s20, 49152
    s_nop 0
    buffer_load_dwordx4 v141, s[4:7], s16 offen offset:0 sc1 lds
    buffer_load_dwordx4 v142, s[4:7], s16 offen offset:1024 sc1 lds
    buffer_load_dwordx4 v143, s[4:7], s16 offen offset:2048 sc1 lds
    buffer_load_dwordx4 v144, s[4:7], s16 offen offset:3072 sc1 lds
    s_add_u32 s16, s16, 1024
    s_add_u32 m0, s19, 49152
    s_nop 0
    buffer_load_dwordx4 v137, s[8:11], s15 offen offset:0 lds
    buffer_load_dwordx4 v138, s[8:11], s15 offen offset:1024 lds
    buffer_load_dwordx4 v139, s[8:11], s15 offen offset:2048 lds
    buffer_load_dwordx4 v140, s[8:11], s15 offen offset:3072 lds
    s_add_u32 s15, s15, s17
    v_accvgpr_write_b32 a0, 0
    v_accvgpr_write_b32 a1, 0
    v_accvgpr_write_b32 a2, 0
    v_accvgpr_write_b32 a3, 0
    v_accvgpr_write_b32 a4, 0
    v_accvgpr_write_b32 a5, 0
    v_accvgpr_write_b32 a6, 0
    v_accvgpr_write_b32 a7, 0
    v_accvgpr_write_b32 a8, 0
    v_accvgpr_write_b32 a9, 0
    v_accvgpr_write_b32 a10, 0
    v_accvgpr_write_b32 a11, 0
    v_accvgpr_write_b32 a12, 0
    v_accvgpr_write_b32 a13, 0
    v_accvgpr_write_b32 a14, 0
    v_accvgpr_write_b32 a15, 0
    v_accvgpr_write_b32 a16, 0
    v_accvgpr_write_b32 a17, 0
    v_accvgpr_write_b32 a18, 0
    v_accvgpr_write_b32 a19, 0
    v_accvgpr_write_b32 a20, 0
    v_accvgpr_write_b32 a21, 0
    v_accvgpr_write_b32 a22, 0
    v_accvgpr_write_b32 a23, 0
    v_accvgpr_write_b32 a24, 0
    v_accvgpr_write_b32 a25, 0
    v_accvgpr_write_b32 a26, 0
    v_accvgpr_write_b32 a27, 0
    v_accvgpr_write_b32 a28, 0
    v_accvgpr_write_b32 a29, 0
    v_accvgpr_write_b32 a30, 0
    v_accvgpr_write_b32 a31, 0
    v_accvgpr_write_b32 a32, 0
    v_accvgpr_write_b32 a33, 0
    v_accvgpr_write_b32 a34, 0
    v_accvgpr_write_b32 a35, 0
    v_accvgpr_write_b32 a36, 0
    v_accvgpr_write_b32 a37, 0
    v_accvgpr_write_b32 a38, 0
    v_accvgpr_write_b32 a39, 0
    v_accvgpr_write_b32 a40, 0
    v_accvgpr_write_b32 a41, 0
    v_accvgpr_write_b32 a42, 0
    v_accvgpr_write_b32 a43, 0
    v_accvgpr_write_b32 a44, 0
    v_accvgpr_write_b32 a45, 0
    v_accvgpr_write_b32 a46, 0
    v_accvgpr_write_b32 a47, 0
    v_accvgpr_write_b32 a48, 0
    v_accvgpr_write_b32 a49, 0
    v_accvgpr_write_b32 a50, 0
    v_accvgpr_write_b32 a51, 0
    v_accvgpr_write_b32 a52, 0
    v_accvgpr_write_b32 a53, 0
    v_accvgpr_write_b32 a54, 0
    v_accvgpr_write_b32 a55, 0
    v_accvgpr_write_b32 a56, 0
    v_accvgpr_write_b32 a57, 0
    v_accvgpr_write_b32 a58, 0
    v_accvgpr_write_b32 a59, 0
    v_accvgpr_write_b32 a60, 0
    v_accvgpr_write_b32 a61, 0
    v_accvgpr_write_b32 a62, 0
    v_accvgpr_write_b32 a63, 0
    v_accvgpr_write_b32 a64, 0
    v_accvgpr_write_b32 a65, 0
    v_accvgpr_write_b32 a66, 0
    v_accvgpr_write_b32 a67, 0
    v_accvgpr_write_b32 a68, 0
    v_accvgpr_write_b32 a69, 0
    v_accvgpr_write_b32 a70, 0
    v_accvgpr_write_b32 a71, 0
    v_accvgpr_write_b32 a72, 0
    v_accvgpr_write_b32 a73, 0
    v_accvgpr_write_b32 a74, 0
    v_accvgpr_write_b32 a75, 0
    v_accvgpr_write_b32 a76, 0
    v_accvgpr_write_b32 a77, 0
    v_accvgpr_write_b32 a78, 0
    v_accvgpr_write_b32 a79, 0
    v_accvgpr_write_b32 a80, 0
    v_accvgpr_write_b32 a81, 0
    v_accvgpr_write_b32 a82, 0
    v_accvgpr_write_b32 a83, 0
    v_accvgpr_write_b32 a84, 0
    v_accvgpr_write_b32 a85, 0
    v_accvgpr_write_b32 a86, 0
    v_accvgpr_write_b32 a87, 0
    v_accvgpr_write_b32 a88, 0
    v_accvgpr_write_b32 a89, 0
    v_accvgpr_write_b32 a90, 0
    v_accvgpr_write_b32 a91, 0
    v_accvgpr_write_b32 a92, 0
    v_accvgpr_write_b32 a93, 0
    v_accvgpr_write_b32 a94, 0
    v_accvgpr_write_b32 a95, 0
    v_accvgpr_write_b32 a96, 0
    v_accvgpr_write_b32 a97, 0
    v_accvgpr_write_b32 a98, 0
    v_accvgpr_write_b32 a99, 0
    v_accvgpr_write_b32 a100, 0
    v_accvgpr_write_b32 a101, 0
    v_accvgpr_write_b32 a102, 0
    v_accvgpr_write_b32 a103, 0
    v_accvgpr_write_b32 a104, 0
    v_accvgpr_write_b32 a105, 0
    v_accvgpr_write_b32 a106, 0
    v_accvgpr_write_b32 a107, 0
    v_accvgpr_write_b32 a108, 0
    v_accvgpr_write_b32 a109, 0
    v_accvgpr_write_b32 a110, 0
    v_accvgpr_write_b32 a111, 0
    v_accvgpr_write_b32 a112, 0
    v_accvgpr_write_b32 a113, 0
    v_accvgpr_write_b32 a114, 0
    v_accvgpr_write_b32 a115, 0
    v_accvgpr_write_b32 a116, 0
    v_accvgpr_write_b32 a117, 0
    v_accvgpr_write_b32 a118, 0
    v_accvgpr_write_b32 a119, 0
    v_accvgpr_write_b32 a120, 0
    v_accvgpr_write_b32 a121, 0
    v_accvgpr_write_b32 a122, 0
    v_accvgpr_write_b32 a123, 0
    v_accvgpr_write_b32 a124, 0
    v_accvgpr_write_b32 a125, 0
    v_accvgpr_write_b32 a126, 0
    v_accvgpr_write_b32 a127, 0
    v_accvgpr_write_b32 a128, 0
    v_accvgpr_write_b32 a129, 0
    v_accvgpr_write_b32 a130, 0
    v_accvgpr_write_b32 a131, 0
    v_accvgpr_write_b32 a132, 0
    v_accvgpr_write_b32 a133, 0
    v_accvgpr_write_b32 a134, 0
    v_accvgpr_write_b32 a135, 0
    v_accvgpr_write_b32 a136, 0
    v_accvgpr_write_b32 a137, 0
    v_accvgpr_write_b32 a138, 0
    v_accvgpr_write_b32 a139, 0
    v_accvgpr_write_b32 a140, 0
    v_accvgpr_write_b32 a141, 0
    v_accvgpr_write_b32 a142, 0
    v_accvgpr_write_b32 a143, 0
    v_accvgpr_write_b32 a144, 0
    v_accvgpr_write_b32 a145, 0
    v_accvgpr_write_b32 a146, 0
    v_accvgpr_write_b32 a147, 0
    v_accvgpr_write_b32 a148, 0
    v_accvgpr_write_b32 a149, 0
    v_accvgpr_write_b32 a150, 0
    v_accvgpr_write_b32 a151, 0
    v_accvgpr_write_b32 a152, 0
    v_accvgpr_write_b32 a153, 0
    v_accvgpr_write_b32 a154, 0
    v_accvgpr_write_b32 a155, 0
    v_accvgpr_write_b32 a156, 0
    v_accvgpr_write_b32 a157, 0
    v_accvgpr_write_b32 a158, 0
    v_accvgpr_write_b32 a159, 0
    v_accvgpr_write_b32 a160, 0
    v_accvgpr_write_b32 a161, 0
    v_accvgpr_write_b32 a162, 0
    v_accvgpr_write_b32 a163, 0
    v_accvgpr_write_b32 a164, 0
    v_accvgpr_write_b32 a165, 0
    v_accvgpr_write_b32 a166, 0
    v_accvgpr_write_b32 a167, 0
    v_accvgpr_write_b32 a168, 0
    v_accvgpr_write_b32 a169, 0
    v_accvgpr_write_b32 a170, 0
    v_accvgpr_write_b32 a171, 0
    v_accvgpr_write_b32 a172, 0
    v_accvgpr_write_b32 a173, 0
    v_accvgpr_write_b32 a174, 0
    v_accvgpr_write_b32 a175, 0
    v_accvgpr_write_b32 a176, 0
    v_accvgpr_write_b32 a177, 0
    v_accvgpr_write_b32 a178, 0
    v_accvgpr_write_b32 a179, 0
    v_accvgpr_write_b32 a180, 0
    v_accvgpr_write_b32 a181, 0
    v_accvgpr_write_b32 a182, 0
    v_accvgpr_write_b32 a183, 0
    v_accvgpr_write_b32 a184, 0
    v_accvgpr_write_b32 a185, 0
    v_accvgpr_write_b32 a186, 0
    v_accvgpr_write_b32 a187, 0
    v_accvgpr_write_b32 a188, 0
    v_accvgpr_write_b32 a189, 0
    v_accvgpr_write_b32 a190, 0
    v_accvgpr_write_b32 a191, 0
    v_accvgpr_write_b32 a192, 0
    v_accvgpr_write_b32 a193, 0
    v_accvgpr_write_b32 a194, 0
    v_accvgpr_write_b32 a195, 0
    v_accvgpr_write_b32 a196, 0
    v_accvgpr_write_b32 a197, 0
    v_accvgpr_write_b32 a198, 0
    v_accvgpr_write_b32 a199, 0
    v_accvgpr_write_b32 a200, 0
    v_accvgpr_write_b32 a201, 0
    v_accvgpr_write_b32 a202, 0
    v_accvgpr_write_b32 a203, 0
    v_accvgpr_write_b32 a204, 0
    v_accvgpr_write_b32 a205, 0
    v_accvgpr_write_b32 a206, 0
    v_accvgpr_write_b32 a207, 0
    v_accvgpr_write_b32 a208, 0
    v_accvgpr_write_b32 a209, 0
    v_accvgpr_write_b32 a210, 0
    v_accvgpr_write_b32 a211, 0
    v_accvgpr_write_b32 a212, 0
    v_accvgpr_write_b32 a213, 0
    v_accvgpr_write_b32 a214, 0
    v_accvgpr_write_b32 a215, 0
    v_accvgpr_write_b32 a216, 0
    v_accvgpr_write_b32 a217, 0
    v_accvgpr_write_b32 a218, 0
    v_accvgpr_write_b32 a219, 0
    v_accvgpr_write_b32 a220, 0
    v_accvgpr_write_b32 a221, 0
    v_accvgpr_write_b32 a222, 0
    v_accvgpr_write_b32 a223, 0
    v_accvgpr_write_b32 a224, 0
    v_accvgpr_write_b32 a225, 0
    v_accvgpr_write_b32 a226, 0
    v_accvgpr_write_b32 a227, 0
    v_accvgpr_write_b32 a228, 0
    v_accvgpr_write_b32 a229, 0
    v_accvgpr_write_b32 a230, 0
    v_accvgpr_write_b32 a231, 0
    v_accvgpr_write_b32 a232, 0
    v_accvgpr_write_b32 a233, 0
    v_accvgpr_write_b32 a234, 0
    v_accvgpr_write_b32 a235, 0
    v_accvgpr_write_b32 a236, 0
    v_accvgpr_write_b32 a237, 0
    v_accvgpr_write_b32 a238, 0
    v_accvgpr_write_b32 a239, 0
    v_accvgpr_write_b32 a240, 0
    v_accvgpr_write_b32 a241, 0
    v_accvgpr_write_b32 a242, 0
    v_accvgpr_write_b32 a243, 0
    v_accvgpr_write_b32 a244, 0
    v_accvgpr_write_b32 a245, 0
    v_accvgpr_write_b32 a246, 0
    v_accvgpr_write_b32 a247, 0
    v_accvgpr_write_b32 a248, 0
    v_accvgpr_write_b32 a249, 0
    v_accvgpr_write_b32 a250, 0
    v_accvgpr_write_b32 a251, 0
    v_accvgpr_write_b32 a252, 0
    v_accvgpr_write_b32 a253, 0
    v_accvgpr_write_b32 a254, 0
    v_accvgpr_write_b32 a255, 0
    s_waitcnt vmcnt(24)
    s_barrier
    ds_read_b128 v[32:35], v136 offset:0
    ds_read_b64_tr_b16 v[0:1], v128 offset:0
    ds_read_b64_tr_b16 v[2:3], v128 offset:8192
    ds_read_b64_tr_b16 v[4:5], v129 offset:0
    ds_read_b64_tr_b16 v[6:7], v129 offset:8192
    ds_read_b64_tr_b16 v[8:9], v130 offset:0
    ds_read_b64_tr_b16 v[10:11], v130 offset:8192
    ds_read_b64_tr_b16 v[12:13], v131 offset:0
    ds_read_b64_tr_b16 v[14:15], v131 offset:8192
    ds_read_b64_tr_b16 v[16:17], v132 offset:0
    ds_read_b64_tr_b16 v[18:19], v132 offset:8192
    ds_read_b64_tr_b16 v[20:21], v133 offset:0
    ds_read_b64_tr_b16 v[22:23], v133 offset:8192
    ds_read_b64_tr_b16 v[24:25], v134 offset:0
    ds_read_b64_tr_b16 v[26:27], v134 offset:8192
    ds_read_b64_tr_b16 v[28:29], v135 offset:0
    ds_read_b64_tr_b16 v[30:31], v135 offset:8192
    ds_read_b128 v[36:39], v136 offset:1024
    ds_read_b128 v[40:43], v136 offset:2048
    ds_read_b128 v[44:47], v136 offset:3072
    ds_read_b128 v[48:51], v136 offset:4096
    ds_read_b128 v[52:55], v136 offset:5120
    ds_read_b128 v[56:59], v136 offset:6144
    ds_read_b128 v[60:63], v136 offset:7168
main_kernel_w_c2_n_loop:
    s_waitcnt lgkmcnt(0)
    v_mfma_f32_16x16x32_bf16 a[0:3], v[0:3], v[32:35], a[0:3]
    s_waitcnt vmcnt(16)
    s_barrier
    ds_read_b128 v[96:99], v136 offset:16384
    s_add_u32 m0, s20, 0
    s_nop 0
    v_mfma_f32_16x16x32_bf16 a[4:7], v[4:7], v[32:35], a[4:7]
    ds_read_b64_tr_b16 v[64:65], v128 offset:16384
    v_mfma_f32_16x16x32_bf16 a[8:11], v[8:11], v[32:35], a[8:11]
    ds_read_b64_tr_b16 v[66:67], v128 offset:24576
    v_mfma_f32_16x16x32_bf16 a[12:15], v[12:15], v[32:35], a[12:15]
    ds_read_b64_tr_b16 v[68:69], v129 offset:16384
    v_mfma_f32_16x16x32_bf16 a[16:19], v[16:19], v[32:35], a[16:19]
    ds_read_b64_tr_b16 v[70:71], v129 offset:24576
    v_mfma_f32_16x16x32_bf16 a[20:23], v[20:23], v[32:35], a[20:23]
    ds_read_b64_tr_b16 v[72:73], v130 offset:16384
    buffer_load_dwordx4 v141, s[4:7], s16 offen offset:0 sc1 lds
    v_mfma_f32_16x16x32_bf16 a[24:27], v[24:27], v[32:35], a[24:27]
    ds_read_b64_tr_b16 v[74:75], v130 offset:24576
    v_mfma_f32_16x16x32_bf16 a[28:31], v[28:31], v[32:35], a[28:31]
    ds_read_b64_tr_b16 v[76:77], v131 offset:16384
    v_mfma_f32_16x16x32_bf16 a[32:35], v[0:3], v[36:39], a[32:35]
    ds_read_b64_tr_b16 v[78:79], v131 offset:24576
    v_mfma_f32_16x16x32_bf16 a[36:39], v[4:7], v[36:39], a[36:39]
    ds_read_b64_tr_b16 v[80:81], v132 offset:16384
    v_mfma_f32_16x16x32_bf16 a[40:43], v[8:11], v[36:39], a[40:43]
    ds_read_b64_tr_b16 v[82:83], v132 offset:24576
    buffer_load_dwordx4 v142, s[4:7], s16 offen offset:1024 sc1 lds
    v_mfma_f32_16x16x32_bf16 a[44:47], v[12:15], v[36:39], a[44:47]
    ds_read_b64_tr_b16 v[84:85], v133 offset:16384
    v_mfma_f32_16x16x32_bf16 a[48:51], v[16:19], v[36:39], a[48:51]
    ds_read_b64_tr_b16 v[86:87], v133 offset:24576
    v_mfma_f32_16x16x32_bf16 a[52:55], v[20:23], v[36:39], a[52:55]
    ds_read_b64_tr_b16 v[88:89], v134 offset:16384
    v_mfma_f32_16x16x32_bf16 a[56:59], v[24:27], v[36:39], a[56:59]
    ds_read_b64_tr_b16 v[90:91], v134 offset:24576
    v_mfma_f32_16x16x32_bf16 a[60:63], v[28:31], v[36:39], a[60:63]
    ds_read_b64_tr_b16 v[92:93], v135 offset:16384
    buffer_load_dwordx4 v143, s[4:7], s16 offen offset:2048 sc1 lds
    v_mfma_f32_16x16x32_bf16 a[64:67], v[0:3], v[40:43], a[64:67]
    ds_read_b64_tr_b16 v[94:95], v135 offset:24576
    v_mfma_f32_16x16x32_bf16 a[68:71], v[4:7], v[40:43], a[68:71]
    ds_read_b128 v[100:103], v136 offset:17408
    v_mfma_f32_16x16x32_bf16 a[72:75], v[8:11], v[40:43], a[72:75]
    ds_read_b128 v[104:107], v136 offset:18432
    v_mfma_f32_16x16x32_bf16 a[76:79], v[12:15], v[40:43], a[76:79]
    ds_read_b128 v[108:111], v136 offset:19456
    v_mfma_f32_16x16x32_bf16 a[80:83], v[16:19], v[40:43], a[80:83]
    ds_read_b128 v[112:115], v136 offset:20480
    v_mfma_f32_16x16x32_bf16 a[84:87], v[20:23], v[40:43], a[84:87]
    ds_read_b128 v[116:119], v136 offset:21504
    buffer_load_dwordx4 v144, s[4:7], s16 offen offset:3072 sc1 lds
    v_mfma_f32_16x16x32_bf16 a[88:91], v[24:27], v[40:43], a[88:91]
    ds_read_b128 v[120:123], v136 offset:22528
    v_mfma_f32_16x16x32_bf16 a[92:95], v[28:31], v[40:43], a[92:95]
    ds_read_b128 v[124:127], v136 offset:23552
    v_mfma_f32_16x16x32_bf16 a[96:99], v[0:3], v[44:47], a[96:99]
    v_mfma_f32_16x16x32_bf16 a[100:103], v[4:7], v[44:47], a[100:103]
    v_mfma_f32_16x16x32_bf16 a[104:107], v[8:11], v[44:47], a[104:107]
    s_add_u32 s16, s16, 1024
    v_mfma_f32_16x16x32_bf16 a[108:111], v[12:15], v[44:47], a[108:111]
    v_mfma_f32_16x16x32_bf16 a[112:115], v[16:19], v[44:47], a[112:115]
    v_mfma_f32_16x16x32_bf16 a[116:119], v[20:23], v[44:47], a[116:119]
    v_mfma_f32_16x16x32_bf16 a[120:123], v[24:27], v[44:47], a[120:123]
    v_mfma_f32_16x16x32_bf16 a[124:127], v[28:31], v[44:47], a[124:127]
    s_add_u32 m0, s19, 0
    s_nop 0
    v_mfma_f32_16x16x32_bf16 a[128:131], v[0:3], v[48:51], a[128:131]
    v_mfma_f32_16x16x32_bf16 a[132:135], v[4:7], v[48:51], a[132:135]
    v_mfma_f32_16x16x32_bf16 a[136:139], v[8:11], v[48:51], a[136:139]
    v_mfma_f32_16x16x32_bf16 a[140:143], v[12:15], v[48:51], a[140:143]
    v_mfma_f32_16x16x32_bf16 a[144:147], v[16:19], v[48:51], a[144:147]
    buffer_load_dwordx4 v137, s[8:11], s15 offen offset:0 lds
    v_mfma_f32_16x16x32_bf16 a[148:151], v[20:23], v[48:51], a[148:151]
    v_mfma_f32_16x16x32_bf16 a[152:155], v[24:27], v[48:51], a[152:155]
    v_mfma_f32_16x16x32_bf16 a[156:159], v[28:31], v[48:51], a[156:159]
    v_mfma_f32_16x16x32_bf16 a[160:163], v[0:3], v[52:55], a[160:163]
    v_mfma_f32_16x16x32_bf16 a[164:167], v[4:7], v[52:55], a[164:167]
    v_mfma_f32_16x16x32_bf16 a[168:171], v[8:11], v[52:55], a[168:171]
    buffer_load_dwordx4 v138, s[8:11], s15 offen offset:1024 lds
    v_mfma_f32_16x16x32_bf16 a[172:175], v[12:15], v[52:55], a[172:175]
    v_mfma_f32_16x16x32_bf16 a[176:179], v[16:19], v[52:55], a[176:179]
    v_mfma_f32_16x16x32_bf16 a[180:183], v[20:23], v[52:55], a[180:183]
    v_mfma_f32_16x16x32_bf16 a[184:187], v[24:27], v[52:55], a[184:187]
    v_mfma_f32_16x16x32_bf16 a[188:191], v[28:31], v[52:55], a[188:191]
    buffer_load_dwordx4 v139, s[8:11], s15 offen offset:2048 lds
    v_mfma_f32_16x16x32_bf16 a[192:195], v[0:3], v[56:59], a[192:195]
    v_mfma_f32_16x16x32_bf16 a[196:199], v[4:7], v[56:59], a[196:199]
    v_mfma_f32_16x16x32_bf16 a[200:203], v[8:11], v[56:59], a[200:203]
    v_mfma_f32_16x16x32_bf16 a[204:207], v[12:15], v[56:59], a[204:207]
    v_mfma_f32_16x16x32_bf16 a[208:211], v[16:19], v[56:59], a[208:211]
    buffer_load_dwordx4 v140, s[8:11], s15 offen offset:3072 lds
    v_mfma_f32_16x16x32_bf16 a[212:215], v[20:23], v[56:59], a[212:215]
    v_mfma_f32_16x16x32_bf16 a[216:219], v[24:27], v[56:59], a[216:219]
    v_mfma_f32_16x16x32_bf16 a[220:223], v[28:31], v[56:59], a[220:223]
    v_mfma_f32_16x16x32_bf16 a[224:227], v[0:3], v[60:63], a[224:227]
    v_mfma_f32_16x16x32_bf16 a[228:231], v[4:7], v[60:63], a[228:231]
    s_add_u32 s15, s15, s17
    v_mfma_f32_16x16x32_bf16 a[232:235], v[8:11], v[60:63], a[232:235]
    v_mfma_f32_16x16x32_bf16 a[236:239], v[12:15], v[60:63], a[236:239]
    v_mfma_f32_16x16x32_bf16 a[240:243], v[16:19], v[60:63], a[240:243]
    v_mfma_f32_16x16x32_bf16 a[244:247], v[20:23], v[60:63], a[244:247]
    v_mfma_f32_16x16x32_bf16 a[248:251], v[24:27], v[60:63], a[248:251]
    v_mfma_f32_16x16x32_bf16 a[252:255], v[28:31], v[60:63], a[252:255]
    s_waitcnt lgkmcnt(0)
    v_mfma_f32_16x16x32_bf16 a[0:3], v[64:67], v[96:99], a[0:3]
    s_waitcnt vmcnt(16)
    s_barrier
    ds_read_b128 v[32:35], v136 offset:32768
    s_add_u32 m0, s20, 16384
    s_nop 0
    v_mfma_f32_16x16x32_bf16 a[4:7], v[68:71], v[96:99], a[4:7]
    ds_read_b64_tr_b16 v[0:1], v128 offset:32768
    v_mfma_f32_16x16x32_bf16 a[8:11], v[72:75], v[96:99], a[8:11]
    ds_read_b64_tr_b16 v[2:3], v128 offset:40960
    v_mfma_f32_16x16x32_bf16 a[12:15], v[76:79], v[96:99], a[12:15]
    ds_read_b64_tr_b16 v[4:5], v129 offset:32768
    v_mfma_f32_16x16x32_bf16 a[16:19], v[80:83], v[96:99], a[16:19]
    ds_read_b64_tr_b16 v[6:7], v129 offset:40960
    v_mfma_f32_16x16x32_bf16 a[20:23], v[84:87], v[96:99], a[20:23]
    ds_read_b64_tr_b16 v[8:9], v130 offset:32768
    buffer_load_dwordx4 v141, s[4:7], s16 offen offset:0 sc1 lds
    v_mfma_f32_16x16x32_bf16 a[24:27], v[88:91], v[96:99], a[24:27]
    ds_read_b64_tr_b16 v[10:11], v130 offset:40960
    v_mfma_f32_16x16x32_bf16 a[28:31], v[92:95], v[96:99], a[28:31]
    ds_read_b64_tr_b16 v[12:13], v131 offset:32768
    v_mfma_f32_16x16x32_bf16 a[32:35], v[64:67], v[100:103], a[32:35]
    ds_read_b64_tr_b16 v[14:15], v131 offset:40960
    v_mfma_f32_16x16x32_bf16 a[36:39], v[68:71], v[100:103], a[36:39]
    ds_read_b64_tr_b16 v[16:17], v132 offset:32768
    v_mfma_f32_16x16x32_bf16 a[40:43], v[72:75], v[100:103], a[40:43]
    ds_read_b64_tr_b16 v[18:19], v132 offset:40960
    buffer_load_dwordx4 v142, s[4:7], s16 offen offset:1024 sc1 lds
    v_mfma_f32_16x16x32_bf16 a[44:47], v[76:79], v[100:103], a[44:47]
    ds_read_b64_tr_b16 v[20:21], v133 offset:32768
    v_mfma_f32_16x16x32_bf16 a[48:51], v[80:83], v[100:103], a[48:51]
    ds_read_b64_tr_b16 v[22:23], v133 offset:40960
    v_mfma_f32_16x16x32_bf16 a[52:55], v[84:87], v[100:103], a[52:55]
    ds_read_b64_tr_b16 v[24:25], v134 offset:32768
    v_mfma_f32_16x16x32_bf16 a[56:59], v[88:91], v[100:103], a[56:59]
    ds_read_b64_tr_b16 v[26:27], v134 offset:40960
    v_mfma_f32_16x16x32_bf16 a[60:63], v[92:95], v[100:103], a[60:63]
    ds_read_b64_tr_b16 v[28:29], v135 offset:32768
    buffer_load_dwordx4 v143, s[4:7], s16 offen offset:2048 sc1 lds
    v_mfma_f32_16x16x32_bf16 a[64:67], v[64:67], v[104:107], a[64:67]
    ds_read_b64_tr_b16 v[30:31], v135 offset:40960
    v_mfma_f32_16x16x32_bf16 a[68:71], v[68:71], v[104:107], a[68:71]
    ds_read_b128 v[36:39], v136 offset:33792
    v_mfma_f32_16x16x32_bf16 a[72:75], v[72:75], v[104:107], a[72:75]
    ds_read_b128 v[40:43], v136 offset:34816
    v_mfma_f32_16x16x32_bf16 a[76:79], v[76:79], v[104:107], a[76:79]
    ds_read_b128 v[44:47], v136 offset:35840
    v_mfma_f32_16x16x32_bf16 a[80:83], v[80:83], v[104:107], a[80:83]
    ds_read_b128 v[48:51], v136 offset:36864
    v_mfma_f32_16x16x32_bf16 a[84:87], v[84:87], v[104:107], a[84:87]
    ds_read_b128 v[52:55], v136 offset:37888
    buffer_load_dwordx4 v144, s[4:7], s16 offen offset:3072 sc1 lds
    v_mfma_f32_16x16x32_bf16 a[88:91], v[88:91], v[104:107], a[88:91]
    ds_read_b128 v[56:59], v136 offset:38912
    v_mfma_f32_16x16x32_bf16 a[92:95], v[92:95], v[104:107], a[92:95]
    ds_read_b128 v[60:63], v136 offset:39936
    v_mfma_f32_16x16x32_bf16 a[96:99], v[64:67], v[108:111], a[96:99]
    v_mfma_f32_16x16x32_bf16 a[100:103], v[68:71], v[108:111], a[100:103]
    v_mfma_f32_16x16x32_bf16 a[104:107], v[72:75], v[108:111], a[104:107]
    s_add_u32 s16, s16, 1024
    v_mfma_f32_16x16x32_bf16 a[108:111], v[76:79], v[108:111], a[108:111]
    v_mfma_f32_16x16x32_bf16 a[112:115], v[80:83], v[108:111], a[112:115]
    v_mfma_f32_16x16x32_bf16 a[116:119], v[84:87], v[108:111], a[116:119]
    v_mfma_f32_16x16x32_bf16 a[120:123], v[88:91], v[108:111], a[120:123]
    v_mfma_f32_16x16x32_bf16 a[124:127], v[92:95], v[108:111], a[124:127]
    s_add_u32 m0, s19, 16384
    s_nop 0
    v_mfma_f32_16x16x32_bf16 a[128:131], v[64:67], v[112:115], a[128:131]
    v_mfma_f32_16x16x32_bf16 a[132:135], v[68:71], v[112:115], a[132:135]
    v_mfma_f32_16x16x32_bf16 a[136:139], v[72:75], v[112:115], a[136:139]
    v_mfma_f32_16x16x32_bf16 a[140:143], v[76:79], v[112:115], a[140:143]
    v_mfma_f32_16x16x32_bf16 a[144:147], v[80:83], v[112:115], a[144:147]
    buffer_load_dwordx4 v137, s[8:11], s15 offen offset:0 lds
    v_mfma_f32_16x16x32_bf16 a[148:151], v[84:87], v[112:115], a[148:151]
    v_mfma_f32_16x16x32_bf16 a[152:155], v[88:91], v[112:115], a[152:155]
    v_mfma_f32_16x16x32_bf16 a[156:159], v[92:95], v[112:115], a[156:159]
    v_mfma_f32_16x16x32_bf16 a[160:163], v[64:67], v[116:119], a[160:163]
    v_mfma_f32_16x16x32_bf16 a[164:167], v[68:71], v[116:119], a[164:167]
    v_mfma_f32_16x16x32_bf16 a[168:171], v[72:75], v[116:119], a[168:171]
    buffer_load_dwordx4 v138, s[8:11], s15 offen offset:1024 lds
    v_mfma_f32_16x16x32_bf16 a[172:175], v[76:79], v[116:119], a[172:175]
    v_mfma_f32_16x16x32_bf16 a[176:179], v[80:83], v[116:119], a[176:179]
    v_mfma_f32_16x16x32_bf16 a[180:183], v[84:87], v[116:119], a[180:183]
    v_mfma_f32_16x16x32_bf16 a[184:187], v[88:91], v[116:119], a[184:187]
    v_mfma_f32_16x16x32_bf16 a[188:191], v[92:95], v[116:119], a[188:191]
    buffer_load_dwordx4 v139, s[8:11], s15 offen offset:2048 lds
    v_mfma_f32_16x16x32_bf16 a[192:195], v[64:67], v[120:123], a[192:195]
    v_mfma_f32_16x16x32_bf16 a[196:199], v[68:71], v[120:123], a[196:199]
    v_mfma_f32_16x16x32_bf16 a[200:203], v[72:75], v[120:123], a[200:203]
    v_mfma_f32_16x16x32_bf16 a[204:207], v[76:79], v[120:123], a[204:207]
    v_mfma_f32_16x16x32_bf16 a[208:211], v[80:83], v[120:123], a[208:211]
    buffer_load_dwordx4 v140, s[8:11], s15 offen offset:3072 lds
    v_mfma_f32_16x16x32_bf16 a[212:215], v[84:87], v[120:123], a[212:215]
    v_mfma_f32_16x16x32_bf16 a[216:219], v[88:91], v[120:123], a[216:219]
    v_mfma_f32_16x16x32_bf16 a[220:223], v[92:95], v[120:123], a[220:223]
    v_mfma_f32_16x16x32_bf16 a[224:227], v[64:67], v[124:127], a[224:227]
    v_mfma_f32_16x16x32_bf16 a[228:231], v[68:71], v[124:127], a[228:231]
    s_add_u32 s15, s15, s17
    v_mfma_f32_16x16x32_bf16 a[232:235], v[72:75], v[124:127], a[232:235]
    v_mfma_f32_16x16x32_bf16 a[236:239], v[76:79], v[124:127], a[236:239]
    v_mfma_f32_16x16x32_bf16 a[240:243], v[80:83], v[124:127], a[240:243]
    v_mfma_f32_16x16x32_bf16 a[244:247], v[84:87], v[124:127], a[244:247]
    v_mfma_f32_16x16x32_bf16 a[248:251], v[88:91], v[124:127], a[248:251]
    v_mfma_f32_16x16x32_bf16 a[252:255], v[92:95], v[124:127], a[252:255]
    s_waitcnt lgkmcnt(0)
    v_mfma_f32_16x16x32_bf16 a[0:3], v[0:3], v[32:35], a[0:3]
    s_waitcnt vmcnt(16)
    s_barrier
    ds_read_b128 v[96:99], v136 offset:49152
    s_add_u32 m0, s20, 32768
    s_nop 0
    v_mfma_f32_16x16x32_bf16 a[4:7], v[4:7], v[32:35], a[4:7]
    ds_read_b64_tr_b16 v[64:65], v128 offset:49152
    v_mfma_f32_16x16x32_bf16 a[8:11], v[8:11], v[32:35], a[8:11]
    ds_read_b64_tr_b16 v[66:67], v128 offset:57344
    v_mfma_f32_16x16x32_bf16 a[12:15], v[12:15], v[32:35], a[12:15]
    ds_read_b64_tr_b16 v[68:69], v129 offset:49152
    v_mfma_f32_16x16x32_bf16 a[16:19], v[16:19], v[32:35], a[16:19]
    ds_read_b64_tr_b16 v[70:71], v129 offset:57344
    v_mfma_f32_16x16x32_bf16 a[20:23], v[20:23], v[32:35], a[20:23]
    ds_read_b64_tr_b16 v[72:73], v130 offset:49152
    buffer_load_dwordx4 v141, s[4:7], s16 offen offset:0 sc1 lds
    v_mfma_f32_16x16x32_bf16 a[24:27], v[24:27], v[32:35], a[24:27]
    ds_read_b64_tr_b16 v[74:75], v130 offset:57344
    v_mfma_f32_16x16x32_bf16 a[28:31], v[28:31], v[32:35], a[28:31]
    ds_read_b64_tr_b16 v[76:77], v131 offset:49152
    v_mfma_f32_16x16x32_bf16 a[32:35], v[0:3], v[36:39], a[32:35]
    ds_read_b64_tr_b16 v[78:79], v131 offset:57344
    v_mfma_f32_16x16x32_bf16 a[36:39], v[4:7], v[36:39], a[36:39]
    ds_read_b64_tr_b16 v[80:81], v132 offset:49152
    v_mfma_f32_16x16x32_bf16 a[40:43], v[8:11], v[36:39], a[40:43]
    ds_read_b64_tr_b16 v[82:83], v132 offset:57344
    buffer_load_dwordx4 v142, s[4:7], s16 offen offset:1024 sc1 lds
    v_mfma_f32_16x16x32_bf16 a[44:47], v[12:15], v[36:39], a[44:47]
    ds_read_b64_tr_b16 v[84:85], v133 offset:49152
    v_mfma_f32_16x16x32_bf16 a[48:51], v[16:19], v[36:39], a[48:51]
    ds_read_b64_tr_b16 v[86:87], v133 offset:57344
    v_mfma_f32_16x16x32_bf16 a[52:55], v[20:23], v[36:39], a[52:55]
    ds_read_b64_tr_b16 v[88:89], v134 offset:49152
    v_mfma_f32_16x16x32_bf16 a[56:59], v[24:27], v[36:39], a[56:59]
    ds_read_b64_tr_b16 v[90:91], v134 offset:57344
    v_mfma_f32_16x16x32_bf16 a[60:63], v[28:31], v[36:39], a[60:63]
    ds_read_b64_tr_b16 v[92:93], v135 offset:49152
    buffer_load_dwordx4 v143, s[4:7], s16 offen offset:2048 sc1 lds
    v_mfma_f32_16x16x32_bf16 a[64:67], v[0:3], v[40:43], a[64:67]
    ds_read_b64_tr_b16 v[94:95], v135 offset:57344
    v_mfma_f32_16x16x32_bf16 a[68:71], v[4:7], v[40:43], a[68:71]
    ds_read_b128 v[100:103], v136 offset:50176
    v_mfma_f32_16x16x32_bf16 a[72:75], v[8:11], v[40:43], a[72:75]
    ds_read_b128 v[104:107], v136 offset:51200
    v_mfma_f32_16x16x32_bf16 a[76:79], v[12:15], v[40:43], a[76:79]
    ds_read_b128 v[108:111], v136 offset:52224
    v_mfma_f32_16x16x32_bf16 a[80:83], v[16:19], v[40:43], a[80:83]
    ds_read_b128 v[112:115], v136 offset:53248
    v_mfma_f32_16x16x32_bf16 a[84:87], v[20:23], v[40:43], a[84:87]
    ds_read_b128 v[116:119], v136 offset:54272
    buffer_load_dwordx4 v144, s[4:7], s16 offen offset:3072 sc1 lds
    v_mfma_f32_16x16x32_bf16 a[88:91], v[24:27], v[40:43], a[88:91]
    ds_read_b128 v[120:123], v136 offset:55296
    v_mfma_f32_16x16x32_bf16 a[92:95], v[28:31], v[40:43], a[92:95]
    ds_read_b128 v[124:127], v136 offset:56320
    v_mfma_f32_16x16x32_bf16 a[96:99], v[0:3], v[44:47], a[96:99]
    v_mfma_f32_16x16x32_bf16 a[100:103], v[4:7], v[44:47], a[100:103]
    v_mfma_f32_16x16x32_bf16 a[104:107], v[8:11], v[44:47], a[104:107]
    s_add_u32 s16, s16, 1024
    v_mfma_f32_16x16x32_bf16 a[108:111], v[12:15], v[44:47], a[108:111]
    v_mfma_f32_16x16x32_bf16 a[112:115], v[16:19], v[44:47], a[112:115]
    v_mfma_f32_16x16x32_bf16 a[116:119], v[20:23], v[44:47], a[116:119]
    v_mfma_f32_16x16x32_bf16 a[120:123], v[24:27], v[44:47], a[120:123]
    v_mfma_f32_16x16x32_bf16 a[124:127], v[28:31], v[44:47], a[124:127]
    s_add_u32 m0, s19, 32768
    s_nop 0
    v_mfma_f32_16x16x32_bf16 a[128:131], v[0:3], v[48:51], a[128:131]
    v_mfma_f32_16x16x32_bf16 a[132:135], v[4:7], v[48:51], a[132:135]
    v_mfma_f32_16x16x32_bf16 a[136:139], v[8:11], v[48:51], a[136:139]
    v_mfma_f32_16x16x32_bf16 a[140:143], v[12:15], v[48:51], a[140:143]
    v_mfma_f32_16x16x32_bf16 a[144:147], v[16:19], v[48:51], a[144:147]
    buffer_load_dwordx4 v137, s[8:11], s15 offen offset:0 lds
    v_mfma_f32_16x16x32_bf16 a[148:151], v[20:23], v[48:51], a[148:151]
    v_mfma_f32_16x16x32_bf16 a[152:155], v[24:27], v[48:51], a[152:155]
    v_mfma_f32_16x16x32_bf16 a[156:159], v[28:31], v[48:51], a[156:159]
    v_mfma_f32_16x16x32_bf16 a[160:163], v[0:3], v[52:55], a[160:163]
    v_mfma_f32_16x16x32_bf16 a[164:167], v[4:7], v[52:55], a[164:167]
    v_mfma_f32_16x16x32_bf16 a[168:171], v[8:11], v[52:55], a[168:171]
    buffer_load_dwordx4 v138, s[8:11], s15 offen offset:1024 lds
    v_mfma_f32_16x16x32_bf16 a[172:175], v[12:15], v[52:55], a[172:175]
    v_mfma_f32_16x16x32_bf16 a[176:179], v[16:19], v[52:55], a[176:179]
    v_mfma_f32_16x16x32_bf16 a[180:183], v[20:23], v[52:55], a[180:183]
    v_mfma_f32_16x16x32_bf16 a[184:187], v[24:27], v[52:55], a[184:187]
    v_mfma_f32_16x16x32_bf16 a[188:191], v[28:31], v[52:55], a[188:191]
    buffer_load_dwordx4 v139, s[8:11], s15 offen offset:2048 lds
    v_mfma_f32_16x16x32_bf16 a[192:195], v[0:3], v[56:59], a[192:195]
    v_mfma_f32_16x16x32_bf16 a[196:199], v[4:7], v[56:59], a[196:199]
    v_mfma_f32_16x16x32_bf16 a[200:203], v[8:11], v[56:59], a[200:203]
    v_mfma_f32_16x16x32_bf16 a[204:207], v[12:15], v[56:59], a[204:207]
    v_mfma_f32_16x16x32_bf16 a[208:211], v[16:19], v[56:59], a[208:211]
    buffer_load_dwordx4 v140, s[8:11], s15 offen offset:3072 lds
    v_mfma_f32_16x16x32_bf16 a[212:215], v[20:23], v[56:59], a[212:215]
    v_mfma_f32_16x16x32_bf16 a[216:219], v[24:27], v[56:59], a[216:219]
    v_mfma_f32_16x16x32_bf16 a[220:223], v[28:31], v[56:59], a[220:223]
    v_mfma_f32_16x16x32_bf16 a[224:227], v[0:3], v[60:63], a[224:227]
    v_mfma_f32_16x16x32_bf16 a[228:231], v[4:7], v[60:63], a[228:231]
    s_add_u32 s15, s15, s17
    v_mfma_f32_16x16x32_bf16 a[232:235], v[8:11], v[60:63], a[232:235]
    v_mfma_f32_16x16x32_bf16 a[236:239], v[12:15], v[60:63], a[236:239]
    v_mfma_f32_16x16x32_bf16 a[240:243], v[16:19], v[60:63], a[240:243]
    v_mfma_f32_16x16x32_bf16 a[244:247], v[20:23], v[60:63], a[244:247]
    v_mfma_f32_16x16x32_bf16 a[248:251], v[24:27], v[60:63], a[248:251]
    v_mfma_f32_16x16x32_bf16 a[252:255], v[28:31], v[60:63], a[252:255]
    s_waitcnt lgkmcnt(0)
    v_mfma_f32_16x16x32_bf16 a[0:3], v[64:67], v[96:99], a[0:3]
    s_waitcnt vmcnt(16)
    s_barrier
    ds_read_b128 v[32:35], v136 offset:0
    s_add_u32 m0, s20, 49152
    s_nop 0
    v_mfma_f32_16x16x32_bf16 a[4:7], v[68:71], v[96:99], a[4:7]
    ds_read_b64_tr_b16 v[0:1], v128 offset:0
    v_mfma_f32_16x16x32_bf16 a[8:11], v[72:75], v[96:99], a[8:11]
    ds_read_b64_tr_b16 v[2:3], v128 offset:8192
    v_mfma_f32_16x16x32_bf16 a[12:15], v[76:79], v[96:99], a[12:15]
    ds_read_b64_tr_b16 v[4:5], v129 offset:0
    v_mfma_f32_16x16x32_bf16 a[16:19], v[80:83], v[96:99], a[16:19]
    ds_read_b64_tr_b16 v[6:7], v129 offset:8192
    v_mfma_f32_16x16x32_bf16 a[20:23], v[84:87], v[96:99], a[20:23]
    ds_read_b64_tr_b16 v[8:9], v130 offset:0
    buffer_load_dwordx4 v141, s[4:7], s16 offen offset:0 sc1 lds
    v_mfma_f32_16x16x32_bf16 a[24:27], v[88:91], v[96:99], a[24:27]
    ds_read_b64_tr_b16 v[10:11], v130 offset:8192
    v_mfma_f32_16x16x32_bf16 a[28:31], v[92:95], v[96:99], a[28:31]
    ds_read_b64_tr_b16 v[12:13], v131 offset:0
    v_mfma_f32_16x16x32_bf16 a[32:35], v[64:67], v[100:103], a[32:35]
    ds_read_b64_tr_b16 v[14:15], v131 offset:8192
    v_mfma_f32_16x16x32_bf16 a[36:39], v[68:71], v[100:103], a[36:39]
    ds_read_b64_tr_b16 v[16:17], v132 offset:0
    v_mfma_f32_16x16x32_bf16 a[40:43], v[72:75], v[100:103], a[40:43]
    ds_read_b64_tr_b16 v[18:19], v132 offset:8192
    buffer_load_dwordx4 v142, s[4:7], s16 offen offset:1024 sc1 lds
    v_mfma_f32_16x16x32_bf16 a[44:47], v[76:79], v[100:103], a[44:47]
    ds_read_b64_tr_b16 v[20:21], v133 offset:0
    v_mfma_f32_16x16x32_bf16 a[48:51], v[80:83], v[100:103], a[48:51]
    ds_read_b64_tr_b16 v[22:23], v133 offset:8192
    v_mfma_f32_16x16x32_bf16 a[52:55], v[84:87], v[100:103], a[52:55]
    ds_read_b64_tr_b16 v[24:25], v134 offset:0
    v_mfma_f32_16x16x32_bf16 a[56:59], v[88:91], v[100:103], a[56:59]
    ds_read_b64_tr_b16 v[26:27], v134 offset:8192
    v_mfma_f32_16x16x32_bf16 a[60:63], v[92:95], v[100:103], a[60:63]
    ds_read_b64_tr_b16 v[28:29], v135 offset:0
    buffer_load_dwordx4 v143, s[4:7], s16 offen offset:2048 sc1 lds
    v_mfma_f32_16x16x32_bf16 a[64:67], v[64:67], v[104:107], a[64:67]
    ds_read_b64_tr_b16 v[30:31], v135 offset:8192
    v_mfma_f32_16x16x32_bf16 a[68:71], v[68:71], v[104:107], a[68:71]
    ds_read_b128 v[36:39], v136 offset:1024
    v_mfma_f32_16x16x32_bf16 a[72:75], v[72:75], v[104:107], a[72:75]
    ds_read_b128 v[40:43], v136 offset:2048
    v_mfma_f32_16x16x32_bf16 a[76:79], v[76:79], v[104:107], a[76:79]
    ds_read_b128 v[44:47], v136 offset:3072
    v_mfma_f32_16x16x32_bf16 a[80:83], v[80:83], v[104:107], a[80:83]
    ds_read_b128 v[48:51], v136 offset:4096
    v_mfma_f32_16x16x32_bf16 a[84:87], v[84:87], v[104:107], a[84:87]
    ds_read_b128 v[52:55], v136 offset:5120
    buffer_load_dwordx4 v144, s[4:7], s16 offen offset:3072 sc1 lds
    v_mfma_f32_16x16x32_bf16 a[88:91], v[88:91], v[104:107], a[88:91]
    ds_read_b128 v[56:59], v136 offset:6144
    v_mfma_f32_16x16x32_bf16 a[92:95], v[92:95], v[104:107], a[92:95]
    ds_read_b128 v[60:63], v136 offset:7168
    v_mfma_f32_16x16x32_bf16 a[96:99], v[64:67], v[108:111], a[96:99]
    v_mfma_f32_16x16x32_bf16 a[100:103], v[68:71], v[108:111], a[100:103]
    v_mfma_f32_16x16x32_bf16 a[104:107], v[72:75], v[108:111], a[104:107]
    s_add_u32 s16, s16, 1024
    v_mfma_f32_16x16x32_bf16 a[108:111], v[76:79], v[108:111], a[108:111]
    v_mfma_f32_16x16x32_bf16 a[112:115], v[80:83], v[108:111], a[112:115]
    v_mfma_f32_16x16x32_bf16 a[116:119], v[84:87], v[108:111], a[116:119]
    v_mfma_f32_16x16x32_bf16 a[120:123], v[88:91], v[108:111], a[120:123]
    v_mfma_f32_16x16x32_bf16 a[124:127], v[92:95], v[108:111], a[124:127]
    s_add_u32 m0, s19, 49152
    s_nop 0
    v_mfma_f32_16x16x32_bf16 a[128:131], v[64:67], v[112:115], a[128:131]
    v_mfma_f32_16x16x32_bf16 a[132:135], v[68:71], v[112:115], a[132:135]
    v_mfma_f32_16x16x32_bf16 a[136:139], v[72:75], v[112:115], a[136:139]
    v_mfma_f32_16x16x32_bf16 a[140:143], v[76:79], v[112:115], a[140:143]
    v_mfma_f32_16x16x32_bf16 a[144:147], v[80:83], v[112:115], a[144:147]
    buffer_load_dwordx4 v137, s[8:11], s15 offen offset:0 lds
    v_mfma_f32_16x16x32_bf16 a[148:151], v[84:87], v[112:115], a[148:151]
    v_mfma_f32_16x16x32_bf16 a[152:155], v[88:91], v[112:115], a[152:155]
    v_mfma_f32_16x16x32_bf16 a[156:159], v[92:95], v[112:115], a[156:159]
    v_mfma_f32_16x16x32_bf16 a[160:163], v[64:67], v[116:119], a[160:163]
    v_mfma_f32_16x16x32_bf16 a[164:167], v[68:71], v[116:119], a[164:167]
    v_mfma_f32_16x16x32_bf16 a[168:171], v[72:75], v[116:119], a[168:171]
    buffer_load_dwordx4 v138, s[8:11], s15 offen offset:1024 lds
    v_mfma_f32_16x16x32_bf16 a[172:175], v[76:79], v[116:119], a[172:175]
    v_mfma_f32_16x16x32_bf16 a[176:179], v[80:83], v[116:119], a[176:179]
    v_mfma_f32_16x16x32_bf16 a[180:183], v[84:87], v[116:119], a[180:183]
    v_mfma_f32_16x16x32_bf16 a[184:187], v[88:91], v[116:119], a[184:187]
    v_mfma_f32_16x16x32_bf16 a[188:191], v[92:95], v[116:119], a[188:191]
    buffer_load_dwordx4 v139, s[8:11], s15 offen offset:2048 lds
    v_mfma_f32_16x16x32_bf16 a[192:195], v[64:67], v[120:123], a[192:195]
    v_mfma_f32_16x16x32_bf16 a[196:199], v[68:71], v[120:123], a[196:199]
    v_mfma_f32_16x16x32_bf16 a[200:203], v[72:75], v[120:123], a[200:203]
    v_mfma_f32_16x16x32_bf16 a[204:207], v[76:79], v[120:123], a[204:207]
    v_mfma_f32_16x16x32_bf16 a[208:211], v[80:83], v[120:123], a[208:211]
    buffer_load_dwordx4 v140, s[8:11], s15 offen offset:3072 lds
    v_mfma_f32_16x16x32_bf16 a[212:215], v[84:87], v[120:123], a[212:215]
    v_mfma_f32_16x16x32_bf16 a[216:219], v[88:91], v[120:123], a[216:219]
    v_mfma_f32_16x16x32_bf16 a[220:223], v[92:95], v[120:123], a[220:223]
    v_mfma_f32_16x16x32_bf16 a[224:227], v[64:67], v[124:127], a[224:227]
    v_mfma_f32_16x16x32_bf16 a[228:231], v[68:71], v[124:127], a[228:231]
    s_add_u32 s15, s15, s17
    v_mfma_f32_16x16x32_bf16 a[232:235], v[72:75], v[124:127], a[232:235]
    v_mfma_f32_16x16x32_bf16 a[236:239], v[76:79], v[124:127], a[236:239]
    v_mfma_f32_16x16x32_bf16 a[240:243], v[80:83], v[124:127], a[240:243]
    v_mfma_f32_16x16x32_bf16 a[244:247], v[84:87], v[124:127], a[244:247]
    v_mfma_f32_16x16x32_bf16 a[248:251], v[88:91], v[124:127], a[248:251]
    v_mfma_f32_16x16x32_bf16 a[252:255], v[92:95], v[124:127], a[252:255]
    s_sub_u32 s18, s18, 1
    s_cmp_lg_u32 s18, 0
    s_cbranch_scc1 main_kernel_w_c2_n_loop
    s_cmp_lg_u32 s14, 0
    s_cbranch_scc1 main_kernel_w_c2_n_nt
    s_lshl_b32 s32, s27, 8
    s_add_u32 s32, s32, 0x841e000
    v_mov_b32 v255, 1
    s_mov_b64 exec, 1
    buffer_atomic_add v255, off, s[4:7], s32 sc0 sc1
    s_mov_b64 exec, -1
main_kernel_w_c2_n_nt:
    s_waitcnt lgkmcnt(0)
    v_mfma_f32_16x16x32_bf16 a[0:3], v[0:3], v[32:35], a[0:3]
    s_waitcnt vmcnt(16)
    s_barrier
    ds_read_b128 v[96:99], v136 offset:16384
    v_mfma_f32_16x16x32_bf16 a[4:7], v[4:7], v[32:35], a[4:7]
    ds_read_b64_tr_b16 v[64:65], v128 offset:16384
    v_mfma_f32_16x16x32_bf16 a[8:11], v[8:11], v[32:35], a[8:11]
    ds_read_b64_tr_b16 v[66:67], v128 offset:24576
    v_mfma_f32_16x16x32_bf16 a[12:15], v[12:15], v[32:35], a[12:15]
    ds_read_b64_tr_b16 v[68:69], v129 offset:16384
    v_mfma_f32_16x16x32_bf16 a[16:19], v[16:19], v[32:35], a[16:19]
    ds_read_b64_tr_b16 v[70:71], v129 offset:24576
    v_mfma_f32_16x16x32_bf16 a[20:23], v[20:23], v[32:35], a[20:23]
    ds_read_b64_tr_b16 v[72:73], v130 offset:16384
    v_mfma_f32_16x16x32_bf16 a[24:27], v[24:27], v[32:35], a[24:27]
    ds_read_b64_tr_b16 v[74:75], v130 offset:24576
    v_mfma_f32_16x16x32_bf16 a[28:31], v[28:31], v[32:35], a[28:31]
    ds_read_b64_tr_b16 v[76:77], v131 offset:16384
    v_mfma_f32_16x16x32_bf16 a[32:35], v[0:3], v[36:39], a[32:35]
    ds_read_b64_tr_b16 v[78:79], v131 offset:24576
    v_mfma_f32_16x16x32_bf16 a[36:39], v[4:7], v[36:39], a[36:39]
    ds_read_b64_tr_b16 v[80:81], v132 offset:16384
    v_mfma_f32_16x16x32_bf16 a[40:43], v[8:11], v[36:39], a[40:43]
    ds_read_b64_tr_b16 v[82:83], v132 offset:24576
    v_mfma_f32_16x16x32_bf16 a[44:47], v[12:15], v[36:39], a[44:47]
    ds_read_b64_tr_b16 v[84:85], v133 offset:16384
    v_mfma_f32_16x16x32_bf16 a[48:51], v[16:19], v[36:39], a[48:51]
    ds_read_b64_tr_b16 v[86:87], v133 offset:24576
    v_mfma_f32_16x16x32_bf16 a[52:55], v[20:23], v[36:39], a[52:55]
    ds_read_b64_tr_b16 v[88:89], v134 offset:16384
    v_mfma_f32_16x16x32_bf16 a[56:59], v[24:27], v[36:39], a[56:59]
    ds_read_b64_tr_b16 v[90:91], v134 offset:24576
    v_mfma_f32_16x16x32_bf16 a[60:63], v[28:31], v[36:39], a[60:63]
    ds_read_b64_tr_b16 v[92:93], v135 offset:16384
    v_mfma_f32_16x16x32_bf16 a[64:67], v[0:3], v[40:43], a[64:67]
    ds_read_b64_tr_b16 v[94:95], v135 offset:24576
    v_mfma_f32_16x16x32_bf16 a[68:71], v[4:7], v[40:43], a[68:71]
    ds_read_b128 v[100:103], v136 offset:17408
    v_mfma_f32_16x16x32_bf16 a[72:75], v[8:11], v[40:43], a[72:75]
    ds_read_b128 v[104:107], v136 offset:18432
    v_mfma_f32_16x16x32_bf16 a[76:79], v[12:15], v[40:43], a[76:79]
    ds_read_b128 v[108:111], v136 offset:19456
    v_mfma_f32_16x16x32_bf16 a[80:83], v[16:19], v[40:43], a[80:83]
    ds_read_b128 v[112:115], v136 offset:20480
    v_mfma_f32_16x16x32_bf16 a[84:87], v[20:23], v[40:43], a[84:87]
    ds_read_b128 v[116:119], v136 offset:21504
    v_mfma_f32_16x16x32_bf16 a[88:91], v[24:27], v[40:43], a[88:91]
    ds_read_b128 v[120:123], v136 offset:22528
    v_mfma_f32_16x16x32_bf16 a[92:95], v[28:31], v[40:43], a[92:95]
    ds_read_b128 v[124:127], v136 offset:23552
    v_mfma_f32_16x16x32_bf16 a[96:99], v[0:3], v[44:47], a[96:99]
    v_mfma_f32_16x16x32_bf16 a[100:103], v[4:7], v[44:47], a[100:103]
    v_mfma_f32_16x16x32_bf16 a[104:107], v[8:11], v[44:47], a[104:107]
    v_mfma_f32_16x16x32_bf16 a[108:111], v[12:15], v[44:47], a[108:111]
    v_mfma_f32_16x16x32_bf16 a[112:115], v[16:19], v[44:47], a[112:115]
    v_mfma_f32_16x16x32_bf16 a[116:119], v[20:23], v[44:47], a[116:119]
    v_mfma_f32_16x16x32_bf16 a[120:123], v[24:27], v[44:47], a[120:123]
    v_mfma_f32_16x16x32_bf16 a[124:127], v[28:31], v[44:47], a[124:127]
    v_mfma_f32_16x16x32_bf16 a[128:131], v[0:3], v[48:51], a[128:131]
    v_mfma_f32_16x16x32_bf16 a[132:135], v[4:7], v[48:51], a[132:135]
    v_mfma_f32_16x16x32_bf16 a[136:139], v[8:11], v[48:51], a[136:139]
    v_mfma_f32_16x16x32_bf16 a[140:143], v[12:15], v[48:51], a[140:143]
    v_mfma_f32_16x16x32_bf16 a[144:147], v[16:19], v[48:51], a[144:147]
    v_mfma_f32_16x16x32_bf16 a[148:151], v[20:23], v[48:51], a[148:151]
    v_mfma_f32_16x16x32_bf16 a[152:155], v[24:27], v[48:51], a[152:155]
    v_mfma_f32_16x16x32_bf16 a[156:159], v[28:31], v[48:51], a[156:159]
    v_mfma_f32_16x16x32_bf16 a[160:163], v[0:3], v[52:55], a[160:163]
    v_mfma_f32_16x16x32_bf16 a[164:167], v[4:7], v[52:55], a[164:167]
    v_mfma_f32_16x16x32_bf16 a[168:171], v[8:11], v[52:55], a[168:171]
    v_mfma_f32_16x16x32_bf16 a[172:175], v[12:15], v[52:55], a[172:175]
    v_mfma_f32_16x16x32_bf16 a[176:179], v[16:19], v[52:55], a[176:179]
    v_mfma_f32_16x16x32_bf16 a[180:183], v[20:23], v[52:55], a[180:183]
    v_mfma_f32_16x16x32_bf16 a[184:187], v[24:27], v[52:55], a[184:187]
    v_mfma_f32_16x16x32_bf16 a[188:191], v[28:31], v[52:55], a[188:191]
    v_mfma_f32_16x16x32_bf16 a[192:195], v[0:3], v[56:59], a[192:195]
    v_mfma_f32_16x16x32_bf16 a[196:199], v[4:7], v[56:59], a[196:199]
    v_mfma_f32_16x16x32_bf16 a[200:203], v[8:11], v[56:59], a[200:203]
    v_mfma_f32_16x16x32_bf16 a[204:207], v[12:15], v[56:59], a[204:207]
    v_mfma_f32_16x16x32_bf16 a[208:211], v[16:19], v[56:59], a[208:211]
    v_mfma_f32_16x16x32_bf16 a[212:215], v[20:23], v[56:59], a[212:215]
    v_mfma_f32_16x16x32_bf16 a[216:219], v[24:27], v[56:59], a[216:219]
    v_mfma_f32_16x16x32_bf16 a[220:223], v[28:31], v[56:59], a[220:223]
    v_mfma_f32_16x16x32_bf16 a[224:227], v[0:3], v[60:63], a[224:227]
    v_mfma_f32_16x16x32_bf16 a[228:231], v[4:7], v[60:63], a[228:231]
    v_mfma_f32_16x16x32_bf16 a[232:235], v[8:11], v[60:63], a[232:235]
    v_mfma_f32_16x16x32_bf16 a[236:239], v[12:15], v[60:63], a[236:239]
    v_mfma_f32_16x16x32_bf16 a[240:243], v[16:19], v[60:63], a[240:243]
    v_mfma_f32_16x16x32_bf16 a[244:247], v[20:23], v[60:63], a[244:247]
    v_mfma_f32_16x16x32_bf16 a[248:251], v[24:27], v[60:63], a[248:251]
    v_mfma_f32_16x16x32_bf16 a[252:255], v[28:31], v[60:63], a[252:255]
    s_waitcnt lgkmcnt(0)
    v_mfma_f32_16x16x32_bf16 a[0:3], v[64:67], v[96:99], a[0:3]
    s_waitcnt vmcnt(8)
    s_barrier
    ds_read_b128 v[32:35], v136 offset:32768
    v_mfma_f32_16x16x32_bf16 a[4:7], v[68:71], v[96:99], a[4:7]
    ds_read_b64_tr_b16 v[0:1], v128 offset:32768
    v_mfma_f32_16x16x32_bf16 a[8:11], v[72:75], v[96:99], a[8:11]
    ds_read_b64_tr_b16 v[2:3], v128 offset:40960
    v_mfma_f32_16x16x32_bf16 a[12:15], v[76:79], v[96:99], a[12:15]
    ds_read_b64_tr_b16 v[4:5], v129 offset:32768
    v_mfma_f32_16x16x32_bf16 a[16:19], v[80:83], v[96:99], a[16:19]
    ds_read_b64_tr_b16 v[6:7], v129 offset:40960
    v_mfma_f32_16x16x32_bf16 a[20:23], v[84:87], v[96:99], a[20:23]
    ds_read_b64_tr_b16 v[8:9], v130 offset:32768
    v_mfma_f32_16x16x32_bf16 a[24:27], v[88:91], v[96:99], a[24:27]
    ds_read_b64_tr_b16 v[10:11], v130 offset:40960
    v_mfma_f32_16x16x32_bf16 a[28:31], v[92:95], v[96:99], a[28:31]
    ds_read_b64_tr_b16 v[12:13], v131 offset:32768
    v_mfma_f32_16x16x32_bf16 a[32:35], v[64:67], v[100:103], a[32:35]
    ds_read_b64_tr_b16 v[14:15], v131 offset:40960
    v_mfma_f32_16x16x32_bf16 a[36:39], v[68:71], v[100:103], a[36:39]
    ds_read_b64_tr_b16 v[16:17], v132 offset:32768
    v_mfma_f32_16x16x32_bf16 a[40:43], v[72:75], v[100:103], a[40:43]
    ds_read_b64_tr_b16 v[18:19], v132 offset:40960
    v_mfma_f32_16x16x32_bf16 a[44:47], v[76:79], v[100:103], a[44:47]
    ds_read_b64_tr_b16 v[20:21], v133 offset:32768
    v_mfma_f32_16x16x32_bf16 a[48:51], v[80:83], v[100:103], a[48:51]
    ds_read_b64_tr_b16 v[22:23], v133 offset:40960
    v_mfma_f32_16x16x32_bf16 a[52:55], v[84:87], v[100:103], a[52:55]
    ds_read_b64_tr_b16 v[24:25], v134 offset:32768
    v_mfma_f32_16x16x32_bf16 a[56:59], v[88:91], v[100:103], a[56:59]
    ds_read_b64_tr_b16 v[26:27], v134 offset:40960
    v_mfma_f32_16x16x32_bf16 a[60:63], v[92:95], v[100:103], a[60:63]
    ds_read_b64_tr_b16 v[28:29], v135 offset:32768
    v_mfma_f32_16x16x32_bf16 a[64:67], v[64:67], v[104:107], a[64:67]
    ds_read_b64_tr_b16 v[30:31], v135 offset:40960
    v_mfma_f32_16x16x32_bf16 a[68:71], v[68:71], v[104:107], a[68:71]
    ds_read_b128 v[36:39], v136 offset:33792
    v_mfma_f32_16x16x32_bf16 a[72:75], v[72:75], v[104:107], a[72:75]
    ds_read_b128 v[40:43], v136 offset:34816
    v_mfma_f32_16x16x32_bf16 a[76:79], v[76:79], v[104:107], a[76:79]
    ds_read_b128 v[44:47], v136 offset:35840
    v_mfma_f32_16x16x32_bf16 a[80:83], v[80:83], v[104:107], a[80:83]
    ds_read_b128 v[48:51], v136 offset:36864
    v_mfma_f32_16x16x32_bf16 a[84:87], v[84:87], v[104:107], a[84:87]
    ds_read_b128 v[52:55], v136 offset:37888
    v_mfma_f32_16x16x32_bf16 a[88:91], v[88:91], v[104:107], a[88:91]
    ds_read_b128 v[56:59], v136 offset:38912
    v_mfma_f32_16x16x32_bf16 a[92:95], v[92:95], v[104:107], a[92:95]
    ds_read_b128 v[60:63], v136 offset:39936
    v_mfma_f32_16x16x32_bf16 a[96:99], v[64:67], v[108:111], a[96:99]
    v_mfma_f32_16x16x32_bf16 a[100:103], v[68:71], v[108:111], a[100:103]
    v_mfma_f32_16x16x32_bf16 a[104:107], v[72:75], v[108:111], a[104:107]
    v_mfma_f32_16x16x32_bf16 a[108:111], v[76:79], v[108:111], a[108:111]
    v_mfma_f32_16x16x32_bf16 a[112:115], v[80:83], v[108:111], a[112:115]
    v_mfma_f32_16x16x32_bf16 a[116:119], v[84:87], v[108:111], a[116:119]
    v_mfma_f32_16x16x32_bf16 a[120:123], v[88:91], v[108:111], a[120:123]
    v_mfma_f32_16x16x32_bf16 a[124:127], v[92:95], v[108:111], a[124:127]
    v_mfma_f32_16x16x32_bf16 a[128:131], v[64:67], v[112:115], a[128:131]
    v_mfma_f32_16x16x32_bf16 a[132:135], v[68:71], v[112:115], a[132:135]
    v_mfma_f32_16x16x32_bf16 a[136:139], v[72:75], v[112:115], a[136:139]
    v_mfma_f32_16x16x32_bf16 a[140:143], v[76:79], v[112:115], a[140:143]
    v_mfma_f32_16x16x32_bf16 a[144:147], v[80:83], v[112:115], a[144:147]
    v_mfma_f32_16x16x32_bf16 a[148:151], v[84:87], v[112:115], a[148:151]
    v_mfma_f32_16x16x32_bf16 a[152:155], v[88:91], v[112:115], a[152:155]
    v_mfma_f32_16x16x32_bf16 a[156:159], v[92:95], v[112:115], a[156:159]
    v_mfma_f32_16x16x32_bf16 a[160:163], v[64:67], v[116:119], a[160:163]
    v_mfma_f32_16x16x32_bf16 a[164:167], v[68:71], v[116:119], a[164:167]
    v_mfma_f32_16x16x32_bf16 a[168:171], v[72:75], v[116:119], a[168:171]
    v_mfma_f32_16x16x32_bf16 a[172:175], v[76:79], v[116:119], a[172:175]
    v_mfma_f32_16x16x32_bf16 a[176:179], v[80:83], v[116:119], a[176:179]
    v_mfma_f32_16x16x32_bf16 a[180:183], v[84:87], v[116:119], a[180:183]
    v_mfma_f32_16x16x32_bf16 a[184:187], v[88:91], v[116:119], a[184:187]
    v_mfma_f32_16x16x32_bf16 a[188:191], v[92:95], v[116:119], a[188:191]
    v_mfma_f32_16x16x32_bf16 a[192:195], v[64:67], v[120:123], a[192:195]
    v_mfma_f32_16x16x32_bf16 a[196:199], v[68:71], v[120:123], a[196:199]
    v_mfma_f32_16x16x32_bf16 a[200:203], v[72:75], v[120:123], a[200:203]
    v_mfma_f32_16x16x32_bf16 a[204:207], v[76:79], v[120:123], a[204:207]
    v_mfma_f32_16x16x32_bf16 a[208:211], v[80:83], v[120:123], a[208:211]
    v_mfma_f32_16x16x32_bf16 a[212:215], v[84:87], v[120:123], a[212:215]
    v_mfma_f32_16x16x32_bf16 a[216:219], v[88:91], v[120:123], a[216:219]
    v_mfma_f32_16x16x32_bf16 a[220:223], v[92:95], v[120:123], a[220:223]
    v_mfma_f32_16x16x32_bf16 a[224:227], v[64:67], v[124:127], a[224:227]
    v_mfma_f32_16x16x32_bf16 a[228:231], v[68:71], v[124:127], a[228:231]
    v_mfma_f32_16x16x32_bf16 a[232:235], v[72:75], v[124:127], a[232:235]
    v_mfma_f32_16x16x32_bf16 a[236:239], v[76:79], v[124:127], a[236:239]
    v_mfma_f32_16x16x32_bf16 a[240:243], v[80:83], v[124:127], a[240:243]
    v_mfma_f32_16x16x32_bf16 a[244:247], v[84:87], v[124:127], a[244:247]
    v_mfma_f32_16x16x32_bf16 a[248:251], v[88:91], v[124:127], a[248:251]
    v_mfma_f32_16x16x32_bf16 a[252:255], v[92:95], v[124:127], a[252:255]
    s_waitcnt lgkmcnt(0)
    v_mfma_f32_16x16x32_bf16 a[0:3], v[0:3], v[32:35], a[0:3]
    s_waitcnt vmcnt(0)
    s_barrier
    ds_read_b128 v[96:99], v136 offset:49152
    v_mfma_f32_16x16x32_bf16 a[4:7], v[4:7], v[32:35], a[4:7]
    ds_read_b64_tr_b16 v[64:65], v128 offset:49152
    v_mfma_f32_16x16x32_bf16 a[8:11], v[8:11], v[32:35], a[8:11]
    ds_read_b64_tr_b16 v[66:67], v128 offset:57344
    v_mfma_f32_16x16x32_bf16 a[12:15], v[12:15], v[32:35], a[12:15]
    ds_read_b64_tr_b16 v[68:69], v129 offset:49152
    v_mfma_f32_16x16x32_bf16 a[16:19], v[16:19], v[32:35], a[16:19]
    ds_read_b64_tr_b16 v[70:71], v129 offset:57344
    v_mfma_f32_16x16x32_bf16 a[20:23], v[20:23], v[32:35], a[20:23]
    ds_read_b64_tr_b16 v[72:73], v130 offset:49152
    v_mfma_f32_16x16x32_bf16 a[24:27], v[24:27], v[32:35], a[24:27]
    ds_read_b64_tr_b16 v[74:75], v130 offset:57344
    v_mfma_f32_16x16x32_bf16 a[28:31], v[28:31], v[32:35], a[28:31]
    ds_read_b64_tr_b16 v[76:77], v131 offset:49152
    v_mfma_f32_16x16x32_bf16 a[32:35], v[0:3], v[36:39], a[32:35]
    ds_read_b64_tr_b16 v[78:79], v131 offset:57344
    v_mfma_f32_16x16x32_bf16 a[36:39], v[4:7], v[36:39], a[36:39]
    ds_read_b64_tr_b16 v[80:81], v132 offset:49152
    v_mfma_f32_16x16x32_bf16 a[40:43], v[8:11], v[36:39], a[40:43]
    ds_read_b64_tr_b16 v[82:83], v132 offset:57344
    v_mfma_f32_16x16x32_bf16 a[44:47], v[12:15], v[36:39], a[44:47]
    ds_read_b64_tr_b16 v[84:85], v133 offset:49152
    v_mfma_f32_16x16x32_bf16 a[48:51], v[16:19], v[36:39], a[48:51]
    ds_read_b64_tr_b16 v[86:87], v133 offset:57344
    v_mfma_f32_16x16x32_bf16 a[52:55], v[20:23], v[36:39], a[52:55]
    ds_read_b64_tr_b16 v[88:89], v134 offset:49152
    v_mfma_f32_16x16x32_bf16 a[56:59], v[24:27], v[36:39], a[56:59]
    ds_read_b64_tr_b16 v[90:91], v134 offset:57344
    v_mfma_f32_16x16x32_bf16 a[60:63], v[28:31], v[36:39], a[60:63]
    ds_read_b64_tr_b16 v[92:93], v135 offset:49152
    v_mfma_f32_16x16x32_bf16 a[64:67], v[0:3], v[40:43], a[64:67]
    ds_read_b64_tr_b16 v[94:95], v135 offset:57344
    v_mfma_f32_16x16x32_bf16 a[68:71], v[4:7], v[40:43], a[68:71]
    ds_read_b128 v[100:103], v136 offset:50176
    v_mfma_f32_16x16x32_bf16 a[72:75], v[8:11], v[40:43], a[72:75]
    ds_read_b128 v[104:107], v136 offset:51200
    v_mfma_f32_16x16x32_bf16 a[76:79], v[12:15], v[40:43], a[76:79]
    ds_read_b128 v[108:111], v136 offset:52224
    v_mfma_f32_16x16x32_bf16 a[80:83], v[16:19], v[40:43], a[80:83]
    ds_read_b128 v[112:115], v136 offset:53248
    v_mfma_f32_16x16x32_bf16 a[84:87], v[20:23], v[40:43], a[84:87]
    ds_read_b128 v[116:119], v136 offset:54272
    v_mfma_f32_16x16x32_bf16 a[88:91], v[24:27], v[40:43], a[88:91]
    ds_read_b128 v[120:123], v136 offset:55296
    v_mfma_f32_16x16x32_bf16 a[92:95], v[28:31], v[40:43], a[92:95]
    ds_read_b128 v[124:127], v136 offset:56320
    v_mfma_f32_16x16x32_bf16 a[96:99], v[0:3], v[44:47], a[96:99]
    v_mfma_f32_16x16x32_bf16 a[100:103], v[4:7], v[44:47], a[100:103]
    v_mfma_f32_16x16x32_bf16 a[104:107], v[8:11], v[44:47], a[104:107]
    v_mfma_f32_16x16x32_bf16 a[108:111], v[12:15], v[44:47], a[108:111]
    v_mfma_f32_16x16x32_bf16 a[112:115], v[16:19], v[44:47], a[112:115]
    v_mfma_f32_16x16x32_bf16 a[116:119], v[20:23], v[44:47], a[116:119]
    v_mfma_f32_16x16x32_bf16 a[120:123], v[24:27], v[44:47], a[120:123]
    v_mfma_f32_16x16x32_bf16 a[124:127], v[28:31], v[44:47], a[124:127]
    v_mfma_f32_16x16x32_bf16 a[128:131], v[0:3], v[48:51], a[128:131]
    v_mfma_f32_16x16x32_bf16 a[132:135], v[4:7], v[48:51], a[132:135]
    v_mfma_f32_16x16x32_bf16 a[136:139], v[8:11], v[48:51], a[136:139]
    v_mfma_f32_16x16x32_bf16 a[140:143], v[12:15], v[48:51], a[140:143]
    v_mfma_f32_16x16x32_bf16 a[144:147], v[16:19], v[48:51], a[144:147]
    v_mfma_f32_16x16x32_bf16 a[148:151], v[20:23], v[48:51], a[148:151]
    v_mfma_f32_16x16x32_bf16 a[152:155], v[24:27], v[48:51], a[152:155]
    v_mfma_f32_16x16x32_bf16 a[156:159], v[28:31], v[48:51], a[156:159]
    v_mfma_f32_16x16x32_bf16 a[160:163], v[0:3], v[52:55], a[160:163]
    v_mfma_f32_16x16x32_bf16 a[164:167], v[4:7], v[52:55], a[164:167]
    v_mfma_f32_16x16x32_bf16 a[168:171], v[8:11], v[52:55], a[168:171]
    v_mfma_f32_16x16x32_bf16 a[172:175], v[12:15], v[52:55], a[172:175]
    v_mfma_f32_16x16x32_bf16 a[176:179], v[16:19], v[52:55], a[176:179]
    v_mfma_f32_16x16x32_bf16 a[180:183], v[20:23], v[52:55], a[180:183]
    v_mfma_f32_16x16x32_bf16 a[184:187], v[24:27], v[52:55], a[184:187]
    v_mfma_f32_16x16x32_bf16 a[188:191], v[28:31], v[52:55], a[188:191]
    v_mfma_f32_16x16x32_bf16 a[192:195], v[0:3], v[56:59], a[192:195]
    v_mfma_f32_16x16x32_bf16 a[196:199], v[4:7], v[56:59], a[196:199]
    v_mfma_f32_16x16x32_bf16 a[200:203], v[8:11], v[56:59], a[200:203]
    v_mfma_f32_16x16x32_bf16 a[204:207], v[12:15], v[56:59], a[204:207]
    v_mfma_f32_16x16x32_bf16 a[208:211], v[16:19], v[56:59], a[208:211]
    v_mfma_f32_16x16x32_bf16 a[212:215], v[20:23], v[56:59], a[212:215]
    v_mfma_f32_16x16x32_bf16 a[216:219], v[24:27], v[56:59], a[216:219]
    v_mfma_f32_16x16x32_bf16 a[220:223], v[28:31], v[56:59], a[220:223]
    v_mfma_f32_16x16x32_bf16 a[224:227], v[0:3], v[60:63], a[224:227]
    v_mfma_f32_16x16x32_bf16 a[228:231], v[4:7], v[60:63], a[228:231]
    v_mfma_f32_16x16x32_bf16 a[232:235], v[8:11], v[60:63], a[232:235]
    v_mfma_f32_16x16x32_bf16 a[236:239], v[12:15], v[60:63], a[236:239]
    v_mfma_f32_16x16x32_bf16 a[240:243], v[16:19], v[60:63], a[240:243]
    v_mfma_f32_16x16x32_bf16 a[244:247], v[20:23], v[60:63], a[244:247]
    v_mfma_f32_16x16x32_bf16 a[248:251], v[24:27], v[60:63], a[248:251]
    v_mfma_f32_16x16x32_bf16 a[252:255], v[28:31], v[60:63], a[252:255]
    v_readfirstlane_b32 s55, v255
    s_waitcnt lgkmcnt(0)
    v_mfma_f32_16x16x32_bf16 a[0:3], v[64:67], v[96:99], a[0:3]
    v_mfma_f32_16x16x32_bf16 a[4:7], v[68:71], v[96:99], a[4:7]
    v_mfma_f32_16x16x32_bf16 a[8:11], v[72:75], v[96:99], a[8:11]
    v_mfma_f32_16x16x32_bf16 a[12:15], v[76:79], v[96:99], a[12:15]
    v_mfma_f32_16x16x32_bf16 a[16:19], v[80:83], v[96:99], a[16:19]
    v_mfma_f32_16x16x32_bf16 a[20:23], v[84:87], v[96:99], a[20:23]
    v_mfma_f32_16x16x32_bf16 a[24:27], v[88:91], v[96:99], a[24:27]
    v_mfma_f32_16x16x32_bf16 a[28:31], v[92:95], v[96:99], a[28:31]
    v_mfma_f32_16x16x32_bf16 a[32:35], v[64:67], v[100:103], a[32:35]
    v_mfma_f32_16x16x32_bf16 a[36:39], v[68:71], v[100:103], a[36:39]
    v_mfma_f32_16x16x32_bf16 a[40:43], v[72:75], v[100:103], a[40:43]
    v_mfma_f32_16x16x32_bf16 a[44:47], v[76:79], v[100:103], a[44:47]
    v_mfma_f32_16x16x32_bf16 a[48:51], v[80:83], v[100:103], a[48:51]
    v_mfma_f32_16x16x32_bf16 a[52:55], v[84:87], v[100:103], a[52:55]
    v_mfma_f32_16x16x32_bf16 a[56:59], v[88:91], v[100:103], a[56:59]
    v_mfma_f32_16x16x32_bf16 a[60:63], v[92:95], v[100:103], a[60:63]
    v_mfma_f32_16x16x32_bf16 a[64:67], v[64:67], v[104:107], a[64:67]
    v_mfma_f32_16x16x32_bf16 a[68:71], v[68:71], v[104:107], a[68:71]
    v_mfma_f32_16x16x32_bf16 a[72:75], v[72:75], v[104:107], a[72:75]
    v_mfma_f32_16x16x32_bf16 a[76:79], v[76:79], v[104:107], a[76:79]
    v_mfma_f32_16x16x32_bf16 a[80:83], v[80:83], v[104:107], a[80:83]
    v_mfma_f32_16x16x32_bf16 a[84:87], v[84:87], v[104:107], a[84:87]
    v_mfma_f32_16x16x32_bf16 a[88:91], v[88:91], v[104:107], a[88:91]
    v_mfma_f32_16x16x32_bf16 a[92:95], v[92:95], v[104:107], a[92:95]
    v_mfma_f32_16x16x32_bf16 a[96:99], v[64:67], v[108:111], a[96:99]
    v_mfma_f32_16x16x32_bf16 a[100:103], v[68:71], v[108:111], a[100:103]
    v_mfma_f32_16x16x32_bf16 a[104:107], v[72:75], v[108:111], a[104:107]
    v_mfma_f32_16x16x32_bf16 a[108:111], v[76:79], v[108:111], a[108:111]
    v_mfma_f32_16x16x32_bf16 a[112:115], v[80:83], v[108:111], a[112:115]
    v_mfma_f32_16x16x32_bf16 a[116:119], v[84:87], v[108:111], a[116:119]
    v_mfma_f32_16x16x32_bf16 a[120:123], v[88:91], v[108:111], a[120:123]
    v_mfma_f32_16x16x32_bf16 a[124:127], v[92:95], v[108:111], a[124:127]
    v_mfma_f32_16x16x32_bf16 a[128:131], v[64:67], v[112:115], a[128:131]
    v_mfma_f32_16x16x32_bf16 a[132:135], v[68:71], v[112:115], a[132:135]
    v_mfma_f32_16x16x32_bf16 a[136:139], v[72:75], v[112:115], a[136:139]
    v_mfma_f32_16x16x32_bf16 a[140:143], v[76:79], v[112:115], a[140:143]
    v_mfma_f32_16x16x32_bf16 a[144:147], v[80:83], v[112:115], a[144:147]
    v_mfma_f32_16x16x32_bf16 a[148:151], v[84:87], v[112:115], a[148:151]
    v_mfma_f32_16x16x32_bf16 a[152:155], v[88:91], v[112:115], a[152:155]
    v_mfma_f32_16x16x32_bf16 a[156:159], v[92:95], v[112:115], a[156:159]
    v_mfma_f32_16x16x32_bf16 a[160:163], v[64:67], v[116:119], a[160:163]
    v_mfma_f32_16x16x32_bf16 a[164:167], v[68:71], v[116:119], a[164:167]
    v_mfma_f32_16x16x32_bf16 a[168:171], v[72:75], v[116:119], a[168:171]
    v_mfma_f32_16x16x32_bf16 a[172:175], v[76:79], v[116:119], a[172:175]
    v_mfma_f32_16x16x32_bf16 a[176:179], v[80:83], v[116:119], a[176:179]
    v_mfma_f32_16x16x32_bf16 a[180:183], v[84:87], v[116:119], a[180:183]
    v_mfma_f32_16x16x32_bf16 a[184:187], v[88:91], v[116:119], a[184:187]
    v_mfma_f32_16x16x32_bf16 a[188:191], v[92:95], v[116:119], a[188:191]
    v_mfma_f32_16x16x32_bf16 a[192:195], v[64:67], v[120:123], a[192:195]
    v_mfma_f32_16x16x32_bf16 a[196:199], v[68:71], v[120:123], a[196:199]
    v_mfma_f32_16x16x32_bf16 a[200:203], v[72:75], v[120:123], a[200:203]
    v_mfma_f32_16x16x32_bf16 a[204:207], v[76:79], v[120:123], a[204:207]
    v_mfma_f32_16x16x32_bf16 a[208:211], v[80:83], v[120:123], a[208:211]
    v_mfma_f32_16x16x32_bf16 a[212:215], v[84:87], v[120:123], a[212:215]
    v_mfma_f32_16x16x32_bf16 a[216:219], v[88:91], v[120:123], a[216:219]
    v_mfma_f32_16x16x32_bf16 a[220:223], v[92:95], v[120:123], a[220:223]
    v_mfma_f32_16x16x32_bf16 a[224:227], v[64:67], v[124:127], a[224:227]
    v_mfma_f32_16x16x32_bf16 a[228:231], v[68:71], v[124:127], a[228:231]
    v_mfma_f32_16x16x32_bf16 a[232:235], v[72:75], v[124:127], a[232:235]
    v_mfma_f32_16x16x32_bf16 a[236:239], v[76:79], v[124:127], a[236:239]
    v_mfma_f32_16x16x32_bf16 a[240:243], v[80:83], v[124:127], a[240:243]
    v_mfma_f32_16x16x32_bf16 a[244:247], v[84:87], v[124:127], a[244:247]
    v_mfma_f32_16x16x32_bf16 a[248:251], v[88:91], v[124:127], a[248:251]
    v_mfma_f32_16x16x32_bf16 a[252:255], v[92:95], v[124:127], a[252:255]
    s_nop 7
    s_cmp_eq_u32 s23, 1
    s_cbranch_scc1 main_kernel_w_c2_escl
    s_cmp_eq_u32 s23, 6
    s_cbranch_scc1 main_kernel_w_c2_egelu
main_kernel_w_c2_eplain:
    s_mov_b32 s53, s21
    v_accvgpr_read_b32 v0, a0
    v_accvgpr_read_b32 v1, a1
    v_accvgpr_read_b32 v2, a2
    v_accvgpr_read_b32 v3, a3
    v_accvgpr_read_b32 v4, a4
    v_accvgpr_read_b32 v5, a5
    v_accvgpr_read_b32 v6, a6
    v_accvgpr_read_b32 v7, a7
    v_cvt_pk_bf16_f32 v16, v0, v1
    v_cvt_pk_bf16_f32 v17, v2, v3
    v_cvt_pk_bf16_f32 v18, v4, v5
    v_cvt_pk_bf16_f32 v19, v6, v7
    buffer_store_dwordx4 v[16:19], v251, s[4:7], s53 offen offset:0 sc1
    v_accvgpr_read_b32 v20, a8
    v_accvgpr_read_b32 v21, a9
    v_accvgpr_read_b32 v22, a10
    v_accvgpr_read_b32 v23, a11
    v_accvgpr_read_b32 v24, a12
    v_accvgpr_read_b32 v25, a13
    v_accvgpr_read_b32 v26, a14
    v_accvgpr_read_b32 v27, a15
    v_cvt_pk_bf16_f32 v36, v20, v21
    v_cvt_pk_bf16_f32 v37, v22, v23
    v_cvt_pk_bf16_f32 v38, v24, v25
    v_cvt_pk_bf16_f32 v39, v26, v27
    buffer_store_dwordx4 v[36:39], v251, s[4:7], s53 offen offset:1024 sc1
    v_accvgpr_read_b32 v40, a16
    v_accvgpr_read_b32 v41, a17
    v_accvgpr_read_b32 v42, a18
    v_accvgpr_read_b32 v43, a19
    v_accvgpr_read_b32 v44, a20
    v_accvgpr_read_b32 v45, a21
    v_accvgpr_read_b32 v46, a22
    v_accvgpr_read_b32 v47, a23
    v_cvt_pk_bf16_f32 v56, v40, v41
    v_cvt_pk_bf16_f32 v57, v42, v43
    v_cvt_pk_bf16_f32 v58, v44, v45
    v_cvt_pk_bf16_f32 v59, v46, v47
    buffer_store_dwordx4 v[56:59], v251, s[4:7], s53 offen offset:2048 sc1
    v_accvgpr_read_b32 v0, a24
    v_accvgpr_read_b32 v1, a25
    v_accvgpr_read_b32 v2, a26
    v_accvgpr_read_b32 v3, a27
    v_accvgpr_read_b32 v4, a28
    v_accvgpr_read_b32 v5, a29
    v_accvgpr_read_b32 v6, a30
    v_accvgpr_read_b32 v7, a31
    v_cvt_pk_bf16_f32 v16, v0, v1
    v_cvt_pk_bf16_f32 v17, v2, v3
    v_cvt_pk_bf16_f32 v18, v4, v5
    v_cvt_pk_bf16_f32 v19, v6, v7
    buffer_store_dwordx4 v[16:19], v251, s[4:7], s53 offen offset:3072 sc1
    s_add_u32 s53, s53, s22
    v_accvgpr_read_b32 v20, a32
    v_accvgpr_read_b32 v21, a33
    v_accvgpr_read_b32 v22, a34
    v_accvgpr_read_b32 v23, a35
    v_accvgpr_read_b32 v24, a36
    v_accvgpr_read_b32 v25, a37
    v_accvgpr_read_b32 v26, a38
    v_accvgpr_read_b32 v27, a39
    v_cvt_pk_bf16_f32 v36, v20, v21
    v_cvt_pk_bf16_f32 v37, v22, v23
    v_cvt_pk_bf16_f32 v38, v24, v25
    v_cvt_pk_bf16_f32 v39, v26, v27
    buffer_store_dwordx4 v[36:39], v251, s[4:7], s53 offen offset:0 sc1
    v_accvgpr_read_b32 v40, a40
    v_accvgpr_read_b32 v41, a41
    v_accvgpr_read_b32 v42, a42
    v_accvgpr_read_b32 v43, a43
    v_accvgpr_read_b32 v44, a44
    v_accvgpr_read_b32 v45, a45
    v_accvgpr_read_b32 v46, a46
    v_accvgpr_read_b32 v47, a47
    v_cvt_pk_bf16_f32 v56, v40, v41
    v_cvt_pk_bf16_f32 v57, v42, v43
    v_cvt_pk_bf16_f32 v58, v44, v45
    v_cvt_pk_bf16_f32 v59, v46, v47
    buffer_store_dwordx4 v[56:59], v251, s[4:7], s53 offen offset:1024 sc1
    v_accvgpr_read_b32 v0, a48
    v_accvgpr_read_b32 v1, a49
    v_accvgpr_read_b32 v2, a50
    v_accvgpr_read_b32 v3, a51
    v_accvgpr_read_b32 v4, a52
    v_accvgpr_read_b32 v5, a53
    v_accvgpr_read_b32 v6, a54
    v_accvgpr_read_b32 v7, a55
    v_cvt_pk_bf16_f32 v16, v0, v1
    v_cvt_pk_bf16_f32 v17, v2, v3
    v_cvt_pk_bf16_f32 v18, v4, v5
    v_cvt_pk_bf16_f32 v19, v6, v7
    buffer_store_dwordx4 v[16:19], v251, s[4:7], s53 offen offset:2048 sc1
    v_accvgpr_read_b32 v20, a56
    v_accvgpr_read_b32 v21, a57
    v_accvgpr_read_b32 v22, a58
    v_accvgpr_read_b32 v23, a59
    v_accvgpr_read_b32 v24, a60
    v_accvgpr_read_b32 v25, a61
    v_accvgpr_read_b32 v26, a62
    v_accvgpr_read_b32 v27, a63
    v_cvt_pk_bf16_f32 v36, v20, v21
    v_cvt_pk_bf16_f32 v37, v22, v23
    v_cvt_pk_bf16_f32 v38, v24, v25
    v_cvt_pk_bf16_f32 v39, v26, v27
    buffer_store_dwordx4 v[36:39], v251, s[4:7], s53 offen offset:3072 sc1
    s_add_u32 s53, s53, s22
    v_accvgpr_read_b32 v40, a64
    v_accvgpr_read_b32 v41, a65
    v_accvgpr_read_b32 v42, a66
    v_accvgpr_read_b32 v43, a67
    v_accvgpr_read_b32 v44, a68
    v_accvgpr_read_b32 v45, a69
    v_accvgpr_read_b32 v46, a70
    v_accvgpr_read_b32 v47, a71
    v_cvt_pk_bf16_f32 v56, v40, v41
    v_cvt_pk_bf16_f32 v57, v42, v43
    v_cvt_pk_bf16_f32 v58, v44, v45
    v_cvt_pk_bf16_f32 v59, v46, v47
    buffer_store_dwordx4 v[56:59], v251, s[4:7], s53 offen offset:0 sc1
    v_accvgpr_read_b32 v0, a72
    v_accvgpr_read_b32 v1, a73
    v_accvgpr_read_b32 v2, a74
    v_accvgpr_read_b32 v3, a75
    v_accvgpr_read_b32 v4, a76
    v_accvgpr_read_b32 v5, a77
    v_accvgpr_read_b32 v6, a78
    v_accvgpr_read_b32 v7, a79
    v_cvt_pk_bf16_f32 v16, v0, v1
    v_cvt_pk_bf16_f32 v17, v2, v3
    v_cvt_pk_bf16_f32 v18, v4, v5
    v_cvt_pk_bf16_f32 v19, v6, v7
    buffer_store_dwordx4 v[16:19], v251, s[4:7], s53 offen offset:1024 sc1
    v_accvgpr_read_b32 v20, a80
    v_accvgpr_read_b32 v21, a81
    v_accvgpr_read_b32 v22, a82
    v_accvgpr_read_b32 v23, a83
    v_accvgpr_read_b32 v24, a84
    v_accvgpr_read_b32 v25, a85
    v_accvgpr_read_b32 v26, a86
    v_accvgpr_read_b32 v27, a87
    v_cvt_pk_bf16_f32 v36, v20, v21
    v_cvt_pk_bf16_f32 v37, v22, v23
    v_cvt_pk_bf16_f32 v38, v24, v25
    v_cvt_pk_bf16_f32 v39, v26, v27
    buffer_store_dwordx4 v[36:39], v251, s[4:7], s53 offen offset:2048 sc1
    v_accvgpr_read_b32 v40, a88
    v_accvgpr_read_b32 v41, a89
    v_accvgpr_read_b32 v42, a90
    v_accvgpr_read_b32 v43, a91
    v_accvgpr_read_b32 v44, a92
    v_accvgpr_read_b32 v45, a93
    v_accvgpr_read_b32 v46, a94
    v_accvgpr_read_b32 v47, a95
    v_cvt_pk_bf16_f32 v56, v40, v41
    v_cvt_pk_bf16_f32 v57, v42, v43
    v_cvt_pk_bf16_f32 v58, v44, v45
    v_cvt_pk_bf16_f32 v59, v46, v47
    buffer_store_dwordx4 v[56:59], v251, s[4:7], s53 offen offset:3072 sc1
    s_add_u32 s53, s53, s22
    v_accvgpr_read_b32 v0, a96
    v_accvgpr_read_b32 v1, a97
    v_accvgpr_read_b32 v2, a98
    v_accvgpr_read_b32 v3, a99
    v_accvgpr_read_b32 v4, a100
    v_accvgpr_read_b32 v5, a101
    v_accvgpr_read_b32 v6, a102
    v_accvgpr_read_b32 v7, a103
    v_cvt_pk_bf16_f32 v16, v0, v1
    v_cvt_pk_bf16_f32 v17, v2, v3
    v_cvt_pk_bf16_f32 v18, v4, v5
    v_cvt_pk_bf16_f32 v19, v6, v7
    buffer_store_dwordx4 v[16:19], v251, s[4:7], s53 offen offset:0 sc1
    v_accvgpr_read_b32 v20, a104
    v_accvgpr_read_b32 v21, a105
    v_accvgpr_read_b32 v22, a106
    v_accvgpr_read_b32 v23, a107
    v_accvgpr_read_b32 v24, a108
    v_accvgpr_read_b32 v25, a109
    v_accvgpr_read_b32 v26, a110
    v_accvgpr_read_b32 v27, a111
    v_cvt_pk_bf16_f32 v36, v20, v21
    v_cvt_pk_bf16_f32 v37, v22, v23
    v_cvt_pk_bf16_f32 v38, v24, v25
    v_cvt_pk_bf16_f32 v39, v26, v27
    buffer_store_dwordx4 v[36:39], v251, s[4:7], s53 offen offset:1024 sc1
    v_accvgpr_read_b32 v40, a112
    v_accvgpr_read_b32 v41, a113
    v_accvgpr_read_b32 v42, a114
    v_accvgpr_read_b32 v43, a115
    v_accvgpr_read_b32 v44, a116
    v_accvgpr_read_b32 v45, a117
    v_accvgpr_read_b32 v46, a118
    v_accvgpr_read_b32 v47, a119
    v_cvt_pk_bf16_f32 v56, v40, v41
    v_cvt_pk_bf16_f32 v57, v42, v43
    v_cvt_pk_bf16_f32 v58, v44, v45
    v_cvt_pk_bf16_f32 v59, v46, v47
    buffer_store_dwordx4 v[56:59], v251, s[4:7], s53 offen offset:2048 sc1
    v_accvgpr_read_b32 v0, a120
    v_accvgpr_read_b32 v1, a121
    v_accvgpr_read_b32 v2, a122
    v_accvgpr_read_b32 v3, a123
    v_accvgpr_read_b32 v4, a124
    v_accvgpr_read_b32 v5, a125
    v_accvgpr_read_b32 v6, a126
    v_accvgpr_read_b32 v7, a127
    v_cvt_pk_bf16_f32 v16, v0, v1
    v_cvt_pk_bf16_f32 v17, v2, v3
    v_cvt_pk_bf16_f32 v18, v4, v5
    v_cvt_pk_bf16_f32 v19, v6, v7
    buffer_store_dwordx4 v[16:19], v251, s[4:7], s53 offen offset:3072 sc1
    s_add_u32 s53, s53, s22
    v_accvgpr_read_b32 v20, a128
    v_accvgpr_read_b32 v21, a129
    v_accvgpr_read_b32 v22, a130
    v_accvgpr_read_b32 v23, a131
    v_accvgpr_read_b32 v24, a132
    v_accvgpr_read_b32 v25, a133
    v_accvgpr_read_b32 v26, a134
    v_accvgpr_read_b32 v27, a135
    v_cvt_pk_bf16_f32 v36, v20, v21
    v_cvt_pk_bf16_f32 v37, v22, v23
    v_cvt_pk_bf16_f32 v38, v24, v25
    v_cvt_pk_bf16_f32 v39, v26, v27
    buffer_store_dwordx4 v[36:39], v251, s[4:7], s53 offen offset:0 sc1
    v_accvgpr_read_b32 v40, a136
    v_accvgpr_read_b32 v41, a137
    v_accvgpr_read_b32 v42, a138
    v_accvgpr_read_b32 v43, a139
    v_accvgpr_read_b32 v44, a140
    v_accvgpr_read_b32 v45, a141
    v_accvgpr_read_b32 v46, a142
    v_accvgpr_read_b32 v47, a143
    v_cvt_pk_bf16_f32 v56, v40, v41
    v_cvt_pk_bf16_f32 v57, v42, v43
    v_cvt_pk_bf16_f32 v58, v44, v45
    v_cvt_pk_bf16_f32 v59, v46, v47
    buffer_store_dwordx4 v[56:59], v251, s[4:7], s53 offen offset:1024 sc1
    v_accvgpr_read_b32 v0, a144
    v_accvgpr_read_b32 v1, a145
    v_accvgpr_read_b32 v2, a146
    v_accvgpr_read_b32 v3, a147
    v_accvgpr_read_b32 v4, a148
    v_accvgpr_read_b32 v5, a149
    v_accvgpr_read_b32 v6, a150
    v_accvgpr_read_b32 v7, a151
    v_cvt_pk_bf16_f32 v16, v0, v1
    v_cvt_pk_bf16_f32 v17, v2, v3
    v_cvt_pk_bf16_f32 v18, v4, v5
    v_cvt_pk_bf16_f32 v19, v6, v7
    buffer_store_dwordx4 v[16:19], v251, s[4:7], s53 offen offset:2048 sc1
    v_accvgpr_read_b32 v20, a152
    v_accvgpr_read_b32 v21, a153
    v_accvgpr_read_b32 v22, a154
    v_accvgpr_read_b32 v23, a155
    v_accvgpr_read_b32 v24, a156
    v_accvgpr_read_b32 v25, a157
    v_accvgpr_read_b32 v26, a158
    v_accvgpr_read_b32 v27, a159
    v_cvt_pk_bf16_f32 v36, v20, v21
    v_cvt_pk_bf16_f32 v37, v22, v23
    v_cvt_pk_bf16_f32 v38, v24, v25
    v_cvt_pk_bf16_f32 v39, v26, v27
    buffer_store_dwordx4 v[36:39], v251, s[4:7], s53 offen offset:3072 sc1
    s_add_u32 s53, s53, s22
    v_accvgpr_read_b32 v40, a160
    v_accvgpr_read_b32 v41, a161
    v_accvgpr_read_b32 v42, a162
    v_accvgpr_read_b32 v43, a163
    v_accvgpr_read_b32 v44, a164
    v_accvgpr_read_b32 v45, a165
    v_accvgpr_read_b32 v46, a166
    v_accvgpr_read_b32 v47, a167
    v_cvt_pk_bf16_f32 v56, v40, v41
    v_cvt_pk_bf16_f32 v57, v42, v43
    v_cvt_pk_bf16_f32 v58, v44, v45
    v_cvt_pk_bf16_f32 v59, v46, v47
    buffer_store_dwordx4 v[56:59], v251, s[4:7], s53 offen offset:0 sc1
    v_accvgpr_read_b32 v0, a168
    v_accvgpr_read_b32 v1, a169
    v_accvgpr_read_b32 v2, a170
    v_accvgpr_read_b32 v3, a171
    v_accvgpr_read_b32 v4, a172
    v_accvgpr_read_b32 v5, a173
    v_accvgpr_read_b32 v6, a174
    v_accvgpr_read_b32 v7, a175
    v_cvt_pk_bf16_f32 v16, v0, v1
    v_cvt_pk_bf16_f32 v17, v2, v3
    v_cvt_pk_bf16_f32 v18, v4, v5
    v_cvt_pk_bf16_f32 v19, v6, v7
    buffer_store_dwordx4 v[16:19], v251, s[4:7], s53 offen offset:1024 sc1
    v_accvgpr_read_b32 v20, a176
    v_accvgpr_read_b32 v21, a177
    v_accvgpr_read_b32 v22, a178
    v_accvgpr_read_b32 v23, a179
    v_accvgpr_read_b32 v24, a180
    v_accvgpr_read_b32 v25, a181
    v_accvgpr_read_b32 v26, a182
    v_accvgpr_read_b32 v27, a183
    v_cvt_pk_bf16_f32 v36, v20, v21
    v_cvt_pk_bf16_f32 v37, v22, v23
    v_cvt_pk_bf16_f32 v38, v24, v25
    v_cvt_pk_bf16_f32 v39, v26, v27
    buffer_store_dwordx4 v[36:39], v251, s[4:7], s53 offen offset:2048 sc1
    v_accvgpr_read_b32 v40, a184
    v_accvgpr_read_b32 v41, a185
    v_accvgpr_read_b32 v42, a186
    v_accvgpr_read_b32 v43, a187
    v_accvgpr_read_b32 v44, a188
    v_accvgpr_read_b32 v45, a189
    v_accvgpr_read_b32 v46, a190
    v_accvgpr_read_b32 v47, a191
    v_cvt_pk_bf16_f32 v56, v40, v41
    v_cvt_pk_bf16_f32 v57, v42, v43
    v_cvt_pk_bf16_f32 v58, v44, v45
    v_cvt_pk_bf16_f32 v59, v46, v47
    buffer_store_dwordx4 v[56:59], v251, s[4:7], s53 offen offset:3072 sc1
    s_add_u32 s53, s53, s22
    v_accvgpr_read_b32 v0, a192
    v_accvgpr_read_b32 v1, a193
    v_accvgpr_read_b32 v2, a194
    v_accvgpr_read_b32 v3, a195
    v_accvgpr_read_b32 v4, a196
    v_accvgpr_read_b32 v5, a197
    v_accvgpr_read_b32 v6, a198
    v_accvgpr_read_b32 v7, a199
    v_cvt_pk_bf16_f32 v16, v0, v1
    v_cvt_pk_bf16_f32 v17, v2, v3
    v_cvt_pk_bf16_f32 v18, v4, v5
    v_cvt_pk_bf16_f32 v19, v6, v7
    buffer_store_dwordx4 v[16:19], v251, s[4:7], s53 offen offset:0 sc1
    v_accvgpr_read_b32 v20, a200
    v_accvgpr_read_b32 v21, a201
    v_accvgpr_read_b32 v22, a202
    v_accvgpr_read_b32 v23, a203
    v_accvgpr_read_b32 v24, a204
    v_accvgpr_read_b32 v25, a205
    v_accvgpr_read_b32 v26, a206
    v_accvgpr_read_b32 v27, a207
    v_cvt_pk_bf16_f32 v36, v20, v21
    v_cvt_pk_bf16_f32 v37, v22, v23
    v_cvt_pk_bf16_f32 v38, v24, v25
    v_cvt_pk_bf16_f32 v39, v26, v27
    buffer_store_dwordx4 v[36:39], v251, s[4:7], s53 offen offset:1024 sc1
    v_accvgpr_read_b32 v40, a208
    v_accvgpr_read_b32 v41, a209
    v_accvgpr_read_b32 v42, a210
    v_accvgpr_read_b32 v43, a211
    v_accvgpr_read_b32 v44, a212
    v_accvgpr_read_b32 v45, a213
    v_accvgpr_read_b32 v46, a214
    v_accvgpr_read_b32 v47, a215
    v_cvt_pk_bf16_f32 v56, v40, v41
    v_cvt_pk_bf16_f32 v57, v42, v43
    v_cvt_pk_bf16_f32 v58, v44, v45
    v_cvt_pk_bf16_f32 v59, v46, v47
    buffer_store_dwordx4 v[56:59], v251, s[4:7], s53 offen offset:2048 sc1
    v_accvgpr_read_b32 v0, a216
    v_accvgpr_read_b32 v1, a217
    v_accvgpr_read_b32 v2, a218
    v_accvgpr_read_b32 v3, a219
    v_accvgpr_read_b32 v4, a220
    v_accvgpr_read_b32 v5, a221
    v_accvgpr_read_b32 v6, a222
    v_accvgpr_read_b32 v7, a223
    v_cvt_pk_bf16_f32 v16, v0, v1
    v_cvt_pk_bf16_f32 v17, v2, v3
    v_cvt_pk_bf16_f32 v18, v4, v5
    v_cvt_pk_bf16_f32 v19, v6, v7
    buffer_store_dwordx4 v[16:19], v251, s[4:7], s53 offen offset:3072 sc1
    s_add_u32 s53, s53, s22
    v_accvgpr_read_b32 v20, a224
    v_accvgpr_read_b32 v21, a225
    v_accvgpr_read_b32 v22, a226
    v_accvgpr_read_b32 v23, a227
    v_accvgpr_read_b32 v24, a228
    v_accvgpr_read_b32 v25, a229
    v_accvgpr_read_b32 v26, a230
    v_accvgpr_read_b32 v27, a231
    v_cvt_pk_bf16_f32 v36, v20, v21
    v_cvt_pk_bf16_f32 v37, v22, v23
    v_cvt_pk_bf16_f32 v38, v24, v25
    v_cvt_pk_bf16_f32 v39, v26, v27
    buffer_store_dwordx4 v[36:39], v251, s[4:7], s53 offen offset:0 sc1
    v_accvgpr_read_b32 v40, a232
    v_accvgpr_read_b32 v41, a233
    v_accvgpr_read_b32 v42, a234
    v_accvgpr_read_b32 v43, a235
    v_accvgpr_read_b32 v44, a236
    v_accvgpr_read_b32 v45, a237
    v_accvgpr_read_b32 v46, a238
    v_accvgpr_read_b32 v47, a239
    v_cvt_pk_bf16_f32 v56, v40, v41
    v_cvt_pk_bf16_f32 v57, v42, v43
    v_cvt_pk_bf16_f32 v58, v44, v45
    v_cvt_pk_bf16_f32 v59, v46, v47
    buffer_store_dwordx4 v[56:59], v251, s[4:7], s53 offen offset:1024 sc1
    v_accvgpr_read_b32 v0, a240
    v_accvgpr_read_b32 v1, a241
    v_accvgpr_read_b32 v2, a242
    v_accvgpr_read_b32 v3, a243
    v_accvgpr_read_b32 v4, a244
    v_accvgpr_read_b32 v5, a245
    v_accvgpr_read_b32 v6, a246
    v_accvgpr_read_b32 v7, a247
    v_cvt_pk_bf16_f32 v16, v0, v1
    v_cvt_pk_bf16_f32 v17, v2, v3
    v_cvt_pk_bf16_f32 v18, v4, v5
    v_cvt_pk_bf16_f32 v19, v6, v7
    buffer_store_dwordx4 v[16:19], v251, s[4:7], s53 offen offset:2048 sc1
    v_accvgpr_read_b32 v20, a248
    v_accvgpr_read_b32 v21, a249
    v_accvgpr_read_b32 v22, a250
    v_accvgpr_read_b32 v23, a251
    v_accvgpr_read_b32 v24, a252
    v_accvgpr_read_b32 v25, a253
    v_accvgpr_read_b32 v26, a254
    v_accvgpr_read_b32 v27, a255
    v_cvt_pk_bf16_f32 v36, v20, v21
    v_cvt_pk_bf16_f32 v37, v22, v23
    v_cvt_pk_bf16_f32 v38, v24, v25
    v_cvt_pk_bf16_f32 v39, v26, v27
    buffer_store_dwordx4 v[36:39], v251, s[4:7], s53 offen offset:3072 sc1
    s_branch main_kernel_w_done
main_kernel_w_c2_escl:
    s_mov_b32 s53, s21
    v_accvgpr_read_b32 v0, a0
    v_accvgpr_read_b32 v1, a1
    v_accvgpr_read_b32 v2, a2
    v_accvgpr_read_b32 v3, a3
    v_accvgpr_read_b32 v4, a4
    v_accvgpr_read_b32 v5, a5
    v_accvgpr_read_b32 v6, a6
    v_accvgpr_read_b32 v7, a7
    v_mul_f32 v0, 0x3e0293ee, v0
    v_mul_f32 v1, 0x3e0293ee, v1
    v_mul_f32 v2, 0x3e0293ee, v2
    v_mul_f32 v3, 0x3e0293ee, v3
    v_mul_f32 v4, 0x3e0293ee, v4
    v_mul_f32 v5, 0x3e0293ee, v5
    v_mul_f32 v6, 0x3e0293ee, v6
    v_mul_f32 v7, 0x3e0293ee, v7
    v_cvt_pk_bf16_f32 v16, v0, v1
    v_cvt_pk_bf16_f32 v17, v2, v3
    v_cvt_pk_bf16_f32 v18, v4, v5
    v_cvt_pk_bf16_f32 v19, v6, v7
    buffer_store_dwordx4 v[16:19], v251, s[4:7], s53 offen offset:0 sc1
    v_accvgpr_read_b32 v20, a8
    v_accvgpr_read_b32 v21, a9
    v_accvgpr_read_b32 v22, a10
    v_accvgpr_read_b32 v23, a11
    v_accvgpr_read_b32 v24, a12
    v_accvgpr_read_b32 v25, a13
    v_accvgpr_read_b32 v26, a14
    v_accvgpr_read_b32 v27, a15
    v_mul_f32 v20, 0x3e0293ee, v20
    v_mul_f32 v21, 0x3e0293ee, v21
    v_mul_f32 v22, 0x3e0293ee, v22
    v_mul_f32 v23, 0x3e0293ee, v23
    v_mul_f32 v24, 0x3e0293ee, v24
    v_mul_f32 v25, 0x3e0293ee, v25
    v_mul_f32 v26, 0x3e0293ee, v26
    v_mul_f32 v27, 0x3e0293ee, v27
    v_cvt_pk_bf16_f32 v36, v20, v21
    v_cvt_pk_bf16_f32 v37, v22, v23
    v_cvt_pk_bf16_f32 v38, v24, v25
    v_cvt_pk_bf16_f32 v39, v26, v27
    buffer_store_dwordx4 v[36:39], v251, s[4:7], s53 offen offset:1024 sc1
    v_accvgpr_read_b32 v40, a16
    v_accvgpr_read_b32 v41, a17
    v_accvgpr_read_b32 v42, a18
    v_accvgpr_read_b32 v43, a19
    v_accvgpr_read_b32 v44, a20
    v_accvgpr_read_b32 v45, a21
    v_accvgpr_read_b32 v46, a22
    v_accvgpr_read_b32 v47, a23
    v_mul_f32 v40, 0x3e0293ee, v40
    v_mul_f32 v41, 0x3e0293ee, v41
    v_mul_f32 v42, 0x3e0293ee, v42
    v_mul_f32 v43, 0x3e0293ee, v43
    v_mul_f32 v44, 0x3e0293ee, v44
    v_mul_f32 v45, 0x3e0293ee, v45
    v_mul_f32 v46, 0x3e0293ee, v46
    v_mul_f32 v47, 0x3e0293ee, v47
    v_cvt_pk_bf16_f32 v56, v40, v41
    v_cvt_pk_bf16_f32 v57, v42, v43
    v_cvt_pk_bf16_f32 v58, v44, v45
    v_cvt_pk_bf16_f32 v59, v46, v47
    buffer_store_dwordx4 v[56:59], v251, s[4:7], s53 offen offset:2048 sc1
    v_accvgpr_read_b32 v0, a24
    v_accvgpr_read_b32 v1, a25
    v_accvgpr_read_b32 v2, a26
    v_accvgpr_read_b32 v3, a27
    v_accvgpr_read_b32 v4, a28
    v_accvgpr_read_b32 v5, a29
    v_accvgpr_read_b32 v6, a30
    v_accvgpr_read_b32 v7, a31
    v_mul_f32 v0, 0x3e0293ee, v0
    v_mul_f32 v1, 0x3e0293ee, v1
    v_mul_f32 v2, 0x3e0293ee, v2
    v_mul_f32 v3, 0x3e0293ee, v3
    v_mul_f32 v4, 0x3e0293ee, v4
    v_mul_f32 v5, 0x3e0293ee, v5
    v_mul_f32 v6, 0x3e0293ee, v6
    v_mul_f32 v7, 0x3e0293ee, v7
    v_cvt_pk_bf16_f32 v16, v0, v1
    v_cvt_pk_bf16_f32 v17, v2, v3
    v_cvt_pk_bf16_f32 v18, v4, v5
    v_cvt_pk_bf16_f32 v19, v6, v7
    buffer_store_dwordx4 v[16:19], v251, s[4:7], s53 offen offset:3072 sc1
    s_add_u32 s53, s53, s22
    v_accvgpr_read_b32 v20, a32
    v_accvgpr_read_b32 v21, a33
    v_accvgpr_read_b32 v22, a34
    v_accvgpr_read_b32 v23, a35
    v_accvgpr_read_b32 v24, a36
    v_accvgpr_read_b32 v25, a37
    v_accvgpr_read_b32 v26, a38
    v_accvgpr_read_b32 v27, a39
    v_mul_f32 v20, 0x3e0293ee, v20
    v_mul_f32 v21, 0x3e0293ee, v21
    v_mul_f32 v22, 0x3e0293ee, v22
    v_mul_f32 v23, 0x3e0293ee, v23
    v_mul_f32 v24, 0x3e0293ee, v24
    v_mul_f32 v25, 0x3e0293ee, v25
    v_mul_f32 v26, 0x3e0293ee, v26
    v_mul_f32 v27, 0x3e0293ee, v27
    v_cvt_pk_bf16_f32 v36, v20, v21
    v_cvt_pk_bf16_f32 v37, v22, v23
    v_cvt_pk_bf16_f32 v38, v24, v25
    v_cvt_pk_bf16_f32 v39, v26, v27
    buffer_store_dwordx4 v[36:39], v251, s[4:7], s53 offen offset:0 sc1
    v_accvgpr_read_b32 v40, a40
    v_accvgpr_read_b32 v41, a41
    v_accvgpr_read_b32 v42, a42
    v_accvgpr_read_b32 v43, a43
    v_accvgpr_read_b32 v44, a44
    v_accvgpr_read_b32 v45, a45
    v_accvgpr_read_b32 v46, a46
    v_accvgpr_read_b32 v47, a47
    v_mul_f32 v40, 0x3e0293ee, v40
    v_mul_f32 v41, 0x3e0293ee, v41
    v_mul_f32 v42, 0x3e0293ee, v42
    v_mul_f32 v43, 0x3e0293ee, v43
    v_mul_f32 v44, 0x3e0293ee, v44
    v_mul_f32 v45, 0x3e0293ee, v45
    v_mul_f32 v46, 0x3e0293ee, v46
    v_mul_f32 v47, 0x3e0293ee, v47
    v_cvt_pk_bf16_f32 v56, v40, v41
    v_cvt_pk_bf16_f32 v57, v42, v43
    v_cvt_pk_bf16_f32 v58, v44, v45
    v_cvt_pk_bf16_f32 v59, v46, v47
    buffer_store_dwordx4 v[56:59], v251, s[4:7], s53 offen offset:1024 sc1
    v_accvgpr_read_b32 v0, a48
    v_accvgpr_read_b32 v1, a49
    v_accvgpr_read_b32 v2, a50
    v_accvgpr_read_b32 v3, a51
    v_accvgpr_read_b32 v4, a52
    v_accvgpr_read_b32 v5, a53
    v_accvgpr_read_b32 v6, a54
    v_accvgpr_read_b32 v7, a55
    v_mul_f32 v0, 0x3e0293ee, v0
    v_mul_f32 v1, 0x3e0293ee, v1
    v_mul_f32 v2, 0x3e0293ee, v2
    v_mul_f32 v3, 0x3e0293ee, v3
    v_mul_f32 v4, 0x3e0293ee, v4
    v_mul_f32 v5, 0x3e0293ee, v5
    v_mul_f32 v6, 0x3e0293ee, v6
    v_mul_f32 v7, 0x3e0293ee, v7
    v_cvt_pk_bf16_f32 v16, v0, v1
    v_cvt_pk_bf16_f32 v17, v2, v3
    v_cvt_pk_bf16_f32 v18, v4, v5
    v_cvt_pk_bf16_f32 v19, v6, v7
    buffer_store_dwordx4 v[16:19], v251, s[4:7], s53 offen offset:2048 sc1
    v_accvgpr_read_b32 v20, a56
    v_accvgpr_read_b32 v21, a57
    v_accvgpr_read_b32 v22, a58
    v_accvgpr_read_b32 v23, a59
    v_accvgpr_read_b32 v24, a60
    v_accvgpr_read_b32 v25, a61
    v_accvgpr_read_b32 v26, a62
    v_accvgpr_read_b32 v27, a63
    v_mul_f32 v20, 0x3e0293ee, v20
    v_mul_f32 v21, 0x3e0293ee, v21
    v_mul_f32 v22, 0x3e0293ee, v22
    v_mul_f32 v23, 0x3e0293ee, v23
    v_mul_f32 v24, 0x3e0293ee, v24
    v_mul_f32 v25, 0x3e0293ee, v25
    v_mul_f32 v26, 0x3e0293ee, v26
    v_mul_f32 v27, 0x3e0293ee, v27
    v_cvt_pk_bf16_f32 v36, v20, v21
    v_cvt_pk_bf16_f32 v37, v22, v23
    v_cvt_pk_bf16_f32 v38, v24, v25
    v_cvt_pk_bf16_f32 v39, v26, v27
    buffer_store_dwordx4 v[36:39], v251, s[4:7], s53 offen offset:3072 sc1
    s_add_u32 s53, s53, s22
    v_accvgpr_read_b32 v40, a64
    v_accvgpr_read_b32 v41, a65
    v_accvgpr_read_b32 v42, a66
    v_accvgpr_read_b32 v43, a67
    v_accvgpr_read_b32 v44, a68
    v_accvgpr_read_b32 v45, a69
    v_accvgpr_read_b32 v46, a70
    v_accvgpr_read_b32 v47, a71
    v_mul_f32 v40, 0x3e0293ee, v40
    v_mul_f32 v41, 0x3e0293ee, v41
    v_mul_f32 v42, 0x3e0293ee, v42
    v_mul_f32 v43, 0x3e0293ee, v43
    v_mul_f32 v44, 0x3e0293ee, v44
    v_mul_f32 v45, 0x3e0293ee, v45
    v_mul_f32 v46, 0x3e0293ee, v46
    v_mul_f32 v47, 0x3e0293ee, v47
    v_cvt_pk_bf16_f32 v56, v40, v41
    v_cvt_pk_bf16_f32 v57, v42, v43
    v_cvt_pk_bf16_f32 v58, v44, v45
    v_cvt_pk_bf16_f32 v59, v46, v47
    buffer_store_dwordx4 v[56:59], v251, s[4:7], s53 offen offset:0 sc1
    v_accvgpr_read_b32 v0, a72
    v_accvgpr_read_b32 v1, a73
    v_accvgpr_read_b32 v2, a74
    v_accvgpr_read_b32 v3, a75
    v_accvgpr_read_b32 v4, a76
    v_accvgpr_read_b32 v5, a77
    v_accvgpr_read_b32 v6, a78
    v_accvgpr_read_b32 v7, a79
    v_mul_f32 v0, 0x3e0293ee, v0
    v_mul_f32 v1, 0x3e0293ee, v1
    v_mul_f32 v2, 0x3e0293ee, v2
    v_mul_f32 v3, 0x3e0293ee, v3
    v_mul_f32 v4, 0x3e0293ee, v4
    v_mul_f32 v5, 0x3e0293ee, v5
    v_mul_f32 v6, 0x3e0293ee, v6
    v_mul_f32 v7, 0x3e0293ee, v7
    v_cvt_pk_bf16_f32 v16, v0, v1
    v_cvt_pk_bf16_f32 v17, v2, v3
    v_cvt_pk_bf16_f32 v18, v4, v5
    v_cvt_pk_bf16_f32 v19, v6, v7
    buffer_store_dwordx4 v[16:19], v251, s[4:7], s53 offen offset:1024 sc1
    v_accvgpr_read_b32 v20, a80
    v_accvgpr_read_b32 v21, a81
    v_accvgpr_read_b32 v22, a82
    v_accvgpr_read_b32 v23, a83
    v_accvgpr_read_b32 v24, a84
    v_accvgpr_read_b32 v25, a85
    v_accvgpr_read_b32 v26, a86
    v_accvgpr_read_b32 v27, a87
    v_mul_f32 v20, 0x3e0293ee, v20
    v_mul_f32 v21, 0x3e0293ee, v21
    v_mul_f32 v22, 0x3e0293ee, v22
    v_mul_f32 v23, 0x3e0293ee, v23
    v_mul_f32 v24, 0x3e0293ee, v24
    v_mul_f32 v25, 0x3e0293ee, v25
    v_mul_f32 v26, 0x3e0293ee, v26
    v_mul_f32 v27, 0x3e0293ee, v27
    v_cvt_pk_bf16_f32 v36, v20, v21
    v_cvt_pk_bf16_f32 v37, v22, v23
    v_cvt_pk_bf16_f32 v38, v24, v25
    v_cvt_pk_bf16_f32 v39, v26, v27
    buffer_store_dwordx4 v[36:39], v251, s[4:7], s53 offen offset:2048 sc1
    v_accvgpr_read_b32 v40, a88
    v_accvgpr_read_b32 v41, a89
    v_accvgpr_read_b32 v42, a90
    v_accvgpr_read_b32 v43, a91
    v_accvgpr_read_b32 v44, a92
    v_accvgpr_read_b32 v45, a93
    v_accvgpr_read_b32 v46, a94
    v_accvgpr_read_b32 v47, a95
    v_mul_f32 v40, 0x3e0293ee, v40
    v_mul_f32 v41, 0x3e0293ee, v41
    v_mul_f32 v42, 0x3e0293ee, v42
    v_mul_f32 v43, 0x3e0293ee, v43
    v_mul_f32 v44, 0x3e0293ee, v44
    v_mul_f32 v45, 0x3e0293ee, v45
    v_mul_f32 v46, 0x3e0293ee, v46
    v_mul_f32 v47, 0x3e0293ee, v47
    v_cvt_pk_bf16_f32 v56, v40, v41
    v_cvt_pk_bf16_f32 v57, v42, v43
    v_cvt_pk_bf16_f32 v58, v44, v45
    v_cvt_pk_bf16_f32 v59, v46, v47
    buffer_store_dwordx4 v[56:59], v251, s[4:7], s53 offen offset:3072 sc1
    s_add_u32 s53, s53, s22
    v_accvgpr_read_b32 v0, a96
    v_accvgpr_read_b32 v1, a97
    v_accvgpr_read_b32 v2, a98
    v_accvgpr_read_b32 v3, a99
    v_accvgpr_read_b32 v4, a100
    v_accvgpr_read_b32 v5, a101
    v_accvgpr_read_b32 v6, a102
    v_accvgpr_read_b32 v7, a103
    v_mul_f32 v0, 0x3e0293ee, v0
    v_mul_f32 v1, 0x3e0293ee, v1
    v_mul_f32 v2, 0x3e0293ee, v2
    v_mul_f32 v3, 0x3e0293ee, v3
    v_mul_f32 v4, 0x3e0293ee, v4
    v_mul_f32 v5, 0x3e0293ee, v5
    v_mul_f32 v6, 0x3e0293ee, v6
    v_mul_f32 v7, 0x3e0293ee, v7
    v_cvt_pk_bf16_f32 v16, v0, v1
    v_cvt_pk_bf16_f32 v17, v2, v3
    v_cvt_pk_bf16_f32 v18, v4, v5
    v_cvt_pk_bf16_f32 v19, v6, v7
    buffer_store_dwordx4 v[16:19], v251, s[4:7], s53 offen offset:0 sc1
    v_accvgpr_read_b32 v20, a104
    v_accvgpr_read_b32 v21, a105
    v_accvgpr_read_b32 v22, a106
    v_accvgpr_read_b32 v23, a107
    v_accvgpr_read_b32 v24, a108
    v_accvgpr_read_b32 v25, a109
    v_accvgpr_read_b32 v26, a110
    v_accvgpr_read_b32 v27, a111
    v_mul_f32 v20, 0x3e0293ee, v20
    v_mul_f32 v21, 0x3e0293ee, v21
    v_mul_f32 v22, 0x3e0293ee, v22
    v_mul_f32 v23, 0x3e0293ee, v23
    v_mul_f32 v24, 0x3e0293ee, v24
    v_mul_f32 v25, 0x3e0293ee, v25
    v_mul_f32 v26, 0x3e0293ee, v26
    v_mul_f32 v27, 0x3e0293ee, v27
    v_cvt_pk_bf16_f32 v36, v20, v21
    v_cvt_pk_bf16_f32 v37, v22, v23
    v_cvt_pk_bf16_f32 v38, v24, v25
    v_cvt_pk_bf16_f32 v39, v26, v27
    buffer_store_dwordx4 v[36:39], v251, s[4:7], s53 offen offset:1024 sc1
    v_accvgpr_read_b32 v40, a112
    v_accvgpr_read_b32 v41, a113
    v_accvgpr_read_b32 v42, a114
    v_accvgpr_read_b32 v43, a115
    v_accvgpr_read_b32 v44, a116
    v_accvgpr_read_b32 v45, a117
    v_accvgpr_read_b32 v46, a118
    v_accvgpr_read_b32 v47, a119
    v_mul_f32 v40, 0x3e0293ee, v40
    v_mul_f32 v41, 0x3e0293ee, v41
    v_mul_f32 v42, 0x3e0293ee, v42
    v_mul_f32 v43, 0x3e0293ee, v43
    v_mul_f32 v44, 0x3e0293ee, v44
    v_mul_f32 v45, 0x3e0293ee, v45
    v_mul_f32 v46, 0x3e0293ee, v46
    v_mul_f32 v47, 0x3e0293ee, v47
    v_cvt_pk_bf16_f32 v56, v40, v41
    v_cvt_pk_bf16_f32 v57, v42, v43
    v_cvt_pk_bf16_f32 v58, v44, v45
    v_cvt_pk_bf16_f32 v59, v46, v47
    buffer_store_dwordx4 v[56:59], v251, s[4:7], s53 offen offset:2048 sc1
    v_accvgpr_read_b32 v0, a120
    v_accvgpr_read_b32 v1, a121
    v_accvgpr_read_b32 v2, a122
    v_accvgpr_read_b32 v3, a123
    v_accvgpr_read_b32 v4, a124
    v_accvgpr_read_b32 v5, a125
    v_accvgpr_read_b32 v6, a126
    v_accvgpr_read_b32 v7, a127
    v_mul_f32 v0, 0x3e0293ee, v0
    v_mul_f32 v1, 0x3e0293ee, v1
    v_mul_f32 v2, 0x3e0293ee, v2
    v_mul_f32 v3, 0x3e0293ee, v3
    v_mul_f32 v4, 0x3e0293ee, v4
    v_mul_f32 v5, 0x3e0293ee, v5
    v_mul_f32 v6, 0x3e0293ee, v6
    v_mul_f32 v7, 0x3e0293ee, v7
    v_cvt_pk_bf16_f32 v16, v0, v1
    v_cvt_pk_bf16_f32 v17, v2, v3
    v_cvt_pk_bf16_f32 v18, v4, v5
    v_cvt_pk_bf16_f32 v19, v6, v7
    buffer_store_dwordx4 v[16:19], v251, s[4:7], s53 offen offset:3072 sc1
    s_add_u32 s53, s53, s22
    v_accvgpr_read_b32 v20, a128
    v_accvgpr_read_b32 v21, a129
    v_accvgpr_read_b32 v22, a130
    v_accvgpr_read_b32 v23, a131
    v_accvgpr_read_b32 v24, a132
    v_accvgpr_read_b32 v25, a133
    v_accvgpr_read_b32 v26, a134
    v_accvgpr_read_b32 v27, a135
    v_mul_f32 v20, 0x3e0293ee, v20
    v_mul_f32 v21, 0x3e0293ee, v21
    v_mul_f32 v22, 0x3e0293ee, v22
    v_mul_f32 v23, 0x3e0293ee, v23
    v_mul_f32 v24, 0x3e0293ee, v24
    v_mul_f32 v25, 0x3e0293ee, v25
    v_mul_f32 v26, 0x3e0293ee, v26
    v_mul_f32 v27, 0x3e0293ee, v27
    v_cvt_pk_bf16_f32 v36, v20, v21
    v_cvt_pk_bf16_f32 v37, v22, v23
    v_cvt_pk_bf16_f32 v38, v24, v25
    v_cvt_pk_bf16_f32 v39, v26, v27
    buffer_store_dwordx4 v[36:39], v251, s[4:7], s53 offen offset:0 sc1
    v_accvgpr_read_b32 v40, a136
    v_accvgpr_read_b32 v41, a137
    v_accvgpr_read_b32 v42, a138
    v_accvgpr_read_b32 v43, a139
    v_accvgpr_read_b32 v44, a140
    v_accvgpr_read_b32 v45, a141
    v_accvgpr_read_b32 v46, a142
    v_accvgpr_read_b32 v47, a143
    v_mul_f32 v40, 0x3e0293ee, v40
    v_mul_f32 v41, 0x3e0293ee, v41
    v_mul_f32 v42, 0x3e0293ee, v42
    v_mul_f32 v43, 0x3e0293ee, v43
    v_mul_f32 v44, 0x3e0293ee, v44
    v_mul_f32 v45, 0x3e0293ee, v45
    v_mul_f32 v46, 0x3e0293ee, v46
    v_mul_f32 v47, 0x3e0293ee, v47
    v_cvt_pk_bf16_f32 v56, v40, v41
    v_cvt_pk_bf16_f32 v57, v42, v43
    v_cvt_pk_bf16_f32 v58, v44, v45
    v_cvt_pk_bf16_f32 v59, v46, v47
    buffer_store_dwordx4 v[56:59], v251, s[4:7], s53 offen offset:1024 sc1
    v_accvgpr_read_b32 v0, a144
    v_accvgpr_read_b32 v1, a145
    v_accvgpr_read_b32 v2, a146
    v_accvgpr_read_b32 v3, a147
    v_accvgpr_read_b32 v4, a148
    v_accvgpr_read_b32 v5, a149
    v_accvgpr_read_b32 v6, a150
    v_accvgpr_read_b32 v7, a151
    v_mul_f32 v0, 0x3e0293ee, v0
    v_mul_f32 v1, 0x3e0293ee, v1
    v_mul_f32 v2, 0x3e0293ee, v2
    v_mul_f32 v3, 0x3e0293ee, v3
    v_mul_f32 v4, 0x3e0293ee, v4
    v_mul_f32 v5, 0x3e0293ee, v5
    v_mul_f32 v6, 0x3e0293ee, v6
    v_mul_f32 v7, 0x3e0293ee, v7
    v_cvt_pk_bf16_f32 v16, v0, v1
    v_cvt_pk_bf16_f32 v17, v2, v3
    v_cvt_pk_bf16_f32 v18, v4, v5
    v_cvt_pk_bf16_f32 v19, v6, v7
    buffer_store_dwordx4 v[16:19], v251, s[4:7], s53 offen offset:2048 sc1
    v_accvgpr_read_b32 v20, a152
    v_accvgpr_read_b32 v21, a153
    v_accvgpr_read_b32 v22, a154
    v_accvgpr_read_b32 v23, a155
    v_accvgpr_read_b32 v24, a156
    v_accvgpr_read_b32 v25, a157
    v_accvgpr_read_b32 v26, a158
    v_accvgpr_read_b32 v27, a159
    v_mul_f32 v20, 0x3e0293ee, v20
    v_mul_f32 v21, 0x3e0293ee, v21
    v_mul_f32 v22, 0x3e0293ee, v22
    v_mul_f32 v23, 0x3e0293ee, v23
    v_mul_f32 v24, 0x3e0293ee, v24
    v_mul_f32 v25, 0x3e0293ee, v25
    v_mul_f32 v26, 0x3e0293ee, v26
    v_mul_f32 v27, 0x3e0293ee, v27
    v_cvt_pk_bf16_f32 v36, v20, v21
    v_cvt_pk_bf16_f32 v37, v22, v23
    v_cvt_pk_bf16_f32 v38, v24, v25
    v_cvt_pk_bf16_f32 v39, v26, v27
    buffer_store_dwordx4 v[36:39], v251, s[4:7], s53 offen offset:3072 sc1
    s_add_u32 s53, s53, s22
    v_accvgpr_read_b32 v40, a160
    v_accvgpr_read_b32 v41, a161
    v_accvgpr_read_b32 v42, a162
    v_accvgpr_read_b32 v43, a163
    v_accvgpr_read_b32 v44, a164
    v_accvgpr_read_b32 v45, a165
    v_accvgpr_read_b32 v46, a166
    v_accvgpr_read_b32 v47, a167
    v_mul_f32 v40, 0x3e0293ee, v40
    v_mul_f32 v41, 0x3e0293ee, v41
    v_mul_f32 v42, 0x3e0293ee, v42
    v_mul_f32 v43, 0x3e0293ee, v43
    v_mul_f32 v44, 0x3e0293ee, v44
    v_mul_f32 v45, 0x3e0293ee, v45
    v_mul_f32 v46, 0x3e0293ee, v46
    v_mul_f32 v47, 0x3e0293ee, v47
    v_cvt_pk_bf16_f32 v56, v40, v41
    v_cvt_pk_bf16_f32 v57, v42, v43
    v_cvt_pk_bf16_f32 v58, v44, v45
    v_cvt_pk_bf16_f32 v59, v46, v47
    buffer_store_dwordx4 v[56:59], v251, s[4:7], s53 offen offset:0 sc1
    v_accvgpr_read_b32 v0, a168
    v_accvgpr_read_b32 v1, a169
    v_accvgpr_read_b32 v2, a170
    v_accvgpr_read_b32 v3, a171
    v_accvgpr_read_b32 v4, a172
    v_accvgpr_read_b32 v5, a173
    v_accvgpr_read_b32 v6, a174
    v_accvgpr_read_b32 v7, a175
    v_mul_f32 v0, 0x3e0293ee, v0
    v_mul_f32 v1, 0x3e0293ee, v1
    v_mul_f32 v2, 0x3e0293ee, v2
    v_mul_f32 v3, 0x3e0293ee, v3
    v_mul_f32 v4, 0x3e0293ee, v4
    v_mul_f32 v5, 0x3e0293ee, v5
    v_mul_f32 v6, 0x3e0293ee, v6
    v_mul_f32 v7, 0x3e0293ee, v7
    v_cvt_pk_bf16_f32 v16, v0, v1
    v_cvt_pk_bf16_f32 v17, v2, v3
    v_cvt_pk_bf16_f32 v18, v4, v5
    v_cvt_pk_bf16_f32 v19, v6, v7
    buffer_store_dwordx4 v[16:19], v251, s[4:7], s53 offen offset:1024 sc1
    v_accvgpr_read_b32 v20, a176
    v_accvgpr_read_b32 v21, a177
    v_accvgpr_read_b32 v22, a178
    v_accvgpr_read_b32 v23, a179
    v_accvgpr_read_b32 v24, a180
    v_accvgpr_read_b32 v25, a181
    v_accvgpr_read_b32 v26, a182
    v_accvgpr_read_b32 v27, a183
    v_mul_f32 v20, 0x3e0293ee, v20
    v_mul_f32 v21, 0x3e0293ee, v21
    v_mul_f32 v22, 0x3e0293ee, v22
    v_mul_f32 v23, 0x3e0293ee, v23
    v_mul_f32 v24, 0x3e0293ee, v24
    v_mul_f32 v25, 0x3e0293ee, v25
    v_mul_f32 v26, 0x3e0293ee, v26
    v_mul_f32 v27, 0x3e0293ee, v27
    v_cvt_pk_bf16_f32 v36, v20, v21
    v_cvt_pk_bf16_f32 v37, v22, v23
    v_cvt_pk_bf16_f32 v38, v24, v25
    v_cvt_pk_bf16_f32 v39, v26, v27
    buffer_store_dwordx4 v[36:39], v251, s[4:7], s53 offen offset:2048 sc1
    v_accvgpr_read_b32 v40, a184
    v_accvgpr_read_b32 v41, a185
    v_accvgpr_read_b32 v42, a186
    v_accvgpr_read_b32 v43, a187
    v_accvgpr_read_b32 v44, a188
    v_accvgpr_read_b32 v45, a189
    v_accvgpr_read_b32 v46, a190
    v_accvgpr_read_b32 v47, a191
    v_mul_f32 v40, 0x3e0293ee, v40
    v_mul_f32 v41, 0x3e0293ee, v41
    v_mul_f32 v42, 0x3e0293ee, v42
    v_mul_f32 v43, 0x3e0293ee, v43
    v_mul_f32 v44, 0x3e0293ee, v44
    v_mul_f32 v45, 0x3e0293ee, v45
    v_mul_f32 v46, 0x3e0293ee, v46
    v_mul_f32 v47, 0x3e0293ee, v47
    v_cvt_pk_bf16_f32 v56, v40, v41
    v_cvt_pk_bf16_f32 v57, v42, v43
    v_cvt_pk_bf16_f32 v58, v44, v45
    v_cvt_pk_bf16_f32 v59, v46, v47
    buffer_store_dwordx4 v[56:59], v251, s[4:7], s53 offen offset:3072 sc1
    s_add_u32 s53, s53, s22
    v_accvgpr_read_b32 v0, a192
    v_accvgpr_read_b32 v1, a193
    v_accvgpr_read_b32 v2, a194
    v_accvgpr_read_b32 v3, a195
    v_accvgpr_read_b32 v4, a196
    v_accvgpr_read_b32 v5, a197
    v_accvgpr_read_b32 v6, a198
    v_accvgpr_read_b32 v7, a199
    v_mul_f32 v0, 0x3e0293ee, v0
    v_mul_f32 v1, 0x3e0293ee, v1
    v_mul_f32 v2, 0x3e0293ee, v2
    v_mul_f32 v3, 0x3e0293ee, v3
    v_mul_f32 v4, 0x3e0293ee, v4
    v_mul_f32 v5, 0x3e0293ee, v5
    v_mul_f32 v6, 0x3e0293ee, v6
    v_mul_f32 v7, 0x3e0293ee, v7
    v_cvt_pk_bf16_f32 v16, v0, v1
    v_cvt_pk_bf16_f32 v17, v2, v3
    v_cvt_pk_bf16_f32 v18, v4, v5
    v_cvt_pk_bf16_f32 v19, v6, v7
    buffer_store_dwordx4 v[16:19], v251, s[4:7], s53 offen offset:0 sc1
    v_accvgpr_read_b32 v20, a200
    v_accvgpr_read_b32 v21, a201
    v_accvgpr_read_b32 v22, a202
    v_accvgpr_read_b32 v23, a203
    v_accvgpr_read_b32 v24, a204
    v_accvgpr_read_b32 v25, a205
    v_accvgpr_read_b32 v26, a206
    v_accvgpr_read_b32 v27, a207
    v_mul_f32 v20, 0x3e0293ee, v20
    v_mul_f32 v21, 0x3e0293ee, v21
    v_mul_f32 v22, 0x3e0293ee, v22
    v_mul_f32 v23, 0x3e0293ee, v23
    v_mul_f32 v24, 0x3e0293ee, v24
    v_mul_f32 v25, 0x3e0293ee, v25
    v_mul_f32 v26, 0x3e0293ee, v26
    v_mul_f32 v27, 0x3e0293ee, v27
    v_cvt_pk_bf16_f32 v36, v20, v21
    v_cvt_pk_bf16_f32 v37, v22, v23
    v_cvt_pk_bf16_f32 v38, v24, v25
    v_cvt_pk_bf16_f32 v39, v26, v27
    buffer_store_dwordx4 v[36:39], v251, s[4:7], s53 offen offset:1024 sc1
    v_accvgpr_read_b32 v40, a208
    v_accvgpr_read_b32 v41, a209
    v_accvgpr_read_b32 v42, a210
    v_accvgpr_read_b32 v43, a211
    v_accvgpr_read_b32 v44, a212
    v_accvgpr_read_b32 v45, a213
    v_accvgpr_read_b32 v46, a214
    v_accvgpr_read_b32 v47, a215
    v_mul_f32 v40, 0x3e0293ee, v40
    v_mul_f32 v41, 0x3e0293ee, v41
    v_mul_f32 v42, 0x3e0293ee, v42
    v_mul_f32 v43, 0x3e0293ee, v43
    v_mul_f32 v44, 0x3e0293ee, v44
    v_mul_f32 v45, 0x3e0293ee, v45
    v_mul_f32 v46, 0x3e0293ee, v46
    v_mul_f32 v47, 0x3e0293ee, v47
    v_cvt_pk_bf16_f32 v56, v40, v41
    v_cvt_pk_bf16_f32 v57, v42, v43
    v_cvt_pk_bf16_f32 v58, v44, v45
    v_cvt_pk_bf16_f32 v59, v46, v47
    buffer_store_dwordx4 v[56:59], v251, s[4:7], s53 offen offset:2048 sc1
    v_accvgpr_read_b32 v0, a216
    v_accvgpr_read_b32 v1, a217
    v_accvgpr_read_b32 v2, a218
    v_accvgpr_read_b32 v3, a219
    v_accvgpr_read_b32 v4, a220
    v_accvgpr_read_b32 v5, a221
    v_accvgpr_read_b32 v6, a222
    v_accvgpr_read_b32 v7, a223
    v_mul_f32 v0, 0x3e0293ee, v0
    v_mul_f32 v1, 0x3e0293ee, v1
    v_mul_f32 v2, 0x3e0293ee, v2
    v_mul_f32 v3, 0x3e0293ee, v3
    v_mul_f32 v4, 0x3e0293ee, v4
    v_mul_f32 v5, 0x3e0293ee, v5
    v_mul_f32 v6, 0x3e0293ee, v6
    v_mul_f32 v7, 0x3e0293ee, v7
    v_cvt_pk_bf16_f32 v16, v0, v1
    v_cvt_pk_bf16_f32 v17, v2, v3
    v_cvt_pk_bf16_f32 v18, v4, v5
    v_cvt_pk_bf16_f32 v19, v6, v7
    buffer_store_dwordx4 v[16:19], v251, s[4:7], s53 offen offset:3072 sc1
    s_add_u32 s53, s53, s22
    v_accvgpr_read_b32 v20, a224
    v_accvgpr_read_b32 v21, a225
    v_accvgpr_read_b32 v22, a226
    v_accvgpr_read_b32 v23, a227
    v_accvgpr_read_b32 v24, a228
    v_accvgpr_read_b32 v25, a229
    v_accvgpr_read_b32 v26, a230
    v_accvgpr_read_b32 v27, a231
    v_mul_f32 v20, 0x3e0293ee, v20
    v_mul_f32 v21, 0x3e0293ee, v21
    v_mul_f32 v22, 0x3e0293ee, v22
    v_mul_f32 v23, 0x3e0293ee, v23
    v_mul_f32 v24, 0x3e0293ee, v24
    v_mul_f32 v25, 0x3e0293ee, v25
    v_mul_f32 v26, 0x3e0293ee, v26
    v_mul_f32 v27, 0x3e0293ee, v27
    v_cvt_pk_bf16_f32 v36, v20, v21
    v_cvt_pk_bf16_f32 v37, v22, v23
    v_cvt_pk_bf16_f32 v38, v24, v25
    v_cvt_pk_bf16_f32 v39, v26, v27
    buffer_store_dwordx4 v[36:39], v251, s[4:7], s53 offen offset:0 sc1
    v_accvgpr_read_b32 v40, a232
    v_accvgpr_read_b32 v41, a233
    v_accvgpr_read_b32 v42, a234
    v_accvgpr_read_b32 v43, a235
    v_accvgpr_read_b32 v44, a236
    v_accvgpr_read_b32 v45, a237
    v_accvgpr_read_b32 v46, a238
    v_accvgpr_read_b32 v47, a239
    v_mul_f32 v40, 0x3e0293ee, v40
    v_mul_f32 v41, 0x3e0293ee, v41
    v_mul_f32 v42, 0x3e0293ee, v42
    v_mul_f32 v43, 0x3e0293ee, v43
    v_mul_f32 v44, 0x3e0293ee, v44
    v_mul_f32 v45, 0x3e0293ee, v45
    v_mul_f32 v46, 0x3e0293ee, v46
    v_mul_f32 v47, 0x3e0293ee, v47
    v_cvt_pk_bf16_f32 v56, v40, v41
    v_cvt_pk_bf16_f32 v57, v42, v43
    v_cvt_pk_bf16_f32 v58, v44, v45
    v_cvt_pk_bf16_f32 v59, v46, v47
    buffer_store_dwordx4 v[56:59], v251, s[4:7], s53 offen offset:1024 sc1
    v_accvgpr_read_b32 v0, a240
    v_accvgpr_read_b32 v1, a241
    v_accvgpr_read_b32 v2, a242
    v_accvgpr_read_b32 v3, a243
    v_accvgpr_read_b32 v4, a244
    v_accvgpr_read_b32 v5, a245
    v_accvgpr_read_b32 v6, a246
    v_accvgpr_read_b32 v7, a247
    v_mul_f32 v0, 0x3e0293ee, v0
    v_mul_f32 v1, 0x3e0293ee, v1
    v_mul_f32 v2, 0x3e0293ee, v2
    v_mul_f32 v3, 0x3e0293ee, v3
    v_mul_f32 v4, 0x3e0293ee, v4
    v_mul_f32 v5, 0x3e0293ee, v5
    v_mul_f32 v6, 0x3e0293ee, v6
    v_mul_f32 v7, 0x3e0293ee, v7
    v_cvt_pk_bf16_f32 v16, v0, v1
    v_cvt_pk_bf16_f32 v17, v2, v3
    v_cvt_pk_bf16_f32 v18, v4, v5
    v_cvt_pk_bf16_f32 v19, v6, v7
    buffer_store_dwordx4 v[16:19], v251, s[4:7], s53 offen offset:2048 sc1
    v_accvgpr_read_b32 v20, a248
    v_accvgpr_read_b32 v21, a249
    v_accvgpr_read_b32 v22, a250
    v_accvgpr_read_b32 v23, a251
    v_accvgpr_read_b32 v24, a252
    v_accvgpr_read_b32 v25, a253
    v_accvgpr_read_b32 v26, a254
    v_accvgpr_read_b32 v27, a255
    v_mul_f32 v20, 0x3e0293ee, v20
    v_mul_f32 v21, 0x3e0293ee, v21
    v_mul_f32 v22, 0x3e0293ee, v22
    v_mul_f32 v23, 0x3e0293ee, v23
    v_mul_f32 v24, 0x3e0293ee, v24
    v_mul_f32 v25, 0x3e0293ee, v25
    v_mul_f32 v26, 0x3e0293ee, v26
    v_mul_f32 v27, 0x3e0293ee, v27
    v_cvt_pk_bf16_f32 v36, v20, v21
    v_cvt_pk_bf16_f32 v37, v22, v23
    v_cvt_pk_bf16_f32 v38, v24, v25
    v_cvt_pk_bf16_f32 v39, v26, v27
    buffer_store_dwordx4 v[36:39], v251, s[4:7], s53 offen offset:3072 sc1
    s_branch main_kernel_w_done
main_kernel_w_c2_egelu:
    s_mov_b32 s53, s21
    v_accvgpr_read_b32 v0, a0
    v_accvgpr_read_b32 v1, a1
    v_accvgpr_read_b32 v2, a2
    v_accvgpr_read_b32 v3, a3
    v_accvgpr_read_b32 v4, a4
    v_accvgpr_read_b32 v5, a5
    v_accvgpr_read_b32 v6, a6
    v_accvgpr_read_b32 v7, a7
    v_pk_mul_f32 v[8:9], v[0:1], v[0:1]
    v_pk_mul_f32 v[10:11], v[2:3], v[2:3]
    v_pk_mul_f32 v[12:13], v[4:5], v[4:5]
    v_pk_mul_f32 v[14:15], v[6:7], v[6:7]
    v_pk_fma_f32 v[8:9], v[8:9], v[242:243], v[240:241]
    v_pk_fma_f32 v[10:11], v[10:11], v[242:243], v[240:241]
    v_pk_fma_f32 v[12:13], v[12:13], v[242:243], v[240:241]
    v_pk_fma_f32 v[14:15], v[14:15], v[242:243], v[240:241]
    v_pk_mul_f32 v[8:9], v[8:9], v[0:1]
    v_pk_mul_f32 v[10:11], v[10:11], v[2:3]
    v_pk_mul_f32 v[12:13], v[12:13], v[4:5]
    v_pk_mul_f32 v[14:15], v[14:15], v[6:7]
    v_exp_f32 v8, v8
    v_exp_f32 v9, v9
    v_exp_f32 v10, v10
    v_exp_f32 v11, v11
    v_exp_f32 v12, v12
    v_exp_f32 v13, v13
    v_exp_f32 v14, v14
    v_exp_f32 v15, v15
    v_pk_add_f32 v[8:9], v[8:9], v[244:245]
    v_pk_add_f32 v[10:11], v[10:11], v[244:245]
    v_pk_add_f32 v[12:13], v[12:13], v[244:245]
    v_pk_add_f32 v[14:15], v[14:15], v[244:245]
    v_rcp_f32 v8, v8
    v_rcp_f32 v9, v9
    v_rcp_f32 v10, v10
    v_rcp_f32 v11, v11
    v_rcp_f32 v12, v12
    v_rcp_f32 v13, v13
    v_rcp_f32 v14, v14
    v_rcp_f32 v15, v15
    v_pk_mul_f32 v[0:1], v[8:9], v[0:1]
    v_pk_mul_f32 v[2:3], v[10:11], v[2:3]
    v_pk_mul_f32 v[4:5], v[12:13], v[4:5]
    v_pk_mul_f32 v[6:7], v[14:15], v[6:7]
    v_cvt_pk_bf16_f32 v16, v0, v1
    v_cvt_pk_bf16_f32 v17, v2, v3
    v_cvt_pk_bf16_f32 v18, v4, v5
    v_cvt_pk_bf16_f32 v19, v6, v7
    buffer_store_dwordx4 v[16:19], v251, s[4:7], s53 offen offset:0 sc1
    v_accvgpr_read_b32 v20, a8
    v_accvgpr_read_b32 v21, a9
    v_accvgpr_read_b32 v22, a10
    v_accvgpr_read_b32 v23, a11
    v_accvgpr_read_b32 v24, a12
    v_accvgpr_read_b32 v25, a13
    v_accvgpr_read_b32 v26, a14
    v_accvgpr_read_b32 v27, a15
    v_pk_mul_f32 v[28:29], v[20:21], v[20:21]
    v_pk_mul_f32 v[30:31], v[22:23], v[22:23]
    v_pk_mul_f32 v[32:33], v[24:25], v[24:25]
    v_pk_mul_f32 v[34:35], v[26:27], v[26:27]
    v_pk_fma_f32 v[28:29], v[28:29], v[242:243], v[240:241]
    v_pk_fma_f32 v[30:31], v[30:31], v[242:243], v[240:241]
    v_pk_fma_f32 v[32:33], v[32:33], v[242:243], v[240:241]
    v_pk_fma_f32 v[34:35], v[34:35], v[242:243], v[240:241]
    v_pk_mul_f32 v[28:29], v[28:29], v[20:21]
    v_pk_mul_f32 v[30:31], v[30:31], v[22:23]
    v_pk_mul_f32 v[32:33], v[32:33], v[24:25]
    v_pk_mul_f32 v[34:35], v[34:35], v[26:27]
    v_exp_f32 v28, v28
    v_exp_f32 v29, v29
    v_exp_f32 v30, v30
    v_exp_f32 v31, v31
    v_exp_f32 v32, v32
    v_exp_f32 v33, v33
    v_exp_f32 v34, v34
    v_exp_f32 v35, v35
    v_pk_add_f32 v[28:29], v[28:29], v[244:245]
    v_pk_add_f32 v[30:31], v[30:31], v[244:245]
    v_pk_add_f32 v[32:33], v[32:33], v[244:245]
    v_pk_add_f32 v[34:35], v[34:35], v[244:245]
    v_rcp_f32 v28, v28
    v_rcp_f32 v29, v29
    v_rcp_f32 v30, v30
    v_rcp_f32 v31, v31
    v_rcp_f32 v32, v32
    v_rcp_f32 v33, v33
    v_rcp_f32 v34, v34
    v_rcp_f32 v35, v35
    v_pk_mul_f32 v[20:21], v[28:29], v[20:21]
    v_pk_mul_f32 v[22:23], v[30:31], v[22:23]
    v_pk_mul_f32 v[24:25], v[32:33], v[24:25]
    v_pk_mul_f32 v[26:27], v[34:35], v[26:27]
    v_cvt_pk_bf16_f32 v36, v20, v21
    v_cvt_pk_bf16_f32 v37, v22, v23
    v_cvt_pk_bf16_f32 v38, v24, v25
    v_cvt_pk_bf16_f32 v39, v26, v27
    buffer_store_dwordx4 v[36:39], v251, s[4:7], s53 offen offset:1024 sc1
    v_accvgpr_read_b32 v40, a16
    v_accvgpr_read_b32 v41, a17
    v_accvgpr_read_b32 v42, a18
    v_accvgpr_read_b32 v43, a19
    v_accvgpr_read_b32 v44, a20
    v_accvgpr_read_b32 v45, a21
    v_accvgpr_read_b32 v46, a22
    v_accvgpr_read_b32 v47, a23
    v_pk_mul_f32 v[48:49], v[40:41], v[40:41]
    v_pk_mul_f32 v[50:51], v[42:43], v[42:43]
    v_pk_mul_f32 v[52:53], v[44:45], v[44:45]
    v_pk_mul_f32 v[54:55], v[46:47], v[46:47]
    v_pk_fma_f32 v[48:49], v[48:49], v[242:243], v[240:241]
    v_pk_fma_f32 v[50:51], v[50:51], v[242:243], v[240:241]
    v_pk_fma_f32 v[52:53], v[52:53], v[242:243], v[240:241]
    v_pk_fma_f32 v[54:55], v[54:55], v[242:243], v[240:241]
    v_pk_mul_f32 v[48:49], v[48:49], v[40:41]
    v_pk_mul_f32 v[50:51], v[50:51], v[42:43]
    v_pk_mul_f32 v[52:53], v[52:53], v[44:45]
    v_pk_mul_f32 v[54:55], v[54:55], v[46:47]
    v_exp_f32 v48, v48
    v_exp_f32 v49, v49
    v_exp_f32 v50, v50
    v_exp_f32 v51, v51
    v_exp_f32 v52, v52
    v_exp_f32 v53, v53
    v_exp_f32 v54, v54
    v_exp_f32 v55, v55
    v_pk_add_f32 v[48:49], v[48:49], v[244:245]
    v_pk_add_f32 v[50:51], v[50:51], v[244:245]
    v_pk_add_f32 v[52:53], v[52:53], v[244:245]
    v_pk_add_f32 v[54:55], v[54:55], v[244:245]
    v_rcp_f32 v48, v48
    v_rcp_f32 v49, v49
    v_rcp_f32 v50, v50
    v_rcp_f32 v51, v51
    v_rcp_f32 v52, v52
    v_rcp_f32 v53, v53
    v_rcp_f32 v54, v54
    v_rcp_f32 v55, v55
    v_pk_mul_f32 v[40:41], v[48:49], v[40:41]
    v_pk_mul_f32 v[42:43], v[50:51], v[42:43]
    v_pk_mul_f32 v[44:45], v[52:53], v[44:45]
    v_pk_mul_f32 v[46:47], v[54:55], v[46:47]
    v_cvt_pk_bf16_f32 v56, v40, v41
    v_cvt_pk_bf16_f32 v57, v42, v43
    v_cvt_pk_bf16_f32 v58, v44, v45
    v_cvt_pk_bf16_f32 v59, v46, v47
    buffer_store_dwordx4 v[56:59], v251, s[4:7], s53 offen offset:2048 sc1
    v_accvgpr_read_b32 v0, a24
    v_accvgpr_read_b32 v1, a25
    v_accvgpr_read_b32 v2, a26
    v_accvgpr_read_b32 v3, a27
    v_accvgpr_read_b32 v4, a28
    v_accvgpr_read_b32 v5, a29
    v_accvgpr_read_b32 v6, a30
    v_accvgpr_read_b32 v7, a31
    v_pk_mul_f32 v[8:9], v[0:1], v[0:1]
    v_pk_mul_f32 v[10:11], v[2:3], v[2:3]
    v_pk_mul_f32 v[12:13], v[4:5], v[4:5]
    v_pk_mul_f32 v[14:15], v[6:7], v[6:7]
    v_pk_fma_f32 v[8:9], v[8:9], v[242:243], v[240:241]
    v_pk_fma_f32 v[10:11], v[10:11], v[242:243], v[240:241]
    v_pk_fma_f32 v[12:13], v[12:13], v[242:243], v[240:241]
    v_pk_fma_f32 v[14:15], v[14:15], v[242:243], v[240:241]
    v_pk_mul_f32 v[8:9], v[8:9], v[0:1]
    v_pk_mul_f32 v[10:11], v[10:11], v[2:3]
    v_pk_mul_f32 v[12:13], v[12:13], v[4:5]
    v_pk_mul_f32 v[14:15], v[14:15], v[6:7]
    v_exp_f32 v8, v8
    v_exp_f32 v9, v9
    v_exp_f32 v10, v10
    v_exp_f32 v11, v11
    v_exp_f32 v12, v12
    v_exp_f32 v13, v13
    v_exp_f32 v14, v14
    v_exp_f32 v15, v15
    v_pk_add_f32 v[8:9], v[8:9], v[244:245]
    v_pk_add_f32 v[10:11], v[10:11], v[244:245]
    v_pk_add_f32 v[12:13], v[12:13], v[244:245]
    v_pk_add_f32 v[14:15], v[14:15], v[244:245]
    v_rcp_f32 v8, v8
    v_rcp_f32 v9, v9
    v_rcp_f32 v10, v10
    v_rcp_f32 v11, v11
    v_rcp_f32 v12, v12
    v_rcp_f32 v13, v13
    v_rcp_f32 v14, v14
    v_rcp_f32 v15, v15
    v_pk_mul_f32 v[0:1], v[8:9], v[0:1]
    v_pk_mul_f32 v[2:3], v[10:11], v[2:3]
    v_pk_mul_f32 v[4:5], v[12:13], v[4:5]
    v_pk_mul_f32 v[6:7], v[14:15], v[6:7]
    v_cvt_pk_bf16_f32 v16, v0, v1
    v_cvt_pk_bf16_f32 v17, v2, v3
    v_cvt_pk_bf16_f32 v18, v4, v5
    v_cvt_pk_bf16_f32 v19, v6, v7
    buffer_store_dwordx4 v[16:19], v251, s[4:7], s53 offen offset:3072 sc1
    s_add_u32 s53, s53, s22
    v_accvgpr_read_b32 v20, a32
    v_accvgpr_read_b32 v21, a33
    v_accvgpr_read_b32 v22, a34
    v_accvgpr_read_b32 v23, a35
    v_accvgpr_read_b32 v24, a36
    v_accvgpr_read_b32 v25, a37
    v_accvgpr_read_b32 v26, a38
    v_accvgpr_read_b32 v27, a39
    v_pk_mul_f32 v[28:29], v[20:21], v[20:21]
    v_pk_mul_f32 v[30:31], v[22:23], v[22:23]
    v_pk_mul_f32 v[32:33], v[24:25], v[24:25]
    v_pk_mul_f32 v[34:35], v[26:27], v[26:27]
    v_pk_fma_f32 v[28:29], v[28:29], v[242:243], v[240:241]
    v_pk_fma_f32 v[30:31], v[30:31], v[242:243], v[240:241]
    v_pk_fma_f32 v[32:33], v[32:33], v[242:243], v[240:241]
    v_pk_fma_f32 v[34:35], v[34:35], v[242:243], v[240:241]
    v_pk_mul_f32 v[28:29], v[28:29], v[20:21]
    v_pk_mul_f32 v[30:31], v[30:31], v[22:23]
    v_pk_mul_f32 v[32:33], v[32:33], v[24:25]
    v_pk_mul_f32 v[34:35], v[34:35], v[26:27]
    v_exp_f32 v28, v28
    v_exp_f32 v29, v29
    v_exp_f32 v30, v30
    v_exp_f32 v31, v31
    v_exp_f32 v32, v32
    v_exp_f32 v33, v33
    v_exp_f32 v34, v34
    v_exp_f32 v35, v35
    v_pk_add_f32 v[28:29], v[28:29], v[244:245]
    v_pk_add_f32 v[30:31], v[30:31], v[244:245]
    v_pk_add_f32 v[32:33], v[32:33], v[244:245]
    v_pk_add_f32 v[34:35], v[34:35], v[244:245]
    v_rcp_f32 v28, v28
    v_rcp_f32 v29, v29
    v_rcp_f32 v30, v30
    v_rcp_f32 v31, v31
    v_rcp_f32 v32, v32
    v_rcp_f32 v33, v33
    v_rcp_f32 v34, v34
    v_rcp_f32 v35, v35
    v_pk_mul_f32 v[20:21], v[28:29], v[20:21]
    v_pk_mul_f32 v[22:23], v[30:31], v[22:23]
    v_pk_mul_f32 v[24:25], v[32:33], v[24:25]
    v_pk_mul_f32 v[26:27], v[34:35], v[26:27]
    v_cvt_pk_bf16_f32 v36, v20, v21
    v_cvt_pk_bf16_f32 v37, v22, v23
    v_cvt_pk_bf16_f32 v38, v24, v25
    v_cvt_pk_bf16_f32 v39, v26, v27
    buffer_store_dwordx4 v[36:39], v251, s[4:7], s53 offen offset:0 sc1
    v_accvgpr_read_b32 v40, a40
    v_accvgpr_read_b32 v41, a41
    v_accvgpr_read_b32 v42, a42
    v_accvgpr_read_b32 v43, a43
    v_accvgpr_read_b32 v44, a44
    v_accvgpr_read_b32 v45, a45
    v_accvgpr_read_b32 v46, a46
    v_accvgpr_read_b32 v47, a47
    v_pk_mul_f32 v[48:49], v[40:41], v[40:41]
    v_pk_mul_f32 v[50:51], v[42:43], v[42:43]
    v_pk_mul_f32 v[52:53], v[44:45], v[44:45]
    v_pk_mul_f32 v[54:55], v[46:47], v[46:47]
    v_pk_fma_f32 v[48:49], v[48:49], v[242:243], v[240:241]
    v_pk_fma_f32 v[50:51], v[50:51], v[242:243], v[240:241]
    v_pk_fma_f32 v[52:53], v[52:53], v[242:243], v[240:241]
    v_pk_fma_f32 v[54:55], v[54:55], v[242:243], v[240:241]
    v_pk_mul_f32 v[48:49], v[48:49], v[40:41]
    v_pk_mul_f32 v[50:51], v[50:51], v[42:43]
    v_pk_mul_f32 v[52:53], v[52:53], v[44:45]
    v_pk_mul_f32 v[54:55], v[54:55], v[46:47]
    v_exp_f32 v48, v48
    v_exp_f32 v49, v49
    v_exp_f32 v50, v50
    v_exp_f32 v51, v51
    v_exp_f32 v52, v52
    v_exp_f32 v53, v53
    v_exp_f32 v54, v54
    v_exp_f32 v55, v55
    v_pk_add_f32 v[48:49], v[48:49], v[244:245]
    v_pk_add_f32 v[50:51], v[50:51], v[244:245]
    v_pk_add_f32 v[52:53], v[52:53], v[244:245]
    v_pk_add_f32 v[54:55], v[54:55], v[244:245]
    v_rcp_f32 v48, v48
    v_rcp_f32 v49, v49
    v_rcp_f32 v50, v50
    v_rcp_f32 v51, v51
    v_rcp_f32 v52, v52
    v_rcp_f32 v53, v53
    v_rcp_f32 v54, v54
    v_rcp_f32 v55, v55
    v_pk_mul_f32 v[40:41], v[48:49], v[40:41]
    v_pk_mul_f32 v[42:43], v[50:51], v[42:43]
    v_pk_mul_f32 v[44:45], v[52:53], v[44:45]
    v_pk_mul_f32 v[46:47], v[54:55], v[46:47]
    v_cvt_pk_bf16_f32 v56, v40, v41
    v_cvt_pk_bf16_f32 v57, v42, v43
    v_cvt_pk_bf16_f32 v58, v44, v45
    v_cvt_pk_bf16_f32 v59, v46, v47
    buffer_store_dwordx4 v[56:59], v251, s[4:7], s53 offen offset:1024 sc1
    v_accvgpr_read_b32 v0, a48
    v_accvgpr_read_b32 v1, a49
    v_accvgpr_read_b32 v2, a50
    v_accvgpr_read_b32 v3, a51
    v_accvgpr_read_b32 v4, a52
    v_accvgpr_read_b32 v5, a53
    v_accvgpr_read_b32 v6, a54
    v_accvgpr_read_b32 v7, a55
    v_pk_mul_f32 v[8:9], v[0:1], v[0:1]
    v_pk_mul_f32 v[10:11], v[2:3], v[2:3]
    v_pk_mul_f32 v[12:13], v[4:5], v[4:5]
    v_pk_mul_f32 v[14:15], v[6:7], v[6:7]
    v_pk_fma_f32 v[8:9], v[8:9], v[242:243], v[240:241]
    v_pk_fma_f32 v[10:11], v[10:11], v[242:243], v[240:241]
    v_pk_fma_f32 v[12:13], v[12:13], v[242:243], v[240:241]
    v_pk_fma_f32 v[14:15], v[14:15], v[242:243], v[240:241]
    v_pk_mul_f32 v[8:9], v[8:9], v[0:1]
    v_pk_mul_f32 v[10:11], v[10:11], v[2:3]
    v_pk_mul_f32 v[12:13], v[12:13], v[4:5]
    v_pk_mul_f32 v[14:15], v[14:15], v[6:7]
    v_exp_f32 v8, v8
    v_exp_f32 v9, v9
    v_exp_f32 v10, v10
    v_exp_f32 v11, v11
    v_exp_f32 v12, v12
    v_exp_f32 v13, v13
    v_exp_f32 v14, v14
    v_exp_f32 v15, v15
    v_pk_add_f32 v[8:9], v[8:9], v[244:245]
    v_pk_add_f32 v[10:11], v[10:11], v[244:245]
    v_pk_add_f32 v[12:13], v[12:13], v[244:245]
    v_pk_add_f32 v[14:15], v[14:15], v[244:245]
    v_rcp_f32 v8, v8
    v_rcp_f32 v9, v9
    v_rcp_f32 v10, v10
    v_rcp_f32 v11, v11
    v_rcp_f32 v12, v12
    v_rcp_f32 v13, v13
    v_rcp_f32 v14, v14
    v_rcp_f32 v15, v15
    v_pk_mul_f32 v[0:1], v[8:9], v[0:1]
    v_pk_mul_f32 v[2:3], v[10:11], v[2:3]
    v_pk_mul_f32 v[4:5], v[12:13], v[4:5]
    v_pk_mul_f32 v[6:7], v[14:15], v[6:7]
    v_cvt_pk_bf16_f32 v16, v0, v1
    v_cvt_pk_bf16_f32 v17, v2, v3
    v_cvt_pk_bf16_f32 v18, v4, v5
    v_cvt_pk_bf16_f32 v19, v6, v7
    buffer_store_dwordx4 v[16:19], v251, s[4:7], s53 offen offset:2048 sc1
    v_accvgpr_read_b32 v20, a56
    v_accvgpr_read_b32 v21, a57
    v_accvgpr_read_b32 v22, a58
    v_accvgpr_read_b32 v23, a59
    v_accvgpr_read_b32 v24, a60
    v_accvgpr_read_b32 v25, a61
    v_accvgpr_read_b32 v26, a62
    v_accvgpr_read_b32 v27, a63
    v_pk_mul_f32 v[28:29], v[20:21], v[20:21]
    v_pk_mul_f32 v[30:31], v[22:23], v[22:23]
    v_pk_mul_f32 v[32:33], v[24:25], v[24:25]
    v_pk_mul_f32 v[34:35], v[26:27], v[26:27]
    v_pk_fma_f32 v[28:29], v[28:29], v[242:243], v[240:241]
    v_pk_fma_f32 v[30:31], v[30:31], v[242:243], v[240:241]
    v_pk_fma_f32 v[32:33], v[32:33], v[242:243], v[240:241]
    v_pk_fma_f32 v[34:35], v[34:35], v[242:243], v[240:241]
    v_pk_mul_f32 v[28:29], v[28:29], v[20:21]
    v_pk_mul_f32 v[30:31], v[30:31], v[22:23]
    v_pk_mul_f32 v[32:33], v[32:33], v[24:25]
    v_pk_mul_f32 v[34:35], v[34:35], v[26:27]
    v_exp_f32 v28, v28
    v_exp_f32 v29, v29
    v_exp_f32 v30, v30
    v_exp_f32 v31, v31
    v_exp_f32 v32, v32
    v_exp_f32 v33, v33
    v_exp_f32 v34, v34
    v_exp_f32 v35, v35
    v_pk_add_f32 v[28:29], v[28:29], v[244:245]
    v_pk_add_f32 v[30:31], v[30:31], v[244:245]
    v_pk_add_f32 v[32:33], v[32:33], v[244:245]
    v_pk_add_f32 v[34:35], v[34:35], v[244:245]
    v_rcp_f32 v28, v28
    v_rcp_f32 v29, v29
    v_rcp_f32 v30, v30
    v_rcp_f32 v31, v31
    v_rcp_f32 v32, v32
    v_rcp_f32 v33, v33
    v_rcp_f32 v34, v34
    v_rcp_f32 v35, v35
    v_pk_mul_f32 v[20:21], v[28:29], v[20:21]
    v_pk_mul_f32 v[22:23], v[30:31], v[22:23]
    v_pk_mul_f32 v[24:25], v[32:33], v[24:25]
    v_pk_mul_f32 v[26:27], v[34:35], v[26:27]
    v_cvt_pk_bf16_f32 v36, v20, v21
    v_cvt_pk_bf16_f32 v37, v22, v23
    v_cvt_pk_bf16_f32 v38, v24, v25
    v_cvt_pk_bf16_f32 v39, v26, v27
    buffer_store_dwordx4 v[36:39], v251, s[4:7], s53 offen offset:3072 sc1
    s_add_u32 s53, s53, s22
    v_accvgpr_read_b32 v40, a64
    v_accvgpr_read_b32 v41, a65
    v_accvgpr_read_b32 v42, a66
    v_accvgpr_read_b32 v43, a67
    v_accvgpr_read_b32 v44, a68
    v_accvgpr_read_b32 v45, a69
    v_accvgpr_read_b32 v46, a70
    v_accvgpr_read_b32 v47, a71
    v_pk_mul_f32 v[48:49], v[40:41], v[40:41]
    v_pk_mul_f32 v[50:51], v[42:43], v[42:43]
    v_pk_mul_f32 v[52:53], v[44:45], v[44:45]
    v_pk_mul_f32 v[54:55], v[46:47], v[46:47]
    v_pk_fma_f32 v[48:49], v[48:49], v[242:243], v[240:241]
    v_pk_fma_f32 v[50:51], v[50:51], v[242:243], v[240:241]
    v_pk_fma_f32 v[52:53], v[52:53], v[242:243], v[240:241]
    v_pk_fma_f32 v[54:55], v[54:55], v[242:243], v[240:241]
    v_pk_mul_f32 v[48:49], v[48:49], v[40:41]
    v_pk_mul_f32 v[50:51], v[50:51], v[42:43]
    v_pk_mul_f32 v[52:53], v[52:53], v[44:45]
    v_pk_mul_f32 v[54:55], v[54:55], v[46:47]
    v_exp_f32 v48, v48
    v_exp_f32 v49, v49
    v_exp_f32 v50, v50
    v_exp_f32 v51, v51
    v_exp_f32 v52, v52
    v_exp_f32 v53, v53
    v_exp_f32 v54, v54
    v_exp_f32 v55, v55
    v_pk_add_f32 v[48:49], v[48:49], v[244:245]
    v_pk_add_f32 v[50:51], v[50:51], v[244:245]
    v_pk_add_f32 v[52:53], v[52:53], v[244:245]
    v_pk_add_f32 v[54:55], v[54:55], v[244:245]
    v_rcp_f32 v48, v48
    v_rcp_f32 v49, v49
    v_rcp_f32 v50, v50
    v_rcp_f32 v51, v51
    v_rcp_f32 v52, v52
    v_rcp_f32 v53, v53
    v_rcp_f32 v54, v54
    v_rcp_f32 v55, v55
    v_pk_mul_f32 v[40:41], v[48:49], v[40:41]
    v_pk_mul_f32 v[42:43], v[50:51], v[42:43]
    v_pk_mul_f32 v[44:45], v[52:53], v[44:45]
    v_pk_mul_f32 v[46:47], v[54:55], v[46:47]
    v_cvt_pk_bf16_f32 v56, v40, v41
    v_cvt_pk_bf16_f32 v57, v42, v43
    v_cvt_pk_bf16_f32 v58, v44, v45
    v_cvt_pk_bf16_f32 v59, v46, v47
    buffer_store_dwordx4 v[56:59], v251, s[4:7], s53 offen offset:0 sc1
    v_accvgpr_read_b32 v0, a72
    v_accvgpr_read_b32 v1, a73
    v_accvgpr_read_b32 v2, a74
    v_accvgpr_read_b32 v3, a75
    v_accvgpr_read_b32 v4, a76
    v_accvgpr_read_b32 v5, a77
    v_accvgpr_read_b32 v6, a78
    v_accvgpr_read_b32 v7, a79
    v_pk_mul_f32 v[8:9], v[0:1], v[0:1]
    v_pk_mul_f32 v[10:11], v[2:3], v[2:3]
    v_pk_mul_f32 v[12:13], v[4:5], v[4:5]
    v_pk_mul_f32 v[14:15], v[6:7], v[6:7]
    v_pk_fma_f32 v[8:9], v[8:9], v[242:243], v[240:241]
    v_pk_fma_f32 v[10:11], v[10:11], v[242:243], v[240:241]
    v_pk_fma_f32 v[12:13], v[12:13], v[242:243], v[240:241]
    v_pk_fma_f32 v[14:15], v[14:15], v[242:243], v[240:241]
    v_pk_mul_f32 v[8:9], v[8:9], v[0:1]
    v_pk_mul_f32 v[10:11], v[10:11], v[2:3]
    v_pk_mul_f32 v[12:13], v[12:13], v[4:5]
    v_pk_mul_f32 v[14:15], v[14:15], v[6:7]
    v_exp_f32 v8, v8
    v_exp_f32 v9, v9
    v_exp_f32 v10, v10
    v_exp_f32 v11, v11
    v_exp_f32 v12, v12
    v_exp_f32 v13, v13
    v_exp_f32 v14, v14
    v_exp_f32 v15, v15
    v_pk_add_f32 v[8:9], v[8:9], v[244:245]
    v_pk_add_f32 v[10:11], v[10:11], v[244:245]
    v_pk_add_f32 v[12:13], v[12:13], v[244:245]
    v_pk_add_f32 v[14:15], v[14:15], v[244:245]
    v_rcp_f32 v8, v8
    v_rcp_f32 v9, v9
    v_rcp_f32 v10, v10
    v_rcp_f32 v11, v11
    v_rcp_f32 v12, v12
    v_rcp_f32 v13, v13
    v_rcp_f32 v14, v14
    v_rcp_f32 v15, v15
    v_pk_mul_f32 v[0:1], v[8:9], v[0:1]
    v_pk_mul_f32 v[2:3], v[10:11], v[2:3]
    v_pk_mul_f32 v[4:5], v[12:13], v[4:5]
    v_pk_mul_f32 v[6:7], v[14:15], v[6:7]
    v_cvt_pk_bf16_f32 v16, v0, v1
    v_cvt_pk_bf16_f32 v17, v2, v3
    v_cvt_pk_bf16_f32 v18, v4, v5
    v_cvt_pk_bf16_f32 v19, v6, v7
    buffer_store_dwordx4 v[16:19], v251, s[4:7], s53 offen offset:1024 sc1
    v_accvgpr_read_b32 v20, a80
    v_accvgpr_read_b32 v21, a81
    v_accvgpr_read_b32 v22, a82
    v_accvgpr_read_b32 v23, a83
    v_accvgpr_read_b32 v24, a84
    v_accvgpr_read_b32 v25, a85
    v_accvgpr_read_b32 v26, a86
    v_accvgpr_read_b32 v27, a87
    v_pk_mul_f32 v[28:29], v[20:21], v[20:21]
    v_pk_mul_f32 v[30:31], v[22:23], v[22:23]
    v_pk_mul_f32 v[32:33], v[24:25], v[24:25]
    v_pk_mul_f32 v[34:35], v[26:27], v[26:27]
    v_pk_fma_f32 v[28:29], v[28:29], v[242:243], v[240:241]
    v_pk_fma_f32 v[30:31], v[30:31], v[242:243], v[240:241]
    v_pk_fma_f32 v[32:33], v[32:33], v[242:243], v[240:241]
    v_pk_fma_f32 v[34:35], v[34:35], v[242:243], v[240:241]
    v_pk_mul_f32 v[28:29], v[28:29], v[20:21]
    v_pk_mul_f32 v[30:31], v[30:31], v[22:23]
    v_pk_mul_f32 v[32:33], v[32:33], v[24:25]
    v_pk_mul_f32 v[34:35], v[34:35], v[26:27]
    v_exp_f32 v28, v28
    v_exp_f32 v29, v29
    v_exp_f32 v30, v30
    v_exp_f32 v31, v31
    v_exp_f32 v32, v32
    v_exp_f32 v33, v33
    v_exp_f32 v34, v34
    v_exp_f32 v35, v35
    v_pk_add_f32 v[28:29], v[28:29], v[244:245]
    v_pk_add_f32 v[30:31], v[30:31], v[244:245]
    v_pk_add_f32 v[32:33], v[32:33], v[244:245]
    v_pk_add_f32 v[34:35], v[34:35], v[244:245]
    v_rcp_f32 v28, v28
    v_rcp_f32 v29, v29
    v_rcp_f32 v30, v30
    v_rcp_f32 v31, v31
    v_rcp_f32 v32, v32
    v_rcp_f32 v33, v33
    v_rcp_f32 v34, v34
    v_rcp_f32 v35, v35
    v_pk_mul_f32 v[20:21], v[28:29], v[20:21]
    v_pk_mul_f32 v[22:23], v[30:31], v[22:23]
    v_pk_mul_f32 v[24:25], v[32:33], v[24:25]
    v_pk_mul_f32 v[26:27], v[34:35], v[26:27]
    v_cvt_pk_bf16_f32 v36, v20, v21
    v_cvt_pk_bf16_f32 v37, v22, v23
    v_cvt_pk_bf16_f32 v38, v24, v25
    v_cvt_pk_bf16_f32 v39, v26, v27
    buffer_store_dwordx4 v[36:39], v251, s[4:7], s53 offen offset:2048 sc1
    v_accvgpr_read_b32 v40, a88
    v_accvgpr_read_b32 v41, a89
    v_accvgpr_read_b32 v42, a90
    v_accvgpr_read_b32 v43, a91
    v_accvgpr_read_b32 v44, a92
    v_accvgpr_read_b32 v45, a93
    v_accvgpr_read_b32 v46, a94
    v_accvgpr_read_b32 v47, a95
    v_pk_mul_f32 v[48:49], v[40:41], v[40:41]
    v_pk_mul_f32 v[50:51], v[42:43], v[42:43]
    v_pk_mul_f32 v[52:53], v[44:45], v[44:45]
    v_pk_mul_f32 v[54:55], v[46:47], v[46:47]
    v_pk_fma_f32 v[48:49], v[48:49], v[242:243], v[240:241]
    v_pk_fma_f32 v[50:51], v[50:51], v[242:243], v[240:241]
    v_pk_fma_f32 v[52:53], v[52:53], v[242:243], v[240:241]
    v_pk_fma_f32 v[54:55], v[54:55], v[242:243], v[240:241]
    v_pk_mul_f32 v[48:49], v[48:49], v[40:41]
    v_pk_mul_f32 v[50:51], v[50:51], v[42:43]
    v_pk_mul_f32 v[52:53], v[52:53], v[44:45]
    v_pk_mul_f32 v[54:55], v[54:55], v[46:47]
    v_exp_f32 v48, v48
    v_exp_f32 v49, v49
    v_exp_f32 v50, v50
    v_exp_f32 v51, v51
    v_exp_f32 v52, v52
    v_exp_f32 v53, v53
    v_exp_f32 v54, v54
    v_exp_f32 v55, v55
    v_pk_add_f32 v[48:49], v[48:49], v[244:245]
    v_pk_add_f32 v[50:51], v[50:51], v[244:245]
    v_pk_add_f32 v[52:53], v[52:53], v[244:245]
    v_pk_add_f32 v[54:55], v[54:55], v[244:245]
    v_rcp_f32 v48, v48
    v_rcp_f32 v49, v49
    v_rcp_f32 v50, v50
    v_rcp_f32 v51, v51
    v_rcp_f32 v52, v52
    v_rcp_f32 v53, v53
    v_rcp_f32 v54, v54
    v_rcp_f32 v55, v55
    v_pk_mul_f32 v[40:41], v[48:49], v[40:41]
    v_pk_mul_f32 v[42:43], v[50:51], v[42:43]
    v_pk_mul_f32 v[44:45], v[52:53], v[44:45]
    v_pk_mul_f32 v[46:47], v[54:55], v[46:47]
    v_cvt_pk_bf16_f32 v56, v40, v41
    v_cvt_pk_bf16_f32 v57, v42, v43
    v_cvt_pk_bf16_f32 v58, v44, v45
    v_cvt_pk_bf16_f32 v59, v46, v47
    buffer_store_dwordx4 v[56:59], v251, s[4:7], s53 offen offset:3072 sc1
    s_add_u32 s53, s53, s22
    v_accvgpr_read_b32 v0, a96
    v_accvgpr_read_b32 v1, a97
    v_accvgpr_read_b32 v2, a98
    v_accvgpr_read_b32 v3, a99
    v_accvgpr_read_b32 v4, a100
    v_accvgpr_read_b32 v5, a101
    v_accvgpr_read_b32 v6, a102
    v_accvgpr_read_b32 v7, a103
    v_pk_mul_f32 v[8:9], v[0:1], v[0:1]
    v_pk_mul_f32 v[10:11], v[2:3], v[2:3]
    v_pk_mul_f32 v[12:13], v[4:5], v[4:5]
    v_pk_mul_f32 v[14:15], v[6:7], v[6:7]
    v_pk_fma_f32 v[8:9], v[8:9], v[242:243], v[240:241]
    v_pk_fma_f32 v[10:11], v[10:11], v[242:243], v[240:241]
    v_pk_fma_f32 v[12:13], v[12:13], v[242:243], v[240:241]
    v_pk_fma_f32 v[14:15], v[14:15], v[242:243], v[240:241]
    v_pk_mul_f32 v[8:9], v[8:9], v[0:1]
    v_pk_mul_f32 v[10:11], v[10:11], v[2:3]
    v_pk_mul_f32 v[12:13], v[12:13], v[4:5]
    v_pk_mul_f32 v[14:15], v[14:15], v[6:7]
    v_exp_f32 v8, v8
    v_exp_f32 v9, v9
    v_exp_f32 v10, v10
    v_exp_f32 v11, v11
    v_exp_f32 v12, v12
    v_exp_f32 v13, v13
    v_exp_f32 v14, v14
    v_exp_f32 v15, v15
    v_pk_add_f32 v[8:9], v[8:9], v[244:245]
    v_pk_add_f32 v[10:11], v[10:11], v[244:245]
    v_pk_add_f32 v[12:13], v[12:13], v[244:245]
    v_pk_add_f32 v[14:15], v[14:15], v[244:245]
    v_rcp_f32 v8, v8
    v_rcp_f32 v9, v9
    v_rcp_f32 v10, v10
    v_rcp_f32 v11, v11
    v_rcp_f32 v12, v12
    v_rcp_f32 v13, v13
    v_rcp_f32 v14, v14
    v_rcp_f32 v15, v15
    v_pk_mul_f32 v[0:1], v[8:9], v[0:1]
    v_pk_mul_f32 v[2:3], v[10:11], v[2:3]
    v_pk_mul_f32 v[4:5], v[12:13], v[4:5]
    v_pk_mul_f32 v[6:7], v[14:15], v[6:7]
    v_cvt_pk_bf16_f32 v16, v0, v1
    v_cvt_pk_bf16_f32 v17, v2, v3
    v_cvt_pk_bf16_f32 v18, v4, v5
    v_cvt_pk_bf16_f32 v19, v6, v7
    buffer_store_dwordx4 v[16:19], v251, s[4:7], s53 offen offset:0 sc1
    v_accvgpr_read_b32 v20, a104
    v_accvgpr_read_b32 v21, a105
    v_accvgpr_read_b32 v22, a106
    v_accvgpr_read_b32 v23, a107
    v_accvgpr_read_b32 v24, a108
    v_accvgpr_read_b32 v25, a109
    v_accvgpr_read_b32 v26, a110
    v_accvgpr_read_b32 v27, a111
    v_pk_mul_f32 v[28:29], v[20:21], v[20:21]
    v_pk_mul_f32 v[30:31], v[22:23], v[22:23]
    v_pk_mul_f32 v[32:33], v[24:25], v[24:25]
    v_pk_mul_f32 v[34:35], v[26:27], v[26:27]
    v_pk_fma_f32 v[28:29], v[28:29], v[242:243], v[240:241]
    v_pk_fma_f32 v[30:31], v[30:31], v[242:243], v[240:241]
    v_pk_fma_f32 v[32:33], v[32:33], v[242:243], v[240:241]
    v_pk_fma_f32 v[34:35], v[34:35], v[242:243], v[240:241]
    v_pk_mul_f32 v[28:29], v[28:29], v[20:21]
    v_pk_mul_f32 v[30:31], v[30:31], v[22:23]
    v_pk_mul_f32 v[32:33], v[32:33], v[24:25]
    v_pk_mul_f32 v[34:35], v[34:35], v[26:27]
    v_exp_f32 v28, v28
    v_exp_f32 v29, v29
    v_exp_f32 v30, v30
    v_exp_f32 v31, v31
    v_exp_f32 v32, v32
    v_exp_f32 v33, v33
    v_exp_f32 v34, v34
    v_exp_f32 v35, v35
    v_pk_add_f32 v[28:29], v[28:29], v[244:245]
    v_pk_add_f32 v[30:31], v[30:31], v[244:245]
    v_pk_add_f32 v[32:33], v[32:33], v[244:245]
    v_pk_add_f32 v[34:35], v[34:35], v[244:245]
    v_rcp_f32 v28, v28
    v_rcp_f32 v29, v29
    v_rcp_f32 v30, v30
    v_rcp_f32 v31, v31
    v_rcp_f32 v32, v32
    v_rcp_f32 v33, v33
    v_rcp_f32 v34, v34
    v_rcp_f32 v35, v35
    v_pk_mul_f32 v[20:21], v[28:29], v[20:21]
    v_pk_mul_f32 v[22:23], v[30:31], v[22:23]
    v_pk_mul_f32 v[24:25], v[32:33], v[24:25]
    v_pk_mul_f32 v[26:27], v[34:35], v[26:27]
    v_cvt_pk_bf16_f32 v36, v20, v21
    v_cvt_pk_bf16_f32 v37, v22, v23
    v_cvt_pk_bf16_f32 v38, v24, v25
    v_cvt_pk_bf16_f32 v39, v26, v27
    buffer_store_dwordx4 v[36:39], v251, s[4:7], s53 offen offset:1024 sc1
    v_accvgpr_read_b32 v40, a112
    v_accvgpr_read_b32 v41, a113
    v_accvgpr_read_b32 v42, a114
    v_accvgpr_read_b32 v43, a115
    v_accvgpr_read_b32 v44, a116
    v_accvgpr_read_b32 v45, a117
    v_accvgpr_read_b32 v46, a118
    v_accvgpr_read_b32 v47, a119
    v_pk_mul_f32 v[48:49], v[40:41], v[40:41]
    v_pk_mul_f32 v[50:51], v[42:43], v[42:43]
    v_pk_mul_f32 v[52:53], v[44:45], v[44:45]
    v_pk_mul_f32 v[54:55], v[46:47], v[46:47]
    v_pk_fma_f32 v[48:49], v[48:49], v[242:243], v[240:241]
    v_pk_fma_f32 v[50:51], v[50:51], v[242:243], v[240:241]
    v_pk_fma_f32 v[52:53], v[52:53], v[242:243], v[240:241]
    v_pk_fma_f32 v[54:55], v[54:55], v[242:243], v[240:241]
    v_pk_mul_f32 v[48:49], v[48:49], v[40:41]
    v_pk_mul_f32 v[50:51], v[50:51], v[42:43]
    v_pk_mul_f32 v[52:53], v[52:53], v[44:45]
    v_pk_mul_f32 v[54:55], v[54:55], v[46:47]
    v_exp_f32 v48, v48
    v_exp_f32 v49, v49
    v_exp_f32 v50, v50
    v_exp_f32 v51, v51
    v_exp_f32 v52, v52
    v_exp_f32 v53, v53
    v_exp_f32 v54, v54
    v_exp_f32 v55, v55
    v_pk_add_f32 v[48:49], v[48:49], v[244:245]
    v_pk_add_f32 v[50:51], v[50:51], v[244:245]
    v_pk_add_f32 v[52:53], v[52:53], v[244:245]
    v_pk_add_f32 v[54:55], v[54:55], v[244:245]
    v_rcp_f32 v48, v48
    v_rcp_f32 v49, v49
    v_rcp_f32 v50, v50
    v_rcp_f32 v51, v51
    v_rcp_f32 v52, v52
    v_rcp_f32 v53, v53
    v_rcp_f32 v54, v54
    v_rcp_f32 v55, v55
    v_pk_mul_f32 v[40:41], v[48:49], v[40:41]
    v_pk_mul_f32 v[42:43], v[50:51], v[42:43]
    v_pk_mul_f32 v[44:45], v[52:53], v[44:45]
    v_pk_mul_f32 v[46:47], v[54:55], v[46:47]
    v_cvt_pk_bf16_f32 v56, v40, v41
    v_cvt_pk_bf16_f32 v57, v42, v43
    v_cvt_pk_bf16_f32 v58, v44, v45
    v_cvt_pk_bf16_f32 v59, v46, v47
    buffer_store_dwordx4 v[56:59], v251, s[4:7], s53 offen offset:2048 sc1
    v_accvgpr_read_b32 v0, a120
    v_accvgpr_read_b32 v1, a121
    v_accvgpr_read_b32 v2, a122
    v_accvgpr_read_b32 v3, a123
    v_accvgpr_read_b32 v4, a124
    v_accvgpr_read_b32 v5, a125
    v_accvgpr_read_b32 v6, a126
    v_accvgpr_read_b32 v7, a127
    v_pk_mul_f32 v[8:9], v[0:1], v[0:1]
    v_pk_mul_f32 v[10:11], v[2:3], v[2:3]
    v_pk_mul_f32 v[12:13], v[4:5], v[4:5]
    v_pk_mul_f32 v[14:15], v[6:7], v[6:7]
    v_pk_fma_f32 v[8:9], v[8:9], v[242:243], v[240:241]
    v_pk_fma_f32 v[10:11], v[10:11], v[242:243], v[240:241]
    v_pk_fma_f32 v[12:13], v[12:13], v[242:243], v[240:241]
    v_pk_fma_f32 v[14:15], v[14:15], v[242:243], v[240:241]
    v_pk_mul_f32 v[8:9], v[8:9], v[0:1]
    v_pk_mul_f32 v[10:11], v[10:11], v[2:3]
    v_pk_mul_f32 v[12:13], v[12:13], v[4:5]
    v_pk_mul_f32 v[14:15], v[14:15], v[6:7]
    v_exp_f32 v8, v8
    v_exp_f32 v9, v9
    v_exp_f32 v10, v10
    v_exp_f32 v11, v11
    v_exp_f32 v12, v12
    v_exp_f32 v13, v13
    v_exp_f32 v14, v14
    v_exp_f32 v15, v15
    v_pk_add_f32 v[8:9], v[8:9], v[244:245]
    v_pk_add_f32 v[10:11], v[10:11], v[244:245]
    v_pk_add_f32 v[12:13], v[12:13], v[244:245]
    v_pk_add_f32 v[14:15], v[14:15], v[244:245]
    v_rcp_f32 v8, v8
    v_rcp_f32 v9, v9
    v_rcp_f32 v10, v10
    v_rcp_f32 v11, v11
    v_rcp_f32 v12, v12
    v_rcp_f32 v13, v13
    v_rcp_f32 v14, v14
    v_rcp_f32 v15, v15
    v_pk_mul_f32 v[0:1], v[8:9], v[0:1]
    v_pk_mul_f32 v[2:3], v[10:11], v[2:3]
    v_pk_mul_f32 v[4:5], v[12:13], v[4:5]
    v_pk_mul_f32 v[6:7], v[14:15], v[6:7]
    v_cvt_pk_bf16_f32 v16, v0, v1
    v_cvt_pk_bf16_f32 v17, v2, v3
    v_cvt_pk_bf16_f32 v18, v4, v5
    v_cvt_pk_bf16_f32 v19, v6, v7
    buffer_store_dwordx4 v[16:19], v251, s[4:7], s53 offen offset:3072 sc1
    s_add_u32 s53, s53, s22
    v_accvgpr_read_b32 v20, a128
    v_accvgpr_read_b32 v21, a129
    v_accvgpr_read_b32 v22, a130
    v_accvgpr_read_b32 v23, a131
    v_accvgpr_read_b32 v24, a132
    v_accvgpr_read_b32 v25, a133
    v_accvgpr_read_b32 v26, a134
    v_accvgpr_read_b32 v27, a135
    v_pk_mul_f32 v[28:29], v[20:21], v[20:21]
    v_pk_mul_f32 v[30:31], v[22:23], v[22:23]
    v_pk_mul_f32 v[32:33], v[24:25], v[24:25]
    v_pk_mul_f32 v[34:35], v[26:27], v[26:27]
    v_pk_fma_f32 v[28:29], v[28:29], v[242:243], v[240:241]
    v_pk_fma_f32 v[30:31], v[30:31], v[242:243], v[240:241]
    v_pk_fma_f32 v[32:33], v[32:33], v[242:243], v[240:241]
    v_pk_fma_f32 v[34:35], v[34:35], v[242:243], v[240:241]
    v_pk_mul_f32 v[28:29], v[28:29], v[20:21]
    v_pk_mul_f32 v[30:31], v[30:31], v[22:23]
    v_pk_mul_f32 v[32:33], v[32:33], v[24:25]
    v_pk_mul_f32 v[34:35], v[34:35], v[26:27]
    v_exp_f32 v28, v28
    v_exp_f32 v29, v29
    v_exp_f32 v30, v30
    v_exp_f32 v31, v31
    v_exp_f32 v32, v32
    v_exp_f32 v33, v33
    v_exp_f32 v34, v34
    v_exp_f32 v35, v35
    v_pk_add_f32 v[28:29], v[28:29], v[244:245]
    v_pk_add_f32 v[30:31], v[30:31], v[244:245]
    v_pk_add_f32 v[32:33], v[32:33], v[244:245]
    v_pk_add_f32 v[34:35], v[34:35], v[244:245]
    v_rcp_f32 v28, v28
    v_rcp_f32 v29, v29
    v_rcp_f32 v30, v30
    v_rcp_f32 v31, v31
    v_rcp_f32 v32, v32
    v_rcp_f32 v33, v33
    v_rcp_f32 v34, v34
    v_rcp_f32 v35, v35
    v_pk_mul_f32 v[20:21], v[28:29], v[20:21]
    v_pk_mul_f32 v[22:23], v[30:31], v[22:23]
    v_pk_mul_f32 v[24:25], v[32:33], v[24:25]
    v_pk_mul_f32 v[26:27], v[34:35], v[26:27]
    v_cvt_pk_bf16_f32 v36, v20, v21
    v_cvt_pk_bf16_f32 v37, v22, v23
    v_cvt_pk_bf16_f32 v38, v24, v25
    v_cvt_pk_bf16_f32 v39, v26, v27
    buffer_store_dwordx4 v[36:39], v251, s[4:7], s53 offen offset:0 sc1
    v_accvgpr_read_b32 v40, a136
    v_accvgpr_read_b32 v41, a137
    v_accvgpr_read_b32 v42, a138
    v_accvgpr_read_b32 v43, a139
    v_accvgpr_read_b32 v44, a140
    v_accvgpr_read_b32 v45, a141
    v_accvgpr_read_b32 v46, a142
    v_accvgpr_read_b32 v47, a143
    v_pk_mul_f32 v[48:49], v[40:41], v[40:41]
    v_pk_mul_f32 v[50:51], v[42:43], v[42:43]
    v_pk_mul_f32 v[52:53], v[44:45], v[44:45]
    v_pk_mul_f32 v[54:55], v[46:47], v[46:47]
    v_pk_fma_f32 v[48:49], v[48:49], v[242:243], v[240:241]
    v_pk_fma_f32 v[50:51], v[50:51], v[242:243], v[240:241]
    v_pk_fma_f32 v[52:53], v[52:53], v[242:243], v[240:241]
    v_pk_fma_f32 v[54:55], v[54:55], v[242:243], v[240:241]
    v_pk_mul_f32 v[48:49], v[48:49], v[40:41]
    v_pk_mul_f32 v[50:51], v[50:51], v[42:43]
    v_pk_mul_f32 v[52:53], v[52:53], v[44:45]
    v_pk_mul_f32 v[54:55], v[54:55], v[46:47]
    v_exp_f32 v48, v48
    v_exp_f32 v49, v49
    v_exp_f32 v50, v50
    v_exp_f32 v51, v51
    v_exp_f32 v52, v52
    v_exp_f32 v53, v53
    v_exp_f32 v54, v54
    v_exp_f32 v55, v55
    v_pk_add_f32 v[48:49], v[48:49], v[244:245]
    v_pk_add_f32 v[50:51], v[50:51], v[244:245]
    v_pk_add_f32 v[52:53], v[52:53], v[244:245]
    v_pk_add_f32 v[54:55], v[54:55], v[244:245]
    v_rcp_f32 v48, v48
    v_rcp_f32 v49, v49
    v_rcp_f32 v50, v50
    v_rcp_f32 v51, v51
    v_rcp_f32 v52, v52
    v_rcp_f32 v53, v53
    v_rcp_f32 v54, v54
    v_rcp_f32 v55, v55
    v_pk_mul_f32 v[40:41], v[48:49], v[40:41]
    v_pk_mul_f32 v[42:43], v[50:51], v[42:43]
    v_pk_mul_f32 v[44:45], v[52:53], v[44:45]
    v_pk_mul_f32 v[46:47], v[54:55], v[46:47]
    v_cvt_pk_bf16_f32 v56, v40, v41
    v_cvt_pk_bf16_f32 v57, v42, v43
    v_cvt_pk_bf16_f32 v58, v44, v45
    v_cvt_pk_bf16_f32 v59, v46, v47
    buffer_store_dwordx4 v[56:59], v251, s[4:7], s53 offen offset:1024 sc1
    v_accvgpr_read_b32 v0, a144
    v_accvgpr_read_b32 v1, a145
    v_accvgpr_read_b32 v2, a146
    v_accvgpr_read_b32 v3, a147
    v_accvgpr_read_b32 v4, a148
    v_accvgpr_read_b32 v5, a149
    v_accvgpr_read_b32 v6, a150
    v_accvgpr_read_b32 v7, a151
    v_pk_mul_f32 v[8:9], v[0:1], v[0:1]
    v_pk_mul_f32 v[10:11], v[2:3], v[2:3]
    v_pk_mul_f32 v[12:13], v[4:5], v[4:5]
    v_pk_mul_f32 v[14:15], v[6:7], v[6:7]
    v_pk_fma_f32 v[8:9], v[8:9], v[242:243], v[240:241]
    v_pk_fma_f32 v[10:11], v[10:11], v[242:243], v[240:241]
    v_pk_fma_f32 v[12:13], v[12:13], v[242:243], v[240:241]
    v_pk_fma_f32 v[14:15], v[14:15], v[242:243], v[240:241]
    v_pk_mul_f32 v[8:9], v[8:9], v[0:1]
    v_pk_mul_f32 v[10:11], v[10:11], v[2:3]
    v_pk_mul_f32 v[12:13], v[12:13], v[4:5]
    v_pk_mul_f32 v[14:15], v[14:15], v[6:7]
    v_exp_f32 v8, v8
    v_exp_f32 v9, v9
    v_exp_f32 v10, v10
    v_exp_f32 v11, v11
    v_exp_f32 v12, v12
    v_exp_f32 v13, v13
    v_exp_f32 v14, v14
    v_exp_f32 v15, v15
    v_pk_add_f32 v[8:9], v[8:9], v[244:245]
    v_pk_add_f32 v[10:11], v[10:11], v[244:245]
    v_pk_add_f32 v[12:13], v[12:13], v[244:245]
    v_pk_add_f32 v[14:15], v[14:15], v[244:245]
    v_rcp_f32 v8, v8
    v_rcp_f32 v9, v9
    v_rcp_f32 v10, v10
    v_rcp_f32 v11, v11
    v_rcp_f32 v12, v12
    v_rcp_f32 v13, v13
    v_rcp_f32 v14, v14
    v_rcp_f32 v15, v15
    v_pk_mul_f32 v[0:1], v[8:9], v[0:1]
    v_pk_mul_f32 v[2:3], v[10:11], v[2:3]
    v_pk_mul_f32 v[4:5], v[12:13], v[4:5]
    v_pk_mul_f32 v[6:7], v[14:15], v[6:7]
    v_cvt_pk_bf16_f32 v16, v0, v1
    v_cvt_pk_bf16_f32 v17, v2, v3
    v_cvt_pk_bf16_f32 v18, v4, v5
    v_cvt_pk_bf16_f32 v19, v6, v7
    buffer_store_dwordx4 v[16:19], v251, s[4:7], s53 offen offset:2048 sc1
    v_accvgpr_read_b32 v20, a152
    v_accvgpr_read_b32 v21, a153
    v_accvgpr_read_b32 v22, a154
    v_accvgpr_read_b32 v23, a155
    v_accvgpr_read_b32 v24, a156
    v_accvgpr_read_b32 v25, a157
    v_accvgpr_read_b32 v26, a158
    v_accvgpr_read_b32 v27, a159
    v_pk_mul_f32 v[28:29], v[20:21], v[20:21]
    v_pk_mul_f32 v[30:31], v[22:23], v[22:23]
    v_pk_mul_f32 v[32:33], v[24:25], v[24:25]
    v_pk_mul_f32 v[34:35], v[26:27], v[26:27]
    v_pk_fma_f32 v[28:29], v[28:29], v[242:243], v[240:241]
    v_pk_fma_f32 v[30:31], v[30:31], v[242:243], v[240:241]
    v_pk_fma_f32 v[32:33], v[32:33], v[242:243], v[240:241]
    v_pk_fma_f32 v[34:35], v[34:35], v[242:243], v[240:241]
    v_pk_mul_f32 v[28:29], v[28:29], v[20:21]
    v_pk_mul_f32 v[30:31], v[30:31], v[22:23]
    v_pk_mul_f32 v[32:33], v[32:33], v[24:25]
    v_pk_mul_f32 v[34:35], v[34:35], v[26:27]
    v_exp_f32 v28, v28
    v_exp_f32 v29, v29
    v_exp_f32 v30, v30
    v_exp_f32 v31, v31
    v_exp_f32 v32, v32
    v_exp_f32 v33, v33
    v_exp_f32 v34, v34
    v_exp_f32 v35, v35
    v_pk_add_f32 v[28:29], v[28:29], v[244:245]
    v_pk_add_f32 v[30:31], v[30:31], v[244:245]
    v_pk_add_f32 v[32:33], v[32:33], v[244:245]
    v_pk_add_f32 v[34:35], v[34:35], v[244:245]
    v_rcp_f32 v28, v28
    v_rcp_f32 v29, v29
    v_rcp_f32 v30, v30
    v_rcp_f32 v31, v31
    v_rcp_f32 v32, v32
    v_rcp_f32 v33, v33
    v_rcp_f32 v34, v34
    v_rcp_f32 v35, v35
    v_pk_mul_f32 v[20:21], v[28:29], v[20:21]
    v_pk_mul_f32 v[22:23], v[30:31], v[22:23]
    v_pk_mul_f32 v[24:25], v[32:33], v[24:25]
    v_pk_mul_f32 v[26:27], v[34:35], v[26:27]
    v_cvt_pk_bf16_f32 v36, v20, v21
    v_cvt_pk_bf16_f32 v37, v22, v23
    v_cvt_pk_bf16_f32 v38, v24, v25
    v_cvt_pk_bf16_f32 v39, v26, v27
    buffer_store_dwordx4 v[36:39], v251, s[4:7], s53 offen offset:3072 sc1
    s_add_u32 s53, s53, s22
    v_accvgpr_read_b32 v40, a160
    v_accvgpr_read_b32 v41, a161
    v_accvgpr_read_b32 v42, a162
    v_accvgpr_read_b32 v43, a163
    v_accvgpr_read_b32 v44, a164
    v_accvgpr_read_b32 v45, a165
    v_accvgpr_read_b32 v46, a166
    v_accvgpr_read_b32 v47, a167
    v_pk_mul_f32 v[48:49], v[40:41], v[40:41]
    v_pk_mul_f32 v[50:51], v[42:43], v[42:43]
    v_pk_mul_f32 v[52:53], v[44:45], v[44:45]
    v_pk_mul_f32 v[54:55], v[46:47], v[46:47]
    v_pk_fma_f32 v[48:49], v[48:49], v[242:243], v[240:241]
    v_pk_fma_f32 v[50:51], v[50:51], v[242:243], v[240:241]
    v_pk_fma_f32 v[52:53], v[52:53], v[242:243], v[240:241]
    v_pk_fma_f32 v[54:55], v[54:55], v[242:243], v[240:241]
    v_pk_mul_f32 v[48:49], v[48:49], v[40:41]
    v_pk_mul_f32 v[50:51], v[50:51], v[42:43]
    v_pk_mul_f32 v[52:53], v[52:53], v[44:45]
    v_pk_mul_f32 v[54:55], v[54:55], v[46:47]
    v_exp_f32 v48, v48
    v_exp_f32 v49, v49
    v_exp_f32 v50, v50
    v_exp_f32 v51, v51
    v_exp_f32 v52, v52
    v_exp_f32 v53, v53
    v_exp_f32 v54, v54
    v_exp_f32 v55, v55
    v_pk_add_f32 v[48:49], v[48:49], v[244:245]
    v_pk_add_f32 v[50:51], v[50:51], v[244:245]
    v_pk_add_f32 v[52:53], v[52:53], v[244:245]
    v_pk_add_f32 v[54:55], v[54:55], v[244:245]
    v_rcp_f32 v48, v48
    v_rcp_f32 v49, v49
    v_rcp_f32 v50, v50
    v_rcp_f32 v51, v51
    v_rcp_f32 v52, v52
    v_rcp_f32 v53, v53
    v_rcp_f32 v54, v54
    v_rcp_f32 v55, v55
    v_pk_mul_f32 v[40:41], v[48:49], v[40:41]
    v_pk_mul_f32 v[42:43], v[50:51], v[42:43]
    v_pk_mul_f32 v[44:45], v[52:53], v[44:45]
    v_pk_mul_f32 v[46:47], v[54:55], v[46:47]
    v_cvt_pk_bf16_f32 v56, v40, v41
    v_cvt_pk_bf16_f32 v57, v42, v43
    v_cvt_pk_bf16_f32 v58, v44, v45
    v_cvt_pk_bf16_f32 v59, v46, v47
    buffer_store_dwordx4 v[56:59], v251, s[4:7], s53 offen offset:0 sc1
    v_accvgpr_read_b32 v0, a168
    v_accvgpr_read_b32 v1, a169
    v_accvgpr_read_b32 v2, a170
    v_accvgpr_read_b32 v3, a171
    v_accvgpr_read_b32 v4, a172
    v_accvgpr_read_b32 v5, a173
    v_accvgpr_read_b32 v6, a174
    v_accvgpr_read_b32 v7, a175
    v_pk_mul_f32 v[8:9], v[0:1], v[0:1]
    v_pk_mul_f32 v[10:11], v[2:3], v[2:3]
    v_pk_mul_f32 v[12:13], v[4:5], v[4:5]
    v_pk_mul_f32 v[14:15], v[6:7], v[6:7]
    v_pk_fma_f32 v[8:9], v[8:9], v[242:243], v[240:241]
    v_pk_fma_f32 v[10:11], v[10:11], v[242:243], v[240:241]
    v_pk_fma_f32 v[12:13], v[12:13], v[242:243], v[240:241]
    v_pk_fma_f32 v[14:15], v[14:15], v[242:243], v[240:241]
    v_pk_mul_f32 v[8:9], v[8:9], v[0:1]
    v_pk_mul_f32 v[10:11], v[10:11], v[2:3]
    v_pk_mul_f32 v[12:13], v[12:13], v[4:5]
    v_pk_mul_f32 v[14:15], v[14:15], v[6:7]
    v_exp_f32 v8, v8
    v_exp_f32 v9, v9
    v_exp_f32 v10, v10
    v_exp_f32 v11, v11
    v_exp_f32 v12, v12
    v_exp_f32 v13, v13
    v_exp_f32 v14, v14
    v_exp_f32 v15, v15
    v_pk_add_f32 v[8:9], v[8:9], v[244:245]
    v_pk_add_f32 v[10:11], v[10:11], v[244:245]
    v_pk_add_f32 v[12:13], v[12:13], v[244:245]
    v_pk_add_f32 v[14:15], v[14:15], v[244:245]
    v_rcp_f32 v8, v8
    v_rcp_f32 v9, v9
    v_rcp_f32 v10, v10
    v_rcp_f32 v11, v11
    v_rcp_f32 v12, v12
    v_rcp_f32 v13, v13
    v_rcp_f32 v14, v14
    v_rcp_f32 v15, v15
    v_pk_mul_f32 v[0:1], v[8:9], v[0:1]
    v_pk_mul_f32 v[2:3], v[10:11], v[2:3]
    v_pk_mul_f32 v[4:5], v[12:13], v[4:5]
    v_pk_mul_f32 v[6:7], v[14:15], v[6:7]
    v_cvt_pk_bf16_f32 v16, v0, v1
    v_cvt_pk_bf16_f32 v17, v2, v3
    v_cvt_pk_bf16_f32 v18, v4, v5
    v_cvt_pk_bf16_f32 v19, v6, v7
    buffer_store_dwordx4 v[16:19], v251, s[4:7], s53 offen offset:1024 sc1
    v_accvgpr_read_b32 v20, a176
    v_accvgpr_read_b32 v21, a177
    v_accvgpr_read_b32 v22, a178
    v_accvgpr_read_b32 v23, a179
    v_accvgpr_read_b32 v24, a180
    v_accvgpr_read_b32 v25, a181
    v_accvgpr_read_b32 v26, a182
    v_accvgpr_read_b32 v27, a183
    v_pk_mul_f32 v[28:29], v[20:21], v[20:21]
    v_pk_mul_f32 v[30:31], v[22:23], v[22:23]
    v_pk_mul_f32 v[32:33], v[24:25], v[24:25]
    v_pk_mul_f32 v[34:35], v[26:27], v[26:27]
    v_pk_fma_f32 v[28:29], v[28:29], v[242:243], v[240:241]
    v_pk_fma_f32 v[30:31], v[30:31], v[242:243], v[240:241]
    v_pk_fma_f32 v[32:33], v[32:33], v[242:243], v[240:241]
    v_pk_fma_f32 v[34:35], v[34:35], v[242:243], v[240:241]
    v_pk_mul_f32 v[28:29], v[28:29], v[20:21]
    v_pk_mul_f32 v[30:31], v[30:31], v[22:23]
    v_pk_mul_f32 v[32:33], v[32:33], v[24:25]
    v_pk_mul_f32 v[34:35], v[34:35], v[26:27]
    v_exp_f32 v28, v28
    v_exp_f32 v29, v29
    v_exp_f32 v30, v30
    v_exp_f32 v31, v31
    v_exp_f32 v32, v32
    v_exp_f32 v33, v33
    v_exp_f32 v34, v34
    v_exp_f32 v35, v35
    v_pk_add_f32 v[28:29], v[28:29], v[244:245]
    v_pk_add_f32 v[30:31], v[30:31], v[244:245]
    v_pk_add_f32 v[32:33], v[32:33], v[244:245]
    v_pk_add_f32 v[34:35], v[34:35], v[244:245]
    v_rcp_f32 v28, v28
    v_rcp_f32 v29, v29
    v_rcp_f32 v30, v30
    v_rcp_f32 v31, v31
    v_rcp_f32 v32, v32
    v_rcp_f32 v33, v33
    v_rcp_f32 v34, v34
    v_rcp_f32 v35, v35
    v_pk_mul_f32 v[20:21], v[28:29], v[20:21]
    v_pk_mul_f32 v[22:23], v[30:31], v[22:23]
    v_pk_mul_f32 v[24:25], v[32:33], v[24:25]
    v_pk_mul_f32 v[26:27], v[34:35], v[26:27]
    v_cvt_pk_bf16_f32 v36, v20, v21
    v_cvt_pk_bf16_f32 v37, v22, v23
    v_cvt_pk_bf16_f32 v38, v24, v25
    v_cvt_pk_bf16_f32 v39, v26, v27
    buffer_store_dwordx4 v[36:39], v251, s[4:7], s53 offen offset:2048 sc1
    v_accvgpr_read_b32 v40, a184
    v_accvgpr_read_b32 v41, a185
    v_accvgpr_read_b32 v42, a186
    v_accvgpr_read_b32 v43, a187
    v_accvgpr_read_b32 v44, a188
    v_accvgpr_read_b32 v45, a189
    v_accvgpr_read_b32 v46, a190
    v_accvgpr_read_b32 v47, a191
    v_pk_mul_f32 v[48:49], v[40:41], v[40:41]
    v_pk_mul_f32 v[50:51], v[42:43], v[42:43]
    v_pk_mul_f32 v[52:53], v[44:45], v[44:45]
    v_pk_mul_f32 v[54:55], v[46:47], v[46:47]
    v_pk_fma_f32 v[48:49], v[48:49], v[242:243], v[240:241]
    v_pk_fma_f32 v[50:51], v[50:51], v[242:243], v[240:241]
    v_pk_fma_f32 v[52:53], v[52:53], v[242:243], v[240:241]
    v_pk_fma_f32 v[54:55], v[54:55], v[242:243], v[240:241]
    v_pk_mul_f32 v[48:49], v[48:49], v[40:41]
    v_pk_mul_f32 v[50:51], v[50:51], v[42:43]
    v_pk_mul_f32 v[52:53], v[52:53], v[44:45]
    v_pk_mul_f32 v[54:55], v[54:55], v[46:47]
    v_exp_f32 v48, v48
    v_exp_f32 v49, v49
    v_exp_f32 v50, v50
    v_exp_f32 v51, v51
    v_exp_f32 v52, v52
    v_exp_f32 v53, v53
    v_exp_f32 v54, v54
    v_exp_f32 v55, v55
    v_pk_add_f32 v[48:49], v[48:49], v[244:245]
    v_pk_add_f32 v[50:51], v[50:51], v[244:245]
    v_pk_add_f32 v[52:53], v[52:53], v[244:245]
    v_pk_add_f32 v[54:55], v[54:55], v[244:245]
    v_rcp_f32 v48, v48
    v_rcp_f32 v49, v49
    v_rcp_f32 v50, v50
    v_rcp_f32 v51, v51
    v_rcp_f32 v52, v52
    v_rcp_f32 v53, v53
    v_rcp_f32 v54, v54
    v_rcp_f32 v55, v55
    v_pk_mul_f32 v[40:41], v[48:49], v[40:41]
    v_pk_mul_f32 v[42:43], v[50:51], v[42:43]
    v_pk_mul_f32 v[44:45], v[52:53], v[44:45]
    v_pk_mul_f32 v[46:47], v[54:55], v[46:47]
    v_cvt_pk_bf16_f32 v56, v40, v41
    v_cvt_pk_bf16_f32 v57, v42, v43
    v_cvt_pk_bf16_f32 v58, v44, v45
    v_cvt_pk_bf16_f32 v59, v46, v47
    buffer_store_dwordx4 v[56:59], v251, s[4:7], s53 offen offset:3072 sc1
    s_add_u32 s53, s53, s22
    v_accvgpr_read_b32 v0, a192
    v_accvgpr_read_b32 v1, a193
    v_accvgpr_read_b32 v2, a194
    v_accvgpr_read_b32 v3, a195
    v_accvgpr_read_b32 v4, a196
    v_accvgpr_read_b32 v5, a197
    v_accvgpr_read_b32 v6, a198
    v_accvgpr_read_b32 v7, a199
    v_pk_mul_f32 v[8:9], v[0:1], v[0:1]
    v_pk_mul_f32 v[10:11], v[2:3], v[2:3]
    v_pk_mul_f32 v[12:13], v[4:5], v[4:5]
    v_pk_mul_f32 v[14:15], v[6:7], v[6:7]
    v_pk_fma_f32 v[8:9], v[8:9], v[242:243], v[240:241]
    v_pk_fma_f32 v[10:11], v[10:11], v[242:243], v[240:241]
    v_pk_fma_f32 v[12:13], v[12:13], v[242:243], v[240:241]
    v_pk_fma_f32 v[14:15], v[14:15], v[242:243], v[240:241]
    v_pk_mul_f32 v[8:9], v[8:9], v[0:1]
    v_pk_mul_f32 v[10:11], v[10:11], v[2:3]
    v_pk_mul_f32 v[12:13], v[12:13], v[4:5]
    v_pk_mul_f32 v[14:15], v[14:15], v[6:7]
    v_exp_f32 v8, v8
    v_exp_f32 v9, v9
    v_exp_f32 v10, v10
    v_exp_f32 v11, v11
    v_exp_f32 v12, v12
    v_exp_f32 v13, v13
    v_exp_f32 v14, v14
    v_exp_f32 v15, v15
    v_pk_add_f32 v[8:9], v[8:9], v[244:245]
    v_pk_add_f32 v[10:11], v[10:11], v[244:245]
    v_pk_add_f32 v[12:13], v[12:13], v[244:245]
    v_pk_add_f32 v[14:15], v[14:15], v[244:245]
    v_rcp_f32 v8, v8
    v_rcp_f32 v9, v9
    v_rcp_f32 v10, v10
    v_rcp_f32 v11, v11
    v_rcp_f32 v12, v12
    v_rcp_f32 v13, v13
    v_rcp_f32 v14, v14
    v_rcp_f32 v15, v15
    v_pk_mul_f32 v[0:1], v[8:9], v[0:1]
    v_pk_mul_f32 v[2:3], v[10:11], v[2:3]
    v_pk_mul_f32 v[4:5], v[12:13], v[4:5]
    v_pk_mul_f32 v[6:7], v[14:15], v[6:7]
    v_cvt_pk_bf16_f32 v16, v0, v1
    v_cvt_pk_bf16_f32 v17, v2, v3
    v_cvt_pk_bf16_f32 v18, v4, v5
    v_cvt_pk_bf16_f32 v19, v6, v7
    buffer_store_dwordx4 v[16:19], v251, s[4:7], s53 offen offset:0 sc1
    v_accvgpr_read_b32 v20, a200
    v_accvgpr_read_b32 v21, a201
    v_accvgpr_read_b32 v22, a202
    v_accvgpr_read_b32 v23, a203
    v_accvgpr_read_b32 v24, a204
    v_accvgpr_read_b32 v25, a205
    v_accvgpr_read_b32 v26, a206
    v_accvgpr_read_b32 v27, a207
    v_pk_mul_f32 v[28:29], v[20:21], v[20:21]
    v_pk_mul_f32 v[30:31], v[22:23], v[22:23]
    v_pk_mul_f32 v[32:33], v[24:25], v[24:25]
    v_pk_mul_f32 v[34:35], v[26:27], v[26:27]
    v_pk_fma_f32 v[28:29], v[28:29], v[242:243], v[240:241]
    v_pk_fma_f32 v[30:31], v[30:31], v[242:243], v[240:241]
    v_pk_fma_f32 v[32:33], v[32:33], v[242:243], v[240:241]
    v_pk_fma_f32 v[34:35], v[34:35], v[242:243], v[240:241]
    v_pk_mul_f32 v[28:29], v[28:29], v[20:21]
    v_pk_mul_f32 v[30:31], v[30:31], v[22:23]
    v_pk_mul_f32 v[32:33], v[32:33], v[24:25]
    v_pk_mul_f32 v[34:35], v[34:35], v[26:27]
    v_exp_f32 v28, v28
    v_exp_f32 v29, v29
    v_exp_f32 v30, v30
    v_exp_f32 v31, v31
    v_exp_f32 v32, v32
    v_exp_f32 v33, v33
    v_exp_f32 v34, v34
    v_exp_f32 v35, v35
    v_pk_add_f32 v[28:29], v[28:29], v[244:245]
    v_pk_add_f32 v[30:31], v[30:31], v[244:245]
    v_pk_add_f32 v[32:33], v[32:33], v[244:245]
    v_pk_add_f32 v[34:35], v[34:35], v[244:245]
    v_rcp_f32 v28, v28
    v_rcp_f32 v29, v29
    v_rcp_f32 v30, v30
    v_rcp_f32 v31, v31
    v_rcp_f32 v32, v32
    v_rcp_f32 v33, v33
    v_rcp_f32 v34, v34
    v_rcp_f32 v35, v35
    v_pk_mul_f32 v[20:21], v[28:29], v[20:21]
    v_pk_mul_f32 v[22:23], v[30:31], v[22:23]
    v_pk_mul_f32 v[24:25], v[32:33], v[24:25]
    v_pk_mul_f32 v[26:27], v[34:35], v[26:27]
    v_cvt_pk_bf16_f32 v36, v20, v21
    v_cvt_pk_bf16_f32 v37, v22, v23
    v_cvt_pk_bf16_f32 v38, v24, v25
    v_cvt_pk_bf16_f32 v39, v26, v27
    buffer_store_dwordx4 v[36:39], v251, s[4:7], s53 offen offset:1024 sc1
    v_accvgpr_read_b32 v40, a208
    v_accvgpr_read_b32 v41, a209
    v_accvgpr_read_b32 v42, a210
    v_accvgpr_read_b32 v43, a211
    v_accvgpr_read_b32 v44, a212
    v_accvgpr_read_b32 v45, a213
    v_accvgpr_read_b32 v46, a214
    v_accvgpr_read_b32 v47, a215
    v_pk_mul_f32 v[48:49], v[40:41], v[40:41]
    v_pk_mul_f32 v[50:51], v[42:43], v[42:43]
    v_pk_mul_f32 v[52:53], v[44:45], v[44:45]
    v_pk_mul_f32 v[54:55], v[46:47], v[46:47]
    v_pk_fma_f32 v[48:49], v[48:49], v[242:243], v[240:241]
    v_pk_fma_f32 v[50:51], v[50:51], v[242:243], v[240:241]
    v_pk_fma_f32 v[52:53], v[52:53], v[242:243], v[240:241]
    v_pk_fma_f32 v[54:55], v[54:55], v[242:243], v[240:241]
    v_pk_mul_f32 v[48:49], v[48:49], v[40:41]
    v_pk_mul_f32 v[50:51], v[50:51], v[42:43]
    v_pk_mul_f32 v[52:53], v[52:53], v[44:45]
    v_pk_mul_f32 v[54:55], v[54:55], v[46:47]
    v_exp_f32 v48, v48
    v_exp_f32 v49, v49
    v_exp_f32 v50, v50
    v_exp_f32 v51, v51
    v_exp_f32 v52, v52
    v_exp_f32 v53, v53
    v_exp_f32 v54, v54
    v_exp_f32 v55, v55
    v_pk_add_f32 v[48:49], v[48:49], v[244:245]
    v_pk_add_f32 v[50:51], v[50:51], v[244:245]
    v_pk_add_f32 v[52:53], v[52:53], v[244:245]
    v_pk_add_f32 v[54:55], v[54:55], v[244:245]
    v_rcp_f32 v48, v48
    v_rcp_f32 v49, v49
    v_rcp_f32 v50, v50
    v_rcp_f32 v51, v51
    v_rcp_f32 v52, v52
    v_rcp_f32 v53, v53
    v_rcp_f32 v54, v54
    v_rcp_f32 v55, v55
    v_pk_mul_f32 v[40:41], v[48:49], v[40:41]
    v_pk_mul_f32 v[42:43], v[50:51], v[42:43]
    v_pk_mul_f32 v[44:45], v[52:53], v[44:45]
    v_pk_mul_f32 v[46:47], v[54:55], v[46:47]
    v_cvt_pk_bf16_f32 v56, v40, v41
    v_cvt_pk_bf16_f32 v57, v42, v43
    v_cvt_pk_bf16_f32 v58, v44, v45
    v_cvt_pk_bf16_f32 v59, v46, v47
    buffer_store_dwordx4 v[56:59], v251, s[4:7], s53 offen offset:2048 sc1
    v_accvgpr_read_b32 v0, a216
    v_accvgpr_read_b32 v1, a217
    v_accvgpr_read_b32 v2, a218
    v_accvgpr_read_b32 v3, a219
    v_accvgpr_read_b32 v4, a220
    v_accvgpr_read_b32 v5, a221
    v_accvgpr_read_b32 v6, a222
    v_accvgpr_read_b32 v7, a223
    v_pk_mul_f32 v[8:9], v[0:1], v[0:1]
    v_pk_mul_f32 v[10:11], v[2:3], v[2:3]
    v_pk_mul_f32 v[12:13], v[4:5], v[4:5]
    v_pk_mul_f32 v[14:15], v[6:7], v[6:7]
    v_pk_fma_f32 v[8:9], v[8:9], v[242:243], v[240:241]
    v_pk_fma_f32 v[10:11], v[10:11], v[242:243], v[240:241]
    v_pk_fma_f32 v[12:13], v[12:13], v[242:243], v[240:241]
    v_pk_fma_f32 v[14:15], v[14:15], v[242:243], v[240:241]
    v_pk_mul_f32 v[8:9], v[8:9], v[0:1]
    v_pk_mul_f32 v[10:11], v[10:11], v[2:3]
    v_pk_mul_f32 v[12:13], v[12:13], v[4:5]
    v_pk_mul_f32 v[14:15], v[14:15], v[6:7]
    v_exp_f32 v8, v8
    v_exp_f32 v9, v9
    v_exp_f32 v10, v10
    v_exp_f32 v11, v11
    v_exp_f32 v12, v12
    v_exp_f32 v13, v13
    v_exp_f32 v14, v14
    v_exp_f32 v15, v15
    v_pk_add_f32 v[8:9], v[8:9], v[244:245]
    v_pk_add_f32 v[10:11], v[10:11], v[244:245]
    v_pk_add_f32 v[12:13], v[12:13], v[244:245]
    v_pk_add_f32 v[14:15], v[14:15], v[244:245]
    v_rcp_f32 v8, v8
    v_rcp_f32 v9, v9
    v_rcp_f32 v10, v10
    v_rcp_f32 v11, v11
    v_rcp_f32 v12, v12
    v_rcp_f32 v13, v13
    v_rcp_f32 v14, v14
    v_rcp_f32 v15, v15
    v_pk_mul_f32 v[0:1], v[8:9], v[0:1]
    v_pk_mul_f32 v[2:3], v[10:11], v[2:3]
    v_pk_mul_f32 v[4:5], v[12:13], v[4:5]
    v_pk_mul_f32 v[6:7], v[14:15], v[6:7]
    v_cvt_pk_bf16_f32 v16, v0, v1
    v_cvt_pk_bf16_f32 v17, v2, v3
    v_cvt_pk_bf16_f32 v18, v4, v5
    v_cvt_pk_bf16_f32 v19, v6, v7
    buffer_store_dwordx4 v[16:19], v251, s[4:7], s53 offen offset:3072 sc1
    s_add_u32 s53, s53, s22
    v_accvgpr_read_b32 v20, a224
    v_accvgpr_read_b32 v21, a225
    v_accvgpr_read_b32 v22, a226
    v_accvgpr_read_b32 v23, a227
    v_accvgpr_read_b32 v24, a228
    v_accvgpr_read_b32 v25, a229
    v_accvgpr_read_b32 v26, a230
    v_accvgpr_read_b32 v27, a231
    v_pk_mul_f32 v[28:29], v[20:21], v[20:21]
    v_pk_mul_f32 v[30:31], v[22:23], v[22:23]
    v_pk_mul_f32 v[32:33], v[24:25], v[24:25]
    v_pk_mul_f32 v[34:35], v[26:27], v[26:27]
    v_pk_fma_f32 v[28:29], v[28:29], v[242:243], v[240:241]
    v_pk_fma_f32 v[30:31], v[30:31], v[242:243], v[240:241]
    v_pk_fma_f32 v[32:33], v[32:33], v[242:243], v[240:241]
    v_pk_fma_f32 v[34:35], v[34:35], v[242:243], v[240:241]
    v_pk_mul_f32 v[28:29], v[28:29], v[20:21]
    v_pk_mul_f32 v[30:31], v[30:31], v[22:23]
    v_pk_mul_f32 v[32:33], v[32:33], v[24:25]
    v_pk_mul_f32 v[34:35], v[34:35], v[26:27]
    v_exp_f32 v28, v28
    v_exp_f32 v29, v29
    v_exp_f32 v30, v30
    v_exp_f32 v31, v31
    v_exp_f32 v32, v32
    v_exp_f32 v33, v33
    v_exp_f32 v34, v34
    v_exp_f32 v35, v35
    v_pk_add_f32 v[28:29], v[28:29], v[244:245]
    v_pk_add_f32 v[30:31], v[30:31], v[244:245]
    v_pk_add_f32 v[32:33], v[32:33], v[244:245]
    v_pk_add_f32 v[34:35], v[34:35], v[244:245]
    v_rcp_f32 v28, v28
    v_rcp_f32 v29, v29
    v_rcp_f32 v30, v30
    v_rcp_f32 v31, v31
    v_rcp_f32 v32, v32
    v_rcp_f32 v33, v33
    v_rcp_f32 v34, v34
    v_rcp_f32 v35, v35
    v_pk_mul_f32 v[20:21], v[28:29], v[20:21]
    v_pk_mul_f32 v[22:23], v[30:31], v[22:23]
    v_pk_mul_f32 v[24:25], v[32:33], v[24:25]
    v_pk_mul_f32 v[26:27], v[34:35], v[26:27]
    v_cvt_pk_bf16_f32 v36, v20, v21
    v_cvt_pk_bf16_f32 v37, v22, v23
    v_cvt_pk_bf16_f32 v38, v24, v25
    v_cvt_pk_bf16_f32 v39, v26, v27
    buffer_store_dwordx4 v[36:39], v251, s[4:7], s53 offen offset:0 sc1
    v_accvgpr_read_b32 v40, a232
    v_accvgpr_read_b32 v41, a233
    v_accvgpr_read_b32 v42, a234
    v_accvgpr_read_b32 v43, a235
    v_accvgpr_read_b32 v44, a236
    v_accvgpr_read_b32 v45, a237
    v_accvgpr_read_b32 v46, a238
    v_accvgpr_read_b32 v47, a239
    v_pk_mul_f32 v[48:49], v[40:41], v[40:41]
    v_pk_mul_f32 v[50:51], v[42:43], v[42:43]
    v_pk_mul_f32 v[52:53], v[44:45], v[44:45]
    v_pk_mul_f32 v[54:55], v[46:47], v[46:47]
    v_pk_fma_f32 v[48:49], v[48:49], v[242:243], v[240:241]
    v_pk_fma_f32 v[50:51], v[50:51], v[242:243], v[240:241]
    v_pk_fma_f32 v[52:53], v[52:53], v[242:243], v[240:241]
    v_pk_fma_f32 v[54:55], v[54:55], v[242:243], v[240:241]
    v_pk_mul_f32 v[48:49], v[48:49], v[40:41]
    v_pk_mul_f32 v[50:51], v[50:51], v[42:43]
    v_pk_mul_f32 v[52:53], v[52:53], v[44:45]
    v_pk_mul_f32 v[54:55], v[54:55], v[46:47]
    v_exp_f32 v48, v48
    v_exp_f32 v49, v49
    v_exp_f32 v50, v50
    v_exp_f32 v51, v51
    v_exp_f32 v52, v52
    v_exp_f32 v53, v53
    v_exp_f32 v54, v54
    v_exp_f32 v55, v55
    v_pk_add_f32 v[48:49], v[48:49], v[244:245]
    v_pk_add_f32 v[50:51], v[50:51], v[244:245]
    v_pk_add_f32 v[52:53], v[52:53], v[244:245]
    v_pk_add_f32 v[54:55], v[54:55], v[244:245]
    v_rcp_f32 v48, v48
    v_rcp_f32 v49, v49
    v_rcp_f32 v50, v50
    v_rcp_f32 v51, v51
    v_rcp_f32 v52, v52
    v_rcp_f32 v53, v53
    v_rcp_f32 v54, v54
    v_rcp_f32 v55, v55
    v_pk_mul_f32 v[40:41], v[48:49], v[40:41]
    v_pk_mul_f32 v[42:43], v[50:51], v[42:43]
    v_pk_mul_f32 v[44:45], v[52:53], v[44:45]
    v_pk_mul_f32 v[46:47], v[54:55], v[46:47]
    v_cvt_pk_bf16_f32 v56, v40, v41
    v_cvt_pk_bf16_f32 v57, v42, v43
    v_cvt_pk_bf16_f32 v58, v44, v45
    v_cvt_pk_bf16_f32 v59, v46, v47
    buffer_store_dwordx4 v[56:59], v251, s[4:7], s53 offen offset:1024 sc1
    v_accvgpr_read_b32 v0, a240
    v_accvgpr_read_b32 v1, a241
    v_accvgpr_read_b32 v2, a242
    v_accvgpr_read_b32 v3, a243
    v_accvgpr_read_b32 v4, a244
    v_accvgpr_read_b32 v5, a245
    v_accvgpr_read_b32 v6, a246
    v_accvgpr_read_b32 v7, a247
    v_pk_mul_f32 v[8:9], v[0:1], v[0:1]
    v_pk_mul_f32 v[10:11], v[2:3], v[2:3]
    v_pk_mul_f32 v[12:13], v[4:5], v[4:5]
    v_pk_mul_f32 v[14:15], v[6:7], v[6:7]
    v_pk_fma_f32 v[8:9], v[8:9], v[242:243], v[240:241]
    v_pk_fma_f32 v[10:11], v[10:11], v[242:243], v[240:241]
    v_pk_fma_f32 v[12:13], v[12:13], v[242:243], v[240:241]
    v_pk_fma_f32 v[14:15], v[14:15], v[242:243], v[240:241]
    v_pk_mul_f32 v[8:9], v[8:9], v[0:1]
    v_pk_mul_f32 v[10:11], v[10:11], v[2:3]
    v_pk_mul_f32 v[12:13], v[12:13], v[4:5]
    v_pk_mul_f32 v[14:15], v[14:15], v[6:7]
    v_exp_f32 v8, v8
    v_exp_f32 v9, v9
    v_exp_f32 v10, v10
    v_exp_f32 v11, v11
    v_exp_f32 v12, v12
    v_exp_f32 v13, v13
    v_exp_f32 v14, v14
    v_exp_f32 v15, v15
    v_pk_add_f32 v[8:9], v[8:9], v[244:245]
    v_pk_add_f32 v[10:11], v[10:11], v[244:245]
    v_pk_add_f32 v[12:13], v[12:13], v[244:245]
    v_pk_add_f32 v[14:15], v[14:15], v[244:245]
    v_rcp_f32 v8, v8
    v_rcp_f32 v9, v9
    v_rcp_f32 v10, v10
    v_rcp_f32 v11, v11
    v_rcp_f32 v12, v12
    v_rcp_f32 v13, v13
    v_rcp_f32 v14, v14
    v_rcp_f32 v15, v15
    v_pk_mul_f32 v[0:1], v[8:9], v[0:1]
    v_pk_mul_f32 v[2:3], v[10:11], v[2:3]
    v_pk_mul_f32 v[4:5], v[12:13], v[4:5]
    v_pk_mul_f32 v[6:7], v[14:15], v[6:7]
    v_cvt_pk_bf16_f32 v16, v0, v1
    v_cvt_pk_bf16_f32 v17, v2, v3
    v_cvt_pk_bf16_f32 v18, v4, v5
    v_cvt_pk_bf16_f32 v19, v6, v7
    buffer_store_dwordx4 v[16:19], v251, s[4:7], s53 offen offset:2048 sc1
    v_accvgpr_read_b32 v20, a248
    v_accvgpr_read_b32 v21, a249
    v_accvgpr_read_b32 v22, a250
    v_accvgpr_read_b32 v23, a251
    v_accvgpr_read_b32 v24, a252
    v_accvgpr_read_b32 v25, a253
    v_accvgpr_read_b32 v26, a254
    v_accvgpr_read_b32 v27, a255
    v_pk_mul_f32 v[28:29], v[20:21], v[20:21]
    v_pk_mul_f32 v[30:31], v[22:23], v[22:23]
    v_pk_mul_f32 v[32:33], v[24:25], v[24:25]
    v_pk_mul_f32 v[34:35], v[26:27], v[26:27]
    v_pk_fma_f32 v[28:29], v[28:29], v[242:243], v[240:241]
    v_pk_fma_f32 v[30:31], v[30:31], v[242:243], v[240:241]
    v_pk_fma_f32 v[32:33], v[32:33], v[242:243], v[240:241]
    v_pk_fma_f32 v[34:35], v[34:35], v[242:243], v[240:241]
    v_pk_mul_f32 v[28:29], v[28:29], v[20:21]
    v_pk_mul_f32 v[30:31], v[30:31], v[22:23]
    v_pk_mul_f32 v[32:33], v[32:33], v[24:25]
    v_pk_mul_f32 v[34:35], v[34:35], v[26:27]
    v_exp_f32 v28, v28
    v_exp_f32 v29, v29
    v_exp_f32 v30, v30
    v_exp_f32 v31, v31
    v_exp_f32 v32, v32
    v_exp_f32 v33, v33
    v_exp_f32 v34, v34
    v_exp_f32 v35, v35
    v_pk_add_f32 v[28:29], v[28:29], v[244:245]
    v_pk_add_f32 v[30:31], v[30:31], v[244:245]
    v_pk_add_f32 v[32:33], v[32:33], v[244:245]
    v_pk_add_f32 v[34:35], v[34:35], v[244:245]
    v_rcp_f32 v28, v28
    v_rcp_f32 v29, v29
    v_rcp_f32 v30, v30
    v_rcp_f32 v31, v31
    v_rcp_f32 v32, v32
    v_rcp_f32 v33, v33
    v_rcp_f32 v34, v34
    v_rcp_f32 v35, v35
    v_pk_mul_f32 v[20:21], v[28:29], v[20:21]
    v_pk_mul_f32 v[22:23], v[30:31], v[22:23]
    v_pk_mul_f32 v[24:25], v[32:33], v[24:25]
    v_pk_mul_f32 v[26:27], v[34:35], v[26:27]
    v_cvt_pk_bf16_f32 v36, v20, v21
    v_cvt_pk_bf16_f32 v37, v22, v23
    v_cvt_pk_bf16_f32 v38, v24, v25
    v_cvt_pk_bf16_f32 v39, v26, v27
    buffer_store_dwordx4 v[36:39], v251, s[4:7], s53 offen offset:3072 sc1
    s_branch main_kernel_w_done
main_kernel_w_c2_gov:
    v_lshrrev_b32 v0, 4, v250
    v_bfe_u32 v1, v250, 2, 2
    v_lshl_add_u32 v4, v0, 2, v1
    v_and_b32 v5, 7, v4
    v_mul_u32_u24 v4, 512, v4
    v_and_b32 v6, 3, v250
    v_lshl_add_u32 v4, v6, 3, v4
    s_mul_i32 s32, s37, 8
    v_xor_b32 v5, s32, v5
    v_lshl_add_u32 v128, v5, 5, v4
    v_xor_b32 v129, 32, v128
    v_xor_b32 v130, 64, v128
    v_xor_b32 v131, 96, v128
    v_xor_b32 v132, 128, v128
    v_xor_b32 v133, 160, v128
    v_xor_b32 v134, 192, v128
    v_xor_b32 v135, 224, v128
    s_mul_i32 s32, s38, 8192
    s_add_u32 s32, s32, 65536
    v_add_u32 v136, s32, v251
    v_lshrrev_b32 v2, 5, v250
    v_and_b32 v3, 31, v250
    s_mul_i32 s32, s14, 8
    v_add_u32 v4, s32, v2
    v_add_u32 v5, 0, v4
    v_and_b32 v6, 7, v5
    v_lshlrev_b32 v6, 1, v6
    v_xor_b32 v6, v6, v3
    v_mul_lo_u32 v5, v5, s30
    v_lshl_add_u32 v5, v6, 4, v5
    v_subrev_u32 v137, 0, v5
    v_add_u32 v5, 2, v4
    v_and_b32 v6, 7, v5
    v_lshlrev_b32 v6, 1, v6
    v_xor_b32 v6, v6, v3
    v_mul_lo_u32 v5, v5, s30
    v_lshl_add_u32 v5, v6, 4, v5
    v_subrev_u32 v138, 1024, v5
    v_add_u32 v5, 4, v4
    v_and_b32 v6, 7, v5
    v_lshlrev_b32 v6, 1, v6
    v_xor_b32 v6, v6, v3
    v_mul_lo_u32 v5, v5, s30
    v_lshl_add_u32 v5, v6, 4, v5
    v_subrev_u32 v139, 2048, v5
    v_add_u32 v5, 6, v4
    v_and_b32 v6, 7, v5
    v_lshlrev_b32 v6, 1, v6
    v_xor_b32 v6, v6, v3
    v_mul_lo_u32 v5, v5, s30
    v_lshl_add_u32 v5, v6, 4, v5
    v_subrev_u32 v140, 3072, v5
    s_mul_i32 s32, s14, 4
    s_mul_i32 s32, s32, s31
    v_add_u32 v141, s32, v251
    s_add_u32 s32, s32, s31
    s_sub_u32 s32, s32, 1024
    v_add_u32 v142, s32, v251
    s_add_u32 s32, s32, s31
    s_sub_u32 s32, s32, 1024
    v_add_u32 v143, s32, v251
    s_add_u32 s32, s32, s31
    s_sub_u32 s32, s32, 1024
    v_add_u32 v144, s32, v251
    s_mul_i32 s19, s14, 4096
    s_mul_i32 s20, s14, 4096
    s_add_u32 s20, s20, 65536
    s_mul_i32 s17, s30, 32
    s_mov_b32 s15, 0
    s_add_u32 m0, s20, 0
    s_nop 0
    buffer_load_dwordx4 v141, s[4:7], s16 offen offset:0 sc1 lds
    buffer_load_dwordx4 v142, s[4:7], s16 offen offset:1024 sc1 lds
    buffer_load_dwordx4 v143, s[4:7], s16 offen offset:2048 sc1 lds
    buffer_load_dwordx4 v144, s[4:7], s16 offen offset:3072 sc1 lds
    s_add_u32 s16, s16, 1024
    s_add_u32 m0, s19, 0
    s_nop 0
    buffer_load_dwordx4 v137, s[8:11], s15 offen offset:0 lds
    buffer_load_dwordx4 v138, s[8:11], s15 offen offset:1024 lds
    buffer_load_dwordx4 v139, s[8:11], s15 offen offset:2048 lds
    buffer_load_dwordx4 v140, s[8:11], s15 offen offset:3072 lds
    s_add_u32 s15, s15, s17
    s_add_u32 m0, s20, 16384
    s_nop 0
    buffer_load_dwordx4 v141, s[4:7], s16 offen offset:0 sc1 lds
    buffer_load_dwordx4 v142, s[4:7], s16 offen offset:1024 sc1 lds
    buffer_load_dwordx4 v143, s[4:7], s16 offen offset:2048 sc1 lds
    buffer_load_dwordx4 v144, s[4:7], s16 offen offset:3072 sc1 lds
    s_add_u32 s16, s16, 1024
    s_add_u32 m0, s19, 16384
    s_nop 0
    buffer_load_dwordx4 v137, s[8:11], s15 offen offset:0 lds
    buffer_load_dwordx4 v138, s[8:11], s15 offen offset:1024 lds
    buffer_load_dwordx4 v139, s[8:11], s15 offen offset:2048 lds
    buffer_load_dwordx4 v140, s[8:11], s15 offen offset:3072 lds
    s_add_u32 s15, s15, s17
    s_add_u32 m0, s20, 32768
    s_nop 0
    buffer_load_dwordx4 v141, s[4:7], s16 offen offset:0 sc1 lds
    buffer_load_dwordx4 v142, s[4:7], s16 offen offset:1024 sc1 lds
    buffer_load_dwordx4 v143, s[4:7], s16 offen offset:2048 sc1 lds
    buffer_load_dwordx4 v144, s[4:7], s16 offen offset:3072 sc1 lds
    s_add_u32 s16, s16, 1024
    s_add_u32 m0, s19, 32768
    s_nop 0
    buffer_load_dwordx4 v137, s[8:11], s15 offen offset:0 lds
    buffer_load_dwordx4 v138, s[8:11], s15 offen offset:1024 lds
    buffer_load_dwordx4 v139, s[8:11], s15 offen offset:2048 lds
    buffer_load_dwordx4 v140, s[8:11], s15 offen offset:3072 lds
    s_add_u32 s15, s15, s17
    s_add_u32 m0, s20, 49152
    s_nop 0
    buffer_load_dwordx4 v141, s[4:7], s16 offen offset:0 sc1 lds
    buffer_load_dwordx4 v142, s[4:7], s16 offen offset:1024 sc1 lds
    buffer_load_dwordx4 v143, s[4:7], s16 offen offset:2048 sc1 lds
    buffer_load_dwordx4 v144, s[4:7], s16 offen offset:3072 sc1 lds
    s_add_u32 s16, s16, 1024
    s_add_u32 m0, s19, 49152
    s_nop 0
    buffer_load_dwordx4 v137, s[8:11], s15 offen offset:0 lds
    buffer_load_dwordx4 v138, s[8:11], s15 offen offset:1024 lds
    buffer_load_dwordx4 v139, s[8:11], s15 offen offset:2048 lds
    buffer_load_dwordx4 v140, s[8:11], s15 offen offset:3072 lds
    s_add_u32 s15, s15, s17
    v_accvgpr_write_b32 a0, 0
    v_accvgpr_write_b32 a1, 0
    v_accvgpr_write_b32 a2, 0
    v_accvgpr_write_b32 a3, 0
    v_accvgpr_write_b32 a4, 0
    v_accvgpr_write_b32 a5, 0
    v_accvgpr_write_b32 a6, 0
    v_accvgpr_write_b32 a7, 0
    v_accvgpr_write_b32 a8, 0
    v_accvgpr_write_b32 a9, 0
    v_accvgpr_write_b32 a10, 0
    v_accvgpr_write_b32 a11, 0
    v_accvgpr_write_b32 a12, 0
    v_accvgpr_write_b32 a13, 0
    v_accvgpr_write_b32 a14, 0
    v_accvgpr_write_b32 a15, 0
    v_accvgpr_write_b32 a16, 0
    v_accvgpr_write_b32 a17, 0
    v_accvgpr_write_b32 a18, 0
    v_accvgpr_write_b32 a19, 0
    v_accvgpr_write_b32 a20, 0
    v_accvgpr_write_b32 a21, 0
    v_accvgpr_write_b32 a22, 0
    v_accvgpr_write_b32 a23, 0
    v_accvgpr_write_b32 a24, 0
    v_accvgpr_write_b32 a25, 0
    v_accvgpr_write_b32 a26, 0
    v_accvgpr_write_b32 a27, 0
    v_accvgpr_write_b32 a28, 0
    v_accvgpr_write_b32 a29, 0
    v_accvgpr_write_b32 a30, 0
    v_accvgpr_write_b32 a31, 0
    v_accvgpr_write_b32 a32, 0
    v_accvgpr_write_b32 a33, 0
    v_accvgpr_write_b32 a34, 0
    v_accvgpr_write_b32 a35, 0
    v_accvgpr_write_b32 a36, 0
    v_accvgpr_write_b32 a37, 0
    v_accvgpr_write_b32 a38, 0
    v_accvgpr_write_b32 a39, 0
    v_accvgpr_write_b32 a40, 0
    v_accvgpr_write_b32 a41, 0
    v_accvgpr_write_b32 a42, 0
    v_accvgpr_write_b32 a43, 0
    v_accvgpr_write_b32 a44, 0
    v_accvgpr_write_b32 a45, 0
    v_accvgpr_write_b32 a46, 0
    v_accvgpr_write_b32 a47, 0
    v_accvgpr_write_b32 a48, 0
    v_accvgpr_write_b32 a49, 0
    v_accvgpr_write_b32 a50, 0
    v_accvgpr_write_b32 a51, 0
    v_accvgpr_write_b32 a52, 0
    v_accvgpr_write_b32 a53, 0
    v_accvgpr_write_b32 a54, 0
    v_accvgpr_write_b32 a55, 0
    v_accvgpr_write_b32 a56, 0
    v_accvgpr_write_b32 a57, 0
    v_accvgpr_write_b32 a58, 0
    v_accvgpr_write_b32 a59, 0
    v_accvgpr_write_b32 a60, 0
    v_accvgpr_write_b32 a61, 0
    v_accvgpr_write_b32 a62, 0
    v_accvgpr_write_b32 a63, 0
    v_accvgpr_write_b32 a64, 0
    v_accvgpr_write_b32 a65, 0
    v_accvgpr_write_b32 a66, 0
    v_accvgpr_write_b32 a67, 0
    v_accvgpr_write_b32 a68, 0
    v_accvgpr_write_b32 a69, 0
    v_accvgpr_write_b32 a70, 0
    v_accvgpr_write_b32 a71, 0
    v_accvgpr_write_b32 a72, 0
    v_accvgpr_write_b32 a73, 0
    v_accvgpr_write_b32 a74, 0
    v_accvgpr_write_b32 a75, 0
    v_accvgpr_write_b32 a76, 0
    v_accvgpr_write_b32 a77, 0
    v_accvgpr_write_b32 a78, 0
    v_accvgpr_write_b32 a79, 0
    v_accvgpr_write_b32 a80, 0
    v_accvgpr_write_b32 a81, 0
    v_accvgpr_write_b32 a82, 0
    v_accvgpr_write_b32 a83, 0
    v_accvgpr_write_b32 a84, 0
    v_accvgpr_write_b32 a85, 0
    v_accvgpr_write_b32 a86, 0
    v_accvgpr_write_b32 a87, 0
    v_accvgpr_write_b32 a88, 0
    v_accvgpr_write_b32 a89, 0
    v_accvgpr_write_b32 a90, 0
    v_accvgpr_write_b32 a91, 0
    v_accvgpr_write_b32 a92, 0
    v_accvgpr_write_b32 a93, 0
    v_accvgpr_write_b32 a94, 0
    v_accvgpr_write_b32 a95, 0
    v_accvgpr_write_b32 a96, 0
    v_accvgpr_write_b32 a97, 0
    v_accvgpr_write_b32 a98, 0
    v_accvgpr_write_b32 a99, 0
    v_accvgpr_write_b32 a100, 0
    v_accvgpr_write_b32 a101, 0
    v_accvgpr_write_b32 a102, 0
    v_accvgpr_write_b32 a103, 0
    v_accvgpr_write_b32 a104, 0
    v_accvgpr_write_b32 a105, 0
    v_accvgpr_write_b32 a106, 0
    v_accvgpr_write_b32 a107, 0
    v_accvgpr_write_b32 a108, 0
    v_accvgpr_write_b32 a109, 0
    v_accvgpr_write_b32 a110, 0
    v_accvgpr_write_b32 a111, 0
    v_accvgpr_write_b32 a112, 0
    v_accvgpr_write_b32 a113, 0
    v_accvgpr_write_b32 a114, 0
    v_accvgpr_write_b32 a115, 0
    v_accvgpr_write_b32 a116, 0
    v_accvgpr_write_b32 a117, 0
    v_accvgpr_write_b32 a118, 0
    v_accvgpr_write_b32 a119, 0
    v_accvgpr_write_b32 a120, 0
    v_accvgpr_write_b32 a121, 0
    v_accvgpr_write_b32 a122, 0
    v_accvgpr_write_b32 a123, 0
    v_accvgpr_write_b32 a124, 0
    v_accvgpr_write_b32 a125, 0
    v_accvgpr_write_b32 a126, 0
    v_accvgpr_write_b32 a127, 0
    v_accvgpr_write_b32 a128, 0
    v_accvgpr_write_b32 a129, 0
    v_accvgpr_write_b32 a130, 0
    v_accvgpr_write_b32 a131, 0
    v_accvgpr_write_b32 a132, 0
    v_accvgpr_write_b32 a133, 0
    v_accvgpr_write_b32 a134, 0
    v_accvgpr_write_b32 a135, 0
    v_accvgpr_write_b32 a136, 0
    v_accvgpr_write_b32 a137, 0
    v_accvgpr_write_b32 a138, 0
    v_accvgpr_write_b32 a139, 0
    v_accvgpr_write_b32 a140, 0
    v_accvgpr_write_b32 a141, 0
    v_accvgpr_write_b32 a142, 0
    v_accvgpr_write_b32 a143, 0
    v_accvgpr_write_b32 a144, 0
    v_accvgpr_write_b32 a145, 0
    v_accvgpr_write_b32 a146, 0
    v_accvgpr_write_b32 a147, 0
    v_accvgpr_write_b32 a148, 0
    v_accvgpr_write_b32 a149, 0
    v_accvgpr_write_b32 a150, 0
    v_accvgpr_write_b32 a151, 0
    v_accvgpr_write_b32 a152, 0
    v_accvgpr_write_b32 a153, 0
    v_accvgpr_write_b32 a154, 0
    v_accvgpr_write_b32 a155, 0
    v_accvgpr_write_b32 a156, 0
    v_accvgpr_write_b32 a157, 0
    v_accvgpr_write_b32 a158, 0
    v_accvgpr_write_b32 a159, 0
    v_accvgpr_write_b32 a160, 0
    v_accvgpr_write_b32 a161, 0
    v_accvgpr_write_b32 a162, 0
    v_accvgpr_write_b32 a163, 0
    v_accvgpr_write_b32 a164, 0
    v_accvgpr_write_b32 a165, 0
    v_accvgpr_write_b32 a166, 0
    v_accvgpr_write_b32 a167, 0
    v_accvgpr_write_b32 a168, 0
    v_accvgpr_write_b32 a169, 0
    v_accvgpr_write_b32 a170, 0
    v_accvgpr_write_b32 a171, 0
    v_accvgpr_write_b32 a172, 0
    v_accvgpr_write_b32 a173, 0
    v_accvgpr_write_b32 a174, 0
    v_accvgpr_write_b32 a175, 0
    v_accvgpr_write_b32 a176, 0
    v_accvgpr_write_b32 a177, 0
    v_accvgpr_write_b32 a178, 0
    v_accvgpr_write_b32 a179, 0
    v_accvgpr_write_b32 a180, 0
    v_accvgpr_write_b32 a181, 0
    v_accvgpr_write_b32 a182, 0
    v_accvgpr_write_b32 a183, 0
    v_accvgpr_write_b32 a184, 0
    v_accvgpr_write_b32 a185, 0
    v_accvgpr_write_b32 a186, 0
    v_accvgpr_write_b32 a187, 0
    v_accvgpr_write_b32 a188, 0
    v_accvgpr_write_b32 a189, 0
    v_accvgpr_write_b32 a190, 0
    v_accvgpr_write_b32 a191, 0
    v_accvgpr_write_b32 a192, 0
    v_accvgpr_write_b32 a193, 0
    v_accvgpr_write_b32 a194, 0
    v_accvgpr_write_b32 a195, 0
    v_accvgpr_write_b32 a196, 0
    v_accvgpr_write_b32 a197, 0
    v_accvgpr_write_b32 a198, 0
    v_accvgpr_write_b32 a199, 0
    v_accvgpr_write_b32 a200, 0
    v_accvgpr_write_b32 a201, 0
    v_accvgpr_write_b32 a202, 0
    v_accvgpr_write_b32 a203, 0
    v_accvgpr_write_b32 a204, 0
    v_accvgpr_write_b32 a205, 0
    v_accvgpr_write_b32 a206, 0
    v_accvgpr_write_b32 a207, 0
    v_accvgpr_write_b32 a208, 0
    v_accvgpr_write_b32 a209, 0
    v_accvgpr_write_b32 a210, 0
    v_accvgpr_write_b32 a211, 0
    v_accvgpr_write_b32 a212, 0
    v_accvgpr_write_b32 a213, 0
    v_accvgpr_write_b32 a214, 0
    v_accvgpr_write_b32 a215, 0
    v_accvgpr_write_b32 a216, 0
    v_accvgpr_write_b32 a217, 0
    v_accvgpr_write_b32 a218, 0
    v_accvgpr_write_b32 a219, 0
    v_accvgpr_write_b32 a220, 0
    v_accvgpr_write_b32 a221, 0
    v_accvgpr_write_b32 a222, 0
    v_accvgpr_write_b32 a223, 0
    v_accvgpr_write_b32 a224, 0
    v_accvgpr_write_b32 a225, 0
    v_accvgpr_write_b32 a226, 0
    v_accvgpr_write_b32 a227, 0
    v_accvgpr_write_b32 a228, 0
    v_accvgpr_write_b32 a229, 0
    v_accvgpr_write_b32 a230, 0
    v_accvgpr_write_b32 a231, 0
    v_accvgpr_write_b32 a232, 0
    v_accvgpr_write_b32 a233, 0
    v_accvgpr_write_b32 a234, 0
    v_accvgpr_write_b32 a235, 0
    v_accvgpr_write_b32 a236, 0
    v_accvgpr_write_b32 a237, 0
    v_accvgpr_write_b32 a238, 0
    v_accvgpr_write_b32 a239, 0
    v_accvgpr_write_b32 a240, 0
    v_accvgpr_write_b32 a241, 0
    v_accvgpr_write_b32 a242, 0
    v_accvgpr_write_b32 a243, 0
    v_accvgpr_write_b32 a244, 0
    v_accvgpr_write_b32 a245, 0
    v_accvgpr_write_b32 a246, 0
    v_accvgpr_write_b32 a247, 0
    v_accvgpr_write_b32 a248, 0
    v_accvgpr_write_b32 a249, 0
    v_accvgpr_write_b32 a250, 0
    v_accvgpr_write_b32 a251, 0
    v_accvgpr_write_b32 a252, 0
    v_accvgpr_write_b32 a253, 0
    v_accvgpr_write_b32 a254, 0
    v_accvgpr_write_b32 a255, 0
    s_waitcnt vmcnt(24)
    s_barrier
    ds_read_b128 v[32:35], v136 offset:0
    ds_read_b64_tr_b16 v[0:1], v128 offset:0
    ds_read_b64_tr_b16 v[2:3], v128 offset:8192
    ds_read_b64_tr_b16 v[4:5], v129 offset:0
    ds_read_b64_tr_b16 v[6:7], v129 offset:8192
    ds_read_b64_tr_b16 v[8:9], v130 offset:0
    ds_read_b64_tr_b16 v[10:11], v130 offset:8192
    ds_read_b64_tr_b16 v[12:13], v131 offset:0
    ds_read_b64_tr_b16 v[14:15], v131 offset:8192
    ds_read_b64_tr_b16 v[16:17], v132 offset:0
    ds_read_b64_tr_b16 v[18:19], v132 offset:8192
    ds_read_b64_tr_b16 v[20:21], v133 offset:0
    ds_read_b64_tr_b16 v[22:23], v133 offset:8192
    ds_read_b64_tr_b16 v[24:25], v134 offset:0
    ds_read_b64_tr_b16 v[26:27], v134 offset:8192
    ds_read_b64_tr_b16 v[28:29], v135 offset:0
    ds_read_b64_tr_b16 v[30:31], v135 offset:8192
    ds_read_b128 v[36:39], v136 offset:1024
    ds_read_b128 v[40:43], v136 offset:2048
    ds_read_b128 v[44:47], v136 offset:3072
    ds_read_b128 v[48:51], v136 offset:4096
    ds_read_b128 v[52:55], v136 offset:5120
    ds_read_b128 v[56:59], v136 offset:6144
    ds_read_b128 v[60:63], v136 offset:7168
main_kernel_w_c2_v_loop:
    s_waitcnt lgkmcnt(0)
    v_mfma_f32_16x16x32_bf16 a[0:3], v[32:35], v[0:3], a[0:3]
    s_waitcnt vmcnt(16)
    s_barrier
    ds_read_b128 v[96:99], v136 offset:16384
    s_add_u32 m0, s20, 0
    s_nop 0
    v_mfma_f32_16x16x32_bf16 a[4:7], v[32:35], v[4:7], a[4:7]
    ds_read_b64_tr_b16 v[64:65], v128 offset:16384
    v_mfma_f32_16x16x32_bf16 a[8:11], v[32:35], v[8:11], a[8:11]
    ds_read_b64_tr_b16 v[66:67], v128 offset:24576
    v_mfma_f32_16x16x32_bf16 a[12:15], v[32:35], v[12:15], a[12:15]
    ds_read_b64_tr_b16 v[68:69], v129 offset:16384
    v_mfma_f32_16x16x32_bf16 a[16:19], v[32:35], v[16:19], a[16:19]
    ds_read_b64_tr_b16 v[70:71], v129 offset:24576
    v_mfma_f32_16x16x32_bf16 a[20:23], v[32:35], v[20:23], a[20:23]
    ds_read_b64_tr_b16 v[72:73], v130 offset:16384
    buffer_load_dwordx4 v141, s[4:7], s16 offen offset:0 sc1 lds
    v_mfma_f32_16x16x32_bf16 a[24:27], v[32:35], v[24:27], a[24:27]
    ds_read_b64_tr_b16 v[74:75], v130 offset:24576
    v_mfma_f32_16x16x32_bf16 a[28:31], v[32:35], v[28:31], a[28:31]
    ds_read_b64_tr_b16 v[76:77], v131 offset:16384
    v_mfma_f32_16x16x32_bf16 a[32:35], v[36:39], v[0:3], a[32:35]
    ds_read_b64_tr_b16 v[78:79], v131 offset:24576
    v_mfma_f32_16x16x32_bf16 a[36:39], v[36:39], v[4:7], a[36:39]
    ds_read_b64_tr_b16 v[80:81], v132 offset:16384
    v_mfma_f32_16x16x32_bf16 a[40:43], v[36:39], v[8:11], a[40:43]
    ds_read_b64_tr_b16 v[82:83], v132 offset:24576
    buffer_load_dwordx4 v142, s[4:7], s16 offen offset:1024 sc1 lds
    v_mfma_f32_16x16x32_bf16 a[44:47], v[36:39], v[12:15], a[44:47]
    ds_read_b64_tr_b16 v[84:85], v133 offset:16384
    v_mfma_f32_16x16x32_bf16 a[48:51], v[36:39], v[16:19], a[48:51]
    ds_read_b64_tr_b16 v[86:87], v133 offset:24576
    v_mfma_f32_16x16x32_bf16 a[52:55], v[36:39], v[20:23], a[52:55]
    ds_read_b64_tr_b16 v[88:89], v134 offset:16384
    v_mfma_f32_16x16x32_bf16 a[56:59], v[36:39], v[24:27], a[56:59]
    ds_read_b64_tr_b16 v[90:91], v134 offset:24576
    v_mfma_f32_16x16x32_bf16 a[60:63], v[36:39], v[28:31], a[60:63]
    ds_read_b64_tr_b16 v[92:93], v135 offset:16384
    buffer_load_dwordx4 v143, s[4:7], s16 offen offset:2048 sc1 lds
    v_mfma_f32_16x16x32_bf16 a[64:67], v[40:43], v[0:3], a[64:67]
    ds_read_b64_tr_b16 v[94:95], v135 offset:24576
    v_mfma_f32_16x16x32_bf16 a[68:71], v[40:43], v[4:7], a[68:71]
    ds_read_b128 v[100:103], v136 offset:17408
    v_mfma_f32_16x16x32_bf16 a[72:75], v[40:43], v[8:11], a[72:75]
    ds_read_b128 v[104:107], v136 offset:18432
    v_mfma_f32_16x16x32_bf16 a[76:79], v[40:43], v[12:15], a[76:79]
    ds_read_b128 v[108:111], v136 offset:19456
    v_mfma_f32_16x16x32_bf16 a[80:83], v[40:43], v[16:19], a[80:83]
    ds_read_b128 v[112:115], v136 offset:20480
    v_mfma_f32_16x16x32_bf16 a[84:87], v[40:43], v[20:23], a[84:87]
    ds_read_b128 v[116:119], v136 offset:21504
    buffer_load_dwordx4 v144, s[4:7], s16 offen offset:3072 sc1 lds
    v_mfma_f32_16x16x32_bf16 a[88:91], v[40:43], v[24:27], a[88:91]
    ds_read_b128 v[120:123], v136 offset:22528
    v_mfma_f32_16x16x32_bf16 a[92:95], v[40:43], v[28:31], a[92:95]
    ds_read_b128 v[124:127], v136 offset:23552
    v_mfma_f32_16x16x32_bf16 a[96:99], v[44:47], v[0:3], a[96:99]
    v_mfma_f32_16x16x32_bf16 a[100:103], v[44:47], v[4:7], a[100:103]
    v_mfma_f32_16x16x32_bf16 a[104:107], v[44:47], v[8:11], a[104:107]
    s_add_u32 s16, s16, 1024
    v_mfma_f32_16x16x32_bf16 a[108:111], v[44:47], v[12:15], a[108:111]
    v_mfma_f32_16x16x32_bf16 a[112:115], v[44:47], v[16:19], a[112:115]
    v_mfma_f32_16x16x32_bf16 a[116:119], v[44:47], v[20:23], a[116:119]
    v_mfma_f32_16x16x32_bf16 a[120:123], v[44:47], v[24:27], a[120:123]
    v_mfma_f32_16x16x32_bf16 a[124:127], v[44:47], v[28:31], a[124:127]
    s_add_u32 m0, s19, 0
    s_nop 0
    v_mfma_f32_16x16x32_bf16 a[128:131], v[48:51], v[0:3], a[128:131]
    v_mfma_f32_16x16x32_bf16 a[132:135], v[48:51], v[4:7], a[132:135]
    v_mfma_f32_16x16x32_bf16 a[136:139], v[48:51], v[8:11], a[136:139]
    v_mfma_f32_16x16x32_bf16 a[140:143], v[48:51], v[12:15], a[140:143]
    v_mfma_f32_16x16x32_bf16 a[144:147], v[48:51], v[16:19], a[144:147]
    buffer_load_dwordx4 v137, s[8:11], s15 offen offset:0 lds
    v_mfma_f32_16x16x32_bf16 a[148:151], v[48:51], v[20:23], a[148:151]
    v_mfma_f32_16x16x32_bf16 a[152:155], v[48:51], v[24:27], a[152:155]
    v_mfma_f32_16x16x32_bf16 a[156:159], v[48:51], v[28:31], a[156:159]
    v_mfma_f32_16x16x32_bf16 a[160:163], v[52:55], v[0:3], a[160:163]
    v_mfma_f32_16x16x32_bf16 a[164:167], v[52:55], v[4:7], a[164:167]
    v_mfma_f32_16x16x32_bf16 a[168:171], v[52:55], v[8:11], a[168:171]
    buffer_load_dwordx4 v138, s[8:11], s15 offen offset:1024 lds
    v_mfma_f32_16x16x32_bf16 a[172:175], v[52:55], v[12:15], a[172:175]
    v_mfma_f32_16x16x32_bf16 a[176:179], v[52:55], v[16:19], a[176:179]
    v_mfma_f32_16x16x32_bf16 a[180:183], v[52:55], v[20:23], a[180:183]
    v_mfma_f32_16x16x32_bf16 a[184:187], v[52:55], v[24:27], a[184:187]
    v_mfma_f32_16x16x32_bf16 a[188:191], v[52:55], v[28:31], a[188:191]
    buffer_load_dwordx4 v139, s[8:11], s15 offen offset:2048 lds
    v_mfma_f32_16x16x32_bf16 a[192:195], v[56:59], v[0:3], a[192:195]
    v_mfma_f32_16x16x32_bf16 a[196:199], v[56:59], v[4:7], a[196:199]
    v_mfma_f32_16x16x32_bf16 a[200:203], v[56:59], v[8:11], a[200:203]
    v_mfma_f32_16x16x32_bf16 a[204:207], v[56:59], v[12:15], a[204:207]
    v_mfma_f32_16x16x32_bf16 a[208:211], v[56:59], v[16:19], a[208:211]
    buffer_load_dwordx4 v140, s[8:11], s15 offen offset:3072 lds
    v_mfma_f32_16x16x32_bf16 a[212:215], v[56:59], v[20:23], a[212:215]
    v_mfma_f32_16x16x32_bf16 a[216:219], v[56:59], v[24:27], a[216:219]
    v_mfma_f32_16x16x32_bf16 a[220:223], v[56:59], v[28:31], a[220:223]
    v_mfma_f32_16x16x32_bf16 a[224:227], v[60:63], v[0:3], a[224:227]
    v_mfma_f32_16x16x32_bf16 a[228:231], v[60:63], v[4:7], a[228:231]
    s_add_u32 s15, s15, s17
    v_mfma_f32_16x16x32_bf16 a[232:235], v[60:63], v[8:11], a[232:235]
    v_mfma_f32_16x16x32_bf16 a[236:239], v[60:63], v[12:15], a[236:239]
    v_mfma_f32_16x16x32_bf16 a[240:243], v[60:63], v[16:19], a[240:243]
    v_mfma_f32_16x16x32_bf16 a[244:247], v[60:63], v[20:23], a[244:247]
    v_mfma_f32_16x16x32_bf16 a[248:251], v[60:63], v[24:27], a[248:251]
    v_mfma_f32_16x16x32_bf16 a[252:255], v[60:63], v[28:31], a[252:255]
    s_waitcnt lgkmcnt(0)
    v_mfma_f32_16x16x32_bf16 a[0:3], v[96:99], v[64:67], a[0:3]
    s_waitcnt vmcnt(16)
    s_barrier
    ds_read_b128 v[32:35], v136 offset:32768
    s_add_u32 m0, s20, 16384
    s_nop 0
    v_mfma_f32_16x16x32_bf16 a[4:7], v[96:99], v[68:71], a[4:7]
    ds_read_b64_tr_b16 v[0:1], v128 offset:32768
    v_mfma_f32_16x16x32_bf16 a[8:11], v[96:99], v[72:75], a[8:11]
    ds_read_b64_tr_b16 v[2:3], v128 offset:40960
    v_mfma_f32_16x16x32_bf16 a[12:15], v[96:99], v[76:79], a[12:15]
    ds_read_b64_tr_b16 v[4:5], v129 offset:32768
    v_mfma_f32_16x16x32_bf16 a[16:19], v[96:99], v[80:83], a[16:19]
    ds_read_b64_tr_b16 v[6:7], v129 offset:40960
    v_mfma_f32_16x16x32_bf16 a[20:23], v[96:99], v[84:87], a[20:23]
    ds_read_b64_tr_b16 v[8:9], v130 offset:32768
    buffer_load_dwordx4 v141, s[4:7], s16 offen offset:0 sc1 lds
    v_mfma_f32_16x16x32_bf16 a[24:27], v[96:99], v[88:91], a[24:27]
    ds_read_b64_tr_b16 v[10:11], v130 offset:40960
    v_mfma_f32_16x16x32_bf16 a[28:31], v[96:99], v[92:95], a[28:31]
    ds_read_b64_tr_b16 v[12:13], v131 offset:32768
    v_mfma_f32_16x16x32_bf16 a[32:35], v[100:103], v[64:67], a[32:35]
    ds_read_b64_tr_b16 v[14:15], v131 offset:40960
    v_mfma_f32_16x16x32_bf16 a[36:39], v[100:103], v[68:71], a[36:39]
    ds_read_b64_tr_b16 v[16:17], v132 offset:32768
    v_mfma_f32_16x16x32_bf16 a[40:43], v[100:103], v[72:75], a[40:43]
    ds_read_b64_tr_b16 v[18:19], v132 offset:40960
    buffer_load_dwordx4 v142, s[4:7], s16 offen offset:1024 sc1 lds
    v_mfma_f32_16x16x32_bf16 a[44:47], v[100:103], v[76:79], a[44:47]
    ds_read_b64_tr_b16 v[20:21], v133 offset:32768
    v_mfma_f32_16x16x32_bf16 a[48:51], v[100:103], v[80:83], a[48:51]
    ds_read_b64_tr_b16 v[22:23], v133 offset:40960
    v_mfma_f32_16x16x32_bf16 a[52:55], v[100:103], v[84:87], a[52:55]
    ds_read_b64_tr_b16 v[24:25], v134 offset:32768
    v_mfma_f32_16x16x32_bf16 a[56:59], v[100:103], v[88:91], a[56:59]
    ds_read_b64_tr_b16 v[26:27], v134 offset:40960
    v_mfma_f32_16x16x32_bf16 a[60:63], v[100:103], v[92:95], a[60:63]
    ds_read_b64_tr_b16 v[28:29], v135 offset:32768
    buffer_load_dwordx4 v143, s[4:7], s16 offen offset:2048 sc1 lds
    v_mfma_f32_16x16x32_bf16 a[64:67], v[104:107], v[64:67], a[64:67]
    ds_read_b64_tr_b16 v[30:31], v135 offset:40960
    v_mfma_f32_16x16x32_bf16 a[68:71], v[104:107], v[68:71], a[68:71]
    ds_read_b128 v[36:39], v136 offset:33792
    v_mfma_f32_16x16x32_bf16 a[72:75], v[104:107], v[72:75], a[72:75]
    ds_read_b128 v[40:43], v136 offset:34816
    v_mfma_f32_16x16x32_bf16 a[76:79], v[104:107], v[76:79], a[76:79]
    ds_read_b128 v[44:47], v136 offset:35840
    v_mfma_f32_16x16x32_bf16 a[80:83], v[104:107], v[80:83], a[80:83]
    ds_read_b128 v[48:51], v136 offset:36864
    v_mfma_f32_16x16x32_bf16 a[84:87], v[104:107], v[84:87], a[84:87]
    ds_read_b128 v[52:55], v136 offset:37888
    buffer_load_dwordx4 v144, s[4:7], s16 offen offset:3072 sc1 lds
    v_mfma_f32_16x16x32_bf16 a[88:91], v[104:107], v[88:91], a[88:91]
    ds_read_b128 v[56:59], v136 offset:38912
    v_mfma_f32_16x16x32_bf16 a[92:95], v[104:107], v[92:95], a[92:95]
    ds_read_b128 v[60:63], v136 offset:39936
    v_mfma_f32_16x16x32_bf16 a[96:99], v[108:111], v[64:67], a[96:99]
    v_mfma_f32_16x16x32_bf16 a[100:103], v[108:111], v[68:71], a[100:103]
    v_mfma_f32_16x16x32_bf16 a[104:107], v[108:111], v[72:75], a[104:107]
    s_add_u32 s16, s16, 1024
    v_mfma_f32_16x16x32_bf16 a[108:111], v[108:111], v[76:79], a[108:111]
    v_mfma_f32_16x16x32_bf16 a[112:115], v[108:111], v[80:83], a[112:115]
    v_mfma_f32_16x16x32_bf16 a[116:119], v[108:111], v[84:87], a[116:119]
    v_mfma_f32_16x16x32_bf16 a[120:123], v[108:111], v[88:91], a[120:123]
    v_mfma_f32_16x16x32_bf16 a[124:127], v[108:111], v[92:95], a[124:127]
    s_add_u32 m0, s19, 16384
    s_nop 0
    v_mfma_f32_16x16x32_bf16 a[128:131], v[112:115], v[64:67], a[128:131]
    v_mfma_f32_16x16x32_bf16 a[132:135], v[112:115], v[68:71], a[132:135]
    v_mfma_f32_16x16x32_bf16 a[136:139], v[112:115], v[72:75], a[136:139]
    v_mfma_f32_16x16x32_bf16 a[140:143], v[112:115], v[76:79], a[140:143]
    v_mfma_f32_16x16x32_bf16 a[144:147], v[112:115], v[80:83], a[144:147]
    buffer_load_dwordx4 v137, s[8:11], s15 offen offset:0 lds
    v_mfma_f32_16x16x32_bf16 a[148:151], v[112:115], v[84:87], a[148:151]
    v_mfma_f32_16x16x32_bf16 a[152:155], v[112:115], v[88:91], a[152:155]
    v_mfma_f32_16x16x32_bf16 a[156:159], v[112:115], v[92:95], a[156:159]
    v_mfma_f32_16x16x32_bf16 a[160:163], v[116:119], v[64:67], a[160:163]
    v_mfma_f32_16x16x32_bf16 a[164:167], v[116:119], v[68:71], a[164:167]
    v_mfma_f32_16x16x32_bf16 a[168:171], v[116:119], v[72:75], a[168:171]
    buffer_load_dwordx4 v138, s[8:11], s15 offen offset:1024 lds
    v_mfma_f32_16x16x32_bf16 a[172:175], v[116:119], v[76:79], a[172:175]
    v_mfma_f32_16x16x32_bf16 a[176:179], v[116:119], v[80:83], a[176:179]
    v_mfma_f32_16x16x32_bf16 a[180:183], v[116:119], v[84:87], a[180:183]
    v_mfma_f32_16x16x32_bf16 a[184:187], v[116:119], v[88:91], a[184:187]
    v_mfma_f32_16x16x32_bf16 a[188:191], v[116:119], v[92:95], a[188:191]
    buffer_load_dwordx4 v139, s[8:11], s15 offen offset:2048 lds
    v_mfma_f32_16x16x32_bf16 a[192:195], v[120:123], v[64:67], a[192:195]
    v_mfma_f32_16x16x32_bf16 a[196:199], v[120:123], v[68:71], a[196:199]
    v_mfma_f32_16x16x32_bf16 a[200:203], v[120:123], v[72:75], a[200:203]
    v_mfma_f32_16x16x32_bf16 a[204:207], v[120:123], v[76:79], a[204:207]
    v_mfma_f32_16x16x32_bf16 a[208:211], v[120:123], v[80:83], a[208:211]
    buffer_load_dwordx4 v140, s[8:11], s15 offen offset:3072 lds
    v_mfma_f32_16x16x32_bf16 a[212:215], v[120:123], v[84:87], a[212:215]
    v_mfma_f32_16x16x32_bf16 a[216:219], v[120:123], v[88:91], a[216:219]
    v_mfma_f32_16x16x32_bf16 a[220:223], v[120:123], v[92:95], a[220:223]
    v_mfma_f32_16x16x32_bf16 a[224:227], v[124:127], v[64:67], a[224:227]
    v_mfma_f32_16x16x32_bf16 a[228:231], v[124:127], v[68:71], a[228:231]
    s_add_u32 s15, s15, s17
    v_mfma_f32_16x16x32_bf16 a[232:235], v[124:127], v[72:75], a[232:235]
    v_mfma_f32_16x16x32_bf16 a[236:239], v[124:127], v[76:79], a[236:239]
    v_mfma_f32_16x16x32_bf16 a[240:243], v[124:127], v[80:83], a[240:243]
    v_mfma_f32_16x16x32_bf16 a[244:247], v[124:127], v[84:87], a[244:247]
    v_mfma_f32_16x16x32_bf16 a[248:251], v[124:127], v[88:91], a[248:251]
    v_mfma_f32_16x16x32_bf16 a[252:255], v[124:127], v[92:95], a[252:255]
    s_waitcnt lgkmcnt(0)
    v_mfma_f32_16x16x32_bf16 a[0:3], v[32:35], v[0:3], a[0:3]
    s_waitcnt vmcnt(16)
    s_barrier
    ds_read_b128 v[96:99], v136 offset:49152
    s_add_u32 m0, s20, 32768
    s_nop 0
    v_mfma_f32_16x16x32_bf16 a[4:7], v[32:35], v[4:7], a[4:7]
    ds_read_b64_tr_b16 v[64:65], v128 offset:49152
    v_mfma_f32_16x16x32_bf16 a[8:11], v[32:35], v[8:11], a[8:11]
    ds_read_b64_tr_b16 v[66:67], v128 offset:57344
    v_mfma_f32_16x16x32_bf16 a[12:15], v[32:35], v[12:15], a[12:15]
    ds_read_b64_tr_b16 v[68:69], v129 offset:49152
    v_mfma_f32_16x16x32_bf16 a[16:19], v[32:35], v[16:19], a[16:19]
    ds_read_b64_tr_b16 v[70:71], v129 offset:57344
    v_mfma_f32_16x16x32_bf16 a[20:23], v[32:35], v[20:23], a[20:23]
    ds_read_b64_tr_b16 v[72:73], v130 offset:49152
    buffer_load_dwordx4 v141, s[4:7], s16 offen offset:0 sc1 lds
    v_mfma_f32_16x16x32_bf16 a[24:27], v[32:35], v[24:27], a[24:27]
    ds_read_b64_tr_b16 v[74:75], v130 offset:57344
    v_mfma_f32_16x16x32_bf16 a[28:31], v[32:35], v[28:31], a[28:31]
    ds_read_b64_tr_b16 v[76:77], v131 offset:49152
    v_mfma_f32_16x16x32_bf16 a[32:35], v[36:39], v[0:3], a[32:35]
    ds_read_b64_tr_b16 v[78:79], v131 offset:57344
    v_mfma_f32_16x16x32_bf16 a[36:39], v[36:39], v[4:7], a[36:39]
    ds_read_b64_tr_b16 v[80:81], v132 offset:49152
    v_mfma_f32_16x16x32_bf16 a[40:43], v[36:39], v[8:11], a[40:43]
    ds_read_b64_tr_b16 v[82:83], v132 offset:57344
    buffer_load_dwordx4 v142, s[4:7], s16 offen offset:1024 sc1 lds
    v_mfma_f32_16x16x32_bf16 a[44:47], v[36:39], v[12:15], a[44:47]
    ds_read_b64_tr_b16 v[84:85], v133 offset:49152
    v_mfma_f32_16x16x32_bf16 a[48:51], v[36:39], v[16:19], a[48:51]
    ds_read_b64_tr_b16 v[86:87], v133 offset:57344
    v_mfma_f32_16x16x32_bf16 a[52:55], v[36:39], v[20:23], a[52:55]
    ds_read_b64_tr_b16 v[88:89], v134 offset:49152
    v_mfma_f32_16x16x32_bf16 a[56:59], v[36:39], v[24:27], a[56:59]
    ds_read_b64_tr_b16 v[90:91], v134 offset:57344
    v_mfma_f32_16x16x32_bf16 a[60:63], v[36:39], v[28:31], a[60:63]
    ds_read_b64_tr_b16 v[92:93], v135 offset:49152
    buffer_load_dwordx4 v143, s[4:7], s16 offen offset:2048 sc1 lds
    v_mfma_f32_16x16x32_bf16 a[64:67], v[40:43], v[0:3], a[64:67]
    ds_read_b64_tr_b16 v[94:95], v135 offset:57344
    v_mfma_f32_16x16x32_bf16 a[68:71], v[40:43], v[4:7], a[68:71]
    ds_read_b128 v[100:103], v136 offset:50176
    v_mfma_f32_16x16x32_bf16 a[72:75], v[40:43], v[8:11], a[72:75]
    ds_read_b128 v[104:107], v136 offset:51200
    v_mfma_f32_16x16x32_bf16 a[76:79], v[40:43], v[12:15], a[76:79]
    ds_read_b128 v[108:111], v136 offset:52224
    v_mfma_f32_16x16x32_bf16 a[80:83], v[40:43], v[16:19], a[80:83]
    ds_read_b128 v[112:115], v136 offset:53248
    v_mfma_f32_16x16x32_bf16 a[84:87], v[40:43], v[20:23], a[84:87]
    ds_read_b128 v[116:119], v136 offset:54272
    buffer_load_dwordx4 v144, s[4:7], s16 offen offset:3072 sc1 lds
    v_mfma_f32_16x16x32_bf16 a[88:91], v[40:43], v[24:27], a[88:91]
    ds_read_b128 v[120:123], v136 offset:55296
    v_mfma_f32_16x16x32_bf16 a[92:95], v[40:43], v[28:31], a[92:95]
    ds_read_b128 v[124:127], v136 offset:56320
    v_mfma_f32_16x16x32_bf16 a[96:99], v[44:47], v[0:3], a[96:99]
    v_mfma_f32_16x16x32_bf16 a[100:103], v[44:47], v[4:7], a[100:103]
    v_mfma_f32_16x16x32_bf16 a[104:107], v[44:47], v[8:11], a[104:107]
    s_add_u32 s16, s16, 1024
    v_mfma_f32_16x16x32_bf16 a[108:111], v[44:47], v[12:15], a[108:111]
    v_mfma_f32_16x16x32_bf16 a[112:115], v[44:47], v[16:19], a[112:115]
    v_mfma_f32_16x16x32_bf16 a[116:119], v[44:47], v[20:23], a[116:119]
    v_mfma_f32_16x16x32_bf16 a[120:123], v[44:47], v[24:27], a[120:123]
    v_mfma_f32_16x16x32_bf16 a[124:127], v[44:47], v[28:31], a[124:127]
    s_add_u32 m0, s19, 32768
    s_nop 0
    v_mfma_f32_16x16x32_bf16 a[128:131], v[48:51], v[0:3], a[128:131]
    v_mfma_f32_16x16x32_bf16 a[132:135], v[48:51], v[4:7], a[132:135]
    v_mfma_f32_16x16x32_bf16 a[136:139], v[48:51], v[8:11], a[136:139]
    v_mfma_f32_16x16x32_bf16 a[140:143], v[48:51], v[12:15], a[140:143]
    v_mfma_f32_16x16x32_bf16 a[144:147], v[48:51], v[16:19], a[144:147]
    buffer_load_dwordx4 v137, s[8:11], s15 offen offset:0 lds
    v_mfma_f32_16x16x32_bf16 a[148:151], v[48:51], v[20:23], a[148:151]
    v_mfma_f32_16x16x32_bf16 a[152:155], v[48:51], v[24:27], a[152:155]
    v_mfma_f32_16x16x32_bf16 a[156:159], v[48:51], v[28:31], a[156:159]
    v_mfma_f32_16x16x32_bf16 a[160:163], v[52:55], v[0:3], a[160:163]
    v_mfma_f32_16x16x32_bf16 a[164:167], v[52:55], v[4:7], a[164:167]
    v_mfma_f32_16x16x32_bf16 a[168:171], v[52:55], v[8:11], a[168:171]
    buffer_load_dwordx4 v138, s[8:11], s15 offen offset:1024 lds
    v_mfma_f32_16x16x32_bf16 a[172:175], v[52:55], v[12:15], a[172:175]
    v_mfma_f32_16x16x32_bf16 a[176:179], v[52:55], v[16:19], a[176:179]
    v_mfma_f32_16x16x32_bf16 a[180:183], v[52:55], v[20:23], a[180:183]
    v_mfma_f32_16x16x32_bf16 a[184:187], v[52:55], v[24:27], a[184:187]
    v_mfma_f32_16x16x32_bf16 a[188:191], v[52:55], v[28:31], a[188:191]
    buffer_load_dwordx4 v139, s[8:11], s15 offen offset:2048 lds
    v_mfma_f32_16x16x32_bf16 a[192:195], v[56:59], v[0:3], a[192:195]
    v_mfma_f32_16x16x32_bf16 a[196:199], v[56:59], v[4:7], a[196:199]
    v_mfma_f32_16x16x32_bf16 a[200:203], v[56:59], v[8:11], a[200:203]
    v_mfma_f32_16x16x32_bf16 a[204:207], v[56:59], v[12:15], a[204:207]
    v_mfma_f32_16x16x32_bf16 a[208:211], v[56:59], v[16:19], a[208:211]
    buffer_load_dwordx4 v140, s[8:11], s15 offen offset:3072 lds
    v_mfma_f32_16x16x32_bf16 a[212:215], v[56:59], v[20:23], a[212:215]
    v_mfma_f32_16x16x32_bf16 a[216:219], v[56:59], v[24:27], a[216:219]
    v_mfma_f32_16x16x32_bf16 a[220:223], v[56:59], v[28:31], a[220:223]
    v_mfma_f32_16x16x32_bf16 a[224:227], v[60:63], v[0:3], a[224:227]
    v_mfma_f32_16x16x32_bf16 a[228:231], v[60:63], v[4:7], a[228:231]
    s_add_u32 s15, s15, s17
    v_mfma_f32_16x16x32_bf16 a[232:235], v[60:63], v[8:11], a[232:235]
    v_mfma_f32_16x16x32_bf16 a[236:239], v[60:63], v[12:15], a[236:239]
    v_mfma_f32_16x16x32_bf16 a[240:243], v[60:63], v[16:19], a[240:243]
    v_mfma_f32_16x16x32_bf16 a[244:247], v[60:63], v[20:23], a[244:247]
    v_mfma_f32_16x16x32_bf16 a[248:251], v[60:63], v[24:27], a[248:251]
    v_mfma_f32_16x16x32_bf16 a[252:255], v[60:63], v[28:31], a[252:255]
    s_waitcnt lgkmcnt(0)
    v_mfma_f32_16x16x32_bf16 a[0:3], v[96:99], v[64:67], a[0:3]
    s_waitcnt vmcnt(16)
    s_barrier
    ds_read_b128 v[32:35], v136 offset:0
    s_add_u32 m0, s20, 49152
    s_nop 0
    v_mfma_f32_16x16x32_bf16 a[4:7], v[96:99], v[68:71], a[4:7]
    ds_read_b64_tr_b16 v[0:1], v128 offset:0
    v_mfma_f32_16x16x32_bf16 a[8:11], v[96:99], v[72:75], a[8:11]
    ds_read_b64_tr_b16 v[2:3], v128 offset:8192
    v_mfma_f32_16x16x32_bf16 a[12:15], v[96:99], v[76:79], a[12:15]
    ds_read_b64_tr_b16 v[4:5], v129 offset:0
    v_mfma_f32_16x16x32_bf16 a[16:19], v[96:99], v[80:83], a[16:19]
    ds_read_b64_tr_b16 v[6:7], v129 offset:8192
    v_mfma_f32_16x16x32_bf16 a[20:23], v[96:99], v[84:87], a[20:23]
    ds_read_b64_tr_b16 v[8:9], v130 offset:0
    buffer_load_dwordx4 v141, s[4:7], s16 offen offset:0 sc1 lds
    v_mfma_f32_16x16x32_bf16 a[24:27], v[96:99], v[88:91], a[24:27]
    ds_read_b64_tr_b16 v[10:11], v130 offset:8192
    v_mfma_f32_16x16x32_bf16 a[28:31], v[96:99], v[92:95], a[28:31]
    ds_read_b64_tr_b16 v[12:13], v131 offset:0
    v_mfma_f32_16x16x32_bf16 a[32:35], v[100:103], v[64:67], a[32:35]
    ds_read_b64_tr_b16 v[14:15], v131 offset:8192
    v_mfma_f32_16x16x32_bf16 a[36:39], v[100:103], v[68:71], a[36:39]
    ds_read_b64_tr_b16 v[16:17], v132 offset:0
    v_mfma_f32_16x16x32_bf16 a[40:43], v[100:103], v[72:75], a[40:43]
    ds_read_b64_tr_b16 v[18:19], v132 offset:8192
    buffer_load_dwordx4 v142, s[4:7], s16 offen offset:1024 sc1 lds
    v_mfma_f32_16x16x32_bf16 a[44:47], v[100:103], v[76:79], a[44:47]
    ds_read_b64_tr_b16 v[20:21], v133 offset:0
    v_mfma_f32_16x16x32_bf16 a[48:51], v[100:103], v[80:83], a[48:51]
    ds_read_b64_tr_b16 v[22:23], v133 offset:8192
    v_mfma_f32_16x16x32_bf16 a[52:55], v[100:103], v[84:87], a[52:55]
    ds_read_b64_tr_b16 v[24:25], v134 offset:0
    v_mfma_f32_16x16x32_bf16 a[56:59], v[100:103], v[88:91], a[56:59]
    ds_read_b64_tr_b16 v[26:27], v134 offset:8192
    v_mfma_f32_16x16x32_bf16 a[60:63], v[100:103], v[92:95], a[60:63]
    ds_read_b64_tr_b16 v[28:29], v135 offset:0
    buffer_load_dwordx4 v143, s[4:7], s16 offen offset:2048 sc1 lds
    v_mfma_f32_16x16x32_bf16 a[64:67], v[104:107], v[64:67], a[64:67]
    ds_read_b64_tr_b16 v[30:31], v135 offset:8192
    v_mfma_f32_16x16x32_bf16 a[68:71], v[104:107], v[68:71], a[68:71]
    ds_read_b128 v[36:39], v136 offset:1024
    v_mfma_f32_16x16x32_bf16 a[72:75], v[104:107], v[72:75], a[72:75]
    ds_read_b128 v[40:43], v136 offset:2048
    v_mfma_f32_16x16x32_bf16 a[76:79], v[104:107], v[76:79], a[76:79]
    ds_read_b128 v[44:47], v136 offset:3072
    v_mfma_f32_16x16x32_bf16 a[80:83], v[104:107], v[80:83], a[80:83]
    ds_read_b128 v[48:51], v136 offset:4096
    v_mfma_f32_16x16x32_bf16 a[84:87], v[104:107], v[84:87], a[84:87]
    ds_read_b128 v[52:55], v136 offset:5120
    buffer_load_dwordx4 v144, s[4:7], s16 offen offset:3072 sc1 lds
    v_mfma_f32_16x16x32_bf16 a[88:91], v[104:107], v[88:91], a[88:91]
    ds_read_b128 v[56:59], v136 offset:6144
    v_mfma_f32_16x16x32_bf16 a[92:95], v[104:107], v[92:95], a[92:95]
    ds_read_b128 v[60:63], v136 offset:7168
    v_mfma_f32_16x16x32_bf16 a[96:99], v[108:111], v[64:67], a[96:99]
    v_mfma_f32_16x16x32_bf16 a[100:103], v[108:111], v[68:71], a[100:103]
    v_mfma_f32_16x16x32_bf16 a[104:107], v[108:111], v[72:75], a[104:107]
    s_add_u32 s16, s16, 1024
    v_mfma_f32_16x16x32_bf16 a[108:111], v[108:111], v[76:79], a[108:111]
    v_mfma_f32_16x16x32_bf16 a[112:115], v[108:111], v[80:83], a[112:115]
    v_mfma_f32_16x16x32_bf16 a[116:119], v[108:111], v[84:87], a[116:119]
    v_mfma_f32_16x16x32_bf16 a[120:123], v[108:111], v[88:91], a[120:123]
    v_mfma_f32_16x16x32_bf16 a[124:127], v[108:111], v[92:95], a[124:127]
    s_add_u32 m0, s19, 49152
    s_nop 0
    v_mfma_f32_16x16x32_bf16 a[128:131], v[112:115], v[64:67], a[128:131]
    v_mfma_f32_16x16x32_bf16 a[132:135], v[112:115], v[68:71], a[132:135]
    v_mfma_f32_16x16x32_bf16 a[136:139], v[112:115], v[72:75], a[136:139]
    v_mfma_f32_16x16x32_bf16 a[140:143], v[112:115], v[76:79], a[140:143]
    v_mfma_f32_16x16x32_bf16 a[144:147], v[112:115], v[80:83], a[144:147]
    buffer_load_dwordx4 v137, s[8:11], s15 offen offset:0 lds
    v_mfma_f32_16x16x32_bf16 a[148:151], v[112:115], v[84:87], a[148:151]
    v_mfma_f32_16x16x32_bf16 a[152:155], v[112:115], v[88:91], a[152:155]
    v_mfma_f32_16x16x32_bf16 a[156:159], v[112:115], v[92:95], a[156:159]
    v_mfma_f32_16x16x32_bf16 a[160:163], v[116:119], v[64:67], a[160:163]
    v_mfma_f32_16x16x32_bf16 a[164:167], v[116:119], v[68:71], a[164:167]
    v_mfma_f32_16x16x32_bf16 a[168:171], v[116:119], v[72:75], a[168:171]
    buffer_load_dwordx4 v138, s[8:11], s15 offen offset:1024 lds
    v_mfma_f32_16x16x32_bf16 a[172:175], v[116:119], v[76:79], a[172:175]
    v_mfma_f32_16x16x32_bf16 a[176:179], v[116:119], v[80:83], a[176:179]
    v_mfma_f32_16x16x32_bf16 a[180:183], v[116:119], v[84:87], a[180:183]
    v_mfma_f32_16x16x32_bf16 a[184:187], v[116:119], v[88:91], a[184:187]
    v_mfma_f32_16x16x32_bf16 a[188:191], v[116:119], v[92:95], a[188:191]
    buffer_load_dwordx4 v139, s[8:11], s15 offen offset:2048 lds
    v_mfma_f32_16x16x32_bf16 a[192:195], v[120:123], v[64:67], a[192:195]
    v_mfma_f32_16x16x32_bf16 a[196:199], v[120:123], v[68:71], a[196:199]
    v_mfma_f32_16x16x32_bf16 a[200:203], v[120:123], v[72:75], a[200:203]
    v_mfma_f32_16x16x32_bf16 a[204:207], v[120:123], v[76:79], a[204:207]
    v_mfma_f32_16x16x32_bf16 a[208:211], v[120:123], v[80:83], a[208:211]
    buffer_load_dwordx4 v140, s[8:11], s15 offen offset:3072 lds
    v_mfma_f32_16x16x32_bf16 a[212:215], v[120:123], v[84:87], a[212:215]
    v_mfma_f32_16x16x32_bf16 a[216:219], v[120:123], v[88:91], a[216:219]
    v_mfma_f32_16x16x32_bf16 a[220:223], v[120:123], v[92:95], a[220:223]
    v_mfma_f32_16x16x32_bf16 a[224:227], v[124:127], v[64:67], a[224:227]
    v_mfma_f32_16x16x32_bf16 a[228:231], v[124:127], v[68:71], a[228:231]
    s_add_u32 s15, s15, s17
    v_mfma_f32_16x16x32_bf16 a[232:235], v[124:127], v[72:75], a[232:235]
    v_mfma_f32_16x16x32_bf16 a[236:239], v[124:127], v[76:79], a[236:239]
    v_mfma_f32_16x16x32_bf16 a[240:243], v[124:127], v[80:83], a[240:243]
    v_mfma_f32_16x16x32_bf16 a[244:247], v[124:127], v[84:87], a[244:247]
    v_mfma_f32_16x16x32_bf16 a[248:251], v[124:127], v[88:91], a[248:251]
    v_mfma_f32_16x16x32_bf16 a[252:255], v[124:127], v[92:95], a[252:255]
    s_sub_u32 s18, s18, 1
    s_cmp_lg_u32 s18, 0
    s_cbranch_scc1 main_kernel_w_c2_v_loop
    s_cmp_lg_u32 s14, 0
    s_cbranch_scc1 main_kernel_w_c2_v_nt
    s_lshl_b32 s32, s27, 8
    s_add_u32 s32, s32, 0x841e000
    v_mov_b32 v255, 1
    s_mov_b64 exec, 1
    buffer_atomic_add v255, off, s[4:7], s32 sc0 sc1
    s_mov_b64 exec, -1
main_kernel_w_c2_v_nt:
    s_waitcnt lgkmcnt(0)
    v_mfma_f32_16x16x32_bf16 a[0:3], v[32:35], v[0:3], a[0:3]
    s_waitcnt vmcnt(16)
    s_barrier
    ds_read_b128 v[96:99], v136 offset:16384
    v_mfma_f32_16x16x32_bf16 a[4:7], v[32:35], v[4:7], a[4:7]
    ds_read_b64_tr_b16 v[64:65], v128 offset:16384
    v_mfma_f32_16x16x32_bf16 a[8:11], v[32:35], v[8:11], a[8:11]
    ds_read_b64_tr_b16 v[66:67], v128 offset:24576
    v_mfma_f32_16x16x32_bf16 a[12:15], v[32:35], v[12:15], a[12:15]
    ds_read_b64_tr_b16 v[68:69], v129 offset:16384
    v_mfma_f32_16x16x32_bf16 a[16:19], v[32:35], v[16:19], a[16:19]
    ds_read_b64_tr_b16 v[70:71], v129 offset:24576
    v_mfma_f32_16x16x32_bf16 a[20:23], v[32:35], v[20:23], a[20:23]
    ds_read_b64_tr_b16 v[72:73], v130 offset:16384
    v_mfma_f32_16x16x32_bf16 a[24:27], v[32:35], v[24:27], a[24:27]
    ds_read_b64_tr_b16 v[74:75], v130 offset:24576
    v_mfma_f32_16x16x32_bf16 a[28:31], v[32:35], v[28:31], a[28:31]
    ds_read_b64_tr_b16 v[76:77], v131 offset:16384
    v_mfma_f32_16x16x32_bf16 a[32:35], v[36:39], v[0:3], a[32:35]
    ds_read_b64_tr_b16 v[78:79], v131 offset:24576
    v_mfma_f32_16x16x32_bf16 a[36:39], v[36:39], v[4:7], a[36:39]
    ds_read_b64_tr_b16 v[80:81], v132 offset:16384
    v_mfma_f32_16x16x32_bf16 a[40:43], v[36:39], v[8:11], a[40:43]
    ds_read_b64_tr_b16 v[82:83], v132 offset:24576
    v_mfma_f32_16x16x32_bf16 a[44:47], v[36:39], v[12:15], a[44:47]
    ds_read_b64_tr_b16 v[84:85], v133 offset:16384
    v_mfma_f32_16x16x32_bf16 a[48:51], v[36:39], v[16:19], a[48:51]
    ds_read_b64_tr_b16 v[86:87], v133 offset:24576
    v_mfma_f32_16x16x32_bf16 a[52:55], v[36:39], v[20:23], a[52:55]
    ds_read_b64_tr_b16 v[88:89], v134 offset:16384
    v_mfma_f32_16x16x32_bf16 a[56:59], v[36:39], v[24:27], a[56:59]
    ds_read_b64_tr_b16 v[90:91], v134 offset:24576
    v_mfma_f32_16x16x32_bf16 a[60:63], v[36:39], v[28:31], a[60:63]
    ds_read_b64_tr_b16 v[92:93], v135 offset:16384
    v_mfma_f32_16x16x32_bf16 a[64:67], v[40:43], v[0:3], a[64:67]
    ds_read_b64_tr_b16 v[94:95], v135 offset:24576
    v_mfma_f32_16x16x32_bf16 a[68:71], v[40:43], v[4:7], a[68:71]
    ds_read_b128 v[100:103], v136 offset:17408
    v_mfma_f32_16x16x32_bf16 a[72:75], v[40:43], v[8:11], a[72:75]
    ds_read_b128 v[104:107], v136 offset:18432
    v_mfma_f32_16x16x32_bf16 a[76:79], v[40:43], v[12:15], a[76:79]
    ds_read_b128 v[108:111], v136 offset:19456
    v_mfma_f32_16x16x32_bf16 a[80:83], v[40:43], v[16:19], a[80:83]
    ds_read_b128 v[112:115], v136 offset:20480
    v_mfma_f32_16x16x32_bf16 a[84:87], v[40:43], v[20:23], a[84:87]
    ds_read_b128 v[116:119], v136 offset:21504
    v_mfma_f32_16x16x32_bf16 a[88:91], v[40:43], v[24:27], a[88:91]
    ds_read_b128 v[120:123], v136 offset:22528
    v_mfma_f32_16x16x32_bf16 a[92:95], v[40:43], v[28:31], a[92:95]
    ds_read_b128 v[124:127], v136 offset:23552
    v_mfma_f32_16x16x32_bf16 a[96:99], v[44:47], v[0:3], a[96:99]
    v_mfma_f32_16x16x32_bf16 a[100:103], v[44:47], v[4:7], a[100:103]
    v_mfma_f32_16x16x32_bf16 a[104:107], v[44:47], v[8:11], a[104:107]
    v_mfma_f32_16x16x32_bf16 a[108:111], v[44:47], v[12:15], a[108:111]
    v_mfma_f32_16x16x32_bf16 a[112:115], v[44:47], v[16:19], a[112:115]
    v_mfma_f32_16x16x32_bf16 a[116:119], v[44:47], v[20:23], a[116:119]
    v_mfma_f32_16x16x32_bf16 a[120:123], v[44:47], v[24:27], a[120:123]
    v_mfma_f32_16x16x32_bf16 a[124:127], v[44:47], v[28:31], a[124:127]
    v_mfma_f32_16x16x32_bf16 a[128:131], v[48:51], v[0:3], a[128:131]
    v_mfma_f32_16x16x32_bf16 a[132:135], v[48:51], v[4:7], a[132:135]
    v_mfma_f32_16x16x32_bf16 a[136:139], v[48:51], v[8:11], a[136:139]
    v_mfma_f32_16x16x32_bf16 a[140:143], v[48:51], v[12:15], a[140:143]
    v_mfma_f32_16x16x32_bf16 a[144:147], v[48:51], v[16:19], a[144:147]
    v_mfma_f32_16x16x32_bf16 a[148:151], v[48:51], v[20:23], a[148:151]
    v_mfma_f32_16x16x32_bf16 a[152:155], v[48:51], v[24:27], a[152:155]
    v_mfma_f32_16x16x32_bf16 a[156:159], v[48:51], v[28:31], a[156:159]
    v_mfma_f32_16x16x32_bf16 a[160:163], v[52:55], v[0:3], a[160:163]
    v_mfma_f32_16x16x32_bf16 a[164:167], v[52:55], v[4:7], a[164:167]
    v_mfma_f32_16x16x32_bf16 a[168:171], v[52:55], v[8:11], a[168:171]
    v_mfma_f32_16x16x32_bf16 a[172:175], v[52:55], v[12:15], a[172:175]
    v_mfma_f32_16x16x32_bf16 a[176:179], v[52:55], v[16:19], a[176:179]
    v_mfma_f32_16x16x32_bf16 a[180:183], v[52:55], v[20:23], a[180:183]
    v_mfma_f32_16x16x32_bf16 a[184:187], v[52:55], v[24:27], a[184:187]
    v_mfma_f32_16x16x32_bf16 a[188:191], v[52:55], v[28:31], a[188:191]
    v_mfma_f32_16x16x32_bf16 a[192:195], v[56:59], v[0:3], a[192:195]
    v_mfma_f32_16x16x32_bf16 a[196:199], v[56:59], v[4:7], a[196:199]
    v_mfma_f32_16x16x32_bf16 a[200:203], v[56:59], v[8:11], a[200:203]
    v_mfma_f32_16x16x32_bf16 a[204:207], v[56:59], v[12:15], a[204:207]
    v_mfma_f32_16x16x32_bf16 a[208:211], v[56:59], v[16:19], a[208:211]
    v_mfma_f32_16x16x32_bf16 a[212:215], v[56:59], v[20:23], a[212:215]
    v_mfma_f32_16x16x32_bf16 a[216:219], v[56:59], v[24:27], a[216:219]
    v_mfma_f32_16x16x32_bf16 a[220:223], v[56:59], v[28:31], a[220:223]
    v_mfma_f32_16x16x32_bf16 a[224:227], v[60:63], v[0:3], a[224:227]
    v_mfma_f32_16x16x32_bf16 a[228:231], v[60:63], v[4:7], a[228:231]
    v_mfma_f32_16x16x32_bf16 a[232:235], v[60:63], v[8:11], a[232:235]
    v_mfma_f32_16x16x32_bf16 a[236:239], v[60:63], v[12:15], a[236:239]
    v_mfma_f32_16x16x32_bf16 a[240:243], v[60:63], v[16:19], a[240:243]
    v_mfma_f32_16x16x32_bf16 a[244:247], v[60:63], v[20:23], a[244:247]
    v_mfma_f32_16x16x32_bf16 a[248:251], v[60:63], v[24:27], a[248:251]
    v_mfma_f32_16x16x32_bf16 a[252:255], v[60:63], v[28:31], a[252:255]
    s_waitcnt lgkmcnt(0)
    v_mfma_f32_16x16x32_bf16 a[0:3], v[96:99], v[64:67], a[0:3]
    s_waitcnt vmcnt(8)
    s_barrier
    ds_read_b128 v[32:35], v136 offset:32768
    v_mfma_f32_16x16x32_bf16 a[4:7], v[96:99], v[68:71], a[4:7]
    ds_read_b64_tr_b16 v[0:1], v128 offset:32768
    v_mfma_f32_16x16x32_bf16 a[8:11], v[96:99], v[72:75], a[8:11]
    ds_read_b64_tr_b16 v[2:3], v128 offset:40960
    v_mfma_f32_16x16x32_bf16 a[12:15], v[96:99], v[76:79], a[12:15]
    ds_read_b64_tr_b16 v[4:5], v129 offset:32768
    v_mfma_f32_16x16x32_bf16 a[16:19], v[96:99], v[80:83], a[16:19]
    ds_read_b64_tr_b16 v[6:7], v129 offset:40960
    v_mfma_f32_16x16x32_bf16 a[20:23], v[96:99], v[84:87], a[20:23]
    ds_read_b64_tr_b16 v[8:9], v130 offset:32768
    v_mfma_f32_16x16x32_bf16 a[24:27], v[96:99], v[88:91], a[24:27]
    ds_read_b64_tr_b16 v[10:11], v130 offset:40960
    v_mfma_f32_16x16x32_bf16 a[28:31], v[96:99], v[92:95], a[28:31]
    ds_read_b64_tr_b16 v[12:13], v131 offset:32768
    v_mfma_f32_16x16x32_bf16 a[32:35], v[100:103], v[64:67], a[32:35]
    ds_read_b64_tr_b16 v[14:15], v131 offset:40960
    v_mfma_f32_16x16x32_bf16 a[36:39], v[100:103], v[68:71], a[36:39]
    ds_read_b64_tr_b16 v[16:17], v132 offset:32768
    v_mfma_f32_16x16x32_bf16 a[40:43], v[100:103], v[72:75], a[40:43]
    ds_read_b64_tr_b16 v[18:19], v132 offset:40960
    v_mfma_f32_16x16x32_bf16 a[44:47], v[100:103], v[76:79], a[44:47]
    ds_read_b64_tr_b16 v[20:21], v133 offset:32768
    v_mfma_f32_16x16x32_bf16 a[48:51], v[100:103], v[80:83], a[48:51]
    ds_read_b64_tr_b16 v[22:23], v133 offset:40960
    v_mfma_f32_16x16x32_bf16 a[52:55], v[100:103], v[84:87], a[52:55]
    ds_read_b64_tr_b16 v[24:25], v134 offset:32768
    v_mfma_f32_16x16x32_bf16 a[56:59], v[100:103], v[88:91], a[56:59]
    ds_read_b64_tr_b16 v[26:27], v134 offset:40960
    v_mfma_f32_16x16x32_bf16 a[60:63], v[100:103], v[92:95], a[60:63]
    ds_read_b64_tr_b16 v[28:29], v135 offset:32768
    v_mfma_f32_16x16x32_bf16 a[64:67], v[104:107], v[64:67], a[64:67]
    ds_read_b64_tr_b16 v[30:31], v135 offset:40960
    v_mfma_f32_16x16x32_bf16 a[68:71], v[104:107], v[68:71], a[68:71]
    ds_read_b128 v[36:39], v136 offset:33792
    v_mfma_f32_16x16x32_bf16 a[72:75], v[104:107], v[72:75], a[72:75]
    ds_read_b128 v[40:43], v136 offset:34816
    v_mfma_f32_16x16x32_bf16 a[76:79], v[104:107], v[76:79], a[76:79]
    ds_read_b128 v[44:47], v136 offset:35840
    v_mfma_f32_16x16x32_bf16 a[80:83], v[104:107], v[80:83], a[80:83]
    ds_read_b128 v[48:51], v136 offset:36864
    v_mfma_f32_16x16x32_bf16 a[84:87], v[104:107], v[84:87], a[84:87]
    ds_read_b128 v[52:55], v136 offset:37888
    v_mfma_f32_16x16x32_bf16 a[88:91], v[104:107], v[88:91], a[88:91]
    ds_read_b128 v[56:59], v136 offset:38912
    v_mfma_f32_16x16x32_bf16 a[92:95], v[104:107], v[92:95], a[92:95]
    ds_read_b128 v[60:63], v136 offset:39936
    v_mfma_f32_16x16x32_bf16 a[96:99], v[108:111], v[64:67], a[96:99]
    v_mfma_f32_16x16x32_bf16 a[100:103], v[108:111], v[68:71], a[100:103]
    v_mfma_f32_16x16x32_bf16 a[104:107], v[108:111], v[72:75], a[104:107]
    v_mfma_f32_16x16x32_bf16 a[108:111], v[108:111], v[76:79], a[108:111]
    v_mfma_f32_16x16x32_bf16 a[112:115], v[108:111], v[80:83], a[112:115]
    v_mfma_f32_16x16x32_bf16 a[116:119], v[108:111], v[84:87], a[116:119]
    v_mfma_f32_16x16x32_bf16 a[120:123], v[108:111], v[88:91], a[120:123]
    v_mfma_f32_16x16x32_bf16 a[124:127], v[108:111], v[92:95], a[124:127]
    v_mfma_f32_16x16x32_bf16 a[128:131], v[112:115], v[64:67], a[128:131]
    v_mfma_f32_16x16x32_bf16 a[132:135], v[112:115], v[68:71], a[132:135]
    v_mfma_f32_16x16x32_bf16 a[136:139], v[112:115], v[72:75], a[136:139]
    v_mfma_f32_16x16x32_bf16 a[140:143], v[112:115], v[76:79], a[140:143]
    v_mfma_f32_16x16x32_bf16 a[144:147], v[112:115], v[80:83], a[144:147]
    v_mfma_f32_16x16x32_bf16 a[148:151], v[112:115], v[84:87], a[148:151]
    v_mfma_f32_16x16x32_bf16 a[152:155], v[112:115], v[88:91], a[152:155]
    v_mfma_f32_16x16x32_bf16 a[156:159], v[112:115], v[92:95], a[156:159]
    v_mfma_f32_16x16x32_bf16 a[160:163], v[116:119], v[64:67], a[160:163]
    v_mfma_f32_16x16x32_bf16 a[164:167], v[116:119], v[68:71], a[164:167]
    v_mfma_f32_16x16x32_bf16 a[168:171], v[116:119], v[72:75], a[168:171]
    v_mfma_f32_16x16x32_bf16 a[172:175], v[116:119], v[76:79], a[172:175]
    v_mfma_f32_16x16x32_bf16 a[176:179], v[116:119], v[80:83], a[176:179]
    v_mfma_f32_16x16x32_bf16 a[180:183], v[116:119], v[84:87], a[180:183]
    v_mfma_f32_16x16x32_bf16 a[184:187], v[116:119], v[88:91], a[184:187]
    v_mfma_f32_16x16x32_bf16 a[188:191], v[116:119], v[92:95], a[188:191]
    v_mfma_f32_16x16x32_bf16 a[192:195], v[120:123], v[64:67], a[192:195]
    v_mfma_f32_16x16x32_bf16 a[196:199], v[120:123], v[68:71], a[196:199]
    v_mfma_f32_16x16x32_bf16 a[200:203], v[120:123], v[72:75], a[200:203]
    v_mfma_f32_16x16x32_bf16 a[204:207], v[120:123], v[76:79], a[204:207]
    v_mfma_f32_16x16x32_bf16 a[208:211], v[120:123], v[80:83], a[208:211]
    v_mfma_f32_16x16x32_bf16 a[212:215], v[120:123], v[84:87], a[212:215]
    v_mfma_f32_16x16x32_bf16 a[216:219], v[120:123], v[88:91], a[216:219]
    v_mfma_f32_16x16x32_bf16 a[220:223], v[120:123], v[92:95], a[220:223]
    v_mfma_f32_16x16x32_bf16 a[224:227], v[124:127], v[64:67], a[224:227]
    v_mfma_f32_16x16x32_bf16 a[228:231], v[124:127], v[68:71], a[228:231]
    v_mfma_f32_16x16x32_bf16 a[232:235], v[124:127], v[72:75], a[232:235]
    v_mfma_f32_16x16x32_bf16 a[236:239], v[124:127], v[76:79], a[236:239]
    v_mfma_f32_16x16x32_bf16 a[240:243], v[124:127], v[80:83], a[240:243]
    v_mfma_f32_16x16x32_bf16 a[244:247], v[124:127], v[84:87], a[244:247]
    v_mfma_f32_16x16x32_bf16 a[248:251], v[124:127], v[88:91], a[248:251]
    v_mfma_f32_16x16x32_bf16 a[252:255], v[124:127], v[92:95], a[252:255]
    s_waitcnt lgkmcnt(0)
    v_mfma_f32_16x16x32_bf16 a[0:3], v[32:35], v[0:3], a[0:3]
    s_waitcnt vmcnt(0)
    s_barrier
    ds_read_b128 v[96:99], v136 offset:49152
    v_mfma_f32_16x16x32_bf16 a[4:7], v[32:35], v[4:7], a[4:7]
    ds_read_b64_tr_b16 v[64:65], v128 offset:49152
    v_mfma_f32_16x16x32_bf16 a[8:11], v[32:35], v[8:11], a[8:11]
    ds_read_b64_tr_b16 v[66:67], v128 offset:57344
    v_mfma_f32_16x16x32_bf16 a[12:15], v[32:35], v[12:15], a[12:15]
    ds_read_b64_tr_b16 v[68:69], v129 offset:49152
    v_mfma_f32_16x16x32_bf16 a[16:19], v[32:35], v[16:19], a[16:19]
    ds_read_b64_tr_b16 v[70:71], v129 offset:57344
    v_mfma_f32_16x16x32_bf16 a[20:23], v[32:35], v[20:23], a[20:23]
    ds_read_b64_tr_b16 v[72:73], v130 offset:49152
    v_mfma_f32_16x16x32_bf16 a[24:27], v[32:35], v[24:27], a[24:27]
    ds_read_b64_tr_b16 v[74:75], v130 offset:57344
    v_mfma_f32_16x16x32_bf16 a[28:31], v[32:35], v[28:31], a[28:31]
    ds_read_b64_tr_b16 v[76:77], v131 offset:49152
    v_mfma_f32_16x16x32_bf16 a[32:35], v[36:39], v[0:3], a[32:35]
    ds_read_b64_tr_b16 v[78:79], v131 offset:57344
    v_mfma_f32_16x16x32_bf16 a[36:39], v[36:39], v[4:7], a[36:39]
    ds_read_b64_tr_b16 v[80:81], v132 offset:49152
    v_mfma_f32_16x16x32_bf16 a[40:43], v[36:39], v[8:11], a[40:43]
    ds_read_b64_tr_b16 v[82:83], v132 offset:57344
    v_mfma_f32_16x16x32_bf16 a[44:47], v[36:39], v[12:15], a[44:47]
    ds_read_b64_tr_b16 v[84:85], v133 offset:49152
    v_mfma_f32_16x16x32_bf16 a[48:51], v[36:39], v[16:19], a[48:51]
    ds_read_b64_tr_b16 v[86:87], v133 offset:57344
    v_mfma_f32_16x16x32_bf16 a[52:55], v[36:39], v[20:23], a[52:55]
    ds_read_b64_tr_b16 v[88:89], v134 offset:49152
    v_mfma_f32_16x16x32_bf16 a[56:59], v[36:39], v[24:27], a[56:59]
    ds_read_b64_tr_b16 v[90:91], v134 offset:57344
    v_mfma_f32_16x16x32_bf16 a[60:63], v[36:39], v[28:31], a[60:63]
    ds_read_b64_tr_b16 v[92:93], v135 offset:49152
    v_mfma_f32_16x16x32_bf16 a[64:67], v[40:43], v[0:3], a[64:67]
    ds_read_b64_tr_b16 v[94:95], v135 offset:57344
    v_mfma_f32_16x16x32_bf16 a[68:71], v[40:43], v[4:7], a[68:71]
    ds_read_b128 v[100:103], v136 offset:50176
    v_mfma_f32_16x16x32_bf16 a[72:75], v[40:43], v[8:11], a[72:75]
    ds_read_b128 v[104:107], v136 offset:51200
    v_mfma_f32_16x16x32_bf16 a[76:79], v[40:43], v[12:15], a[76:79]
    ds_read_b128 v[108:111], v136 offset:52224
    v_mfma_f32_16x16x32_bf16 a[80:83], v[40:43], v[16:19], a[80:83]
    ds_read_b128 v[112:115], v136 offset:53248
    v_mfma_f32_16x16x32_bf16 a[84:87], v[40:43], v[20:23], a[84:87]
    ds_read_b128 v[116:119], v136 offset:54272
    v_mfma_f32_16x16x32_bf16 a[88:91], v[40:43], v[24:27], a[88:91]
    ds_read_b128 v[120:123], v136 offset:55296
    v_mfma_f32_16x16x32_bf16 a[92:95], v[40:43], v[28:31], a[92:95]
    ds_read_b128 v[124:127], v136 offset:56320
    v_mfma_f32_16x16x32_bf16 a[96:99], v[44:47], v[0:3], a[96:99]
    v_mfma_f32_16x16x32_bf16 a[100:103], v[44:47], v[4:7], a[100:103]
    v_mfma_f32_16x16x32_bf16 a[104:107], v[44:47], v[8:11], a[104:107]
    v_mfma_f32_16x16x32_bf16 a[108:111], v[44:47], v[12:15], a[108:111]
    v_mfma_f32_16x16x32_bf16 a[112:115], v[44:47], v[16:19], a[112:115]
    v_mfma_f32_16x16x32_bf16 a[116:119], v[44:47], v[20:23], a[116:119]
    v_mfma_f32_16x16x32_bf16 a[120:123], v[44:47], v[24:27], a[120:123]
    v_mfma_f32_16x16x32_bf16 a[124:127], v[44:47], v[28:31], a[124:127]
    v_mfma_f32_16x16x32_bf16 a[128:131], v[48:51], v[0:3], a[128:131]
    v_mfma_f32_16x16x32_bf16 a[132:135], v[48:51], v[4:7], a[132:135]
    v_mfma_f32_16x16x32_bf16 a[136:139], v[48:51], v[8:11], a[136:139]
    v_mfma_f32_16x16x32_bf16 a[140:143], v[48:51], v[12:15], a[140:143]
    v_mfma_f32_16x16x32_bf16 a[144:147], v[48:51], v[16:19], a[144:147]
    v_mfma_f32_16x16x32_bf16 a[148:151], v[48:51], v[20:23], a[148:151]
    v_mfma_f32_16x16x32_bf16 a[152:155], v[48:51], v[24:27], a[152:155]
    v_mfma_f32_16x16x32_bf16 a[156:159], v[48:51], v[28:31], a[156:159]
    v_mfma_f32_16x16x32_bf16 a[160:163], v[52:55], v[0:3], a[160:163]
    v_mfma_f32_16x16x32_bf16 a[164:167], v[52:55], v[4:7], a[164:167]
    v_mfma_f32_16x16x32_bf16 a[168:171], v[52:55], v[8:11], a[168:171]
    v_mfma_f32_16x16x32_bf16 a[172:175], v[52:55], v[12:15], a[172:175]
    v_mfma_f32_16x16x32_bf16 a[176:179], v[52:55], v[16:19], a[176:179]
    v_mfma_f32_16x16x32_bf16 a[180:183], v[52:55], v[20:23], a[180:183]
    v_mfma_f32_16x16x32_bf16 a[184:187], v[52:55], v[24:27], a[184:187]
    v_mfma_f32_16x16x32_bf16 a[188:191], v[52:55], v[28:31], a[188:191]
    v_mfma_f32_16x16x32_bf16 a[192:195], v[56:59], v[0:3], a[192:195]
    v_mfma_f32_16x16x32_bf16 a[196:199], v[56:59], v[4:7], a[196:199]
    v_mfma_f32_16x16x32_bf16 a[200:203], v[56:59], v[8:11], a[200:203]
    v_mfma_f32_16x16x32_bf16 a[204:207], v[56:59], v[12:15], a[204:207]
    v_mfma_f32_16x16x32_bf16 a[208:211], v[56:59], v[16:19], a[208:211]
    v_mfma_f32_16x16x32_bf16 a[212:215], v[56:59], v[20:23], a[212:215]
    v_mfma_f32_16x16x32_bf16 a[216:219], v[56:59], v[24:27], a[216:219]
    v_mfma_f32_16x16x32_bf16 a[220:223], v[56:59], v[28:31], a[220:223]
    v_mfma_f32_16x16x32_bf16 a[224:227], v[60:63], v[0:3], a[224:227]
    v_mfma_f32_16x16x32_bf16 a[228:231], v[60:63], v[4:7], a[228:231]
    v_mfma_f32_16x16x32_bf16 a[232:235], v[60:63], v[8:11], a[232:235]
    v_mfma_f32_16x16x32_bf16 a[236:239], v[60:63], v[12:15], a[236:239]
    v_mfma_f32_16x16x32_bf16 a[240:243], v[60:63], v[16:19], a[240:243]
    v_mfma_f32_16x16x32_bf16 a[244:247], v[60:63], v[20:23], a[244:247]
    v_mfma_f32_16x16x32_bf16 a[248:251], v[60:63], v[24:27], a[248:251]
    v_mfma_f32_16x16x32_bf16 a[252:255], v[60:63], v[28:31], a[252:255]
    v_readfirstlane_b32 s55, v255
    s_waitcnt lgkmcnt(0)
    v_mfma_f32_16x16x32_bf16 a[0:3], v[96:99], v[64:67], a[0:3]
    v_mfma_f32_16x16x32_bf16 a[4:7], v[96:99], v[68:71], a[4:7]
    v_mfma_f32_16x16x32_bf16 a[8:11], v[96:99], v[72:75], a[8:11]
    v_mfma_f32_16x16x32_bf16 a[12:15], v[96:99], v[76:79], a[12:15]
    v_mfma_f32_16x16x32_bf16 a[16:19], v[96:99], v[80:83], a[16:19]
    v_mfma_f32_16x16x32_bf16 a[20:23], v[96:99], v[84:87], a[20:23]
    v_mfma_f32_16x16x32_bf16 a[24:27], v[96:99], v[88:91], a[24:27]
    v_mfma_f32_16x16x32_bf16 a[28:31], v[96:99], v[92:95], a[28:31]
    v_mfma_f32_16x16x32_bf16 a[32:35], v[100:103], v[64:67], a[32:35]
    v_mfma_f32_16x16x32_bf16 a[36:39], v[100:103], v[68:71], a[36:39]
    v_mfma_f32_16x16x32_bf16 a[40:43], v[100:103], v[72:75], a[40:43]
    v_mfma_f32_16x16x32_bf16 a[44:47], v[100:103], v[76:79], a[44:47]
    v_mfma_f32_16x16x32_bf16 a[48:51], v[100:103], v[80:83], a[48:51]
    v_mfma_f32_16x16x32_bf16 a[52:55], v[100:103], v[84:87], a[52:55]
    v_mfma_f32_16x16x32_bf16 a[56:59], v[100:103], v[88:91], a[56:59]
    v_mfma_f32_16x16x32_bf16 a[60:63], v[100:103], v[92:95], a[60:63]
    v_mfma_f32_16x16x32_bf16 a[64:67], v[104:107], v[64:67], a[64:67]
    v_mfma_f32_16x16x32_bf16 a[68:71], v[104:107], v[68:71], a[68:71]
    v_mfma_f32_16x16x32_bf16 a[72:75], v[104:107], v[72:75], a[72:75]
    v_mfma_f32_16x16x32_bf16 a[76:79], v[104:107], v[76:79], a[76:79]
    v_mfma_f32_16x16x32_bf16 a[80:83], v[104:107], v[80:83], a[80:83]
    v_mfma_f32_16x16x32_bf16 a[84:87], v[104:107], v[84:87], a[84:87]
    v_mfma_f32_16x16x32_bf16 a[88:91], v[104:107], v[88:91], a[88:91]
    v_mfma_f32_16x16x32_bf16 a[92:95], v[104:107], v[92:95], a[92:95]
    v_mfma_f32_16x16x32_bf16 a[96:99], v[108:111], v[64:67], a[96:99]
    v_mfma_f32_16x16x32_bf16 a[100:103], v[108:111], v[68:71], a[100:103]
    v_mfma_f32_16x16x32_bf16 a[104:107], v[108:111], v[72:75], a[104:107]
    v_mfma_f32_16x16x32_bf16 a[108:111], v[108:111], v[76:79], a[108:111]
    v_mfma_f32_16x16x32_bf16 a[112:115], v[108:111], v[80:83], a[112:115]
    v_mfma_f32_16x16x32_bf16 a[116:119], v[108:111], v[84:87], a[116:119]
    v_mfma_f32_16x16x32_bf16 a[120:123], v[108:111], v[88:91], a[120:123]
    v_mfma_f32_16x16x32_bf16 a[124:127], v[108:111], v[92:95], a[124:127]
    v_mfma_f32_16x16x32_bf16 a[128:131], v[112:115], v[64:67], a[128:131]
    v_mfma_f32_16x16x32_bf16 a[132:135], v[112:115], v[68:71], a[132:135]
    v_mfma_f32_16x16x32_bf16 a[136:139], v[112:115], v[72:75], a[136:139]
    v_mfma_f32_16x16x32_bf16 a[140:143], v[112:115], v[76:79], a[140:143]
    v_mfma_f32_16x16x32_bf16 a[144:147], v[112:115], v[80:83], a[144:147]
    v_mfma_f32_16x16x32_bf16 a[148:151], v[112:115], v[84:87], a[148:151]
    v_mfma_f32_16x16x32_bf16 a[152:155], v[112:115], v[88:91], a[152:155]
    v_mfma_f32_16x16x32_bf16 a[156:159], v[112:115], v[92:95], a[156:159]
    v_mfma_f32_16x16x32_bf16 a[160:163], v[116:119], v[64:67], a[160:163]
    v_mfma_f32_16x16x32_bf16 a[164:167], v[116:119], v[68:71], a[164:167]
    v_mfma_f32_16x16x32_bf16 a[168:171], v[116:119], v[72:75], a[168:171]
    v_mfma_f32_16x16x32_bf16 a[172:175], v[116:119], v[76:79], a[172:175]
    v_mfma_f32_16x16x32_bf16 a[176:179], v[116:119], v[80:83], a[176:179]
    v_mfma_f32_16x16x32_bf16 a[180:183], v[116:119], v[84:87], a[180:183]
    v_mfma_f32_16x16x32_bf16 a[184:187], v[116:119], v[88:91], a[184:187]
    v_mfma_f32_16x16x32_bf16 a[188:191], v[116:119], v[92:95], a[188:191]
    v_mfma_f32_16x16x32_bf16 a[192:195], v[120:123], v[64:67], a[192:195]
    v_mfma_f32_16x16x32_bf16 a[196:199], v[120:123], v[68:71], a[196:199]
    v_mfma_f32_16x16x32_bf16 a[200:203], v[120:123], v[72:75], a[200:203]
    v_mfma_f32_16x16x32_bf16 a[204:207], v[120:123], v[76:79], a[204:207]
    v_mfma_f32_16x16x32_bf16 a[208:211], v[120:123], v[80:83], a[208:211]
    v_mfma_f32_16x16x32_bf16 a[212:215], v[120:123], v[84:87], a[212:215]
    v_mfma_f32_16x16x32_bf16 a[216:219], v[120:123], v[88:91], a[216:219]
    v_mfma_f32_16x16x32_bf16 a[220:223], v[120:123], v[92:95], a[220:223]
    v_mfma_f32_16x16x32_bf16 a[224:227], v[124:127], v[64:67], a[224:227]
    v_mfma_f32_16x16x32_bf16 a[228:231], v[124:127], v[68:71], a[228:231]
    v_mfma_f32_16x16x32_bf16 a[232:235], v[124:127], v[72:75], a[232:235]
    v_mfma_f32_16x16x32_bf16 a[236:239], v[124:127], v[76:79], a[236:239]
    v_mfma_f32_16x16x32_bf16 a[240:243], v[124:127], v[80:83], a[240:243]
    v_mfma_f32_16x16x32_bf16 a[244:247], v[124:127], v[84:87], a[244:247]
    v_mfma_f32_16x16x32_bf16 a[248:251], v[124:127], v[88:91], a[248:251]
    v_mfma_f32_16x16x32_bf16 a[252:255], v[124:127], v[92:95], a[252:255]
    s_nop 7
    s_mov_b32 s53, s21
    v_accvgpr_read_b32 v0, a0
    v_accvgpr_read_b32 v1, a1
    v_accvgpr_read_b32 v2, a2
    v_accvgpr_read_b32 v3, a3
    v_accvgpr_read_b32 v4, a32
    v_accvgpr_read_b32 v5, a33
    v_accvgpr_read_b32 v6, a34
    v_accvgpr_read_b32 v7, a35
    v_cvt_pk_bf16_f32 v8, v0, v1
    v_cvt_pk_bf16_f32 v9, v2, v3
    v_cvt_pk_bf16_f32 v10, v4, v5
    v_cvt_pk_bf16_f32 v11, v6, v7
    buffer_store_dwordx4 v[8:11], v251, s[4:7], s53 offen offset:0 sc1
    v_accvgpr_read_b32 v16, a4
    v_accvgpr_read_b32 v17, a5
    v_accvgpr_read_b32 v18, a6
    v_accvgpr_read_b32 v19, a7
    v_accvgpr_read_b32 v20, a36
    v_accvgpr_read_b32 v21, a37
    v_accvgpr_read_b32 v22, a38
    v_accvgpr_read_b32 v23, a39
    v_cvt_pk_bf16_f32 v24, v16, v17
    v_cvt_pk_bf16_f32 v25, v18, v19
    v_cvt_pk_bf16_f32 v26, v20, v21
    v_cvt_pk_bf16_f32 v27, v22, v23
    buffer_store_dwordx4 v[24:27], v251, s[4:7], s53 offen offset:1024 sc1
    v_accvgpr_read_b32 v32, a8
    v_accvgpr_read_b32 v33, a9
    v_accvgpr_read_b32 v34, a10
    v_accvgpr_read_b32 v35, a11
    v_accvgpr_read_b32 v36, a40
    v_accvgpr_read_b32 v37, a41
    v_accvgpr_read_b32 v38, a42
    v_accvgpr_read_b32 v39, a43
    v_cvt_pk_bf16_f32 v40, v32, v33
    v_cvt_pk_bf16_f32 v41, v34, v35
    v_cvt_pk_bf16_f32 v42, v36, v37
    v_cvt_pk_bf16_f32 v43, v38, v39
    buffer_store_dwordx4 v[40:43], v251, s[4:7], s53 offen offset:2048 sc1
    v_accvgpr_read_b32 v48, a12
    v_accvgpr_read_b32 v49, a13
    v_accvgpr_read_b32 v50, a14
    v_accvgpr_read_b32 v51, a15
    v_accvgpr_read_b32 v52, a44
    v_accvgpr_read_b32 v53, a45
    v_accvgpr_read_b32 v54, a46
    v_accvgpr_read_b32 v55, a47
    v_cvt_pk_bf16_f32 v56, v48, v49
    v_cvt_pk_bf16_f32 v57, v50, v51
    v_cvt_pk_bf16_f32 v58, v52, v53
    v_cvt_pk_bf16_f32 v59, v54, v55
    buffer_store_dwordx4 v[56:59], v251, s[4:7], s53 offen offset:3072 sc1
    s_add_u32 s53, s53, 4096
    v_accvgpr_read_b32 v0, a16
    v_accvgpr_read_b32 v1, a17
    v_accvgpr_read_b32 v2, a18
    v_accvgpr_read_b32 v3, a19
    v_accvgpr_read_b32 v4, a48
    v_accvgpr_read_b32 v5, a49
    v_accvgpr_read_b32 v6, a50
    v_accvgpr_read_b32 v7, a51
    v_cvt_pk_bf16_f32 v8, v0, v1
    v_cvt_pk_bf16_f32 v9, v2, v3
    v_cvt_pk_bf16_f32 v10, v4, v5
    v_cvt_pk_bf16_f32 v11, v6, v7
    buffer_store_dwordx4 v[8:11], v251, s[4:7], s53 offen offset:0 sc1
    v_accvgpr_read_b32 v16, a20
    v_accvgpr_read_b32 v17, a21
    v_accvgpr_read_b32 v18, a22
    v_accvgpr_read_b32 v19, a23
    v_accvgpr_read_b32 v20, a52
    v_accvgpr_read_b32 v21, a53
    v_accvgpr_read_b32 v22, a54
    v_accvgpr_read_b32 v23, a55
    v_cvt_pk_bf16_f32 v24, v16, v17
    v_cvt_pk_bf16_f32 v25, v18, v19
    v_cvt_pk_bf16_f32 v26, v20, v21
    v_cvt_pk_bf16_f32 v27, v22, v23
    buffer_store_dwordx4 v[24:27], v251, s[4:7], s53 offen offset:1024 sc1
    v_accvgpr_read_b32 v32, a24
    v_accvgpr_read_b32 v33, a25
    v_accvgpr_read_b32 v34, a26
    v_accvgpr_read_b32 v35, a27
    v_accvgpr_read_b32 v36, a56
    v_accvgpr_read_b32 v37, a57
    v_accvgpr_read_b32 v38, a58
    v_accvgpr_read_b32 v39, a59
    v_cvt_pk_bf16_f32 v40, v32, v33
    v_cvt_pk_bf16_f32 v41, v34, v35
    v_cvt_pk_bf16_f32 v42, v36, v37
    v_cvt_pk_bf16_f32 v43, v38, v39
    buffer_store_dwordx4 v[40:43], v251, s[4:7], s53 offen offset:2048 sc1
    v_accvgpr_read_b32 v48, a28
    v_accvgpr_read_b32 v49, a29
    v_accvgpr_read_b32 v50, a30
    v_accvgpr_read_b32 v51, a31
    v_accvgpr_read_b32 v52, a60
    v_accvgpr_read_b32 v53, a61
    v_accvgpr_read_b32 v54, a62
    v_accvgpr_read_b32 v55, a63
    v_cvt_pk_bf16_f32 v56, v48, v49
    v_cvt_pk_bf16_f32 v57, v50, v51
    v_cvt_pk_bf16_f32 v58, v52, v53
    v_cvt_pk_bf16_f32 v59, v54, v55
    buffer_store_dwordx4 v[56:59], v251, s[4:7], s53 offen offset:3072 sc1
    s_add_u32 s53, s53, 258048
    v_accvgpr_read_b32 v0, a64
    v_accvgpr_read_b32 v1, a65
    v_accvgpr_read_b32 v2, a66
    v_accvgpr_read_b32 v3, a67
    v_accvgpr_read_b32 v4, a96
    v_accvgpr_read_b32 v5, a97
    v_accvgpr_read_b32 v6, a98
    v_accvgpr_read_b32 v7, a99
    v_cvt_pk_bf16_f32 v8, v0, v1
    v_cvt_pk_bf16_f32 v9, v2, v3
    v_cvt_pk_bf16_f32 v10, v4, v5
    v_cvt_pk_bf16_f32 v11, v6, v7
    buffer_store_dwordx4 v[8:11], v251, s[4:7], s53 offen offset:0 sc1
    v_accvgpr_read_b32 v16, a68
    v_accvgpr_read_b32 v17, a69
    v_accvgpr_read_b32 v18, a70
    v_accvgpr_read_b32 v19, a71
    v_accvgpr_read_b32 v20, a100
    v_accvgpr_read_b32 v21, a101
    v_accvgpr_read_b32 v22, a102
    v_accvgpr_read_b32 v23, a103
    v_cvt_pk_bf16_f32 v24, v16, v17
    v_cvt_pk_bf16_f32 v25, v18, v19
    v_cvt_pk_bf16_f32 v26, v20, v21
    v_cvt_pk_bf16_f32 v27, v22, v23
    buffer_store_dwordx4 v[24:27], v251, s[4:7], s53 offen offset:1024 sc1
    v_accvgpr_read_b32 v32, a72
    v_accvgpr_read_b32 v33, a73
    v_accvgpr_read_b32 v34, a74
    v_accvgpr_read_b32 v35, a75
    v_accvgpr_read_b32 v36, a104
    v_accvgpr_read_b32 v37, a105
    v_accvgpr_read_b32 v38, a106
    v_accvgpr_read_b32 v39, a107
    v_cvt_pk_bf16_f32 v40, v32, v33
    v_cvt_pk_bf16_f32 v41, v34, v35
    v_cvt_pk_bf16_f32 v42, v36, v37
    v_cvt_pk_bf16_f32 v43, v38, v39
    buffer_store_dwordx4 v[40:43], v251, s[4:7], s53 offen offset:2048 sc1
    v_accvgpr_read_b32 v48, a76
    v_accvgpr_read_b32 v49, a77
    v_accvgpr_read_b32 v50, a78
    v_accvgpr_read_b32 v51, a79
    v_accvgpr_read_b32 v52, a108
    v_accvgpr_read_b32 v53, a109
    v_accvgpr_read_b32 v54, a110
    v_accvgpr_read_b32 v55, a111
    v_cvt_pk_bf16_f32 v56, v48, v49
    v_cvt_pk_bf16_f32 v57, v50, v51
    v_cvt_pk_bf16_f32 v58, v52, v53
    v_cvt_pk_bf16_f32 v59, v54, v55
    buffer_store_dwordx4 v[56:59], v251, s[4:7], s53 offen offset:3072 sc1
    s_add_u32 s53, s53, 4096
    v_accvgpr_read_b32 v0, a80
    v_accvgpr_read_b32 v1, a81
    v_accvgpr_read_b32 v2, a82
    v_accvgpr_read_b32 v3, a83
    v_accvgpr_read_b32 v4, a112
    v_accvgpr_read_b32 v5, a113
    v_accvgpr_read_b32 v6, a114
    v_accvgpr_read_b32 v7, a115
    v_cvt_pk_bf16_f32 v8, v0, v1
    v_cvt_pk_bf16_f32 v9, v2, v3
    v_cvt_pk_bf16_f32 v10, v4, v5
    v_cvt_pk_bf16_f32 v11, v6, v7
    buffer_store_dwordx4 v[8:11], v251, s[4:7], s53 offen offset:0 sc1
    v_accvgpr_read_b32 v16, a84
    v_accvgpr_read_b32 v17, a85
    v_accvgpr_read_b32 v18, a86
    v_accvgpr_read_b32 v19, a87
    v_accvgpr_read_b32 v20, a116
    v_accvgpr_read_b32 v21, a117
    v_accvgpr_read_b32 v22, a118
    v_accvgpr_read_b32 v23, a119
    v_cvt_pk_bf16_f32 v24, v16, v17
    v_cvt_pk_bf16_f32 v25, v18, v19
    v_cvt_pk_bf16_f32 v26, v20, v21
    v_cvt_pk_bf16_f32 v27, v22, v23
    buffer_store_dwordx4 v[24:27], v251, s[4:7], s53 offen offset:1024 sc1
    v_accvgpr_read_b32 v32, a88
    v_accvgpr_read_b32 v33, a89
    v_accvgpr_read_b32 v34, a90
    v_accvgpr_read_b32 v35, a91
    v_accvgpr_read_b32 v36, a120
    v_accvgpr_read_b32 v37, a121
    v_accvgpr_read_b32 v38, a122
    v_accvgpr_read_b32 v39, a123
    v_cvt_pk_bf16_f32 v40, v32, v33
    v_cvt_pk_bf16_f32 v41, v34, v35
    v_cvt_pk_bf16_f32 v42, v36, v37
    v_cvt_pk_bf16_f32 v43, v38, v39
    buffer_store_dwordx4 v[40:43], v251, s[4:7], s53 offen offset:2048 sc1
    v_accvgpr_read_b32 v48, a92
    v_accvgpr_read_b32 v49, a93
    v_accvgpr_read_b32 v50, a94
    v_accvgpr_read_b32 v51, a95
    v_accvgpr_read_b32 v52, a124
    v_accvgpr_read_b32 v53, a125
    v_accvgpr_read_b32 v54, a126
    v_accvgpr_read_b32 v55, a127
    v_cvt_pk_bf16_f32 v56, v48, v49
    v_cvt_pk_bf16_f32 v57, v50, v51
    v_cvt_pk_bf16_f32 v58, v52, v53
    v_cvt_pk_bf16_f32 v59, v54, v55
    buffer_store_dwordx4 v[56:59], v251, s[4:7], s53 offen offset:3072 sc1
    s_add_u32 s53, s53, 258048
    v_accvgpr_read_b32 v0, a128
    v_accvgpr_read_b32 v1, a129
    v_accvgpr_read_b32 v2, a130
    v_accvgpr_read_b32 v3, a131
    v_accvgpr_read_b32 v4, a160
    v_accvgpr_read_b32 v5, a161
    v_accvgpr_read_b32 v6, a162
    v_accvgpr_read_b32 v7, a163
    v_cvt_pk_bf16_f32 v8, v0, v1
    v_cvt_pk_bf16_f32 v9, v2, v3
    v_cvt_pk_bf16_f32 v10, v4, v5
    v_cvt_pk_bf16_f32 v11, v6, v7
    buffer_store_dwordx4 v[8:11], v251, s[4:7], s53 offen offset:0 sc1
    v_accvgpr_read_b32 v16, a132
    v_accvgpr_read_b32 v17, a133
    v_accvgpr_read_b32 v18, a134
    v_accvgpr_read_b32 v19, a135
    v_accvgpr_read_b32 v20, a164
    v_accvgpr_read_b32 v21, a165
    v_accvgpr_read_b32 v22, a166
    v_accvgpr_read_b32 v23, a167
    v_cvt_pk_bf16_f32 v24, v16, v17
    v_cvt_pk_bf16_f32 v25, v18, v19
    v_cvt_pk_bf16_f32 v26, v20, v21
    v_cvt_pk_bf16_f32 v27, v22, v23
    buffer_store_dwordx4 v[24:27], v251, s[4:7], s53 offen offset:1024 sc1
    v_accvgpr_read_b32 v32, a136
    v_accvgpr_read_b32 v33, a137
    v_accvgpr_read_b32 v34, a138
    v_accvgpr_read_b32 v35, a139
    v_accvgpr_read_b32 v36, a168
    v_accvgpr_read_b32 v37, a169
    v_accvgpr_read_b32 v38, a170
    v_accvgpr_read_b32 v39, a171
    v_cvt_pk_bf16_f32 v40, v32, v33
    v_cvt_pk_bf16_f32 v41, v34, v35
    v_cvt_pk_bf16_f32 v42, v36, v37
    v_cvt_pk_bf16_f32 v43, v38, v39
    buffer_store_dwordx4 v[40:43], v251, s[4:7], s53 offen offset:2048 sc1
    v_accvgpr_read_b32 v48, a140
    v_accvgpr_read_b32 v49, a141
    v_accvgpr_read_b32 v50, a142
    v_accvgpr_read_b32 v51, a143
    v_accvgpr_read_b32 v52, a172
    v_accvgpr_read_b32 v53, a173
    v_accvgpr_read_b32 v54, a174
    v_accvgpr_read_b32 v55, a175
    v_cvt_pk_bf16_f32 v56, v48, v49
    v_cvt_pk_bf16_f32 v57, v50, v51
    v_cvt_pk_bf16_f32 v58, v52, v53
    v_cvt_pk_bf16_f32 v59, v54, v55
    buffer_store_dwordx4 v[56:59], v251, s[4:7], s53 offen offset:3072 sc1
    s_add_u32 s53, s53, 4096
    v_accvgpr_read_b32 v0, a144
    v_accvgpr_read_b32 v1, a145
    v_accvgpr_read_b32 v2, a146
    v_accvgpr_read_b32 v3, a147
    v_accvgpr_read_b32 v4, a176
    v_accvgpr_read_b32 v5, a177
    v_accvgpr_read_b32 v6, a178
    v_accvgpr_read_b32 v7, a179
    v_cvt_pk_bf16_f32 v8, v0, v1
    v_cvt_pk_bf16_f32 v9, v2, v3
    v_cvt_pk_bf16_f32 v10, v4, v5
    v_cvt_pk_bf16_f32 v11, v6, v7
    buffer_store_dwordx4 v[8:11], v251, s[4:7], s53 offen offset:0 sc1
    v_accvgpr_read_b32 v16, a148
    v_accvgpr_read_b32 v17, a149
    v_accvgpr_read_b32 v18, a150
    v_accvgpr_read_b32 v19, a151
    v_accvgpr_read_b32 v20, a180
    v_accvgpr_read_b32 v21, a181
    v_accvgpr_read_b32 v22, a182
    v_accvgpr_read_b32 v23, a183
    v_cvt_pk_bf16_f32 v24, v16, v17
    v_cvt_pk_bf16_f32 v25, v18, v19
    v_cvt_pk_bf16_f32 v26, v20, v21
    v_cvt_pk_bf16_f32 v27, v22, v23
    buffer_store_dwordx4 v[24:27], v251, s[4:7], s53 offen offset:1024 sc1
    v_accvgpr_read_b32 v32, a152
    v_accvgpr_read_b32 v33, a153
    v_accvgpr_read_b32 v34, a154
    v_accvgpr_read_b32 v35, a155
    v_accvgpr_read_b32 v36, a184
    v_accvgpr_read_b32 v37, a185
    v_accvgpr_read_b32 v38, a186
    v_accvgpr_read_b32 v39, a187
    v_cvt_pk_bf16_f32 v40, v32, v33
    v_cvt_pk_bf16_f32 v41, v34, v35
    v_cvt_pk_bf16_f32 v42, v36, v37
    v_cvt_pk_bf16_f32 v43, v38, v39
    buffer_store_dwordx4 v[40:43], v251, s[4:7], s53 offen offset:2048 sc1
    v_accvgpr_read_b32 v48, a156
    v_accvgpr_read_b32 v49, a157
    v_accvgpr_read_b32 v50, a158
    v_accvgpr_read_b32 v51, a159
    v_accvgpr_read_b32 v52, a188
    v_accvgpr_read_b32 v53, a189
    v_accvgpr_read_b32 v54, a190
    v_accvgpr_read_b32 v55, a191
    v_cvt_pk_bf16_f32 v56, v48, v49
    v_cvt_pk_bf16_f32 v57, v50, v51
    v_cvt_pk_bf16_f32 v58, v52, v53
    v_cvt_pk_bf16_f32 v59, v54, v55
    buffer_store_dwordx4 v[56:59], v251, s[4:7], s53 offen offset:3072 sc1
    s_add_u32 s53, s53, 258048
    v_accvgpr_read_b32 v0, a192
    v_accvgpr_read_b32 v1, a193
    v_accvgpr_read_b32 v2, a194
    v_accvgpr_read_b32 v3, a195
    v_accvgpr_read_b32 v4, a224
    v_accvgpr_read_b32 v5, a225
    v_accvgpr_read_b32 v6, a226
    v_accvgpr_read_b32 v7, a227
    v_cvt_pk_bf16_f32 v8, v0, v1
    v_cvt_pk_bf16_f32 v9, v2, v3
    v_cvt_pk_bf16_f32 v10, v4, v5
    v_cvt_pk_bf16_f32 v11, v6, v7
    buffer_store_dwordx4 v[8:11], v251, s[4:7], s53 offen offset:0 sc1
    v_accvgpr_read_b32 v16, a196
    v_accvgpr_read_b32 v17, a197
    v_accvgpr_read_b32 v18, a198
    v_accvgpr_read_b32 v19, a199
    v_accvgpr_read_b32 v20, a228
    v_accvgpr_read_b32 v21, a229
    v_accvgpr_read_b32 v22, a230
    v_accvgpr_read_b32 v23, a231
    v_cvt_pk_bf16_f32 v24, v16, v17
    v_cvt_pk_bf16_f32 v25, v18, v19
    v_cvt_pk_bf16_f32 v26, v20, v21
    v_cvt_pk_bf16_f32 v27, v22, v23
    buffer_store_dwordx4 v[24:27], v251, s[4:7], s53 offen offset:1024 sc1
    v_accvgpr_read_b32 v32, a200
    v_accvgpr_read_b32 v33, a201
    v_accvgpr_read_b32 v34, a202
    v_accvgpr_read_b32 v35, a203
    v_accvgpr_read_b32 v36, a232
    v_accvgpr_read_b32 v37, a233
    v_accvgpr_read_b32 v38, a234
    v_accvgpr_read_b32 v39, a235
    v_cvt_pk_bf16_f32 v40, v32, v33
    v_cvt_pk_bf16_f32 v41, v34, v35
    v_cvt_pk_bf16_f32 v42, v36, v37
    v_cvt_pk_bf16_f32 v43, v38, v39
    buffer_store_dwordx4 v[40:43], v251, s[4:7], s53 offen offset:2048 sc1
    v_accvgpr_read_b32 v48, a204
    v_accvgpr_read_b32 v49, a205
    v_accvgpr_read_b32 v50, a206
    v_accvgpr_read_b32 v51, a207
    v_accvgpr_read_b32 v52, a236
    v_accvgpr_read_b32 v53, a237
    v_accvgpr_read_b32 v54, a238
    v_accvgpr_read_b32 v55, a239
    v_cvt_pk_bf16_f32 v56, v48, v49
    v_cvt_pk_bf16_f32 v57, v50, v51
    v_cvt_pk_bf16_f32 v58, v52, v53
    v_cvt_pk_bf16_f32 v59, v54, v55
    buffer_store_dwordx4 v[56:59], v251, s[4:7], s53 offen offset:3072 sc1
    s_add_u32 s53, s53, 4096
    v_accvgpr_read_b32 v0, a208
    v_accvgpr_read_b32 v1, a209
    v_accvgpr_read_b32 v2, a210
    v_accvgpr_read_b32 v3, a211
    v_accvgpr_read_b32 v4, a240
    v_accvgpr_read_b32 v5, a241
    v_accvgpr_read_b32 v6, a242
    v_accvgpr_read_b32 v7, a243
    v_cvt_pk_bf16_f32 v8, v0, v1
    v_cvt_pk_bf16_f32 v9, v2, v3
    v_cvt_pk_bf16_f32 v10, v4, v5
    v_cvt_pk_bf16_f32 v11, v6, v7
    buffer_store_dwordx4 v[8:11], v251, s[4:7], s53 offen offset:0 sc1
    v_accvgpr_read_b32 v16, a212
    v_accvgpr_read_b32 v17, a213
    v_accvgpr_read_b32 v18, a214
    v_accvgpr_read_b32 v19, a215
    v_accvgpr_read_b32 v20, a244
    v_accvgpr_read_b32 v21, a245
    v_accvgpr_read_b32 v22, a246
    v_accvgpr_read_b32 v23, a247
    v_cvt_pk_bf16_f32 v24, v16, v17
    v_cvt_pk_bf16_f32 v25, v18, v19
    v_cvt_pk_bf16_f32 v26, v20, v21
    v_cvt_pk_bf16_f32 v27, v22, v23
    buffer_store_dwordx4 v[24:27], v251, s[4:7], s53 offen offset:1024 sc1
    v_accvgpr_read_b32 v32, a216
    v_accvgpr_read_b32 v33, a217
    v_accvgpr_read_b32 v34, a218
    v_accvgpr_read_b32 v35, a219
    v_accvgpr_read_b32 v36, a248
    v_accvgpr_read_b32 v37, a249
    v_accvgpr_read_b32 v38, a250
    v_accvgpr_read_b32 v39, a251
    v_cvt_pk_bf16_f32 v40, v32, v33
    v_cvt_pk_bf16_f32 v41, v34, v35
    v_cvt_pk_bf16_f32 v42, v36, v37
    v_cvt_pk_bf16_f32 v43, v38, v39
    buffer_store_dwordx4 v[40:43], v251, s[4:7], s53 offen offset:2048 sc1
    v_accvgpr_read_b32 v48, a220
    v_accvgpr_read_b32 v49, a221
    v_accvgpr_read_b32 v50, a222
    v_accvgpr_read_b32 v51, a223
    v_accvgpr_read_b32 v52, a252
    v_accvgpr_read_b32 v53, a253
    v_accvgpr_read_b32 v54, a254
    v_accvgpr_read_b32 v55, a255
    v_cvt_pk_bf16_f32 v56, v48, v49
    v_cvt_pk_bf16_f32 v57, v50, v51
    v_cvt_pk_bf16_f32 v58, v52, v53
    v_cvt_pk_bf16_f32 v59, v54, v55
    buffer_store_dwordx4 v[56:59], v251, s[4:7], s53 offen offset:3072 sc1
    s_add_u32 s53, s53, 258048
    s_branch main_kernel_w_done
main_kernel_w_pref:
    s_cmp_lg_u32 s24, 0
    s_cbranch_scc1 main_kernel_w_pf0
    s_mov_b32 s8, s64
    s_and_b32 s9, s65, 0xffff
    s_mov_b32 s10, 0x200000
    s_mov_b32 s11, 0x20000
    s_branch main_kernel_w_pfg
main_kernel_w_pf0:
    s_cmp_lg_u32 s24, 1
    s_cbranch_scc1 main_kernel_w_pf1
    s_mov_b32 s8, s66
    s_and_b32 s9, s67, 0xffff
    s_mov_b32 s10, 0x200000
    s_mov_b32 s11, 0x20000
    s_branch main_kernel_w_pfg
main_kernel_w_pf1:
    s_cmp_lg_u32 s24, 2
    s_cbranch_scc1 main_kernel_w_pf2
    s_mov_b32 s8, s68
    s_and_b32 s9, s69, 0xffff
    s_mov_b32 s10, 0x700000
    s_mov_b32 s11, 0x20000
    s_branch main_kernel_w_pfg
main_kernel_w_pf2:
    s_mov_b32 s8, s70
    s_and_b32 s9, s71, 0xffff
    s_mov_b32 s10, 0x700000
    s_mov_b32 s11, 0x20000
main_kernel_w_pfg:
    s_lshl_b32 s32, s25, 19
    s_lshl_b32 s33, s14, 17
    s_add_u32 s32, s32, s33
    v_lshlrev_b32 v253, 7, v250
    buffer_load_dword v0, v253, s[8:11], s32 offen
    s_add_u32 s32, s32, 8192
    buffer_load_dword v0, v253, s[8:11], s32 offen
    s_add_u32 s32, s32, 8192
    buffer_load_dword v0, v253, s[8:11], s32 offen
    s_add_u32 s32, s32, 8192
    buffer_load_dword v0, v253, s[8:11], s32 offen
    s_add_u32 s32, s32, 8192
    buffer_load_dword v0, v253, s[8:11], s32 offen
    s_add_u32 s32, s32, 8192
    buffer_load_dword v0, v253, s[8:11], s32 offen
    s_add_u32 s32, s32, 8192
    buffer_load_dword v0, v253, s[8:11], s32 offen
    s_add_u32 s32, s32, 8192
    buffer_load_dword v0, v253, s[8:11], s32 offen
    s_add_u32 s32, s32, 8192
    buffer_load_dword v0, v253, s[8:11], s32 offen
    s_add_u32 s32, s32, 8192
    buffer_load_dword v0, v253, s[8:11], s32 offen
    s_add_u32 s32, s32, 8192
    buffer_load_dword v0, v253, s[8:11], s32 offen
    s_add_u32 s32, s32, 8192
    buffer_load_dword v0, v253, s[8:11], s32 offen
    s_add_u32 s32, s32, 8192
    buffer_load_dword v0, v253, s[8:11], s32 offen
    s_add_u32 s32, s32, 8192
    buffer_load_dword v0, v253, s[8:11], s32 offen
    s_add_u32 s32, s32, 8192
    buffer_load_dword v0, v253, s[8:11], s32 offen
    s_add_u32 s32, s32, 8192
    buffer_load_dword v0, v253, s[8:11], s32 offen
    s_add_u32 s32, s32, 8192
    s_branch main_kernel_w_done
main_kernel_w_fill:
    s_lshl_b32 s32, s24, 2
    s_add_u32 s32, s32, s25
    s_lshl_b32 s33, s32, 16
    s_add_u32 s32, s33, 0x6e00000
    s_add_u32 s35, s33, 0x8c00000
    s_add_u32 s33, s33, 0x8000000
    s_lshl_b32 s34, s14, 12
    v_add_u32 v253, s34, v251
    v_mov_b32 v0, -1
    v_mov_b32 v1, -1
    v_mov_b32 v2, -1
    v_mov_b32 v3, -1
    s_mov_b32 s18, 4
main_kernel_w_fl:
    buffer_store_dwordx4 v[0:3], v253, s[4:7], s32 offen offset:0 sc1
    buffer_store_dwordx4 v[0:3], v253, s[4:7], s32 offen offset:1024 sc1
    buffer_store_dwordx4 v[0:3], v253, s[4:7], s32 offen offset:2048 sc1
    buffer_store_dwordx4 v[0:3], v253, s[4:7], s32 offen offset:3072 sc1
    s_add_u32 s32, s32, 16384
    buffer_store_dwordx4 v[0:3], v253, s[4:7], s33 offen offset:0 sc1
    buffer_store_dwordx4 v[0:3], v253, s[4:7], s33 offen offset:1024 sc1
    buffer_store_dwordx4 v[0:3], v253, s[4:7], s33 offen offset:2048 sc1
    buffer_store_dwordx4 v[0:3], v253, s[4:7], s33 offen offset:3072 sc1
    s_add_u32 s33, s33, 16384
    s_sub_u32 s18, s18, 1
    s_cmp_lg_u32 s18, 0
    s_cbranch_scc1 main_kernel_w_fl
    s_branch main_kernel_w_done
main_kernel_w_ln2:
    s_lshl_b32 s32, s24, 3
    s_mul_i32 s33, s25, 2
    s_add_u32 s32, s32, s33
    s_lshl_b32 s32, s32, 15
    s_lshl_b32 s33, s14, 13
    s_add_u32 s32, s32, s33
    s_add_u32 s21, s32, 0x6800000
    s_add_u32 s32, s32, 0x5000000
    buffer_load_dwordx4 v[0:3], v251, s[4:7], s32 offen offset:0 sc1
    buffer_load_dwordx4 v[4:7], v251, s[4:7], s32 offen offset:1024 sc1
    buffer_load_dwordx4 v[8:11], v251, s[4:7], s32 offen offset:2048 sc1
    buffer_load_dwordx4 v[12:15], v251, s[4:7], s32 offen offset:3072 sc1
    s_add_u32 s32, s32, 4096
    buffer_load_dwordx4 v[16:19], v251, s[4:7], s32 offen offset:0 sc1
    buffer_load_dwordx4 v[20:23], v251, s[4:7], s32 offen offset:1024 sc1
    buffer_load_dwordx4 v[24:27], v251, s[4:7], s32 offen offset:2048 sc1
    buffer_load_dwordx4 v[28:31], v251, s[4:7], s32 offen offset:3072 sc1
    s_add_u32 s32, s32, 28672
    buffer_load_dwordx4 v[32:35], v251, s[4:7], s32 offen offset:0 sc1
    buffer_load_dwordx4 v[36:39], v251, s[4:7], s32 offen offset:1024 sc1
    buffer_load_dwordx4 v[40:43], v251, s[4:7], s32 offen offset:2048 sc1
    buffer_load_dwordx4 v[44:47], v251, s[4:7], s32 offen offset:3072 sc1
    s_add_u32 s32, s32, 4096
    buffer_load_dwordx4 v[48:51], v251, s[4:7], s32 offen offset:0 sc1
    buffer_load_dwordx4 v[52:55], v251, s[4:7], s32 offen offset:1024 sc1
    buffer_load_dwordx4 v[56:59], v251, s[4:7], s32 offen offset:2048 sc1
    buffer_load_dwordx4 v[60:63], v251, s[4:7], s32 offen offset:3072 sc1
    s_add_u32 s32, s32, 28672
    v_and_b32 v255, 15, v250
    v_lshlrev_b32 v254, 6, v255
    v_add_u32 v254, 132096, v254
    v_lshrrev_b32 v255, 4, v250
    v_lshl_add_u32 v253, v255, 2, v254
    v_lshl_add_u32 v253, s14, 4, v253
    s_waitcnt vmcnt(8)
    v_lshlrev_b32 v128, 16, v0
    v_and_b32 v129, 0xffff0000, v0
    v_lshlrev_b32 v130, 16, v1
    v_and_b32 v131, 0xffff0000, v1
    v_lshlrev_b32 v132, 16, v2
    v_and_b32 v133, 0xffff0000, v2
    v_lshlrev_b32 v134, 16, v3
    v_and_b32 v135, 0xffff0000, v3
    v_lshlrev_b32 v136, 16, v4
    v_and_b32 v137, 0xffff0000, v4
    v_lshlrev_b32 v138, 16, v5
    v_and_b32 v139, 0xffff0000, v5
    v_lshlrev_b32 v140, 16, v6
    v_and_b32 v141, 0xffff0000, v6
    v_lshlrev_b32 v142, 16, v7
    v_and_b32 v143, 0xffff0000, v7
    v_lshlrev_b32 v144, 16, v8
    v_and_b32 v145, 0xffff0000, v8
    v_lshlrev_b32 v146, 16, v9
    v_and_b32 v147, 0xffff0000, v9
    v_lshlrev_b32 v148, 16, v10
    v_and_b32 v149, 0xffff0000, v10
    v_lshlrev_b32 v150, 16, v11
    v_and_b32 v151, 0xffff0000, v11
    v_lshlrev_b32 v152, 16, v12
    v_and_b32 v153, 0xffff0000, v12
    v_lshlrev_b32 v154, 16, v13
    v_and_b32 v155, 0xffff0000, v13
    v_lshlrev_b32 v156, 16, v14
    v_and_b32 v157, 0xffff0000, v14
    v_lshlrev_b32 v158, 16, v15
    v_and_b32 v159, 0xffff0000, v15
    v_lshlrev_b32 v160, 16, v16
    v_and_b32 v161, 0xffff0000, v16
    v_lshlrev_b32 v162, 16, v17
    v_and_b32 v163, 0xffff0000, v17
    v_lshlrev_b32 v164, 16, v18
    v_and_b32 v165, 0xffff0000, v18
    v_lshlrev_b32 v166, 16, v19
    v_and_b32 v167, 0xffff0000, v19
    v_lshlrev_b32 v168, 16, v20
    v_and_b32 v169, 0xffff0000, v20
    v_lshlrev_b32 v170, 16, v21
    v_and_b32 v171, 0xffff0000, v21
    v_lshlrev_b32 v172, 16, v22
    v_and_b32 v173, 0xffff0000, v22
    v_lshlrev_b32 v174, 16, v23
    v_and_b32 v175, 0xffff0000, v23
    v_lshlrev_b32 v176, 16, v24
    v_and_b32 v177, 0xffff0000, v24
    v_lshlrev_b32 v178, 16, v25
    v_and_b32 v179, 0xffff0000, v25
    v_lshlrev_b32 v180, 16, v26
    v_and_b32 v181, 0xffff0000, v26
    v_lshlrev_b32 v182, 16, v27
    v_and_b32 v183, 0xffff0000, v27
    v_lshlrev_b32 v184, 16, v28
    v_and_b32 v185, 0xffff0000, v28
    v_lshlrev_b32 v186, 16, v29
    v_and_b32 v187, 0xffff0000, v29
    v_lshlrev_b32 v188, 16, v30
    v_and_b32 v189, 0xffff0000, v30
    v_lshlrev_b32 v190, 16, v31
    v_and_b32 v191, 0xffff0000, v31
    v_pk_add_f32 v[192:193], v[128:129], v[136:137]
    v_pk_add_f32 v[194:195], v[130:131], v[138:139]
    v_pk_add_f32 v[196:197], v[132:133], v[140:141]
    v_pk_add_f32 v[198:199], v[134:135], v[142:143]
    v_pk_add_f32 v[192:193], v[192:193], v[144:145]
    v_pk_add_f32 v[194:195], v[194:195], v[146:147]
    v_pk_add_f32 v[196:197], v[196:197], v[148:149]
    v_pk_add_f32 v[198:199], v[198:199], v[150:151]
    v_pk_add_f32 v[192:193], v[192:193], v[152:153]
    v_pk_add_f32 v[194:195], v[194:195], v[154:155]
    v_pk_add_f32 v[196:197], v[196:197], v[156:157]
    v_pk_add_f32 v[198:199], v[198:199], v[158:159]
    v_pk_add_f32 v[192:193], v[192:193], v[160:161]
    v_pk_add_f32 v[194:195], v[194:195], v[162:163]
    v_pk_add_f32 v[196:197], v[196:197], v[164:165]
    v_pk_add_f32 v[198:199], v[198:199], v[166:167]
    v_pk_add_f32 v[192:193], v[192:193], v[168:169]
    v_pk_add_f32 v[194:195], v[194:195], v[170:171]
    v_pk_add_f32 v[196:197], v[196:197], v[172:173]
    v_pk_add_f32 v[198:199], v[198:199], v[174:175]
    v_pk_add_f32 v[192:193], v[192:193], v[176:177]
    v_pk_add_f32 v[194:195], v[194:195], v[178:179]
    v_pk_add_f32 v[196:197], v[196:197], v[180:181]
    v_pk_add_f32 v[198:199], v[198:199], v[182:183]
    v_pk_add_f32 v[192:193], v[192:193], v[184:185]
    v_pk_add_f32 v[194:195], v[194:195], v[186:187]
    v_pk_add_f32 v[196:197], v[196:197], v[188:189]
    v_pk_add_f32 v[198:199], v[198:199], v[190:191]
    v_pk_add_f32 v[192:193], v[192:193], v[194:195]
    v_pk_add_f32 v[196:197], v[196:197], v[198:199]
    v_pk_add_f32 v[192:193], v[192:193], v[196:197]
    v_add_f32 v192, v192, v193
    ds_write_b32 v253, v192 offset:0
    s_waitcnt lgkmcnt(0)
    s_barrier
    ds_read_b128 v[192:195], v254 offset:0
    ds_read_b128 v[196:199], v254 offset:16
    ds_read_b128 v[200:203], v254 offset:32
    ds_read_b128 v[204:207], v254 offset:48
    s_waitcnt lgkmcnt(2)
    v_pk_add_f32 v[192:193], v[192:193], v[194:195]
    v_pk_add_f32 v[196:197], v[196:197], v[198:199]
    s_waitcnt lgkmcnt(0)
    v_pk_add_f32 v[200:201], v[200:201], v[202:203]
    v_pk_add_f32 v[204:205], v[204:205], v[206:207]
    v_pk_add_f32 v[192:193], v[192:193], v[196:197]
    v_pk_add_f32 v[200:201], v[200:201], v[204:205]
    v_pk_add_f32 v[192:193], v[192:193], v[200:201]
    v_add_f32 v192, v192, v193
    v_mul_f32 v192, 0xba800000, v192
    v_mov_b32 v193, v192
    v_pk_add_f32 v[128:129], v[128:129], v[192:193]
    v_pk_add_f32 v[130:131], v[130:131], v[192:193]
    v_pk_add_f32 v[132:133], v[132:133], v[192:193]
    v_pk_add_f32 v[134:135], v[134:135], v[192:193]
    v_pk_add_f32 v[136:137], v[136:137], v[192:193]
    v_pk_add_f32 v[138:139], v[138:139], v[192:193]
    v_pk_add_f32 v[140:141], v[140:141], v[192:193]
    v_pk_add_f32 v[142:143], v[142:143], v[192:193]
    v_pk_add_f32 v[144:145], v[144:145], v[192:193]
    v_pk_add_f32 v[146:147], v[146:147], v[192:193]
    v_pk_add_f32 v[148:149], v[148:149], v[192:193]
    v_pk_add_f32 v[150:151], v[150:151], v[192:193]
    v_pk_add_f32 v[152:153], v[152:153], v[192:193]
    v_pk_add_f32 v[154:155], v[154:155], v[192:193]
    v_pk_add_f32 v[156:157], v[156:157], v[192:193]
    v_pk_add_f32 v[158:159], v[158:159], v[192:193]
    v_pk_add_f32 v[160:161], v[160:161], v[192:193]
    v_pk_add_f32 v[162:163], v[162:163], v[192:193]
    v_pk_add_f32 v[164:165], v[164:165], v[192:193]
    v_pk_add_f32 v[166:167], v[166:167], v[192:193]
    v_pk_add_f32 v[168:169], v[168:169], v[192:193]
    v_pk_add_f32 v[170:171], v[170:171], v[192:193]
    v_pk_add_f32 v[172:173], v[172:173], v[192:193]
    v_pk_add_f32 v[174:175], v[174:175], v[192:193]
    v_pk_add_f32 v[176:177], v[176:177], v[192:193]
    v_pk_add_f32 v[178:179], v[178:179], v[192:193]
    v_pk_add_f32 v[180:181], v[180:181], v[192:193]
    v_pk_add_f32 v[182:183], v[182:183], v[192:193]
    v_pk_add_f32 v[184:185], v[184:185], v[192:193]
    v_pk_add_f32 v[186:187], v[186:187], v[192:193]
    v_pk_add_f32 v[188:189], v[188:189], v[192:193]
    v_pk_add_f32 v[190:191], v[190:191], v[192:193]
    v_pk_mul_f32 v[192:193], v[128:129], v[128:129]
    v_pk_mul_f32 v[194:195], v[130:131], v[130:131]
    v_pk_mul_f32 v[196:197], v[132:133], v[132:133]
    v_pk_mul_f32 v[198:199], v[134:135], v[134:135]
    v_pk_fma_f32 v[192:193], v[136:137], v[136:137], v[192:193]
    v_pk_fma_f32 v[194:195], v[138:139], v[138:139], v[194:195]
    v_pk_fma_f32 v[196:197], v[140:141], v[140:141], v[196:197]
    v_pk_fma_f32 v[198:199], v[142:143], v[142:143], v[198:199]
    v_pk_fma_f32 v[192:193], v[144:145], v[144:145], v[192:193]
    v_pk_fma_f32 v[194:195], v[146:147], v[146:147], v[194:195]
    v_pk_fma_f32 v[196:197], v[148:149], v[148:149], v[196:197]
    v_pk_fma_f32 v[198:199], v[150:151], v[150:151], v[198:199]
    v_pk_fma_f32 v[192:193], v[152:153], v[152:153], v[192:193]
    v_pk_fma_f32 v[194:195], v[154:155], v[154:155], v[194:195]
    v_pk_fma_f32 v[196:197], v[156:157], v[156:157], v[196:197]
    v_pk_fma_f32 v[198:199], v[158:159], v[158:159], v[198:199]
    v_pk_fma_f32 v[192:193], v[160:161], v[160:161], v[192:193]
    v_pk_fma_f32 v[194:195], v[162:163], v[162:163], v[194:195]
    v_pk_fma_f32 v[196:197], v[164:165], v[164:165], v[196:197]
    v_pk_fma_f32 v[198:199], v[166:167], v[166:167], v[198:199]
    v_pk_fma_f32 v[192:193], v[168:169], v[168:169], v[192:193]
    v_pk_fma_f32 v[194:195], v[170:171], v[170:171], v[194:195]
    v_pk_fma_f32 v[196:197], v[172:173], v[172:173], v[196:197]
    v_pk_fma_f32 v[198:199], v[174:175], v[174:175], v[198:199]
    v_pk_fma_f32 v[192:193], v[176:177], v[176:177], v[192:193]
    v_pk_fma_f32 v[194:195], v[178:179], v[178:179], v[194:195]
    v_pk_fma_f32 v[196:197], v[180:181], v[180:181], v[196:197]
    v_pk_fma_f32 v[198:199], v[182:183], v[182:183], v[198:199]
    v_pk_fma_f32 v[192:193], v[184:185], v[184:185], v[192:193]
    v_pk_fma_f32 v[194:195], v[186:187], v[186:187], v[194:195]
    v_pk_fma_f32 v[196:197], v[188:189], v[188:189], v[196:197]
    v_pk_fma_f32 v[198:199], v[190:191], v[190:191], v[198:199]
    v_pk_add_f32 v[192:193], v[192:193], v[194:195]
    v_pk_add_f32 v[196:197], v[196:197], v[198:199]
    v_pk_add_f32 v[192:193], v[192:193], v[196:197]
    v_add_f32 v192, v192, v193
    ds_write_b32 v253, v192 offset:1024
    s_waitcnt lgkmcnt(0)
    s_barrier
    ds_read_b128 v[192:195], v254 offset:1024
    ds_read_b128 v[196:199], v254 offset:1040
    ds_read_b128 v[200:203], v254 offset:1056
    ds_read_b128 v[204:207], v254 offset:1072
    s_waitcnt lgkmcnt(2)
    v_pk_add_f32 v[192:193], v[192:193], v[194:195]
    v_pk_add_f32 v[196:197], v[196:197], v[198:199]
    s_waitcnt lgkmcnt(0)
    v_pk_add_f32 v[200:201], v[200:201], v[202:203]
    v_pk_add_f32 v[204:205], v[204:205], v[206:207]
    v_pk_add_f32 v[192:193], v[192:193], v[196:197]
    v_pk_add_f32 v[200:201], v[200:201], v[204:205]
    v_pk_add_f32 v[192:193], v[192:193], v[200:201]
    v_add_f32 v192, v192, v193
    v_mov_b32 v193, 0x3727c5ac
    v_fmac_f32 v193, 0x3a800000, v192
    v_rsq_f32 v192, v193
    s_nop 0
    v_mov_b32 v193, v192
    v_pk_mul_f32 v[128:129], v[128:129], v[192:193]
    v_pk_mul_f32 v[130:131], v[130:131], v[192:193]
    v_pk_mul_f32 v[132:133], v[132:133], v[192:193]
    v_pk_mul_f32 v[134:135], v[134:135], v[192:193]
    v_pk_mul_f32 v[136:137], v[136:137], v[192:193]
    v_pk_mul_f32 v[138:139], v[138:139], v[192:193]
    v_pk_mul_f32 v[140:141], v[140:141], v[192:193]
    v_pk_mul_f32 v[142:143], v[142:143], v[192:193]
    v_pk_mul_f32 v[144:145], v[144:145], v[192:193]
    v_pk_mul_f32 v[146:147], v[146:147], v[192:193]
    v_pk_mul_f32 v[148:149], v[148:149], v[192:193]
    v_pk_mul_f32 v[150:151], v[150:151], v[192:193]
    v_pk_mul_f32 v[152:153], v[152:153], v[192:193]
    v_pk_mul_f32 v[154:155], v[154:155], v[192:193]
    v_pk_mul_f32 v[156:157], v[156:157], v[192:193]
    v_pk_mul_f32 v[158:159], v[158:159], v[192:193]
    v_pk_mul_f32 v[160:161], v[160:161], v[192:193]
    v_pk_mul_f32 v[162:163], v[162:163], v[192:193]
    v_pk_mul_f32 v[164:165], v[164:165], v[192:193]
    v_pk_mul_f32 v[166:167], v[166:167], v[192:193]
    v_pk_mul_f32 v[168:169], v[168:169], v[192:193]
    v_pk_mul_f32 v[170:171], v[170:171], v[192:193]
    v_pk_mul_f32 v[172:173], v[172:173], v[192:193]
    v_pk_mul_f32 v[174:175], v[174:175], v[192:193]
    v_pk_mul_f32 v[176:177], v[176:177], v[192:193]
    v_pk_mul_f32 v[178:179], v[178:179], v[192:193]
    v_pk_mul_f32 v[180:181], v[180:181], v[192:193]
    v_pk_mul_f32 v[182:183], v[182:183], v[192:193]
    v_pk_mul_f32 v[184:185], v[184:185], v[192:193]
    v_pk_mul_f32 v[186:187], v[186:187], v[192:193]
    v_pk_mul_f32 v[188:189], v[188:189], v[192:193]
    v_pk_mul_f32 v[190:191], v[190:191], v[192:193]
    v_cvt_pk_bf16_f32 v0, v128, v129
    v_cvt_pk_bf16_f32 v1, v130, v131
    v_cvt_pk_bf16_f32 v2, v132, v133
    v_cvt_pk_bf16_f32 v3, v134, v135
    v_cvt_pk_bf16_f32 v4, v136, v137
    v_cvt_pk_bf16_f32 v5, v138, v139
    v_cvt_pk_bf16_f32 v6, v140, v141
    v_cvt_pk_bf16_f32 v7, v142, v143
    v_cvt_pk_bf16_f32 v8, v144, v145
    v_cvt_pk_bf16_f32 v9, v146, v147
    v_cvt_pk_bf16_f32 v10, v148, v149
    v_cvt_pk_bf16_f32 v11, v150, v151
    v_cvt_pk_bf16_f32 v12, v152, v153
    v_cvt_pk_bf16_f32 v13, v154, v155
    v_cvt_pk_bf16_f32 v14, v156, v157
    v_cvt_pk_bf16_f32 v15, v158, v159
    v_cvt_pk_bf16_f32 v16, v160, v161
    v_cvt_pk_bf16_f32 v17, v162, v163
    v_cvt_pk_bf16_f32 v18, v164, v165
    v_cvt_pk_bf16_f32 v19, v166, v167
    v_cvt_pk_bf16_f32 v20, v168, v169
    v_cvt_pk_bf16_f32 v21, v170, v171
    v_cvt_pk_bf16_f32 v22, v172, v173
    v_cvt_pk_bf16_f32 v23, v174, v175
    v_cvt_pk_bf16_f32 v24, v176, v177
    v_cvt_pk_bf16_f32 v25, v178, v179
    v_cvt_pk_bf16_f32 v26, v180, v181
    v_cvt_pk_bf16_f32 v27, v182, v183
    v_cvt_pk_bf16_f32 v28, v184, v185
    v_cvt_pk_bf16_f32 v29, v186, v187
    v_cvt_pk_bf16_f32 v30, v188, v189
    v_cvt_pk_bf16_f32 v31, v190, v191
    buffer_store_dwordx4 v[0:3], v251, s[4:7], s21 offen offset:0 sc1
    buffer_store_dwordx4 v[4:7], v251, s[4:7], s21 offen offset:1024 sc1
    buffer_store_dwordx4 v[8:11], v251, s[4:7], s21 offen offset:2048 sc1
    buffer_store_dwordx4 v[12:15], v251, s[4:7], s21 offen offset:3072 sc1
    s_add_u32 s21, s21, 4096
    buffer_store_dwordx4 v[16:19], v251, s[4:7], s21 offen offset:0 sc1
    buffer_store_dwordx4 v[20:23], v251, s[4:7], s21 offen offset:1024 sc1
    buffer_store_dwordx4 v[24:27], v251, s[4:7], s21 offen offset:2048 sc1
    buffer_store_dwordx4 v[28:31], v251, s[4:7], s21 offen offset:3072 sc1
    s_add_u32 s21, s21, 28672
    s_waitcnt vmcnt(8)
    v_lshlrev_b32 v128, 16, v32
    v_and_b32 v129, 0xffff0000, v32
    v_lshlrev_b32 v130, 16, v33
    v_and_b32 v131, 0xffff0000, v33
    v_lshlrev_b32 v132, 16, v34
    v_and_b32 v133, 0xffff0000, v34
    v_lshlrev_b32 v134, 16, v35
    v_and_b32 v135, 0xffff0000, v35
    v_lshlrev_b32 v136, 16, v36
    v_and_b32 v137, 0xffff0000, v36
    v_lshlrev_b32 v138, 16, v37
    v_and_b32 v139, 0xffff0000, v37
    v_lshlrev_b32 v140, 16, v38
    v_and_b32 v141, 0xffff0000, v38
    v_lshlrev_b32 v142, 16, v39
    v_and_b32 v143, 0xffff0000, v39
    v_lshlrev_b32 v144, 16, v40
    v_and_b32 v145, 0xffff0000, v40
    v_lshlrev_b32 v146, 16, v41
    v_and_b32 v147, 0xffff0000, v41
    v_lshlrev_b32 v148, 16, v42
    v_and_b32 v149, 0xffff0000, v42
    v_lshlrev_b32 v150, 16, v43
    v_and_b32 v151, 0xffff0000, v43
    v_lshlrev_b32 v152, 16, v44
    v_and_b32 v153, 0xffff0000, v44
    v_lshlrev_b32 v154, 16, v45
    v_and_b32 v155, 0xffff0000, v45
    v_lshlrev_b32 v156, 16, v46
    v_and_b32 v157, 0xffff0000, v46
    v_lshlrev_b32 v158, 16, v47
    v_and_b32 v159, 0xffff0000, v47
    v_lshlrev_b32 v160, 16, v48
    v_and_b32 v161, 0xffff0000, v48
    v_lshlrev_b32 v162, 16, v49
    v_and_b32 v163, 0xffff0000, v49
    v_lshlrev_b32 v164, 16, v50
    v_and_b32 v165, 0xffff0000, v50
    v_lshlrev_b32 v166, 16, v51
    v_and_b32 v167, 0xffff0000, v51
    v_lshlrev_b32 v168, 16, v52
    v_and_b32 v169, 0xffff0000, v52
    v_lshlrev_b32 v170, 16, v53
    v_and_b32 v171, 0xffff0000, v53
    v_lshlrev_b32 v172, 16, v54
    v_and_b32 v173, 0xffff0000, v54
    v_lshlrev_b32 v174, 16, v55
    v_and_b32 v175, 0xffff0000, v55
    v_lshlrev_b32 v176, 16, v56
    v_and_b32 v177, 0xffff0000, v56
    v_lshlrev_b32 v178, 16, v57
    v_and_b32 v179, 0xffff0000, v57
    v_lshlrev_b32 v180, 16, v58
    v_and_b32 v181, 0xffff0000, v58
    v_lshlrev_b32 v182, 16, v59
    v_and_b32 v183, 0xffff0000, v59
    v_lshlrev_b32 v184, 16, v60
    v_and_b32 v185, 0xffff0000, v60
    v_lshlrev_b32 v186, 16, v61
    v_and_b32 v187, 0xffff0000, v61
    v_lshlrev_b32 v188, 16, v62
    v_and_b32 v189, 0xffff0000, v62
    v_lshlrev_b32 v190, 16, v63
    v_and_b32 v191, 0xffff0000, v63
    v_pk_add_f32 v[192:193], v[128:129], v[136:137]
    v_pk_add_f32 v[194:195], v[130:131], v[138:139]
    v_pk_add_f32 v[196:197], v[132:133], v[140:141]
    v_pk_add_f32 v[198:199], v[134:135], v[142:143]
    v_pk_add_f32 v[192:193], v[192:193], v[144:145]
    v_pk_add_f32 v[194:195], v[194:195], v[146:147]
    v_pk_add_f32 v[196:197], v[196:197], v[148:149]
    v_pk_add_f32 v[198:199], v[198:199], v[150:151]
    v_pk_add_f32 v[192:193], v[192:193], v[152:153]
    v_pk_add_f32 v[194:195], v[194:195], v[154:155]
    v_pk_add_f32 v[196:197], v[196:197], v[156:157]
    v_pk_add_f32 v[198:199], v[198:199], v[158:159]
    v_pk_add_f32 v[192:193], v[192:193], v[160:161]
    v_pk_add_f32 v[194:195], v[194:195], v[162:163]
    v_pk_add_f32 v[196:197], v[196:197], v[164:165]
    v_pk_add_f32 v[198:199], v[198:199], v[166:167]
    v_pk_add_f32 v[192:193], v[192:193], v[168:169]
    v_pk_add_f32 v[194:195], v[194:195], v[170:171]
    v_pk_add_f32 v[196:197], v[196:197], v[172:173]
    v_pk_add_f32 v[198:199], v[198:199], v[174:175]
    v_pk_add_f32 v[192:193], v[192:193], v[176:177]
    v_pk_add_f32 v[194:195], v[194:195], v[178:179]
    v_pk_add_f32 v[196:197], v[196:197], v[180:181]
    v_pk_add_f32 v[198:199], v[198:199], v[182:183]
    v_pk_add_f32 v[192:193], v[192:193], v[184:185]
    v_pk_add_f32 v[194:195], v[194:195], v[186:187]
    v_pk_add_f32 v[196:197], v[196:197], v[188:189]
    v_pk_add_f32 v[198:199], v[198:199], v[190:191]
    v_pk_add_f32 v[192:193], v[192:193], v[194:195]
    v_pk_add_f32 v[196:197], v[196:197], v[198:199]
    v_pk_add_f32 v[192:193], v[192:193], v[196:197]
    v_add_f32 v192, v192, v193
    ds_write_b32 v253, v192 offset:0
    s_waitcnt lgkmcnt(0)
    s_barrier
    ds_read_b128 v[192:195], v254 offset:0
    ds_read_b128 v[196:199], v254 offset:16
    ds_read_b128 v[200:203], v254 offset:32
    ds_read_b128 v[204:207], v254 offset:48
    s_waitcnt lgkmcnt(2)
    v_pk_add_f32 v[192:193], v[192:193], v[194:195]
    v_pk_add_f32 v[196:197], v[196:197], v[198:199]
    s_waitcnt lgkmcnt(0)
    v_pk_add_f32 v[200:201], v[200:201], v[202:203]
    v_pk_add_f32 v[204:205], v[204:205], v[206:207]
    v_pk_add_f32 v[192:193], v[192:193], v[196:197]
    v_pk_add_f32 v[200:201], v[200:201], v[204:205]
    v_pk_add_f32 v[192:193], v[192:193], v[200:201]
    v_add_f32 v192, v192, v193
    v_mul_f32 v192, 0xba800000, v192
    v_mov_b32 v193, v192
    v_pk_add_f32 v[128:129], v[128:129], v[192:193]
    v_pk_add_f32 v[130:131], v[130:131], v[192:193]
    v_pk_add_f32 v[132:133], v[132:133], v[192:193]
    v_pk_add_f32 v[134:135], v[134:135], v[192:193]
    v_pk_add_f32 v[136:137], v[136:137], v[192:193]
    v_pk_add_f32 v[138:139], v[138:139], v[192:193]
    v_pk_add_f32 v[140:141], v[140:141], v[192:193]
    v_pk_add_f32 v[142:143], v[142:143], v[192:193]
    v_pk_add_f32 v[144:145], v[144:145], v[192:193]
    v_pk_add_f32 v[146:147], v[146:147], v[192:193]
    v_pk_add_f32 v[148:149], v[148:149], v[192:193]
    v_pk_add_f32 v[150:151], v[150:151], v[192:193]
    v_pk_add_f32 v[152:153], v[152:153], v[192:193]
    v_pk_add_f32 v[154:155], v[154:155], v[192:193]
    v_pk_add_f32 v[156:157], v[156:157], v[192:193]
    v_pk_add_f32 v[158:159], v[158:159], v[192:193]
    v_pk_add_f32 v[160:161], v[160:161], v[192:193]
    v_pk_add_f32 v[162:163], v[162:163], v[192:193]
    v_pk_add_f32 v[164:165], v[164:165], v[192:193]
    v_pk_add_f32 v[166:167], v[166:167], v[192:193]
    v_pk_add_f32 v[168:169], v[168:169], v[192:193]
    v_pk_add_f32 v[170:171], v[170:171], v[192:193]
    v_pk_add_f32 v[172:173], v[172:173], v[192:193]
    v_pk_add_f32 v[174:175], v[174:175], v[192:193]
    v_pk_add_f32 v[176:177], v[176:177], v[192:193]
    v_pk_add_f32 v[178:179], v[178:179], v[192:193]
    v_pk_add_f32 v[180:181], v[180:181], v[192:193]
    v_pk_add_f32 v[182:183], v[182:183], v[192:193]
    v_pk_add_f32 v[184:185], v[184:185], v[192:193]
    v_pk_add_f32 v[186:187], v[186:187], v[192:193]
    v_pk_add_f32 v[188:189], v[188:189], v[192:193]
    v_pk_add_f32 v[190:191], v[190:191], v[192:193]
    v_pk_mul_f32 v[192:193], v[128:129], v[128:129]
    v_pk_mul_f32 v[194:195], v[130:131], v[130:131]
    v_pk_mul_f32 v[196:197], v[132:133], v[132:133]
    v_pk_mul_f32 v[198:199], v[134:135], v[134:135]
    v_pk_fma_f32 v[192:193], v[136:137], v[136:137], v[192:193]
    v_pk_fma_f32 v[194:195], v[138:139], v[138:139], v[194:195]
    v_pk_fma_f32 v[196:197], v[140:141], v[140:141], v[196:197]
    v_pk_fma_f32 v[198:199], v[142:143], v[142:143], v[198:199]
    v_pk_fma_f32 v[192:193], v[144:145], v[144:145], v[192:193]
    v_pk_fma_f32 v[194:195], v[146:147], v[146:147], v[194:195]
    v_pk_fma_f32 v[196:197], v[148:149], v[148:149], v[196:197]
    v_pk_fma_f32 v[198:199], v[150:151], v[150:151], v[198:199]
    v_pk_fma_f32 v[192:193], v[152:153], v[152:153], v[192:193]
    v_pk_fma_f32 v[194:195], v[154:155], v[154:155], v[194:195]
    v_pk_fma_f32 v[196:197], v[156:157], v[156:157], v[196:197]
    v_pk_fma_f32 v[198:199], v[158:159], v[158:159], v[198:199]
    v_pk_fma_f32 v[192:193], v[160:161], v[160:161], v[192:193]
    v_pk_fma_f32 v[194:195], v[162:163], v[162:163], v[194:195]
    v_pk_fma_f32 v[196:197], v[164:165], v[164:165], v[196:197]
    v_pk_fma_f32 v[198:199], v[166:167], v[166:167], v[198:199]
    v_pk_fma_f32 v[192:193], v[168:169], v[168:169], v[192:193]
    v_pk_fma_f32 v[194:195], v[170:171], v[170:171], v[194:195]
    v_pk_fma_f32 v[196:197], v[172:173], v[172:173], v[196:197]
    v_pk_fma_f32 v[198:199], v[174:175], v[174:175], v[198:199]
    v_pk_fma_f32 v[192:193], v[176:177], v[176:177], v[192:193]
    v_pk_fma_f32 v[194:195], v[178:179], v[178:179], v[194:195]
    v_pk_fma_f32 v[196:197], v[180:181], v[180:181], v[196:197]
    v_pk_fma_f32 v[198:199], v[182:183], v[182:183], v[198:199]
    v_pk_fma_f32 v[192:193], v[184:185], v[184:185], v[192:193]
    v_pk_fma_f32 v[194:195], v[186:187], v[186:187], v[194:195]
    v_pk_fma_f32 v[196:197], v[188:189], v[188:189], v[196:197]
    v_pk_fma_f32 v[198:199], v[190:191], v[190:191], v[198:199]
    v_pk_add_f32 v[192:193], v[192:193], v[194:195]
    v_pk_add_f32 v[196:197], v[196:197], v[198:199]
    v_pk_add_f32 v[192:193], v[192:193], v[196:197]
    v_add_f32 v192, v192, v193
    ds_write_b32 v253, v192 offset:1024
    s_waitcnt lgkmcnt(0)
    s_barrier
    ds_read_b128 v[192:195], v254 offset:1024
    ds_read_b128 v[196:199], v254 offset:1040
    ds_read_b128 v[200:203], v254 offset:1056
    ds_read_b128 v[204:207], v254 offset:1072
    s_waitcnt lgkmcnt(2)
    v_pk_add_f32 v[192:193], v[192:193], v[194:195]
    v_pk_add_f32 v[196:197], v[196:197], v[198:199]
    s_waitcnt lgkmcnt(0)
    v_pk_add_f32 v[200:201], v[200:201], v[202:203]
    v_pk_add_f32 v[204:205], v[204:205], v[206:207]
    v_pk_add_f32 v[192:193], v[192:193], v[196:197]
    v_pk_add_f32 v[200:201], v[200:201], v[204:205]
    v_pk_add_f32 v[192:193], v[192:193], v[200:201]
    v_add_f32 v192, v192, v193
    v_mov_b32 v193, 0x3727c5ac
    v_fmac_f32 v193, 0x3a800000, v192
    v_rsq_f32 v192, v193
    s_nop 0
    v_mov_b32 v193, v192
    v_pk_mul_f32 v[128:129], v[128:129], v[192:193]
    v_pk_mul_f32 v[130:131], v[130:131], v[192:193]
    v_pk_mul_f32 v[132:133], v[132:133], v[192:193]
    v_pk_mul_f32 v[134:135], v[134:135], v[192:193]
    v_pk_mul_f32 v[136:137], v[136:137], v[192:193]
    v_pk_mul_f32 v[138:139], v[138:139], v[192:193]
    v_pk_mul_f32 v[140:141], v[140:141], v[192:193]
    v_pk_mul_f32 v[142:143], v[142:143], v[192:193]
    v_pk_mul_f32 v[144:145], v[144:145], v[192:193]
    v_pk_mul_f32 v[146:147], v[146:147], v[192:193]
    v_pk_mul_f32 v[148:149], v[148:149], v[192:193]
    v_pk_mul_f32 v[150:151], v[150:151], v[192:193]
    v_pk_mul_f32 v[152:153], v[152:153], v[192:193]
    v_pk_mul_f32 v[154:155], v[154:155], v[192:193]
    v_pk_mul_f32 v[156:157], v[156:157], v[192:193]
    v_pk_mul_f32 v[158:159], v[158:159], v[192:193]
    v_pk_mul_f32 v[160:161], v[160:161], v[192:193]
    v_pk_mul_f32 v[162:163], v[162:163], v[192:193]
    v_pk_mul_f32 v[164:165], v[164:165], v[192:193]
    v_pk_mul_f32 v[166:167], v[166:167], v[192:193]
    v_pk_mul_f32 v[168:169], v[168:169], v[192:193]
    v_pk_mul_f32 v[170:171], v[170:171], v[192:193]
    v_pk_mul_f32 v[172:173], v[172:173], v[192:193]
    v_pk_mul_f32 v[174:175], v[174:175], v[192:193]
    v_pk_mul_f32 v[176:177], v[176:177], v[192:193]
    v_pk_mul_f32 v[178:179], v[178:179], v[192:193]
    v_pk_mul_f32 v[180:181], v[180:181], v[192:193]
    v_pk_mul_f32 v[182:183], v[182:183], v[192:193]
    v_pk_mul_f32 v[184:185], v[184:185], v[192:193]
    v_pk_mul_f32 v[186:187], v[186:187], v[192:193]
    v_pk_mul_f32 v[188:189], v[188:189], v[192:193]
    v_pk_mul_f32 v[190:191], v[190:191], v[192:193]
    v_cvt_pk_bf16_f32 v32, v128, v129
    v_cvt_pk_bf16_f32 v33, v130, v131
    v_cvt_pk_bf16_f32 v34, v132, v133
    v_cvt_pk_bf16_f32 v35, v134, v135
    v_cvt_pk_bf16_f32 v36, v136, v137
    v_cvt_pk_bf16_f32 v37, v138, v139
    v_cvt_pk_bf16_f32 v38, v140, v141
    v_cvt_pk_bf16_f32 v39, v142, v143
    v_cvt_pk_bf16_f32 v40, v144, v145
    v_cvt_pk_bf16_f32 v41, v146, v147
    v_cvt_pk_bf16_f32 v42, v148, v149
    v_cvt_pk_bf16_f32 v43, v150, v151
    v_cvt_pk_bf16_f32 v44, v152, v153
    v_cvt_pk_bf16_f32 v45, v154, v155
    v_cvt_pk_bf16_f32 v46, v156, v157
    v_cvt_pk_bf16_f32 v47, v158, v159
    v_cvt_pk_bf16_f32 v48, v160, v161
    v_cvt_pk_bf16_f32 v49, v162, v163
    v_cvt_pk_bf16_f32 v50, v164, v165
    v_cvt_pk_bf16_f32 v51, v166, v167
    v_cvt_pk_bf16_f32 v52, v168, v169
    v_cvt_pk_bf16_f32 v53, v170, v171
    v_cvt_pk_bf16_f32 v54, v172, v173
    v_cvt_pk_bf16_f32 v55, v174, v175
    v_cvt_pk_bf16_f32 v56, v176, v177
    v_cvt_pk_bf16_f32 v57, v178, v179
    v_cvt_pk_bf16_f32 v58, v180, v181
    v_cvt_pk_bf16_f32 v59, v182, v183
    v_cvt_pk_bf16_f32 v60, v184, v185
    v_cvt_pk_bf16_f32 v61, v186, v187
    v_cvt_pk_bf16_f32 v62, v188, v189
    v_cvt_pk_bf16_f32 v63, v190, v191
    buffer_store_dwordx4 v[32:35], v251, s[4:7], s21 offen offset:0 sc1
    buffer_store_dwordx4 v[36:39], v251, s[4:7], s21 offen offset:1024 sc1
    buffer_store_dwordx4 v[40:43], v251, s[4:7], s21 offen offset:2048 sc1
    buffer_store_dwordx4 v[44:47], v251, s[4:7], s21 offen offset:3072 sc1
    s_add_u32 s21, s21, 4096
    buffer_store_dwordx4 v[48:51], v251, s[4:7], s21 offen offset:0 sc1
    buffer_store_dwordx4 v[52:55], v251, s[4:7], s21 offen offset:1024 sc1
    buffer_store_dwordx4 v[56:59], v251, s[4:7], s21 offen offset:2048 sc1
    buffer_store_dwordx4 v[60:63], v251, s[4:7], s21 offen offset:3072 sc1
    s_add_u32 s21, s21, 28672
    s_mov_b32 s54, 0
main_kernel_w_done:
    s_cmp_eq_u32 s14, 0
    s_cbranch_scc1 main_kernel_w_dw0
    s_waitcnt vmcnt(0)
    s_barrier
    s_branch main_kernel_w_bar
main_kernel_w_dw0:
    s_add_u32 s32, s23, 1
    s_bitcmp0_b32 s32, 2
    s_cselect_b32 s34, 4, 9
    s_cselect_b32 s35, 8, 4
    s_lshl_b32 s32, s23, 13
    s_add_u32 s56, s32, 0x8404000
    v_lshrrev_b32 v253, 1, v250
    v_add_u32 v253, s24, v253
    v_lshlrev_b32 v253, s34, v253
    v_and_b32 v254, 1, v250
    v_add_u32 v254, s25, v254
    v_lshlrev_b32 v254, s35, v254
    v_add_u32 v249, v254, v253
    s_lshl_b32 s57, 1, s54
    s_mov_b32 s28, s55
    s_cmp_eq_u32 s55, -1
    s_cbranch_scc0 main_kernel_w_have
    s_branch main_kernel_w_try
.section .rodata,"a"
.p2align 6
.amdhsa_kernel main_kernel
  .amdhsa_next_free_vgpr 512
  .amdhsa_next_free_sgpr 102
  .amdhsa_accum_offset 256
  .amdhsa_group_segment_fixed_size 0
  .amdhsa_kernarg_size 120
  .amdhsa_user_sgpr_count 2
  .amdhsa_user_sgpr_kernarg_segment_ptr 1
  .amdhsa_system_sgpr_workgroup_id_x 1
.end_amdhsa_kernel
```

```asm
; @launch kernel=main_kernel grid=(256,1,1) block=(256,1,1) lds=163840
.amdgcn_target "amdgcn-amd-amdhsa--gfx950"
.text
.text
.globl main_kernel
.p2align 8
.type main_kernel,@function
main_kernel:
    s_load_dwordx4 s[20:23], s[0:1], 104
    s_load_dwordx8 s[40:47], s[0:1], 16
    s_load_dwordx8 s[64:71], s[0:1], 64
    s_load_dwordx2 s[72:73], s[0:1], 0
    s_load_dwordx2 s[74:75], s[0:1], 96
    s_load_dwordx2 s[76:77], s[0:1], 8
    s_cmp_ge_u32 s2, 256
    s_cbranch_scc1 main_kernel_end
    v_lshrrev_b32 v126, 6, v0
    v_and_b32 v94, 63, v0
    v_and_b32 v250, 63, v0
    v_readfirstlane_b32 s14, v126
    s_mov_b32 s29, 0x80000
    s_waitcnt lgkmcnt(0)
    s_mov_b32 s60, s20
    s_and_b32 s61, s21, 0xffff
    s_mov_b32 s62, 0x100
    s_mov_b32 s63, 0x20000
    s_mov_b32 s4, s22
    s_and_b32 s5, s23, 0xffff
    s_mov_b32 s6, 0x10000000
    s_mov_b32 s7, 0x20000
    s_cmp_lg_u32 s14, 0
    s_cbranch_scc1 main_kernel_slot_wait
    s_getreg_b32 s12, hwreg(HW_REG_XCC_ID, 0, 4)
    s_and_b32 s12, s12, 7
    s_lshl_b32 s32, s12, 5
    v_mov_b32 v126, 0
    v_mov_b32 v127, 1
    s_mov_b64 exec, 1
    buffer_atomic_add v127, v126, s[60:63], s32 offen sc0 sc1
    s_waitcnt vmcnt(0)
    s_mov_b64 exec, -1
    v_readfirstlane_b32 s13, v127
    s_nop 3
    s_cmp_lt_u32 s13, 32
    s_cbranch_scc1 main_kernel_slot_pub
    v_and_b32 v126, 7, v94
    v_lshlrev_b32 v126, 5, v126
main_kernel_ovf_cnt:
    buffer_load_dword v127, v126, s[60:63], 0 offen sc1
    s_waitcnt vmcnt(0)
    v_readlane_b32 s48, v127, 0
    v_readlane_b32 s49, v127, 1
    v_readlane_b32 s50, v127, 2
    v_readlane_b32 s51, v127, 3
    v_readlane_b32 s52, v127, 4
    v_readlane_b32 s53, v127, 5
    v_readlane_b32 s54, v127, 6
    v_readlane_b32 s55, v127, 7
    s_nop 3
    s_add_u32 s33, s48, s49
    s_add_u32 s33, s33, s50
    s_add_u32 s33, s33, s51
    s_add_u32 s33, s33, s52
    s_add_u32 s33, s33, s53
    s_add_u32 s33, s33, s54
    s_add_u32 s33, s33, s55
    s_cmp_ge_u32 s33, 256
    s_cbranch_scc1 main_kernel_ovf_cnt_ok
    s_sub_u32 s29, s29, 1
    s_cbranch_scc1 main_kernel_end
    s_sleep 4
    s_branch main_kernel_ovf_cnt
main_kernel_ovf_cnt_ok:
    v_mov_b32 v126, 0
    v_mov_b32 v127, 1
    s_mov_b64 exec, 1
    buffer_atomic_add v127, v126, s[60:63], 0 offen offset:8 sc0 sc1
    s_waitcnt vmcnt(0)
    s_mov_b64 exec, -1
    v_readfirstlane_b32 s33, v127
    s_nop 3
    s_min_u32 s34, s48, 32
    s_sub_u32 s35, 32, s34
    s_mov_b32 s12, 0
    s_add_u32 s13, s34, s33
    s_cmp_lt_u32 s33, s35
    s_cbranch_scc1 main_kernel_slot_pub
    s_sub_u32 s33, s33, s35
    s_min_u32 s34, s49, 32
    s_sub_u32 s35, 32, s34
    s_mov_b32 s12, 1
    s_add_u32 s13, s34, s33
    s_cmp_lt_u32 s33, s35
    s_cbranch_scc1 main_kernel_slot_pub
    s_sub_u32 s33, s33, s35
    s_min_u32 s34, s50, 32
    s_sub_u32 s35, 32, s34
    s_mov_b32 s12, 2
    s_add_u32 s13, s34, s33
    s_cmp_lt_u32 s33, s35
    s_cbranch_scc1 main_kernel_slot_pub
    s_sub_u32 s33, s33, s35
    s_min_u32 s34, s51, 32
    s_sub_u32 s35, 32, s34
    s_mov_b32 s12, 3
    s_add_u32 s13, s34, s33
    s_cmp_lt_u32 s33, s35
    s_cbranch_scc1 main_kernel_slot_pub
    s_sub_u32 s33, s33, s35
    s_min_u32 s34, s52, 32
    s_sub_u32 s35, 32, s34
    s_mov_b32 s12, 4
    s_add_u32 s13, s34, s33
    s_cmp_lt_u32 s33, s35
    s_cbranch_scc1 main_kernel_slot_pub
    s_sub_u32 s33, s33, s35
    s_min_u32 s34, s53, 32
    s_sub_u32 s35, 32, s34
    s_mov_b32 s12, 5
    s_add_u32 s13, s34, s33
    s_cmp_lt_u32 s33, s35
    s_cbranch_scc1 main_kernel_slot_pub
    s_sub_u32 s33, s33, s35
    s_min_u32 s34, s54, 32
    s_sub_u32 s35, 32, s34
    s_mov_b32 s12, 6
    s_add_u32 s13, s34, s33
    s_cmp_lt_u32 s33, s35
    s_cbranch_scc1 main_kernel_slot_pub
    s_sub_u32 s33, s33, s35
    s_min_u32 s34, s55, 32
    s_sub_u32 s35, 32, s34
    s_mov_b32 s12, 7
    s_add_u32 s13, s34, s33
    s_cmp_lt_u32 s33, s35
    s_cbranch_scc1 main_kernel_slot_pub
    s_sub_u32 s33, s33, s35
    s_mov_b32 s12, 8
    s_mov_b32 s13, 0
main_kernel_slot_pub:
    v_mov_b32 v126, 0
    v_mov_b32 v127, s12
    v_mov_b32 v95, s13
    ds_write_b32 v126, v127
    ds_write_b32 v126, v95 offset:4
    s_waitcnt lgkmcnt(0)
main_kernel_slot_wait:
    s_barrier
    v_mov_b32 v126, 0
    ds_read_b32 v127, v126
    ds_read_b32 v95, v126 offset:4
    s_waitcnt lgkmcnt(0)
    v_readfirstlane_b32 s12, v127
    v_readfirstlane_b32 s13, v95
    s_nop 3
    s_barrier
    s_cmp_ge_u32 s12, 8
    s_cbranch_scc1 main_kernel_end
    s_cmp_lt_u32 s12, 2
    s_cbranch_scc1 main_kernel_chain
    s_mov_b32 s96, s72
    s_and_b32 s97, s73, 0xffff
    s_mov_b32 s98, 0x400000
    s_mov_b32 s99, 0x20000
    s_mov_b32 s92, s74
    s_and_b32 s93, s75, 0xffff
    s_mov_b32 s94, 0x400000
    s_mov_b32 s95, 0x20000
    v_lshlrev_b32 v1, 4, v0
    v_lshlrev_b32 v251, 4, v250
    v_mov_b32 v4, 0
    v_mov_b32 v8, -1
    v_mov_b32 v5, 0
    v_mov_b32 v9, -1
    v_mov_b32 v6, 0
    v_mov_b32 v10, -1
    v_mov_b32 v7, 0
    v_mov_b32 v11, -1
    v_mul_u32_u24 v12, 128, v0
    s_lshl_b32 s15, s12, 4
    s_and_b32 s32, s12, 1
    s_lshl_b32 s32, s32, 5
    s_cmp_lt_u32 s12, 4
    s_cselect_b32 s15, s32, s15
    s_cselect_b32 s32, 32, 16
    s_add_u32 s15, s15, s13
    s_sub_u32 s16, s15, 80
    s_sub_u32 s27, s12, 2
    s_mov_b32 s52, 0
    s_cmp_lt_u32 s13, s32
    s_cbranch_scc1 main_kernel_s_ln
    s_cmp_lg_u32 s13, 16
    s_cbranch_scc1 main_kernel_s_fill
    s_lshl_b32 s32, s16, 11
    s_add_u32 s32, s32, 0x8400000
    buffer_store_dwordx4 v[4:7], v1, s[4:7], s32 offen sc1
    s_add_u32 s32, s32, 4096
    buffer_store_dwordx4 v[4:7], v1, s[4:7], s32 offen sc1
    s_add_u32 s32, s32, 4096
    buffer_store_dwordx4 v[4:7], v1, s[4:7], s32 offen sc1
    s_add_u32 s32, s32, 4096
    buffer_store_dwordx4 v[4:7], v1, s[4:7], s32 offen sc1
    s_add_u32 s32, s32, 4096
    buffer_store_dwordx4 v[4:7], v1, s[4:7], s32 offen sc1
    s_add_u32 s32, s32, 4096
    buffer_store_dwordx4 v[4:7], v1, s[4:7], s32 offen sc1
    s_add_u32 s32, s32, 4096
    buffer_store_dwordx4 v[4:7], v1, s[4:7], s32 offen sc1
    s_add_u32 s32, s32, 4096
    buffer_store_dwordx4 v[4:7], v1, s[4:7], s32 offen sc1
    s_add_u32 s32, s32, 4096
    v_bfe_u32 v2, v0, 2, 1
    s_lshr_b32 s32, s14, 1
    v_and_b32 v2, s32, v2
    s_bitcmp1_b32 s14, 0
    s_cselect_b32 s32, 15, 0
    s_cselect_b32 s33, 4161536, 0
    v_xor_b32 v2, s32, v2
    v_lshlrev_b32 v2, 4, v2
    v_and_b32 v3, 3, v0
    v_lshl_add_u32 v2, v3, 8, v2
    v_lshrrev_b32 v3, 3, v0
    v_lshl_add_u32 v2, v3, 10, v2
    s_add_u32 s33, s33, 0x4808000
    buffer_store_dwordx4 v[4:7], v2, s[4:7], s33 offen sc1
    s_waitcnt vmcnt(0)
    s_barrier
    s_cmp_lg_u32 s14, 0
    s_cbranch_scc1 main_kernel_s_fill
    v_mov_b32 v2, 1
    s_mov_b64 exec, 1
    buffer_atomic_add v2, v4, s[60:63], 0 offen offset:12 sc1
    s_mov_b64 exec, -1
    s_branch main_kernel_s_fill
main_kernel_s_ln:
    v_and_b32 v3, 15, v250
    v_and_b32 v2, 48, v250
    v_lshl_add_u32 v3, v3, 11, v2
    s_lshl_b32 s34, s15, 15
    s_lshl_b32 s32, s14, 9
    s_add_u32 s32, s34, s32
    buffer_load_dwordx4 v[32:35], v3, s[96:99], s32 offen offset:0
    buffer_load_dwordx4 v[36:39], v3, s[96:99], s32 offen offset:64
    buffer_load_dwordx4 v[40:43], v3, s[96:99], s32 offen offset:128
    buffer_load_dwordx4 v[44:47], v3, s[96:99], s32 offen offset:192
    buffer_load_dwordx4 v[48:51], v3, s[96:99], s32 offen offset:256
    buffer_load_dwordx4 v[52:55], v3, s[96:99], s32 offen offset:320
    buffer_load_dwordx4 v[56:59], v3, s[96:99], s32 offen offset:384
    buffer_load_dwordx4 v[60:63], v3, s[96:99], s32 offen offset:448
    v_and_b32 v255, 15, v250
    v_lshlrev_b32 v254, 6, v255
    v_add_u32 v254, 132096, v254
    v_lshrrev_b32 v255, 4, v250
    v_lshl_add_u32 v253, v255, 2, v254
    v_lshl_add_u32 v253, s14, 4, v253
    s_lshl_b32 s32, s14, 13
    s_add_u32 s34, s34, s32
    s_waitcnt vmcnt(0)
    v_permlane16_swap_b32 v32, v34
    v_permlane16_swap_b32 v33, v35
    v_permlane16_swap_b32 v36, v38
    v_permlane16_swap_b32 v37, v39
    v_permlane16_swap_b32 v40, v42
    v_permlane16_swap_b32 v41, v43
    v_permlane16_swap_b32 v44, v46
    v_permlane16_swap_b32 v45, v47
    v_permlane16_swap_b32 v48, v50
    v_permlane16_swap_b32 v49, v51
    v_permlane16_swap_b32 v52, v54
    v_permlane16_swap_b32 v53, v55
    v_permlane16_swap_b32 v56, v58
    v_permlane16_swap_b32 v57, v59
    v_permlane16_swap_b32 v60, v62
    v_permlane16_swap_b32 v61, v63
    v_permlane32_swap_b32 v32, v34
    v_permlane32_swap_b32 v33, v35
    v_permlane32_swap_b32 v36, v38
    v_permlane32_swap_b32 v37, v39
    v_permlane32_swap_b32 v40, v42
    v_permlane32_swap_b32 v41, v43
    v_permlane32_swap_b32 v44, v46
    v_permlane32_swap_b32 v45, v47
    v_permlane32_swap_b32 v48, v50
    v_permlane32_swap_b32 v49, v51
    v_permlane32_swap_b32 v52, v54
    v_permlane32_swap_b32 v53, v55
    v_permlane32_swap_b32 v56, v58
    v_permlane32_swap_b32 v57, v59
    v_permlane32_swap_b32 v60, v62
    v_permlane32_swap_b32 v61, v63
    s_lshr_b32 s32, s15, 3
    s_lshl_b32 s32, s32, 9
    s_and_b32 s33, s15, 7
    s_lshl_b32 s33, s33, 4
    s_add_u32 s32, s32, s33
    s_add_u32 s16, s32, 0x8416000
    v_lshlrev_b32 v64, 16, v32
    v_and_b32 v65, 0xffff0000, v32
    v_lshlrev_b32 v66, 16, v33
    v_and_b32 v67, 0xffff0000, v33
    v_lshlrev_b32 v68, 16, v34
    v_and_b32 v69, 0xffff0000, v34
    v_lshlrev_b32 v70, 16, v35
    v_and_b32 v71, 0xffff0000, v35
    v_lshlrev_b32 v72, 16, v36
    v_and_b32 v73, 0xffff0000, v36
    v_lshlrev_b32 v74, 16, v37
    v_and_b32 v75, 0xffff0000, v37
    v_lshlrev_b32 v76, 16, v38
    v_and_b32 v77, 0xffff0000, v38
    v_lshlrev_b32 v78, 16, v39
    v_and_b32 v79, 0xffff0000, v39
    v_lshlrev_b32 v80, 16, v40
    v_and_b32 v81, 0xffff0000, v40
    v_lshlrev_b32 v82, 16, v41
    v_and_b32 v83, 0xffff0000, v41
    v_lshlrev_b32 v84, 16, v42
    v_and_b32 v85, 0xffff0000, v42
    v_lshlrev_b32 v86, 16, v43
    v_and_b32 v87, 0xffff0000, v43
    v_lshlrev_b32 v88, 16, v44
    v_and_b32 v89, 0xffff0000, v44
    v_lshlrev_b32 v90, 16, v45
    v_and_b32 v91, 0xffff0000, v45
    v_lshlrev_b32 v92, 16, v46
    v_and_b32 v93, 0xffff0000, v46
    v_lshlrev_b32 v94, 16, v47
    v_and_b32 v95, 0xffff0000, v47
    v_lshlrev_b32 v96, 16, v48
    v_and_b32 v97, 0xffff0000, v48
    v_lshlrev_b32 v98, 16, v49
    v_and_b32 v99, 0xffff0000, v49
    v_lshlrev_b32 v100, 16, v50
    v_and_b32 v101, 0xffff0000, v50
    v_lshlrev_b32 v102, 16, v51
    v_and_b32 v103, 0xffff0000, v51
    v_lshlrev_b32 v104, 16, v52
    v_and_b32 v105, 0xffff0000, v52
    v_lshlrev_b32 v106, 16, v53
    v_and_b32 v107, 0xffff0000, v53
    v_lshlrev_b32 v108, 16, v54
    v_and_b32 v109, 0xffff0000, v54
    v_lshlrev_b32 v110, 16, v55
    v_and_b32 v111, 0xffff0000, v55
    v_lshlrev_b32 v112, 16, v56
    v_and_b32 v113, 0xffff0000, v56
    v_lshlrev_b32 v114, 16, v57
    v_and_b32 v115, 0xffff0000, v57
    v_lshlrev_b32 v116, 16, v58
    v_and_b32 v117, 0xffff0000, v58
    v_lshlrev_b32 v118, 16, v59
    v_and_b32 v119, 0xffff0000, v59
    v_lshlrev_b32 v120, 16, v60
    v_and_b32 v121, 0xffff0000, v60
    v_lshlrev_b32 v122, 16, v61
    v_and_b32 v123, 0xffff0000, v61
    v_lshlrev_b32 v124, 16, v62
    v_and_b32 v125, 0xffff0000, v62
    v_lshlrev_b32 v126, 16, v63
    v_and_b32 v127, 0xffff0000, v63
    v_pk_add_f32 v[16:17], v[64:65], v[72:73]
    v_pk_add_f32 v[18:19], v[66:67], v[74:75]
    v_pk_add_f32 v[20:21], v[68:69], v[76:77]
    v_pk_add_f32 v[22:23], v[70:71], v[78:79]
    v_pk_add_f32 v[16:17], v[16:17], v[80:81]
    v_pk_add_f32 v[18:19], v[18:19], v[82:83]
    v_pk_add_f32 v[20:21], v[20:21], v[84:85]
    v_pk_add_f32 v[22:23], v[22:23], v[86:87]
    v_pk_add_f32 v[16:17], v[16:17], v[88:89]
    v_pk_add_f32 v[18:19], v[18:19], v[90:91]
    v_pk_add_f32 v[20:21], v[20:21], v[92:93]
    v_pk_add_f32 v[22:23], v[22:23], v[94:95]
    v_pk_add_f32 v[16:17], v[16:17], v[96:97]
    v_pk_add_f32 v[18:19], v[18:19], v[98:99]
    v_pk_add_f32 v[20:21], v[20:21], v[100:101]
    v_pk_add_f32 v[22:23], v[22:23], v[102:103]
    v_pk_add_f32 v[16:17], v[16:17], v[104:105]
    v_pk_add_f32 v[18:19], v[18:19], v[106:107]
    v_pk_add_f32 v[20:21], v[20:21], v[108:109]
    v_pk_add_f32 v[22:23], v[22:23], v[110:111]
    v_pk_add_f32 v[16:17], v[16:17], v[112:113]
    v_pk_add_f32 v[18:19], v[18:19], v[114:115]
    v_pk_add_f32 v[20:21], v[20:21], v[116:117]
    v_pk_add_f32 v[22:23], v[22:23], v[118:119]
    v_pk_add_f32 v[16:17], v[16:17], v[120:121]
    v_pk_add_f32 v[18:19], v[18:19], v[122:123]
    v_pk_add_f32 v[20:21], v[20:21], v[124:125]
    v_pk_add_f32 v[22:23], v[22:23], v[126:127]
    v_pk_add_f32 v[16:17], v[16:17], v[18:19]
    v_pk_add_f32 v[20:21], v[20:21], v[22:23]
    v_pk_add_f32 v[16:17], v[16:17], v[20:21]
    v_add_f32 v16, v16, v17
    ds_write_b32 v253, v16 offset:0
    s_waitcnt lgkmcnt(0)
    s_barrier
    ds_read_b128 v[16:19], v254 offset:0
    ds_read_b128 v[20:23], v254 offset:16
    ds_read_b128 v[24:27], v254 offset:32
    ds_read_b128 v[28:31], v254 offset:48
    s_waitcnt lgkmcnt(2)
    v_pk_add_f32 v[16:17], v[16:17], v[18:19]
    v_pk_add_f32 v[20:21], v[20:21], v[22:23]
    s_waitcnt lgkmcnt(0)
    v_pk_add_f32 v[24:25], v[24:25], v[26:27]
    v_pk_add_f32 v[28:29], v[28:29], v[30:31]
    v_pk_add_f32 v[16:17], v[16:17], v[20:21]
    v_pk_add_f32 v[24:25], v[24:25], v[28:29]
    v_pk_add_f32 v[16:17], v[16:17], v[24:25]
    v_add_f32 v16, v16, v17
    v_mul_f32 v16, 0xba800000, v16
    v_mov_b32 v17, v16
    v_pk_add_f32 v[64:65], v[64:65], v[16:17]
    v_pk_add_f32 v[66:67], v[66:67], v[16:17]
    v_pk_add_f32 v[68:69], v[68:69], v[16:17]
    v_pk_add_f32 v[70:71], v[70:71], v[16:17]
    v_pk_add_f32 v[72:73], v[72:73], v[16:17]
    v_pk_add_f32 v[74:75], v[74:75], v[16:17]
    v_pk_add_f32 v[76:77], v[76:77], v[16:17]
    v_pk_add_f32 v[78:79], v[78:79], v[16:17]
    v_pk_add_f32 v[80:81], v[80:81], v[16:17]
    v_pk_add_f32 v[82:83], v[82:83], v[16:17]
    v_pk_add_f32 v[84:85], v[84:85], v[16:17]
    v_pk_add_f32 v[86:87], v[86:87], v[16:17]
    v_pk_add_f32 v[88:89], v[88:89], v[16:17]
    v_pk_add_f32 v[90:91], v[90:91], v[16:17]
    v_pk_add_f32 v[92:93], v[92:93], v[16:17]
    v_pk_add_f32 v[94:95], v[94:95], v[16:17]
    v_pk_add_f32 v[96:97], v[96:97], v[16:17]
    v_pk_add_f32 v[98:99], v[98:99], v[16:17]
    v_pk_add_f32 v[100:101], v[100:101], v[16:17]
    v_pk_add_f32 v[102:103], v[102:103], v[16:17]
    v_pk_add_f32 v[104:105], v[104:105], v[16:17]
    v_pk_add_f32 v[106:107], v[106:107], v[16:17]
    v_pk_add_f32 v[108:109], v[108:109], v[16:17]
    v_pk_add_f32 v[110:111], v[110:111], v[16:17]
    v_pk_add_f32 v[112:113], v[112:113], v[16:17]
    v_pk_add_f32 v[114:115], v[114:115], v[16:17]
    v_pk_add_f32 v[116:117], v[116:117], v[16:17]
    v_pk_add_f32 v[118:119], v[118:119], v[16:17]
    v_pk_add_f32 v[120:121], v[120:121], v[16:17]
    v_pk_add_f32 v[122:123], v[122:123], v[16:17]
    v_pk_add_f32 v[124:125], v[124:125], v[16:17]
    v_pk_add_f32 v[126:127], v[126:127], v[16:17]
    v_pk_mul_f32 v[16:17], v[64:65], v[64:65]
    v_pk_mul_f32 v[18:19], v[66:67], v[66:67]
    v_pk_mul_f32 v[20:21], v[68:69], v[68:69]
    v_pk_mul_f32 v[22:23], v[70:71], v[70:71]
    v_pk_fma_f32 v[16:17], v[72:73], v[72:73], v[16:17]
    v_pk_fma_f32 v[18:19], v[74:75], v[74:75], v[18:19]
    v_pk_fma_f32 v[20:21], v[76:77], v[76:77], v[20:21]
    v_pk_fma_f32 v[22:23], v[78:79], v[78:79], v[22:23]
    v_pk_fma_f32 v[16:17], v[80:81], v[80:81], v[16:17]
    v_pk_fma_f32 v[18:19], v[82:83], v[82:83], v[18:19]
    v_pk_fma_f32 v[20:21], v[84:85], v[84:85], v[20:21]
    v_pk_fma_f32 v[22:23], v[86:87], v[86:87], v[22:23]
    v_pk_fma_f32 v[16:17], v[88:89], v[88:89], v[16:17]
    v_pk_fma_f32 v[18:19], v[90:91], v[90:91], v[18:19]
    v_pk_fma_f32 v[20:21], v[92:93], v[92:93], v[20:21]
    v_pk_fma_f32 v[22:23], v[94:95], v[94:95], v[22:23]
    v_pk_fma_f32 v[16:17], v[96:97], v[96:97], v[16:17]
    v_pk_fma_f32 v[18:19], v[98:99], v[98:99], v[18:19]
    v_pk_fma_f32 v[20:21], v[100:101], v[100:101], v[20:21]
    v_pk_fma_f32 v[22:23], v[102:103], v[102:103], v[22:23]
    v_pk_fma_f32 v[16:17], v[104:105], v[104:105], v[16:17]
    v_pk_fma_f32 v[18:19], v[106:107], v[106:107], v[18:19]
    v_pk_fma_f32 v[20:21], v[108:109], v[108:109], v[20:21]
    v_pk_fma_f32 v[22:23], v[110:111], v[110:111], v[22:23]
    v_pk_fma_f32 v[16:17], v[112:113], v[112:113], v[16:17]
    v_pk_fma_f32 v[18:19], v[114:115], v[114:115], v[18:19]
    v_pk_fma_f32 v[20:21], v[116:117], v[116:117], v[20:21]
    v_pk_fma_f32 v[22:23], v[118:119], v[118:119], v[22:23]
    v_pk_fma_f32 v[16:17], v[120:121], v[120:121], v[16:17]
    v_pk_fma_f32 v[18:19], v[122:123], v[122:123], v[18:19]
    v_pk_fma_f32 v[20:21], v[124:125], v[124:125], v[20:21]
    v_pk_fma_f32 v[22:23], v[126:127], v[126:127], v[22:23]
    v_pk_add_f32 v[16:17], v[16:17], v[18:19]
    v_pk_add_f32 v[20:21], v[20:21], v[22:23]
    v_pk_add_f32 v[16:17], v[16:17], v[20:21]
    v_add_f32 v16, v16, v17
    ds_write_b32 v253, v16 offset:1024
    s_waitcnt lgkmcnt(0)
    s_barrier
    ds_read_b128 v[16:19], v254 offset:1024
    ds_read_b128 v[20:23], v254 offset:1040
    ds_read_b128 v[24:27], v254 offset:1056
    ds_read_b128 v[28:31], v254 offset:1072
    s_waitcnt lgkmcnt(2)
    v_pk_add_f32 v[16:17], v[16:17], v[18:19]
    v_pk_add_f32 v[20:21], v[20:21], v[22:23]
    s_waitcnt lgkmcnt(0)
    v_pk_add_f32 v[24:25], v[24:25], v[26:27]
    v_pk_add_f32 v[28:29], v[28:29], v[30:31]
    v_pk_add_f32 v[16:17], v[16:17], v[20:21]
    v_pk_add_f32 v[24:25], v[24:25], v[28:29]
    v_pk_add_f32 v[16:17], v[16:17], v[24:25]
    v_add_f32 v16, v16, v17
    v_mov_b32 v17, 0x3727c5ac
    v_fmac_f32 v17, 0x3a800000, v16
    v_rsq_f32 v16, v17
    s_nop 0
    v_mov_b32 v17, v16
    v_pk_mul_f32 v[64:65], v[64:65], v[16:17]
    v_pk_mul_f32 v[66:67], v[66:67], v[16:17]
    v_pk_mul_f32 v[68:69], v[68:69], v[16:17]
    v_pk_mul_f32 v[70:71], v[70:71], v[16:17]
    v_pk_mul_f32 v[72:73], v[72:73], v[16:17]
    v_pk_mul_f32 v[74:75], v[74:75], v[16:17]
    v_pk_mul_f32 v[76:77], v[76:77], v[16:17]
    v_pk_mul_f32 v[78:79], v[78:79], v[16:17]
    v_pk_mul_f32 v[80:81], v[80:81], v[16:17]
    v_pk_mul_f32 v[82:83], v[82:83], v[16:17]
    v_pk_mul_f32 v[84:85], v[84:85], v[16:17]
    v_pk_mul_f32 v[86:87], v[86:87], v[16:17]
    v_pk_mul_f32 v[88:89], v[88:89], v[16:17]
    v_pk_mul_f32 v[90:91], v[90:91], v[16:17]
    v_pk_mul_f32 v[92:93], v[92:93], v[16:17]
    v_pk_mul_f32 v[94:95], v[94:95], v[16:17]
    v_pk_mul_f32 v[96:97], v[96:97], v[16:17]
    v_pk_mul_f32 v[98:99], v[98:99], v[16:17]
    v_pk_mul_f32 v[100:101], v[100:101], v[16:17]
    v_pk_mul_f32 v[102:103], v[102:103], v[16:17]
    v_pk_mul_f32 v[104:105], v[104:105], v[16:17]
    v_pk_mul_f32 v[106:107], v[106:107], v[16:17]
    v_pk_mul_f32 v[108:109], v[108:109], v[16:17]
    v_pk_mul_f32 v[110:111], v[110:111], v[16:17]
    v_pk_mul_f32 v[112:113], v[112:113], v[16:17]
    v_pk_mul_f32 v[114:115], v[114:115], v[16:17]
    v_pk_mul_f32 v[116:117], v[116:117], v[16:17]
    v_pk_mul_f32 v[118:119], v[118:119], v[16:17]
    v_pk_mul_f32 v[120:121], v[120:121], v[16:17]
    v_pk_mul_f32 v[122:123], v[122:123], v[16:17]
    v_pk_mul_f32 v[124:125], v[124:125], v[16:17]
    v_pk_mul_f32 v[126:127], v[126:127], v[16:17]
    v_cvt_pk_bf16_f32 v128, v64, v65
    v_cvt_pk_bf16_f32 v129, v66, v67
    v_cvt_pk_bf16_f32 v130, v68, v69
    v_cvt_pk_bf16_f32 v131, v70, v71
    v_cvt_pk_bf16_f32 v132, v72, v73
    v_cvt_pk_bf16_f32 v133, v74, v75
    v_cvt_pk_bf16_f32 v134, v76, v77
    v_cvt_pk_bf16_f32 v135, v78, v79
    v_cvt_pk_bf16_f32 v136, v80, v81
    v_cvt_pk_bf16_f32 v137, v82, v83
    v_cvt_pk_bf16_f32 v138, v84, v85
    v_cvt_pk_bf16_f32 v139, v86, v87
    v_cvt_pk_bf16_f32 v140, v88, v89
    v_cvt_pk_bf16_f32 v141, v90, v91
    v_cvt_pk_bf16_f32 v142, v92, v93
    v_cvt_pk_bf16_f32 v143, v94, v95
    v_cvt_pk_bf16_f32 v144, v96, v97
    v_cvt_pk_bf16_f32 v145, v98, v99
    v_cvt_pk_bf16_f32 v146, v100, v101
    v_cvt_pk_bf16_f32 v147, v102, v103
    v_cvt_pk_bf16_f32 v148, v104, v105
    v_cvt_pk_bf16_f32 v149, v106, v107
    v_cvt_pk_bf16_f32 v150, v108, v109
    v_cvt_pk_bf16_f32 v151, v110, v111
    v_cvt_pk_bf16_f32 v152, v112, v113
    v_cvt_pk_bf16_f32 v153, v114, v115
    v_cvt_pk_bf16_f32 v154, v116, v117
    v_cvt_pk_bf16_f32 v155, v118, v119
    v_cvt_pk_bf16_f32 v156, v120, v121
    v_cvt_pk_bf16_f32 v157, v122, v123
    v_cvt_pk_bf16_f32 v158, v124, v125
    v_cvt_pk_bf16_f32 v159, v126, v127
    s_add_u32 s32, s34, 0x0
    s_add_u32 s33, s32, 4096
    buffer_store_dwordx4 v[128:131], v251, s[4:7], s32 offen offset:0 sc1
    buffer_store_dwordx4 v[132:135], v251, s[4:7], s32 offen offset:1024 sc1
    buffer_store_dwordx4 v[136:139], v251, s[4:7], s32 offen offset:2048 sc1
    buffer_store_dwordx4 v[140:143], v251, s[4:7], s32 offen offset:3072 sc1
    buffer_store_dwordx4 v[144:147], v251, s[4:7], s33 offen offset:0 sc1
    buffer_store_dwordx4 v[148:151], v251, s[4:7], s33 offen offset:1024 sc1
    buffer_store_dwordx4 v[152:155], v251, s[4:7], s33 offen offset:2048 sc1
    buffer_store_dwordx4 v[156:159], v251, s[4:7], s33 offen offset:3072 sc1
    buffer_load_dword v2, v4, s[60:63], 0 offen offset:12 sc1
    v_lshlrev_b32 v64, 16, v128
    v_and_b32 v65, 0xffff0000, v128
    v_lshlrev_b32 v66, 16, v129
    v_and_b32 v67, 0xffff0000, v129
    v_lshlrev_b32 v68, 16, v130
    v_and_b32 v69, 0xffff0000, v130
    v_lshlrev_b32 v70, 16, v131
    v_and_b32 v71, 0xffff0000, v131
    v_lshlrev_b32 v72, 16, v132
    v_and_b32 v73, 0xffff0000, v132
    v_lshlrev_b32 v74, 16, v133
    v_and_b32 v75, 0xffff0000, v133
    v_lshlrev_b32 v76, 16, v134
    v_and_b32 v77, 0xffff0000, v134
    v_lshlrev_b32 v78, 16, v135
    v_and_b32 v79, 0xffff0000, v135
    v_lshlrev_b32 v80, 16, v136
    v_and_b32 v81, 0xffff0000, v136
    v_lshlrev_b32 v82, 16, v137
    v_and_b32 v83, 0xffff0000, v137
    v_lshlrev_b32 v84, 16, v138
    v_and_b32 v85, 0xffff0000, v138
    v_lshlrev_b32 v86, 16, v139
    v_and_b32 v87, 0xffff0000, v139
    v_lshlrev_b32 v88, 16, v140
    v_and_b32 v89, 0xffff0000, v140
    v_lshlrev_b32 v90, 16, v141
    v_and_b32 v91, 0xffff0000, v141
    v_lshlrev_b32 v92, 16, v142
    v_and_b32 v93, 0xffff0000, v142
    v_lshlrev_b32 v94, 16, v143
    v_and_b32 v95, 0xffff0000, v143
    v_lshlrev_b32 v96, 16, v144
    v_and_b32 v97, 0xffff0000, v144
    v_lshlrev_b32 v98, 16, v145
    v_and_b32 v99, 0xffff0000, v145
    v_lshlrev_b32 v100, 16, v146
    v_and_b32 v101, 0xffff0000, v146
    v_lshlrev_b32 v102, 16, v147
    v_and_b32 v103, 0xffff0000, v147
    v_lshlrev_b32 v104, 16, v148
    v_and_b32 v105, 0xffff0000, v148
    v_lshlrev_b32 v106, 16, v149
    v_and_b32 v107, 0xffff0000, v149
    v_lshlrev_b32 v108, 16, v150
    v_and_b32 v109, 0xffff0000, v150
    v_lshlrev_b32 v110, 16, v151
    v_and_b32 v111, 0xffff0000, v151
    v_lshlrev_b32 v112, 16, v152
    v_and_b32 v113, 0xffff0000, v152
    v_lshlrev_b32 v114, 16, v153
    v_and_b32 v115, 0xffff0000, v153
    v_lshlrev_b32 v116, 16, v154
    v_and_b32 v117, 0xffff0000, v154
    v_lshlrev_b32 v118, 16, v155
    v_and_b32 v119, 0xffff0000, v155
    v_lshlrev_b32 v120, 16, v156
    v_and_b32 v121, 0xffff0000, v156
    v_lshlrev_b32 v122, 16, v157
    v_and_b32 v123, 0xffff0000, v157
    v_lshlrev_b32 v124, 16, v158
    v_and_b32 v125, 0xffff0000, v158
    v_lshlrev_b32 v126, 16, v159
    v_and_b32 v127, 0xffff0000, v159
    v_pk_add_f32 v[16:17], v[64:65], v[72:73]
    v_pk_add_f32 v[18:19], v[66:67], v[74:75]
    v_pk_add_f32 v[20:21], v[68:69], v[76:77]
    v_pk_add_f32 v[22:23], v[70:71], v[78:79]
    v_pk_add_f32 v[16:17], v[16:17], v[80:81]
    v_pk_add_f32 v[18:19], v[18:19], v[82:83]
    v_pk_add_f32 v[20:21], v[20:21], v[84:85]
    v_pk_add_f32 v[22:23], v[22:23], v[86:87]
    v_pk_add_f32 v[16:17], v[16:17], v[88:89]
    v_pk_add_f32 v[18:19], v[18:19], v[90:91]
    v_pk_add_f32 v[20:21], v[20:21], v[92:93]
    v_pk_add_f32 v[22:23], v[22:23], v[94:95]
    v_pk_add_f32 v[16:17], v[16:17], v[96:97]
    v_pk_add_f32 v[18:19], v[18:19], v[98:99]
    v_pk_add_f32 v[20:21], v[20:21], v[100:101]
    v_pk_add_f32 v[22:23], v[22:23], v[102:103]
    v_pk_add_f32 v[16:17], v[16:17], v[104:105]
    v_pk_add_f32 v[18:19], v[18:19], v[106:107]
    v_pk_add_f32 v[20:21], v[20:21], v[108:109]
    v_pk_add_f32 v[22:23], v[22:23], v[110:111]
    v_pk_add_f32 v[16:17], v[16:17], v[112:113]
    v_pk_add_f32 v[18:19], v[18:19], v[114:115]
    v_pk_add_f32 v[20:21], v[20:21], v[116:117]
    v_pk_add_f32 v[22:23], v[22:23], v[118:119]
    v_pk_add_f32 v[16:17], v[16:17], v[120:121]
    v_pk_add_f32 v[18:19], v[18:19], v[122:123]
    v_pk_add_f32 v[20:21], v[20:21], v[124:125]
    v_pk_add_f32 v[22:23], v[22:23], v[126:127]
    v_pk_add_f32 v[16:17], v[16:17], v[18:19]
    v_pk_add_f32 v[20:21], v[20:21], v[22:23]
    v_pk_add_f32 v[16:17], v[16:17], v[20:21]
    v_add_f32 v16, v16, v17
    ds_write_b32 v253, v16 offset:0
    s_waitcnt lgkmcnt(0)
    s_barrier
    ds_read_b128 v[16:19], v254 offset:0
    ds_read_b128 v[20:23], v254 offset:16
    ds_read_b128 v[24:27], v254 offset:32
    ds_read_b128 v[28:31], v254 offset:48
    s_waitcnt lgkmcnt(2)
    v_pk_add_f32 v[16:17], v[16:17], v[18:19]
    v_pk_add_f32 v[20:21], v[20:21], v[22:23]
    s_waitcnt lgkmcnt(0)
    v_pk_add_f32 v[24:25], v[24:25], v[26:27]
    v_pk_add_f32 v[28:29], v[28:29], v[30:31]
    v_pk_add_f32 v[16:17], v[16:17], v[20:21]
    v_pk_add_f32 v[24:25], v[24:25], v[28:29]
    v_pk_add_f32 v[16:17], v[16:17], v[24:25]
    v_add_f32 v16, v16, v17
    v_mul_f32 v16, 0xba800000, v16
    v_mov_b32 v17, v16
    v_pk_add_f32 v[64:65], v[64:65], v[16:17]
    v_pk_add_f32 v[66:67], v[66:67], v[16:17]
    v_pk_add_f32 v[68:69], v[68:69], v[16:17]
    v_pk_add_f32 v[70:71], v[70:71], v[16:17]
    v_pk_add_f32 v[72:73], v[72:73], v[16:17]
    v_pk_add_f32 v[74:75], v[74:75], v[16:17]
    v_pk_add_f32 v[76:77], v[76:77], v[16:17]
    v_pk_add_f32 v[78:79], v[78:79], v[16:17]
    v_pk_add_f32 v[80:81], v[80:81], v[16:17]
    v_pk_add_f32 v[82:83], v[82:83], v[16:17]
    v_pk_add_f32 v[84:85], v[84:85], v[16:17]
    v_pk_add_f32 v[86:87], v[86:87], v[16:17]
    v_pk_add_f32 v[88:89], v[88:89], v[16:17]
    v_pk_add_f32 v[90:91], v[90:91], v[16:17]
    v_pk_add_f32 v[92:93], v[92:93], v[16:17]
    v_pk_add_f32 v[94:95], v[94:95], v[16:17]
    v_pk_add_f32 v[96:97], v[96:97], v[16:17]
    v_pk_add_f32 v[98:99], v[98:99], v[16:17]
    v_pk_add_f32 v[100:101], v[100:101], v[16:17]
    v_pk_add_f32 v[102:103], v[102:103], v[16:17]
    v_pk_add_f32 v[104:105], v[104:105], v[16:17]
    v_pk_add_f32 v[106:107], v[106:107], v[16:17]
    v_pk_add_f32 v[108:109], v[108:109], v[16:17]
    v_pk_add_f32 v[110:111], v[110:111], v[16:17]
    v_pk_add_f32 v[112:113], v[112:113], v[16:17]
    v_pk_add_f32 v[114:115], v[114:115], v[16:17]
    v_pk_add_f32 v[116:117], v[116:117], v[16:17]
    v_pk_add_f32 v[118:119], v[118:119], v[16:17]
    v_pk_add_f32 v[120:121], v[120:121], v[16:17]
    v_pk_add_f32 v[122:123], v[122:123], v[16:17]
    v_pk_add_f32 v[124:125], v[124:125], v[16:17]
    v_pk_add_f32 v[126:127], v[126:127], v[16:17]
    v_pk_mul_f32 v[16:17], v[64:65], v[64:65]
    v_pk_mul_f32 v[18:19], v[66:67], v[66:67]
    v_pk_mul_f32 v[20:21], v[68:69], v[68:69]
    v_pk_mul_f32 v[22:23], v[70:71], v[70:71]
    v_pk_fma_f32 v[16:17], v[72:73], v[72:73], v[16:17]
    v_pk_fma_f32 v[18:19], v[74:75], v[74:75], v[18:19]
    v_pk_fma_f32 v[20:21], v[76:77], v[76:77], v[20:21]
    v_pk_fma_f32 v[22:23], v[78:79], v[78:79], v[22:23]
    v_pk_fma_f32 v[16:17], v[80:81], v[80:81], v[16:17]
    v_pk_fma_f32 v[18:19], v[82:83], v[82:83], v[18:19]
    v_pk_fma_f32 v[20:21], v[84:85], v[84:85], v[20:21]
    v_pk_fma_f32 v[22:23], v[86:87], v[86:87], v[22:23]
    v_pk_fma_f32 v[16:17], v[88:89], v[88:89], v[16:17]
    v_pk_fma_f32 v[18:19], v[90:91], v[90:91], v[18:19]
    v_pk_fma_f32 v[20:21], v[92:93], v[92:93], v[20:21]
    v_pk_fma_f32 v[22:23], v[94:95], v[94:95], v[22:23]
    v_pk_fma_f32 v[16:17], v[96:97], v[96:97], v[16:17]
    v_pk_fma_f32 v[18:19], v[98:99], v[98:99], v[18:19]
    v_pk_fma_f32 v[20:21], v[100:101], v[100:101], v[20:21]
    v_pk_fma_f32 v[22:23], v[102:103], v[102:103], v[22:23]
    v_pk_fma_f32 v[16:17], v[104:105], v[104:105], v[16:17]
    v_pk_fma_f32 v[18:19], v[106:107], v[106:107], v[18:19]
    v_pk_fma_f32 v[20:21], v[108:109], v[108:109], v[20:21]
    v_pk_fma_f32 v[22:23], v[110:111], v[110:111], v[22:23]
    v_pk_fma_f32 v[16:17], v[112:113], v[112:113], v[16:17]
    v_pk_fma_f32 v[18:19], v[114:115], v[114:115], v[18:19]
    v_pk_fma_f32 v[20:21], v[116:117], v[116:117], v[20:21]
    v_pk_fma_f32 v[22:23], v[118:119], v[118:119], v[22:23]
    v_pk_fma_f32 v[16:17], v[120:121], v[120:121], v[16:17]
    v_pk_fma_f32 v[18:19], v[122:123], v[122:123], v[18:19]
    v_pk_fma_f32 v[20:21], v[124:125], v[124:125], v[20:21]
    v_pk_fma_f32 v[22:23], v[126:127], v[126:127], v[22:23]
    v_pk_add_f32 v[16:17], v[16:17], v[18:19]
    v_pk_add_f32 v[20:21], v[20:21], v[22:23]
    v_pk_add_f32 v[16:17], v[16:17], v[20:21]
    v_add_f32 v16, v16, v17
    ds_write_b32 v253, v16 offset:1024
    s_waitcnt lgkmcnt(0)
    s_waitcnt vmcnt(0)
    s_barrier
    s_cmp_lg_u32 s14, 0
    s_cbranch_scc1 main_kernel_s_nf
    v_cmp_gt_u32 vcc, 4, v2
    s_cbranch_vccz main_kernel_s_wa1_ok
    v_mov_b32 v2, 0
main_kernel_s_wa1:
    buffer_load_dword v3, v2, s[60:63], 0 offen offset:12 sc1
    s_waitcnt vmcnt(0)
    v_cmp_gt_u32 vcc, 4, v3
    s_cbranch_vccz main_kernel_s_wa1_ok
    s_sleep 4
    s_sub_u32 s29, s29, 1
    s_cbranch_scc0 main_kernel_s_wa1
    s_branch main_kernel_end
main_kernel_s_wa1_ok:
    s_mov_b64 exec, 1
    buffer_store_dword v8, v4, s[4:7], s16 offen sc1
    s_mov_b64 exec, -1
main_kernel_s_nf:
    ds_read_b128 v[16:19], v254 offset:1024
    ds_read_b128 v[20:23], v254 offset:1040
    ds_read_b128 v[24:27], v254 offset:1056
    ds_read_b128 v[28:31], v254 offset:1072
    s_waitcnt lgkmcnt(2)
    v_pk_add_f32 v[16:17], v[16:17], v[18:19]
    v_pk_add_f32 v[20:21], v[20:21], v[22:23]
    s_waitcnt lgkmcnt(0)
    v_pk_add_f32 v[24:25], v[24:25], v[26:27]
    v_pk_add_f32 v[28:29], v[28:29], v[30:31]
    v_pk_add_f32 v[16:17], v[16:17], v[20:21]
    v_pk_add_f32 v[24:25], v[24:25], v[28:29]
    v_pk_add_f32 v[16:17], v[16:17], v[24:25]
    v_add_f32 v16, v16, v17
    v_mov_b32 v17, 0x3727c5ac
    v_fmac_f32 v17, 0x3a800000, v16
    v_rsq_f32 v16, v17
    s_nop 0
    v_mov_b32 v17, v16
    v_pk_mul_f32 v[64:65], v[64:65], v[16:17]
    v_pk_mul_f32 v[66:67], v[66:67], v[16:17]
    v_pk_mul_f32 v[68:69], v[68:69], v[16:17]
    v_pk_mul_f32 v[70:71], v[70:71], v[16:17]
    v_pk_mul_f32 v[72:73], v[72:73], v[16:17]
    v_pk_mul_f32 v[74:75], v[74:75], v[16:17]
    v_pk_mul_f32 v[76:77], v[76:77], v[16:17]
    v_pk_mul_f32 v[78:79], v[78:79], v[16:17]
    v_pk_mul_f32 v[80:81], v[80:81], v[16:17]
    v_pk_mul_f32 v[82:83], v[82:83], v[16:17]
    v_pk_mul_f32 v[84:85], v[84:85], v[16:17]
    v_pk_mul_f32 v[86:87], v[86:87], v[16:17]
    v_pk_mul_f32 v[88:89], v[88:89], v[16:17]
    v_pk_mul_f32 v[90:91], v[90:91], v[16:17]
    v_pk_mul_f32 v[92:93], v[92:93], v[16:17]
    v_pk_mul_f32 v[94:95], v[94:95], v[16:17]
    v_pk_mul_f32 v[96:97], v[96:97], v[16:17]
    v_pk_mul_f32 v[98:99], v[98:99], v[16:17]
    v_pk_mul_f32 v[100:101], v[100:101], v[16:17]
    v_pk_mul_f32 v[102:103], v[102:103], v[16:17]
    v_pk_mul_f32 v[104:105], v[104:105], v[16:17]
    v_pk_mul_f32 v[106:107], v[106:107], v[16:17]
    v_pk_mul_f32 v[108:109], v[108:109], v[16:17]
    v_pk_mul_f32 v[110:111], v[110:111], v[16:17]
    v_pk_mul_f32 v[112:113], v[112:113], v[16:17]
    v_pk_mul_f32 v[114:115], v[114:115], v[16:17]
    v_pk_mul_f32 v[116:117], v[116:117], v[16:17]
    v_pk_mul_f32 v[118:119], v[118:119], v[16:17]
    v_pk_mul_f32 v[120:121], v[120:121], v[16:17]
    v_pk_mul_f32 v[122:123], v[122:123], v[16:17]
    v_pk_mul_f32 v[124:125], v[124:125], v[16:17]
    v_pk_mul_f32 v[126:127], v[126:127], v[16:17]
    v_cvt_pk_bf16_f32 v32, v64, v65
    v_cvt_pk_bf16_f32 v33, v66, v67
    v_cvt_pk_bf16_f32 v34, v68, v69
    v_cvt_pk_bf16_f32 v35, v70, v71
    v_cvt_pk_bf16_f32 v36, v72, v73
    v_cvt_pk_bf16_f32 v37, v74, v75
    v_cvt_pk_bf16_f32 v38, v76, v77
    v_cvt_pk_bf16_f32 v39, v78, v79
    v_cvt_pk_bf16_f32 v40, v80, v81
    v_cvt_pk_bf16_f32 v41, v82, v83
    v_cvt_pk_bf16_f32 v42, v84, v85
    v_cvt_pk_bf16_f32 v43, v86, v87
    v_cvt_pk_bf16_f32 v44, v88, v89
    v_cvt_pk_bf16_f32 v45, v90, v91
    v_cvt_pk_bf16_f32 v46, v92, v93
    v_cvt_pk_bf16_f32 v47, v94, v95
    v_cvt_pk_bf16_f32 v48, v96, v97
    v_cvt_pk_bf16_f32 v49, v98, v99
    v_cvt_pk_bf16_f32 v50, v100, v101
    v_cvt_pk_bf16_f32 v51, v102, v103
    v_cvt_pk_bf16_f32 v52, v104, v105
    v_cvt_pk_bf16_f32 v53, v106, v107
    v_cvt_pk_bf16_f32 v54, v108, v109
    v_cvt_pk_bf16_f32 v55, v110, v111
    v_cvt_pk_bf16_f32 v56, v112, v113
    v_cvt_pk_bf16_f32 v57, v114, v115
    v_cvt_pk_bf16_f32 v58, v116, v117
    v_cvt_pk_bf16_f32 v59, v118, v119
    v_cvt_pk_bf16_f32 v60, v120, v121
    v_cvt_pk_bf16_f32 v61, v122, v123
    v_cvt_pk_bf16_f32 v62, v124, v125
    v_cvt_pk_bf16_f32 v63, v126, v127
    s_add_u32 s32, s34, 0x400000
    s_add_u32 s33, s32, 4096
    buffer_store_dwordx4 v[32:35], v251, s[4:7], s32 offen offset:0 sc1
    buffer_store_dwordx4 v[36:39], v251, s[4:7], s32 offen offset:1024 sc1
    buffer_store_dwordx4 v[40:43], v251, s[4:7], s32 offen offset:2048 sc1
    buffer_store_dwordx4 v[44:47], v251, s[4:7], s32 offen offset:3072 sc1
    buffer_store_dwordx4 v[48:51], v251, s[4:7], s33 offen offset:0 sc1
    buffer_store_dwordx4 v[52:55], v251, s[4:7], s33 offen offset:1024 sc1
    buffer_store_dwordx4 v[56:59], v251, s[4:7], s33 offen offset:2048 sc1
    buffer_store_dwordx4 v[60:63], v251, s[4:7], s33 offen offset:3072 sc1
    s_add_u32 s16, s16, 4
    s_branch main_kernel_s_wa2_ok
main_kernel_s_fill:
    s_lshl_b32 s32, s16, 14
    s_add_u32 s34, s32, 0x6c00000
    buffer_store_dwordx4 v[8:11], v1, s[4:7], s34 offen sc1
    s_add_u32 s34, s32, 0x6c01000
    buffer_store_dwordx4 v[8:11], v1, s[4:7], s34 offen sc1
    s_add_u32 s34, s32, 0x6c02000
    buffer_store_dwordx4 v[8:11], v1, s[4:7], s34 offen sc1
    s_add_u32 s34, s32, 0x6c03000
    buffer_store_dwordx4 v[8:11], v1, s[4:7], s34 offen sc1
    s_lshl_b32 s32, s16, 14
    s_add_u32 s34, s32, 0x8c00000
    buffer_store_dwordx4 v[8:11], v1, s[4:7], s34 offen sc1
    s_add_u32 s34, s32, 0x8c01000
    buffer_store_dwordx4 v[8:11], v1, s[4:7], s34 offen sc1
    s_add_u32 s34, s32, 0x8c02000
    buffer_store_dwordx4 v[8:11], v1, s[4:7], s34 offen sc1
    s_add_u32 s34, s32, 0x8c03000
    buffer_store_dwordx4 v[8:11], v1, s[4:7], s34 offen sc1
    s_add_u32 s34, s32, 0x8d00000
    buffer_store_dwordx4 v[8:11], v1, s[4:7], s34 offen sc1
    s_add_u32 s34, s32, 0x8d01000
    buffer_store_dwordx4 v[8:11], v1, s[4:7], s34 offen sc1
    s_add_u32 s34, s32, 0x8d02000
    buffer_store_dwordx4 v[8:11], v1, s[4:7], s34 offen sc1
    s_add_u32 s34, s32, 0x8d03000
    buffer_store_dwordx4 v[8:11], v1, s[4:7], s34 offen sc1
    s_lshl_b32 s32, s16, 2
    s_lshl_b32 s32, s16, 12
    s_add_u32 s33, s32, 0x8c00000
    s_add_u32 s34, s32, 0x6e00000
    buffer_store_dwordx4 v[8:11], v1, s[4:7], s34 offen sc1
    s_add_u32 s32, s32, 0x8000000
    buffer_store_dwordx4 v[8:11], v1, s[4:7], s32 offen sc1
    s_lshl_b32 s16, s16, 2
    s_add_u32 s16, s16, 0x841f000
    s_cmp_lg_u32 s16, 0x841f034
    s_cbranch_scc1 main_kernel_s_fd
    s_mov_b32 s8, s76
    s_and_b32 s9, s77, 0xffff
    s_mov_b32 s10, 0x4000
    s_mov_b32 s11, 0x20000
    v_and_b32 v2, 7, v0
    v_lshlrev_b32 v2, 11, v2
    v_lshrrev_b32 v3, 6, v0
    v_lshl_add_u32 v2, v3, 7, v2
    v_bfe_u32 v3, v0, 4, 2
    v_lshl_add_u32 v2, v3, 5, v2
    v_bfe_u32 v3, v0, 3, 1
    v_lshl_add_u32 v2, v3, 4, v2
    buffer_load_dwordx4 v[16:19], v2, s[8:11], 0 offen offset:0
    buffer_load_dwordx4 v[20:23], v2, s[8:11], 0 offen offset:512
    buffer_load_dwordx4 v[24:27], v2, s[8:11], 0 offen offset:1024
    buffer_load_dwordx4 v[28:31], v2, s[8:11], 0 offen offset:1536
    s_mov_b32 s32, 0x6d00000
    s_waitcnt vmcnt(0)
    buffer_store_dwordx4 v[16:19], v1, s[4:7], s32 offen sc1
    s_add_u32 s32, s32, 4096
    buffer_store_dwordx4 v[20:23], v1, s[4:7], s32 offen sc1
    s_add_u32 s32, s32, 4096
    buffer_store_dwordx4 v[24:27], v1, s[4:7], s32 offen sc1
    s_add_u32 s32, s32, 4096
    buffer_store_dwordx4 v[28:31], v1, s[4:7], s32 offen sc1
    s_add_u32 s32, s32, 4096
    buffer_store_dwordx4 v[8:11], v1, s[4:7], s32 offen sc1
    s_add_u32 s32, s32, 4096
    buffer_store_dwordx4 v[8:11], v1, s[4:7], s32 offen sc1
    s_add_u32 s32, s32, 4096
    buffer_store_dwordx4 v[8:11], v1, s[4:7], s32 offen sc1
    s_add_u32 s32, s32, 4096
    buffer_store_dwordx4 v[8:11], v1, s[4:7], s32 offen sc1
    s_add_u32 s32, s32, 4096
    v_xor_b32 v2, 0, v1
    v_mov_b32 v2, 0
main_kernel_s_wa3:
    buffer_load_dword v3, v2, s[60:63], 0 offen offset:12 sc1
    s_waitcnt vmcnt(0)
    v_cmp_gt_u32 vcc, 4, v3
    s_cbranch_vccz main_kernel_s_wa3_ok
    s_sleep 4
    s_sub_u32 s29, s29, 1
    s_cbranch_scc0 main_kernel_s_wa3
    s_branch main_kernel_end
main_kernel_s_wa3_ok:
    v_lshlrev_b32 v2, 8, v250
    s_mov_b32 s32, 0x8418100
    s_mov_b64 exec, 15
    buffer_store_dwordx4 v[8:11], v2, s[4:7], s32 offen sc1
    s_mov_b64 exec, -1
main_kernel_s_fd:
    s_cmp_lg_u32 s14, 0
    s_cbranch_scc1 main_kernel_s_wa2_ok
    v_mov_b32 v2, 0
main_kernel_s_wa2:
    buffer_load_dword v3, v2, s[60:63], 0 offen offset:12 sc1
    s_waitcnt vmcnt(0)
    v_cmp_gt_u32 vcc, 4, v3
    s_cbranch_vccz main_kernel_s_wa2_ok
    s_sleep 4
    s_sub_u32 s29, s29, 1
    s_cbranch_scc0 main_kernel_s_wa2
    s_branch main_kernel_end
main_kernel_s_wa2_ok:
    s_waitcnt vmcnt(0)
    s_barrier
    s_cmp_lg_u32 s14, 0
    s_cbranch_scc1 main_kernel_s_end
    s_mov_b64 exec, 1
    buffer_store_dword v8, v4, s[4:7], s16 offen sc1
    s_mov_b64 exec, -1
main_kernel_s_end:
    s_lshl_b32 s32, s12, 5
    s_add_u32 s32, s32, s13
    s_sub_u32 s32, s32, 96
    s_cmp_lt_u32 s32, 16
    s_cbranch_scc1 main_kernel_att
    s_branch main_kernel_worker
main_kernel_end:
    s_endpgm
main_kernel_chain:
    s_lshl_b32 s36, s14, 15
    s_add_u32 s36, s36, 32768
    v_lshlrev_b32 v116, 4, v94
    v_add_u32 v113, s36, v116
    v_lshrrev_b32 v126, 4, v94
    v_and_b32 v127, 15, v94
    v_lshlrev_b32 v95, 2, v126
    v_xor_b32 v127, v127, v95
    v_lshlrev_b32 v127, 4, v127
    v_and_b32 v95, 1, v126
    v_lshrrev_b32 v126, 1, v126
    v_lshl_add_u32 v127, v126, 15, v127
    v_lshl_add_u32 v65, v95, 13, v127
    v_lshl_add_u32 v66, v95, 11, v127
    s_lshr_b32 s32, s14, 1
    s_lshl_b32 s32, s32, 5
    v_xor_b32 v64, s32, v65
    v_bfe_u32 v127, v94, 2, 1
    v_bfe_u32 v95, v94, 4, 1
    v_lshl_add_u32 v78, v95, 1, v127
    v_lshl_add_u32 v126, v126, 3, v78
    v_and_b32 v127, 3, v94
    v_lshlrev_b32 v127, 3, v127
    v_lshl_add_u32 v71, v126, 8, v127
    v_bfe_u32 v95, v94, 3, 1
    v_lshl_add_u32 v71, v95, 5, v71
    v_xor_b32 v126, s14, v78
    v_lshl_add_u32 v126, v126, 6, v71
    v_add_u32 v69, 32768, v126
    v_add_u32 v70, 0x10000, v69
    v_lshl_add_u32 v126, v78, 6, v71
    v_add_u32 v80, s36, v126
    s_lshl_b32 s32, s14, 5
    s_add_u32 s32, s32, 32768
    v_xor_b32 v126, s32, v126
    v_lshl_add_u32 v67, v95, 16, v126
    v_xor_b32 v68, 0x80, v67
    v_xor_b32 v81, 64, v80
    v_xor_b32 v82, 128, v80
    v_xor_b32 v83, 192, v80
    v_and_b32 v126, 7, v94
    v_lshl_add_u32 v126, s13, 3, v126
    v_lshlrev_b32 v77, 10, v126
    s_lshl_b32 s32, s12, 22
    s_lshl_b32 s33, s13, 8
    s_add_u32 s32, s32, s33
    s_lshl_b32 s33, s14, 18
    s_add_u32 s35, s32, s33
    s_bitset0_b32 s33, 19
    s_add_u32 s34, s32, s33
    s_lshl_b32 s3, s13, 18
    s_lshl2_add_u32 s32, s12, s14
    s_lshl_b32 s32, s32, 8
    s_add_u32 s3, s3, s32
    s_cmp_lt_u32 s14, 2
    s_cbranch_scc1 main_kernel_c_pq
    s_mov_b64 s[40:41], s[42:43]
main_kernel_c_pq:
    v_min_u32 v73, 8, v94
    v_lshlrev_b32 v73, 5, v73
    v_mov_b32 v126, 12
    v_cmp_gt_u32 vcc, 8, v94
    v_lshlrev_b32 v74, 2, v94
    v_add_u32 v74, 0x841f000, v74
    v_cndmask_b32 v73, v126, v73, vcc
    v_and_b32 v75, 1, v94
    s_lshl_b32 s32, s13, 8
    s_add_u32 s32, s32, 0x8406000
    v_lshl_add_u32 v75, v75, 13, s32
    s_mov_b32 s8, s44
    s_and_b32 s9, s45, 0xffff
    s_mov_b32 s10, 0x800000
    s_mov_b32 s11, 0x20000
    s_sub_u32 s39, 511, s44
    s_and_b32 s39, s39, 0x380
    s_andn2_b32 s32, s35, 0x1fff
    s_add_u32 s39, s39, s32
    s_add_u32 s32, s39, 0x0
    buffer_load_dword v86, v77, s[8:11], s32 offen
    s_add_u32 s32, s35, 0x0
    s_add_u32 m0, s36, 0
    s_nop 0
    buffer_load_dwordx4 v65, s[8:11], s32 offen lds
    s_add_u32 s32, s35, 0x4000
    s_add_u32 m0, s36, 1024
    s_nop 0
    buffer_load_dwordx4 v65, s[8:11], s32 offen lds
    s_add_u32 s32, s35, 0x10000
    s_add_u32 m0, s36, 2048
    s_nop 0
    buffer_load_dwordx4 v65, s[8:11], s32 offen lds
    s_add_u32 s32, s35, 0x14000
    s_add_u32 m0, s36, 3072
    s_nop 0
    buffer_load_dwordx4 v65, s[8:11], s32 offen lds
    s_add_u32 s32, s35, 0x20000
    s_add_u32 m0, s36, 4096
    s_nop 0
    buffer_load_dwordx4 v65, s[8:11], s32 offen lds
    s_add_u32 s32, s35, 0x24000
    s_add_u32 m0, s36, 5120
    s_nop 0
    buffer_load_dwordx4 v65, s[8:11], s32 offen lds
    s_add_u32 s32, s35, 0x30000
    s_add_u32 m0, s36, 6144
    s_nop 0
    buffer_load_dwordx4 v65, s[8:11], s32 offen lds
    s_add_u32 s32, s35, 0x34000
    s_add_u32 m0, s36, 7168
    s_nop 0
    buffer_load_dwordx4 v65, s[8:11], s32 offen lds
    s_add_u32 s32, s39, 0x100000
    buffer_load_dword v86, v77, s[8:11], s32 offen
    s_add_u32 s32, s35, 0x100000
    s_add_u32 m0, s36, 8192
    s_nop 0
    buffer_load_dwordx4 v65, s[8:11], s32 offen lds
    s_add_u32 s32, s35, 0x104000
    s_add_u32 m0, s36, 9216
    s_nop 0
    buffer_load_dwordx4 v65, s[8:11], s32 offen lds
    s_add_u32 s32, s35, 0x110000
    s_add_u32 m0, s36, 10240
    s_nop 0
    buffer_load_dwordx4 v65, s[8:11], s32 offen lds
    s_add_u32 s32, s35, 0x114000
    s_add_u32 m0, s36, 11264
    s_nop 0
    buffer_load_dwordx4 v65, s[8:11], s32 offen lds
    s_add_u32 s32, s35, 0x120000
    s_add_u32 m0, s36, 12288
    s_nop 0
    buffer_load_dwordx4 v65, s[8:11], s32 offen lds
    s_add_u32 s32, s35, 0x124000
    s_add_u32 m0, s36, 13312
    s_nop 0
    buffer_load_dwordx4 v65, s[8:11], s32 offen lds
    s_add_u32 s32, s35, 0x130000
    s_add_u32 m0, s36, 14336
    s_nop 0
    buffer_load_dwordx4 v65, s[8:11], s32 offen lds
    s_add_u32 s32, s35, 0x134000
    s_add_u32 m0, s36, 15360
    s_nop 0
    buffer_load_dwordx4 v65, s[8:11], s32 offen lds
    s_mov_b32 s8, s40
    s_and_b32 s9, s41, 0xffff
    s_mov_b32 s10, 0x800000
    s_mov_b32 s11, 0x20000
    s_sub_u32 s39, 511, s40
    s_and_b32 s39, s39, 0x380
    s_andn2_b32 s32, s34, 0x1fff
    s_add_u32 s39, s39, s32
    s_add_u32 s32, s39, 0x0
    buffer_load_dword v86, v77, s[8:11], s32 offen
    s_add_u32 s32, s34, 0x0
    s_add_u32 m0, s36, 16384
    s_nop 0
    buffer_load_dwordx4 v64, s[8:11], s32 offen lds
    s_add_u32 s32, s34, 0x4000
    s_add_u32 m0, s36, 17408
    s_nop 0
    buffer_load_dwordx4 v64, s[8:11], s32 offen lds
    s_add_u32 s32, s34, 0x10000
    s_add_u32 m0, s36, 18432
    s_nop 0
    buffer_load_dwordx4 v64, s[8:11], s32 offen lds
    s_add_u32 s32, s34, 0x14000
    s_add_u32 m0, s36, 19456
    s_nop 0
    buffer_load_dwordx4 v64, s[8:11], s32 offen lds
    s_add_u32 s32, s34, 0x20000
    s_add_u32 m0, s36, 20480
    s_nop 0
    buffer_load_dwordx4 v64, s[8:11], s32 offen lds
    s_add_u32 s32, s34, 0x24000
    s_add_u32 m0, s36, 21504
    s_nop 0
    buffer_load_dwordx4 v64, s[8:11], s32 offen lds
    s_add_u32 s32, s34, 0x30000
    s_add_u32 m0, s36, 22528
    s_nop 0
    buffer_load_dwordx4 v64, s[8:11], s32 offen lds
    s_add_u32 s32, s34, 0x34000
    s_add_u32 m0, s36, 23552
    s_nop 0
    buffer_load_dwordx4 v64, s[8:11], s32 offen lds
    s_add_u32 s32, s39, 0x80000
    buffer_load_dword v86, v77, s[8:11], s32 offen
    s_add_u32 s32, s34, 0x80000
    s_add_u32 m0, s36, 24576
    s_nop 0
    buffer_load_dwordx4 v64, s[8:11], s32 offen lds
    s_add_u32 s32, s34, 0x84000
    s_add_u32 m0, s36, 25600
    s_nop 0
    buffer_load_dwordx4 v64, s[8:11], s32 offen lds
    s_add_u32 s32, s34, 0x90000
    s_add_u32 m0, s36, 26624
    s_nop 0
    buffer_load_dwordx4 v64, s[8:11], s32 offen lds
    s_add_u32 s32, s34, 0x94000
    s_add_u32 m0, s36, 27648
    s_nop 0
    buffer_load_dwordx4 v64, s[8:11], s32 offen lds
    s_add_u32 s32, s34, 0xa0000
    s_add_u32 m0, s36, 28672
    s_nop 0
    buffer_load_dwordx4 v64, s[8:11], s32 offen lds
    s_add_u32 s32, s34, 0xa4000
    s_add_u32 m0, s36, 29696
    s_nop 0
    buffer_load_dwordx4 v64, s[8:11], s32 offen lds
    s_add_u32 s32, s34, 0xb0000
    s_add_u32 m0, s36, 30720
    s_nop 0
    buffer_load_dwordx4 v64, s[8:11], s32 offen lds
    s_add_u32 s32, s34, 0xb4000
    s_add_u32 m0, s36, 31744
    s_nop 0
    buffer_load_dwordx4 v64, s[8:11], s32 offen lds
    s_waitcnt vmcnt(27)
    s_barrier
    ds_read_b64_tr_b16 v[128:129], v69 offset:0
    ds_read_b64_tr_b16 v[130:131], v69 offset:1024
    ds_read_b64_tr_b16 v[132:133], v69 offset:4096
    ds_read_b64_tr_b16 v[134:135], v69 offset:5120
    ds_read_b64_tr_b16 v[136:137], v69 offset:32768
    ds_read_b64_tr_b16 v[138:139], v69 offset:33792
    ds_read_b64_tr_b16 v[140:141], v69 offset:36864
    ds_read_b64_tr_b16 v[142:143], v69 offset:37888
    ds_read_b64_tr_b16 v[144:145], v70 offset:0
    ds_read_b64_tr_b16 v[146:147], v70 offset:1024
    ds_read_b64_tr_b16 v[148:149], v70 offset:4096
    ds_read_b64_tr_b16 v[150:151], v70 offset:5120
    ds_read_b64_tr_b16 v[152:153], v70 offset:32768
    ds_read_b64_tr_b16 v[154:155], v70 offset:33792
    ds_read_b64_tr_b16 v[156:157], v70 offset:36864
    ds_read_b64_tr_b16 v[158:159], v70 offset:37888
    s_waitcnt lgkmcnt(0)
    s_waitcnt vmcnt(18)
    s_barrier
    s_add_u32 s32, s39, 0x100000
    buffer_load_dword v86, v77, s[8:11], s32 offen
    s_add_u32 s32, s34, 0x100000
    s_add_u32 m0, s36, 0
    s_nop 0
    buffer_load_dwordx4 v64, s[8:11], s32 offen lds
    s_add_u32 s32, s34, 0x104000
    s_add_u32 m0, s36, 1024
    s_nop 0
    buffer_load_dwordx4 v64, s[8:11], s32 offen lds
    s_add_u32 s32, s34, 0x110000
    s_add_u32 m0, s36, 2048
    s_nop 0
    buffer_load_dwordx4 v64, s[8:11], s32 offen lds
    s_add_u32 s32, s34, 0x114000
    s_add_u32 m0, s36, 3072
    s_nop 0
    buffer_load_dwordx4 v64, s[8:11], s32 offen lds
    s_add_u32 s32, s34, 0x120000
    s_add_u32 m0, s36, 4096
    s_nop 0
    buffer_load_dwordx4 v64, s[8:11], s32 offen lds
    s_add_u32 s32, s34, 0x124000
    s_add_u32 m0, s36, 5120
    s_nop 0
    buffer_load_dwordx4 v64, s[8:11], s32 offen lds
    s_add_u32 s32, s34, 0x130000
    s_add_u32 m0, s36, 6144
    s_nop 0
    buffer_load_dwordx4 v64, s[8:11], s32 offen lds
    s_add_u32 s32, s34, 0x134000
    s_add_u32 m0, s36, 7168
    s_nop 0
    buffer_load_dwordx4 v64, s[8:11], s32 offen lds
    ds_read_b64_tr_b16 v[160:161], v69 offset:8192
    ds_read_b64_tr_b16 v[162:163], v69 offset:9216
    ds_read_b64_tr_b16 v[164:165], v69 offset:12288
    ds_read_b64_tr_b16 v[166:167], v69 offset:13312
    ds_read_b64_tr_b16 v[168:169], v69 offset:40960
    ds_read_b64_tr_b16 v[170:171], v69 offset:41984
    ds_read_b64_tr_b16 v[172:173], v69 offset:45056
    ds_read_b64_tr_b16 v[174:175], v69 offset:46080
    ds_read_b64_tr_b16 v[176:177], v70 offset:8192
    ds_read_b64_tr_b16 v[178:179], v70 offset:9216
    ds_read_b64_tr_b16 v[180:181], v70 offset:12288
    ds_read_b64_tr_b16 v[182:183], v70 offset:13312
    ds_read_b64_tr_b16 v[184:185], v70 offset:40960
    ds_read_b64_tr_b16 v[186:187], v70 offset:41984
    ds_read_b64_tr_b16 v[188:189], v70 offset:45056
    ds_read_b64_tr_b16 v[190:191], v70 offset:46080
    s_waitcnt lgkmcnt(0)
    s_waitcnt vmcnt(18)
    s_barrier
    s_add_u32 s32, s39, 0x180000
    buffer_load_dword v86, v77, s[8:11], s32 offen
    s_add_u32 s32, s34, 0x180000
    s_add_u32 m0, s36, 8192
    s_nop 0
    buffer_load_dwordx4 v64, s[8:11], s32 offen lds
    s_add_u32 s32, s34, 0x184000
    s_add_u32 m0, s36, 9216
    s_nop 0
    buffer_load_dwordx4 v64, s[8:11], s32 offen lds
    s_add_u32 s32, s34, 0x190000
    s_add_u32 m0, s36, 10240
    s_nop 0
    buffer_load_dwordx4 v64, s[8:11], s32 offen lds
    s_add_u32 s32, s34, 0x194000
    s_add_u32 m0, s36, 11264
    s_nop 0
    buffer_load_dwordx4 v64, s[8:11], s32 offen lds
    s_add_u32 s32, s34, 0x1a0000
    s_add_u32 m0, s36, 12288
    s_nop 0
    buffer_load_dwordx4 v64, s[8:11], s32 offen lds
    s_add_u32 s32, s34, 0x1a4000
    s_add_u32 m0, s36, 13312
    s_nop 0
    buffer_load_dwordx4 v64, s[8:11], s32 offen lds
    s_add_u32 s32, s34, 0x1b0000
    s_add_u32 m0, s36, 14336
    s_nop 0
    buffer_load_dwordx4 v64, s[8:11], s32 offen lds
    s_add_u32 s32, s34, 0x1b4000
    s_add_u32 m0, s36, 15360
    s_nop 0
    buffer_load_dwordx4 v64, s[8:11], s32 offen lds
    ds_read_b64_tr_b16 a[0:1], v67 offset:16384
    ds_read_b64_tr_b16 a[2:3], v67 offset:17408
    ds_read_b64_tr_b16 a[4:5], v67 offset:20480
    ds_read_b64_tr_b16 a[6:7], v67 offset:21504
    ds_read_b64_tr_b16 a[8:9], v67 offset:49152
    ds_read_b64_tr_b16 a[10:11], v67 offset:50176
    ds_read_b64_tr_b16 a[12:13], v67 offset:53248
    ds_read_b64_tr_b16 a[14:15], v67 offset:54272
    ds_read_b64_tr_b16 a[128:129], v68 offset:16384
    ds_read_b64_tr_b16 a[130:131], v68 offset:17408
    ds_read_b64_tr_b16 a[132:133], v68 offset:20480
    ds_read_b64_tr_b16 a[134:135], v68 offset:21504
    ds_read_b64_tr_b16 a[136:137], v68 offset:49152
    ds_read_b64_tr_b16 a[138:139], v68 offset:50176
    ds_read_b64_tr_b16 a[140:141], v68 offset:53248
    ds_read_b64_tr_b16 a[142:143], v68 offset:54272
    s_waitcnt lgkmcnt(0)
    s_waitcnt vmcnt(18)
    s_barrier
    s_add_u32 s32, s39, 0x200000
    buffer_load_dword v86, v77, s[8:11], s32 offen
    s_add_u32 s32, s34, 0x200000
    s_add_u32 m0, s36, 16384
    s_nop 0
    buffer_load_dwordx4 v64, s[8:11], s32 offen lds
    s_add_u32 s32, s34, 0x204000
    s_add_u32 m0, s36, 17408
    s_nop 0
    buffer_load_dwordx4 v64, s[8:11], s32 offen lds
    s_add_u32 s32, s34, 0x210000
    s_add_u32 m0, s36, 18432
    s_nop 0
    buffer_load_dwordx4 v64, s[8:11], s32 offen lds
    s_add_u32 s32, s34, 0x214000
    s_add_u32 m0, s36, 19456
    s_nop 0
    buffer_load_dwordx4 v64, s[8:11], s32 offen lds
    s_add_u32 s32, s34, 0x220000
    s_add_u32 m0, s36, 20480
    s_nop 0
    buffer_load_dwordx4 v64, s[8:11], s32 offen lds
    s_add_u32 s32, s34, 0x224000
    s_add_u32 m0, s36, 21504
    s_nop 0
    buffer_load_dwordx4 v64, s[8:11], s32 offen lds
    s_add_u32 s32, s34, 0x230000
    s_add_u32 m0, s36, 22528
    s_nop 0
    buffer_load_dwordx4 v64, s[8:11], s32 offen lds
    s_add_u32 s32, s34, 0x234000
    s_add_u32 m0, s36, 23552
    s_nop 0
    buffer_load_dwordx4 v64, s[8:11], s32 offen lds
    ds_read_b64_tr_b16 a[16:17], v67 offset:24576
    ds_read_b64_tr_b16 a[18:19], v67 offset:25600
    ds_read_b64_tr_b16 a[20:21], v67 offset:28672
    ds_read_b64_tr_b16 a[22:23], v67 offset:29696
    ds_read_b64_tr_b16 a[24:25], v67 offset:57344
    ds_read_b64_tr_b16 a[26:27], v67 offset:58368
    ds_read_b64_tr_b16 a[28:29], v67 offset:61440
    ds_read_b64_tr_b16 a[30:31], v67 offset:62464
    ds_read_b64_tr_b16 a[144:145], v68 offset:24576
    ds_read_b64_tr_b16 a[146:147], v68 offset:25600
    ds_read_b64_tr_b16 a[148:149], v68 offset:28672
    ds_read_b64_tr_b16 a[150:151], v68 offset:29696
    ds_read_b64_tr_b16 a[152:153], v68 offset:57344
    ds_read_b64_tr_b16 a[154:155], v68 offset:58368
    ds_read_b64_tr_b16 a[156:157], v68 offset:61440
    ds_read_b64_tr_b16 a[158:159], v68 offset:62464
    s_waitcnt lgkmcnt(0)
    s_waitcnt vmcnt(18)
    s_barrier
    s_add_u32 s32, s39, 0x280000
    buffer_load_dword v86, v77, s[8:11], s32 offen
    s_add_u32 s32, s34, 0x280000
    s_add_u32 m0, s36, 24576
    s_nop 0
    buffer_load_dwordx4 v64, s[8:11], s32 offen lds
    s_add_u32 s32, s34, 0x284000
    s_add_u32 m0, s36, 25600
    s_nop 0
    buffer_load_dwordx4 v64, s[8:11], s32 offen lds
    s_add_u32 s32, s34, 0x290000
    s_add_u32 m0, s36, 26624
    s_nop 0
    buffer_load_dwordx4 v64, s[8:11], s32 offen lds
    s_add_u32 s32, s34, 0x294000
    s_add_u32 m0, s36, 27648
    s_nop 0
    buffer_load_dwordx4 v64, s[8:11], s32 offen lds
    s_add_u32 s32, s34, 0x2a0000
    s_add_u32 m0, s36, 28672
    s_nop 0
    buffer_load_dwordx4 v64, s[8:11], s32 offen lds
    s_add_u32 s32, s34, 0x2a4000
    s_add_u32 m0, s36, 29696
    s_nop 0
    buffer_load_dwordx4 v64, s[8:11], s32 offen lds
    s_add_u32 s32, s34, 0x2b0000
    s_add_u32 m0, s36, 30720
    s_nop 0
    buffer_load_dwordx4 v64, s[8:11], s32 offen lds
    s_add_u32 s32, s34, 0x2b4000
    s_add_u32 m0, s36, 31744
    s_nop 0
    buffer_load_dwordx4 v64, s[8:11], s32 offen lds
    ds_read_b64_tr_b16 a[32:33], v67 offset:0
    ds_read_b64_tr_b16 a[34:35], v67 offset:1024
    ds_read_b64_tr_b16 a[36:37], v67 offset:4096
    ds_read_b64_tr_b16 a[38:39], v67 offset:5120
    ds_read_b64_tr_b16 a[40:41], v67 offset:32768
    ds_read_b64_tr_b16 a[42:43], v67 offset:33792
    ds_read_b64_tr_b16 a[44:45], v67 offset:36864
    ds_read_b64_tr_b16 a[46:47], v67 offset:37888
    ds_read_b64_tr_b16 a[160:161], v68 offset:0
    ds_read_b64_tr_b16 a[162:163], v68 offset:1024
    ds_read_b64_tr_b16 a[164:165], v68 offset:4096
    ds_read_b64_tr_b16 a[166:167], v68 offset:5120
    ds_read_b64_tr_b16 a[168:169], v68 offset:32768
    ds_read_b64_tr_b16 a[170:171], v68 offset:33792
    ds_read_b64_tr_b16 a[172:173], v68 offset:36864
    ds_read_b64_tr_b16 a[174:175], v68 offset:37888
    s_waitcnt lgkmcnt(0)
    s_waitcnt vmcnt(18)
    s_barrier
    s_add_u32 s32, s39, 0x300000
    buffer_load_dword v86, v77, s[8:11], s32 offen
    s_add_u32 s32, s34, 0x300000
    s_add_u32 m0, s36, 0
    s_nop 0
    buffer_load_dwordx4 v64, s[8:11], s32 offen lds
    s_add_u32 s32, s34, 0x304000
    s_add_u32 m0, s36, 1024
    s_nop 0
    buffer_load_dwordx4 v64, s[8:11], s32 offen lds
    s_add_u32 s32, s34, 0x310000
    s_add_u32 m0, s36, 2048
    s_nop 0
    buffer_load_dwordx4 v64, s[8:11], s32 offen lds
    s_add_u32 s32, s34, 0x314000
    s_add_u32 m0, s36, 3072
    s_nop 0
    buffer_load_dwordx4 v64, s[8:11], s32 offen lds
    s_add_u32 s32, s34, 0x320000
    s_add_u32 m0, s36, 4096
    s_nop 0
    buffer_load_dwordx4 v64, s[8:11], s32 offen lds
    s_add_u32 s32, s34, 0x324000
    s_add_u32 m0, s36, 5120
    s_nop 0
    buffer_load_dwordx4 v64, s[8:11], s32 offen lds
    s_add_u32 s32, s34, 0x330000
    s_add_u32 m0, s36, 6144
    s_nop 0
    buffer_load_dwordx4 v64, s[8:11], s32 offen lds
    s_add_u32 s32, s34, 0x334000
    s_add_u32 m0, s36, 7168
    s_nop 0
    buffer_load_dwordx4 v64, s[8:11], s32 offen lds
    ds_read_b64_tr_b16 a[48:49], v67 offset:8192
    ds_read_b64_tr_b16 a[50:51], v67 offset:9216
    ds_read_b64_tr_b16 a[52:53], v67 offset:12288
    ds_read_b64_tr_b16 a[54:55], v67 offset:13312
    ds_read_b64_tr_b16 a[56:57], v67 offset:40960
    ds_read_b64_tr_b16 a[58:59], v67 offset:41984
    ds_read_b64_tr_b16 a[60:61], v67 offset:45056
    ds_read_b64_tr_b16 a[62:63], v67 offset:46080
    ds_read_b64_tr_b16 a[176:177], v68 offset:8192
    ds_read_b64_tr_b16 a[178:179], v68 offset:9216
    ds_read_b64_tr_b16 a[180:181], v68 offset:12288
    ds_read_b64_tr_b16 a[182:183], v68 offset:13312
    ds_read_b64_tr_b16 a[184:185], v68 offset:40960
    ds_read_b64_tr_b16 a[186:187], v68 offset:41984
    ds_read_b64_tr_b16 a[188:189], v68 offset:45056
    ds_read_b64_tr_b16 a[190:191], v68 offset:46080
    s_waitcnt lgkmcnt(0)
    s_waitcnt vmcnt(18)
    s_barrier
    s_add_u32 s32, s39, 0x380000
    buffer_load_dword v86, v77, s[8:11], s32 offen
    s_add_u32 s32, s34, 0x380000
    s_add_u32 m0, s36, 8192
    s_nop 0
    buffer_load_dwordx4 v64, s[8:11], s32 offen lds
    s_add_u32 s32, s34, 0x384000
    s_add_u32 m0, s36, 9216
    s_nop 0
    buffer_load_dwordx4 v64, s[8:11], s32 offen lds
    s_add_u32 s32, s34, 0x390000
    s_add_u32 m0, s36, 10240
    s_nop 0
    buffer_load_dwordx4 v64, s[8:11], s32 offen lds
    s_add_u32 s32, s34, 0x394000
    s_add_u32 m0, s36, 11264
    s_nop 0
    buffer_load_dwordx4 v64, s[8:11], s32 offen lds
    s_add_u32 s32, s34, 0x3a0000
    s_add_u32 m0, s36, 12288
    s_nop 0
    buffer_load_dwordx4 v64, s[8:11], s32 offen lds
    s_add_u32 s32, s34, 0x3a4000
    s_add_u32 m0, s36, 13312
    s_nop 0
    buffer_load_dwordx4 v64, s[8:11], s32 offen lds
    s_add_u32 s32, s34, 0x3b0000
    s_add_u32 m0, s36, 14336
    s_nop 0
    buffer_load_dwordx4 v64, s[8:11], s32 offen lds
    s_add_u32 s32, s34, 0x3b4000
    s_add_u32 m0, s36, 15360
    s_nop 0
    buffer_load_dwordx4 v64, s[8:11], s32 offen lds
    ds_read_b64_tr_b16 a[64:65], v67 offset:16384
    ds_read_b64_tr_b16 a[66:67], v67 offset:17408
    ds_read_b64_tr_b16 a[68:69], v67 offset:20480
    ds_read_b64_tr_b16 a[70:71], v67 offset:21504
    ds_read_b64_tr_b16 a[72:73], v67 offset:49152
    ds_read_b64_tr_b16 a[74:75], v67 offset:50176
    ds_read_b64_tr_b16 a[76:77], v67 offset:53248
    ds_read_b64_tr_b16 a[78:79], v67 offset:54272
    ds_read_b64_tr_b16 a[192:193], v68 offset:16384
    ds_read_b64_tr_b16 a[194:195], v68 offset:17408
    ds_read_b64_tr_b16 a[196:197], v68 offset:20480
    ds_read_b64_tr_b16 a[198:199], v68 offset:21504
    ds_read_b64_tr_b16 a[200:201], v68 offset:49152
    ds_read_b64_tr_b16 a[202:203], v68 offset:50176
    ds_read_b64_tr_b16 a[204:205], v68 offset:53248
    ds_read_b64_tr_b16 a[206:207], v68 offset:54272
    s_waitcnt lgkmcnt(0)
    buffer_load_dword v72, v73, s[60:63], 0 offen sc1
    buffer_load_dwordx2 v[84:85], off, s[60:63], 0 offset:16 sc1
    s_waitcnt vmcnt(20)
    s_barrier
    s_mov_b32 s8, s46
    s_and_b32 s9, s47, 0xffff
    s_mov_b32 s10, 0x800000
    s_mov_b32 s11, 0x20000
    s_add_u32 s32, s3, 0x0
    s_add_u32 m0, s36, 16384
    s_nop 0
    buffer_load_dwordx4 v66, s[8:11], s32 offen lds
    s_add_u32 s32, s3, 0x1000
    s_add_u32 m0, s36, 17408
    s_nop 0
    buffer_load_dwordx4 v66, s[8:11], s32 offen lds
    s_add_u32 s32, s3, 0x2000
    s_add_u32 m0, s36, 18432
    s_nop 0
    buffer_load_dwordx4 v66, s[8:11], s32 offen lds
    s_add_u32 s32, s3, 0x3000
    s_add_u32 m0, s36, 19456
    s_nop 0
    buffer_load_dwordx4 v66, s[8:11], s32 offen lds
    s_add_u32 s32, s3, 0x4000
    s_add_u32 m0, s36, 20480
    s_nop 0
    buffer_load_dwordx4 v66, s[8:11], s32 offen lds
    s_add_u32 s32, s3, 0x5000
    s_add_u32 m0, s36, 21504
    s_nop 0
    buffer_load_dwordx4 v66, s[8:11], s32 offen lds
    s_add_u32 s32, s3, 0x6000
    s_add_u32 m0, s36, 22528
    s_nop 0
    buffer_load_dwordx4 v66, s[8:11], s32 offen lds
    s_add_u32 s32, s3, 0x7000
    s_add_u32 m0, s36, 23552
    s_nop 0
    buffer_load_dwordx4 v66, s[8:11], s32 offen lds
    ds_read_b64_tr_b16 a[80:81], v67 offset:24576
    ds_read_b64_tr_b16 a[82:83], v67 offset:25600
    ds_read_b64_tr_b16 a[84:85], v67 offset:28672
    ds_read_b64_tr_b16 a[86:87], v67 offset:29696
    ds_read_b64_tr_b16 a[88:89], v67 offset:57344
    ds_read_b64_tr_b16 a[90:91], v67 offset:58368
    ds_read_b64_tr_b16 a[92:93], v67 offset:61440
    ds_read_b64_tr_b16 a[94:95], v67 offset:62464
    ds_read_b64_tr_b16 a[208:209], v68 offset:24576
    ds_read_b64_tr_b16 a[210:211], v68 offset:25600
    ds_read_b64_tr_b16 a[212:213], v68 offset:28672
    ds_read_b64_tr_b16 a[214:215], v68 offset:29696
    ds_read_b64_tr_b16 a[216:217], v68 offset:57344
    ds_read_b64_tr_b16 a[218:219], v68 offset:58368
    ds_read_b64_tr_b16 a[220:221], v68 offset:61440
    ds_read_b64_tr_b16 a[222:223], v68 offset:62464
    s_waitcnt lgkmcnt(0)
    s_waitcnt vmcnt(19)
    s_barrier
    s_add_u32 s32, s3, 0x10000
    s_add_u32 m0, s36, 24576
    s_nop 0
    buffer_load_dwordx4 v66, s[8:11], s32 offen lds
    s_add_u32 s32, s3, 0x11000
    s_add_u32 m0, s36, 25600
    s_nop 0
    buffer_load_dwordx4 v66, s[8:11], s32 offen lds
    s_add_u32 s32, s3, 0x12000
    s_add_u32 m0, s36, 26624
    s_nop 0
    buffer_load_dwordx4 v66, s[8:11], s32 offen lds
    s_add_u32 s32, s3, 0x13000
    s_add_u32 m0, s36, 27648
    s_nop 0
    buffer_load_dwordx4 v66, s[8:11], s32 offen lds
    s_add_u32 s32, s3, 0x14000
    s_add_u32 m0, s36, 28672
    s_nop 0
    buffer_load_dwordx4 v66, s[8:11], s32 offen lds
    s_add_u32 s32, s3, 0x15000
    s_add_u32 m0, s36, 29696
    s_nop 0
    buffer_load_dwordx4 v66, s[8:11], s32 offen lds
    s_add_u32 s32, s3, 0x16000
    s_add_u32 m0, s36, 30720
    s_nop 0
    buffer_load_dwordx4 v66, s[8:11], s32 offen lds
    s_add_u32 s32, s3, 0x17000
    s_add_u32 m0, s36, 31744
    s_nop 0
    buffer_load_dwordx4 v66, s[8:11], s32 offen lds
    ds_read_b64_tr_b16 a[96:97], v67 offset:0
    ds_read_b64_tr_b16 a[98:99], v67 offset:1024
    ds_read_b64_tr_b16 a[100:101], v67 offset:4096
    ds_read_b64_tr_b16 a[102:103], v67 offset:5120
    ds_read_b64_tr_b16 a[104:105], v67 offset:32768
    ds_read_b64_tr_b16 a[106:107], v67 offset:33792
    ds_read_b64_tr_b16 a[108:109], v67 offset:36864
    ds_read_b64_tr_b16 a[110:111], v67 offset:37888
    ds_read_b64_tr_b16 a[224:225], v68 offset:0
    ds_read_b64_tr_b16 a[226:227], v68 offset:1024
    ds_read_b64_tr_b16 a[228:229], v68 offset:4096
    ds_read_b64_tr_b16 a[230:231], v68 offset:5120
    ds_read_b64_tr_b16 a[232:233], v68 offset:32768
    ds_read_b64_tr_b16 a[234:235], v68 offset:33792
    ds_read_b64_tr_b16 a[236:237], v68 offset:36864
    ds_read_b64_tr_b16 a[238:239], v68 offset:37888
    s_waitcnt lgkmcnt(0)
    s_waitcnt vmcnt(18)
    s_barrier
    s_mov_b32 s8, s44
    s_and_b32 s9, s45, 0xffff
    s_mov_b32 s10, 0x800000
    s_mov_b32 s11, 0x20000
    s_sub_u32 s39, 511, s44
    s_and_b32 s39, s39, 0x380
    s_andn2_b32 s32, s35, 0x1fff
    s_add_u32 s39, s39, s32
    s_add_u32 s32, s39, 0x200000
    buffer_load_dword v86, v77, s[8:11], s32 offen
    s_add_u32 s32, s35, 0x200000
    s_add_u32 m0, s36, 0
    s_nop 0
    buffer_load_dwordx4 v65, s[8:11], s32 offen lds
    s_add_u32 s32, s35, 0x204000
    s_add_u32 m0, s36, 1024
    s_nop 0
    buffer_load_dwordx4 v65, s[8:11], s32 offen lds
    s_add_u32 s32, s35, 0x210000
    s_add_u32 m0, s36, 2048
    s_nop 0
    buffer_load_dwordx4 v65, s[8:11], s32 offen lds
    s_add_u32 s32, s35, 0x214000
    s_add_u32 m0, s36, 3072
    s_nop 0
    buffer_load_dwordx4 v65, s[8:11], s32 offen lds
    s_add_u32 s32, s35, 0x220000
    s_add_u32 m0, s36, 4096
    s_nop 0
    buffer_load_dwordx4 v65, s[8:11], s32 offen lds
    s_add_u32 s32, s35, 0x224000
    s_add_u32 m0, s36, 5120
    s_nop 0
    buffer_load_dwordx4 v65, s[8:11], s32 offen lds
    s_add_u32 s32, s35, 0x230000
    s_add_u32 m0, s36, 6144
    s_nop 0
    buffer_load_dwordx4 v65, s[8:11], s32 offen lds
    s_add_u32 s32, s35, 0x234000
    s_add_u32 m0, s36, 7168
    s_nop 0
    buffer_load_dwordx4 v65, s[8:11], s32 offen lds
    ds_read_b64_tr_b16 a[112:113], v67 offset:8192
    ds_read_b64_tr_b16 a[114:115], v67 offset:9216
    ds_read_b64_tr_b16 a[116:117], v67 offset:12288
    ds_read_b64_tr_b16 a[118:119], v67 offset:13312
    ds_read_b64_tr_b16 a[120:121], v67 offset:40960
    ds_read_b64_tr_b16 a[122:123], v67 offset:41984
    ds_read_b64_tr_b16 a[124:125], v67 offset:45056
    ds_read_b64_tr_b16 a[126:127], v67 offset:46080
    ds_read_b64_tr_b16 a[240:241], v68 offset:8192
    ds_read_b64_tr_b16 a[242:243], v68 offset:9216
    ds_read_b64_tr_b16 a[244:245], v68 offset:12288
    ds_read_b64_tr_b16 a[246:247], v68 offset:13312
    ds_read_b64_tr_b16 a[248:249], v68 offset:40960
    ds_read_b64_tr_b16 a[250:251], v68 offset:41984
    ds_read_b64_tr_b16 a[252:253], v68 offset:45056
    ds_read_b64_tr_b16 a[254:255], v68 offset:46080
    s_waitcnt lgkmcnt(0)
    s_waitcnt vmcnt(17)
    s_barrier
    s_add_u32 s32, s39, 0x300000
    buffer_load_dword v86, v77, s[8:11], s32 offen
    s_add_u32 s32, s35, 0x300000
    s_add_u32 m0, s36, 8192
    s_nop 0
    buffer_load_dwordx4 v65, s[8:11], s32 offen lds
    s_add_u32 s32, s35, 0x304000
    s_add_u32 m0, s36, 9216
    s_nop 0
    buffer_load_dwordx4 v65, s[8:11], s32 offen lds
    s_add_u32 s32, s35, 0x310000
    s_add_u32 m0, s36, 10240
    s_nop 0
    buffer_load_dwordx4 v65, s[8:11], s32 offen lds
    s_add_u32 s32, s35, 0x314000
    s_add_u32 m0, s36, 11264
    s_nop 0
    buffer_load_dwordx4 v65, s[8:11], s32 offen lds
    s_add_u32 s32, s35, 0x320000
    s_add_u32 m0, s36, 12288
    s_nop 0
    buffer_load_dwordx4 v65, s[8:11], s32 offen lds
    s_add_u32 s32, s35, 0x324000
    s_add_u32 m0, s36, 13312
    s_nop 0
    buffer_load_dwordx4 v65, s[8:11], s32 offen lds
    s_add_u32 s32, s35, 0x330000
    s_add_u32 m0, s36, 14336
    s_nop 0
    buffer_load_dwordx4 v65, s[8:11], s32 offen lds
    s_add_u32 s32, s35, 0x334000
    s_add_u32 m0, s36, 15360
    s_nop 0
    buffer_load_dwordx4 v65, s[8:11], s32 offen lds
    v_readlane_b32 s48, v72, 0
    v_readlane_b32 s49, v72, 1
    v_readlane_b32 s50, v72, 2
    v_readlane_b32 s51, v72, 3
    v_readlane_b32 s52, v72, 4
    v_readlane_b32 s53, v72, 5
    v_readlane_b32 s54, v72, 6
    v_readlane_b32 s55, v72, 7
    v_readlane_b32 s38, v72, 8
    s_nop 3
    s_add_u32 s33, s48, s49
    s_add_u32 s33, s33, s50
    s_add_u32 s33, s33, s51
    s_add_u32 s33, s33, s52
    s_add_u32 s33, s33, s53
    s_add_u32 s33, s33, s54
    s_add_u32 s33, s33, s55
    s_cmp_ge_u32 s38, 4
    s_cselect_b32 s33, s33, 0
    s_cmp_ge_u32 s33, 256
    s_cselect_b32 s38, 0, 1
    ds_read_b64_tr_b16 v[192:193], v80 offset:16384
    ds_read_b64_tr_b16 v[194:195], v80 offset:17408
    ds_read_b64_tr_b16 v[196:197], v80 offset:20480
    ds_read_b64_tr_b16 v[198:199], v80 offset:21504
    ds_read_b64_tr_b16 v[208:209], v81 offset:16384
    ds_read_b64_tr_b16 v[210:211], v81 offset:17408
    ds_read_b64_tr_b16 v[212:213], v81 offset:20480
    ds_read_b64_tr_b16 v[214:215], v81 offset:21504
    ds_read_b64_tr_b16 v[224:225], v82 offset:16384
    ds_read_b64_tr_b16 v[226:227], v82 offset:17408
    ds_read_b64_tr_b16 v[228:229], v82 offset:20480
    ds_read_b64_tr_b16 v[230:231], v82 offset:21504
    ds_read_b64_tr_b16 v[240:241], v83 offset:16384
    ds_read_b64_tr_b16 v[242:243], v83 offset:17408
    ds_read_b64_tr_b16 v[244:245], v83 offset:20480
    ds_read_b64_tr_b16 v[246:247], v83 offset:21504
    s_waitcnt lgkmcnt(0)
    s_waitcnt vmcnt(18)
    s_barrier
    s_mov_b32 s8, s46
    s_and_b32 s9, s47, 0xffff
    s_mov_b32 s10, 0x800000
    s_mov_b32 s11, 0x20000
    s_add_u32 s32, s3, 0x20000
    s_add_u32 m0, s36, 16384
    s_nop 0
    buffer_load_dwordx4 v66, s[8:11], s32 offen lds
    s_add_u32 s32, s3, 0x21000
    s_add_u32 m0, s36, 17408
    s_nop 0
    buffer_load_dwordx4 v66, s[8:11], s32 offen lds
    s_add_u32 s32, s3, 0x22000
    s_add_u32 m0, s36, 18432
    s_nop 0
    buffer_load_dwordx4 v66, s[8:11], s32 offen lds
    s_add_u32 s32, s3, 0x23000
    s_add_u32 m0, s36, 19456
    s_nop 0
    buffer_load_dwordx4 v66, s[8:11], s32 offen lds
    s_add_u32 s32, s3, 0x24000
    s_add_u32 m0, s36, 20480
    s_nop 0
    buffer_load_dwordx4 v66, s[8:11], s32 offen lds
    s_add_u32 s32, s3, 0x25000
    s_add_u32 m0, s36, 21504
    s_nop 0
    buffer_load_dwordx4 v66, s[8:11], s32 offen lds
    s_add_u32 s32, s3, 0x26000
    s_add_u32 m0, s36, 22528
    s_nop 0
    buffer_load_dwordx4 v66, s[8:11], s32 offen lds
    s_add_u32 s32, s3, 0x27000
    s_add_u32 m0, s36, 23552
    s_nop 0
    buffer_load_dwordx4 v66, s[8:11], s32 offen lds
    ds_read_b64_tr_b16 v[200:201], v80 offset:24576
    ds_read_b64_tr_b16 v[202:203], v80 offset:25600
    ds_read_b64_tr_b16 v[204:205], v80 offset:28672
    ds_read_b64_tr_b16 v[206:207], v80 offset:29696
    ds_read_b64_tr_b16 v[216:217], v81 offset:24576
    ds_read_b64_tr_b16 v[218:219], v81 offset:25600
    ds_read_b64_tr_b16 v[220:221], v81 offset:28672
    ds_read_b64_tr_b16 v[222:223], v81 offset:29696
    ds_read_b64_tr_b16 v[232:233], v82 offset:24576
    ds_read_b64_tr_b16 v[234:235], v82 offset:25600
    ds_read_b64_tr_b16 v[236:237], v82 offset:28672
    ds_read_b64_tr_b16 v[238:239], v82 offset:29696
    ds_read_b64_tr_b16 v[248:249], v83 offset:24576
    ds_read_b64_tr_b16 v[250:251], v83 offset:25600
    ds_read_b64_tr_b16 v[252:253], v83 offset:28672
    ds_read_b64_tr_b16 v[254:255], v83 offset:29696
    s_waitcnt lgkmcnt(0)
    s_waitcnt vmcnt(17)
    s_barrier
    s_add_u32 s32, s3, 0x30000
    s_add_u32 m0, s36, 24576
    s_nop 0
    buffer_load_dwordx4 v66, s[8:11], s32 offen lds
    s_add_u32 s32, s3, 0x31000
    s_add_u32 m0, s36, 25600
    s_nop 0
    buffer_load_dwordx4 v66, s[8:11], s32 offen lds
    s_add_u32 s32, s3, 0x32000
    s_add_u32 m0, s36, 26624
    s_nop 0
    buffer_load_dwordx4 v66, s[8:11], s32 offen lds
    s_add_u32 s32, s3, 0x33000
    s_add_u32 m0, s36, 27648
    s_nop 0
    buffer_load_dwordx4 v66, s[8:11], s32 offen lds
    s_add_u32 s32, s3, 0x34000
    s_add_u32 m0, s36, 28672
    s_nop 0
    buffer_load_dwordx4 v66, s[8:11], s32 offen lds
    s_add_u32 s32, s3, 0x35000
    s_add_u32 m0, s36, 29696
    s_nop 0
    buffer_load_dwordx4 v66, s[8:11], s32 offen lds
    s_add_u32 s32, s3, 0x36000
    s_add_u32 m0, s36, 30720
    s_nop 0
    buffer_load_dwordx4 v66, s[8:11], s32 offen lds
    s_add_u32 s32, s3, 0x37000
    s_add_u32 m0, s36, 31744
    s_nop 0
    buffer_load_dwordx4 v66, s[8:11], s32 offen lds
    ds_read_b64_tr_b16 v[0:1], v69 offset:0
    ds_read_b64_tr_b16 v[2:3], v69 offset:1024
    ds_read_b64_tr_b16 v[4:5], v69 offset:4096
    ds_read_b64_tr_b16 v[6:7], v69 offset:5120
    ds_read_b64_tr_b16 v[8:9], v69 offset:32768
    ds_read_b64_tr_b16 v[10:11], v69 offset:33792
    ds_read_b64_tr_b16 v[12:13], v69 offset:36864
    ds_read_b64_tr_b16 v[14:15], v69 offset:37888
    ds_read_b64_tr_b16 v[16:17], v70 offset:0
    ds_read_b64_tr_b16 v[18:19], v70 offset:1024
    ds_read_b64_tr_b16 v[20:21], v70 offset:4096
    ds_read_b64_tr_b16 v[22:23], v70 offset:5120
    ds_read_b64_tr_b16 v[24:25], v70 offset:32768
    ds_read_b64_tr_b16 v[26:27], v70 offset:33792
    ds_read_b64_tr_b16 v[28:29], v70 offset:36864
    ds_read_b64_tr_b16 v[30:31], v70 offset:37888
    s_waitcnt lgkmcnt(0)
    v_and_b32 v64, 15, v94
    v_lshrrev_b32 v65, 4, v94
    v_mov_b32 v66, 0x3c00
    v_mov_b32 v67, 0x3c000000
    v_cmp_eq_u32 vcc, 0, v64
    s_nop 1
    v_cndmask_b32 v127, 0, v66, vcc
    v_cmp_eq_u32 vcc, 1, v64
    s_nop 1
    v_cndmask_b32 v106, v127, v67, vcc
    v_cmp_eq_u32 vcc, 2, v64
    s_nop 1
    v_cndmask_b32 v127, 0, v66, vcc
    v_cmp_eq_u32 vcc, 3, v64
    s_nop 1
    v_cndmask_b32 v107, v127, v67, vcc
    v_cmp_eq_u32 vcc, 4, v64
    s_nop 1
    v_cndmask_b32 v127, 0, v66, vcc
    v_cmp_eq_u32 vcc, 5, v64
    s_nop 1
    v_cndmask_b32 v108, v127, v67, vcc
    v_cmp_eq_u32 vcc, 6, v64
    s_nop 1
    v_cndmask_b32 v127, 0, v66, vcc
    v_cmp_eq_u32 vcc, 7, v64
    s_nop 1
    v_cndmask_b32 v109, v127, v67, vcc
    v_mov_b32 v66, 0x3f80
    v_mov_b32 v67, 0x3f800000
    v_and_b32 v126, 1, v65
    v_lshrrev_b32 v68, 1, v65
    v_lshl_add_u32 v126, v126, 2, v68
    v_sub_u32 v68, v64, v126
    v_cmp_eq_u32 vcc, 0, v68
    s_nop 1
    v_cndmask_b32 v127, 0, v66, vcc
    v_cmp_eq_u32 vcc, 2, v68
    s_nop 1
    v_cndmask_b32 v102, v127, v67, vcc
    v_cmp_eq_u32 vcc, 0, v68
    s_nop 1
    v_cndmask_b32 v127, 0, v66, vcc
    v_cmp_eq_u32 vcc, 2, v68
    s_nop 1
    v_cndmask_b32 v103, v127, v67, vcc
    v_cmp_eq_u32 vcc, 8, v68
    s_nop 1
    v_cndmask_b32 v127, 0, v66, vcc
    v_cmp_eq_u32 vcc, 10, v68
    s_nop 1
    v_cndmask_b32 v104, v127, v67, vcc
    v_cmp_eq_u32 vcc, 8, v68
    s_nop 1
    v_cndmask_b32 v127, 0, v66, vcc
    v_cmp_eq_u32 vcc, 10, v68
    s_nop 1
    v_cndmask_b32 v105, v127, v67, vcc
    v_mov_b32 v100, 0x3f003f00
    v_mov_b32 v101, 0x3f003f00
    v_and_b32 v126, 7, v64
    v_lshlrev_b32 v126, 4, v126
    v_lshl_add_u32 v114, v65, 7, v126
    v_lshrrev_b32 v126, 3, v64
    v_lshl_add_u32 v119, v126, 3, v114
    v_lshl_add_u32 v118, v126, 11, v114
    v_lshl_add_u32 v118, s14, 9, v118
    v_lshlrev_b32 v126, 4, v64
    v_lshl_add_u32 v120, v65, 13, v126
    v_lshlrev_b32 v123, 3, v94
    s_lshl_b32 s32, s14, 10
    s_add_u32 s32, s32, 16384
    v_and_b32 v126, 32, v94
    v_lshlrev_b32 v126, 1, v126
    v_xor_b32 v126, v126, v123
    v_add_u32 v124, s32, v126
    v_lshrrev_b32 v126, 2, v64
    v_lshrrev_b32 v127, 1, v65
    v_lshl_add_u32 v126, v126, 1, v127
    v_and_b32 v127, 3, v64
    v_lshl_add_u32 v126, v126, 2, v127
    v_and_b32 v127, 1, v65
    v_lshl_add_u32 v126, v126, 1, v127
    v_lshlrev_b32 v126, 3, v126
    v_mov_b32 v95, 0x7f000000
    v_mov_b32 v66, 0x4444
    v_mov_b32 v67, 0xeeee
    v_cmp_gt_u32 vcc, 8, v64
    s_nop 1
    v_cndmask_b32 v122, v95, v126, vcc
    v_cndmask_b32 v125, v114, v95, vcc
    v_cndmask_b32 v110, v67, v66, vcc
    v_lshrrev_b32 v126, 2, v94
    v_lshlrev_b32 v126, 3, v126
    v_and_b32 v127, 2, v94
    v_lshlrev_b32 v127, 5, v127
    v_xor_b32 v126, v126, v127
    v_and_b32 v127, 3, v94
    v_lshl_add_u32 v115, v127, 7, v126
    s_mov_b32 s37, 0x3f80
    s_mov_b32 s57, 0x3f800000
    s_and_b32 s32, s14, 1
    s_lshr_b32 s33, s14, 1
    s_lshl2_add_u32 s32, s32, s33
    s_lshl_b32 s59, s32, 9
    s_mov_b32 s17, 0
    s_mov_b32 s0, 0x00ff00ff
    s_mov_b32 s1, s0
    s_mov_b64 s[44:45], s[0:1]
    s_lshl_b32 s32, s12, 18
    s_lshl2_add_u32 s33, s13, s14
    s_lshl_b32 s34, s33, 11
    s_add_u32 s28, s34, 0x2800000
    s_add_u32 s21, s32, s34
    s_add_u32 s21, s21, 0x6c00000
    s_lshl_b32 s34, s13, 8
    s_add_u32 s23, s32, s34
    s_add_u32 s23, s23, 0x6c80000
    s_lshl_b32 s32, s12, 13
    s_add_u32 s25, s32, 0x6d00000
    s_add_u32 s24, s25, s34
    s_lshl_b32 s34, s33, 9
    s_add_u32 s26, s34, 0x8000000
    s_add_u32 s31, s34, 0x6e00000
    s_cmp_eq_u32 s12, 0
    s_cselect_b32 s26, s26, s31
    s_lshl_b32 s32, s12, 7
    s_add_u32 s32, s32, s33
    s_cmp_eq_u32 s32, 1
    s_mov_b32 s39, 0x7f000000
    s_cselect_b32 s39, 0x841ec04, s39
    s_lshl_b32 s27, s13, 12
    s_lshl_b32 s36, s14, 11
    s_and_b32 s33, s36, 2048
    s_add_u32 s27, s27, s33
    s_lshr_b32 s33, s14, 1
    s_lshl_b32 s33, s33, 17
    s_add_u32 s27, s27, s33
    s_add_u32 s27, s27, 0x1800000
    s_add_u32 s36, s36, 24576
    v_add_u32 v112, 24576, v116
    s_lshl_b32 s32, s12, 12
    s_add_u32 s32, s32, 0x841c000
    s_lshl2_add_u32 s46, s13, s32
    v_lshl_add_u32 v117, v123, 25, v114
    s_and_b32 s33, s13, 3
    s_lshl_b32 s33, s33, 7
    s_add_u32 s47, s32, s33
    s_cmp_eq_u32 s14, 0
    s_cselect_b32 s47, s47, 0x7f000000
    s_cselect_b32 s11, -1, 0
    s_mov_b32 s30, 0x3e0293ee
    v_mov_b32 v121, 0x7f000000
    v_and_b32 v127, 1, v94
    s_mov_b32 exec_lo, 0
    s_mov_b32 exec_hi, 0x300
    s_lshl_b32 s32, s13, 8
    s_add_u32 s32, s32, 0x8406000
    v_lshl_add_u32 v121, v127, 13, s32
    s_mov_b32 exec_hi, 0x3c00
    s_mov_b32 s32, 0x841760c
    v_lshl_add_u32 v121, v64, 8, s32
    s_mov_b64 exec, -1
    s_waitcnt vmcnt(16)
    s_barrier
    ds_write_b128 v113, v[0:3] offset:0
    ds_write_b128 v113, v[4:7] offset:1024
    ds_write_b128 v113, v[8:11] offset:2048
    ds_write_b128 v113, v[12:15] offset:3072
    ds_write_b128 v113, v[16:19] offset:4096
    ds_write_b128 v113, v[20:23] offset:5120
    ds_write_b128 v113, v[24:27] offset:6144
    ds_write_b128 v113, v[28:31] offset:7168
    ds_read_b64_tr_b16 v[32:33], v69 offset:8192
    ds_read_b64_tr_b16 v[34:35], v69 offset:9216
    ds_read_b64_tr_b16 v[36:37], v69 offset:12288
    ds_read_b64_tr_b16 v[38:39], v69 offset:13312
    ds_read_b64_tr_b16 v[40:41], v69 offset:40960
    ds_read_b64_tr_b16 v[42:43], v69 offset:41984
    ds_read_b64_tr_b16 v[44:45], v69 offset:45056
    ds_read_b64_tr_b16 v[46:47], v69 offset:46080
    ds_read_b64_tr_b16 v[48:49], v70 offset:8192
    ds_read_b64_tr_b16 v[50:51], v70 offset:9216
    ds_read_b64_tr_b16 v[52:53], v70 offset:12288
    ds_read_b64_tr_b16 v[54:55], v70 offset:13312
    ds_read_b64_tr_b16 v[56:57], v70 offset:40960
    ds_read_b64_tr_b16 v[58:59], v70 offset:41984
    ds_read_b64_tr_b16 v[60:61], v70 offset:45056
    ds_read_b64_tr_b16 v[62:63], v70 offset:46080
    s_waitcnt lgkmcnt(0)
    s_waitcnt vmcnt(8)
    s_barrier
    ds_write_b128 v113, v[32:35] offset:8192
    ds_write_b128 v113, v[36:39] offset:9216
    ds_write_b128 v113, v[40:43] offset:10240
    ds_write_b128 v113, v[44:47] offset:11264
    ds_write_b128 v113, v[48:51] offset:12288
    ds_write_b128 v113, v[52:55] offset:13312
    ds_write_b128 v113, v[56:59] offset:14336
    ds_write_b128 v113, v[60:63] offset:15360
    buffer_load_dword v76, v74, s[4:7], 0 offen sc1
    buffer_load_dword v79, v75, s[4:7], 0 offen sc1
    ds_read_b64_tr_b16 v[0:1], v80 offset:16384
    ds_read_b64_tr_b16 v[2:3], v80 offset:17408
    ds_read_b64_tr_b16 v[4:5], v80 offset:20480
    ds_read_b64_tr_b16 v[6:7], v80 offset:21504
    ds_read_b64_tr_b16 v[8:9], v81 offset:16384
    ds_read_b64_tr_b16 v[10:11], v81 offset:17408
    ds_read_b64_tr_b16 v[12:13], v81 offset:20480
    ds_read_b64_tr_b16 v[14:15], v81 offset:21504
    ds_read_b64_tr_b16 v[16:17], v82 offset:16384
    ds_read_b64_tr_b16 v[18:19], v82 offset:17408
    ds_read_b64_tr_b16 v[20:21], v82 offset:20480
    ds_read_b64_tr_b16 v[22:23], v82 offset:21504
    ds_read_b64_tr_b16 v[24:25], v83 offset:16384
    ds_read_b64_tr_b16 v[26:27], v83 offset:17408
    ds_read_b64_tr_b16 v[28:29], v83 offset:20480
    ds_read_b64_tr_b16 v[30:31], v83 offset:21504
    s_waitcnt lgkmcnt(0)
    ds_write_b128 v113, v[0:3] offset:16384
    ds_write_b128 v113, v[4:7] offset:17408
    ds_write_b128 v113, v[8:11] offset:18432
    ds_write_b128 v113, v[12:15] offset:19456
    ds_write_b128 v113, v[16:19] offset:20480
    ds_write_b128 v113, v[20:23] offset:21504
    ds_write_b128 v113, v[24:27] offset:22528
    ds_write_b128 v113, v[28:31] offset:23552
    s_waitcnt lgkmcnt(0)
    s_waitcnt vmcnt(2)
    s_waitcnt vmcnt(0)
    v_min_u32 v76, v76, v79
    v_cmp_eq_u32 vcc, 0, v76
    s_cmp_eq_u32 s38, 0
    s_cbranch_scc0 main_kernel_c_sl0
    s_cbranch_vccnz main_kernel_c_sl1
    s_branch main_kernel_c_kv0_ok
main_kernel_c_sl0:
    v_and_b32 v126, 7, v94
    v_lshlrev_b32 v126, 5, v126
main_kernel_c_mode_cnt:
    buffer_load_dword v127, v126, s[60:63], 0 offen sc1
    s_waitcnt vmcnt(0)
    v_readlane_b32 s48, v127, 0
    v_readlane_b32 s49, v127, 1
    v_readlane_b32 s50, v127, 2
    v_readlane_b32 s51, v127, 3
    v_readlane_b32 s52, v127, 4
    v_readlane_b32 s53, v127, 5
    v_readlane_b32 s54, v127, 6
    v_readlane_b32 s55, v127, 7
    s_nop 3
    s_add_u32 s33, s48, s49
    s_add_u32 s33, s33, s50
    s_add_u32 s33, s33, s51
    s_add_u32 s33, s33, s52
    s_add_u32 s33, s33, s53
    s_add_u32 s33, s33, s54
    s_add_u32 s33, s33, s55
    s_cmp_ge_u32 s33, 256
    s_cbranch_scc1 main_kernel_c_mode_cnt_ok
    s_sub_u32 s29, s29, 1
    s_cbranch_scc1 main_kernel_end
    s_sleep 4
    s_branch main_kernel_c_mode_cnt
main_kernel_c_mode_cnt_ok:
    v_mov_b32 v126, 0
main_kernel_c_wa:
    buffer_load_dword v127, v126, s[60:63], 0 offen offset:12 sc1
    s_waitcnt vmcnt(0)
    v_cmp_gt_u32 vcc, 4, v127
    s_cbranch_vccz main_kernel_c_wa_ok
    s_sleep 4
    s_sub_u32 s29, s29, 1
    s_cbranch_scc0 main_kernel_c_wa
    s_branch main_kernel_end
main_kernel_c_wa_ok:
main_kernel_c_sl1:
    v_lshlrev_b32 v126, 2, v94
    s_mov_b32 s32, 0x841f000
main_kernel_c_wf:
    buffer_load_dword v0, v126, s[4:7], s32 offen sc1
    s_waitcnt vmcnt(0)
    v_cmp_eq_u32 vcc, 0, v0
    s_cbranch_vccz main_kernel_c_wf_ok
    s_sleep 4
    s_sub_u32 s29, s29, 1
    s_cbranch_scc0 main_kernel_c_wf
    s_branch main_kernel_end
main_kernel_c_wf_ok:
    s_mov_b32 exec_lo, 0
    s_mov_b32 exec_hi, 0x300
    v_subrev_u32 v127, 0, v121
main_kernel_c_kv0:
    buffer_load_dword v126, v127, s[4:7], 0 offen sc1
    s_waitcnt vmcnt(0)
    v_cmp_eq_u32 vcc, 0, v126
    s_cbranch_vccz main_kernel_c_kv0_ok
    s_sleep 2
    s_sub_u32 s29, s29, 1
    s_cbranch_scc0 main_kernel_c_kv0
    s_branch main_kernel_end
main_kernel_c_kv0_ok:
    s_mov_b32 exec_lo, 0
    s_mov_b32 exec_hi, 0x100
    v_add_u32 v121, 4, v121
    s_mov_b64 exec, -1
    v_add_u32 v121, 4, v121
    v_lshlrev_b32 v126, 3, v116
    v_and_b32 v126, 0x780, v126
    s_mov_b32 m0, s36
    buffer_load_dword v111, v126, s[4:7], s21 offen sc1
    buffer_load_dwordx4 v116, s[4:7], s27 offen offset:0 sc1 lds
    buffer_load_dwordx4 v116, s[4:7], s27 offen offset:1024 sc1 lds
    s_lshl_b32 s32, s14, 11
    s_add_u32 m0, s32, 0
    s_add_u32 s32, s32, s25
    buffer_load_dwordx4 v116, s[4:7], s32 offen offset:0 sc1 lds
    buffer_load_dwordx4 v116, s[4:7], s32 offen offset:1024 sc1 lds
    s_add_u32 s27, s27, 0x40000
    ds_read_b64_tr_b16 v[32:33], v80 offset:24576
    ds_read_b64_tr_b16 v[34:35], v80 offset:25600
    ds_read_b64_tr_b16 v[36:37], v80 offset:28672
    ds_read_b64_tr_b16 v[38:39], v80 offset:29696
    ds_read_b64_tr_b16 v[40:41], v81 offset:24576
    ds_read_b64_tr_b16 v[42:43], v81 offset:25600
    ds_read_b64_tr_b16 v[44:45], v81 offset:28672
    ds_read_b64_tr_b16 v[46:47], v81 offset:29696
    ds_read_b64_tr_b16 v[48:49], v82 offset:24576
    ds_read_b64_tr_b16 v[50:51], v82 offset:25600
    ds_read_b64_tr_b16 v[52:53], v82 offset:28672
    ds_read_b64_tr_b16 v[54:55], v82 offset:29696
    ds_read_b64_tr_b16 v[56:57], v83 offset:24576
    ds_read_b64_tr_b16 v[58:59], v83 offset:25600
    ds_read_b64_tr_b16 v[60:61], v83 offset:28672
    ds_read_b64_tr_b16 v[62:63], v83 offset:29696
    s_waitcnt lgkmcnt(0)
    ds_write_b128 v113, v[32:35] offset:24576
    ds_write_b128 v113, v[36:39] offset:25600
    ds_write_b128 v113, v[40:43] offset:26624
    ds_write_b128 v113, v[44:47] offset:27648
    ds_write_b128 v113, v[48:51] offset:28672
    ds_write_b128 v113, v[52:55] offset:29696
    ds_write_b128 v113, v[56:59] offset:30720
    ds_write_b128 v113, v[60:63] offset:31744
    s_waitcnt lgkmcnt(0)
main_kernel_c_nb:
    v_readfirstlane_b32 s33, v84
    v_readfirstlane_b32 s32, v85
    s_nop 3
    s_and_b32 s34, s32, s33
    s_cbranch_scc1 main_kernel_c_nb_ok
    buffer_load_dwordx2 v[84:85], off, s[60:63], 0 offset:16 sc1
    s_sub_u32 s29, s29, 1
    s_cbranch_scc1 main_kernel_end
    s_waitcnt vmcnt(0)
    s_branch main_kernel_c_nb
main_kernel_c_nb_ok:
    s_and_b32 s33, s33, 1
    s_lshl_b32 s32, s12, 5
    s_add_u32 s32, s32, s13
    s_lshl1_add_u32 s32, s32, s33
    s_lshl2_add_u32 s32, s32, s14
    s_lshl_b32 s32, s32, 11
    s_add_u32 s18, s32, 0x8c00000
    s_xor_b32 s19, s18, 0x80000
    v_mov_b32 v64, 0
    v_mov_b32 v65, 0
    v_mov_b32 v66, 0
    v_mov_b32 v67, 0
    v_mov_b32 v68, 0
    v_mov_b32 v69, 0
    v_mov_b32 v70, 0
    v_mov_b32 v71, 0
    v_mov_b32 v96, 0
    v_mov_b32 v97, 0
    v_mov_b32 v98, 0
    v_mov_b32 v99, 0
    s_xor_b32 s36, s36, 0x4000
    s_waitcnt vmcnt(0)
    buffer_store_dword v64, off, s[4:7], s18 offset:1536 sc1
    s_mov_b32 m0, s36
    buffer_load_dwordx4 v[88:91], v116, s[4:7], s28 offen offset:0 sc1
    buffer_load_dwordx4 v116, s[4:7], s27 offen offset:0 sc1 lds
    buffer_load_dwordx4 v[92:95], v116, s[4:7], s28 offen offset:1024 sc1
    s_barrier
    s_memrealtime s[32:33]
    s_waitcnt lgkmcnt(0)
    s_mul_i32 s32, s32, 22
    s_sub_u32 s20, s32, 0x40000
    s_mov_b32 s9, 0
    s_mov_b32 s10, 0
    s_memtime s[52:53]
    s_waitcnt lgkmcnt(0)
    s_sub_u32 s38, s52, s32
    s_sub_u32 s3, s52, 0x4000
    v_mov_b32 v126, s38
    ds_write_b32 v123, v126 offset:20992
    s_waitcnt lgkmcnt(0)
    s_min_u32 s32, s48, s49
    s_cmp_ge_u32 s32, 32
    s_cbranch_scc0 main_kernel_cs_top
    .p2align 6
main_kernel_cf_top:
    s_barrier
main_kernel_cf_mrd:
    ds_read_b128 v[0:3], v114 offset:0
    ds_read_b128 v[4:7], v114 offset:512
    ds_read_b128 v[8:11], v114 offset:1024
    ds_read_b128 v[12:15], v114 offset:1536
    ds_read_b128 v[16:19], v114 offset:2048
    s_waitcnt lgkmcnt(4)
    v_smfmac_f32_16x16x64_bf16 v[96:99], v[0:3], a[0:7], v110
    ds_read_b128 v[20:23], v114 offset:2560
    s_waitcnt lgkmcnt(4)
    v_smfmac_f32_16x16x64_bf16 v[96:99], v[4:7], a[8:15], v110
    ds_read_b128 v[24:27], v114 offset:3072
    s_waitcnt lgkmcnt(4)
    s_bfe_u32 s22, s17, 0x10001
    v_smfmac_f32_16x16x64_bf16 v[96:99], v[8:11], a[16:23], v110
    ds_read_b128 v[28:31], v114 offset:3584
    s_waitcnt lgkmcnt(4)
    v_smfmac_f32_16x16x64_bf16 v[96:99], v[12:15], a[24:31], v110
    ds_read_b128 v[32:35], v114 offset:4096
    s_waitcnt lgkmcnt(4)
    v_smfmac_f32_16x16x64_bf16 v[96:99], v[16:19], a[32:39], v110
    ds_read_b128 v[36:39], v114 offset:4608
    s_waitcnt lgkmcnt(4)
    v_smfmac_f32_16x16x64_bf16 v[96:99], v[20:23], a[40:47], v110
    ds_read_b128 v[40:43], v114 offset:5120
    s_waitcnt lgkmcnt(4)
    v_smfmac_f32_16x16x64_bf16 v[96:99], v[24:27], a[48:55], v110
    ds_read_b128 v[44:47], v114 offset:5632
    s_waitcnt lgkmcnt(4)
    v_smfmac_f32_16x16x64_bf16 v[96:99], v[28:31], a[56:63], v110
    ds_read_b128 v[48:51], v114 offset:6144
    s_waitcnt lgkmcnt(4)
    v_smfmac_f32_16x16x64_bf16 v[96:99], v[32:35], a[64:71], v110
    ds_read_b128 v[52:55], v114 offset:6656
    s_waitcnt lgkmcnt(4)
    v_smfmac_f32_16x16x64_bf16 v[96:99], v[36:39], a[72:79], v110
    ds_read_b128 v[56:59], v114 offset:7168
    s_waitcnt lgkmcnt(4)
    v_smfmac_f32_16x16x64_bf16 v[96:99], v[40:43], a[80:87], v110
    ds_read_b128 v[60:63], v114 offset:7680
    s_waitcnt lgkmcnt(4)
    v_smfmac_f32_16x16x64_bf16 v[96:99], v[44:47], a[88:95], v110
    s_waitcnt lgkmcnt(3)
    buffer_load_dword v111, v121, s[4:7], 0 offen sc1
    v_smfmac_f32_16x16x64_bf16 v[96:99], v[48:51], a[96:103], v110
    s_waitcnt lgkmcnt(2)
    ds_read_b128 v[80:83], v113 offset:0
    v_smfmac_f32_16x16x64_bf16 v[96:99], v[52:55], a[104:111], v110
    s_waitcnt lgkmcnt(2)
    ds_read_b128 v[84:87], v113 offset:1024
    v_smfmac_f32_16x16x64_bf16 v[96:99], v[56:59], a[112:119], v110
    s_waitcnt lgkmcnt(2)
    v_smfmac_f32_16x16x64_bf16 v[96:99], v[60:63], a[120:127], v110
    v_smfmac_f32_16x16x64_bf16 v[68:71], v[0:3], a[128:135], v110
    ds_read_b128 v[72:75], v113 offset:2048
    v_smfmac_f32_16x16x64_bf16 v[68:71], v[4:7], a[136:143], v110
    s_nop 1
    v_pk_add_f32 v[126:127], v[96:97], v[98:99]
    ds_read_b128 v[76:79], v113 offset:3072
    v_smfmac_f32_16x16x64_bf16 v[68:71], v[8:11], a[144:151], v110
    v_cmp_u_f32 vcc, v126, v127
    v_smfmac_f32_16x16x64_bf16 v[68:71], v[12:15], a[152:159], v110
    v_cvt_pk_bf16_f32 v126, v96, v97
    v_smfmac_f32_16x16x64_bf16 v[68:71], v[16:19], a[160:167], v110
    v_cvt_pk_bf16_f32 v127, v98, v99
    s_and_b64 s[42:43], vcc, s[44:45]
    s_cbranch_scc1 main_kernel_cf_m_f
    v_smfmac_f32_16x16x64_bf16 v[68:71], v[20:23], a[168:175], v110
    v_bfi_b32 v126, 1, s22, v126
    buffer_store_dwordx2 v[126:127], v123, s[4:7], s18 offen sc1
    v_smfmac_f32_16x16x64_bf16 v[68:71], v[24:27], a[176:183], v110
    s_mov_b64 s[44:45], s[0:1]
    v_smfmac_f32_16x16x64_bf16 v[68:71], v[28:31], a[184:191], v110
    s_add_u32 s17, s17, 1
    s_bfe_u32 s40, s17, 0x10001
    v_smfmac_f32_16x16x64_bf16 v[68:71], v[32:35], a[192:199], v110
    s_add_u32 s28, s28, 0x40000
    s_mov_b32 m0, s36
    v_smfmac_f32_16x16x64_bf16 v[68:71], v[36:39], a[200:207], v110
    s_add_u32 s34, s3, 2130
    v_smfmac_f32_16x16x64_bf16 v[68:71], v[40:43], a[208:215], v110
    v_smfmac_f32_16x16x64_bf16 v[68:71], v[44:47], a[216:223], v110
    v_smfmac_f32_16x16x64_bf16 v[68:71], v[48:51], a[224:231], v110
    v_smfmac_f32_16x16x64_bf16 v[68:71], v[52:55], a[232:239], v110
    v_smfmac_f32_16x16x64_bf16 v[68:71], v[56:59], a[240:247], v110
    v_smfmac_f32_16x16x64_bf16 v[68:71], v[60:63], a[248:255], v110
    s_waitcnt lgkmcnt(2)
    v_smfmac_f32_16x16x64_bf16 v[64:67], v[32:35], v[80:87], v110
    s_waitcnt lgkmcnt(0)
    s_nop 3
    v_cvt_pk_bf16_f32 v126, v68, v69
    v_cvt_pk_bf16_f32 v127, v70, v71
    v_bfi_b32 v126, 1, s22, v126
    buffer_store_dwordx2 v[126:127], v123, s[4:7], s18 offen offset:512 sc1
    ds_read_b128 v[80:83], v113 offset:4096
    v_smfmac_f32_16x16x64_bf16 v[64:67], v[36:39], v[72:79], v110
    ds_read_b128 v[84:87], v113 offset:5120
    v_smfmac_f32_16x16x64_bf16 v[64:67], v[0:3], v[128:135], v110
    ds_read_b128 v[72:75], v113 offset:6144
    v_smfmac_f32_16x16x64_bf16 v[64:67], v[4:7], v[136:143], v110
    ds_read_b128 v[76:79], v113 offset:7168
    v_smfmac_f32_16x16x64_bf16 v[64:67], v[8:11], v[144:151], v110
    ds_read_b128 v[32:35], v113 offset:8192
    v_smfmac_f32_16x16x64_bf16 v[64:67], v[12:15], v[152:159], v110
    ds_read_b128 v[36:39], v113 offset:9216
    v_smfmac_f32_16x16x64_bf16 v[64:67], v[16:19], v[160:167], v110
    ds_read_b128 v[0:3], v113 offset:10240
    s_memtime s[52:53]
    v_smfmac_f32_16x16x64_bf16 v[64:67], v[20:23], v[168:175], v110
    ds_read_b128 v[4:7], v113 offset:11264
    s_memtime s[52:53]
    s_xor_b32 s32, s9, s22
    s_bitcmp1_b32 s32, 0
    s_cbranch_scc1 main_kernel_cf_t_p
main_kernel_cf_t_ok:
    s_sub_u32 s32, s9, s10
    v_smfmac_f32_16x16x64_bf16 v[64:67], v[24:27], v[176:183], v110
    ds_read_b128 v[8:11], v113 offset:12288
    s_memtime s[52:53]
    s_max_i32 s32, s32, 0
    s_min_i32 s32, s32, 0x4000
    v_smfmac_f32_16x16x64_bf16 v[64:67], v[28:31], v[184:191], v110
    s_waitcnt lgkmcnt(7)
    ds_read_b128 v[12:15], v113 offset:13312
    s_memtime s[52:53]
    s_add_u32 s34, s34, s32
    s_and_b32 s34, s34, s11
    v_smfmac_f32_16x16x64_bf16 v[64:67], v[40:43], v[80:87], v110
    s_waitcnt lgkmcnt(6)
    ds_read_b128 v[16:19], v113 offset:14336
    s_cmp_lt_u32 s52, s34
    s_cbranch_scc1 main_kernel_cf_t_w
main_kernel_cf_t_go:
    s_barrier
    buffer_load_dwordx2 v[126:127], v123, s[4:7], s19 offen offset:0 sc1
    v_smfmac_f32_16x16x64_bf16 v[64:67], v[44:47], v[72:79], v110
    s_waitcnt lgkmcnt(5)
    ds_read_b128 v[20:23], v113 offset:15360
    v_smfmac_f32_16x16x64_bf16 v[64:67], v[48:51], v[32:39], v110
    s_waitcnt lgkmcnt(4)
    v_smfmac_f32_16x16x64_bf16 v[64:67], v[52:55], v[0:7], v110
    s_waitcnt lgkmcnt(2)
    ds_read_b128 v[24:27], v112 offset:6144
    ds_read_b128 v[28:31], v112 offset:7168
    v_smfmac_f32_16x16x64_bf16 v[64:67], v[56:59], v[8:15], v110
    s_waitcnt lgkmcnt(2)
    ds_read_b128 v[0:3], v112 offset:0
    ds_read_b128 v[4:7], v112 offset:1024
    v_smfmac_f32_16x16x64_bf16 v[64:67], v[60:63], v[16:23], v110
    ds_read_b128 v[8:11], v112 offset:2048
    ds_read_b128 v[12:15], v112 offset:3072
    ds_read_b128 v[16:19], v112 offset:4096
    ds_read_b128 v[20:23], v112 offset:5120
    v_mov_b32 v76, 0
    v_mov_b32 v77, 0
    v_mov_b32 v78, 0
    s_nop 0
    v_permlane32_swap_b32 v64, v65
    v_permlane32_swap_b32 v66, v67
    v_cvt_pk_bf16_f32 v84, v64, v66
    v_cvt_pk_bf16_f32 v85, v65, v67
    v_bfi_b32 v84, 1, s22, v84
    buffer_load_dwordx2 v[42:43], v123, s[4:7], s19 offen offset:512 sc1
    v_mov_b32 v79, 0
    v_mov_b32 v80, 0
    v_mov_b32 v81, 0
    v_mov_b32 v82, 0
    v_mov_b32 v83, 0
    v_mov_b32 v60, 0
    v_mov_b32 v60, 0
    v_mov_b32 v60, 0
    v_mov_b32 v60, 0
    v_mov_b32 v60, 0
    v_mov_b32 v60, 0
    v_mov_b32 v60, 0
    buffer_store_dwordx2 v[84:85], v123, s[4:7], s18 offen offset:1024 sc1
    v_mov_b32 v60, 0
    v_mov_b32 v60, 0
    v_mov_b32 v60, 0
    v_mov_b32 v60, 0
    v_mov_b32 v60, 0
    v_mov_b32 v60, 0
    v_mov_b32 v60, 0
    v_mov_b32 v60, 0
    v_mov_b32 v60, 0
    v_mov_b32 v60, 0
    v_mov_b32 v60, 0
    v_mov_b32 v60, 0
    v_mov_b32 v60, 0
    v_mov_b32 v60, 0
    v_mov_b32 v60, 0
    v_mov_b32 v60, 0
    v_mov_b32 v60, 0
    v_mov_b32 v60, 0
    v_mov_b32 v60, 0
    v_mov_b32 v60, 0
    v_mov_b32 v60, 0
    v_mov_b32 v60, 0
    v_mov_b32 v60, 0
    v_mov_b32 v60, 0
    v_mov_b32 v60, 0
    v_mov_b32 v60, 0
    v_mov_b32 v60, 0
    v_mov_b32 v60, 0
    v_mov_b32 v60, 0
    v_mov_b32 v60, 0
    v_mov_b32 v60, 0
    v_mov_b32 v60, 0
    v_mov_b32 v60, 0
    v_mov_b32 v60, 0
    v_mov_b32 v60, 0
    v_mov_b32 v60, 0
    v_mov_b32 v60, 0
    v_mov_b32 v60, 0
    s_waitcnt vmcnt(2)
main_kernel_cf_z0:
    v_dot2_f32_bf16 v44, v126, s37, v96
    v_dot2_f32_bf16 v45, v126, s57, v97
    v_dot2_f32_bf16 v46, v127, s37, v98
    v_dot2_f32_bf16 v47, v127, s57, v99
    v_bitop3_b32 v60, v126, s22, 1 bitop3:0x28
    v_cvt_pk_bf16_f32 v44, v44, v45
    v_cmp_ne_u32 vcc, 0, v60
    v_cvt_pk_bf16_f32 v45, v46, v47
    ds_write_b64 v124, v[44:45] offset:0
    buffer_load_dwordx2 v[64:65], v123, s[4:7], s19 offen offset:512 sc1
    v_cmp_eq_u32 s[42:43], 0, v111
    s_cbranch_vccnz main_kernel_cf_z0_f
    v_mov_b32 v96, 0x3f803f80
    v_mov_b32 v97, 0x3f803f80
    v_mov_b32 v98, 0x3f803f80
    v_mov_b32 v99, 0x3f803f80
    s_and_b32 s32, s43, 0x3f00
    s_cbranch_scc1 main_kernel_cf_kvw
main_kernel_cf_kvok:
    s_waitcnt lgkmcnt(0)
    s_barrier
    ds_read_b64_tr_b16 v[48:49], v115 offset:16384
    ds_read_b64_tr_b16 v[50:51], v115 offset:17408
    ds_read_b64_tr_b16 v[52:53], v115 offset:18432
    ds_read_b64_tr_b16 v[54:55], v115 offset:19456
    s_waitcnt vmcnt(2)
    s_memtime s[52:53]
    v_dot2_f32_bf16 v44, v42, s37, v68
    v_dot2_f32_bf16 v45, v42, s57, v69
    v_dot2_f32_bf16 v46, v43, s37, v70
    v_dot2_f32_bf16 v47, v43, s57, v71
    v_bitop3_b32 v60, v42, s22, 1 bitop3:0x28
    v_cvt_pk_bf16_f32 v44, v44, v45
    v_cmp_ne_u32 vcc, 0, v60
    v_cvt_pk_bf16_f32 v45, v46, v47
    ds_write_b64 v124, v[44:45] offset:512
    s_waitcnt lgkmcnt(3)
    v_mfma_f32_16x16x32_bf16 v[32:35], v[0:3], v[48:51], 0
    v_mfma_f32_16x16x32_bf16 v[36:39], v[16:19], v[48:51], 0
    s_cbranch_vccnz main_kernel_cf_z1_f
main_kernel_cf_z_ok:
    v_mfma_f32_16x16x32_bf16 v[72:75], v[48:51], v[48:51], 0
    s_waitcnt lgkmcnt(1)
    s_sub_u32 s32, s52, s38
    v_mov_b32 v46, s32
    v_mfma_f32_16x16x32_bf16 v[32:35], v[4:7], v[52:55], v[32:35]
    buffer_load_dwordx2 v[86:87], v123, s[4:7], s19 offen offset:1024 sc1
    buffer_store_dword v46, v117, s[4:7], s46 offen
    s_cmp_eq_u32 s17, 64
    s_waitcnt lgkmcnt(0)
    s_barrier
    ds_read_b64_tr_b16 v[56:57], v115 offset:16896
    ds_read_b64_tr_b16 v[58:59], v115 offset:17920
    ds_read_b64_tr_b16 v[60:61], v115 offset:18944
    ds_read_b64_tr_b16 v[62:63], v115 offset:19968
    s_cbranch_scc1 main_kernel_cf_last
    v_bfe_u32 v47, v123, 1, 7
    buffer_load_dwordx2 v[126:127], v123, s[4:7], s19 offen offset:1024 sc1
    buffer_load_dwordx4 v116, s[4:7], s27 offen offset:1024 sc1 lds
    v_mfma_f32_16x16x32_bf16 v[36:39], v[20:23], v[52:55], v[36:39]
    v_mfma_f32_16x16x32_bf16 v[72:75], v[52:55], v[52:55], v[72:75]
    s_waitcnt lgkmcnt(2)
    v_mfma_f32_16x16x32_bf16 v[72:75], v[56:59], v[56:59], v[72:75]
    v_mfma_f32_16x16x32_bf16 v[32:35], v[8:11], v[56:59], v[32:35]
    s_waitcnt lgkmcnt(0)
    v_mfma_f32_16x16x32_bf16 v[72:75], v[60:63], v[60:63], v[72:75]
    ds_read_b128 v[0:3], v113 offset:16384
    v_mfma_f32_16x16x32_bf16 v[32:35], v[12:15], v[60:63], v[32:35]
    ds_read_b128 v[16:19], v113 offset:18432
    v_mfma_f32_16x16x32_bf16 v[36:39], v[24:27], v[56:59], v[36:39]
    ds_read_b128 v[4:7], v113 offset:17408
    s_nop 0
    v_permlane32_swap_b32 v72, v73
    v_permlane32_swap_b32 v74, v75
    v_mfma_f32_16x16x32_bf16 v[36:39], v[28:31], v[60:63], v[36:39]
    ds_read_b128 v[20:23], v113 offset:19456
    v_mul_f32 v73, s30, v73
    v_mul_f32 v75, s30, v75
    v_exp_f32 v32, v32
    ds_read_b128 v[8:11], v113 offset:24576
    v_exp_f32 v33, v33
    ds_read_b128 v[12:15], v113 offset:25600
    v_exp_f32 v73, v73
    ds_read_b128 v[24:27], v113 offset:26624
    v_exp_f32 v75, v75
    ds_read_b128 v[28:31], v113 offset:27648
    v_exp_f32 v34, v34
    v_cvt_pk_bf16_f32 v72, v73, v75
    v_cvt_pk_bf16_f32 v73, v73, v75
    v_exp_f32 v35, v35
    s_waitcnt vmcnt(4)
    v_mfma_f32_16x16x16_bf16 v[40:43], v[100:101], v[72:73], 0
    v_exp_f32 v36, v36
    v_cvt_pk_bf16_f32 v32, v32, v33
    v_exp_f32 v37, v37
    v_cvt_pk_bf16_f32 v33, v34, v35
    v_exp_f32 v38, v38
    v_exp_f32 v39, v39
    v_cvt_pk_bf16_f32 v34, v36, v37
    v_cvt_pk_bf16_f32 v35, v38, v39
    s_nop 1
    v_mfma_f32_16x16x32_bf16 v[40:43], v[96:99], v[32:35], v[40:43]
    v_mfma_f32_16x16x32_bf16 v[64:67], v[88:91], v[32:35], 0
    v_mfma_f32_16x16x32_bf16 v[68:71], v[92:95], v[32:35], 0
    s_waitcnt vmcnt(3)
main_kernel_cf_v_ok:
    v_bitop3_b32 v44, v86, s22, 1 bitop3:0x28
    v_swap_b32 v85, v86
    v_cmp_ne_u32 vcc, 0, v44
main_kernel_cf_d_ok:
    s_nop 0
    v_mfma_f32_16x16x16_bf16 v[64:67], v[84:85], v[72:73], v[64:67]
    v_mfma_f32_16x16x16_bf16 v[68:71], v[86:87], v[72:73], v[68:71]
    s_cbranch_vccnz main_kernel_cf_v_f
    v_rcp_f32 v42, v40
    v_subrev_u32 v41, 0x21800000, v41
    v_cmp_lt_u32 vcc, 0x3c000000, v41
    s_nop 0
    v_pk_mul_f32 v[64:65], v[64:65], v[42:43] op_sel_hi:[1,0]
    v_pk_mul_f32 v[66:67], v[66:67], v[42:43] op_sel_hi:[1,0]
    v_cvt_pk_bf16_f32 v44, v64, v65
    v_pk_mul_f32 v[68:69], v[68:69], v[42:43] op_sel_hi:[1,0]
    v_cvt_pk_bf16_f32 v45, v66, v67
    v_pk_mul_f32 v[70:71], v[70:71], v[42:43] op_sel_hi:[1,0]
    v_cvt_pk_bf16_f32 v46, v68, v69
    v_cvt_pk_bf16_f32 v47, v70, v71
    ds_write_b128 v118, v[44:47]
    s_and_b64 s[42:43], vcc, s[44:45]
    s_cbranch_scc1 main_kernel_cf_d_f
    s_mov_b64 s[44:45], s[0:1]
    v_mov_b32 v64, 0
    v_mov_b32 v65, 0
    v_mov_b32 v66, 0
    v_mov_b32 v67, 0
    v_mov_b32 v68, 0
    v_mov_b32 v69, 0
    v_mov_b32 v70, 0
    v_mov_b32 v71, 0
    v_bfe_u32 v90, v123, 1, 7
    s_xor_b32 s23, s23, 0x80000
    s_waitcnt lgkmcnt(0)
    s_barrier
    ds_read_b128 v[56:59], v114 offset:1024
    ds_read_b128 v[60:63], v114 offset:1536
    ds_read_b128 v[48:51], v114 offset:0
    ds_read_b128 v[52:55], v114 offset:512
    s_xor_b32 s18, s18, 0x100000
    s_xor_b32 s19, s18, 0x80000
    s_xor_b32 s25, s25, 0x4000
    s_add_u32 s27, s27, 0x40000
    v_add_u32 v121, 4, v121
    v_xor_b32 v112, 0x4000, v112
    s_xor_b32 s36, s36, 0x4000
    s_mov_b32 m0, 0
    s_mov_b32 s54, s24
    s_xor_b32 s24, s24, 0x4000
    s_add_u32 s55, s25, 4096
    v_mov_b32 v89, s17
    s_mov_b32 s15, 0
    s_add_u32 s56, s19, 1536
    s_xor_b32 s9, s11, s40
    s_add_u32 s16, s20, s38
    s_waitcnt lgkmcnt(3)
    v_smfmac_f32_16x16x64_bf16 v[76:79], v[56:59], v[0:7], v110
    s_waitcnt lgkmcnt(2)
    ds_read_b128 v[0:3], v113 offset:20480
    v_smfmac_f32_16x16x64_bf16 v[76:79], v[60:63], v[8:15], v110
    s_waitcnt lgkmcnt(2)
    ds_read_b128 v[4:7], v113 offset:21504
    v_smfmac_f32_16x16x64_bf16 v[76:79], v[48:51], v[192:199], v110
    s_waitcnt lgkmcnt(2)
    ds_read_b128 v[8:11], v113 offset:28672
    v_smfmac_f32_16x16x64_bf16 v[76:79], v[52:55], v[200:207], v110
    ds_read_b128 v[12:15], v113 offset:29696
    buffer_load_dword v111, v90, s[4:7], s47 offen sc1
    v_smfmac_f32_16x16x64_bf16 v[80:83], v[56:59], v[16:23], v110
    ds_read_b128 v[16:19], v113 offset:22528
    v_smfmac_f32_16x16x64_bf16 v[80:83], v[60:63], v[24:31], v110
    ds_read_b128 v[20:23], v113 offset:23552
    v_smfmac_f32_16x16x64_bf16 v[80:83], v[48:51], v[208:215], v110
    ds_read_b128 v[24:27], v113 offset:30720
    v_cvt_pk_f16_f32 v40, v76, v77
    v_smfmac_f32_16x16x64_bf16 v[80:83], v[52:55], v[216:223], v110
    ds_read_b128 v[28:31], v113 offset:31744
    v_cvt_pk_f16_f32 v41, v78, v79
    v_smfmac_f32_16x16x64_bf16 v[64:67], v[48:51], v[224:231], v110
    v_bfi_b32 v40, 1, s22, v40
    v_smfmac_f32_16x16x64_bf16 v[64:67], v[52:55], v[232:239], v110
    s_waitcnt lgkmcnt(6)
    buffer_load_dword v111, v90, s[4:7], s47 offen sc1
    v_smfmac_f32_16x16x64_bf16 v[64:67], v[56:59], v[0:7], v110
    s_waitcnt lgkmcnt(4)
    buffer_store_dwordx2 v[40:41], v119, s[4:7], s21 offen offset:0
    v_cvt_pk_f16_f32 v42, v80, v81
    v_smfmac_f32_16x16x64_bf16 v[64:67], v[60:63], v[8:15], v110
    v_cvt_pk_f16_f32 v43, v82, v83
    v_smfmac_f32_16x16x64_bf16 v[68:71], v[48:51], v[240:247], v110
    v_bfi_b32 v42, 1, s22, v42
    v_smfmac_f32_16x16x64_bf16 v[68:71], v[52:55], v[248:255], v110
    s_waitcnt lgkmcnt(2)
    v_smfmac_f32_16x16x64_bf16 v[68:71], v[56:59], v[16:23], v110
    s_waitcnt lgkmcnt(0)
    buffer_store_dwordx2 v[42:43], v119, s[4:7], s21 offen offset:512
    v_cvt_pk_f16_f32 v44, v64, v65
    v_smfmac_f32_16x16x64_bf16 v[68:71], v[60:63], v[24:31], v110
    v_cvt_pk_f16_f32 v45, v66, v67
    v_bfi_b32 v44, 1, s22, v44
    s_cmp_lg_u32 s14, 0
    buffer_store_dwordx2 v[44:45], v119, s[4:7], s21 offen offset:1024
    s_nop 3
    v_cvt_pk_f16_f32 v46, v68, v69
    v_cvt_pk_f16_f32 v47, v70, v71
    v_bfi_b32 v46, 1, s22, v46
    buffer_store_dwordx2 v[46:47], v119, s[4:7], s21 offen offset:1536
    s_cbranch_scc1 main_kernel_cf_wx
    s_waitcnt vmcnt(5)
    s_xor_b32 s21, s21, 0x80000
main_kernel_cf_rgo:
    v_subrev_u32 v32, s20, v111
    s_memtime s[52:53]
    v_cmp_lt_u32 vcc, 0x100000, v32
    v_max_u32_dpp v32, v32, v32 row_shr:1 row_mask:0xf bank_mask:0xf
    s_nop 0
    s_nop 0
    v_max_u32_dpp v32, v32, v32 row_shr:2 row_mask:0xf bank_mask:0xf
    s_nop 0
    s_cbranch_vccnz main_kernel_cf_fsp
main_kernel_cf_fok:
    s_nop 0
    v_max_u32_dpp v32, v32, v32 row_shr:4 row_mask:0xf bank_mask:0xf
    s_memtime s[52:53]
    s_nop 0
    v_max_u32_dpp v32, v32, v32 row_shr:8 row_mask:0xf bank_mask:0xf
    s_memtime s[52:53]
    s_nop 0
    v_max_u32_dpp v32, v32, v32 row_bcast:15 row_mask:0xa bank_mask:0xf
    s_memtime s[52:53]
    s_sub_u32 s33, s52, s16
    v_readlane_b32 s32, v32, 31
    s_add_u32 s33, s33, 0x400
    s_memtime s[52:53]
    s_add_u32 s34, s16, 1650
    s_memtime s[52:53]
    s_min_u32 s32, s32, s33
    s_max_u32 s32, s32, s15
    s_add_u32 s34, s34, s32
    s_mov_b32 s35, 200
main_kernel_cf_fw:
    s_memtime s[52:53]
    s_cmp_ge_u32 s52, s34
    s_cbranch_scc1 main_kernel_cf_fgo
    s_memtime s[52:53]
    s_cmp_ge_u32 s52, s34
    s_cbranch_scc1 main_kernel_cf_fgo
    s_memtime s[52:53]
    s_cmp_ge_u32 s52, s34
    s_cbranch_scc1 main_kernel_cf_fgo
    s_memtime s[52:53]
    s_cmp_ge_u32 s52, s34
    s_cbranch_scc1 main_kernel_cf_fgo
    s_memtime s[52:53]
    s_cmp_ge_u32 s52, s34
    s_cbranch_scc1 main_kernel_cf_fgo
    s_memtime s[52:53]
    s_cmp_ge_u32 s52, s34
    s_cbranch_scc1 main_kernel_cf_fgo
    s_memtime s[52:53]
    s_cmp_ge_u32 s52, s34
    s_cbranch_scc1 main_kernel_cf_fgo
    s_memtime s[52:53]
    s_cmp_ge_u32 s52, s34
    s_cbranch_scc1 main_kernel_cf_fgo
    s_sub_u32 s35, s35, 1
    s_cbranch_scc0 main_kernel_cf_fw
main_kernel_cf_fgo:
    buffer_load_dwordx4 v[0:3], v120, s[4:7], s23 offen sc1
    s_add_u32 s35, s23, 0x8000
    buffer_load_dwordx4 v[4:7], v120, s[4:7], s35 offen sc1
    s_add_u32 s35, s23, 0x10000
    buffer_load_dwordx4 v[8:11], v120, s[4:7], s35 offen sc1
    ds_read_b32 v33, v123 offset:20992
    s_add_u32 s35, s23, 0x18000
    buffer_load_dwordx4 v[12:15], v120, s[4:7], s35 offen sc1
    s_add_u32 s35, s23, 0x20000
    buffer_load_dwordx4 v[16:19], v120, s[4:7], s35 offen sc1
    s_add_u32 s35, s23, 0x28000
    buffer_load_dwordx4 v[20:23], v120, s[4:7], s35 offen sc1
    s_add_u32 s35, s23, 0x30000
    buffer_load_dwordx4 v[24:27], v120, s[4:7], s35 offen sc1
    s_add_u32 s35, s23, 0x38000
    buffer_load_dwordx4 v[28:31], v120, s[4:7], s35 offen sc1
    s_mov_b64 exec, 1
    s_waitcnt lgkmcnt(0)
    v_sub_u32 v33, s34, v33
    v_bfi_b32 v33, 1, s40, v33
    buffer_store_dword v33, off, s[4:7], s18 offset:1536 sc1
    v_readfirstlane_b32 s10, v33
    s_mov_b64 exec, -1
    s_waitcnt vmcnt(8)
    v_mfma_f32_16x16x32_f16 v[76:79], v[0:3], v[106:109], 0
    v_xor_b32 v36, s22, v0
    v_bitop3_b32 v36, v2, s22, v36 bitop3:0xbe
    s_waitcnt vmcnt(7)
    v_mfma_f32_16x16x32_f16 v[76:79], v[4:7], v[106:109], v[76:79]
    v_bitop3_b32 v36, v4, s22, v36 bitop3:0xbe
    v_bitop3_b32 v36, v6, s22, v36 bitop3:0xbe
    s_waitcnt vmcnt(6)
    v_mfma_f32_16x16x32_f16 v[76:79], v[8:11], v[106:109], v[76:79]
    v_bitop3_b32 v36, v8, s22, v36 bitop3:0xbe
    v_bitop3_b32 v36, v10, s22, v36 bitop3:0xbe
    s_waitcnt vmcnt(5)
    v_mfma_f32_16x16x32_f16 v[76:79], v[12:15], v[106:109], v[76:79]
    v_bitop3_b32 v36, v12, s22, v36 bitop3:0xbe
    v_bitop3_b32 v36, v14, s22, v36 bitop3:0xbe
    s_waitcnt vmcnt(4)
    v_mfma_f32_16x16x32_f16 v[76:79], v[16:19], v[106:109], v[76:79]
    v_bitop3_b32 v36, v16, s22, v36 bitop3:0xbe
    v_bitop3_b32 v36, v18, s22, v36 bitop3:0xbe
    s_waitcnt vmcnt(3)
    v_mfma_f32_16x16x32_f16 v[76:79], v[20:23], v[106:109], v[76:79]
    v_bitop3_b32 v36, v20, s22, v36 bitop3:0xbe
    v_bitop3_b32 v36, v22, s22, v36 bitop3:0xbe
    s_waitcnt vmcnt(2)
    v_mfma_f32_16x16x32_f16 v[76:79], v[24:27], v[106:109], v[76:79]
    v_bitop3_b32 v36, v24, s22, v36 bitop3:0xbe
    v_bitop3_b32 v36, v26, s22, v36 bitop3:0xbe
    s_waitcnt vmcnt(1)
    v_mfma_f32_16x16x32_f16 v[76:79], v[28:31], v[106:109], v[76:79]
    v_bitop3_b32 v36, v28, s22, v36 bitop3:0xbe
    v_bitop3_b32 v36, v30, s22, v36 bitop3:0xbe
    v_and_b32 v36, 1, v36
    v_cmp_ne_u32 vcc, 0, v36
    s_nop 3
    v_cvt_pk_bf16_f32 v126, v76, v77
    v_cvt_pk_bf16_f32 v127, v78, v79
    s_cbranch_vccnz main_kernel_cf_r_f
    buffer_store_dwordx2 v[126:127], v122, s[4:7], s24 offen
    s_sub_u32 s20, s34, s38
    s_mov_b32 s3, s34
    buffer_store_dword v89, v117, s[4:7], s46 offen offset:512
    v_mov_b32 v32, -1
    v_mov_b32 v33, -1
    v_mov_b32 v64, 0
    v_mov_b32 v65, 0
    v_mov_b32 v66, 0
    v_mov_b32 v67, 0
    v_mov_b32 v68, 0
    v_mov_b32 v69, 0
    v_mov_b32 v70, 0
    v_mov_b32 v71, 0
    v_mov_b32 v96, 0
    v_mov_b32 v97, 0
    v_mov_b32 v98, 0
    v_mov_b32 v99, 0
    buffer_store_dwordx2 v[32:33], v122, s[4:7], s54 offen
    s_cmp_eq_u32 s12, 0
    v_add_u32 v56, s59, v115
    s_cbranch_scc0 main_kernel_cf_vma
    ds_read_b64_tr_b16 v[80:81], v56 offset:16384
    ds_read_b64_tr_b16 v[82:83], v56 offset:17408
    s_waitcnt lgkmcnt(0)
    s_nop 15
    s_nop 15
    s_nop 5
    s_buffer_load_dword s9, s[4:7], s56 glc
    buffer_load_dword v111, v90, s[4:7], s47 offen offset:512 sc1
    buffer_load_dwordx4 v116, s[4:7], s25 offen offset:0 sc1 lds
    buffer_load_dwordx4 v116, s[4:7], s25 offen offset:1024 sc1 lds
    buffer_load_dwordx4 v116, s[4:7], s25 offen offset:2048 sc1 lds
    buffer_load_dwordx4 v116, s[4:7], s25 offen offset:3072 sc1 lds
    s_mov_b32 m0, 4096
    s_nop 0
    buffer_load_dwordx4 v116, s[4:7], s55 offen offset:0 sc1 lds
    buffer_load_dwordx4 v116, s[4:7], s55 offen offset:1024 sc1 lds
    buffer_load_dwordx4 v116, s[4:7], s55 offen offset:2048 sc1 lds
    buffer_load_dwordx4 v116, s[4:7], s55 offen offset:3072 sc1 lds
    v_mov_b32 v34, v90
    s_mov_b32 m0, s36
    s_barrier
    ds_read_b32 v35, v123 offset:20480
    buffer_load_dwordx4 v[88:91], v116, s[4:7], s28 offen offset:0 sc1
    buffer_load_dwordx4 v[92:95], v116, s[4:7], s28 offen offset:1024 sc1
    buffer_load_dwordx4 v116, s[4:7], s27 offen offset:0 sc1 lds
    buffer_store_dwordx4 v[80:83], v125, s[4:7], s26 offen sc1
    s_branch main_kernel_cf_kva
main_kernel_cf_vma:
    v_mfma_f32_16x16x32_bf16 v[56:59], v[102:105], v[84:87], 0
    s_nop 7
    v_cvt_pk_bf16_f32 v80, v56, v57
    v_cvt_pk_bf16_f32 v81, v58, v59
    s_nop 15
    s_nop 15
    s_nop 5
    s_buffer_load_dword s9, s[4:7], s56 glc
    buffer_load_dword v111, v90, s[4:7], s47 offen offset:512 sc1
    buffer_load_dwordx4 v116, s[4:7], s25 offen offset:0 sc1 lds
    buffer_load_dwordx4 v116, s[4:7], s25 offen offset:1024 sc1 lds
    buffer_load_dwordx4 v116, s[4:7], s25 offen offset:2048 sc1 lds
    buffer_load_dwordx4 v116, s[4:7], s25 offen offset:3072 sc1 lds
    s_mov_b32 m0, 4096
    s_nop 0
    buffer_load_dwordx4 v116, s[4:7], s55 offen offset:0 sc1 lds
    buffer_load_dwordx4 v116, s[4:7], s55 offen offset:1024 sc1 lds
    buffer_load_dwordx4 v116, s[4:7], s55 offen offset:2048 sc1 lds
    buffer_load_dwordx4 v116, s[4:7], s55 offen offset:3072 sc1 lds
    v_mov_b32 v34, v90
    s_mov_b32 m0, s36
    s_barrier
    ds_read_b32 v35, v123 offset:20480
    buffer_load_dwordx4 v[88:91], v116, s[4:7], s28 offen offset:0 sc1
    buffer_load_dwordx4 v[92:95], v116, s[4:7], s28 offen offset:1024 sc1
    buffer_load_dwordx4 v116, s[4:7], s27 offen offset:0 sc1 lds
    buffer_store_dwordx2 v[80:81], v123, s[4:7], s26 offen sc1
main_kernel_cf_kva:
    s_add_u32 s26, s26, 0x10000
    s_waitcnt vmcnt(12)
    v_cmp_gt_i32 vcc, s17, v111
    v_readfirstlane_b32 s38, v35
    s_cbranch_vccnz main_kernel_cf_mc_f
    s_waitcnt vmcnt(4)
    s_branch main_kernel_cf_top
main_kernel_cf_wx:
    s_cmp_lg_u32 s14, 1
    s_cbranch_scc1 main_kernel_cf_wy
    s_memrealtime s[32:33]
    s_nop 0
    s_nop 0
    s_memrealtime s[32:33]
    s_nop 0
    s_nop 0
    s_memrealtime s[32:33]
    s_nop 0
    s_nop 0
    s_memrealtime s[32:33]
    s_nop 0
    s_nop 0
    s_memrealtime s[32:33]
    s_nop 0
    s_nop 0
    s_memrealtime s[32:33]
    s_nop 0
    s_nop 0
    s_memrealtime s[32:33]
    s_nop 0
    s_nop 0
    s_memrealtime s[32:33]
    s_nop 0
    s_nop 0
    s_memrealtime s[32:33]
    s_nop 0
    s_nop 0
    s_memrealtime s[32:33]
    s_nop 0
    s_nop 0
    s_memrealtime s[32:33]
    s_nop 0
    s_nop 0
    s_memrealtime s[32:33]
    s_nop 0
    s_nop 0
    s_mov_b32 s34, s32
    s_memrealtime s[32:33]
    s_cmp_lg_u32 s32, s34
    s_cbranch_scc1 main_kernel_cf_e1
    s_memrealtime s[32:33]
    s_cmp_lg_u32 s32, s34
    s_cbranch_scc1 main_kernel_cf_e1
    s_memrealtime s[32:33]
    s_cmp_lg_u32 s32, s34
    s_cbranch_scc1 main_kernel_cf_e1
    s_memrealtime s[32:33]
    s_cmp_lg_u32 s32, s34
    s_cbranch_scc1 main_kernel_cf_e1
    s_memrealtime s[32:33]
    s_cmp_lg_u32 s32, s34
    s_cbranch_scc1 main_kernel_cf_e1
    s_memrealtime s[32:33]
    s_cmp_lg_u32 s32, s34
    s_cbranch_scc1 main_kernel_cf_e1
    s_memrealtime s[32:33]
    s_cmp_lg_u32 s32, s34
    s_cbranch_scc1 main_kernel_cf_e1
    s_memrealtime s[32:33]
    s_cmp_lg_u32 s32, s34
    s_cbranch_scc1 main_kernel_cf_e1
    s_memrealtime s[32:33]
    s_cmp_lg_u32 s32, s34
    s_cbranch_scc1 main_kernel_cf_e1
    s_memrealtime s[32:33]
    s_cmp_lg_u32 s32, s34
    s_cbranch_scc1 main_kernel_cf_e1
    s_memrealtime s[32:33]
    s_cmp_lg_u32 s32, s34
    s_cbranch_scc1 main_kernel_cf_e1
    s_memrealtime s[32:33]
    s_cmp_lg_u32 s32, s34
    s_cbranch_scc1 main_kernel_cf_e1
main_kernel_cf_e1:
    s_memtime s[52:53]
    s_mul_i32 s34, s32, 22
    s_waitcnt lgkmcnt(0)
    s_sub_u32 s32, s52, s34
    s_sub_u32 s33, s32, s38
    s_ashr_i32 s34, s33, 1
    s_add_u32 s34, s34, s32
    v_mov_b32 v34, s34
    v_mov_b32 v33, s32
    ds_write2st64_b32 v123, v33, v34 offset0:80 offset1:82
    v_add_u32 v37, s33, v34
main_kernel_cf_wy:
    s_xor_b32 s21, s21, 0x80000
    v_mov_b32 v64, 0
    v_mov_b32 v65, 0
    v_mov_b32 v66, 0
    v_mov_b32 v67, 0
    v_mov_b32 v68, 0
    v_mov_b32 v69, 0
    v_mov_b32 v70, 0
    v_mov_b32 v71, 0
    v_mov_b32 v96, 0
    v_mov_b32 v97, 0
    v_mov_b32 v98, 0
    v_mov_b32 v99, 0
    s_cmp_eq_u32 s12, 0
    v_add_u32 v56, s59, v115
    s_cbranch_scc0 main_kernel_cf_vmb
    ds_read_b64_tr_b16 v[80:81], v56 offset:16384
    ds_read_b64_tr_b16 v[82:83], v56 offset:17408
    s_waitcnt lgkmcnt(0)
    s_waitcnt vmcnt(0)
    s_mov_b32 m0, s36
    s_barrier
    ds_read_b32 v35, v123 offset:20480
    ds_write_b32 v124, v37 offset:3584
    buffer_load_dwordx4 v[88:91], v116, s[4:7], s28 offen offset:0 sc1
    buffer_load_dwordx4 v[92:95], v116, s[4:7], s28 offen offset:1024 sc1
    buffer_load_dwordx4 v116, s[4:7], s27 offen offset:0 sc1 lds
    buffer_store_dwordx4 v[80:83], v125, s[4:7], s26 offen sc1
    s_branch main_kernel_cf_kvb
main_kernel_cf_vmb:
    v_mfma_f32_16x16x32_bf16 v[56:59], v[102:105], v[84:87], 0
    s_nop 7
    v_cvt_pk_bf16_f32 v80, v56, v57
    v_cvt_pk_bf16_f32 v81, v58, v59
    s_waitcnt vmcnt(0)
    s_mov_b32 m0, s36
    s_barrier
    ds_read_b32 v35, v123 offset:20480
    ds_write_b32 v124, v37 offset:3584
    buffer_load_dwordx4 v[88:91], v116, s[4:7], s28 offen offset:0 sc1
    buffer_load_dwordx4 v[92:95], v116, s[4:7], s28 offen offset:1024 sc1
    buffer_load_dwordx4 v116, s[4:7], s27 offen offset:0 sc1 lds
    buffer_store_dwordx2 v[80:81], v123, s[4:7], s26 offen sc1
main_kernel_cf_kvb:
    s_add_u32 s26, s26, 0x10000
    s_mov_b64 exec, 1
    buffer_store_dword v100, off, s[4:7], s39 sc1
    s_mov_b64 exec, -1
    s_add_u32 s39, s39, 4
    s_waitcnt lgkmcnt(0)
    v_readfirstlane_b32 s38, v35
    v_mov_b32 v35, 0
    v_mov_b32 v35, 0
    v_mov_b32 v35, 0
    v_mov_b32 v35, 0
    v_mov_b32 v35, 0
    v_mov_b32 v35, 0
main_kernel_cf_end:
    s_branch main_kernel_cf_top
main_kernel_cf_mc_f:
    s_mov_b32 m0, 0
    s_sub_u32 s29, s29, 1
    s_cbranch_scc1 main_kernel_end
    buffer_load_dword v111, v34, s[4:7], s47 offen offset:512 sc1
    buffer_load_dwordx4 v116, s[4:7], s25 offen offset:0 sc1 lds
    buffer_load_dwordx4 v116, s[4:7], s25 offen offset:1024 sc1 lds
    buffer_load_dwordx4 v116, s[4:7], s25 offen offset:2048 sc1 lds
    buffer_load_dwordx4 v116, s[4:7], s25 offen offset:3072 sc1 lds
    s_mov_b32 m0, 4096
    s_nop 0
    buffer_load_dwordx4 v116, s[4:7], s55 offen offset:0 sc1 lds
    buffer_load_dwordx4 v116, s[4:7], s55 offen offset:1024 sc1 lds
    buffer_load_dwordx4 v116, s[4:7], s55 offen offset:2048 sc1 lds
    buffer_load_dwordx4 v116, s[4:7], s55 offen offset:3072 sc1 lds
    s_waitcnt vmcnt(8)
    v_cmp_gt_i32 vcc, s17, v111
    v_readfirstlane_b32 s38, v35
    s_cbranch_vccnz main_kernel_cf_mc_f
    s_waitcnt vmcnt(0)
    s_branch main_kernel_cf_end
main_kernel_cf_t_w:
    s_mov_b32 s35, 200
main_kernel_cf_t_s:
    s_memtime s[52:53]
    s_cmp_ge_u32 s52, s34
    s_cbranch_scc1 main_kernel_cf_t_go
    s_memtime s[52:53]
    s_cmp_ge_u32 s52, s34
    s_cbranch_scc1 main_kernel_cf_t_go
    s_memtime s[52:53]
    s_cmp_ge_u32 s52, s34
    s_cbranch_scc1 main_kernel_cf_t_go
    s_memtime s[52:53]
    s_cmp_ge_u32 s52, s34
    s_cbranch_scc1 main_kernel_cf_t_go
    s_memtime s[52:53]
    s_cmp_ge_u32 s52, s34
    s_cbranch_scc1 main_kernel_cf_t_go
    s_memtime s[52:53]
    s_cmp_ge_u32 s52, s34
    s_cbranch_scc1 main_kernel_cf_t_go
    s_memtime s[52:53]
    s_cmp_ge_u32 s52, s34
    s_cbranch_scc1 main_kernel_cf_t_go
    s_memtime s[52:53]
    s_cmp_ge_u32 s52, s34
    s_cbranch_scc1 main_kernel_cf_t_go
    s_sub_u32 s35, s35, 1
    s_cbranch_scc0 main_kernel_cf_t_s
    s_branch main_kernel_cf_t_go
main_kernel_cf_t_p:
    s_waitcnt lgkmcnt(0)
    s_xor_b32 s32, s9, s22
    s_bitcmp1_b32 s32, 0
    s_cbranch_scc0 main_kernel_cf_t_ok
    s_buffer_load_dword s9, s[4:7], s56 glc
    s_sub_u32 s29, s29, 1
    s_cbranch_scc1 main_kernel_end
    s_branch main_kernel_cf_t_p
main_kernel_cf_z0_f:
    buffer_load_dwordx2 v[126:127], v123, s[4:7], s19 offen offset:0 sc1
    s_sub_u32 s29, s29, 1
    s_cbranch_scc1 main_kernel_end
    s_waitcnt vmcnt(0)
    s_branch main_kernel_cf_z0
main_kernel_cf_z2_f:
    buffer_load_dwordx2 v[64:65], v123, s[4:7], s19 offen offset:512 sc1
    s_sub_u32 s29, s29, 1
    s_cbranch_scc1 main_kernel_end
    s_waitcnt vmcnt(0)
main_kernel_cf_z1_f:
    s_waitcnt vmcnt(0)
    s_memtime s[52:53]
    v_dot2_f32_bf16 v44, v64, s37, v68
    v_dot2_f32_bf16 v45, v64, s57, v69
    v_dot2_f32_bf16 v46, v65, s37, v70
    v_dot2_f32_bf16 v47, v65, s57, v71
    v_bitop3_b32 v60, v64, s22, 1 bitop3:0x28
    v_cvt_pk_bf16_f32 v44, v44, v45
    v_cmp_ne_u32 vcc, 0, v60
    v_cvt_pk_bf16_f32 v45, v46, v47
    ds_write_b64 v124, v[44:45] offset:512
    s_cbranch_vccnz main_kernel_cf_z2_f
    s_branch main_kernel_cf_z_ok
main_kernel_cf_kvw:
    s_cmp_eq_u32 s17, 64
    s_cbranch_scc1 main_kernel_cf_kvok
    s_waitcnt vmcnt(0)
    s_mov_b32 exec_lo, 0
    s_mov_b32 exec_hi, 0x3f00
    v_subrev_u32 v127, 0, v121
main_kernel_cf_kvp:
    buffer_load_dword v126, v127, s[4:7], 0 offen sc1
    s_waitcnt vmcnt(0)
    v_cmp_eq_u32 vcc, 0, v126
    s_cbranch_vccz main_kernel_cf_kvp_ok
    s_sleep 2
    s_sub_u32 s29, s29, 1
    s_cbranch_scc0 main_kernel_cf_kvp
    s_branch main_kernel_end
main_kernel_cf_kvp_ok:
    s_mov_b64 exec, -1
    s_branch main_kernel_cf_kvok
main_kernel_cf_last:
    buffer_load_dwordx2 v[86:87], v123, s[4:7], s19 offen offset:1024 sc1
    s_sub_u32 s29, s29, 1
    s_cbranch_scc1 main_kernel_end
    s_waitcnt vmcnt(0) lgkmcnt(0)
    v_bitop3_b32 v44, v86, s22, 1 bitop3:0x28
    v_cmp_ne_u32 vcc, 0, v44
    s_cbranch_vccnz main_kernel_cf_last
    v_swap_b32 v85, v86
    s_cmp_eq_u32 s12, 0
    v_add_u32 v56, s59, v115
    s_cbranch_scc0 main_kernel_cf_vmc
    ds_read_b64_tr_b16 v[80:81], v56 offset:16384
    ds_read_b64_tr_b16 v[82:83], v56 offset:17408
    s_waitcnt lgkmcnt(0)
    buffer_store_dwordx4 v[80:83], v125, s[4:7], s26 offen sc1
    s_branch main_kernel_cf_kvc
main_kernel_cf_vmc:
    v_mfma_f32_16x16x32_bf16 v[56:59], v[102:105], v[84:87], 0
    s_nop 7
    v_cvt_pk_bf16_f32 v80, v56, v57
    v_cvt_pk_bf16_f32 v81, v58, v59
    buffer_store_dwordx2 v[80:81], v123, s[4:7], s26 offen sc1
main_kernel_cf_kvc:
    s_add_u32 s26, s26, 0x10000
    s_branch main_kernel_end
main_kernel_cf_m_f:
main_kernel_cf_m_t:
    ds_read_b128 v[0:3], v116 offset:0
    ds_read_b128 v[4:7], v116 offset:1024
    ds_read_b128 v[8:11], v116 offset:2048
    ds_read_b128 v[12:15], v116 offset:3072
    ds_read_b128 v[16:19], v116 offset:4096
    ds_read_b128 v[20:23], v116 offset:5120
    ds_read_b128 v[24:27], v116 offset:6144
    ds_read_b128 v[28:31], v116 offset:7168
    s_waitcnt lgkmcnt(0)
    v_max_u32 v126, v0, v2
    v_max3_u32 v126, v126, v4, v6
    v_max3_u32 v126, v126, v8, v10
    v_max3_u32 v126, v126, v12, v14
    v_max3_u32 v126, v126, v16, v18
    v_max3_u32 v126, v126, v20, v22
    v_max3_u32 v126, v126, v24, v26
    v_max3_u32 v126, v126, v28, v30
    v_cmp_eq_u32 vcc, -1, v126
    s_cbranch_vccz main_kernel_cf_m_g
    s_barrier
    s_lshl_b32 s32, s14, 11
    s_add_u32 m0, s32, 0
    s_add_u32 s32, s32, s25
    buffer_load_dwordx4 v116, s[4:7], s32 offen offset:0 sc1 lds
    buffer_load_dwordx4 v116, s[4:7], s32 offen offset:1024 sc1 lds
    s_sub_u32 s29, s29, 1
    s_cbranch_scc1 main_kernel_end
    s_waitcnt vmcnt(0)
    s_barrier
    s_branch main_kernel_cf_m_t
main_kernel_cf_m_g:
    s_mov_b64 s[44:45], 0
    v_mov_b32 v64, 0
    v_mov_b32 v65, 0
    v_mov_b32 v66, 0
    v_mov_b32 v67, 0
    v_mov_b32 v68, 0
    v_mov_b32 v69, 0
    v_mov_b32 v70, 0
    v_mov_b32 v71, 0
    v_mov_b32 v96, 0
    v_mov_b32 v97, 0
    v_mov_b32 v98, 0
    v_mov_b32 v99, 0
    s_branch main_kernel_cf_mrd
main_kernel_cf_v_f:
    v_swap_b32 v85, v86
    s_nop 7
    s_waitcnt vmcnt(1)
main_kernel_cf_v_t:
    s_memtime s[52:53]
    v_bitop3_b32 v44, v126, s22, 1 bitop3:0x28
    v_cmp_ne_u32 vcc, 0, v44
    s_sub_u32 s29, s29, 1
    s_cbranch_scc1 main_kernel_end
    s_cbranch_vccnz main_kernel_cf_v_g
    v_mfma_f32_16x16x32_bf16 v[64:67], v[88:91], v[32:35], 0
    v_mfma_f32_16x16x32_bf16 v[68:71], v[92:95], v[32:35], 0
    v_mov_b32 v86, v126
    v_mov_b32 v87, v127
    s_waitcnt lgkmcnt(0)
    s_sub_u32 s32, s52, s38
    s_add_u32 s32, s32, -550
    v_mov_b32 v46, s32
    buffer_store_dword v46, v117, s[4:7], s46 offen
    s_branch main_kernel_cf_v_ok
main_kernel_cf_v_g:
    buffer_load_dwordx2 v[126:127], v123, s[4:7], s19 offen offset:1024 sc1
    s_waitcnt lgkmcnt(0)
    s_sub_u32 s32, s52, s38
    s_add_u32 s32, s32, -50
    v_mov_b32 v46, s32
    buffer_store_dword v46, v117, s[4:7], s46 offen
    s_waitcnt vmcnt(0)
    s_branch main_kernel_cf_v_t
main_kernel_cf_d_f:
    s_memtime s[52:53]
    s_waitcnt vmcnt(1) lgkmcnt(0)
    s_sub_u32 s32, s52, s38
    s_add_u32 s32, s32, 300
    v_mov_b32 v46, s32
    buffer_store_dword v46, v117, s[4:7], s46 offen
    ds_read_b128 v[0:3], v112 offset:0
    ds_read_b128 v[4:7], v112 offset:1024
    ds_read_b128 v[8:11], v112 offset:2048
    ds_read_b128 v[12:15], v112 offset:3072
    ds_read_b128 v[16:19], v112 offset:4096
    ds_read_b128 v[20:23], v112 offset:5120
    ds_read_b128 v[24:27], v112 offset:6144
    ds_read_b128 v[28:31], v112 offset:7168
    s_waitcnt lgkmcnt(0)
    v_mfma_f32_16x16x32_bf16 v[32:35], v[0:3], v[48:51], 0
    v_mfma_f32_16x16x32_bf16 v[36:39], v[16:19], v[48:51], 0
    v_mfma_f32_16x16x32_bf16 v[72:75], v[48:51], v[48:51], 0
    v_mfma_f32_16x16x32_bf16 v[32:35], v[4:7], v[52:55], v[32:35]
    v_mfma_f32_16x16x32_bf16 v[36:39], v[20:23], v[52:55], v[36:39]
    v_mfma_f32_16x16x32_bf16 v[72:75], v[52:55], v[52:55], v[72:75]
    v_mfma_f32_16x16x32_bf16 v[32:35], v[8:11], v[56:59], v[32:35]
    v_mfma_f32_16x16x32_bf16 v[36:39], v[24:27], v[56:59], v[36:39]
    v_mfma_f32_16x16x32_bf16 v[72:75], v[56:59], v[56:59], v[72:75]
    v_mfma_f32_16x16x32_bf16 v[32:35], v[12:15], v[60:63], v[32:35]
    v_mfma_f32_16x16x32_bf16 v[36:39], v[28:31], v[60:63], v[36:39]
    v_mfma_f32_16x16x32_bf16 v[72:75], v[60:63], v[60:63], v[72:75]
    s_nop 7
    ds_read_b128 v[0:3], v113 offset:16384
    ds_read_b128 v[16:19], v113 offset:18432
    ds_read_b128 v[4:7], v113 offset:17408
    ds_read_b128 v[20:23], v113 offset:19456
    ds_read_b128 v[8:11], v113 offset:24576
    ds_read_b128 v[24:27], v113 offset:26624
    ds_read_b128 v[12:15], v113 offset:25600
    ds_read_b128 v[28:31], v113 offset:27648
    v_permlane32_swap_b32 v72, v73
    v_permlane32_swap_b32 v74, v75
    v_mul_f32 v73, s30, v73
    v_mul_f32 v75, s30, v75
    v_max_f32 v126, v73, v75
    v_max3_f32 v126, v126, v32, v33
    v_max3_f32 v126, v126, v34, v35
    v_max3_f32 v126, v126, v36, v37
    v_max3_f32 v126, v126, v38, v39
    v_mov_b32 v127, v126
    s_nop 1
    v_permlane32_swap_b32 v126, v127
    v_max_f32 v126, v126, v127
    v_mov_b32 v127, v126
    s_nop 1
    v_permlane16_swap_b32 v126, v127
    v_max_f32 v126, v126, v127
    v_sub_f32 v32, v32, v126
    v_sub_f32 v33, v33, v126
    v_sub_f32 v34, v34, v126
    v_sub_f32 v35, v35, v126
    v_sub_f32 v36, v36, v126
    v_sub_f32 v37, v37, v126
    v_sub_f32 v38, v38, v126
    v_sub_f32 v39, v39, v126
    v_sub_f32 v73, v73, v126
    v_sub_f32 v75, v75, v126
    v_exp_f32 v32, v32
    v_exp_f32 v33, v33
    v_exp_f32 v34, v34
    v_exp_f32 v35, v35
    v_exp_f32 v36, v36
    v_exp_f32 v37, v37
    v_exp_f32 v38, v38
    v_exp_f32 v39, v39
    v_exp_f32 v73, v73
    v_exp_f32 v75, v75
    v_cvt_pk_bf16_f32 v32, v32, v33
    v_cvt_pk_bf16_f32 v33, v34, v35
    v_cvt_pk_bf16_f32 v34, v36, v37
    v_cvt_pk_bf16_f32 v35, v38, v39
    v_cvt_pk_bf16_f32 v72, v73, v75
    v_cvt_pk_bf16_f32 v73, v73, v75
    s_nop 1
    v_mfma_f32_16x16x32_bf16 v[64:67], v[88:91], v[32:35], 0
    v_mfma_f32_16x16x32_bf16 v[68:71], v[92:95], v[32:35], 0
    v_mfma_f32_16x16x32_bf16 v[40:43], v[96:99], v[32:35], 0
    v_mfma_f32_16x16x16_bf16 v[40:43], v[100:101], v[72:73], v[40:43]
    s_mov_b64 s[44:45], 0
    s_mov_b64 vcc, 0
    s_nop 7
    s_branch main_kernel_cf_d_ok
main_kernel_cf_fsp:
    s_mov_b32 s35, 40
main_kernel_cf_fsl:
    buffer_load_dword v111, v90, s[4:7], s47 offen sc1
    s_waitcnt vmcnt(1)
    v_subrev_u32 v32, s20, v111
    v_cmp_lt_u32 vcc, 0x100000, v32
    s_cbranch_vccz main_kernel_cf_rgo
    s_sub_u32 s35, s35, 1
    s_cbranch_scc0 main_kernel_cf_fsl
    v_mov_b32 v32, 0
    s_branch main_kernel_cf_fok
main_kernel_cf_r_f:
    s_memtime s[52:53]
    buffer_load_dword v111, v90, s[4:7], s47 offen sc1
    s_waitcnt lgkmcnt(0)
    s_sub_u32 s15, s52, s16
    s_add_u32 s15, s15, -1500
    s_waitcnt vmcnt(0)
    s_sub_u32 s29, s29, 1
    s_cbranch_scc1 main_kernel_end
    s_branch main_kernel_cf_rgo
    .p2align 6
main_kernel_cs_top:
    s_barrier
main_kernel_cs_mrd:
    ds_read_b128 v[0:3], v114 offset:0
    ds_read_b128 v[4:7], v114 offset:512
    ds_read_b128 v[8:11], v114 offset:1024
    ds_read_b128 v[12:15], v114 offset:1536
    ds_read_b128 v[16:19], v114 offset:2048
    s_waitcnt lgkmcnt(4)
    v_smfmac_f32_16x16x64_bf16 v[96:99], v[0:3], a[0:7], v110
    ds_read_b128 v[20:23], v114 offset:2560
    s_waitcnt lgkmcnt(4)
    v_smfmac_f32_16x16x64_bf16 v[96:99], v[4:7], a[8:15], v110
    ds_read_b128 v[24:27], v114 offset:3072
    s_waitcnt lgkmcnt(4)
    s_bfe_u32 s22, s17, 0x10001
    v_smfmac_f32_16x16x64_bf16 v[96:99], v[8:11], a[16:23], v110
    ds_read_b128 v[28:31], v114 offset:3584
    s_waitcnt lgkmcnt(4)
    v_smfmac_f32_16x16x64_bf16 v[96:99], v[12:15], a[24:31], v110
    ds_read_b128 v[32:35], v114 offset:4096
    s_waitcnt lgkmcnt(4)
    v_smfmac_f32_16x16x64_bf16 v[96:99], v[16:19], a[32:39], v110
    ds_read_b128 v[36:39], v114 offset:4608
    s_waitcnt lgkmcnt(4)
    v_smfmac_f32_16x16x64_bf16 v[96:99], v[20:23], a[40:47], v110
    ds_read_b128 v[40:43], v114 offset:5120
    s_waitcnt lgkmcnt(4)
    v_smfmac_f32_16x16x64_bf16 v[96:99], v[24:27], a[48:55], v110
    ds_read_b128 v[44:47], v114 offset:5632
    s_waitcnt lgkmcnt(4)
    v_smfmac_f32_16x16x64_bf16 v[96:99], v[28:31], a[56:63], v110
    ds_read_b128 v[48:51], v114 offset:6144
    s_waitcnt lgkmcnt(4)
    v_smfmac_f32_16x16x64_bf16 v[96:99], v[32:35], a[64:71], v110
    ds_read_b128 v[52:55], v114 offset:6656
    s_waitcnt lgkmcnt(4)
    v_smfmac_f32_16x16x64_bf16 v[96:99], v[36:39], a[72:79], v110
    ds_read_b128 v[56:59], v114 offset:7168
    s_waitcnt lgkmcnt(4)
    v_smfmac_f32_16x16x64_bf16 v[96:99], v[40:43], a[80:87], v110
    ds_read_b128 v[60:63], v114 offset:7680
    s_waitcnt lgkmcnt(4)
    v_smfmac_f32_16x16x64_bf16 v[96:99], v[44:47], a[88:95], v110
    s_waitcnt lgkmcnt(3)
    buffer_load_dword v111, v121, s[4:7], 0 offen sc1
    v_smfmac_f32_16x16x64_bf16 v[96:99], v[48:51], a[96:103], v110
    s_waitcnt lgkmcnt(2)
    ds_read_b128 v[80:83], v113 offset:0
    v_smfmac_f32_16x16x64_bf16 v[96:99], v[52:55], a[104:111], v110
    s_waitcnt lgkmcnt(2)
    ds_read_b128 v[84:87], v113 offset:1024
    v_smfmac_f32_16x16x64_bf16 v[96:99], v[56:59], a[112:119], v110
    s_waitcnt lgkmcnt(2)
    v_smfmac_f32_16x16x64_bf16 v[96:99], v[60:63], a[120:127], v110
    v_smfmac_f32_16x16x64_bf16 v[68:71], v[0:3], a[128:135], v110
    ds_read_b128 v[72:75], v113 offset:2048
    v_smfmac_f32_16x16x64_bf16 v[68:71], v[4:7], a[136:143], v110
    s_nop 1
    v_pk_add_f32 v[126:127], v[96:97], v[98:99]
    ds_read_b128 v[76:79], v113 offset:3072
    v_smfmac_f32_16x16x64_bf16 v[68:71], v[8:11], a[144:151], v110
    v_cmp_u_f32 vcc, v126, v127
    v_smfmac_f32_16x16x64_bf16 v[68:71], v[12:15], a[152:159], v110
    v_cvt_pk_bf16_f32 v126, v96, v97
    v_smfmac_f32_16x16x64_bf16 v[68:71], v[16:19], a[160:167], v110
    v_cvt_pk_bf16_f32 v127, v98, v99
    s_and_b64 s[42:43], vcc, s[44:45]
    s_cbranch_scc1 main_kernel_cs_m_f
    v_smfmac_f32_16x16x64_bf16 v[68:71], v[20:23], a[168:175], v110
    v_bfi_b32 v126, 1, s22, v126
    buffer_store_dwordx2 v[126:127], v123, s[4:7], s18 offen sc1
    v_smfmac_f32_16x16x64_bf16 v[68:71], v[24:27], a[176:183], v110
    s_mov_b64 s[44:45], s[0:1]
    v_smfmac_f32_16x16x64_bf16 v[68:71], v[28:31], a[184:191], v110
    s_add_u32 s17, s17, 1
    s_bfe_u32 s40, s17, 0x10001
    v_smfmac_f32_16x16x64_bf16 v[68:71], v[32:35], a[192:199], v110
    s_add_u32 s28, s28, 0x40000
    s_mov_b32 m0, s36
    v_smfmac_f32_16x16x64_bf16 v[68:71], v[36:39], a[200:207], v110
    s_add_u32 s34, s3, 2130
    v_smfmac_f32_16x16x64_bf16 v[68:71], v[40:43], a[208:215], v110
    v_smfmac_f32_16x16x64_bf16 v[68:71], v[44:47], a[216:223], v110
    v_smfmac_f32_16x16x64_bf16 v[68:71], v[48:51], a[224:231], v110
    v_smfmac_f32_16x16x64_bf16 v[68:71], v[52:55], a[232:239], v110
    v_smfmac_f32_16x16x64_bf16 v[68:71], v[56:59], a[240:247], v110
    v_smfmac_f32_16x16x64_bf16 v[68:71], v[60:63], a[248:255], v110
    s_waitcnt lgkmcnt(2)
    v_smfmac_f32_16x16x64_bf16 v[64:67], v[32:35], v[80:87], v110
    s_waitcnt lgkmcnt(0)
    s_nop 3
    v_cvt_pk_bf16_f32 v126, v68, v69
    v_cvt_pk_bf16_f32 v127, v70, v71
    v_bfi_b32 v126, 1, s22, v126
    buffer_store_dwordx2 v[126:127], v123, s[4:7], s18 offen offset:512 sc1
    ds_read_b128 v[80:83], v113 offset:4096
    v_smfmac_f32_16x16x64_bf16 v[64:67], v[36:39], v[72:79], v110
    ds_read_b128 v[84:87], v113 offset:5120
    v_smfmac_f32_16x16x64_bf16 v[64:67], v[0:3], v[128:135], v110
    ds_read_b128 v[72:75], v113 offset:6144
    v_smfmac_f32_16x16x64_bf16 v[64:67], v[4:7], v[136:143], v110
    ds_read_b128 v[76:79], v113 offset:7168
    v_smfmac_f32_16x16x64_bf16 v[64:67], v[8:11], v[144:151], v110
    ds_read_b128 v[32:35], v113 offset:8192
    v_smfmac_f32_16x16x64_bf16 v[64:67], v[12:15], v[152:159], v110
    ds_read_b128 v[36:39], v113 offset:9216
    v_smfmac_f32_16x16x64_bf16 v[64:67], v[16:19], v[160:167], v110
    ds_read_b128 v[0:3], v113 offset:10240
    s_memtime s[52:53]
    v_smfmac_f32_16x16x64_bf16 v[64:67], v[20:23], v[168:175], v110
    ds_read_b128 v[4:7], v113 offset:11264
    s_memtime s[52:53]
    s_xor_b32 s32, s9, s22
    s_bitcmp1_b32 s32, 0
    s_cbranch_scc1 main_kernel_cs_t_p
main_kernel_cs_t_ok:
    s_sub_u32 s32, s9, s10
    v_smfmac_f32_16x16x64_bf16 v[64:67], v[24:27], v[176:183], v110
    ds_read_b128 v[8:11], v113 offset:12288
    s_memtime s[52:53]
    s_max_i32 s32, s32, 0
    s_min_i32 s32, s32, 0x4000
    v_smfmac_f32_16x16x64_bf16 v[64:67], v[28:31], v[184:191], v110
    s_waitcnt lgkmcnt(7)
    ds_read_b128 v[12:15], v113 offset:13312
    s_memtime s[52:53]
    s_add_u32 s34, s34, s32
    s_and_b32 s34, s34, s11
    v_smfmac_f32_16x16x64_bf16 v[64:67], v[40:43], v[80:87], v110
    s_waitcnt lgkmcnt(6)
    ds_read_b128 v[16:19], v113 offset:14336
    s_cmp_lt_u32 s52, s34
    s_cbranch_scc1 main_kernel_cs_t_w
main_kernel_cs_t_go:
    s_barrier
    buffer_load_dwordx2 v[126:127], v123, s[4:7], s19 offen offset:0 sc1
    v_smfmac_f32_16x16x64_bf16 v[64:67], v[44:47], v[72:79], v110
    s_waitcnt lgkmcnt(5)
    ds_read_b128 v[20:23], v113 offset:15360
    v_smfmac_f32_16x16x64_bf16 v[64:67], v[48:51], v[32:39], v110
    s_waitcnt lgkmcnt(4)
    v_smfmac_f32_16x16x64_bf16 v[64:67], v[52:55], v[0:7], v110
    s_waitcnt lgkmcnt(2)
    ds_read_b128 v[24:27], v112 offset:6144
    ds_read_b128 v[28:31], v112 offset:7168
    v_smfmac_f32_16x16x64_bf16 v[64:67], v[56:59], v[8:15], v110
    s_waitcnt lgkmcnt(2)
    ds_read_b128 v[0:3], v112 offset:0
    ds_read_b128 v[4:7], v112 offset:1024
    v_smfmac_f32_16x16x64_bf16 v[64:67], v[60:63], v[16:23], v110
    ds_read_b128 v[8:11], v112 offset:2048
    ds_read_b128 v[12:15], v112 offset:3072
    ds_read_b128 v[16:19], v112 offset:4096
    ds_read_b128 v[20:23], v112 offset:5120
    v_mov_b32 v76, 0
    v_mov_b32 v77, 0
    v_mov_b32 v78, 0
    s_nop 0
    v_permlane32_swap_b32 v64, v65
    v_permlane32_swap_b32 v66, v67
    v_cvt_pk_bf16_f32 v84, v64, v66
    v_cvt_pk_bf16_f32 v85, v65, v67
    v_bfi_b32 v84, 1, s22, v84
    buffer_load_dwordx2 v[42:43], v123, s[4:7], s19 offen offset:512 sc1
    v_mov_b32 v79, 0
    v_mov_b32 v80, 0
    v_mov_b32 v81, 0
    v_mov_b32 v82, 0
    v_mov_b32 v83, 0
    v_mov_b32 v60, 0
    v_mov_b32 v60, 0
    v_mov_b32 v60, 0
    v_mov_b32 v60, 0
    v_mov_b32 v60, 0
    v_mov_b32 v60, 0
    v_mov_b32 v60, 0
    buffer_store_dwordx2 v[84:85], v123, s[4:7], s18 offen offset:1024 sc1
    v_mov_b32 v60, 0
    v_mov_b32 v60, 0
    v_mov_b32 v60, 0
    v_mov_b32 v60, 0
    v_mov_b32 v60, 0
    v_mov_b32 v60, 0
    v_mov_b32 v60, 0
    v_mov_b32 v60, 0
    v_mov_b32 v60, 0
    v_mov_b32 v60, 0
    v_mov_b32 v60, 0
    v_mov_b32 v60, 0
    v_mov_b32 v60, 0
    v_mov_b32 v60, 0
    v_mov_b32 v60, 0
    v_mov_b32 v60, 0
    v_mov_b32 v60, 0
    v_mov_b32 v60, 0
    v_mov_b32 v60, 0
    v_mov_b32 v60, 0
    v_mov_b32 v60, 0
    v_mov_b32 v60, 0
    v_mov_b32 v60, 0
    v_mov_b32 v60, 0
    v_mov_b32 v60, 0
    v_mov_b32 v60, 0
    v_mov_b32 v60, 0
    v_mov_b32 v60, 0
    v_mov_b32 v60, 0
    v_mov_b32 v60, 0
    v_mov_b32 v60, 0
    v_mov_b32 v60, 0
    v_mov_b32 v60, 0
    v_mov_b32 v60, 0
    v_mov_b32 v60, 0
    v_mov_b32 v60, 0
    v_mov_b32 v60, 0
    v_mov_b32 v60, 0
    s_waitcnt vmcnt(2)
main_kernel_cs_z0:
    v_dot2_f32_bf16 v44, v126, s37, v96
    v_dot2_f32_bf16 v45, v126, s57, v97
    v_dot2_f32_bf16 v46, v127, s37, v98
    v_dot2_f32_bf16 v47, v127, s57, v99
    v_bitop3_b32 v60, v126, s22, 1 bitop3:0x28
    v_cvt_pk_bf16_f32 v44, v44, v45
    v_cmp_ne_u32 vcc, 0, v60
    v_cvt_pk_bf16_f32 v45, v46, v47
    ds_write_b64 v124, v[44:45] offset:0
    buffer_load_dwordx2 v[64:65], v123, s[4:7], s19 offen offset:512 sc1
    v_cmp_eq_u32 s[42:43], 0, v111
    s_cbranch_vccnz main_kernel_cs_z0_f
    v_mov_b32 v96, 0x3f803f80
    v_mov_b32 v97, 0x3f803f80
    v_mov_b32 v98, 0x3f803f80
    v_mov_b32 v99, 0x3f803f80
    s_and_b32 s32, s43, 0x3f00
    s_cbranch_scc1 main_kernel_cs_kvw
main_kernel_cs_kvok:
    s_waitcnt lgkmcnt(0)
    s_barrier
    ds_read_b64_tr_b16 v[48:49], v115 offset:16384
    ds_read_b64_tr_b16 v[50:51], v115 offset:17408
    ds_read_b64_tr_b16 v[52:53], v115 offset:18432
    ds_read_b64_tr_b16 v[54:55], v115 offset:19456
    s_waitcnt vmcnt(2)
    s_memtime s[52:53]
    v_dot2_f32_bf16 v44, v42, s37, v68
    v_dot2_f32_bf16 v45, v42, s57, v69
    v_dot2_f32_bf16 v46, v43, s37, v70
    v_dot2_f32_bf16 v47, v43, s57, v71
    v_bitop3_b32 v60, v42, s22, 1 bitop3:0x28
    v_cvt_pk_bf16_f32 v44, v44, v45
    v_cmp_ne_u32 vcc, 0, v60
    v_cvt_pk_bf16_f32 v45, v46, v47
    ds_write_b64 v124, v[44:45] offset:512
    s_waitcnt lgkmcnt(3)
    v_mfma_f32_16x16x32_bf16 v[32:35], v[0:3], v[48:51], 0
    v_mfma_f32_16x16x32_bf16 v[36:39], v[16:19], v[48:51], 0
    s_cbranch_vccnz main_kernel_cs_z1_f
main_kernel_cs_z_ok:
    v_mfma_f32_16x16x32_bf16 v[72:75], v[48:51], v[48:51], 0
    s_waitcnt lgkmcnt(1)
    s_sub_u32 s32, s52, s38
    v_mov_b32 v46, s32
    v_mfma_f32_16x16x32_bf16 v[32:35], v[4:7], v[52:55], v[32:35]
    buffer_load_dwordx2 v[86:87], v123, s[4:7], s19 offen offset:1024 sc1
    buffer_store_dword v46, v117, s[4:7], s46 offen sc1
    s_cmp_eq_u32 s17, 64
    s_waitcnt lgkmcnt(0)
    s_barrier
    ds_read_b64_tr_b16 v[56:57], v115 offset:16896
    ds_read_b64_tr_b16 v[58:59], v115 offset:17920
    ds_read_b64_tr_b16 v[60:61], v115 offset:18944
    ds_read_b64_tr_b16 v[62:63], v115 offset:19968
    s_cbranch_scc1 main_kernel_cs_last
    v_bfe_u32 v47, v123, 1, 7
    buffer_load_dwordx2 v[126:127], v123, s[4:7], s19 offen offset:1024 sc1
    buffer_load_dwordx4 v116, s[4:7], s27 offen offset:1024 sc1 lds
    v_mfma_f32_16x16x32_bf16 v[36:39], v[20:23], v[52:55], v[36:39]
    v_mfma_f32_16x16x32_bf16 v[72:75], v[52:55], v[52:55], v[72:75]
    s_waitcnt lgkmcnt(2)
    v_mfma_f32_16x16x32_bf16 v[72:75], v[56:59], v[56:59], v[72:75]
    v_mfma_f32_16x16x32_bf16 v[32:35], v[8:11], v[56:59], v[32:35]
    s_waitcnt lgkmcnt(0)
    v_mfma_f32_16x16x32_bf16 v[72:75], v[60:63], v[60:63], v[72:75]
    ds_read_b128 v[0:3], v113 offset:16384
    v_mfma_f32_16x16x32_bf16 v[32:35], v[12:15], v[60:63], v[32:35]
    ds_read_b128 v[16:19], v113 offset:18432
    v_mfma_f32_16x16x32_bf16 v[36:39], v[24:27], v[56:59], v[36:39]
    ds_read_b128 v[4:7], v113 offset:17408
    s_nop 0
    v_permlane32_swap_b32 v72, v73
    v_permlane32_swap_b32 v74, v75
    v_mfma_f32_16x16x32_bf16 v[36:39], v[28:31], v[60:63], v[36:39]
    ds_read_b128 v[20:23], v113 offset:19456
    v_mul_f32 v73, s30, v73
    v_mul_f32 v75, s30, v75
    v_exp_f32 v32, v32
    ds_read_b128 v[8:11], v113 offset:24576
    v_exp_f32 v33, v33
    ds_read_b128 v[12:15], v113 offset:25600
    v_exp_f32 v73, v73
    ds_read_b128 v[24:27], v113 offset:26624
    v_exp_f32 v75, v75
    ds_read_b128 v[28:31], v113 offset:27648
    v_exp_f32 v34, v34
    v_cvt_pk_bf16_f32 v72, v73, v75
    v_cvt_pk_bf16_f32 v73, v73, v75
    v_exp_f32 v35, v35
    s_waitcnt vmcnt(4)
    v_mfma_f32_16x16x16_bf16 v[40:43], v[100:101], v[72:73], 0
    v_exp_f32 v36, v36
    v_cvt_pk_bf16_f32 v32, v32, v33
    v_exp_f32 v37, v37
    v_cvt_pk_bf16_f32 v33, v34, v35
    v_exp_f32 v38, v38
    v_exp_f32 v39, v39
    v_cvt_pk_bf16_f32 v34, v36, v37
    v_cvt_pk_bf16_f32 v35, v38, v39
    s_nop 1
    v_mfma_f32_16x16x32_bf16 v[40:43], v[96:99], v[32:35], v[40:43]
    v_mfma_f32_16x16x32_bf16 v[64:67], v[88:91], v[32:35], 0
    v_mfma_f32_16x16x32_bf16 v[68:71], v[92:95], v[32:35], 0
    s_waitcnt vmcnt(3)
main_kernel_cs_v_ok:
    v_bitop3_b32 v44, v86, s22, 1 bitop3:0x28
    v_swap_b32 v85, v86
    v_cmp_ne_u32 vcc, 0, v44
main_kernel_cs_d_ok:
    s_nop 0
    v_mfma_f32_16x16x16_bf16 v[64:67], v[84:85], v[72:73], v[64:67]
    v_mfma_f32_16x16x16_bf16 v[68:71], v[86:87], v[72:73], v[68:71]
    s_cbranch_vccnz main_kernel_cs_v_f
    v_rcp_f32 v42, v40
    v_subrev_u32 v41, 0x21800000, v41
    v_cmp_lt_u32 vcc, 0x3c000000, v41
    s_nop 0
    v_pk_mul_f32 v[64:65], v[64:65], v[42:43] op_sel_hi:[1,0]
    v_pk_mul_f32 v[66:67], v[66:67], v[42:43] op_sel_hi:[1,0]
    v_cvt_pk_bf16_f32 v44, v64, v65
    v_pk_mul_f32 v[68:69], v[68:69], v[42:43] op_sel_hi:[1,0]
    v_cvt_pk_bf16_f32 v45, v66, v67
    v_pk_mul_f32 v[70:71], v[70:71], v[42:43] op_sel_hi:[1,0]
    v_cvt_pk_bf16_f32 v46, v68, v69
    v_cvt_pk_bf16_f32 v47, v70, v71
    ds_write_b128 v118, v[44:47]
    s_and_b64 s[42:43], vcc, s[44:45]
    s_cbranch_scc1 main_kernel_cs_d_f
    s_mov_b64 s[44:45], s[0:1]
    v_mov_b32 v64, 0
    v_mov_b32 v65, 0
    v_mov_b32 v66, 0
    v_mov_b32 v67, 0
    v_mov_b32 v68, 0
    v_mov_b32 v69, 0
    v_mov_b32 v70, 0
    v_mov_b32 v71, 0
    v_bfe_u32 v90, v123, 1, 7
    s_xor_b32 s23, s23, 0x80000
    s_waitcnt lgkmcnt(0)
    s_barrier
    ds_read_b128 v[56:59], v114 offset:1024
    ds_read_b128 v[60:63], v114 offset:1536
    ds_read_b128 v[48:51], v114 offset:0
    ds_read_b128 v[52:55], v114 offset:512
    s_xor_b32 s18, s18, 0x100000
    s_xor_b32 s19, s18, 0x80000
    s_xor_b32 s25, s25, 0x4000
    s_add_u32 s27, s27, 0x40000
    v_add_u32 v121, 4, v121
    v_xor_b32 v112, 0x4000, v112
    s_xor_b32 s36, s36, 0x4000
    s_mov_b32 m0, 0
    s_mov_b32 s54, s24
    s_xor_b32 s24, s24, 0x4000
    s_add_u32 s55, s25, 4096
    v_mov_b32 v89, s17
    s_mov_b32 s15, 0
    s_add_u32 s56, s19, 1536
    s_xor_b32 s9, s11, s40
    s_add_u32 s16, s20, s38
    s_waitcnt lgkmcnt(3)
    v_smfmac_f32_16x16x64_bf16 v[76:79], v[56:59], v[0:7], v110
    s_waitcnt lgkmcnt(2)
    ds_read_b128 v[0:3], v113 offset:20480
    v_smfmac_f32_16x16x64_bf16 v[76:79], v[60:63], v[8:15], v110
    s_waitcnt lgkmcnt(2)
    ds_read_b128 v[4:7], v113 offset:21504
    v_smfmac_f32_16x16x64_bf16 v[76:79], v[48:51], v[192:199], v110
    s_waitcnt lgkmcnt(2)
    ds_read_b128 v[8:11], v113 offset:28672
    v_smfmac_f32_16x16x64_bf16 v[76:79], v[52:55], v[200:207], v110
    ds_read_b128 v[12:15], v113 offset:29696
    buffer_load_dword v111, v90, s[4:7], s47 offen sc1
    v_smfmac_f32_16x16x64_bf16 v[80:83], v[56:59], v[16:23], v110
    ds_read_b128 v[16:19], v113 offset:22528
    v_smfmac_f32_16x16x64_bf16 v[80:83], v[60:63], v[24:31], v110
    ds_read_b128 v[20:23], v113 offset:23552
    v_smfmac_f32_16x16x64_bf16 v[80:83], v[48:51], v[208:215], v110
    ds_read_b128 v[24:27], v113 offset:30720
    v_cvt_pk_f16_f32 v40, v76, v77
    v_smfmac_f32_16x16x64_bf16 v[80:83], v[52:55], v[216:223], v110
    ds_read_b128 v[28:31], v113 offset:31744
    v_cvt_pk_f16_f32 v41, v78, v79
    v_smfmac_f32_16x16x64_bf16 v[64:67], v[48:51], v[224:231], v110
    v_bfi_b32 v40, 1, s22, v40
    v_smfmac_f32_16x16x64_bf16 v[64:67], v[52:55], v[232:239], v110
    s_waitcnt lgkmcnt(6)
    buffer_load_dword v111, v90, s[4:7], s47 offen sc1
    v_smfmac_f32_16x16x64_bf16 v[64:67], v[56:59], v[0:7], v110
    s_waitcnt lgkmcnt(4)
    buffer_store_dwordx2 v[40:41], v119, s[4:7], s21 offen offset:0 sc1
    v_cvt_pk_f16_f32 v42, v80, v81
    v_smfmac_f32_16x16x64_bf16 v[64:67], v[60:63], v[8:15], v110
    v_cvt_pk_f16_f32 v43, v82, v83
    v_smfmac_f32_16x16x64_bf16 v[68:71], v[48:51], v[240:247], v110
    v_bfi_b32 v42, 1, s22, v42
    v_smfmac_f32_16x16x64_bf16 v[68:71], v[52:55], v[248:255], v110
    s_waitcnt lgkmcnt(2)
    v_smfmac_f32_16x16x64_bf16 v[68:71], v[56:59], v[16:23], v110
    s_waitcnt lgkmcnt(0)
    buffer_store_dwordx2 v[42:43], v119, s[4:7], s21 offen offset:512 sc1
    v_cvt_pk_f16_f32 v44, v64, v65
    v_smfmac_f32_16x16x64_bf16 v[68:71], v[60:63], v[24:31], v110
    v_cvt_pk_f16_f32 v45, v66, v67
    v_bfi_b32 v44, 1, s22, v44
    s_cmp_lg_u32 s14, 0
    buffer_store_dwordx2 v[44:45], v119, s[4:7], s21 offen offset:1024 sc1
    s_nop 3
    v_cvt_pk_f16_f32 v46, v68, v69
    v_cvt_pk_f16_f32 v47, v70, v71
    v_bfi_b32 v46, 1, s22, v46
    buffer_store_dwordx2 v[46:47], v119, s[4:7], s21 offen offset:1536 sc1
    s_cbranch_scc1 main_kernel_cs_wx
    s_waitcnt vmcnt(5)
    s_xor_b32 s21, s21, 0x80000
main_kernel_cs_rgo:
    v_subrev_u32 v32, s20, v111
    s_memtime s[52:53]
    v_cmp_lt_u32 vcc, 0x100000, v32
    v_max_u32_dpp v32, v32, v32 row_shr:1 row_mask:0xf bank_mask:0xf
    s_nop 0
    s_nop 0
    v_max_u32_dpp v32, v32, v32 row_shr:2 row_mask:0xf bank_mask:0xf
    s_nop 0
    s_cbranch_vccnz main_kernel_cs_fsp
main_kernel_cs_fok:
    s_nop 0
    v_max_u32_dpp v32, v32, v32 row_shr:4 row_mask:0xf bank_mask:0xf
    s_memtime s[52:53]
    s_nop 0
    v_max_u32_dpp v32, v32, v32 row_shr:8 row_mask:0xf bank_mask:0xf
    s_memtime s[52:53]
    s_nop 0
    v_max_u32_dpp v32, v32, v32 row_bcast:15 row_mask:0xa bank_mask:0xf
    s_memtime s[52:53]
    s_sub_u32 s33, s52, s16
    v_readlane_b32 s32, v32, 31
    s_add_u32 s33, s33, 0x400
    s_memtime s[52:53]
    s_add_u32 s34, s16, 1650
    s_memtime s[52:53]
    s_min_u32 s32, s32, s33
    s_max_u32 s32, s32, s15
    s_add_u32 s34, s34, s32
    s_mov_b32 s35, 200
main_kernel_cs_fw:
    s_memtime s[52:53]
    s_cmp_ge_u32 s52, s34
    s_cbranch_scc1 main_kernel_cs_fgo
    s_memtime s[52:53]
    s_cmp_ge_u32 s52, s34
    s_cbranch_scc1 main_kernel_cs_fgo
    s_memtime s[52:53]
    s_cmp_ge_u32 s52, s34
    s_cbranch_scc1 main_kernel_cs_fgo
    s_memtime s[52:53]
    s_cmp_ge_u32 s52, s34
    s_cbranch_scc1 main_kernel_cs_fgo
    s_memtime s[52:53]
    s_cmp_ge_u32 s52, s34
    s_cbranch_scc1 main_kernel_cs_fgo
    s_memtime s[52:53]
    s_cmp_ge_u32 s52, s34
    s_cbranch_scc1 main_kernel_cs_fgo
    s_memtime s[52:53]
    s_cmp_ge_u32 s52, s34
    s_cbranch_scc1 main_kernel_cs_fgo
    s_memtime s[52:53]
    s_cmp_ge_u32 s52, s34
    s_cbranch_scc1 main_kernel_cs_fgo
    s_sub_u32 s35, s35, 1
    s_cbranch_scc0 main_kernel_cs_fw
main_kernel_cs_fgo:
    buffer_load_dwordx4 v[0:3], v120, s[4:7], s23 offen sc1
    s_add_u32 s35, s23, 0x8000
    buffer_load_dwordx4 v[4:7], v120, s[4:7], s35 offen sc1
    s_add_u32 s35, s23, 0x10000
    buffer_load_dwordx4 v[8:11], v120, s[4:7], s35 offen sc1
    ds_read_b32 v33, v123 offset:20992
    s_add_u32 s35, s23, 0x18000
    buffer_load_dwordx4 v[12:15], v120, s[4:7], s35 offen sc1
    s_add_u32 s35, s23, 0x20000
    buffer_load_dwordx4 v[16:19], v120, s[4:7], s35 offen sc1
    s_add_u32 s35, s23, 0x28000
    buffer_load_dwordx4 v[20:23], v120, s[4:7], s35 offen sc1
    s_add_u32 s35, s23, 0x30000
    buffer_load_dwordx4 v[24:27], v120, s[4:7], s35 offen sc1
    s_add_u32 s35, s23, 0x38000
    buffer_load_dwordx4 v[28:31], v120, s[4:7], s35 offen sc1
    s_mov_b64 exec, 1
    s_waitcnt lgkmcnt(0)
    v_sub_u32 v33, s34, v33
    v_bfi_b32 v33, 1, s40, v33
    buffer_store_dword v33, off, s[4:7], s18 offset:1536 sc1
    v_readfirstlane_b32 s10, v33
    s_mov_b64 exec, -1
    s_waitcnt vmcnt(8)
    v_mfma_f32_16x16x32_f16 v[76:79], v[0:3], v[106:109], 0
    v_xor_b32 v36, s22, v0
    v_bitop3_b32 v36, v2, s22, v36 bitop3:0xbe
    s_waitcnt vmcnt(7)
    v_mfma_f32_16x16x32_f16 v[76:79], v[4:7], v[106:109], v[76:79]
    v_bitop3_b32 v36, v4, s22, v36 bitop3:0xbe
    v_bitop3_b32 v36, v6, s22, v36 bitop3:0xbe
    s_waitcnt vmcnt(6)
    v_mfma_f32_16x16x32_f16 v[76:79], v[8:11], v[106:109], v[76:79]
    v_bitop3_b32 v36, v8, s22, v36 bitop3:0xbe
    v_bitop3_b32 v36, v10, s22, v36 bitop3:0xbe
    s_waitcnt vmcnt(5)
    v_mfma_f32_16x16x32_f16 v[76:79], v[12:15], v[106:109], v[76:79]
    v_bitop3_b32 v36, v12, s22, v36 bitop3:0xbe
    v_bitop3_b32 v36, v14, s22, v36 bitop3:0xbe
    s_waitcnt vmcnt(4)
    v_mfma_f32_16x16x32_f16 v[76:79], v[16:19], v[106:109], v[76:79]
    v_bitop3_b32 v36, v16, s22, v36 bitop3:0xbe
    v_bitop3_b32 v36, v18, s22, v36 bitop3:0xbe
    s_waitcnt vmcnt(3)
    v_mfma_f32_16x16x32_f16 v[76:79], v[20:23], v[106:109], v[76:79]
    v_bitop3_b32 v36, v20, s22, v36 bitop3:0xbe
    v_bitop3_b32 v36, v22, s22, v36 bitop3:0xbe
    s_waitcnt vmcnt(2)
    v_mfma_f32_16x16x32_f16 v[76:79], v[24:27], v[106:109], v[76:79]
    v_bitop3_b32 v36, v24, s22, v36 bitop3:0xbe
    v_bitop3_b32 v36, v26, s22, v36 bitop3:0xbe
    s_waitcnt vmcnt(1)
    v_mfma_f32_16x16x32_f16 v[76:79], v[28:31], v[106:109], v[76:79]
    v_bitop3_b32 v36, v28, s22, v36 bitop3:0xbe
    v_bitop3_b32 v36, v30, s22, v36 bitop3:0xbe
    v_and_b32 v36, 1, v36
    v_cmp_ne_u32 vcc, 0, v36
    s_nop 3
    v_cvt_pk_bf16_f32 v126, v76, v77
    v_cvt_pk_bf16_f32 v127, v78, v79
    s_cbranch_vccnz main_kernel_cs_r_f
    buffer_store_dwordx2 v[126:127], v122, s[4:7], s24 offen sc1
    s_sub_u32 s20, s34, s38
    s_mov_b32 s3, s34
    buffer_store_dword v89, v117, s[4:7], s46 offen offset:512 sc1
    v_mov_b32 v32, -1
    v_mov_b32 v33, -1
    v_mov_b32 v64, 0
    v_mov_b32 v65, 0
    v_mov_b32 v66, 0
    v_mov_b32 v67, 0
    v_mov_b32 v68, 0
    v_mov_b32 v69, 0
    v_mov_b32 v70, 0
    v_mov_b32 v71, 0
    v_mov_b32 v96, 0
    v_mov_b32 v97, 0
    v_mov_b32 v98, 0
    v_mov_b32 v99, 0
    buffer_store_dwordx2 v[32:33], v122, s[4:7], s54 offen sc1
    s_cmp_eq_u32 s12, 0
    v_add_u32 v56, s59, v115
    s_cbranch_scc0 main_kernel_cs_vma
    ds_read_b64_tr_b16 v[80:81], v56 offset:16384
    ds_read_b64_tr_b16 v[82:83], v56 offset:17408
    s_waitcnt lgkmcnt(0)
    s_nop 15
    s_nop 15
    s_nop 5
    s_buffer_load_dword s9, s[4:7], s56 glc
    buffer_load_dword v111, v90, s[4:7], s47 offen offset:512 sc1
    buffer_load_dwordx4 v116, s[4:7], s25 offen offset:0 sc1 lds
    buffer_load_dwordx4 v116, s[4:7], s25 offen offset:1024 sc1 lds
    buffer_load_dwordx4 v116, s[4:7], s25 offen offset:2048 sc1 lds
    buffer_load_dwordx4 v116, s[4:7], s25 offen offset:3072 sc1 lds
    s_mov_b32 m0, 4096
    s_nop 0
    buffer_load_dwordx4 v116, s[4:7], s55 offen offset:0 sc1 lds
    buffer_load_dwordx4 v116, s[4:7], s55 offen offset:1024 sc1 lds
    buffer_load_dwordx4 v116, s[4:7], s55 offen offset:2048 sc1 lds
    buffer_load_dwordx4 v116, s[4:7], s55 offen offset:3072 sc1 lds
    v_mov_b32 v34, v90
    s_mov_b32 m0, s36
    s_barrier
    ds_read_b32 v35, v123 offset:20480
    buffer_load_dwordx4 v[88:91], v116, s[4:7], s28 offen offset:0 sc1
    buffer_load_dwordx4 v[92:95], v116, s[4:7], s28 offen offset:1024 sc1
    buffer_load_dwordx4 v116, s[4:7], s27 offen offset:0 sc1 lds
    buffer_store_dwordx4 v[80:83], v125, s[4:7], s26 offen sc1
    s_branch main_kernel_cs_kva
main_kernel_cs_vma:
    v_mfma_f32_16x16x32_bf16 v[56:59], v[102:105], v[84:87], 0
    s_nop 7
    v_cvt_pk_bf16_f32 v80, v56, v57
    v_cvt_pk_bf16_f32 v81, v58, v59
    s_nop 15
    s_nop 15
    s_nop 5
    s_buffer_load_dword s9, s[4:7], s56 glc
    buffer_load_dword v111, v90, s[4:7], s47 offen offset:512 sc1
    buffer_load_dwordx4 v116, s[4:7], s25 offen offset:0 sc1 lds
    buffer_load_dwordx4 v116, s[4:7], s25 offen offset:1024 sc1 lds
    buffer_load_dwordx4 v116, s[4:7], s25 offen offset:2048 sc1 lds
    buffer_load_dwordx4 v116, s[4:7], s25 offen offset:3072 sc1 lds
    s_mov_b32 m0, 4096
    s_nop 0
    buffer_load_dwordx4 v116, s[4:7], s55 offen offset:0 sc1 lds
    buffer_load_dwordx4 v116, s[4:7], s55 offen offset:1024 sc1 lds
    buffer_load_dwordx4 v116, s[4:7], s55 offen offset:2048 sc1 lds
    buffer_load_dwordx4 v116, s[4:7], s55 offen offset:3072 sc1 lds
    v_mov_b32 v34, v90
    s_mov_b32 m0, s36
    s_barrier
    ds_read_b32 v35, v123 offset:20480
    buffer_load_dwordx4 v[88:91], v116, s[4:7], s28 offen offset:0 sc1
    buffer_load_dwordx4 v[92:95], v116, s[4:7], s28 offen offset:1024 sc1
    buffer_load_dwordx4 v116, s[4:7], s27 offen offset:0 sc1 lds
    buffer_store_dwordx2 v[80:81], v123, s[4:7], s26 offen sc1
main_kernel_cs_kva:
    s_add_u32 s26, s26, 0x10000
    s_waitcnt vmcnt(12)
    v_cmp_gt_i32 vcc, s17, v111
    v_readfirstlane_b32 s38, v35
    s_cbranch_vccnz main_kernel_cs_mc_f
    s_waitcnt vmcnt(4)
    s_branch main_kernel_cs_top
main_kernel_cs_wx:
    s_cmp_lg_u32 s14, 1
    s_cbranch_scc1 main_kernel_cs_wy
    s_memrealtime s[32:33]
    s_nop 0
    s_nop 0
    s_memrealtime s[32:33]
    s_nop 0
    s_nop 0
    s_memrealtime s[32:33]
    s_nop 0
    s_nop 0
    s_memrealtime s[32:33]
    s_nop 0
    s_nop 0
    s_memrealtime s[32:33]
    s_nop 0
    s_nop 0
    s_memrealtime s[32:33]
    s_nop 0
    s_nop 0
    s_memrealtime s[32:33]
    s_nop 0
    s_nop 0
    s_memrealtime s[32:33]
    s_nop 0
    s_nop 0
    s_memrealtime s[32:33]
    s_nop 0
    s_nop 0
    s_memrealtime s[32:33]
    s_nop 0
    s_nop 0
    s_memrealtime s[32:33]
    s_nop 0
    s_nop 0
    s_memrealtime s[32:33]
    s_nop 0
    s_nop 0
    s_mov_b32 s34, s32
    s_memrealtime s[32:33]
    s_cmp_lg_u32 s32, s34
    s_cbranch_scc1 main_kernel_cs_e1
    s_memrealtime s[32:33]
    s_cmp_lg_u32 s32, s34
    s_cbranch_scc1 main_kernel_cs_e1
    s_memrealtime s[32:33]
    s_cmp_lg_u32 s32, s34
    s_cbranch_scc1 main_kernel_cs_e1
    s_memrealtime s[32:33]
    s_cmp_lg_u32 s32, s34
    s_cbranch_scc1 main_kernel_cs_e1
    s_memrealtime s[32:33]
    s_cmp_lg_u32 s32, s34
    s_cbranch_scc1 main_kernel_cs_e1
    s_memrealtime s[32:33]
    s_cmp_lg_u32 s32, s34
    s_cbranch_scc1 main_kernel_cs_e1
    s_memrealtime s[32:33]
    s_cmp_lg_u32 s32, s34
    s_cbranch_scc1 main_kernel_cs_e1
    s_memrealtime s[32:33]
    s_cmp_lg_u32 s32, s34
    s_cbranch_scc1 main_kernel_cs_e1
    s_memrealtime s[32:33]
    s_cmp_lg_u32 s32, s34
    s_cbranch_scc1 main_kernel_cs_e1
    s_memrealtime s[32:33]
    s_cmp_lg_u32 s32, s34
    s_cbranch_scc1 main_kernel_cs_e1
    s_memrealtime s[32:33]
    s_cmp_lg_u32 s32, s34
    s_cbranch_scc1 main_kernel_cs_e1
    s_memrealtime s[32:33]
    s_cmp_lg_u32 s32, s34
    s_cbranch_scc1 main_kernel_cs_e1
main_kernel_cs_e1:
    s_memtime s[52:53]
    s_mul_i32 s34, s32, 22
    s_waitcnt lgkmcnt(0)
    s_sub_u32 s32, s52, s34
    s_sub_u32 s33, s32, s38
    s_ashr_i32 s34, s33, 1
    s_add_u32 s34, s34, s32
    v_mov_b32 v34, s34
    v_mov_b32 v33, s32
    ds_write2st64_b32 v123, v33, v34 offset0:80 offset1:82
    v_add_u32 v37, s33, v34
main_kernel_cs_wy:
    s_xor_b32 s21, s21, 0x80000
    v_mov_b32 v64, 0
    v_mov_b32 v65, 0
    v_mov_b32 v66, 0
    v_mov_b32 v67, 0
    v_mov_b32 v68, 0
    v_mov_b32 v69, 0
    v_mov_b32 v70, 0
    v_mov_b32 v71, 0
    v_mov_b32 v96, 0
    v_mov_b32 v97, 0
    v_mov_b32 v98, 0
    v_mov_b32 v99, 0
    s_cmp_eq_u32 s12, 0
    v_add_u32 v56, s59, v115
    s_cbranch_scc0 main_kernel_cs_vmb
    ds_read_b64_tr_b16 v[80:81], v56 offset:16384
    ds_read_b64_tr_b16 v[82:83], v56 offset:17408
    s_waitcnt lgkmcnt(0)
    s_waitcnt vmcnt(0)
    s_mov_b32 m0, s36
    s_barrier
    ds_read_b32 v35, v123 offset:20480
    ds_write_b32 v124, v37 offset:3584
    buffer_load_dwordx4 v[88:91], v116, s[4:7], s28 offen offset:0 sc1
    buffer_load_dwordx4 v[92:95], v116, s[4:7], s28 offen offset:1024 sc1
    buffer_load_dwordx4 v116, s[4:7], s27 offen offset:0 sc1 lds
    buffer_store_dwordx4 v[80:83], v125, s[4:7], s26 offen sc1
    s_branch main_kernel_cs_kvb
main_kernel_cs_vmb:
    v_mfma_f32_16x16x32_bf16 v[56:59], v[102:105], v[84:87], 0
    s_nop 7
    v_cvt_pk_bf16_f32 v80, v56, v57
    v_cvt_pk_bf16_f32 v81, v58, v59
    s_waitcnt vmcnt(0)
    s_mov_b32 m0, s36
    s_barrier
    ds_read_b32 v35, v123 offset:20480
    ds_write_b32 v124, v37 offset:3584
    buffer_load_dwordx4 v[88:91], v116, s[4:7], s28 offen offset:0 sc1
    buffer_load_dwordx4 v[92:95], v116, s[4:7], s28 offen offset:1024 sc1
    buffer_load_dwordx4 v116, s[4:7], s27 offen offset:0 sc1 lds
    buffer_store_dwordx2 v[80:81], v123, s[4:7], s26 offen sc1
main_kernel_cs_kvb:
    s_add_u32 s26, s26, 0x10000
    s_mov_b64 exec, 1
    buffer_store_dword v100, off, s[4:7], s39 sc1
    s_mov_b64 exec, -1
    s_add_u32 s39, s39, 4
    s_waitcnt lgkmcnt(0)
    v_readfirstlane_b32 s38, v35
    v_mov_b32 v35, 0
    v_mov_b32 v35, 0
    v_mov_b32 v35, 0
    v_mov_b32 v35, 0
    v_mov_b32 v35, 0
    v_mov_b32 v35, 0
main_kernel_cs_end:
    s_branch main_kernel_cs_top
main_kernel_cs_mc_f:
    s_mov_b32 m0, 0
    s_sub_u32 s29, s29, 1
    s_cbranch_scc1 main_kernel_end
    buffer_load_dword v111, v34, s[4:7], s47 offen offset:512 sc1
    buffer_load_dwordx4 v116, s[4:7], s25 offen offset:0 sc1 lds
    buffer_load_dwordx4 v116, s[4:7], s25 offen offset:1024 sc1 lds
    buffer_load_dwordx4 v116, s[4:7], s25 offen offset:2048 sc1 lds
    buffer_load_dwordx4 v116, s[4:7], s25 offen offset:3072 sc1 lds
    s_mov_b32 m0, 4096
    s_nop 0
    buffer_load_dwordx4 v116, s[4:7], s55 offen offset:0 sc1 lds
    buffer_load_dwordx4 v116, s[4:7], s55 offen offset:1024 sc1 lds
    buffer_load_dwordx4 v116, s[4:7], s55 offen offset:2048 sc1 lds
    buffer_load_dwordx4 v116, s[4:7], s55 offen offset:3072 sc1 lds
    s_waitcnt vmcnt(8)
    v_cmp_gt_i32 vcc, s17, v111
    v_readfirstlane_b32 s38, v35
    s_cbranch_vccnz main_kernel_cs_mc_f
    s_waitcnt vmcnt(0)
    s_branch main_kernel_cs_end
main_kernel_cs_t_w:
    s_mov_b32 s35, 200
main_kernel_cs_t_s:
    s_memtime s[52:53]
    s_cmp_ge_u32 s52, s34
    s_cbranch_scc1 main_kernel_cs_t_go
    s_memtime s[52:53]
    s_cmp_ge_u32 s52, s34
    s_cbranch_scc1 main_kernel_cs_t_go
    s_memtime s[52:53]
    s_cmp_ge_u32 s52, s34
    s_cbranch_scc1 main_kernel_cs_t_go
    s_memtime s[52:53]
    s_cmp_ge_u32 s52, s34
    s_cbranch_scc1 main_kernel_cs_t_go
    s_memtime s[52:53]
    s_cmp_ge_u32 s52, s34
    s_cbranch_scc1 main_kernel_cs_t_go
    s_memtime s[52:53]
    s_cmp_ge_u32 s52, s34
    s_cbranch_scc1 main_kernel_cs_t_go
    s_memtime s[52:53]
    s_cmp_ge_u32 s52, s34
    s_cbranch_scc1 main_kernel_cs_t_go
    s_memtime s[52:53]
    s_cmp_ge_u32 s52, s34
    s_cbranch_scc1 main_kernel_cs_t_go
    s_sub_u32 s35, s35, 1
    s_cbranch_scc0 main_kernel_cs_t_s
    s_branch main_kernel_cs_t_go
main_kernel_cs_t_p:
    s_waitcnt lgkmcnt(0)
    s_xor_b32 s32, s9, s22
    s_bitcmp1_b32 s32, 0
    s_cbranch_scc0 main_kernel_cs_t_ok
    s_buffer_load_dword s9, s[4:7], s56 glc
    s_sub_u32 s29, s29, 1
    s_cbranch_scc1 main_kernel_end
    s_branch main_kernel_cs_t_p
main_kernel_cs_z0_f:
    buffer_load_dwordx2 v[126:127], v123, s[4:7], s19 offen offset:0 sc1
    s_sub_u32 s29, s29, 1
    s_cbranch_scc1 main_kernel_end
    s_waitcnt vmcnt(0)
    s_branch main_kernel_cs_z0
main_kernel_cs_z2_f:
    buffer_load_dwordx2 v[64:65], v123, s[4:7], s19 offen offset:512 sc1
    s_sub_u32 s29, s29, 1
    s_cbranch_scc1 main_kernel_end
    s_waitcnt vmcnt(0)
main_kernel_cs_z1_f:
    s_waitcnt vmcnt(0)
    s_memtime s[52:53]
    v_dot2_f32_bf16 v44, v64, s37, v68
    v_dot2_f32_bf16 v45, v64, s57, v69
    v_dot2_f32_bf16 v46, v65, s37, v70
    v_dot2_f32_bf16 v47, v65, s57, v71
    v_bitop3_b32 v60, v64, s22, 1 bitop3:0x28
    v_cvt_pk_bf16_f32 v44, v44, v45
    v_cmp_ne_u32 vcc, 0, v60
    v_cvt_pk_bf16_f32 v45, v46, v47
    ds_write_b64 v124, v[44:45] offset:512
    s_cbranch_vccnz main_kernel_cs_z2_f
    s_branch main_kernel_cs_z_ok
main_kernel_cs_kvw:
    s_cmp_eq_u32 s17, 64
    s_cbranch_scc1 main_kernel_cs_kvok
    s_waitcnt vmcnt(0)
    s_mov_b32 exec_lo, 0
    s_mov_b32 exec_hi, 0x3f00
    v_subrev_u32 v127, 0, v121
main_kernel_cs_kvp:
    buffer_load_dword v126, v127, s[4:7], 0 offen sc1
    s_waitcnt vmcnt(0)
    v_cmp_eq_u32 vcc, 0, v126
    s_cbranch_vccz main_kernel_cs_kvp_ok
    s_sleep 2
    s_sub_u32 s29, s29, 1
    s_cbranch_scc0 main_kernel_cs_kvp
    s_branch main_kernel_end
main_kernel_cs_kvp_ok:
    s_mov_b64 exec, -1
    s_branch main_kernel_cs_kvok
main_kernel_cs_last:
    buffer_load_dwordx2 v[86:87], v123, s[4:7], s19 offen offset:1024 sc1
    s_sub_u32 s29, s29, 1
    s_cbranch_scc1 main_kernel_end
    s_waitcnt vmcnt(0) lgkmcnt(0)
    v_bitop3_b32 v44, v86, s22, 1 bitop3:0x28
    v_cmp_ne_u32 vcc, 0, v44
    s_cbranch_vccnz main_kernel_cs_last
    v_swap_b32 v85, v86
    s_cmp_eq_u32 s12, 0
    v_add_u32 v56, s59, v115
    s_cbranch_scc0 main_kernel_cs_vmc
    ds_read_b64_tr_b16 v[80:81], v56 offset:16384
    ds_read_b64_tr_b16 v[82:83], v56 offset:17408
    s_waitcnt lgkmcnt(0)
    buffer_store_dwordx4 v[80:83], v125, s[4:7], s26 offen sc1
    s_branch main_kernel_cs_kvc
main_kernel_cs_vmc:
    v_mfma_f32_16x16x32_bf16 v[56:59], v[102:105], v[84:87], 0
    s_nop 7
    v_cvt_pk_bf16_f32 v80, v56, v57
    v_cvt_pk_bf16_f32 v81, v58, v59
    buffer_store_dwordx2 v[80:81], v123, s[4:7], s26 offen sc1
main_kernel_cs_kvc:
    s_add_u32 s26, s26, 0x10000
    s_branch main_kernel_end
main_kernel_cs_m_f:
main_kernel_cs_m_t:
    ds_read_b128 v[0:3], v116 offset:0
    ds_read_b128 v[4:7], v116 offset:1024
    ds_read_b128 v[8:11], v116 offset:2048
    ds_read_b128 v[12:15], v116 offset:3072
    ds_read_b128 v[16:19], v116 offset:4096
    ds_read_b128 v[20:23], v116 offset:5120
    ds_read_b128 v[24:27], v116 offset:6144
    ds_read_b128 v[28:31], v116 offset:7168
    s_waitcnt lgkmcnt(0)
    v_max_u32 v126, v0, v2
    v_max3_u32 v126, v126, v4, v6
    v_max3_u32 v126, v126, v8, v10
    v_max3_u32 v126, v126, v12, v14
    v_max3_u32 v126, v126, v16, v18
    v_max3_u32 v126, v126, v20, v22
    v_max3_u32 v126, v126, v24, v26
    v_max3_u32 v126, v126, v28, v30
    v_cmp_eq_u32 vcc, -1, v126
    s_cbranch_vccz main_kernel_cs_m_g
    s_barrier
    s_lshl_b32 s32, s14, 11
    s_add_u32 m0, s32, 0
    s_add_u32 s32, s32, s25
    buffer_load_dwordx4 v116, s[4:7], s32 offen offset:0 sc1 lds
    buffer_load_dwordx4 v116, s[4:7], s32 offen offset:1024 sc1 lds
    s_sub_u32 s29, s29, 1
    s_cbranch_scc1 main_kernel_end
    s_waitcnt vmcnt(0)
    s_barrier
    s_branch main_kernel_cs_m_t
main_kernel_cs_m_g:
    s_mov_b64 s[44:45], 0
    v_mov_b32 v64, 0
    v_mov_b32 v65, 0
    v_mov_b32 v66, 0
    v_mov_b32 v67, 0
    v_mov_b32 v68, 0
    v_mov_b32 v69, 0
    v_mov_b32 v70, 0
    v_mov_b32 v71, 0
    v_mov_b32 v96, 0
    v_mov_b32 v97, 0
    v_mov_b32 v98, 0
    v_mov_b32 v99, 0
    s_branch main_kernel_cs_mrd
main_kernel_cs_v_f:
    v_swap_b32 v85, v86
    s_nop 7
    s_waitcnt vmcnt(1)
main_kernel_cs_v_t:
    s_memtime s[52:53]
    v_bitop3_b32 v44, v126, s22, 1 bitop3:0x28
    v_cmp_ne_u32 vcc, 0, v44
    s_sub_u32 s29, s29, 1
    s_cbranch_scc1 main_kernel_end
    s_cbranch_vccnz main_kernel_cs_v_g
    v_mfma_f32_16x16x32_bf16 v[64:67], v[88:91], v[32:35], 0
    v_mfma_f32_16x16x32_bf16 v[68:71], v[92:95], v[32:35], 0
    v_mov_b32 v86, v126
    v_mov_b32 v87, v127
    s_waitcnt lgkmcnt(0)
    s_sub_u32 s32, s52, s38
    s_add_u32 s32, s32, -550
    v_mov_b32 v46, s32
    buffer_store_dword v46, v117, s[4:7], s46 offen sc1
    s_branch main_kernel_cs_v_ok
main_kernel_cs_v_g:
    buffer_load_dwordx2 v[126:127], v123, s[4:7], s19 offen offset:1024 sc1
    s_waitcnt lgkmcnt(0)
    s_sub_u32 s32, s52, s38
    s_add_u32 s32, s32, -50
    v_mov_b32 v46, s32
    buffer_store_dword v46, v117, s[4:7], s46 offen sc1
    s_waitcnt vmcnt(0)
    s_branch main_kernel_cs_v_t
main_kernel_cs_d_f:
    s_memtime s[52:53]
    s_waitcnt vmcnt(1) lgkmcnt(0)
    s_sub_u32 s32, s52, s38
    s_add_u32 s32, s32, 300
    v_mov_b32 v46, s32
    buffer_store_dword v46, v117, s[4:7], s46 offen sc1
    ds_read_b128 v[0:3], v112 offset:0
    ds_read_b128 v[4:7], v112 offset:1024
    ds_read_b128 v[8:11], v112 offset:2048
    ds_read_b128 v[12:15], v112 offset:3072
    ds_read_b128 v[16:19], v112 offset:4096
    ds_read_b128 v[20:23], v112 offset:5120
    ds_read_b128 v[24:27], v112 offset:6144
    ds_read_b128 v[28:31], v112 offset:7168
    s_waitcnt lgkmcnt(0)
    v_mfma_f32_16x16x32_bf16 v[32:35], v[0:3], v[48:51], 0
    v_mfma_f32_16x16x32_bf16 v[36:39], v[16:19], v[48:51], 0
    v_mfma_f32_16x16x32_bf16 v[72:75], v[48:51], v[48:51], 0
    v_mfma_f32_16x16x32_bf16 v[32:35], v[4:7], v[52:55], v[32:35]
    v_mfma_f32_16x16x32_bf16 v[36:39], v[20:23], v[52:55], v[36:39]
    v_mfma_f32_16x16x32_bf16 v[72:75], v[52:55], v[52:55], v[72:75]
    v_mfma_f32_16x16x32_bf16 v[32:35], v[8:11], v[56:59], v[32:35]
    v_mfma_f32_16x16x32_bf16 v[36:39], v[24:27], v[56:59], v[36:39]
    v_mfma_f32_16x16x32_bf16 v[72:75], v[56:59], v[56:59], v[72:75]
    v_mfma_f32_16x16x32_bf16 v[32:35], v[12:15], v[60:63], v[32:35]
    v_mfma_f32_16x16x32_bf16 v[36:39], v[28:31], v[60:63], v[36:39]
    v_mfma_f32_16x16x32_bf16 v[72:75], v[60:63], v[60:63], v[72:75]
    s_nop 7
    ds_read_b128 v[0:3], v113 offset:16384
    ds_read_b128 v[16:19], v113 offset:18432
    ds_read_b128 v[4:7], v113 offset:17408
    ds_read_b128 v[20:23], v113 offset:19456
    ds_read_b128 v[8:11], v113 offset:24576
    ds_read_b128 v[24:27], v113 offset:26624
    ds_read_b128 v[12:15], v113 offset:25600
    ds_read_b128 v[28:31], v113 offset:27648
    v_permlane32_swap_b32 v72, v73
    v_permlane32_swap_b32 v74, v75
    v_mul_f32 v73, s30, v73
    v_mul_f32 v75, s30, v75
    v_max_f32 v126, v73, v75
    v_max3_f32 v126, v126, v32, v33
    v_max3_f32 v126, v126, v34, v35
    v_max3_f32 v126, v126, v36, v37
    v_max3_f32 v126, v126, v38, v39
    v_mov_b32 v127, v126
    s_nop 1
    v_permlane32_swap_b32 v126, v127
    v_max_f32 v126, v126, v127
    v_mov_b32 v127, v126
    s_nop 1
    v_permlane16_swap_b32 v126, v127
    v_max_f32 v126, v126, v127
    v_sub_f32 v32, v32, v126
    v_sub_f32 v33, v33, v126
    v_sub_f32 v34, v34, v126
    v_sub_f32 v35, v35, v126
    v_sub_f32 v36, v36, v126
    v_sub_f32 v37, v37, v126
    v_sub_f32 v38, v38, v126
    v_sub_f32 v39, v39, v126
    v_sub_f32 v73, v73, v126
    v_sub_f32 v75, v75, v126
    v_exp_f32 v32, v32
    v_exp_f32 v33, v33
    v_exp_f32 v34, v34
    v_exp_f32 v35, v35
    v_exp_f32 v36, v36
    v_exp_f32 v37, v37
    v_exp_f32 v38, v38
    v_exp_f32 v39, v39
    v_exp_f32 v73, v73
    v_exp_f32 v75, v75
    v_cvt_pk_bf16_f32 v32, v32, v33
    v_cvt_pk_bf16_f32 v33, v34, v35
    v_cvt_pk_bf16_f32 v34, v36, v37
    v_cvt_pk_bf16_f32 v35, v38, v39
    v_cvt_pk_bf16_f32 v72, v73, v75
    v_cvt_pk_bf16_f32 v73, v73, v75
    s_nop 1
    v_mfma_f32_16x16x32_bf16 v[64:67], v[88:91], v[32:35], 0
    v_mfma_f32_16x16x32_bf16 v[68:71], v[92:95], v[32:35], 0
    v_mfma_f32_16x16x32_bf16 v[40:43], v[96:99], v[32:35], 0
    v_mfma_f32_16x16x16_bf16 v[40:43], v[100:101], v[72:73], v[40:43]
    s_mov_b64 s[44:45], 0
    s_mov_b64 vcc, 0
    s_nop 7
    s_branch main_kernel_cs_d_ok
main_kernel_cs_fsp:
    s_mov_b32 s35, 40
main_kernel_cs_fsl:
    buffer_load_dword v111, v90, s[4:7], s47 offen sc1
    s_waitcnt vmcnt(1)
    v_subrev_u32 v32, s20, v111
    v_cmp_lt_u32 vcc, 0x100000, v32
    s_cbranch_vccz main_kernel_cs_rgo
    s_sub_u32 s35, s35, 1
    s_cbranch_scc0 main_kernel_cs_fsl
    v_mov_b32 v32, 0
    s_branch main_kernel_cs_fok
main_kernel_cs_r_f:
    s_memtime s[52:53]
    buffer_load_dword v111, v90, s[4:7], s47 offen sc1
    s_waitcnt lgkmcnt(0)
    s_sub_u32 s15, s52, s16
    s_add_u32 s15, s15, -1500
    s_waitcnt vmcnt(0)
    s_sub_u32 s29, s29, 1
    s_cbranch_scc1 main_kernel_end
    s_branch main_kernel_cs_rgo
main_kernel_att:
    s_cmp_gt_u32 s13, 1
    s_cbranch_scc1 main_kernel_p_end
    s_cmp_lg_u32 s14, 0
    s_cbranch_scc1 main_kernel_p_bar
    s_lshl_b32 s32, s13, 21
    s_add_u32 s32, s32, 0x8c00000
    v_lshlrev_b32 v2, 2, v250
    v_mov_b32 v3, -1
    s_mov_b64 s[20:21], -1
    s_mov_b32 s34, 12
    s_mov_b32 exec_hi, 0
    s_waitcnt vmcnt(0)
main_kernel_p_lp:
    s_memtime s[16:17]
    s_waitcnt lgkmcnt(0)
    buffer_store_dword v3, v2, s[4:7], s32 offen sc1
    s_waitcnt vmcnt(0)
    s_memtime s[18:19]
    s_xor_b32 s32, s32, 0x2000
    s_waitcnt lgkmcnt(0)
    s_sub_u32 s33, s18, s16
    s_min_u32 s20, s20, s33
    s_memtime s[16:17]
    s_waitcnt lgkmcnt(0)
    buffer_store_dword v3, v2, s[4:7], s32 offen sc1
    s_waitcnt vmcnt(0)
    s_memtime s[18:19]
    s_xor_b32 s32, s32, 0x2000
    s_waitcnt lgkmcnt(0)
    s_sub_u32 s33, s18, s16
    s_min_u32 s21, s21, s33
    s_add_u32 s32, s32, 128
    s_sub_u32 s34, s34, 1
    s_cmp_lg_u32 s34, 0
    s_cbranch_scc1 main_kernel_p_lp
    s_cmp_lt_u32 s21, s20
    s_cselect_b32 s32, 3, 2
    s_lshl_b32 s33, s13, 2
    v_mov_b32 v3, s32
    s_mov_b64 exec, 1
    buffer_store_dword v3, off, s[60:63], s33 offset:16 sc1
    s_mov_b64 exec, -1
main_kernel_p_bar:
    s_barrier
main_kernel_p_end:
    v_lshlrev_b32 v0, 2, v250
    s_mov_b32 s32, 0x841f000
main_kernel_awf:
    buffer_load_dword v2, v0, s[4:7], s32 offen sc1
    s_waitcnt vmcnt(0)
    v_cmp_eq_u32 vcc, 0, v2
    s_cbranch_vccz main_kernel_awf_ok
    s_sleep 4
    s_sub_u32 s29, s29, 1
    s_cbranch_scc0 main_kernel_awf
    s_branch main_kernel_end
main_kernel_awf_ok:
main_kernel_att2:
    s_lshl_b32 s28, s13, 1
    s_lshr_b32 s31, s14, 1
    s_add_u32 s28, s28, s31
    s_and_b32 s30, s14, 1
    v_lshlrev_b32 v204, 4, v250
    v_and_b32 v200, 15, v250
    v_lshrrev_b32 v201, 4, v250
    v_and_b32 v202, 7, v250
    v_lshl_add_u32 v202, v201, 3, v202
    v_lshlrev_b32 v205, 4, v202
    v_bfe_u32 v206, v204, 1, 8
    v_min_u32 v207, 2, v250
    v_lshlrev_b32 v207, 13, v207
    s_lshl_b32 s31, s28, 8
    s_sub_u32 s31, 80912, s31
    s_cmp_eq_u32 s12, 7
    s_cselect_b32 s25, 61, 0
    s_cselect_b32 s32, 16, 0
    s_sub_u32 s31, s31, s32
    s_mov_b64 exec, 0xf0
    v_lshl_add_u32 v207, v250, 8, s31
    s_mov_b64 exec, -1
    v_mov_b32 v208, 1
    v_mov_b32 v209, 0
    s_lshl_b32 s31, s30, 4
    v_add_u32 v200, s31, v200
    v_lshlrev_b32 v202, 2, v201
    v_sub_u32 v200, v200, v202
    v_mov_b32 v202, 0xf149f2ca
    v_cmp_le_i32 vcc, 0, v200
    s_nop 1
    v_cndmask_b32 v124, v202, 0, vcc
    v_cmp_le_i32 vcc, 1, v200
    s_nop 1
    v_cndmask_b32 v125, v202, 0, vcc
    v_cmp_le_i32 vcc, 2, v200
    s_nop 1
    v_cndmask_b32 v126, v202, 0, vcc
    v_cmp_le_i32 vcc, 3, v200
    s_nop 1
    v_cndmask_b32 v127, v202, 0, vcc
    v_cmp_le_i32 vcc, 16, v200
    s_nop 1
    v_cndmask_b32 v128, v202, 0, vcc
    v_cmp_le_i32 vcc, 17, v200
    s_nop 1
    v_cndmask_b32 v129, v202, 0, vcc
    v_cmp_le_i32 vcc, 18, v200
    s_nop 1
    v_cndmask_b32 v130, v202, 0, vcc
    v_cmp_le_i32 vcc, 19, v200
    s_nop 1
    v_cndmask_b32 v131, v202, 0, vcc
    v_cmp_le_u32 vcc, 2, v201
    s_nop 1
    v_cndmask_b32 v132, v202, 0, vcc
    v_mov_b32 v180, 0x3f803f80
    v_cndmask_b32 v133, v202, 0, vcc
    v_mov_b32 v181, 0x3f803f80
    v_cndmask_b32 v134, v202, 0, vcc
    v_mov_b32 v182, 0x3f803f80
    v_cndmask_b32 v135, v202, 0, vcc
    v_mov_b32 v183, 0x3f803f80
    s_mov_b32 s26, 0x3e0293ee
    s_mov_b32 s27, 0xbe0293ee
    s_lshl_b32 s31, s28, 12
    s_add_u32 s16, s31, 0x1800000
    s_add_u32 s17, s16, 131072
    s_lshl_b32 s32, s30, 17
    s_add_u32 s31, s31, s32
    s_add_u32 s15, s31, 0x800000
    s_add_u32 s22, s31, 0x3800000
    s_lshl_b32 s31, s28, 13
    s_add_u32 s18, s31, 0x2800000
    s_add_u32 s19, s18, 4096
    s_lshl_b32 s31, s28, 11
    s_add_u32 s20, s31, 0x8000000
    s_add_u32 s21, s31, 0x6e00000
    s_lshl_b32 s31, s28, 8
    s_add_u32 s23, s31, 0x8404000
    s_lshl_b32 s31, s28, 3
    s_lshl_b32 s32, s30, 2
    s_add_u32 s31, s31, s32
    s_add_u32 s24, s31, 0x8400000
    v_and_b32 v210, 3, v250
    s_mov_b32 s39, 0
    v_lshlrev_b32 v210, 2, v210
    s_mov_b32 s33, 0x841ec00
    s_lshl_b32 s31, s25, 18
    s_add_u32 s15, s15, s31
    s_add_u32 s16, s16, s31
    s_add_u32 s17, s17, s31
    s_add_u32 s18, s18, s31
    s_add_u32 s19, s19, s31
    s_add_u32 s22, s22, s31
    s_lshl_b32 s31, s25, 16
    s_add_u32 s20, s20, s31
    s_add_u32 s21, s21, s31
    s_lshl_b32 s31, s25, 8
    s_add_u32 s24, s24, s31
    s_lshl_b32 s31, s25, 2
    s_add_u32 s23, s23, s31
    s_add_u32 s33, s33, s31
    s_cmp_lg_u32 s25, 0
    s_cbranch_scc1 main_kernel_a_npf
    s_cmp_lt_u32 s13, 14
    s_cbranch_scc0 main_kernel_a_pf4
    s_mov_b32 s8, s68
    s_and_b32 s9, s69, 0xffff
    s_mov_b32 s10, 0x700000
    s_mov_b32 s11, 0x20000
    s_lshl_b32 s31, s13, 19
    s_branch main_kernel_a_pfg
main_kernel_a_pf4:
    s_mov_b32 s8, s70
    s_and_b32 s9, s71, 0xffff
    s_mov_b32 s10, 0x700000
    s_mov_b32 s11, 0x20000
    s_sub_u32 s31, s13, 2
    s_lshl_b32 s31, s31, 19
main_kernel_a_pfg:
    s_lshl_b32 s32, s14, 17
    s_add_u32 s31, s31, s32
    v_lshlrev_b32 v200, 7, v250
    buffer_load_dword v0, v200, s[8:11], s31 offen
    s_add_u32 s31, s31, 8192
    buffer_load_dword v0, v200, s[8:11], s31 offen
    s_add_u32 s31, s31, 8192
    buffer_load_dword v0, v200, s[8:11], s31 offen
    s_add_u32 s31, s31, 8192
    buffer_load_dword v0, v200, s[8:11], s31 offen
    s_add_u32 s31, s31, 8192
    buffer_load_dword v0, v200, s[8:11], s31 offen
    s_add_u32 s31, s31, 8192
    buffer_load_dword v0, v200, s[8:11], s31 offen
    s_add_u32 s31, s31, 8192
    buffer_load_dword v0, v200, s[8:11], s31 offen
    s_add_u32 s31, s31, 8192
    buffer_load_dword v0, v200, s[8:11], s31 offen
    s_add_u32 s31, s31, 8192
    buffer_load_dword v0, v200, s[8:11], s31 offen
    s_add_u32 s31, s31, 8192
    buffer_load_dword v0, v200, s[8:11], s31 offen
    s_add_u32 s31, s31, 8192
    buffer_load_dword v0, v200, s[8:11], s31 offen
    s_add_u32 s31, s31, 8192
    buffer_load_dword v0, v200, s[8:11], s31 offen
    s_add_u32 s31, s31, 8192
    buffer_load_dword v0, v200, s[8:11], s31 offen
    s_add_u32 s31, s31, 8192
    buffer_load_dword v0, v200, s[8:11], s31 offen
    s_add_u32 s31, s31, 8192
    buffer_load_dword v0, v200, s[8:11], s31 offen
    s_add_u32 s31, s31, 8192
    buffer_load_dword v0, v200, s[8:11], s31 offen
    s_add_u32 s31, s31, 8192
    s_mov_b32 s8, s70
    s_and_b32 s9, s71, 0xffff
    s_mov_b32 s10, 0x700000
    s_mov_b32 s11, 0x20000
    s_sub_u32 s31, s13, 0
    s_lshl_b32 s31, s31, 19
    s_cmp_ge_u32 s13, 12
    s_cbranch_scc1 main_kernel_a_npf
    s_lshl_b32 s32, s14, 17
    s_add_u32 s31, s31, s32
    v_lshlrev_b32 v200, 7, v250
    buffer_load_dword v0, v200, s[8:11], s31 offen
    s_add_u32 s31, s31, 8192
    buffer_load_dword v0, v200, s[8:11], s31 offen
    s_add_u32 s31, s31, 8192
    buffer_load_dword v0, v200, s[8:11], s31 offen
    s_add_u32 s31, s31, 8192
    buffer_load_dword v0, v200, s[8:11], s31 offen
    s_add_u32 s31, s31, 8192
    buffer_load_dword v0, v200, s[8:11], s31 offen
    s_add_u32 s31, s31, 8192
    buffer_load_dword v0, v200, s[8:11], s31 offen
    s_add_u32 s31, s31, 8192
    buffer_load_dword v0, v200, s[8:11], s31 offen
    s_add_u32 s31, s31, 8192
    buffer_load_dword v0, v200, s[8:11], s31 offen
    s_add_u32 s31, s31, 8192
    buffer_load_dword v0, v200, s[8:11], s31 offen
    s_add_u32 s31, s31, 8192
    buffer_load_dword v0, v200, s[8:11], s31 offen
    s_add_u32 s31, s31, 8192
    buffer_load_dword v0, v200, s[8:11], s31 offen
    s_add_u32 s31, s31, 8192
    buffer_load_dword v0, v200, s[8:11], s31 offen
    s_add_u32 s31, s31, 8192
    buffer_load_dword v0, v200, s[8:11], s31 offen
    s_add_u32 s31, s31, 8192
    buffer_load_dword v0, v200, s[8:11], s31 offen
    s_add_u32 s31, s31, 8192
    buffer_load_dword v0, v200, s[8:11], s31 offen
    s_add_u32 s31, s31, 8192
    buffer_load_dword v0, v200, s[8:11], s31 offen
    s_add_u32 s31, s31, 8192
    s_waitcnt vmcnt(0)
main_kernel_a_npf:
    s_cmp_eq_u32 s25, 0
    s_cbranch_scc1 main_kernel_a_fp
    s_sub_u32 s32, s24, 1280
main_kernel_a_gp:
    buffer_load_dword v200, v209, s[4:7], s32 offen sc1
    s_waitcnt vmcnt(0)
    v_cmp_eq_u32 vcc, 0, v200
    s_and_b32 s31, vcc_lo, 1
    s_cbranch_scc0 main_kernel_a_fp
    s_sleep 32
    s_sub_u32 s29, s29, 1
    s_cbranch_scc0 main_kernel_a_gp
    s_branch main_kernel_end
main_kernel_a_fp:
    buffer_load_dword v200, v207, s[4:7], s23 offen sc1
    s_waitcnt vmcnt(0)
    v_cmp_eq_u32 vcc, 0, v200
    s_and_b32 s31, vcc_lo, -1
    s_cbranch_scc0 main_kernel_a_fok
    s_sleep 8
    s_sub_u32 s29, s29, 1
    s_cbranch_scc0 main_kernel_a_fp
    s_branch main_kernel_end
main_kernel_a_fok:
    buffer_load_dwordx4 v[0:3], v204, s[4:7], s15 offen offset:0 sc1
    buffer_load_dwordx4 v[16:19], v204, s[4:7], s16 offen offset:0 sc1
    buffer_load_dwordx4 v[32:35], v204, s[4:7], s17 offen offset:0 sc1
    buffer_load_dwordx4 v[4:7], v204, s[4:7], s15 offen offset:1024 sc1
    buffer_load_dwordx4 v[20:23], v204, s[4:7], s16 offen offset:1024 sc1
    buffer_load_dwordx4 v[36:39], v204, s[4:7], s17 offen offset:1024 sc1
    buffer_load_dwordx4 v[8:11], v204, s[4:7], s15 offen offset:2048 sc1
    buffer_load_dwordx4 v[24:27], v204, s[4:7], s16 offen offset:2048 sc1
    buffer_load_dwordx4 v[40:43], v204, s[4:7], s17 offen offset:2048 sc1
    buffer_load_dwordx4 v[12:15], v204, s[4:7], s15 offen offset:3072 sc1
    buffer_load_dwordx4 v[28:31], v204, s[4:7], s16 offen offset:3072 sc1
    buffer_load_dwordx4 v[44:47], v204, s[4:7], s17 offen offset:3072 sc1
    buffer_load_dword v211, v210, s[4:7], s33 offen sc1
    buffer_load_dwordx4 v[48:51], v204, s[4:7], s18 offen offset:0 sc1
    buffer_load_dwordx4 v[52:55], v204, s[4:7], s18 offen offset:1024 sc1
    buffer_load_dwordx4 v[56:59], v204, s[4:7], s18 offen offset:2048 sc1
    buffer_load_dwordx4 v[60:63], v204, s[4:7], s18 offen offset:3072 sc1
    buffer_load_dwordx4 v[64:67], v204, s[4:7], s19 offen offset:0 sc1
    buffer_load_dwordx4 v[68:71], v204, s[4:7], s19 offen offset:1024 sc1
    buffer_load_dwordx4 v[72:75], v204, s[4:7], s19 offen offset:2048 sc1
    buffer_load_dwordx4 v[76:79], v204, s[4:7], s19 offen offset:3072 sc1
    s_waitcnt vmcnt(0)
main_kernel_a_top:
    s_cmp_ge_u32 s25, 60
    s_cselect_b32 s38, 2, 1
    s_lshl_b32 s34, s38, 18
    s_lshl_b32 s35, s38, 16
    s_lshl_b32 s36, s38, 8
    s_lshl_b32 s37, s38, 2
    s_waitcnt vmcnt(19)
    v_mfma_f32_16x16x32_bf16 v[112:115], v[16:19], v[0:3], v[124:127]
    v_mfma_f32_16x16x32_bf16 v[116:119], v[32:35], v[0:3], v[128:131]
    s_waitcnt vmcnt(16)
    v_mfma_f32_16x16x32_bf16 v[112:115], v[20:23], v[4:7], v[112:115]
    v_mfma_f32_16x16x32_bf16 v[116:119], v[36:39], v[4:7], v[116:119]
    s_waitcnt vmcnt(13)
    v_mfma_f32_16x16x32_bf16 v[112:115], v[24:27], v[8:11], v[112:115]
    v_mfma_f32_16x16x32_bf16 v[116:119], v[40:43], v[8:11], v[116:119]
    s_waitcnt vmcnt(10)
    v_mfma_f32_16x16x32_bf16 v[112:115], v[28:31], v[12:15], v[112:115]
    v_mfma_f32_16x16x32_bf16 v[116:119], v[44:47], v[12:15], v[116:119]
    s_add_u32 s15, s15, s34
    s_add_u32 s16, s16, s34
    s_add_u32 s17, s17, s34
    s_add_u32 s18, s18, s34
    s_add_u32 s19, s19, s34
    s_add_u32 s23, s23, s37
    s_waitcnt vmcnt(9)
    v_cmp_eq_u32 vcc, 0, v211
    s_nop 0
    v_max3_f32 v202, v112, v113, v114
    s_nop 1
    v_max3_f32 v202, v202, v115, v116
    v_max3_f32 v202, v202, v117, v118
    v_max_f32 v202, v202, v119
    s_cmp_lg_u32 s39, 0
    s_cbranch_scc1 main_kernel_a_mq
    s_cmp_ge_u32 s25, 56
    s_cselect_b32 s32, 1, 2
    s_and_b32 s31, vcc_lo, s32
    s_cbranch_scc0 main_kernel_a_mp
main_kernel_a_pp:
    buffer_load_dword v200, v210, s[4:7], s33 offen sc1
    s_waitcnt vmcnt(0)
    v_cmp_eq_u32 vcc, 0, v200
    s_and_b32 s31, vcc_lo, s32
    s_cbranch_scc0 main_kernel_a_pok
    s_sleep 2
    s_sub_u32 s29, s29, 1
    s_cbranch_scc0 main_kernel_a_pp
    s_branch main_kernel_end
main_kernel_a_pok:
    s_cmp_eq_u32 s32, 2
    s_cbranch_scc1 main_kernel_a_mp
    s_sleep 2
    s_cmp_eq_u32 s25, 63
    s_cbranch_scc1 main_kernel_a_mp
    s_sleep 40
main_kernel_a_mp:
    s_mov_b32 s39, 0
    buffer_load_dwordx4 v[80:83], v205, s[4:7], s20 offen offset:0 sc1
    buffer_load_dwordx4 v[84:87], v205, s[4:7], s20 offen offset:512 sc1
    buffer_load_dwordx4 v[88:91], v205, s[4:7], s20 offen offset:1024 sc1
    buffer_load_dwordx4 v[92:95], v205, s[4:7], s20 offen offset:1536 sc1
    buffer_load_dwordx2 v[96:97], v206, s[4:7], s21 offen offset:0 sc1
    buffer_load_dwordx2 v[98:99], v206, s[4:7], s21 offen offset:256 sc1
    buffer_load_dwordx2 v[100:101], v206, s[4:7], s21 offen offset:512 sc1
    buffer_load_dwordx2 v[102:103], v206, s[4:7], s21 offen offset:768 sc1
    buffer_load_dwordx2 v[104:105], v206, s[4:7], s21 offen offset:1024 sc1
    buffer_load_dwordx2 v[106:107], v206, s[4:7], s21 offen offset:1280 sc1
    buffer_load_dwordx2 v[108:109], v206, s[4:7], s21 offen offset:1536 sc1
    buffer_load_dwordx2 v[110:111], v206, s[4:7], s21 offen offset:1792 sc1
    buffer_load_dword v212, v207, s[4:7], s23 offen offset:0 sc1
    buffer_load_dword v211, v210, s[4:7], s33 offen sc1
main_kernel_a_mq:
    s_waitcnt vmcnt(13)
    v_mfma_f32_16x16x32_bf16 v[120:123], v[80:83], v[0:3], v[132:135]
    v_max3_u32 v200, v80, v81, v82
    v_max_u32 v200, v200, v83
    s_waitcnt vmcnt(12)
    v_mfma_f32_16x16x32_bf16 v[120:123], v[84:87], v[4:7], v[120:123]
    v_max3_u32 v200, v200, v84, v85
    v_max3_u32 v200, v200, v86, v87
    s_waitcnt vmcnt(11)
    v_mfma_f32_16x16x32_bf16 v[120:123], v[88:91], v[8:11], v[120:123]
    v_max3_u32 v200, v200, v88, v89
    v_max3_u32 v200, v200, v90, v91
    s_waitcnt vmcnt(10)
    v_mfma_f32_16x16x32_bf16 v[120:123], v[92:95], v[12:15], v[120:123]
    v_max3_u32 v200, v200, v92, v93
    v_max3_u32 v200, v200, v94, v95
    s_waitcnt vmcnt(8)
    v_max3_u32 v200, v200, v96, v97
    v_max3_u32 v200, v200, v98, v99
    s_waitcnt vmcnt(6)
    v_max3_u32 v200, v200, v100, v101
    v_max3_u32 v200, v200, v102, v103
    s_waitcnt vmcnt(4)
    v_max3_u32 v200, v200, v104, v105
    v_max3_u32 v200, v200, v106, v107
    s_waitcnt vmcnt(2)
    v_max3_u32 v200, v200, v108, v109
    v_max3_u32 v200, v200, v110, v111
    v_cmp_eq_u32 vcc, -1, v200
    s_cbranch_vccz main_kernel_a_mok
    s_sleep 1
    s_sub_u32 s29, s29, 1
    s_cbranch_scc0 main_kernel_a_mp
    s_branch main_kernel_end
main_kernel_a_mok:
    v_mul_f32 v120, s26, v120
    v_mul_f32 v121, s26, v121
    v_mul_f32 v122, s26, v122
    v_mul_f32 v123, s26, v123
    v_max3_f32 v200, v202, v120, v121
    v_max3_f32 v200, v200, v122, v123
    v_mov_b32 v201, v200
    s_add_u32 s20, s20, s35
    s_add_u32 s21, s21, s35
    v_permlane32_swap_b32 v200, v201
    v_max_f32 v200, v200, v201
    v_mov_b32 v201, v200
    s_nop 1
    v_permlane16_swap_b32 v200, v201
    v_max_f32 v200, v200, v201
    v_sub_f32 v112, v112, v200
    v_sub_f32 v113, v113, v200
    v_sub_f32 v114, v114, v200
    v_sub_f32 v115, v115, v200
    v_sub_f32 v116, v116, v200
    v_sub_f32 v117, v117, v200
    v_sub_f32 v118, v118, v200
    v_sub_f32 v119, v119, v200
    v_sub_f32 v120, v120, v200
    v_sub_f32 v121, v121, v200
    v_sub_f32 v122, v122, v200
    v_sub_f32 v123, v123, v200
    v_exp_f32 v112, v112
    v_exp_f32 v113, v113
    v_exp_f32 v114, v114
    v_cvt_pk_bf16_f32 v136, v112, v113
    v_exp_f32 v115, v115
    v_exp_f32 v116, v116
    v_cvt_pk_bf16_f32 v137, v114, v115
    v_exp_f32 v117, v117
    v_exp_f32 v118, v118
    v_cvt_pk_bf16_f32 v138, v116, v117
    v_exp_f32 v119, v119
    v_exp_f32 v120, v120
    v_cvt_pk_bf16_f32 v139, v118, v119
    v_exp_f32 v121, v121
    v_exp_f32 v122, v122
    v_cvt_pk_bf16_f32 v140, v120, v121
    v_exp_f32 v123, v123
    s_nop 0
    v_cvt_pk_bf16_f32 v141, v122, v123
    s_waitcnt vmcnt(1)
    v_mfma_f32_16x16x32_bf16 v[144:147], v[180:183], v[136:139], 0
    v_mfma_f32_16x16x32_bf16 v[148:151], v[48:51], v[136:139], 0
    v_mfma_f32_16x16x16_bf16 v[144:147], v[180:181], v[140:141], v[144:147]
    v_mfma_f32_16x16x32_bf16 v[152:155], v[52:55], v[136:139], 0
    v_mfma_f32_16x16x32_bf16 v[156:159], v[56:59], v[136:139], 0
    v_mfma_f32_16x16x32_bf16 v[160:163], v[60:63], v[136:139], 0
    v_mfma_f32_16x16x32_bf16 v[164:167], v[64:67], v[136:139], 0
    v_mfma_f32_16x16x32_bf16 v[168:171], v[68:71], v[136:139], 0
    v_mfma_f32_16x16x32_bf16 v[172:175], v[72:75], v[136:139], 0
    v_mfma_f32_16x16x32_bf16 v[176:179], v[76:79], v[136:139], 0
    v_rcp_f32 v200, v144
    v_mfma_f32_16x16x16_bf16 v[148:151], v[96:97], v[140:141], v[148:151]
    v_mfma_f32_16x16x16_bf16 v[152:155], v[98:99], v[140:141], v[152:155]
    v_mfma_f32_16x16x16_bf16 v[156:159], v[100:101], v[140:141], v[156:159]
    v_mfma_f32_16x16x16_bf16 v[160:163], v[102:103], v[140:141], v[160:163]
    v_mfma_f32_16x16x16_bf16 v[164:167], v[104:105], v[140:141], v[164:167]
    v_mfma_f32_16x16x16_bf16 v[168:171], v[106:107], v[140:141], v[168:171]
    v_mfma_f32_16x16x16_bf16 v[172:175], v[108:109], v[140:141], v[172:175]
    v_mfma_f32_16x16x16_bf16 v[176:179], v[110:111], v[140:141], v[176:179]
    v_mov_b32 v201, v200
    s_cmp_lg_u32 s39, 0
    s_cbranch_scc1 main_kernel_a_nw
    s_waitcnt vmcnt(0)
main_kernel_a_nw:
    v_cmp_ne_u32 vcc, 0, v211
    s_and_b32 s39, vcc_lo, 4
    v_cmp_eq_u32 vcc, 0, v212
    v_pk_mul_f32 v[148:149], v[148:149], v[200:201]
    v_pk_mul_f32 v[150:151], v[150:151], v[200:201]
    v_pk_mul_f32 v[152:153], v[152:153], v[200:201]
    v_pk_mul_f32 v[154:155], v[154:155], v[200:201]
    v_cvt_pk_bf16_f32 v184, v148, v149
    v_cvt_pk_bf16_f32 v185, v150, v151
    v_cvt_pk_bf16_f32 v186, v152, v153
    v_cvt_pk_bf16_f32 v187, v154, v155
    buffer_store_dwordx4 v[184:187], v204, s[4:7], s22 offen offset:0 sc1
    v_pk_mul_f32 v[156:157], v[156:157], v[200:201]
    v_pk_mul_f32 v[158:159], v[158:159], v[200:201]
    v_pk_mul_f32 v[160:161], v[160:161], v[200:201]
    v_pk_mul_f32 v[162:163], v[162:163], v[200:201]
    v_cvt_pk_bf16_f32 v188, v156, v157
    v_cvt_pk_bf16_f32 v189, v158, v159
    v_cvt_pk_bf16_f32 v190, v160, v161
    v_cvt_pk_bf16_f32 v191, v162, v163
    buffer_store_dwordx4 v[188:191], v204, s[4:7], s22 offen offset:1024 sc1
    v_pk_mul_f32 v[164:165], v[164:165], v[200:201]
    v_pk_mul_f32 v[166:167], v[166:167], v[200:201]
    v_pk_mul_f32 v[168:169], v[168:169], v[200:201]
    v_pk_mul_f32 v[170:171], v[170:171], v[200:201]
    v_cvt_pk_bf16_f32 v192, v164, v165
    v_cvt_pk_bf16_f32 v193, v166, v167
    v_cvt_pk_bf16_f32 v194, v168, v169
    v_cvt_pk_bf16_f32 v195, v170, v171
    buffer_store_dwordx4 v[192:195], v204, s[4:7], s22 offen offset:2048 sc1
    s_nop 0
    v_pk_mul_f32 v[172:173], v[172:173], v[200:201]
    v_pk_mul_f32 v[174:175], v[174:175], v[200:201]
    v_pk_mul_f32 v[176:177], v[176:177], v[200:201]
    v_pk_mul_f32 v[178:179], v[178:179], v[200:201]
    v_cvt_pk_bf16_f32 v196, v172, v173
    v_cvt_pk_bf16_f32 v197, v174, v175
    v_cvt_pk_bf16_f32 v198, v176, v177
    v_cvt_pk_bf16_f32 v199, v178, v179
    buffer_store_dwordx4 v[196:199], v204, s[4:7], s22 offen offset:3072 sc1
    s_add_u32 s22, s22, s34
    s_add_u32 s33, s33, s37
    s_add_u32 s25, s25, s38
    s_cmp_ge_u32 s25, 64
    s_cbranch_scc1 main_kernel_a_last
    s_cbranch_vccnz main_kernel_a_slow
    s_cmp_gt_u32 s25, 60
    s_cbranch_scc1 main_kernel_a_slow
    s_cmp_ge_u32 s25, 56
    s_cselect_b32 s39, 0, s39
    s_cmp_lg_u32 s39, 0
    s_cbranch_scc1 main_kernel_a_pre
    buffer_load_dwordx4 v[0:3], v204, s[4:7], s15 offen offset:0 sc1
    buffer_load_dwordx4 v[16:19], v204, s[4:7], s16 offen offset:0 sc1
    buffer_load_dwordx4 v[32:35], v204, s[4:7], s17 offen offset:0 sc1
    buffer_load_dwordx4 v[4:7], v204, s[4:7], s15 offen offset:1024 sc1
    buffer_load_dwordx4 v[20:23], v204, s[4:7], s16 offen offset:1024 sc1
    buffer_load_dwordx4 v[36:39], v204, s[4:7], s17 offen offset:1024 sc1
    buffer_load_dwordx4 v[8:11], v204, s[4:7], s15 offen offset:2048 sc1
    buffer_load_dwordx4 v[24:27], v204, s[4:7], s16 offen offset:2048 sc1
    buffer_load_dwordx4 v[40:43], v204, s[4:7], s17 offen offset:2048 sc1
    buffer_load_dwordx4 v[12:15], v204, s[4:7], s15 offen offset:3072 sc1
    buffer_load_dwordx4 v[28:31], v204, s[4:7], s16 offen offset:3072 sc1
    buffer_load_dwordx4 v[44:47], v204, s[4:7], s17 offen offset:3072 sc1
    buffer_load_dword v211, v210, s[4:7], s33 offen sc1
    buffer_load_dwordx4 v[48:51], v204, s[4:7], s18 offen offset:0 sc1
    buffer_load_dwordx4 v[52:55], v204, s[4:7], s18 offen offset:1024 sc1
    buffer_load_dwordx4 v[56:59], v204, s[4:7], s18 offen offset:2048 sc1
    buffer_load_dwordx4 v[60:63], v204, s[4:7], s18 offen offset:3072 sc1
    buffer_load_dwordx4 v[64:67], v204, s[4:7], s19 offen offset:0 sc1
    buffer_load_dwordx4 v[68:71], v204, s[4:7], s19 offen offset:1024 sc1
    buffer_load_dwordx4 v[72:75], v204, s[4:7], s19 offen offset:2048 sc1
    buffer_load_dwordx4 v[76:79], v204, s[4:7], s19 offen offset:3072 sc1
    s_waitcnt vmcnt(21)
    s_mov_b64 exec, 1
    buffer_store_dword v208, v209, s[4:7], s24 offen sc1
    s_mov_b64 exec, -1
    s_add_u32 s24, s24, s36
    s_branch main_kernel_a_top
main_kernel_a_pre:
    buffer_load_dwordx4 v[80:83], v205, s[4:7], s20 offen offset:0 sc1
    buffer_load_dwordx4 v[84:87], v205, s[4:7], s20 offen offset:512 sc1
    buffer_load_dwordx4 v[88:91], v205, s[4:7], s20 offen offset:1024 sc1
    buffer_load_dwordx4 v[92:95], v205, s[4:7], s20 offen offset:1536 sc1
    buffer_load_dwordx2 v[96:97], v206, s[4:7], s21 offen offset:0 sc1
    buffer_load_dwordx2 v[98:99], v206, s[4:7], s21 offen offset:256 sc1
    buffer_load_dwordx2 v[100:101], v206, s[4:7], s21 offen offset:512 sc1
    buffer_load_dwordx2 v[102:103], v206, s[4:7], s21 offen offset:768 sc1
    buffer_load_dwordx2 v[104:105], v206, s[4:7], s21 offen offset:1024 sc1
    buffer_load_dwordx2 v[106:107], v206, s[4:7], s21 offen offset:1280 sc1
    buffer_load_dwordx2 v[108:109], v206, s[4:7], s21 offen offset:1536 sc1
    buffer_load_dwordx2 v[110:111], v206, s[4:7], s21 offen offset:1792 sc1
    buffer_load_dword v212, v207, s[4:7], s23 offen offset:4 sc1
    buffer_load_dwordx4 v[0:3], v204, s[4:7], s15 offen offset:0 sc1
    buffer_load_dwordx4 v[16:19], v204, s[4:7], s16 offen offset:0 sc1
    buffer_load_dwordx4 v[32:35], v204, s[4:7], s17 offen offset:0 sc1
    buffer_load_dwordx4 v[4:7], v204, s[4:7], s15 offen offset:1024 sc1
    buffer_load_dwordx4 v[20:23], v204, s[4:7], s16 offen offset:1024 sc1
    buffer_load_dwordx4 v[36:39], v204, s[4:7], s17 offen offset:1024 sc1
    buffer_load_dwordx4 v[8:11], v204, s[4:7], s15 offen offset:2048 sc1
    buffer_load_dwordx4 v[24:27], v204, s[4:7], s16 offen offset:2048 sc1
    buffer_load_dwordx4 v[40:43], v204, s[4:7], s17 offen offset:2048 sc1
    buffer_load_dwordx4 v[12:15], v204, s[4:7], s15 offen offset:3072 sc1
    buffer_load_dwordx4 v[28:31], v204, s[4:7], s16 offen offset:3072 sc1
    buffer_load_dwordx4 v[44:47], v204, s[4:7], s17 offen offset:3072 sc1
    buffer_load_dword v211, v210, s[4:7], s33 offen sc1
    buffer_load_dwordx4 v[48:51], v204, s[4:7], s18 offen offset:0 sc1
    buffer_load_dwordx4 v[52:55], v204, s[4:7], s18 offen offset:1024 sc1
    buffer_load_dwordx4 v[56:59], v204, s[4:7], s18 offen offset:2048 sc1
    buffer_load_dwordx4 v[60:63], v204, s[4:7], s18 offen offset:3072 sc1
    buffer_load_dwordx4 v[64:67], v204, s[4:7], s19 offen offset:0 sc1
    buffer_load_dwordx4 v[68:71], v204, s[4:7], s19 offen offset:1024 sc1
    buffer_load_dwordx4 v[72:75], v204, s[4:7], s19 offen offset:2048 sc1
    buffer_load_dwordx4 v[76:79], v204, s[4:7], s19 offen offset:3072 sc1
    s_waitcnt vmcnt(34)
    s_mov_b64 exec, 1
    buffer_store_dword v208, v209, s[4:7], s24 offen sc1
    s_mov_b64 exec, -1
    s_add_u32 s24, s24, s36
    s_branch main_kernel_a_top
main_kernel_a_slow:
    s_mov_b32 s39, 0
    s_waitcnt vmcnt(0)
    s_mov_b64 exec, 1
    buffer_store_dword v208, v209, s[4:7], s24 offen sc1
    s_mov_b64 exec, -1
    s_add_u32 s24, s24, s36
    s_branch main_kernel_a_fp
main_kernel_a_last:
    s_waitcnt vmcnt(0)
    s_mov_b64 exec, 1
    buffer_store_dword v208, v209, s[4:7], s24 offen sc1
    s_mov_b64 exec, -1
    s_add_u32 s24, s24, s36
    s_branch main_kernel_end
main_kernel_wo:
    s_mov_b32 s8, s46
    s_and_b32 s9, s47, 0xffff
    s_mov_b32 s10, 0x800000
    s_mov_b32 s11, 0x20000
    v_lshlrev_b32 v170, 4, v250
    s_lshr_b32 s23, s12, 2
    s_sub_u32 s21, s12, 5
    s_cselect_b32 s23, s23, s21
    s_cselect_b32 s18, 44, 63
    v_lshrrev_b32 v178, 2, v250
    v_and_b32 v179, 3, v250
    v_lshlrev_b32 v0, 11, v178
    v_lshl_add_u32 v0, v179, 4, v0
    s_lshl_b32 s19, s14, 15
    v_lshl_add_u32 v1, v178, 6, s19
    v_lshl_add_u32 v1, v179, 3, v1
    s_lshl_b32 s20, s14, 21
    s_lshl_b32 s21, s13, 6
    s_add_u32 s20, s20, s21
    s_add_u32 s21, s20, 0x0
    s_add_u32 m0, s19, 0
    s_nop 0
    buffer_load_dwordx4 v0, s[8:11], s21 offen lds
    s_add_u32 s21, s20, 0x8000
    s_add_u32 m0, s19, 1024
    s_nop 0
    buffer_load_dwordx4 v0, s[8:11], s21 offen lds
    s_add_u32 s21, s20, 0x10000
    s_add_u32 m0, s19, 2048
    s_nop 0
    buffer_load_dwordx4 v0, s[8:11], s21 offen lds
    s_add_u32 s21, s20, 0x18000
    s_add_u32 m0, s19, 3072
    s_nop 0
    buffer_load_dwordx4 v0, s[8:11], s21 offen lds
    s_add_u32 s21, s20, 0x20000
    s_add_u32 m0, s19, 4096
    s_nop 0
    buffer_load_dwordx4 v0, s[8:11], s21 offen lds
    s_add_u32 s21, s20, 0x28000
    s_add_u32 m0, s19, 5120
    s_nop 0
    buffer_load_dwordx4 v0, s[8:11], s21 offen lds
    s_add_u32 s21, s20, 0x30000
    s_add_u32 m0, s19, 6144
    s_nop 0
    buffer_load_dwordx4 v0, s[8:11], s21 offen lds
    s_add_u32 s21, s20, 0x38000
    s_add_u32 m0, s19, 7168
    s_nop 0
    buffer_load_dwordx4 v0, s[8:11], s21 offen lds
    s_add_u32 s21, s20, 0x40000
    s_add_u32 m0, s19, 8192
    s_nop 0
    buffer_load_dwordx4 v0, s[8:11], s21 offen lds
    s_add_u32 s21, s20, 0x48000
    s_add_u32 m0, s19, 9216
    s_nop 0
    buffer_load_dwordx4 v0, s[8:11], s21 offen lds
    s_add_u32 s21, s20, 0x50000
    s_add_u32 m0, s19, 10240
    s_nop 0
    buffer_load_dwordx4 v0, s[8:11], s21 offen lds
    s_add_u32 s21, s20, 0x58000
    s_add_u32 m0, s19, 11264
    s_nop 0
    buffer_load_dwordx4 v0, s[8:11], s21 offen lds
    s_add_u32 s21, s20, 0x60000
    s_add_u32 m0, s19, 12288
    s_nop 0
    buffer_load_dwordx4 v0, s[8:11], s21 offen lds
    s_add_u32 s21, s20, 0x68000
    s_add_u32 m0, s19, 13312
    s_nop 0
    buffer_load_dwordx4 v0, s[8:11], s21 offen lds
    s_add_u32 s21, s20, 0x70000
    s_add_u32 m0, s19, 14336
    s_nop 0
    buffer_load_dwordx4 v0, s[8:11], s21 offen lds
    s_add_u32 s21, s20, 0x78000
    s_add_u32 m0, s19, 15360
    s_nop 0
    buffer_load_dwordx4 v0, s[8:11], s21 offen lds
    s_add_u32 s21, s20, 0x80000
    s_add_u32 m0, s19, 16384
    s_nop 0
    buffer_load_dwordx4 v0, s[8:11], s21 offen lds
    s_add_u32 s21, s20, 0x88000
    s_add_u32 m0, s19, 17408
    s_nop 0
    buffer_load_dwordx4 v0, s[8:11], s21 offen lds
    s_add_u32 s21, s20, 0x90000
    s_add_u32 m0, s19, 18432
    s_nop 0
    buffer_load_dwordx4 v0, s[8:11], s21 offen lds
    s_add_u32 s21, s20, 0x98000
    s_add_u32 m0, s19, 19456
    s_nop 0
    buffer_load_dwordx4 v0, s[8:11], s21 offen lds
    s_add_u32 s21, s20, 0xa0000
    s_add_u32 m0, s19, 20480
    s_nop 0
    buffer_load_dwordx4 v0, s[8:11], s21 offen lds
    s_add_u32 s21, s20, 0xa8000
    s_add_u32 m0, s19, 21504
    s_nop 0
    buffer_load_dwordx4 v0, s[8:11], s21 offen lds
    s_add_u32 s21, s20, 0xb0000
    s_add_u32 m0, s19, 22528
    s_nop 0
    buffer_load_dwordx4 v0, s[8:11], s21 offen lds
    s_add_u32 s21, s20, 0xb8000
    s_add_u32 m0, s19, 23552
    s_nop 0
    buffer_load_dwordx4 v0, s[8:11], s21 offen lds
    s_add_u32 s21, s20, 0xc0000
    s_add_u32 m0, s19, 24576
    s_nop 0
    buffer_load_dwordx4 v0, s[8:11], s21 offen lds
    s_add_u32 s21, s20, 0xc8000
    s_add_u32 m0, s19, 25600
    s_nop 0
    buffer_load_dwordx4 v0, s[8:11], s21 offen lds
    s_add_u32 s21, s20, 0xd0000
    s_add_u32 m0, s19, 26624
    s_nop 0
    buffer_load_dwordx4 v0, s[8:11], s21 offen lds
    s_add_u32 s21, s20, 0xd8000
    s_add_u32 m0, s19, 27648
    s_nop 0
    buffer_load_dwordx4 v0, s[8:11], s21 offen lds
    s_add_u32 s21, s20, 0xe0000
    s_add_u32 m0, s19, 28672
    s_nop 0
    buffer_load_dwordx4 v0, s[8:11], s21 offen lds
    s_add_u32 s21, s20, 0xe8000
    s_add_u32 m0, s19, 29696
    s_nop 0
    buffer_load_dwordx4 v0, s[8:11], s21 offen lds
    s_add_u32 s21, s20, 0xf0000
    s_add_u32 m0, s19, 30720
    s_nop 0
    buffer_load_dwordx4 v0, s[8:11], s21 offen lds
    s_add_u32 s21, s20, 0xf8000
    s_add_u32 m0, s19, 31744
    s_nop 0
    buffer_load_dwordx4 v0, s[8:11], s21 offen lds
    v_and_b32 v178, 15, v250
    v_lshrrev_b32 v179, 4, v250
    v_lshlrev_b32 v175, 11, v178
    v_lshl_add_u32 v175, v179, 3, v175
    s_lshl_b32 s21, s14, 11
    s_add_u32 s21, s21, 131072
    v_add_u32 v176, s21, v170
    s_lshl_b32 s21, s14, 10
    s_add_u32 s21, s21, 131072
    v_add_u32 v177, s21, v170
    s_lshr_b32 s21, s13, 2
    s_lshl_b32 s21, s21, 8
    s_add_u32 s21, s21, 0x8412000
    s_lshl2_add_u32 s21, s18, s21
    v_mov_b32 v172, s21
    v_mov_b32 v173, 4
    s_lshl_b32 s21, s14, 4
    s_add_u32 s21, s21, s23
    s_lshl_b32 s21, s21, 2
    s_add_u32 s21, s21, 0x8400000
    s_lshl_b32 s22, s18, 8
    s_add_u32 s21, s21, s22
    s_mov_b64 exec, 0xff
    v_lshl_add_u32 v172, v250, 3, s21
    v_mov_b32 v173, 0x100
    s_mov_b64 exec, -1
    s_lshl_b32 s15, s14, 15
    s_lshl_b32 s21, s23, 17
    s_add_u32 s15, s15, s21
    s_add_u32 s15, s15, 0x3800000
    s_lshl_b32 s21, s18, 18
    s_add_u32 s15, s15, s21
    s_lshl_b32 s21, s23, 15
    s_lshl_b32 s22, s18, 16
    s_add_u32 s21, s21, s22
    s_and_b32 s22, s14, 1
    s_lshl_b32 s16, s13, 1
    s_add_u32 s16, s16, s22
    s_lshl_b32 s16, s16, 5
    s_add_u32 s16, s16, s21
    s_lshl_b32 s17, s13, 7
    s_add_u32 s17, s17, s22
    s_lshl_b32 s17, s17, 3
    s_add_u32 s17, s17, s21
    s_add_u32 s17, s17, 0x6400000
    s_waitcnt vmcnt(24)
    ds_read_b64_tr_b16 a[0:1], v1 offset:0
    ds_read_b64_tr_b16 a[2:3], v1 offset:1024
    ds_read_b64_tr_b16 a[128:129], v1 offset:32
    ds_read_b64_tr_b16 a[130:131], v1 offset:1056
    ds_read_b64_tr_b16 a[4:5], v1 offset:2048
    ds_read_b64_tr_b16 a[6:7], v1 offset:3072
    ds_read_b64_tr_b16 a[132:133], v1 offset:2080
    ds_read_b64_tr_b16 a[134:135], v1 offset:3104
    ds_read_b64_tr_b16 a[8:9], v1 offset:4096
    ds_read_b64_tr_b16 a[10:11], v1 offset:5120
    ds_read_b64_tr_b16 a[136:137], v1 offset:4128
    ds_read_b64_tr_b16 a[138:139], v1 offset:5152
    ds_read_b64_tr_b16 a[12:13], v1 offset:6144
    ds_read_b64_tr_b16 a[14:15], v1 offset:7168
    ds_read_b64_tr_b16 a[140:141], v1 offset:6176
    ds_read_b64_tr_b16 a[142:143], v1 offset:7200
    s_waitcnt lgkmcnt(0)
    s_add_u32 s21, s20, 0x100000
    s_add_u32 m0, s19, 0
    s_nop 0
    buffer_load_dwordx4 v0, s[8:11], s21 offen lds
    s_add_u32 s21, s20, 0x108000
    s_add_u32 m0, s19, 1024
    s_nop 0
    buffer_load_dwordx4 v0, s[8:11], s21 offen lds
    s_add_u32 s21, s20, 0x110000
    s_add_u32 m0, s19, 2048
    s_nop 0
    buffer_load_dwordx4 v0, s[8:11], s21 offen lds
    s_add_u32 s21, s20, 0x118000
    s_add_u32 m0, s19, 3072
    s_nop 0
    buffer_load_dwordx4 v0, s[8:11], s21 offen lds
    s_add_u32 s21, s20, 0x120000
    s_add_u32 m0, s19, 4096
    s_nop 0
    buffer_load_dwordx4 v0, s[8:11], s21 offen lds
    s_add_u32 s21, s20, 0x128000
    s_add_u32 m0, s19, 5120
    s_nop 0
    buffer_load_dwordx4 v0, s[8:11], s21 offen lds
    s_add_u32 s21, s20, 0x130000
    s_add_u32 m0, s19, 6144
    s_nop 0
    buffer_load_dwordx4 v0, s[8:11], s21 offen lds
    s_add_u32 s21, s20, 0x138000
    s_add_u32 m0, s19, 7168
    s_nop 0
    buffer_load_dwordx4 v0, s[8:11], s21 offen lds
    s_waitcnt vmcnt(24)
    ds_read_b64_tr_b16 a[16:17], v1 offset:8192
    ds_read_b64_tr_b16 a[18:19], v1 offset:9216
    ds_read_b64_tr_b16 a[144:145], v1 offset:8224
    ds_read_b64_tr_b16 a[146:147], v1 offset:9248
    ds_read_b64_tr_b16 a[20:21], v1 offset:10240
    ds_read_b64_tr_b16 a[22:23], v1 offset:11264
    ds_read_b64_tr_b16 a[148:149], v1 offset:10272
    ds_read_b64_tr_b16 a[150:151], v1 offset:11296
    ds_read_b64_tr_b16 a[24:25], v1 offset:12288
    ds_read_b64_tr_b16 a[26:27], v1 offset:13312
    ds_read_b64_tr_b16 a[152:153], v1 offset:12320
    ds_read_b64_tr_b16 a[154:155], v1 offset:13344
    ds_read_b64_tr_b16 a[28:29], v1 offset:14336
    ds_read_b64_tr_b16 a[30:31], v1 offset:15360
    ds_read_b64_tr_b16 a[156:157], v1 offset:14368
    ds_read_b64_tr_b16 a[158:159], v1 offset:15392
    s_waitcnt lgkmcnt(0)
    s_add_u32 s21, s20, 0x140000
    s_add_u32 m0, s19, 8192
    s_nop 0
    buffer_load_dwordx4 v0, s[8:11], s21 offen lds
    s_add_u32 s21, s20, 0x148000
    s_add_u32 m0, s19, 9216
    s_nop 0
    buffer_load_dwordx4 v0, s[8:11], s21 offen lds
    s_add_u32 s21, s20, 0x150000
    s_add_u32 m0, s19, 10240
    s_nop 0
    buffer_load_dwordx4 v0, s[8:11], s21 offen lds
    s_add_u32 s21, s20, 0x158000
    s_add_u32 m0, s19, 11264
    s_nop 0
    buffer_load_dwordx4 v0, s[8:11], s21 offen lds
    s_add_u32 s21, s20, 0x160000
    s_add_u32 m0, s19, 12288
    s_nop 0
    buffer_load_dwordx4 v0, s[8:11], s21 offen lds
    s_add_u32 s21, s20, 0x168000
    s_add_u32 m0, s19, 13312
    s_nop 0
    buffer_load_dwordx4 v0, s[8:11], s21 offen lds
    s_add_u32 s21, s20, 0x170000
    s_add_u32 m0, s19, 14336
    s_nop 0
    buffer_load_dwordx4 v0, s[8:11], s21 offen lds
    s_add_u32 s21, s20, 0x178000
    s_add_u32 m0, s19, 15360
    s_nop 0
    buffer_load_dwordx4 v0, s[8:11], s21 offen lds
    s_waitcnt vmcnt(24)
    ds_read_b64_tr_b16 a[32:33], v1 offset:16384
    ds_read_b64_tr_b16 a[34:35], v1 offset:17408
    ds_read_b64_tr_b16 a[160:161], v1 offset:16416
    ds_read_b64_tr_b16 a[162:163], v1 offset:17440
    ds_read_b64_tr_b16 a[36:37], v1 offset:18432
    ds_read_b64_tr_b16 a[38:39], v1 offset:19456
    ds_read_b64_tr_b16 a[164:165], v1 offset:18464
    ds_read_b64_tr_b16 a[166:167], v1 offset:19488
    ds_read_b64_tr_b16 a[40:41], v1 offset:20480
    ds_read_b64_tr_b16 a[42:43], v1 offset:21504
    ds_read_b64_tr_b16 a[168:169], v1 offset:20512
    ds_read_b64_tr_b16 a[170:171], v1 offset:21536
    ds_read_b64_tr_b16 a[44:45], v1 offset:22528
    ds_read_b64_tr_b16 a[46:47], v1 offset:23552
    ds_read_b64_tr_b16 a[172:173], v1 offset:22560
    ds_read_b64_tr_b16 a[174:175], v1 offset:23584
    s_waitcnt lgkmcnt(0)
    s_add_u32 s21, s20, 0x180000
    s_add_u32 m0, s19, 16384
    s_nop 0
    buffer_load_dwordx4 v0, s[8:11], s21 offen lds
    s_add_u32 s21, s20, 0x188000
    s_add_u32 m0, s19, 17408
    s_nop 0
    buffer_load_dwordx4 v0, s[8:11], s21 offen lds
    s_add_u32 s21, s20, 0x190000
    s_add_u32 m0, s19, 18432
    s_nop 0
    buffer_load_dwordx4 v0, s[8:11], s21 offen lds
    s_add_u32 s21, s20, 0x198000
    s_add_u32 m0, s19, 19456
    s_nop 0
    buffer_load_dwordx4 v0, s[8:11], s21 offen lds
    s_add_u32 s21, s20, 0x1a0000
    s_add_u32 m0, s19, 20480
    s_nop 0
    buffer_load_dwordx4 v0, s[8:11], s21 offen lds
    s_add_u32 s21, s20, 0x1a8000
    s_add_u32 m0, s19, 21504
    s_nop 0
    buffer_load_dwordx4 v0, s[8:11], s21 offen lds
    s_add_u32 s21, s20, 0x1b0000
    s_add_u32 m0, s19, 22528
    s_nop 0
    buffer_load_dwordx4 v0, s[8:11], s21 offen lds
    s_add_u32 s21, s20, 0x1b8000
    s_add_u32 m0, s19, 23552
    s_nop 0
    buffer_load_dwordx4 v0, s[8:11], s21 offen lds
    s_waitcnt vmcnt(24)
    ds_read_b64_tr_b16 a[48:49], v1 offset:24576
    ds_read_b64_tr_b16 a[50:51], v1 offset:25600
    ds_read_b64_tr_b16 a[176:177], v1 offset:24608
    ds_read_b64_tr_b16 a[178:179], v1 offset:25632
    ds_read_b64_tr_b16 a[52:53], v1 offset:26624
    ds_read_b64_tr_b16 a[54:55], v1 offset:27648
    ds_read_b64_tr_b16 a[180:181], v1 offset:26656
    ds_read_b64_tr_b16 a[182:183], v1 offset:27680
    ds_read_b64_tr_b16 a[56:57], v1 offset:28672
    ds_read_b64_tr_b16 a[58:59], v1 offset:29696
    ds_read_b64_tr_b16 a[184:185], v1 offset:28704
    ds_read_b64_tr_b16 a[186:187], v1 offset:29728
    ds_read_b64_tr_b16 a[60:61], v1 offset:30720
    ds_read_b64_tr_b16 a[62:63], v1 offset:31744
    ds_read_b64_tr_b16 a[188:189], v1 offset:30752
    ds_read_b64_tr_b16 a[190:191], v1 offset:31776
    s_waitcnt lgkmcnt(0)
    s_add_u32 s21, s20, 0x1c0000
    s_add_u32 m0, s19, 24576
    s_nop 0
    buffer_load_dwordx4 v0, s[8:11], s21 offen lds
    s_add_u32 s21, s20, 0x1c8000
    s_add_u32 m0, s19, 25600
    s_nop 0
    buffer_load_dwordx4 v0, s[8:11], s21 offen lds
    s_add_u32 s21, s20, 0x1d0000
    s_add_u32 m0, s19, 26624
    s_nop 0
    buffer_load_dwordx4 v0, s[8:11], s21 offen lds
    s_add_u32 s21, s20, 0x1d8000
    s_add_u32 m0, s19, 27648
    s_nop 0
    buffer_load_dwordx4 v0, s[8:11], s21 offen lds
    s_add_u32 s21, s20, 0x1e0000
    s_add_u32 m0, s19, 28672
    s_nop 0
    buffer_load_dwordx4 v0, s[8:11], s21 offen lds
    s_add_u32 s21, s20, 0x1e8000
    s_add_u32 m0, s19, 29696
    s_nop 0
    buffer_load_dwordx4 v0, s[8:11], s21 offen lds
    s_add_u32 s21, s20, 0x1f0000
    s_add_u32 m0, s19, 30720
    s_nop 0
    buffer_load_dwordx4 v0, s[8:11], s21 offen lds
    s_add_u32 s21, s20, 0x1f8000
    s_add_u32 m0, s19, 31744
    s_nop 0
    buffer_load_dwordx4 v0, s[8:11], s21 offen lds
    s_waitcnt vmcnt(24)
    ds_read_b64_tr_b16 a[64:65], v1 offset:0
    ds_read_b64_tr_b16 a[66:67], v1 offset:1024
    ds_read_b64_tr_b16 a[192:193], v1 offset:32
    ds_read_b64_tr_b16 a[194:195], v1 offset:1056
    ds_read_b64_tr_b16 a[68:69], v1 offset:2048
    ds_read_b64_tr_b16 a[70:71], v1 offset:3072
    ds_read_b64_tr_b16 a[196:197], v1 offset:2080
    ds_read_b64_tr_b16 a[198:199], v1 offset:3104
    ds_read_b64_tr_b16 a[72:73], v1 offset:4096
    ds_read_b64_tr_b16 a[74:75], v1 offset:5120
    ds_read_b64_tr_b16 a[200:201], v1 offset:4128
    ds_read_b64_tr_b16 a[202:203], v1 offset:5152
    ds_read_b64_tr_b16 a[76:77], v1 offset:6144
    ds_read_b64_tr_b16 a[78:79], v1 offset:7168
    ds_read_b64_tr_b16 a[204:205], v1 offset:6176
    ds_read_b64_tr_b16 a[206:207], v1 offset:7200
    s_waitcnt lgkmcnt(0)
    s_waitcnt vmcnt(16)
    ds_read_b64_tr_b16 a[80:81], v1 offset:8192
    ds_read_b64_tr_b16 a[82:83], v1 offset:9216
    ds_read_b64_tr_b16 a[208:209], v1 offset:8224
    ds_read_b64_tr_b16 a[210:211], v1 offset:9248
    ds_read_b64_tr_b16 a[84:85], v1 offset:10240
    ds_read_b64_tr_b16 a[86:87], v1 offset:11264
    ds_read_b64_tr_b16 a[212:213], v1 offset:10272
    ds_read_b64_tr_b16 a[214:215], v1 offset:11296
    ds_read_b64_tr_b16 a[88:89], v1 offset:12288
    ds_read_b64_tr_b16 a[90:91], v1 offset:13312
    ds_read_b64_tr_b16 a[216:217], v1 offset:12320
    ds_read_b64_tr_b16 a[218:219], v1 offset:13344
    ds_read_b64_tr_b16 a[92:93], v1 offset:14336
    ds_read_b64_tr_b16 a[94:95], v1 offset:15360
    ds_read_b64_tr_b16 a[220:221], v1 offset:14368
    ds_read_b64_tr_b16 a[222:223], v1 offset:15392
    s_waitcnt lgkmcnt(0)
    s_waitcnt vmcnt(8)
    ds_read_b64_tr_b16 a[96:97], v1 offset:16384
    ds_read_b64_tr_b16 a[98:99], v1 offset:17408
    ds_read_b64_tr_b16 a[224:225], v1 offset:16416
    ds_read_b64_tr_b16 a[226:227], v1 offset:17440
    ds_read_b64_tr_b16 a[100:101], v1 offset:18432
    ds_read_b64_tr_b16 a[102:103], v1 offset:19456
    ds_read_b64_tr_b16 a[228:229], v1 offset:18464
    ds_read_b64_tr_b16 a[230:231], v1 offset:19488
    ds_read_b64_tr_b16 a[104:105], v1 offset:20480
    ds_read_b64_tr_b16 a[106:107], v1 offset:21504
    ds_read_b64_tr_b16 a[232:233], v1 offset:20512
    ds_read_b64_tr_b16 a[234:235], v1 offset:21536
    ds_read_b64_tr_b16 a[108:109], v1 offset:22528
    ds_read_b64_tr_b16 a[110:111], v1 offset:23552
    ds_read_b64_tr_b16 a[236:237], v1 offset:22560
    ds_read_b64_tr_b16 a[238:239], v1 offset:23584
    s_waitcnt lgkmcnt(0)
    s_waitcnt vmcnt(0)
    ds_read_b64_tr_b16 a[112:113], v1 offset:24576
    ds_read_b64_tr_b16 a[114:115], v1 offset:25600
    ds_read_b64_tr_b16 a[240:241], v1 offset:24608
    ds_read_b64_tr_b16 a[242:243], v1 offset:25632
    ds_read_b64_tr_b16 a[116:117], v1 offset:26624
    ds_read_b64_tr_b16 a[118:119], v1 offset:27648
    ds_read_b64_tr_b16 a[244:245], v1 offset:26656
    ds_read_b64_tr_b16 a[246:247], v1 offset:27680
    ds_read_b64_tr_b16 a[120:121], v1 offset:28672
    ds_read_b64_tr_b16 a[122:123], v1 offset:29696
    ds_read_b64_tr_b16 a[248:249], v1 offset:28704
    ds_read_b64_tr_b16 a[250:251], v1 offset:29728
    ds_read_b64_tr_b16 a[124:125], v1 offset:30720
    ds_read_b64_tr_b16 a[126:127], v1 offset:31744
    ds_read_b64_tr_b16 a[252:253], v1 offset:30752
    ds_read_b64_tr_b16 a[254:255], v1 offset:31776
    s_waitcnt lgkmcnt(0)
    s_cmp_lt_u32 s12, 5
    s_cbranch_scc1 main_kernel_o_top
    v_mul_u32_u24 v178, 2, v173
    v_sub_u32 v171, v172, v178
main_kernel_o_gp:
    buffer_load_dword v174, v171, s[4:7], 0 offen sc1
    s_waitcnt vmcnt(0)
    v_cmp_eq_u32 vcc, 0, v174
    s_cbranch_vccz main_kernel_o_top
    s_sleep 32
    s_sub_u32 s29, s29, 1
    s_cbranch_scc0 main_kernel_o_gp
    s_branch main_kernel_end
main_kernel_o_top:
    buffer_load_dword v174, v172, s[4:7], 0 offen sc1
    s_waitcnt vmcnt(0)
    v_cmp_eq_u32 vcc, 0, v174
    s_cbranch_vccz main_kernel_o_go
    s_sleep 1
    s_sub_u32 s29, s29, 1
    s_cbranch_scc0 main_kernel_o_top
    s_branch main_kernel_end
main_kernel_o_go:
    buffer_load_dwordx4 v[0:3], v170, s[4:7], s15 offen offset:0 sc1
    buffer_load_dwordx4 v[4:7], v170, s[4:7], s15 offen offset:1024 sc1
    buffer_load_dwordx4 v[8:11], v170, s[4:7], s15 offen offset:2048 sc1
    buffer_load_dwordx4 v[12:15], v170, s[4:7], s15 offen offset:3072 sc1
    s_add_u32 s15, s15, 4096
    buffer_load_dwordx4 v[16:19], v170, s[4:7], s15 offen offset:0 sc1
    buffer_load_dwordx4 v[20:23], v170, s[4:7], s15 offen offset:1024 sc1
    buffer_load_dwordx4 v[24:27], v170, s[4:7], s15 offen offset:2048 sc1
    buffer_load_dwordx4 v[28:31], v170, s[4:7], s15 offen offset:3072 sc1
    s_add_u32 s15, s15, 4096
    buffer_load_dwordx4 v[32:35], v170, s[4:7], s15 offen offset:0 sc1
    buffer_load_dwordx4 v[36:39], v170, s[4:7], s15 offen offset:1024 sc1
    buffer_load_dwordx4 v[40:43], v170, s[4:7], s15 offen offset:2048 sc1
    buffer_load_dwordx4 v[44:47], v170, s[4:7], s15 offen offset:3072 sc1
    s_add_u32 s15, s15, 4096
    buffer_load_dwordx4 v[48:51], v170, s[4:7], s15 offen offset:0 sc1
    buffer_load_dwordx4 v[52:55], v170, s[4:7], s15 offen offset:1024 sc1
    buffer_load_dwordx4 v[56:59], v170, s[4:7], s15 offen offset:2048 sc1
    buffer_load_dwordx4 v[60:63], v170, s[4:7], s15 offen offset:3072 sc1
    s_add_u32 s15, s15, 4096
    buffer_load_dwordx2 v[160:161], v175, s[96:99], s16 offen
    buffer_load_dwordx2 v[162:163], v170, s[4:7], s17 offen sc1
    buffer_load_dwordx4 v[64:67], v170, s[4:7], s15 offen offset:0 sc1
    buffer_load_dwordx4 v[68:71], v170, s[4:7], s15 offen offset:1024 sc1
    buffer_load_dwordx4 v[72:75], v170, s[4:7], s15 offen offset:2048 sc1
    buffer_load_dwordx4 v[76:79], v170, s[4:7], s15 offen offset:3072 sc1
    s_add_u32 s15, s15, 4096
    buffer_load_dwordx4 v[80:83], v170, s[4:7], s15 offen offset:0 sc1
    buffer_load_dwordx4 v[84:87], v170, s[4:7], s15 offen offset:1024 sc1
    buffer_load_dwordx4 v[88:91], v170, s[4:7], s15 offen offset:2048 sc1
    buffer_load_dwordx4 v[92:95], v170, s[4:7], s15 offen offset:3072 sc1
    s_add_u32 s15, s15, 4096
    buffer_load_dwordx4 v[96:99], v170, s[4:7], s15 offen offset:0 sc1
    buffer_load_dwordx4 v[100:103], v170, s[4:7], s15 offen offset:1024 sc1
    buffer_load_dwordx4 v[104:107], v170, s[4:7], s15 offen offset:2048 sc1
    buffer_load_dwordx4 v[108:111], v170, s[4:7], s15 offen offset:3072 sc1
    s_add_u32 s15, s15, 4096
    buffer_load_dwordx4 v[112:115], v170, s[4:7], s15 offen offset:0 sc1
    buffer_load_dwordx4 v[116:119], v170, s[4:7], s15 offen offset:1024 sc1
    buffer_load_dwordx4 v[120:123], v170, s[4:7], s15 offen offset:2048 sc1
    buffer_load_dwordx4 v[124:127], v170, s[4:7], s15 offen offset:3072 sc1
    s_add_u32 s15, s15, 233472
    v_add_u32 v172, v172, v173
    s_add_u32 s17, s17, 65536
    s_add_u32 s18, s18, 1
    s_waitcnt vmcnt(33)
    v_mfma_f32_16x16x32_bf16 v[128:131], a[0:3], v[0:3], 0
    v_mfma_f32_16x16x32_bf16 v[132:135], a[128:131], v[0:3], 0
    s_waitcnt vmcnt(32)
    v_mfma_f32_16x16x32_bf16 v[128:131], a[4:7], v[4:7], v[128:131]
    v_mfma_f32_16x16x32_bf16 v[132:135], a[132:135], v[4:7], v[132:135]
    s_waitcnt vmcnt(31)
    v_mfma_f32_16x16x32_bf16 v[128:131], a[8:11], v[8:11], v[128:131]
    v_mfma_f32_16x16x32_bf16 v[132:135], a[136:139], v[8:11], v[132:135]
    s_waitcnt vmcnt(30)
    v_mfma_f32_16x16x32_bf16 v[128:131], a[12:15], v[12:15], v[128:131]
    v_mfma_f32_16x16x32_bf16 v[132:135], a[140:143], v[12:15], v[132:135]
    s_waitcnt vmcnt(29)
    v_mfma_f32_16x16x32_bf16 v[128:131], a[16:19], v[16:19], v[128:131]
    v_mfma_f32_16x16x32_bf16 v[132:135], a[144:147], v[16:19], v[132:135]
    s_waitcnt vmcnt(28)
    v_mfma_f32_16x16x32_bf16 v[128:131], a[20:23], v[20:23], v[128:131]
    v_mfma_f32_16x16x32_bf16 v[132:135], a[148:151], v[20:23], v[132:135]
    s_waitcnt vmcnt(27)
    v_mfma_f32_16x16x32_bf16 v[128:131], a[24:27], v[24:27], v[128:131]
    v_mfma_f32_16x16x32_bf16 v[132:135], a[152:155], v[24:27], v[132:135]
    s_waitcnt vmcnt(26)
    v_mfma_f32_16x16x32_bf16 v[128:131], a[28:31], v[28:31], v[128:131]
    v_mfma_f32_16x16x32_bf16 v[132:135], a[156:159], v[28:31], v[132:135]
    s_waitcnt vmcnt(25)
    v_mfma_f32_16x16x32_bf16 v[128:131], a[32:35], v[32:35], v[128:131]
    v_mfma_f32_16x16x32_bf16 v[132:135], a[160:163], v[32:35], v[132:135]
    s_waitcnt vmcnt(24)
    v_mfma_f32_16x16x32_bf16 v[128:131], a[36:39], v[36:39], v[128:131]
    v_mfma_f32_16x16x32_bf16 v[132:135], a[164:167], v[36:39], v[132:135]
    s_waitcnt vmcnt(23)
    v_mfma_f32_16x16x32_bf16 v[128:131], a[40:43], v[40:43], v[128:131]
    v_mfma_f32_16x16x32_bf16 v[132:135], a[168:171], v[40:43], v[132:135]
    s_waitcnt vmcnt(22)
    v_mfma_f32_16x16x32_bf16 v[128:131], a[44:47], v[44:47], v[128:131]
    v_mfma_f32_16x16x32_bf16 v[132:135], a[172:175], v[44:47], v[132:135]
    s_waitcnt vmcnt(21)
    v_mfma_f32_16x16x32_bf16 v[128:131], a[48:51], v[48:51], v[128:131]
    v_mfma_f32_16x16x32_bf16 v[132:135], a[176:179], v[48:51], v[132:135]
    s_waitcnt vmcnt(20)
    v_mfma_f32_16x16x32_bf16 v[128:131], a[52:55], v[52:55], v[128:131]
    v_mfma_f32_16x16x32_bf16 v[132:135], a[180:183], v[52:55], v[132:135]
    s_waitcnt vmcnt(19)
    v_mfma_f32_16x16x32_bf16 v[128:131], a[56:59], v[56:59], v[128:131]
    v_mfma_f32_16x16x32_bf16 v[132:135], a[184:187], v[56:59], v[132:135]
    s_waitcnt vmcnt(18)
    v_mfma_f32_16x16x32_bf16 v[128:131], a[60:63], v[60:63], v[128:131]
    v_mfma_f32_16x16x32_bf16 v[132:135], a[188:191], v[60:63], v[132:135]
    s_waitcnt vmcnt(15)
    v_mfma_f32_16x16x32_bf16 v[128:131], a[64:67], v[64:67], v[128:131]
    v_mfma_f32_16x16x32_bf16 v[132:135], a[192:195], v[64:67], v[132:135]
    s_waitcnt vmcnt(14)
    v_mfma_f32_16x16x32_bf16 v[128:131], a[68:71], v[68:71], v[128:131]
    v_mfma_f32_16x16x32_bf16 v[132:135], a[196:199], v[68:71], v[132:135]
    s_waitcnt vmcnt(13)
    v_mfma_f32_16x16x32_bf16 v[128:131], a[72:75], v[72:75], v[128:131]
    v_mfma_f32_16x16x32_bf16 v[132:135], a[200:203], v[72:75], v[132:135]
    s_waitcnt vmcnt(12)
    v_mfma_f32_16x16x32_bf16 v[128:131], a[76:79], v[76:79], v[128:131]
    v_mfma_f32_16x16x32_bf16 v[132:135], a[204:207], v[76:79], v[132:135]
    s_waitcnt vmcnt(11)
    v_mfma_f32_16x16x32_bf16 v[128:131], a[80:83], v[80:83], v[128:131]
    v_mfma_f32_16x16x32_bf16 v[132:135], a[208:211], v[80:83], v[132:135]
    v_lshlrev_b32 v164, 16, v160
    v_and_b32 v165, 0xffff0000, v160
    v_lshlrev_b32 v166, 16, v161
    v_and_b32 v167, 0xffff0000, v161
    v_lshlrev_b32 v160, 16, v162
    v_and_b32 v161, 0xffff0000, v162
    v_lshlrev_b32 v162, 16, v163
    v_and_b32 v163, 0xffff0000, v163
    s_waitcnt vmcnt(10)
    v_mfma_f32_16x16x32_bf16 v[128:131], a[84:87], v[84:87], v[128:131]
    v_mfma_f32_16x16x32_bf16 v[132:135], a[212:215], v[84:87], v[132:135]
    s_waitcnt vmcnt(9)
    v_mfma_f32_16x16x32_bf16 v[128:131], a[88:91], v[88:91], v[128:131]
    v_mfma_f32_16x16x32_bf16 v[132:135], a[216:219], v[88:91], v[132:135]
    s_waitcnt vmcnt(8)
    v_mfma_f32_16x16x32_bf16 v[128:131], a[92:95], v[92:95], v[128:131]
    v_mfma_f32_16x16x32_bf16 v[132:135], a[220:223], v[92:95], v[132:135]
    s_waitcnt vmcnt(7)
    v_mfma_f32_16x16x32_bf16 v[128:131], a[96:99], v[96:99], v[128:131]
    v_mfma_f32_16x16x32_bf16 v[132:135], a[224:227], v[96:99], v[132:135]
    s_waitcnt vmcnt(6)
    v_mfma_f32_16x16x32_bf16 v[128:131], a[100:103], v[100:103], v[128:131]
    v_mfma_f32_16x16x32_bf16 v[132:135], a[228:231], v[100:103], v[132:135]
    s_waitcnt vmcnt(5)
    v_mfma_f32_16x16x32_bf16 v[128:131], a[104:107], v[104:107], v[128:131]
    v_mfma_f32_16x16x32_bf16 v[132:135], a[232:235], v[104:107], v[132:135]
    s_waitcnt vmcnt(4)
    v_mfma_f32_16x16x32_bf16 v[128:131], a[108:111], v[108:111], v[128:131]
    v_mfma_f32_16x16x32_bf16 v[132:135], a[236:239], v[108:111], v[132:135]
    s_waitcnt vmcnt(3)
    v_mfma_f32_16x16x32_bf16 v[128:131], a[112:115], v[112:115], v[128:131]
    v_mfma_f32_16x16x32_bf16 v[132:135], a[240:243], v[112:115], v[132:135]
    s_waitcnt vmcnt(2)
    v_mfma_f32_16x16x32_bf16 v[128:131], a[116:119], v[116:119], v[128:131]
    v_mfma_f32_16x16x32_bf16 v[132:135], a[244:247], v[116:119], v[132:135]
    s_waitcnt vmcnt(1)
    v_mfma_f32_16x16x32_bf16 v[128:131], a[120:123], v[120:123], v[128:131]
    v_mfma_f32_16x16x32_bf16 v[132:135], a[248:251], v[120:123], v[132:135]
    s_waitcnt vmcnt(0)
    v_mfma_f32_16x16x32_bf16 v[128:131], a[124:127], v[124:127], v[128:131]
    v_mfma_f32_16x16x32_bf16 v[132:135], a[252:255], v[124:127], v[132:135]
    s_cmp_ge_u32 s14, 2
    s_nop 5
    ds_write_b128 v176, v[128:131] offset:0
    ds_write_b128 v176, v[132:135] offset:1024
    v_xor_b32 v176, 0x4000, v176
    s_waitcnt lgkmcnt(0)
    s_barrier
    s_cbranch_scc1 main_kernel_o_nx
    ds_read_b128 v[144:147], v177 offset:0
    ds_read_b128 v[148:151], v177 offset:2048
    ds_read_b128 v[152:155], v177 offset:4096
    ds_read_b128 v[156:159], v177 offset:6144
    v_xor_b32 v177, 0x4000, v177
    s_waitcnt lgkmcnt(2)
    v_pk_add_f32 v[144:145], v[144:145], v[148:149]
    v_pk_add_f32 v[146:147], v[146:147], v[150:151]
    s_waitcnt lgkmcnt(0)
    v_pk_add_f32 v[152:153], v[152:153], v[156:157]
    v_pk_add_f32 v[154:155], v[154:155], v[158:159]
    v_pk_add_f32 v[144:145], v[144:145], v[152:153]
    v_pk_add_f32 v[146:147], v[146:147], v[154:155]
    v_pk_fma_f32 v[144:145], v[144:145], v[160:161], v[164:165]
    v_pk_fma_f32 v[146:147], v[146:147], v[162:163], v[166:167]
    v_cvt_pk_bf16_f32 v148, v144, v145
    v_cvt_pk_bf16_f32 v149, v146, v147
    buffer_store_dwordx2 v[148:149], v175, s[92:95], s16 offen
main_kernel_o_nx:
    s_add_u32 s16, s16, 65536
    s_cmp_le_u32 s18, 62
    s_cbranch_scc1 main_kernel_o_top
    v_add_u32 v172, v172, v173
    s_add_u32 s17, s17, 65536
    s_add_u32 s16, s16, 65536
    s_add_u32 s15, s15, 262144
    s_add_u32 s18, s18, 1
    s_cmp_lt_u32 s18, 64
    s_cbranch_scc1 main_kernel_o_top
    s_branch main_kernel_end
main_kernel_end2:
    s_endpgm
main_kernel_worker:
    v_lshlrev_b32 v251, 4, v250
    v_mov_b32 v240, 0xc0135761
    v_mov_b32 v241, 0xc0135761
    v_mov_b32 v242, 0xbdd2d3e8
    v_mov_b32 v243, 0xbdd2d3e8
    v_mov_b32 v244, 0x3f800000
    v_mov_b32 v245, 0x3f800000
    v_mov_b32 v246, 0xbfb8aa3b
    v_mov_b32 v247, 0xbfb8aa3b
    s_lshr_b32 s37, s14, 1
    s_and_b32 s38, s14, 1
    v_mov_b32 v252, 0
    s_mov_b32 s8, s40
    s_and_b32 s9, s41, 0xffff
    s_mov_b32 s10, 0x0
    s_mov_b32 s11, 0x20000
    s_mov_b32 s57, 0
    s_mov_b32 s56, 0x7f000000
    v_mov_b32 v249, 0
main_kernel_w_next:
    s_cmp_lg_u32 s14, 0
    s_cbranch_scc1 main_kernel_w_bar
main_kernel_w_try:
    s_lshl_b32 s32, s27, 8
    s_add_u32 s32, s32, 0x841e000
    v_mov_b32 v254, 1
    s_mov_b64 exec, 1
    buffer_atomic_add v254, off, s[4:7], s32 sc0 sc1
    s_mov_b64 exec, -1
    s_waitcnt vmcnt(0)
    v_readfirstlane_b32 s28, v254
    s_cmp_eq_u32 s57, 0
    s_cbranch_scc1 main_kernel_w_fl1
    s_waitcnt vmcnt(0)
    s_barrier
    v_mov_b32 v4, 1
    v_mov_b32 v5, 1
    v_mov_b32 v6, 1
    v_mov_b32 v7, 1
    s_bfm_b64 exec, s57, 0
    buffer_store_dwordx4 v[4:7], v249, s[4:7], s56 offen sc1
    s_mov_b64 exec, -1
    s_mov_b32 s57, 0
main_kernel_w_fl1:
    s_nop 3
main_kernel_w_have:
    s_cmp_lg_u32 s27, 0
    s_cbranch_scc1 main_kernel_w_q1
    s_cmp_lt_u32 s28, 96
    s_cbranch_scc0 main_kernel_w_d_1
    s_cmp_lt_u32 s28, 32
    s_cbranch_scc0 main_kernel_w_d_2
    s_cmp_lt_u32 s28, 16
    s_cbranch_scc0 main_kernel_w_d_3
    s_cmp_lt_u32 s28, 8
    s_cbranch_scc0 main_kernel_w_d_4
    s_mov_b32 s36, 0x4045000
    s_branch main_kernel_w_dec
main_kernel_w_d_4:
    s_mov_b32 s36, 0x64091008
    s_branch main_kernel_w_dec
main_kernel_w_d_3:
    s_cmp_lt_u32 s28, 24
    s_cbranch_scc0 main_kernel_w_d_5
    s_mov_b32 s36, 0x42069010
    s_branch main_kernel_w_dec
main_kernel_w_d_5:
    s_mov_b32 s36, 0x4005818
    s_branch main_kernel_w_dec
main_kernel_w_d_2:
    s_cmp_lt_u32 s28, 56
    s_cbranch_scc0 main_kernel_w_d_6
    s_cmp_lt_u32 s28, 48
    s_cbranch_scc0 main_kernel_w_d_7
    s_mov_b32 s36, 0x48189820
    s_branch main_kernel_w_dec
main_kernel_w_d_7:
    s_mov_b32 s36, 0x67091030
    s_branch main_kernel_w_dec
main_kernel_w_d_6:
    s_cmp_lt_u32 s28, 64
    s_cbranch_scc0 main_kernel_w_d_8
    s_mov_b32 s36, 0x67090838
    s_branch main_kernel_w_dec
main_kernel_w_d_8:
    s_cmp_lt_u32 s28, 80
    s_cbranch_scc0 main_kernel_w_d_9
    s_mov_b32 s36, 0x4102040
    s_branch main_kernel_w_dec
main_kernel_w_d_9:
    s_mov_b32 s36, 0x4142050
    s_branch main_kernel_w_dec
main_kernel_w_d_1:
    s_cmp_lt_u32 s28, 164
    s_cbranch_scc0 main_kernel_w_d_10
    s_cmp_lt_u32 s28, 120
    s_cbranch_scc0 main_kernel_w_d_11
    s_cmp_lt_u32 s28, 112
    s_cbranch_scc0 main_kernel_w_d_12
    s_mov_b32 s36, 0x4182060
    s_branch main_kernel_w_dec
main_kernel_w_d_12:
    s_mov_b32 s36, 0x67090070
    s_branch main_kernel_w_dec
main_kernel_w_d_11:
    s_cmp_lt_u32 s28, 136
    s_cbranch_scc0 main_kernel_w_d_13
    s_mov_b32 s36, 0x8082878
    s_branch main_kernel_w_dec
main_kernel_w_d_13:
    s_cmp_lt_u32 s28, 152
    s_cbranch_scc0 main_kernel_w_d_14
    s_mov_b32 s36, 0x49088088
    s_branch main_kernel_w_dec
main_kernel_w_d_14:
    s_mov_b32 s36, 0x4ad0b098
    s_branch main_kernel_w_dec
main_kernel_w_d_10:
    s_cmp_lt_u32 s28, 192
    s_cbranch_scc0 main_kernel_w_d_15
    s_cmp_lt_u32 s28, 176
    s_cbranch_scc0 main_kernel_w_d_16
    s_mov_b32 s36, 0x4a08b0a4
    s_branch main_kernel_w_dec
main_kernel_w_d_16:
    s_mov_b32 s36, 0x4810b0b0
    s_branch main_kernel_w_dec
main_kernel_w_d_15:
    s_cmp_lt_u32 s28, 208
    s_cbranch_scc0 main_kernel_w_d_17
    s_mov_b32 s36, 0x89038c0
    s_branch main_kernel_w_dec
main_kernel_w_d_17:
    s_cmp_lt_u32 s28, 224
    s_cbranch_scc0 main_kernel_w_d_18
    s_mov_b32 s36, 0x81038d0
    s_branch main_kernel_w_dec
main_kernel_w_d_18:
    s_mov_b32 s36, 0xffffffff
    s_branch main_kernel_w_dec
main_kernel_w_q1:
    s_cmp_lg_u32 s27, 1
    s_cbranch_scc1 main_kernel_w_q2
    s_cmp_lt_u32 s28, 68
    s_cbranch_scc0 main_kernel_w_d_19
    s_cmp_lt_u32 s28, 28
    s_cbranch_scc0 main_kernel_w_d_20
    s_cmp_lt_u32 s28, 4
    s_cbranch_scc0 main_kernel_w_d_21
    s_mov_b32 s36, 0x25000
    s_branch main_kernel_w_dec
main_kernel_w_d_21:
    s_cmp_lt_u32 s28, 20
    s_cbranch_scc0 main_kernel_w_d_22
    s_mov_b32 s36, 0x4a088804
    s_branch main_kernel_w_dec
main_kernel_w_d_22:
    s_mov_b32 s36, 0x64090014
    s_branch main_kernel_w_dec
main_kernel_w_d_20:
    s_cmp_lt_u32 s28, 44
    s_cbranch_scc0 main_kernel_w_d_23
    s_mov_b32 s36, 0x4b10881c
    s_branch main_kernel_w_dec
main_kernel_w_d_23:
    s_cmp_lt_u32 s28, 60
    s_cbranch_scc0 main_kernel_w_d_24
    s_mov_b32 s36, 0x41c202c
    s_branch main_kernel_w_dec
main_kernel_w_d_24:
    s_mov_b32 s36, 0x6411083c
    s_branch main_kernel_w_dec
main_kernel_w_d_19:
    s_cmp_lt_u32 s28, 104
    s_cbranch_scc0 main_kernel_w_d_25
    s_cmp_lt_u32 s28, 76
    s_cbranch_scc0 main_kernel_w_d_26
    s_mov_b32 s36, 0x66111044
    s_branch main_kernel_w_dec
main_kernel_w_d_26:
    s_cmp_lt_u32 s28, 88
    s_cbranch_scc0 main_kernel_w_d_27
    s_mov_b32 s36, 0x4ad8b04c
    s_branch main_kernel_w_dec
main_kernel_w_d_27:
    s_mov_b32 s36, 0x8183858
    s_branch main_kernel_w_dec
main_kernel_w_d_25:
    s_cmp_lt_u32 s28, 112
    s_cbranch_scc0 main_kernel_w_d_28
    s_mov_b32 s36, 0x124068
    s_branch main_kernel_w_dec
main_kernel_w_d_28:
    s_cmp_lt_u32 s28, 120
    s_cbranch_scc0 main_kernel_w_d_29
    s_mov_b32 s36, 0x144070
    s_branch main_kernel_w_dec
main_kernel_w_d_29:
    s_mov_b32 s36, 0xffffffff
    s_branch main_kernel_w_dec
main_kernel_w_q2:
    s_cmp_lg_u32 s27, 2
    s_cbranch_scc1 main_kernel_w_q3
    s_cmp_lt_u32 s28, 112
    s_cbranch_scc0 main_kernel_w_d_30
    s_cmp_lt_u32 s28, 48
    s_cbranch_scc0 main_kernel_w_d_31
    s_cmp_lt_u32 s28, 16
    s_cbranch_scc0 main_kernel_w_d_32
    s_cmp_lt_u32 s28, 8
    s_cbranch_scc0 main_kernel_w_d_33
    s_mov_b32 s36, 0x800
    s_branch main_kernel_w_dec
main_kernel_w_d_33:
    s_mov_b32 s36, 0x1008
    s_branch main_kernel_w_dec
main_kernel_w_d_32:
    s_cmp_lt_u32 s28, 24
    s_cbranch_scc0 main_kernel_w_d_34
    s_mov_b32 s36, 0x44028810
    s_branch main_kernel_w_dec
main_kernel_w_d_34:
    s_cmp_lt_u32 s28, 32
    s_cbranch_scc0 main_kernel_w_d_35
    s_mov_b32 s36, 0x44029018
    s_branch main_kernel_w_dec
main_kernel_w_d_35:
    s_mov_b32 s36, 0x48089820
    s_branch main_kernel_w_dec
main_kernel_w_d_31:
    s_cmp_lt_u32 s28, 72
    s_cbranch_scc0 main_kernel_w_d_36
    s_cmp_lt_u32 s28, 56
    s_cbranch_scc0 main_kernel_w_d_37
    s_mov_b32 s36, 0x65091030
    s_branch main_kernel_w_dec
main_kernel_w_d_37:
    s_mov_b32 s36, 0x46008038
    s_branch main_kernel_w_dec
main_kernel_w_d_36:
    s_cmp_lt_u32 s28, 88
    s_cbranch_scc0 main_kernel_w_d_38
    s_mov_b32 s36, 0x4042048
    s_branch main_kernel_w_dec
main_kernel_w_d_38:
    s_cmp_lt_u32 s28, 104
    s_cbranch_scc0 main_kernel_w_d_39
    s_mov_b32 s36, 0x46048058
    s_branch main_kernel_w_dec
main_kernel_w_d_39:
    s_mov_b32 s36, 0x65191068
    s_branch main_kernel_w_dec
main_kernel_w_d_30:
    s_cmp_lt_u32 s28, 152
    s_cbranch_scc0 main_kernel_w_d_40
    s_cmp_lt_u32 s28, 128
    s_cbranch_scc0 main_kernel_w_d_41
    s_cmp_lt_u32 s28, 120
    s_cbranch_scc0 main_kernel_w_d_42
    s_mov_b32 s36, 0x65110070
    s_branch main_kernel_w_dec
main_kernel_w_d_42:
    s_mov_b32 s36, 0x65013078
    s_branch main_kernel_w_dec
main_kernel_w_d_41:
    s_cmp_lt_u32 s28, 136
    s_cbranch_scc0 main_kernel_w_d_43
    s_mov_b32 s36, 0x66110880
    s_branch main_kernel_w_dec
main_kernel_w_d_43:
    s_cmp_lt_u32 s28, 144
    s_cbranch_scc0 main_kernel_w_d_44
    s_mov_b32 s36, 0x64093088
    s_branch main_kernel_w_dec
main_kernel_w_d_44:
    s_mov_b32 s36, 0x67110090
    s_branch main_kernel_w_dec
main_kernel_w_d_40:
    s_cmp_lt_u32 s28, 176
    s_cbranch_scc0 main_kernel_w_d_45
    s_cmp_lt_u32 s28, 160
    s_cbranch_scc0 main_kernel_w_d_46
    s_mov_b32 s36, 0x67190098
    s_branch main_kernel_w_dec
main_kernel_w_d_46:
    s_cmp_lt_u32 s28, 168
    s_cbranch_scc0 main_kernel_w_d_47
    s_mov_b32 s36, 0x671910a0
    s_branch main_kernel_w_dec
main_kernel_w_d_47:
    s_mov_b32 s36, 0x661908a8
    s_branch main_kernel_w_dec
main_kernel_w_d_45:
    s_cmp_lt_u32 s28, 184
    s_cbranch_scc0 main_kernel_w_d_48
    s_mov_b32 s36, 0x661910b0
    s_branch main_kernel_w_dec
main_kernel_w_d_48:
    s_cmp_lt_u32 s28, 200
    s_cbranch_scc0 main_kernel_w_d_49
    s_mov_b32 s36, 0x481880b8
    s_branch main_kernel_w_dec
main_kernel_w_d_49:
    s_mov_b32 s36, 0xffffffff
    s_branch main_kernel_w_dec
main_kernel_w_q3:
    s_cmp_lg_u32 s27, 3
    s_cbranch_scc1 main_kernel_w_q4
    s_cmp_lt_u32 s28, 96
    s_cbranch_scc0 main_kernel_w_d_50
    s_cmp_lt_u32 s28, 40
    s_cbranch_scc0 main_kernel_w_d_51
    s_cmp_lt_u32 s28, 16
    s_cbranch_scc0 main_kernel_w_d_52
    s_cmp_lt_u32 s28, 8
    s_cbranch_scc0 main_kernel_w_d_53
    s_mov_b32 s36, 0x1000800
    s_branch main_kernel_w_dec
main_kernel_w_d_53:
    s_mov_b32 s36, 0x1001008
    s_branch main_kernel_w_dec
main_kernel_w_d_52:
    s_cmp_lt_u32 s28, 24
    s_cbranch_scc0 main_kernel_w_d_54
    s_mov_b32 s36, 0x45028810
    s_branch main_kernel_w_dec
main_kernel_w_d_54:
    s_cmp_lt_u32 s28, 32
    s_cbranch_scc0 main_kernel_w_d_55
    s_mov_b32 s36, 0x45029018
    s_branch main_kernel_w_dec
main_kernel_w_d_55:
    s_mov_b32 s36, 0x40068820
    s_branch main_kernel_w_dec
main_kernel_w_d_51:
    s_cmp_lt_u32 s28, 64
    s_cbranch_scc0 main_kernel_w_d_56
    s_cmp_lt_u32 s28, 48
    s_cbranch_scc0 main_kernel_w_d_57
    s_mov_b32 s36, 0x64190828
    s_branch main_kernel_w_dec
main_kernel_w_d_57:
    s_cmp_lt_u32 s28, 56
    s_cbranch_scc0 main_kernel_w_d_58
    s_mov_b32 s36, 0x66091030
    s_branch main_kernel_w_dec
main_kernel_w_d_58:
    s_mov_b32 s36, 0x65110838
    s_branch main_kernel_w_dec
main_kernel_w_d_56:
    s_cmp_lt_u32 s28, 72
    s_cbranch_scc0 main_kernel_w_d_59
    s_mov_b32 s36, 0x64191040
    s_branch main_kernel_w_dec
main_kernel_w_d_59:
    s_cmp_lt_u32 s28, 88
    s_cbranch_scc0 main_kernel_w_d_60
    s_mov_b32 s36, 0x4082048
    s_branch main_kernel_w_dec
main_kernel_w_d_60:
    s_mov_b32 s36, 0x64110058
    s_branch main_kernel_w_dec
main_kernel_w_d_50:
    s_cmp_lt_u32 s28, 164
    s_cbranch_scc0 main_kernel_w_d_61
    s_cmp_lt_u32 s28, 136
    s_cbranch_scc0 main_kernel_w_d_62
    s_cmp_lt_u32 s28, 112
    s_cbranch_scc0 main_kernel_w_d_63
    s_mov_b32 s36, 0x8185060
    s_branch main_kernel_w_dec
main_kernel_w_d_63:
    s_cmp_lt_u32 s28, 128
    s_cbranch_scc0 main_kernel_w_d_64
    s_mov_b32 s36, 0x4a108070
    s_branch main_kernel_w_dec
main_kernel_w_d_64:
    s_mov_b32 s36, 0x65190880
    s_branch main_kernel_w_dec
main_kernel_w_d_62:
    s_cmp_lt_u32 s28, 144
    s_cbranch_scc0 main_kernel_w_d_65
    s_mov_b32 s36, 0x64013088
    s_branch main_kernel_w_dec
main_kernel_w_d_65:
    s_cmp_lt_u32 s28, 152
    s_cbranch_scc0 main_kernel_w_d_66
    s_mov_b32 s36, 0x64193090
    s_branch main_kernel_w_dec
main_kernel_w_d_66:
    s_mov_b32 s36, 0x4a18b098
    s_branch main_kernel_w_dec
main_kernel_w_d_61:
    s_cmp_lt_u32 s28, 204
    s_cbranch_scc0 main_kernel_w_d_67
    s_cmp_lt_u32 s28, 180
    s_cbranch_scc0 main_kernel_w_d_68
    s_mov_b32 s36, 0x80038a4
    s_branch main_kernel_w_dec
main_kernel_w_d_68:
    s_cmp_lt_u32 s28, 196
    s_cbranch_scc0 main_kernel_w_d_69
    s_mov_b32 s36, 0x88038b4
    s_branch main_kernel_w_dec
main_kernel_w_d_69:
    s_mov_b32 s36, 0xa40c4
    s_branch main_kernel_w_dec
main_kernel_w_d_67:
    s_cmp_lt_u32 s28, 212
    s_cbranch_scc0 main_kernel_w_d_70
    s_mov_b32 s36, 0x1040cc
    s_branch main_kernel_w_dec
main_kernel_w_d_70:
    s_cmp_lt_u32 s28, 220
    s_cbranch_scc0 main_kernel_w_d_71
    s_mov_b32 s36, 0x240d4
    s_branch main_kernel_w_dec
main_kernel_w_d_71:
    s_mov_b32 s36, 0xffffffff
    s_branch main_kernel_w_dec
main_kernel_w_q4:
    s_cmp_lg_u32 s27, 4
    s_cbranch_scc1 main_kernel_w_q5
    s_cmp_lt_u32 s28, 138
    s_cbranch_scc0 main_kernel_w_d_72
    s_cmp_lt_u32 s28, 56
    s_cbranch_scc0 main_kernel_w_d_73
    s_cmp_lt_u32 s28, 24
    s_cbranch_scc0 main_kernel_w_d_74
    s_cmp_lt_u32 s28, 8
    s_cbranch_scc0 main_kernel_w_d_75
    s_mov_b32 s36, 0x2000800
    s_branch main_kernel_w_dec
main_kernel_w_d_75:
    s_cmp_lt_u32 s28, 16
    s_cbranch_scc0 main_kernel_w_d_76
    s_mov_b32 s36, 0x2001008
    s_branch main_kernel_w_dec
main_kernel_w_d_76:
    s_mov_b32 s36, 0x46028810
    s_branch main_kernel_w_dec
main_kernel_w_d_74:
    s_cmp_lt_u32 s28, 32
    s_cbranch_scc0 main_kernel_w_d_77
    s_mov_b32 s36, 0x46029018
    s_branch main_kernel_w_dec
main_kernel_w_d_77:
    s_cmp_lt_u32 s28, 48
    s_cbranch_scc0 main_kernel_w_d_78
    s_mov_b32 s36, 0x48009820
    s_branch main_kernel_w_dec
main_kernel_w_d_78:
    s_mov_b32 s36, 0x64090830
    s_branch main_kernel_w_dec
main_kernel_w_d_73:
    s_cmp_lt_u32 s28, 96
    s_cbranch_scc0 main_kernel_w_d_79
    s_cmp_lt_u32 s28, 64
    s_cbranch_scc0 main_kernel_w_d_80
    s_mov_b32 s36, 0x65090838
    s_branch main_kernel_w_dec
main_kernel_w_d_80:
    s_cmp_lt_u32 s28, 80
    s_cbranch_scc0 main_kernel_w_d_81
    s_mov_b32 s36, 0x4002040
    s_branch main_kernel_w_dec
main_kernel_w_d_81:
    s_mov_b32 s36, 0x44048050
    s_branch main_kernel_w_dec
main_kernel_w_d_79:
    s_cmp_lt_u32 s28, 120
    s_cbranch_scc0 main_kernel_w_d_82
    s_cmp_lt_u32 s28, 112
    s_cbranch_scc0 main_kernel_w_d_83
    s_mov_b32 s36, 0x4b109060
    s_branch main_kernel_w_dec
main_kernel_w_d_83:
    s_mov_b32 s36, 0x64111070
    s_branch main_kernel_w_dec
main_kernel_w_d_82:
    s_cmp_lt_u32 s28, 132
    s_cbranch_scc0 main_kernel_w_d_84
    s_mov_b32 s36, 0x4a00b078
    s_branch main_kernel_w_dec
main_kernel_w_d_84:
    s_mov_b32 s36, 0x66113084
    s_branch main_kernel_w_dec
main_kernel_w_d_72:
    s_cmp_lt_u32 s28, 214
    s_cbranch_scc0 main_kernel_w_d_85
    s_cmp_lt_u32 s28, 182
    s_cbranch_scc0 main_kernel_w_d_86
    s_cmp_lt_u32 s28, 150
    s_cbranch_scc0 main_kernel_w_d_87
    s_mov_b32 s36, 0x4ac0b08a
    s_branch main_kernel_w_dec
main_kernel_w_d_87:
    s_cmp_lt_u32 s28, 166
    s_cbranch_scc0 main_kernel_w_d_88
    s_mov_b32 s36, 0x8105096
    s_branch main_kernel_w_dec
main_kernel_w_d_88:
    s_mov_b32 s36, 0x4908b0a6
    s_branch main_kernel_w_dec
main_kernel_w_d_86:
    s_cmp_lt_u32 s28, 198
    s_cbranch_scc0 main_kernel_w_d_89
    s_mov_b32 s36, 0x80838b6
    s_branch main_kernel_w_dec
main_kernel_w_d_89:
    s_cmp_lt_u32 s28, 206
    s_cbranch_scc0 main_kernel_w_d_90
    s_mov_b32 s36, 0x671908c6
    s_branch main_kernel_w_dec
main_kernel_w_d_90:
    s_mov_b32 s36, 0x661900ce
    s_branch main_kernel_w_dec
main_kernel_w_d_85:
    s_cmp_lt_u32 s28, 238
    s_cbranch_scc0 main_kernel_w_d_91
    s_cmp_lt_u32 s28, 222
    s_cbranch_scc0 main_kernel_w_d_92
    s_mov_b32 s36, 0x40d6
    s_branch main_kernel_w_dec
main_kernel_w_d_92:
    s_cmp_lt_u32 s28, 230
    s_cbranch_scc0 main_kernel_w_d_93
    s_mov_b32 s36, 0x640de
    s_branch main_kernel_w_dec
main_kernel_w_d_93:
    s_mov_b32 s36, 0xc40e6
    s_branch main_kernel_w_dec
main_kernel_w_d_91:
    s_cmp_lt_u32 s28, 254
    s_cbranch_scc0 main_kernel_w_d_94
    s_cmp_lt_u32 s28, 246
    s_cbranch_scc0 main_kernel_w_d_95
    s_mov_b32 s36, 0x840ee
    s_branch main_kernel_w_dec
main_kernel_w_d_95:
    s_mov_b32 s36, 0x440f6
    s_branch main_kernel_w_dec
main_kernel_w_d_94:
    s_cmp_lt_u32 s28, 262
    s_cbranch_scc0 main_kernel_w_d_96
    s_mov_b32 s36, 0xe40fe
    s_branch main_kernel_w_dec
main_kernel_w_d_96:
    s_mov_b32 s36, 0xffffffff
    s_branch main_kernel_w_dec
main_kernel_w_q5:
    s_cmp_lt_u32 s28, 120
    s_cbranch_scc0 main_kernel_w_d_97
    s_cmp_lt_u32 s28, 48
    s_cbranch_scc0 main_kernel_w_d_98
    s_cmp_lt_u32 s28, 16
    s_cbranch_scc0 main_kernel_w_d_99
    s_cmp_lt_u32 s28, 8
    s_cbranch_scc0 main_kernel_w_d_100
    s_mov_b32 s36, 0x3000800
    s_branch main_kernel_w_dec
main_kernel_w_d_100:
    s_mov_b32 s36, 0x3001008
    s_branch main_kernel_w_dec
main_kernel_w_d_99:
    s_cmp_lt_u32 s28, 24
    s_cbranch_scc0 main_kernel_w_d_101
    s_mov_b32 s36, 0x47028810
    s_branch main_kernel_w_dec
main_kernel_w_d_101:
    s_cmp_lt_u32 s28, 32
    s_cbranch_scc0 main_kernel_w_d_102
    s_mov_b32 s36, 0x47029018
    s_branch main_kernel_w_dec
main_kernel_w_d_102:
    s_mov_b32 s36, 0x48109820
    s_branch main_kernel_w_dec
main_kernel_w_d_98:
    s_cmp_lt_u32 s28, 80
    s_cbranch_scc0 main_kernel_w_d_103
    s_cmp_lt_u32 s28, 56
    s_cbranch_scc0 main_kernel_w_d_104
    s_mov_b32 s36, 0x42068830
    s_branch main_kernel_w_dec
main_kernel_w_d_104:
    s_cmp_lt_u32 s28, 64
    s_cbranch_scc0 main_kernel_w_d_105
    s_mov_b32 s36, 0x40069038
    s_branch main_kernel_w_dec
main_kernel_w_d_105:
    s_mov_b32 s36, 0x44008040
    s_branch main_kernel_w_dec
main_kernel_w_d_103:
    s_cmp_lt_u32 s28, 88
    s_cbranch_scc0 main_kernel_w_d_106
    s_mov_b32 s36, 0x65190050
    s_branch main_kernel_w_dec
main_kernel_w_d_106:
    s_cmp_lt_u32 s28, 104
    s_cbranch_scc0 main_kernel_w_d_107
    s_mov_b32 s36, 0x8085058
    s_branch main_kernel_w_dec
main_kernel_w_d_107:
    s_mov_b32 s36, 0x8002868
    s_branch main_kernel_w_dec
main_kernel_w_d_97:
    s_cmp_lt_u32 s28, 184
    s_cbranch_scc0 main_kernel_w_d_108
    s_cmp_lt_u32 s28, 144
    s_cbranch_scc0 main_kernel_w_d_109
    s_cmp_lt_u32 s28, 136
    s_cbranch_scc0 main_kernel_w_d_110
    s_mov_b32 s36, 0x40c2078
    s_branch main_kernel_w_dec
main_kernel_w_d_110:
    s_mov_b32 s36, 0x66090088
    s_branch main_kernel_w_dec
main_kernel_w_d_109:
    s_cmp_lt_u32 s28, 152
    s_cbranch_scc0 main_kernel_w_d_111
    s_mov_b32 s36, 0x65111090
    s_branch main_kernel_w_dec
main_kernel_w_d_111:
    s_cmp_lt_u32 s28, 168
    s_cbranch_scc0 main_kernel_w_d_112
    s_mov_b32 s36, 0x8102898
    s_branch main_kernel_w_dec
main_kernel_w_d_112:
    s_mov_b32 s36, 0x81828a8
    s_branch main_kernel_w_dec
main_kernel_w_d_108:
    s_cmp_lt_u32 s28, 212
    s_cbranch_scc0 main_kernel_w_d_113
    s_cmp_lt_u32 s28, 192
    s_cbranch_scc0 main_kernel_w_d_114
    s_mov_b32 s36, 0x651130b8
    s_branch main_kernel_w_dec
main_kernel_w_d_114:
    s_cmp_lt_u32 s28, 200
    s_cbranch_scc0 main_kernel_w_d_115
    s_mov_b32 s36, 0x651930c0
    s_branch main_kernel_w_dec
main_kernel_w_d_115:
    s_mov_b32 s36, 0x4ac8b0c8
    s_branch main_kernel_w_dec
main_kernel_w_d_113:
    s_cmp_lt_u32 s28, 228
    s_cbranch_scc0 main_kernel_w_d_116
    s_mov_b32 s36, 0x88838d4
    s_branch main_kernel_w_dec
main_kernel_w_d_116:
    s_cmp_lt_u32 s28, 244
    s_cbranch_scc0 main_kernel_w_d_117
    s_mov_b32 s36, 0x89838e4
    s_branch main_kernel_w_dec
main_kernel_w_d_117:
    s_mov_b32 s36, 0xffffffff
    s_branch main_kernel_w_dec
main_kernel_w_dec:
    s_cmp_lg_u32 s36, -1
    s_cbranch_scc1 main_kernel_w_got
    s_add_u32 s27, s27, 1
    s_cmp_ge_u32 s27, 6
    s_cselect_b32 s27, 0, s27
    s_add_u32 s52, s52, 1
    s_lshl_b32 s32, 1, s12
    s_and_b32 s32, s32, 116
    s_cselect_b32 s36, -2, -1
    s_cbranch_scc1 main_kernel_w_pub
    s_lshl_b32 s32, s12, 5
    s_add_u32 s32, s32, s13
    s_sub_u32 s32, s32, 224
    s_cmp_lt_u32 s32, 16
    s_cselect_b32 s52, 6, s52
    s_cmp_lt_u32 s52, 6
    s_cbranch_scc1 main_kernel_w_try
    s_lshl_b32 s32, s12, 5
    s_add_u32 s32, s32, s13
    s_sub_u32 s32, s32, 160
    s_cmp_lt_u32 s32, 80
    s_cselect_b32 s36, -3, -1
    s_cmp_lt_u32 s32, 64
    s_cselect_b32 s36, -2, s36
    s_branch main_kernel_w_pub
main_kernel_w_got:
    s_and_b32 s32, s36, 0x7ff
    s_sub_u32 s28, s28, s32
    s_bfe_u32 s32, s36, 0x3001a
    s_lshr_b32 s25, s28, s32
    s_lshl_b32 s33, s25, s32
    s_sub_u32 s24, s28, s33
    s_bfe_u32 s34, s36, 0x1001d
    s_lshl_b32 s24, s24, s34
    s_bfe_u32 s35, s36, 0x1001e
    s_lshl_b32 s25, s25, s35
    s_bfe_u32 s32, s36, 0x40011
    s_add_u32 s24, s24, s32
    s_bfe_u32 s32, s36, 0x50015
    s_add_u32 s25, s25, s32
    s_bfe_u32 s23, s36, 0x4000b
    s_bfe_u32 s36, s36, 0x6000b
    s_lshl_b32 s32, s24, 8
    s_or_b32 s36, s36, s32
    s_lshl_b32 s32, s25, 16
    s_or_b32 s36, s36, s32
    s_cmp_eq_u32 s23, 8
    s_cbranch_scc1 main_kernel_w_dwo
    s_cmp_ge_u32 s23, 10
    s_cbranch_scc1 main_kernel_w_pub
    s_mov_b32 s48, s24
    s_add_u32 s49, s24, s34
    s_mov_b32 s50, 4
    s_mov_b32 s51, 7
    s_cmp_lg_u32 s23, 4
    s_cbranch_scc1 main_kernel_w_dp1
    s_sub_u32 s48, s48, 1
    s_max_i32 s48, s48, 0
    s_add_u32 s49, s49, 1
    s_min_u32 s49, s49, 15
main_kernel_w_dp1:
    s_cmp_eq_u32 s23, 6
    s_cselect_b32 s51, 3, s51
    s_cmp_eq_u32 s23, 7
    s_cselect_b32 s51, 27, s51
    s_cselect_b32 s50, 5, s50
    v_lshrrev_b32 v253, s50, v250
    v_lshlrev_b32 v254, s50, v253
    v_sub_u32 v254, v250, v254
    v_min_u32 v254, s51, v254
    v_add_u32 v253, s48, v253
    v_min_u32 v253, s49, v253
    v_lshlrev_b32 v253, 9, v253
    v_lshl_add_u32 v253, v254, 4, v253
    s_cmp_lt_u32 s23, 4
    s_cselect_b32 s39, 10, s23
    s_lshl_b32 s39, s39, 13
    s_cmp_eq_u32 s23, 3
    s_cselect_b32 s32, 4, 0
    s_add_u32 s39, s39, s32
    s_add_u32 s39, s39, 0x8402000
main_kernel_w_poll:
    buffer_load_dword v254, v253, s[4:7], s39 offen sc1
    s_waitcnt vmcnt(0)
    v_cmp_eq_u32 vcc, 0, v254
    s_cmp_eq_u32 s57, 0
    s_cbranch_scc1 main_kernel_w_fl2
    s_waitcnt vmcnt(0)
    s_barrier
    v_mov_b32 v4, 1
    v_mov_b32 v5, 1
    v_mov_b32 v6, 1
    v_mov_b32 v7, 1
    s_bfm_b64 exec, s57, 0
    buffer_store_dwordx4 v[4:7], v249, s[4:7], s56 offen sc1
    s_mov_b64 exec, -1
    s_mov_b32 s57, 0
main_kernel_w_fl2:
    s_cbranch_vccz main_kernel_w_pub
    s_sleep 8
    s_sub_u32 s29, s29, 1
    s_cbranch_scc0 main_kernel_w_poll
    s_mov_b32 s36, -1
    s_branch main_kernel_w_pub
main_kernel_w_dwo:
    s_lshl_b32 s39, s24, 10
    s_add_u32 s39, s39, 0x8400000
main_kernel_w_pollo:
    buffer_load_dwordx4 v[0:3], v251, s[4:7], s39 offen sc1
    s_waitcnt vmcnt(0)
    v_min3_u32 v0, v0, v1, v2
    v_min_u32 v0, v0, v3
    v_cmp_eq_u32 vcc, 0, v0
    s_cmp_eq_u32 s57, 0
    s_cbranch_scc1 main_kernel_w_fl3
    s_waitcnt vmcnt(0)
    s_barrier
    v_mov_b32 v4, 1
    v_mov_b32 v5, 1
    v_mov_b32 v6, 1
    v_mov_b32 v7, 1
    s_bfm_b64 exec, s57, 0
    buffer_store_dwordx4 v[4:7], v249, s[4:7], s56 offen sc1
    s_mov_b64 exec, -1
    s_mov_b32 s57, 0
main_kernel_w_fl3:
    s_cbranch_vccz main_kernel_w_pub
    s_sleep 16
    s_sub_u32 s29, s29, 1
    s_cbranch_scc0 main_kernel_w_pollo
    s_mov_b32 s36, -1
    s_branch main_kernel_w_pub
main_kernel_w_oko:
    v_min_u32 v253, s35, v250
    v_add_u32 v253, s25, v253
    v_lshlrev_b32 v253, 8, v253
    s_lshl_b32 s39, s24, 4
    s_add_u32 s39, s39, 0x8412000
    s_branch main_kernel_w_poll
main_kernel_w_pub:
    s_cmp_eq_u32 s57, 0
    s_cbranch_scc1 main_kernel_w_fl4
    s_waitcnt vmcnt(0)
    s_barrier
    v_mov_b32 v4, 1
    v_mov_b32 v5, 1
    v_mov_b32 v6, 1
    v_mov_b32 v7, 1
    s_bfm_b64 exec, s57, 0
    buffer_store_dwordx4 v[4:7], v249, s[4:7], s56 offen sc1
    s_mov_b64 exec, -1
    s_mov_b32 s57, 0
main_kernel_w_fl4:
    v_mov_b32 v253, 131072
    v_mov_b32 v254, s36
    ds_write_b32 v253, v254
    s_waitcnt lgkmcnt(0)
main_kernel_w_bar:
    s_barrier
    v_mov_b32 v253, 131072
    ds_read_b32 v254, v253
    s_waitcnt lgkmcnt(0)
    v_readfirstlane_b32 s36, v254
    s_nop 3
    s_cmp_eq_u32 s36, -1
    s_cbranch_scc1 main_kernel_end2
    s_cmp_eq_u32 s36, -2
    s_cbranch_scc1 main_kernel_wo
    s_cmp_eq_u32 s36, -3
    s_cbranch_scc1 main_kernel_att2
    s_mov_b32 s55, -1
    s_and_b32 s23, s36, 15
    s_bfe_u32 s54, s36, 0x20004
    s_bfe_u32 s24, s36, 0x80008
    s_lshr_b32 s25, s36, 16
    s_cmp_eq_u32 s23, 5
    s_cbranch_scc1 main_kernel_w_ln2
    s_cmp_eq_u32 s23, 10
    s_cbranch_scc1 main_kernel_w_fill
    s_cmp_eq_u32 s23, 11
    s_cbranch_scc1 main_kernel_w_pref
    s_cmp_eq_u32 s54, 1
    s_cbranch_scc1 main_kernel_w_c1_task
    s_cmp_eq_u32 s54, 2
    s_cbranch_scc1 main_kernel_w_c2_task
main_kernel_w_c0_task:
    s_cmp_eq_u32 s23, 1
    s_cbranch_scc1 main_kernel_w_c0_set1
    s_cmp_eq_u32 s23, 2
    s_cbranch_scc1 main_kernel_w_c0_set2
    s_cmp_eq_u32 s23, 4
    s_cbranch_scc1 main_kernel_w_c0_set4
    s_cmp_eq_u32 s23, 7
    s_cbranch_scc1 main_kernel_w_c0_set7
    s_cmp_eq_u32 s23, 8
    s_cbranch_scc1 main_kernel_w_c0_set8
    s_branch main_kernel_w_done
main_kernel_w_c0_set1:
    s_lshl_b32 s32, s25, 8
    s_add_u32 s8, s42, s32
    s_addc_u32 s9, s43, 0
    s_and_b32 s9, s9, 0xffff
    s_sub_u32 s10, 0x800000, s32
    s_mov_b32 s11, 0x20000
    s_mov_b32 s30, 8192
    s_mov_b32 s31, 32768
    s_mul_i32 s16, s24, 262144
    s_add_u32 s16, s16, 0x0
    s_mov_b32 s18, 3
    s_lshl_b32 s32, s24, 3
    s_mul_i32 s33, s38, 4
    s_add_u32 s32, s32, s33
    s_mul_i32 s32, s32, 131072
    s_lshl_b32 s33, s25, 12
    s_add_u32 s32, s32, s33
    s_mul_i32 s33, s37, 2048
    s_add_u32 s32, s32, s33
    s_add_u32 s21, s32, 0x1800000
    s_mov_b32 s22, 131072
    s_mov_b32 s26, -1
    s_branch main_kernel_w_c0_go
main_kernel_w_c0_set2:
    s_lshl_b32 s32, s25, 8
    s_add_u32 s8, s44, s32
    s_addc_u32 s9, s45, 0
    s_and_b32 s9, s9, 0xffff
    s_sub_u32 s10, 0x800000, s32
    s_mov_b32 s11, 0x20000
    s_mov_b32 s30, 8192
    s_mov_b32 s31, 32768
    s_mul_i32 s16, s24, 262144
    s_add_u32 s16, s16, 0x0
    s_mov_b32 s18, 3
    s_lshl_b32 s32, s24, 2
    s_mul_i32 s33, s38, 2
    s_add_u32 s32, s32, s33
    s_lshl_b32 s32, s32, 18
    s_lshl_b32 s33, s25, 13
    s_add_u32 s32, s32, s33
    s_mul_i32 s33, s37, 4096
    s_add_u32 s32, s32, s33
    s_add_u32 s21, s32, 0x2800000
    s_branch main_kernel_w_c0_gov
main_kernel_w_c0_set4:
    s_lshl_b32 s32, s25, 8
    s_add_u32 s8, s66, s32
    s_addc_u32 s9, s67, 0
    s_and_b32 s9, s9, 0xffff
    s_sub_u32 s10, 0x200000, s32
    s_mov_b32 s11, 0x20000
    s_mov_b32 s30, 2048
    s_mov_b32 s31, 32768
    s_mul_i32 s16, s24, 262144
    s_add_u32 s16, s16, 0x4808000
    s_mov_b32 s18, 3
    s_lshl_b32 s32, s24, 3
    s_mul_i32 s33, s38, 4
    s_add_u32 s32, s32, s33
    s_mul_i32 s32, s32, 32768
    s_lshl_b32 s33, s25, 12
    s_add_u32 s32, s32, s33
    s_mul_i32 s33, s37, 2048
    s_add_u32 s32, s32, s33
    s_add_u32 s21, s32, 0x5000000
    s_mov_b32 s22, 32768
    s_add_u32 s26, s32, 0x0
    s_branch main_kernel_w_c0_go
main_kernel_w_c0_set7:
    s_lshl_b32 s32, s25, 8
    s_add_u32 s8, s70, s32
    s_addc_u32 s9, s71, 0
    s_and_b32 s9, s9, 0xffff
    s_sub_u32 s10, 0x700000, s32
    s_mov_b32 s11, 0x20000
    s_mov_b32 s30, 2048
    s_mov_b32 s31, 114688
    s_mul_i32 s16, s24, 917504
    s_add_u32 s16, s16, 0x5400000
    s_mov_b32 s18, 13
    s_lshl_b32 s32, s24, 3
    s_mul_i32 s33, s38, 4
    s_add_u32 s32, s32, s33
    s_mul_i32 s32, s32, 32768
    s_lshl_b32 s33, s25, 12
    s_add_u32 s32, s32, s33
    s_mul_i32 s33, s37, 2048
    s_add_u32 s32, s32, s33
    s_add_u32 s21, s32, 0x6400000
    s_mov_b32 s22, 32768
    s_add_u32 s26, s32, 0x5000000
    s_branch main_kernel_w_c0_go
main_kernel_w_c0_set8:
    s_lshl_b32 s32, s25, 8
    s_add_u32 s8, s46, s32
    s_addc_u32 s9, s47, 0
    s_and_b32 s9, s9, 0xffff
    s_sub_u32 s10, 0x800000, s32
    s_mov_b32 s11, 0x20000
    s_mov_b32 s30, 2048
    s_mov_b32 s31, 131072
    s_mul_i32 s16, s24, 1048576
    s_add_u32 s16, s16, 0x3800000
    s_mov_b32 s18, 15
    s_lshl_b32 s32, s24, 3
    s_mul_i32 s33, s38, 4
    s_add_u32 s32, s32, s33
    s_mul_i32 s32, s32, 32768
    s_lshl_b32 s33, s25, 8
    s_add_u32 s34, s32, s33
    s_mul_i32 s33, s37, 128
    s_add_u32 s34, s34, s33
    s_lshl_b32 s33, s25, 12
    s_add_u32 s32, s32, s33
    s_mul_i32 s33, s37, 2048
    s_add_u32 s32, s32, s33
    s_add_u32 s21, s32, 0x0
    s_mov_b32 s22, 32768
    s_add_u32 s26, s32, 0x6400000
    s_mov_b32 s21, s34
    v_and_b32 v253, 15, v250
    v_and_b32 v254, 48, v250
    v_lshl_add_u32 v252, v253, 11, v254
    s_branch main_kernel_w_c0_go
main_kernel_w_c0_go:
    v_lshrrev_b32 v0, 4, v250
    v_bfe_u32 v1, v250, 2, 2
    v_lshl_add_u32 v4, v0, 2, v1
    v_and_b32 v5, 7, v4
    v_mul_u32_u24 v4, 256, v4
    v_and_b32 v6, 3, v250
    v_lshl_add_u32 v4, v6, 3, v4
    s_mul_i32 s32, s37, 4
    v_xor_b32 v5, s32, v5
    v_lshl_add_u32 v128, v5, 5, v4
    v_xor_b32 v129, 32, v128
    v_xor_b32 v130, 64, v128
    v_xor_b32 v131, 96, v128
    s_mul_i32 s32, s38, 8192
    s_add_u32 s32, s32, 65536
    v_add_u32 v136, s32, v251
    v_lshrrev_b32 v2, 4, v250
    v_and_b32 v3, 15, v250
    s_mul_i32 s32, s14, 16
    v_add_u32 v4, s32, v2
    v_add_u32 v5, 0, v4
    v_and_b32 v6, 7, v5
    v_lshlrev_b32 v6, 1, v6
    v_xor_b32 v6, v6, v3
    v_mul_lo_u32 v5, v5, s30
    v_lshl_add_u32 v5, v6, 4, v5
    v_subrev_u32 v137, 0, v5
    v_add_u32 v5, 4, v4
    v_and_b32 v6, 7, v5
    v_lshlrev_b32 v6, 1, v6
    v_xor_b32 v6, v6, v3
    v_mul_lo_u32 v5, v5, s30
    v_lshl_add_u32 v5, v6, 4, v5
    v_subrev_u32 v138, 1024, v5
    v_add_u32 v5, 8, v4
    v_and_b32 v6, 7, v5
    v_lshlrev_b32 v6, 1, v6
    v_xor_b32 v6, v6, v3
    v_mul_lo_u32 v5, v5, s30
    v_lshl_add_u32 v5, v6, 4, v5
    v_subrev_u32 v139, 2048, v5
    v_add_u32 v5, 12, v4
    v_and_b32 v6, 7, v5
    v_lshlrev_b32 v6, 1, v6
    v_xor_b32 v6, v6, v3
    v_mul_lo_u32 v5, v5, s30
    v_lshl_add_u32 v5, v6, 4, v5
    v_subrev_u32 v140, 3072, v5
    s_mul_i32 s32, s14, 2
    s_mul_i32 s32, s32, s31
    v_add_u32 v141, s32, v251
    s_add_u32 s32, s32, s31
    s_sub_u32 s32, s32, 2048
    v_add_u32 v142, s32, v251
    s_mul_i32 s19, s14, 4096
    s_mul_i32 s20, s14, 4096
    s_add_u32 s20, s20, 65536
    s_mul_i32 s17, s30, 64
    s_mov_b32 s15, 0
    s_add_u32 m0, s20, 0
    s_nop 0
    buffer_load_dwordx4 v141, s[4:7], s16 offen offset:0 sc1 lds
    buffer_load_dwordx4 v141, s[4:7], s16 offen offset:1024 sc1 lds
    buffer_load_dwordx4 v142, s[4:7], s16 offen offset:2048 sc1 lds
    buffer_load_dwordx4 v142, s[4:7], s16 offen offset:3072 sc1 lds
    s_add_u32 s16, s16, 2048
    s_add_u32 m0, s19, 0
    s_nop 0
    buffer_load_dwordx4 v137, s[8:11], s15 offen offset:0 lds
    buffer_load_dwordx4 v138, s[8:11], s15 offen offset:1024 lds
    buffer_load_dwordx4 v139, s[8:11], s15 offen offset:2048 lds
    buffer_load_dwordx4 v140, s[8:11], s15 offen offset:3072 lds
    s_add_u32 s15, s15, s17
    s_add_u32 m0, s20, 16384
    s_nop 0
    buffer_load_dwordx4 v141, s[4:7], s16 offen offset:0 sc1 lds
    buffer_load_dwordx4 v141, s[4:7], s16 offen offset:1024 sc1 lds
    buffer_load_dwordx4 v142, s[4:7], s16 offen offset:2048 sc1 lds
    buffer_load_dwordx4 v142, s[4:7], s16 offen offset:3072 sc1 lds
    s_add_u32 s16, s16, 2048
    s_add_u32 m0, s19, 16384
    s_nop 0
    buffer_load_dwordx4 v137, s[8:11], s15 offen offset:0 lds
    buffer_load_dwordx4 v138, s[8:11], s15 offen offset:1024 lds
    buffer_load_dwordx4 v139, s[8:11], s15 offen offset:2048 lds
    buffer_load_dwordx4 v140, s[8:11], s15 offen offset:3072 lds
    s_add_u32 s15, s15, s17
    s_add_u32 m0, s20, 32768
    s_nop 0
    buffer_load_dwordx4 v141, s[4:7], s16 offen offset:0 sc1 lds
    buffer_load_dwordx4 v141, s[4:7], s16 offen offset:1024 sc1 lds
    buffer_load_dwordx4 v142, s[4:7], s16 offen offset:2048 sc1 lds
    buffer_load_dwordx4 v142, s[4:7], s16 offen offset:3072 sc1 lds
    s_add_u32 s16, s16, 2048
    s_add_u32 m0, s19, 32768
    s_nop 0
    buffer_load_dwordx4 v137, s[8:11], s15 offen offset:0 lds
    buffer_load_dwordx4 v138, s[8:11], s15 offen offset:1024 lds
    buffer_load_dwordx4 v139, s[8:11], s15 offen offset:2048 lds
    buffer_load_dwordx4 v140, s[8:11], s15 offen offset:3072 lds
    s_add_u32 s15, s15, s17
    s_add_u32 m0, s20, 49152
    s_nop 0
    buffer_load_dwordx4 v141, s[4:7], s16 offen offset:0 sc1 lds
    buffer_load_dwordx4 v141, s[4:7], s16 offen offset:1024 sc1 lds
    buffer_load_dwordx4 v142, s[4:7], s16 offen offset:2048 sc1 lds
    buffer_load_dwordx4 v142, s[4:7], s16 offen offset:3072 sc1 lds
    s_add_u32 s16, s16, 2048
    v_mov_b32 v64, 0
    v_mov_b32 v65, 0
    v_mov_b32 v66, 0
    v_mov_b32 v67, 0
    v_mov_b32 v68, 0
    v_mov_b32 v69, 0
    v_mov_b32 v70, 0
    v_mov_b32 v71, 0
    v_mov_b32 v72, 0
    v_mov_b32 v73, 0
    v_mov_b32 v74, 0
    v_mov_b32 v75, 0
    v_mov_b32 v76, 0
    v_mov_b32 v77, 0
    v_mov_b32 v78, 0
    v_mov_b32 v79, 0
    v_mov_b32 v80, 0
    v_mov_b32 v81, 0
    v_mov_b32 v82, 0
    v_mov_b32 v83, 0
    v_mov_b32 v84, 0
    v_mov_b32 v85, 0
    v_mov_b32 v86, 0
    v_mov_b32 v87, 0
    v_mov_b32 v88, 0
    v_mov_b32 v89, 0
    v_mov_b32 v90, 0
    v_mov_b32 v91, 0
    v_mov_b32 v92, 0
    v_mov_b32 v93, 0
    v_mov_b32 v94, 0
    v_mov_b32 v95, 0
    v_mov_b32 v96, 0
    v_mov_b32 v97, 0
    v_mov_b32 v98, 0
    v_mov_b32 v99, 0
    v_mov_b32 v100, 0
    v_mov_b32 v101, 0
    v_mov_b32 v102, 0
    v_mov_b32 v103, 0
    v_mov_b32 v104, 0
    v_mov_b32 v105, 0
    v_mov_b32 v106, 0
    v_mov_b32 v107, 0
    v_mov_b32 v108, 0
    v_mov_b32 v109, 0
    v_mov_b32 v110, 0
    v_mov_b32 v111, 0
    v_mov_b32 v112, 0
    v_mov_b32 v113, 0
    v_mov_b32 v114, 0
    v_mov_b32 v115, 0
    v_mov_b32 v116, 0
    v_mov_b32 v117, 0
    v_mov_b32 v118, 0
    v_mov_b32 v119, 0
    v_mov_b32 v120, 0
    v_mov_b32 v121, 0
    v_mov_b32 v122, 0
    v_mov_b32 v123, 0
    v_mov_b32 v124, 0
    v_mov_b32 v125, 0
    v_mov_b32 v126, 0
    v_mov_b32 v127, 0
    s_waitcnt vmcnt(20)
    s_barrier
    ds_read_b128 v[16:19], v136 offset:0
    ds_read_b64_tr_b16 v[0:1], v128 offset:0
    ds_read_b64_tr_b16 v[2:3], v128 offset:4096
    ds_read_b64_tr_b16 v[4:5], v129 offset:0
    ds_read_b64_tr_b16 v[6:7], v129 offset:4096
    ds_read_b64_tr_b16 v[8:9], v130 offset:0
    ds_read_b64_tr_b16 v[10:11], v130 offset:4096
    ds_read_b64_tr_b16 v[12:13], v131 offset:0
    ds_read_b64_tr_b16 v[14:15], v131 offset:4096
    ds_read_b128 v[20:23], v136 offset:2048
    ds_read_b128 v[24:27], v136 offset:4096
    ds_read_b128 v[28:31], v136 offset:6144
main_kernel_w_c0_n_loop:
    s_waitcnt lgkmcnt(0)
    ds_read_b128 v[48:51], v136 offset:1024
    s_add_u32 m0, s19, 49152
    s_nop 0
    v_mfma_f32_16x16x32_bf16 v[64:67], v[0:3], v[16:19], v[64:67]
    ds_read_b64_tr_b16 v[32:33], v128 offset:8192
    v_mfma_f32_16x16x32_bf16 v[68:71], v[4:7], v[16:19], v[68:71]
    ds_read_b64_tr_b16 v[34:35], v128 offset:12288
    buffer_load_dwordx4 v137, s[8:11], s15 offen offset:0 lds
    v_mfma_f32_16x16x32_bf16 v[72:75], v[8:11], v[16:19], v[72:75]
    ds_read_b64_tr_b16 v[36:37], v129 offset:8192
    v_mfma_f32_16x16x32_bf16 v[76:79], v[12:15], v[16:19], v[76:79]
    ds_read_b64_tr_b16 v[38:39], v129 offset:12288
    v_mfma_f32_16x16x32_bf16 v[80:83], v[0:3], v[20:23], v[80:83]
    ds_read_b64_tr_b16 v[40:41], v130 offset:8192
    buffer_load_dwordx4 v138, s[8:11], s15 offen offset:1024 lds
    v_mfma_f32_16x16x32_bf16 v[84:87], v[4:7], v[20:23], v[84:87]
    ds_read_b64_tr_b16 v[42:43], v130 offset:12288
    v_mfma_f32_16x16x32_bf16 v[88:91], v[8:11], v[20:23], v[88:91]
    ds_read_b64_tr_b16 v[44:45], v131 offset:8192
    v_mfma_f32_16x16x32_bf16 v[92:95], v[12:15], v[20:23], v[92:95]
    ds_read_b64_tr_b16 v[46:47], v131 offset:12288
    buffer_load_dwordx4 v139, s[8:11], s15 offen offset:2048 lds
    v_mfma_f32_16x16x32_bf16 v[96:99], v[0:3], v[24:27], v[96:99]
    ds_read_b128 v[52:55], v136 offset:3072
    v_mfma_f32_16x16x32_bf16 v[100:103], v[4:7], v[24:27], v[100:103]
    ds_read_b128 v[56:59], v136 offset:5120
    buffer_load_dwordx4 v140, s[8:11], s15 offen offset:3072 lds
    v_mfma_f32_16x16x32_bf16 v[104:107], v[8:11], v[24:27], v[104:107]
    ds_read_b128 v[60:63], v136 offset:7168
    v_mfma_f32_16x16x32_bf16 v[108:111], v[12:15], v[24:27], v[108:111]
    v_mfma_f32_16x16x32_bf16 v[112:115], v[0:3], v[28:31], v[112:115]
    s_add_u32 s15, s15, s17
    v_mfma_f32_16x16x32_bf16 v[116:119], v[4:7], v[28:31], v[116:119]
    v_mfma_f32_16x16x32_bf16 v[120:123], v[8:11], v[28:31], v[120:123]
    v_mfma_f32_16x16x32_bf16 v[124:127], v[12:15], v[28:31], v[124:127]
    s_waitcnt lgkmcnt(0)
    v_mfma_f32_16x16x32_bf16 v[64:67], v[32:35], v[48:51], v[64:67]
    s_waitcnt vmcnt(16)
    s_barrier
    ds_read_b128 v[16:19], v136 offset:16384
    s_add_u32 m0, s20, 0
    s_nop 0
    v_mfma_f32_16x16x32_bf16 v[68:71], v[36:39], v[48:51], v[68:71]
    ds_read_b64_tr_b16 v[0:1], v128 offset:16384
    v_mfma_f32_16x16x32_bf16 v[72:75], v[40:43], v[48:51], v[72:75]
    ds_read_b64_tr_b16 v[2:3], v128 offset:20480
    buffer_load_dwordx4 v141, s[4:7], s16 offen offset:0 sc1 lds
    v_mfma_f32_16x16x32_bf16 v[76:79], v[44:47], v[48:51], v[76:79]
    ds_read_b64_tr_b16 v[4:5], v129 offset:16384
    v_mfma_f32_16x16x32_bf16 v[80:83], v[32:35], v[52:55], v[80:83]
    ds_read_b64_tr_b16 v[6:7], v129 offset:20480
    v_mfma_f32_16x16x32_bf16 v[84:87], v[36:39], v[52:55], v[84:87]
    ds_read_b64_tr_b16 v[8:9], v130 offset:16384
    buffer_load_dwordx4 v141, s[4:7], s16 offen offset:1024 sc1 lds
    v_mfma_f32_16x16x32_bf16 v[88:91], v[40:43], v[52:55], v[88:91]
    ds_read_b64_tr_b16 v[10:11], v130 offset:20480
    v_mfma_f32_16x16x32_bf16 v[92:95], v[44:47], v[52:55], v[92:95]
    ds_read_b64_tr_b16 v[12:13], v131 offset:16384
    buffer_load_dwordx4 v142, s[4:7], s16 offen offset:2048 sc1 lds
    v_mfma_f32_16x16x32_bf16 v[96:99], v[32:35], v[56:59], v[96:99]
    ds_read_b64_tr_b16 v[14:15], v131 offset:20480
    v_mfma_f32_16x16x32_bf16 v[100:103], v[36:39], v[56:59], v[100:103]
    ds_read_b128 v[20:23], v136 offset:18432
    v_mfma_f32_16x16x32_bf16 v[104:107], v[40:43], v[56:59], v[104:107]
    ds_read_b128 v[24:27], v136 offset:20480
    buffer_load_dwordx4 v142, s[4:7], s16 offen offset:3072 sc1 lds
    v_mfma_f32_16x16x32_bf16 v[108:111], v[44:47], v[56:59], v[108:111]
    ds_read_b128 v[28:31], v136 offset:22528
    v_mfma_f32_16x16x32_bf16 v[112:115], v[32:35], v[60:63], v[112:115]
    s_add_u32 s16, s16, 2048
    v_mfma_f32_16x16x32_bf16 v[116:119], v[36:39], v[60:63], v[116:119]
    v_mfma_f32_16x16x32_bf16 v[120:123], v[40:43], v[60:63], v[120:123]
    v_mfma_f32_16x16x32_bf16 v[124:127], v[44:47], v[60:63], v[124:127]
    s_waitcnt lgkmcnt(0)
    ds_read_b128 v[48:51], v136 offset:17408
    s_add_u32 m0, s19, 0
    s_nop 0
    v_mfma_f32_16x16x32_bf16 v[64:67], v[0:3], v[16:19], v[64:67]
    ds_read_b64_tr_b16 v[32:33], v128 offset:24576
    v_mfma_f32_16x16x32_bf16 v[68:71], v[4:7], v[16:19], v[68:71]
    ds_read_b64_tr_b16 v[34:35], v128 offset:28672
    buffer_load_dwordx4 v137, s[8:11], s15 offen offset:0 lds
    v_mfma_f32_16x16x32_bf16 v[72:75], v[8:11], v[16:19], v[72:75]
    ds_read_b64_tr_b16 v[36:37], v129 offset:24576
    v_mfma_f32_16x16x32_bf16 v[76:79], v[12:15], v[16:19], v[76:79]
    ds_read_b64_tr_b16 v[38:39], v129 offset:28672
    v_mfma_f32_16x16x32_bf16 v[80:83], v[0:3], v[20:23], v[80:83]
    ds_read_b64_tr_b16 v[40:41], v130 offset:24576
    buffer_load_dwordx4 v138, s[8:11], s15 offen offset:1024 lds
    v_mfma_f32_16x16x32_bf16 v[84:87], v[4:7], v[20:23], v[84:87]
    ds_read_b64_tr_b16 v[42:43], v130 offset:28672
    v_mfma_f32_16x16x32_bf16 v[88:91], v[8:11], v[20:23], v[88:91]
    ds_read_b64_tr_b16 v[44:45], v131 offset:24576
    v_mfma_f32_16x16x32_bf16 v[92:95], v[12:15], v[20:23], v[92:95]
    ds_read_b64_tr_b16 v[46:47], v131 offset:28672
    buffer_load_dwordx4 v139, s[8:11], s15 offen offset:2048 lds
    v_mfma_f32_16x16x32_bf16 v[96:99], v[0:3], v[24:27], v[96:99]
    ds_read_b128 v[52:55], v136 offset:19456
    v_mfma_f32_16x16x32_bf16 v[100:103], v[4:7], v[24:27], v[100:103]
    ds_read_b128 v[56:59], v136 offset:21504
    buffer_load_dwordx4 v140, s[8:11], s15 offen offset:3072 lds
    v_mfma_f32_16x16x32_bf16 v[104:107], v[8:11], v[24:27], v[104:107]
    ds_read_b128 v[60:63], v136 offset:23552
    v_mfma_f32_16x16x32_bf16 v[108:111], v[12:15], v[24:27], v[108:111]
    v_mfma_f32_16x16x32_bf16 v[112:115], v[0:3], v[28:31], v[112:115]
    s_add_u32 s15, s15, s17
    v_mfma_f32_16x16x32_bf16 v[116:119], v[4:7], v[28:31], v[116:119]
    v_mfma_f32_16x16x32_bf16 v[120:123], v[8:11], v[28:31], v[120:123]
    v_mfma_f32_16x16x32_bf16 v[124:127], v[12:15], v[28:31], v[124:127]
    s_waitcnt lgkmcnt(0)
    v_mfma_f32_16x16x32_bf16 v[64:67], v[32:35], v[48:51], v[64:67]
    s_waitcnt vmcnt(16)
    s_barrier
    ds_read_b128 v[16:19], v136 offset:32768
    s_add_u32 m0, s20, 16384
    s_nop 0
    v_mfma_f32_16x16x32_bf16 v[68:71], v[36:39], v[48:51], v[68:71]
    ds_read_b64_tr_b16 v[0:1], v128 offset:32768
    v_mfma_f32_16x16x32_bf16 v[72:75], v[40:43], v[48:51], v[72:75]
    ds_read_b64_tr_b16 v[2:3], v128 offset:36864
    buffer_load_dwordx4 v141, s[4:7], s16 offen offset:0 sc1 lds
    v_mfma_f32_16x16x32_bf16 v[76:79], v[44:47], v[48:51], v[76:79]
    ds_read_b64_tr_b16 v[4:5], v129 offset:32768
    v_mfma_f32_16x16x32_bf16 v[80:83], v[32:35], v[52:55], v[80:83]
    ds_read_b64_tr_b16 v[6:7], v129 offset:36864
    v_mfma_f32_16x16x32_bf16 v[84:87], v[36:39], v[52:55], v[84:87]
    ds_read_b64_tr_b16 v[8:9], v130 offset:32768
    buffer_load_dwordx4 v141, s[4:7], s16 offen offset:1024 sc1 lds
    v_mfma_f32_16x16x32_bf16 v[88:91], v[40:43], v[52:55], v[88:91]
    ds_read_b64_tr_b16 v[10:11], v130 offset:36864
    v_mfma_f32_16x16x32_bf16 v[92:95], v[44:47], v[52:55], v[92:95]
    ds_read_b64_tr_b16 v[12:13], v131 offset:32768
    buffer_load_dwordx4 v142, s[4:7], s16 offen offset:2048 sc1 lds
    v_mfma_f32_16x16x32_bf16 v[96:99], v[32:35], v[56:59], v[96:99]
    ds_read_b64_tr_b16 v[14:15], v131 offset:36864
    v_mfma_f32_16x16x32_bf16 v[100:103], v[36:39], v[56:59], v[100:103]
    ds_read_b128 v[20:23], v136 offset:34816
    v_mfma_f32_16x16x32_bf16 v[104:107], v[40:43], v[56:59], v[104:107]
    ds_read_b128 v[24:27], v136 offset:36864
    buffer_load_dwordx4 v142, s[4:7], s16 offen offset:3072 sc1 lds
    v_mfma_f32_16x16x32_bf16 v[108:111], v[44:47], v[56:59], v[108:111]
    ds_read_b128 v[28:31], v136 offset:38912
    v_mfma_f32_16x16x32_bf16 v[112:115], v[32:35], v[60:63], v[112:115]
    s_add_u32 s16, s16, 2048
    v_mfma_f32_16x16x32_bf16 v[116:119], v[36:39], v[60:63], v[116:119]
    v_mfma_f32_16x16x32_bf16 v[120:123], v[40:43], v[60:63], v[120:123]
    v_mfma_f32_16x16x32_bf16 v[124:127], v[44:47], v[60:63], v[124:127]
    s_waitcnt lgkmcnt(0)
    ds_read_b128 v[48:51], v136 offset:33792
    s_add_u32 m0, s19, 16384
    s_nop 0
    v_mfma_f32_16x16x32_bf16 v[64:67], v[0:3], v[16:19], v[64:67]
    ds_read_b64_tr_b16 v[32:33], v128 offset:40960
    v_mfma_f32_16x16x32_bf16 v[68:71], v[4:7], v[16:19], v[68:71]
    ds_read_b64_tr_b16 v[34:35], v128 offset:45056
    buffer_load_dwordx4 v137, s[8:11], s15 offen offset:0 lds
    v_mfma_f32_16x16x32_bf16 v[72:75], v[8:11], v[16:19], v[72:75]
    ds_read_b64_tr_b16 v[36:37], v129 offset:40960
    v_mfma_f32_16x16x32_bf16 v[76:79], v[12:15], v[16:19], v[76:79]
    ds_read_b64_tr_b16 v[38:39], v129 offset:45056
    v_mfma_f32_16x16x32_bf16 v[80:83], v[0:3], v[20:23], v[80:83]
    ds_read_b64_tr_b16 v[40:41], v130 offset:40960
    buffer_load_dwordx4 v138, s[8:11], s15 offen offset:1024 lds
    v_mfma_f32_16x16x32_bf16 v[84:87], v[4:7], v[20:23], v[84:87]
    ds_read_b64_tr_b16 v[42:43], v130 offset:45056
    v_mfma_f32_16x16x32_bf16 v[88:91], v[8:11], v[20:23], v[88:91]
    ds_read_b64_tr_b16 v[44:45], v131 offset:40960
    v_mfma_f32_16x16x32_bf16 v[92:95], v[12:15], v[20:23], v[92:95]
    ds_read_b64_tr_b16 v[46:47], v131 offset:45056
    buffer_load_dwordx4 v139, s[8:11], s15 offen offset:2048 lds
    v_mfma_f32_16x16x32_bf16 v[96:99], v[0:3], v[24:27], v[96:99]
    ds_read_b128 v[52:55], v136 offset:35840
    v_mfma_f32_16x16x32_bf16 v[100:103], v[4:7], v[24:27], v[100:103]
    ds_read_b128 v[56:59], v136 offset:37888
    buffer_load_dwordx4 v140, s[8:11], s15 offen offset:3072 lds
    v_mfma_f32_16x16x32_bf16 v[104:107], v[8:11], v[24:27], v[104:107]
    ds_read_b128 v[60:63], v136 offset:39936
    v_mfma_f32_16x16x32_bf16 v[108:111], v[12:15], v[24:27], v[108:111]
    v_mfma_f32_16x16x32_bf16 v[112:115], v[0:3], v[28:31], v[112:115]
    s_add_u32 s15, s15, s17
    v_mfma_f32_16x16x32_bf16 v[116:119], v[4:7], v[28:31], v[116:119]
    v_mfma_f32_16x16x32_bf16 v[120:123], v[8:11], v[28:31], v[120:123]
    v_mfma_f32_16x16x32_bf16 v[124:127], v[12:15], v[28:31], v[124:127]
    s_waitcnt lgkmcnt(0)
    v_mfma_f32_16x16x32_bf16 v[64:67], v[32:35], v[48:51], v[64:67]
    s_waitcnt vmcnt(16)
    s_barrier
    ds_read_b128 v[16:19], v136 offset:49152
    s_add_u32 m0, s20, 32768
    s_nop 0
    v_mfma_f32_16x16x32_bf16 v[68:71], v[36:39], v[48:51], v[68:71]
    ds_read_b64_tr_b16 v[0:1], v128 offset:49152
    v_mfma_f32_16x16x32_bf16 v[72:75], v[40:43], v[48:51], v[72:75]
    ds_read_b64_tr_b16 v[2:3], v128 offset:53248
    buffer_load_dwordx4 v141, s[4:7], s16 offen offset:0 sc1 lds
    v_mfma_f32_16x16x32_bf16 v[76:79], v[44:47], v[48:51], v[76:79]
    ds_read_b64_tr_b16 v[4:5], v129 offset:49152
    v_mfma_f32_16x16x32_bf16 v[80:83], v[32:35], v[52:55], v[80:83]
    ds_read_b64_tr_b16 v[6:7], v129 offset:53248
    v_mfma_f32_16x16x32_bf16 v[84:87], v[36:39], v[52:55], v[84:87]
    ds_read_b64_tr_b16 v[8:9], v130 offset:49152
    buffer_load_dwordx4 v141, s[4:7], s16 offen offset:1024 sc1 lds
    v_mfma_f32_16x16x32_bf16 v[88:91], v[40:43], v[52:55], v[88:91]
    ds_read_b64_tr_b16 v[10:11], v130 offset:53248
    v_mfma_f32_16x16x32_bf16 v[92:95], v[44:47], v[52:55], v[92:95]
    ds_read_b64_tr_b16 v[12:13], v131 offset:49152
    buffer_load_dwordx4 v142, s[4:7], s16 offen offset:2048 sc1 lds
    v_mfma_f32_16x16x32_bf16 v[96:99], v[32:35], v[56:59], v[96:99]
    ds_read_b64_tr_b16 v[14:15], v131 offset:53248
    v_mfma_f32_16x16x32_bf16 v[100:103], v[36:39], v[56:59], v[100:103]
    ds_read_b128 v[20:23], v136 offset:51200
    v_mfma_f32_16x16x32_bf16 v[104:107], v[40:43], v[56:59], v[104:107]
    ds_read_b128 v[24:27], v136 offset:53248
    buffer_load_dwordx4 v142, s[4:7], s16 offen offset:3072 sc1 lds
    v_mfma_f32_16x16x32_bf16 v[108:111], v[44:47], v[56:59], v[108:111]
    ds_read_b128 v[28:31], v136 offset:55296
    v_mfma_f32_16x16x32_bf16 v[112:115], v[32:35], v[60:63], v[112:115]
    s_add_u32 s16, s16, 2048
    v_mfma_f32_16x16x32_bf16 v[116:119], v[36:39], v[60:63], v[116:119]
    v_mfma_f32_16x16x32_bf16 v[120:123], v[40:43], v[60:63], v[120:123]
    v_mfma_f32_16x16x32_bf16 v[124:127], v[44:47], v[60:63], v[124:127]
    s_waitcnt lgkmcnt(0)
    ds_read_b128 v[48:51], v136 offset:50176
    s_add_u32 m0, s19, 32768
    s_nop 0
    v_mfma_f32_16x16x32_bf16 v[64:67], v[0:3], v[16:19], v[64:67]
    ds_read_b64_tr_b16 v[32:33], v128 offset:57344
    v_mfma_f32_16x16x32_bf16 v[68:71], v[4:7], v[16:19], v[68:71]
    ds_read_b64_tr_b16 v[34:35], v128 offset:61440
    buffer_load_dwordx4 v137, s[8:11], s15 offen offset:0 lds
    v_mfma_f32_16x16x32_bf16 v[72:75], v[8:11], v[16:19], v[72:75]
    ds_read_b64_tr_b16 v[36:37], v129 offset:57344
    v_mfma_f32_16x16x32_bf16 v[76:79], v[12:15], v[16:19], v[76:79]
    ds_read_b64_tr_b16 v[38:39], v129 offset:61440
    v_mfma_f32_16x16x32_bf16 v[80:83], v[0:3], v[20:23], v[80:83]
    ds_read_b64_tr_b16 v[40:41], v130 offset:57344
    buffer_load_dwordx4 v138, s[8:11], s15 offen offset:1024 lds
    v_mfma_f32_16x16x32_bf16 v[84:87], v[4:7], v[20:23], v[84:87]
    ds_read_b64_tr_b16 v[42:43], v130 offset:61440
    v_mfma_f32_16x16x32_bf16 v[88:91], v[8:11], v[20:23], v[88:91]
    ds_read_b64_tr_b16 v[44:45], v131 offset:57344
    v_mfma_f32_16x16x32_bf16 v[92:95], v[12:15], v[20:23], v[92:95]
    ds_read_b64_tr_b16 v[46:47], v131 offset:61440
    buffer_load_dwordx4 v139, s[8:11], s15 offen offset:2048 lds
    v_mfma_f32_16x16x32_bf16 v[96:99], v[0:3], v[24:27], v[96:99]
    ds_read_b128 v[52:55], v136 offset:52224
    v_mfma_f32_16x16x32_bf16 v[100:103], v[4:7], v[24:27], v[100:103]
    ds_read_b128 v[56:59], v136 offset:54272
    buffer_load_dwordx4 v140, s[8:11], s15 offen offset:3072 lds
    v_mfma_f32_16x16x32_bf16 v[104:107], v[8:11], v[24:27], v[104:107]
    ds_read_b128 v[60:63], v136 offset:56320
    v_mfma_f32_16x16x32_bf16 v[108:111], v[12:15], v[24:27], v[108:111]
    v_mfma_f32_16x16x32_bf16 v[112:115], v[0:3], v[28:31], v[112:115]
    s_add_u32 s15, s15, s17
    v_mfma_f32_16x16x32_bf16 v[116:119], v[4:7], v[28:31], v[116:119]
    v_mfma_f32_16x16x32_bf16 v[120:123], v[8:11], v[28:31], v[120:123]
    v_mfma_f32_16x16x32_bf16 v[124:127], v[12:15], v[28:31], v[124:127]
    s_waitcnt lgkmcnt(0)
    v_mfma_f32_16x16x32_bf16 v[64:67], v[32:35], v[48:51], v[64:67]
    s_waitcnt vmcnt(16)
    s_barrier
    ds_read_b128 v[16:19], v136 offset:0
    s_add_u32 m0, s20, 49152
    s_nop 0
    v_mfma_f32_16x16x32_bf16 v[68:71], v[36:39], v[48:51], v[68:71]
    ds_read_b64_tr_b16 v[0:1], v128 offset:0
    v_mfma_f32_16x16x32_bf16 v[72:75], v[40:43], v[48:51], v[72:75]
    ds_read_b64_tr_b16 v[2:3], v128 offset:4096
    buffer_load_dwordx4 v141, s[4:7], s16 offen offset:0 sc1 lds
    v_mfma_f32_16x16x32_bf16 v[76:79], v[44:47], v[48:51], v[76:79]
    ds_read_b64_tr_b16 v[4:5], v129 offset:0
    v_mfma_f32_16x16x32_bf16 v[80:83], v[32:35], v[52:55], v[80:83]
    ds_read_b64_tr_b16 v[6:7], v129 offset:4096
    v_mfma_f32_16x16x32_bf16 v[84:87], v[36:39], v[52:55], v[84:87]
    ds_read_b64_tr_b16 v[8:9], v130 offset:0
    buffer_load_dwordx4 v141, s[4:7], s16 offen offset:1024 sc1 lds
    v_mfma_f32_16x16x32_bf16 v[88:91], v[40:43], v[52:55], v[88:91]
    ds_read_b64_tr_b16 v[10:11], v130 offset:4096
    v_mfma_f32_16x16x32_bf16 v[92:95], v[44:47], v[52:55], v[92:95]
    ds_read_b64_tr_b16 v[12:13], v131 offset:0
    buffer_load_dwordx4 v142, s[4:7], s16 offen offset:2048 sc1 lds
    v_mfma_f32_16x16x32_bf16 v[96:99], v[32:35], v[56:59], v[96:99]
    ds_read_b64_tr_b16 v[14:15], v131 offset:4096
    v_mfma_f32_16x16x32_bf16 v[100:103], v[36:39], v[56:59], v[100:103]
    ds_read_b128 v[20:23], v136 offset:2048
    v_mfma_f32_16x16x32_bf16 v[104:107], v[40:43], v[56:59], v[104:107]
    ds_read_b128 v[24:27], v136 offset:4096
    buffer_load_dwordx4 v142, s[4:7], s16 offen offset:3072 sc1 lds
    v_mfma_f32_16x16x32_bf16 v[108:111], v[44:47], v[56:59], v[108:111]
    ds_read_b128 v[28:31], v136 offset:6144
    v_mfma_f32_16x16x32_bf16 v[112:115], v[32:35], v[60:63], v[112:115]
    s_add_u32 s16, s16, 2048
    v_mfma_f32_16x16x32_bf16 v[116:119], v[36:39], v[60:63], v[116:119]
    v_mfma_f32_16x16x32_bf16 v[120:123], v[40:43], v[60:63], v[120:123]
    v_mfma_f32_16x16x32_bf16 v[124:127], v[44:47], v[60:63], v[124:127]
    s_sub_u32 s18, s18, 1
    s_cmp_lg_u32 s18, 0
    s_cbranch_scc1 main_kernel_w_c0_n_loop
    s_cmp_lg_u32 s14, 0
    s_cbranch_scc1 main_kernel_w_c0_n_nt
    s_lshl_b32 s32, s27, 8
    s_add_u32 s32, s32, 0x841e000
    v_mov_b32 v255, 1
    s_mov_b64 exec, 1
    buffer_atomic_add v255, off, s[4:7], s32 sc0 sc1
    s_mov_b64 exec, -1
main_kernel_w_c0_n_nt:
    s_cmp_lg_u32 s23, 8
    s_cbranch_scc1 main_kernel_w_c0_nlw
    s_lshl_b32 s18, s25, 4
    s_add_u32 s18, s18, s24
    s_lshl_b32 s18, s18, 4
    s_add_u32 s18, s18, 0x8412000
    buffer_load_dword v192, off, s[4:7], s18 sc1
main_kernel_w_c0_nlw:
    s_waitcnt lgkmcnt(0)
    ds_read_b128 v[48:51], v136 offset:1024
    s_add_u32 m0, s19, 49152
    s_nop 0
    v_mfma_f32_16x16x32_bf16 v[64:67], v[0:3], v[16:19], v[64:67]
    ds_read_b64_tr_b16 v[32:33], v128 offset:8192
    v_mfma_f32_16x16x32_bf16 v[68:71], v[4:7], v[16:19], v[68:71]
    ds_read_b64_tr_b16 v[34:35], v128 offset:12288
    buffer_load_dwordx4 v137, s[8:11], s15 offen offset:0 lds
    v_mfma_f32_16x16x32_bf16 v[72:75], v[8:11], v[16:19], v[72:75]
    ds_read_b64_tr_b16 v[36:37], v129 offset:8192
    v_mfma_f32_16x16x32_bf16 v[76:79], v[12:15], v[16:19], v[76:79]
    ds_read_b64_tr_b16 v[38:39], v129 offset:12288
    v_mfma_f32_16x16x32_bf16 v[80:83], v[0:3], v[20:23], v[80:83]
    ds_read_b64_tr_b16 v[40:41], v130 offset:8192
    buffer_load_dwordx4 v138, s[8:11], s15 offen offset:1024 lds
    v_mfma_f32_16x16x32_bf16 v[84:87], v[4:7], v[20:23], v[84:87]
    ds_read_b64_tr_b16 v[42:43], v130 offset:12288
    v_mfma_f32_16x16x32_bf16 v[88:91], v[8:11], v[20:23], v[88:91]
    ds_read_b64_tr_b16 v[44:45], v131 offset:8192
    v_mfma_f32_16x16x32_bf16 v[92:95], v[12:15], v[20:23], v[92:95]
    ds_read_b64_tr_b16 v[46:47], v131 offset:12288
    buffer_load_dwordx4 v139, s[8:11], s15 offen offset:2048 lds
    v_mfma_f32_16x16x32_bf16 v[96:99], v[0:3], v[24:27], v[96:99]
    ds_read_b128 v[52:55], v136 offset:3072
    v_mfma_f32_16x16x32_bf16 v[100:103], v[4:7], v[24:27], v[100:103]
    ds_read_b128 v[56:59], v136 offset:5120
    buffer_load_dwordx4 v140, s[8:11], s15 offen offset:3072 lds
    v_mfma_f32_16x16x32_bf16 v[104:107], v[8:11], v[24:27], v[104:107]
    ds_read_b128 v[60:63], v136 offset:7168
    v_mfma_f32_16x16x32_bf16 v[108:111], v[12:15], v[24:27], v[108:111]
    v_mfma_f32_16x16x32_bf16 v[112:115], v[0:3], v[28:31], v[112:115]
    s_add_u32 s15, s15, s17
    v_mfma_f32_16x16x32_bf16 v[116:119], v[4:7], v[28:31], v[116:119]
    v_mfma_f32_16x16x32_bf16 v[120:123], v[8:11], v[28:31], v[120:123]
    v_mfma_f32_16x16x32_bf16 v[124:127], v[12:15], v[28:31], v[124:127]
    s_waitcnt lgkmcnt(0)
    v_mfma_f32_16x16x32_bf16 v[64:67], v[32:35], v[48:51], v[64:67]
    s_waitcnt vmcnt(16)
    s_barrier
    ds_read_b128 v[16:19], v136 offset:16384
    v_mfma_f32_16x16x32_bf16 v[68:71], v[36:39], v[48:51], v[68:71]
    ds_read_b64_tr_b16 v[0:1], v128 offset:16384
    v_mfma_f32_16x16x32_bf16 v[72:75], v[40:43], v[48:51], v[72:75]
    ds_read_b64_tr_b16 v[2:3], v128 offset:20480
    v_mfma_f32_16x16x32_bf16 v[76:79], v[44:47], v[48:51], v[76:79]
    ds_read_b64_tr_b16 v[4:5], v129 offset:16384
    v_mfma_f32_16x16x32_bf16 v[80:83], v[32:35], v[52:55], v[80:83]
    ds_read_b64_tr_b16 v[6:7], v129 offset:20480
    v_mfma_f32_16x16x32_bf16 v[84:87], v[36:39], v[52:55], v[84:87]
    ds_read_b64_tr_b16 v[8:9], v130 offset:16384
    v_mfma_f32_16x16x32_bf16 v[88:91], v[40:43], v[52:55], v[88:91]
    ds_read_b64_tr_b16 v[10:11], v130 offset:20480
    v_mfma_f32_16x16x32_bf16 v[92:95], v[44:47], v[52:55], v[92:95]
    ds_read_b64_tr_b16 v[12:13], v131 offset:16384
    v_mfma_f32_16x16x32_bf16 v[96:99], v[32:35], v[56:59], v[96:99]
    ds_read_b64_tr_b16 v[14:15], v131 offset:20480
    v_mfma_f32_16x16x32_bf16 v[100:103], v[36:39], v[56:59], v[100:103]
    ds_read_b128 v[20:23], v136 offset:18432
    v_mfma_f32_16x16x32_bf16 v[104:107], v[40:43], v[56:59], v[104:107]
    ds_read_b128 v[24:27], v136 offset:20480
    v_mfma_f32_16x16x32_bf16 v[108:111], v[44:47], v[56:59], v[108:111]
    ds_read_b128 v[28:31], v136 offset:22528
    v_mfma_f32_16x16x32_bf16 v[112:115], v[32:35], v[60:63], v[112:115]
    v_mfma_f32_16x16x32_bf16 v[116:119], v[36:39], v[60:63], v[116:119]
    v_mfma_f32_16x16x32_bf16 v[120:123], v[40:43], v[60:63], v[120:123]
    v_mfma_f32_16x16x32_bf16 v[124:127], v[44:47], v[60:63], v[124:127]
    s_waitcnt lgkmcnt(0)
    ds_read_b128 v[48:51], v136 offset:17408
    v_mfma_f32_16x16x32_bf16 v[64:67], v[0:3], v[16:19], v[64:67]
    ds_read_b64_tr_b16 v[32:33], v128 offset:24576
    v_mfma_f32_16x16x32_bf16 v[68:71], v[4:7], v[16:19], v[68:71]
    ds_read_b64_tr_b16 v[34:35], v128 offset:28672
    v_mfma_f32_16x16x32_bf16 v[72:75], v[8:11], v[16:19], v[72:75]
    ds_read_b64_tr_b16 v[36:37], v129 offset:24576
    v_mfma_f32_16x16x32_bf16 v[76:79], v[12:15], v[16:19], v[76:79]
    ds_read_b64_tr_b16 v[38:39], v129 offset:28672
    v_mfma_f32_16x16x32_bf16 v[80:83], v[0:3], v[20:23], v[80:83]
    ds_read_b64_tr_b16 v[40:41], v130 offset:24576
    v_mfma_f32_16x16x32_bf16 v[84:87], v[4:7], v[20:23], v[84:87]
    ds_read_b64_tr_b16 v[42:43], v130 offset:28672
    v_mfma_f32_16x16x32_bf16 v[88:91], v[8:11], v[20:23], v[88:91]
    ds_read_b64_tr_b16 v[44:45], v131 offset:24576
    v_mfma_f32_16x16x32_bf16 v[92:95], v[12:15], v[20:23], v[92:95]
    ds_read_b64_tr_b16 v[46:47], v131 offset:28672
    v_mfma_f32_16x16x32_bf16 v[96:99], v[0:3], v[24:27], v[96:99]
    ds_read_b128 v[52:55], v136 offset:19456
    v_mfma_f32_16x16x32_bf16 v[100:103], v[4:7], v[24:27], v[100:103]
    ds_read_b128 v[56:59], v136 offset:21504
    v_mfma_f32_16x16x32_bf16 v[104:107], v[8:11], v[24:27], v[104:107]
    ds_read_b128 v[60:63], v136 offset:23552
    v_mfma_f32_16x16x32_bf16 v[108:111], v[12:15], v[24:27], v[108:111]
    v_mfma_f32_16x16x32_bf16 v[112:115], v[0:3], v[28:31], v[112:115]
    v_mfma_f32_16x16x32_bf16 v[116:119], v[4:7], v[28:31], v[116:119]
    v_mfma_f32_16x16x32_bf16 v[120:123], v[8:11], v[28:31], v[120:123]
    v_mfma_f32_16x16x32_bf16 v[124:127], v[12:15], v[28:31], v[124:127]
    s_waitcnt lgkmcnt(0)
    v_mfma_f32_16x16x32_bf16 v[64:67], v[32:35], v[48:51], v[64:67]
    s_waitcnt vmcnt(8)
    s_barrier
    ds_read_b128 v[16:19], v136 offset:32768
    v_mfma_f32_16x16x32_bf16 v[68:71], v[36:39], v[48:51], v[68:71]
    ds_read_b64_tr_b16 v[0:1], v128 offset:32768
    v_mfma_f32_16x16x32_bf16 v[72:75], v[40:43], v[48:51], v[72:75]
    ds_read_b64_tr_b16 v[2:3], v128 offset:36864
    v_mfma_f32_16x16x32_bf16 v[76:79], v[44:47], v[48:51], v[76:79]
    ds_read_b64_tr_b16 v[4:5], v129 offset:32768
    v_mfma_f32_16x16x32_bf16 v[80:83], v[32:35], v[52:55], v[80:83]
    ds_read_b64_tr_b16 v[6:7], v129 offset:36864
    v_mfma_f32_16x16x32_bf16 v[84:87], v[36:39], v[52:55], v[84:87]
    ds_read_b64_tr_b16 v[8:9], v130 offset:32768
    v_mfma_f32_16x16x32_bf16 v[88:91], v[40:43], v[52:55], v[88:91]
    ds_read_b64_tr_b16 v[10:11], v130 offset:36864
    v_mfma_f32_16x16x32_bf16 v[92:95], v[44:47], v[52:55], v[92:95]
    ds_read_b64_tr_b16 v[12:13], v131 offset:32768
    v_mfma_f32_16x16x32_bf16 v[96:99], v[32:35], v[56:59], v[96:99]
    ds_read_b64_tr_b16 v[14:15], v131 offset:36864
    v_mfma_f32_16x16x32_bf16 v[100:103], v[36:39], v[56:59], v[100:103]
    ds_read_b128 v[20:23], v136 offset:34816
    v_mfma_f32_16x16x32_bf16 v[104:107], v[40:43], v[56:59], v[104:107]
    ds_read_b128 v[24:27], v136 offset:36864
    v_mfma_f32_16x16x32_bf16 v[108:111], v[44:47], v[56:59], v[108:111]
    ds_read_b128 v[28:31], v136 offset:38912
    v_mfma_f32_16x16x32_bf16 v[112:115], v[32:35], v[60:63], v[112:115]
    v_mfma_f32_16x16x32_bf16 v[116:119], v[36:39], v[60:63], v[116:119]
    v_mfma_f32_16x16x32_bf16 v[120:123], v[40:43], v[60:63], v[120:123]
    v_mfma_f32_16x16x32_bf16 v[124:127], v[44:47], v[60:63], v[124:127]
    s_waitcnt lgkmcnt(0)
    ds_read_b128 v[48:51], v136 offset:33792
    v_mfma_f32_16x16x32_bf16 v[64:67], v[0:3], v[16:19], v[64:67]
    ds_read_b64_tr_b16 v[32:33], v128 offset:40960
    v_mfma_f32_16x16x32_bf16 v[68:71], v[4:7], v[16:19], v[68:71]
    ds_read_b64_tr_b16 v[34:35], v128 offset:45056
    v_mfma_f32_16x16x32_bf16 v[72:75], v[8:11], v[16:19], v[72:75]
    ds_read_b64_tr_b16 v[36:37], v129 offset:40960
    v_mfma_f32_16x16x32_bf16 v[76:79], v[12:15], v[16:19], v[76:79]
    ds_read_b64_tr_b16 v[38:39], v129 offset:45056
    v_mfma_f32_16x16x32_bf16 v[80:83], v[0:3], v[20:23], v[80:83]
    ds_read_b64_tr_b16 v[40:41], v130 offset:40960
    v_mfma_f32_16x16x32_bf16 v[84:87], v[4:7], v[20:23], v[84:87]
    ds_read_b64_tr_b16 v[42:43], v130 offset:45056
    v_mfma_f32_16x16x32_bf16 v[88:91], v[8:11], v[20:23], v[88:91]
    ds_read_b64_tr_b16 v[44:45], v131 offset:40960
    v_mfma_f32_16x16x32_bf16 v[92:95], v[12:15], v[20:23], v[92:95]
    ds_read_b64_tr_b16 v[46:47], v131 offset:45056
    v_mfma_f32_16x16x32_bf16 v[96:99], v[0:3], v[24:27], v[96:99]
    ds_read_b128 v[52:55], v136 offset:35840
    v_mfma_f32_16x16x32_bf16 v[100:103], v[4:7], v[24:27], v[100:103]
    ds_read_b128 v[56:59], v136 offset:37888
    v_mfma_f32_16x16x32_bf16 v[104:107], v[8:11], v[24:27], v[104:107]
    ds_read_b128 v[60:63], v136 offset:39936
    v_mfma_f32_16x16x32_bf16 v[108:111], v[12:15], v[24:27], v[108:111]
    v_mfma_f32_16x16x32_bf16 v[112:115], v[0:3], v[28:31], v[112:115]
    v_mfma_f32_16x16x32_bf16 v[116:119], v[4:7], v[28:31], v[116:119]
    v_mfma_f32_16x16x32_bf16 v[120:123], v[8:11], v[28:31], v[120:123]
    v_mfma_f32_16x16x32_bf16 v[124:127], v[12:15], v[28:31], v[124:127]
    s_waitcnt lgkmcnt(0)
    v_mfma_f32_16x16x32_bf16 v[64:67], v[32:35], v[48:51], v[64:67]
    s_waitcnt vmcnt(0)
    s_barrier
    ds_read_b128 v[16:19], v136 offset:49152
    v_mfma_f32_16x16x32_bf16 v[68:71], v[36:39], v[48:51], v[68:71]
    ds_read_b64_tr_b16 v[0:1], v128 offset:49152
    v_mfma_f32_16x16x32_bf16 v[72:75], v[40:43], v[48:51], v[72:75]
    ds_read_b64_tr_b16 v[2:3], v128 offset:53248
    v_mfma_f32_16x16x32_bf16 v[76:79], v[44:47], v[48:51], v[76:79]
    ds_read_b64_tr_b16 v[4:5], v129 offset:49152
    v_mfma_f32_16x16x32_bf16 v[80:83], v[32:35], v[52:55], v[80:83]
    ds_read_b64_tr_b16 v[6:7], v129 offset:53248
    v_mfma_f32_16x16x32_bf16 v[84:87], v[36:39], v[52:55], v[84:87]
    ds_read_b64_tr_b16 v[8:9], v130 offset:49152
    v_mfma_f32_16x16x32_bf16 v[88:91], v[40:43], v[52:55], v[88:91]
    ds_read_b64_tr_b16 v[10:11], v130 offset:53248
    v_mfma_f32_16x16x32_bf16 v[92:95], v[44:47], v[52:55], v[92:95]
    ds_read_b64_tr_b16 v[12:13], v131 offset:49152
    v_mfma_f32_16x16x32_bf16 v[96:99], v[32:35], v[56:59], v[96:99]
    ds_read_b64_tr_b16 v[14:15], v131 offset:53248
    v_mfma_f32_16x16x32_bf16 v[100:103], v[36:39], v[56:59], v[100:103]
    ds_read_b128 v[20:23], v136 offset:51200
    v_mfma_f32_16x16x32_bf16 v[104:107], v[40:43], v[56:59], v[104:107]
    ds_read_b128 v[24:27], v136 offset:53248
    v_mfma_f32_16x16x32_bf16 v[108:111], v[44:47], v[56:59], v[108:111]
    ds_read_b128 v[28:31], v136 offset:55296
    v_mfma_f32_16x16x32_bf16 v[112:115], v[32:35], v[60:63], v[112:115]
    v_mfma_f32_16x16x32_bf16 v[116:119], v[36:39], v[60:63], v[116:119]
    v_mfma_f32_16x16x32_bf16 v[120:123], v[40:43], v[60:63], v[120:123]
    v_mfma_f32_16x16x32_bf16 v[124:127], v[44:47], v[60:63], v[124:127]
    v_readfirstlane_b32 s55, v255
    s_cmp_lg_u32 s23, 8
    s_cbranch_scc1 main_kernel_w_c0_lwk
main_kernel_w_c0_lwp:
    v_cmp_eq_u32 vcc, 0, v192
    s_cbranch_vccz main_kernel_w_c0_lwk
    s_sleep 8
    buffer_load_dword v192, off, s[4:7], s18 sc1
    s_waitcnt vmcnt(0)
    s_sub_u32 s29, s29, 1
    s_cbranch_scc0 main_kernel_w_c0_lwp
main_kernel_w_c0_lwk:
    s_cmp_eq_u32 s26, -1
    s_cbranch_scc1 main_kernel_w_c0_nores
    s_add_u32 s32, s26, 0
    buffer_load_dwordx4 v[192:195], v251, s[4:7], s32 offen offset:0 sc1
    buffer_load_dwordx4 v[196:199], v251, s[4:7], s32 offen offset:1024 sc1
    s_add_u32 s32, s26, 32768
    buffer_load_dwordx4 v[200:203], v251, s[4:7], s32 offen offset:0 sc1
    buffer_load_dwordx4 v[204:207], v251, s[4:7], s32 offen offset:1024 sc1
    s_add_u32 s32, s26, 65536
    buffer_load_dwordx4 v[208:211], v251, s[4:7], s32 offen offset:0 sc1
    buffer_load_dwordx4 v[212:215], v251, s[4:7], s32 offen offset:1024 sc1
    s_add_u32 s32, s26, 98304
    buffer_load_dwordx4 v[216:219], v251, s[4:7], s32 offen offset:0 sc1
    buffer_load_dwordx4 v[220:223], v251, s[4:7], s32 offen offset:1024 sc1
main_kernel_w_c0_nores:
    s_waitcnt lgkmcnt(0)
    ds_read_b128 v[48:51], v136 offset:50176
    v_mfma_f32_16x16x32_bf16 v[64:67], v[0:3], v[16:19], v[64:67]
    ds_read_b64_tr_b16 v[32:33], v128 offset:57344
    v_mfma_f32_16x16x32_bf16 v[68:71], v[4:7], v[16:19], v[68:71]
    ds_read_b64_tr_b16 v[34:35], v128 offset:61440
    v_mfma_f32_16x16x32_bf16 v[72:75], v[8:11], v[16:19], v[72:75]
    ds_read_b64_tr_b16 v[36:37], v129 offset:57344
    v_mfma_f32_16x16x32_bf16 v[76:79], v[12:15], v[16:19], v[76:79]
    ds_read_b64_tr_b16 v[38:39], v129 offset:61440
    v_mfma_f32_16x16x32_bf16 v[80:83], v[0:3], v[20:23], v[80:83]
    ds_read_b64_tr_b16 v[40:41], v130 offset:57344
    v_mfma_f32_16x16x32_bf16 v[84:87], v[4:7], v[20:23], v[84:87]
    ds_read_b64_tr_b16 v[42:43], v130 offset:61440
    v_mfma_f32_16x16x32_bf16 v[88:91], v[8:11], v[20:23], v[88:91]
    ds_read_b64_tr_b16 v[44:45], v131 offset:57344
    v_mfma_f32_16x16x32_bf16 v[92:95], v[12:15], v[20:23], v[92:95]
    ds_read_b64_tr_b16 v[46:47], v131 offset:61440
    v_mfma_f32_16x16x32_bf16 v[96:99], v[0:3], v[24:27], v[96:99]
    ds_read_b128 v[52:55], v136 offset:52224
    v_mfma_f32_16x16x32_bf16 v[100:103], v[4:7], v[24:27], v[100:103]
    ds_read_b128 v[56:59], v136 offset:54272
    v_mfma_f32_16x16x32_bf16 v[104:107], v[8:11], v[24:27], v[104:107]
    ds_read_b128 v[60:63], v136 offset:56320
    v_mfma_f32_16x16x32_bf16 v[108:111], v[12:15], v[24:27], v[108:111]
    v_mfma_f32_16x16x32_bf16 v[112:115], v[0:3], v[28:31], v[112:115]
    v_mfma_f32_16x16x32_bf16 v[116:119], v[4:7], v[28:31], v[116:119]
    v_mfma_f32_16x16x32_bf16 v[120:123], v[8:11], v[28:31], v[120:123]
    v_mfma_f32_16x16x32_bf16 v[124:127], v[12:15], v[28:31], v[124:127]
    s_waitcnt lgkmcnt(0)
    v_mfma_f32_16x16x32_bf16 v[64:67], v[32:35], v[48:51], v[64:67]
    v_mfma_f32_16x16x32_bf16 v[68:71], v[36:39], v[48:51], v[68:71]
    v_mfma_f32_16x16x32_bf16 v[72:75], v[40:43], v[48:51], v[72:75]
    v_mfma_f32_16x16x32_bf16 v[76:79], v[44:47], v[48:51], v[76:79]
    v_mfma_f32_16x16x32_bf16 v[80:83], v[32:35], v[52:55], v[80:83]
    v_mfma_f32_16x16x32_bf16 v[84:87], v[36:39], v[52:55], v[84:87]
    v_mfma_f32_16x16x32_bf16 v[88:91], v[40:43], v[52:55], v[88:91]
    v_mfma_f32_16x16x32_bf16 v[92:95], v[44:47], v[52:55], v[92:95]
    v_mfma_f32_16x16x32_bf16 v[96:99], v[32:35], v[56:59], v[96:99]
    v_mfma_f32_16x16x32_bf16 v[100:103], v[36:39], v[56:59], v[100:103]
    v_mfma_f32_16x16x32_bf16 v[104:107], v[40:43], v[56:59], v[104:107]
    v_mfma_f32_16x16x32_bf16 v[108:111], v[44:47], v[56:59], v[108:111]
    v_mfma_f32_16x16x32_bf16 v[112:115], v[32:35], v[60:63], v[112:115]
    v_mfma_f32_16x16x32_bf16 v[116:119], v[36:39], v[60:63], v[116:119]
    v_mfma_f32_16x16x32_bf16 v[120:123], v[40:43], v[60:63], v[120:123]
    v_mfma_f32_16x16x32_bf16 v[124:127], v[44:47], v[60:63], v[124:127]
    s_nop 7
    s_cmp_eq_u32 s23, 4
    s_cbranch_scc1 main_kernel_w_c0_eadd
    s_cmp_eq_u32 s23, 7
    s_cbranch_scc1 main_kernel_w_c0_esilu
    s_cmp_eq_u32 s23, 8
    s_cbranch_scc1 main_kernel_w_c0_efin
main_kernel_w_c0_escl:
    s_mov_b32 s53, s21
    v_mul_f32 v64, 0x3e0293ee, v64
    v_mul_f32 v65, 0x3e0293ee, v65
    v_mul_f32 v66, 0x3e0293ee, v66
    v_mul_f32 v67, 0x3e0293ee, v67
    v_mul_f32 v68, 0x3e0293ee, v68
    v_mul_f32 v69, 0x3e0293ee, v69
    v_mul_f32 v70, 0x3e0293ee, v70
    v_mul_f32 v71, 0x3e0293ee, v71
    v_cvt_pk_bf16_f32 v16, v64, v65
    v_cvt_pk_bf16_f32 v17, v66, v67
    v_cvt_pk_bf16_f32 v18, v68, v69
    v_cvt_pk_bf16_f32 v19, v70, v71
    buffer_store_dwordx4 v[16:19], v251, s[4:7], s53 offen offset:0 sc1
    v_mul_f32 v72, 0x3e0293ee, v72
    v_mul_f32 v73, 0x3e0293ee, v73
    v_mul_f32 v74, 0x3e0293ee, v74
    v_mul_f32 v75, 0x3e0293ee, v75
    v_mul_f32 v76, 0x3e0293ee, v76
    v_mul_f32 v77, 0x3e0293ee, v77
    v_mul_f32 v78, 0x3e0293ee, v78
    v_mul_f32 v79, 0x3e0293ee, v79
    v_cvt_pk_bf16_f32 v36, v72, v73
    v_cvt_pk_bf16_f32 v37, v74, v75
    v_cvt_pk_bf16_f32 v38, v76, v77
    v_cvt_pk_bf16_f32 v39, v78, v79
    buffer_store_dwordx4 v[36:39], v251, s[4:7], s53 offen offset:1024 sc1
    s_add_u32 s53, s53, s22
    v_mul_f32 v80, 0x3e0293ee, v80
    v_mul_f32 v81, 0x3e0293ee, v81
    v_mul_f32 v82, 0x3e0293ee, v82
    v_mul_f32 v83, 0x3e0293ee, v83
    v_mul_f32 v84, 0x3e0293ee, v84
    v_mul_f32 v85, 0x3e0293ee, v85
    v_mul_f32 v86, 0x3e0293ee, v86
    v_mul_f32 v87, 0x3e0293ee, v87
    v_cvt_pk_bf16_f32 v56, v80, v81
    v_cvt_pk_bf16_f32 v57, v82, v83
    v_cvt_pk_bf16_f32 v58, v84, v85
    v_cvt_pk_bf16_f32 v59, v86, v87
    buffer_store_dwordx4 v[56:59], v251, s[4:7], s53 offen offset:0 sc1
    v_mul_f32 v88, 0x3e0293ee, v88
    v_mul_f32 v89, 0x3e0293ee, v89
    v_mul_f32 v90, 0x3e0293ee, v90
    v_mul_f32 v91, 0x3e0293ee, v91
    v_mul_f32 v92, 0x3e0293ee, v92
    v_mul_f32 v93, 0x3e0293ee, v93
    v_mul_f32 v94, 0x3e0293ee, v94
    v_mul_f32 v95, 0x3e0293ee, v95
    v_cvt_pk_bf16_f32 v16, v88, v89
    v_cvt_pk_bf16_f32 v17, v90, v91
    v_cvt_pk_bf16_f32 v18, v92, v93
    v_cvt_pk_bf16_f32 v19, v94, v95
    buffer_store_dwordx4 v[16:19], v251, s[4:7], s53 offen offset:1024 sc1
    s_add_u32 s53, s53, s22
    v_mul_f32 v96, 0x3e0293ee, v96
    v_mul_f32 v97, 0x3e0293ee, v97
    v_mul_f32 v98, 0x3e0293ee, v98
    v_mul_f32 v99, 0x3e0293ee, v99
    v_mul_f32 v100, 0x3e0293ee, v100
    v_mul_f32 v101, 0x3e0293ee, v101
    v_mul_f32 v102, 0x3e0293ee, v102
    v_mul_f32 v103, 0x3e0293ee, v103
    v_cvt_pk_bf16_f32 v36, v96, v97
    v_cvt_pk_bf16_f32 v37, v98, v99
    v_cvt_pk_bf16_f32 v38, v100, v101
    v_cvt_pk_bf16_f32 v39, v102, v103
    buffer_store_dwordx4 v[36:39], v251, s[4:7], s53 offen offset:0 sc1
    v_mul_f32 v104, 0x3e0293ee, v104
    v_mul_f32 v105, 0x3e0293ee, v105
    v_mul_f32 v106, 0x3e0293ee, v106
    v_mul_f32 v107, 0x3e0293ee, v107
    v_mul_f32 v108, 0x3e0293ee, v108
    v_mul_f32 v109, 0x3e0293ee, v109
    v_mul_f32 v110, 0x3e0293ee, v110
    v_mul_f32 v111, 0x3e0293ee, v111
    v_cvt_pk_bf16_f32 v56, v104, v105
    v_cvt_pk_bf16_f32 v57, v106, v107
    v_cvt_pk_bf16_f32 v58, v108, v109
    v_cvt_pk_bf16_f32 v59, v110, v111
    buffer_store_dwordx4 v[56:59], v251, s[4:7], s53 offen offset:1024 sc1
    s_add_u32 s53, s53, s22
    v_mul_f32 v112, 0x3e0293ee, v112
    v_mul_f32 v113, 0x3e0293ee, v113
    v_mul_f32 v114, 0x3e0293ee, v114
    v_mul_f32 v115, 0x3e0293ee, v115
    v_mul_f32 v116, 0x3e0293ee, v116
    v_mul_f32 v117, 0x3e0293ee, v117
    v_mul_f32 v118, 0x3e0293ee, v118
    v_mul_f32 v119, 0x3e0293ee, v119
    v_cvt_pk_bf16_f32 v16, v112, v113
    v_cvt_pk_bf16_f32 v17, v114, v115
    v_cvt_pk_bf16_f32 v18, v116, v117
    v_cvt_pk_bf16_f32 v19, v118, v119
    buffer_store_dwordx4 v[16:19], v251, s[4:7], s53 offen offset:0 sc1
    v_mul_f32 v120, 0x3e0293ee, v120
    v_mul_f32 v121, 0x3e0293ee, v121
    v_mul_f32 v122, 0x3e0293ee, v122
    v_mul_f32 v123, 0x3e0293ee, v123
    v_mul_f32 v124, 0x3e0293ee, v124
    v_mul_f32 v125, 0x3e0293ee, v125
    v_mul_f32 v126, 0x3e0293ee, v126
    v_mul_f32 v127, 0x3e0293ee, v127
    v_cvt_pk_bf16_f32 v36, v120, v121
    v_cvt_pk_bf16_f32 v37, v122, v123
    v_cvt_pk_bf16_f32 v38, v124, v125
    v_cvt_pk_bf16_f32 v39, v126, v127
    buffer_store_dwordx4 v[36:39], v251, s[4:7], s53 offen offset:1024 sc1
    s_branch main_kernel_w_done
main_kernel_w_c0_eadd:
    s_mov_b32 s53, s21
    s_waitcnt vmcnt(7)
    v_lshlrev_b32 v8, 16, v192
    v_and_b32 v9, 0xffff0000, v192
    v_lshlrev_b32 v10, 16, v193
    v_and_b32 v11, 0xffff0000, v193
    v_lshlrev_b32 v12, 16, v194
    v_and_b32 v13, 0xffff0000, v194
    v_lshlrev_b32 v14, 16, v195
    v_and_b32 v15, 0xffff0000, v195
    v_pk_add_f32 v[64:65], v[64:65], v[8:9]
    v_pk_add_f32 v[66:67], v[66:67], v[10:11]
    v_pk_add_f32 v[68:69], v[68:69], v[12:13]
    v_pk_add_f32 v[70:71], v[70:71], v[14:15]
    v_cvt_pk_bf16_f32 v16, v64, v65
    v_cvt_pk_bf16_f32 v17, v66, v67
    v_cvt_pk_bf16_f32 v18, v68, v69
    v_cvt_pk_bf16_f32 v19, v70, v71
    buffer_store_dwordx4 v[16:19], v251, s[4:7], s53 offen offset:0 sc1
    s_waitcnt vmcnt(7)
    v_lshlrev_b32 v28, 16, v196
    v_and_b32 v29, 0xffff0000, v196
    v_lshlrev_b32 v30, 16, v197
    v_and_b32 v31, 0xffff0000, v197
    v_lshlrev_b32 v32, 16, v198
    v_and_b32 v33, 0xffff0000, v198
    v_lshlrev_b32 v34, 16, v199
    v_and_b32 v35, 0xffff0000, v199
    v_pk_add_f32 v[72:73], v[72:73], v[28:29]
    v_pk_add_f32 v[74:75], v[74:75], v[30:31]
    v_pk_add_f32 v[76:77], v[76:77], v[32:33]
    v_pk_add_f32 v[78:79], v[78:79], v[34:35]
    v_cvt_pk_bf16_f32 v36, v72, v73
    v_cvt_pk_bf16_f32 v37, v74, v75
    v_cvt_pk_bf16_f32 v38, v76, v77
    v_cvt_pk_bf16_f32 v39, v78, v79
    buffer_store_dwordx4 v[36:39], v251, s[4:7], s53 offen offset:1024 sc1
    s_add_u32 s53, s53, s22
    s_waitcnt vmcnt(7)
    v_lshlrev_b32 v48, 16, v200
    v_and_b32 v49, 0xffff0000, v200
    v_lshlrev_b32 v50, 16, v201
    v_and_b32 v51, 0xffff0000, v201
    v_lshlrev_b32 v52, 16, v202
    v_and_b32 v53, 0xffff0000, v202
    v_lshlrev_b32 v54, 16, v203
    v_and_b32 v55, 0xffff0000, v203
    v_pk_add_f32 v[80:81], v[80:81], v[48:49]
    v_pk_add_f32 v[82:83], v[82:83], v[50:51]
    v_pk_add_f32 v[84:85], v[84:85], v[52:53]
    v_pk_add_f32 v[86:87], v[86:87], v[54:55]
    v_cvt_pk_bf16_f32 v56, v80, v81
    v_cvt_pk_bf16_f32 v57, v82, v83
    v_cvt_pk_bf16_f32 v58, v84, v85
    v_cvt_pk_bf16_f32 v59, v86, v87
    buffer_store_dwordx4 v[56:59], v251, s[4:7], s53 offen offset:0 sc1
    s_waitcnt vmcnt(7)
    v_lshlrev_b32 v8, 16, v204
    v_and_b32 v9, 0xffff0000, v204
    v_lshlrev_b32 v10, 16, v205
    v_and_b32 v11, 0xffff0000, v205
    v_lshlrev_b32 v12, 16, v206
    v_and_b32 v13, 0xffff0000, v206
    v_lshlrev_b32 v14, 16, v207
    v_and_b32 v15, 0xffff0000, v207
    v_pk_add_f32 v[88:89], v[88:89], v[8:9]
    v_pk_add_f32 v[90:91], v[90:91], v[10:11]
    v_pk_add_f32 v[92:93], v[92:93], v[12:13]
    v_pk_add_f32 v[94:95], v[94:95], v[14:15]
    v_cvt_pk_bf16_f32 v16, v88, v89
    v_cvt_pk_bf16_f32 v17, v90, v91
    v_cvt_pk_bf16_f32 v18, v92, v93
    v_cvt_pk_bf16_f32 v19, v94, v95
    buffer_store_dwordx4 v[16:19], v251, s[4:7], s53 offen offset:1024 sc1
    s_add_u32 s53, s53, s22
    s_waitcnt vmcnt(7)
    v_lshlrev_b32 v28, 16, v208
    v_and_b32 v29, 0xffff0000, v208
    v_lshlrev_b32 v30, 16, v209
    v_and_b32 v31, 0xffff0000, v209
    v_lshlrev_b32 v32, 16, v210
    v_and_b32 v33, 0xffff0000, v210
    v_lshlrev_b32 v34, 16, v211
    v_and_b32 v35, 0xffff0000, v211
    v_pk_add_f32 v[96:97], v[96:97], v[28:29]
    v_pk_add_f32 v[98:99], v[98:99], v[30:31]
    v_pk_add_f32 v[100:101], v[100:101], v[32:33]
    v_pk_add_f32 v[102:103], v[102:103], v[34:35]
    v_cvt_pk_bf16_f32 v36, v96, v97
    v_cvt_pk_bf16_f32 v37, v98, v99
    v_cvt_pk_bf16_f32 v38, v100, v101
    v_cvt_pk_bf16_f32 v39, v102, v103
    buffer_store_dwordx4 v[36:39], v251, s[4:7], s53 offen offset:0 sc1
    s_waitcnt vmcnt(7)
    v_lshlrev_b32 v48, 16, v212
    v_and_b32 v49, 0xffff0000, v212
    v_lshlrev_b32 v50, 16, v213
    v_and_b32 v51, 0xffff0000, v213
    v_lshlrev_b32 v52, 16, v214
    v_and_b32 v53, 0xffff0000, v214
    v_lshlrev_b32 v54, 16, v215
    v_and_b32 v55, 0xffff0000, v215
    v_pk_add_f32 v[104:105], v[104:105], v[48:49]
    v_pk_add_f32 v[106:107], v[106:107], v[50:51]
    v_pk_add_f32 v[108:109], v[108:109], v[52:53]
    v_pk_add_f32 v[110:111], v[110:111], v[54:55]
    v_cvt_pk_bf16_f32 v56, v104, v105
    v_cvt_pk_bf16_f32 v57, v106, v107
    v_cvt_pk_bf16_f32 v58, v108, v109
    v_cvt_pk_bf16_f32 v59, v110, v111
    buffer_store_dwordx4 v[56:59], v251, s[4:7], s53 offen offset:1024 sc1
    s_add_u32 s53, s53, s22
    s_waitcnt vmcnt(7)
    v_lshlrev_b32 v8, 16, v216
    v_and_b32 v9, 0xffff0000, v216
    v_lshlrev_b32 v10, 16, v217
    v_and_b32 v11, 0xffff0000, v217
    v_lshlrev_b32 v12, 16, v218
    v_and_b32 v13, 0xffff0000, v218
    v_lshlrev_b32 v14, 16, v219
    v_and_b32 v15, 0xffff0000, v219
    v_pk_add_f32 v[112:113], v[112:113], v[8:9]
    v_pk_add_f32 v[114:115], v[114:115], v[10:11]
    v_pk_add_f32 v[116:117], v[116:117], v[12:13]
    v_pk_add_f32 v[118:119], v[118:119], v[14:15]
    v_cvt_pk_bf16_f32 v16, v112, v113
    v_cvt_pk_bf16_f32 v17, v114, v115
    v_cvt_pk_bf16_f32 v18, v116, v117
    v_cvt_pk_bf16_f32 v19, v118, v119
    buffer_store_dwordx4 v[16:19], v251, s[4:7], s53 offen offset:0 sc1
    s_waitcnt vmcnt(7)
    v_lshlrev_b32 v28, 16, v220
    v_and_b32 v29, 0xffff0000, v220
    v_lshlrev_b32 v30, 16, v221
    v_and_b32 v31, 0xffff0000, v221
    v_lshlrev_b32 v32, 16, v222
    v_and_b32 v33, 0xffff0000, v222
    v_lshlrev_b32 v34, 16, v223
    v_and_b32 v35, 0xffff0000, v223
    v_pk_add_f32 v[120:121], v[120:121], v[28:29]
    v_pk_add_f32 v[122:123], v[122:123], v[30:31]
    v_pk_add_f32 v[124:125], v[124:125], v[32:33]
    v_pk_add_f32 v[126:127], v[126:127], v[34:35]
    v_cvt_pk_bf16_f32 v36, v120, v121
    v_cvt_pk_bf16_f32 v37, v122, v123
    v_cvt_pk_bf16_f32 v38, v124, v125
    v_cvt_pk_bf16_f32 v39, v126, v127
    buffer_store_dwordx4 v[36:39], v251, s[4:7], s53 offen offset:1024 sc1
    s_branch main_kernel_w_done
main_kernel_w_c0_esilu:
    s_mov_b32 s53, s21
    s_waitcnt vmcnt(7)
    v_lshlrev_b32 v8, 16, v192
    v_and_b32 v9, 0xffff0000, v192
    v_lshlrev_b32 v10, 16, v193
    v_and_b32 v11, 0xffff0000, v193
    v_lshlrev_b32 v12, 16, v194
    v_and_b32 v13, 0xffff0000, v194
    v_lshlrev_b32 v14, 16, v195
    v_and_b32 v15, 0xffff0000, v195
    v_pk_add_f32 v[64:65], v[64:65], v[8:9]
    v_pk_add_f32 v[66:67], v[66:67], v[10:11]
    v_pk_add_f32 v[68:69], v[68:69], v[12:13]
    v_pk_add_f32 v[70:71], v[70:71], v[14:15]
    v_pk_mul_f32 v[8:9], v[64:65], v[246:247]
    v_pk_mul_f32 v[10:11], v[66:67], v[246:247]
    v_pk_mul_f32 v[12:13], v[68:69], v[246:247]
    v_pk_mul_f32 v[14:15], v[70:71], v[246:247]
    v_exp_f32 v8, v8
    v_exp_f32 v9, v9
    v_exp_f32 v10, v10
    v_exp_f32 v11, v11
    v_exp_f32 v12, v12
    v_exp_f32 v13, v13
    v_exp_f32 v14, v14
    v_exp_f32 v15, v15
    v_pk_add_f32 v[8:9], v[8:9], v[244:245]
    v_pk_add_f32 v[10:11], v[10:11], v[244:245]
    v_pk_add_f32 v[12:13], v[12:13], v[244:245]
    v_pk_add_f32 v[14:15], v[14:15], v[244:245]
    v_rcp_f32 v8, v8
    v_rcp_f32 v9, v9
    v_rcp_f32 v10, v10
    v_rcp_f32 v11, v11
    v_rcp_f32 v12, v12
    v_rcp_f32 v13, v13
    v_rcp_f32 v14, v14
    v_rcp_f32 v15, v15
    v_pk_mul_f32 v[64:65], v[8:9], v[64:65]
    v_pk_mul_f32 v[66:67], v[10:11], v[66:67]
    v_pk_mul_f32 v[68:69], v[12:13], v[68:69]
    v_pk_mul_f32 v[70:71], v[14:15], v[70:71]
    v_cvt_pk_bf16_f32 v16, v64, v65
    v_cvt_pk_bf16_f32 v17, v66, v67
    v_cvt_pk_bf16_f32 v18, v68, v69
    v_cvt_pk_bf16_f32 v19, v70, v71
    buffer_store_dwordx4 v[16:19], v251, s[4:7], s53 offen offset:0 sc1
    s_waitcnt vmcnt(7)
    v_lshlrev_b32 v28, 16, v196
    v_and_b32 v29, 0xffff0000, v196
    v_lshlrev_b32 v30, 16, v197
    v_and_b32 v31, 0xffff0000, v197
    v_lshlrev_b32 v32, 16, v198
    v_and_b32 v33, 0xffff0000, v198
    v_lshlrev_b32 v34, 16, v199
    v_and_b32 v35, 0xffff0000, v199
    v_pk_add_f32 v[72:73], v[72:73], v[28:29]
    v_pk_add_f32 v[74:75], v[74:75], v[30:31]
    v_pk_add_f32 v[76:77], v[76:77], v[32:33]
    v_pk_add_f32 v[78:79], v[78:79], v[34:35]
    v_pk_mul_f32 v[28:29], v[72:73], v[246:247]
    v_pk_mul_f32 v[30:31], v[74:75], v[246:247]
    v_pk_mul_f32 v[32:33], v[76:77], v[246:247]
    v_pk_mul_f32 v[34:35], v[78:79], v[246:247]
    v_exp_f32 v28, v28
    v_exp_f32 v29, v29
    v_exp_f32 v30, v30
    v_exp_f32 v31, v31
    v_exp_f32 v32, v32
    v_exp_f32 v33, v33
    v_exp_f32 v34, v34
    v_exp_f32 v35, v35
    v_pk_add_f32 v[28:29], v[28:29], v[244:245]
    v_pk_add_f32 v[30:31], v[30:31], v[244:245]
    v_pk_add_f32 v[32:33], v[32:33], v[244:245]
    v_pk_add_f32 v[34:35], v[34:35], v[244:245]
    v_rcp_f32 v28, v28
    v_rcp_f32 v29, v29
    v_rcp_f32 v30, v30
    v_rcp_f32 v31, v31
    v_rcp_f32 v32, v32
    v_rcp_f32 v33, v33
    v_rcp_f32 v34, v34
    v_rcp_f32 v35, v35
    v_pk_mul_f32 v[72:73], v[28:29], v[72:73]
    v_pk_mul_f32 v[74:75], v[30:31], v[74:75]
    v_pk_mul_f32 v[76:77], v[32:33], v[76:77]
    v_pk_mul_f32 v[78:79], v[34:35], v[78:79]
    v_cvt_pk_bf16_f32 v36, v72, v73
    v_cvt_pk_bf16_f32 v37, v74, v75
    v_cvt_pk_bf16_f32 v38, v76, v77
    v_cvt_pk_bf16_f32 v39, v78, v79
    buffer_store_dwordx4 v[36:39], v251, s[4:7], s53 offen offset:1024 sc1
    s_add_u32 s53, s53, s22
    s_waitcnt vmcnt(7)
    v_lshlrev_b32 v48, 16, v200
    v_and_b32 v49, 0xffff0000, v200
    v_lshlrev_b32 v50, 16, v201
    v_and_b32 v51, 0xffff0000, v201
    v_lshlrev_b32 v52, 16, v202
    v_and_b32 v53, 0xffff0000, v202
    v_lshlrev_b32 v54, 16, v203
    v_and_b32 v55, 0xffff0000, v203
    v_pk_add_f32 v[80:81], v[80:81], v[48:49]
    v_pk_add_f32 v[82:83], v[82:83], v[50:51]
    v_pk_add_f32 v[84:85], v[84:85], v[52:53]
    v_pk_add_f32 v[86:87], v[86:87], v[54:55]
    v_pk_mul_f32 v[48:49], v[80:81], v[246:247]
    v_pk_mul_f32 v[50:51], v[82:83], v[246:247]
    v_pk_mul_f32 v[52:53], v[84:85], v[246:247]
    v_pk_mul_f32 v[54:55], v[86:87], v[246:247]
    v_exp_f32 v48, v48
    v_exp_f32 v49, v49
    v_exp_f32 v50, v50
    v_exp_f32 v51, v51
    v_exp_f32 v52, v52
    v_exp_f32 v53, v53
    v_exp_f32 v54, v54
    v_exp_f32 v55, v55
    v_pk_add_f32 v[48:49], v[48:49], v[244:245]
    v_pk_add_f32 v[50:51], v[50:51], v[244:245]
    v_pk_add_f32 v[52:53], v[52:53], v[244:245]
    v_pk_add_f32 v[54:55], v[54:55], v[244:245]
    v_rcp_f32 v48, v48
    v_rcp_f32 v49, v49
    v_rcp_f32 v50, v50
    v_rcp_f32 v51, v51
    v_rcp_f32 v52, v52
    v_rcp_f32 v53, v53
    v_rcp_f32 v54, v54
    v_rcp_f32 v55, v55
    v_pk_mul_f32 v[80:81], v[48:49], v[80:81]
    v_pk_mul_f32 v[82:83], v[50:51], v[82:83]
    v_pk_mul_f32 v[84:85], v[52:53], v[84:85]
    v_pk_mul_f32 v[86:87], v[54:55], v[86:87]
    v_cvt_pk_bf16_f32 v56, v80, v81
    v_cvt_pk_bf16_f32 v57, v82, v83
    v_cvt_pk_bf16_f32 v58, v84, v85
    v_cvt_pk_bf16_f32 v59, v86, v87
    buffer_store_dwordx4 v[56:59], v251, s[4:7], s53 offen offset:0 sc1
    s_waitcnt vmcnt(7)
    v_lshlrev_b32 v8, 16, v204
    v_and_b32 v9, 0xffff0000, v204
    v_lshlrev_b32 v10, 16, v205
    v_and_b32 v11, 0xffff0000, v205
    v_lshlrev_b32 v12, 16, v206
    v_and_b32 v13, 0xffff0000, v206
    v_lshlrev_b32 v14, 16, v207
    v_and_b32 v15, 0xffff0000, v207
    v_pk_add_f32 v[88:89], v[88:89], v[8:9]
    v_pk_add_f32 v[90:91], v[90:91], v[10:11]
    v_pk_add_f32 v[92:93], v[92:93], v[12:13]
    v_pk_add_f32 v[94:95], v[94:95], v[14:15]
    v_pk_mul_f32 v[8:9], v[88:89], v[246:247]
    v_pk_mul_f32 v[10:11], v[90:91], v[246:247]
    v_pk_mul_f32 v[12:13], v[92:93], v[246:247]
    v_pk_mul_f32 v[14:15], v[94:95], v[246:247]
    v_exp_f32 v8, v8
    v_exp_f32 v9, v9
    v_exp_f32 v10, v10
    v_exp_f32 v11, v11
    v_exp_f32 v12, v12
    v_exp_f32 v13, v13
    v_exp_f32 v14, v14
    v_exp_f32 v15, v15
    v_pk_add_f32 v[8:9], v[8:9], v[244:245]
    v_pk_add_f32 v[10:11], v[10:11], v[244:245]
    v_pk_add_f32 v[12:13], v[12:13], v[244:245]
    v_pk_add_f32 v[14:15], v[14:15], v[244:245]
    v_rcp_f32 v8, v8
    v_rcp_f32 v9, v9
    v_rcp_f32 v10, v10
    v_rcp_f32 v11, v11
    v_rcp_f32 v12, v12
    v_rcp_f32 v13, v13
    v_rcp_f32 v14, v14
    v_rcp_f32 v15, v15
    v_pk_mul_f32 v[88:89], v[8:9], v[88:89]
    v_pk_mul_f32 v[90:91], v[10:11], v[90:91]
    v_pk_mul_f32 v[92:93], v[12:13], v[92:93]
    v_pk_mul_f32 v[94:95], v[14:15], v[94:95]
    v_cvt_pk_bf16_f32 v16, v88, v89
    v_cvt_pk_bf16_f32 v17, v90, v91
    v_cvt_pk_bf16_f32 v18, v92, v93
    v_cvt_pk_bf16_f32 v19, v94, v95
    buffer_store_dwordx4 v[16:19], v251, s[4:7], s53 offen offset:1024 sc1
    s_add_u32 s53, s53, s22
    s_waitcnt vmcnt(7)
    v_lshlrev_b32 v28, 16, v208
    v_and_b32 v29, 0xffff0000, v208
    v_lshlrev_b32 v30, 16, v209
    v_and_b32 v31, 0xffff0000, v209
    v_lshlrev_b32 v32, 16, v210
    v_and_b32 v33, 0xffff0000, v210
    v_lshlrev_b32 v34, 16, v211
    v_and_b32 v35, 0xffff0000, v211
    v_pk_add_f32 v[96:97], v[96:97], v[28:29]
    v_pk_add_f32 v[98:99], v[98:99], v[30:31]
    v_pk_add_f32 v[100:101], v[100:101], v[32:33]
    v_pk_add_f32 v[102:103], v[102:103], v[34:35]
    v_pk_mul_f32 v[28:29], v[96:97], v[246:247]
    v_pk_mul_f32 v[30:31], v[98:99], v[246:247]
    v_pk_mul_f32 v[32:33], v[100:101], v[246:247]
    v_pk_mul_f32 v[34:35], v[102:103], v[246:247]
    v_exp_f32 v28, v28
    v_exp_f32 v29, v29
    v_exp_f32 v30, v30
    v_exp_f32 v31, v31
    v_exp_f32 v32, v32
    v_exp_f32 v33, v33
    v_exp_f32 v34, v34
    v_exp_f32 v35, v35
    v_pk_add_f32 v[28:29], v[28:29], v[244:245]
    v_pk_add_f32 v[30:31], v[30:31], v[244:245]
    v_pk_add_f32 v[32:33], v[32:33], v[244:245]
    v_pk_add_f32 v[34:35], v[34:35], v[244:245]
    v_rcp_f32 v28, v28
    v_rcp_f32 v29, v29
    v_rcp_f32 v30, v30
    v_rcp_f32 v31, v31
    v_rcp_f32 v32, v32
    v_rcp_f32 v33, v33
    v_rcp_f32 v34, v34
    v_rcp_f32 v35, v35
    v_pk_mul_f32 v[96:97], v[28:29], v[96:97]
    v_pk_mul_f32 v[98:99], v[30:31], v[98:99]
    v_pk_mul_f32 v[100:101], v[32:33], v[100:101]
    v_pk_mul_f32 v[102:103], v[34:35], v[102:103]
    v_cvt_pk_bf16_f32 v36, v96, v97
    v_cvt_pk_bf16_f32 v37, v98, v99
    v_cvt_pk_bf16_f32 v38, v100, v101
    v_cvt_pk_bf16_f32 v39, v102, v103
    buffer_store_dwordx4 v[36:39], v251, s[4:7], s53 offen offset:0 sc1
    s_waitcnt vmcnt(7)
    v_lshlrev_b32 v48, 16, v212
    v_and_b32 v49, 0xffff0000, v212
    v_lshlrev_b32 v50, 16, v213
    v_and_b32 v51, 0xffff0000, v213
    v_lshlrev_b32 v52, 16, v214
    v_and_b32 v53, 0xffff0000, v214
    v_lshlrev_b32 v54, 16, v215
    v_and_b32 v55, 0xffff0000, v215
    v_pk_add_f32 v[104:105], v[104:105], v[48:49]
    v_pk_add_f32 v[106:107], v[106:107], v[50:51]
    v_pk_add_f32 v[108:109], v[108:109], v[52:53]
    v_pk_add_f32 v[110:111], v[110:111], v[54:55]
    v_pk_mul_f32 v[48:49], v[104:105], v[246:247]
    v_pk_mul_f32 v[50:51], v[106:107], v[246:247]
    v_pk_mul_f32 v[52:53], v[108:109], v[246:247]
    v_pk_mul_f32 v[54:55], v[110:111], v[246:247]
    v_exp_f32 v48, v48
    v_exp_f32 v49, v49
    v_exp_f32 v50, v50
    v_exp_f32 v51, v51
    v_exp_f32 v52, v52
    v_exp_f32 v53, v53
    v_exp_f32 v54, v54
    v_exp_f32 v55, v55
    v_pk_add_f32 v[48:49], v[48:49], v[244:245]
    v_pk_add_f32 v[50:51], v[50:51], v[244:245]
    v_pk_add_f32 v[52:53], v[52:53], v[244:245]
    v_pk_add_f32 v[54:55], v[54:55], v[244:245]
    v_rcp_f32 v48, v48
    v_rcp_f32 v49, v49
    v_rcp_f32 v50, v50
    v_rcp_f32 v51, v51
    v_rcp_f32 v52, v52
    v_rcp_f32 v53, v53
    v_rcp_f32 v54, v54
    v_rcp_f32 v55, v55
    v_pk_mul_f32 v[104:105], v[48:49], v[104:105]
    v_pk_mul_f32 v[106:107], v[50:51], v[106:107]
    v_pk_mul_f32 v[108:109], v[52:53], v[108:109]
    v_pk_mul_f32 v[110:111], v[54:55], v[110:111]
    v_cvt_pk_bf16_f32 v56, v104, v105
    v_cvt_pk_bf16_f32 v57, v106, v107
    v_cvt_pk_bf16_f32 v58, v108, v109
    v_cvt_pk_bf16_f32 v59, v110, v111
    buffer_store_dwordx4 v[56:59], v251, s[4:7], s53 offen offset:1024 sc1
    s_add_u32 s53, s53, s22
    s_waitcnt vmcnt(7)
    v_lshlrev_b32 v8, 16, v216
    v_and_b32 v9, 0xffff0000, v216
    v_lshlrev_b32 v10, 16, v217
    v_and_b32 v11, 0xffff0000, v217
    v_lshlrev_b32 v12, 16, v218
    v_and_b32 v13, 0xffff0000, v218
    v_lshlrev_b32 v14, 16, v219
    v_and_b32 v15, 0xffff0000, v219
    v_pk_add_f32 v[112:113], v[112:113], v[8:9]
    v_pk_add_f32 v[114:115], v[114:115], v[10:11]
    v_pk_add_f32 v[116:117], v[116:117], v[12:13]
    v_pk_add_f32 v[118:119], v[118:119], v[14:15]
    v_pk_mul_f32 v[8:9], v[112:113], v[246:247]
    v_pk_mul_f32 v[10:11], v[114:115], v[246:247]
    v_pk_mul_f32 v[12:13], v[116:117], v[246:247]
    v_pk_mul_f32 v[14:15], v[118:119], v[246:247]
    v_exp_f32 v8, v8
    v_exp_f32 v9, v9
    v_exp_f32 v10, v10
    v_exp_f32 v11, v11
    v_exp_f32 v12, v12
    v_exp_f32 v13, v13
    v_exp_f32 v14, v14
    v_exp_f32 v15, v15
    v_pk_add_f32 v[8:9], v[8:9], v[244:245]
    v_pk_add_f32 v[10:11], v[10:11], v[244:245]
    v_pk_add_f32 v[12:13], v[12:13], v[244:245]
    v_pk_add_f32 v[14:15], v[14:15], v[244:245]
    v_rcp_f32 v8, v8
    v_rcp_f32 v9, v9
    v_rcp_f32 v10, v10
    v_rcp_f32 v11, v11
    v_rcp_f32 v12, v12
    v_rcp_f32 v13, v13
    v_rcp_f32 v14, v14
    v_rcp_f32 v15, v15
    v_pk_mul_f32 v[112:113], v[8:9], v[112:113]
    v_pk_mul_f32 v[114:115], v[10:11], v[114:115]
    v_pk_mul_f32 v[116:117], v[12:13], v[116:117]
    v_pk_mul_f32 v[118:119], v[14:15], v[118:119]
    v_cvt_pk_bf16_f32 v16, v112, v113
    v_cvt_pk_bf16_f32 v17, v114, v115
    v_cvt_pk_bf16_f32 v18, v116, v117
    v_cvt_pk_bf16_f32 v19, v118, v119
    buffer_store_dwordx4 v[16:19], v251, s[4:7], s53 offen offset:0 sc1
    s_waitcnt vmcnt(7)
    v_lshlrev_b32 v28, 16, v220
    v_and_b32 v29, 0xffff0000, v220
    v_lshlrev_b32 v30, 16, v221
    v_and_b32 v31, 0xffff0000, v221
    v_lshlrev_b32 v32, 16, v222
    v_and_b32 v33, 0xffff0000, v222
    v_lshlrev_b32 v34, 16, v223
    v_and_b32 v35, 0xffff0000, v223
    v_pk_add_f32 v[120:121], v[120:121], v[28:29]
    v_pk_add_f32 v[122:123], v[122:123], v[30:31]
    v_pk_add_f32 v[124:125], v[124:125], v[32:33]
    v_pk_add_f32 v[126:127], v[126:127], v[34:35]
    v_pk_mul_f32 v[28:29], v[120:121], v[246:247]
    v_pk_mul_f32 v[30:31], v[122:123], v[246:247]
    v_pk_mul_f32 v[32:33], v[124:125], v[246:247]
    v_pk_mul_f32 v[34:35], v[126:127], v[246:247]
    v_exp_f32 v28, v28
    v_exp_f32 v29, v29
    v_exp_f32 v30, v30
    v_exp_f32 v31, v31
    v_exp_f32 v32, v32
    v_exp_f32 v33, v33
    v_exp_f32 v34, v34
    v_exp_f32 v35, v35
    v_pk_add_f32 v[28:29], v[28:29], v[244:245]
    v_pk_add_f32 v[30:31], v[30:31], v[244:245]
    v_pk_add_f32 v[32:33], v[32:33], v[244:245]
    v_pk_add_f32 v[34:35], v[34:35], v[244:245]
    v_rcp_f32 v28, v28
    v_rcp_f32 v29, v29
    v_rcp_f32 v30, v30
    v_rcp_f32 v31, v31
    v_rcp_f32 v32, v32
    v_rcp_f32 v33, v33
    v_rcp_f32 v34, v34
    v_rcp_f32 v35, v35
    v_pk_mul_f32 v[120:121], v[28:29], v[120:121]
    v_pk_mul_f32 v[122:123], v[30:31], v[122:123]
    v_pk_mul_f32 v[124:125], v[32:33], v[124:125]
    v_pk_mul_f32 v[126:127], v[34:35], v[126:127]
    v_cvt_pk_bf16_f32 v36, v120, v121
    v_cvt_pk_bf16_f32 v37, v122, v123
    v_cvt_pk_bf16_f32 v38, v124, v125
    v_cvt_pk_bf16_f32 v39, v126, v127
    buffer_store_dwordx4 v[36:39], v251, s[4:7], s53 offen offset:1024 sc1
    s_branch main_kernel_w_done
main_kernel_w_c0_efin:
    s_mov_b32 s53, s21
    s_add_u32 s32, s21, 0
    buffer_load_dwordx4 v[160:163], v252, s[96:99], s32 offen offset:0
    buffer_load_dwordx4 v[164:167], v252, s[96:99], s32 offen offset:64
    s_add_u32 s32, s21, 32768
    buffer_load_dwordx4 v[168:171], v252, s[96:99], s32 offen offset:0
    buffer_load_dwordx4 v[172:175], v252, s[96:99], s32 offen offset:64
    s_add_u32 s32, s21, 65536
    buffer_load_dwordx4 v[176:179], v252, s[96:99], s32 offen offset:0
    buffer_load_dwordx4 v[180:183], v252, s[96:99], s32 offen offset:64
    s_add_u32 s32, s21, 98304
    buffer_load_dwordx4 v[184:187], v252, s[96:99], s32 offen offset:0
    buffer_load_dwordx4 v[188:191], v252, s[96:99], s32 offen offset:64
    s_waitcnt vmcnt(7)
    v_permlane16_swap_b32 v160, v162
    v_permlane16_swap_b32 v161, v163
    v_lshlrev_b32 v8, 16, v192
    v_and_b32 v9, 0xffff0000, v192
    v_lshlrev_b32 v10, 16, v193
    v_and_b32 v11, 0xffff0000, v193
    v_lshlrev_b32 v12, 16, v194
    v_and_b32 v13, 0xffff0000, v194
    v_lshlrev_b32 v14, 16, v195
    v_and_b32 v15, 0xffff0000, v195
    v_permlane32_swap_b32 v160, v162
    v_permlane32_swap_b32 v161, v163
    v_lshlrev_b32 v16, 16, v160
    v_and_b32 v17, 0xffff0000, v160
    v_lshlrev_b32 v18, 16, v161
    v_and_b32 v19, 0xffff0000, v161
    v_lshlrev_b32 v20, 16, v162
    v_and_b32 v21, 0xffff0000, v162
    v_lshlrev_b32 v22, 16, v163
    v_and_b32 v23, 0xffff0000, v163
    v_pk_fma_f32 v[8:9], v[64:65], v[8:9], v[16:17]
    v_pk_fma_f32 v[10:11], v[66:67], v[10:11], v[18:19]
    v_pk_fma_f32 v[12:13], v[68:69], v[12:13], v[20:21]
    v_pk_fma_f32 v[14:15], v[70:71], v[14:15], v[22:23]
    v_cvt_pk_bf16_f32 v24, v8, v9
    v_cvt_pk_bf16_f32 v25, v10, v11
    v_cvt_pk_bf16_f32 v26, v12, v13
    v_cvt_pk_bf16_f32 v27, v14, v15
    s_nop 0
    v_permlane32_swap_b32 v24, v26
    v_permlane32_swap_b32 v25, v27
    s_nop 0
    v_permlane16_swap_b32 v24, v26
    v_permlane16_swap_b32 v25, v27
    buffer_store_dwordx4 v[24:27], v252, s[92:95], s53 offen offset:0
    s_waitcnt vmcnt(7)
    v_permlane16_swap_b32 v164, v166
    v_permlane16_swap_b32 v165, v167
    v_lshlrev_b32 v36, 16, v196
    v_and_b32 v37, 0xffff0000, v196
    v_lshlrev_b32 v38, 16, v197
    v_and_b32 v39, 0xffff0000, v197
    v_lshlrev_b32 v40, 16, v198
    v_and_b32 v41, 0xffff0000, v198
    v_lshlrev_b32 v42, 16, v199
    v_and_b32 v43, 0xffff0000, v199
    v_permlane32_swap_b32 v164, v166
    v_permlane32_swap_b32 v165, v167
    v_lshlrev_b32 v44, 16, v164
    v_and_b32 v45, 0xffff0000, v164
    v_lshlrev_b32 v46, 16, v165
    v_and_b32 v47, 0xffff0000, v165
    v_lshlrev_b32 v48, 16, v166
    v_and_b32 v49, 0xffff0000, v166
    v_lshlrev_b32 v50, 16, v167
    v_and_b32 v51, 0xffff0000, v167
    v_pk_fma_f32 v[36:37], v[72:73], v[36:37], v[44:45]
    v_pk_fma_f32 v[38:39], v[74:75], v[38:39], v[46:47]
    v_pk_fma_f32 v[40:41], v[76:77], v[40:41], v[48:49]
    v_pk_fma_f32 v[42:43], v[78:79], v[42:43], v[50:51]
    v_cvt_pk_bf16_f32 v52, v36, v37
    v_cvt_pk_bf16_f32 v53, v38, v39
    v_cvt_pk_bf16_f32 v54, v40, v41
    v_cvt_pk_bf16_f32 v55, v42, v43
    s_nop 0
    v_permlane32_swap_b32 v52, v54
    v_permlane32_swap_b32 v53, v55
    s_nop 0
    v_permlane16_swap_b32 v52, v54
    v_permlane16_swap_b32 v53, v55
    buffer_store_dwordx4 v[52:55], v252, s[92:95], s53 offen offset:64
    s_add_u32 s53, s53, 32768
    s_waitcnt vmcnt(7)
    v_permlane16_swap_b32 v168, v170
    v_permlane16_swap_b32 v169, v171
    v_lshlrev_b32 v8, 16, v200
    v_and_b32 v9, 0xffff0000, v200
    v_lshlrev_b32 v10, 16, v201
    v_and_b32 v11, 0xffff0000, v201
    v_lshlrev_b32 v12, 16, v202
    v_and_b32 v13, 0xffff0000, v202
    v_lshlrev_b32 v14, 16, v203
    v_and_b32 v15, 0xffff0000, v203
    v_permlane32_swap_b32 v168, v170
    v_permlane32_swap_b32 v169, v171
    v_lshlrev_b32 v16, 16, v168
    v_and_b32 v17, 0xffff0000, v168
    v_lshlrev_b32 v18, 16, v169
    v_and_b32 v19, 0xffff0000, v169
    v_lshlrev_b32 v20, 16, v170
    v_and_b32 v21, 0xffff0000, v170
    v_lshlrev_b32 v22, 16, v171
    v_and_b32 v23, 0xffff0000, v171
    v_pk_fma_f32 v[8:9], v[80:81], v[8:9], v[16:17]
    v_pk_fma_f32 v[10:11], v[82:83], v[10:11], v[18:19]
    v_pk_fma_f32 v[12:13], v[84:85], v[12:13], v[20:21]
    v_pk_fma_f32 v[14:15], v[86:87], v[14:15], v[22:23]
    v_cvt_pk_bf16_f32 v24, v8, v9
    v_cvt_pk_bf16_f32 v25, v10, v11
    v_cvt_pk_bf16_f32 v26, v12, v13
    v_cvt_pk_bf16_f32 v27, v14, v15
    s_nop 0
    v_permlane32_swap_b32 v24, v26
    v_permlane32_swap_b32 v25, v27
    s_nop 0
    v_permlane16_swap_b32 v24, v26
    v_permlane16_swap_b32 v25, v27
    buffer_store_dwordx4 v[24:27], v252, s[92:95], s53 offen offset:0
    s_waitcnt vmcnt(7)
    v_permlane16_swap_b32 v172, v174
    v_permlane16_swap_b32 v173, v175
    v_lshlrev_b32 v36, 16, v204
    v_and_b32 v37, 0xffff0000, v204
    v_lshlrev_b32 v38, 16, v205
    v_and_b32 v39, 0xffff0000, v205
    v_lshlrev_b32 v40, 16, v206
    v_and_b32 v41, 0xffff0000, v206
    v_lshlrev_b32 v42, 16, v207
    v_and_b32 v43, 0xffff0000, v207
    v_permlane32_swap_b32 v172, v174
    v_permlane32_swap_b32 v173, v175
    v_lshlrev_b32 v44, 16, v172
    v_and_b32 v45, 0xffff0000, v172
    v_lshlrev_b32 v46, 16, v173
    v_and_b32 v47, 0xffff0000, v173
    v_lshlrev_b32 v48, 16, v174
    v_and_b32 v49, 0xffff0000, v174
    v_lshlrev_b32 v50, 16, v175
    v_and_b32 v51, 0xffff0000, v175
    v_pk_fma_f32 v[36:37], v[88:89], v[36:37], v[44:45]
    v_pk_fma_f32 v[38:39], v[90:91], v[38:39], v[46:47]
    v_pk_fma_f32 v[40:41], v[92:93], v[40:41], v[48:49]
    v_pk_fma_f32 v[42:43], v[94:95], v[42:43], v[50:51]
    v_cvt_pk_bf16_f32 v52, v36, v37
    v_cvt_pk_bf16_f32 v53, v38, v39
    v_cvt_pk_bf16_f32 v54, v40, v41
    v_cvt_pk_bf16_f32 v55, v42, v43
    s_nop 0
    v_permlane32_swap_b32 v52, v54
    v_permlane32_swap_b32 v53, v55
    s_nop 0
    v_permlane16_swap_b32 v52, v54
    v_permlane16_swap_b32 v53, v55
    buffer_store_dwordx4 v[52:55], v252, s[92:95], s53 offen offset:64
    s_add_u32 s53, s53, 32768
    s_waitcnt vmcnt(7)
    v_permlane16_swap_b32 v176, v178
    v_permlane16_swap_b32 v177, v179
    v_lshlrev_b32 v8, 16, v208
    v_and_b32 v9, 0xffff0000, v208
    v_lshlrev_b32 v10, 16, v209
    v_and_b32 v11, 0xffff0000, v209
    v_lshlrev_b32 v12, 16, v210
    v_and_b32 v13, 0xffff0000, v210
    v_lshlrev_b32 v14, 16, v211
    v_and_b32 v15, 0xffff0000, v211
    v_permlane32_swap_b32 v176, v178
    v_permlane32_swap_b32 v177, v179
    v_lshlrev_b32 v16, 16, v176
    v_and_b32 v17, 0xffff0000, v176
    v_lshlrev_b32 v18, 16, v177
    v_and_b32 v19, 0xffff0000, v177
    v_lshlrev_b32 v20, 16, v178
    v_and_b32 v21, 0xffff0000, v178
    v_lshlrev_b32 v22, 16, v179
    v_and_b32 v23, 0xffff0000, v179
    v_pk_fma_f32 v[8:9], v[96:97], v[8:9], v[16:17]
    v_pk_fma_f32 v[10:11], v[98:99], v[10:11], v[18:19]
    v_pk_fma_f32 v[12:13], v[100:101], v[12:13], v[20:21]
    v_pk_fma_f32 v[14:15], v[102:103], v[14:15], v[22:23]
    v_cvt_pk_bf16_f32 v24, v8, v9
    v_cvt_pk_bf16_f32 v25, v10, v11
    v_cvt_pk_bf16_f32 v26, v12, v13
    v_cvt_pk_bf16_f32 v27, v14, v15
    s_nop 0
    v_permlane32_swap_b32 v24, v26
    v_permlane32_swap_b32 v25, v27
    s_nop 0
    v_permlane16_swap_b32 v24, v26
    v_permlane16_swap_b32 v25, v27
    buffer_store_dwordx4 v[24:27], v252, s[92:95], s53 offen offset:0
    s_waitcnt vmcnt(7)
    v_permlane16_swap_b32 v180, v182
    v_permlane16_swap_b32 v181, v183
    v_lshlrev_b32 v36, 16, v212
    v_and_b32 v37, 0xffff0000, v212
    v_lshlrev_b32 v38, 16, v213
    v_and_b32 v39, 0xffff0000, v213
    v_lshlrev_b32 v40, 16, v214
    v_and_b32 v41, 0xffff0000, v214
    v_lshlrev_b32 v42, 16, v215
    v_and_b32 v43, 0xffff0000, v215
    v_permlane32_swap_b32 v180, v182
    v_permlane32_swap_b32 v181, v183
    v_lshlrev_b32 v44, 16, v180
    v_and_b32 v45, 0xffff0000, v180
    v_lshlrev_b32 v46, 16, v181
    v_and_b32 v47, 0xffff0000, v181
    v_lshlrev_b32 v48, 16, v182
    v_and_b32 v49, 0xffff0000, v182
    v_lshlrev_b32 v50, 16, v183
    v_and_b32 v51, 0xffff0000, v183
    v_pk_fma_f32 v[36:37], v[104:105], v[36:37], v[44:45]
    v_pk_fma_f32 v[38:39], v[106:107], v[38:39], v[46:47]
    v_pk_fma_f32 v[40:41], v[108:109], v[40:41], v[48:49]
    v_pk_fma_f32 v[42:43], v[110:111], v[42:43], v[50:51]
    v_cvt_pk_bf16_f32 v52, v36, v37
    v_cvt_pk_bf16_f32 v53, v38, v39
    v_cvt_pk_bf16_f32 v54, v40, v41
    v_cvt_pk_bf16_f32 v55, v42, v43
    s_nop 0
    v_permlane32_swap_b32 v52, v54
    v_permlane32_swap_b32 v53, v55
    s_nop 0
    v_permlane16_swap_b32 v52, v54
    v_permlane16_swap_b32 v53, v55
    buffer_store_dwordx4 v[52:55], v252, s[92:95], s53 offen offset:64
    s_add_u32 s53, s53, 32768
    s_waitcnt vmcnt(7)
    v_permlane16_swap_b32 v184, v186
    v_permlane16_swap_b32 v185, v187
    v_lshlrev_b32 v8, 16, v216
    v_and_b32 v9, 0xffff0000, v216
    v_lshlrev_b32 v10, 16, v217
    v_and_b32 v11, 0xffff0000, v217
    v_lshlrev_b32 v12, 16, v218
    v_and_b32 v13, 0xffff0000, v218
    v_lshlrev_b32 v14, 16, v219
    v_and_b32 v15, 0xffff0000, v219
    v_permlane32_swap_b32 v184, v186
    v_permlane32_swap_b32 v185, v187
    v_lshlrev_b32 v16, 16, v184
    v_and_b32 v17, 0xffff0000, v184
    v_lshlrev_b32 v18, 16, v185
    v_and_b32 v19, 0xffff0000, v185
    v_lshlrev_b32 v20, 16, v186
    v_and_b32 v21, 0xffff0000, v186
    v_lshlrev_b32 v22, 16, v187
    v_and_b32 v23, 0xffff0000, v187
    v_pk_fma_f32 v[8:9], v[112:113], v[8:9], v[16:17]
    v_pk_fma_f32 v[10:11], v[114:115], v[10:11], v[18:19]
    v_pk_fma_f32 v[12:13], v[116:117], v[12:13], v[20:21]
    v_pk_fma_f32 v[14:15], v[118:119], v[14:15], v[22:23]
    v_cvt_pk_bf16_f32 v24, v8, v9
    v_cvt_pk_bf16_f32 v25, v10, v11
    v_cvt_pk_bf16_f32 v26, v12, v13
    v_cvt_pk_bf16_f32 v27, v14, v15
    s_nop 0
    v_permlane32_swap_b32 v24, v26
    v_permlane32_swap_b32 v25, v27
    s_nop 0
    v_permlane16_swap_b32 v24, v26
    v_permlane16_swap_b32 v25, v27
    buffer_store_dwordx4 v[24:27], v252, s[92:95], s53 offen offset:0
    s_waitcnt vmcnt(7)
    v_permlane16_swap_b32 v188, v190
    v_permlane16_swap_b32 v189, v191
    v_lshlrev_b32 v36, 16, v220
    v_and_b32 v37, 0xffff0000, v220
    v_lshlrev_b32 v38, 16, v221
    v_and_b32 v39, 0xffff0000, v221
    v_lshlrev_b32 v40, 16, v222
    v_and_b32 v41, 0xffff0000, v222
    v_lshlrev_b32 v42, 16, v223
    v_and_b32 v43, 0xffff0000, v223
    v_permlane32_swap_b32 v188, v190
    v_permlane32_swap_b32 v189, v191
    v_lshlrev_b32 v44, 16, v188
    v_and_b32 v45, 0xffff0000, v188
    v_lshlrev_b32 v46, 16, v189
    v_and_b32 v47, 0xffff0000, v189
    v_lshlrev_b32 v48, 16, v190
    v_and_b32 v49, 0xffff0000, v190
    v_lshlrev_b32 v50, 16, v191
    v_and_b32 v51, 0xffff0000, v191
    v_pk_fma_f32 v[36:37], v[120:121], v[36:37], v[44:45]
    v_pk_fma_f32 v[38:39], v[122:123], v[38:39], v[46:47]
    v_pk_fma_f32 v[40:41], v[124:125], v[40:41], v[48:49]
    v_pk_fma_f32 v[42:43], v[126:127], v[42:43], v[50:51]
    v_cvt_pk_bf16_f32 v52, v36, v37
    v_cvt_pk_bf16_f32 v53, v38, v39
    v_cvt_pk_bf16_f32 v54, v40, v41
    v_cvt_pk_bf16_f32 v55, v42, v43
    s_nop 0
    v_permlane32_swap_b32 v52, v54
    v_permlane32_swap_b32 v53, v55
    s_nop 0
    v_permlane16_swap_b32 v52, v54
    v_permlane16_swap_b32 v53, v55
    buffer_store_dwordx4 v[52:55], v252, s[92:95], s53 offen offset:64
    s_branch main_kernel_w_done
main_kernel_w_c0_gov:
    v_lshrrev_b32 v0, 4, v250
    v_bfe_u32 v1, v250, 2, 2
    v_lshl_add_u32 v4, v0, 2, v1
    v_and_b32 v5, 7, v4
    v_mul_u32_u24 v4, 256, v4
    v_and_b32 v6, 3, v250
    v_lshl_add_u32 v4, v6, 3, v4
    s_mul_i32 s32, s37, 4
    v_xor_b32 v5, s32, v5
    v_lshl_add_u32 v128, v5, 5, v4
    v_xor_b32 v129, 32, v128
    v_xor_b32 v130, 64, v128
    v_xor_b32 v131, 96, v128
    s_mul_i32 s32, s38, 8192
    s_add_u32 s32, s32, 65536
    v_add_u32 v136, s32, v251
    v_lshrrev_b32 v2, 4, v250
    v_and_b32 v3, 15, v250
    s_mul_i32 s32, s14, 16
    v_add_u32 v4, s32, v2
    v_add_u32 v5, 0, v4
    v_and_b32 v6, 7, v5
    v_lshlrev_b32 v6, 1, v6
    v_xor_b32 v6, v6, v3
    v_mul_lo_u32 v5, v5, s30
    v_lshl_add_u32 v5, v6, 4, v5
    v_subrev_u32 v137, 0, v5
    v_add_u32 v5, 4, v4
    v_and_b32 v6, 7, v5
    v_lshlrev_b32 v6, 1, v6
    v_xor_b32 v6, v6, v3
    v_mul_lo_u32 v5, v5, s30
    v_lshl_add_u32 v5, v6, 4, v5
    v_subrev_u32 v138, 1024, v5
    v_add_u32 v5, 8, v4
    v_and_b32 v6, 7, v5
    v_lshlrev_b32 v6, 1, v6
    v_xor_b32 v6, v6, v3
    v_mul_lo_u32 v5, v5, s30
    v_lshl_add_u32 v5, v6, 4, v5
    v_subrev_u32 v139, 2048, v5
    v_add_u32 v5, 12, v4
    v_and_b32 v6, 7, v5
    v_lshlrev_b32 v6, 1, v6
    v_xor_b32 v6, v6, v3
    v_mul_lo_u32 v5, v5, s30
    v_lshl_add_u32 v5, v6, 4, v5
    v_subrev_u32 v140, 3072, v5
    s_mul_i32 s32, s14, 2
    s_mul_i32 s32, s32, s31
    v_add_u32 v141, s32, v251
    s_add_u32 s32, s32, s31
    s_sub_u32 s32, s32, 2048
    v_add_u32 v142, s32, v251
    s_mul_i32 s19, s14, 4096
    s_mul_i32 s20, s14, 4096
    s_add_u32 s20, s20, 65536
    s_mul_i32 s17, s30, 64
    s_mov_b32 s15, 0
    s_add_u32 m0, s20, 0
    s_nop 0
    buffer_load_dwordx4 v141, s[4:7], s16 offen offset:0 sc1 lds
    buffer_load_dwordx4 v141, s[4:7], s16 offen offset:1024 sc1 lds
    buffer_load_dwordx4 v142, s[4:7], s16 offen offset:2048 sc1 lds
    buffer_load_dwordx4 v142, s[4:7], s16 offen offset:3072 sc1 lds
    s_add_u32 s16, s16, 2048
    s_add_u32 m0, s19, 0
    s_nop 0
    buffer_load_dwordx4 v137, s[8:11], s15 offen offset:0 lds
    buffer_load_dwordx4 v138, s[8:11], s15 offen offset:1024 lds
    buffer_load_dwordx4 v139, s[8:11], s15 offen offset:2048 lds
    buffer_load_dwordx4 v140, s[8:11], s15 offen offset:3072 lds
    s_add_u32 s15, s15, s17
    s_add_u32 m0, s20, 16384
    s_nop 0
    buffer_load_dwordx4 v141, s[4:7], s16 offen offset:0 sc1 lds
    buffer_load_dwordx4 v141, s[4:7], s16 offen offset:1024 sc1 lds
    buffer_load_dwordx4 v142, s[4:7], s16 offen offset:2048 sc1 lds
    buffer_load_dwordx4 v142, s[4:7], s16 offen offset:3072 sc1 lds
    s_add_u32 s16, s16, 2048
    s_add_u32 m0, s19, 16384
    s_nop 0
    buffer_load_dwordx4 v137, s[8:11], s15 offen offset:0 lds
    buffer_load_dwordx4 v138, s[8:11], s15 offen offset:1024 lds
    buffer_load_dwordx4 v139, s[8:11], s15 offen offset:2048 lds
    buffer_load_dwordx4 v140, s[8:11], s15 offen offset:3072 lds
    s_add_u32 s15, s15, s17
    s_add_u32 m0, s20, 32768
    s_nop 0
    buffer_load_dwordx4 v141, s[4:7], s16 offen offset:0 sc1 lds
    buffer_load_dwordx4 v141, s[4:7], s16 offen offset:1024 sc1 lds
    buffer_load_dwordx4 v142, s[4:7], s16 offen offset:2048 sc1 lds
    buffer_load_dwordx4 v142, s[4:7], s16 offen offset:3072 sc1 lds
    s_add_u32 s16, s16, 2048
    s_add_u32 m0, s19, 32768
    s_nop 0
    buffer_load_dwordx4 v137, s[8:11], s15 offen offset:0 lds
    buffer_load_dwordx4 v138, s[8:11], s15 offen offset:1024 lds
    buffer_load_dwordx4 v139, s[8:11], s15 offen offset:2048 lds
    buffer_load_dwordx4 v140, s[8:11], s15 offen offset:3072 lds
    s_add_u32 s15, s15, s17
    s_add_u32 m0, s20, 49152
    s_nop 0
    buffer_load_dwordx4 v141, s[4:7], s16 offen offset:0 sc1 lds
    buffer_load_dwordx4 v141, s[4:7], s16 offen offset:1024 sc1 lds
    buffer_load_dwordx4 v142, s[4:7], s16 offen offset:2048 sc1 lds
    buffer_load_dwordx4 v142, s[4:7], s16 offen offset:3072 sc1 lds
    s_add_u32 s16, s16, 2048
    v_mov_b32 v64, 0
    v_mov_b32 v65, 0
    v_mov_b32 v66, 0
    v_mov_b32 v67, 0
    v_mov_b32 v68, 0
    v_mov_b32 v69, 0
    v_mov_b32 v70, 0
    v_mov_b32 v71, 0
    v_mov_b32 v72, 0
    v_mov_b32 v73, 0
    v_mov_b32 v74, 0
    v_mov_b32 v75, 0
    v_mov_b32 v76, 0
    v_mov_b32 v77, 0
    v_mov_b32 v78, 0
    v_mov_b32 v79, 0
    v_mov_b32 v80, 0
    v_mov_b32 v81, 0
    v_mov_b32 v82, 0
    v_mov_b32 v83, 0
    v_mov_b32 v84, 0
    v_mov_b32 v85, 0
    v_mov_b32 v86, 0
    v_mov_b32 v87, 0
    v_mov_b32 v88, 0
    v_mov_b32 v89, 0
    v_mov_b32 v90, 0
    v_mov_b32 v91, 0
    v_mov_b32 v92, 0
    v_mov_b32 v93, 0
    v_mov_b32 v94, 0
    v_mov_b32 v95, 0
    v_mov_b32 v96, 0
    v_mov_b32 v97, 0
    v_mov_b32 v98, 0
    v_mov_b32 v99, 0
    v_mov_b32 v100, 0
    v_mov_b32 v101, 0
    v_mov_b32 v102, 0
    v_mov_b32 v103, 0
    v_mov_b32 v104, 0
    v_mov_b32 v105, 0
    v_mov_b32 v106, 0
    v_mov_b32 v107, 0
    v_mov_b32 v108, 0
    v_mov_b32 v109, 0
    v_mov_b32 v110, 0
    v_mov_b32 v111, 0
    v_mov_b32 v112, 0
    v_mov_b32 v113, 0
    v_mov_b32 v114, 0
    v_mov_b32 v115, 0
    v_mov_b32 v116, 0
    v_mov_b32 v117, 0
    v_mov_b32 v118, 0
    v_mov_b32 v119, 0
    v_mov_b32 v120, 0
    v_mov_b32 v121, 0
    v_mov_b32 v122, 0
    v_mov_b32 v123, 0
    v_mov_b32 v124, 0
    v_mov_b32 v125, 0
    v_mov_b32 v126, 0
    v_mov_b32 v127, 0
    s_waitcnt vmcnt(20)
    s_barrier
    ds_read_b128 v[16:19], v136 offset:0
    ds_read_b64_tr_b16 v[0:1], v128 offset:0
    ds_read_b64_tr_b16 v[2:3], v128 offset:4096
    ds_read_b64_tr_b16 v[4:5], v129 offset:0
    ds_read_b64_tr_b16 v[6:7], v129 offset:4096
    ds_read_b64_tr_b16 v[8:9], v130 offset:0
    ds_read_b64_tr_b16 v[10:11], v130 offset:4096
    ds_read_b64_tr_b16 v[12:13], v131 offset:0
    ds_read_b64_tr_b16 v[14:15], v131 offset:4096
    ds_read_b128 v[20:23], v136 offset:2048
    ds_read_b128 v[24:27], v136 offset:4096
    ds_read_b128 v[28:31], v136 offset:6144
main_kernel_w_c0_v_loop:
    s_waitcnt lgkmcnt(0)
    ds_read_b128 v[48:51], v136 offset:1024
    s_add_u32 m0, s19, 49152
    s_nop 0
    v_mfma_f32_16x16x32_bf16 v[64:67], v[16:19], v[0:3], v[64:67]
    ds_read_b64_tr_b16 v[32:33], v128 offset:8192
    v_mfma_f32_16x16x32_bf16 v[68:71], v[16:19], v[4:7], v[68:71]
    ds_read_b64_tr_b16 v[34:35], v128 offset:12288
    buffer_load_dwordx4 v137, s[8:11], s15 offen offset:0 lds
    v_mfma_f32_16x16x32_bf16 v[72:75], v[16:19], v[8:11], v[72:75]
    ds_read_b64_tr_b16 v[36:37], v129 offset:8192
    v_mfma_f32_16x16x32_bf16 v[76:79], v[16:19], v[12:15], v[76:79]
    ds_read_b64_tr_b16 v[38:39], v129 offset:12288
    v_mfma_f32_16x16x32_bf16 v[80:83], v[20:23], v[0:3], v[80:83]
    ds_read_b64_tr_b16 v[40:41], v130 offset:8192
    buffer_load_dwordx4 v138, s[8:11], s15 offen offset:1024 lds
    v_mfma_f32_16x16x32_bf16 v[84:87], v[20:23], v[4:7], v[84:87]
    ds_read_b64_tr_b16 v[42:43], v130 offset:12288
    v_mfma_f32_16x16x32_bf16 v[88:91], v[20:23], v[8:11], v[88:91]
    ds_read_b64_tr_b16 v[44:45], v131 offset:8192
    v_mfma_f32_16x16x32_bf16 v[92:95], v[20:23], v[12:15], v[92:95]
    ds_read_b64_tr_b16 v[46:47], v131 offset:12288
    buffer_load_dwordx4 v139, s[8:11], s15 offen offset:2048 lds
    v_mfma_f32_16x16x32_bf16 v[96:99], v[24:27], v[0:3], v[96:99]
    ds_read_b128 v[52:55], v136 offset:3072
    v_mfma_f32_16x16x32_bf16 v[100:103], v[24:27], v[4:7], v[100:103]
    ds_read_b128 v[56:59], v136 offset:5120
    buffer_load_dwordx4 v140, s[8:11], s15 offen offset:3072 lds
    v_mfma_f32_16x16x32_bf16 v[104:107], v[24:27], v[8:11], v[104:107]
    ds_read_b128 v[60:63], v136 offset:7168
    v_mfma_f32_16x16x32_bf16 v[108:111], v[24:27], v[12:15], v[108:111]
    v_mfma_f32_16x16x32_bf16 v[112:115], v[28:31], v[0:3], v[112:115]
    s_add_u32 s15, s15, s17
    v_mfma_f32_16x16x32_bf16 v[116:119], v[28:31], v[4:7], v[116:119]
    v_mfma_f32_16x16x32_bf16 v[120:123], v[28:31], v[8:11], v[120:123]
    v_mfma_f32_16x16x32_bf16 v[124:127], v[28:31], v[12:15], v[124:127]
    s_waitcnt lgkmcnt(0)
    v_mfma_f32_16x16x32_bf16 v[64:67], v[48:51], v[32:35], v[64:67]
    s_waitcnt vmcnt(16)
    s_barrier
    ds_read_b128 v[16:19], v136 offset:16384
    s_add_u32 m0, s20, 0
    s_nop 0
    v_mfma_f32_16x16x32_bf16 v[68:71], v[48:51], v[36:39], v[68:71]
    ds_read_b64_tr_b16 v[0:1], v128 offset:16384
    v_mfma_f32_16x16x32_bf16 v[72:75], v[48:51], v[40:43], v[72:75]
    ds_read_b64_tr_b16 v[2:3], v128 offset:20480
    buffer_load_dwordx4 v141, s[4:7], s16 offen offset:0 sc1 lds
    v_mfma_f32_16x16x32_bf16 v[76:79], v[48:51], v[44:47], v[76:79]
    ds_read_b64_tr_b16 v[4:5], v129 offset:16384
    v_mfma_f32_16x16x32_bf16 v[80:83], v[52:55], v[32:35], v[80:83]
    ds_read_b64_tr_b16 v[6:7], v129 offset:20480
    v_mfma_f32_16x16x32_bf16 v[84:87], v[52:55], v[36:39], v[84:87]
    ds_read_b64_tr_b16 v[8:9], v130 offset:16384
    buffer_load_dwordx4 v141, s[4:7], s16 offen offset:1024 sc1 lds
    v_mfma_f32_16x16x32_bf16 v[88:91], v[52:55], v[40:43], v[88:91]
    ds_read_b64_tr_b16 v[10:11], v130 offset:20480
    v_mfma_f32_16x16x32_bf16 v[92:95], v[52:55], v[44:47], v[92:95]
    ds_read_b64_tr_b16 v[12:13], v131 offset:16384
    buffer_load_dwordx4 v142, s[4:7], s16 offen offset:2048 sc1 lds
    v_mfma_f32_16x16x32_bf16 v[96:99], v[56:59], v[32:35], v[96:99]
    ds_read_b64_tr_b16 v[14:15], v131 offset:20480
    v_mfma_f32_16x16x32_bf16 v[100:103], v[56:59], v[36:39], v[100:103]
    ds_read_b128 v[20:23], v136 offset:18432
    v_mfma_f32_16x16x32_bf16 v[104:107], v[56:59], v[40:43], v[104:107]
    ds_read_b128 v[24:27], v136 offset:20480
    buffer_load_dwordx4 v142, s[4:7], s16 offen offset:3072 sc1 lds
    v_mfma_f32_16x16x32_bf16 v[108:111], v[56:59], v[44:47], v[108:111]
    ds_read_b128 v[28:31], v136 offset:22528
    v_mfma_f32_16x16x32_bf16 v[112:115], v[60:63], v[32:35], v[112:115]
    s_add_u32 s16, s16, 2048
    v_mfma_f32_16x16x32_bf16 v[116:119], v[60:63], v[36:39], v[116:119]
    v_mfma_f32_16x16x32_bf16 v[120:123], v[60:63], v[40:43], v[120:123]
    v_mfma_f32_16x16x32_bf16 v[124:127], v[60:63], v[44:47], v[124:127]
    s_waitcnt lgkmcnt(0)
    ds_read_b128 v[48:51], v136 offset:17408
    s_add_u32 m0, s19, 0
    s_nop 0
    v_mfma_f32_16x16x32_bf16 v[64:67], v[16:19], v[0:3], v[64:67]
    ds_read_b64_tr_b16 v[32:33], v128 offset:24576
    v_mfma_f32_16x16x32_bf16 v[68:71], v[16:19], v[4:7], v[68:71]
    ds_read_b64_tr_b16 v[34:35], v128 offset:28672
    buffer_load_dwordx4 v137, s[8:11], s15 offen offset:0 lds
    v_mfma_f32_16x16x32_bf16 v[72:75], v[16:19], v[8:11], v[72:75]
    ds_read_b64_tr_b16 v[36:37], v129 offset:24576
    v_mfma_f32_16x16x32_bf16 v[76:79], v[16:19], v[12:15], v[76:79]
    ds_read_b64_tr_b16 v[38:39], v129 offset:28672
    v_mfma_f32_16x16x32_bf16 v[80:83], v[20:23], v[0:3], v[80:83]
    ds_read_b64_tr_b16 v[40:41], v130 offset:24576
    buffer_load_dwordx4 v138, s[8:11], s15 offen offset:1024 lds
    v_mfma_f32_16x16x32_bf16 v[84:87], v[20:23], v[4:7], v[84:87]
    ds_read_b64_tr_b16 v[42:43], v130 offset:28672
    v_mfma_f32_16x16x32_bf16 v[88:91], v[20:23], v[8:11], v[88:91]
    ds_read_b64_tr_b16 v[44:45], v131 offset:24576
    v_mfma_f32_16x16x32_bf16 v[92:95], v[20:23], v[12:15], v[92:95]
    ds_read_b64_tr_b16 v[46:47], v131 offset:28672
    buffer_load_dwordx4 v139, s[8:11], s15 offen offset:2048 lds
    v_mfma_f32_16x16x32_bf16 v[96:99], v[24:27], v[0:3], v[96:99]
    ds_read_b128 v[52:55], v136 offset:19456
    v_mfma_f32_16x16x32_bf16 v[100:103], v[24:27], v[4:7], v[100:103]
    ds_read_b128 v[56:59], v136 offset:21504
    buffer_load_dwordx4 v140, s[8:11], s15 offen offset:3072 lds
    v_mfma_f32_16x16x32_bf16 v[104:107], v[24:27], v[8:11], v[104:107]
    ds_read_b128 v[60:63], v136 offset:23552
    v_mfma_f32_16x16x32_bf16 v[108:111], v[24:27], v[12:15], v[108:111]
    v_mfma_f32_16x16x32_bf16 v[112:115], v[28:31], v[0:3], v[112:115]
    s_add_u32 s15, s15, s17
    v_mfma_f32_16x16x32_bf16 v[116:119], v[28:31], v[4:7], v[116:119]
    v_mfma_f32_16x16x32_bf16 v[120:123], v[28:31], v[8:11], v[120:123]
    v_mfma_f32_16x16x32_bf16 v[124:127], v[28:31], v[12:15], v[124:127]
    s_waitcnt lgkmcnt(0)
    v_mfma_f32_16x16x32_bf16 v[64:67], v[48:51], v[32:35], v[64:67]
    s_waitcnt vmcnt(16)
    s_barrier
    ds_read_b128 v[16:19], v136 offset:32768
    s_add_u32 m0, s20, 16384
    s_nop 0
    v_mfma_f32_16x16x32_bf16 v[68:71], v[48:51], v[36:39], v[68:71]
    ds_read_b64_tr_b16 v[0:1], v128 offset:32768
    v_mfma_f32_16x16x32_bf16 v[72:75], v[48:51], v[40:43], v[72:75]
    ds_read_b64_tr_b16 v[2:3], v128 offset:36864
    buffer_load_dwordx4 v141, s[4:7], s16 offen offset:0 sc1 lds
    v_mfma_f32_16x16x32_bf16 v[76:79], v[48:51], v[44:47], v[76:79]
    ds_read_b64_tr_b16 v[4:5], v129 offset:32768
    v_mfma_f32_16x16x32_bf16 v[80:83], v[52:55], v[32:35], v[80:83]
    ds_read_b64_tr_b16 v[6:7], v129 offset:36864
    v_mfma_f32_16x16x32_bf16 v[84:87], v[52:55], v[36:39], v[84:87]
    ds_read_b64_tr_b16 v[8:9], v130 offset:32768
    buffer_load_dwordx4 v141, s[4:7], s16 offen offset:1024 sc1 lds
    v_mfma_f32_16x16x32_bf16 v[88:91], v[52:55], v[40:43], v[88:91]
    ds_read_b64_tr_b16 v[10:11], v130 offset:36864
    v_mfma_f32_16x16x32_bf16 v[92:95], v[52:55], v[44:47], v[92:95]
    ds_read_b64_tr_b16 v[12:13], v131 offset:32768
    buffer_load_dwordx4 v142, s[4:7], s16 offen offset:2048 sc1 lds
    v_mfma_f32_16x16x32_bf16 v[96:99], v[56:59], v[32:35], v[96:99]
    ds_read_b64_tr_b16 v[14:15], v131 offset:36864
    v_mfma_f32_16x16x32_bf16 v[100:103], v[56:59], v[36:39], v[100:103]
    ds_read_b128 v[20:23], v136 offset:34816
    v_mfma_f32_16x16x32_bf16 v[104:107], v[56:59], v[40:43], v[104:107]
    ds_read_b128 v[24:27], v136 offset:36864
    buffer_load_dwordx4 v142, s[4:7], s16 offen offset:3072 sc1 lds
    v_mfma_f32_16x16x32_bf16 v[108:111], v[56:59], v[44:47], v[108:111]
    ds_read_b128 v[28:31], v136 offset:38912
    v_mfma_f32_16x16x32_bf16 v[112:115], v[60:63], v[32:35], v[112:115]
    s_add_u32 s16, s16, 2048
    v_mfma_f32_16x16x32_bf16 v[116:119], v[60:63], v[36:39], v[116:119]
    v_mfma_f32_16x16x32_bf16 v[120:123], v[60:63], v[40:43], v[120:123]
    v_mfma_f32_16x16x32_bf16 v[124:127], v[60:63], v[44:47], v[124:127]
    s_waitcnt lgkmcnt(0)
    ds_read_b128 v[48:51], v136 offset:33792
    s_add_u32 m0, s19, 16384
    s_nop 0
    v_mfma_f32_16x16x32_bf16 v[64:67], v[16:19], v[0:3], v[64:67]
    ds_read_b64_tr_b16 v[32:33], v128 offset:40960
    v_mfma_f32_16x16x32_bf16 v[68:71], v[16:19], v[4:7], v[68:71]
    ds_read_b64_tr_b16 v[34:35], v128 offset:45056
    buffer_load_dwordx4 v137, s[8:11], s15 offen offset:0 lds
    v_mfma_f32_16x16x32_bf16 v[72:75], v[16:19], v[8:11], v[72:75]
    ds_read_b64_tr_b16 v[36:37], v129 offset:40960
    v_mfma_f32_16x16x32_bf16 v[76:79], v[16:19], v[12:15], v[76:79]
    ds_read_b64_tr_b16 v[38:39], v129 offset:45056
    v_mfma_f32_16x16x32_bf16 v[80:83], v[20:23], v[0:3], v[80:83]
    ds_read_b64_tr_b16 v[40:41], v130 offset:40960
    buffer_load_dwordx4 v138, s[8:11], s15 offen offset:1024 lds
    v_mfma_f32_16x16x32_bf16 v[84:87], v[20:23], v[4:7], v[84:87]
    ds_read_b64_tr_b16 v[42:43], v130 offset:45056
    v_mfma_f32_16x16x32_bf16 v[88:91], v[20:23], v[8:11], v[88:91]
    ds_read_b64_tr_b16 v[44:45], v131 offset:40960
    v_mfma_f32_16x16x32_bf16 v[92:95], v[20:23], v[12:15], v[92:95]
    ds_read_b64_tr_b16 v[46:47], v131 offset:45056
    buffer_load_dwordx4 v139, s[8:11], s15 offen offset:2048 lds
    v_mfma_f32_16x16x32_bf16 v[96:99], v[24:27], v[0:3], v[96:99]
    ds_read_b128 v[52:55], v136 offset:35840
    v_mfma_f32_16x16x32_bf16 v[100:103], v[24:27], v[4:7], v[100:103]
    ds_read_b128 v[56:59], v136 offset:37888
    buffer_load_dwordx4 v140, s[8:11], s15 offen offset:3072 lds
    v_mfma_f32_16x16x32_bf16 v[104:107], v[24:27], v[8:11], v[104:107]
    ds_read_b128 v[60:63], v136 offset:39936
    v_mfma_f32_16x16x32_bf16 v[108:111], v[24:27], v[12:15], v[108:111]
    v_mfma_f32_16x16x32_bf16 v[112:115], v[28:31], v[0:3], v[112:115]
    s_add_u32 s15, s15, s17
    v_mfma_f32_16x16x32_bf16 v[116:119], v[28:31], v[4:7], v[116:119]
    v_mfma_f32_16x16x32_bf16 v[120:123], v[28:31], v[8:11], v[120:123]
    v_mfma_f32_16x16x32_bf16 v[124:127], v[28:31], v[12:15], v[124:127]
    s_waitcnt lgkmcnt(0)
    v_mfma_f32_16x16x32_bf16 v[64:67], v[48:51], v[32:35], v[64:67]
    s_waitcnt vmcnt(16)
    s_barrier
    ds_read_b128 v[16:19], v136 offset:49152
    s_add_u32 m0, s20, 32768
    s_nop 0
    v_mfma_f32_16x16x32_bf16 v[68:71], v[48:51], v[36:39], v[68:71]
    ds_read_b64_tr_b16 v[0:1], v128 offset:49152
    v_mfma_f32_16x16x32_bf16 v[72:75], v[48:51], v[40:43], v[72:75]
    ds_read_b64_tr_b16 v[2:3], v128 offset:53248
    buffer_load_dwordx4 v141, s[4:7], s16 offen offset:0 sc1 lds
    v_mfma_f32_16x16x32_bf16 v[76:79], v[48:51], v[44:47], v[76:79]
    ds_read_b64_tr_b16 v[4:5], v129 offset:49152
    v_mfma_f32_16x16x32_bf16 v[80:83], v[52:55], v[32:35], v[80:83]
    ds_read_b64_tr_b16 v[6:7], v129 offset:53248
    v_mfma_f32_16x16x32_bf16 v[84:87], v[52:55], v[36:39], v[84:87]
    ds_read_b64_tr_b16 v[8:9], v130 offset:49152
    buffer_load_dwordx4 v141, s[4:7], s16 offen offset:1024 sc1 lds
    v_mfma_f32_16x16x32_bf16 v[88:91], v[52:55], v[40:43], v[88:91]
    ds_read_b64_tr_b16 v[10:11], v130 offset:53248
    v_mfma_f32_16x16x32_bf16 v[92:95], v[52:55], v[44:47], v[92:95]
    ds_read_b64_tr_b16 v[12:13], v131 offset:49152
    buffer_load_dwordx4 v142, s[4:7], s16 offen offset:2048 sc1 lds
    v_mfma_f32_16x16x32_bf16 v[96:99], v[56:59], v[32:35], v[96:99]
    ds_read_b64_tr_b16 v[14:15], v131 offset:53248
    v_mfma_f32_16x16x32_bf16 v[100:103], v[56:59], v[36:39], v[100:103]
    ds_read_b128 v[20:23], v136 offset:51200
    v_mfma_f32_16x16x32_bf16 v[104:107], v[56:59], v[40:43], v[104:107]
    ds_read_b128 v[24:27], v136 offset:53248
    buffer_load_dwordx4 v142, s[4:7], s16 offen offset:3072 sc1 lds
    v_mfma_f32_16x16x32_bf16 v[108:111], v[56:59], v[44:47], v[108:111]
    ds_read_b128 v[28:31], v136 offset:55296
    v_mfma_f32_16x16x32_bf16 v[112:115], v[60:63], v[32:35], v[112:115]
    s_add_u32 s16, s16, 2048
    v_mfma_f32_16x16x32_bf16 v[116:119], v[60:63], v[36:39], v[116:119]
    v_mfma_f32_16x16x32_bf16 v[120:123], v[60:63], v[40:43], v[120:123]
    v_mfma_f32_16x16x32_bf16 v[124:127], v[60:63], v[44:47], v[124:127]
    s_waitcnt lgkmcnt(0)
    ds_read_b128 v[48:51], v136 offset:50176
    s_add_u32 m0, s19, 32768
    s_nop 0
    v_mfma_f32_16x16x32_bf16 v[64:67], v[16:19], v[0:3], v[64:67]
    ds_read_b64_tr_b16 v[32:33], v128 offset:57344
    v_mfma_f32_16x16x32_bf16 v[68:71], v[16:19], v[4:7], v[68:71]
    ds_read_b64_tr_b16 v[34:35], v128 offset:61440
    buffer_load_dwordx4 v137, s[8:11], s15 offen offset:0 lds
    v_mfma_f32_16x16x32_bf16 v[72:75], v[16:19], v[8:11], v[72:75]
    ds_read_b64_tr_b16 v[36:37], v129 offset:57344
    v_mfma_f32_16x16x32_bf16 v[76:79], v[16:19], v[12:15], v[76:79]
    ds_read_b64_tr_b16 v[38:39], v129 offset:61440
    v_mfma_f32_16x16x32_bf16 v[80:83], v[20:23], v[0:3], v[80:83]
    ds_read_b64_tr_b16 v[40:41], v130 offset:57344
    buffer_load_dwordx4 v138, s[8:11], s15 offen offset:1024 lds
    v_mfma_f32_16x16x32_bf16 v[84:87], v[20:23], v[4:7], v[84:87]
    ds_read_b64_tr_b16 v[42:43], v130 offset:61440
    v_mfma_f32_16x16x32_bf16 v[88:91], v[20:23], v[8:11], v[88:91]
    ds_read_b64_tr_b16 v[44:45], v131 offset:57344
    v_mfma_f32_16x16x32_bf16 v[92:95], v[20:23], v[12:15], v[92:95]
    ds_read_b64_tr_b16 v[46:47], v131 offset:61440
    buffer_load_dwordx4 v139, s[8:11], s15 offen offset:2048 lds
    v_mfma_f32_16x16x32_bf16 v[96:99], v[24:27], v[0:3], v[96:99]
    ds_read_b128 v[52:55], v136 offset:52224
    v_mfma_f32_16x16x32_bf16 v[100:103], v[24:27], v[4:7], v[100:103]
    ds_read_b128 v[56:59], v136 offset:54272
    buffer_load_dwordx4 v140, s[8:11], s15 offen offset:3072 lds
    v_mfma_f32_16x16x32_bf16 v[104:107], v[24:27], v[8:11], v[104:107]
    ds_read_b128 v[60:63], v136 offset:56320
    v_mfma_f32_16x16x32_bf16 v[108:111], v[24:27], v[12:15], v[108:111]
    v_mfma_f32_16x16x32_bf16 v[112:115], v[28:31], v[0:3], v[112:115]
    s_add_u32 s15, s15, s17
    v_mfma_f32_16x16x32_bf16 v[116:119], v[28:31], v[4:7], v[116:119]
    v_mfma_f32_16x16x32_bf16 v[120:123], v[28:31], v[8:11], v[120:123]
    v_mfma_f32_16x16x32_bf16 v[124:127], v[28:31], v[12:15], v[124:127]
    s_waitcnt lgkmcnt(0)
    v_mfma_f32_16x16x32_bf16 v[64:67], v[48:51], v[32:35], v[64:67]
    s_waitcnt vmcnt(16)
    s_barrier
    ds_read_b128 v[16:19], v136 offset:0
    s_add_u32 m0, s20, 49152
    s_nop 0
    v_mfma_f32_16x16x32_bf16 v[68:71], v[48:51], v[36:39], v[68:71]
    ds_read_b64_tr_b16 v[0:1], v128 offset:0
    v_mfma_f32_16x16x32_bf16 v[72:75], v[48:51], v[40:43], v[72:75]
    ds_read_b64_tr_b16 v[2:3], v128 offset:4096
    buffer_load_dwordx4 v141, s[4:7], s16 offen offset:0 sc1 lds
    v_mfma_f32_16x16x32_bf16 v[76:79], v[48:51], v[44:47], v[76:79]
    ds_read_b64_tr_b16 v[4:5], v129 offset:0
    v_mfma_f32_16x16x32_bf16 v[80:83], v[52:55], v[32:35], v[80:83]
    ds_read_b64_tr_b16 v[6:7], v129 offset:4096
    v_mfma_f32_16x16x32_bf16 v[84:87], v[52:55], v[36:39], v[84:87]
    ds_read_b64_tr_b16 v[8:9], v130 offset:0
    buffer_load_dwordx4 v141, s[4:7], s16 offen offset:1024 sc1 lds
    v_mfma_f32_16x16x32_bf16 v[88:91], v[52:55], v[40:43], v[88:91]
    ds_read_b64_tr_b16 v[10:11], v130 offset:4096
    v_mfma_f32_16x16x32_bf16 v[92:95], v[52:55], v[44:47], v[92:95]
    ds_read_b64_tr_b16 v[12:13], v131 offset:0
    buffer_load_dwordx4 v142, s[4:7], s16 offen offset:2048 sc1 lds
    v_mfma_f32_16x16x32_bf16 v[96:99], v[56:59], v[32:35], v[96:99]
    ds_read_b64_tr_b16 v[14:15], v131 offset:4096
    v_mfma_f32_16x16x32_bf16 v[100:103], v[56:59], v[36:39], v[100:103]
    ds_read_b128 v[20:23], v136 offset:2048
    v_mfma_f32_16x16x32_bf16 v[104:107], v[56:59], v[40:43], v[104:107]
    ds_read_b128 v[24:27], v136 offset:4096
    buffer_load_dwordx4 v142, s[4:7], s16 offen offset:3072 sc1 lds
    v_mfma_f32_16x16x32_bf16 v[108:111], v[56:59], v[44:47], v[108:111]
    ds_read_b128 v[28:31], v136 offset:6144
    v_mfma_f32_16x16x32_bf16 v[112:115], v[60:63], v[32:35], v[112:115]
    s_add_u32 s16, s16, 2048
    v_mfma_f32_16x16x32_bf16 v[116:119], v[60:63], v[36:39], v[116:119]
    v_mfma_f32_16x16x32_bf16 v[120:123], v[60:63], v[40:43], v[120:123]
    v_mfma_f32_16x16x32_bf16 v[124:127], v[60:63], v[44:47], v[124:127]
    s_sub_u32 s18, s18, 1
    s_cmp_lg_u32 s18, 0
    s_cbranch_scc1 main_kernel_w_c0_v_loop
    s_cmp_lg_u32 s14, 0
    s_cbranch_scc1 main_kernel_w_c0_v_nt
    s_lshl_b32 s32, s27, 8
    s_add_u32 s32, s32, 0x841e000
    v_mov_b32 v255, 1
    s_mov_b64 exec, 1
    buffer_atomic_add v255, off, s[4:7], s32 sc0 sc1
    s_mov_b64 exec, -1
main_kernel_w_c0_v_nt:
    s_waitcnt lgkmcnt(0)
    ds_read_b128 v[48:51], v136 offset:1024
    s_add_u32 m0, s19, 49152
    s_nop 0
    v_mfma_f32_16x16x32_bf16 v[64:67], v[16:19], v[0:3], v[64:67]
    ds_read_b64_tr_b16 v[32:33], v128 offset:8192
    v_mfma_f32_16x16x32_bf16 v[68:71], v[16:19], v[4:7], v[68:71]
    ds_read_b64_tr_b16 v[34:35], v128 offset:12288
    buffer_load_dwordx4 v137, s[8:11], s15 offen offset:0 lds
    v_mfma_f32_16x16x32_bf16 v[72:75], v[16:19], v[8:11], v[72:75]
    ds_read_b64_tr_b16 v[36:37], v129 offset:8192
    v_mfma_f32_16x16x32_bf16 v[76:79], v[16:19], v[12:15], v[76:79]
    ds_read_b64_tr_b16 v[38:39], v129 offset:12288
    v_mfma_f32_16x16x32_bf16 v[80:83], v[20:23], v[0:3], v[80:83]
    ds_read_b64_tr_b16 v[40:41], v130 offset:8192
    buffer_load_dwordx4 v138, s[8:11], s15 offen offset:1024 lds
    v_mfma_f32_16x16x32_bf16 v[84:87], v[20:23], v[4:7], v[84:87]
    ds_read_b64_tr_b16 v[42:43], v130 offset:12288
    v_mfma_f32_16x16x32_bf16 v[88:91], v[20:23], v[8:11], v[88:91]
    ds_read_b64_tr_b16 v[44:45], v131 offset:8192
    v_mfma_f32_16x16x32_bf16 v[92:95], v[20:23], v[12:15], v[92:95]
    ds_read_b64_tr_b16 v[46:47], v131 offset:12288
    buffer_load_dwordx4 v139, s[8:11], s15 offen offset:2048 lds
    v_mfma_f32_16x16x32_bf16 v[96:99], v[24:27], v[0:3], v[96:99]
    ds_read_b128 v[52:55], v136 offset:3072
    v_mfma_f32_16x16x32_bf16 v[100:103], v[24:27], v[4:7], v[100:103]
    ds_read_b128 v[56:59], v136 offset:5120
    buffer_load_dwordx4 v140, s[8:11], s15 offen offset:3072 lds
    v_mfma_f32_16x16x32_bf16 v[104:107], v[24:27], v[8:11], v[104:107]
    ds_read_b128 v[60:63], v136 offset:7168
    v_mfma_f32_16x16x32_bf16 v[108:111], v[24:27], v[12:15], v[108:111]
    v_mfma_f32_16x16x32_bf16 v[112:115], v[28:31], v[0:3], v[112:115]
    s_add_u32 s15, s15, s17
    v_mfma_f32_16x16x32_bf16 v[116:119], v[28:31], v[4:7], v[116:119]
    v_mfma_f32_16x16x32_bf16 v[120:123], v[28:31], v[8:11], v[120:123]
    v_mfma_f32_16x16x32_bf16 v[124:127], v[28:31], v[12:15], v[124:127]
    s_waitcnt lgkmcnt(0)
    v_mfma_f32_16x16x32_bf16 v[64:67], v[48:51], v[32:35], v[64:67]
    s_waitcnt vmcnt(16)
    s_barrier
    ds_read_b128 v[16:19], v136 offset:16384
    v_mfma_f32_16x16x32_bf16 v[68:71], v[48:51], v[36:39], v[68:71]
    ds_read_b64_tr_b16 v[0:1], v128 offset:16384
    v_mfma_f32_16x16x32_bf16 v[72:75], v[48:51], v[40:43], v[72:75]
    ds_read_b64_tr_b16 v[2:3], v128 offset:20480
    v_mfma_f32_16x16x32_bf16 v[76:79], v[48:51], v[44:47], v[76:79]
    ds_read_b64_tr_b16 v[4:5], v129 offset:16384
    v_mfma_f32_16x16x32_bf16 v[80:83], v[52:55], v[32:35], v[80:83]
    ds_read_b64_tr_b16 v[6:7], v129 offset:20480
    v_mfma_f32_16x16x32_bf16 v[84:87], v[52:55], v[36:39], v[84:87]
    ds_read_b64_tr_b16 v[8:9], v130 offset:16384
    v_mfma_f32_16x16x32_bf16 v[88:91], v[52:55], v[40:43], v[88:91]
    ds_read_b64_tr_b16 v[10:11], v130 offset:20480
    v_mfma_f32_16x16x32_bf16 v[92:95], v[52:55], v[44:47], v[92:95]
    ds_read_b64_tr_b16 v[12:13], v131 offset:16384
    v_mfma_f32_16x16x32_bf16 v[96:99], v[56:59], v[32:35], v[96:99]
    ds_read_b64_tr_b16 v[14:15], v131 offset:20480
    v_mfma_f32_16x16x32_bf16 v[100:103], v[56:59], v[36:39], v[100:103]
    ds_read_b128 v[20:23], v136 offset:18432
    v_mfma_f32_16x16x32_bf16 v[104:107], v[56:59], v[40:43], v[104:107]
    ds_read_b128 v[24:27], v136 offset:20480
    v_mfma_f32_16x16x32_bf16 v[108:111], v[56:59], v[44:47], v[108:111]
    ds_read_b128 v[28:31], v136 offset:22528
    v_mfma_f32_16x16x32_bf16 v[112:115], v[60:63], v[32:35], v[112:115]
    v_mfma_f32_16x16x32_bf16 v[116:119], v[60:63], v[36:39], v[116:119]
    v_mfma_f32_16x16x32_bf16 v[120:123], v[60:63], v[40:43], v[120:123]
    v_mfma_f32_16x16x32_bf16 v[124:127], v[60:63], v[44:47], v[124:127]
    s_waitcnt lgkmcnt(0)
    ds_read_b128 v[48:51], v136 offset:17408
    v_mfma_f32_16x16x32_bf16 v[64:67], v[16:19], v[0:3], v[64:67]
    ds_read_b64_tr_b16 v[32:33], v128 offset:24576
    v_mfma_f32_16x16x32_bf16 v[68:71], v[16:19], v[4:7], v[68:71]
    ds_read_b64_tr_b16 v[34:35], v128 offset:28672
    v_mfma_f32_16x16x32_bf16 v[72:75], v[16:19], v[8:11], v[72:75]
    ds_read_b64_tr_b16 v[36:37], v129 offset:24576
    v_mfma_f32_16x16x32_bf16 v[76:79], v[16:19], v[12:15], v[76:79]
    ds_read_b64_tr_b16 v[38:39], v129 offset:28672
    v_mfma_f32_16x16x32_bf16 v[80:83], v[20:23], v[0:3], v[80:83]
    ds_read_b64_tr_b16 v[40:41], v130 offset:24576
    v_mfma_f32_16x16x32_bf16 v[84:87], v[20:23], v[4:7], v[84:87]
    ds_read_b64_tr_b16 v[42:43], v130 offset:28672
    v_mfma_f32_16x16x32_bf16 v[88:91], v[20:23], v[8:11], v[88:91]
    ds_read_b64_tr_b16 v[44:45], v131 offset:24576
    v_mfma_f32_16x16x32_bf16 v[92:95], v[20:23], v[12:15], v[92:95]
    ds_read_b64_tr_b16 v[46:47], v131 offset:28672
    v_mfma_f32_16x16x32_bf16 v[96:99], v[24:27], v[0:3], v[96:99]
    ds_read_b128 v[52:55], v136 offset:19456
    v_mfma_f32_16x16x32_bf16 v[100:103], v[24:27], v[4:7], v[100:103]
    ds_read_b128 v[56:59], v136 offset:21504
    v_mfma_f32_16x16x32_bf16 v[104:107], v[24:27], v[8:11], v[104:107]
    ds_read_b128 v[60:63], v136 offset:23552
    v_mfma_f32_16x16x32_bf16 v[108:111], v[24:27], v[12:15], v[108:111]
    v_mfma_f32_16x16x32_bf16 v[112:115], v[28:31], v[0:3], v[112:115]
    v_mfma_f32_16x16x32_bf16 v[116:119], v[28:31], v[4:7], v[116:119]
    v_mfma_f32_16x16x32_bf16 v[120:123], v[28:31], v[8:11], v[120:123]
    v_mfma_f32_16x16x32_bf16 v[124:127], v[28:31], v[12:15], v[124:127]
    s_waitcnt lgkmcnt(0)
    v_mfma_f32_16x16x32_bf16 v[64:67], v[48:51], v[32:35], v[64:67]
    s_waitcnt vmcnt(8)
    s_barrier
    ds_read_b128 v[16:19], v136 offset:32768
    v_mfma_f32_16x16x32_bf16 v[68:71], v[48:51], v[36:39], v[68:71]
    ds_read_b64_tr_b16 v[0:1], v128 offset:32768
    v_mfma_f32_16x16x32_bf16 v[72:75], v[48:51], v[40:43], v[72:75]
    ds_read_b64_tr_b16 v[2:3], v128 offset:36864
    v_mfma_f32_16x16x32_bf16 v[76:79], v[48:51], v[44:47], v[76:79]
    ds_read_b64_tr_b16 v[4:5], v129 offset:32768
    v_mfma_f32_16x16x32_bf16 v[80:83], v[52:55], v[32:35], v[80:83]
    ds_read_b64_tr_b16 v[6:7], v129 offset:36864
    v_mfma_f32_16x16x32_bf16 v[84:87], v[52:55], v[36:39], v[84:87]
    ds_read_b64_tr_b16 v[8:9], v130 offset:32768
    v_mfma_f32_16x16x32_bf16 v[88:91], v[52:55], v[40:43], v[88:91]
    ds_read_b64_tr_b16 v[10:11], v130 offset:36864
    v_mfma_f32_16x16x32_bf16 v[92:95], v[52:55], v[44:47], v[92:95]
    ds_read_b64_tr_b16 v[12:13], v131 offset:32768
    v_mfma_f32_16x16x32_bf16 v[96:99], v[56:59], v[32:35], v[96:99]
    ds_read_b64_tr_b16 v[14:15], v131 offset:36864
    v_mfma_f32_16x16x32_bf16 v[100:103], v[56:59], v[36:39], v[100:103]
    ds_read_b128 v[20:23], v136 offset:34816
    v_mfma_f32_16x16x32_bf16 v[104:107], v[56:59], v[40:43], v[104:107]
    ds_read_b128 v[24:27], v136 offset:36864
    v_mfma_f32_16x16x32_bf16 v[108:111], v[56:59], v[44:47], v[108:111]
    ds_read_b128 v[28:31], v136 offset:38912
    v_mfma_f32_16x16x32_bf16 v[112:115], v[60:63], v[32:35], v[112:115]
    v_mfma_f32_16x16x32_bf16 v[116:119], v[60:63], v[36:39], v[116:119]
    v_mfma_f32_16x16x32_bf16 v[120:123], v[60:63], v[40:43], v[120:123]
    v_mfma_f32_16x16x32_bf16 v[124:127], v[60:63], v[44:47], v[124:127]
    s_waitcnt lgkmcnt(0)
    ds_read_b128 v[48:51], v136 offset:33792
    v_mfma_f32_16x16x32_bf16 v[64:67], v[16:19], v[0:3], v[64:67]
    ds_read_b64_tr_b16 v[32:33], v128 offset:40960
    v_mfma_f32_16x16x32_bf16 v[68:71], v[16:19], v[4:7], v[68:71]
    ds_read_b64_tr_b16 v[34:35], v128 offset:45056
    v_mfma_f32_16x16x32_bf16 v[72:75], v[16:19], v[8:11], v[72:75]
    ds_read_b64_tr_b16 v[36:37], v129 offset:40960
    v_mfma_f32_16x16x32_bf16 v[76:79], v[16:19], v[12:15], v[76:79]
    ds_read_b64_tr_b16 v[38:39], v129 offset:45056
    v_mfma_f32_16x16x32_bf16 v[80:83], v[20:23], v[0:3], v[80:83]
    ds_read_b64_tr_b16 v[40:41], v130 offset:40960
    v_mfma_f32_16x16x32_bf16 v[84:87], v[20:23], v[4:7], v[84:87]
    ds_read_b64_tr_b16 v[42:43], v130 offset:45056
    v_mfma_f32_16x16x32_bf16 v[88:91], v[20:23], v[8:11], v[88:91]
    ds_read_b64_tr_b16 v[44:45], v131 offset:40960
    v_mfma_f32_16x16x32_bf16 v[92:95], v[20:23], v[12:15], v[92:95]
    ds_read_b64_tr_b16 v[46:47], v131 offset:45056
    v_mfma_f32_16x16x32_bf16 v[96:99], v[24:27], v[0:3], v[96:99]
    ds_read_b128 v[52:55], v136 offset:35840
    v_mfma_f32_16x16x32_bf16 v[100:103], v[24:27], v[4:7], v[100:103]
    ds_read_b128 v[56:59], v136 offset:37888
    v_mfma_f32_16x16x32_bf16 v[104:107], v[24:27], v[8:11], v[104:107]
    ds_read_b128 v[60:63], v136 offset:39936
    v_mfma_f32_16x16x32_bf16 v[108:111], v[24:27], v[12:15], v[108:111]
    v_mfma_f32_16x16x32_bf16 v[112:115], v[28:31], v[0:3], v[112:115]
    v_mfma_f32_16x16x32_bf16 v[116:119], v[28:31], v[4:7], v[116:119]
    v_mfma_f32_16x16x32_bf16 v[120:123], v[28:31], v[8:11], v[120:123]
    v_mfma_f32_16x16x32_bf16 v[124:127], v[28:31], v[12:15], v[124:127]
    s_waitcnt lgkmcnt(0)
    v_mfma_f32_16x16x32_bf16 v[64:67], v[48:51], v[32:35], v[64:67]
    s_waitcnt vmcnt(0)
    s_barrier
    ds_read_b128 v[16:19], v136 offset:49152
    v_mfma_f32_16x16x32_bf16 v[68:71], v[48:51], v[36:39], v[68:71]
    ds_read_b64_tr_b16 v[0:1], v128 offset:49152
    v_mfma_f32_16x16x32_bf16 v[72:75], v[48:51], v[40:43], v[72:75]
    ds_read_b64_tr_b16 v[2:3], v128 offset:53248
    v_mfma_f32_16x16x32_bf16 v[76:79], v[48:51], v[44:47], v[76:79]
    ds_read_b64_tr_b16 v[4:5], v129 offset:49152
    v_mfma_f32_16x16x32_bf16 v[80:83], v[52:55], v[32:35], v[80:83]
    ds_read_b64_tr_b16 v[6:7], v129 offset:53248
    v_mfma_f32_16x16x32_bf16 v[84:87], v[52:55], v[36:39], v[84:87]
    ds_read_b64_tr_b16 v[8:9], v130 offset:49152
    v_mfma_f32_16x16x32_bf16 v[88:91], v[52:55], v[40:43], v[88:91]
    ds_read_b64_tr_b16 v[10:11], v130 offset:53248
    v_mfma_f32_16x16x32_bf16 v[92:95], v[52:55], v[44:47], v[92:95]
    ds_read_b64_tr_b16 v[12:13], v131 offset:49152
    v_mfma_f32_16x16x32_bf16 v[96:99], v[56:59], v[32:35], v[96:99]
    ds_read_b64_tr_b16 v[14:15], v131 offset:53248
    v_mfma_f32_16x16x32_bf16 v[100:103], v[56:59], v[36:39], v[100:103]
    ds_read_b128 v[20:23], v136 offset:51200
    v_mfma_f32_16x16x32_bf16 v[104:107], v[56:59], v[40:43], v[104:107]
    ds_read_b128 v[24:27], v136 offset:53248
    v_mfma_f32_16x16x32_bf16 v[108:111], v[56:59], v[44:47], v[108:111]
    ds_read_b128 v[28:31], v136 offset:55296
    v_mfma_f32_16x16x32_bf16 v[112:115], v[60:63], v[32:35], v[112:115]
    v_mfma_f32_16x16x32_bf16 v[116:119], v[60:63], v[36:39], v[116:119]
    v_mfma_f32_16x16x32_bf16 v[120:123], v[60:63], v[40:43], v[120:123]
    v_mfma_f32_16x16x32_bf16 v[124:127], v[60:63], v[44:47], v[124:127]
    v_readfirstlane_b32 s55, v255
    s_waitcnt lgkmcnt(0)
    ds_read_b128 v[48:51], v136 offset:50176
    v_mfma_f32_16x16x32_bf16 v[64:67], v[16:19], v[0:3], v[64:67]
    ds_read_b64_tr_b16 v[32:33], v128 offset:57344
    v_mfma_f32_16x16x32_bf16 v[68:71], v[16:19], v[4:7], v[68:71]
    ds_read_b64_tr_b16 v[34:35], v128 offset:61440
    v_mfma_f32_16x16x32_bf16 v[72:75], v[16:19], v[8:11], v[72:75]
    ds_read_b64_tr_b16 v[36:37], v129 offset:57344
    v_mfma_f32_16x16x32_bf16 v[76:79], v[16:19], v[12:15], v[76:79]
    ds_read_b64_tr_b16 v[38:39], v129 offset:61440
    v_mfma_f32_16x16x32_bf16 v[80:83], v[20:23], v[0:3], v[80:83]
    ds_read_b64_tr_b16 v[40:41], v130 offset:57344
    v_mfma_f32_16x16x32_bf16 v[84:87], v[20:23], v[4:7], v[84:87]
    ds_read_b64_tr_b16 v[42:43], v130 offset:61440
    v_mfma_f32_16x16x32_bf16 v[88:91], v[20:23], v[8:11], v[88:91]
    ds_read_b64_tr_b16 v[44:45], v131 offset:57344
    v_mfma_f32_16x16x32_bf16 v[92:95], v[20:23], v[12:15], v[92:95]
    ds_read_b64_tr_b16 v[46:47], v131 offset:61440
    v_mfma_f32_16x16x32_bf16 v[96:99], v[24:27], v[0:3], v[96:99]
    ds_read_b128 v[52:55], v136 offset:52224
    v_mfma_f32_16x16x32_bf16 v[100:103], v[24:27], v[4:7], v[100:103]
    ds_read_b128 v[56:59], v136 offset:54272
    v_mfma_f32_16x16x32_bf16 v[104:107], v[24:27], v[8:11], v[104:107]
    ds_read_b128 v[60:63], v136 offset:56320
    v_mfma_f32_16x16x32_bf16 v[108:111], v[24:27], v[12:15], v[108:111]
    v_mfma_f32_16x16x32_bf16 v[112:115], v[28:31], v[0:3], v[112:115]
    v_mfma_f32_16x16x32_bf16 v[116:119], v[28:31], v[4:7], v[116:119]
    v_mfma_f32_16x16x32_bf16 v[120:123], v[28:31], v[8:11], v[120:123]
    v_mfma_f32_16x16x32_bf16 v[124:127], v[28:31], v[12:15], v[124:127]
    s_waitcnt lgkmcnt(0)
    v_mfma_f32_16x16x32_bf16 v[64:67], v[48:51], v[32:35], v[64:67]
    v_mfma_f32_16x16x32_bf16 v[68:71], v[48:51], v[36:39], v[68:71]
    v_mfma_f32_16x16x32_bf16 v[72:75], v[48:51], v[40:43], v[72:75]
    v_mfma_f32_16x16x32_bf16 v[76:79], v[48:51], v[44:47], v[76:79]
    v_mfma_f32_16x16x32_bf16 v[80:83], v[52:55], v[32:35], v[80:83]
    v_mfma_f32_16x16x32_bf16 v[84:87], v[52:55], v[36:39], v[84:87]
    v_mfma_f32_16x16x32_bf16 v[88:91], v[52:55], v[40:43], v[88:91]
    v_mfma_f32_16x16x32_bf16 v[92:95], v[52:55], v[44:47], v[92:95]
    v_mfma_f32_16x16x32_bf16 v[96:99], v[56:59], v[32:35], v[96:99]
    v_mfma_f32_16x16x32_bf16 v[100:103], v[56:59], v[36:39], v[100:103]
    v_mfma_f32_16x16x32_bf16 v[104:107], v[56:59], v[40:43], v[104:107]
    v_mfma_f32_16x16x32_bf16 v[108:111], v[56:59], v[44:47], v[108:111]
    v_mfma_f32_16x16x32_bf16 v[112:115], v[60:63], v[32:35], v[112:115]
    v_mfma_f32_16x16x32_bf16 v[116:119], v[60:63], v[36:39], v[116:119]
    v_mfma_f32_16x16x32_bf16 v[120:123], v[60:63], v[40:43], v[120:123]
    v_mfma_f32_16x16x32_bf16 v[124:127], v[60:63], v[44:47], v[124:127]
    s_nop 7
    s_mov_b32 s53, s21
    v_cvt_pk_bf16_f32 v8, v64, v65
    v_cvt_pk_bf16_f32 v9, v66, v67
    v_cvt_pk_bf16_f32 v10, v80, v81
    v_cvt_pk_bf16_f32 v11, v82, v83
    buffer_store_dwordx4 v[8:11], v251, s[4:7], s53 offen offset:0 sc1
    v_cvt_pk_bf16_f32 v24, v68, v69
    v_cvt_pk_bf16_f32 v25, v70, v71
    v_cvt_pk_bf16_f32 v26, v84, v85
    v_cvt_pk_bf16_f32 v27, v86, v87
    buffer_store_dwordx4 v[24:27], v251, s[4:7], s53 offen offset:1024 sc1
    v_cvt_pk_bf16_f32 v40, v72, v73
    v_cvt_pk_bf16_f32 v41, v74, v75
    v_cvt_pk_bf16_f32 v42, v88, v89
    v_cvt_pk_bf16_f32 v43, v90, v91
    buffer_store_dwordx4 v[40:43], v251, s[4:7], s53 offen offset:2048 sc1
    v_cvt_pk_bf16_f32 v56, v76, v77
    v_cvt_pk_bf16_f32 v57, v78, v79
    v_cvt_pk_bf16_f32 v58, v92, v93
    v_cvt_pk_bf16_f32 v59, v94, v95
    buffer_store_dwordx4 v[56:59], v251, s[4:7], s53 offen offset:3072 sc1
    s_add_u32 s53, s53, 262144
    v_cvt_pk_bf16_f32 v8, v96, v97
    v_cvt_pk_bf16_f32 v9, v98, v99
    v_cvt_pk_bf16_f32 v10, v112, v113
    v_cvt_pk_bf16_f32 v11, v114, v115
    buffer_store_dwordx4 v[8:11], v251, s[4:7], s53 offen offset:0 sc1
    v_cvt_pk_bf16_f32 v24, v100, v101
    v_cvt_pk_bf16_f32 v25, v102, v103
    v_cvt_pk_bf16_f32 v26, v116, v117
    v_cvt_pk_bf16_f32 v27, v118, v119
    buffer_store_dwordx4 v[24:27], v251, s[4:7], s53 offen offset:1024 sc1
    v_cvt_pk_bf16_f32 v40, v104, v105
    v_cvt_pk_bf16_f32 v41, v106, v107
    v_cvt_pk_bf16_f32 v42, v120, v121
    v_cvt_pk_bf16_f32 v43, v122, v123
    buffer_store_dwordx4 v[40:43], v251, s[4:7], s53 offen offset:2048 sc1
    v_cvt_pk_bf16_f32 v56, v108, v109
    v_cvt_pk_bf16_f32 v57, v110, v111
    v_cvt_pk_bf16_f32 v58, v124, v125
    v_cvt_pk_bf16_f32 v59, v126, v127
    buffer_store_dwordx4 v[56:59], v251, s[4:7], s53 offen offset:3072 sc1
    s_add_u32 s53, s53, 262144
    s_branch main_kernel_w_done
main_kernel_w_c1_task:
    s_cmp_eq_u32 s23, 0
    s_cbranch_scc1 main_kernel_w_c1_set0
    s_cmp_eq_u32 s23, 1
    s_cbranch_scc1 main_kernel_w_c1_set1
    s_cmp_eq_u32 s23, 2
    s_cbranch_scc1 main_kernel_w_c1_set2
    s_cmp_eq_u32 s23, 3
    s_cbranch_scc1 main_kernel_w_c1_set3
    s_cmp_eq_u32 s23, 6
    s_cbranch_scc1 main_kernel_w_c1_set6
    s_branch main_kernel_w_done
main_kernel_w_c1_set0:
    s_lshl_b32 s32, s25, 8
    s_add_u32 s8, s40, s32
    s_addc_u32 s9, s41, 0
    s_and_b32 s9, s9, 0xffff
    s_sub_u32 s10, 0x800000, s32
    s_mov_b32 s11, 0x20000
    s_mov_b32 s30, 8192
    s_mov_b32 s31, 32768
    s_mul_i32 s16, s24, 262144
    s_add_u32 s16, s16, 0x0
    s_mov_b32 s18, 7
    s_lshl_b32 s32, s24, 3
    s_mul_i32 s33, s38, 4
    s_add_u32 s32, s32, s33
    s_mul_i32 s32, s32, 131072
    s_lshl_b32 s33, s25, 12
    s_add_u32 s32, s32, s33
    s_mul_i32 s33, s37, 4096
    s_add_u32 s32, s32, s33
    s_add_u32 s21, s32, 0x800000
    s_mov_b32 s22, 131072
    s_mov_b32 s26, -1
    s_branch main_kernel_w_c1_go
main_kernel_w_c1_set1:
    s_lshl_b32 s32, s25, 8
    s_add_u32 s8, s42, s32
    s_addc_u32 s9, s43, 0
    s_and_b32 s9, s9, 0xffff
    s_sub_u32 s10, 0x800000, s32
    s_mov_b32 s11, 0x20000
    s_mov_b32 s30, 8192
    s_mov_b32 s31, 32768
    s_mul_i32 s16, s24, 262144
    s_add_u32 s16, s16, 0x0
    s_mov_b32 s18, 7
    s_lshl_b32 s32, s24, 3
    s_mul_i32 s33, s38, 4
    s_add_u32 s32, s32, s33
    s_mul_i32 s32, s32, 131072
    s_lshl_b32 s33, s25, 12
    s_add_u32 s32, s32, s33
    s_mul_i32 s33, s37, 4096
    s_add_u32 s32, s32, s33
    s_add_u32 s21, s32, 0x1800000
    s_mov_b32 s22, 131072
    s_mov_b32 s26, -1
    s_branch main_kernel_w_c1_go
main_kernel_w_c1_set2:
    s_lshl_b32 s32, s25, 8
    s_add_u32 s8, s44, s32
    s_addc_u32 s9, s45, 0
    s_and_b32 s9, s9, 0xffff
    s_sub_u32 s10, 0x800000, s32
    s_mov_b32 s11, 0x20000
    s_mov_b32 s30, 8192
    s_mov_b32 s31, 32768
    s_mul_i32 s16, s24, 262144
    s_add_u32 s16, s16, 0x0
    s_mov_b32 s18, 7
    s_lshl_b32 s32, s24, 2
    s_mul_i32 s33, s38, 2
    s_add_u32 s32, s32, s33
    s_lshl_b32 s32, s32, 18
    s_lshl_b32 s33, s25, 13
    s_add_u32 s32, s32, s33
    s_mul_i32 s33, s37, 8192
    s_add_u32 s32, s32, s33
    s_add_u32 s21, s32, 0x2800000
    s_branch main_kernel_w_c1_gov
main_kernel_w_c1_set3:
    s_lshl_b32 s32, s25, 8
    s_add_u32 s8, s64, s32
    s_addc_u32 s9, s65, 0
    s_and_b32 s9, s9, 0xffff
    s_sub_u32 s10, 0x200000, s32
    s_mov_b32 s11, 0x20000
    s_mov_b32 s30, 2048
    s_mov_b32 s31, 32768
    s_mul_i32 s16, s24, 262144
    s_add_u32 s16, s16, 0x400000
    s_mov_b32 s18, 7
    s_lshl_b32 s32, s24, 3
    s_mul_i32 s33, s38, 4
    s_add_u32 s32, s32, s33
    s_mul_i32 s32, s32, 32768
    s_lshl_b32 s33, s25, 12
    s_add_u32 s32, s32, s33
    s_mul_i32 s33, s37, 4096
    s_add_u32 s32, s32, s33
    s_add_u32 s21, s32, 0x4800000
    s_mov_b32 s22, 32768
    s_mov_b32 s26, -1
    s_lshr_b32 s32, s25, 2
    s_add_u32 s32, s32, 1
    s_sub_u32 s33, 0, s32
    s_bitcmp1_b32 s25, 1
    s_cselect_b32 s32, s33, s32
    s_add_u32 s32, s32, 16
    v_and_b32 v253, 15, v250
    v_add_u32 v253, s32, v253
    v_lshrrev_b32 v254, 4, v253
    v_lshlrev_b32 v254, 15, v254
    v_and_b32 v253, 15, v253
    v_lshl_add_u32 v254, v253, 4, v254
    v_and_b32 v253, 0x300, v251
    v_add_u32 v252, v253, v254
    s_branch main_kernel_w_c1_go
main_kernel_w_c1_set6:
    s_lshl_b32 s32, s25, 8
    s_add_u32 s8, s68, s32
    s_addc_u32 s9, s69, 0
    s_and_b32 s9, s9, 0xffff
    s_sub_u32 s10, 0x700000, s32
    s_mov_b32 s11, 0x20000
    s_mov_b32 s30, 7168
    s_mov_b32 s31, 32768
    s_mul_i32 s16, s24, 262144
    s_add_u32 s16, s16, 0x6800000
    s_mov_b32 s18, 7
    s_lshl_b32 s32, s24, 3
    s_mul_i32 s33, s38, 4
    s_add_u32 s32, s32, s33
    s_mul_i32 s32, s32, 114688
    s_lshl_b32 s33, s25, 12
    s_add_u32 s32, s32, s33
    s_mul_i32 s33, s37, 4096
    s_add_u32 s32, s32, s33
    s_add_u32 s21, s32, 0x5400000
    s_mov_b32 s22, 114688
    s_mov_b32 s26, -1
    s_branch main_kernel_w_c1_go
main_kernel_w_c1_go:
    v_lshrrev_b32 v0, 4, v250
    v_bfe_u32 v1, v250, 2, 2
    v_lshl_add_u32 v4, v0, 2, v1
    v_and_b32 v5, 7, v4
    v_mul_u32_u24 v4, 512, v4
    v_and_b32 v6, 3, v250
    v_lshl_add_u32 v4, v6, 3, v4
    s_mul_i32 s32, s37, 8
    v_xor_b32 v5, s32, v5
    v_lshl_add_u32 v128, v5, 5, v4
    v_xor_b32 v129, 32, v128
    v_xor_b32 v130, 64, v128
    v_xor_b32 v131, 96, v128
    v_xor_b32 v132, 128, v128
    v_xor_b32 v133, 160, v128
    v_xor_b32 v134, 192, v128
    v_xor_b32 v135, 224, v128
    s_mul_i32 s32, s38, 4096
    s_add_u32 s32, s32, 65536
    v_add_u32 v136, s32, v251
    v_lshrrev_b32 v2, 5, v250
    v_and_b32 v3, 31, v250
    s_mul_i32 s32, s14, 8
    v_add_u32 v4, s32, v2
    v_add_u32 v5, 0, v4
    v_and_b32 v6, 7, v5
    v_lshlrev_b32 v6, 1, v6
    v_xor_b32 v6, v6, v3
    v_mul_lo_u32 v5, v5, s30
    v_lshl_add_u32 v5, v6, 4, v5
    v_subrev_u32 v137, 0, v5
    v_add_u32 v5, 2, v4
    v_and_b32 v6, 7, v5
    v_lshlrev_b32 v6, 1, v6
    v_xor_b32 v6, v6, v3
    v_mul_lo_u32 v5, v5, s30
    v_lshl_add_u32 v5, v6, 4, v5
    v_subrev_u32 v138, 1024, v5
    v_add_u32 v5, 4, v4
    v_and_b32 v6, 7, v5
    v_lshlrev_b32 v6, 1, v6
    v_xor_b32 v6, v6, v3
    v_mul_lo_u32 v5, v5, s30
    v_lshl_add_u32 v5, v6, 4, v5
    v_subrev_u32 v139, 2048, v5
    v_add_u32 v5, 6, v4
    v_and_b32 v6, 7, v5
    v_lshlrev_b32 v6, 1, v6
    v_xor_b32 v6, v6, v3
    v_mul_lo_u32 v5, v5, s30
    v_lshl_add_u32 v5, v6, 4, v5
    v_subrev_u32 v140, 3072, v5
    s_mul_i32 s32, s14, 2
    s_mul_i32 s32, s32, s31
    v_add_u32 v141, s32, v251
    s_add_u32 s32, s32, s31
    s_sub_u32 s32, s32, 1024
    v_add_u32 v142, s32, v251
    s_mul_i32 s19, s14, 4096
    s_mul_i32 s20, s14, 2048
    s_add_u32 s20, s20, 65536
    s_mul_i32 s17, s30, 32
    s_mov_b32 s15, 0
    s_add_u32 m0, s20, 0
    s_nop 0
    buffer_load_dwordx4 v141, s[4:7], s16 offen offset:0 sc1 lds
    buffer_load_dwordx4 v142, s[4:7], s16 offen offset:1024 sc1 lds
    s_add_u32 s16, s16, 1024
    s_add_u32 m0, s19, 0
    s_nop 0
    buffer_load_dwordx4 v137, s[8:11], s15 offen offset:0 lds
    buffer_load_dwordx4 v138, s[8:11], s15 offen offset:1024 lds
    buffer_load_dwordx4 v139, s[8:11], s15 offen offset:2048 lds
    buffer_load_dwordx4 v140, s[8:11], s15 offen offset:3072 lds
    s_add_u32 s15, s15, s17
    s_add_u32 m0, s20, 8192
    s_nop 0
    buffer_load_dwordx4 v141, s[4:7], s16 offen offset:0 sc1 lds
    buffer_load_dwordx4 v142, s[4:7], s16 offen offset:1024 sc1 lds
    s_add_u32 s16, s16, 1024
    s_add_u32 m0, s19, 16384
    s_nop 0
    buffer_load_dwordx4 v137, s[8:11], s15 offen offset:0 lds
    buffer_load_dwordx4 v138, s[8:11], s15 offen offset:1024 lds
    buffer_load_dwordx4 v139, s[8:11], s15 offen offset:2048 lds
    buffer_load_dwordx4 v140, s[8:11], s15 offen offset:3072 lds
    s_add_u32 s15, s15, s17
    s_add_u32 m0, s20, 16384
    s_nop 0
    buffer_load_dwordx4 v141, s[4:7], s16 offen offset:0 sc1 lds
    buffer_load_dwordx4 v142, s[4:7], s16 offen offset:1024 sc1 lds
    s_add_u32 s16, s16, 1024
    s_add_u32 m0, s19, 32768
    s_nop 0
    buffer_load_dwordx4 v137, s[8:11], s15 offen offset:0 lds
    buffer_load_dwordx4 v138, s[8:11], s15 offen offset:1024 lds
    buffer_load_dwordx4 v139, s[8:11], s15 offen offset:2048 lds
    buffer_load_dwordx4 v140, s[8:11], s15 offen offset:3072 lds
    s_add_u32 s15, s15, s17
    s_add_u32 m0, s20, 24576
    s_nop 0
    buffer_load_dwordx4 v141, s[4:7], s16 offen offset:0 sc1 lds
    buffer_load_dwordx4 v142, s[4:7], s16 offen offset:1024 sc1 lds
    s_add_u32 s16, s16, 1024
    s_add_u32 m0, s19, 49152
    s_nop 0
    buffer_load_dwordx4 v137, s[8:11], s15 offen offset:0 lds
    buffer_load_dwordx4 v138, s[8:11], s15 offen offset:1024 lds
    buffer_load_dwordx4 v139, s[8:11], s15 offen offset:2048 lds
    buffer_load_dwordx4 v140, s[8:11], s15 offen offset:3072 lds
    s_add_u32 s15, s15, s17
    v_accvgpr_write_b32 a0, 0
    v_accvgpr_write_b32 a1, 0
    v_accvgpr_write_b32 a2, 0
    v_accvgpr_write_b32 a3, 0
    v_accvgpr_write_b32 a4, 0
    v_accvgpr_write_b32 a5, 0
    v_accvgpr_write_b32 a6, 0
    v_accvgpr_write_b32 a7, 0
    v_accvgpr_write_b32 a8, 0
    v_accvgpr_write_b32 a9, 0
    v_accvgpr_write_b32 a10, 0
    v_accvgpr_write_b32 a11, 0
    v_accvgpr_write_b32 a12, 0
    v_accvgpr_write_b32 a13, 0
    v_accvgpr_write_b32 a14, 0
    v_accvgpr_write_b32 a15, 0
    v_accvgpr_write_b32 a16, 0
    v_accvgpr_write_b32 a17, 0
    v_accvgpr_write_b32 a18, 0
    v_accvgpr_write_b32 a19, 0
    v_accvgpr_write_b32 a20, 0
    v_accvgpr_write_b32 a21, 0
    v_accvgpr_write_b32 a22, 0
    v_accvgpr_write_b32 a23, 0
    v_accvgpr_write_b32 a24, 0
    v_accvgpr_write_b32 a25, 0
    v_accvgpr_write_b32 a26, 0
    v_accvgpr_write_b32 a27, 0
    v_accvgpr_write_b32 a28, 0
    v_accvgpr_write_b32 a29, 0
    v_accvgpr_write_b32 a30, 0
    v_accvgpr_write_b32 a31, 0
    v_accvgpr_write_b32 a32, 0
    v_accvgpr_write_b32 a33, 0
    v_accvgpr_write_b32 a34, 0
    v_accvgpr_write_b32 a35, 0
    v_accvgpr_write_b32 a36, 0
    v_accvgpr_write_b32 a37, 0
    v_accvgpr_write_b32 a38, 0
    v_accvgpr_write_b32 a39, 0
    v_accvgpr_write_b32 a40, 0
    v_accvgpr_write_b32 a41, 0
    v_accvgpr_write_b32 a42, 0
    v_accvgpr_write_b32 a43, 0
    v_accvgpr_write_b32 a44, 0
    v_accvgpr_write_b32 a45, 0
    v_accvgpr_write_b32 a46, 0
    v_accvgpr_write_b32 a47, 0
    v_accvgpr_write_b32 a48, 0
    v_accvgpr_write_b32 a49, 0
    v_accvgpr_write_b32 a50, 0
    v_accvgpr_write_b32 a51, 0
    v_accvgpr_write_b32 a52, 0
    v_accvgpr_write_b32 a53, 0
    v_accvgpr_write_b32 a54, 0
    v_accvgpr_write_b32 a55, 0
    v_accvgpr_write_b32 a56, 0
    v_accvgpr_write_b32 a57, 0
    v_accvgpr_write_b32 a58, 0
    v_accvgpr_write_b32 a59, 0
    v_accvgpr_write_b32 a60, 0
    v_accvgpr_write_b32 a61, 0
    v_accvgpr_write_b32 a62, 0
    v_accvgpr_write_b32 a63, 0
    v_accvgpr_write_b32 a64, 0
    v_accvgpr_write_b32 a65, 0
    v_accvgpr_write_b32 a66, 0
    v_accvgpr_write_b32 a67, 0
    v_accvgpr_write_b32 a68, 0
    v_accvgpr_write_b32 a69, 0
    v_accvgpr_write_b32 a70, 0
    v_accvgpr_write_b32 a71, 0
    v_accvgpr_write_b32 a72, 0
    v_accvgpr_write_b32 a73, 0
    v_accvgpr_write_b32 a74, 0
    v_accvgpr_write_b32 a75, 0
    v_accvgpr_write_b32 a76, 0
    v_accvgpr_write_b32 a77, 0
    v_accvgpr_write_b32 a78, 0
    v_accvgpr_write_b32 a79, 0
    v_accvgpr_write_b32 a80, 0
    v_accvgpr_write_b32 a81, 0
    v_accvgpr_write_b32 a82, 0
    v_accvgpr_write_b32 a83, 0
    v_accvgpr_write_b32 a84, 0
    v_accvgpr_write_b32 a85, 0
    v_accvgpr_write_b32 a86, 0
    v_accvgpr_write_b32 a87, 0
    v_accvgpr_write_b32 a88, 0
    v_accvgpr_write_b32 a89, 0
    v_accvgpr_write_b32 a90, 0
    v_accvgpr_write_b32 a91, 0
    v_accvgpr_write_b32 a92, 0
    v_accvgpr_write_b32 a93, 0
    v_accvgpr_write_b32 a94, 0
    v_accvgpr_write_b32 a95, 0
    v_accvgpr_write_b32 a96, 0
    v_accvgpr_write_b32 a97, 0
    v_accvgpr_write_b32 a98, 0
    v_accvgpr_write_b32 a99, 0
    v_accvgpr_write_b32 a100, 0
    v_accvgpr_write_b32 a101, 0
    v_accvgpr_write_b32 a102, 0
    v_accvgpr_write_b32 a103, 0
    v_accvgpr_write_b32 a104, 0
    v_accvgpr_write_b32 a105, 0
    v_accvgpr_write_b32 a106, 0
    v_accvgpr_write_b32 a107, 0
    v_accvgpr_write_b32 a108, 0
    v_accvgpr_write_b32 a109, 0
    v_accvgpr_write_b32 a110, 0
    v_accvgpr_write_b32 a111, 0
    v_accvgpr_write_b32 a112, 0
    v_accvgpr_write_b32 a113, 0
    v_accvgpr_write_b32 a114, 0
    v_accvgpr_write_b32 a115, 0
    v_accvgpr_write_b32 a116, 0
    v_accvgpr_write_b32 a117, 0
    v_accvgpr_write_b32 a118, 0
    v_accvgpr_write_b32 a119, 0
    v_accvgpr_write_b32 a120, 0
    v_accvgpr_write_b32 a121, 0
    v_accvgpr_write_b32 a122, 0
    v_accvgpr_write_b32 a123, 0
    v_accvgpr_write_b32 a124, 0
    v_accvgpr_write_b32 a125, 0
    v_accvgpr_write_b32 a126, 0
    v_accvgpr_write_b32 a127, 0
    s_waitcnt vmcnt(18)
    s_barrier
    ds_read_b128 v[32:35], v136 offset:0
    ds_read_b64_tr_b16 v[0:1], v128 offset:0
    ds_read_b64_tr_b16 v[2:3], v128 offset:8192
    ds_read_b64_tr_b16 v[4:5], v129 offset:0
    ds_read_b64_tr_b16 v[6:7], v129 offset:8192
    ds_read_b64_tr_b16 v[8:9], v130 offset:0
    ds_read_b64_tr_b16 v[10:11], v130 offset:8192
    ds_read_b64_tr_b16 v[12:13], v131 offset:0
    ds_read_b64_tr_b16 v[14:15], v131 offset:8192
    ds_read_b64_tr_b16 v[16:17], v132 offset:0
    ds_read_b64_tr_b16 v[18:19], v132 offset:8192
    ds_read_b64_tr_b16 v[20:21], v133 offset:0
    ds_read_b64_tr_b16 v[22:23], v133 offset:8192
    ds_read_b64_tr_b16 v[24:25], v134 offset:0
    ds_read_b64_tr_b16 v[26:27], v134 offset:8192
    ds_read_b64_tr_b16 v[28:29], v135 offset:0
    ds_read_b64_tr_b16 v[30:31], v135 offset:8192
    ds_read_b128 v[36:39], v136 offset:1024
    ds_read_b128 v[40:43], v136 offset:2048
    ds_read_b128 v[44:47], v136 offset:3072
main_kernel_w_c1_n_loop:
    s_waitcnt lgkmcnt(0)
    v_mfma_f32_16x16x32_bf16 a[0:3], v[0:3], v[32:35], a[0:3]
    s_waitcnt vmcnt(12)
    s_barrier
    ds_read_b128 v[80:83], v136 offset:8192
    s_add_u32 m0, s20, 0
    s_nop 0
    v_mfma_f32_16x16x32_bf16 a[4:7], v[4:7], v[32:35], a[4:7]
    ds_read_b64_tr_b16 v[48:49], v128 offset:16384
    v_mfma_f32_16x16x32_bf16 a[8:11], v[8:11], v[32:35], a[8:11]
    ds_read_b64_tr_b16 v[50:51], v128 offset:24576
    v_mfma_f32_16x16x32_bf16 a[12:15], v[12:15], v[32:35], a[12:15]
    ds_read_b64_tr_b16 v[52:53], v129 offset:16384
    buffer_load_dwordx4 v141, s[4:7], s16 offen offset:0 sc1 lds
    v_mfma_f32_16x16x32_bf16 a[16:19], v[16:19], v[32:35], a[16:19]
    ds_read_b64_tr_b16 v[54:55], v129 offset:24576
    v_mfma_f32_16x16x32_bf16 a[20:23], v[20:23], v[32:35], a[20:23]
    ds_read_b64_tr_b16 v[56:57], v130 offset:16384
    v_mfma_f32_16x16x32_bf16 a[24:27], v[24:27], v[32:35], a[24:27]
    ds_read_b64_tr_b16 v[58:59], v130 offset:24576
    buffer_load_dwordx4 v142, s[4:7], s16 offen offset:1024 sc1 lds
    v_mfma_f32_16x16x32_bf16 a[28:31], v[28:31], v[32:35], a[28:31]
    ds_read_b64_tr_b16 v[60:61], v131 offset:16384
    v_mfma_f32_16x16x32_bf16 a[32:35], v[0:3], v[36:39], a[32:35]
    ds_read_b64_tr_b16 v[62:63], v131 offset:24576
    v_mfma_f32_16x16x32_bf16 a[36:39], v[4:7], v[36:39], a[36:39]
    ds_read_b64_tr_b16 v[64:65], v132 offset:16384
    s_add_u32 s16, s16, 1024
    v_mfma_f32_16x16x32_bf16 a[40:43], v[8:11], v[36:39], a[40:43]
    ds_read_b64_tr_b16 v[66:67], v132 offset:24576
    v_mfma_f32_16x16x32_bf16 a[44:47], v[12:15], v[36:39], a[44:47]
    ds_read_b64_tr_b16 v[68:69], v133 offset:16384
    v_mfma_f32_16x16x32_bf16 a[48:51], v[16:19], v[36:39], a[48:51]
    ds_read_b64_tr_b16 v[70:71], v133 offset:24576
    s_add_u32 m0, s19, 0
    s_nop 0
    v_mfma_f32_16x16x32_bf16 a[52:55], v[20:23], v[36:39], a[52:55]
    ds_read_b64_tr_b16 v[72:73], v134 offset:16384
    v_mfma_f32_16x16x32_bf16 a[56:59], v[24:27], v[36:39], a[56:59]
    ds_read_b64_tr_b16 v[74:75], v134 offset:24576
    v_mfma_f32_16x16x32_bf16 a[60:63], v[28:31], v[36:39], a[60:63]
    ds_read_b64_tr_b16 v[76:77], v135 offset:16384
    buffer_load_dwordx4 v137, s[8:11], s15 offen offset:0 lds
    v_mfma_f32_16x16x32_bf16 a[64:67], v[0:3], v[40:43], a[64:67]
    ds_read_b64_tr_b16 v[78:79], v135 offset:24576
    v_mfma_f32_16x16x32_bf16 a[68:71], v[4:7], v[40:43], a[68:71]
    ds_read_b128 v[84:87], v136 offset:9216
    v_mfma_f32_16x16x32_bf16 a[72:75], v[8:11], v[40:43], a[72:75]
    ds_read_b128 v[88:91], v136 offset:10240
    buffer_load_dwordx4 v138, s[8:11], s15 offen offset:1024 lds
    v_mfma_f32_16x16x32_bf16 a[76:79], v[12:15], v[40:43], a[76:79]
    ds_read_b128 v[92:95], v136 offset:11264
    v_mfma_f32_16x16x32_bf16 a[80:83], v[16:19], v[40:43], a[80:83]
    v_mfma_f32_16x16x32_bf16 a[84:87], v[20:23], v[40:43], a[84:87]
    buffer_load_dwordx4 v139, s[8:11], s15 offen offset:2048 lds
    v_mfma_f32_16x16x32_bf16 a[88:91], v[24:27], v[40:43], a[88:91]
    v_mfma_f32_16x16x32_bf16 a[92:95], v[28:31], v[40:43], a[92:95]
    v_mfma_f32_16x16x32_bf16 a[96:99], v[0:3], v[44:47], a[96:99]
    buffer_load_dwordx4 v140, s[8:11], s15 offen offset:3072 lds
    v_mfma_f32_16x16x32_bf16 a[100:103], v[4:7], v[44:47], a[100:103]
    v_mfma_f32_16x16x32_bf16 a[104:107], v[8:11], v[44:47], a[104:107]
    v_mfma_f32_16x16x32_bf16 a[108:111], v[12:15], v[44:47], a[108:111]
    s_add_u32 s15, s15, s17
    v_mfma_f32_16x16x32_bf16 a[112:115], v[16:19], v[44:47], a[112:115]
    v_mfma_f32_16x16x32_bf16 a[116:119], v[20:23], v[44:47], a[116:119]
    v_mfma_f32_16x16x32_bf16 a[120:123], v[24:27], v[44:47], a[120:123]
    v_mfma_f32_16x16x32_bf16 a[124:127], v[28:31], v[44:47], a[124:127]
    s_waitcnt lgkmcnt(0)
    v_mfma_f32_16x16x32_bf16 a[0:3], v[48:51], v[80:83], a[0:3]
    s_waitcnt vmcnt(12)
    s_barrier
    ds_read_b128 v[32:35], v136 offset:16384
    s_add_u32 m0, s20, 8192
    s_nop 0
    v_mfma_f32_16x16x32_bf16 a[4:7], v[52:55], v[80:83], a[4:7]
    ds_read_b64_tr_b16 v[0:1], v128 offset:32768
    v_mfma_f32_16x16x32_bf16 a[8:11], v[56:59], v[80:83], a[8:11]
    ds_read_b64_tr_b16 v[2:3], v128 offset:40960
    v_mfma_f32_16x16x32_bf16 a[12:15], v[60:63], v[80:83], a[12:15]
    ds_read_b64_tr_b16 v[4:5], v129 offset:32768
    buffer_load_dwordx4 v141, s[4:7], s16 offen offset:0 sc1 lds
    v_mfma_f32_16x16x32_bf16 a[16:19], v[64:67], v[80:83], a[16:19]
    ds_read_b64_tr_b16 v[6:7], v129 offset:40960
    v_mfma_f32_16x16x32_bf16 a[20:23], v[68:71], v[80:83], a[20:23]
    ds_read_b64_tr_b16 v[8:9], v130 offset:32768
    v_mfma_f32_16x16x32_bf16 a[24:27], v[72:75], v[80:83], a[24:27]
    ds_read_b64_tr_b16 v[10:11], v130 offset:40960
    buffer_load_dwordx4 v142, s[4:7], s16 offen offset:1024 sc1 lds
    v_mfma_f32_16x16x32_bf16 a[28:31], v[76:79], v[80:83], a[28:31]
    ds_read_b64_tr_b16 v[12:13], v131 offset:32768
    v_mfma_f32_16x16x32_bf16 a[32:35], v[48:51], v[84:87], a[32:35]
    ds_read_b64_tr_b16 v[14:15], v131 offset:40960
    v_mfma_f32_16x16x32_bf16 a[36:39], v[52:55], v[84:87], a[36:39]
    ds_read_b64_tr_b16 v[16:17], v132 offset:32768
    s_add_u32 s16, s16, 1024
    v_mfma_f32_16x16x32_bf16 a[40:43], v[56:59], v[84:87], a[40:43]
    ds_read_b64_tr_b16 v[18:19], v132 offset:40960
    v_mfma_f32_16x16x32_bf16 a[44:47], v[60:63], v[84:87], a[44:47]
    ds_read_b64_tr_b16 v[20:21], v133 offset:32768
    v_mfma_f32_16x16x32_bf16 a[48:51], v[64:67], v[84:87], a[48:51]
    ds_read_b64_tr_b16 v[22:23], v133 offset:40960
    s_add_u32 m0, s19, 16384
    s_nop 0
    v_mfma_f32_16x16x32_bf16 a[52:55], v[68:71], v[84:87], a[52:55]
    ds_read_b64_tr_b16 v[24:25], v134 offset:32768
    v_mfma_f32_16x16x32_bf16 a[56:59], v[72:75], v[84:87], a[56:59]
    ds_read_b64_tr_b16 v[26:27], v134 offset:40960
    v_mfma_f32_16x16x32_bf16 a[60:63], v[76:79], v[84:87], a[60:63]
    ds_read_b64_tr_b16 v[28:29], v135 offset:32768
    buffer_load_dwordx4 v137, s[8:11], s15 offen offset:0 lds
    v_mfma_f32_16x16x32_bf16 a[64:67], v[48:51], v[88:91], a[64:67]
    ds_read_b64_tr_b16 v[30:31], v135 offset:40960
    v_mfma_f32_16x16x32_bf16 a[68:71], v[52:55], v[88:91], a[68:71]
    ds_read_b128 v[36:39], v136 offset:17408
    v_mfma_f32_16x16x32_bf16 a[72:75], v[56:59], v[88:91], a[72:75]
    ds_read_b128 v[40:43], v136 offset:18432
    buffer_load_dwordx4 v138, s[8:11], s15 offen offset:1024 lds
    v_mfma_f32_16x16x32_bf16 a[76:79], v[60:63], v[88:91], a[76:79]
    ds_read_b128 v[44:47], v136 offset:19456
    v_mfma_f32_16x16x32_bf16 a[80:83], v[64:67], v[88:91], a[80:83]
    v_mfma_f32_16x16x32_bf16 a[84:87], v[68:71], v[88:91], a[84:87]
    buffer_load_dwordx4 v139, s[8:11], s15 offen offset:2048 lds
    v_mfma_f32_16x16x32_bf16 a[88:91], v[72:75], v[88:91], a[88:91]
    v_mfma_f32_16x16x32_bf16 a[92:95], v[76:79], v[88:91], a[92:95]
    v_mfma_f32_16x16x32_bf16 a[96:99], v[48:51], v[92:95], a[96:99]
    buffer_load_dwordx4 v140, s[8:11], s15 offen offset:3072 lds
    v_mfma_f32_16x16x32_bf16 a[100:103], v[52:55], v[92:95], a[100:103]
    v_mfma_f32_16x16x32_bf16 a[104:107], v[56:59], v[92:95], a[104:107]
    v_mfma_f32_16x16x32_bf16 a[108:111], v[60:63], v[92:95], a[108:111]
    s_add_u32 s15, s15, s17
    v_mfma_f32_16x16x32_bf16 a[112:115], v[64:67], v[92:95], a[112:115]
    v_mfma_f32_16x16x32_bf16 a[116:119], v[68:71], v[92:95], a[116:119]
    v_mfma_f32_16x16x32_bf16 a[120:123], v[72:75], v[92:95], a[120:123]
    v_mfma_f32_16x16x32_bf16 a[124:127], v[76:79], v[92:95], a[124:127]
    s_waitcnt lgkmcnt(0)
    v_mfma_f32_16x16x32_bf16 a[0:3], v[0:3], v[32:35], a[0:3]
    s_waitcnt vmcnt(12)
    s_barrier
    ds_read_b128 v[80:83], v136 offset:24576
    s_add_u32 m0, s20, 16384
    s_nop 0
    v_mfma_f32_16x16x32_bf16 a[4:7], v[4:7], v[32:35], a[4:7]
    ds_read_b64_tr_b16 v[48:49], v128 offset:49152
    v_mfma_f32_16x16x32_bf16 a[8:11], v[8:11], v[32:35], a[8:11]
    ds_read_b64_tr_b16 v[50:51], v128 offset:57344
    v_mfma_f32_16x16x32_bf16 a[12:15], v[12:15], v[32:35], a[12:15]
    ds_read_b64_tr_b16 v[52:53], v129 offset:49152
    buffer_load_dwordx4 v141, s[4:7], s16 offen offset:0 sc1 lds
    v_mfma_f32_16x16x32_bf16 a[16:19], v[16:19], v[32:35], a[16:19]
    ds_read_b64_tr_b16 v[54:55], v129 offset:57344
    v_mfma_f32_16x16x32_bf16 a[20:23], v[20:23], v[32:35], a[20:23]
    ds_read_b64_tr_b16 v[56:57], v130 offset:49152
    v_mfma_f32_16x16x32_bf16 a[24:27], v[24:27], v[32:35], a[24:27]
    ds_read_b64_tr_b16 v[58:59], v130 offset:57344
    buffer_load_dwordx4 v142, s[4:7], s16 offen offset:1024 sc1 lds
    v_mfma_f32_16x16x32_bf16 a[28:31], v[28:31], v[32:35], a[28:31]
    ds_read_b64_tr_b16 v[60:61], v131 offset:49152
    v_mfma_f32_16x16x32_bf16 a[32:35], v[0:3], v[36:39], a[32:35]
    ds_read_b64_tr_b16 v[62:63], v131 offset:57344
    v_mfma_f32_16x16x32_bf16 a[36:39], v[4:7], v[36:39], a[36:39]
    ds_read_b64_tr_b16 v[64:65], v132 offset:49152
    s_add_u32 s16, s16, 1024
    v_mfma_f32_16x16x32_bf16 a[40:43], v[8:11], v[36:39], a[40:43]
    ds_read_b64_tr_b16 v[66:67], v132 offset:57344
    v_mfma_f32_16x16x32_bf16 a[44:47], v[12:15], v[36:39], a[44:47]
    ds_read_b64_tr_b16 v[68:69], v133 offset:49152
    v_mfma_f32_16x16x32_bf16 a[48:51], v[16:19], v[36:39], a[48:51]
    ds_read_b64_tr_b16 v[70:71], v133 offset:57344
    s_add_u32 m0, s19, 32768
    s_nop 0
    v_mfma_f32_16x16x32_bf16 a[52:55], v[20:23], v[36:39], a[52:55]
    ds_read_b64_tr_b16 v[72:73], v134 offset:49152
    v_mfma_f32_16x16x32_bf16 a[56:59], v[24:27], v[36:39], a[56:59]
    ds_read_b64_tr_b16 v[74:75], v134 offset:57344
    v_mfma_f32_16x16x32_bf16 a[60:63], v[28:31], v[36:39], a[60:63]
    ds_read_b64_tr_b16 v[76:77], v135 offset:49152
    buffer_load_dwordx4 v137, s[8:11], s15 offen offset:0 lds
    v_mfma_f32_16x16x32_bf16 a[64:67], v[0:3], v[40:43], a[64:67]
    ds_read_b64_tr_b16 v[78:79], v135 offset:57344
    v_mfma_f32_16x16x32_bf16 a[68:71], v[4:7], v[40:43], a[68:71]
    ds_read_b128 v[84:87], v136 offset:25600
    v_mfma_f32_16x16x32_bf16 a[72:75], v[8:11], v[40:43], a[72:75]
    ds_read_b128 v[88:91], v136 offset:26624
    buffer_load_dwordx4 v138, s[8:11], s15 offen offset:1024 lds
    v_mfma_f32_16x16x32_bf16 a[76:79], v[12:15], v[40:43], a[76:79]
    ds_read_b128 v[92:95], v136 offset:27648
    v_mfma_f32_16x16x32_bf16 a[80:83], v[16:19], v[40:43], a[80:83]
    v_mfma_f32_16x16x32_bf16 a[84:87], v[20:23], v[40:43], a[84:87]
    buffer_load_dwordx4 v139, s[8:11], s15 offen offset:2048 lds
    v_mfma_f32_16x16x32_bf16 a[88:91], v[24:27], v[40:43], a[88:91]
    v_mfma_f32_16x16x32_bf16 a[92:95], v[28:31], v[40:43], a[92:95]
    v_mfma_f32_16x16x32_bf16 a[96:99], v[0:3], v[44:47], a[96:99]
    buffer_load_dwordx4 v140, s[8:11], s15 offen offset:3072 lds
    v_mfma_f32_16x16x32_bf16 a[100:103], v[4:7], v[44:47], a[100:103]
    v_mfma_f32_16x16x32_bf16 a[104:107], v[8:11], v[44:47], a[104:107]
    v_mfma_f32_16x16x32_bf16 a[108:111], v[12:15], v[44:47], a[108:111]
    s_add_u32 s15, s15, s17
    v_mfma_f32_16x16x32_bf16 a[112:115], v[16:19], v[44:47], a[112:115]
    v_mfma_f32_16x16x32_bf16 a[116:119], v[20:23], v[44:47], a[116:119]
    v_mfma_f32_16x16x32_bf16 a[120:123], v[24:27], v[44:47], a[120:123]
    v_mfma_f32_16x16x32_bf16 a[124:127], v[28:31], v[44:47], a[124:127]
    s_waitcnt lgkmcnt(0)
    v_mfma_f32_16x16x32_bf16 a[0:3], v[48:51], v[80:83], a[0:3]
    s_waitcnt vmcnt(12)
    s_barrier
    ds_read_b128 v[32:35], v136 offset:0
    s_add_u32 m0, s20, 24576
    s_nop 0
    v_mfma_f32_16x16x32_bf16 a[4:7], v[52:55], v[80:83], a[4:7]
    ds_read_b64_tr_b16 v[0:1], v128 offset:0
    v_mfma_f32_16x16x32_bf16 a[8:11], v[56:59], v[80:83], a[8:11]
    ds_read_b64_tr_b16 v[2:3], v128 offset:8192
    v_mfma_f32_16x16x32_bf16 a[12:15], v[60:63], v[80:83], a[12:15]
    ds_read_b64_tr_b16 v[4:5], v129 offset:0
    buffer_load_dwordx4 v141, s[4:7], s16 offen offset:0 sc1 lds
    v_mfma_f32_16x16x32_bf16 a[16:19], v[64:67], v[80:83], a[16:19]
    ds_read_b64_tr_b16 v[6:7], v129 offset:8192
    v_mfma_f32_16x16x32_bf16 a[20:23], v[68:71], v[80:83], a[20:23]
    ds_read_b64_tr_b16 v[8:9], v130 offset:0
    v_mfma_f32_16x16x32_bf16 a[24:27], v[72:75], v[80:83], a[24:27]
    ds_read_b64_tr_b16 v[10:11], v130 offset:8192
    buffer_load_dwordx4 v142, s[4:7], s16 offen offset:1024 sc1 lds
    v_mfma_f32_16x16x32_bf16 a[28:31], v[76:79], v[80:83], a[28:31]
    ds_read_b64_tr_b16 v[12:13], v131 offset:0
    v_mfma_f32_16x16x32_bf16 a[32:35], v[48:51], v[84:87], a[32:35]
    ds_read_b64_tr_b16 v[14:15], v131 offset:8192
    v_mfma_f32_16x16x32_bf16 a[36:39], v[52:55], v[84:87], a[36:39]
    ds_read_b64_tr_b16 v[16:17], v132 offset:0
    s_add_u32 s16, s16, 1024
    v_mfma_f32_16x16x32_bf16 a[40:43], v[56:59], v[84:87], a[40:43]
    ds_read_b64_tr_b16 v[18:19], v132 offset:8192
    v_mfma_f32_16x16x32_bf16 a[44:47], v[60:63], v[84:87], a[44:47]
    ds_read_b64_tr_b16 v[20:21], v133 offset:0
    v_mfma_f32_16x16x32_bf16 a[48:51], v[64:67], v[84:87], a[48:51]
    ds_read_b64_tr_b16 v[22:23], v133 offset:8192
    s_add_u32 m0, s19, 49152
    s_nop 0
    v_mfma_f32_16x16x32_bf16 a[52:55], v[68:71], v[84:87], a[52:55]
    ds_read_b64_tr_b16 v[24:25], v134 offset:0
    v_mfma_f32_16x16x32_bf16 a[56:59], v[72:75], v[84:87], a[56:59]
    ds_read_b64_tr_b16 v[26:27], v134 offset:8192
    v_mfma_f32_16x16x32_bf16 a[60:63], v[76:79], v[84:87], a[60:63]
    ds_read_b64_tr_b16 v[28:29], v135 offset:0
    buffer_load_dwordx4 v137, s[8:11], s15 offen offset:0 lds
    v_mfma_f32_16x16x32_bf16 a[64:67], v[48:51], v[88:91], a[64:67]
    ds_read_b64_tr_b16 v[30:31], v135 offset:8192
    v_mfma_f32_16x16x32_bf16 a[68:71], v[52:55], v[88:91], a[68:71]
    ds_read_b128 v[36:39], v136 offset:1024
    v_mfma_f32_16x16x32_bf16 a[72:75], v[56:59], v[88:91], a[72:75]
    ds_read_b128 v[40:43], v136 offset:2048
    buffer_load_dwordx4 v138, s[8:11], s15 offen offset:1024 lds
    v_mfma_f32_16x16x32_bf16 a[76:79], v[60:63], v[88:91], a[76:79]
    ds_read_b128 v[44:47], v136 offset:3072
    v_mfma_f32_16x16x32_bf16 a[80:83], v[64:67], v[88:91], a[80:83]
    v_mfma_f32_16x16x32_bf16 a[84:87], v[68:71], v[88:91], a[84:87]
    buffer_load_dwordx4 v139, s[8:11], s15 offen offset:2048 lds
    v_mfma_f32_16x16x32_bf16 a[88:91], v[72:75], v[88:91], a[88:91]
    v_mfma_f32_16x16x32_bf16 a[92:95], v[76:79], v[88:91], a[92:95]
    v_mfma_f32_16x16x32_bf16 a[96:99], v[48:51], v[92:95], a[96:99]
    buffer_load_dwordx4 v140, s[8:11], s15 offen offset:3072 lds
    v_mfma_f32_16x16x32_bf16 a[100:103], v[52:55], v[92:95], a[100:103]
    v_mfma_f32_16x16x32_bf16 a[104:107], v[56:59], v[92:95], a[104:107]
    v_mfma_f32_16x16x32_bf16 a[108:111], v[60:63], v[92:95], a[108:111]
    s_add_u32 s15, s15, s17
    v_mfma_f32_16x16x32_bf16 a[112:115], v[64:67], v[92:95], a[112:115]
    v_mfma_f32_16x16x32_bf16 a[116:119], v[68:71], v[92:95], a[116:119]
    v_mfma_f32_16x16x32_bf16 a[120:123], v[72:75], v[92:95], a[120:123]
    v_mfma_f32_16x16x32_bf16 a[124:127], v[76:79], v[92:95], a[124:127]
    s_sub_u32 s18, s18, 1
    s_cmp_lg_u32 s18, 0
    s_cbranch_scc1 main_kernel_w_c1_n_loop
    s_cmp_lg_u32 s14, 0
    s_cbranch_scc1 main_kernel_w_c1_n_nt
    s_lshl_b32 s32, s27, 8
    s_add_u32 s32, s32, 0x841e000
    v_mov_b32 v255, 1
    s_mov_b64 exec, 1
    buffer_atomic_add v255, off, s[4:7], s32 sc0 sc1
    s_mov_b64 exec, -1
main_kernel_w_c1_n_nt:
    s_waitcnt lgkmcnt(0)
    v_mfma_f32_16x16x32_bf16 a[0:3], v[0:3], v[32:35], a[0:3]
    s_waitcnt vmcnt(12)
    s_barrier
    ds_read_b128 v[80:83], v136 offset:8192
    v_mfma_f32_16x16x32_bf16 a[4:7], v[4:7], v[32:35], a[4:7]
    ds_read_b64_tr_b16 v[48:49], v128 offset:16384
    v_mfma_f32_16x16x32_bf16 a[8:11], v[8:11], v[32:35], a[8:11]
    ds_read_b64_tr_b16 v[50:51], v128 offset:24576
    v_mfma_f32_16x16x32_bf16 a[12:15], v[12:15], v[32:35], a[12:15]
    ds_read_b64_tr_b16 v[52:53], v129 offset:16384
    v_mfma_f32_16x16x32_bf16 a[16:19], v[16:19], v[32:35], a[16:19]
    ds_read_b64_tr_b16 v[54:55], v129 offset:24576
    v_mfma_f32_16x16x32_bf16 a[20:23], v[20:23], v[32:35], a[20:23]
    ds_read_b64_tr_b16 v[56:57], v130 offset:16384
    v_mfma_f32_16x16x32_bf16 a[24:27], v[24:27], v[32:35], a[24:27]
    ds_read_b64_tr_b16 v[58:59], v130 offset:24576
    v_mfma_f32_16x16x32_bf16 a[28:31], v[28:31], v[32:35], a[28:31]
    ds_read_b64_tr_b16 v[60:61], v131 offset:16384
    v_mfma_f32_16x16x32_bf16 a[32:35], v[0:3], v[36:39], a[32:35]
    ds_read_b64_tr_b16 v[62:63], v131 offset:24576
    v_mfma_f32_16x16x32_bf16 a[36:39], v[4:7], v[36:39], a[36:39]
    ds_read_b64_tr_b16 v[64:65], v132 offset:16384
    v_mfma_f32_16x16x32_bf16 a[40:43], v[8:11], v[36:39], a[40:43]
    ds_read_b64_tr_b16 v[66:67], v132 offset:24576
    v_mfma_f32_16x16x32_bf16 a[44:47], v[12:15], v[36:39], a[44:47]
    ds_read_b64_tr_b16 v[68:69], v133 offset:16384
    v_mfma_f32_16x16x32_bf16 a[48:51], v[16:19], v[36:39], a[48:51]
    ds_read_b64_tr_b16 v[70:71], v133 offset:24576
    v_mfma_f32_16x16x32_bf16 a[52:55], v[20:23], v[36:39], a[52:55]
    ds_read_b64_tr_b16 v[72:73], v134 offset:16384
    v_mfma_f32_16x16x32_bf16 a[56:59], v[24:27], v[36:39], a[56:59]
    ds_read_b64_tr_b16 v[74:75], v134 offset:24576
    v_mfma_f32_16x16x32_bf16 a[60:63], v[28:31], v[36:39], a[60:63]
    ds_read_b64_tr_b16 v[76:77], v135 offset:16384
    v_mfma_f32_16x16x32_bf16 a[64:67], v[0:3], v[40:43], a[64:67]
    ds_read_b64_tr_b16 v[78:79], v135 offset:24576
    v_mfma_f32_16x16x32_bf16 a[68:71], v[4:7], v[40:43], a[68:71]
    ds_read_b128 v[84:87], v136 offset:9216
    v_mfma_f32_16x16x32_bf16 a[72:75], v[8:11], v[40:43], a[72:75]
    ds_read_b128 v[88:91], v136 offset:10240
    v_mfma_f32_16x16x32_bf16 a[76:79], v[12:15], v[40:43], a[76:79]
    ds_read_b128 v[92:95], v136 offset:11264
    v_mfma_f32_16x16x32_bf16 a[80:83], v[16:19], v[40:43], a[80:83]
    v_mfma_f32_16x16x32_bf16 a[84:87], v[20:23], v[40:43], a[84:87]
    v_mfma_f32_16x16x32_bf16 a[88:91], v[24:27], v[40:43], a[88:91]
    v_mfma_f32_16x16x32_bf16 a[92:95], v[28:31], v[40:43], a[92:95]
    v_mfma_f32_16x16x32_bf16 a[96:99], v[0:3], v[44:47], a[96:99]
    v_mfma_f32_16x16x32_bf16 a[100:103], v[4:7], v[44:47], a[100:103]
    v_mfma_f32_16x16x32_bf16 a[104:107], v[8:11], v[44:47], a[104:107]
    v_mfma_f32_16x16x32_bf16 a[108:111], v[12:15], v[44:47], a[108:111]
    v_mfma_f32_16x16x32_bf16 a[112:115], v[16:19], v[44:47], a[112:115]
    v_mfma_f32_16x16x32_bf16 a[116:119], v[20:23], v[44:47], a[116:119]
    v_mfma_f32_16x16x32_bf16 a[120:123], v[24:27], v[44:47], a[120:123]
    v_mfma_f32_16x16x32_bf16 a[124:127], v[28:31], v[44:47], a[124:127]
    s_waitcnt lgkmcnt(0)
    v_mfma_f32_16x16x32_bf16 a[0:3], v[48:51], v[80:83], a[0:3]
    s_waitcnt vmcnt(6)
    s_barrier
    ds_read_b128 v[32:35], v136 offset:16384
    v_mfma_f32_16x16x32_bf16 a[4:7], v[52:55], v[80:83], a[4:7]
    ds_read_b64_tr_b16 v[0:1], v128 offset:32768
    v_mfma_f32_16x16x32_bf16 a[8:11], v[56:59], v[80:83], a[8:11]
    ds_read_b64_tr_b16 v[2:3], v128 offset:40960
    v_mfma_f32_16x16x32_bf16 a[12:15], v[60:63], v[80:83], a[12:15]
    ds_read_b64_tr_b16 v[4:5], v129 offset:32768
    v_mfma_f32_16x16x32_bf16 a[16:19], v[64:67], v[80:83], a[16:19]
    ds_read_b64_tr_b16 v[6:7], v129 offset:40960
    v_mfma_f32_16x16x32_bf16 a[20:23], v[68:71], v[80:83], a[20:23]
    ds_read_b64_tr_b16 v[8:9], v130 offset:32768
    v_mfma_f32_16x16x32_bf16 a[24:27], v[72:75], v[80:83], a[24:27]
    ds_read_b64_tr_b16 v[10:11], v130 offset:40960
    v_mfma_f32_16x16x32_bf16 a[28:31], v[76:79], v[80:83], a[28:31]
    ds_read_b64_tr_b16 v[12:13], v131 offset:32768
    v_mfma_f32_16x16x32_bf16 a[32:35], v[48:51], v[84:87], a[32:35]
    ds_read_b64_tr_b16 v[14:15], v131 offset:40960
    v_mfma_f32_16x16x32_bf16 a[36:39], v[52:55], v[84:87], a[36:39]
    ds_read_b64_tr_b16 v[16:17], v132 offset:32768
    v_mfma_f32_16x16x32_bf16 a[40:43], v[56:59], v[84:87], a[40:43]
    ds_read_b64_tr_b16 v[18:19], v132 offset:40960
    v_mfma_f32_16x16x32_bf16 a[44:47], v[60:63], v[84:87], a[44:47]
    ds_read_b64_tr_b16 v[20:21], v133 offset:32768
    v_mfma_f32_16x16x32_bf16 a[48:51], v[64:67], v[84:87], a[48:51]
    ds_read_b64_tr_b16 v[22:23], v133 offset:40960
    v_mfma_f32_16x16x32_bf16 a[52:55], v[68:71], v[84:87], a[52:55]
    ds_read_b64_tr_b16 v[24:25], v134 offset:32768
    v_mfma_f32_16x16x32_bf16 a[56:59], v[72:75], v[84:87], a[56:59]
    ds_read_b64_tr_b16 v[26:27], v134 offset:40960
    v_mfma_f32_16x16x32_bf16 a[60:63], v[76:79], v[84:87], a[60:63]
    ds_read_b64_tr_b16 v[28:29], v135 offset:32768
    v_mfma_f32_16x16x32_bf16 a[64:67], v[48:51], v[88:91], a[64:67]
    ds_read_b64_tr_b16 v[30:31], v135 offset:40960
    v_mfma_f32_16x16x32_bf16 a[68:71], v[52:55], v[88:91], a[68:71]
    ds_read_b128 v[36:39], v136 offset:17408
    v_mfma_f32_16x16x32_bf16 a[72:75], v[56:59], v[88:91], a[72:75]
    ds_read_b128 v[40:43], v136 offset:18432
    v_mfma_f32_16x16x32_bf16 a[76:79], v[60:63], v[88:91], a[76:79]
    ds_read_b128 v[44:47], v136 offset:19456
    v_mfma_f32_16x16x32_bf16 a[80:83], v[64:67], v[88:91], a[80:83]
    v_mfma_f32_16x16x32_bf16 a[84:87], v[68:71], v[88:91], a[84:87]
    v_mfma_f32_16x16x32_bf16 a[88:91], v[72:75], v[88:91], a[88:91]
    v_mfma_f32_16x16x32_bf16 a[92:95], v[76:79], v[88:91], a[92:95]
    v_mfma_f32_16x16x32_bf16 a[96:99], v[48:51], v[92:95], a[96:99]
    v_mfma_f32_16x16x32_bf16 a[100:103], v[52:55], v[92:95], a[100:103]
    v_mfma_f32_16x16x32_bf16 a[104:107], v[56:59], v[92:95], a[104:107]
    v_mfma_f32_16x16x32_bf16 a[108:111], v[60:63], v[92:95], a[108:111]
    v_mfma_f32_16x16x32_bf16 a[112:115], v[64:67], v[92:95], a[112:115]
    v_mfma_f32_16x16x32_bf16 a[116:119], v[68:71], v[92:95], a[116:119]
    v_mfma_f32_16x16x32_bf16 a[120:123], v[72:75], v[92:95], a[120:123]
    v_mfma_f32_16x16x32_bf16 a[124:127], v[76:79], v[92:95], a[124:127]
    s_waitcnt lgkmcnt(0)
    v_mfma_f32_16x16x32_bf16 a[0:3], v[0:3], v[32:35], a[0:3]
    s_waitcnt vmcnt(0)
    s_barrier
    ds_read_b128 v[80:83], v136 offset:24576
    v_mfma_f32_16x16x32_bf16 a[4:7], v[4:7], v[32:35], a[4:7]
    ds_read_b64_tr_b16 v[48:49], v128 offset:49152
    v_mfma_f32_16x16x32_bf16 a[8:11], v[8:11], v[32:35], a[8:11]
    ds_read_b64_tr_b16 v[50:51], v128 offset:57344
    v_mfma_f32_16x16x32_bf16 a[12:15], v[12:15], v[32:35], a[12:15]
    ds_read_b64_tr_b16 v[52:53], v129 offset:49152
    v_mfma_f32_16x16x32_bf16 a[16:19], v[16:19], v[32:35], a[16:19]
    ds_read_b64_tr_b16 v[54:55], v129 offset:57344
    v_mfma_f32_16x16x32_bf16 a[20:23], v[20:23], v[32:35], a[20:23]
    ds_read_b64_tr_b16 v[56:57], v130 offset:49152
    v_mfma_f32_16x16x32_bf16 a[24:27], v[24:27], v[32:35], a[24:27]
    ds_read_b64_tr_b16 v[58:59], v130 offset:57344
    v_mfma_f32_16x16x32_bf16 a[28:31], v[28:31], v[32:35], a[28:31]
    ds_read_b64_tr_b16 v[60:61], v131 offset:49152
    v_mfma_f32_16x16x32_bf16 a[32:35], v[0:3], v[36:39], a[32:35]
    ds_read_b64_tr_b16 v[62:63], v131 offset:57344
    v_mfma_f32_16x16x32_bf16 a[36:39], v[4:7], v[36:39], a[36:39]
    ds_read_b64_tr_b16 v[64:65], v132 offset:49152
    v_mfma_f32_16x16x32_bf16 a[40:43], v[8:11], v[36:39], a[40:43]
    ds_read_b64_tr_b16 v[66:67], v132 offset:57344
    v_mfma_f32_16x16x32_bf16 a[44:47], v[12:15], v[36:39], a[44:47]
    ds_read_b64_tr_b16 v[68:69], v133 offset:49152
    v_mfma_f32_16x16x32_bf16 a[48:51], v[16:19], v[36:39], a[48:51]
    ds_read_b64_tr_b16 v[70:71], v133 offset:57344
    v_mfma_f32_16x16x32_bf16 a[52:55], v[20:23], v[36:39], a[52:55]
    ds_read_b64_tr_b16 v[72:73], v134 offset:49152
    v_mfma_f32_16x16x32_bf16 a[56:59], v[24:27], v[36:39], a[56:59]
    ds_read_b64_tr_b16 v[74:75], v134 offset:57344
    v_mfma_f32_16x16x32_bf16 a[60:63], v[28:31], v[36:39], a[60:63]
    ds_read_b64_tr_b16 v[76:77], v135 offset:49152
    v_mfma_f32_16x16x32_bf16 a[64:67], v[0:3], v[40:43], a[64:67]
    ds_read_b64_tr_b16 v[78:79], v135 offset:57344
    v_mfma_f32_16x16x32_bf16 a[68:71], v[4:7], v[40:43], a[68:71]
    ds_read_b128 v[84:87], v136 offset:25600
    v_mfma_f32_16x16x32_bf16 a[72:75], v[8:11], v[40:43], a[72:75]
    ds_read_b128 v[88:91], v136 offset:26624
    v_mfma_f32_16x16x32_bf16 a[76:79], v[12:15], v[40:43], a[76:79]
    ds_read_b128 v[92:95], v136 offset:27648
    v_mfma_f32_16x16x32_bf16 a[80:83], v[16:19], v[40:43], a[80:83]
    v_mfma_f32_16x16x32_bf16 a[84:87], v[20:23], v[40:43], a[84:87]
    v_mfma_f32_16x16x32_bf16 a[88:91], v[24:27], v[40:43], a[88:91]
    v_mfma_f32_16x16x32_bf16 a[92:95], v[28:31], v[40:43], a[92:95]
    v_mfma_f32_16x16x32_bf16 a[96:99], v[0:3], v[44:47], a[96:99]
    v_mfma_f32_16x16x32_bf16 a[100:103], v[4:7], v[44:47], a[100:103]
    v_mfma_f32_16x16x32_bf16 a[104:107], v[8:11], v[44:47], a[104:107]
    v_mfma_f32_16x16x32_bf16 a[108:111], v[12:15], v[44:47], a[108:111]
    v_mfma_f32_16x16x32_bf16 a[112:115], v[16:19], v[44:47], a[112:115]
    v_mfma_f32_16x16x32_bf16 a[116:119], v[20:23], v[44:47], a[116:119]
    v_mfma_f32_16x16x32_bf16 a[120:123], v[24:27], v[44:47], a[120:123]
    v_mfma_f32_16x16x32_bf16 a[124:127], v[28:31], v[44:47], a[124:127]
    v_readfirstlane_b32 s55, v255
    s_waitcnt lgkmcnt(0)
    v_mfma_f32_16x16x32_bf16 a[0:3], v[48:51], v[80:83], a[0:3]
    v_mfma_f32_16x16x32_bf16 a[4:7], v[52:55], v[80:83], a[4:7]
    v_mfma_f32_16x16x32_bf16 a[8:11], v[56:59], v[80:83], a[8:11]
    v_mfma_f32_16x16x32_bf16 a[12:15], v[60:63], v[80:83], a[12:15]
    v_mfma_f32_16x16x32_bf16 a[16:19], v[64:67], v[80:83], a[16:19]
    v_mfma_f32_16x16x32_bf16 a[20:23], v[68:71], v[80:83], a[20:23]
    v_mfma_f32_16x16x32_bf16 a[24:27], v[72:75], v[80:83], a[24:27]
    v_mfma_f32_16x16x32_bf16 a[28:31], v[76:79], v[80:83], a[28:31]
    v_mfma_f32_16x16x32_bf16 a[32:35], v[48:51], v[84:87], a[32:35]
    v_mfma_f32_16x16x32_bf16 a[36:39], v[52:55], v[84:87], a[36:39]
    v_mfma_f32_16x16x32_bf16 a[40:43], v[56:59], v[84:87], a[40:43]
    v_mfma_f32_16x16x32_bf16 a[44:47], v[60:63], v[84:87], a[44:47]
    v_mfma_f32_16x16x32_bf16 a[48:51], v[64:67], v[84:87], a[48:51]
    v_mfma_f32_16x16x32_bf16 a[52:55], v[68:71], v[84:87], a[52:55]
    v_mfma_f32_16x16x32_bf16 a[56:59], v[72:75], v[84:87], a[56:59]
    v_mfma_f32_16x16x32_bf16 a[60:63], v[76:79], v[84:87], a[60:63]
    v_mfma_f32_16x16x32_bf16 a[64:67], v[48:51], v[88:91], a[64:67]
    v_mfma_f32_16x16x32_bf16 a[68:71], v[52:55], v[88:91], a[68:71]
    v_mfma_f32_16x16x32_bf16 a[72:75], v[56:59], v[88:91], a[72:75]
    v_mfma_f32_16x16x32_bf16 a[76:79], v[60:63], v[88:91], a[76:79]
    v_mfma_f32_16x16x32_bf16 a[80:83], v[64:67], v[88:91], a[80:83]
    v_mfma_f32_16x16x32_bf16 a[84:87], v[68:71], v[88:91], a[84:87]
    v_mfma_f32_16x16x32_bf16 a[88:91], v[72:75], v[88:91], a[88:91]
    v_mfma_f32_16x16x32_bf16 a[92:95], v[76:79], v[88:91], a[92:95]
    v_mfma_f32_16x16x32_bf16 a[96:99], v[48:51], v[92:95], a[96:99]
    v_mfma_f32_16x16x32_bf16 a[100:103], v[52:55], v[92:95], a[100:103]
    v_mfma_f32_16x16x32_bf16 a[104:107], v[56:59], v[92:95], a[104:107]
    v_mfma_f32_16x16x32_bf16 a[108:111], v[60:63], v[92:95], a[108:111]
    v_mfma_f32_16x16x32_bf16 a[112:115], v[64:67], v[92:95], a[112:115]
    v_mfma_f32_16x16x32_bf16 a[116:119], v[68:71], v[92:95], a[116:119]
    v_mfma_f32_16x16x32_bf16 a[120:123], v[72:75], v[92:95], a[120:123]
    v_mfma_f32_16x16x32_bf16 a[124:127], v[76:79], v[92:95], a[124:127]
    s_nop 7
    s_cmp_eq_u32 s23, 1
    s_cbranch_scc1 main_kernel_w_c1_escl
    s_cmp_eq_u32 s23, 3
    s_cbranch_scc1 main_kernel_w_c1_egelus
    s_cmp_eq_u32 s23, 6
    s_cbranch_scc1 main_kernel_w_c1_egelu
main_kernel_w_c1_eplain:
    s_mov_b32 s53, s21
    v_accvgpr_read_b32 v0, a0
    v_accvgpr_read_b32 v1, a1
    v_accvgpr_read_b32 v2, a2
    v_accvgpr_read_b32 v3, a3
    v_accvgpr_read_b32 v4, a4
    v_accvgpr_read_b32 v5, a5
    v_accvgpr_read_b32 v6, a6
    v_accvgpr_read_b32 v7, a7
    v_cvt_pk_bf16_f32 v16, v0, v1
    v_cvt_pk_bf16_f32 v17, v2, v3
    v_cvt_pk_bf16_f32 v18, v4, v5
    v_cvt_pk_bf16_f32 v19, v6, v7
    buffer_store_dwordx4 v[16:19], v251, s[4:7], s53 offen offset:0 sc1
    v_accvgpr_read_b32 v20, a8
    v_accvgpr_read_b32 v21, a9
    v_accvgpr_read_b32 v22, a10
    v_accvgpr_read_b32 v23, a11
    v_accvgpr_read_b32 v24, a12
    v_accvgpr_read_b32 v25, a13
    v_accvgpr_read_b32 v26, a14
    v_accvgpr_read_b32 v27, a15
    v_cvt_pk_bf16_f32 v36, v20, v21
    v_cvt_pk_bf16_f32 v37, v22, v23
    v_cvt_pk_bf16_f32 v38, v24, v25
    v_cvt_pk_bf16_f32 v39, v26, v27
    buffer_store_dwordx4 v[36:39], v251, s[4:7], s53 offen offset:1024 sc1
    v_accvgpr_read_b32 v40, a16
    v_accvgpr_read_b32 v41, a17
    v_accvgpr_read_b32 v42, a18
    v_accvgpr_read_b32 v43, a19
    v_accvgpr_read_b32 v44, a20
    v_accvgpr_read_b32 v45, a21
    v_accvgpr_read_b32 v46, a22
    v_accvgpr_read_b32 v47, a23
    v_cvt_pk_bf16_f32 v56, v40, v41
    v_cvt_pk_bf16_f32 v57, v42, v43
    v_cvt_pk_bf16_f32 v58, v44, v45
    v_cvt_pk_bf16_f32 v59, v46, v47
    buffer_store_dwordx4 v[56:59], v251, s[4:7], s53 offen offset:2048 sc1
    v_accvgpr_read_b32 v0, a24
    v_accvgpr_read_b32 v1, a25
    v_accvgpr_read_b32 v2, a26
    v_accvgpr_read_b32 v3, a27
    v_accvgpr_read_b32 v4, a28
    v_accvgpr_read_b32 v5, a29
    v_accvgpr_read_b32 v6, a30
    v_accvgpr_read_b32 v7, a31
    v_cvt_pk_bf16_f32 v16, v0, v1
    v_cvt_pk_bf16_f32 v17, v2, v3
    v_cvt_pk_bf16_f32 v18, v4, v5
    v_cvt_pk_bf16_f32 v19, v6, v7
    buffer_store_dwordx4 v[16:19], v251, s[4:7], s53 offen offset:3072 sc1
    s_add_u32 s53, s53, s22
    v_accvgpr_read_b32 v20, a32
    v_accvgpr_read_b32 v21, a33
    v_accvgpr_read_b32 v22, a34
    v_accvgpr_read_b32 v23, a35
    v_accvgpr_read_b32 v24, a36
    v_accvgpr_read_b32 v25, a37
    v_accvgpr_read_b32 v26, a38
    v_accvgpr_read_b32 v27, a39
    v_cvt_pk_bf16_f32 v36, v20, v21
    v_cvt_pk_bf16_f32 v37, v22, v23
    v_cvt_pk_bf16_f32 v38, v24, v25
    v_cvt_pk_bf16_f32 v39, v26, v27
    buffer_store_dwordx4 v[36:39], v251, s[4:7], s53 offen offset:0 sc1
    v_accvgpr_read_b32 v40, a40
    v_accvgpr_read_b32 v41, a41
    v_accvgpr_read_b32 v42, a42
    v_accvgpr_read_b32 v43, a43
    v_accvgpr_read_b32 v44, a44
    v_accvgpr_read_b32 v45, a45
    v_accvgpr_read_b32 v46, a46
    v_accvgpr_read_b32 v47, a47
    v_cvt_pk_bf16_f32 v56, v40, v41
    v_cvt_pk_bf16_f32 v57, v42, v43
    v_cvt_pk_bf16_f32 v58, v44, v45
    v_cvt_pk_bf16_f32 v59, v46, v47
    buffer_store_dwordx4 v[56:59], v251, s[4:7], s53 offen offset:1024 sc1
    v_accvgpr_read_b32 v0, a48
    v_accvgpr_read_b32 v1, a49
    v_accvgpr_read_b32 v2, a50
    v_accvgpr_read_b32 v3, a51
    v_accvgpr_read_b32 v4, a52
    v_accvgpr_read_b32 v5, a53
    v_accvgpr_read_b32 v6, a54
    v_accvgpr_read_b32 v7, a55
    v_cvt_pk_bf16_f32 v16, v0, v1
    v_cvt_pk_bf16_f32 v17, v2, v3
    v_cvt_pk_bf16_f32 v18, v4, v5
    v_cvt_pk_bf16_f32 v19, v6, v7
    buffer_store_dwordx4 v[16:19], v251, s[4:7], s53 offen offset:2048 sc1
    v_accvgpr_read_b32 v20, a56
    v_accvgpr_read_b32 v21, a57
    v_accvgpr_read_b32 v22, a58
    v_accvgpr_read_b32 v23, a59
    v_accvgpr_read_b32 v24, a60
    v_accvgpr_read_b32 v25, a61
    v_accvgpr_read_b32 v26, a62
    v_accvgpr_read_b32 v27, a63
    v_cvt_pk_bf16_f32 v36, v20, v21
    v_cvt_pk_bf16_f32 v37, v22, v23
    v_cvt_pk_bf16_f32 v38, v24, v25
    v_cvt_pk_bf16_f32 v39, v26, v27
    buffer_store_dwordx4 v[36:39], v251, s[4:7], s53 offen offset:3072 sc1
    s_add_u32 s53, s53, s22
    v_accvgpr_read_b32 v40, a64
    v_accvgpr_read_b32 v41, a65
    v_accvgpr_read_b32 v42, a66
    v_accvgpr_read_b32 v43, a67
    v_accvgpr_read_b32 v44, a68
    v_accvgpr_read_b32 v45, a69
    v_accvgpr_read_b32 v46, a70
    v_accvgpr_read_b32 v47, a71
    v_cvt_pk_bf16_f32 v56, v40, v41
    v_cvt_pk_bf16_f32 v57, v42, v43
    v_cvt_pk_bf16_f32 v58, v44, v45
    v_cvt_pk_bf16_f32 v59, v46, v47
    buffer_store_dwordx4 v[56:59], v251, s[4:7], s53 offen offset:0 sc1
    v_accvgpr_read_b32 v0, a72
    v_accvgpr_read_b32 v1, a73
    v_accvgpr_read_b32 v2, a74
    v_accvgpr_read_b32 v3, a75
    v_accvgpr_read_b32 v4, a76
    v_accvgpr_read_b32 v5, a77
    v_accvgpr_read_b32 v6, a78
    v_accvgpr_read_b32 v7, a79
    v_cvt_pk_bf16_f32 v16, v0, v1
    v_cvt_pk_bf16_f32 v17, v2, v3
    v_cvt_pk_bf16_f32 v18, v4, v5
    v_cvt_pk_bf16_f32 v19, v6, v7
    buffer_store_dwordx4 v[16:19], v251, s[4:7], s53 offen offset:1024 sc1
    v_accvgpr_read_b32 v20, a80
    v_accvgpr_read_b32 v21, a81
    v_accvgpr_read_b32 v22, a82
    v_accvgpr_read_b32 v23, a83
    v_accvgpr_read_b32 v24, a84
    v_accvgpr_read_b32 v25, a85
    v_accvgpr_read_b32 v26, a86
    v_accvgpr_read_b32 v27, a87
    v_cvt_pk_bf16_f32 v36, v20, v21
    v_cvt_pk_bf16_f32 v37, v22, v23
    v_cvt_pk_bf16_f32 v38, v24, v25
    v_cvt_pk_bf16_f32 v39, v26, v27
    buffer_store_dwordx4 v[36:39], v251, s[4:7], s53 offen offset:2048 sc1
    v_accvgpr_read_b32 v40, a88
    v_accvgpr_read_b32 v41, a89
    v_accvgpr_read_b32 v42, a90
    v_accvgpr_read_b32 v43, a91
    v_accvgpr_read_b32 v44, a92
    v_accvgpr_read_b32 v45, a93
    v_accvgpr_read_b32 v46, a94
    v_accvgpr_read_b32 v47, a95
    v_cvt_pk_bf16_f32 v56, v40, v41
    v_cvt_pk_bf16_f32 v57, v42, v43
    v_cvt_pk_bf16_f32 v58, v44, v45
    v_cvt_pk_bf16_f32 v59, v46, v47
    buffer_store_dwordx4 v[56:59], v251, s[4:7], s53 offen offset:3072 sc1
    s_add_u32 s53, s53, s22
    v_accvgpr_read_b32 v0, a96
    v_accvgpr_read_b32 v1, a97
    v_accvgpr_read_b32 v2, a98
    v_accvgpr_read_b32 v3, a99
    v_accvgpr_read_b32 v4, a100
    v_accvgpr_read_b32 v5, a101
    v_accvgpr_read_b32 v6, a102
    v_accvgpr_read_b32 v7, a103
    v_cvt_pk_bf16_f32 v16, v0, v1
    v_cvt_pk_bf16_f32 v17, v2, v3
    v_cvt_pk_bf16_f32 v18, v4, v5
    v_cvt_pk_bf16_f32 v19, v6, v7
    buffer_store_dwordx4 v[16:19], v251, s[4:7], s53 offen offset:0 sc1
    v_accvgpr_read_b32 v20, a104
    v_accvgpr_read_b32 v21, a105
    v_accvgpr_read_b32 v22, a106
    v_accvgpr_read_b32 v23, a107
    v_accvgpr_read_b32 v24, a108
    v_accvgpr_read_b32 v25, a109
    v_accvgpr_read_b32 v26, a110
    v_accvgpr_read_b32 v27, a111
    v_cvt_pk_bf16_f32 v36, v20, v21
    v_cvt_pk_bf16_f32 v37, v22, v23
    v_cvt_pk_bf16_f32 v38, v24, v25
    v_cvt_pk_bf16_f32 v39, v26, v27
    buffer_store_dwordx4 v[36:39], v251, s[4:7], s53 offen offset:1024 sc1
    v_accvgpr_read_b32 v40, a112
    v_accvgpr_read_b32 v41, a113
    v_accvgpr_read_b32 v42, a114
    v_accvgpr_read_b32 v43, a115
    v_accvgpr_read_b32 v44, a116
    v_accvgpr_read_b32 v45, a117
    v_accvgpr_read_b32 v46, a118
    v_accvgpr_read_b32 v47, a119
    v_cvt_pk_bf16_f32 v56, v40, v41
    v_cvt_pk_bf16_f32 v57, v42, v43
    v_cvt_pk_bf16_f32 v58, v44, v45
    v_cvt_pk_bf16_f32 v59, v46, v47
    buffer_store_dwordx4 v[56:59], v251, s[4:7], s53 offen offset:2048 sc1
    v_accvgpr_read_b32 v0, a120
    v_accvgpr_read_b32 v1, a121
    v_accvgpr_read_b32 v2, a122
    v_accvgpr_read_b32 v3, a123
    v_accvgpr_read_b32 v4, a124
    v_accvgpr_read_b32 v5, a125
    v_accvgpr_read_b32 v6, a126
    v_accvgpr_read_b32 v7, a127
    v_cvt_pk_bf16_f32 v16, v0, v1
    v_cvt_pk_bf16_f32 v17, v2, v3
    v_cvt_pk_bf16_f32 v18, v4, v5
    v_cvt_pk_bf16_f32 v19, v6, v7
    buffer_store_dwordx4 v[16:19], v251, s[4:7], s53 offen offset:3072 sc1
    s_branch main_kernel_w_done
main_kernel_w_c1_escl:
    s_mov_b32 s53, s21
    v_accvgpr_read_b32 v0, a0
    v_accvgpr_read_b32 v1, a1
    v_accvgpr_read_b32 v2, a2
    v_accvgpr_read_b32 v3, a3
    v_accvgpr_read_b32 v4, a4
    v_accvgpr_read_b32 v5, a5
    v_accvgpr_read_b32 v6, a6
    v_accvgpr_read_b32 v7, a7
    v_mul_f32 v0, 0x3e0293ee, v0
    v_mul_f32 v1, 0x3e0293ee, v1
    v_mul_f32 v2, 0x3e0293ee, v2
    v_mul_f32 v3, 0x3e0293ee, v3
    v_mul_f32 v4, 0x3e0293ee, v4
    v_mul_f32 v5, 0x3e0293ee, v5
    v_mul_f32 v6, 0x3e0293ee, v6
    v_mul_f32 v7, 0x3e0293ee, v7
    v_cvt_pk_bf16_f32 v16, v0, v1
    v_cvt_pk_bf16_f32 v17, v2, v3
    v_cvt_pk_bf16_f32 v18, v4, v5
    v_cvt_pk_bf16_f32 v19, v6, v7
    buffer_store_dwordx4 v[16:19], v251, s[4:7], s53 offen offset:0 sc1
    v_accvgpr_read_b32 v20, a8
    v_accvgpr_read_b32 v21, a9
    v_accvgpr_read_b32 v22, a10
    v_accvgpr_read_b32 v23, a11
    v_accvgpr_read_b32 v24, a12
    v_accvgpr_read_b32 v25, a13
    v_accvgpr_read_b32 v26, a14
    v_accvgpr_read_b32 v27, a15
    v_mul_f32 v20, 0x3e0293ee, v20
    v_mul_f32 v21, 0x3e0293ee, v21
    v_mul_f32 v22, 0x3e0293ee, v22
    v_mul_f32 v23, 0x3e0293ee, v23
    v_mul_f32 v24, 0x3e0293ee, v24
    v_mul_f32 v25, 0x3e0293ee, v25
    v_mul_f32 v26, 0x3e0293ee, v26
    v_mul_f32 v27, 0x3e0293ee, v27
    v_cvt_pk_bf16_f32 v36, v20, v21
    v_cvt_pk_bf16_f32 v37, v22, v23
    v_cvt_pk_bf16_f32 v38, v24, v25
    v_cvt_pk_bf16_f32 v39, v26, v27
    buffer_store_dwordx4 v[36:39], v251, s[4:7], s53 offen offset:1024 sc1
    v_accvgpr_read_b32 v40, a16
    v_accvgpr_read_b32 v41, a17
    v_accvgpr_read_b32 v42, a18
    v_accvgpr_read_b32 v43, a19
    v_accvgpr_read_b32 v44, a20
    v_accvgpr_read_b32 v45, a21
    v_accvgpr_read_b32 v46, a22
    v_accvgpr_read_b32 v47, a23
    v_mul_f32 v40, 0x3e0293ee, v40
    v_mul_f32 v41, 0x3e0293ee, v41
    v_mul_f32 v42, 0x3e0293ee, v42
    v_mul_f32 v43, 0x3e0293ee, v43
    v_mul_f32 v44, 0x3e0293ee, v44
    v_mul_f32 v45, 0x3e0293ee, v45
    v_mul_f32 v46, 0x3e0293ee, v46
    v_mul_f32 v47, 0x3e0293ee, v47
    v_cvt_pk_bf16_f32 v56, v40, v41
    v_cvt_pk_bf16_f32 v57, v42, v43
    v_cvt_pk_bf16_f32 v58, v44, v45
    v_cvt_pk_bf16_f32 v59, v46, v47
    buffer_store_dwordx4 v[56:59], v251, s[4:7], s53 offen offset:2048 sc1
    v_accvgpr_read_b32 v0, a24
    v_accvgpr_read_b32 v1, a25
    v_accvgpr_read_b32 v2, a26
    v_accvgpr_read_b32 v3, a27
    v_accvgpr_read_b32 v4, a28
    v_accvgpr_read_b32 v5, a29
    v_accvgpr_read_b32 v6, a30
    v_accvgpr_read_b32 v7, a31
    v_mul_f32 v0, 0x3e0293ee, v0
    v_mul_f32 v1, 0x3e0293ee, v1
    v_mul_f32 v2, 0x3e0293ee, v2
    v_mul_f32 v3, 0x3e0293ee, v3
    v_mul_f32 v4, 0x3e0293ee, v4
    v_mul_f32 v5, 0x3e0293ee, v5
    v_mul_f32 v6, 0x3e0293ee, v6
    v_mul_f32 v7, 0x3e0293ee, v7
    v_cvt_pk_bf16_f32 v16, v0, v1
    v_cvt_pk_bf16_f32 v17, v2, v3
    v_cvt_pk_bf16_f32 v18, v4, v5
    v_cvt_pk_bf16_f32 v19, v6, v7
    buffer_store_dwordx4 v[16:19], v251, s[4:7], s53 offen offset:3072 sc1
    s_add_u32 s53, s53, s22
    v_accvgpr_read_b32 v20, a32
    v_accvgpr_read_b32 v21, a33
    v_accvgpr_read_b32 v22, a34
    v_accvgpr_read_b32 v23, a35
    v_accvgpr_read_b32 v24, a36
    v_accvgpr_read_b32 v25, a37
    v_accvgpr_read_b32 v26, a38
    v_accvgpr_read_b32 v27, a39
    v_mul_f32 v20, 0x3e0293ee, v20
    v_mul_f32 v21, 0x3e0293ee, v21
    v_mul_f32 v22, 0x3e0293ee, v22
    v_mul_f32 v23, 0x3e0293ee, v23
    v_mul_f32 v24, 0x3e0293ee, v24
    v_mul_f32 v25, 0x3e0293ee, v25
    v_mul_f32 v26, 0x3e0293ee, v26
    v_mul_f32 v27, 0x3e0293ee, v27
    v_cvt_pk_bf16_f32 v36, v20, v21
    v_cvt_pk_bf16_f32 v37, v22, v23
    v_cvt_pk_bf16_f32 v38, v24, v25
    v_cvt_pk_bf16_f32 v39, v26, v27
    buffer_store_dwordx4 v[36:39], v251, s[4:7], s53 offen offset:0 sc1
    v_accvgpr_read_b32 v40, a40
    v_accvgpr_read_b32 v41, a41
    v_accvgpr_read_b32 v42, a42
    v_accvgpr_read_b32 v43, a43
    v_accvgpr_read_b32 v44, a44
    v_accvgpr_read_b32 v45, a45
    v_accvgpr_read_b32 v46, a46
    v_accvgpr_read_b32 v47, a47
    v_mul_f32 v40, 0x3e0293ee, v40
    v_mul_f32 v41, 0x3e0293ee, v41
    v_mul_f32 v42, 0x3e0293ee, v42
    v_mul_f32 v43, 0x3e0293ee, v43
    v_mul_f32 v44, 0x3e0293ee, v44
    v_mul_f32 v45, 0x3e0293ee, v45
    v_mul_f32 v46, 0x3e0293ee, v46
    v_mul_f32 v47, 0x3e0293ee, v47
    v_cvt_pk_bf16_f32 v56, v40, v41
    v_cvt_pk_bf16_f32 v57, v42, v43
    v_cvt_pk_bf16_f32 v58, v44, v45
    v_cvt_pk_bf16_f32 v59, v46, v47
    buffer_store_dwordx4 v[56:59], v251, s[4:7], s53 offen offset:1024 sc1
    v_accvgpr_read_b32 v0, a48
    v_accvgpr_read_b32 v1, a49
    v_accvgpr_read_b32 v2, a50
    v_accvgpr_read_b32 v3, a51
    v_accvgpr_read_b32 v4, a52
    v_accvgpr_read_b32 v5, a53
    v_accvgpr_read_b32 v6, a54
    v_accvgpr_read_b32 v7, a55
    v_mul_f32 v0, 0x3e0293ee, v0
    v_mul_f32 v1, 0x3e0293ee, v1
    v_mul_f32 v2, 0x3e0293ee, v2
    v_mul_f32 v3, 0x3e0293ee, v3
    v_mul_f32 v4, 0x3e0293ee, v4
    v_mul_f32 v5, 0x3e0293ee, v5
    v_mul_f32 v6, 0x3e0293ee, v6
    v_mul_f32 v7, 0x3e0293ee, v7
    v_cvt_pk_bf16_f32 v16, v0, v1
    v_cvt_pk_bf16_f32 v17, v2, v3
    v_cvt_pk_bf16_f32 v18, v4, v5
    v_cvt_pk_bf16_f32 v19, v6, v7
    buffer_store_dwordx4 v[16:19], v251, s[4:7], s53 offen offset:2048 sc1
    v_accvgpr_read_b32 v20, a56
    v_accvgpr_read_b32 v21, a57
    v_accvgpr_read_b32 v22, a58
    v_accvgpr_read_b32 v23, a59
    v_accvgpr_read_b32 v24, a60
    v_accvgpr_read_b32 v25, a61
    v_accvgpr_read_b32 v26, a62
    v_accvgpr_read_b32 v27, a63
    v_mul_f32 v20, 0x3e0293ee, v20
    v_mul_f32 v21, 0x3e0293ee, v21
    v_mul_f32 v22, 0x3e0293ee, v22
    v_mul_f32 v23, 0x3e0293ee, v23
    v_mul_f32 v24, 0x3e0293ee, v24
    v_mul_f32 v25, 0x3e0293ee, v25
    v_mul_f32 v26, 0x3e0293ee, v26
    v_mul_f32 v27, 0x3e0293ee, v27
    v_cvt_pk_bf16_f32 v36, v20, v21
    v_cvt_pk_bf16_f32 v37, v22, v23
    v_cvt_pk_bf16_f32 v38, v24, v25
    v_cvt_pk_bf16_f32 v39, v26, v27
    buffer_store_dwordx4 v[36:39], v251, s[4:7], s53 offen offset:3072 sc1
    s_add_u32 s53, s53, s22
    v_accvgpr_read_b32 v40, a64
    v_accvgpr_read_b32 v41, a65
    v_accvgpr_read_b32 v42, a66
    v_accvgpr_read_b32 v43, a67
    v_accvgpr_read_b32 v44, a68
    v_accvgpr_read_b32 v45, a69
    v_accvgpr_read_b32 v46, a70
    v_accvgpr_read_b32 v47, a71
    v_mul_f32 v40, 0x3e0293ee, v40
    v_mul_f32 v41, 0x3e0293ee, v41
    v_mul_f32 v42, 0x3e0293ee, v42
    v_mul_f32 v43, 0x3e0293ee, v43
    v_mul_f32 v44, 0x3e0293ee, v44
    v_mul_f32 v45, 0x3e0293ee, v45
    v_mul_f32 v46, 0x3e0293ee, v46
    v_mul_f32 v47, 0x3e0293ee, v47
    v_cvt_pk_bf16_f32 v56, v40, v41
    v_cvt_pk_bf16_f32 v57, v42, v43
    v_cvt_pk_bf16_f32 v58, v44, v45
    v_cvt_pk_bf16_f32 v59, v46, v47
    buffer_store_dwordx4 v[56:59], v251, s[4:7], s53 offen offset:0 sc1
    v_accvgpr_read_b32 v0, a72
    v_accvgpr_read_b32 v1, a73
    v_accvgpr_read_b32 v2, a74
    v_accvgpr_read_b32 v3, a75
    v_accvgpr_read_b32 v4, a76
    v_accvgpr_read_b32 v5, a77
    v_accvgpr_read_b32 v6, a78
    v_accvgpr_read_b32 v7, a79
    v_mul_f32 v0, 0x3e0293ee, v0
    v_mul_f32 v1, 0x3e0293ee, v1
    v_mul_f32 v2, 0x3e0293ee, v2
    v_mul_f32 v3, 0x3e0293ee, v3
    v_mul_f32 v4, 0x3e0293ee, v4
    v_mul_f32 v5, 0x3e0293ee, v5
    v_mul_f32 v6, 0x3e0293ee, v6
    v_mul_f32 v7, 0x3e0293ee, v7
    v_cvt_pk_bf16_f32 v16, v0, v1
    v_cvt_pk_bf16_f32 v17, v2, v3
    v_cvt_pk_bf16_f32 v18, v4, v5
    v_cvt_pk_bf16_f32 v19, v6, v7
    buffer_store_dwordx4 v[16:19], v251, s[4:7], s53 offen offset:1024 sc1
    v_accvgpr_read_b32 v20, a80
    v_accvgpr_read_b32 v21, a81
    v_accvgpr_read_b32 v22, a82
    v_accvgpr_read_b32 v23, a83
    v_accvgpr_read_b32 v24, a84
    v_accvgpr_read_b32 v25, a85
    v_accvgpr_read_b32 v26, a86
    v_accvgpr_read_b32 v27, a87
    v_mul_f32 v20, 0x3e0293ee, v20
    v_mul_f32 v21, 0x3e0293ee, v21
    v_mul_f32 v22, 0x3e0293ee, v22
    v_mul_f32 v23, 0x3e0293ee, v23
    v_mul_f32 v24, 0x3e0293ee, v24
    v_mul_f32 v25, 0x3e0293ee, v25
    v_mul_f32 v26, 0x3e0293ee, v26
    v_mul_f32 v27, 0x3e0293ee, v27
    v_cvt_pk_bf16_f32 v36, v20, v21
    v_cvt_pk_bf16_f32 v37, v22, v23
    v_cvt_pk_bf16_f32 v38, v24, v25
    v_cvt_pk_bf16_f32 v39, v26, v27
    buffer_store_dwordx4 v[36:39], v251, s[4:7], s53 offen offset:2048 sc1
    v_accvgpr_read_b32 v40, a88
    v_accvgpr_read_b32 v41, a89
    v_accvgpr_read_b32 v42, a90
    v_accvgpr_read_b32 v43, a91
    v_accvgpr_read_b32 v44, a92
    v_accvgpr_read_b32 v45, a93
    v_accvgpr_read_b32 v46, a94
    v_accvgpr_read_b32 v47, a95
    v_mul_f32 v40, 0x3e0293ee, v40
    v_mul_f32 v41, 0x3e0293ee, v41
    v_mul_f32 v42, 0x3e0293ee, v42
    v_mul_f32 v43, 0x3e0293ee, v43
    v_mul_f32 v44, 0x3e0293ee, v44
    v_mul_f32 v45, 0x3e0293ee, v45
    v_mul_f32 v46, 0x3e0293ee, v46
    v_mul_f32 v47, 0x3e0293ee, v47
    v_cvt_pk_bf16_f32 v56, v40, v41
    v_cvt_pk_bf16_f32 v57, v42, v43
    v_cvt_pk_bf16_f32 v58, v44, v45
    v_cvt_pk_bf16_f32 v59, v46, v47
    buffer_store_dwordx4 v[56:59], v251, s[4:7], s53 offen offset:3072 sc1
    s_add_u32 s53, s53, s22
    v_accvgpr_read_b32 v0, a96
    v_accvgpr_read_b32 v1, a97
    v_accvgpr_read_b32 v2, a98
    v_accvgpr_read_b32 v3, a99
    v_accvgpr_read_b32 v4, a100
    v_accvgpr_read_b32 v5, a101
    v_accvgpr_read_b32 v6, a102
    v_accvgpr_read_b32 v7, a103
    v_mul_f32 v0, 0x3e0293ee, v0
    v_mul_f32 v1, 0x3e0293ee, v1
    v_mul_f32 v2, 0x3e0293ee, v2
    v_mul_f32 v3, 0x3e0293ee, v3
    v_mul_f32 v4, 0x3e0293ee, v4
    v_mul_f32 v5, 0x3e0293ee, v5
    v_mul_f32 v6, 0x3e0293ee, v6
    v_mul_f32 v7, 0x3e0293ee, v7
    v_cvt_pk_bf16_f32 v16, v0, v1
    v_cvt_pk_bf16_f32 v17, v2, v3
    v_cvt_pk_bf16_f32 v18, v4, v5
    v_cvt_pk_bf16_f32 v19, v6, v7
    buffer_store_dwordx4 v[16:19], v251, s[4:7], s53 offen offset:0 sc1
    v_accvgpr_read_b32 v20, a104
    v_accvgpr_read_b32 v21, a105
    v_accvgpr_read_b32 v22, a106
    v_accvgpr_read_b32 v23, a107
    v_accvgpr_read_b32 v24, a108
    v_accvgpr_read_b32 v25, a109
    v_accvgpr_read_b32 v26, a110
    v_accvgpr_read_b32 v27, a111
    v_mul_f32 v20, 0x3e0293ee, v20
    v_mul_f32 v21, 0x3e0293ee, v21
    v_mul_f32 v22, 0x3e0293ee, v22
    v_mul_f32 v23, 0x3e0293ee, v23
    v_mul_f32 v24, 0x3e0293ee, v24
    v_mul_f32 v25, 0x3e0293ee, v25
    v_mul_f32 v26, 0x3e0293ee, v26
    v_mul_f32 v27, 0x3e0293ee, v27
    v_cvt_pk_bf16_f32 v36, v20, v21
    v_cvt_pk_bf16_f32 v37, v22, v23
    v_cvt_pk_bf16_f32 v38, v24, v25
    v_cvt_pk_bf16_f32 v39, v26, v27
    buffer_store_dwordx4 v[36:39], v251, s[4:7], s53 offen offset:1024 sc1
    v_accvgpr_read_b32 v40, a112
    v_accvgpr_read_b32 v41, a113
    v_accvgpr_read_b32 v42, a114
    v_accvgpr_read_b32 v43, a115
    v_accvgpr_read_b32 v44, a116
    v_accvgpr_read_b32 v45, a117
    v_accvgpr_read_b32 v46, a118
    v_accvgpr_read_b32 v47, a119
    v_mul_f32 v40, 0x3e0293ee, v40
    v_mul_f32 v41, 0x3e0293ee, v41
    v_mul_f32 v42, 0x3e0293ee, v42
    v_mul_f32 v43, 0x3e0293ee, v43
    v_mul_f32 v44, 0x3e0293ee, v44
    v_mul_f32 v45, 0x3e0293ee, v45
    v_mul_f32 v46, 0x3e0293ee, v46
    v_mul_f32 v47, 0x3e0293ee, v47
    v_cvt_pk_bf16_f32 v56, v40, v41
    v_cvt_pk_bf16_f32 v57, v42, v43
    v_cvt_pk_bf16_f32 v58, v44, v45
    v_cvt_pk_bf16_f32 v59, v46, v47
    buffer_store_dwordx4 v[56:59], v251, s[4:7], s53 offen offset:2048 sc1
    v_accvgpr_read_b32 v0, a120
    v_accvgpr_read_b32 v1, a121
    v_accvgpr_read_b32 v2, a122
    v_accvgpr_read_b32 v3, a123
    v_accvgpr_read_b32 v4, a124
    v_accvgpr_read_b32 v5, a125
    v_accvgpr_read_b32 v6, a126
    v_accvgpr_read_b32 v7, a127
    v_mul_f32 v0, 0x3e0293ee, v0
    v_mul_f32 v1, 0x3e0293ee, v1
    v_mul_f32 v2, 0x3e0293ee, v2
    v_mul_f32 v3, 0x3e0293ee, v3
    v_mul_f32 v4, 0x3e0293ee, v4
    v_mul_f32 v5, 0x3e0293ee, v5
    v_mul_f32 v6, 0x3e0293ee, v6
    v_mul_f32 v7, 0x3e0293ee, v7
    v_cvt_pk_bf16_f32 v16, v0, v1
    v_cvt_pk_bf16_f32 v17, v2, v3
    v_cvt_pk_bf16_f32 v18, v4, v5
    v_cvt_pk_bf16_f32 v19, v6, v7
    buffer_store_dwordx4 v[16:19], v251, s[4:7], s53 offen offset:3072 sc1
    s_branch main_kernel_w_done
main_kernel_w_c1_egelus:
    s_mov_b32 s53, s21
    v_accvgpr_read_b32 v0, a0
    v_accvgpr_read_b32 v1, a1
    v_accvgpr_read_b32 v2, a2
    v_accvgpr_read_b32 v3, a3
    v_accvgpr_read_b32 v4, a4
    v_accvgpr_read_b32 v5, a5
    v_accvgpr_read_b32 v6, a6
    v_accvgpr_read_b32 v7, a7
    v_pk_mul_f32 v[8:9], v[0:1], v[0:1]
    v_pk_mul_f32 v[10:11], v[2:3], v[2:3]
    v_pk_mul_f32 v[12:13], v[4:5], v[4:5]
    v_pk_mul_f32 v[14:15], v[6:7], v[6:7]
    v_pk_fma_f32 v[8:9], v[8:9], v[242:243], v[240:241]
    v_pk_fma_f32 v[10:11], v[10:11], v[242:243], v[240:241]
    v_pk_fma_f32 v[12:13], v[12:13], v[242:243], v[240:241]
    v_pk_fma_f32 v[14:15], v[14:15], v[242:243], v[240:241]
    v_pk_mul_f32 v[8:9], v[8:9], v[0:1]
    v_pk_mul_f32 v[10:11], v[10:11], v[2:3]
    v_pk_mul_f32 v[12:13], v[12:13], v[4:5]
    v_pk_mul_f32 v[14:15], v[14:15], v[6:7]
    v_exp_f32 v8, v8
    v_exp_f32 v9, v9
    v_exp_f32 v10, v10
    v_exp_f32 v11, v11
    v_exp_f32 v12, v12
    v_exp_f32 v13, v13
    v_exp_f32 v14, v14
    v_exp_f32 v15, v15
    v_pk_add_f32 v[8:9], v[8:9], v[244:245]
    v_pk_add_f32 v[10:11], v[10:11], v[244:245]
    v_pk_add_f32 v[12:13], v[12:13], v[244:245]
    v_pk_add_f32 v[14:15], v[14:15], v[244:245]
    v_rcp_f32 v8, v8
    v_rcp_f32 v9, v9
    v_rcp_f32 v10, v10
    v_rcp_f32 v11, v11
    v_rcp_f32 v12, v12
    v_rcp_f32 v13, v13
    v_rcp_f32 v14, v14
    v_rcp_f32 v15, v15
    v_pk_mul_f32 v[0:1], v[8:9], v[0:1]
    v_pk_mul_f32 v[2:3], v[10:11], v[2:3]
    v_pk_mul_f32 v[4:5], v[12:13], v[4:5]
    v_pk_mul_f32 v[6:7], v[14:15], v[6:7]
    v_cvt_pk_bf16_f32 v16, v0, v1
    v_cvt_pk_bf16_f32 v17, v2, v3
    v_cvt_pk_bf16_f32 v18, v4, v5
    v_cvt_pk_bf16_f32 v19, v6, v7
    buffer_store_dwordx4 v[16:19], v252, s[4:7], s53 offen offset:0 sc1
    v_accvgpr_read_b32 v20, a8
    v_accvgpr_read_b32 v21, a9
    v_accvgpr_read_b32 v22, a10
    v_accvgpr_read_b32 v23, a11
    v_accvgpr_read_b32 v24, a12
    v_accvgpr_read_b32 v25, a13
    v_accvgpr_read_b32 v26, a14
    v_accvgpr_read_b32 v27, a15
    v_pk_mul_f32 v[28:29], v[20:21], v[20:21]
    v_pk_mul_f32 v[30:31], v[22:23], v[22:23]
    v_pk_mul_f32 v[32:33], v[24:25], v[24:25]
    v_pk_mul_f32 v[34:35], v[26:27], v[26:27]
    v_pk_fma_f32 v[28:29], v[28:29], v[242:243], v[240:241]
    v_pk_fma_f32 v[30:31], v[30:31], v[242:243], v[240:241]
    v_pk_fma_f32 v[32:33], v[32:33], v[242:243], v[240:241]
    v_pk_fma_f32 v[34:35], v[34:35], v[242:243], v[240:241]
    v_pk_mul_f32 v[28:29], v[28:29], v[20:21]
    v_pk_mul_f32 v[30:31], v[30:31], v[22:23]
    v_pk_mul_f32 v[32:33], v[32:33], v[24:25]
    v_pk_mul_f32 v[34:35], v[34:35], v[26:27]
    v_exp_f32 v28, v28
    v_exp_f32 v29, v29
    v_exp_f32 v30, v30
    v_exp_f32 v31, v31
    v_exp_f32 v32, v32
    v_exp_f32 v33, v33
    v_exp_f32 v34, v34
    v_exp_f32 v35, v35
    v_pk_add_f32 v[28:29], v[28:29], v[244:245]
    v_pk_add_f32 v[30:31], v[30:31], v[244:245]
    v_pk_add_f32 v[32:33], v[32:33], v[244:245]
    v_pk_add_f32 v[34:35], v[34:35], v[244:245]
    v_rcp_f32 v28, v28
    v_rcp_f32 v29, v29
    v_rcp_f32 v30, v30
    v_rcp_f32 v31, v31
    v_rcp_f32 v32, v32
    v_rcp_f32 v33, v33
    v_rcp_f32 v34, v34
    v_rcp_f32 v35, v35
    v_pk_mul_f32 v[20:21], v[28:29], v[20:21]
    v_pk_mul_f32 v[22:23], v[30:31], v[22:23]
    v_pk_mul_f32 v[24:25], v[32:33], v[24:25]
    v_pk_mul_f32 v[26:27], v[34:35], v[26:27]
    v_cvt_pk_bf16_f32 v36, v20, v21
    v_cvt_pk_bf16_f32 v37, v22, v23
    v_cvt_pk_bf16_f32 v38, v24, v25
    v_cvt_pk_bf16_f32 v39, v26, v27
    buffer_store_dwordx4 v[36:39], v252, s[4:7], s53 offen offset:1024 sc1
    v_accvgpr_read_b32 v40, a16
    v_accvgpr_read_b32 v41, a17
    v_accvgpr_read_b32 v42, a18
    v_accvgpr_read_b32 v43, a19
    v_accvgpr_read_b32 v44, a20
    v_accvgpr_read_b32 v45, a21
    v_accvgpr_read_b32 v46, a22
    v_accvgpr_read_b32 v47, a23
    v_pk_mul_f32 v[48:49], v[40:41], v[40:41]
    v_pk_mul_f32 v[50:51], v[42:43], v[42:43]
    v_pk_mul_f32 v[52:53], v[44:45], v[44:45]
    v_pk_mul_f32 v[54:55], v[46:47], v[46:47]
    v_pk_fma_f32 v[48:49], v[48:49], v[242:243], v[240:241]
    v_pk_fma_f32 v[50:51], v[50:51], v[242:243], v[240:241]
    v_pk_fma_f32 v[52:53], v[52:53], v[242:243], v[240:241]
    v_pk_fma_f32 v[54:55], v[54:55], v[242:243], v[240:241]
    v_pk_mul_f32 v[48:49], v[48:49], v[40:41]
    v_pk_mul_f32 v[50:51], v[50:51], v[42:43]
    v_pk_mul_f32 v[52:53], v[52:53], v[44:45]
    v_pk_mul_f32 v[54:55], v[54:55], v[46:47]
    v_exp_f32 v48, v48
    v_exp_f32 v49, v49
    v_exp_f32 v50, v50
    v_exp_f32 v51, v51
    v_exp_f32 v52, v52
    v_exp_f32 v53, v53
    v_exp_f32 v54, v54
    v_exp_f32 v55, v55
    v_pk_add_f32 v[48:49], v[48:49], v[244:245]
    v_pk_add_f32 v[50:51], v[50:51], v[244:245]
    v_pk_add_f32 v[52:53], v[52:53], v[244:245]
    v_pk_add_f32 v[54:55], v[54:55], v[244:245]
    v_rcp_f32 v48, v48
    v_rcp_f32 v49, v49
    v_rcp_f32 v50, v50
    v_rcp_f32 v51, v51
    v_rcp_f32 v52, v52
    v_rcp_f32 v53, v53
    v_rcp_f32 v54, v54
    v_rcp_f32 v55, v55
    v_pk_mul_f32 v[40:41], v[48:49], v[40:41]
    v_pk_mul_f32 v[42:43], v[50:51], v[42:43]
    v_pk_mul_f32 v[44:45], v[52:53], v[44:45]
    v_pk_mul_f32 v[46:47], v[54:55], v[46:47]
    v_cvt_pk_bf16_f32 v56, v40, v41
    v_cvt_pk_bf16_f32 v57, v42, v43
    v_cvt_pk_bf16_f32 v58, v44, v45
    v_cvt_pk_bf16_f32 v59, v46, v47
    buffer_store_dwordx4 v[56:59], v252, s[4:7], s53 offen offset:2048 sc1
    v_accvgpr_read_b32 v0, a24
    v_accvgpr_read_b32 v1, a25
    v_accvgpr_read_b32 v2, a26
    v_accvgpr_read_b32 v3, a27
    v_accvgpr_read_b32 v4, a28
    v_accvgpr_read_b32 v5, a29
    v_accvgpr_read_b32 v6, a30
    v_accvgpr_read_b32 v7, a31
    v_pk_mul_f32 v[8:9], v[0:1], v[0:1]
    v_pk_mul_f32 v[10:11], v[2:3], v[2:3]
    v_pk_mul_f32 v[12:13], v[4:5], v[4:5]
    v_pk_mul_f32 v[14:15], v[6:7], v[6:7]
    v_pk_fma_f32 v[8:9], v[8:9], v[242:243], v[240:241]
    v_pk_fma_f32 v[10:11], v[10:11], v[242:243], v[240:241]
    v_pk_fma_f32 v[12:13], v[12:13], v[242:243], v[240:241]
    v_pk_fma_f32 v[14:15], v[14:15], v[242:243], v[240:241]
    v_pk_mul_f32 v[8:9], v[8:9], v[0:1]
    v_pk_mul_f32 v[10:11], v[10:11], v[2:3]
    v_pk_mul_f32 v[12:13], v[12:13], v[4:5]
    v_pk_mul_f32 v[14:15], v[14:15], v[6:7]
    v_exp_f32 v8, v8
    v_exp_f32 v9, v9
    v_exp_f32 v10, v10
    v_exp_f32 v11, v11
    v_exp_f32 v12, v12
    v_exp_f32 v13, v13
    v_exp_f32 v14, v14
    v_exp_f32 v15, v15
    v_pk_add_f32 v[8:9], v[8:9], v[244:245]
    v_pk_add_f32 v[10:11], v[10:11], v[244:245]
    v_pk_add_f32 v[12:13], v[12:13], v[244:245]
    v_pk_add_f32 v[14:15], v[14:15], v[244:245]
    v_rcp_f32 v8, v8
    v_rcp_f32 v9, v9
    v_rcp_f32 v10, v10
    v_rcp_f32 v11, v11
    v_rcp_f32 v12, v12
    v_rcp_f32 v13, v13
    v_rcp_f32 v14, v14
    v_rcp_f32 v15, v15
    v_pk_mul_f32 v[0:1], v[8:9], v[0:1]
    v_pk_mul_f32 v[2:3], v[10:11], v[2:3]
    v_pk_mul_f32 v[4:5], v[12:13], v[4:5]
    v_pk_mul_f32 v[6:7], v[14:15], v[6:7]
    v_cvt_pk_bf16_f32 v16, v0, v1
    v_cvt_pk_bf16_f32 v17, v2, v3
    v_cvt_pk_bf16_f32 v18, v4, v5
    v_cvt_pk_bf16_f32 v19, v6, v7
    buffer_store_dwordx4 v[16:19], v252, s[4:7], s53 offen offset:3072 sc1
    s_add_u32 s53, s53, s22
    v_accvgpr_read_b32 v20, a32
    v_accvgpr_read_b32 v21, a33
    v_accvgpr_read_b32 v22, a34
    v_accvgpr_read_b32 v23, a35
    v_accvgpr_read_b32 v24, a36
    v_accvgpr_read_b32 v25, a37
    v_accvgpr_read_b32 v26, a38
    v_accvgpr_read_b32 v27, a39
    v_pk_mul_f32 v[28:29], v[20:21], v[20:21]
    v_pk_mul_f32 v[30:31], v[22:23], v[22:23]
    v_pk_mul_f32 v[32:33], v[24:25], v[24:25]
    v_pk_mul_f32 v[34:35], v[26:27], v[26:27]
    v_pk_fma_f32 v[28:29], v[28:29], v[242:243], v[240:241]
    v_pk_fma_f32 v[30:31], v[30:31], v[242:243], v[240:241]
    v_pk_fma_f32 v[32:33], v[32:33], v[242:243], v[240:241]
    v_pk_fma_f32 v[34:35], v[34:35], v[242:243], v[240:241]
    v_pk_mul_f32 v[28:29], v[28:29], v[20:21]
    v_pk_mul_f32 v[30:31], v[30:31], v[22:23]
    v_pk_mul_f32 v[32:33], v[32:33], v[24:25]
    v_pk_mul_f32 v[34:35], v[34:35], v[26:27]
    v_exp_f32 v28, v28
    v_exp_f32 v29, v29
    v_exp_f32 v30, v30
    v_exp_f32 v31, v31
    v_exp_f32 v32, v32
    v_exp_f32 v33, v33
    v_exp_f32 v34, v34
    v_exp_f32 v35, v35
    v_pk_add_f32 v[28:29], v[28:29], v[244:245]
    v_pk_add_f32 v[30:31], v[30:31], v[244:245]
    v_pk_add_f32 v[32:33], v[32:33], v[244:245]
    v_pk_add_f32 v[34:35], v[34:35], v[244:245]
    v_rcp_f32 v28, v28
    v_rcp_f32 v29, v29
    v_rcp_f32 v30, v30
    v_rcp_f32 v31, v31
    v_rcp_f32 v32, v32
    v_rcp_f32 v33, v33
    v_rcp_f32 v34, v34
    v_rcp_f32 v35, v35
    v_pk_mul_f32 v[20:21], v[28:29], v[20:21]
    v_pk_mul_f32 v[22:23], v[30:31], v[22:23]
    v_pk_mul_f32 v[24:25], v[32:33], v[24:25]
    v_pk_mul_f32 v[26:27], v[34:35], v[26:27]
    v_cvt_pk_bf16_f32 v36, v20, v21
    v_cvt_pk_bf16_f32 v37, v22, v23
    v_cvt_pk_bf16_f32 v38, v24, v25
    v_cvt_pk_bf16_f32 v39, v26, v27
    buffer_store_dwordx4 v[36:39], v252, s[4:7], s53 offen offset:0 sc1
    v_accvgpr_read_b32 v40, a40
    v_accvgpr_read_b32 v41, a41
    v_accvgpr_read_b32 v42, a42
    v_accvgpr_read_b32 v43, a43
    v_accvgpr_read_b32 v44, a44
    v_accvgpr_read_b32 v45, a45
    v_accvgpr_read_b32 v46, a46
    v_accvgpr_read_b32 v47, a47
    v_pk_mul_f32 v[48:49], v[40:41], v[40:41]
    v_pk_mul_f32 v[50:51], v[42:43], v[42:43]
    v_pk_mul_f32 v[52:53], v[44:45], v[44:45]
    v_pk_mul_f32 v[54:55], v[46:47], v[46:47]
    v_pk_fma_f32 v[48:49], v[48:49], v[242:243], v[240:241]
    v_pk_fma_f32 v[50:51], v[50:51], v[242:243], v[240:241]
    v_pk_fma_f32 v[52:53], v[52:53], v[242:243], v[240:241]
    v_pk_fma_f32 v[54:55], v[54:55], v[242:243], v[240:241]
    v_pk_mul_f32 v[48:49], v[48:49], v[40:41]
    v_pk_mul_f32 v[50:51], v[50:51], v[42:43]
    v_pk_mul_f32 v[52:53], v[52:53], v[44:45]
    v_pk_mul_f32 v[54:55], v[54:55], v[46:47]
    v_exp_f32 v48, v48
    v_exp_f32 v49, v49
    v_exp_f32 v50, v50
    v_exp_f32 v51, v51
    v_exp_f32 v52, v52
    v_exp_f32 v53, v53
    v_exp_f32 v54, v54
    v_exp_f32 v55, v55
    v_pk_add_f32 v[48:49], v[48:49], v[244:245]
    v_pk_add_f32 v[50:51], v[50:51], v[244:245]
    v_pk_add_f32 v[52:53], v[52:53], v[244:245]
    v_pk_add_f32 v[54:55], v[54:55], v[244:245]
    v_rcp_f32 v48, v48
    v_rcp_f32 v49, v49
    v_rcp_f32 v50, v50
    v_rcp_f32 v51, v51
    v_rcp_f32 v52, v52
    v_rcp_f32 v53, v53
    v_rcp_f32 v54, v54
    v_rcp_f32 v55, v55
    v_pk_mul_f32 v[40:41], v[48:49], v[40:41]
    v_pk_mul_f32 v[42:43], v[50:51], v[42:43]
    v_pk_mul_f32 v[44:45], v[52:53], v[44:45]
    v_pk_mul_f32 v[46:47], v[54:55], v[46:47]
    v_cvt_pk_bf16_f32 v56, v40, v41
    v_cvt_pk_bf16_f32 v57, v42, v43
    v_cvt_pk_bf16_f32 v58, v44, v45
    v_cvt_pk_bf16_f32 v59, v46, v47
    buffer_store_dwordx4 v[56:59], v252, s[4:7], s53 offen offset:1024 sc1
    v_accvgpr_read_b32 v0, a48
    v_accvgpr_read_b32 v1, a49
    v_accvgpr_read_b32 v2, a50
    v_accvgpr_read_b32 v3, a51
    v_accvgpr_read_b32 v4, a52
    v_accvgpr_read_b32 v5, a53
    v_accvgpr_read_b32 v6, a54
    v_accvgpr_read_b32 v7, a55
    v_pk_mul_f32 v[8:9], v[0:1], v[0:1]
    v_pk_mul_f32 v[10:11], v[2:3], v[2:3]
    v_pk_mul_f32 v[12:13], v[4:5], v[4:5]
    v_pk_mul_f32 v[14:15], v[6:7], v[6:7]
    v_pk_fma_f32 v[8:9], v[8:9], v[242:243], v[240:241]
    v_pk_fma_f32 v[10:11], v[10:11], v[242:243], v[240:241]
    v_pk_fma_f32 v[12:13], v[12:13], v[242:243], v[240:241]
    v_pk_fma_f32 v[14:15], v[14:15], v[242:243], v[240:241]
    v_pk_mul_f32 v[8:9], v[8:9], v[0:1]
    v_pk_mul_f32 v[10:11], v[10:11], v[2:3]
    v_pk_mul_f32 v[12:13], v[12:13], v[4:5]
    v_pk_mul_f32 v[14:15], v[14:15], v[6:7]
    v_exp_f32 v8, v8
    v_exp_f32 v9, v9
    v_exp_f32 v10, v10
    v_exp_f32 v11, v11
    v_exp_f32 v12, v12
    v_exp_f32 v13, v13
    v_exp_f32 v14, v14
    v_exp_f32 v15, v15
    v_pk_add_f32 v[8:9], v[8:9], v[244:245]
    v_pk_add_f32 v[10:11], v[10:11], v[244:245]
    v_pk_add_f32 v[12:13], v[12:13], v[244:245]
    v_pk_add_f32 v[14:15], v[14:15], v[244:245]
    v_rcp_f32 v8, v8
    v_rcp_f32 v9, v9
    v_rcp_f32 v10, v10
    v_rcp_f32 v11, v11
    v_rcp_f32 v12, v12
    v_rcp_f32 v13, v13
    v_rcp_f32 v14, v14
    v_rcp_f32 v15, v15
    v_pk_mul_f32 v[0:1], v[8:9], v[0:1]
    v_pk_mul_f32 v[2:3], v[10:11], v[2:3]
    v_pk_mul_f32 v[4:5], v[12:13], v[4:5]
    v_pk_mul_f32 v[6:7], v[14:15], v[6:7]
    v_cvt_pk_bf16_f32 v16, v0, v1
    v_cvt_pk_bf16_f32 v17, v2, v3
    v_cvt_pk_bf16_f32 v18, v4, v5
    v_cvt_pk_bf16_f32 v19, v6, v7
    buffer_store_dwordx4 v[16:19], v252, s[4:7], s53 offen offset:2048 sc1
    v_accvgpr_read_b32 v20, a56
    v_accvgpr_read_b32 v21, a57
    v_accvgpr_read_b32 v22, a58
    v_accvgpr_read_b32 v23, a59
    v_accvgpr_read_b32 v24, a60
    v_accvgpr_read_b32 v25, a61
    v_accvgpr_read_b32 v26, a62
    v_accvgpr_read_b32 v27, a63
    v_pk_mul_f32 v[28:29], v[20:21], v[20:21]
    v_pk_mul_f32 v[30:31], v[22:23], v[22:23]
    v_pk_mul_f32 v[32:33], v[24:25], v[24:25]
    v_pk_mul_f32 v[34:35], v[26:27], v[26:27]
    v_pk_fma_f32 v[28:29], v[28:29], v[242:243], v[240:241]
    v_pk_fma_f32 v[30:31], v[30:31], v[242:243], v[240:241]
    v_pk_fma_f32 v[32:33], v[32:33], v[242:243], v[240:241]
    v_pk_fma_f32 v[34:35], v[34:35], v[242:243], v[240:241]
    v_pk_mul_f32 v[28:29], v[28:29], v[20:21]
    v_pk_mul_f32 v[30:31], v[30:31], v[22:23]
    v_pk_mul_f32 v[32:33], v[32:33], v[24:25]
    v_pk_mul_f32 v[34:35], v[34:35], v[26:27]
    v_exp_f32 v28, v28
    v_exp_f32 v29, v29
    v_exp_f32 v30, v30
    v_exp_f32 v31, v31
    v_exp_f32 v32, v32
    v_exp_f32 v33, v33
    v_exp_f32 v34, v34
    v_exp_f32 v35, v35
    v_pk_add_f32 v[28:29], v[28:29], v[244:245]
    v_pk_add_f32 v[30:31], v[30:31], v[244:245]
    v_pk_add_f32 v[32:33], v[32:33], v[244:245]
    v_pk_add_f32 v[34:35], v[34:35], v[244:245]
    v_rcp_f32 v28, v28
    v_rcp_f32 v29, v29
    v_rcp_f32 v30, v30
    v_rcp_f32 v31, v31
    v_rcp_f32 v32, v32
    v_rcp_f32 v33, v33
    v_rcp_f32 v34, v34
    v_rcp_f32 v35, v35
    v_pk_mul_f32 v[20:21], v[28:29], v[20:21]
    v_pk_mul_f32 v[22:23], v[30:31], v[22:23]
    v_pk_mul_f32 v[24:25], v[32:33], v[24:25]
    v_pk_mul_f32 v[26:27], v[34:35], v[26:27]
    v_cvt_pk_bf16_f32 v36, v20, v21
    v_cvt_pk_bf16_f32 v37, v22, v23
    v_cvt_pk_bf16_f32 v38, v24, v25
    v_cvt_pk_bf16_f32 v39, v26, v27
    buffer_store_dwordx4 v[36:39], v252, s[4:7], s53 offen offset:3072 sc1
    s_add_u32 s53, s53, s22
    v_accvgpr_read_b32 v40, a64
    v_accvgpr_read_b32 v41, a65
    v_accvgpr_read_b32 v42, a66
    v_accvgpr_read_b32 v43, a67
    v_accvgpr_read_b32 v44, a68
    v_accvgpr_read_b32 v45, a69
    v_accvgpr_read_b32 v46, a70
    v_accvgpr_read_b32 v47, a71
    v_pk_mul_f32 v[48:49], v[40:41], v[40:41]
    v_pk_mul_f32 v[50:51], v[42:43], v[42:43]
    v_pk_mul_f32 v[52:53], v[44:45], v[44:45]
    v_pk_mul_f32 v[54:55], v[46:47], v[46:47]
    v_pk_fma_f32 v[48:49], v[48:49], v[242:243], v[240:241]
    v_pk_fma_f32 v[50:51], v[50:51], v[242:243], v[240:241]
    v_pk_fma_f32 v[52:53], v[52:53], v[242:243], v[240:241]
    v_pk_fma_f32 v[54:55], v[54:55], v[242:243], v[240:241]
    v_pk_mul_f32 v[48:49], v[48:49], v[40:41]
    v_pk_mul_f32 v[50:51], v[50:51], v[42:43]
    v_pk_mul_f32 v[52:53], v[52:53], v[44:45]
    v_pk_mul_f32 v[54:55], v[54:55], v[46:47]
    v_exp_f32 v48, v48
    v_exp_f32 v49, v49
    v_exp_f32 v50, v50
    v_exp_f32 v51, v51
    v_exp_f32 v52, v52
    v_exp_f32 v53, v53
    v_exp_f32 v54, v54
    v_exp_f32 v55, v55
    v_pk_add_f32 v[48:49], v[48:49], v[244:245]
    v_pk_add_f32 v[50:51], v[50:51], v[244:245]
    v_pk_add_f32 v[52:53], v[52:53], v[244:245]
    v_pk_add_f32 v[54:55], v[54:55], v[244:245]
    v_rcp_f32 v48, v48
    v_rcp_f32 v49, v49
    v_rcp_f32 v50, v50
    v_rcp_f32 v51, v51
    v_rcp_f32 v52, v52
    v_rcp_f32 v53, v53
    v_rcp_f32 v54, v54
    v_rcp_f32 v55, v55
    v_pk_mul_f32 v[40:41], v[48:49], v[40:41]
    v_pk_mul_f32 v[42:43], v[50:51], v[42:43]
    v_pk_mul_f32 v[44:45], v[52:53], v[44:45]
    v_pk_mul_f32 v[46:47], v[54:55], v[46:47]
    v_cvt_pk_bf16_f32 v56, v40, v41
    v_cvt_pk_bf16_f32 v57, v42, v43
    v_cvt_pk_bf16_f32 v58, v44, v45
    v_cvt_pk_bf16_f32 v59, v46, v47
    buffer_store_dwordx4 v[56:59], v252, s[4:7], s53 offen offset:0 sc1
    v_accvgpr_read_b32 v0, a72
    v_accvgpr_read_b32 v1, a73
    v_accvgpr_read_b32 v2, a74
    v_accvgpr_read_b32 v3, a75
    v_accvgpr_read_b32 v4, a76
    v_accvgpr_read_b32 v5, a77
    v_accvgpr_read_b32 v6, a78
    v_accvgpr_read_b32 v7, a79
    v_pk_mul_f32 v[8:9], v[0:1], v[0:1]
    v_pk_mul_f32 v[10:11], v[2:3], v[2:3]
    v_pk_mul_f32 v[12:13], v[4:5], v[4:5]
    v_pk_mul_f32 v[14:15], v[6:7], v[6:7]
    v_pk_fma_f32 v[8:9], v[8:9], v[242:243], v[240:241]
    v_pk_fma_f32 v[10:11], v[10:11], v[242:243], v[240:241]
    v_pk_fma_f32 v[12:13], v[12:13], v[242:243], v[240:241]
    v_pk_fma_f32 v[14:15], v[14:15], v[242:243], v[240:241]
    v_pk_mul_f32 v[8:9], v[8:9], v[0:1]
    v_pk_mul_f32 v[10:11], v[10:11], v[2:3]
    v_pk_mul_f32 v[12:13], v[12:13], v[4:5]
    v_pk_mul_f32 v[14:15], v[14:15], v[6:7]
    v_exp_f32 v8, v8
    v_exp_f32 v9, v9
    v_exp_f32 v10, v10
    v_exp_f32 v11, v11
    v_exp_f32 v12, v12
    v_exp_f32 v13, v13
    v_exp_f32 v14, v14
    v_exp_f32 v15, v15
    v_pk_add_f32 v[8:9], v[8:9], v[244:245]
    v_pk_add_f32 v[10:11], v[10:11], v[244:245]
    v_pk_add_f32 v[12:13], v[12:13], v[244:245]
    v_pk_add_f32 v[14:15], v[14:15], v[244:245]
    v_rcp_f32 v8, v8
    v_rcp_f32 v9, v9
    v_rcp_f32 v10, v10
    v_rcp_f32 v11, v11
    v_rcp_f32 v12, v12
    v_rcp_f32 v13, v13
    v_rcp_f32 v14, v14
    v_rcp_f32 v15, v15
    v_pk_mul_f32 v[0:1], v[8:9], v[0:1]
    v_pk_mul_f32 v[2:3], v[10:11], v[2:3]
    v_pk_mul_f32 v[4:5], v[12:13], v[4:5]
    v_pk_mul_f32 v[6:7], v[14:15], v[6:7]
    v_cvt_pk_bf16_f32 v16, v0, v1
    v_cvt_pk_bf16_f32 v17, v2, v3
    v_cvt_pk_bf16_f32 v18, v4, v5
    v_cvt_pk_bf16_f32 v19, v6, v7
    buffer_store_dwordx4 v[16:19], v252, s[4:7], s53 offen offset:1024 sc1
    v_accvgpr_read_b32 v20, a80
    v_accvgpr_read_b32 v21, a81
    v_accvgpr_read_b32 v22, a82
    v_accvgpr_read_b32 v23, a83
    v_accvgpr_read_b32 v24, a84
    v_accvgpr_read_b32 v25, a85
    v_accvgpr_read_b32 v26, a86
    v_accvgpr_read_b32 v27, a87
    v_pk_mul_f32 v[28:29], v[20:21], v[20:21]
    v_pk_mul_f32 v[30:31], v[22:23], v[22:23]
    v_pk_mul_f32 v[32:33], v[24:25], v[24:25]
    v_pk_mul_f32 v[34:35], v[26:27], v[26:27]
    v_pk_fma_f32 v[28:29], v[28:29], v[242:243], v[240:241]
    v_pk_fma_f32 v[30:31], v[30:31], v[242:243], v[240:241]
    v_pk_fma_f32 v[32:33], v[32:33], v[242:243], v[240:241]
    v_pk_fma_f32 v[34:35], v[34:35], v[242:243], v[240:241]
    v_pk_mul_f32 v[28:29], v[28:29], v[20:21]
    v_pk_mul_f32 v[30:31], v[30:31], v[22:23]
    v_pk_mul_f32 v[32:33], v[32:33], v[24:25]
    v_pk_mul_f32 v[34:35], v[34:35], v[26:27]
    v_exp_f32 v28, v28
    v_exp_f32 v29, v29
    v_exp_f32 v30, v30
    v_exp_f32 v31, v31
    v_exp_f32 v32, v32
    v_exp_f32 v33, v33
    v_exp_f32 v34, v34
    v_exp_f32 v35, v35
    v_pk_add_f32 v[28:29], v[28:29], v[244:245]
    v_pk_add_f32 v[30:31], v[30:31], v[244:245]
    v_pk_add_f32 v[32:33], v[32:33], v[244:245]
    v_pk_add_f32 v[34:35], v[34:35], v[244:245]
    v_rcp_f32 v28, v28
    v_rcp_f32 v29, v29
    v_rcp_f32 v30, v30
    v_rcp_f32 v31, v31
    v_rcp_f32 v32, v32
    v_rcp_f32 v33, v33
    v_rcp_f32 v34, v34
    v_rcp_f32 v35, v35
    v_pk_mul_f32 v[20:21], v[28:29], v[20:21]
    v_pk_mul_f32 v[22:23], v[30:31], v[22:23]
    v_pk_mul_f32 v[24:25], v[32:33], v[24:25]
    v_pk_mul_f32 v[26:27], v[34:35], v[26:27]
    v_cvt_pk_bf16_f32 v36, v20, v21
    v_cvt_pk_bf16_f32 v37, v22, v23
    v_cvt_pk_bf16_f32 v38, v24, v25
    v_cvt_pk_bf16_f32 v39, v26, v27
    buffer_store_dwordx4 v[36:39], v252, s[4:7], s53 offen offset:2048 sc1
    v_accvgpr_read_b32 v40, a88
    v_accvgpr_read_b32 v41, a89
    v_accvgpr_read_b32 v42, a90
    v_accvgpr_read_b32 v43, a91
    v_accvgpr_read_b32 v44, a92
    v_accvgpr_read_b32 v45, a93
    v_accvgpr_read_b32 v46, a94
    v_accvgpr_read_b32 v47, a95
    v_pk_mul_f32 v[48:49], v[40:41], v[40:41]
    v_pk_mul_f32 v[50:51], v[42:43], v[42:43]
    v_pk_mul_f32 v[52:53], v[44:45], v[44:45]
    v_pk_mul_f32 v[54:55], v[46:47], v[46:47]
    v_pk_fma_f32 v[48:49], v[48:49], v[242:243], v[240:241]
    v_pk_fma_f32 v[50:51], v[50:51], v[242:243], v[240:241]
    v_pk_fma_f32 v[52:53], v[52:53], v[242:243], v[240:241]
    v_pk_fma_f32 v[54:55], v[54:55], v[242:243], v[240:241]
    v_pk_mul_f32 v[48:49], v[48:49], v[40:41]
    v_pk_mul_f32 v[50:51], v[50:51], v[42:43]
    v_pk_mul_f32 v[52:53], v[52:53], v[44:45]
    v_pk_mul_f32 v[54:55], v[54:55], v[46:47]
    v_exp_f32 v48, v48
    v_exp_f32 v49, v49
    v_exp_f32 v50, v50
    v_exp_f32 v51, v51
    v_exp_f32 v52, v52
    v_exp_f32 v53, v53
    v_exp_f32 v54, v54
    v_exp_f32 v55, v55
    v_pk_add_f32 v[48:49], v[48:49], v[244:245]
    v_pk_add_f32 v[50:51], v[50:51], v[244:245]
    v_pk_add_f32 v[52:53], v[52:53], v[244:245]
    v_pk_add_f32 v[54:55], v[54:55], v[244:245]
    v_rcp_f32 v48, v48
    v_rcp_f32 v49, v49
    v_rcp_f32 v50, v50
    v_rcp_f32 v51, v51
    v_rcp_f32 v52, v52
    v_rcp_f32 v53, v53
    v_rcp_f32 v54, v54
    v_rcp_f32 v55, v55
    v_pk_mul_f32 v[40:41], v[48:49], v[40:41]
    v_pk_mul_f32 v[42:43], v[50:51], v[42:43]
    v_pk_mul_f32 v[44:45], v[52:53], v[44:45]
    v_pk_mul_f32 v[46:47], v[54:55], v[46:47]
    v_cvt_pk_bf16_f32 v56, v40, v41
    v_cvt_pk_bf16_f32 v57, v42, v43
    v_cvt_pk_bf16_f32 v58, v44, v45
    v_cvt_pk_bf16_f32 v59, v46, v47
    buffer_store_dwordx4 v[56:59], v252, s[4:7], s53 offen offset:3072 sc1
    s_add_u32 s53, s53, s22
    v_accvgpr_read_b32 v0, a96
    v_accvgpr_read_b32 v1, a97
    v_accvgpr_read_b32 v2, a98
    v_accvgpr_read_b32 v3, a99
    v_accvgpr_read_b32 v4, a100
    v_accvgpr_read_b32 v5, a101
    v_accvgpr_read_b32 v6, a102
    v_accvgpr_read_b32 v7, a103
    v_pk_mul_f32 v[8:9], v[0:1], v[0:1]
    v_pk_mul_f32 v[10:11], v[2:3], v[2:3]
    v_pk_mul_f32 v[12:13], v[4:5], v[4:5]
    v_pk_mul_f32 v[14:15], v[6:7], v[6:7]
    v_pk_fma_f32 v[8:9], v[8:9], v[242:243], v[240:241]
    v_pk_fma_f32 v[10:11], v[10:11], v[242:243], v[240:241]
    v_pk_fma_f32 v[12:13], v[12:13], v[242:243], v[240:241]
    v_pk_fma_f32 v[14:15], v[14:15], v[242:243], v[240:241]
    v_pk_mul_f32 v[8:9], v[8:9], v[0:1]
    v_pk_mul_f32 v[10:11], v[10:11], v[2:3]
    v_pk_mul_f32 v[12:13], v[12:13], v[4:5]
    v_pk_mul_f32 v[14:15], v[14:15], v[6:7]
    v_exp_f32 v8, v8
    v_exp_f32 v9, v9
    v_exp_f32 v10, v10
    v_exp_f32 v11, v11
    v_exp_f32 v12, v12
    v_exp_f32 v13, v13
    v_exp_f32 v14, v14
    v_exp_f32 v15, v15
    v_pk_add_f32 v[8:9], v[8:9], v[244:245]
    v_pk_add_f32 v[10:11], v[10:11], v[244:245]
    v_pk_add_f32 v[12:13], v[12:13], v[244:245]
    v_pk_add_f32 v[14:15], v[14:15], v[244:245]
    v_rcp_f32 v8, v8
    v_rcp_f32 v9, v9
    v_rcp_f32 v10, v10
    v_rcp_f32 v11, v11
    v_rcp_f32 v12, v12
    v_rcp_f32 v13, v13
    v_rcp_f32 v14, v14
    v_rcp_f32 v15, v15
    v_pk_mul_f32 v[0:1], v[8:9], v[0:1]
    v_pk_mul_f32 v[2:3], v[10:11], v[2:3]
    v_pk_mul_f32 v[4:5], v[12:13], v[4:5]
    v_pk_mul_f32 v[6:7], v[14:15], v[6:7]
    v_cvt_pk_bf16_f32 v16, v0, v1
    v_cvt_pk_bf16_f32 v17, v2, v3
    v_cvt_pk_bf16_f32 v18, v4, v5
    v_cvt_pk_bf16_f32 v19, v6, v7
    buffer_store_dwordx4 v[16:19], v252, s[4:7], s53 offen offset:0 sc1
    v_accvgpr_read_b32 v20, a104
    v_accvgpr_read_b32 v21, a105
    v_accvgpr_read_b32 v22, a106
    v_accvgpr_read_b32 v23, a107
    v_accvgpr_read_b32 v24, a108
    v_accvgpr_read_b32 v25, a109
    v_accvgpr_read_b32 v26, a110
    v_accvgpr_read_b32 v27, a111
    v_pk_mul_f32 v[28:29], v[20:21], v[20:21]
    v_pk_mul_f32 v[30:31], v[22:23], v[22:23]
    v_pk_mul_f32 v[32:33], v[24:25], v[24:25]
    v_pk_mul_f32 v[34:35], v[26:27], v[26:27]
    v_pk_fma_f32 v[28:29], v[28:29], v[242:243], v[240:241]
    v_pk_fma_f32 v[30:31], v[30:31], v[242:243], v[240:241]
    v_pk_fma_f32 v[32:33], v[32:33], v[242:243], v[240:241]
    v_pk_fma_f32 v[34:35], v[34:35], v[242:243], v[240:241]
    v_pk_mul_f32 v[28:29], v[28:29], v[20:21]
    v_pk_mul_f32 v[30:31], v[30:31], v[22:23]
    v_pk_mul_f32 v[32:33], v[32:33], v[24:25]
    v_pk_mul_f32 v[34:35], v[34:35], v[26:27]
    v_exp_f32 v28, v28
    v_exp_f32 v29, v29
    v_exp_f32 v30, v30
    v_exp_f32 v31, v31
    v_exp_f32 v32, v32
    v_exp_f32 v33, v33
    v_exp_f32 v34, v34
    v_exp_f32 v35, v35
    v_pk_add_f32 v[28:29], v[28:29], v[244:245]
    v_pk_add_f32 v[30:31], v[30:31], v[244:245]
    v_pk_add_f32 v[32:33], v[32:33], v[244:245]
    v_pk_add_f32 v[34:35], v[34:35], v[244:245]
    v_rcp_f32 v28, v28
    v_rcp_f32 v29, v29
    v_rcp_f32 v30, v30
    v_rcp_f32 v31, v31
    v_rcp_f32 v32, v32
    v_rcp_f32 v33, v33
    v_rcp_f32 v34, v34
    v_rcp_f32 v35, v35
    v_pk_mul_f32 v[20:21], v[28:29], v[20:21]
    v_pk_mul_f32 v[22:23], v[30:31], v[22:23]
    v_pk_mul_f32 v[24:25], v[32:33], v[24:25]
    v_pk_mul_f32 v[26:27], v[34:35], v[26:27]
    v_cvt_pk_bf16_f32 v36, v20, v21
    v_cvt_pk_bf16_f32 v37, v22, v23
    v_cvt_pk_bf16_f32 v38, v24, v25
    v_cvt_pk_bf16_f32 v39, v26, v27
    buffer_store_dwordx4 v[36:39], v252, s[4:7], s53 offen offset:1024 sc1
    v_accvgpr_read_b32 v40, a112
    v_accvgpr_read_b32 v41, a113
    v_accvgpr_read_b32 v42, a114
    v_accvgpr_read_b32 v43, a115
    v_accvgpr_read_b32 v44, a116
    v_accvgpr_read_b32 v45, a117
    v_accvgpr_read_b32 v46, a118
    v_accvgpr_read_b32 v47, a119
    v_pk_mul_f32 v[48:49], v[40:41], v[40:41]
    v_pk_mul_f32 v[50:51], v[42:43], v[42:43]
    v_pk_mul_f32 v[52:53], v[44:45], v[44:45]
    v_pk_mul_f32 v[54:55], v[46:47], v[46:47]
    v_pk_fma_f32 v[48:49], v[48:49], v[242:243], v[240:241]
    v_pk_fma_f32 v[50:51], v[50:51], v[242:243], v[240:241]
    v_pk_fma_f32 v[52:53], v[52:53], v[242:243], v[240:241]
    v_pk_fma_f32 v[54:55], v[54:55], v[242:243], v[240:241]
    v_pk_mul_f32 v[48:49], v[48:49], v[40:41]
    v_pk_mul_f32 v[50:51], v[50:51], v[42:43]
    v_pk_mul_f32 v[52:53], v[52:53], v[44:45]
    v_pk_mul_f32 v[54:55], v[54:55], v[46:47]
    v_exp_f32 v48, v48
    v_exp_f32 v49, v49
    v_exp_f32 v50, v50
    v_exp_f32 v51, v51
    v_exp_f32 v52, v52
    v_exp_f32 v53, v53
    v_exp_f32 v54, v54
    v_exp_f32 v55, v55
    v_pk_add_f32 v[48:49], v[48:49], v[244:245]
    v_pk_add_f32 v[50:51], v[50:51], v[244:245]
    v_pk_add_f32 v[52:53], v[52:53], v[244:245]
    v_pk_add_f32 v[54:55], v[54:55], v[244:245]
    v_rcp_f32 v48, v48
    v_rcp_f32 v49, v49
    v_rcp_f32 v50, v50
    v_rcp_f32 v51, v51
    v_rcp_f32 v52, v52
    v_rcp_f32 v53, v53
    v_rcp_f32 v54, v54
    v_rcp_f32 v55, v55
    v_pk_mul_f32 v[40:41], v[48:49], v[40:41]
    v_pk_mul_f32 v[42:43], v[50:51], v[42:43]
    v_pk_mul_f32 v[44:45], v[52:53], v[44:45]
    v_pk_mul_f32 v[46:47], v[54:55], v[46:47]
    v_cvt_pk_bf16_f32 v56, v40, v41
    v_cvt_pk_bf16_f32 v57, v42, v43
    v_cvt_pk_bf16_f32 v58, v44, v45
    v_cvt_pk_bf16_f32 v59, v46, v47
    buffer_store_dwordx4 v[56:59], v252, s[4:7], s53 offen offset:2048 sc1
    v_accvgpr_read_b32 v0, a120
    v_accvgpr_read_b32 v1, a121
    v_accvgpr_read_b32 v2, a122
    v_accvgpr_read_b32 v3, a123
    v_accvgpr_read_b32 v4, a124
    v_accvgpr_read_b32 v5, a125
    v_accvgpr_read_b32 v6, a126
    v_accvgpr_read_b32 v7, a127
    v_pk_mul_f32 v[8:9], v[0:1], v[0:1]
    v_pk_mul_f32 v[10:11], v[2:3], v[2:3]
    v_pk_mul_f32 v[12:13], v[4:5], v[4:5]
    v_pk_mul_f32 v[14:15], v[6:7], v[6:7]
    v_pk_fma_f32 v[8:9], v[8:9], v[242:243], v[240:241]
    v_pk_fma_f32 v[10:11], v[10:11], v[242:243], v[240:241]
    v_pk_fma_f32 v[12:13], v[12:13], v[242:243], v[240:241]
    v_pk_fma_f32 v[14:15], v[14:15], v[242:243], v[240:241]
    v_pk_mul_f32 v[8:9], v[8:9], v[0:1]
    v_pk_mul_f32 v[10:11], v[10:11], v[2:3]
    v_pk_mul_f32 v[12:13], v[12:13], v[4:5]
    v_pk_mul_f32 v[14:15], v[14:15], v[6:7]
    v_exp_f32 v8, v8
    v_exp_f32 v9, v9
    v_exp_f32 v10, v10
    v_exp_f32 v11, v11
    v_exp_f32 v12, v12
    v_exp_f32 v13, v13
    v_exp_f32 v14, v14
    v_exp_f32 v15, v15
    v_pk_add_f32 v[8:9], v[8:9], v[244:245]
    v_pk_add_f32 v[10:11], v[10:11], v[244:245]
    v_pk_add_f32 v[12:13], v[12:13], v[244:245]
    v_pk_add_f32 v[14:15], v[14:15], v[244:245]
    v_rcp_f32 v8, v8
    v_rcp_f32 v9, v9
    v_rcp_f32 v10, v10
    v_rcp_f32 v11, v11
    v_rcp_f32 v12, v12
    v_rcp_f32 v13, v13
    v_rcp_f32 v14, v14
    v_rcp_f32 v15, v15
    v_pk_mul_f32 v[0:1], v[8:9], v[0:1]
    v_pk_mul_f32 v[2:3], v[10:11], v[2:3]
    v_pk_mul_f32 v[4:5], v[12:13], v[4:5]
    v_pk_mul_f32 v[6:7], v[14:15], v[6:7]
    v_cvt_pk_bf16_f32 v16, v0, v1
    v_cvt_pk_bf16_f32 v17, v2, v3
    v_cvt_pk_bf16_f32 v18, v4, v5
    v_cvt_pk_bf16_f32 v19, v6, v7
    buffer_store_dwordx4 v[16:19], v252, s[4:7], s53 offen offset:3072 sc1
    s_branch main_kernel_w_done
main_kernel_w_c1_egelu:
    s_mov_b32 s53, s21
    v_accvgpr_read_b32 v0, a0
    v_accvgpr_read_b32 v1, a1
    v_accvgpr_read_b32 v2, a2
    v_accvgpr_read_b32 v3, a3
    v_accvgpr_read_b32 v4, a4
    v_accvgpr_read_b32 v5, a5
    v_accvgpr_read_b32 v6, a6
    v_accvgpr_read_b32 v7, a7
    v_pk_mul_f32 v[8:9], v[0:1], v[0:1]
    v_pk_mul_f32 v[10:11], v[2:3], v[2:3]
    v_pk_mul_f32 v[12:13], v[4:5], v[4:5]
    v_pk_mul_f32 v[14:15], v[6:7], v[6:7]
    v_pk_fma_f32 v[8:9], v[8:9], v[242:243], v[240:241]
    v_pk_fma_f32 v[10:11], v[10:11], v[242:243], v[240:241]
    v_pk_fma_f32 v[12:13], v[12:13], v[242:243], v[240:241]
    v_pk_fma_f32 v[14:15], v[14:15], v[242:243], v[240:241]
    v_pk_mul_f32 v[8:9], v[8:9], v[0:1]
    v_pk_mul_f32 v[10:11], v[10:11], v[2:3]
    v_pk_mul_f32 v[12:13], v[12:13], v[4:5]
    v_pk_mul_f32 v[14:15], v[14:15], v[6:7]
    v_exp_f32 v8, v8
    v_exp_f32 v9, v9
    v_exp_f32 v10, v10
    v_exp_f32 v11, v11
    v_exp_f32 v12, v12
    v_exp_f32 v13, v13
    v_exp_f32 v14, v14
    v_exp_f32 v15, v15
    v_pk_add_f32 v[8:9], v[8:9], v[244:245]
    v_pk_add_f32 v[10:11], v[10:11], v[244:245]
    v_pk_add_f32 v[12:13], v[12:13], v[244:245]
    v_pk_add_f32 v[14:15], v[14:15], v[244:245]
    v_rcp_f32 v8, v8
    v_rcp_f32 v9, v9
    v_rcp_f32 v10, v10
    v_rcp_f32 v11, v11
    v_rcp_f32 v12, v12
    v_rcp_f32 v13, v13
    v_rcp_f32 v14, v14
    v_rcp_f32 v15, v15
    v_pk_mul_f32 v[0:1], v[8:9], v[0:1]
    v_pk_mul_f32 v[2:3], v[10:11], v[2:3]
    v_pk_mul_f32 v[4:5], v[12:13], v[4:5]
    v_pk_mul_f32 v[6:7], v[14:15], v[6:7]
    v_cvt_pk_bf16_f32 v16, v0, v1
    v_cvt_pk_bf16_f32 v17, v2, v3
    v_cvt_pk_bf16_f32 v18, v4, v5
    v_cvt_pk_bf16_f32 v19, v6, v7
    buffer_store_dwordx4 v[16:19], v251, s[4:7], s53 offen offset:0 sc1
    v_accvgpr_read_b32 v20, a8
    v_accvgpr_read_b32 v21, a9
    v_accvgpr_read_b32 v22, a10
    v_accvgpr_read_b32 v23, a11
    v_accvgpr_read_b32 v24, a12
    v_accvgpr_read_b32 v25, a13
    v_accvgpr_read_b32 v26, a14
    v_accvgpr_read_b32 v27, a15
    v_pk_mul_f32 v[28:29], v[20:21], v[20:21]
    v_pk_mul_f32 v[30:31], v[22:23], v[22:23]
    v_pk_mul_f32 v[32:33], v[24:25], v[24:25]
    v_pk_mul_f32 v[34:35], v[26:27], v[26:27]
    v_pk_fma_f32 v[28:29], v[28:29], v[242:243], v[240:241]
    v_pk_fma_f32 v[30:31], v[30:31], v[242:243], v[240:241]
    v_pk_fma_f32 v[32:33], v[32:33], v[242:243], v[240:241]
    v_pk_fma_f32 v[34:35], v[34:35], v[242:243], v[240:241]
    v_pk_mul_f32 v[28:29], v[28:29], v[20:21]
    v_pk_mul_f32 v[30:31], v[30:31], v[22:23]
    v_pk_mul_f32 v[32:33], v[32:33], v[24:25]
    v_pk_mul_f32 v[34:35], v[34:35], v[26:27]
    v_exp_f32 v28, v28
    v_exp_f32 v29, v29
    v_exp_f32 v30, v30
    v_exp_f32 v31, v31
    v_exp_f32 v32, v32
    v_exp_f32 v33, v33
    v_exp_f32 v34, v34
    v_exp_f32 v35, v35
    v_pk_add_f32 v[28:29], v[28:29], v[244:245]
    v_pk_add_f32 v[30:31], v[30:31], v[244:245]
    v_pk_add_f32 v[32:33], v[32:33], v[244:245]
    v_pk_add_f32 v[34:35], v[34:35], v[244:245]
    v_rcp_f32 v28, v28
    v_rcp_f32 v29, v29
    v_rcp_f32 v30, v30
    v_rcp_f32 v31, v31
    v_rcp_f32 v32, v32
    v_rcp_f32 v33, v33
    v_rcp_f32 v34, v34
    v_rcp_f32 v35, v35
    v_pk_mul_f32 v[20:21], v[28:29], v[20:21]
    v_pk_mul_f32 v[22:23], v[30:31], v[22:23]
    v_pk_mul_f32 v[24:25], v[32:33], v[24:25]
    v_pk_mul_f32 v[26:27], v[34:35], v[26:27]
    v_cvt_pk_bf16_f32 v36, v20, v21
    v_cvt_pk_bf16_f32 v37, v22, v23
    v_cvt_pk_bf16_f32 v38, v24, v25
    v_cvt_pk_bf16_f32 v39, v26, v27
    buffer_store_dwordx4 v[36:39], v251, s[4:7], s53 offen offset:1024 sc1
    v_accvgpr_read_b32 v40, a16
    v_accvgpr_read_b32 v41, a17
    v_accvgpr_read_b32 v42, a18
    v_accvgpr_read_b32 v43, a19
    v_accvgpr_read_b32 v44, a20
    v_accvgpr_read_b32 v45, a21
    v_accvgpr_read_b32 v46, a22
    v_accvgpr_read_b32 v47, a23
    v_pk_mul_f32 v[48:49], v[40:41], v[40:41]
    v_pk_mul_f32 v[50:51], v[42:43], v[42:43]
    v_pk_mul_f32 v[52:53], v[44:45], v[44:45]
    v_pk_mul_f32 v[54:55], v[46:47], v[46:47]
    v_pk_fma_f32 v[48:49], v[48:49], v[242:243], v[240:241]
    v_pk_fma_f32 v[50:51], v[50:51], v[242:243], v[240:241]
    v_pk_fma_f32 v[52:53], v[52:53], v[242:243], v[240:241]
    v_pk_fma_f32 v[54:55], v[54:55], v[242:243], v[240:241]
    v_pk_mul_f32 v[48:49], v[48:49], v[40:41]
    v_pk_mul_f32 v[50:51], v[50:51], v[42:43]
    v_pk_mul_f32 v[52:53], v[52:53], v[44:45]
    v_pk_mul_f32 v[54:55], v[54:55], v[46:47]
    v_exp_f32 v48, v48
    v_exp_f32 v49, v49
    v_exp_f32 v50, v50
    v_exp_f32 v51, v51
    v_exp_f32 v52, v52
    v_exp_f32 v53, v53
    v_exp_f32 v54, v54
    v_exp_f32 v55, v55
    v_pk_add_f32 v[48:49], v[48:49], v[244:245]
    v_pk_add_f32 v[50:51], v[50:51], v[244:245]
    v_pk_add_f32 v[52:53], v[52:53], v[244:245]
    v_pk_add_f32 v[54:55], v[54:55], v[244:245]
    v_rcp_f32 v48, v48
    v_rcp_f32 v49, v49
    v_rcp_f32 v50, v50
    v_rcp_f32 v51, v51
    v_rcp_f32 v52, v52
    v_rcp_f32 v53, v53
    v_rcp_f32 v54, v54
    v_rcp_f32 v55, v55
    v_pk_mul_f32 v[40:41], v[48:49], v[40:41]
    v_pk_mul_f32 v[42:43], v[50:51], v[42:43]
    v_pk_mul_f32 v[44:45], v[52:53], v[44:45]
    v_pk_mul_f32 v[46:47], v[54:55], v[46:47]
    v_cvt_pk_bf16_f32 v56, v40, v41
    v_cvt_pk_bf16_f32 v57, v42, v43
    v_cvt_pk_bf16_f32 v58, v44, v45
    v_cvt_pk_bf16_f32 v59, v46, v47
    buffer_store_dwordx4 v[56:59], v251, s[4:7], s53 offen offset:2048 sc1
    v_accvgpr_read_b32 v0, a24
    v_accvgpr_read_b32 v1, a25
    v_accvgpr_read_b32 v2, a26
    v_accvgpr_read_b32 v3, a27
    v_accvgpr_read_b32 v4, a28
    v_accvgpr_read_b32 v5, a29
    v_accvgpr_read_b32 v6, a30
    v_accvgpr_read_b32 v7, a31
    v_pk_mul_f32 v[8:9], v[0:1], v[0:1]
    v_pk_mul_f32 v[10:11], v[2:3], v[2:3]
    v_pk_mul_f32 v[12:13], v[4:5], v[4:5]
    v_pk_mul_f32 v[14:15], v[6:7], v[6:7]
    v_pk_fma_f32 v[8:9], v[8:9], v[242:243], v[240:241]
    v_pk_fma_f32 v[10:11], v[10:11], v[242:243], v[240:241]
    v_pk_fma_f32 v[12:13], v[12:13], v[242:243], v[240:241]
    v_pk_fma_f32 v[14:15], v[14:15], v[242:243], v[240:241]
    v_pk_mul_f32 v[8:9], v[8:9], v[0:1]
    v_pk_mul_f32 v[10:11], v[10:11], v[2:3]
    v_pk_mul_f32 v[12:13], v[12:13], v[4:5]
    v_pk_mul_f32 v[14:15], v[14:15], v[6:7]
    v_exp_f32 v8, v8
    v_exp_f32 v9, v9
    v_exp_f32 v10, v10
    v_exp_f32 v11, v11
    v_exp_f32 v12, v12
    v_exp_f32 v13, v13
    v_exp_f32 v14, v14
    v_exp_f32 v15, v15
    v_pk_add_f32 v[8:9], v[8:9], v[244:245]
    v_pk_add_f32 v[10:11], v[10:11], v[244:245]
    v_pk_add_f32 v[12:13], v[12:13], v[244:245]
    v_pk_add_f32 v[14:15], v[14:15], v[244:245]
    v_rcp_f32 v8, v8
    v_rcp_f32 v9, v9
    v_rcp_f32 v10, v10
    v_rcp_f32 v11, v11
    v_rcp_f32 v12, v12
    v_rcp_f32 v13, v13
    v_rcp_f32 v14, v14
    v_rcp_f32 v15, v15
    v_pk_mul_f32 v[0:1], v[8:9], v[0:1]
    v_pk_mul_f32 v[2:3], v[10:11], v[2:3]
    v_pk_mul_f32 v[4:5], v[12:13], v[4:5]
    v_pk_mul_f32 v[6:7], v[14:15], v[6:7]
    v_cvt_pk_bf16_f32 v16, v0, v1
    v_cvt_pk_bf16_f32 v17, v2, v3
    v_cvt_pk_bf16_f32 v18, v4, v5
    v_cvt_pk_bf16_f32 v19, v6, v7
    buffer_store_dwordx4 v[16:19], v251, s[4:7], s53 offen offset:3072 sc1
    s_add_u32 s53, s53, s22
    v_accvgpr_read_b32 v20, a32
    v_accvgpr_read_b32 v21, a33
    v_accvgpr_read_b32 v22, a34
    v_accvgpr_read_b32 v23, a35
    v_accvgpr_read_b32 v24, a36
    v_accvgpr_read_b32 v25, a37
    v_accvgpr_read_b32 v26, a38
    v_accvgpr_read_b32 v27, a39
    v_pk_mul_f32 v[28:29], v[20:21], v[20:21]
    v_pk_mul_f32 v[30:31], v[22:23], v[22:23]
    v_pk_mul_f32 v[32:33], v[24:25], v[24:25]
    v_pk_mul_f32 v[34:35], v[26:27], v[26:27]
    v_pk_fma_f32 v[28:29], v[28:29], v[242:243], v[240:241]
    v_pk_fma_f32 v[30:31], v[30:31], v[242:243], v[240:241]
    v_pk_fma_f32 v[32:33], v[32:33], v[242:243], v[240:241]
    v_pk_fma_f32 v[34:35], v[34:35], v[242:243], v[240:241]
    v_pk_mul_f32 v[28:29], v[28:29], v[20:21]
    v_pk_mul_f32 v[30:31], v[30:31], v[22:23]
    v_pk_mul_f32 v[32:33], v[32:33], v[24:25]
    v_pk_mul_f32 v[34:35], v[34:35], v[26:27]
    v_exp_f32 v28, v28
    v_exp_f32 v29, v29
    v_exp_f32 v30, v30
    v_exp_f32 v31, v31
    v_exp_f32 v32, v32
    v_exp_f32 v33, v33
    v_exp_f32 v34, v34
    v_exp_f32 v35, v35
    v_pk_add_f32 v[28:29], v[28:29], v[244:245]
    v_pk_add_f32 v[30:31], v[30:31], v[244:245]
    v_pk_add_f32 v[32:33], v[32:33], v[244:245]
    v_pk_add_f32 v[34:35], v[34:35], v[244:245]
    v_rcp_f32 v28, v28
    v_rcp_f32 v29, v29
    v_rcp_f32 v30, v30
    v_rcp_f32 v31, v31
    v_rcp_f32 v32, v32
    v_rcp_f32 v33, v33
    v_rcp_f32 v34, v34
    v_rcp_f32 v35, v35
    v_pk_mul_f32 v[20:21], v[28:29], v[20:21]
    v_pk_mul_f32 v[22:23], v[30:31], v[22:23]
    v_pk_mul_f32 v[24:25], v[32:33], v[24:25]
    v_pk_mul_f32 v[26:27], v[34:35], v[26:27]
    v_cvt_pk_bf16_f32 v36, v20, v21
    v_cvt_pk_bf16_f32 v37, v22, v23
    v_cvt_pk_bf16_f32 v38, v24, v25
    v_cvt_pk_bf16_f32 v39, v26, v27
    buffer_store_dwordx4 v[36:39], v251, s[4:7], s53 offen offset:0 sc1
    v_accvgpr_read_b32 v40, a40
    v_accvgpr_read_b32 v41, a41
    v_accvgpr_read_b32 v42, a42
    v_accvgpr_read_b32 v43, a43
    v_accvgpr_read_b32 v44, a44
    v_accvgpr_read_b32 v45, a45
    v_accvgpr_read_b32 v46, a46
    v_accvgpr_read_b32 v47, a47
    v_pk_mul_f32 v[48:49], v[40:41], v[40:41]
    v_pk_mul_f32 v[50:51], v[42:43], v[42:43]
    v_pk_mul_f32 v[52:53], v[44:45], v[44:45]
    v_pk_mul_f32 v[54:55], v[46:47], v[46:47]
    v_pk_fma_f32 v[48:49], v[48:49], v[242:243], v[240:241]
    v_pk_fma_f32 v[50:51], v[50:51], v[242:243], v[240:241]
    v_pk_fma_f32 v[52:53], v[52:53], v[242:243], v[240:241]
    v_pk_fma_f32 v[54:55], v[54:55], v[242:243], v[240:241]
    v_pk_mul_f32 v[48:49], v[48:49], v[40:41]
    v_pk_mul_f32 v[50:51], v[50:51], v[42:43]
    v_pk_mul_f32 v[52:53], v[52:53], v[44:45]
    v_pk_mul_f32 v[54:55], v[54:55], v[46:47]
    v_exp_f32 v48, v48
    v_exp_f32 v49, v49
    v_exp_f32 v50, v50
    v_exp_f32 v51, v51
    v_exp_f32 v52, v52
    v_exp_f32 v53, v53
    v_exp_f32 v54, v54
    v_exp_f32 v55, v55
    v_pk_add_f32 v[48:49], v[48:49], v[244:245]
    v_pk_add_f32 v[50:51], v[50:51], v[244:245]
    v_pk_add_f32 v[52:53], v[52:53], v[244:245]
    v_pk_add_f32 v[54:55], v[54:55], v[244:245]
    v_rcp_f32 v48, v48
    v_rcp_f32 v49, v49
    v_rcp_f32 v50, v50
    v_rcp_f32 v51, v51
    v_rcp_f32 v52, v52
    v_rcp_f32 v53, v53
    v_rcp_f32 v54, v54
    v_rcp_f32 v55, v55
    v_pk_mul_f32 v[40:41], v[48:49], v[40:41]
    v_pk_mul_f32 v[42:43], v[50:51], v[42:43]
    v_pk_mul_f32 v[44:45], v[52:53], v[44:45]
    v_pk_mul_f32 v[46:47], v[54:55], v[46:47]
    v_cvt_pk_bf16_f32 v56, v40, v41
    v_cvt_pk_bf16_f32 v57, v42, v43
    v_cvt_pk_bf16_f32 v58, v44, v45
    v_cvt_pk_bf16_f32 v59, v46, v47
    buffer_store_dwordx4 v[56:59], v251, s[4:7], s53 offen offset:1024 sc1
    v_accvgpr_read_b32 v0, a48
    v_accvgpr_read_b32 v1, a49
    v_accvgpr_read_b32 v2, a50
    v_accvgpr_read_b32 v3, a51
    v_accvgpr_read_b32 v4, a52
    v_accvgpr_read_b32 v5, a53
    v_accvgpr_read_b32 v6, a54
    v_accvgpr_read_b32 v7, a55
    v_pk_mul_f32 v[8:9], v[0:1], v[0:1]
    v_pk_mul_f32 v[10:11], v[2:3], v[2:3]
    v_pk_mul_f32 v[12:13], v[4:5], v[4:5]
    v_pk_mul_f32 v[14:15], v[6:7], v[6:7]
    v_pk_fma_f32 v[8:9], v[8:9], v[242:243], v[240:241]
    v_pk_fma_f32 v[10:11], v[10:11], v[242:243], v[240:241]
    v_pk_fma_f32 v[12:13], v[12:13], v[242:243], v[240:241]
    v_pk_fma_f32 v[14:15], v[14:15], v[242:243], v[240:241]
    v_pk_mul_f32 v[8:9], v[8:9], v[0:1]
    v_pk_mul_f32 v[10:11], v[10:11], v[2:3]
    v_pk_mul_f32 v[12:13], v[12:13], v[4:5]
    v_pk_mul_f32 v[14:15], v[14:15], v[6:7]
    v_exp_f32 v8, v8
    v_exp_f32 v9, v9
    v_exp_f32 v10, v10
    v_exp_f32 v11, v11
    v_exp_f32 v12, v12
    v_exp_f32 v13, v13
    v_exp_f32 v14, v14
    v_exp_f32 v15, v15
    v_pk_add_f32 v[8:9], v[8:9], v[244:245]
    v_pk_add_f32 v[10:11], v[10:11], v[244:245]
    v_pk_add_f32 v[12:13], v[12:13], v[244:245]
    v_pk_add_f32 v[14:15], v[14:15], v[244:245]
    v_rcp_f32 v8, v8
    v_rcp_f32 v9, v9
    v_rcp_f32 v10, v10
    v_rcp_f32 v11, v11
    v_rcp_f32 v12, v12
    v_rcp_f32 v13, v13
    v_rcp_f32 v14, v14
    v_rcp_f32 v15, v15
    v_pk_mul_f32 v[0:1], v[8:9], v[0:1]
    v_pk_mul_f32 v[2:3], v[10:11], v[2:3]
    v_pk_mul_f32 v[4:5], v[12:13], v[4:5]
    v_pk_mul_f32 v[6:7], v[14:15], v[6:7]
    v_cvt_pk_bf16_f32 v16, v0, v1
    v_cvt_pk_bf16_f32 v17, v2, v3
    v_cvt_pk_bf16_f32 v18, v4, v5
    v_cvt_pk_bf16_f32 v19, v6, v7
    buffer_store_dwordx4 v[16:19], v251, s[4:7], s53 offen offset:2048 sc1
    v_accvgpr_read_b32 v20, a56
    v_accvgpr_read_b32 v21, a57
    v_accvgpr_read_b32 v22, a58
    v_accvgpr_read_b32 v23, a59
    v_accvgpr_read_b32 v24, a60
    v_accvgpr_read_b32 v25, a61
    v_accvgpr_read_b32 v26, a62
    v_accvgpr_read_b32 v27, a63
    v_pk_mul_f32 v[28:29], v[20:21], v[20:21]
    v_pk_mul_f32 v[30:31], v[22:23], v[22:23]
    v_pk_mul_f32 v[32:33], v[24:25], v[24:25]
    v_pk_mul_f32 v[34:35], v[26:27], v[26:27]
    v_pk_fma_f32 v[28:29], v[28:29], v[242:243], v[240:241]
    v_pk_fma_f32 v[30:31], v[30:31], v[242:243], v[240:241]
    v_pk_fma_f32 v[32:33], v[32:33], v[242:243], v[240:241]
    v_pk_fma_f32 v[34:35], v[34:35], v[242:243], v[240:241]
    v_pk_mul_f32 v[28:29], v[28:29], v[20:21]
    v_pk_mul_f32 v[30:31], v[30:31], v[22:23]
    v_pk_mul_f32 v[32:33], v[32:33], v[24:25]
    v_pk_mul_f32 v[34:35], v[34:35], v[26:27]
    v_exp_f32 v28, v28
    v_exp_f32 v29, v29
    v_exp_f32 v30, v30
    v_exp_f32 v31, v31
    v_exp_f32 v32, v32
    v_exp_f32 v33, v33
    v_exp_f32 v34, v34
    v_exp_f32 v35, v35
    v_pk_add_f32 v[28:29], v[28:29], v[244:245]
    v_pk_add_f32 v[30:31], v[30:31], v[244:245]
    v_pk_add_f32 v[32:33], v[32:33], v[244:245]
    v_pk_add_f32 v[34:35], v[34:35], v[244:245]
    v_rcp_f32 v28, v28
    v_rcp_f32 v29, v29
    v_rcp_f32 v30, v30
    v_rcp_f32 v31, v31
    v_rcp_f32 v32, v32
    v_rcp_f32 v33, v33
    v_rcp_f32 v34, v34
    v_rcp_f32 v35, v35
    v_pk_mul_f32 v[20:21], v[28:29], v[20:21]
    v_pk_mul_f32 v[22:23], v[30:31], v[22:23]
    v_pk_mul_f32 v[24:25], v[32:33], v[24:25]
    v_pk_mul_f32 v[26:27], v[34:35], v[26:27]
    v_cvt_pk_bf16_f32 v36, v20, v21
    v_cvt_pk_bf16_f32 v37, v22, v23
    v_cvt_pk_bf16_f32 v38, v24, v25
    v_cvt_pk_bf16_f32 v39, v26, v27
    buffer_store_dwordx4 v[36:39], v251, s[4:7], s53 offen offset:3072 sc1
    s_add_u32 s53, s53, s22
    v_accvgpr_read_b32 v40, a64
    v_accvgpr_read_b32 v41, a65
    v_accvgpr_read_b32 v42, a66
    v_accvgpr_read_b32 v43, a67
    v_accvgpr_read_b32 v44, a68
    v_accvgpr_read_b32 v45, a69
    v_accvgpr_read_b32 v46, a70
    v_accvgpr_read_b32 v47, a71
    v_pk_mul_f32 v[48:49], v[40:41], v[40:41]
    v_pk_mul_f32 v[50:51], v[42:43], v[42:43]
    v_pk_mul_f32 v[52:53], v[44:45], v[44:45]
    v_pk_mul_f32 v[54:55], v[46:47], v[46:47]
    v_pk_fma_f32 v[48:49], v[48:49], v[242:243], v[240:241]
    v_pk_fma_f32 v[50:51], v[50:51], v[242:243], v[240:241]
    v_pk_fma_f32 v[52:53], v[52:53], v[242:243], v[240:241]
    v_pk_fma_f32 v[54:55], v[54:55], v[242:243], v[240:241]
    v_pk_mul_f32 v[48:49], v[48:49], v[40:41]
    v_pk_mul_f32 v[50:51], v[50:51], v[42:43]
    v_pk_mul_f32 v[52:53], v[52:53], v[44:45]
    v_pk_mul_f32 v[54:55], v[54:55], v[46:47]
    v_exp_f32 v48, v48
    v_exp_f32 v49, v49
    v_exp_f32 v50, v50
    v_exp_f32 v51, v51
    v_exp_f32 v52, v52
    v_exp_f32 v53, v53
    v_exp_f32 v54, v54
    v_exp_f32 v55, v55
    v_pk_add_f32 v[48:49], v[48:49], v[244:245]
    v_pk_add_f32 v[50:51], v[50:51], v[244:245]
    v_pk_add_f32 v[52:53], v[52:53], v[244:245]
    v_pk_add_f32 v[54:55], v[54:55], v[244:245]
    v_rcp_f32 v48, v48
    v_rcp_f32 v49, v49
    v_rcp_f32 v50, v50
    v_rcp_f32 v51, v51
    v_rcp_f32 v52, v52
    v_rcp_f32 v53, v53
    v_rcp_f32 v54, v54
    v_rcp_f32 v55, v55
    v_pk_mul_f32 v[40:41], v[48:49], v[40:41]
    v_pk_mul_f32 v[42:43], v[50:51], v[42:43]
    v_pk_mul_f32 v[44:45], v[52:53], v[44:45]
    v_pk_mul_f32 v[46:47], v[54:55], v[46:47]
    v_cvt_pk_bf16_f32 v56, v40, v41
    v_cvt_pk_bf16_f32 v57, v42, v43
    v_cvt_pk_bf16_f32 v58, v44, v45
    v_cvt_pk_bf16_f32 v59, v46, v47
    buffer_store_dwordx4 v[56:59], v251, s[4:7], s53 offen offset:0 sc1
    v_accvgpr_read_b32 v0, a72
    v_accvgpr_read_b32 v1, a73
    v_accvgpr_read_b32 v2, a74
    v_accvgpr_read_b32 v3, a75
    v_accvgpr_read_b32 v4, a76
    v_accvgpr_read_b32 v5, a77
    v_accvgpr_read_b32 v6, a78
    v_accvgpr_read_b32 v7, a79
    v_pk_mul_f32 v[8:9], v[0:1], v[0:1]
    v_pk_mul_f32 v[10:11], v[2:3], v[2:3]
    v_pk_mul_f32 v[12:13], v[4:5], v[4:5]
    v_pk_mul_f32 v[14:15], v[6:7], v[6:7]
    v_pk_fma_f32 v[8:9], v[8:9], v[242:243], v[240:241]
    v_pk_fma_f32 v[10:11], v[10:11], v[242:243], v[240:241]
    v_pk_fma_f32 v[12:13], v[12:13], v[242:243], v[240:241]
    v_pk_fma_f32 v[14:15], v[14:15], v[242:243], v[240:241]
    v_pk_mul_f32 v[8:9], v[8:9], v[0:1]
    v_pk_mul_f32 v[10:11], v[10:11], v[2:3]
    v_pk_mul_f32 v[12:13], v[12:13], v[4:5]
    v_pk_mul_f32 v[14:15], v[14:15], v[6:7]
    v_exp_f32 v8, v8
    v_exp_f32 v9, v9
    v_exp_f32 v10, v10
    v_exp_f32 v11, v11
    v_exp_f32 v12, v12
    v_exp_f32 v13, v13
    v_exp_f32 v14, v14
    v_exp_f32 v15, v15
    v_pk_add_f32 v[8:9], v[8:9], v[244:245]
    v_pk_add_f32 v[10:11], v[10:11], v[244:245]
    v_pk_add_f32 v[12:13], v[12:13], v[244:245]
    v_pk_add_f32 v[14:15], v[14:15], v[244:245]
    v_rcp_f32 v8, v8
    v_rcp_f32 v9, v9
    v_rcp_f32 v10, v10
    v_rcp_f32 v11, v11
    v_rcp_f32 v12, v12
    v_rcp_f32 v13, v13
    v_rcp_f32 v14, v14
    v_rcp_f32 v15, v15
    v_pk_mul_f32 v[0:1], v[8:9], v[0:1]
    v_pk_mul_f32 v[2:3], v[10:11], v[2:3]
    v_pk_mul_f32 v[4:5], v[12:13], v[4:5]
    v_pk_mul_f32 v[6:7], v[14:15], v[6:7]
    v_cvt_pk_bf16_f32 v16, v0, v1
    v_cvt_pk_bf16_f32 v17, v2, v3
    v_cvt_pk_bf16_f32 v18, v4, v5
    v_cvt_pk_bf16_f32 v19, v6, v7
    buffer_store_dwordx4 v[16:19], v251, s[4:7], s53 offen offset:1024 sc1
    v_accvgpr_read_b32 v20, a80
    v_accvgpr_read_b32 v21, a81
    v_accvgpr_read_b32 v22, a82
    v_accvgpr_read_b32 v23, a83
    v_accvgpr_read_b32 v24, a84
    v_accvgpr_read_b32 v25, a85
    v_accvgpr_read_b32 v26, a86
    v_accvgpr_read_b32 v27, a87
    v_pk_mul_f32 v[28:29], v[20:21], v[20:21]
    v_pk_mul_f32 v[30:31], v[22:23], v[22:23]
    v_pk_mul_f32 v[32:33], v[24:25], v[24:25]
    v_pk_mul_f32 v[34:35], v[26:27], v[26:27]
    v_pk_fma_f32 v[28:29], v[28:29], v[242:243], v[240:241]
    v_pk_fma_f32 v[30:31], v[30:31], v[242:243], v[240:241]
    v_pk_fma_f32 v[32:33], v[32:33], v[242:243], v[240:241]
    v_pk_fma_f32 v[34:35], v[34:35], v[242:243], v[240:241]
    v_pk_mul_f32 v[28:29], v[28:29], v[20:21]
    v_pk_mul_f32 v[30:31], v[30:31], v[22:23]
    v_pk_mul_f32 v[32:33], v[32:33], v[24:25]
    v_pk_mul_f32 v[34:35], v[34:35], v[26:27]
    v_exp_f32 v28, v28
    v_exp_f32 v29, v29
    v_exp_f32 v30, v30
    v_exp_f32 v31, v31
    v_exp_f32 v32, v32
    v_exp_f32 v33, v33
    v_exp_f32 v34, v34
    v_exp_f32 v35, v35
    v_pk_add_f32 v[28:29], v[28:29], v[244:245]
    v_pk_add_f32 v[30:31], v[30:31], v[244:245]
    v_pk_add_f32 v[32:33], v[32:33], v[244:245]
    v_pk_add_f32 v[34:35], v[34:35], v[244:245]
    v_rcp_f32 v28, v28
    v_rcp_f32 v29, v29
    v_rcp_f32 v30, v30
    v_rcp_f32 v31, v31
    v_rcp_f32 v32, v32
    v_rcp_f32 v33, v33
    v_rcp_f32 v34, v34
    v_rcp_f32 v35, v35
    v_pk_mul_f32 v[20:21], v[28:29], v[20:21]
    v_pk_mul_f32 v[22:23], v[30:31], v[22:23]
    v_pk_mul_f32 v[24:25], v[32:33], v[24:25]
    v_pk_mul_f32 v[26:27], v[34:35], v[26:27]
    v_cvt_pk_bf16_f32 v36, v20, v21
    v_cvt_pk_bf16_f32 v37, v22, v23
    v_cvt_pk_bf16_f32 v38, v24, v25
    v_cvt_pk_bf16_f32 v39, v26, v27
    buffer_store_dwordx4 v[36:39], v251, s[4:7], s53 offen offset:2048 sc1
    v_accvgpr_read_b32 v40, a88
    v_accvgpr_read_b32 v41, a89
    v_accvgpr_read_b32 v42, a90
    v_accvgpr_read_b32 v43, a91
    v_accvgpr_read_b32 v44, a92
    v_accvgpr_read_b32 v45, a93
    v_accvgpr_read_b32 v46, a94
    v_accvgpr_read_b32 v47, a95
    v_pk_mul_f32 v[48:49], v[40:41], v[40:41]
    v_pk_mul_f32 v[50:51], v[42:43], v[42:43]
    v_pk_mul_f32 v[52:53], v[44:45], v[44:45]
    v_pk_mul_f32 v[54:55], v[46:47], v[46:47]
    v_pk_fma_f32 v[48:49], v[48:49], v[242:243], v[240:241]
    v_pk_fma_f32 v[50:51], v[50:51], v[242:243], v[240:241]
    v_pk_fma_f32 v[52:53], v[52:53], v[242:243], v[240:241]
    v_pk_fma_f32 v[54:55], v[54:55], v[242:243], v[240:241]
    v_pk_mul_f32 v[48:49], v[48:49], v[40:41]
    v_pk_mul_f32 v[50:51], v[50:51], v[42:43]
    v_pk_mul_f32 v[52:53], v[52:53], v[44:45]
    v_pk_mul_f32 v[54:55], v[54:55], v[46:47]
    v_exp_f32 v48, v48
    v_exp_f32 v49, v49
    v_exp_f32 v50, v50
    v_exp_f32 v51, v51
    v_exp_f32 v52, v52
    v_exp_f32 v53, v53
    v_exp_f32 v54, v54
    v_exp_f32 v55, v55
    v_pk_add_f32 v[48:49], v[48:49], v[244:245]
    v_pk_add_f32 v[50:51], v[50:51], v[244:245]
    v_pk_add_f32 v[52:53], v[52:53], v[244:245]
    v_pk_add_f32 v[54:55], v[54:55], v[244:245]
    v_rcp_f32 v48, v48
    v_rcp_f32 v49, v49
    v_rcp_f32 v50, v50
    v_rcp_f32 v51, v51
    v_rcp_f32 v52, v52
    v_rcp_f32 v53, v53
    v_rcp_f32 v54, v54
    v_rcp_f32 v55, v55
    v_pk_mul_f32 v[40:41], v[48:49], v[40:41]
    v_pk_mul_f32 v[42:43], v[50:51], v[42:43]
    v_pk_mul_f32 v[44:45], v[52:53], v[44:45]
    v_pk_mul_f32 v[46:47], v[54:55], v[46:47]
    v_cvt_pk_bf16_f32 v56, v40, v41
    v_cvt_pk_bf16_f32 v57, v42, v43
    v_cvt_pk_bf16_f32 v58, v44, v45
    v_cvt_pk_bf16_f32 v59, v46, v47
    buffer_store_dwordx4 v[56:59], v251, s[4:7], s53 offen offset:3072 sc1
    s_add_u32 s53, s53, s22
    v_accvgpr_read_b32 v0, a96
    v_accvgpr_read_b32 v1, a97
    v_accvgpr_read_b32 v2, a98
    v_accvgpr_read_b32 v3, a99
    v_accvgpr_read_b32 v4, a100
    v_accvgpr_read_b32 v5, a101
    v_accvgpr_read_b32 v6, a102
    v_accvgpr_read_b32 v7, a103
    v_pk_mul_f32 v[8:9], v[0:1], v[0:1]
    v_pk_mul_f32 v[10:11], v[2:3], v[2:3]
    v_pk_mul_f32 v[12:13], v[4:5], v[4:5]
    v_pk_mul_f32 v[14:15], v[6:7], v[6:7]
    v_pk_fma_f32 v[8:9], v[8:9], v[242:243], v[240:241]
    v_pk_fma_f32 v[10:11], v[10:11], v[242:243], v[240:241]
    v_pk_fma_f32 v[12:13], v[12:13], v[242:243], v[240:241]
    v_pk_fma_f32 v[14:15], v[14:15], v[242:243], v[240:241]
    v_pk_mul_f32 v[8:9], v[8:9], v[0:1]
    v_pk_mul_f32 v[10:11], v[10:11], v[2:3]
    v_pk_mul_f32 v[12:13], v[12:13], v[4:5]
    v_pk_mul_f32 v[14:15], v[14:15], v[6:7]
    v_exp_f32 v8, v8
    v_exp_f32 v9, v9
    v_exp_f32 v10, v10
    v_exp_f32 v11, v11
    v_exp_f32 v12, v12
    v_exp_f32 v13, v13
    v_exp_f32 v14, v14
    v_exp_f32 v15, v15
    v_pk_add_f32 v[8:9], v[8:9], v[244:245]
    v_pk_add_f32 v[10:11], v[10:11], v[244:245]
    v_pk_add_f32 v[12:13], v[12:13], v[244:245]
    v_pk_add_f32 v[14:15], v[14:15], v[244:245]
    v_rcp_f32 v8, v8
    v_rcp_f32 v9, v9
    v_rcp_f32 v10, v10
    v_rcp_f32 v11, v11
    v_rcp_f32 v12, v12
    v_rcp_f32 v13, v13
    v_rcp_f32 v14, v14
    v_rcp_f32 v15, v15
    v_pk_mul_f32 v[0:1], v[8:9], v[0:1]
    v_pk_mul_f32 v[2:3], v[10:11], v[2:3]
    v_pk_mul_f32 v[4:5], v[12:13], v[4:5]
    v_pk_mul_f32 v[6:7], v[14:15], v[6:7]
    v_cvt_pk_bf16_f32 v16, v0, v1
    v_cvt_pk_bf16_f32 v17, v2, v3
    v_cvt_pk_bf16_f32 v18, v4, v5
    v_cvt_pk_bf16_f32 v19, v6, v7
    buffer_store_dwordx4 v[16:19], v251, s[4:7], s53 offen offset:0 sc1
    v_accvgpr_read_b32 v20, a104
    v_accvgpr_read_b32 v21, a105
    v_accvgpr_read_b32 v22, a106
    v_accvgpr_read_b32 v23, a107
    v_accvgpr_read_b32 v24, a108
    v_accvgpr_read_b32 v25, a109
    v_accvgpr_read_b32 v26, a110
    v_accvgpr_read_b32 v27, a111
    v_pk_mul_f32 v[28:29], v[20:21], v[20:21]
    v_pk_mul_f32 v[30:31], v[22:23], v[22:23]
    v_pk_mul_f32 v[32:33], v[24:25], v[24:25]
    v_pk_mul_f32 v[34:35], v[26:27], v[26:27]
    v_pk_fma_f32 v[28:29], v[28:29], v[242:243], v[240:241]
    v_pk_fma_f32 v[30:31], v[30:31], v[242:243], v[240:241]
    v_pk_fma_f32 v[32:33], v[32:33], v[242:243], v[240:241]
    v_pk_fma_f32 v[34:35], v[34:35], v[242:243], v[240:241]
    v_pk_mul_f32 v[28:29], v[28:29], v[20:21]
    v_pk_mul_f32 v[30:31], v[30:31], v[22:23]
    v_pk_mul_f32 v[32:33], v[32:33], v[24:25]
    v_pk_mul_f32 v[34:35], v[34:35], v[26:27]
    v_exp_f32 v28, v28
    v_exp_f32 v29, v29
    v_exp_f32 v30, v30
    v_exp_f32 v31, v31
    v_exp_f32 v32, v32
    v_exp_f32 v33, v33
    v_exp_f32 v34, v34
    v_exp_f32 v35, v35
    v_pk_add_f32 v[28:29], v[28:29], v[244:245]
    v_pk_add_f32 v[30:31], v[30:31], v[244:245]
    v_pk_add_f32 v[32:33], v[32:33], v[244:245]
    v_pk_add_f32 v[34:35], v[34:35], v[244:245]
    v_rcp_f32 v28, v28
    v_rcp_f32 v29, v29
    v_rcp_f32 v30, v30
    v_rcp_f32 v31, v31
    v_rcp_f32 v32, v32
    v_rcp_f32 v33, v33
    v_rcp_f32 v34, v34
    v_rcp_f32 v35, v35
    v_pk_mul_f32 v[20:21], v[28:29], v[20:21]
    v_pk_mul_f32 v[22:23], v[30:31], v[22:23]
    v_pk_mul_f32 v[24:25], v[32:33], v[24:25]
    v_pk_mul_f32 v[26:27], v[34:35], v[26:27]
    v_cvt_pk_bf16_f32 v36, v20, v21
    v_cvt_pk_bf16_f32 v37, v22, v23
    v_cvt_pk_bf16_f32 v38, v24, v25
    v_cvt_pk_bf16_f32 v39, v26, v27
    buffer_store_dwordx4 v[36:39], v251, s[4:7], s53 offen offset:1024 sc1
    v_accvgpr_read_b32 v40, a112
    v_accvgpr_read_b32 v41, a113
    v_accvgpr_read_b32 v42, a114
    v_accvgpr_read_b32 v43, a115
    v_accvgpr_read_b32 v44, a116
    v_accvgpr_read_b32 v45, a117
    v_accvgpr_read_b32 v46, a118
    v_accvgpr_read_b32 v47, a119
    v_pk_mul_f32 v[48:49], v[40:41], v[40:41]
    v_pk_mul_f32 v[50:51], v[42:43], v[42:43]
    v_pk_mul_f32 v[52:53], v[44:45], v[44:45]
    v_pk_mul_f32 v[54:55], v[46:47], v[46:47]
    v_pk_fma_f32 v[48:49], v[48:49], v[242:243], v[240:241]
    v_pk_fma_f32 v[50:51], v[50:51], v[242:243], v[240:241]
    v_pk_fma_f32 v[52:53], v[52:53], v[242:243], v[240:241]
    v_pk_fma_f32 v[54:55], v[54:55], v[242:243], v[240:241]
    v_pk_mul_f32 v[48:49], v[48:49], v[40:41]
    v_pk_mul_f32 v[50:51], v[50:51], v[42:43]
    v_pk_mul_f32 v[52:53], v[52:53], v[44:45]
    v_pk_mul_f32 v[54:55], v[54:55], v[46:47]
    v_exp_f32 v48, v48
    v_exp_f32 v49, v49
    v_exp_f32 v50, v50
    v_exp_f32 v51, v51
    v_exp_f32 v52, v52
    v_exp_f32 v53, v53
    v_exp_f32 v54, v54
    v_exp_f32 v55, v55
    v_pk_add_f32 v[48:49], v[48:49], v[244:245]
    v_pk_add_f32 v[50:51], v[50:51], v[244:245]
    v_pk_add_f32 v[52:53], v[52:53], v[244:245]
    v_pk_add_f32 v[54:55], v[54:55], v[244:245]
    v_rcp_f32 v48, v48
    v_rcp_f32 v49, v49
    v_rcp_f32 v50, v50
    v_rcp_f32 v51, v51
    v_rcp_f32 v52, v52
    v_rcp_f32 v53, v53
    v_rcp_f32 v54, v54
    v_rcp_f32 v55, v55
    v_pk_mul_f32 v[40:41], v[48:49], v[40:41]
    v_pk_mul_f32 v[42:43], v[50:51], v[42:43]
    v_pk_mul_f32 v[44:45], v[52:53], v[44:45]
    v_pk_mul_f32 v[46:47], v[54:55], v[46:47]
    v_cvt_pk_bf16_f32 v56, v40, v41
    v_cvt_pk_bf16_f32 v57, v42, v43
    v_cvt_pk_bf16_f32 v58, v44, v45
    v_cvt_pk_bf16_f32 v59, v46, v47
    buffer_store_dwordx4 v[56:59], v251, s[4:7], s53 offen offset:2048 sc1
    v_accvgpr_read_b32 v0, a120
    v_accvgpr_read_b32 v1, a121
    v_accvgpr_read_b32 v2, a122
    v_accvgpr_read_b32 v3, a123
    v_accvgpr_read_b32 v4, a124
    v_accvgpr_read_b32 v5, a125
    v_accvgpr_read_b32 v6, a126
    v_accvgpr_read_b32 v7, a127
    v_pk_mul_f32 v[8:9], v[0:1], v[0:1]
    v_pk_mul_f32 v[10:11], v[2:3], v[2:3]
    v_pk_mul_f32 v[12:13], v[4:5], v[4:5]
    v_pk_mul_f32 v[14:15], v[6:7], v[6:7]
    v_pk_fma_f32 v[8:9], v[8:9], v[242:243], v[240:241]
    v_pk_fma_f32 v[10:11], v[10:11], v[242:243], v[240:241]
    v_pk_fma_f32 v[12:13], v[12:13], v[242:243], v[240:241]
    v_pk_fma_f32 v[14:15], v[14:15], v[242:243], v[240:241]
    v_pk_mul_f32 v[8:9], v[8:9], v[0:1]
    v_pk_mul_f32 v[10:11], v[10:11], v[2:3]
    v_pk_mul_f32 v[12:13], v[12:13], v[4:5]
    v_pk_mul_f32 v[14:15], v[14:15], v[6:7]
    v_exp_f32 v8, v8
    v_exp_f32 v9, v9
    v_exp_f32 v10, v10
    v_exp_f32 v11, v11
    v_exp_f32 v12, v12
    v_exp_f32 v13, v13
    v_exp_f32 v14, v14
    v_exp_f32 v15, v15
    v_pk_add_f32 v[8:9], v[8:9], v[244:245]
    v_pk_add_f32 v[10:11], v[10:11], v[244:245]
    v_pk_add_f32 v[12:13], v[12:13], v[244:245]
    v_pk_add_f32 v[14:15], v[14:15], v[244:245]
    v_rcp_f32 v8, v8
    v_rcp_f32 v9, v9
    v_rcp_f32 v10, v10
    v_rcp_f32 v11, v11
    v_rcp_f32 v12, v12
    v_rcp_f32 v13, v13
    v_rcp_f32 v14, v14
    v_rcp_f32 v15, v15
    v_pk_mul_f32 v[0:1], v[8:9], v[0:1]
    v_pk_mul_f32 v[2:3], v[10:11], v[2:3]
    v_pk_mul_f32 v[4:5], v[12:13], v[4:5]
    v_pk_mul_f32 v[6:7], v[14:15], v[6:7]
    v_cvt_pk_bf16_f32 v16, v0, v1
    v_cvt_pk_bf16_f32 v17, v2, v3
    v_cvt_pk_bf16_f32 v18, v4, v5
    v_cvt_pk_bf16_f32 v19, v6, v7
    buffer_store_dwordx4 v[16:19], v251, s[4:7], s53 offen offset:3072 sc1
    s_branch main_kernel_w_done
main_kernel_w_c1_gov:
    v_lshrrev_b32 v0, 4, v250
    v_bfe_u32 v1, v250, 2, 2
    v_lshl_add_u32 v4, v0, 2, v1
    v_and_b32 v5, 7, v4
    v_mul_u32_u24 v4, 512, v4
    v_and_b32 v6, 3, v250
    v_lshl_add_u32 v4, v6, 3, v4
    s_mul_i32 s32, s37, 8
    v_xor_b32 v5, s32, v5
    v_lshl_add_u32 v128, v5, 5, v4
    v_xor_b32 v129, 32, v128
    v_xor_b32 v130, 64, v128
    v_xor_b32 v131, 96, v128
    v_xor_b32 v132, 128, v128
    v_xor_b32 v133, 160, v128
    v_xor_b32 v134, 192, v128
    v_xor_b32 v135, 224, v128
    s_mul_i32 s32, s38, 4096
    s_add_u32 s32, s32, 65536
    v_add_u32 v136, s32, v251
    v_lshrrev_b32 v2, 5, v250
    v_and_b32 v3, 31, v250
    s_mul_i32 s32, s14, 8
    v_add_u32 v4, s32, v2
    v_add_u32 v5, 0, v4
    v_and_b32 v6, 7, v5
    v_lshlrev_b32 v6, 1, v6
    v_xor_b32 v6, v6, v3
    v_mul_lo_u32 v5, v5, s30
    v_lshl_add_u32 v5, v6, 4, v5
    v_subrev_u32 v137, 0, v5
    v_add_u32 v5, 2, v4
    v_and_b32 v6, 7, v5
    v_lshlrev_b32 v6, 1, v6
    v_xor_b32 v6, v6, v3
    v_mul_lo_u32 v5, v5, s30
    v_lshl_add_u32 v5, v6, 4, v5
    v_subrev_u32 v138, 1024, v5
    v_add_u32 v5, 4, v4
    v_and_b32 v6, 7, v5
    v_lshlrev_b32 v6, 1, v6
    v_xor_b32 v6, v6, v3
    v_mul_lo_u32 v5, v5, s30
    v_lshl_add_u32 v5, v6, 4, v5
    v_subrev_u32 v139, 2048, v5
    v_add_u32 v5, 6, v4
    v_and_b32 v6, 7, v5
    v_lshlrev_b32 v6, 1, v6
    v_xor_b32 v6, v6, v3
    v_mul_lo_u32 v5, v5, s30
    v_lshl_add_u32 v5, v6, 4, v5
    v_subrev_u32 v140, 3072, v5
    s_mul_i32 s32, s14, 2
    s_mul_i32 s32, s32, s31
    v_add_u32 v141, s32, v251
    s_add_u32 s32, s32, s31
    s_sub_u32 s32, s32, 1024
    v_add_u32 v142, s32, v251
    s_mul_i32 s19, s14, 4096
    s_mul_i32 s20, s14, 2048
    s_add_u32 s20, s20, 65536
    s_mul_i32 s17, s30, 32
    s_mov_b32 s15, 0
    s_add_u32 m0, s20, 0
    s_nop 0
    buffer_load_dwordx4 v141, s[4:7], s16 offen offset:0 sc1 lds
    buffer_load_dwordx4 v142, s[4:7], s16 offen offset:1024 sc1 lds
    s_add_u32 s16, s16, 1024
    s_add_u32 m0, s19, 0
    s_nop 0
    buffer_load_dwordx4 v137, s[8:11], s15 offen offset:0 lds
    buffer_load_dwordx4 v138, s[8:11], s15 offen offset:1024 lds
    buffer_load_dwordx4 v139, s[8:11], s15 offen offset:2048 lds
    buffer_load_dwordx4 v140, s[8:11], s15 offen offset:3072 lds
    s_add_u32 s15, s15, s17
    s_add_u32 m0, s20, 8192
    s_nop 0
    buffer_load_dwordx4 v141, s[4:7], s16 offen offset:0 sc1 lds
    buffer_load_dwordx4 v142, s[4:7], s16 offen offset:1024 sc1 lds
    s_add_u32 s16, s16, 1024
    s_add_u32 m0, s19, 16384
    s_nop 0
    buffer_load_dwordx4 v137, s[8:11], s15 offen offset:0 lds
    buffer_load_dwordx4 v138, s[8:11], s15 offen offset:1024 lds
    buffer_load_dwordx4 v139, s[8:11], s15 offen offset:2048 lds
    buffer_load_dwordx4 v140, s[8:11], s15 offen offset:3072 lds
    s_add_u32 s15, s15, s17
    s_add_u32 m0, s20, 16384
    s_nop 0
    buffer_load_dwordx4 v141, s[4:7], s16 offen offset:0 sc1 lds
    buffer_load_dwordx4 v142, s[4:7], s16 offen offset:1024 sc1 lds
    s_add_u32 s16, s16, 1024
    s_add_u32 m0, s19, 32768
    s_nop 0
    buffer_load_dwordx4 v137, s[8:11], s15 offen offset:0 lds
    buffer_load_dwordx4 v138, s[8:11], s15 offen offset:1024 lds
    buffer_load_dwordx4 v139, s[8:11], s15 offen offset:2048 lds
    buffer_load_dwordx4 v140, s[8:11], s15 offen offset:3072 lds
    s_add_u32 s15, s15, s17
    s_add_u32 m0, s20, 24576
    s_nop 0
    buffer_load_dwordx4 v141, s[4:7], s16 offen offset:0 sc1 lds
    buffer_load_dwordx4 v142, s[4:7], s16 offen offset:1024 sc1 lds
    s_add_u32 s16, s16, 1024
    s_add_u32 m0, s19, 49152
    s_nop 0
    buffer_load_dwordx4 v137, s[8:11], s15 offen offset:0 lds
    buffer_load_dwordx4 v138, s[8:11], s15 offen offset:1024 lds
    buffer_load_dwordx4 v139, s[8:11], s15 offen offset:2048 lds
    buffer_load_dwordx4 v140, s[8:11], s15 offen offset:3072 lds
    s_add_u32 s15, s15, s17
    v_accvgpr_write_b32 a0, 0
    v_accvgpr_write_b32 a1, 0
    v_accvgpr_write_b32 a2, 0
    v_accvgpr_write_b32 a3, 0
    v_accvgpr_write_b32 a4, 0
    v_accvgpr_write_b32 a5, 0
    v_accvgpr_write_b32 a6, 0
    v_accvgpr_write_b32 a7, 0
    v_accvgpr_write_b32 a8, 0
    v_accvgpr_write_b32 a9, 0
    v_accvgpr_write_b32 a10, 0
    v_accvgpr_write_b32 a11, 0
    v_accvgpr_write_b32 a12, 0
    v_accvgpr_write_b32 a13, 0
    v_accvgpr_write_b32 a14, 0
    v_accvgpr_write_b32 a15, 0
    v_accvgpr_write_b32 a16, 0
    v_accvgpr_write_b32 a17, 0
    v_accvgpr_write_b32 a18, 0
    v_accvgpr_write_b32 a19, 0
    v_accvgpr_write_b32 a20, 0
    v_accvgpr_write_b32 a21, 0
    v_accvgpr_write_b32 a22, 0
    v_accvgpr_write_b32 a23, 0
    v_accvgpr_write_b32 a24, 0
    v_accvgpr_write_b32 a25, 0
    v_accvgpr_write_b32 a26, 0
    v_accvgpr_write_b32 a27, 0
    v_accvgpr_write_b32 a28, 0
    v_accvgpr_write_b32 a29, 0
    v_accvgpr_write_b32 a30, 0
    v_accvgpr_write_b32 a31, 0
    v_accvgpr_write_b32 a32, 0
    v_accvgpr_write_b32 a33, 0
    v_accvgpr_write_b32 a34, 0
    v_accvgpr_write_b32 a35, 0
    v_accvgpr_write_b32 a36, 0
    v_accvgpr_write_b32 a37, 0
    v_accvgpr_write_b32 a38, 0
    v_accvgpr_write_b32 a39, 0
    v_accvgpr_write_b32 a40, 0
    v_accvgpr_write_b32 a41, 0
    v_accvgpr_write_b32 a42, 0
    v_accvgpr_write_b32 a43, 0
    v_accvgpr_write_b32 a44, 0
    v_accvgpr_write_b32 a45, 0
    v_accvgpr_write_b32 a46, 0
    v_accvgpr_write_b32 a47, 0
    v_accvgpr_write_b32 a48, 0
    v_accvgpr_write_b32 a49, 0
    v_accvgpr_write_b32 a50, 0
    v_accvgpr_write_b32 a51, 0
    v_accvgpr_write_b32 a52, 0
    v_accvgpr_write_b32 a53, 0
    v_accvgpr_write_b32 a54, 0
    v_accvgpr_write_b32 a55, 0
    v_accvgpr_write_b32 a56, 0
    v_accvgpr_write_b32 a57, 0
    v_accvgpr_write_b32 a58, 0
    v_accvgpr_write_b32 a59, 0
    v_accvgpr_write_b32 a60, 0
    v_accvgpr_write_b32 a61, 0
    v_accvgpr_write_b32 a62, 0
    v_accvgpr_write_b32 a63, 0
    v_accvgpr_write_b32 a64, 0
    v_accvgpr_write_b32 a65, 0
    v_accvgpr_write_b32 a66, 0
    v_accvgpr_write_b32 a67, 0
    v_accvgpr_write_b32 a68, 0
    v_accvgpr_write_b32 a69, 0
    v_accvgpr_write_b32 a70, 0
    v_accvgpr_write_b32 a71, 0
    v_accvgpr_write_b32 a72, 0
    v_accvgpr_write_b32 a73, 0
    v_accvgpr_write_b32 a74, 0
    v_accvgpr_write_b32 a75, 0
    v_accvgpr_write_b32 a76, 0
    v_accvgpr_write_b32 a77, 0
    v_accvgpr_write_b32 a78, 0
    v_accvgpr_write_b32 a79, 0
    v_accvgpr_write_b32 a80, 0
    v_accvgpr_write_b32 a81, 0
    v_accvgpr_write_b32 a82, 0
    v_accvgpr_write_b32 a83, 0
    v_accvgpr_write_b32 a84, 0
    v_accvgpr_write_b32 a85, 0
    v_accvgpr_write_b32 a86, 0
    v_accvgpr_write_b32 a87, 0
    v_accvgpr_write_b32 a88, 0
    v_accvgpr_write_b32 a89, 0
    v_accvgpr_write_b32 a90, 0
    v_accvgpr_write_b32 a91, 0
    v_accvgpr_write_b32 a92, 0
    v_accvgpr_write_b32 a93, 0
    v_accvgpr_write_b32 a94, 0
    v_accvgpr_write_b32 a95, 0
    v_accvgpr_write_b32 a96, 0
    v_accvgpr_write_b32 a97, 0
    v_accvgpr_write_b32 a98, 0
    v_accvgpr_write_b32 a99, 0
    v_accvgpr_write_b32 a100, 0
    v_accvgpr_write_b32 a101, 0
    v_accvgpr_write_b32 a102, 0
    v_accvgpr_write_b32 a103, 0
    v_accvgpr_write_b32 a104, 0
    v_accvgpr_write_b32 a105, 0
    v_accvgpr_write_b32 a106, 0
    v_accvgpr_write_b32 a107, 0
    v_accvgpr_write_b32 a108, 0
    v_accvgpr_write_b32 a109, 0
    v_accvgpr_write_b32 a110, 0
    v_accvgpr_write_b32 a111, 0
    v_accvgpr_write_b32 a112, 0
    v_accvgpr_write_b32 a113, 0
    v_accvgpr_write_b32 a114, 0
    v_accvgpr_write_b32 a115, 0
    v_accvgpr_write_b32 a116, 0
    v_accvgpr_write_b32 a117, 0
    v_accvgpr_write_b32 a118, 0
    v_accvgpr_write_b32 a119, 0
    v_accvgpr_write_b32 a120, 0
    v_accvgpr_write_b32 a121, 0
    v_accvgpr_write_b32 a122, 0
    v_accvgpr_write_b32 a123, 0
    v_accvgpr_write_b32 a124, 0
    v_accvgpr_write_b32 a125, 0
    v_accvgpr_write_b32 a126, 0
    v_accvgpr_write_b32 a127, 0
    s_waitcnt vmcnt(18)
    s_barrier
    ds_read_b128 v[32:35], v136 offset:0
    ds_read_b64_tr_b16 v[0:1], v128 offset:0
    ds_read_b64_tr_b16 v[2:3], v128 offset:8192
    ds_read_b64_tr_b16 v[4:5], v129 offset:0
    ds_read_b64_tr_b16 v[6:7], v129 offset:8192
    ds_read_b64_tr_b16 v[8:9], v130 offset:0
    ds_read_b64_tr_b16 v[10:11], v130 offset:8192
    ds_read_b64_tr_b16 v[12:13], v131 offset:0
    ds_read_b64_tr_b16 v[14:15], v131 offset:8192
    ds_read_b64_tr_b16 v[16:17], v132 offset:0
    ds_read_b64_tr_b16 v[18:19], v132 offset:8192
    ds_read_b64_tr_b16 v[20:21], v133 offset:0
    ds_read_b64_tr_b16 v[22:23], v133 offset:8192
    ds_read_b64_tr_b16 v[24:25], v134 offset:0
    ds_read_b64_tr_b16 v[26:27], v134 offset:8192
    ds_read_b64_tr_b16 v[28:29], v135 offset:0
    ds_read_b64_tr_b16 v[30:31], v135 offset:8192
    ds_read_b128 v[36:39], v136 offset:1024
    ds_read_b128 v[40:43], v136 offset:2048
    ds_read_b128 v[44:47], v136 offset:3072
main_kernel_w_c1_v_loop:
    s_waitcnt lgkmcnt(0)
    v_mfma_f32_16x16x32_bf16 a[0:3], v[32:35], v[0:3], a[0:3]
    s_waitcnt vmcnt(12)
    s_barrier
    ds_read_b128 v[80:83], v136 offset:8192
    s_add_u32 m0, s20, 0
    s_nop 0
    v_mfma_f32_16x16x32_bf16 a[4:7], v[32:35], v[4:7], a[4:7]
    ds_read_b64_tr_b16 v[48:49], v128 offset:16384
    v_mfma_f32_16x16x32_bf16 a[8:11], v[32:35], v[8:11], a[8:11]
    ds_read_b64_tr_b16 v[50:51], v128 offset:24576
    v_mfma_f32_16x16x32_bf16 a[12:15], v[32:35], v[12:15], a[12:15]
    ds_read_b64_tr_b16 v[52:53], v129 offset:16384
    buffer_load_dwordx4 v141, s[4:7], s16 offen offset:0 sc1 lds
    v_mfma_f32_16x16x32_bf16 a[16:19], v[32:35], v[16:19], a[16:19]
    ds_read_b64_tr_b16 v[54:55], v129 offset:24576
    v_mfma_f32_16x16x32_bf16 a[20:23], v[32:35], v[20:23], a[20:23]
    ds_read_b64_tr_b16 v[56:57], v130 offset:16384
    v_mfma_f32_16x16x32_bf16 a[24:27], v[32:35], v[24:27], a[24:27]
    ds_read_b64_tr_b16 v[58:59], v130 offset:24576
    buffer_load_dwordx4 v142, s[4:7], s16 offen offset:1024 sc1 lds
    v_mfma_f32_16x16x32_bf16 a[28:31], v[32:35], v[28:31], a[28:31]
    ds_read_b64_tr_b16 v[60:61], v131 offset:16384
    v_mfma_f32_16x16x32_bf16 a[32:35], v[36:39], v[0:3], a[32:35]
    ds_read_b64_tr_b16 v[62:63], v131 offset:24576
    v_mfma_f32_16x16x32_bf16 a[36:39], v[36:39], v[4:7], a[36:39]
    ds_read_b64_tr_b16 v[64:65], v132 offset:16384
    s_add_u32 s16, s16, 1024
    v_mfma_f32_16x16x32_bf16 a[40:43], v[36:39], v[8:11], a[40:43]
    ds_read_b64_tr_b16 v[66:67], v132 offset:24576
    v_mfma_f32_16x16x32_bf16 a[44:47], v[36:39], v[12:15], a[44:47]
    ds_read_b64_tr_b16 v[68:69], v133 offset:16384
    v_mfma_f32_16x16x32_bf16 a[48:51], v[36:39], v[16:19], a[48:51]
    ds_read_b64_tr_b16 v[70:71], v133 offset:24576
    s_add_u32 m0, s19, 0
    s_nop 0
    v_mfma_f32_16x16x32_bf16 a[52:55], v[36:39], v[20:23], a[52:55]
    ds_read_b64_tr_b16 v[72:73], v134 offset:16384
    v_mfma_f32_16x16x32_bf16 a[56:59], v[36:39], v[24:27], a[56:59]
    ds_read_b64_tr_b16 v[74:75], v134 offset:24576
    v_mfma_f32_16x16x32_bf16 a[60:63], v[36:39], v[28:31], a[60:63]
    ds_read_b64_tr_b16 v[76:77], v135 offset:16384
    buffer_load_dwordx4 v137, s[8:11], s15 offen offset:0 lds
    v_mfma_f32_16x16x32_bf16 a[64:67], v[40:43], v[0:3], a[64:67]
    ds_read_b64_tr_b16 v[78:79], v135 offset:24576
    v_mfma_f32_16x16x32_bf16 a[68:71], v[40:43], v[4:7], a[68:71]
    ds_read_b128 v[84:87], v136 offset:9216
    v_mfma_f32_16x16x32_bf16 a[72:75], v[40:43], v[8:11], a[72:75]
    ds_read_b128 v[88:91], v136 offset:10240
    buffer_load_dwordx4 v138, s[8:11], s15 offen offset:1024 lds
    v_mfma_f32_16x16x32_bf16 a[76:79], v[40:43], v[12:15], a[76:79]
    ds_read_b128 v[92:95], v136 offset:11264
    v_mfma_f32_16x16x32_bf16 a[80:83], v[40:43], v[16:19], a[80:83]
    v_mfma_f32_16x16x32_bf16 a[84:87], v[40:43], v[20:23], a[84:87]
    buffer_load_dwordx4 v139, s[8:11], s15 offen offset:2048 lds
    v_mfma_f32_16x16x32_bf16 a[88:91], v[40:43], v[24:27], a[88:91]
    v_mfma_f32_16x16x32_bf16 a[92:95], v[40:43], v[28:31], a[92:95]
    v_mfma_f32_16x16x32_bf16 a[96:99], v[44:47], v[0:3], a[96:99]
    buffer_load_dwordx4 v140, s[8:11], s15 offen offset:3072 lds
    v_mfma_f32_16x16x32_bf16 a[100:103], v[44:47], v[4:7], a[100:103]
    v_mfma_f32_16x16x32_bf16 a[104:107], v[44:47], v[8:11], a[104:107]
    v_mfma_f32_16x16x32_bf16 a[108:111], v[44:47], v[12:15], a[108:111]
    s_add_u32 s15, s15, s17
    v_mfma_f32_16x16x32_bf16 a[112:115], v[44:47], v[16:19], a[112:115]
    v_mfma_f32_16x16x32_bf16 a[116:119], v[44:47], v[20:23], a[116:119]
    v_mfma_f32_16x16x32_bf16 a[120:123], v[44:47], v[24:27], a[120:123]
    v_mfma_f32_16x16x32_bf16 a[124:127], v[44:47], v[28:31], a[124:127]
    s_waitcnt lgkmcnt(0)
    v_mfma_f32_16x16x32_bf16 a[0:3], v[80:83], v[48:51], a[0:3]
    s_waitcnt vmcnt(12)
    s_barrier
    ds_read_b128 v[32:35], v136 offset:16384
    s_add_u32 m0, s20, 8192
    s_nop 0
    v_mfma_f32_16x16x32_bf16 a[4:7], v[80:83], v[52:55], a[4:7]
    ds_read_b64_tr_b16 v[0:1], v128 offset:32768
    v_mfma_f32_16x16x32_bf16 a[8:11], v[80:83], v[56:59], a[8:11]
    ds_read_b64_tr_b16 v[2:3], v128 offset:40960
    v_mfma_f32_16x16x32_bf16 a[12:15], v[80:83], v[60:63], a[12:15]
    ds_read_b64_tr_b16 v[4:5], v129 offset:32768
    buffer_load_dwordx4 v141, s[4:7], s16 offen offset:0 sc1 lds
    v_mfma_f32_16x16x32_bf16 a[16:19], v[80:83], v[64:67], a[16:19]
    ds_read_b64_tr_b16 v[6:7], v129 offset:40960
    v_mfma_f32_16x16x32_bf16 a[20:23], v[80:83], v[68:71], a[20:23]
    ds_read_b64_tr_b16 v[8:9], v130 offset:32768
    v_mfma_f32_16x16x32_bf16 a[24:27], v[80:83], v[72:75], a[24:27]
    ds_read_b64_tr_b16 v[10:11], v130 offset:40960
    buffer_load_dwordx4 v142, s[4:7], s16 offen offset:1024 sc1 lds
    v_mfma_f32_16x16x32_bf16 a[28:31], v[80:83], v[76:79], a[28:31]
    ds_read_b64_tr_b16 v[12:13], v131 offset:32768
    v_mfma_f32_16x16x32_bf16 a[32:35], v[84:87], v[48:51], a[32:35]
    ds_read_b64_tr_b16 v[14:15], v131 offset:40960
    v_mfma_f32_16x16x32_bf16 a[36:39], v[84:87], v[52:55], a[36:39]
    ds_read_b64_tr_b16 v[16:17], v132 offset:32768
    s_add_u32 s16, s16, 1024
    v_mfma_f32_16x16x32_bf16 a[40:43], v[84:87], v[56:59], a[40:43]
    ds_read_b64_tr_b16 v[18:19], v132 offset:40960
    v_mfma_f32_16x16x32_bf16 a[44:47], v[84:87], v[60:63], a[44:47]
    ds_read_b64_tr_b16 v[20:21], v133 offset:32768
    v_mfma_f32_16x16x32_bf16 a[48:51], v[84:87], v[64:67], a[48:51]
    ds_read_b64_tr_b16 v[22:23], v133 offset:40960
    s_add_u32 m0, s19, 16384
    s_nop 0
    v_mfma_f32_16x16x32_bf16 a[52:55], v[84:87], v[68:71], a[52:55]
    ds_read_b64_tr_b16 v[24:25], v134 offset:32768
    v_mfma_f32_16x16x32_bf16 a[56:59], v[84:87], v[72:75], a[56:59]
    ds_read_b64_tr_b16 v[26:27], v134 offset:40960
    v_mfma_f32_16x16x32_bf16 a[60:63], v[84:87], v[76:79], a[60:63]
    ds_read_b64_tr_b16 v[28:29], v135 offset:32768
    buffer_load_dwordx4 v137, s[8:11], s15 offen offset:0 lds
    v_mfma_f32_16x16x32_bf16 a[64:67], v[88:91], v[48:51], a[64:67]
    ds_read_b64_tr_b16 v[30:31], v135 offset:40960
    v_mfma_f32_16x16x32_bf16 a[68:71], v[88:91], v[52:55], a[68:71]
    ds_read_b128 v[36:39], v136 offset:17408
    v_mfma_f32_16x16x32_bf16 a[72:75], v[88:91], v[56:59], a[72:75]
    ds_read_b128 v[40:43], v136 offset:18432
    buffer_load_dwordx4 v138, s[8:11], s15 offen offset:1024 lds
    v_mfma_f32_16x16x32_bf16 a[76:79], v[88:91], v[60:63], a[76:79]
    ds_read_b128 v[44:47], v136 offset:19456
    v_mfma_f32_16x16x32_bf16 a[80:83], v[88:91], v[64:67], a[80:83]
    v_mfma_f32_16x16x32_bf16 a[84:87], v[88:91], v[68:71], a[84:87]
    buffer_load_dwordx4 v139, s[8:11], s15 offen offset:2048 lds
    v_mfma_f32_16x16x32_bf16 a[88:91], v[88:91], v[72:75], a[88:91]
    v_mfma_f32_16x16x32_bf16 a[92:95], v[88:91], v[76:79], a[92:95]
    v_mfma_f32_16x16x32_bf16 a[96:99], v[92:95], v[48:51], a[96:99]
    buffer_load_dwordx4 v140, s[8:11], s15 offen offset:3072 lds
    v_mfma_f32_16x16x32_bf16 a[100:103], v[92:95], v[52:55], a[100:103]
    v_mfma_f32_16x16x32_bf16 a[104:107], v[92:95], v[56:59], a[104:107]
    v_mfma_f32_16x16x32_bf16 a[108:111], v[92:95], v[60:63], a[108:111]
    s_add_u32 s15, s15, s17
    v_mfma_f32_16x16x32_bf16 a[112:115], v[92:95], v[64:67], a[112:115]
    v_mfma_f32_16x16x32_bf16 a[116:119], v[92:95], v[68:71], a[116:119]
    v_mfma_f32_16x16x32_bf16 a[120:123], v[92:95], v[72:75], a[120:123]
    v_mfma_f32_16x16x32_bf16 a[124:127], v[92:95], v[76:79], a[124:127]
    s_waitcnt lgkmcnt(0)
    v_mfma_f32_16x16x32_bf16 a[0:3], v[32:35], v[0:3], a[0:3]
    s_waitcnt vmcnt(12)
    s_barrier
    ds_read_b128 v[80:83], v136 offset:24576
    s_add_u32 m0, s20, 16384
    s_nop 0
    v_mfma_f32_16x16x32_bf16 a[4:7], v[32:35], v[4:7], a[4:7]
    ds_read_b64_tr_b16 v[48:49], v128 offset:49152
    v_mfma_f32_16x16x32_bf16 a[8:11], v[32:35], v[8:11], a[8:11]
    ds_read_b64_tr_b16 v[50:51], v128 offset:57344
    v_mfma_f32_16x16x32_bf16 a[12:15], v[32:35], v[12:15], a[12:15]
    ds_read_b64_tr_b16 v[52:53], v129 offset:49152
    buffer_load_dwordx4 v141, s[4:7], s16 offen offset:0 sc1 lds
    v_mfma_f32_16x16x32_bf16 a[16:19], v[32:35], v[16:19], a[16:19]
    ds_read_b64_tr_b16 v[54:55], v129 offset:57344
    v_mfma_f32_16x16x32_bf16 a[20:23], v[32:35], v[20:23], a[20:23]
    ds_read_b64_tr_b16 v[56:57], v130 offset:49152
    v_mfma_f32_16x16x32_bf16 a[24:27], v[32:35], v[24:27], a[24:27]
    ds_read_b64_tr_b16 v[58:59], v130 offset:57344
    buffer_load_dwordx4 v142, s[4:7], s16 offen offset:1024 sc1 lds
    v_mfma_f32_16x16x32_bf16 a[28:31], v[32:35], v[28:31], a[28:31]
    ds_read_b64_tr_b16 v[60:61], v131 offset:49152
    v_mfma_f32_16x16x32_bf16 a[32:35], v[36:39], v[0:3], a[32:35]
    ds_read_b64_tr_b16 v[62:63], v131 offset:57344
    v_mfma_f32_16x16x32_bf16 a[36:39], v[36:39], v[4:7], a[36:39]
    ds_read_b64_tr_b16 v[64:65], v132 offset:49152
    s_add_u32 s16, s16, 1024
    v_mfma_f32_16x16x32_bf16 a[40:43], v[36:39], v[8:11], a[40:43]
    ds_read_b64_tr_b16 v[66:67], v132 offset:57344
    v_mfma_f32_16x16x32_bf16 a[44:47], v[36:39], v[12:15], a[44:47]
    ds_read_b64_tr_b16 v[68:69], v133 offset:49152
    v_mfma_f32_16x16x32_bf16 a[48:51], v[36:39], v[16:19], a[48:51]
    ds_read_b64_tr_b16 v[70:71], v133 offset:57344
    s_add_u32 m0, s19, 32768
    s_nop 0
    v_mfma_f32_16x16x32_bf16 a[52:55], v[36:39], v[20:23], a[52:55]
    ds_read_b64_tr_b16 v[72:73], v134 offset:49152
    v_mfma_f32_16x16x32_bf16 a[56:59], v[36:39], v[24:27], a[56:59]
    ds_read_b64_tr_b16 v[74:75], v134 offset:57344
    v_mfma_f32_16x16x32_bf16 a[60:63], v[36:39], v[28:31], a[60:63]
    ds_read_b64_tr_b16 v[76:77], v135 offset:49152
    buffer_load_dwordx4 v137, s[8:11], s15 offen offset:0 lds
    v_mfma_f32_16x16x32_bf16 a[64:67], v[40:43], v[0:3], a[64:67]
    ds_read_b64_tr_b16 v[78:79], v135 offset:57344
    v_mfma_f32_16x16x32_bf16 a[68:71], v[40:43], v[4:7], a[68:71]
    ds_read_b128 v[84:87], v136 offset:25600
    v_mfma_f32_16x16x32_bf16 a[72:75], v[40:43], v[8:11], a[72:75]
    ds_read_b128 v[88:91], v136 offset:26624
    buffer_load_dwordx4 v138, s[8:11], s15 offen offset:1024 lds
    v_mfma_f32_16x16x32_bf16 a[76:79], v[40:43], v[12:15], a[76:79]
    ds_read_b128 v[92:95], v136 offset:27648
    v_mfma_f32_16x16x32_bf16 a[80:83], v[40:43], v[16:19], a[80:83]
    v_mfma_f32_16x16x32_bf16 a[84:87], v[40:43], v[20:23], a[84:87]
    buffer_load_dwordx4 v139, s[8:11], s15 offen offset:2048 lds
    v_mfma_f32_16x16x32_bf16 a[88:91], v[40:43], v[24:27], a[88:91]
    v_mfma_f32_16x16x32_bf16 a[92:95], v[40:43], v[28:31], a[92:95]
    v_mfma_f32_16x16x32_bf16 a[96:99], v[44:47], v[0:3], a[96:99]
    buffer_load_dwordx4 v140, s[8:11], s15 offen offset:3072 lds
    v_mfma_f32_16x16x32_bf16 a[100:103], v[44:47], v[4:7], a[100:103]
    v_mfma_f32_16x16x32_bf16 a[104:107], v[44:47], v[8:11], a[104:107]
    v_mfma_f32_16x16x32_bf16 a[108:111], v[44:47], v[12:15], a[108:111]
    s_add_u32 s15, s15, s17
    v_mfma_f32_16x16x32_bf16 a[112:115], v[44:47], v[16:19], a[112:115]
    v_mfma_f32_16x16x32_bf16 a[116:119], v[44:47], v[20:23], a[116:119]
    v_mfma_f32_16x16x32_bf16 a[120:123], v[44:47], v[24:27], a[120:123]
    v_mfma_f32_16x16x32_bf16 a[124:127], v[44:47], v[28:31], a[124:127]
    s_waitcnt lgkmcnt(0)
    v_mfma_f32_16x16x32_bf16 a[0:3], v[80:83], v[48:51], a[0:3]
    s_waitcnt vmcnt(12)
    s_barrier
    ds_read_b128 v[32:35], v136 offset:0
    s_add_u32 m0, s20, 24576
    s_nop 0
    v_mfma_f32_16x16x32_bf16 a[4:7], v[80:83], v[52:55], a[4:7]
    ds_read_b64_tr_b16 v[0:1], v128 offset:0
    v_mfma_f32_16x16x32_bf16 a[8:11], v[80:83], v[56:59], a[8:11]
    ds_read_b64_tr_b16 v[2:3], v128 offset:8192
    v_mfma_f32_16x16x32_bf16 a[12:15], v[80:83], v[60:63], a[12:15]
    ds_read_b64_tr_b16 v[4:5], v129 offset:0
    buffer_load_dwordx4 v141, s[4:7], s16 offen offset:0 sc1 lds
    v_mfma_f32_16x16x32_bf16 a[16:19], v[80:83], v[64:67], a[16:19]
    ds_read_b64_tr_b16 v[6:7], v129 offset:8192
    v_mfma_f32_16x16x32_bf16 a[20:23], v[80:83], v[68:71], a[20:23]
    ds_read_b64_tr_b16 v[8:9], v130 offset:0
    v_mfma_f32_16x16x32_bf16 a[24:27], v[80:83], v[72:75], a[24:27]
    ds_read_b64_tr_b16 v[10:11], v130 offset:8192
    buffer_load_dwordx4 v142, s[4:7], s16 offen offset:1024 sc1 lds
    v_mfma_f32_16x16x32_bf16 a[28:31], v[80:83], v[76:79], a[28:31]
    ds_read_b64_tr_b16 v[12:13], v131 offset:0
    v_mfma_f32_16x16x32_bf16 a[32:35], v[84:87], v[48:51], a[32:35]
    ds_read_b64_tr_b16 v[14:15], v131 offset:8192
    v_mfma_f32_16x16x32_bf16 a[36:39], v[84:87], v[52:55], a[36:39]
    ds_read_b64_tr_b16 v[16:17], v132 offset:0
    s_add_u32 s16, s16, 1024
    v_mfma_f32_16x16x32_bf16 a[40:43], v[84:87], v[56:59], a[40:43]
    ds_read_b64_tr_b16 v[18:19], v132 offset:8192
    v_mfma_f32_16x16x32_bf16 a[44:47], v[84:87], v[60:63], a[44:47]
    ds_read_b64_tr_b16 v[20:21], v133 offset:0
    v_mfma_f32_16x16x32_bf16 a[48:51], v[84:87], v[64:67], a[48:51]
    ds_read_b64_tr_b16 v[22:23], v133 offset:8192
    s_add_u32 m0, s19, 49152
    s_nop 0
    v_mfma_f32_16x16x32_bf16 a[52:55], v[84:87], v[68:71], a[52:55]
    ds_read_b64_tr_b16 v[24:25], v134 offset:0
    v_mfma_f32_16x16x32_bf16 a[56:59], v[84:87], v[72:75], a[56:59]
    ds_read_b64_tr_b16 v[26:27], v134 offset:8192
    v_mfma_f32_16x16x32_bf16 a[60:63], v[84:87], v[76:79], a[60:63]
    ds_read_b64_tr_b16 v[28:29], v135 offset:0
    buffer_load_dwordx4 v137, s[8:11], s15 offen offset:0 lds
    v_mfma_f32_16x16x32_bf16 a[64:67], v[88:91], v[48:51], a[64:67]
    ds_read_b64_tr_b16 v[30:31], v135 offset:8192
    v_mfma_f32_16x16x32_bf16 a[68:71], v[88:91], v[52:55], a[68:71]
    ds_read_b128 v[36:39], v136 offset:1024
    v_mfma_f32_16x16x32_bf16 a[72:75], v[88:91], v[56:59], a[72:75]
    ds_read_b128 v[40:43], v136 offset:2048
    buffer_load_dwordx4 v138, s[8:11], s15 offen offset:1024 lds
    v_mfma_f32_16x16x32_bf16 a[76:79], v[88:91], v[60:63], a[76:79]
    ds_read_b128 v[44:47], v136 offset:3072
    v_mfma_f32_16x16x32_bf16 a[80:83], v[88:91], v[64:67], a[80:83]
    v_mfma_f32_16x16x32_bf16 a[84:87], v[88:91], v[68:71], a[84:87]
    buffer_load_dwordx4 v139, s[8:11], s15 offen offset:2048 lds
    v_mfma_f32_16x16x32_bf16 a[88:91], v[88:91], v[72:75], a[88:91]
    v_mfma_f32_16x16x32_bf16 a[92:95], v[88:91], v[76:79], a[92:95]
    v_mfma_f32_16x16x32_bf16 a[96:99], v[92:95], v[48:51], a[96:99]
    buffer_load_dwordx4 v140, s[8:11], s15 offen offset:3072 lds
    v_mfma_f32_16x16x32_bf16 a[100:103], v[92:95], v[52:55], a[100:103]
    v_mfma_f32_16x16x32_bf16 a[104:107], v[92:95], v[56:59], a[104:107]
    v_mfma_f32_16x16x32_bf16 a[108:111], v[92:95], v[60:63], a[108:111]
    s_add_u32 s15, s15, s17
    v_mfma_f32_16x16x32_bf16 a[112:115], v[92:95], v[64:67], a[112:115]
    v_mfma_f32_16x16x32_bf16 a[116:119], v[92:95], v[68:71], a[116:119]
    v_mfma_f32_16x16x32_bf16 a[120:123], v[92:95], v[72:75], a[120:123]
    v_mfma_f32_16x16x32_bf16 a[124:127], v[92:95], v[76:79], a[124:127]
    s_sub_u32 s18, s18, 1
    s_cmp_lg_u32 s18, 0
    s_cbranch_scc1 main_kernel_w_c1_v_loop
    s_cmp_lg_u32 s14, 0
    s_cbranch_scc1 main_kernel_w_c1_v_nt
    s_lshl_b32 s32, s27, 8
    s_add_u32 s32, s32, 0x841e000
    v_mov_b32 v255, 1
    s_mov_b64 exec, 1
    buffer_atomic_add v255, off, s[4:7], s32 sc0 sc1
    s_mov_b64 exec, -1
main_kernel_w_c1_v_nt:
    s_waitcnt lgkmcnt(0)
    v_mfma_f32_16x16x32_bf16 a[0:3], v[32:35], v[0:3], a[0:3]
    s_waitcnt vmcnt(12)
    s_barrier
    ds_read_b128 v[80:83], v136 offset:8192
    v_mfma_f32_16x16x32_bf16 a[4:7], v[32:35], v[4:7], a[4:7]
    ds_read_b64_tr_b16 v[48:49], v128 offset:16384
    v_mfma_f32_16x16x32_bf16 a[8:11], v[32:35], v[8:11], a[8:11]
    ds_read_b64_tr_b16 v[50:51], v128 offset:24576
    v_mfma_f32_16x16x32_bf16 a[12:15], v[32:35], v[12:15], a[12:15]
    ds_read_b64_tr_b16 v[52:53], v129 offset:16384
    v_mfma_f32_16x16x32_bf16 a[16:19], v[32:35], v[16:19], a[16:19]
    ds_read_b64_tr_b16 v[54:55], v129 offset:24576
    v_mfma_f32_16x16x32_bf16 a[20:23], v[32:35], v[20:23], a[20:23]
    ds_read_b64_tr_b16 v[56:57], v130 offset:16384
    v_mfma_f32_16x16x32_bf16 a[24:27], v[32:35], v[24:27], a[24:27]
    ds_read_b64_tr_b16 v[58:59], v130 offset:24576
    v_mfma_f32_16x16x32_bf16 a[28:31], v[32:35], v[28:31], a[28:31]
    ds_read_b64_tr_b16 v[60:61], v131 offset:16384
    v_mfma_f32_16x16x32_bf16 a[32:35], v[36:39], v[0:3], a[32:35]
    ds_read_b64_tr_b16 v[62:63], v131 offset:24576
    v_mfma_f32_16x16x32_bf16 a[36:39], v[36:39], v[4:7], a[36:39]
    ds_read_b64_tr_b16 v[64:65], v132 offset:16384
    v_mfma_f32_16x16x32_bf16 a[40:43], v[36:39], v[8:11], a[40:43]
    ds_read_b64_tr_b16 v[66:67], v132 offset:24576
    v_mfma_f32_16x16x32_bf16 a[44:47], v[36:39], v[12:15], a[44:47]
    ds_read_b64_tr_b16 v[68:69], v133 offset:16384
    v_mfma_f32_16x16x32_bf16 a[48:51], v[36:39], v[16:19], a[48:51]
    ds_read_b64_tr_b16 v[70:71], v133 offset:24576
    v_mfma_f32_16x16x32_bf16 a[52:55], v[36:39], v[20:23], a[52:55]
    ds_read_b64_tr_b16 v[72:73], v134 offset:16384
    v_mfma_f32_16x16x32_bf16 a[56:59], v[36:39], v[24:27], a[56:59]
    ds_read_b64_tr_b16 v[74:75], v134 offset:24576
    v_mfma_f32_16x16x32_bf16 a[60:63], v[36:39], v[28:31], a[60:63]
    ds_read_b64_tr_b16 v[76:77], v135 offset:16384
    v_mfma_f32_16x16x32_bf16 a[64:67], v[40:43], v[0:3], a[64:67]
    ds_read_b64_tr_b16 v[78:79], v135 offset:24576
    v_mfma_f32_16x16x32_bf16 a[68:71], v[40:43], v[4:7], a[68:71]
    ds_read_b128 v[84:87], v136 offset:9216
    v_mfma_f32_16x16x32_bf16 a[72:75], v[40:43], v[8:11], a[72:75]
    ds_read_b128 v[88:91], v136 offset:10240
    v_mfma_f32_16x16x32_bf16 a[76:79], v[40:43], v[12:15], a[76:79]
    ds_read_b128 v[92:95], v136 offset:11264
    v_mfma_f32_16x16x32_bf16 a[80:83], v[40:43], v[16:19], a[80:83]
    v_mfma_f32_16x16x32_bf16 a[84:87], v[40:43], v[20:23], a[84:87]
    v_mfma_f32_16x16x32_bf16 a[88:91], v[40:43], v[24:27], a[88:91]
    v_mfma_f32_16x16x32_bf16 a[92:95], v[40:43], v[28:31], a[92:95]
    v_mfma_f32_16x16x32_bf16 a[96:99], v[44:47], v[0:3], a[96:99]
    v_mfma_f32_16x16x32_bf16 a[100:103], v[44:47], v[4:7], a[100:103]
    v_mfma_f32_16x16x32_bf16 a[104:107], v[44:47], v[8:11], a[104:107]
    v_mfma_f32_16x16x32_bf16 a[108:111], v[44:47], v[12:15], a[108:111]
    v_mfma_f32_16x16x32_bf16 a[112:115], v[44:47], v[16:19], a[112:115]
    v_mfma_f32_16x16x32_bf16 a[116:119], v[44:47], v[20:23], a[116:119]
    v_mfma_f32_16x16x32_bf16 a[120:123], v[44:47], v[24:27], a[120:123]
    v_mfma_f32_16x16x32_bf16 a[124:127], v[44:47], v[28:31], a[124:127]
    s_waitcnt lgkmcnt(0)
    v_mfma_f32_16x16x32_bf16 a[0:3], v[80:83], v[48:51], a[0:3]
    s_waitcnt vmcnt(6)
    s_barrier
    ds_read_b128 v[32:35], v136 offset:16384
    v_mfma_f32_16x16x32_bf16 a[4:7], v[80:83], v[52:55], a[4:7]
    ds_read_b64_tr_b16 v[0:1], v128 offset:32768
    v_mfma_f32_16x16x32_bf16 a[8:11], v[80:83], v[56:59], a[8:11]
    ds_read_b64_tr_b16 v[2:3], v128 offset:40960
    v_mfma_f32_16x16x32_bf16 a[12:15], v[80:83], v[60:63], a[12:15]
    ds_read_b64_tr_b16 v[4:5], v129 offset:32768
    v_mfma_f32_16x16x32_bf16 a[16:19], v[80:83], v[64:67], a[16:19]
    ds_read_b64_tr_b16 v[6:7], v129 offset:40960
    v_mfma_f32_16x16x32_bf16 a[20:23], v[80:83], v[68:71], a[20:23]
    ds_read_b64_tr_b16 v[8:9], v130 offset:32768
    v_mfma_f32_16x16x32_bf16 a[24:27], v[80:83], v[72:75], a[24:27]
    ds_read_b64_tr_b16 v[10:11], v130 offset:40960
    v_mfma_f32_16x16x32_bf16 a[28:31], v[80:83], v[76:79], a[28:31]
    ds_read_b64_tr_b16 v[12:13], v131 offset:32768
    v_mfma_f32_16x16x32_bf16 a[32:35], v[84:87], v[48:51], a[32:35]
    ds_read_b64_tr_b16 v[14:15], v131 offset:40960
    v_mfma_f32_16x16x32_bf16 a[36:39], v[84:87], v[52:55], a[36:39]
    ds_read_b64_tr_b16 v[16:17], v132 offset:32768
    v_mfma_f32_16x16x32_bf16 a[40:43], v[84:87], v[56:59], a[40:43]
    ds_read_b64_tr_b16 v[18:19], v132 offset:40960
    v_mfma_f32_16x16x32_bf16 a[44:47], v[84:87], v[60:63], a[44:47]
    ds_read_b64_tr_b16 v[20:21], v133 offset:32768
    v_mfma_f32_16x16x32_bf16 a[48:51], v[84:87], v[64:67], a[48:51]
    ds_read_b64_tr_b16 v[22:23], v133 offset:40960
    v_mfma_f32_16x16x32_bf16 a[52:55], v[84:87], v[68:71], a[52:55]
    ds_read_b64_tr_b16 v[24:25], v134 offset:32768
    v_mfma_f32_16x16x32_bf16 a[56:59], v[84:87], v[72:75], a[56:59]
    ds_read_b64_tr_b16 v[26:27], v134 offset:40960
    v_mfma_f32_16x16x32_bf16 a[60:63], v[84:87], v[76:79], a[60:63]
    ds_read_b64_tr_b16 v[28:29], v135 offset:32768
    v_mfma_f32_16x16x32_bf16 a[64:67], v[88:91], v[48:51], a[64:67]
    ds_read_b64_tr_b16 v[30:31], v135 offset:40960
    v_mfma_f32_16x16x32_bf16 a[68:71], v[88:91], v[52:55], a[68:71]
    ds_read_b128 v[36:39], v136 offset:17408
    v_mfma_f32_16x16x32_bf16 a[72:75], v[88:91], v[56:59], a[72:75]
    ds_read_b128 v[40:43], v136 offset:18432
    v_mfma_f32_16x16x32_bf16 a[76:79], v[88:91], v[60:63], a[76:79]
    ds_read_b128 v[44:47], v136 offset:19456
    v_mfma_f32_16x16x32_bf16 a[80:83], v[88:91], v[64:67], a[80:83]
    v_mfma_f32_16x16x32_bf16 a[84:87], v[88:91], v[68:71], a[84:87]
    v_mfma_f32_16x16x32_bf16 a[88:91], v[88:91], v[72:75], a[88:91]
    v_mfma_f32_16x16x32_bf16 a[92:95], v[88:91], v[76:79], a[92:95]
    v_mfma_f32_16x16x32_bf16 a[96:99], v[92:95], v[48:51], a[96:99]
    v_mfma_f32_16x16x32_bf16 a[100:103], v[92:95], v[52:55], a[100:103]
    v_mfma_f32_16x16x32_bf16 a[104:107], v[92:95], v[56:59], a[104:107]
    v_mfma_f32_16x16x32_bf16 a[108:111], v[92:95], v[60:63], a[108:111]
    v_mfma_f32_16x16x32_bf16 a[112:115], v[92:95], v[64:67], a[112:115]
    v_mfma_f32_16x16x32_bf16 a[116:119], v[92:95], v[68:71], a[116:119]
    v_mfma_f32_16x16x32_bf16 a[120:123], v[92:95], v[72:75], a[120:123]
    v_mfma_f32_16x16x32_bf16 a[124:127], v[92:95], v[76:79], a[124:127]
    s_waitcnt lgkmcnt(0)
    v_mfma_f32_16x16x32_bf16 a[0:3], v[32:35], v[0:3], a[0:3]
    s_waitcnt vmcnt(0)
    s_barrier
    ds_read_b128 v[80:83], v136 offset:24576
    v_mfma_f32_16x16x32_bf16 a[4:7], v[32:35], v[4:7], a[4:7]
    ds_read_b64_tr_b16 v[48:49], v128 offset:49152
    v_mfma_f32_16x16x32_bf16 a[8:11], v[32:35], v[8:11], a[8:11]
    ds_read_b64_tr_b16 v[50:51], v128 offset:57344
    v_mfma_f32_16x16x32_bf16 a[12:15], v[32:35], v[12:15], a[12:15]
    ds_read_b64_tr_b16 v[52:53], v129 offset:49152
    v_mfma_f32_16x16x32_bf16 a[16:19], v[32:35], v[16:19], a[16:19]
    ds_read_b64_tr_b16 v[54:55], v129 offset:57344
    v_mfma_f32_16x16x32_bf16 a[20:23], v[32:35], v[20:23], a[20:23]
    ds_read_b64_tr_b16 v[56:57], v130 offset:49152
    v_mfma_f32_16x16x32_bf16 a[24:27], v[32:35], v[24:27], a[24:27]
    ds_read_b64_tr_b16 v[58:59], v130 offset:57344
    v_mfma_f32_16x16x32_bf16 a[28:31], v[32:35], v[28:31], a[28:31]
    ds_read_b64_tr_b16 v[60:61], v131 offset:49152
    v_mfma_f32_16x16x32_bf16 a[32:35], v[36:39], v[0:3], a[32:35]
    ds_read_b64_tr_b16 v[62:63], v131 offset:57344
    v_mfma_f32_16x16x32_bf16 a[36:39], v[36:39], v[4:7], a[36:39]
    ds_read_b64_tr_b16 v[64:65], v132 offset:49152
    v_mfma_f32_16x16x32_bf16 a[40:43], v[36:39], v[8:11], a[40:43]
    ds_read_b64_tr_b16 v[66:67], v132 offset:57344
    v_mfma_f32_16x16x32_bf16 a[44:47], v[36:39], v[12:15], a[44:47]
    ds_read_b64_tr_b16 v[68:69], v133 offset:49152
    v_mfma_f32_16x16x32_bf16 a[48:51], v[36:39], v[16:19], a[48:51]
    ds_read_b64_tr_b16 v[70:71], v133 offset:57344
    v_mfma_f32_16x16x32_bf16 a[52:55], v[36:39], v[20:23], a[52:55]
    ds_read_b64_tr_b16 v[72:73], v134 offset:49152
    v_mfma_f32_16x16x32_bf16 a[56:59], v[36:39], v[24:27], a[56:59]
    ds_read_b64_tr_b16 v[74:75], v134 offset:57344
    v_mfma_f32_16x16x32_bf16 a[60:63], v[36:39], v[28:31], a[60:63]
    ds_read_b64_tr_b16 v[76:77], v135 offset:49152
    v_mfma_f32_16x16x32_bf16 a[64:67], v[40:43], v[0:3], a[64:67]
    ds_read_b64_tr_b16 v[78:79], v135 offset:57344
    v_mfma_f32_16x16x32_bf16 a[68:71], v[40:43], v[4:7], a[68:71]
    ds_read_b128 v[84:87], v136 offset:25600
    v_mfma_f32_16x16x32_bf16 a[72:75], v[40:43], v[8:11], a[72:75]
    ds_read_b128 v[88:91], v136 offset:26624
    v_mfma_f32_16x16x32_bf16 a[76:79], v[40:43], v[12:15], a[76:79]
    ds_read_b128 v[92:95], v136 offset:27648
    v_mfma_f32_16x16x32_bf16 a[80:83], v[40:43], v[16:19], a[80:83]
    v_mfma_f32_16x16x32_bf16 a[84:87], v[40:43], v[20:23], a[84:87]
    v_mfma_f32_16x16x32_bf16 a[88:91], v[40:43], v[24:27], a[88:91]
    v_mfma_f32_16x16x32_bf16 a[92:95], v[40:43], v[28:31], a[92:95]
    v_mfma_f32_16x16x32_bf16 a[96:99], v[44:47], v[0:3], a[96:99]
    v_mfma_f32_16x16x32_bf16 a[100:103], v[44:47], v[4:7], a[100:103]
    v_mfma_f32_16x16x32_bf16 a[104:107], v[44:47], v[8:11], a[104:107]
    v_mfma_f32_16x16x32_bf16 a[108:111], v[44:47], v[12:15], a[108:111]
    v_mfma_f32_16x16x32_bf16 a[112:115], v[44:47], v[16:19], a[112:115]
    v_mfma_f32_16x16x32_bf16 a[116:119], v[44:47], v[20:23], a[116:119]
    v_mfma_f32_16x16x32_bf16 a[120:123], v[44:47], v[24:27], a[120:123]
    v_mfma_f32_16x16x32_bf16 a[124:127], v[44:47], v[28:31], a[124:127]
    v_readfirstlane_b32 s55, v255
    s_waitcnt lgkmcnt(0)
    v_mfma_f32_16x16x32_bf16 a[0:3], v[80:83], v[48:51], a[0:3]
    v_mfma_f32_16x16x32_bf16 a[4:7], v[80:83], v[52:55], a[4:7]
    v_mfma_f32_16x16x32_bf16 a[8:11], v[80:83], v[56:59], a[8:11]
    v_mfma_f32_16x16x32_bf16 a[12:15], v[80:83], v[60:63], a[12:15]
    v_mfma_f32_16x16x32_bf16 a[16:19], v[80:83], v[64:67], a[16:19]
    v_mfma_f32_16x16x32_bf16 a[20:23], v[80:83], v[68:71], a[20:23]
    v_mfma_f32_16x16x32_bf16 a[24:27], v[80:83], v[72:75], a[24:27]
    v_mfma_f32_16x16x32_bf16 a[28:31], v[80:83], v[76:79], a[28:31]
    v_mfma_f32_16x16x32_bf16 a[32:35], v[84:87], v[48:51], a[32:35]
    v_mfma_f32_16x16x32_bf16 a[36:39], v[84:87], v[52:55], a[36:39]
    v_mfma_f32_16x16x32_bf16 a[40:43], v[84:87], v[56:59], a[40:43]
    v_mfma_f32_16x16x32_bf16 a[44:47], v[84:87], v[60:63], a[44:47]
    v_mfma_f32_16x16x32_bf16 a[48:51], v[84:87], v[64:67], a[48:51]
    v_mfma_f32_16x16x32_bf16 a[52:55], v[84:87], v[68:71], a[52:55]
    v_mfma_f32_16x16x32_bf16 a[56:59], v[84:87], v[72:75], a[56:59]
    v_mfma_f32_16x16x32_bf16 a[60:63], v[84:87], v[76:79], a[60:63]
    v_mfma_f32_16x16x32_bf16 a[64:67], v[88:91], v[48:51], a[64:67]
    v_mfma_f32_16x16x32_bf16 a[68:71], v[88:91], v[52:55], a[68:71]
    v_mfma_f32_16x16x32_bf16 a[72:75], v[88:91], v[56:59], a[72:75]
    v_mfma_f32_16x16x32_bf16 a[76:79], v[88:91], v[60:63], a[76:79]
    v_mfma_f32_16x16x32_bf16 a[80:83], v[88:91], v[64:67], a[80:83]
    v_mfma_f32_16x16x32_bf16 a[84:87], v[88:91], v[68:71], a[84:87]
    v_mfma_f32_16x16x32_bf16 a[88:91], v[88:91], v[72:75], a[88:91]
    v_mfma_f32_16x16x32_bf16 a[92:95], v[88:91], v[76:79], a[92:95]
    v_mfma_f32_16x16x32_bf16 a[96:99], v[92:95], v[48:51], a[96:99]
    v_mfma_f32_16x16x32_bf16 a[100:103], v[92:95], v[52:55], a[100:103]
    v_mfma_f32_16x16x32_bf16 a[104:107], v[92:95], v[56:59], a[104:107]
    v_mfma_f32_16x16x32_bf16 a[108:111], v[92:95], v[60:63], a[108:111]
    v_mfma_f32_16x16x32_bf16 a[112:115], v[92:95], v[64:67], a[112:115]
    v_mfma_f32_16x16x32_bf16 a[116:119], v[92:95], v[68:71], a[116:119]
    v_mfma_f32_16x16x32_bf16 a[120:123], v[92:95], v[72:75], a[120:123]
    v_mfma_f32_16x16x32_bf16 a[124:127], v[92:95], v[76:79], a[124:127]
    s_nop 7
    s_mov_b32 s53, s21
    v_accvgpr_read_b32 v0, a0
    v_accvgpr_read_b32 v1, a1
    v_accvgpr_read_b32 v2, a2
    v_accvgpr_read_b32 v3, a3
    v_accvgpr_read_b32 v4, a32
    v_accvgpr_read_b32 v5, a33
    v_accvgpr_read_b32 v6, a34
    v_accvgpr_read_b32 v7, a35
    v_cvt_pk_bf16_f32 v8, v0, v1
    v_cvt_pk_bf16_f32 v9, v2, v3
    v_cvt_pk_bf16_f32 v10, v4, v5
    v_cvt_pk_bf16_f32 v11, v6, v7
    buffer_store_dwordx4 v[8:11], v251, s[4:7], s53 offen offset:0 sc1
    v_accvgpr_read_b32 v16, a4
    v_accvgpr_read_b32 v17, a5
    v_accvgpr_read_b32 v18, a6
    v_accvgpr_read_b32 v19, a7
    v_accvgpr_read_b32 v20, a36
    v_accvgpr_read_b32 v21, a37
    v_accvgpr_read_b32 v22, a38
    v_accvgpr_read_b32 v23, a39
    v_cvt_pk_bf16_f32 v24, v16, v17
    v_cvt_pk_bf16_f32 v25, v18, v19
    v_cvt_pk_bf16_f32 v26, v20, v21
    v_cvt_pk_bf16_f32 v27, v22, v23
    buffer_store_dwordx4 v[24:27], v251, s[4:7], s53 offen offset:1024 sc1
    v_accvgpr_read_b32 v32, a8
    v_accvgpr_read_b32 v33, a9
    v_accvgpr_read_b32 v34, a10
    v_accvgpr_read_b32 v35, a11
    v_accvgpr_read_b32 v36, a40
    v_accvgpr_read_b32 v37, a41
    v_accvgpr_read_b32 v38, a42
    v_accvgpr_read_b32 v39, a43
    v_cvt_pk_bf16_f32 v40, v32, v33
    v_cvt_pk_bf16_f32 v41, v34, v35
    v_cvt_pk_bf16_f32 v42, v36, v37
    v_cvt_pk_bf16_f32 v43, v38, v39
    buffer_store_dwordx4 v[40:43], v251, s[4:7], s53 offen offset:2048 sc1
    v_accvgpr_read_b32 v48, a12
    v_accvgpr_read_b32 v49, a13
    v_accvgpr_read_b32 v50, a14
    v_accvgpr_read_b32 v51, a15
    v_accvgpr_read_b32 v52, a44
    v_accvgpr_read_b32 v53, a45
    v_accvgpr_read_b32 v54, a46
    v_accvgpr_read_b32 v55, a47
    v_cvt_pk_bf16_f32 v56, v48, v49
    v_cvt_pk_bf16_f32 v57, v50, v51
    v_cvt_pk_bf16_f32 v58, v52, v53
    v_cvt_pk_bf16_f32 v59, v54, v55
    buffer_store_dwordx4 v[56:59], v251, s[4:7], s53 offen offset:3072 sc1
    s_add_u32 s53, s53, 4096
    v_accvgpr_read_b32 v0, a16
    v_accvgpr_read_b32 v1, a17
    v_accvgpr_read_b32 v2, a18
    v_accvgpr_read_b32 v3, a19
    v_accvgpr_read_b32 v4, a48
    v_accvgpr_read_b32 v5, a49
    v_accvgpr_read_b32 v6, a50
    v_accvgpr_read_b32 v7, a51
    v_cvt_pk_bf16_f32 v8, v0, v1
    v_cvt_pk_bf16_f32 v9, v2, v3
    v_cvt_pk_bf16_f32 v10, v4, v5
    v_cvt_pk_bf16_f32 v11, v6, v7
    buffer_store_dwordx4 v[8:11], v251, s[4:7], s53 offen offset:0 sc1
    v_accvgpr_read_b32 v16, a20
    v_accvgpr_read_b32 v17, a21
    v_accvgpr_read_b32 v18, a22
    v_accvgpr_read_b32 v19, a23
    v_accvgpr_read_b32 v20, a52
    v_accvgpr_read_b32 v21, a53
    v_accvgpr_read_b32 v22, a54
    v_accvgpr_read_b32 v23, a55
    v_cvt_pk_bf16_f32 v24, v16, v17
    v_cvt_pk_bf16_f32 v25, v18, v19
    v_cvt_pk_bf16_f32 v26, v20, v21
    v_cvt_pk_bf16_f32 v27, v22, v23
    buffer_store_dwordx4 v[24:27], v251, s[4:7], s53 offen offset:1024 sc1
    v_accvgpr_read_b32 v32, a24
    v_accvgpr_read_b32 v33, a25
    v_accvgpr_read_b32 v34, a26
    v_accvgpr_read_b32 v35, a27
    v_accvgpr_read_b32 v36, a56
    v_accvgpr_read_b32 v37, a57
    v_accvgpr_read_b32 v38, a58
    v_accvgpr_read_b32 v39, a59
    v_cvt_pk_bf16_f32 v40, v32, v33
    v_cvt_pk_bf16_f32 v41, v34, v35
    v_cvt_pk_bf16_f32 v42, v36, v37
    v_cvt_pk_bf16_f32 v43, v38, v39
    buffer_store_dwordx4 v[40:43], v251, s[4:7], s53 offen offset:2048 sc1
    v_accvgpr_read_b32 v48, a28
    v_accvgpr_read_b32 v49, a29
    v_accvgpr_read_b32 v50, a30
    v_accvgpr_read_b32 v51, a31
    v_accvgpr_read_b32 v52, a60
    v_accvgpr_read_b32 v53, a61
    v_accvgpr_read_b32 v54, a62
    v_accvgpr_read_b32 v55, a63
    v_cvt_pk_bf16_f32 v56, v48, v49
    v_cvt_pk_bf16_f32 v57, v50, v51
    v_cvt_pk_bf16_f32 v58, v52, v53
    v_cvt_pk_bf16_f32 v59, v54, v55
    buffer_store_dwordx4 v[56:59], v251, s[4:7], s53 offen offset:3072 sc1
    s_add_u32 s53, s53, 258048
    v_accvgpr_read_b32 v0, a64
    v_accvgpr_read_b32 v1, a65
    v_accvgpr_read_b32 v2, a66
    v_accvgpr_read_b32 v3, a67
    v_accvgpr_read_b32 v4, a96
    v_accvgpr_read_b32 v5, a97
    v_accvgpr_read_b32 v6, a98
    v_accvgpr_read_b32 v7, a99
    v_cvt_pk_bf16_f32 v8, v0, v1
    v_cvt_pk_bf16_f32 v9, v2, v3
    v_cvt_pk_bf16_f32 v10, v4, v5
    v_cvt_pk_bf16_f32 v11, v6, v7
    buffer_store_dwordx4 v[8:11], v251, s[4:7], s53 offen offset:0 sc1
    v_accvgpr_read_b32 v16, a68
    v_accvgpr_read_b32 v17, a69
    v_accvgpr_read_b32 v18, a70
    v_accvgpr_read_b32 v19, a71
    v_accvgpr_read_b32 v20, a100
    v_accvgpr_read_b32 v21, a101
    v_accvgpr_read_b32 v22, a102
    v_accvgpr_read_b32 v23, a103
    v_cvt_pk_bf16_f32 v24, v16, v17
    v_cvt_pk_bf16_f32 v25, v18, v19
    v_cvt_pk_bf16_f32 v26, v20, v21
    v_cvt_pk_bf16_f32 v27, v22, v23
    buffer_store_dwordx4 v[24:27], v251, s[4:7], s53 offen offset:1024 sc1
    v_accvgpr_read_b32 v32, a72
    v_accvgpr_read_b32 v33, a73
    v_accvgpr_read_b32 v34, a74
    v_accvgpr_read_b32 v35, a75
    v_accvgpr_read_b32 v36, a104
    v_accvgpr_read_b32 v37, a105
    v_accvgpr_read_b32 v38, a106
    v_accvgpr_read_b32 v39, a107
    v_cvt_pk_bf16_f32 v40, v32, v33
    v_cvt_pk_bf16_f32 v41, v34, v35
    v_cvt_pk_bf16_f32 v42, v36, v37
    v_cvt_pk_bf16_f32 v43, v38, v39
    buffer_store_dwordx4 v[40:43], v251, s[4:7], s53 offen offset:2048 sc1
    v_accvgpr_read_b32 v48, a76
    v_accvgpr_read_b32 v49, a77
    v_accvgpr_read_b32 v50, a78
    v_accvgpr_read_b32 v51, a79
    v_accvgpr_read_b32 v52, a108
    v_accvgpr_read_b32 v53, a109
    v_accvgpr_read_b32 v54, a110
    v_accvgpr_read_b32 v55, a111
    v_cvt_pk_bf16_f32 v56, v48, v49
    v_cvt_pk_bf16_f32 v57, v50, v51
    v_cvt_pk_bf16_f32 v58, v52, v53
    v_cvt_pk_bf16_f32 v59, v54, v55
    buffer_store_dwordx4 v[56:59], v251, s[4:7], s53 offen offset:3072 sc1
    s_add_u32 s53, s53, 4096
    v_accvgpr_read_b32 v0, a80
    v_accvgpr_read_b32 v1, a81
    v_accvgpr_read_b32 v2, a82
    v_accvgpr_read_b32 v3, a83
    v_accvgpr_read_b32 v4, a112
    v_accvgpr_read_b32 v5, a113
    v_accvgpr_read_b32 v6, a114
    v_accvgpr_read_b32 v7, a115
    v_cvt_pk_bf16_f32 v8, v0, v1
    v_cvt_pk_bf16_f32 v9, v2, v3
    v_cvt_pk_bf16_f32 v10, v4, v5
    v_cvt_pk_bf16_f32 v11, v6, v7
    buffer_store_dwordx4 v[8:11], v251, s[4:7], s53 offen offset:0 sc1
    v_accvgpr_read_b32 v16, a84
    v_accvgpr_read_b32 v17, a85
    v_accvgpr_read_b32 v18, a86
    v_accvgpr_read_b32 v19, a87
    v_accvgpr_read_b32 v20, a116
    v_accvgpr_read_b32 v21, a117
    v_accvgpr_read_b32 v22, a118
    v_accvgpr_read_b32 v23, a119
    v_cvt_pk_bf16_f32 v24, v16, v17
    v_cvt_pk_bf16_f32 v25, v18, v19
    v_cvt_pk_bf16_f32 v26, v20, v21
    v_cvt_pk_bf16_f32 v27, v22, v23
    buffer_store_dwordx4 v[24:27], v251, s[4:7], s53 offen offset:1024 sc1
    v_accvgpr_read_b32 v32, a88
    v_accvgpr_read_b32 v33, a89
    v_accvgpr_read_b32 v34, a90
    v_accvgpr_read_b32 v35, a91
    v_accvgpr_read_b32 v36, a120
    v_accvgpr_read_b32 v37, a121
    v_accvgpr_read_b32 v38, a122
    v_accvgpr_read_b32 v39, a123
    v_cvt_pk_bf16_f32 v40, v32, v33
    v_cvt_pk_bf16_f32 v41, v34, v35
    v_cvt_pk_bf16_f32 v42, v36, v37
    v_cvt_pk_bf16_f32 v43, v38, v39
    buffer_store_dwordx4 v[40:43], v251, s[4:7], s53 offen offset:2048 sc1
    v_accvgpr_read_b32 v48, a92
    v_accvgpr_read_b32 v49, a93
    v_accvgpr_read_b32 v50, a94
    v_accvgpr_read_b32 v51, a95
    v_accvgpr_read_b32 v52, a124
    v_accvgpr_read_b32 v53, a125
    v_accvgpr_read_b32 v54, a126
    v_accvgpr_read_b32 v55, a127
    v_cvt_pk_bf16_f32 v56, v48, v49
    v_cvt_pk_bf16_f32 v57, v50, v51
    v_cvt_pk_bf16_f32 v58, v52, v53
    v_cvt_pk_bf16_f32 v59, v54, v55
    buffer_store_dwordx4 v[56:59], v251, s[4:7], s53 offen offset:3072 sc1
    s_add_u32 s53, s53, 258048
    s_branch main_kernel_w_done
main_kernel_w_c2_task:
    s_cmp_eq_u32 s23, 0
    s_cbranch_scc1 main_kernel_w_c2_set0
    s_cmp_eq_u32 s23, 1
    s_cbranch_scc1 main_kernel_w_c2_set1
    s_cmp_eq_u32 s23, 2
    s_cbranch_scc1 main_kernel_w_c2_set2
    s_cmp_eq_u32 s23, 6
    s_cbranch_scc1 main_kernel_w_c2_set6
    s_branch main_kernel_w_done
main_kernel_w_c2_set0:
    s_lshl_b32 s32, s25, 8
    s_add_u32 s8, s40, s32
    s_addc_u32 s9, s41, 0
    s_and_b32 s9, s9, 0xffff
    s_sub_u32 s10, 0x800000, s32
    s_mov_b32 s11, 0x20000
    s_mov_b32 s30, 8192
    s_mov_b32 s31, 32768
    s_mul_i32 s16, s24, 262144
    s_add_u32 s16, s16, 0x0
    s_mov_b32 s18, 7
    s_lshl_b32 s32, s24, 3
    s_mul_i32 s33, s38, 8
    s_add_u32 s32, s32, s33
    s_mul_i32 s32, s32, 131072
    s_lshl_b32 s33, s25, 12
    s_add_u32 s32, s32, s33
    s_mul_i32 s33, s37, 4096
    s_add_u32 s32, s32, s33
    s_add_u32 s21, s32, 0x800000
    s_mov_b32 s22, 131072
    s_mov_b32 s26, -1
    s_branch main_kernel_w_c2_go
main_kernel_w_c2_set1:
    s_lshl_b32 s32, s25, 8
    s_add_u32 s8, s42, s32
    s_addc_u32 s9, s43, 0
    s_and_b32 s9, s9, 0xffff
    s_sub_u32 s10, 0x800000, s32
    s_mov_b32 s11, 0x20000
    s_mov_b32 s30, 8192
    s_mov_b32 s31, 32768
    s_mul_i32 s16, s24, 262144
    s_add_u32 s16, s16, 0x0
    s_mov_b32 s18, 7
    s_lshl_b32 s32, s24, 3
    s_mul_i32 s33, s38, 8
    s_add_u32 s32, s32, s33
    s_mul_i32 s32, s32, 131072
    s_lshl_b32 s33, s25, 12
    s_add_u32 s32, s32, s33
    s_mul_i32 s33, s37, 4096
    s_add_u32 s32, s32, s33
    s_add_u32 s21, s32, 0x1800000
    s_mov_b32 s22, 131072
    s_mov_b32 s26, -1
    s_branch main_kernel_w_c2_go
main_kernel_w_c2_set2:
    s_lshl_b32 s32, s25, 8
    s_add_u32 s8, s44, s32
    s_addc_u32 s9, s45, 0
    s_and_b32 s9, s9, 0xffff
    s_sub_u32 s10, 0x800000, s32
    s_mov_b32 s11, 0x20000
    s_mov_b32 s30, 8192
    s_mov_b32 s31, 32768
    s_mul_i32 s16, s24, 262144
    s_add_u32 s16, s16, 0x0
    s_mov_b32 s18, 7
    s_lshl_b32 s32, s24, 2
    s_mul_i32 s33, s38, 4
    s_add_u32 s32, s32, s33
    s_lshl_b32 s32, s32, 18
    s_lshl_b32 s33, s25, 13
    s_add_u32 s32, s32, s33
    s_mul_i32 s33, s37, 8192
    s_add_u32 s32, s32, s33
    s_add_u32 s21, s32, 0x2800000
    s_branch main_kernel_w_c2_gov
main_kernel_w_c2_set6:
    s_lshl_b32 s32, s25, 8
    s_add_u32 s8, s68, s32
    s_addc_u32 s9, s69, 0
    s_and_b32 s9, s9, 0xffff
    s_sub_u32 s10, 0x700000, s32
    s_mov_b32 s11, 0x20000
    s_mov_b32 s30, 7168
    s_mov_b32 s31, 32768
    s_mul_i32 s16, s24, 262144
    s_add_u32 s16, s16, 0x6800000
    s_mov_b32 s18, 7
    s_lshl_b32 s32, s24, 3
    s_mul_i32 s33, s38, 8
    s_add_u32 s32, s32, s33
    s_mul_i32 s32, s32, 114688
    s_lshl_b32 s33, s25, 12
    s_add_u32 s32, s32, s33
    s_mul_i32 s33, s37, 4096
    s_add_u32 s32, s32, s33
    s_add_u32 s21, s32, 0x5400000
    s_mov_b32 s22, 114688
    s_mov_b32 s26, -1
    s_branch main_kernel_w_c2_go
main_kernel_w_c2_go:
    v_lshrrev_b32 v0, 4, v250
    v_bfe_u32 v1, v250, 2, 2
    v_lshl_add_u32 v4, v0, 2, v1
    v_and_b32 v5, 7, v4
    v_mul_u32_u24 v4, 512, v4
    v_and_b32 v6, 3, v250
    v_lshl_add_u32 v4, v6, 3, v4
    s_mul_i32 s32, s37, 8
    v_xor_b32 v5, s32, v5
    v_lshl_add_u32 v128, v5, 5, v4
    v_xor_b32 v129, 32, v128
    v_xor_b32 v130, 64, v128
    v_xor_b32 v131, 96, v128
    v_xor_b32 v132, 128, v128
    v_xor_b32 v133, 160, v128
    v_xor_b32 v134, 192, v128
    v_xor_b32 v135, 224, v128
    s_mul_i32 s32, s38, 8192
    s_add_u32 s32, s32, 65536
    v_add_u32 v136, s32, v251
    v_lshrrev_b32 v2, 5, v250
    v_and_b32 v3, 31, v250
    s_mul_i32 s32, s14, 8
    v_add_u32 v4, s32, v2
    v_add_u32 v5, 0, v4
    v_and_b32 v6, 7, v5
    v_lshlrev_b32 v6, 1, v6
    v_xor_b32 v6, v6, v3
    v_mul_lo_u32 v5, v5, s30
    v_lshl_add_u32 v5, v6, 4, v5
    v_subrev_u32 v137, 0, v5
    v_add_u32 v5, 2, v4
    v_and_b32 v6, 7, v5
    v_lshlrev_b32 v6, 1, v6
    v_xor_b32 v6, v6, v3
    v_mul_lo_u32 v5, v5, s30
    v_lshl_add_u32 v5, v6, 4, v5
    v_subrev_u32 v138, 1024, v5
    v_add_u32 v5, 4, v4
    v_and_b32 v6, 7, v5
    v_lshlrev_b32 v6, 1, v6
    v_xor_b32 v6, v6, v3
    v_mul_lo_u32 v5, v5, s30
    v_lshl_add_u32 v5, v6, 4, v5
    v_subrev_u32 v139, 2048, v5
    v_add_u32 v5, 6, v4
    v_and_b32 v6, 7, v5
    v_lshlrev_b32 v6, 1, v6
    v_xor_b32 v6, v6, v3
    v_mul_lo_u32 v5, v5, s30
    v_lshl_add_u32 v5, v6, 4, v5
    v_subrev_u32 v140, 3072, v5
    s_mul_i32 s32, s14, 4
    s_mul_i32 s32, s32, s31
    v_add_u32 v141, s32, v251
    s_add_u32 s32, s32, s31
    s_sub_u32 s32, s32, 1024
    v_add_u32 v142, s32, v251
    s_add_u32 s32, s32, s31
    s_sub_u32 s32, s32, 1024
    v_add_u32 v143, s32, v251
    s_add_u32 s32, s32, s31
    s_sub_u32 s32, s32, 1024
    v_add_u32 v144, s32, v251
    s_mul_i32 s19, s14, 4096
    s_mul_i32 s20, s14, 4096
    s_add_u32 s20, s20, 65536
    s_mul_i32 s17, s30, 32
    s_mov_b32 s15, 0
    s_add_u32 m0, s20, 0
    s_nop 0
    buffer_load_dwordx4 v141, s[4:7], s16 offen offset:0 sc1 lds
    buffer_load_dwordx4 v142, s[4:7], s16 offen offset:1024 sc1 lds
    buffer_load_dwordx4 v143, s[4:7], s16 offen offset:2048 sc1 lds
    buffer_load_dwordx4 v144, s[4:7], s16 offen offset:3072 sc1 lds
    s_add_u32 s16, s16, 1024
    s_add_u32 m0, s19, 0
    s_nop 0
    buffer_load_dwordx4 v137, s[8:11], s15 offen offset:0 lds
    buffer_load_dwordx4 v138, s[8:11], s15 offen offset:1024 lds
    buffer_load_dwordx4 v139, s[8:11], s15 offen offset:2048 lds
    buffer_load_dwordx4 v140, s[8:11], s15 offen offset:3072 lds
    s_add_u32 s15, s15, s17
    s_add_u32 m0, s20, 16384
    s_nop 0
    buffer_load_dwordx4 v141, s[4:7], s16 offen offset:0 sc1 lds
    buffer_load_dwordx4 v142, s[4:7], s16 offen offset:1024 sc1 lds
    buffer_load_dwordx4 v143, s[4:7], s16 offen offset:2048 sc1 lds
    buffer_load_dwordx4 v144, s[4:7], s16 offen offset:3072 sc1 lds
    s_add_u32 s16, s16, 1024
    s_add_u32 m0, s19, 16384
    s_nop 0
    buffer_load_dwordx4 v137, s[8:11], s15 offen offset:0 lds
    buffer_load_dwordx4 v138, s[8:11], s15 offen offset:1024 lds
    buffer_load_dwordx4 v139, s[8:11], s15 offen offset:2048 lds
    buffer_load_dwordx4 v140, s[8:11], s15 offen offset:3072 lds
    s_add_u32 s15, s15, s17
    s_add_u32 m0, s20, 32768
    s_nop 0
    buffer_load_dwordx4 v141, s[4:7], s16 offen offset:0 sc1 lds
    buffer_load_dwordx4 v142, s[4:7], s16 offen offset:1024 sc1 lds
    buffer_load_dwordx4 v143, s[4:7], s16 offen offset:2048 sc1 lds
    buffer_load_dwordx4 v144, s[4:7], s16 offen offset:3072 sc1 lds
    s_add_u32 s16, s16, 1024
    s_add_u32 m0, s19, 32768
    s_nop 0
    buffer_load_dwordx4 v137, s[8:11], s15 offen offset:0 lds
    buffer_load_dwordx4 v138, s[8:11], s15 offen offset:1024 lds
    buffer_load_dwordx4 v139, s[8:11], s15 offen offset:2048 lds
    buffer_load_dwordx4 v140, s[8:11], s15 offen offset:3072 lds
    s_add_u32 s15, s15, s17
    s_add_u32 m0, s20, 49152
    s_nop 0
    buffer_load_dwordx4 v141, s[4:7], s16 offen offset:0 sc1 lds
    buffer_load_dwordx4 v142, s[4:7], s16 offen offset:1024 sc1 lds
    buffer_load_dwordx4 v143, s[4:7], s16 offen offset:2048 sc1 lds
    buffer_load_dwordx4 v144, s[4:7], s16 offen offset:3072 sc1 lds
    s_add_u32 s16, s16, 1024
    s_add_u32 m0, s19, 49152
    s_nop 0
    buffer_load_dwordx4 v137, s[8:11], s15 offen offset:0 lds
    buffer_load_dwordx4 v138, s[8:11], s15 offen offset:1024 lds
    buffer_load_dwordx4 v139, s[8:11], s15 offen offset:2048 lds
    buffer_load_dwordx4 v140, s[8:11], s15 offen offset:3072 lds
    s_add_u32 s15, s15, s17
    v_accvgpr_write_b32 a0, 0
    v_accvgpr_write_b32 a1, 0
    v_accvgpr_write_b32 a2, 0
    v_accvgpr_write_b32 a3, 0
    v_accvgpr_write_b32 a4, 0
    v_accvgpr_write_b32 a5, 0
    v_accvgpr_write_b32 a6, 0
    v_accvgpr_write_b32 a7, 0
    v_accvgpr_write_b32 a8, 0
    v_accvgpr_write_b32 a9, 0
    v_accvgpr_write_b32 a10, 0
    v_accvgpr_write_b32 a11, 0
    v_accvgpr_write_b32 a12, 0
    v_accvgpr_write_b32 a13, 0
    v_accvgpr_write_b32 a14, 0
    v_accvgpr_write_b32 a15, 0
    v_accvgpr_write_b32 a16, 0
    v_accvgpr_write_b32 a17, 0
    v_accvgpr_write_b32 a18, 0
    v_accvgpr_write_b32 a19, 0
    v_accvgpr_write_b32 a20, 0
    v_accvgpr_write_b32 a21, 0
    v_accvgpr_write_b32 a22, 0
    v_accvgpr_write_b32 a23, 0
    v_accvgpr_write_b32 a24, 0
    v_accvgpr_write_b32 a25, 0
    v_accvgpr_write_b32 a26, 0
    v_accvgpr_write_b32 a27, 0
    v_accvgpr_write_b32 a28, 0
    v_accvgpr_write_b32 a29, 0
    v_accvgpr_write_b32 a30, 0
    v_accvgpr_write_b32 a31, 0
    v_accvgpr_write_b32 a32, 0
    v_accvgpr_write_b32 a33, 0
    v_accvgpr_write_b32 a34, 0
    v_accvgpr_write_b32 a35, 0
    v_accvgpr_write_b32 a36, 0
    v_accvgpr_write_b32 a37, 0
    v_accvgpr_write_b32 a38, 0
    v_accvgpr_write_b32 a39, 0
    v_accvgpr_write_b32 a40, 0
    v_accvgpr_write_b32 a41, 0
    v_accvgpr_write_b32 a42, 0
    v_accvgpr_write_b32 a43, 0
    v_accvgpr_write_b32 a44, 0
    v_accvgpr_write_b32 a45, 0
    v_accvgpr_write_b32 a46, 0
    v_accvgpr_write_b32 a47, 0
    v_accvgpr_write_b32 a48, 0
    v_accvgpr_write_b32 a49, 0
    v_accvgpr_write_b32 a50, 0
    v_accvgpr_write_b32 a51, 0
    v_accvgpr_write_b32 a52, 0
    v_accvgpr_write_b32 a53, 0
    v_accvgpr_write_b32 a54, 0
    v_accvgpr_write_b32 a55, 0
    v_accvgpr_write_b32 a56, 0
    v_accvgpr_write_b32 a57, 0
    v_accvgpr_write_b32 a58, 0
    v_accvgpr_write_b32 a59, 0
    v_accvgpr_write_b32 a60, 0
    v_accvgpr_write_b32 a61, 0
    v_accvgpr_write_b32 a62, 0
    v_accvgpr_write_b32 a63, 0
    v_accvgpr_write_b32 a64, 0
    v_accvgpr_write_b32 a65, 0
    v_accvgpr_write_b32 a66, 0
    v_accvgpr_write_b32 a67, 0
    v_accvgpr_write_b32 a68, 0
    v_accvgpr_write_b32 a69, 0
    v_accvgpr_write_b32 a70, 0
    v_accvgpr_write_b32 a71, 0
    v_accvgpr_write_b32 a72, 0
    v_accvgpr_write_b32 a73, 0
    v_accvgpr_write_b32 a74, 0
    v_accvgpr_write_b32 a75, 0
    v_accvgpr_write_b32 a76, 0
    v_accvgpr_write_b32 a77, 0
    v_accvgpr_write_b32 a78, 0
    v_accvgpr_write_b32 a79, 0
    v_accvgpr_write_b32 a80, 0
    v_accvgpr_write_b32 a81, 0
    v_accvgpr_write_b32 a82, 0
    v_accvgpr_write_b32 a83, 0
    v_accvgpr_write_b32 a84, 0
    v_accvgpr_write_b32 a85, 0
    v_accvgpr_write_b32 a86, 0
    v_accvgpr_write_b32 a87, 0
    v_accvgpr_write_b32 a88, 0
    v_accvgpr_write_b32 a89, 0
    v_accvgpr_write_b32 a90, 0
    v_accvgpr_write_b32 a91, 0
    v_accvgpr_write_b32 a92, 0
    v_accvgpr_write_b32 a93, 0
    v_accvgpr_write_b32 a94, 0
    v_accvgpr_write_b32 a95, 0
    v_accvgpr_write_b32 a96, 0
    v_accvgpr_write_b32 a97, 0
    v_accvgpr_write_b32 a98, 0
    v_accvgpr_write_b32 a99, 0
    v_accvgpr_write_b32 a100, 0
    v_accvgpr_write_b32 a101, 0
    v_accvgpr_write_b32 a102, 0
    v_accvgpr_write_b32 a103, 0
    v_accvgpr_write_b32 a104, 0
    v_accvgpr_write_b32 a105, 0
    v_accvgpr_write_b32 a106, 0
    v_accvgpr_write_b32 a107, 0
    v_accvgpr_write_b32 a108, 0
    v_accvgpr_write_b32 a109, 0
    v_accvgpr_write_b32 a110, 0
    v_accvgpr_write_b32 a111, 0
    v_accvgpr_write_b32 a112, 0
    v_accvgpr_write_b32 a113, 0
    v_accvgpr_write_b32 a114, 0
    v_accvgpr_write_b32 a115, 0
    v_accvgpr_write_b32 a116, 0
    v_accvgpr_write_b32 a117, 0
    v_accvgpr_write_b32 a118, 0
    v_accvgpr_write_b32 a119, 0
    v_accvgpr_write_b32 a120, 0
    v_accvgpr_write_b32 a121, 0
    v_accvgpr_write_b32 a122, 0
    v_accvgpr_write_b32 a123, 0
    v_accvgpr_write_b32 a124, 0
    v_accvgpr_write_b32 a125, 0
    v_accvgpr_write_b32 a126, 0
    v_accvgpr_write_b32 a127, 0
    v_accvgpr_write_b32 a128, 0
    v_accvgpr_write_b32 a129, 0
    v_accvgpr_write_b32 a130, 0
    v_accvgpr_write_b32 a131, 0
    v_accvgpr_write_b32 a132, 0
    v_accvgpr_write_b32 a133, 0
    v_accvgpr_write_b32 a134, 0
    v_accvgpr_write_b32 a135, 0
    v_accvgpr_write_b32 a136, 0
    v_accvgpr_write_b32 a137, 0
    v_accvgpr_write_b32 a138, 0
    v_accvgpr_write_b32 a139, 0
    v_accvgpr_write_b32 a140, 0
    v_accvgpr_write_b32 a141, 0
    v_accvgpr_write_b32 a142, 0
    v_accvgpr_write_b32 a143, 0
    v_accvgpr_write_b32 a144, 0
    v_accvgpr_write_b32 a145, 0
    v_accvgpr_write_b32 a146, 0
    v_accvgpr_write_b32 a147, 0
    v_accvgpr_write_b32 a148, 0
    v_accvgpr_write_b32 a149, 0
    v_accvgpr_write_b32 a150, 0
    v_accvgpr_write_b32 a151, 0
    v_accvgpr_write_b32 a152, 0
    v_accvgpr_write_b32 a153, 0
    v_accvgpr_write_b32 a154, 0
    v_accvgpr_write_b32 a155, 0
    v_accvgpr_write_b32 a156, 0
    v_accvgpr_write_b32 a157, 0
    v_accvgpr_write_b32 a158, 0
    v_accvgpr_write_b32 a159, 0
    v_accvgpr_write_b32 a160, 0
    v_accvgpr_write_b32 a161, 0
    v_accvgpr_write_b32 a162, 0
    v_accvgpr_write_b32 a163, 0
    v_accvgpr_write_b32 a164, 0
    v_accvgpr_write_b32 a165, 0
    v_accvgpr_write_b32 a166, 0
    v_accvgpr_write_b32 a167, 0
    v_accvgpr_write_b32 a168, 0
    v_accvgpr_write_b32 a169, 0
    v_accvgpr_write_b32 a170, 0
    v_accvgpr_write_b32 a171, 0
    v_accvgpr_write_b32 a172, 0
    v_accvgpr_write_b32 a173, 0
    v_accvgpr_write_b32 a174, 0
    v_accvgpr_write_b32 a175, 0
    v_accvgpr_write_b32 a176, 0
    v_accvgpr_write_b32 a177, 0
    v_accvgpr_write_b32 a178, 0
    v_accvgpr_write_b32 a179, 0
    v_accvgpr_write_b32 a180, 0
    v_accvgpr_write_b32 a181, 0
    v_accvgpr_write_b32 a182, 0
    v_accvgpr_write_b32 a183, 0
    v_accvgpr_write_b32 a184, 0
    v_accvgpr_write_b32 a185, 0
    v_accvgpr_write_b32 a186, 0
    v_accvgpr_write_b32 a187, 0
    v_accvgpr_write_b32 a188, 0
    v_accvgpr_write_b32 a189, 0
    v_accvgpr_write_b32 a190, 0
    v_accvgpr_write_b32 a191, 0
    v_accvgpr_write_b32 a192, 0
    v_accvgpr_write_b32 a193, 0
    v_accvgpr_write_b32 a194, 0
    v_accvgpr_write_b32 a195, 0
    v_accvgpr_write_b32 a196, 0
    v_accvgpr_write_b32 a197, 0
    v_accvgpr_write_b32 a198, 0
    v_accvgpr_write_b32 a199, 0
    v_accvgpr_write_b32 a200, 0
    v_accvgpr_write_b32 a201, 0
    v_accvgpr_write_b32 a202, 0
    v_accvgpr_write_b32 a203, 0
    v_accvgpr_write_b32 a204, 0
    v_accvgpr_write_b32 a205, 0
    v_accvgpr_write_b32 a206, 0
    v_accvgpr_write_b32 a207, 0
    v_accvgpr_write_b32 a208, 0
    v_accvgpr_write_b32 a209, 0
    v_accvgpr_write_b32 a210, 0
    v_accvgpr_write_b32 a211, 0
    v_accvgpr_write_b32 a212, 0
    v_accvgpr_write_b32 a213, 0
    v_accvgpr_write_b32 a214, 0
    v_accvgpr_write_b32 a215, 0
    v_accvgpr_write_b32 a216, 0
    v_accvgpr_write_b32 a217, 0
    v_accvgpr_write_b32 a218, 0
    v_accvgpr_write_b32 a219, 0
    v_accvgpr_write_b32 a220, 0
    v_accvgpr_write_b32 a221, 0
    v_accvgpr_write_b32 a222, 0
    v_accvgpr_write_b32 a223, 0
    v_accvgpr_write_b32 a224, 0
    v_accvgpr_write_b32 a225, 0
    v_accvgpr_write_b32 a226, 0
    v_accvgpr_write_b32 a227, 0
    v_accvgpr_write_b32 a228, 0
    v_accvgpr_write_b32 a229, 0
    v_accvgpr_write_b32 a230, 0
    v_accvgpr_write_b32 a231, 0
    v_accvgpr_write_b32 a232, 0
    v_accvgpr_write_b32 a233, 0
    v_accvgpr_write_b32 a234, 0
    v_accvgpr_write_b32 a235, 0
    v_accvgpr_write_b32 a236, 0
    v_accvgpr_write_b32 a237, 0
    v_accvgpr_write_b32 a238, 0
    v_accvgpr_write_b32 a239, 0
    v_accvgpr_write_b32 a240, 0
    v_accvgpr_write_b32 a241, 0
    v_accvgpr_write_b32 a242, 0
    v_accvgpr_write_b32 a243, 0
    v_accvgpr_write_b32 a244, 0
    v_accvgpr_write_b32 a245, 0
    v_accvgpr_write_b32 a246, 0
    v_accvgpr_write_b32 a247, 0
    v_accvgpr_write_b32 a248, 0
    v_accvgpr_write_b32 a249, 0
    v_accvgpr_write_b32 a250, 0
    v_accvgpr_write_b32 a251, 0
    v_accvgpr_write_b32 a252, 0
    v_accvgpr_write_b32 a253, 0
    v_accvgpr_write_b32 a254, 0
    v_accvgpr_write_b32 a255, 0
    s_waitcnt vmcnt(24)
    s_barrier
    ds_read_b128 v[32:35], v136 offset:0
    ds_read_b64_tr_b16 v[0:1], v128 offset:0
    ds_read_b64_tr_b16 v[2:3], v128 offset:8192
    ds_read_b64_tr_b16 v[4:5], v129 offset:0
    ds_read_b64_tr_b16 v[6:7], v129 offset:8192
    ds_read_b64_tr_b16 v[8:9], v130 offset:0
    ds_read_b64_tr_b16 v[10:11], v130 offset:8192
    ds_read_b64_tr_b16 v[12:13], v131 offset:0
    ds_read_b64_tr_b16 v[14:15], v131 offset:8192
    ds_read_b64_tr_b16 v[16:17], v132 offset:0
    ds_read_b64_tr_b16 v[18:19], v132 offset:8192
    ds_read_b64_tr_b16 v[20:21], v133 offset:0
    ds_read_b64_tr_b16 v[22:23], v133 offset:8192
    ds_read_b64_tr_b16 v[24:25], v134 offset:0
    ds_read_b64_tr_b16 v[26:27], v134 offset:8192
    ds_read_b64_tr_b16 v[28:29], v135 offset:0
    ds_read_b64_tr_b16 v[30:31], v135 offset:8192
    ds_read_b128 v[36:39], v136 offset:1024
    ds_read_b128 v[40:43], v136 offset:2048
    ds_read_b128 v[44:47], v136 offset:3072
    ds_read_b128 v[48:51], v136 offset:4096
    ds_read_b128 v[52:55], v136 offset:5120
    ds_read_b128 v[56:59], v136 offset:6144
    ds_read_b128 v[60:63], v136 offset:7168
main_kernel_w_c2_n_loop:
    s_waitcnt lgkmcnt(0)
    v_mfma_f32_16x16x32_bf16 a[0:3], v[0:3], v[32:35], a[0:3]
    s_waitcnt vmcnt(16)
    s_barrier
    ds_read_b128 v[96:99], v136 offset:16384
    s_add_u32 m0, s20, 0
    s_nop 0
    v_mfma_f32_16x16x32_bf16 a[4:7], v[4:7], v[32:35], a[4:7]
    ds_read_b64_tr_b16 v[64:65], v128 offset:16384
    v_mfma_f32_16x16x32_bf16 a[8:11], v[8:11], v[32:35], a[8:11]
    ds_read_b64_tr_b16 v[66:67], v128 offset:24576
    v_mfma_f32_16x16x32_bf16 a[12:15], v[12:15], v[32:35], a[12:15]
    ds_read_b64_tr_b16 v[68:69], v129 offset:16384
    v_mfma_f32_16x16x32_bf16 a[16:19], v[16:19], v[32:35], a[16:19]
    ds_read_b64_tr_b16 v[70:71], v129 offset:24576
    v_mfma_f32_16x16x32_bf16 a[20:23], v[20:23], v[32:35], a[20:23]
    ds_read_b64_tr_b16 v[72:73], v130 offset:16384
    buffer_load_dwordx4 v141, s[4:7], s16 offen offset:0 sc1 lds
    v_mfma_f32_16x16x32_bf16 a[24:27], v[24:27], v[32:35], a[24:27]
    ds_read_b64_tr_b16 v[74:75], v130 offset:24576
    v_mfma_f32_16x16x32_bf16 a[28:31], v[28:31], v[32:35], a[28:31]
    ds_read_b64_tr_b16 v[76:77], v131 offset:16384
    v_mfma_f32_16x16x32_bf16 a[32:35], v[0:3], v[36:39], a[32:35]
    ds_read_b64_tr_b16 v[78:79], v131 offset:24576
    v_mfma_f32_16x16x32_bf16 a[36:39], v[4:7], v[36:39], a[36:39]
    ds_read_b64_tr_b16 v[80:81], v132 offset:16384
    v_mfma_f32_16x16x32_bf16 a[40:43], v[8:11], v[36:39], a[40:43]
    ds_read_b64_tr_b16 v[82:83], v132 offset:24576
    buffer_load_dwordx4 v142, s[4:7], s16 offen offset:1024 sc1 lds
    v_mfma_f32_16x16x32_bf16 a[44:47], v[12:15], v[36:39], a[44:47]
    ds_read_b64_tr_b16 v[84:85], v133 offset:16384
    v_mfma_f32_16x16x32_bf16 a[48:51], v[16:19], v[36:39], a[48:51]
    ds_read_b64_tr_b16 v[86:87], v133 offset:24576
    v_mfma_f32_16x16x32_bf16 a[52:55], v[20:23], v[36:39], a[52:55]
    ds_read_b64_tr_b16 v[88:89], v134 offset:16384
    v_mfma_f32_16x16x32_bf16 a[56:59], v[24:27], v[36:39], a[56:59]
    ds_read_b64_tr_b16 v[90:91], v134 offset:24576
    v_mfma_f32_16x16x32_bf16 a[60:63], v[28:31], v[36:39], a[60:63]
    ds_read_b64_tr_b16 v[92:93], v135 offset:16384
    buffer_load_dwordx4 v143, s[4:7], s16 offen offset:2048 sc1 lds
    v_mfma_f32_16x16x32_bf16 a[64:67], v[0:3], v[40:43], a[64:67]
    ds_read_b64_tr_b16 v[94:95], v135 offset:24576
    v_mfma_f32_16x16x32_bf16 a[68:71], v[4:7], v[40:43], a[68:71]
    ds_read_b128 v[100:103], v136 offset:17408
    v_mfma_f32_16x16x32_bf16 a[72:75], v[8:11], v[40:43], a[72:75]
    ds_read_b128 v[104:107], v136 offset:18432
    v_mfma_f32_16x16x32_bf16 a[76:79], v[12:15], v[40:43], a[76:79]
    ds_read_b128 v[108:111], v136 offset:19456
    v_mfma_f32_16x16x32_bf16 a[80:83], v[16:19], v[40:43], a[80:83]
    ds_read_b128 v[112:115], v136 offset:20480
    v_mfma_f32_16x16x32_bf16 a[84:87], v[20:23], v[40:43], a[84:87]
    ds_read_b128 v[116:119], v136 offset:21504
    buffer_load_dwordx4 v144, s[4:7], s16 offen offset:3072 sc1 lds
    v_mfma_f32_16x16x32_bf16 a[88:91], v[24:27], v[40:43], a[88:91]
    ds_read_b128 v[120:123], v136 offset:22528
    v_mfma_f32_16x16x32_bf16 a[92:95], v[28:31], v[40:43], a[92:95]
    ds_read_b128 v[124:127], v136 offset:23552
    v_mfma_f32_16x16x32_bf16 a[96:99], v[0:3], v[44:47], a[96:99]
    v_mfma_f32_16x16x32_bf16 a[100:103], v[4:7], v[44:47], a[100:103]
    v_mfma_f32_16x16x32_bf16 a[104:107], v[8:11], v[44:47], a[104:107]
    s_add_u32 s16, s16, 1024
    v_mfma_f32_16x16x32_bf16 a[108:111], v[12:15], v[44:47], a[108:111]
    v_mfma_f32_16x16x32_bf16 a[112:115], v[16:19], v[44:47], a[112:115]
    v_mfma_f32_16x16x32_bf16 a[116:119], v[20:23], v[44:47], a[116:119]
    v_mfma_f32_16x16x32_bf16 a[120:123], v[24:27], v[44:47], a[120:123]
    v_mfma_f32_16x16x32_bf16 a[124:127], v[28:31], v[44:47], a[124:127]
    s_add_u32 m0, s19, 0
    s_nop 0
    v_mfma_f32_16x16x32_bf16 a[128:131], v[0:3], v[48:51], a[128:131]
    v_mfma_f32_16x16x32_bf16 a[132:135], v[4:7], v[48:51], a[132:135]
    v_mfma_f32_16x16x32_bf16 a[136:139], v[8:11], v[48:51], a[136:139]
    v_mfma_f32_16x16x32_bf16 a[140:143], v[12:15], v[48:51], a[140:143]
    v_mfma_f32_16x16x32_bf16 a[144:147], v[16:19], v[48:51], a[144:147]
    buffer_load_dwordx4 v137, s[8:11], s15 offen offset:0 lds
    v_mfma_f32_16x16x32_bf16 a[148:151], v[20:23], v[48:51], a[148:151]
    v_mfma_f32_16x16x32_bf16 a[152:155], v[24:27], v[48:51], a[152:155]
    v_mfma_f32_16x16x32_bf16 a[156:159], v[28:31], v[48:51], a[156:159]
    v_mfma_f32_16x16x32_bf16 a[160:163], v[0:3], v[52:55], a[160:163]
    v_mfma_f32_16x16x32_bf16 a[164:167], v[4:7], v[52:55], a[164:167]
    v_mfma_f32_16x16x32_bf16 a[168:171], v[8:11], v[52:55], a[168:171]
    buffer_load_dwordx4 v138, s[8:11], s15 offen offset:1024 lds
    v_mfma_f32_16x16x32_bf16 a[172:175], v[12:15], v[52:55], a[172:175]
    v_mfma_f32_16x16x32_bf16 a[176:179], v[16:19], v[52:55], a[176:179]
    v_mfma_f32_16x16x32_bf16 a[180:183], v[20:23], v[52:55], a[180:183]
    v_mfma_f32_16x16x32_bf16 a[184:187], v[24:27], v[52:55], a[184:187]
    v_mfma_f32_16x16x32_bf16 a[188:191], v[28:31], v[52:55], a[188:191]
    buffer_load_dwordx4 v139, s[8:11], s15 offen offset:2048 lds
    v_mfma_f32_16x16x32_bf16 a[192:195], v[0:3], v[56:59], a[192:195]
    v_mfma_f32_16x16x32_bf16 a[196:199], v[4:7], v[56:59], a[196:199]
    v_mfma_f32_16x16x32_bf16 a[200:203], v[8:11], v[56:59], a[200:203]
    v_mfma_f32_16x16x32_bf16 a[204:207], v[12:15], v[56:59], a[204:207]
    v_mfma_f32_16x16x32_bf16 a[208:211], v[16:19], v[56:59], a[208:211]
    buffer_load_dwordx4 v140, s[8:11], s15 offen offset:3072 lds
    v_mfma_f32_16x16x32_bf16 a[212:215], v[20:23], v[56:59], a[212:215]
    v_mfma_f32_16x16x32_bf16 a[216:219], v[24:27], v[56:59], a[216:219]
    v_mfma_f32_16x16x32_bf16 a[220:223], v[28:31], v[56:59], a[220:223]
    v_mfma_f32_16x16x32_bf16 a[224:227], v[0:3], v[60:63], a[224:227]
    v_mfma_f32_16x16x32_bf16 a[228:231], v[4:7], v[60:63], a[228:231]
    s_add_u32 s15, s15, s17
    v_mfma_f32_16x16x32_bf16 a[232:235], v[8:11], v[60:63], a[232:235]
    v_mfma_f32_16x16x32_bf16 a[236:239], v[12:15], v[60:63], a[236:239]
    v_mfma_f32_16x16x32_bf16 a[240:243], v[16:19], v[60:63], a[240:243]
    v_mfma_f32_16x16x32_bf16 a[244:247], v[20:23], v[60:63], a[244:247]
    v_mfma_f32_16x16x32_bf16 a[248:251], v[24:27], v[60:63], a[248:251]
    v_mfma_f32_16x16x32_bf16 a[252:255], v[28:31], v[60:63], a[252:255]
    s_waitcnt lgkmcnt(0)
    v_mfma_f32_16x16x32_bf16 a[0:3], v[64:67], v[96:99], a[0:3]
    s_waitcnt vmcnt(16)
    s_barrier
    ds_read_b128 v[32:35], v136 offset:32768
    s_add_u32 m0, s20, 16384
    s_nop 0
    v_mfma_f32_16x16x32_bf16 a[4:7], v[68:71], v[96:99], a[4:7]
    ds_read_b64_tr_b16 v[0:1], v128 offset:32768
    v_mfma_f32_16x16x32_bf16 a[8:11], v[72:75], v[96:99], a[8:11]
    ds_read_b64_tr_b16 v[2:3], v128 offset:40960
    v_mfma_f32_16x16x32_bf16 a[12:15], v[76:79], v[96:99], a[12:15]
    ds_read_b64_tr_b16 v[4:5], v129 offset:32768
    v_mfma_f32_16x16x32_bf16 a[16:19], v[80:83], v[96:99], a[16:19]
    ds_read_b64_tr_b16 v[6:7], v129 offset:40960
    v_mfma_f32_16x16x32_bf16 a[20:23], v[84:87], v[96:99], a[20:23]
    ds_read_b64_tr_b16 v[8:9], v130 offset:32768
    buffer_load_dwordx4 v141, s[4:7], s16 offen offset:0 sc1 lds
    v_mfma_f32_16x16x32_bf16 a[24:27], v[88:91], v[96:99], a[24:27]
    ds_read_b64_tr_b16 v[10:11], v130 offset:40960
    v_mfma_f32_16x16x32_bf16 a[28:31], v[92:95], v[96:99], a[28:31]
    ds_read_b64_tr_b16 v[12:13], v131 offset:32768
    v_mfma_f32_16x16x32_bf16 a[32:35], v[64:67], v[100:103], a[32:35]
    ds_read_b64_tr_b16 v[14:15], v131 offset:40960
    v_mfma_f32_16x16x32_bf16 a[36:39], v[68:71], v[100:103], a[36:39]
    ds_read_b64_tr_b16 v[16:17], v132 offset:32768
    v_mfma_f32_16x16x32_bf16 a[40:43], v[72:75], v[100:103], a[40:43]
    ds_read_b64_tr_b16 v[18:19], v132 offset:40960
    buffer_load_dwordx4 v142, s[4:7], s16 offen offset:1024 sc1 lds
    v_mfma_f32_16x16x32_bf16 a[44:47], v[76:79], v[100:103], a[44:47]
    ds_read_b64_tr_b16 v[20:21], v133 offset:32768
    v_mfma_f32_16x16x32_bf16 a[48:51], v[80:83], v[100:103], a[48:51]
    ds_read_b64_tr_b16 v[22:23], v133 offset:40960
    v_mfma_f32_16x16x32_bf16 a[52:55], v[84:87], v[100:103], a[52:55]
    ds_read_b64_tr_b16 v[24:25], v134 offset:32768
    v_mfma_f32_16x16x32_bf16 a[56:59], v[88:91], v[100:103], a[56:59]
    ds_read_b64_tr_b16 v[26:27], v134 offset:40960
    v_mfma_f32_16x16x32_bf16 a[60:63], v[92:95], v[100:103], a[60:63]
    ds_read_b64_tr_b16 v[28:29], v135 offset:32768
    buffer_load_dwordx4 v143, s[4:7], s16 offen offset:2048 sc1 lds
    v_mfma_f32_16x16x32_bf16 a[64:67], v[64:67], v[104:107], a[64:67]
    ds_read_b64_tr_b16 v[30:31], v135 offset:40960
    v_mfma_f32_16x16x32_bf16 a[68:71], v[68:71], v[104:107], a[68:71]
    ds_read_b128 v[36:39], v136 offset:33792
    v_mfma_f32_16x16x32_bf16 a[72:75], v[72:75], v[104:107], a[72:75]
    ds_read_b128 v[40:43], v136 offset:34816
    v_mfma_f32_16x16x32_bf16 a[76:79], v[76:79], v[104:107], a[76:79]
    ds_read_b128 v[44:47], v136 offset:35840
    v_mfma_f32_16x16x32_bf16 a[80:83], v[80:83], v[104:107], a[80:83]
    ds_read_b128 v[48:51], v136 offset:36864
    v_mfma_f32_16x16x32_bf16 a[84:87], v[84:87], v[104:107], a[84:87]
    ds_read_b128 v[52:55], v136 offset:37888
    buffer_load_dwordx4 v144, s[4:7], s16 offen offset:3072 sc1 lds
    v_mfma_f32_16x16x32_bf16 a[88:91], v[88:91], v[104:107], a[88:91]
    ds_read_b128 v[56:59], v136 offset:38912
    v_mfma_f32_16x16x32_bf16 a[92:95], v[92:95], v[104:107], a[92:95]
    ds_read_b128 v[60:63], v136 offset:39936
    v_mfma_f32_16x16x32_bf16 a[96:99], v[64:67], v[108:111], a[96:99]
    v_mfma_f32_16x16x32_bf16 a[100:103], v[68:71], v[108:111], a[100:103]
    v_mfma_f32_16x16x32_bf16 a[104:107], v[72:75], v[108:111], a[104:107]
    s_add_u32 s16, s16, 1024
    v_mfma_f32_16x16x32_bf16 a[108:111], v[76:79], v[108:111], a[108:111]
    v_mfma_f32_16x16x32_bf16 a[112:115], v[80:83], v[108:111], a[112:115]
    v_mfma_f32_16x16x32_bf16 a[116:119], v[84:87], v[108:111], a[116:119]
    v_mfma_f32_16x16x32_bf16 a[120:123], v[88:91], v[108:111], a[120:123]
    v_mfma_f32_16x16x32_bf16 a[124:127], v[92:95], v[108:111], a[124:127]
    s_add_u32 m0, s19, 16384
    s_nop 0
    v_mfma_f32_16x16x32_bf16 a[128:131], v[64:67], v[112:115], a[128:131]
    v_mfma_f32_16x16x32_bf16 a[132:135], v[68:71], v[112:115], a[132:135]
    v_mfma_f32_16x16x32_bf16 a[136:139], v[72:75], v[112:115], a[136:139]
    v_mfma_f32_16x16x32_bf16 a[140:143], v[76:79], v[112:115], a[140:143]
    v_mfma_f32_16x16x32_bf16 a[144:147], v[80:83], v[112:115], a[144:147]
    buffer_load_dwordx4 v137, s[8:11], s15 offen offset:0 lds
    v_mfma_f32_16x16x32_bf16 a[148:151], v[84:87], v[112:115], a[148:151]
    v_mfma_f32_16x16x32_bf16 a[152:155], v[88:91], v[112:115], a[152:155]
    v_mfma_f32_16x16x32_bf16 a[156:159], v[92:95], v[112:115], a[156:159]
    v_mfma_f32_16x16x32_bf16 a[160:163], v[64:67], v[116:119], a[160:163]
    v_mfma_f32_16x16x32_bf16 a[164:167], v[68:71], v[116:119], a[164:167]
    v_mfma_f32_16x16x32_bf16 a[168:171], v[72:75], v[116:119], a[168:171]
    buffer_load_dwordx4 v138, s[8:11], s15 offen offset:1024 lds
    v_mfma_f32_16x16x32_bf16 a[172:175], v[76:79], v[116:119], a[172:175]
    v_mfma_f32_16x16x32_bf16 a[176:179], v[80:83], v[116:119], a[176:179]
    v_mfma_f32_16x16x32_bf16 a[180:183], v[84:87], v[116:119], a[180:183]
    v_mfma_f32_16x16x32_bf16 a[184:187], v[88:91], v[116:119], a[184:187]
    v_mfma_f32_16x16x32_bf16 a[188:191], v[92:95], v[116:119], a[188:191]
    buffer_load_dwordx4 v139, s[8:11], s15 offen offset:2048 lds
    v_mfma_f32_16x16x32_bf16 a[192:195], v[64:67], v[120:123], a[192:195]
    v_mfma_f32_16x16x32_bf16 a[196:199], v[68:71], v[120:123], a[196:199]
    v_mfma_f32_16x16x32_bf16 a[200:203], v[72:75], v[120:123], a[200:203]
    v_mfma_f32_16x16x32_bf16 a[204:207], v[76:79], v[120:123], a[204:207]
    v_mfma_f32_16x16x32_bf16 a[208:211], v[80:83], v[120:123], a[208:211]
    buffer_load_dwordx4 v140, s[8:11], s15 offen offset:3072 lds
    v_mfma_f32_16x16x32_bf16 a[212:215], v[84:87], v[120:123], a[212:215]
    v_mfma_f32_16x16x32_bf16 a[216:219], v[88:91], v[120:123], a[216:219]
    v_mfma_f32_16x16x32_bf16 a[220:223], v[92:95], v[120:123], a[220:223]
    v_mfma_f32_16x16x32_bf16 a[224:227], v[64:67], v[124:127], a[224:227]
    v_mfma_f32_16x16x32_bf16 a[228:231], v[68:71], v[124:127], a[228:231]
    s_add_u32 s15, s15, s17
    v_mfma_f32_16x16x32_bf16 a[232:235], v[72:75], v[124:127], a[232:235]
    v_mfma_f32_16x16x32_bf16 a[236:239], v[76:79], v[124:127], a[236:239]
    v_mfma_f32_16x16x32_bf16 a[240:243], v[80:83], v[124:127], a[240:243]
    v_mfma_f32_16x16x32_bf16 a[244:247], v[84:87], v[124:127], a[244:247]
    v_mfma_f32_16x16x32_bf16 a[248:251], v[88:91], v[124:127], a[248:251]
    v_mfma_f32_16x16x32_bf16 a[252:255], v[92:95], v[124:127], a[252:255]
    s_waitcnt lgkmcnt(0)
    v_mfma_f32_16x16x32_bf16 a[0:3], v[0:3], v[32:35], a[0:3]
    s_waitcnt vmcnt(16)
    s_barrier
    ds_read_b128 v[96:99], v136 offset:49152
    s_add_u32 m0, s20, 32768
    s_nop 0
    v_mfma_f32_16x16x32_bf16 a[4:7], v[4:7], v[32:35], a[4:7]
    ds_read_b64_tr_b16 v[64:65], v128 offset:49152
    v_mfma_f32_16x16x32_bf16 a[8:11], v[8:11], v[32:35], a[8:11]
    ds_read_b64_tr_b16 v[66:67], v128 offset:57344
    v_mfma_f32_16x16x32_bf16 a[12:15], v[12:15], v[32:35], a[12:15]
    ds_read_b64_tr_b16 v[68:69], v129 offset:49152
    v_mfma_f32_16x16x32_bf16 a[16:19], v[16:19], v[32:35], a[16:19]
    ds_read_b64_tr_b16 v[70:71], v129 offset:57344
    v_mfma_f32_16x16x32_bf16 a[20:23], v[20:23], v[32:35], a[20:23]
    ds_read_b64_tr_b16 v[72:73], v130 offset:49152
    buffer_load_dwordx4 v141, s[4:7], s16 offen offset:0 sc1 lds
    v_mfma_f32_16x16x32_bf16 a[24:27], v[24:27], v[32:35], a[24:27]
    ds_read_b64_tr_b16 v[74:75], v130 offset:57344
    v_mfma_f32_16x16x32_bf16 a[28:31], v[28:31], v[32:35], a[28:31]
    ds_read_b64_tr_b16 v[76:77], v131 offset:49152
    v_mfma_f32_16x16x32_bf16 a[32:35], v[0:3], v[36:39], a[32:35]
    ds_read_b64_tr_b16 v[78:79], v131 offset:57344
    v_mfma_f32_16x16x32_bf16 a[36:39], v[4:7], v[36:39], a[36:39]
    ds_read_b64_tr_b16 v[80:81], v132 offset:49152
    v_mfma_f32_16x16x32_bf16 a[40:43], v[8:11], v[36:39], a[40:43]
    ds_read_b64_tr_b16 v[82:83], v132 offset:57344
    buffer_load_dwordx4 v142, s[4:7], s16 offen offset:1024 sc1 lds
    v_mfma_f32_16x16x32_bf16 a[44:47], v[12:15], v[36:39], a[44:47]
    ds_read_b64_tr_b16 v[84:85], v133 offset:49152
    v_mfma_f32_16x16x32_bf16 a[48:51], v[16:19], v[36:39], a[48:51]
    ds_read_b64_tr_b16 v[86:87], v133 offset:57344
    v_mfma_f32_16x16x32_bf16 a[52:55], v[20:23], v[36:39], a[52:55]
    ds_read_b64_tr_b16 v[88:89], v134 offset:49152
    v_mfma_f32_16x16x32_bf16 a[56:59], v[24:27], v[36:39], a[56:59]
    ds_read_b64_tr_b16 v[90:91], v134 offset:57344
    v_mfma_f32_16x16x32_bf16 a[60:63], v[28:31], v[36:39], a[60:63]
    ds_read_b64_tr_b16 v[92:93], v135 offset:49152
    buffer_load_dwordx4 v143, s[4:7], s16 offen offset:2048 sc1 lds
    v_mfma_f32_16x16x32_bf16 a[64:67], v[0:3], v[40:43], a[64:67]
    ds_read_b64_tr_b16 v[94:95], v135 offset:57344
    v_mfma_f32_16x16x32_bf16 a[68:71], v[4:7], v[40:43], a[68:71]
    ds_read_b128 v[100:103], v136 offset:50176
    v_mfma_f32_16x16x32_bf16 a[72:75], v[8:11], v[40:43], a[72:75]
    ds_read_b128 v[104:107], v136 offset:51200
    v_mfma_f32_16x16x32_bf16 a[76:79], v[12:15], v[40:43], a[76:79]
    ds_read_b128 v[108:111], v136 offset:52224
    v_mfma_f32_16x16x32_bf16 a[80:83], v[16:19], v[40:43], a[80:83]
    ds_read_b128 v[112:115], v136 offset:53248
    v_mfma_f32_16x16x32_bf16 a[84:87], v[20:23], v[40:43], a[84:87]
    ds_read_b128 v[116:119], v136 offset:54272
    buffer_load_dwordx4 v144, s[4:7], s16 offen offset:3072 sc1 lds
    v_mfma_f32_16x16x32_bf16 a[88:91], v[24:27], v[40:43], a[88:91]
    ds_read_b128 v[120:123], v136 offset:55296
    v_mfma_f32_16x16x32_bf16 a[92:95], v[28:31], v[40:43], a[92:95]
    ds_read_b128 v[124:127], v136 offset:56320
    v_mfma_f32_16x16x32_bf16 a[96:99], v[0:3], v[44:47], a[96:99]
    v_mfma_f32_16x16x32_bf16 a[100:103], v[4:7], v[44:47], a[100:103]
    v_mfma_f32_16x16x32_bf16 a[104:107], v[8:11], v[44:47], a[104:107]
    s_add_u32 s16, s16, 1024
    v_mfma_f32_16x16x32_bf16 a[108:111], v[12:15], v[44:47], a[108:111]
    v_mfma_f32_16x16x32_bf16 a[112:115], v[16:19], v[44:47], a[112:115]
    v_mfma_f32_16x16x32_bf16 a[116:119], v[20:23], v[44:47], a[116:119]
    v_mfma_f32_16x16x32_bf16 a[120:123], v[24:27], v[44:47], a[120:123]
    v_mfma_f32_16x16x32_bf16 a[124:127], v[28:31], v[44:47], a[124:127]
    s_add_u32 m0, s19, 32768
    s_nop 0
    v_mfma_f32_16x16x32_bf16 a[128:131], v[0:3], v[48:51], a[128:131]
    v_mfma_f32_16x16x32_bf16 a[132:135], v[4:7], v[48:51], a[132:135]
    v_mfma_f32_16x16x32_bf16 a[136:139], v[8:11], v[48:51], a[136:139]
    v_mfma_f32_16x16x32_bf16 a[140:143], v[12:15], v[48:51], a[140:143]
    v_mfma_f32_16x16x32_bf16 a[144:147], v[16:19], v[48:51], a[144:147]
    buffer_load_dwordx4 v137, s[8:11], s15 offen offset:0 lds
    v_mfma_f32_16x16x32_bf16 a[148:151], v[20:23], v[48:51], a[148:151]
    v_mfma_f32_16x16x32_bf16 a[152:155], v[24:27], v[48:51], a[152:155]
    v_mfma_f32_16x16x32_bf16 a[156:159], v[28:31], v[48:51], a[156:159]
    v_mfma_f32_16x16x32_bf16 a[160:163], v[0:3], v[52:55], a[160:163]
    v_mfma_f32_16x16x32_bf16 a[164:167], v[4:7], v[52:55], a[164:167]
    v_mfma_f32_16x16x32_bf16 a[168:171], v[8:11], v[52:55], a[168:171]
    buffer_load_dwordx4 v138, s[8:11], s15 offen offset:1024 lds
    v_mfma_f32_16x16x32_bf16 a[172:175], v[12:15], v[52:55], a[172:175]
    v_mfma_f32_16x16x32_bf16 a[176:179], v[16:19], v[52:55], a[176:179]
    v_mfma_f32_16x16x32_bf16 a[180:183], v[20:23], v[52:55], a[180:183]
    v_mfma_f32_16x16x32_bf16 a[184:187], v[24:27], v[52:55], a[184:187]
    v_mfma_f32_16x16x32_bf16 a[188:191], v[28:31], v[52:55], a[188:191]
    buffer_load_dwordx4 v139, s[8:11], s15 offen offset:2048 lds
    v_mfma_f32_16x16x32_bf16 a[192:195], v[0:3], v[56:59], a[192:195]
    v_mfma_f32_16x16x32_bf16 a[196:199], v[4:7], v[56:59], a[196:199]
    v_mfma_f32_16x16x32_bf16 a[200:203], v[8:11], v[56:59], a[200:203]
    v_mfma_f32_16x16x32_bf16 a[204:207], v[12:15], v[56:59], a[204:207]
    v_mfma_f32_16x16x32_bf16 a[208:211], v[16:19], v[56:59], a[208:211]
    buffer_load_dwordx4 v140, s[8:11], s15 offen offset:3072 lds
    v_mfma_f32_16x16x32_bf16 a[212:215], v[20:23], v[56:59], a[212:215]
    v_mfma_f32_16x16x32_bf16 a[216:219], v[24:27], v[56:59], a[216:219]
    v_mfma_f32_16x16x32_bf16 a[220:223], v[28:31], v[56:59], a[220:223]
    v_mfma_f32_16x16x32_bf16 a[224:227], v[0:3], v[60:63], a[224:227]
    v_mfma_f32_16x16x32_bf16 a[228:231], v[4:7], v[60:63], a[228:231]
    s_add_u32 s15, s15, s17
    v_mfma_f32_16x16x32_bf16 a[232:235], v[8:11], v[60:63], a[232:235]
    v_mfma_f32_16x16x32_bf16 a[236:239], v[12:15], v[60:63], a[236:239]
    v_mfma_f32_16x16x32_bf16 a[240:243], v[16:19], v[60:63], a[240:243]
    v_mfma_f32_16x16x32_bf16 a[244:247], v[20:23], v[60:63], a[244:247]
    v_mfma_f32_16x16x32_bf16 a[248:251], v[24:27], v[60:63], a[248:251]
    v_mfma_f32_16x16x32_bf16 a[252:255], v[28:31], v[60:63], a[252:255]
    s_waitcnt lgkmcnt(0)
    v_mfma_f32_16x16x32_bf16 a[0:3], v[64:67], v[96:99], a[0:3]
    s_waitcnt vmcnt(16)
    s_barrier
    ds_read_b128 v[32:35], v136 offset:0
    s_add_u32 m0, s20, 49152
    s_nop 0
    v_mfma_f32_16x16x32_bf16 a[4:7], v[68:71], v[96:99], a[4:7]
    ds_read_b64_tr_b16 v[0:1], v128 offset:0
    v_mfma_f32_16x16x32_bf16 a[8:11], v[72:75], v[96:99], a[8:11]
    ds_read_b64_tr_b16 v[2:3], v128 offset:8192
    v_mfma_f32_16x16x32_bf16 a[12:15], v[76:79], v[96:99], a[12:15]
    ds_read_b64_tr_b16 v[4:5], v129 offset:0
    v_mfma_f32_16x16x32_bf16 a[16:19], v[80:83], v[96:99], a[16:19]
    ds_read_b64_tr_b16 v[6:7], v129 offset:8192
    v_mfma_f32_16x16x32_bf16 a[20:23], v[84:87], v[96:99], a[20:23]
    ds_read_b64_tr_b16 v[8:9], v130 offset:0
    buffer_load_dwordx4 v141, s[4:7], s16 offen offset:0 sc1 lds
    v_mfma_f32_16x16x32_bf16 a[24:27], v[88:91], v[96:99], a[24:27]
    ds_read_b64_tr_b16 v[10:11], v130 offset:8192
    v_mfma_f32_16x16x32_bf16 a[28:31], v[92:95], v[96:99], a[28:31]
    ds_read_b64_tr_b16 v[12:13], v131 offset:0
    v_mfma_f32_16x16x32_bf16 a[32:35], v[64:67], v[100:103], a[32:35]
    ds_read_b64_tr_b16 v[14:15], v131 offset:8192
    v_mfma_f32_16x16x32_bf16 a[36:39], v[68:71], v[100:103], a[36:39]
    ds_read_b64_tr_b16 v[16:17], v132 offset:0
    v_mfma_f32_16x16x32_bf16 a[40:43], v[72:75], v[100:103], a[40:43]
    ds_read_b64_tr_b16 v[18:19], v132 offset:8192
    buffer_load_dwordx4 v142, s[4:7], s16 offen offset:1024 sc1 lds
    v_mfma_f32_16x16x32_bf16 a[44:47], v[76:79], v[100:103], a[44:47]
    ds_read_b64_tr_b16 v[20:21], v133 offset:0
    v_mfma_f32_16x16x32_bf16 a[48:51], v[80:83], v[100:103], a[48:51]
    ds_read_b64_tr_b16 v[22:23], v133 offset:8192
    v_mfma_f32_16x16x32_bf16 a[52:55], v[84:87], v[100:103], a[52:55]
    ds_read_b64_tr_b16 v[24:25], v134 offset:0
    v_mfma_f32_16x16x32_bf16 a[56:59], v[88:91], v[100:103], a[56:59]
    ds_read_b64_tr_b16 v[26:27], v134 offset:8192
    v_mfma_f32_16x16x32_bf16 a[60:63], v[92:95], v[100:103], a[60:63]
    ds_read_b64_tr_b16 v[28:29], v135 offset:0
    buffer_load_dwordx4 v143, s[4:7], s16 offen offset:2048 sc1 lds
    v_mfma_f32_16x16x32_bf16 a[64:67], v[64:67], v[104:107], a[64:67]
    ds_read_b64_tr_b16 v[30:31], v135 offset:8192
    v_mfma_f32_16x16x32_bf16 a[68:71], v[68:71], v[104:107], a[68:71]
    ds_read_b128 v[36:39], v136 offset:1024
    v_mfma_f32_16x16x32_bf16 a[72:75], v[72:75], v[104:107], a[72:75]
    ds_read_b128 v[40:43], v136 offset:2048
    v_mfma_f32_16x16x32_bf16 a[76:79], v[76:79], v[104:107], a[76:79]
    ds_read_b128 v[44:47], v136 offset:3072
    v_mfma_f32_16x16x32_bf16 a[80:83], v[80:83], v[104:107], a[80:83]
    ds_read_b128 v[48:51], v136 offset:4096
    v_mfma_f32_16x16x32_bf16 a[84:87], v[84:87], v[104:107], a[84:87]
    ds_read_b128 v[52:55], v136 offset:5120
    buffer_load_dwordx4 v144, s[4:7], s16 offen offset:3072 sc1 lds
    v_mfma_f32_16x16x32_bf16 a[88:91], v[88:91], v[104:107], a[88:91]
    ds_read_b128 v[56:59], v136 offset:6144
    v_mfma_f32_16x16x32_bf16 a[92:95], v[92:95], v[104:107], a[92:95]
    ds_read_b128 v[60:63], v136 offset:7168
    v_mfma_f32_16x16x32_bf16 a[96:99], v[64:67], v[108:111], a[96:99]
    v_mfma_f32_16x16x32_bf16 a[100:103], v[68:71], v[108:111], a[100:103]
    v_mfma_f32_16x16x32_bf16 a[104:107], v[72:75], v[108:111], a[104:107]
    s_add_u32 s16, s16, 1024
    v_mfma_f32_16x16x32_bf16 a[108:111], v[76:79], v[108:111], a[108:111]
    v_mfma_f32_16x16x32_bf16 a[112:115], v[80:83], v[108:111], a[112:115]
    v_mfma_f32_16x16x32_bf16 a[116:119], v[84:87], v[108:111], a[116:119]
    v_mfma_f32_16x16x32_bf16 a[120:123], v[88:91], v[108:111], a[120:123]
    v_mfma_f32_16x16x32_bf16 a[124:127], v[92:95], v[108:111], a[124:127]
    s_add_u32 m0, s19, 49152
    s_nop 0
    v_mfma_f32_16x16x32_bf16 a[128:131], v[64:67], v[112:115], a[128:131]
    v_mfma_f32_16x16x32_bf16 a[132:135], v[68:71], v[112:115], a[132:135]
    v_mfma_f32_16x16x32_bf16 a[136:139], v[72:75], v[112:115], a[136:139]
    v_mfma_f32_16x16x32_bf16 a[140:143], v[76:79], v[112:115], a[140:143]
    v_mfma_f32_16x16x32_bf16 a[144:147], v[80:83], v[112:115], a[144:147]
    buffer_load_dwordx4 v137, s[8:11], s15 offen offset:0 lds
    v_mfma_f32_16x16x32_bf16 a[148:151], v[84:87], v[112:115], a[148:151]
    v_mfma_f32_16x16x32_bf16 a[152:155], v[88:91], v[112:115], a[152:155]
    v_mfma_f32_16x16x32_bf16 a[156:159], v[92:95], v[112:115], a[156:159]
    v_mfma_f32_16x16x32_bf16 a[160:163], v[64:67], v[116:119], a[160:163]
    v_mfma_f32_16x16x32_bf16 a[164:167], v[68:71], v[116:119], a[164:167]
    v_mfma_f32_16x16x32_bf16 a[168:171], v[72:75], v[116:119], a[168:171]
    buffer_load_dwordx4 v138, s[8:11], s15 offen offset:1024 lds
    v_mfma_f32_16x16x32_bf16 a[172:175], v[76:79], v[116:119], a[172:175]
    v_mfma_f32_16x16x32_bf16 a[176:179], v[80:83], v[116:119], a[176:179]
    v_mfma_f32_16x16x32_bf16 a[180:183], v[84:87], v[116:119], a[180:183]
    v_mfma_f32_16x16x32_bf16 a[184:187], v[88:91], v[116:119], a[184:187]
    v_mfma_f32_16x16x32_bf16 a[188:191], v[92:95], v[116:119], a[188:191]
    buffer_load_dwordx4 v139, s[8:11], s15 offen offset:2048 lds
    v_mfma_f32_16x16x32_bf16 a[192:195], v[64:67], v[120:123], a[192:195]
    v_mfma_f32_16x16x32_bf16 a[196:199], v[68:71], v[120:123], a[196:199]
    v_mfma_f32_16x16x32_bf16 a[200:203], v[72:75], v[120:123], a[200:203]
    v_mfma_f32_16x16x32_bf16 a[204:207], v[76:79], v[120:123], a[204:207]
    v_mfma_f32_16x16x32_bf16 a[208:211], v[80:83], v[120:123], a[208:211]
    buffer_load_dwordx4 v140, s[8:11], s15 offen offset:3072 lds
    v_mfma_f32_16x16x32_bf16 a[212:215], v[84:87], v[120:123], a[212:215]
    v_mfma_f32_16x16x32_bf16 a[216:219], v[88:91], v[120:123], a[216:219]
    v_mfma_f32_16x16x32_bf16 a[220:223], v[92:95], v[120:123], a[220:223]
    v_mfma_f32_16x16x32_bf16 a[224:227], v[64:67], v[124:127], a[224:227]
    v_mfma_f32_16x16x32_bf16 a[228:231], v[68:71], v[124:127], a[228:231]
    s_add_u32 s15, s15, s17
    v_mfma_f32_16x16x32_bf16 a[232:235], v[72:75], v[124:127], a[232:235]
    v_mfma_f32_16x16x32_bf16 a[236:239], v[76:79], v[124:127], a[236:239]
    v_mfma_f32_16x16x32_bf16 a[240:243], v[80:83], v[124:127], a[240:243]
    v_mfma_f32_16x16x32_bf16 a[244:247], v[84:87], v[124:127], a[244:247]
    v_mfma_f32_16x16x32_bf16 a[248:251], v[88:91], v[124:127], a[248:251]
    v_mfma_f32_16x16x32_bf16 a[252:255], v[92:95], v[124:127], a[252:255]
    s_sub_u32 s18, s18, 1
    s_cmp_lg_u32 s18, 0
    s_cbranch_scc1 main_kernel_w_c2_n_loop
    s_cmp_lg_u32 s14, 0
    s_cbranch_scc1 main_kernel_w_c2_n_nt
    s_lshl_b32 s32, s27, 8
    s_add_u32 s32, s32, 0x841e000
    v_mov_b32 v255, 1
    s_mov_b64 exec, 1
    buffer_atomic_add v255, off, s[4:7], s32 sc0 sc1
    s_mov_b64 exec, -1
main_kernel_w_c2_n_nt:
    s_waitcnt lgkmcnt(0)
    v_mfma_f32_16x16x32_bf16 a[0:3], v[0:3], v[32:35], a[0:3]
    s_waitcnt vmcnt(16)
    s_barrier
    ds_read_b128 v[96:99], v136 offset:16384
    v_mfma_f32_16x16x32_bf16 a[4:7], v[4:7], v[32:35], a[4:7]
    ds_read_b64_tr_b16 v[64:65], v128 offset:16384
    v_mfma_f32_16x16x32_bf16 a[8:11], v[8:11], v[32:35], a[8:11]
    ds_read_b64_tr_b16 v[66:67], v128 offset:24576
    v_mfma_f32_16x16x32_bf16 a[12:15], v[12:15], v[32:35], a[12:15]
    ds_read_b64_tr_b16 v[68:69], v129 offset:16384
    v_mfma_f32_16x16x32_bf16 a[16:19], v[16:19], v[32:35], a[16:19]
    ds_read_b64_tr_b16 v[70:71], v129 offset:24576
    v_mfma_f32_16x16x32_bf16 a[20:23], v[20:23], v[32:35], a[20:23]
    ds_read_b64_tr_b16 v[72:73], v130 offset:16384
    v_mfma_f32_16x16x32_bf16 a[24:27], v[24:27], v[32:35], a[24:27]
    ds_read_b64_tr_b16 v[74:75], v130 offset:24576
    v_mfma_f32_16x16x32_bf16 a[28:31], v[28:31], v[32:35], a[28:31]
    ds_read_b64_tr_b16 v[76:77], v131 offset:16384
    v_mfma_f32_16x16x32_bf16 a[32:35], v[0:3], v[36:39], a[32:35]
    ds_read_b64_tr_b16 v[78:79], v131 offset:24576
    v_mfma_f32_16x16x32_bf16 a[36:39], v[4:7], v[36:39], a[36:39]
    ds_read_b64_tr_b16 v[80:81], v132 offset:16384
    v_mfma_f32_16x16x32_bf16 a[40:43], v[8:11], v[36:39], a[40:43]
    ds_read_b64_tr_b16 v[82:83], v132 offset:24576
    v_mfma_f32_16x16x32_bf16 a[44:47], v[12:15], v[36:39], a[44:47]
    ds_read_b64_tr_b16 v[84:85], v133 offset:16384
    v_mfma_f32_16x16x32_bf16 a[48:51], v[16:19], v[36:39], a[48:51]
    ds_read_b64_tr_b16 v[86:87], v133 offset:24576
    v_mfma_f32_16x16x32_bf16 a[52:55], v[20:23], v[36:39], a[52:55]
    ds_read_b64_tr_b16 v[88:89], v134 offset:16384
    v_mfma_f32_16x16x32_bf16 a[56:59], v[24:27], v[36:39], a[56:59]
    ds_read_b64_tr_b16 v[90:91], v134 offset:24576
    v_mfma_f32_16x16x32_bf16 a[60:63], v[28:31], v[36:39], a[60:63]
    ds_read_b64_tr_b16 v[92:93], v135 offset:16384
    v_mfma_f32_16x16x32_bf16 a[64:67], v[0:3], v[40:43], a[64:67]
    ds_read_b64_tr_b16 v[94:95], v135 offset:24576
    v_mfma_f32_16x16x32_bf16 a[68:71], v[4:7], v[40:43], a[68:71]
    ds_read_b128 v[100:103], v136 offset:17408
    v_mfma_f32_16x16x32_bf16 a[72:75], v[8:11], v[40:43], a[72:75]
    ds_read_b128 v[104:107], v136 offset:18432
    v_mfma_f32_16x16x32_bf16 a[76:79], v[12:15], v[40:43], a[76:79]
    ds_read_b128 v[108:111], v136 offset:19456
    v_mfma_f32_16x16x32_bf16 a[80:83], v[16:19], v[40:43], a[80:83]
    ds_read_b128 v[112:115], v136 offset:20480
    v_mfma_f32_16x16x32_bf16 a[84:87], v[20:23], v[40:43], a[84:87]
    ds_read_b128 v[116:119], v136 offset:21504
    v_mfma_f32_16x16x32_bf16 a[88:91], v[24:27], v[40:43], a[88:91]
    ds_read_b128 v[120:123], v136 offset:22528
    v_mfma_f32_16x16x32_bf16 a[92:95], v[28:31], v[40:43], a[92:95]
    ds_read_b128 v[124:127], v136 offset:23552
    v_mfma_f32_16x16x32_bf16 a[96:99], v[0:3], v[44:47], a[96:99]
    v_mfma_f32_16x16x32_bf16 a[100:103], v[4:7], v[44:47], a[100:103]
    v_mfma_f32_16x16x32_bf16 a[104:107], v[8:11], v[44:47], a[104:107]
    v_mfma_f32_16x16x32_bf16 a[108:111], v[12:15], v[44:47], a[108:111]
    v_mfma_f32_16x16x32_bf16 a[112:115], v[16:19], v[44:47], a[112:115]
    v_mfma_f32_16x16x32_bf16 a[116:119], v[20:23], v[44:47], a[116:119]
    v_mfma_f32_16x16x32_bf16 a[120:123], v[24:27], v[44:47], a[120:123]
    v_mfma_f32_16x16x32_bf16 a[124:127], v[28:31], v[44:47], a[124:127]
    v_mfma_f32_16x16x32_bf16 a[128:131], v[0:3], v[48:51], a[128:131]
    v_mfma_f32_16x16x32_bf16 a[132:135], v[4:7], v[48:51], a[132:135]
    v_mfma_f32_16x16x32_bf16 a[136:139], v[8:11], v[48:51], a[136:139]
    v_mfma_f32_16x16x32_bf16 a[140:143], v[12:15], v[48:51], a[140:143]
    v_mfma_f32_16x16x32_bf16 a[144:147], v[16:19], v[48:51], a[144:147]
    v_mfma_f32_16x16x32_bf16 a[148:151], v[20:23], v[48:51], a[148:151]
    v_mfma_f32_16x16x32_bf16 a[152:155], v[24:27], v[48:51], a[152:155]
    v_mfma_f32_16x16x32_bf16 a[156:159], v[28:31], v[48:51], a[156:159]
    v_mfma_f32_16x16x32_bf16 a[160:163], v[0:3], v[52:55], a[160:163]
    v_mfma_f32_16x16x32_bf16 a[164:167], v[4:7], v[52:55], a[164:167]
    v_mfma_f32_16x16x32_bf16 a[168:171], v[8:11], v[52:55], a[168:171]
    v_mfma_f32_16x16x32_bf16 a[172:175], v[12:15], v[52:55], a[172:175]
    v_mfma_f32_16x16x32_bf16 a[176:179], v[16:19], v[52:55], a[176:179]
    v_mfma_f32_16x16x32_bf16 a[180:183], v[20:23], v[52:55], a[180:183]
    v_mfma_f32_16x16x32_bf16 a[184:187], v[24:27], v[52:55], a[184:187]
    v_mfma_f32_16x16x32_bf16 a[188:191], v[28:31], v[52:55], a[188:191]
    v_mfma_f32_16x16x32_bf16 a[192:195], v[0:3], v[56:59], a[192:195]
    v_mfma_f32_16x16x32_bf16 a[196:199], v[4:7], v[56:59], a[196:199]
    v_mfma_f32_16x16x32_bf16 a[200:203], v[8:11], v[56:59], a[200:203]
    v_mfma_f32_16x16x32_bf16 a[204:207], v[12:15], v[56:59], a[204:207]
    v_mfma_f32_16x16x32_bf16 a[208:211], v[16:19], v[56:59], a[208:211]
    v_mfma_f32_16x16x32_bf16 a[212:215], v[20:23], v[56:59], a[212:215]
    v_mfma_f32_16x16x32_bf16 a[216:219], v[24:27], v[56:59], a[216:219]
    v_mfma_f32_16x16x32_bf16 a[220:223], v[28:31], v[56:59], a[220:223]
    v_mfma_f32_16x16x32_bf16 a[224:227], v[0:3], v[60:63], a[224:227]
    v_mfma_f32_16x16x32_bf16 a[228:231], v[4:7], v[60:63], a[228:231]
    v_mfma_f32_16x16x32_bf16 a[232:235], v[8:11], v[60:63], a[232:235]
    v_mfma_f32_16x16x32_bf16 a[236:239], v[12:15], v[60:63], a[236:239]
    v_mfma_f32_16x16x32_bf16 a[240:243], v[16:19], v[60:63], a[240:243]
    v_mfma_f32_16x16x32_bf16 a[244:247], v[20:23], v[60:63], a[244:247]
    v_mfma_f32_16x16x32_bf16 a[248:251], v[24:27], v[60:63], a[248:251]
    v_mfma_f32_16x16x32_bf16 a[252:255], v[28:31], v[60:63], a[252:255]
    s_waitcnt lgkmcnt(0)
    v_mfma_f32_16x16x32_bf16 a[0:3], v[64:67], v[96:99], a[0:3]
    s_waitcnt vmcnt(8)
    s_barrier
    ds_read_b128 v[32:35], v136 offset:32768
    v_mfma_f32_16x16x32_bf16 a[4:7], v[68:71], v[96:99], a[4:7]
    ds_read_b64_tr_b16 v[0:1], v128 offset:32768
    v_mfma_f32_16x16x32_bf16 a[8:11], v[72:75], v[96:99], a[8:11]
    ds_read_b64_tr_b16 v[2:3], v128 offset:40960
    v_mfma_f32_16x16x32_bf16 a[12:15], v[76:79], v[96:99], a[12:15]
    ds_read_b64_tr_b16 v[4:5], v129 offset:32768
    v_mfma_f32_16x16x32_bf16 a[16:19], v[80:83], v[96:99], a[16:19]
    ds_read_b64_tr_b16 v[6:7], v129 offset:40960
    v_mfma_f32_16x16x32_bf16 a[20:23], v[84:87], v[96:99], a[20:23]
    ds_read_b64_tr_b16 v[8:9], v130 offset:32768
    v_mfma_f32_16x16x32_bf16 a[24:27], v[88:91], v[96:99], a[24:27]
    ds_read_b64_tr_b16 v[10:11], v130 offset:40960
    v_mfma_f32_16x16x32_bf16 a[28:31], v[92:95], v[96:99], a[28:31]
    ds_read_b64_tr_b16 v[12:13], v131 offset:32768
    v_mfma_f32_16x16x32_bf16 a[32:35], v[64:67], v[100:103], a[32:35]
    ds_read_b64_tr_b16 v[14:15], v131 offset:40960
    v_mfma_f32_16x16x32_bf16 a[36:39], v[68:71], v[100:103], a[36:39]
    ds_read_b64_tr_b16 v[16:17], v132 offset:32768
    v_mfma_f32_16x16x32_bf16 a[40:43], v[72:75], v[100:103], a[40:43]
    ds_read_b64_tr_b16 v[18:19], v132 offset:40960
    v_mfma_f32_16x16x32_bf16 a[44:47], v[76:79], v[100:103], a[44:47]
    ds_read_b64_tr_b16 v[20:21], v133 offset:32768
    v_mfma_f32_16x16x32_bf16 a[48:51], v[80:83], v[100:103], a[48:51]
    ds_read_b64_tr_b16 v[22:23], v133 offset:40960
    v_mfma_f32_16x16x32_bf16 a[52:55], v[84:87], v[100:103], a[52:55]
    ds_read_b64_tr_b16 v[24:25], v134 offset:32768
    v_mfma_f32_16x16x32_bf16 a[56:59], v[88:91], v[100:103], a[56:59]
    ds_read_b64_tr_b16 v[26:27], v134 offset:40960
    v_mfma_f32_16x16x32_bf16 a[60:63], v[92:95], v[100:103], a[60:63]
    ds_read_b64_tr_b16 v[28:29], v135 offset:32768
    v_mfma_f32_16x16x32_bf16 a[64:67], v[64:67], v[104:107], a[64:67]
    ds_read_b64_tr_b16 v[30:31], v135 offset:40960
    v_mfma_f32_16x16x32_bf16 a[68:71], v[68:71], v[104:107], a[68:71]
    ds_read_b128 v[36:39], v136 offset:33792
    v_mfma_f32_16x16x32_bf16 a[72:75], v[72:75], v[104:107], a[72:75]
    ds_read_b128 v[40:43], v136 offset:34816
    v_mfma_f32_16x16x32_bf16 a[76:79], v[76:79], v[104:107], a[76:79]
    ds_read_b128 v[44:47], v136 offset:35840
    v_mfma_f32_16x16x32_bf16 a[80:83], v[80:83], v[104:107], a[80:83]
    ds_read_b128 v[48:51], v136 offset:36864
    v_mfma_f32_16x16x32_bf16 a[84:87], v[84:87], v[104:107], a[84:87]
    ds_read_b128 v[52:55], v136 offset:37888
    v_mfma_f32_16x16x32_bf16 a[88:91], v[88:91], v[104:107], a[88:91]
    ds_read_b128 v[56:59], v136 offset:38912
    v_mfma_f32_16x16x32_bf16 a[92:95], v[92:95], v[104:107], a[92:95]
    ds_read_b128 v[60:63], v136 offset:39936
    v_mfma_f32_16x16x32_bf16 a[96:99], v[64:67], v[108:111], a[96:99]
    v_mfma_f32_16x16x32_bf16 a[100:103], v[68:71], v[108:111], a[100:103]
    v_mfma_f32_16x16x32_bf16 a[104:107], v[72:75], v[108:111], a[104:107]
    v_mfma_f32_16x16x32_bf16 a[108:111], v[76:79], v[108:111], a[108:111]
    v_mfma_f32_16x16x32_bf16 a[112:115], v[80:83], v[108:111], a[112:115]
    v_mfma_f32_16x16x32_bf16 a[116:119], v[84:87], v[108:111], a[116:119]
    v_mfma_f32_16x16x32_bf16 a[120:123], v[88:91], v[108:111], a[120:123]
    v_mfma_f32_16x16x32_bf16 a[124:127], v[92:95], v[108:111], a[124:127]
    v_mfma_f32_16x16x32_bf16 a[128:131], v[64:67], v[112:115], a[128:131]
    v_mfma_f32_16x16x32_bf16 a[132:135], v[68:71], v[112:115], a[132:135]
    v_mfma_f32_16x16x32_bf16 a[136:139], v[72:75], v[112:115], a[136:139]
    v_mfma_f32_16x16x32_bf16 a[140:143], v[76:79], v[112:115], a[140:143]
    v_mfma_f32_16x16x32_bf16 a[144:147], v[80:83], v[112:115], a[144:147]
    v_mfma_f32_16x16x32_bf16 a[148:151], v[84:87], v[112:115], a[148:151]
    v_mfma_f32_16x16x32_bf16 a[152:155], v[88:91], v[112:115], a[152:155]
    v_mfma_f32_16x16x32_bf16 a[156:159], v[92:95], v[112:115], a[156:159]
    v_mfma_f32_16x16x32_bf16 a[160:163], v[64:67], v[116:119], a[160:163]
    v_mfma_f32_16x16x32_bf16 a[164:167], v[68:71], v[116:119], a[164:167]
    v_mfma_f32_16x16x32_bf16 a[168:171], v[72:75], v[116:119], a[168:171]
    v_mfma_f32_16x16x32_bf16 a[172:175], v[76:79], v[116:119], a[172:175]
    v_mfma_f32_16x16x32_bf16 a[176:179], v[80:83], v[116:119], a[176:179]
    v_mfma_f32_16x16x32_bf16 a[180:183], v[84:87], v[116:119], a[180:183]
    v_mfma_f32_16x16x32_bf16 a[184:187], v[88:91], v[116:119], a[184:187]
    v_mfma_f32_16x16x32_bf16 a[188:191], v[92:95], v[116:119], a[188:191]
    v_mfma_f32_16x16x32_bf16 a[192:195], v[64:67], v[120:123], a[192:195]
    v_mfma_f32_16x16x32_bf16 a[196:199], v[68:71], v[120:123], a[196:199]
    v_mfma_f32_16x16x32_bf16 a[200:203], v[72:75], v[120:123], a[200:203]
    v_mfma_f32_16x16x32_bf16 a[204:207], v[76:79], v[120:123], a[204:207]
    v_mfma_f32_16x16x32_bf16 a[208:211], v[80:83], v[120:123], a[208:211]
    v_mfma_f32_16x16x32_bf16 a[212:215], v[84:87], v[120:123], a[212:215]
    v_mfma_f32_16x16x32_bf16 a[216:219], v[88:91], v[120:123], a[216:219]
    v_mfma_f32_16x16x32_bf16 a[220:223], v[92:95], v[120:123], a[220:223]
    v_mfma_f32_16x16x32_bf16 a[224:227], v[64:67], v[124:127], a[224:227]
    v_mfma_f32_16x16x32_bf16 a[228:231], v[68:71], v[124:127], a[228:231]
    v_mfma_f32_16x16x32_bf16 a[232:235], v[72:75], v[124:127], a[232:235]
    v_mfma_f32_16x16x32_bf16 a[236:239], v[76:79], v[124:127], a[236:239]
    v_mfma_f32_16x16x32_bf16 a[240:243], v[80:83], v[124:127], a[240:243]
    v_mfma_f32_16x16x32_bf16 a[244:247], v[84:87], v[124:127], a[244:247]
    v_mfma_f32_16x16x32_bf16 a[248:251], v[88:91], v[124:127], a[248:251]
    v_mfma_f32_16x16x32_bf16 a[252:255], v[92:95], v[124:127], a[252:255]
    s_waitcnt lgkmcnt(0)
    v_mfma_f32_16x16x32_bf16 a[0:3], v[0:3], v[32:35], a[0:3]
    s_waitcnt vmcnt(0)
    s_barrier
    ds_read_b128 v[96:99], v136 offset:49152
    v_mfma_f32_16x16x32_bf16 a[4:7], v[4:7], v[32:35], a[4:7]
    ds_read_b64_tr_b16 v[64:65], v128 offset:49152
    v_mfma_f32_16x16x32_bf16 a[8:11], v[8:11], v[32:35], a[8:11]
    ds_read_b64_tr_b16 v[66:67], v128 offset:57344
    v_mfma_f32_16x16x32_bf16 a[12:15], v[12:15], v[32:35], a[12:15]
    ds_read_b64_tr_b16 v[68:69], v129 offset:49152
    v_mfma_f32_16x16x32_bf16 a[16:19], v[16:19], v[32:35], a[16:19]
    ds_read_b64_tr_b16 v[70:71], v129 offset:57344
    v_mfma_f32_16x16x32_bf16 a[20:23], v[20:23], v[32:35], a[20:23]
    ds_read_b64_tr_b16 v[72:73], v130 offset:49152
    v_mfma_f32_16x16x32_bf16 a[24:27], v[24:27], v[32:35], a[24:27]
    ds_read_b64_tr_b16 v[74:75], v130 offset:57344
    v_mfma_f32_16x16x32_bf16 a[28:31], v[28:31], v[32:35], a[28:31]
    ds_read_b64_tr_b16 v[76:77], v131 offset:49152
    v_mfma_f32_16x16x32_bf16 a[32:35], v[0:3], v[36:39], a[32:35]
    ds_read_b64_tr_b16 v[78:79], v131 offset:57344
    v_mfma_f32_16x16x32_bf16 a[36:39], v[4:7], v[36:39], a[36:39]
    ds_read_b64_tr_b16 v[80:81], v132 offset:49152
    v_mfma_f32_16x16x32_bf16 a[40:43], v[8:11], v[36:39], a[40:43]
    ds_read_b64_tr_b16 v[82:83], v132 offset:57344
    v_mfma_f32_16x16x32_bf16 a[44:47], v[12:15], v[36:39], a[44:47]
    ds_read_b64_tr_b16 v[84:85], v133 offset:49152
    v_mfma_f32_16x16x32_bf16 a[48:51], v[16:19], v[36:39], a[48:51]
    ds_read_b64_tr_b16 v[86:87], v133 offset:57344
    v_mfma_f32_16x16x32_bf16 a[52:55], v[20:23], v[36:39], a[52:55]
    ds_read_b64_tr_b16 v[88:89], v134 offset:49152
    v_mfma_f32_16x16x32_bf16 a[56:59], v[24:27], v[36:39], a[56:59]
    ds_read_b64_tr_b16 v[90:91], v134 offset:57344
    v_mfma_f32_16x16x32_bf16 a[60:63], v[28:31], v[36:39], a[60:63]
    ds_read_b64_tr_b16 v[92:93], v135 offset:49152
    v_mfma_f32_16x16x32_bf16 a[64:67], v[0:3], v[40:43], a[64:67]
    ds_read_b64_tr_b16 v[94:95], v135 offset:57344
    v_mfma_f32_16x16x32_bf16 a[68:71], v[4:7], v[40:43], a[68:71]
    ds_read_b128 v[100:103], v136 offset:50176
    v_mfma_f32_16x16x32_bf16 a[72:75], v[8:11], v[40:43], a[72:75]
    ds_read_b128 v[104:107], v136 offset:51200
    v_mfma_f32_16x16x32_bf16 a[76:79], v[12:15], v[40:43], a[76:79]
    ds_read_b128 v[108:111], v136 offset:52224
    v_mfma_f32_16x16x32_bf16 a[80:83], v[16:19], v[40:43], a[80:83]
    ds_read_b128 v[112:115], v136 offset:53248
    v_mfma_f32_16x16x32_bf16 a[84:87], v[20:23], v[40:43], a[84:87]
    ds_read_b128 v[116:119], v136 offset:54272
    v_mfma_f32_16x16x32_bf16 a[88:91], v[24:27], v[40:43], a[88:91]
    ds_read_b128 v[120:123], v136 offset:55296
    v_mfma_f32_16x16x32_bf16 a[92:95], v[28:31], v[40:43], a[92:95]
    ds_read_b128 v[124:127], v136 offset:56320
    v_mfma_f32_16x16x32_bf16 a[96:99], v[0:3], v[44:47], a[96:99]
    v_mfma_f32_16x16x32_bf16 a[100:103], v[4:7], v[44:47], a[100:103]
    v_mfma_f32_16x16x32_bf16 a[104:107], v[8:11], v[44:47], a[104:107]
    v_mfma_f32_16x16x32_bf16 a[108:111], v[12:15], v[44:47], a[108:111]
    v_mfma_f32_16x16x32_bf16 a[112:115], v[16:19], v[44:47], a[112:115]
    v_mfma_f32_16x16x32_bf16 a[116:119], v[20:23], v[44:47], a[116:119]
    v_mfma_f32_16x16x32_bf16 a[120:123], v[24:27], v[44:47], a[120:123]
    v_mfma_f32_16x16x32_bf16 a[124:127], v[28:31], v[44:47], a[124:127]
    v_mfma_f32_16x16x32_bf16 a[128:131], v[0:3], v[48:51], a[128:131]
    v_mfma_f32_16x16x32_bf16 a[132:135], v[4:7], v[48:51], a[132:135]
    v_mfma_f32_16x16x32_bf16 a[136:139], v[8:11], v[48:51], a[136:139]
    v_mfma_f32_16x16x32_bf16 a[140:143], v[12:15], v[48:51], a[140:143]
    v_mfma_f32_16x16x32_bf16 a[144:147], v[16:19], v[48:51], a[144:147]
    v_mfma_f32_16x16x32_bf16 a[148:151], v[20:23], v[48:51], a[148:151]
    v_mfma_f32_16x16x32_bf16 a[152:155], v[24:27], v[48:51], a[152:155]
    v_mfma_f32_16x16x32_bf16 a[156:159], v[28:31], v[48:51], a[156:159]
    v_mfma_f32_16x16x32_bf16 a[160:163], v[0:3], v[52:55], a[160:163]
    v_mfma_f32_16x16x32_bf16 a[164:167], v[4:7], v[52:55], a[164:167]
    v_mfma_f32_16x16x32_bf16 a[168:171], v[8:11], v[52:55], a[168:171]
    v_mfma_f32_16x16x32_bf16 a[172:175], v[12:15], v[52:55], a[172:175]
    v_mfma_f32_16x16x32_bf16 a[176:179], v[16:19], v[52:55], a[176:179]
    v_mfma_f32_16x16x32_bf16 a[180:183], v[20:23], v[52:55], a[180:183]
    v_mfma_f32_16x16x32_bf16 a[184:187], v[24:27], v[52:55], a[184:187]
    v_mfma_f32_16x16x32_bf16 a[188:191], v[28:31], v[52:55], a[188:191]
    v_mfma_f32_16x16x32_bf16 a[192:195], v[0:3], v[56:59], a[192:195]
    v_mfma_f32_16x16x32_bf16 a[196:199], v[4:7], v[56:59], a[196:199]
    v_mfma_f32_16x16x32_bf16 a[200:203], v[8:11], v[56:59], a[200:203]
    v_mfma_f32_16x16x32_bf16 a[204:207], v[12:15], v[56:59], a[204:207]
    v_mfma_f32_16x16x32_bf16 a[208:211], v[16:19], v[56:59], a[208:211]
    v_mfma_f32_16x16x32_bf16 a[212:215], v[20:23], v[56:59], a[212:215]
    v_mfma_f32_16x16x32_bf16 a[216:219], v[24:27], v[56:59], a[216:219]
    v_mfma_f32_16x16x32_bf16 a[220:223], v[28:31], v[56:59], a[220:223]
    v_mfma_f32_16x16x32_bf16 a[224:227], v[0:3], v[60:63], a[224:227]
    v_mfma_f32_16x16x32_bf16 a[228:231], v[4:7], v[60:63], a[228:231]
    v_mfma_f32_16x16x32_bf16 a[232:235], v[8:11], v[60:63], a[232:235]
    v_mfma_f32_16x16x32_bf16 a[236:239], v[12:15], v[60:63], a[236:239]
    v_mfma_f32_16x16x32_bf16 a[240:243], v[16:19], v[60:63], a[240:243]
    v_mfma_f32_16x16x32_bf16 a[244:247], v[20:23], v[60:63], a[244:247]
    v_mfma_f32_16x16x32_bf16 a[248:251], v[24:27], v[60:63], a[248:251]
    v_mfma_f32_16x16x32_bf16 a[252:255], v[28:31], v[60:63], a[252:255]
    v_readfirstlane_b32 s55, v255
    s_waitcnt lgkmcnt(0)
    v_mfma_f32_16x16x32_bf16 a[0:3], v[64:67], v[96:99], a[0:3]
    v_mfma_f32_16x16x32_bf16 a[4:7], v[68:71], v[96:99], a[4:7]
    v_mfma_f32_16x16x32_bf16 a[8:11], v[72:75], v[96:99], a[8:11]
    v_mfma_f32_16x16x32_bf16 a[12:15], v[76:79], v[96:99], a[12:15]
    v_mfma_f32_16x16x32_bf16 a[16:19], v[80:83], v[96:99], a[16:19]
    v_mfma_f32_16x16x32_bf16 a[20:23], v[84:87], v[96:99], a[20:23]
    v_mfma_f32_16x16x32_bf16 a[24:27], v[88:91], v[96:99], a[24:27]
    v_mfma_f32_16x16x32_bf16 a[28:31], v[92:95], v[96:99], a[28:31]
    v_mfma_f32_16x16x32_bf16 a[32:35], v[64:67], v[100:103], a[32:35]
    v_mfma_f32_16x16x32_bf16 a[36:39], v[68:71], v[100:103], a[36:39]
    v_mfma_f32_16x16x32_bf16 a[40:43], v[72:75], v[100:103], a[40:43]
    v_mfma_f32_16x16x32_bf16 a[44:47], v[76:79], v[100:103], a[44:47]
    v_mfma_f32_16x16x32_bf16 a[48:51], v[80:83], v[100:103], a[48:51]
    v_mfma_f32_16x16x32_bf16 a[52:55], v[84:87], v[100:103], a[52:55]
    v_mfma_f32_16x16x32_bf16 a[56:59], v[88:91], v[100:103], a[56:59]
    v_mfma_f32_16x16x32_bf16 a[60:63], v[92:95], v[100:103], a[60:63]
    v_mfma_f32_16x16x32_bf16 a[64:67], v[64:67], v[104:107], a[64:67]
    v_mfma_f32_16x16x32_bf16 a[68:71], v[68:71], v[104:107], a[68:71]
    v_mfma_f32_16x16x32_bf16 a[72:75], v[72:75], v[104:107], a[72:75]
    v_mfma_f32_16x16x32_bf16 a[76:79], v[76:79], v[104:107], a[76:79]
    v_mfma_f32_16x16x32_bf16 a[80:83], v[80:83], v[104:107], a[80:83]
    v_mfma_f32_16x16x32_bf16 a[84:87], v[84:87], v[104:107], a[84:87]
    v_mfma_f32_16x16x32_bf16 a[88:91], v[88:91], v[104:107], a[88:91]
    v_mfma_f32_16x16x32_bf16 a[92:95], v[92:95], v[104:107], a[92:95]
    v_mfma_f32_16x16x32_bf16 a[96:99], v[64:67], v[108:111], a[96:99]
    v_mfma_f32_16x16x32_bf16 a[100:103], v[68:71], v[108:111], a[100:103]
    v_mfma_f32_16x16x32_bf16 a[104:107], v[72:75], v[108:111], a[104:107]
    v_mfma_f32_16x16x32_bf16 a[108:111], v[76:79], v[108:111], a[108:111]
    v_mfma_f32_16x16x32_bf16 a[112:115], v[80:83], v[108:111], a[112:115]
    v_mfma_f32_16x16x32_bf16 a[116:119], v[84:87], v[108:111], a[116:119]
    v_mfma_f32_16x16x32_bf16 a[120:123], v[88:91], v[108:111], a[120:123]
    v_mfma_f32_16x16x32_bf16 a[124:127], v[92:95], v[108:111], a[124:127]
    v_mfma_f32_16x16x32_bf16 a[128:131], v[64:67], v[112:115], a[128:131]
    v_mfma_f32_16x16x32_bf16 a[132:135], v[68:71], v[112:115], a[132:135]
    v_mfma_f32_16x16x32_bf16 a[136:139], v[72:75], v[112:115], a[136:139]
    v_mfma_f32_16x16x32_bf16 a[140:143], v[76:79], v[112:115], a[140:143]
    v_mfma_f32_16x16x32_bf16 a[144:147], v[80:83], v[112:115], a[144:147]
    v_mfma_f32_16x16x32_bf16 a[148:151], v[84:87], v[112:115], a[148:151]
    v_mfma_f32_16x16x32_bf16 a[152:155], v[88:91], v[112:115], a[152:155]
    v_mfma_f32_16x16x32_bf16 a[156:159], v[92:95], v[112:115], a[156:159]
    v_mfma_f32_16x16x32_bf16 a[160:163], v[64:67], v[116:119], a[160:163]
    v_mfma_f32_16x16x32_bf16 a[164:167], v[68:71], v[116:119], a[164:167]
    v_mfma_f32_16x16x32_bf16 a[168:171], v[72:75], v[116:119], a[168:171]
    v_mfma_f32_16x16x32_bf16 a[172:175], v[76:79], v[116:119], a[172:175]
    v_mfma_f32_16x16x32_bf16 a[176:179], v[80:83], v[116:119], a[176:179]
    v_mfma_f32_16x16x32_bf16 a[180:183], v[84:87], v[116:119], a[180:183]
    v_mfma_f32_16x16x32_bf16 a[184:187], v[88:91], v[116:119], a[184:187]
    v_mfma_f32_16x16x32_bf16 a[188:191], v[92:95], v[116:119], a[188:191]
    v_mfma_f32_16x16x32_bf16 a[192:195], v[64:67], v[120:123], a[192:195]
    v_mfma_f32_16x16x32_bf16 a[196:199], v[68:71], v[120:123], a[196:199]
    v_mfma_f32_16x16x32_bf16 a[200:203], v[72:75], v[120:123], a[200:203]
    v_mfma_f32_16x16x32_bf16 a[204:207], v[76:79], v[120:123], a[204:207]
    v_mfma_f32_16x16x32_bf16 a[208:211], v[80:83], v[120:123], a[208:211]
    v_mfma_f32_16x16x32_bf16 a[212:215], v[84:87], v[120:123], a[212:215]
    v_mfma_f32_16x16x32_bf16 a[216:219], v[88:91], v[120:123], a[216:219]
    v_mfma_f32_16x16x32_bf16 a[220:223], v[92:95], v[120:123], a[220:223]
    v_mfma_f32_16x16x32_bf16 a[224:227], v[64:67], v[124:127], a[224:227]
    v_mfma_f32_16x16x32_bf16 a[228:231], v[68:71], v[124:127], a[228:231]
    v_mfma_f32_16x16x32_bf16 a[232:235], v[72:75], v[124:127], a[232:235]
    v_mfma_f32_16x16x32_bf16 a[236:239], v[76:79], v[124:127], a[236:239]
    v_mfma_f32_16x16x32_bf16 a[240:243], v[80:83], v[124:127], a[240:243]
    v_mfma_f32_16x16x32_bf16 a[244:247], v[84:87], v[124:127], a[244:247]
    v_mfma_f32_16x16x32_bf16 a[248:251], v[88:91], v[124:127], a[248:251]
    v_mfma_f32_16x16x32_bf16 a[252:255], v[92:95], v[124:127], a[252:255]
    s_nop 7
    s_cmp_eq_u32 s23, 1
    s_cbranch_scc1 main_kernel_w_c2_escl
    s_cmp_eq_u32 s23, 6
    s_cbranch_scc1 main_kernel_w_c2_egelu
main_kernel_w_c2_eplain:
    s_mov_b32 s53, s21
    v_accvgpr_read_b32 v0, a0
    v_accvgpr_read_b32 v1, a1
    v_accvgpr_read_b32 v2, a2
    v_accvgpr_read_b32 v3, a3
    v_accvgpr_read_b32 v4, a4
    v_accvgpr_read_b32 v5, a5
    v_accvgpr_read_b32 v6, a6
    v_accvgpr_read_b32 v7, a7
    v_cvt_pk_bf16_f32 v16, v0, v1
    v_cvt_pk_bf16_f32 v17, v2, v3
    v_cvt_pk_bf16_f32 v18, v4, v5
    v_cvt_pk_bf16_f32 v19, v6, v7
    buffer_store_dwordx4 v[16:19], v251, s[4:7], s53 offen offset:0 sc1
    v_accvgpr_read_b32 v20, a8
    v_accvgpr_read_b32 v21, a9
    v_accvgpr_read_b32 v22, a10
    v_accvgpr_read_b32 v23, a11
    v_accvgpr_read_b32 v24, a12
    v_accvgpr_read_b32 v25, a13
    v_accvgpr_read_b32 v26, a14
    v_accvgpr_read_b32 v27, a15
    v_cvt_pk_bf16_f32 v36, v20, v21
    v_cvt_pk_bf16_f32 v37, v22, v23
    v_cvt_pk_bf16_f32 v38, v24, v25
    v_cvt_pk_bf16_f32 v39, v26, v27
    buffer_store_dwordx4 v[36:39], v251, s[4:7], s53 offen offset:1024 sc1
    v_accvgpr_read_b32 v40, a16
    v_accvgpr_read_b32 v41, a17
    v_accvgpr_read_b32 v42, a18
    v_accvgpr_read_b32 v43, a19
    v_accvgpr_read_b32 v44, a20
    v_accvgpr_read_b32 v45, a21
    v_accvgpr_read_b32 v46, a22
    v_accvgpr_read_b32 v47, a23
    v_cvt_pk_bf16_f32 v56, v40, v41
    v_cvt_pk_bf16_f32 v57, v42, v43
    v_cvt_pk_bf16_f32 v58, v44, v45
    v_cvt_pk_bf16_f32 v59, v46, v47
    buffer_store_dwordx4 v[56:59], v251, s[4:7], s53 offen offset:2048 sc1
    v_accvgpr_read_b32 v0, a24
    v_accvgpr_read_b32 v1, a25
    v_accvgpr_read_b32 v2, a26
    v_accvgpr_read_b32 v3, a27
    v_accvgpr_read_b32 v4, a28
    v_accvgpr_read_b32 v5, a29
    v_accvgpr_read_b32 v6, a30
    v_accvgpr_read_b32 v7, a31
    v_cvt_pk_bf16_f32 v16, v0, v1
    v_cvt_pk_bf16_f32 v17, v2, v3
    v_cvt_pk_bf16_f32 v18, v4, v5
    v_cvt_pk_bf16_f32 v19, v6, v7
    buffer_store_dwordx4 v[16:19], v251, s[4:7], s53 offen offset:3072 sc1
    s_add_u32 s53, s53, s22
    v_accvgpr_read_b32 v20, a32
    v_accvgpr_read_b32 v21, a33
    v_accvgpr_read_b32 v22, a34
    v_accvgpr_read_b32 v23, a35
    v_accvgpr_read_b32 v24, a36
    v_accvgpr_read_b32 v25, a37
    v_accvgpr_read_b32 v26, a38
    v_accvgpr_read_b32 v27, a39
    v_cvt_pk_bf16_f32 v36, v20, v21
    v_cvt_pk_bf16_f32 v37, v22, v23
    v_cvt_pk_bf16_f32 v38, v24, v25
    v_cvt_pk_bf16_f32 v39, v26, v27
    buffer_store_dwordx4 v[36:39], v251, s[4:7], s53 offen offset:0 sc1
    v_accvgpr_read_b32 v40, a40
    v_accvgpr_read_b32 v41, a41
    v_accvgpr_read_b32 v42, a42
    v_accvgpr_read_b32 v43, a43
    v_accvgpr_read_b32 v44, a44
    v_accvgpr_read_b32 v45, a45
    v_accvgpr_read_b32 v46, a46
    v_accvgpr_read_b32 v47, a47
    v_cvt_pk_bf16_f32 v56, v40, v41
    v_cvt_pk_bf16_f32 v57, v42, v43
    v_cvt_pk_bf16_f32 v58, v44, v45
    v_cvt_pk_bf16_f32 v59, v46, v47
    buffer_store_dwordx4 v[56:59], v251, s[4:7], s53 offen offset:1024 sc1
    v_accvgpr_read_b32 v0, a48
    v_accvgpr_read_b32 v1, a49
    v_accvgpr_read_b32 v2, a50
    v_accvgpr_read_b32 v3, a51
    v_accvgpr_read_b32 v4, a52
    v_accvgpr_read_b32 v5, a53
    v_accvgpr_read_b32 v6, a54
    v_accvgpr_read_b32 v7, a55
    v_cvt_pk_bf16_f32 v16, v0, v1
    v_cvt_pk_bf16_f32 v17, v2, v3
    v_cvt_pk_bf16_f32 v18, v4, v5
    v_cvt_pk_bf16_f32 v19, v6, v7
    buffer_store_dwordx4 v[16:19], v251, s[4:7], s53 offen offset:2048 sc1
    v_accvgpr_read_b32 v20, a56
    v_accvgpr_read_b32 v21, a57
    v_accvgpr_read_b32 v22, a58
    v_accvgpr_read_b32 v23, a59
    v_accvgpr_read_b32 v24, a60
    v_accvgpr_read_b32 v25, a61
    v_accvgpr_read_b32 v26, a62
    v_accvgpr_read_b32 v27, a63
    v_cvt_pk_bf16_f32 v36, v20, v21
    v_cvt_pk_bf16_f32 v37, v22, v23
    v_cvt_pk_bf16_f32 v38, v24, v25
    v_cvt_pk_bf16_f32 v39, v26, v27
    buffer_store_dwordx4 v[36:39], v251, s[4:7], s53 offen offset:3072 sc1
    s_add_u32 s53, s53, s22
    v_accvgpr_read_b32 v40, a64
    v_accvgpr_read_b32 v41, a65
    v_accvgpr_read_b32 v42, a66
    v_accvgpr_read_b32 v43, a67
    v_accvgpr_read_b32 v44, a68
    v_accvgpr_read_b32 v45, a69
    v_accvgpr_read_b32 v46, a70
    v_accvgpr_read_b32 v47, a71
    v_cvt_pk_bf16_f32 v56, v40, v41
    v_cvt_pk_bf16_f32 v57, v42, v43
    v_cvt_pk_bf16_f32 v58, v44, v45
    v_cvt_pk_bf16_f32 v59, v46, v47
    buffer_store_dwordx4 v[56:59], v251, s[4:7], s53 offen offset:0 sc1
    v_accvgpr_read_b32 v0, a72
    v_accvgpr_read_b32 v1, a73
    v_accvgpr_read_b32 v2, a74
    v_accvgpr_read_b32 v3, a75
    v_accvgpr_read_b32 v4, a76
    v_accvgpr_read_b32 v5, a77
    v_accvgpr_read_b32 v6, a78
    v_accvgpr_read_b32 v7, a79
    v_cvt_pk_bf16_f32 v16, v0, v1
    v_cvt_pk_bf16_f32 v17, v2, v3
    v_cvt_pk_bf16_f32 v18, v4, v5
    v_cvt_pk_bf16_f32 v19, v6, v7
    buffer_store_dwordx4 v[16:19], v251, s[4:7], s53 offen offset:1024 sc1
    v_accvgpr_read_b32 v20, a80
    v_accvgpr_read_b32 v21, a81
    v_accvgpr_read_b32 v22, a82
    v_accvgpr_read_b32 v23, a83
    v_accvgpr_read_b32 v24, a84
    v_accvgpr_read_b32 v25, a85
    v_accvgpr_read_b32 v26, a86
    v_accvgpr_read_b32 v27, a87
    v_cvt_pk_bf16_f32 v36, v20, v21
    v_cvt_pk_bf16_f32 v37, v22, v23
    v_cvt_pk_bf16_f32 v38, v24, v25
    v_cvt_pk_bf16_f32 v39, v26, v27
    buffer_store_dwordx4 v[36:39], v251, s[4:7], s53 offen offset:2048 sc1
    v_accvgpr_read_b32 v40, a88
    v_accvgpr_read_b32 v41, a89
    v_accvgpr_read_b32 v42, a90
    v_accvgpr_read_b32 v43, a91
    v_accvgpr_read_b32 v44, a92
    v_accvgpr_read_b32 v45, a93
    v_accvgpr_read_b32 v46, a94
    v_accvgpr_read_b32 v47, a95
    v_cvt_pk_bf16_f32 v56, v40, v41
    v_cvt_pk_bf16_f32 v57, v42, v43
    v_cvt_pk_bf16_f32 v58, v44, v45
    v_cvt_pk_bf16_f32 v59, v46, v47
    buffer_store_dwordx4 v[56:59], v251, s[4:7], s53 offen offset:3072 sc1
    s_add_u32 s53, s53, s22
    v_accvgpr_read_b32 v0, a96
    v_accvgpr_read_b32 v1, a97
    v_accvgpr_read_b32 v2, a98
    v_accvgpr_read_b32 v3, a99
    v_accvgpr_read_b32 v4, a100
    v_accvgpr_read_b32 v5, a101
    v_accvgpr_read_b32 v6, a102
    v_accvgpr_read_b32 v7, a103
    v_cvt_pk_bf16_f32 v16, v0, v1
    v_cvt_pk_bf16_f32 v17, v2, v3
    v_cvt_pk_bf16_f32 v18, v4, v5
    v_cvt_pk_bf16_f32 v19, v6, v7
    buffer_store_dwordx4 v[16:19], v251, s[4:7], s53 offen offset:0 sc1
    v_accvgpr_read_b32 v20, a104
    v_accvgpr_read_b32 v21, a105
    v_accvgpr_read_b32 v22, a106
    v_accvgpr_read_b32 v23, a107
    v_accvgpr_read_b32 v24, a108
    v_accvgpr_read_b32 v25, a109
    v_accvgpr_read_b32 v26, a110
    v_accvgpr_read_b32 v27, a111
    v_cvt_pk_bf16_f32 v36, v20, v21
    v_cvt_pk_bf16_f32 v37, v22, v23
    v_cvt_pk_bf16_f32 v38, v24, v25
    v_cvt_pk_bf16_f32 v39, v26, v27
    buffer_store_dwordx4 v[36:39], v251, s[4:7], s53 offen offset:1024 sc1
    v_accvgpr_read_b32 v40, a112
    v_accvgpr_read_b32 v41, a113
    v_accvgpr_read_b32 v42, a114
    v_accvgpr_read_b32 v43, a115
    v_accvgpr_read_b32 v44, a116
    v_accvgpr_read_b32 v45, a117
    v_accvgpr_read_b32 v46, a118
    v_accvgpr_read_b32 v47, a119
    v_cvt_pk_bf16_f32 v56, v40, v41
    v_cvt_pk_bf16_f32 v57, v42, v43
    v_cvt_pk_bf16_f32 v58, v44, v45
    v_cvt_pk_bf16_f32 v59, v46, v47
    buffer_store_dwordx4 v[56:59], v251, s[4:7], s53 offen offset:2048 sc1
    v_accvgpr_read_b32 v0, a120
    v_accvgpr_read_b32 v1, a121
    v_accvgpr_read_b32 v2, a122
    v_accvgpr_read_b32 v3, a123
    v_accvgpr_read_b32 v4, a124
    v_accvgpr_read_b32 v5, a125
    v_accvgpr_read_b32 v6, a126
    v_accvgpr_read_b32 v7, a127
    v_cvt_pk_bf16_f32 v16, v0, v1
    v_cvt_pk_bf16_f32 v17, v2, v3
    v_cvt_pk_bf16_f32 v18, v4, v5
    v_cvt_pk_bf16_f32 v19, v6, v7
    buffer_store_dwordx4 v[16:19], v251, s[4:7], s53 offen offset:3072 sc1
    s_add_u32 s53, s53, s22
    v_accvgpr_read_b32 v20, a128
    v_accvgpr_read_b32 v21, a129
    v_accvgpr_read_b32 v22, a130
    v_accvgpr_read_b32 v23, a131
    v_accvgpr_read_b32 v24, a132
    v_accvgpr_read_b32 v25, a133
    v_accvgpr_read_b32 v26, a134
    v_accvgpr_read_b32 v27, a135
    v_cvt_pk_bf16_f32 v36, v20, v21
    v_cvt_pk_bf16_f32 v37, v22, v23
    v_cvt_pk_bf16_f32 v38, v24, v25
    v_cvt_pk_bf16_f32 v39, v26, v27
    buffer_store_dwordx4 v[36:39], v251, s[4:7], s53 offen offset:0 sc1
    v_accvgpr_read_b32 v40, a136
    v_accvgpr_read_b32 v41, a137
    v_accvgpr_read_b32 v42, a138
    v_accvgpr_read_b32 v43, a139
    v_accvgpr_read_b32 v44, a140
    v_accvgpr_read_b32 v45, a141
    v_accvgpr_read_b32 v46, a142
    v_accvgpr_read_b32 v47, a143
    v_cvt_pk_bf16_f32 v56, v40, v41
    v_cvt_pk_bf16_f32 v57, v42, v43
    v_cvt_pk_bf16_f32 v58, v44, v45
    v_cvt_pk_bf16_f32 v59, v46, v47
    buffer_store_dwordx4 v[56:59], v251, s[4:7], s53 offen offset:1024 sc1
    v_accvgpr_read_b32 v0, a144
    v_accvgpr_read_b32 v1, a145
    v_accvgpr_read_b32 v2, a146
    v_accvgpr_read_b32 v3, a147
    v_accvgpr_read_b32 v4, a148
    v_accvgpr_read_b32 v5, a149
    v_accvgpr_read_b32 v6, a150
    v_accvgpr_read_b32 v7, a151
    v_cvt_pk_bf16_f32 v16, v0, v1
    v_cvt_pk_bf16_f32 v17, v2, v3
    v_cvt_pk_bf16_f32 v18, v4, v5
    v_cvt_pk_bf16_f32 v19, v6, v7
    buffer_store_dwordx4 v[16:19], v251, s[4:7], s53 offen offset:2048 sc1
    v_accvgpr_read_b32 v20, a152
    v_accvgpr_read_b32 v21, a153
    v_accvgpr_read_b32 v22, a154
    v_accvgpr_read_b32 v23, a155
    v_accvgpr_read_b32 v24, a156
    v_accvgpr_read_b32 v25, a157
    v_accvgpr_read_b32 v26, a158
    v_accvgpr_read_b32 v27, a159
    v_cvt_pk_bf16_f32 v36, v20, v21
    v_cvt_pk_bf16_f32 v37, v22, v23
    v_cvt_pk_bf16_f32 v38, v24, v25
    v_cvt_pk_bf16_f32 v39, v26, v27
    buffer_store_dwordx4 v[36:39], v251, s[4:7], s53 offen offset:3072 sc1
    s_add_u32 s53, s53, s22
    v_accvgpr_read_b32 v40, a160
    v_accvgpr_read_b32 v41, a161
    v_accvgpr_read_b32 v42, a162
    v_accvgpr_read_b32 v43, a163
    v_accvgpr_read_b32 v44, a164
    v_accvgpr_read_b32 v45, a165
    v_accvgpr_read_b32 v46, a166
    v_accvgpr_read_b32 v47, a167
    v_cvt_pk_bf16_f32 v56, v40, v41
    v_cvt_pk_bf16_f32 v57, v42, v43
    v_cvt_pk_bf16_f32 v58, v44, v45
    v_cvt_pk_bf16_f32 v59, v46, v47
    buffer_store_dwordx4 v[56:59], v251, s[4:7], s53 offen offset:0 sc1
    v_accvgpr_read_b32 v0, a168
    v_accvgpr_read_b32 v1, a169
    v_accvgpr_read_b32 v2, a170
    v_accvgpr_read_b32 v3, a171
    v_accvgpr_read_b32 v4, a172
    v_accvgpr_read_b32 v5, a173
    v_accvgpr_read_b32 v6, a174
    v_accvgpr_read_b32 v7, a175
    v_cvt_pk_bf16_f32 v16, v0, v1
    v_cvt_pk_bf16_f32 v17, v2, v3
    v_cvt_pk_bf16_f32 v18, v4, v5
    v_cvt_pk_bf16_f32 v19, v6, v7
    buffer_store_dwordx4 v[16:19], v251, s[4:7], s53 offen offset:1024 sc1
    v_accvgpr_read_b32 v20, a176
    v_accvgpr_read_b32 v21, a177
    v_accvgpr_read_b32 v22, a178
    v_accvgpr_read_b32 v23, a179
    v_accvgpr_read_b32 v24, a180
    v_accvgpr_read_b32 v25, a181
    v_accvgpr_read_b32 v26, a182
    v_accvgpr_read_b32 v27, a183
    v_cvt_pk_bf16_f32 v36, v20, v21
    v_cvt_pk_bf16_f32 v37, v22, v23
    v_cvt_pk_bf16_f32 v38, v24, v25
    v_cvt_pk_bf16_f32 v39, v26, v27
    buffer_store_dwordx4 v[36:39], v251, s[4:7], s53 offen offset:2048 sc1
    v_accvgpr_read_b32 v40, a184
    v_accvgpr_read_b32 v41, a185
    v_accvgpr_read_b32 v42, a186
    v_accvgpr_read_b32 v43, a187
    v_accvgpr_read_b32 v44, a188
    v_accvgpr_read_b32 v45, a189
    v_accvgpr_read_b32 v46, a190
    v_accvgpr_read_b32 v47, a191
    v_cvt_pk_bf16_f32 v56, v40, v41
    v_cvt_pk_bf16_f32 v57, v42, v43
    v_cvt_pk_bf16_f32 v58, v44, v45
    v_cvt_pk_bf16_f32 v59, v46, v47
    buffer_store_dwordx4 v[56:59], v251, s[4:7], s53 offen offset:3072 sc1
    s_add_u32 s53, s53, s22
    v_accvgpr_read_b32 v0, a192
    v_accvgpr_read_b32 v1, a193
    v_accvgpr_read_b32 v2, a194
    v_accvgpr_read_b32 v3, a195
    v_accvgpr_read_b32 v4, a196
    v_accvgpr_read_b32 v5, a197
    v_accvgpr_read_b32 v6, a198
    v_accvgpr_read_b32 v7, a199
    v_cvt_pk_bf16_f32 v16, v0, v1
    v_cvt_pk_bf16_f32 v17, v2, v3
    v_cvt_pk_bf16_f32 v18, v4, v5
    v_cvt_pk_bf16_f32 v19, v6, v7
    buffer_store_dwordx4 v[16:19], v251, s[4:7], s53 offen offset:0 sc1
    v_accvgpr_read_b32 v20, a200
    v_accvgpr_read_b32 v21, a201
    v_accvgpr_read_b32 v22, a202
    v_accvgpr_read_b32 v23, a203
    v_accvgpr_read_b32 v24, a204
    v_accvgpr_read_b32 v25, a205
    v_accvgpr_read_b32 v26, a206
    v_accvgpr_read_b32 v27, a207
    v_cvt_pk_bf16_f32 v36, v20, v21
    v_cvt_pk_bf16_f32 v37, v22, v23
    v_cvt_pk_bf16_f32 v38, v24, v25
    v_cvt_pk_bf16_f32 v39, v26, v27
    buffer_store_dwordx4 v[36:39], v251, s[4:7], s53 offen offset:1024 sc1
    v_accvgpr_read_b32 v40, a208
    v_accvgpr_read_b32 v41, a209
    v_accvgpr_read_b32 v42, a210
    v_accvgpr_read_b32 v43, a211
    v_accvgpr_read_b32 v44, a212
    v_accvgpr_read_b32 v45, a213
    v_accvgpr_read_b32 v46, a214
    v_accvgpr_read_b32 v47, a215
    v_cvt_pk_bf16_f32 v56, v40, v41
    v_cvt_pk_bf16_f32 v57, v42, v43
    v_cvt_pk_bf16_f32 v58, v44, v45
    v_cvt_pk_bf16_f32 v59, v46, v47
    buffer_store_dwordx4 v[56:59], v251, s[4:7], s53 offen offset:2048 sc1
    v_accvgpr_read_b32 v0, a216
    v_accvgpr_read_b32 v1, a217
    v_accvgpr_read_b32 v2, a218
    v_accvgpr_read_b32 v3, a219
    v_accvgpr_read_b32 v4, a220
    v_accvgpr_read_b32 v5, a221
    v_accvgpr_read_b32 v6, a222
    v_accvgpr_read_b32 v7, a223
    v_cvt_pk_bf16_f32 v16, v0, v1
    v_cvt_pk_bf16_f32 v17, v2, v3
    v_cvt_pk_bf16_f32 v18, v4, v5
    v_cvt_pk_bf16_f32 v19, v6, v7
    buffer_store_dwordx4 v[16:19], v251, s[4:7], s53 offen offset:3072 sc1
    s_add_u32 s53, s53, s22
    v_accvgpr_read_b32 v20, a224
    v_accvgpr_read_b32 v21, a225
    v_accvgpr_read_b32 v22, a226
    v_accvgpr_read_b32 v23, a227
    v_accvgpr_read_b32 v24, a228
    v_accvgpr_read_b32 v25, a229
    v_accvgpr_read_b32 v26, a230
    v_accvgpr_read_b32 v27, a231
    v_cvt_pk_bf16_f32 v36, v20, v21
    v_cvt_pk_bf16_f32 v37, v22, v23
    v_cvt_pk_bf16_f32 v38, v24, v25
    v_cvt_pk_bf16_f32 v39, v26, v27
    buffer_store_dwordx4 v[36:39], v251, s[4:7], s53 offen offset:0 sc1
    v_accvgpr_read_b32 v40, a232
    v_accvgpr_read_b32 v41, a233
    v_accvgpr_read_b32 v42, a234
    v_accvgpr_read_b32 v43, a235
    v_accvgpr_read_b32 v44, a236
    v_accvgpr_read_b32 v45, a237
    v_accvgpr_read_b32 v46, a238
    v_accvgpr_read_b32 v47, a239
    v_cvt_pk_bf16_f32 v56, v40, v41
    v_cvt_pk_bf16_f32 v57, v42, v43
    v_cvt_pk_bf16_f32 v58, v44, v45
    v_cvt_pk_bf16_f32 v59, v46, v47
    buffer_store_dwordx4 v[56:59], v251, s[4:7], s53 offen offset:1024 sc1
    v_accvgpr_read_b32 v0, a240
    v_accvgpr_read_b32 v1, a241
    v_accvgpr_read_b32 v2, a242
    v_accvgpr_read_b32 v3, a243
    v_accvgpr_read_b32 v4, a244
    v_accvgpr_read_b32 v5, a245
    v_accvgpr_read_b32 v6, a246
    v_accvgpr_read_b32 v7, a247
    v_cvt_pk_bf16_f32 v16, v0, v1
    v_cvt_pk_bf16_f32 v17, v2, v3
    v_cvt_pk_bf16_f32 v18, v4, v5
    v_cvt_pk_bf16_f32 v19, v6, v7
    buffer_store_dwordx4 v[16:19], v251, s[4:7], s53 offen offset:2048 sc1
    v_accvgpr_read_b32 v20, a248
    v_accvgpr_read_b32 v21, a249
    v_accvgpr_read_b32 v22, a250
    v_accvgpr_read_b32 v23, a251
    v_accvgpr_read_b32 v24, a252
    v_accvgpr_read_b32 v25, a253
    v_accvgpr_read_b32 v26, a254
    v_accvgpr_read_b32 v27, a255
    v_cvt_pk_bf16_f32 v36, v20, v21
    v_cvt_pk_bf16_f32 v37, v22, v23
    v_cvt_pk_bf16_f32 v38, v24, v25
    v_cvt_pk_bf16_f32 v39, v26, v27
    buffer_store_dwordx4 v[36:39], v251, s[4:7], s53 offen offset:3072 sc1
    s_branch main_kernel_w_done
main_kernel_w_c2_escl:
    s_mov_b32 s53, s21
    v_accvgpr_read_b32 v0, a0
    v_accvgpr_read_b32 v1, a1
    v_accvgpr_read_b32 v2, a2
    v_accvgpr_read_b32 v3, a3
    v_accvgpr_read_b32 v4, a4
    v_accvgpr_read_b32 v5, a5
    v_accvgpr_read_b32 v6, a6
    v_accvgpr_read_b32 v7, a7
    v_mul_f32 v0, 0x3e0293ee, v0
    v_mul_f32 v1, 0x3e0293ee, v1
    v_mul_f32 v2, 0x3e0293ee, v2
    v_mul_f32 v3, 0x3e0293ee, v3
    v_mul_f32 v4, 0x3e0293ee, v4
    v_mul_f32 v5, 0x3e0293ee, v5
    v_mul_f32 v6, 0x3e0293ee, v6
    v_mul_f32 v7, 0x3e0293ee, v7
    v_cvt_pk_bf16_f32 v16, v0, v1
    v_cvt_pk_bf16_f32 v17, v2, v3
    v_cvt_pk_bf16_f32 v18, v4, v5
    v_cvt_pk_bf16_f32 v19, v6, v7
    buffer_store_dwordx4 v[16:19], v251, s[4:7], s53 offen offset:0 sc1
    v_accvgpr_read_b32 v20, a8
    v_accvgpr_read_b32 v21, a9
    v_accvgpr_read_b32 v22, a10
    v_accvgpr_read_b32 v23, a11
    v_accvgpr_read_b32 v24, a12
    v_accvgpr_read_b32 v25, a13
    v_accvgpr_read_b32 v26, a14
    v_accvgpr_read_b32 v27, a15
    v_mul_f32 v20, 0x3e0293ee, v20
    v_mul_f32 v21, 0x3e0293ee, v21
    v_mul_f32 v22, 0x3e0293ee, v22
    v_mul_f32 v23, 0x3e0293ee, v23
    v_mul_f32 v24, 0x3e0293ee, v24
    v_mul_f32 v25, 0x3e0293ee, v25
    v_mul_f32 v26, 0x3e0293ee, v26
    v_mul_f32 v27, 0x3e0293ee, v27
    v_cvt_pk_bf16_f32 v36, v20, v21
    v_cvt_pk_bf16_f32 v37, v22, v23
    v_cvt_pk_bf16_f32 v38, v24, v25
    v_cvt_pk_bf16_f32 v39, v26, v27
    buffer_store_dwordx4 v[36:39], v251, s[4:7], s53 offen offset:1024 sc1
    v_accvgpr_read_b32 v40, a16
    v_accvgpr_read_b32 v41, a17
    v_accvgpr_read_b32 v42, a18
    v_accvgpr_read_b32 v43, a19
    v_accvgpr_read_b32 v44, a20
    v_accvgpr_read_b32 v45, a21
    v_accvgpr_read_b32 v46, a22
    v_accvgpr_read_b32 v47, a23
    v_mul_f32 v40, 0x3e0293ee, v40
    v_mul_f32 v41, 0x3e0293ee, v41
    v_mul_f32 v42, 0x3e0293ee, v42
    v_mul_f32 v43, 0x3e0293ee, v43
    v_mul_f32 v44, 0x3e0293ee, v44
    v_mul_f32 v45, 0x3e0293ee, v45
    v_mul_f32 v46, 0x3e0293ee, v46
    v_mul_f32 v47, 0x3e0293ee, v47
    v_cvt_pk_bf16_f32 v56, v40, v41
    v_cvt_pk_bf16_f32 v57, v42, v43
    v_cvt_pk_bf16_f32 v58, v44, v45
    v_cvt_pk_bf16_f32 v59, v46, v47
    buffer_store_dwordx4 v[56:59], v251, s[4:7], s53 offen offset:2048 sc1
    v_accvgpr_read_b32 v0, a24
    v_accvgpr_read_b32 v1, a25
    v_accvgpr_read_b32 v2, a26
    v_accvgpr_read_b32 v3, a27
    v_accvgpr_read_b32 v4, a28
    v_accvgpr_read_b32 v5, a29
    v_accvgpr_read_b32 v6, a30
    v_accvgpr_read_b32 v7, a31
    v_mul_f32 v0, 0x3e0293ee, v0
    v_mul_f32 v1, 0x3e0293ee, v1
    v_mul_f32 v2, 0x3e0293ee, v2
    v_mul_f32 v3, 0x3e0293ee, v3
    v_mul_f32 v4, 0x3e0293ee, v4
    v_mul_f32 v5, 0x3e0293ee, v5
    v_mul_f32 v6, 0x3e0293ee, v6
    v_mul_f32 v7, 0x3e0293ee, v7
    v_cvt_pk_bf16_f32 v16, v0, v1
    v_cvt_pk_bf16_f32 v17, v2, v3
    v_cvt_pk_bf16_f32 v18, v4, v5
    v_cvt_pk_bf16_f32 v19, v6, v7
    buffer_store_dwordx4 v[16:19], v251, s[4:7], s53 offen offset:3072 sc1
    s_add_u32 s53, s53, s22
    v_accvgpr_read_b32 v20, a32
    v_accvgpr_read_b32 v21, a33
    v_accvgpr_read_b32 v22, a34
    v_accvgpr_read_b32 v23, a35
    v_accvgpr_read_b32 v24, a36
    v_accvgpr_read_b32 v25, a37
    v_accvgpr_read_b32 v26, a38
    v_accvgpr_read_b32 v27, a39
    v_mul_f32 v20, 0x3e0293ee, v20
    v_mul_f32 v21, 0x3e0293ee, v21
    v_mul_f32 v22, 0x3e0293ee, v22
    v_mul_f32 v23, 0x3e0293ee, v23
    v_mul_f32 v24, 0x3e0293ee, v24
    v_mul_f32 v25, 0x3e0293ee, v25
    v_mul_f32 v26, 0x3e0293ee, v26
    v_mul_f32 v27, 0x3e0293ee, v27
    v_cvt_pk_bf16_f32 v36, v20, v21
    v_cvt_pk_bf16_f32 v37, v22, v23
    v_cvt_pk_bf16_f32 v38, v24, v25
    v_cvt_pk_bf16_f32 v39, v26, v27
    buffer_store_dwordx4 v[36:39], v251, s[4:7], s53 offen offset:0 sc1
    v_accvgpr_read_b32 v40, a40
    v_accvgpr_read_b32 v41, a41
    v_accvgpr_read_b32 v42, a42
    v_accvgpr_read_b32 v43, a43
    v_accvgpr_read_b32 v44, a44
    v_accvgpr_read_b32 v45, a45
    v_accvgpr_read_b32 v46, a46
    v_accvgpr_read_b32 v47, a47
    v_mul_f32 v40, 0x3e0293ee, v40
    v_mul_f32 v41, 0x3e0293ee, v41
    v_mul_f32 v42, 0x3e0293ee, v42
    v_mul_f32 v43, 0x3e0293ee, v43
    v_mul_f32 v44, 0x3e0293ee, v44
    v_mul_f32 v45, 0x3e0293ee, v45
    v_mul_f32 v46, 0x3e0293ee, v46
    v_mul_f32 v47, 0x3e0293ee, v47
    v_cvt_pk_bf16_f32 v56, v40, v41
    v_cvt_pk_bf16_f32 v57, v42, v43
    v_cvt_pk_bf16_f32 v58, v44, v45
    v_cvt_pk_bf16_f32 v59, v46, v47
    buffer_store_dwordx4 v[56:59], v251, s[4:7], s53 offen offset:1024 sc1
    v_accvgpr_read_b32 v0, a48
    v_accvgpr_read_b32 v1, a49
    v_accvgpr_read_b32 v2, a50
    v_accvgpr_read_b32 v3, a51
    v_accvgpr_read_b32 v4, a52
    v_accvgpr_read_b32 v5, a53
    v_accvgpr_read_b32 v6, a54
    v_accvgpr_read_b32 v7, a55
    v_mul_f32 v0, 0x3e0293ee, v0
    v_mul_f32 v1, 0x3e0293ee, v1
    v_mul_f32 v2, 0x3e0293ee, v2
    v_mul_f32 v3, 0x3e0293ee, v3
    v_mul_f32 v4, 0x3e0293ee, v4
    v_mul_f32 v5, 0x3e0293ee, v5
    v_mul_f32 v6, 0x3e0293ee, v6
    v_mul_f32 v7, 0x3e0293ee, v7
    v_cvt_pk_bf16_f32 v16, v0, v1
    v_cvt_pk_bf16_f32 v17, v2, v3
    v_cvt_pk_bf16_f32 v18, v4, v5
    v_cvt_pk_bf16_f32 v19, v6, v7
    buffer_store_dwordx4 v[16:19], v251, s[4:7], s53 offen offset:2048 sc1
    v_accvgpr_read_b32 v20, a56
    v_accvgpr_read_b32 v21, a57
    v_accvgpr_read_b32 v22, a58
    v_accvgpr_read_b32 v23, a59
    v_accvgpr_read_b32 v24, a60
    v_accvgpr_read_b32 v25, a61
    v_accvgpr_read_b32 v26, a62
    v_accvgpr_read_b32 v27, a63
    v_mul_f32 v20, 0x3e0293ee, v20
    v_mul_f32 v21, 0x3e0293ee, v21
    v_mul_f32 v22, 0x3e0293ee, v22
    v_mul_f32 v23, 0x3e0293ee, v23
    v_mul_f32 v24, 0x3e0293ee, v24
    v_mul_f32 v25, 0x3e0293ee, v25
    v_mul_f32 v26, 0x3e0293ee, v26
    v_mul_f32 v27, 0x3e0293ee, v27
    v_cvt_pk_bf16_f32 v36, v20, v21
    v_cvt_pk_bf16_f32 v37, v22, v23
    v_cvt_pk_bf16_f32 v38, v24, v25
    v_cvt_pk_bf16_f32 v39, v26, v27
    buffer_store_dwordx4 v[36:39], v251, s[4:7], s53 offen offset:3072 sc1
    s_add_u32 s53, s53, s22
    v_accvgpr_read_b32 v40, a64
    v_accvgpr_read_b32 v41, a65
    v_accvgpr_read_b32 v42, a66
    v_accvgpr_read_b32 v43, a67
    v_accvgpr_read_b32 v44, a68
    v_accvgpr_read_b32 v45, a69
    v_accvgpr_read_b32 v46, a70
    v_accvgpr_read_b32 v47, a71
    v_mul_f32 v40, 0x3e0293ee, v40
    v_mul_f32 v41, 0x3e0293ee, v41
    v_mul_f32 v42, 0x3e0293ee, v42
    v_mul_f32 v43, 0x3e0293ee, v43
    v_mul_f32 v44, 0x3e0293ee, v44
    v_mul_f32 v45, 0x3e0293ee, v45
    v_mul_f32 v46, 0x3e0293ee, v46
    v_mul_f32 v47, 0x3e0293ee, v47
    v_cvt_pk_bf16_f32 v56, v40, v41
    v_cvt_pk_bf16_f32 v57, v42, v43
    v_cvt_pk_bf16_f32 v58, v44, v45
    v_cvt_pk_bf16_f32 v59, v46, v47
    buffer_store_dwordx4 v[56:59], v251, s[4:7], s53 offen offset:0 sc1
    v_accvgpr_read_b32 v0, a72
    v_accvgpr_read_b32 v1, a73
    v_accvgpr_read_b32 v2, a74
    v_accvgpr_read_b32 v3, a75
    v_accvgpr_read_b32 v4, a76
    v_accvgpr_read_b32 v5, a77
    v_accvgpr_read_b32 v6, a78
    v_accvgpr_read_b32 v7, a79
    v_mul_f32 v0, 0x3e0293ee, v0
    v_mul_f32 v1, 0x3e0293ee, v1
    v_mul_f32 v2, 0x3e0293ee, v2
    v_mul_f32 v3, 0x3e0293ee, v3
    v_mul_f32 v4, 0x3e0293ee, v4
    v_mul_f32 v5, 0x3e0293ee, v5
    v_mul_f32 v6, 0x3e0293ee, v6
    v_mul_f32 v7, 0x3e0293ee, v7
    v_cvt_pk_bf16_f32 v16, v0, v1
    v_cvt_pk_bf16_f32 v17, v2, v3
    v_cvt_pk_bf16_f32 v18, v4, v5
    v_cvt_pk_bf16_f32 v19, v6, v7
    buffer_store_dwordx4 v[16:19], v251, s[4:7], s53 offen offset:1024 sc1
    v_accvgpr_read_b32 v20, a80
    v_accvgpr_read_b32 v21, a81
    v_accvgpr_read_b32 v22, a82
    v_accvgpr_read_b32 v23, a83
    v_accvgpr_read_b32 v24, a84
    v_accvgpr_read_b32 v25, a85
    v_accvgpr_read_b32 v26, a86
    v_accvgpr_read_b32 v27, a87
    v_mul_f32 v20, 0x3e0293ee, v20
    v_mul_f32 v21, 0x3e0293ee, v21
    v_mul_f32 v22, 0x3e0293ee, v22
    v_mul_f32 v23, 0x3e0293ee, v23
    v_mul_f32 v24, 0x3e0293ee, v24
    v_mul_f32 v25, 0x3e0293ee, v25
    v_mul_f32 v26, 0x3e0293ee, v26
    v_mul_f32 v27, 0x3e0293ee, v27
    v_cvt_pk_bf16_f32 v36, v20, v21
    v_cvt_pk_bf16_f32 v37, v22, v23
    v_cvt_pk_bf16_f32 v38, v24, v25
    v_cvt_pk_bf16_f32 v39, v26, v27
    buffer_store_dwordx4 v[36:39], v251, s[4:7], s53 offen offset:2048 sc1
    v_accvgpr_read_b32 v40, a88
    v_accvgpr_read_b32 v41, a89
    v_accvgpr_read_b32 v42, a90
    v_accvgpr_read_b32 v43, a91
    v_accvgpr_read_b32 v44, a92
    v_accvgpr_read_b32 v45, a93
    v_accvgpr_read_b32 v46, a94
    v_accvgpr_read_b32 v47, a95
    v_mul_f32 v40, 0x3e0293ee, v40
    v_mul_f32 v41, 0x3e0293ee, v41
    v_mul_f32 v42, 0x3e0293ee, v42
    v_mul_f32 v43, 0x3e0293ee, v43
    v_mul_f32 v44, 0x3e0293ee, v44
    v_mul_f32 v45, 0x3e0293ee, v45
    v_mul_f32 v46, 0x3e0293ee, v46
    v_mul_f32 v47, 0x3e0293ee, v47
    v_cvt_pk_bf16_f32 v56, v40, v41
    v_cvt_pk_bf16_f32 v57, v42, v43
    v_cvt_pk_bf16_f32 v58, v44, v45
    v_cvt_pk_bf16_f32 v59, v46, v47
    buffer_store_dwordx4 v[56:59], v251, s[4:7], s53 offen offset:3072 sc1
    s_add_u32 s53, s53, s22
    v_accvgpr_read_b32 v0, a96
    v_accvgpr_read_b32 v1, a97
    v_accvgpr_read_b32 v2, a98
    v_accvgpr_read_b32 v3, a99
    v_accvgpr_read_b32 v4, a100
    v_accvgpr_read_b32 v5, a101
    v_accvgpr_read_b32 v6, a102
    v_accvgpr_read_b32 v7, a103
    v_mul_f32 v0, 0x3e0293ee, v0
    v_mul_f32 v1, 0x3e0293ee, v1
    v_mul_f32 v2, 0x3e0293ee, v2
    v_mul_f32 v3, 0x3e0293ee, v3
    v_mul_f32 v4, 0x3e0293ee, v4
    v_mul_f32 v5, 0x3e0293ee, v5
    v_mul_f32 v6, 0x3e0293ee, v6
    v_mul_f32 v7, 0x3e0293ee, v7
    v_cvt_pk_bf16_f32 v16, v0, v1
    v_cvt_pk_bf16_f32 v17, v2, v3
    v_cvt_pk_bf16_f32 v18, v4, v5
    v_cvt_pk_bf16_f32 v19, v6, v7
    buffer_store_dwordx4 v[16:19], v251, s[4:7], s53 offen offset:0 sc1
    v_accvgpr_read_b32 v20, a104
    v_accvgpr_read_b32 v21, a105
    v_accvgpr_read_b32 v22, a106
    v_accvgpr_read_b32 v23, a107
    v_accvgpr_read_b32 v24, a108
    v_accvgpr_read_b32 v25, a109
    v_accvgpr_read_b32 v26, a110
    v_accvgpr_read_b32 v27, a111
    v_mul_f32 v20, 0x3e0293ee, v20
    v_mul_f32 v21, 0x3e0293ee, v21
    v_mul_f32 v22, 0x3e0293ee, v22
    v_mul_f32 v23, 0x3e0293ee, v23
    v_mul_f32 v24, 0x3e0293ee, v24
    v_mul_f32 v25, 0x3e0293ee, v25
    v_mul_f32 v26, 0x3e0293ee, v26
    v_mul_f32 v27, 0x3e0293ee, v27
    v_cvt_pk_bf16_f32 v36, v20, v21
    v_cvt_pk_bf16_f32 v37, v22, v23
    v_cvt_pk_bf16_f32 v38, v24, v25
    v_cvt_pk_bf16_f32 v39, v26, v27
    buffer_store_dwordx4 v[36:39], v251, s[4:7], s53 offen offset:1024 sc1
    v_accvgpr_read_b32 v40, a112
    v_accvgpr_read_b32 v41, a113
    v_accvgpr_read_b32 v42, a114
    v_accvgpr_read_b32 v43, a115
    v_accvgpr_read_b32 v44, a116
    v_accvgpr_read_b32 v45, a117
    v_accvgpr_read_b32 v46, a118
    v_accvgpr_read_b32 v47, a119
    v_mul_f32 v40, 0x3e0293ee, v40
    v_mul_f32 v41, 0x3e0293ee, v41
    v_mul_f32 v42, 0x3e0293ee, v42
    v_mul_f32 v43, 0x3e0293ee, v43
    v_mul_f32 v44, 0x3e0293ee, v44
    v_mul_f32 v45, 0x3e0293ee, v45
    v_mul_f32 v46, 0x3e0293ee, v46
    v_mul_f32 v47, 0x3e0293ee, v47
    v_cvt_pk_bf16_f32 v56, v40, v41
    v_cvt_pk_bf16_f32 v57, v42, v43
    v_cvt_pk_bf16_f32 v58, v44, v45
    v_cvt_pk_bf16_f32 v59, v46, v47
    buffer_store_dwordx4 v[56:59], v251, s[4:7], s53 offen offset:2048 sc1
    v_accvgpr_read_b32 v0, a120
    v_accvgpr_read_b32 v1, a121
    v_accvgpr_read_b32 v2, a122
    v_accvgpr_read_b32 v3, a123
    v_accvgpr_read_b32 v4, a124
    v_accvgpr_read_b32 v5, a125
    v_accvgpr_read_b32 v6, a126
    v_accvgpr_read_b32 v7, a127
    v_mul_f32 v0, 0x3e0293ee, v0
    v_mul_f32 v1, 0x3e0293ee, v1
    v_mul_f32 v2, 0x3e0293ee, v2
    v_mul_f32 v3, 0x3e0293ee, v3
    v_mul_f32 v4, 0x3e0293ee, v4
    v_mul_f32 v5, 0x3e0293ee, v5
    v_mul_f32 v6, 0x3e0293ee, v6
    v_mul_f32 v7, 0x3e0293ee, v7
    v_cvt_pk_bf16_f32 v16, v0, v1
    v_cvt_pk_bf16_f32 v17, v2, v3
    v_cvt_pk_bf16_f32 v18, v4, v5
    v_cvt_pk_bf16_f32 v19, v6, v7
    buffer_store_dwordx4 v[16:19], v251, s[4:7], s53 offen offset:3072 sc1
    s_add_u32 s53, s53, s22
    v_accvgpr_read_b32 v20, a128
    v_accvgpr_read_b32 v21, a129
    v_accvgpr_read_b32 v22, a130
    v_accvgpr_read_b32 v23, a131
    v_accvgpr_read_b32 v24, a132
    v_accvgpr_read_b32 v25, a133
    v_accvgpr_read_b32 v26, a134
    v_accvgpr_read_b32 v27, a135
    v_mul_f32 v20, 0x3e0293ee, v20
    v_mul_f32 v21, 0x3e0293ee, v21
    v_mul_f32 v22, 0x3e0293ee, v22
    v_mul_f32 v23, 0x3e0293ee, v23
    v_mul_f32 v24, 0x3e0293ee, v24
    v_mul_f32 v25, 0x3e0293ee, v25
    v_mul_f32 v26, 0x3e0293ee, v26
    v_mul_f32 v27, 0x3e0293ee, v27
    v_cvt_pk_bf16_f32 v36, v20, v21
    v_cvt_pk_bf16_f32 v37, v22, v23
    v_cvt_pk_bf16_f32 v38, v24, v25
    v_cvt_pk_bf16_f32 v39, v26, v27
    buffer_store_dwordx4 v[36:39], v251, s[4:7], s53 offen offset:0 sc1
    v_accvgpr_read_b32 v40, a136
    v_accvgpr_read_b32 v41, a137
    v_accvgpr_read_b32 v42, a138
    v_accvgpr_read_b32 v43, a139
    v_accvgpr_read_b32 v44, a140
    v_accvgpr_read_b32 v45, a141
    v_accvgpr_read_b32 v46, a142
    v_accvgpr_read_b32 v47, a143
    v_mul_f32 v40, 0x3e0293ee, v40
    v_mul_f32 v41, 0x3e0293ee, v41
    v_mul_f32 v42, 0x3e0293ee, v42
    v_mul_f32 v43, 0x3e0293ee, v43
    v_mul_f32 v44, 0x3e0293ee, v44
    v_mul_f32 v45, 0x3e0293ee, v45
    v_mul_f32 v46, 0x3e0293ee, v46
    v_mul_f32 v47, 0x3e0293ee, v47
    v_cvt_pk_bf16_f32 v56, v40, v41
    v_cvt_pk_bf16_f32 v57, v42, v43
    v_cvt_pk_bf16_f32 v58, v44, v45
    v_cvt_pk_bf16_f32 v59, v46, v47
    buffer_store_dwordx4 v[56:59], v251, s[4:7], s53 offen offset:1024 sc1
    v_accvgpr_read_b32 v0, a144
    v_accvgpr_read_b32 v1, a145
    v_accvgpr_read_b32 v2, a146
    v_accvgpr_read_b32 v3, a147
    v_accvgpr_read_b32 v4, a148
    v_accvgpr_read_b32 v5, a149
    v_accvgpr_read_b32 v6, a150
    v_accvgpr_read_b32 v7, a151
    v_mul_f32 v0, 0x3e0293ee, v0
    v_mul_f32 v1, 0x3e0293ee, v1
    v_mul_f32 v2, 0x3e0293ee, v2
    v_mul_f32 v3, 0x3e0293ee, v3
    v_mul_f32 v4, 0x3e0293ee, v4
    v_mul_f32 v5, 0x3e0293ee, v5
    v_mul_f32 v6, 0x3e0293ee, v6
    v_mul_f32 v7, 0x3e0293ee, v7
    v_cvt_pk_bf16_f32 v16, v0, v1
    v_cvt_pk_bf16_f32 v17, v2, v3
    v_cvt_pk_bf16_f32 v18, v4, v5
    v_cvt_pk_bf16_f32 v19, v6, v7
    buffer_store_dwordx4 v[16:19], v251, s[4:7], s53 offen offset:2048 sc1
    v_accvgpr_read_b32 v20, a152
    v_accvgpr_read_b32 v21, a153
    v_accvgpr_read_b32 v22, a154
    v_accvgpr_read_b32 v23, a155
    v_accvgpr_read_b32 v24, a156
    v_accvgpr_read_b32 v25, a157
    v_accvgpr_read_b32 v26, a158
    v_accvgpr_read_b32 v27, a159
    v_mul_f32 v20, 0x3e0293ee, v20
    v_mul_f32 v21, 0x3e0293ee, v21
    v_mul_f32 v22, 0x3e0293ee, v22
    v_mul_f32 v23, 0x3e0293ee, v23
    v_mul_f32 v24, 0x3e0293ee, v24
    v_mul_f32 v25, 0x3e0293ee, v25
    v_mul_f32 v26, 0x3e0293ee, v26
    v_mul_f32 v27, 0x3e0293ee, v27
    v_cvt_pk_bf16_f32 v36, v20, v21
    v_cvt_pk_bf16_f32 v37, v22, v23
    v_cvt_pk_bf16_f32 v38, v24, v25
    v_cvt_pk_bf16_f32 v39, v26, v27
    buffer_store_dwordx4 v[36:39], v251, s[4:7], s53 offen offset:3072 sc1
    s_add_u32 s53, s53, s22
    v_accvgpr_read_b32 v40, a160
    v_accvgpr_read_b32 v41, a161
    v_accvgpr_read_b32 v42, a162
    v_accvgpr_read_b32 v43, a163
    v_accvgpr_read_b32 v44, a164
    v_accvgpr_read_b32 v45, a165
    v_accvgpr_read_b32 v46, a166
    v_accvgpr_read_b32 v47, a167
    v_mul_f32 v40, 0x3e0293ee, v40
    v_mul_f32 v41, 0x3e0293ee, v41
    v_mul_f32 v42, 0x3e0293ee, v42
    v_mul_f32 v43, 0x3e0293ee, v43
    v_mul_f32 v44, 0x3e0293ee, v44
    v_mul_f32 v45, 0x3e0293ee, v45
    v_mul_f32 v46, 0x3e0293ee, v46
    v_mul_f32 v47, 0x3e0293ee, v47
    v_cvt_pk_bf16_f32 v56, v40, v41
    v_cvt_pk_bf16_f32 v57, v42, v43
    v_cvt_pk_bf16_f32 v58, v44, v45
    v_cvt_pk_bf16_f32 v59, v46, v47
    buffer_store_dwordx4 v[56:59], v251, s[4:7], s53 offen offset:0 sc1
    v_accvgpr_read_b32 v0, a168
    v_accvgpr_read_b32 v1, a169
    v_accvgpr_read_b32 v2, a170
    v_accvgpr_read_b32 v3, a171
    v_accvgpr_read_b32 v4, a172
    v_accvgpr_read_b32 v5, a173
    v_accvgpr_read_b32 v6, a174
    v_accvgpr_read_b32 v7, a175
    v_mul_f32 v0, 0x3e0293ee, v0
    v_mul_f32 v1, 0x3e0293ee, v1
    v_mul_f32 v2, 0x3e0293ee, v2
    v_mul_f32 v3, 0x3e0293ee, v3
    v_mul_f32 v4, 0x3e0293ee, v4
    v_mul_f32 v5, 0x3e0293ee, v5
    v_mul_f32 v6, 0x3e0293ee, v6
    v_mul_f32 v7, 0x3e0293ee, v7
    v_cvt_pk_bf16_f32 v16, v0, v1
    v_cvt_pk_bf16_f32 v17, v2, v3
    v_cvt_pk_bf16_f32 v18, v4, v5
    v_cvt_pk_bf16_f32 v19, v6, v7
    buffer_store_dwordx4 v[16:19], v251, s[4:7], s53 offen offset:1024 sc1
    v_accvgpr_read_b32 v20, a176
    v_accvgpr_read_b32 v21, a177
    v_accvgpr_read_b32 v22, a178
    v_accvgpr_read_b32 v23, a179
    v_accvgpr_read_b32 v24, a180
    v_accvgpr_read_b32 v25, a181
    v_accvgpr_read_b32 v26, a182
    v_accvgpr_read_b32 v27, a183
    v_mul_f32 v20, 0x3e0293ee, v20
    v_mul_f32 v21, 0x3e0293ee, v21
    v_mul_f32 v22, 0x3e0293ee, v22
    v_mul_f32 v23, 0x3e0293ee, v23
    v_mul_f32 v24, 0x3e0293ee, v24
    v_mul_f32 v25, 0x3e0293ee, v25
    v_mul_f32 v26, 0x3e0293ee, v26
    v_mul_f32 v27, 0x3e0293ee, v27
    v_cvt_pk_bf16_f32 v36, v20, v21
    v_cvt_pk_bf16_f32 v37, v22, v23
    v_cvt_pk_bf16_f32 v38, v24, v25
    v_cvt_pk_bf16_f32 v39, v26, v27
    buffer_store_dwordx4 v[36:39], v251, s[4:7], s53 offen offset:2048 sc1
    v_accvgpr_read_b32 v40, a184
    v_accvgpr_read_b32 v41, a185
    v_accvgpr_read_b32 v42, a186
    v_accvgpr_read_b32 v43, a187
    v_accvgpr_read_b32 v44, a188
    v_accvgpr_read_b32 v45, a189
    v_accvgpr_read_b32 v46, a190
    v_accvgpr_read_b32 v47, a191
    v_mul_f32 v40, 0x3e0293ee, v40
    v_mul_f32 v41, 0x3e0293ee, v41
    v_mul_f32 v42, 0x3e0293ee, v42
    v_mul_f32 v43, 0x3e0293ee, v43
    v_mul_f32 v44, 0x3e0293ee, v44
    v_mul_f32 v45, 0x3e0293ee, v45
    v_mul_f32 v46, 0x3e0293ee, v46
    v_mul_f32 v47, 0x3e0293ee, v47
    v_cvt_pk_bf16_f32 v56, v40, v41
    v_cvt_pk_bf16_f32 v57, v42, v43
    v_cvt_pk_bf16_f32 v58, v44, v45
    v_cvt_pk_bf16_f32 v59, v46, v47
    buffer_store_dwordx4 v[56:59], v251, s[4:7], s53 offen offset:3072 sc1
    s_add_u32 s53, s53, s22
    v_accvgpr_read_b32 v0, a192
    v_accvgpr_read_b32 v1, a193
    v_accvgpr_read_b32 v2, a194
    v_accvgpr_read_b32 v3, a195
    v_accvgpr_read_b32 v4, a196
    v_accvgpr_read_b32 v5, a197
    v_accvgpr_read_b32 v6, a198
    v_accvgpr_read_b32 v7, a199
    v_mul_f32 v0, 0x3e0293ee, v0
    v_mul_f32 v1, 0x3e0293ee, v1
    v_mul_f32 v2, 0x3e0293ee, v2
    v_mul_f32 v3, 0x3e0293ee, v3
    v_mul_f32 v4, 0x3e0293ee, v4
    v_mul_f32 v5, 0x3e0293ee, v5
    v_mul_f32 v6, 0x3e0293ee, v6
    v_mul_f32 v7, 0x3e0293ee, v7
    v_cvt_pk_bf16_f32 v16, v0, v1
    v_cvt_pk_bf16_f32 v17, v2, v3
    v_cvt_pk_bf16_f32 v18, v4, v5
    v_cvt_pk_bf16_f32 v19, v6, v7
    buffer_store_dwordx4 v[16:19], v251, s[4:7], s53 offen offset:0 sc1
    v_accvgpr_read_b32 v20, a200
    v_accvgpr_read_b32 v21, a201
    v_accvgpr_read_b32 v22, a202
    v_accvgpr_read_b32 v23, a203
    v_accvgpr_read_b32 v24, a204
    v_accvgpr_read_b32 v25, a205
    v_accvgpr_read_b32 v26, a206
    v_accvgpr_read_b32 v27, a207
    v_mul_f32 v20, 0x3e0293ee, v20
    v_mul_f32 v21, 0x3e0293ee, v21
    v_mul_f32 v22, 0x3e0293ee, v22
    v_mul_f32 v23, 0x3e0293ee, v23
    v_mul_f32 v24, 0x3e0293ee, v24
    v_mul_f32 v25, 0x3e0293ee, v25
    v_mul_f32 v26, 0x3e0293ee, v26
    v_mul_f32 v27, 0x3e0293ee, v27
    v_cvt_pk_bf16_f32 v36, v20, v21
    v_cvt_pk_bf16_f32 v37, v22, v23
    v_cvt_pk_bf16_f32 v38, v24, v25
    v_cvt_pk_bf16_f32 v39, v26, v27
    buffer_store_dwordx4 v[36:39], v251, s[4:7], s53 offen offset:1024 sc1
    v_accvgpr_read_b32 v40, a208
    v_accvgpr_read_b32 v41, a209
    v_accvgpr_read_b32 v42, a210
    v_accvgpr_read_b32 v43, a211
    v_accvgpr_read_b32 v44, a212
    v_accvgpr_read_b32 v45, a213
    v_accvgpr_read_b32 v46, a214
    v_accvgpr_read_b32 v47, a215
    v_mul_f32 v40, 0x3e0293ee, v40
    v_mul_f32 v41, 0x3e0293ee, v41
    v_mul_f32 v42, 0x3e0293ee, v42
    v_mul_f32 v43, 0x3e0293ee, v43
    v_mul_f32 v44, 0x3e0293ee, v44
    v_mul_f32 v45, 0x3e0293ee, v45
    v_mul_f32 v46, 0x3e0293ee, v46
    v_mul_f32 v47, 0x3e0293ee, v47
    v_cvt_pk_bf16_f32 v56, v40, v41
    v_cvt_pk_bf16_f32 v57, v42, v43
    v_cvt_pk_bf16_f32 v58, v44, v45
    v_cvt_pk_bf16_f32 v59, v46, v47
    buffer_store_dwordx4 v[56:59], v251, s[4:7], s53 offen offset:2048 sc1
    v_accvgpr_read_b32 v0, a216
    v_accvgpr_read_b32 v1, a217
    v_accvgpr_read_b32 v2, a218
    v_accvgpr_read_b32 v3, a219
    v_accvgpr_read_b32 v4, a220
    v_accvgpr_read_b32 v5, a221
    v_accvgpr_read_b32 v6, a222
    v_accvgpr_read_b32 v7, a223
    v_mul_f32 v0, 0x3e0293ee, v0
    v_mul_f32 v1, 0x3e0293ee, v1
    v_mul_f32 v2, 0x3e0293ee, v2
    v_mul_f32 v3, 0x3e0293ee, v3
    v_mul_f32 v4, 0x3e0293ee, v4
    v_mul_f32 v5, 0x3e0293ee, v5
    v_mul_f32 v6, 0x3e0293ee, v6
    v_mul_f32 v7, 0x3e0293ee, v7
    v_cvt_pk_bf16_f32 v16, v0, v1
    v_cvt_pk_bf16_f32 v17, v2, v3
    v_cvt_pk_bf16_f32 v18, v4, v5
    v_cvt_pk_bf16_f32 v19, v6, v7
    buffer_store_dwordx4 v[16:19], v251, s[4:7], s53 offen offset:3072 sc1
    s_add_u32 s53, s53, s22
    v_accvgpr_read_b32 v20, a224
    v_accvgpr_read_b32 v21, a225
    v_accvgpr_read_b32 v22, a226
    v_accvgpr_read_b32 v23, a227
    v_accvgpr_read_b32 v24, a228
    v_accvgpr_read_b32 v25, a229
    v_accvgpr_read_b32 v26, a230
    v_accvgpr_read_b32 v27, a231
    v_mul_f32 v20, 0x3e0293ee, v20
    v_mul_f32 v21, 0x3e0293ee, v21
    v_mul_f32 v22, 0x3e0293ee, v22
    v_mul_f32 v23, 0x3e0293ee, v23
    v_mul_f32 v24, 0x3e0293ee, v24
    v_mul_f32 v25, 0x3e0293ee, v25
    v_mul_f32 v26, 0x3e0293ee, v26
    v_mul_f32 v27, 0x3e0293ee, v27
    v_cvt_pk_bf16_f32 v36, v20, v21
    v_cvt_pk_bf16_f32 v37, v22, v23
    v_cvt_pk_bf16_f32 v38, v24, v25
    v_cvt_pk_bf16_f32 v39, v26, v27
    buffer_store_dwordx4 v[36:39], v251, s[4:7], s53 offen offset:0 sc1
    v_accvgpr_read_b32 v40, a232
    v_accvgpr_read_b32 v41, a233
    v_accvgpr_read_b32 v42, a234
    v_accvgpr_read_b32 v43, a235
    v_accvgpr_read_b32 v44, a236
    v_accvgpr_read_b32 v45, a237
    v_accvgpr_read_b32 v46, a238
    v_accvgpr_read_b32 v47, a239
    v_mul_f32 v40, 0x3e0293ee, v40
    v_mul_f32 v41, 0x3e0293ee, v41
    v_mul_f32 v42, 0x3e0293ee, v42
    v_mul_f32 v43, 0x3e0293ee, v43
    v_mul_f32 v44, 0x3e0293ee, v44
    v_mul_f32 v45, 0x3e0293ee, v45
    v_mul_f32 v46, 0x3e0293ee, v46
    v_mul_f32 v47, 0x3e0293ee, v47
    v_cvt_pk_bf16_f32 v56, v40, v41
    v_cvt_pk_bf16_f32 v57, v42, v43
    v_cvt_pk_bf16_f32 v58, v44, v45
    v_cvt_pk_bf16_f32 v59, v46, v47
    buffer_store_dwordx4 v[56:59], v251, s[4:7], s53 offen offset:1024 sc1
    v_accvgpr_read_b32 v0, a240
    v_accvgpr_read_b32 v1, a241
    v_accvgpr_read_b32 v2, a242
    v_accvgpr_read_b32 v3, a243
    v_accvgpr_read_b32 v4, a244
    v_accvgpr_read_b32 v5, a245
    v_accvgpr_read_b32 v6, a246
    v_accvgpr_read_b32 v7, a247
    v_mul_f32 v0, 0x3e0293ee, v0
    v_mul_f32 v1, 0x3e0293ee, v1
    v_mul_f32 v2, 0x3e0293ee, v2
    v_mul_f32 v3, 0x3e0293ee, v3
    v_mul_f32 v4, 0x3e0293ee, v4
    v_mul_f32 v5, 0x3e0293ee, v5
    v_mul_f32 v6, 0x3e0293ee, v6
    v_mul_f32 v7, 0x3e0293ee, v7
    v_cvt_pk_bf16_f32 v16, v0, v1
    v_cvt_pk_bf16_f32 v17, v2, v3
    v_cvt_pk_bf16_f32 v18, v4, v5
    v_cvt_pk_bf16_f32 v19, v6, v7
    buffer_store_dwordx4 v[16:19], v251, s[4:7], s53 offen offset:2048 sc1
    v_accvgpr_read_b32 v20, a248
    v_accvgpr_read_b32 v21, a249
    v_accvgpr_read_b32 v22, a250
    v_accvgpr_read_b32 v23, a251
    v_accvgpr_read_b32 v24, a252
    v_accvgpr_read_b32 v25, a253
    v_accvgpr_read_b32 v26, a254
    v_accvgpr_read_b32 v27, a255
    v_mul_f32 v20, 0x3e0293ee, v20
    v_mul_f32 v21, 0x3e0293ee, v21
    v_mul_f32 v22, 0x3e0293ee, v22
    v_mul_f32 v23, 0x3e0293ee, v23
    v_mul_f32 v24, 0x3e0293ee, v24
    v_mul_f32 v25, 0x3e0293ee, v25
    v_mul_f32 v26, 0x3e0293ee, v26
    v_mul_f32 v27, 0x3e0293ee, v27
    v_cvt_pk_bf16_f32 v36, v20, v21
    v_cvt_pk_bf16_f32 v37, v22, v23
    v_cvt_pk_bf16_f32 v38, v24, v25
    v_cvt_pk_bf16_f32 v39, v26, v27
    buffer_store_dwordx4 v[36:39], v251, s[4:7], s53 offen offset:3072 sc1
    s_branch main_kernel_w_done
main_kernel_w_c2_egelu:
    s_mov_b32 s53, s21
    v_accvgpr_read_b32 v0, a0
    v_accvgpr_read_b32 v1, a1
    v_accvgpr_read_b32 v2, a2
    v_accvgpr_read_b32 v3, a3
    v_accvgpr_read_b32 v4, a4
    v_accvgpr_read_b32 v5, a5
    v_accvgpr_read_b32 v6, a6
    v_accvgpr_read_b32 v7, a7
    v_pk_mul_f32 v[8:9], v[0:1], v[0:1]
    v_pk_mul_f32 v[10:11], v[2:3], v[2:3]
    v_pk_mul_f32 v[12:13], v[4:5], v[4:5]
    v_pk_mul_f32 v[14:15], v[6:7], v[6:7]
    v_pk_fma_f32 v[8:9], v[8:9], v[242:243], v[240:241]
    v_pk_fma_f32 v[10:11], v[10:11], v[242:243], v[240:241]
    v_pk_fma_f32 v[12:13], v[12:13], v[242:243], v[240:241]
    v_pk_fma_f32 v[14:15], v[14:15], v[242:243], v[240:241]
    v_pk_mul_f32 v[8:9], v[8:9], v[0:1]
    v_pk_mul_f32 v[10:11], v[10:11], v[2:3]
    v_pk_mul_f32 v[12:13], v[12:13], v[4:5]
    v_pk_mul_f32 v[14:15], v[14:15], v[6:7]
    v_exp_f32 v8, v8
    v_exp_f32 v9, v9
    v_exp_f32 v10, v10
    v_exp_f32 v11, v11
    v_exp_f32 v12, v12
    v_exp_f32 v13, v13
    v_exp_f32 v14, v14
    v_exp_f32 v15, v15
    v_pk_add_f32 v[8:9], v[8:9], v[244:245]
    v_pk_add_f32 v[10:11], v[10:11], v[244:245]
    v_pk_add_f32 v[12:13], v[12:13], v[244:245]
    v_pk_add_f32 v[14:15], v[14:15], v[244:245]
    v_rcp_f32 v8, v8
    v_rcp_f32 v9, v9
    v_rcp_f32 v10, v10
    v_rcp_f32 v11, v11
    v_rcp_f32 v12, v12
    v_rcp_f32 v13, v13
    v_rcp_f32 v14, v14
    v_rcp_f32 v15, v15
    v_pk_mul_f32 v[0:1], v[8:9], v[0:1]
    v_pk_mul_f32 v[2:3], v[10:11], v[2:3]
    v_pk_mul_f32 v[4:5], v[12:13], v[4:5]
    v_pk_mul_f32 v[6:7], v[14:15], v[6:7]
    v_cvt_pk_bf16_f32 v16, v0, v1
    v_cvt_pk_bf16_f32 v17, v2, v3
    v_cvt_pk_bf16_f32 v18, v4, v5
    v_cvt_pk_bf16_f32 v19, v6, v7
    buffer_store_dwordx4 v[16:19], v251, s[4:7], s53 offen offset:0 sc1
    v_accvgpr_read_b32 v20, a8
    v_accvgpr_read_b32 v21, a9
    v_accvgpr_read_b32 v22, a10
    v_accvgpr_read_b32 v23, a11
    v_accvgpr_read_b32 v24, a12
    v_accvgpr_read_b32 v25, a13
    v_accvgpr_read_b32 v26, a14
    v_accvgpr_read_b32 v27, a15
    v_pk_mul_f32 v[28:29], v[20:21], v[20:21]
    v_pk_mul_f32 v[30:31], v[22:23], v[22:23]
    v_pk_mul_f32 v[32:33], v[24:25], v[24:25]
    v_pk_mul_f32 v[34:35], v[26:27], v[26:27]
    v_pk_fma_f32 v[28:29], v[28:29], v[242:243], v[240:241]
    v_pk_fma_f32 v[30:31], v[30:31], v[242:243], v[240:241]
    v_pk_fma_f32 v[32:33], v[32:33], v[242:243], v[240:241]
    v_pk_fma_f32 v[34:35], v[34:35], v[242:243], v[240:241]
    v_pk_mul_f32 v[28:29], v[28:29], v[20:21]
    v_pk_mul_f32 v[30:31], v[30:31], v[22:23]
    v_pk_mul_f32 v[32:33], v[32:33], v[24:25]
    v_pk_mul_f32 v[34:35], v[34:35], v[26:27]
    v_exp_f32 v28, v28
    v_exp_f32 v29, v29
    v_exp_f32 v30, v30
    v_exp_f32 v31, v31
    v_exp_f32 v32, v32
    v_exp_f32 v33, v33
    v_exp_f32 v34, v34
    v_exp_f32 v35, v35
    v_pk_add_f32 v[28:29], v[28:29], v[244:245]
    v_pk_add_f32 v[30:31], v[30:31], v[244:245]
    v_pk_add_f32 v[32:33], v[32:33], v[244:245]
    v_pk_add_f32 v[34:35], v[34:35], v[244:245]
    v_rcp_f32 v28, v28
    v_rcp_f32 v29, v29
    v_rcp_f32 v30, v30
    v_rcp_f32 v31, v31
    v_rcp_f32 v32, v32
    v_rcp_f32 v33, v33
    v_rcp_f32 v34, v34
    v_rcp_f32 v35, v35
    v_pk_mul_f32 v[20:21], v[28:29], v[20:21]
    v_pk_mul_f32 v[22:23], v[30:31], v[22:23]
    v_pk_mul_f32 v[24:25], v[32:33], v[24:25]
    v_pk_mul_f32 v[26:27], v[34:35], v[26:27]
    v_cvt_pk_bf16_f32 v36, v20, v21
    v_cvt_pk_bf16_f32 v37, v22, v23
    v_cvt_pk_bf16_f32 v38, v24, v25
    v_cvt_pk_bf16_f32 v39, v26, v27
    buffer_store_dwordx4 v[36:39], v251, s[4:7], s53 offen offset:1024 sc1
    v_accvgpr_read_b32 v40, a16
    v_accvgpr_read_b32 v41, a17
    v_accvgpr_read_b32 v42, a18
    v_accvgpr_read_b32 v43, a19
    v_accvgpr_read_b32 v44, a20
    v_accvgpr_read_b32 v45, a21
    v_accvgpr_read_b32 v46, a22
    v_accvgpr_read_b32 v47, a23
    v_pk_mul_f32 v[48:49], v[40:41], v[40:41]
    v_pk_mul_f32 v[50:51], v[42:43], v[42:43]
    v_pk_mul_f32 v[52:53], v[44:45], v[44:45]
    v_pk_mul_f32 v[54:55], v[46:47], v[46:47]
    v_pk_fma_f32 v[48:49], v[48:49], v[242:243], v[240:241]
    v_pk_fma_f32 v[50:51], v[50:51], v[242:243], v[240:241]
    v_pk_fma_f32 v[52:53], v[52:53], v[242:243], v[240:241]
    v_pk_fma_f32 v[54:55], v[54:55], v[242:243], v[240:241]
    v_pk_mul_f32 v[48:49], v[48:49], v[40:41]
    v_pk_mul_f32 v[50:51], v[50:51], v[42:43]
    v_pk_mul_f32 v[52:53], v[52:53], v[44:45]
    v_pk_mul_f32 v[54:55], v[54:55], v[46:47]
    v_exp_f32 v48, v48
    v_exp_f32 v49, v49
    v_exp_f32 v50, v50
    v_exp_f32 v51, v51
    v_exp_f32 v52, v52
    v_exp_f32 v53, v53
    v_exp_f32 v54, v54
    v_exp_f32 v55, v55
    v_pk_add_f32 v[48:49], v[48:49], v[244:245]
    v_pk_add_f32 v[50:51], v[50:51], v[244:245]
    v_pk_add_f32 v[52:53], v[52:53], v[244:245]
    v_pk_add_f32 v[54:55], v[54:55], v[244:245]
    v_rcp_f32 v48, v48
    v_rcp_f32 v49, v49
    v_rcp_f32 v50, v50
    v_rcp_f32 v51, v51
    v_rcp_f32 v52, v52
    v_rcp_f32 v53, v53
    v_rcp_f32 v54, v54
    v_rcp_f32 v55, v55
    v_pk_mul_f32 v[40:41], v[48:49], v[40:41]
    v_pk_mul_f32 v[42:43], v[50:51], v[42:43]
    v_pk_mul_f32 v[44:45], v[52:53], v[44:45]
    v_pk_mul_f32 v[46:47], v[54:55], v[46:47]
    v_cvt_pk_bf16_f32 v56, v40, v41
    v_cvt_pk_bf16_f32 v57, v42, v43
    v_cvt_pk_bf16_f32 v58, v44, v45
    v_cvt_pk_bf16_f32 v59, v46, v47
    buffer_store_dwordx4 v[56:59], v251, s[4:7], s53 offen offset:2048 sc1
    v_accvgpr_read_b32 v0, a24
    v_accvgpr_read_b32 v1, a25
    v_accvgpr_read_b32 v2, a26
    v_accvgpr_read_b32 v3, a27
    v_accvgpr_read_b32 v4, a28
    v_accvgpr_read_b32 v5, a29
    v_accvgpr_read_b32 v6, a30
    v_accvgpr_read_b32 v7, a31
    v_pk_mul_f32 v[8:9], v[0:1], v[0:1]
    v_pk_mul_f32 v[10:11], v[2:3], v[2:3]
    v_pk_mul_f32 v[12:13], v[4:5], v[4:5]
    v_pk_mul_f32 v[14:15], v[6:7], v[6:7]
    v_pk_fma_f32 v[8:9], v[8:9], v[242:243], v[240:241]
    v_pk_fma_f32 v[10:11], v[10:11], v[242:243], v[240:241]
    v_pk_fma_f32 v[12:13], v[12:13], v[242:243], v[240:241]
    v_pk_fma_f32 v[14:15], v[14:15], v[242:243], v[240:241]
    v_pk_mul_f32 v[8:9], v[8:9], v[0:1]
    v_pk_mul_f32 v[10:11], v[10:11], v[2:3]
    v_pk_mul_f32 v[12:13], v[12:13], v[4:5]
    v_pk_mul_f32 v[14:15], v[14:15], v[6:7]
    v_exp_f32 v8, v8
    v_exp_f32 v9, v9
    v_exp_f32 v10, v10
    v_exp_f32 v11, v11
    v_exp_f32 v12, v12
    v_exp_f32 v13, v13
    v_exp_f32 v14, v14
    v_exp_f32 v15, v15
    v_pk_add_f32 v[8:9], v[8:9], v[244:245]
    v_pk_add_f32 v[10:11], v[10:11], v[244:245]
    v_pk_add_f32 v[12:13], v[12:13], v[244:245]
    v_pk_add_f32 v[14:15], v[14:15], v[244:245]
    v_rcp_f32 v8, v8
    v_rcp_f32 v9, v9
    v_rcp_f32 v10, v10
    v_rcp_f32 v11, v11
    v_rcp_f32 v12, v12
    v_rcp_f32 v13, v13
    v_rcp_f32 v14, v14
    v_rcp_f32 v15, v15
    v_pk_mul_f32 v[0:1], v[8:9], v[0:1]
    v_pk_mul_f32 v[2:3], v[10:11], v[2:3]
    v_pk_mul_f32 v[4:5], v[12:13], v[4:5]
    v_pk_mul_f32 v[6:7], v[14:15], v[6:7]
    v_cvt_pk_bf16_f32 v16, v0, v1
    v_cvt_pk_bf16_f32 v17, v2, v3
    v_cvt_pk_bf16_f32 v18, v4, v5
    v_cvt_pk_bf16_f32 v19, v6, v7
    buffer_store_dwordx4 v[16:19], v251, s[4:7], s53 offen offset:3072 sc1
    s_add_u32 s53, s53, s22
    v_accvgpr_read_b32 v20, a32
    v_accvgpr_read_b32 v21, a33
    v_accvgpr_read_b32 v22, a34
    v_accvgpr_read_b32 v23, a35
    v_accvgpr_read_b32 v24, a36
    v_accvgpr_read_b32 v25, a37
    v_accvgpr_read_b32 v26, a38
    v_accvgpr_read_b32 v27, a39
    v_pk_mul_f32 v[28:29], v[20:21], v[20:21]
    v_pk_mul_f32 v[30:31], v[22:23], v[22:23]
    v_pk_mul_f32 v[32:33], v[24:25], v[24:25]
    v_pk_mul_f32 v[34:35], v[26:27], v[26:27]
    v_pk_fma_f32 v[28:29], v[28:29], v[242:243], v[240:241]
    v_pk_fma_f32 v[30:31], v[30:31], v[242:243], v[240:241]
    v_pk_fma_f32 v[32:33], v[32:33], v[242:243], v[240:241]
    v_pk_fma_f32 v[34:35], v[34:35], v[242:243], v[240:241]
    v_pk_mul_f32 v[28:29], v[28:29], v[20:21]
    v_pk_mul_f32 v[30:31], v[30:31], v[22:23]
    v_pk_mul_f32 v[32:33], v[32:33], v[24:25]
    v_pk_mul_f32 v[34:35], v[34:35], v[26:27]
    v_exp_f32 v28, v28
    v_exp_f32 v29, v29
    v_exp_f32 v30, v30
    v_exp_f32 v31, v31
    v_exp_f32 v32, v32
    v_exp_f32 v33, v33
    v_exp_f32 v34, v34
    v_exp_f32 v35, v35
    v_pk_add_f32 v[28:29], v[28:29], v[244:245]
    v_pk_add_f32 v[30:31], v[30:31], v[244:245]
    v_pk_add_f32 v[32:33], v[32:33], v[244:245]
    v_pk_add_f32 v[34:35], v[34:35], v[244:245]
    v_rcp_f32 v28, v28
    v_rcp_f32 v29, v29
    v_rcp_f32 v30, v30
    v_rcp_f32 v31, v31
    v_rcp_f32 v32, v32
    v_rcp_f32 v33, v33
    v_rcp_f32 v34, v34
    v_rcp_f32 v35, v35
    v_pk_mul_f32 v[20:21], v[28:29], v[20:21]
    v_pk_mul_f32 v[22:23], v[30:31], v[22:23]
    v_pk_mul_f32 v[24:25], v[32:33], v[24:25]
    v_pk_mul_f32 v[26:27], v[34:35], v[26:27]
    v_cvt_pk_bf16_f32 v36, v20, v21
    v_cvt_pk_bf16_f32 v37, v22, v23
    v_cvt_pk_bf16_f32 v38, v24, v25
    v_cvt_pk_bf16_f32 v39, v26, v27
    buffer_store_dwordx4 v[36:39], v251, s[4:7], s53 offen offset:0 sc1
    v_accvgpr_read_b32 v40, a40
    v_accvgpr_read_b32 v41, a41
    v_accvgpr_read_b32 v42, a42
    v_accvgpr_read_b32 v43, a43
    v_accvgpr_read_b32 v44, a44
    v_accvgpr_read_b32 v45, a45
    v_accvgpr_read_b32 v46, a46
    v_accvgpr_read_b32 v47, a47
    v_pk_mul_f32 v[48:49], v[40:41], v[40:41]
    v_pk_mul_f32 v[50:51], v[42:43], v[42:43]
    v_pk_mul_f32 v[52:53], v[44:45], v[44:45]
    v_pk_mul_f32 v[54:55], v[46:47], v[46:47]
    v_pk_fma_f32 v[48:49], v[48:49], v[242:243], v[240:241]
    v_pk_fma_f32 v[50:51], v[50:51], v[242:243], v[240:241]
    v_pk_fma_f32 v[52:53], v[52:53], v[242:243], v[240:241]
    v_pk_fma_f32 v[54:55], v[54:55], v[242:243], v[240:241]
    v_pk_mul_f32 v[48:49], v[48:49], v[40:41]
    v_pk_mul_f32 v[50:51], v[50:51], v[42:43]
    v_pk_mul_f32 v[52:53], v[52:53], v[44:45]
    v_pk_mul_f32 v[54:55], v[54:55], v[46:47]
    v_exp_f32 v48, v48
    v_exp_f32 v49, v49
    v_exp_f32 v50, v50
    v_exp_f32 v51, v51
    v_exp_f32 v52, v52
    v_exp_f32 v53, v53
    v_exp_f32 v54, v54
    v_exp_f32 v55, v55
    v_pk_add_f32 v[48:49], v[48:49], v[244:245]
    v_pk_add_f32 v[50:51], v[50:51], v[244:245]
    v_pk_add_f32 v[52:53], v[52:53], v[244:245]
    v_pk_add_f32 v[54:55], v[54:55], v[244:245]
    v_rcp_f32 v48, v48
    v_rcp_f32 v49, v49
    v_rcp_f32 v50, v50
    v_rcp_f32 v51, v51
    v_rcp_f32 v52, v52
    v_rcp_f32 v53, v53
    v_rcp_f32 v54, v54
    v_rcp_f32 v55, v55
    v_pk_mul_f32 v[40:41], v[48:49], v[40:41]
    v_pk_mul_f32 v[42:43], v[50:51], v[42:43]
    v_pk_mul_f32 v[44:45], v[52:53], v[44:45]
    v_pk_mul_f32 v[46:47], v[54:55], v[46:47]
    v_cvt_pk_bf16_f32 v56, v40, v41
    v_cvt_pk_bf16_f32 v57, v42, v43
    v_cvt_pk_bf16_f32 v58, v44, v45
    v_cvt_pk_bf16_f32 v59, v46, v47
    buffer_store_dwordx4 v[56:59], v251, s[4:7], s53 offen offset:1024 sc1
    v_accvgpr_read_b32 v0, a48
    v_accvgpr_read_b32 v1, a49
    v_accvgpr_read_b32 v2, a50
    v_accvgpr_read_b32 v3, a51
    v_accvgpr_read_b32 v4, a52
    v_accvgpr_read_b32 v5, a53
    v_accvgpr_read_b32 v6, a54
    v_accvgpr_read_b32 v7, a55
    v_pk_mul_f32 v[8:9], v[0:1], v[0:1]
    v_pk_mul_f32 v[10:11], v[2:3], v[2:3]
    v_pk_mul_f32 v[12:13], v[4:5], v[4:5]
    v_pk_mul_f32 v[14:15], v[6:7], v[6:7]
    v_pk_fma_f32 v[8:9], v[8:9], v[242:243], v[240:241]
    v_pk_fma_f32 v[10:11], v[10:11], v[242:243], v[240:241]
    v_pk_fma_f32 v[12:13], v[12:13], v[242:243], v[240:241]
    v_pk_fma_f32 v[14:15], v[14:15], v[242:243], v[240:241]
    v_pk_mul_f32 v[8:9], v[8:9], v[0:1]
    v_pk_mul_f32 v[10:11], v[10:11], v[2:3]
    v_pk_mul_f32 v[12:13], v[12:13], v[4:5]
    v_pk_mul_f32 v[14:15], v[14:15], v[6:7]
    v_exp_f32 v8, v8
    v_exp_f32 v9, v9
    v_exp_f32 v10, v10
    v_exp_f32 v11, v11
    v_exp_f32 v12, v12
    v_exp_f32 v13, v13
    v_exp_f32 v14, v14
    v_exp_f32 v15, v15
    v_pk_add_f32 v[8:9], v[8:9], v[244:245]
    v_pk_add_f32 v[10:11], v[10:11], v[244:245]
    v_pk_add_f32 v[12:13], v[12:13], v[244:245]
    v_pk_add_f32 v[14:15], v[14:15], v[244:245]
    v_rcp_f32 v8, v8
    v_rcp_f32 v9, v9
    v_rcp_f32 v10, v10
    v_rcp_f32 v11, v11
    v_rcp_f32 v12, v12
    v_rcp_f32 v13, v13
    v_rcp_f32 v14, v14
    v_rcp_f32 v15, v15
    v_pk_mul_f32 v[0:1], v[8:9], v[0:1]
    v_pk_mul_f32 v[2:3], v[10:11], v[2:3]
    v_pk_mul_f32 v[4:5], v[12:13], v[4:5]
    v_pk_mul_f32 v[6:7], v[14:15], v[6:7]
    v_cvt_pk_bf16_f32 v16, v0, v1
    v_cvt_pk_bf16_f32 v17, v2, v3
    v_cvt_pk_bf16_f32 v18, v4, v5
    v_cvt_pk_bf16_f32 v19, v6, v7
    buffer_store_dwordx4 v[16:19], v251, s[4:7], s53 offen offset:2048 sc1
    v_accvgpr_read_b32 v20, a56
    v_accvgpr_read_b32 v21, a57
    v_accvgpr_read_b32 v22, a58
    v_accvgpr_read_b32 v23, a59
    v_accvgpr_read_b32 v24, a60
    v_accvgpr_read_b32 v25, a61
    v_accvgpr_read_b32 v26, a62
    v_accvgpr_read_b32 v27, a63
    v_pk_mul_f32 v[28:29], v[20:21], v[20:21]
    v_pk_mul_f32 v[30:31], v[22:23], v[22:23]
    v_pk_mul_f32 v[32:33], v[24:25], v[24:25]
    v_pk_mul_f32 v[34:35], v[26:27], v[26:27]
    v_pk_fma_f32 v[28:29], v[28:29], v[242:243], v[240:241]
    v_pk_fma_f32 v[30:31], v[30:31], v[242:243], v[240:241]
    v_pk_fma_f32 v[32:33], v[32:33], v[242:243], v[240:241]
    v_pk_fma_f32 v[34:35], v[34:35], v[242:243], v[240:241]
    v_pk_mul_f32 v[28:29], v[28:29], v[20:21]
    v_pk_mul_f32 v[30:31], v[30:31], v[22:23]
    v_pk_mul_f32 v[32:33], v[32:33], v[24:25]
    v_pk_mul_f32 v[34:35], v[34:35], v[26:27]
    v_exp_f32 v28, v28
    v_exp_f32 v29, v29
    v_exp_f32 v30, v30
    v_exp_f32 v31, v31
    v_exp_f32 v32, v32
    v_exp_f32 v33, v33
    v_exp_f32 v34, v34
    v_exp_f32 v35, v35
    v_pk_add_f32 v[28:29], v[28:29], v[244:245]
    v_pk_add_f32 v[30:31], v[30:31], v[244:245]
    v_pk_add_f32 v[32:33], v[32:33], v[244:245]
    v_pk_add_f32 v[34:35], v[34:35], v[244:245]
    v_rcp_f32 v28, v28
    v_rcp_f32 v29, v29
    v_rcp_f32 v30, v30
    v_rcp_f32 v31, v31
    v_rcp_f32 v32, v32
    v_rcp_f32 v33, v33
    v_rcp_f32 v34, v34
    v_rcp_f32 v35, v35
    v_pk_mul_f32 v[20:21], v[28:29], v[20:21]
    v_pk_mul_f32 v[22:23], v[30:31], v[22:23]
    v_pk_mul_f32 v[24:25], v[32:33], v[24:25]
    v_pk_mul_f32 v[26:27], v[34:35], v[26:27]
    v_cvt_pk_bf16_f32 v36, v20, v21
    v_cvt_pk_bf16_f32 v37, v22, v23
    v_cvt_pk_bf16_f32 v38, v24, v25
    v_cvt_pk_bf16_f32 v39, v26, v27
    buffer_store_dwordx4 v[36:39], v251, s[4:7], s53 offen offset:3072 sc1
    s_add_u32 s53, s53, s22
    v_accvgpr_read_b32 v40, a64
    v_accvgpr_read_b32 v41, a65
    v_accvgpr_read_b32 v42, a66
    v_accvgpr_read_b32 v43, a67
    v_accvgpr_read_b32 v44, a68
    v_accvgpr_read_b32 v45, a69
    v_accvgpr_read_b32 v46, a70
    v_accvgpr_read_b32 v47, a71
    v_pk_mul_f32 v[48:49], v[40:41], v[40:41]
    v_pk_mul_f32 v[50:51], v[42:43], v[42:43]
    v_pk_mul_f32 v[52:53], v[44:45], v[44:45]
    v_pk_mul_f32 v[54:55], v[46:47], v[46:47]
    v_pk_fma_f32 v[48:49], v[48:49], v[242:243], v[240:241]
    v_pk_fma_f32 v[50:51], v[50:51], v[242:243], v[240:241]
    v_pk_fma_f32 v[52:53], v[52:53], v[242:243], v[240:241]
    v_pk_fma_f32 v[54:55], v[54:55], v[242:243], v[240:241]
    v_pk_mul_f32 v[48:49], v[48:49], v[40:41]
    v_pk_mul_f32 v[50:51], v[50:51], v[42:43]
    v_pk_mul_f32 v[52:53], v[52:53], v[44:45]
    v_pk_mul_f32 v[54:55], v[54:55], v[46:47]
    v_exp_f32 v48, v48
    v_exp_f32 v49, v49
    v_exp_f32 v50, v50
    v_exp_f32 v51, v51
    v_exp_f32 v52, v52
    v_exp_f32 v53, v53
    v_exp_f32 v54, v54
    v_exp_f32 v55, v55
    v_pk_add_f32 v[48:49], v[48:49], v[244:245]
    v_pk_add_f32 v[50:51], v[50:51], v[244:245]
    v_pk_add_f32 v[52:53], v[52:53], v[244:245]
    v_pk_add_f32 v[54:55], v[54:55], v[244:245]
    v_rcp_f32 v48, v48
    v_rcp_f32 v49, v49
    v_rcp_f32 v50, v50
    v_rcp_f32 v51, v51
    v_rcp_f32 v52, v52
    v_rcp_f32 v53, v53
    v_rcp_f32 v54, v54
    v_rcp_f32 v55, v55
    v_pk_mul_f32 v[40:41], v[48:49], v[40:41]
    v_pk_mul_f32 v[42:43], v[50:51], v[42:43]
    v_pk_mul_f32 v[44:45], v[52:53], v[44:45]
    v_pk_mul_f32 v[46:47], v[54:55], v[46:47]
    v_cvt_pk_bf16_f32 v56, v40, v41
    v_cvt_pk_bf16_f32 v57, v42, v43
    v_cvt_pk_bf16_f32 v58, v44, v45
    v_cvt_pk_bf16_f32 v59, v46, v47
    buffer_store_dwordx4 v[56:59], v251, s[4:7], s53 offen offset:0 sc1
    v_accvgpr_read_b32 v0, a72
    v_accvgpr_read_b32 v1, a73
    v_accvgpr_read_b32 v2, a74
    v_accvgpr_read_b32 v3, a75
    v_accvgpr_read_b32 v4, a76
    v_accvgpr_read_b32 v5, a77
    v_accvgpr_read_b32 v6, a78
    v_accvgpr_read_b32 v7, a79
    v_pk_mul_f32 v[8:9], v[0:1], v[0:1]
    v_pk_mul_f32 v[10:11], v[2:3], v[2:3]
    v_pk_mul_f32 v[12:13], v[4:5], v[4:5]
    v_pk_mul_f32 v[14:15], v[6:7], v[6:7]
    v_pk_fma_f32 v[8:9], v[8:9], v[242:243], v[240:241]
    v_pk_fma_f32 v[10:11], v[10:11], v[242:243], v[240:241]
    v_pk_fma_f32 v[12:13], v[12:13], v[242:243], v[240:241]
    v_pk_fma_f32 v[14:15], v[14:15], v[242:243], v[240:241]
    v_pk_mul_f32 v[8:9], v[8:9], v[0:1]
    v_pk_mul_f32 v[10:11], v[10:11], v[2:3]
    v_pk_mul_f32 v[12:13], v[12:13], v[4:5]
    v_pk_mul_f32 v[14:15], v[14:15], v[6:7]
    v_exp_f32 v8, v8
    v_exp_f32 v9, v9
    v_exp_f32 v10, v10
    v_exp_f32 v11, v11
    v_exp_f32 v12, v12
    v_exp_f32 v13, v13
    v_exp_f32 v14, v14
    v_exp_f32 v15, v15
    v_pk_add_f32 v[8:9], v[8:9], v[244:245]
    v_pk_add_f32 v[10:11], v[10:11], v[244:245]
    v_pk_add_f32 v[12:13], v[12:13], v[244:245]
    v_pk_add_f32 v[14:15], v[14:15], v[244:245]
    v_rcp_f32 v8, v8
    v_rcp_f32 v9, v9
    v_rcp_f32 v10, v10
    v_rcp_f32 v11, v11
    v_rcp_f32 v12, v12
    v_rcp_f32 v13, v13
    v_rcp_f32 v14, v14
    v_rcp_f32 v15, v15
    v_pk_mul_f32 v[0:1], v[8:9], v[0:1]
    v_pk_mul_f32 v[2:3], v[10:11], v[2:3]
    v_pk_mul_f32 v[4:5], v[12:13], v[4:5]
    v_pk_mul_f32 v[6:7], v[14:15], v[6:7]
    v_cvt_pk_bf16_f32 v16, v0, v1
    v_cvt_pk_bf16_f32 v17, v2, v3
    v_cvt_pk_bf16_f32 v18, v4, v5
    v_cvt_pk_bf16_f32 v19, v6, v7
    buffer_store_dwordx4 v[16:19], v251, s[4:7], s53 offen offset:1024 sc1
    v_accvgpr_read_b32 v20, a80
    v_accvgpr_read_b32 v21, a81
    v_accvgpr_read_b32 v22, a82
    v_accvgpr_read_b32 v23, a83
    v_accvgpr_read_b32 v24, a84
    v_accvgpr_read_b32 v25, a85
    v_accvgpr_read_b32 v26, a86
    v_accvgpr_read_b32 v27, a87
    v_pk_mul_f32 v[28:29], v[20:21], v[20:21]
    v_pk_mul_f32 v[30:31], v[22:23], v[22:23]
    v_pk_mul_f32 v[32:33], v[24:25], v[24:25]
    v_pk_mul_f32 v[34:35], v[26:27], v[26:27]
    v_pk_fma_f32 v[28:29], v[28:29], v[242:243], v[240:241]
    v_pk_fma_f32 v[30:31], v[30:31], v[242:243], v[240:241]
    v_pk_fma_f32 v[32:33], v[32:33], v[242:243], v[240:241]
    v_pk_fma_f32 v[34:35], v[34:35], v[242:243], v[240:241]
    v_pk_mul_f32 v[28:29], v[28:29], v[20:21]
    v_pk_mul_f32 v[30:31], v[30:31], v[22:23]
    v_pk_mul_f32 v[32:33], v[32:33], v[24:25]
    v_pk_mul_f32 v[34:35], v[34:35], v[26:27]
    v_exp_f32 v28, v28
    v_exp_f32 v29, v29
    v_exp_f32 v30, v30
    v_exp_f32 v31, v31
    v_exp_f32 v32, v32
    v_exp_f32 v33, v33
    v_exp_f32 v34, v34
    v_exp_f32 v35, v35
    v_pk_add_f32 v[28:29], v[28:29], v[244:245]
    v_pk_add_f32 v[30:31], v[30:31], v[244:245]
    v_pk_add_f32 v[32:33], v[32:33], v[244:245]
    v_pk_add_f32 v[34:35], v[34:35], v[244:245]
    v_rcp_f32 v28, v28
    v_rcp_f32 v29, v29
    v_rcp_f32 v30, v30
    v_rcp_f32 v31, v31
    v_rcp_f32 v32, v32
    v_rcp_f32 v33, v33
    v_rcp_f32 v34, v34
    v_rcp_f32 v35, v35
    v_pk_mul_f32 v[20:21], v[28:29], v[20:21]
    v_pk_mul_f32 v[22:23], v[30:31], v[22:23]
    v_pk_mul_f32 v[24:25], v[32:33], v[24:25]
    v_pk_mul_f32 v[26:27], v[34:35], v[26:27]
    v_cvt_pk_bf16_f32 v36, v20, v21
    v_cvt_pk_bf16_f32 v37, v22, v23
    v_cvt_pk_bf16_f32 v38, v24, v25
    v_cvt_pk_bf16_f32 v39, v26, v27
    buffer_store_dwordx4 v[36:39], v251, s[4:7], s53 offen offset:2048 sc1
    v_accvgpr_read_b32 v40, a88
    v_accvgpr_read_b32 v41, a89
    v_accvgpr_read_b32 v42, a90
    v_accvgpr_read_b32 v43, a91
    v_accvgpr_read_b32 v44, a92
    v_accvgpr_read_b32 v45, a93
    v_accvgpr_read_b32 v46, a94
    v_accvgpr_read_b32 v47, a95
    v_pk_mul_f32 v[48:49], v[40:41], v[40:41]
    v_pk_mul_f32 v[50:51], v[42:43], v[42:43]
    v_pk_mul_f32 v[52:53], v[44:45], v[44:45]
    v_pk_mul_f32 v[54:55], v[46:47], v[46:47]
    v_pk_fma_f32 v[48:49], v[48:49], v[242:243], v[240:241]
    v_pk_fma_f32 v[50:51], v[50:51], v[242:243], v[240:241]
    v_pk_fma_f32 v[52:53], v[52:53], v[242:243], v[240:241]
    v_pk_fma_f32 v[54:55], v[54:55], v[242:243], v[240:241]
    v_pk_mul_f32 v[48:49], v[48:49], v[40:41]
    v_pk_mul_f32 v[50:51], v[50:51], v[42:43]
    v_pk_mul_f32 v[52:53], v[52:53], v[44:45]
    v_pk_mul_f32 v[54:55], v[54:55], v[46:47]
    v_exp_f32 v48, v48
    v_exp_f32 v49, v49
    v_exp_f32 v50, v50
    v_exp_f32 v51, v51
    v_exp_f32 v52, v52
    v_exp_f32 v53, v53
    v_exp_f32 v54, v54
    v_exp_f32 v55, v55
    v_pk_add_f32 v[48:49], v[48:49], v[244:245]
    v_pk_add_f32 v[50:51], v[50:51], v[244:245]
    v_pk_add_f32 v[52:53], v[52:53], v[244:245]
    v_pk_add_f32 v[54:55], v[54:55], v[244:245]
    v_rcp_f32 v48, v48
    v_rcp_f32 v49, v49
    v_rcp_f32 v50, v50
    v_rcp_f32 v51, v51
    v_rcp_f32 v52, v52
    v_rcp_f32 v53, v53
    v_rcp_f32 v54, v54
    v_rcp_f32 v55, v55
    v_pk_mul_f32 v[40:41], v[48:49], v[40:41]
    v_pk_mul_f32 v[42:43], v[50:51], v[42:43]
    v_pk_mul_f32 v[44:45], v[52:53], v[44:45]
    v_pk_mul_f32 v[46:47], v[54:55], v[46:47]
    v_cvt_pk_bf16_f32 v56, v40, v41
    v_cvt_pk_bf16_f32 v57, v42, v43
    v_cvt_pk_bf16_f32 v58, v44, v45
    v_cvt_pk_bf16_f32 v59, v46, v47
    buffer_store_dwordx4 v[56:59], v251, s[4:7], s53 offen offset:3072 sc1
    s_add_u32 s53, s53, s22
    v_accvgpr_read_b32 v0, a96
    v_accvgpr_read_b32 v1, a97
    v_accvgpr_read_b32 v2, a98
    v_accvgpr_read_b32 v3, a99
    v_accvgpr_read_b32 v4, a100
    v_accvgpr_read_b32 v5, a101
    v_accvgpr_read_b32 v6, a102
    v_accvgpr_read_b32 v7, a103
    v_pk_mul_f32 v[8:9], v[0:1], v[0:1]
    v_pk_mul_f32 v[10:11], v[2:3], v[2:3]
    v_pk_mul_f32 v[12:13], v[4:5], v[4:5]
    v_pk_mul_f32 v[14:15], v[6:7], v[6:7]
    v_pk_fma_f32 v[8:9], v[8:9], v[242:243], v[240:241]
    v_pk_fma_f32 v[10:11], v[10:11], v[242:243], v[240:241]
    v_pk_fma_f32 v[12:13], v[12:13], v[242:243], v[240:241]
    v_pk_fma_f32 v[14:15], v[14:15], v[242:243], v[240:241]
    v_pk_mul_f32 v[8:9], v[8:9], v[0:1]
    v_pk_mul_f32 v[10:11], v[10:11], v[2:3]
    v_pk_mul_f32 v[12:13], v[12:13], v[4:5]
    v_pk_mul_f32 v[14:15], v[14:15], v[6:7]
    v_exp_f32 v8, v8
    v_exp_f32 v9, v9
    v_exp_f32 v10, v10
    v_exp_f32 v11, v11
    v_exp_f32 v12, v12
    v_exp_f32 v13, v13
    v_exp_f32 v14, v14
    v_exp_f32 v15, v15
    v_pk_add_f32 v[8:9], v[8:9], v[244:245]
    v_pk_add_f32 v[10:11], v[10:11], v[244:245]
    v_pk_add_f32 v[12:13], v[12:13], v[244:245]
    v_pk_add_f32 v[14:15], v[14:15], v[244:245]
    v_rcp_f32 v8, v8
    v_rcp_f32 v9, v9
    v_rcp_f32 v10, v10
    v_rcp_f32 v11, v11
    v_rcp_f32 v12, v12
    v_rcp_f32 v13, v13
    v_rcp_f32 v14, v14
    v_rcp_f32 v15, v15
    v_pk_mul_f32 v[0:1], v[8:9], v[0:1]
    v_pk_mul_f32 v[2:3], v[10:11], v[2:3]
    v_pk_mul_f32 v[4:5], v[12:13], v[4:5]
    v_pk_mul_f32 v[6:7], v[14:15], v[6:7]
    v_cvt_pk_bf16_f32 v16, v0, v1
    v_cvt_pk_bf16_f32 v17, v2, v3
    v_cvt_pk_bf16_f32 v18, v4, v5
    v_cvt_pk_bf16_f32 v19, v6, v7
    buffer_store_dwordx4 v[16:19], v251, s[4:7], s53 offen offset:0 sc1
    v_accvgpr_read_b32 v20, a104
    v_accvgpr_read_b32 v21, a105
    v_accvgpr_read_b32 v22, a106
    v_accvgpr_read_b32 v23, a107
    v_accvgpr_read_b32 v24, a108
    v_accvgpr_read_b32 v25, a109
    v_accvgpr_read_b32 v26, a110
    v_accvgpr_read_b32 v27, a111
    v_pk_mul_f32 v[28:29], v[20:21], v[20:21]
    v_pk_mul_f32 v[30:31], v[22:23], v[22:23]
    v_pk_mul_f32 v[32:33], v[24:25], v[24:25]
    v_pk_mul_f32 v[34:35], v[26:27], v[26:27]
    v_pk_fma_f32 v[28:29], v[28:29], v[242:243], v[240:241]
    v_pk_fma_f32 v[30:31], v[30:31], v[242:243], v[240:241]
    v_pk_fma_f32 v[32:33], v[32:33], v[242:243], v[240:241]
    v_pk_fma_f32 v[34:35], v[34:35], v[242:243], v[240:241]
    v_pk_mul_f32 v[28:29], v[28:29], v[20:21]
    v_pk_mul_f32 v[30:31], v[30:31], v[22:23]
    v_pk_mul_f32 v[32:33], v[32:33], v[24:25]
    v_pk_mul_f32 v[34:35], v[34:35], v[26:27]
    v_exp_f32 v28, v28
    v_exp_f32 v29, v29
    v_exp_f32 v30, v30
    v_exp_f32 v31, v31
    v_exp_f32 v32, v32
    v_exp_f32 v33, v33
    v_exp_f32 v34, v34
    v_exp_f32 v35, v35
    v_pk_add_f32 v[28:29], v[28:29], v[244:245]
    v_pk_add_f32 v[30:31], v[30:31], v[244:245]
    v_pk_add_f32 v[32:33], v[32:33], v[244:245]
    v_pk_add_f32 v[34:35], v[34:35], v[244:245]
    v_rcp_f32 v28, v28
    v_rcp_f32 v29, v29
    v_rcp_f32 v30, v30
    v_rcp_f32 v31, v31
    v_rcp_f32 v32, v32
    v_rcp_f32 v33, v33
    v_rcp_f32 v34, v34
    v_rcp_f32 v35, v35
    v_pk_mul_f32 v[20:21], v[28:29], v[20:21]
    v_pk_mul_f32 v[22:23], v[30:31], v[22:23]
    v_pk_mul_f32 v[24:25], v[32:33], v[24:25]
    v_pk_mul_f32 v[26:27], v[34:35], v[26:27]
    v_cvt_pk_bf16_f32 v36, v20, v21
    v_cvt_pk_bf16_f32 v37, v22, v23
    v_cvt_pk_bf16_f32 v38, v24, v25
    v_cvt_pk_bf16_f32 v39, v26, v27
    buffer_store_dwordx4 v[36:39], v251, s[4:7], s53 offen offset:1024 sc1
    v_accvgpr_read_b32 v40, a112
    v_accvgpr_read_b32 v41, a113
    v_accvgpr_read_b32 v42, a114
    v_accvgpr_read_b32 v43, a115
    v_accvgpr_read_b32 v44, a116
    v_accvgpr_read_b32 v45, a117
    v_accvgpr_read_b32 v46, a118
    v_accvgpr_read_b32 v47, a119
    v_pk_mul_f32 v[48:49], v[40:41], v[40:41]
    v_pk_mul_f32 v[50:51], v[42:43], v[42:43]
    v_pk_mul_f32 v[52:53], v[44:45], v[44:45]
    v_pk_mul_f32 v[54:55], v[46:47], v[46:47]
    v_pk_fma_f32 v[48:49], v[48:49], v[242:243], v[240:241]
    v_pk_fma_f32 v[50:51], v[50:51], v[242:243], v[240:241]
    v_pk_fma_f32 v[52:53], v[52:53], v[242:243], v[240:241]
    v_pk_fma_f32 v[54:55], v[54:55], v[242:243], v[240:241]
    v_pk_mul_f32 v[48:49], v[48:49], v[40:41]
    v_pk_mul_f32 v[50:51], v[50:51], v[42:43]
    v_pk_mul_f32 v[52:53], v[52:53], v[44:45]
    v_pk_mul_f32 v[54:55], v[54:55], v[46:47]
    v_exp_f32 v48, v48
    v_exp_f32 v49, v49
    v_exp_f32 v50, v50
    v_exp_f32 v51, v51
    v_exp_f32 v52, v52
    v_exp_f32 v53, v53
    v_exp_f32 v54, v54
    v_exp_f32 v55, v55
    v_pk_add_f32 v[48:49], v[48:49], v[244:245]
    v_pk_add_f32 v[50:51], v[50:51], v[244:245]
    v_pk_add_f32 v[52:53], v[52:53], v[244:245]
    v_pk_add_f32 v[54:55], v[54:55], v[244:245]
    v_rcp_f32 v48, v48
    v_rcp_f32 v49, v49
    v_rcp_f32 v50, v50
    v_rcp_f32 v51, v51
    v_rcp_f32 v52, v52
    v_rcp_f32 v53, v53
    v_rcp_f32 v54, v54
    v_rcp_f32 v55, v55
    v_pk_mul_f32 v[40:41], v[48:49], v[40:41]
    v_pk_mul_f32 v[42:43], v[50:51], v[42:43]
    v_pk_mul_f32 v[44:45], v[52:53], v[44:45]
    v_pk_mul_f32 v[46:47], v[54:55], v[46:47]
    v_cvt_pk_bf16_f32 v56, v40, v41
    v_cvt_pk_bf16_f32 v57, v42, v43
    v_cvt_pk_bf16_f32 v58, v44, v45
    v_cvt_pk_bf16_f32 v59, v46, v47
    buffer_store_dwordx4 v[56:59], v251, s[4:7], s53 offen offset:2048 sc1
    v_accvgpr_read_b32 v0, a120
    v_accvgpr_read_b32 v1, a121
    v_accvgpr_read_b32 v2, a122
    v_accvgpr_read_b32 v3, a123
    v_accvgpr_read_b32 v4, a124
    v_accvgpr_read_b32 v5, a125
    v_accvgpr_read_b32 v6, a126
    v_accvgpr_read_b32 v7, a127
    v_pk_mul_f32 v[8:9], v[0:1], v[0:1]
    v_pk_mul_f32 v[10:11], v[2:3], v[2:3]
    v_pk_mul_f32 v[12:13], v[4:5], v[4:5]
    v_pk_mul_f32 v[14:15], v[6:7], v[6:7]
    v_pk_fma_f32 v[8:9], v[8:9], v[242:243], v[240:241]
    v_pk_fma_f32 v[10:11], v[10:11], v[242:243], v[240:241]
    v_pk_fma_f32 v[12:13], v[12:13], v[242:243], v[240:241]
    v_pk_fma_f32 v[14:15], v[14:15], v[242:243], v[240:241]
    v_pk_mul_f32 v[8:9], v[8:9], v[0:1]
    v_pk_mul_f32 v[10:11], v[10:11], v[2:3]
    v_pk_mul_f32 v[12:13], v[12:13], v[4:5]
    v_pk_mul_f32 v[14:15], v[14:15], v[6:7]
    v_exp_f32 v8, v8
    v_exp_f32 v9, v9
    v_exp_f32 v10, v10
    v_exp_f32 v11, v11
    v_exp_f32 v12, v12
    v_exp_f32 v13, v13
    v_exp_f32 v14, v14
    v_exp_f32 v15, v15
    v_pk_add_f32 v[8:9], v[8:9], v[244:245]
    v_pk_add_f32 v[10:11], v[10:11], v[244:245]
    v_pk_add_f32 v[12:13], v[12:13], v[244:245]
    v_pk_add_f32 v[14:15], v[14:15], v[244:245]
    v_rcp_f32 v8, v8
    v_rcp_f32 v9, v9
    v_rcp_f32 v10, v10
    v_rcp_f32 v11, v11
    v_rcp_f32 v12, v12
    v_rcp_f32 v13, v13
    v_rcp_f32 v14, v14
    v_rcp_f32 v15, v15
    v_pk_mul_f32 v[0:1], v[8:9], v[0:1]
    v_pk_mul_f32 v[2:3], v[10:11], v[2:3]
    v_pk_mul_f32 v[4:5], v[12:13], v[4:5]
    v_pk_mul_f32 v[6:7], v[14:15], v[6:7]
    v_cvt_pk_bf16_f32 v16, v0, v1
    v_cvt_pk_bf16_f32 v17, v2, v3
    v_cvt_pk_bf16_f32 v18, v4, v5
    v_cvt_pk_bf16_f32 v19, v6, v7
    buffer_store_dwordx4 v[16:19], v251, s[4:7], s53 offen offset:3072 sc1
    s_add_u32 s53, s53, s22
    v_accvgpr_read_b32 v20, a128
    v_accvgpr_read_b32 v21, a129
    v_accvgpr_read_b32 v22, a130
    v_accvgpr_read_b32 v23, a131
    v_accvgpr_read_b32 v24, a132
    v_accvgpr_read_b32 v25, a133
    v_accvgpr_read_b32 v26, a134
    v_accvgpr_read_b32 v27, a135
    v_pk_mul_f32 v[28:29], v[20:21], v[20:21]
    v_pk_mul_f32 v[30:31], v[22:23], v[22:23]
    v_pk_mul_f32 v[32:33], v[24:25], v[24:25]
    v_pk_mul_f32 v[34:35], v[26:27], v[26:27]
    v_pk_fma_f32 v[28:29], v[28:29], v[242:243], v[240:241]
    v_pk_fma_f32 v[30:31], v[30:31], v[242:243], v[240:241]
    v_pk_fma_f32 v[32:33], v[32:33], v[242:243], v[240:241]
    v_pk_fma_f32 v[34:35], v[34:35], v[242:243], v[240:241]
    v_pk_mul_f32 v[28:29], v[28:29], v[20:21]
    v_pk_mul_f32 v[30:31], v[30:31], v[22:23]
    v_pk_mul_f32 v[32:33], v[32:33], v[24:25]
    v_pk_mul_f32 v[34:35], v[34:35], v[26:27]
    v_exp_f32 v28, v28
    v_exp_f32 v29, v29
    v_exp_f32 v30, v30
    v_exp_f32 v31, v31
    v_exp_f32 v32, v32
    v_exp_f32 v33, v33
    v_exp_f32 v34, v34
    v_exp_f32 v35, v35
    v_pk_add_f32 v[28:29], v[28:29], v[244:245]
    v_pk_add_f32 v[30:31], v[30:31], v[244:245]
    v_pk_add_f32 v[32:33], v[32:33], v[244:245]
    v_pk_add_f32 v[34:35], v[34:35], v[244:245]
    v_rcp_f32 v28, v28
    v_rcp_f32 v29, v29
    v_rcp_f32 v30, v30
    v_rcp_f32 v31, v31
    v_rcp_f32 v32, v32
    v_rcp_f32 v33, v33
    v_rcp_f32 v34, v34
    v_rcp_f32 v35, v35
    v_pk_mul_f32 v[20:21], v[28:29], v[20:21]
    v_pk_mul_f32 v[22:23], v[30:31], v[22:23]
    v_pk_mul_f32 v[24:25], v[32:33], v[24:25]
    v_pk_mul_f32 v[26:27], v[34:35], v[26:27]
    v_cvt_pk_bf16_f32 v36, v20, v21
    v_cvt_pk_bf16_f32 v37, v22, v23
    v_cvt_pk_bf16_f32 v38, v24, v25
    v_cvt_pk_bf16_f32 v39, v26, v27
    buffer_store_dwordx4 v[36:39], v251, s[4:7], s53 offen offset:0 sc1
    v_accvgpr_read_b32 v40, a136
    v_accvgpr_read_b32 v41, a137
    v_accvgpr_read_b32 v42, a138
    v_accvgpr_read_b32 v43, a139
    v_accvgpr_read_b32 v44, a140
    v_accvgpr_read_b32 v45, a141
    v_accvgpr_read_b32 v46, a142
    v_accvgpr_read_b32 v47, a143
    v_pk_mul_f32 v[48:49], v[40:41], v[40:41]
    v_pk_mul_f32 v[50:51], v[42:43], v[42:43]
    v_pk_mul_f32 v[52:53], v[44:45], v[44:45]
    v_pk_mul_f32 v[54:55], v[46:47], v[46:47]
    v_pk_fma_f32 v[48:49], v[48:49], v[242:243], v[240:241]
    v_pk_fma_f32 v[50:51], v[50:51], v[242:243], v[240:241]
    v_pk_fma_f32 v[52:53], v[52:53], v[242:243], v[240:241]
    v_pk_fma_f32 v[54:55], v[54:55], v[242:243], v[240:241]
    v_pk_mul_f32 v[48:49], v[48:49], v[40:41]
    v_pk_mul_f32 v[50:51], v[50:51], v[42:43]
    v_pk_mul_f32 v[52:53], v[52:53], v[44:45]
    v_pk_mul_f32 v[54:55], v[54:55], v[46:47]
    v_exp_f32 v48, v48
    v_exp_f32 v49, v49
    v_exp_f32 v50, v50
    v_exp_f32 v51, v51
    v_exp_f32 v52, v52
    v_exp_f32 v53, v53
    v_exp_f32 v54, v54
    v_exp_f32 v55, v55
    v_pk_add_f32 v[48:49], v[48:49], v[244:245]
    v_pk_add_f32 v[50:51], v[50:51], v[244:245]
    v_pk_add_f32 v[52:53], v[52:53], v[244:245]
    v_pk_add_f32 v[54:55], v[54:55], v[244:245]
    v_rcp_f32 v48, v48
    v_rcp_f32 v49, v49
    v_rcp_f32 v50, v50
    v_rcp_f32 v51, v51
    v_rcp_f32 v52, v52
    v_rcp_f32 v53, v53
    v_rcp_f32 v54, v54
    v_rcp_f32 v55, v55
    v_pk_mul_f32 v[40:41], v[48:49], v[40:41]
    v_pk_mul_f32 v[42:43], v[50:51], v[42:43]
    v_pk_mul_f32 v[44:45], v[52:53], v[44:45]
    v_pk_mul_f32 v[46:47], v[54:55], v[46:47]
    v_cvt_pk_bf16_f32 v56, v40, v41
    v_cvt_pk_bf16_f32 v57, v42, v43
    v_cvt_pk_bf16_f32 v58, v44, v45
    v_cvt_pk_bf16_f32 v59, v46, v47
    buffer_store_dwordx4 v[56:59], v251, s[4:7], s53 offen offset:1024 sc1
    v_accvgpr_read_b32 v0, a144
    v_accvgpr_read_b32 v1, a145
    v_accvgpr_read_b32 v2, a146
    v_accvgpr_read_b32 v3, a147
    v_accvgpr_read_b32 v4, a148
    v_accvgpr_read_b32 v5, a149
    v_accvgpr_read_b32 v6, a150
    v_accvgpr_read_b32 v7, a151
    v_pk_mul_f32 v[8:9], v[0:1], v[0:1]
    v_pk_mul_f32 v[10:11], v[2:3], v[2:3]
    v_pk_mul_f32 v[12:13], v[4:5], v[4:5]
    v_pk_mul_f32 v[14:15], v[6:7], v[6:7]
    v_pk_fma_f32 v[8:9], v[8:9], v[242:243], v[240:241]
    v_pk_fma_f32 v[10:11], v[10:11], v[242:243], v[240:241]
    v_pk_fma_f32 v[12:13], v[12:13], v[242:243], v[240:241]
    v_pk_fma_f32 v[14:15], v[14:15], v[242:243], v[240:241]
    v_pk_mul_f32 v[8:9], v[8:9], v[0:1]
    v_pk_mul_f32 v[10:11], v[10:11], v[2:3]
    v_pk_mul_f32 v[12:13], v[12:13], v[4:5]
    v_pk_mul_f32 v[14:15], v[14:15], v[6:7]
    v_exp_f32 v8, v8
    v_exp_f32 v9, v9
    v_exp_f32 v10, v10
    v_exp_f32 v11, v11
    v_exp_f32 v12, v12
    v_exp_f32 v13, v13
    v_exp_f32 v14, v14
    v_exp_f32 v15, v15
    v_pk_add_f32 v[8:9], v[8:9], v[244:245]
    v_pk_add_f32 v[10:11], v[10:11], v[244:245]
    v_pk_add_f32 v[12:13], v[12:13], v[244:245]
    v_pk_add_f32 v[14:15], v[14:15], v[244:245]
    v_rcp_f32 v8, v8
    v_rcp_f32 v9, v9
    v_rcp_f32 v10, v10
    v_rcp_f32 v11, v11
    v_rcp_f32 v12, v12
    v_rcp_f32 v13, v13
    v_rcp_f32 v14, v14
    v_rcp_f32 v15, v15
    v_pk_mul_f32 v[0:1], v[8:9], v[0:1]
    v_pk_mul_f32 v[2:3], v[10:11], v[2:3]
    v_pk_mul_f32 v[4:5], v[12:13], v[4:5]
    v_pk_mul_f32 v[6:7], v[14:15], v[6:7]
    v_cvt_pk_bf16_f32 v16, v0, v1
    v_cvt_pk_bf16_f32 v17, v2, v3
    v_cvt_pk_bf16_f32 v18, v4, v5
    v_cvt_pk_bf16_f32 v19, v6, v7
    buffer_store_dwordx4 v[16:19], v251, s[4:7], s53 offen offset:2048 sc1
    v_accvgpr_read_b32 v20, a152
    v_accvgpr_read_b32 v21, a153
    v_accvgpr_read_b32 v22, a154
    v_accvgpr_read_b32 v23, a155
    v_accvgpr_read_b32 v24, a156
    v_accvgpr_read_b32 v25, a157
    v_accvgpr_read_b32 v26, a158
    v_accvgpr_read_b32 v27, a159
    v_pk_mul_f32 v[28:29], v[20:21], v[20:21]
    v_pk_mul_f32 v[30:31], v[22:23], v[22:23]
    v_pk_mul_f32 v[32:33], v[24:25], v[24:25]
    v_pk_mul_f32 v[34:35], v[26:27], v[26:27]
    v_pk_fma_f32 v[28:29], v[28:29], v[242:243], v[240:241]
    v_pk_fma_f32 v[30:31], v[30:31], v[242:243], v[240:241]
    v_pk_fma_f32 v[32:33], v[32:33], v[242:243], v[240:241]
    v_pk_fma_f32 v[34:35], v[34:35], v[242:243], v[240:241]
    v_pk_mul_f32 v[28:29], v[28:29], v[20:21]
    v_pk_mul_f32 v[30:31], v[30:31], v[22:23]
    v_pk_mul_f32 v[32:33], v[32:33], v[24:25]
    v_pk_mul_f32 v[34:35], v[34:35], v[26:27]
    v_exp_f32 v28, v28
    v_exp_f32 v29, v29
    v_exp_f32 v30, v30
    v_exp_f32 v31, v31
    v_exp_f32 v32, v32
    v_exp_f32 v33, v33
    v_exp_f32 v34, v34
    v_exp_f32 v35, v35
    v_pk_add_f32 v[28:29], v[28:29], v[244:245]
    v_pk_add_f32 v[30:31], v[30:31], v[244:245]
    v_pk_add_f32 v[32:33], v[32:33], v[244:245]
    v_pk_add_f32 v[34:35], v[34:35], v[244:245]
    v_rcp_f32 v28, v28
    v_rcp_f32 v29, v29
    v_rcp_f32 v30, v30
    v_rcp_f32 v31, v31
    v_rcp_f32 v32, v32
    v_rcp_f32 v33, v33
    v_rcp_f32 v34, v34
    v_rcp_f32 v35, v35
    v_pk_mul_f32 v[20:21], v[28:29], v[20:21]
    v_pk_mul_f32 v[22:23], v[30:31], v[22:23]
    v_pk_mul_f32 v[24:25], v[32:33], v[24:25]
    v_pk_mul_f32 v[26:27], v[34:35], v[26:27]
    v_cvt_pk_bf16_f32 v36, v20, v21
    v_cvt_pk_bf16_f32 v37, v22, v23
    v_cvt_pk_bf16_f32 v38, v24, v25
    v_cvt_pk_bf16_f32 v39, v26, v27
    buffer_store_dwordx4 v[36:39], v251, s[4:7], s53 offen offset:3072 sc1
    s_add_u32 s53, s53, s22
    v_accvgpr_read_b32 v40, a160
    v_accvgpr_read_b32 v41, a161
    v_accvgpr_read_b32 v42, a162
    v_accvgpr_read_b32 v43, a163
    v_accvgpr_read_b32 v44, a164
    v_accvgpr_read_b32 v45, a165
    v_accvgpr_read_b32 v46, a166
    v_accvgpr_read_b32 v47, a167
    v_pk_mul_f32 v[48:49], v[40:41], v[40:41]
    v_pk_mul_f32 v[50:51], v[42:43], v[42:43]
    v_pk_mul_f32 v[52:53], v[44:45], v[44:45]
    v_pk_mul_f32 v[54:55], v[46:47], v[46:47]
    v_pk_fma_f32 v[48:49], v[48:49], v[242:243], v[240:241]
    v_pk_fma_f32 v[50:51], v[50:51], v[242:243], v[240:241]
    v_pk_fma_f32 v[52:53], v[52:53], v[242:243], v[240:241]
    v_pk_fma_f32 v[54:55], v[54:55], v[242:243], v[240:241]
    v_pk_mul_f32 v[48:49], v[48:49], v[40:41]
    v_pk_mul_f32 v[50:51], v[50:51], v[42:43]
    v_pk_mul_f32 v[52:53], v[52:53], v[44:45]
    v_pk_mul_f32 v[54:55], v[54:55], v[46:47]
    v_exp_f32 v48, v48
    v_exp_f32 v49, v49
    v_exp_f32 v50, v50
    v_exp_f32 v51, v51
    v_exp_f32 v52, v52
    v_exp_f32 v53, v53
    v_exp_f32 v54, v54
    v_exp_f32 v55, v55
    v_pk_add_f32 v[48:49], v[48:49], v[244:245]
    v_pk_add_f32 v[50:51], v[50:51], v[244:245]
    v_pk_add_f32 v[52:53], v[52:53], v[244:245]
    v_pk_add_f32 v[54:55], v[54:55], v[244:245]
    v_rcp_f32 v48, v48
    v_rcp_f32 v49, v49
    v_rcp_f32 v50, v50
    v_rcp_f32 v51, v51
    v_rcp_f32 v52, v52
    v_rcp_f32 v53, v53
    v_rcp_f32 v54, v54
    v_rcp_f32 v55, v55
    v_pk_mul_f32 v[40:41], v[48:49], v[40:41]
    v_pk_mul_f32 v[42:43], v[50:51], v[42:43]
    v_pk_mul_f32 v[44:45], v[52:53], v[44:45]
    v_pk_mul_f32 v[46:47], v[54:55], v[46:47]
    v_cvt_pk_bf16_f32 v56, v40, v41
    v_cvt_pk_bf16_f32 v57, v42, v43
    v_cvt_pk_bf16_f32 v58, v44, v45
    v_cvt_pk_bf16_f32 v59, v46, v47
    buffer_store_dwordx4 v[56:59], v251, s[4:7], s53 offen offset:0 sc1
    v_accvgpr_read_b32 v0, a168
    v_accvgpr_read_b32 v1, a169
    v_accvgpr_read_b32 v2, a170
    v_accvgpr_read_b32 v3, a171
    v_accvgpr_read_b32 v4, a172
    v_accvgpr_read_b32 v5, a173
    v_accvgpr_read_b32 v6, a174
    v_accvgpr_read_b32 v7, a175
    v_pk_mul_f32 v[8:9], v[0:1], v[0:1]
    v_pk_mul_f32 v[10:11], v[2:3], v[2:3]
    v_pk_mul_f32 v[12:13], v[4:5], v[4:5]
    v_pk_mul_f32 v[14:15], v[6:7], v[6:7]
    v_pk_fma_f32 v[8:9], v[8:9], v[242:243], v[240:241]
    v_pk_fma_f32 v[10:11], v[10:11], v[242:243], v[240:241]
    v_pk_fma_f32 v[12:13], v[12:13], v[242:243], v[240:241]
    v_pk_fma_f32 v[14:15], v[14:15], v[242:243], v[240:241]
    v_pk_mul_f32 v[8:9], v[8:9], v[0:1]
    v_pk_mul_f32 v[10:11], v[10:11], v[2:3]
    v_pk_mul_f32 v[12:13], v[12:13], v[4:5]
    v_pk_mul_f32 v[14:15], v[14:15], v[6:7]
    v_exp_f32 v8, v8
    v_exp_f32 v9, v9
    v_exp_f32 v10, v10
    v_exp_f32 v11, v11
    v_exp_f32 v12, v12
    v_exp_f32 v13, v13
    v_exp_f32 v14, v14
    v_exp_f32 v15, v15
    v_pk_add_f32 v[8:9], v[8:9], v[244:245]
    v_pk_add_f32 v[10:11], v[10:11], v[244:245]
    v_pk_add_f32 v[12:13], v[12:13], v[244:245]
    v_pk_add_f32 v[14:15], v[14:15], v[244:245]
    v_rcp_f32 v8, v8
    v_rcp_f32 v9, v9
    v_rcp_f32 v10, v10
    v_rcp_f32 v11, v11
    v_rcp_f32 v12, v12
    v_rcp_f32 v13, v13
    v_rcp_f32 v14, v14
    v_rcp_f32 v15, v15
    v_pk_mul_f32 v[0:1], v[8:9], v[0:1]
    v_pk_mul_f32 v[2:3], v[10:11], v[2:3]
    v_pk_mul_f32 v[4:5], v[12:13], v[4:5]
    v_pk_mul_f32 v[6:7], v[14:15], v[6:7]
    v_cvt_pk_bf16_f32 v16, v0, v1
    v_cvt_pk_bf16_f32 v17, v2, v3
    v_cvt_pk_bf16_f32 v18, v4, v5
    v_cvt_pk_bf16_f32 v19, v6, v7
    buffer_store_dwordx4 v[16:19], v251, s[4:7], s53 offen offset:1024 sc1
    v_accvgpr_read_b32 v20, a176
    v_accvgpr_read_b32 v21, a177
    v_accvgpr_read_b32 v22, a178
    v_accvgpr_read_b32 v23, a179
    v_accvgpr_read_b32 v24, a180
    v_accvgpr_read_b32 v25, a181
    v_accvgpr_read_b32 v26, a182
    v_accvgpr_read_b32 v27, a183
    v_pk_mul_f32 v[28:29], v[20:21], v[20:21]
    v_pk_mul_f32 v[30:31], v[22:23], v[22:23]
    v_pk_mul_f32 v[32:33], v[24:25], v[24:25]
    v_pk_mul_f32 v[34:35], v[26:27], v[26:27]
    v_pk_fma_f32 v[28:29], v[28:29], v[242:243], v[240:241]
    v_pk_fma_f32 v[30:31], v[30:31], v[242:243], v[240:241]
    v_pk_fma_f32 v[32:33], v[32:33], v[242:243], v[240:241]
    v_pk_fma_f32 v[34:35], v[34:35], v[242:243], v[240:241]
    v_pk_mul_f32 v[28:29], v[28:29], v[20:21]
    v_pk_mul_f32 v[30:31], v[30:31], v[22:23]
    v_pk_mul_f32 v[32:33], v[32:33], v[24:25]
    v_pk_mul_f32 v[34:35], v[34:35], v[26:27]
    v_exp_f32 v28, v28
    v_exp_f32 v29, v29
    v_exp_f32 v30, v30
    v_exp_f32 v31, v31
    v_exp_f32 v32, v32
    v_exp_f32 v33, v33
    v_exp_f32 v34, v34
    v_exp_f32 v35, v35
    v_pk_add_f32 v[28:29], v[28:29], v[244:245]
    v_pk_add_f32 v[30:31], v[30:31], v[244:245]
    v_pk_add_f32 v[32:33], v[32:33], v[244:245]
    v_pk_add_f32 v[34:35], v[34:35], v[244:245]
    v_rcp_f32 v28, v28
    v_rcp_f32 v29, v29
    v_rcp_f32 v30, v30
    v_rcp_f32 v31, v31
    v_rcp_f32 v32, v32
    v_rcp_f32 v33, v33
    v_rcp_f32 v34, v34
    v_rcp_f32 v35, v35
    v_pk_mul_f32 v[20:21], v[28:29], v[20:21]
    v_pk_mul_f32 v[22:23], v[30:31], v[22:23]
    v_pk_mul_f32 v[24:25], v[32:33], v[24:25]
    v_pk_mul_f32 v[26:27], v[34:35], v[26:27]
    v_cvt_pk_bf16_f32 v36, v20, v21
    v_cvt_pk_bf16_f32 v37, v22, v23
    v_cvt_pk_bf16_f32 v38, v24, v25
    v_cvt_pk_bf16_f32 v39, v26, v27
    buffer_store_dwordx4 v[36:39], v251, s[4:7], s53 offen offset:2048 sc1
    v_accvgpr_read_b32 v40, a184
    v_accvgpr_read_b32 v41, a185
    v_accvgpr_read_b32 v42, a186
    v_accvgpr_read_b32 v43, a187
    v_accvgpr_read_b32 v44, a188
    v_accvgpr_read_b32 v45, a189
    v_accvgpr_read_b32 v46, a190
    v_accvgpr_read_b32 v47, a191
    v_pk_mul_f32 v[48:49], v[40:41], v[40:41]
    v_pk_mul_f32 v[50:51], v[42:43], v[42:43]
    v_pk_mul_f32 v[52:53], v[44:45], v[44:45]
    v_pk_mul_f32 v[54:55], v[46:47], v[46:47]
    v_pk_fma_f32 v[48:49], v[48:49], v[242:243], v[240:241]
    v_pk_fma_f32 v[50:51], v[50:51], v[242:243], v[240:241]
    v_pk_fma_f32 v[52:53], v[52:53], v[242:243], v[240:241]
    v_pk_fma_f32 v[54:55], v[54:55], v[242:243], v[240:241]
    v_pk_mul_f32 v[48:49], v[48:49], v[40:41]
    v_pk_mul_f32 v[50:51], v[50:51], v[42:43]
    v_pk_mul_f32 v[52:53], v[52:53], v[44:45]
    v_pk_mul_f32 v[54:55], v[54:55], v[46:47]
    v_exp_f32 v48, v48
    v_exp_f32 v49, v49
    v_exp_f32 v50, v50
    v_exp_f32 v51, v51
    v_exp_f32 v52, v52
    v_exp_f32 v53, v53
    v_exp_f32 v54, v54
    v_exp_f32 v55, v55
    v_pk_add_f32 v[48:49], v[48:49], v[244:245]
    v_pk_add_f32 v[50:51], v[50:51], v[244:245]
    v_pk_add_f32 v[52:53], v[52:53], v[244:245]
    v_pk_add_f32 v[54:55], v[54:55], v[244:245]
    v_rcp_f32 v48, v48
    v_rcp_f32 v49, v49
    v_rcp_f32 v50, v50
    v_rcp_f32 v51, v51
    v_rcp_f32 v52, v52
    v_rcp_f32 v53, v53
    v_rcp_f32 v54, v54
    v_rcp_f32 v55, v55
    v_pk_mul_f32 v[40:41], v[48:49], v[40:41]
    v_pk_mul_f32 v[42:43], v[50:51], v[42:43]
    v_pk_mul_f32 v[44:45], v[52:53], v[44:45]
    v_pk_mul_f32 v[46:47], v[54:55], v[46:47]
    v_cvt_pk_bf16_f32 v56, v40, v41
    v_cvt_pk_bf16_f32 v57, v42, v43
    v_cvt_pk_bf16_f32 v58, v44, v45
    v_cvt_pk_bf16_f32 v59, v46, v47
    buffer_store_dwordx4 v[56:59], v251, s[4:7], s53 offen offset:3072 sc1
    s_add_u32 s53, s53, s22
    v_accvgpr_read_b32 v0, a192
    v_accvgpr_read_b32 v1, a193
    v_accvgpr_read_b32 v2, a194
    v_accvgpr_read_b32 v3, a195
    v_accvgpr_read_b32 v4, a196
    v_accvgpr_read_b32 v5, a197
    v_accvgpr_read_b32 v6, a198
    v_accvgpr_read_b32 v7, a199
    v_pk_mul_f32 v[8:9], v[0:1], v[0:1]
    v_pk_mul_f32 v[10:11], v[2:3], v[2:3]
    v_pk_mul_f32 v[12:13], v[4:5], v[4:5]
    v_pk_mul_f32 v[14:15], v[6:7], v[6:7]
    v_pk_fma_f32 v[8:9], v[8:9], v[242:243], v[240:241]
    v_pk_fma_f32 v[10:11], v[10:11], v[242:243], v[240:241]
    v_pk_fma_f32 v[12:13], v[12:13], v[242:243], v[240:241]
    v_pk_fma_f32 v[14:15], v[14:15], v[242:243], v[240:241]
    v_pk_mul_f32 v[8:9], v[8:9], v[0:1]
    v_pk_mul_f32 v[10:11], v[10:11], v[2:3]
    v_pk_mul_f32 v[12:13], v[12:13], v[4:5]
    v_pk_mul_f32 v[14:15], v[14:15], v[6:7]
    v_exp_f32 v8, v8
    v_exp_f32 v9, v9
    v_exp_f32 v10, v10
    v_exp_f32 v11, v11
    v_exp_f32 v12, v12
    v_exp_f32 v13, v13
    v_exp_f32 v14, v14
    v_exp_f32 v15, v15
    v_pk_add_f32 v[8:9], v[8:9], v[244:245]
    v_pk_add_f32 v[10:11], v[10:11], v[244:245]
    v_pk_add_f32 v[12:13], v[12:13], v[244:245]
    v_pk_add_f32 v[14:15], v[14:15], v[244:245]
    v_rcp_f32 v8, v8
    v_rcp_f32 v9, v9
    v_rcp_f32 v10, v10
    v_rcp_f32 v11, v11
    v_rcp_f32 v12, v12
    v_rcp_f32 v13, v13
    v_rcp_f32 v14, v14
    v_rcp_f32 v15, v15
    v_pk_mul_f32 v[0:1], v[8:9], v[0:1]
    v_pk_mul_f32 v[2:3], v[10:11], v[2:3]
    v_pk_mul_f32 v[4:5], v[12:13], v[4:5]
    v_pk_mul_f32 v[6:7], v[14:15], v[6:7]
    v_cvt_pk_bf16_f32 v16, v0, v1
    v_cvt_pk_bf16_f32 v17, v2, v3
    v_cvt_pk_bf16_f32 v18, v4, v5
    v_cvt_pk_bf16_f32 v19, v6, v7
    buffer_store_dwordx4 v[16:19], v251, s[4:7], s53 offen offset:0 sc1
    v_accvgpr_read_b32 v20, a200
    v_accvgpr_read_b32 v21, a201
    v_accvgpr_read_b32 v22, a202
    v_accvgpr_read_b32 v23, a203
    v_accvgpr_read_b32 v24, a204
    v_accvgpr_read_b32 v25, a205
    v_accvgpr_read_b32 v26, a206
    v_accvgpr_read_b32 v27, a207
    v_pk_mul_f32 v[28:29], v[20:21], v[20:21]
    v_pk_mul_f32 v[30:31], v[22:23], v[22:23]
    v_pk_mul_f32 v[32:33], v[24:25], v[24:25]
    v_pk_mul_f32 v[34:35], v[26:27], v[26:27]
    v_pk_fma_f32 v[28:29], v[28:29], v[242:243], v[240:241]
    v_pk_fma_f32 v[30:31], v[30:31], v[242:243], v[240:241]
    v_pk_fma_f32 v[32:33], v[32:33], v[242:243], v[240:241]
    v_pk_fma_f32 v[34:35], v[34:35], v[242:243], v[240:241]
    v_pk_mul_f32 v[28:29], v[28:29], v[20:21]
    v_pk_mul_f32 v[30:31], v[30:31], v[22:23]
    v_pk_mul_f32 v[32:33], v[32:33], v[24:25]
    v_pk_mul_f32 v[34:35], v[34:35], v[26:27]
    v_exp_f32 v28, v28
    v_exp_f32 v29, v29
    v_exp_f32 v30, v30
    v_exp_f32 v31, v31
    v_exp_f32 v32, v32
    v_exp_f32 v33, v33
    v_exp_f32 v34, v34
    v_exp_f32 v35, v35
    v_pk_add_f32 v[28:29], v[28:29], v[244:245]
    v_pk_add_f32 v[30:31], v[30:31], v[244:245]
    v_pk_add_f32 v[32:33], v[32:33], v[244:245]
    v_pk_add_f32 v[34:35], v[34:35], v[244:245]
    v_rcp_f32 v28, v28
    v_rcp_f32 v29, v29
    v_rcp_f32 v30, v30
    v_rcp_f32 v31, v31
    v_rcp_f32 v32, v32
    v_rcp_f32 v33, v33
    v_rcp_f32 v34, v34
    v_rcp_f32 v35, v35
    v_pk_mul_f32 v[20:21], v[28:29], v[20:21]
    v_pk_mul_f32 v[22:23], v[30:31], v[22:23]
    v_pk_mul_f32 v[24:25], v[32:33], v[24:25]
    v_pk_mul_f32 v[26:27], v[34:35], v[26:27]
    v_cvt_pk_bf16_f32 v36, v20, v21
    v_cvt_pk_bf16_f32 v37, v22, v23
    v_cvt_pk_bf16_f32 v38, v24, v25
    v_cvt_pk_bf16_f32 v39, v26, v27
    buffer_store_dwordx4 v[36:39], v251, s[4:7], s53 offen offset:1024 sc1
    v_accvgpr_read_b32 v40, a208
    v_accvgpr_read_b32 v41, a209
    v_accvgpr_read_b32 v42, a210
    v_accvgpr_read_b32 v43, a211
    v_accvgpr_read_b32 v44, a212
    v_accvgpr_read_b32 v45, a213
    v_accvgpr_read_b32 v46, a214
    v_accvgpr_read_b32 v47, a215
    v_pk_mul_f32 v[48:49], v[40:41], v[40:41]
    v_pk_mul_f32 v[50:51], v[42:43], v[42:43]
    v_pk_mul_f32 v[52:53], v[44:45], v[44:45]
    v_pk_mul_f32 v[54:55], v[46:47], v[46:47]
    v_pk_fma_f32 v[48:49], v[48:49], v[242:243], v[240:241]
    v_pk_fma_f32 v[50:51], v[50:51], v[242:243], v[240:241]
    v_pk_fma_f32 v[52:53], v[52:53], v[242:243], v[240:241]
    v_pk_fma_f32 v[54:55], v[54:55], v[242:243], v[240:241]
    v_pk_mul_f32 v[48:49], v[48:49], v[40:41]
    v_pk_mul_f32 v[50:51], v[50:51], v[42:43]
    v_pk_mul_f32 v[52:53], v[52:53], v[44:45]
    v_pk_mul_f32 v[54:55], v[54:55], v[46:47]
    v_exp_f32 v48, v48
    v_exp_f32 v49, v49
    v_exp_f32 v50, v50
    v_exp_f32 v51, v51
    v_exp_f32 v52, v52
    v_exp_f32 v53, v53
    v_exp_f32 v54, v54
    v_exp_f32 v55, v55
    v_pk_add_f32 v[48:49], v[48:49], v[244:245]
    v_pk_add_f32 v[50:51], v[50:51], v[244:245]
    v_pk_add_f32 v[52:53], v[52:53], v[244:245]
    v_pk_add_f32 v[54:55], v[54:55], v[244:245]
    v_rcp_f32 v48, v48
    v_rcp_f32 v49, v49
    v_rcp_f32 v50, v50
    v_rcp_f32 v51, v51
    v_rcp_f32 v52, v52
    v_rcp_f32 v53, v53
    v_rcp_f32 v54, v54
    v_rcp_f32 v55, v55
    v_pk_mul_f32 v[40:41], v[48:49], v[40:41]
    v_pk_mul_f32 v[42:43], v[50:51], v[42:43]
    v_pk_mul_f32 v[44:45], v[52:53], v[44:45]
    v_pk_mul_f32 v[46:47], v[54:55], v[46:47]
    v_cvt_pk_bf16_f32 v56, v40, v41
    v_cvt_pk_bf16_f32 v57, v42, v43
    v_cvt_pk_bf16_f32 v58, v44, v45
    v_cvt_pk_bf16_f32 v59, v46, v47
    buffer_store_dwordx4 v[56:59], v251, s[4:7], s53 offen offset:2048 sc1
    v_accvgpr_read_b32 v0, a216
    v_accvgpr_read_b32 v1, a217
    v_accvgpr_read_b32 v2, a218
    v_accvgpr_read_b32 v3, a219
    v_accvgpr_read_b32 v4, a220
    v_accvgpr_read_b32 v5, a221
    v_accvgpr_read_b32 v6, a222
    v_accvgpr_read_b32 v7, a223
    v_pk_mul_f32 v[8:9], v[0:1], v[0:1]
    v_pk_mul_f32 v[10:11], v[2:3], v[2:3]
    v_pk_mul_f32 v[12:13], v[4:5], v[4:5]
    v_pk_mul_f32 v[14:15], v[6:7], v[6:7]
    v_pk_fma_f32 v[8:9], v[8:9], v[242:243], v[240:241]
    v_pk_fma_f32 v[10:11], v[10:11], v[242:243], v[240:241]
    v_pk_fma_f32 v[12:13], v[12:13], v[242:243], v[240:241]
    v_pk_fma_f32 v[14:15], v[14:15], v[242:243], v[240:241]
    v_pk_mul_f32 v[8:9], v[8:9], v[0:1]
    v_pk_mul_f32 v[10:11], v[10:11], v[2:3]
    v_pk_mul_f32 v[12:13], v[12:13], v[4:5]
    v_pk_mul_f32 v[14:15], v[14:15], v[6:7]
    v_exp_f32 v8, v8
    v_exp_f32 v9, v9
    v_exp_f32 v10, v10
    v_exp_f32 v11, v11
    v_exp_f32 v12, v12
    v_exp_f32 v13, v13
    v_exp_f32 v14, v14
    v_exp_f32 v15, v15
    v_pk_add_f32 v[8:9], v[8:9], v[244:245]
    v_pk_add_f32 v[10:11], v[10:11], v[244:245]
    v_pk_add_f32 v[12:13], v[12:13], v[244:245]
    v_pk_add_f32 v[14:15], v[14:15], v[244:245]
    v_rcp_f32 v8, v8
    v_rcp_f32 v9, v9
    v_rcp_f32 v10, v10
    v_rcp_f32 v11, v11
    v_rcp_f32 v12, v12
    v_rcp_f32 v13, v13
    v_rcp_f32 v14, v14
    v_rcp_f32 v15, v15
    v_pk_mul_f32 v[0:1], v[8:9], v[0:1]
    v_pk_mul_f32 v[2:3], v[10:11], v[2:3]
    v_pk_mul_f32 v[4:5], v[12:13], v[4:5]
    v_pk_mul_f32 v[6:7], v[14:15], v[6:7]
    v_cvt_pk_bf16_f32 v16, v0, v1
    v_cvt_pk_bf16_f32 v17, v2, v3
    v_cvt_pk_bf16_f32 v18, v4, v5
    v_cvt_pk_bf16_f32 v19, v6, v7
    buffer_store_dwordx4 v[16:19], v251, s[4:7], s53 offen offset:3072 sc1
    s_add_u32 s53, s53, s22
    v_accvgpr_read_b32 v20, a224
    v_accvgpr_read_b32 v21, a225
    v_accvgpr_read_b32 v22, a226
    v_accvgpr_read_b32 v23, a227
    v_accvgpr_read_b32 v24, a228
    v_accvgpr_read_b32 v25, a229
    v_accvgpr_read_b32 v26, a230
    v_accvgpr_read_b32 v27, a231
    v_pk_mul_f32 v[28:29], v[20:21], v[20:21]
    v_pk_mul_f32 v[30:31], v[22:23], v[22:23]
    v_pk_mul_f32 v[32:33], v[24:25], v[24:25]
    v_pk_mul_f32 v[34:35], v[26:27], v[26:27]
    v_pk_fma_f32 v[28:29], v[28:29], v[242:243], v[240:241]
    v_pk_fma_f32 v[30:31], v[30:31], v[242:243], v[240:241]
    v_pk_fma_f32 v[32:33], v[32:33], v[242:243], v[240:241]
    v_pk_fma_f32 v[34:35], v[34:35], v[242:243], v[240:241]
    v_pk_mul_f32 v[28:29], v[28:29], v[20:21]
    v_pk_mul_f32 v[30:31], v[30:31], v[22:23]
    v_pk_mul_f32 v[32:33], v[32:33], v[24:25]
    v_pk_mul_f32 v[34:35], v[34:35], v[26:27]
    v_exp_f32 v28, v28
    v_exp_f32 v29, v29
    v_exp_f32 v30, v30
    v_exp_f32 v31, v31
    v_exp_f32 v32, v32
    v_exp_f32 v33, v33
    v_exp_f32 v34, v34
    v_exp_f32 v35, v35
    v_pk_add_f32 v[28:29], v[28:29], v[244:245]
    v_pk_add_f32 v[30:31], v[30:31], v[244:245]
    v_pk_add_f32 v[32:33], v[32:33], v[244:245]
    v_pk_add_f32 v[34:35], v[34:35], v[244:245]
    v_rcp_f32 v28, v28
    v_rcp_f32 v29, v29
    v_rcp_f32 v30, v30
    v_rcp_f32 v31, v31
    v_rcp_f32 v32, v32
    v_rcp_f32 v33, v33
    v_rcp_f32 v34, v34
    v_rcp_f32 v35, v35
    v_pk_mul_f32 v[20:21], v[28:29], v[20:21]
    v_pk_mul_f32 v[22:23], v[30:31], v[22:23]
    v_pk_mul_f32 v[24:25], v[32:33], v[24:25]
    v_pk_mul_f32 v[26:27], v[34:35], v[26:27]
    v_cvt_pk_bf16_f32 v36, v20, v21
    v_cvt_pk_bf16_f32 v37, v22, v23
    v_cvt_pk_bf16_f32 v38, v24, v25
    v_cvt_pk_bf16_f32 v39, v26, v27
    buffer_store_dwordx4 v[36:39], v251, s[4:7], s53 offen offset:0 sc1
    v_accvgpr_read_b32 v40, a232
    v_accvgpr_read_b32 v41, a233
    v_accvgpr_read_b32 v42, a234
    v_accvgpr_read_b32 v43, a235
    v_accvgpr_read_b32 v44, a236
    v_accvgpr_read_b32 v45, a237
    v_accvgpr_read_b32 v46, a238
    v_accvgpr_read_b32 v47, a239
    v_pk_mul_f32 v[48:49], v[40:41], v[40:41]
    v_pk_mul_f32 v[50:51], v[42:43], v[42:43]
    v_pk_mul_f32 v[52:53], v[44:45], v[44:45]
    v_pk_mul_f32 v[54:55], v[46:47], v[46:47]
    v_pk_fma_f32 v[48:49], v[48:49], v[242:243], v[240:241]
    v_pk_fma_f32 v[50:51], v[50:51], v[242:243], v[240:241]
    v_pk_fma_f32 v[52:53], v[52:53], v[242:243], v[240:241]
    v_pk_fma_f32 v[54:55], v[54:55], v[242:243], v[240:241]
    v_pk_mul_f32 v[48:49], v[48:49], v[40:41]
    v_pk_mul_f32 v[50:51], v[50:51], v[42:43]
    v_pk_mul_f32 v[52:53], v[52:53], v[44:45]
    v_pk_mul_f32 v[54:55], v[54:55], v[46:47]
    v_exp_f32 v48, v48
    v_exp_f32 v49, v49
    v_exp_f32 v50, v50
    v_exp_f32 v51, v51
    v_exp_f32 v52, v52
    v_exp_f32 v53, v53
    v_exp_f32 v54, v54
    v_exp_f32 v55, v55
    v_pk_add_f32 v[48:49], v[48:49], v[244:245]
    v_pk_add_f32 v[50:51], v[50:51], v[244:245]
    v_pk_add_f32 v[52:53], v[52:53], v[244:245]
    v_pk_add_f32 v[54:55], v[54:55], v[244:245]
    v_rcp_f32 v48, v48
    v_rcp_f32 v49, v49
    v_rcp_f32 v50, v50
    v_rcp_f32 v51, v51
    v_rcp_f32 v52, v52
    v_rcp_f32 v53, v53
    v_rcp_f32 v54, v54
    v_rcp_f32 v55, v55
    v_pk_mul_f32 v[40:41], v[48:49], v[40:41]
    v_pk_mul_f32 v[42:43], v[50:51], v[42:43]
    v_pk_mul_f32 v[44:45], v[52:53], v[44:45]
    v_pk_mul_f32 v[46:47], v[54:55], v[46:47]
    v_cvt_pk_bf16_f32 v56, v40, v41
    v_cvt_pk_bf16_f32 v57, v42, v43
    v_cvt_pk_bf16_f32 v58, v44, v45
    v_cvt_pk_bf16_f32 v59, v46, v47
    buffer_store_dwordx4 v[56:59], v251, s[4:7], s53 offen offset:1024 sc1
    v_accvgpr_read_b32 v0, a240
    v_accvgpr_read_b32 v1, a241
    v_accvgpr_read_b32 v2, a242
    v_accvgpr_read_b32 v3, a243
    v_accvgpr_read_b32 v4, a244
    v_accvgpr_read_b32 v5, a245
    v_accvgpr_read_b32 v6, a246
    v_accvgpr_read_b32 v7, a247
    v_pk_mul_f32 v[8:9], v[0:1], v[0:1]
    v_pk_mul_f32 v[10:11], v[2:3], v[2:3]
    v_pk_mul_f32 v[12:13], v[4:5], v[4:5]
    v_pk_mul_f32 v[14:15], v[6:7], v[6:7]
    v_pk_fma_f32 v[8:9], v[8:9], v[242:243], v[240:241]
    v_pk_fma_f32 v[10:11], v[10:11], v[242:243], v[240:241]
    v_pk_fma_f32 v[12:13], v[12:13], v[242:243], v[240:241]
    v_pk_fma_f32 v[14:15], v[14:15], v[242:243], v[240:241]
    v_pk_mul_f32 v[8:9], v[8:9], v[0:1]
    v_pk_mul_f32 v[10:11], v[10:11], v[2:3]
    v_pk_mul_f32 v[12:13], v[12:13], v[4:5]
    v_pk_mul_f32 v[14:15], v[14:15], v[6:7]
    v_exp_f32 v8, v8
    v_exp_f32 v9, v9
    v_exp_f32 v10, v10
    v_exp_f32 v11, v11
    v_exp_f32 v12, v12
    v_exp_f32 v13, v13
    v_exp_f32 v14, v14
    v_exp_f32 v15, v15
    v_pk_add_f32 v[8:9], v[8:9], v[244:245]
    v_pk_add_f32 v[10:11], v[10:11], v[244:245]
    v_pk_add_f32 v[12:13], v[12:13], v[244:245]
    v_pk_add_f32 v[14:15], v[14:15], v[244:245]
    v_rcp_f32 v8, v8
    v_rcp_f32 v9, v9
    v_rcp_f32 v10, v10
    v_rcp_f32 v11, v11
    v_rcp_f32 v12, v12
    v_rcp_f32 v13, v13
    v_rcp_f32 v14, v14
    v_rcp_f32 v15, v15
    v_pk_mul_f32 v[0:1], v[8:9], v[0:1]
    v_pk_mul_f32 v[2:3], v[10:11], v[2:3]
    v_pk_mul_f32 v[4:5], v[12:13], v[4:5]
    v_pk_mul_f32 v[6:7], v[14:15], v[6:7]
    v_cvt_pk_bf16_f32 v16, v0, v1
    v_cvt_pk_bf16_f32 v17, v2, v3
    v_cvt_pk_bf16_f32 v18, v4, v5
    v_cvt_pk_bf16_f32 v19, v6, v7
    buffer_store_dwordx4 v[16:19], v251, s[4:7], s53 offen offset:2048 sc1
    v_accvgpr_read_b32 v20, a248
    v_accvgpr_read_b32 v21, a249
    v_accvgpr_read_b32 v22, a250
    v_accvgpr_read_b32 v23, a251
    v_accvgpr_read_b32 v24, a252
    v_accvgpr_read_b32 v25, a253
    v_accvgpr_read_b32 v26, a254
    v_accvgpr_read_b32 v27, a255
    v_pk_mul_f32 v[28:29], v[20:21], v[20:21]
    v_pk_mul_f32 v[30:31], v[22:23], v[22:23]
    v_pk_mul_f32 v[32:33], v[24:25], v[24:25]
    v_pk_mul_f32 v[34:35], v[26:27], v[26:27]
    v_pk_fma_f32 v[28:29], v[28:29], v[242:243], v[240:241]
    v_pk_fma_f32 v[30:31], v[30:31], v[242:243], v[240:241]
    v_pk_fma_f32 v[32:33], v[32:33], v[242:243], v[240:241]
    v_pk_fma_f32 v[34:35], v[34:35], v[242:243], v[240:241]
    v_pk_mul_f32 v[28:29], v[28:29], v[20:21]
    v_pk_mul_f32 v[30:31], v[30:31], v[22:23]
    v_pk_mul_f32 v[32:33], v[32:33], v[24:25]
    v_pk_mul_f32 v[34:35], v[34:35], v[26:27]
    v_exp_f32 v28, v28
    v_exp_f32 v29, v29
    v_exp_f32 v30, v30
    v_exp_f32 v31, v31
    v_exp_f32 v32, v32
    v_exp_f32 v33, v33
    v_exp_f32 v34, v34
    v_exp_f32 v35, v35
    v_pk_add_f32 v[28:29], v[28:29], v[244:245]
    v_pk_add_f32 v[30:31], v[30:31], v[244:245]
    v_pk_add_f32 v[32:33], v[32:33], v[244:245]
    v_pk_add_f32 v[34:35], v[34:35], v[244:245]
    v_rcp_f32 v28, v28
    v_rcp_f32 v29, v29
    v_rcp_f32 v30, v30
    v_rcp_f32 v31, v31
    v_rcp_f32 v32, v32
    v_rcp_f32 v33, v33
    v_rcp_f32 v34, v34
    v_rcp_f32 v35, v35
    v_pk_mul_f32 v[20:21], v[28:29], v[20:21]
    v_pk_mul_f32 v[22:23], v[30:31], v[22:23]
    v_pk_mul_f32 v[24:25], v[32:33], v[24:25]
    v_pk_mul_f32 v[26:27], v[34:35], v[26:27]
    v_cvt_pk_bf16_f32 v36, v20, v21
    v_cvt_pk_bf16_f32 v37, v22, v23
    v_cvt_pk_bf16_f32 v38, v24, v25
    v_cvt_pk_bf16_f32 v39, v26, v27
    buffer_store_dwordx4 v[36:39], v251, s[4:7], s53 offen offset:3072 sc1
    s_branch main_kernel_w_done
main_kernel_w_c2_gov:
    v_lshrrev_b32 v0, 4, v250
    v_bfe_u32 v1, v250, 2, 2
    v_lshl_add_u32 v4, v0, 2, v1
    v_and_b32 v5, 7, v4
    v_mul_u32_u24 v4, 512, v4
    v_and_b32 v6, 3, v250
    v_lshl_add_u32 v4, v6, 3, v4
    s_mul_i32 s32, s37, 8
    v_xor_b32 v5, s32, v5
    v_lshl_add_u32 v128, v5, 5, v4
    v_xor_b32 v129, 32, v128
    v_xor_b32 v130, 64, v128
    v_xor_b32 v131, 96, v128
    v_xor_b32 v132, 128, v128
    v_xor_b32 v133, 160, v128
    v_xor_b32 v134, 192, v128
    v_xor_b32 v135, 224, v128
    s_mul_i32 s32, s38, 8192
    s_add_u32 s32, s32, 65536
    v_add_u32 v136, s32, v251
    v_lshrrev_b32 v2, 5, v250
    v_and_b32 v3, 31, v250
    s_mul_i32 s32, s14, 8
    v_add_u32 v4, s32, v2
    v_add_u32 v5, 0, v4
    v_and_b32 v6, 7, v5
    v_lshlrev_b32 v6, 1, v6
    v_xor_b32 v6, v6, v3
    v_mul_lo_u32 v5, v5, s30
    v_lshl_add_u32 v5, v6, 4, v5
    v_subrev_u32 v137, 0, v5
    v_add_u32 v5, 2, v4
    v_and_b32 v6, 7, v5
    v_lshlrev_b32 v6, 1, v6
    v_xor_b32 v6, v6, v3
    v_mul_lo_u32 v5, v5, s30
    v_lshl_add_u32 v5, v6, 4, v5
    v_subrev_u32 v138, 1024, v5
    v_add_u32 v5, 4, v4
    v_and_b32 v6, 7, v5
    v_lshlrev_b32 v6, 1, v6
    v_xor_b32 v6, v6, v3
    v_mul_lo_u32 v5, v5, s30
    v_lshl_add_u32 v5, v6, 4, v5
    v_subrev_u32 v139, 2048, v5
    v_add_u32 v5, 6, v4
    v_and_b32 v6, 7, v5
    v_lshlrev_b32 v6, 1, v6
    v_xor_b32 v6, v6, v3
    v_mul_lo_u32 v5, v5, s30
    v_lshl_add_u32 v5, v6, 4, v5
    v_subrev_u32 v140, 3072, v5
    s_mul_i32 s32, s14, 4
    s_mul_i32 s32, s32, s31
    v_add_u32 v141, s32, v251
    s_add_u32 s32, s32, s31
    s_sub_u32 s32, s32, 1024
    v_add_u32 v142, s32, v251
    s_add_u32 s32, s32, s31
    s_sub_u32 s32, s32, 1024
    v_add_u32 v143, s32, v251
    s_add_u32 s32, s32, s31
    s_sub_u32 s32, s32, 1024
    v_add_u32 v144, s32, v251
    s_mul_i32 s19, s14, 4096
    s_mul_i32 s20, s14, 4096
    s_add_u32 s20, s20, 65536
    s_mul_i32 s17, s30, 32
    s_mov_b32 s15, 0
    s_add_u32 m0, s20, 0
    s_nop 0
    buffer_load_dwordx4 v141, s[4:7], s16 offen offset:0 sc1 lds
    buffer_load_dwordx4 v142, s[4:7], s16 offen offset:1024 sc1 lds
    buffer_load_dwordx4 v143, s[4:7], s16 offen offset:2048 sc1 lds
    buffer_load_dwordx4 v144, s[4:7], s16 offen offset:3072 sc1 lds
    s_add_u32 s16, s16, 1024
    s_add_u32 m0, s19, 0
    s_nop 0
    buffer_load_dwordx4 v137, s[8:11], s15 offen offset:0 lds
    buffer_load_dwordx4 v138, s[8:11], s15 offen offset:1024 lds
    buffer_load_dwordx4 v139, s[8:11], s15 offen offset:2048 lds
    buffer_load_dwordx4 v140, s[8:11], s15 offen offset:3072 lds
    s_add_u32 s15, s15, s17
    s_add_u32 m0, s20, 16384
    s_nop 0
    buffer_load_dwordx4 v141, s[4:7], s16 offen offset:0 sc1 lds
    buffer_load_dwordx4 v142, s[4:7], s16 offen offset:1024 sc1 lds
    buffer_load_dwordx4 v143, s[4:7], s16 offen offset:2048 sc1 lds
    buffer_load_dwordx4 v144, s[4:7], s16 offen offset:3072 sc1 lds
    s_add_u32 s16, s16, 1024
    s_add_u32 m0, s19, 16384
    s_nop 0
    buffer_load_dwordx4 v137, s[8:11], s15 offen offset:0 lds
    buffer_load_dwordx4 v138, s[8:11], s15 offen offset:1024 lds
    buffer_load_dwordx4 v139, s[8:11], s15 offen offset:2048 lds
    buffer_load_dwordx4 v140, s[8:11], s15 offen offset:3072 lds
    s_add_u32 s15, s15, s17
    s_add_u32 m0, s20, 32768
    s_nop 0
    buffer_load_dwordx4 v141, s[4:7], s16 offen offset:0 sc1 lds
    buffer_load_dwordx4 v142, s[4:7], s16 offen offset:1024 sc1 lds
    buffer_load_dwordx4 v143, s[4:7], s16 offen offset:2048 sc1 lds
    buffer_load_dwordx4 v144, s[4:7], s16 offen offset:3072 sc1 lds
    s_add_u32 s16, s16, 1024
    s_add_u32 m0, s19, 32768
    s_nop 0
    buffer_load_dwordx4 v137, s[8:11], s15 offen offset:0 lds
    buffer_load_dwordx4 v138, s[8:11], s15 offen offset:1024 lds
    buffer_load_dwordx4 v139, s[8:11], s15 offen offset:2048 lds
    buffer_load_dwordx4 v140, s[8:11], s15 offen offset:3072 lds
    s_add_u32 s15, s15, s17
    s_add_u32 m0, s20, 49152
    s_nop 0
    buffer_load_dwordx4 v141, s[4:7], s16 offen offset:0 sc1 lds
    buffer_load_dwordx4 v142, s[4:7], s16 offen offset:1024 sc1 lds
    buffer_load_dwordx4 v143, s[4:7], s16 offen offset:2048 sc1 lds
    buffer_load_dwordx4 v144, s[4:7], s16 offen offset:3072 sc1 lds
    s_add_u32 s16, s16, 1024
    s_add_u32 m0, s19, 49152
    s_nop 0
    buffer_load_dwordx4 v137, s[8:11], s15 offen offset:0 lds
    buffer_load_dwordx4 v138, s[8:11], s15 offen offset:1024 lds
    buffer_load_dwordx4 v139, s[8:11], s15 offen offset:2048 lds
    buffer_load_dwordx4 v140, s[8:11], s15 offen offset:3072 lds
    s_add_u32 s15, s15, s17
    v_accvgpr_write_b32 a0, 0
    v_accvgpr_write_b32 a1, 0
    v_accvgpr_write_b32 a2, 0
    v_accvgpr_write_b32 a3, 0
    v_accvgpr_write_b32 a4, 0
    v_accvgpr_write_b32 a5, 0
    v_accvgpr_write_b32 a6, 0
    v_accvgpr_write_b32 a7, 0
    v_accvgpr_write_b32 a8, 0
    v_accvgpr_write_b32 a9, 0
    v_accvgpr_write_b32 a10, 0
    v_accvgpr_write_b32 a11, 0
    v_accvgpr_write_b32 a12, 0
    v_accvgpr_write_b32 a13, 0
    v_accvgpr_write_b32 a14, 0
    v_accvgpr_write_b32 a15, 0
    v_accvgpr_write_b32 a16, 0
    v_accvgpr_write_b32 a17, 0
    v_accvgpr_write_b32 a18, 0
    v_accvgpr_write_b32 a19, 0
    v_accvgpr_write_b32 a20, 0
    v_accvgpr_write_b32 a21, 0
    v_accvgpr_write_b32 a22, 0
    v_accvgpr_write_b32 a23, 0
    v_accvgpr_write_b32 a24, 0
    v_accvgpr_write_b32 a25, 0
    v_accvgpr_write_b32 a26, 0
    v_accvgpr_write_b32 a27, 0
    v_accvgpr_write_b32 a28, 0
    v_accvgpr_write_b32 a29, 0
    v_accvgpr_write_b32 a30, 0
    v_accvgpr_write_b32 a31, 0
    v_accvgpr_write_b32 a32, 0
    v_accvgpr_write_b32 a33, 0
    v_accvgpr_write_b32 a34, 0
    v_accvgpr_write_b32 a35, 0
    v_accvgpr_write_b32 a36, 0
    v_accvgpr_write_b32 a37, 0
    v_accvgpr_write_b32 a38, 0
    v_accvgpr_write_b32 a39, 0
    v_accvgpr_write_b32 a40, 0
    v_accvgpr_write_b32 a41, 0
    v_accvgpr_write_b32 a42, 0
    v_accvgpr_write_b32 a43, 0
    v_accvgpr_write_b32 a44, 0
    v_accvgpr_write_b32 a45, 0
    v_accvgpr_write_b32 a46, 0
    v_accvgpr_write_b32 a47, 0
    v_accvgpr_write_b32 a48, 0
    v_accvgpr_write_b32 a49, 0
    v_accvgpr_write_b32 a50, 0
    v_accvgpr_write_b32 a51, 0
    v_accvgpr_write_b32 a52, 0
    v_accvgpr_write_b32 a53, 0
    v_accvgpr_write_b32 a54, 0
    v_accvgpr_write_b32 a55, 0
    v_accvgpr_write_b32 a56, 0
    v_accvgpr_write_b32 a57, 0
    v_accvgpr_write_b32 a58, 0
    v_accvgpr_write_b32 a59, 0
    v_accvgpr_write_b32 a60, 0
    v_accvgpr_write_b32 a61, 0
    v_accvgpr_write_b32 a62, 0
    v_accvgpr_write_b32 a63, 0
    v_accvgpr_write_b32 a64, 0
    v_accvgpr_write_b32 a65, 0
    v_accvgpr_write_b32 a66, 0
    v_accvgpr_write_b32 a67, 0
    v_accvgpr_write_b32 a68, 0
    v_accvgpr_write_b32 a69, 0
    v_accvgpr_write_b32 a70, 0
    v_accvgpr_write_b32 a71, 0
    v_accvgpr_write_b32 a72, 0
    v_accvgpr_write_b32 a73, 0
    v_accvgpr_write_b32 a74, 0
    v_accvgpr_write_b32 a75, 0
    v_accvgpr_write_b32 a76, 0
    v_accvgpr_write_b32 a77, 0
    v_accvgpr_write_b32 a78, 0
    v_accvgpr_write_b32 a79, 0
    v_accvgpr_write_b32 a80, 0
    v_accvgpr_write_b32 a81, 0
    v_accvgpr_write_b32 a82, 0
    v_accvgpr_write_b32 a83, 0
    v_accvgpr_write_b32 a84, 0
    v_accvgpr_write_b32 a85, 0
    v_accvgpr_write_b32 a86, 0
    v_accvgpr_write_b32 a87, 0
    v_accvgpr_write_b32 a88, 0
    v_accvgpr_write_b32 a89, 0
    v_accvgpr_write_b32 a90, 0
    v_accvgpr_write_b32 a91, 0
    v_accvgpr_write_b32 a92, 0
    v_accvgpr_write_b32 a93, 0
    v_accvgpr_write_b32 a94, 0
    v_accvgpr_write_b32 a95, 0
    v_accvgpr_write_b32 a96, 0
    v_accvgpr_write_b32 a97, 0
    v_accvgpr_write_b32 a98, 0
    v_accvgpr_write_b32 a99, 0
    v_accvgpr_write_b32 a100, 0
    v_accvgpr_write_b32 a101, 0
    v_accvgpr_write_b32 a102, 0
    v_accvgpr_write_b32 a103, 0
    v_accvgpr_write_b32 a104, 0
    v_accvgpr_write_b32 a105, 0
    v_accvgpr_write_b32 a106, 0
    v_accvgpr_write_b32 a107, 0
    v_accvgpr_write_b32 a108, 0
    v_accvgpr_write_b32 a109, 0
    v_accvgpr_write_b32 a110, 0
    v_accvgpr_write_b32 a111, 0
    v_accvgpr_write_b32 a112, 0
    v_accvgpr_write_b32 a113, 0
    v_accvgpr_write_b32 a114, 0
    v_accvgpr_write_b32 a115, 0
    v_accvgpr_write_b32 a116, 0
    v_accvgpr_write_b32 a117, 0
    v_accvgpr_write_b32 a118, 0
    v_accvgpr_write_b32 a119, 0
    v_accvgpr_write_b32 a120, 0
    v_accvgpr_write_b32 a121, 0
    v_accvgpr_write_b32 a122, 0
    v_accvgpr_write_b32 a123, 0
    v_accvgpr_write_b32 a124, 0
    v_accvgpr_write_b32 a125, 0
    v_accvgpr_write_b32 a126, 0
    v_accvgpr_write_b32 a127, 0
    v_accvgpr_write_b32 a128, 0
    v_accvgpr_write_b32 a129, 0
    v_accvgpr_write_b32 a130, 0
    v_accvgpr_write_b32 a131, 0
    v_accvgpr_write_b32 a132, 0
    v_accvgpr_write_b32 a133, 0
    v_accvgpr_write_b32 a134, 0
    v_accvgpr_write_b32 a135, 0
    v_accvgpr_write_b32 a136, 0
    v_accvgpr_write_b32 a137, 0
    v_accvgpr_write_b32 a138, 0
    v_accvgpr_write_b32 a139, 0
    v_accvgpr_write_b32 a140, 0
    v_accvgpr_write_b32 a141, 0
    v_accvgpr_write_b32 a142, 0
    v_accvgpr_write_b32 a143, 0
    v_accvgpr_write_b32 a144, 0
    v_accvgpr_write_b32 a145, 0
    v_accvgpr_write_b32 a146, 0
    v_accvgpr_write_b32 a147, 0
    v_accvgpr_write_b32 a148, 0
    v_accvgpr_write_b32 a149, 0
    v_accvgpr_write_b32 a150, 0
    v_accvgpr_write_b32 a151, 0
    v_accvgpr_write_b32 a152, 0
    v_accvgpr_write_b32 a153, 0
    v_accvgpr_write_b32 a154, 0
    v_accvgpr_write_b32 a155, 0
    v_accvgpr_write_b32 a156, 0
    v_accvgpr_write_b32 a157, 0
    v_accvgpr_write_b32 a158, 0
    v_accvgpr_write_b32 a159, 0
    v_accvgpr_write_b32 a160, 0
    v_accvgpr_write_b32 a161, 0
    v_accvgpr_write_b32 a162, 0
    v_accvgpr_write_b32 a163, 0
    v_accvgpr_write_b32 a164, 0
    v_accvgpr_write_b32 a165, 0
    v_accvgpr_write_b32 a166, 0
    v_accvgpr_write_b32 a167, 0
    v_accvgpr_write_b32 a168, 0
    v_accvgpr_write_b32 a169, 0
    v_accvgpr_write_b32 a170, 0
    v_accvgpr_write_b32 a171, 0
    v_accvgpr_write_b32 a172, 0
    v_accvgpr_write_b32 a173, 0
    v_accvgpr_write_b32 a174, 0
    v_accvgpr_write_b32 a175, 0
    v_accvgpr_write_b32 a176, 0
    v_accvgpr_write_b32 a177, 0
    v_accvgpr_write_b32 a178, 0
    v_accvgpr_write_b32 a179, 0
    v_accvgpr_write_b32 a180, 0
    v_accvgpr_write_b32 a181, 0
    v_accvgpr_write_b32 a182, 0
    v_accvgpr_write_b32 a183, 0
    v_accvgpr_write_b32 a184, 0
    v_accvgpr_write_b32 a185, 0
    v_accvgpr_write_b32 a186, 0
    v_accvgpr_write_b32 a187, 0
    v_accvgpr_write_b32 a188, 0
    v_accvgpr_write_b32 a189, 0
    v_accvgpr_write_b32 a190, 0
    v_accvgpr_write_b32 a191, 0
    v_accvgpr_write_b32 a192, 0
    v_accvgpr_write_b32 a193, 0
    v_accvgpr_write_b32 a194, 0
    v_accvgpr_write_b32 a195, 0
    v_accvgpr_write_b32 a196, 0
    v_accvgpr_write_b32 a197, 0
    v_accvgpr_write_b32 a198, 0
    v_accvgpr_write_b32 a199, 0
    v_accvgpr_write_b32 a200, 0
    v_accvgpr_write_b32 a201, 0
    v_accvgpr_write_b32 a202, 0
    v_accvgpr_write_b32 a203, 0
    v_accvgpr_write_b32 a204, 0
    v_accvgpr_write_b32 a205, 0
    v_accvgpr_write_b32 a206, 0
    v_accvgpr_write_b32 a207, 0
    v_accvgpr_write_b32 a208, 0
    v_accvgpr_write_b32 a209, 0
    v_accvgpr_write_b32 a210, 0
    v_accvgpr_write_b32 a211, 0
    v_accvgpr_write_b32 a212, 0
    v_accvgpr_write_b32 a213, 0
    v_accvgpr_write_b32 a214, 0
    v_accvgpr_write_b32 a215, 0
    v_accvgpr_write_b32 a216, 0
    v_accvgpr_write_b32 a217, 0
    v_accvgpr_write_b32 a218, 0
    v_accvgpr_write_b32 a219, 0
    v_accvgpr_write_b32 a220, 0
    v_accvgpr_write_b32 a221, 0
    v_accvgpr_write_b32 a222, 0
    v_accvgpr_write_b32 a223, 0
    v_accvgpr_write_b32 a224, 0
    v_accvgpr_write_b32 a225, 0
    v_accvgpr_write_b32 a226, 0
    v_accvgpr_write_b32 a227, 0
    v_accvgpr_write_b32 a228, 0
    v_accvgpr_write_b32 a229, 0
    v_accvgpr_write_b32 a230, 0
    v_accvgpr_write_b32 a231, 0
    v_accvgpr_write_b32 a232, 0
    v_accvgpr_write_b32 a233, 0
    v_accvgpr_write_b32 a234, 0
    v_accvgpr_write_b32 a235, 0
    v_accvgpr_write_b32 a236, 0
    v_accvgpr_write_b32 a237, 0
    v_accvgpr_write_b32 a238, 0
    v_accvgpr_write_b32 a239, 0
    v_accvgpr_write_b32 a240, 0
    v_accvgpr_write_b32 a241, 0
    v_accvgpr_write_b32 a242, 0
    v_accvgpr_write_b32 a243, 0
    v_accvgpr_write_b32 a244, 0
    v_accvgpr_write_b32 a245, 0
    v_accvgpr_write_b32 a246, 0
    v_accvgpr_write_b32 a247, 0
    v_accvgpr_write_b32 a248, 0
    v_accvgpr_write_b32 a249, 0
    v_accvgpr_write_b32 a250, 0
    v_accvgpr_write_b32 a251, 0
    v_accvgpr_write_b32 a252, 0
    v_accvgpr_write_b32 a253, 0
    v_accvgpr_write_b32 a254, 0
    v_accvgpr_write_b32 a255, 0
    s_waitcnt vmcnt(24)
    s_barrier
    ds_read_b128 v[32:35], v136 offset:0
    ds_read_b64_tr_b16 v[0:1], v128 offset:0
    ds_read_b64_tr_b16 v[2:3], v128 offset:8192
    ds_read_b64_tr_b16 v[4:5], v129 offset:0
    ds_read_b64_tr_b16 v[6:7], v129 offset:8192
    ds_read_b64_tr_b16 v[8:9], v130 offset:0
    ds_read_b64_tr_b16 v[10:11], v130 offset:8192
    ds_read_b64_tr_b16 v[12:13], v131 offset:0
    ds_read_b64_tr_b16 v[14:15], v131 offset:8192
    ds_read_b64_tr_b16 v[16:17], v132 offset:0
    ds_read_b64_tr_b16 v[18:19], v132 offset:8192
    ds_read_b64_tr_b16 v[20:21], v133 offset:0
    ds_read_b64_tr_b16 v[22:23], v133 offset:8192
    ds_read_b64_tr_b16 v[24:25], v134 offset:0
    ds_read_b64_tr_b16 v[26:27], v134 offset:8192
    ds_read_b64_tr_b16 v[28:29], v135 offset:0
    ds_read_b64_tr_b16 v[30:31], v135 offset:8192
    ds_read_b128 v[36:39], v136 offset:1024
    ds_read_b128 v[40:43], v136 offset:2048
    ds_read_b128 v[44:47], v136 offset:3072
    ds_read_b128 v[48:51], v136 offset:4096
    ds_read_b128 v[52:55], v136 offset:5120
    ds_read_b128 v[56:59], v136 offset:6144
    ds_read_b128 v[60:63], v136 offset:7168
main_kernel_w_c2_v_loop:
    s_waitcnt lgkmcnt(0)
    v_mfma_f32_16x16x32_bf16 a[0:3], v[32:35], v[0:3], a[0:3]
    s_waitcnt vmcnt(16)
    s_barrier
    ds_read_b128 v[96:99], v136 offset:16384
    s_add_u32 m0, s20, 0
    s_nop 0
    v_mfma_f32_16x16x32_bf16 a[4:7], v[32:35], v[4:7], a[4:7]
    ds_read_b64_tr_b16 v[64:65], v128 offset:16384
    v_mfma_f32_16x16x32_bf16 a[8:11], v[32:35], v[8:11], a[8:11]
    ds_read_b64_tr_b16 v[66:67], v128 offset:24576
    v_mfma_f32_16x16x32_bf16 a[12:15], v[32:35], v[12:15], a[12:15]
    ds_read_b64_tr_b16 v[68:69], v129 offset:16384
    v_mfma_f32_16x16x32_bf16 a[16:19], v[32:35], v[16:19], a[16:19]
    ds_read_b64_tr_b16 v[70:71], v129 offset:24576
    v_mfma_f32_16x16x32_bf16 a[20:23], v[32:35], v[20:23], a[20:23]
    ds_read_b64_tr_b16 v[72:73], v130 offset:16384
    buffer_load_dwordx4 v141, s[4:7], s16 offen offset:0 sc1 lds
    v_mfma_f32_16x16x32_bf16 a[24:27], v[32:35], v[24:27], a[24:27]
    ds_read_b64_tr_b16 v[74:75], v130 offset:24576
    v_mfma_f32_16x16x32_bf16 a[28:31], v[32:35], v[28:31], a[28:31]
    ds_read_b64_tr_b16 v[76:77], v131 offset:16384
    v_mfma_f32_16x16x32_bf16 a[32:35], v[36:39], v[0:3], a[32:35]
    ds_read_b64_tr_b16 v[78:79], v131 offset:24576
    v_mfma_f32_16x16x32_bf16 a[36:39], v[36:39], v[4:7], a[36:39]
    ds_read_b64_tr_b16 v[80:81], v132 offset:16384
    v_mfma_f32_16x16x32_bf16 a[40:43], v[36:39], v[8:11], a[40:43]
    ds_read_b64_tr_b16 v[82:83], v132 offset:24576
    buffer_load_dwordx4 v142, s[4:7], s16 offen offset:1024 sc1 lds
    v_mfma_f32_16x16x32_bf16 a[44:47], v[36:39], v[12:15], a[44:47]
    ds_read_b64_tr_b16 v[84:85], v133 offset:16384
    v_mfma_f32_16x16x32_bf16 a[48:51], v[36:39], v[16:19], a[48:51]
    ds_read_b64_tr_b16 v[86:87], v133 offset:24576
    v_mfma_f32_16x16x32_bf16 a[52:55], v[36:39], v[20:23], a[52:55]
    ds_read_b64_tr_b16 v[88:89], v134 offset:16384
    v_mfma_f32_16x16x32_bf16 a[56:59], v[36:39], v[24:27], a[56:59]
    ds_read_b64_tr_b16 v[90:91], v134 offset:24576
    v_mfma_f32_16x16x32_bf16 a[60:63], v[36:39], v[28:31], a[60:63]
    ds_read_b64_tr_b16 v[92:93], v135 offset:16384
    buffer_load_dwordx4 v143, s[4:7], s16 offen offset:2048 sc1 lds
    v_mfma_f32_16x16x32_bf16 a[64:67], v[40:43], v[0:3], a[64:67]
    ds_read_b64_tr_b16 v[94:95], v135 offset:24576
    v_mfma_f32_16x16x32_bf16 a[68:71], v[40:43], v[4:7], a[68:71]
    ds_read_b128 v[100:103], v136 offset:17408
    v_mfma_f32_16x16x32_bf16 a[72:75], v[40:43], v[8:11], a[72:75]
    ds_read_b128 v[104:107], v136 offset:18432
    v_mfma_f32_16x16x32_bf16 a[76:79], v[40:43], v[12:15], a[76:79]
    ds_read_b128 v[108:111], v136 offset:19456
    v_mfma_f32_16x16x32_bf16 a[80:83], v[40:43], v[16:19], a[80:83]
    ds_read_b128 v[112:115], v136 offset:20480
    v_mfma_f32_16x16x32_bf16 a[84:87], v[40:43], v[20:23], a[84:87]
    ds_read_b128 v[116:119], v136 offset:21504
    buffer_load_dwordx4 v144, s[4:7], s16 offen offset:3072 sc1 lds
    v_mfma_f32_16x16x32_bf16 a[88:91], v[40:43], v[24:27], a[88:91]
    ds_read_b128 v[120:123], v136 offset:22528
    v_mfma_f32_16x16x32_bf16 a[92:95], v[40:43], v[28:31], a[92:95]
    ds_read_b128 v[124:127], v136 offset:23552
    v_mfma_f32_16x16x32_bf16 a[96:99], v[44:47], v[0:3], a[96:99]
    v_mfma_f32_16x16x32_bf16 a[100:103], v[44:47], v[4:7], a[100:103]
    v_mfma_f32_16x16x32_bf16 a[104:107], v[44:47], v[8:11], a[104:107]
    s_add_u32 s16, s16, 1024
    v_mfma_f32_16x16x32_bf16 a[108:111], v[44:47], v[12:15], a[108:111]
    v_mfma_f32_16x16x32_bf16 a[112:115], v[44:47], v[16:19], a[112:115]
    v_mfma_f32_16x16x32_bf16 a[116:119], v[44:47], v[20:23], a[116:119]
    v_mfma_f32_16x16x32_bf16 a[120:123], v[44:47], v[24:27], a[120:123]
    v_mfma_f32_16x16x32_bf16 a[124:127], v[44:47], v[28:31], a[124:127]
    s_add_u32 m0, s19, 0
    s_nop 0
    v_mfma_f32_16x16x32_bf16 a[128:131], v[48:51], v[0:3], a[128:131]
    v_mfma_f32_16x16x32_bf16 a[132:135], v[48:51], v[4:7], a[132:135]
    v_mfma_f32_16x16x32_bf16 a[136:139], v[48:51], v[8:11], a[136:139]
    v_mfma_f32_16x16x32_bf16 a[140:143], v[48:51], v[12:15], a[140:143]
    v_mfma_f32_16x16x32_bf16 a[144:147], v[48:51], v[16:19], a[144:147]
    buffer_load_dwordx4 v137, s[8:11], s15 offen offset:0 lds
    v_mfma_f32_16x16x32_bf16 a[148:151], v[48:51], v[20:23], a[148:151]
    v_mfma_f32_16x16x32_bf16 a[152:155], v[48:51], v[24:27], a[152:155]
    v_mfma_f32_16x16x32_bf16 a[156:159], v[48:51], v[28:31], a[156:159]
    v_mfma_f32_16x16x32_bf16 a[160:163], v[52:55], v[0:3], a[160:163]
    v_mfma_f32_16x16x32_bf16 a[164:167], v[52:55], v[4:7], a[164:167]
    v_mfma_f32_16x16x32_bf16 a[168:171], v[52:55], v[8:11], a[168:171]
    buffer_load_dwordx4 v138, s[8:11], s15 offen offset:1024 lds
    v_mfma_f32_16x16x32_bf16 a[172:175], v[52:55], v[12:15], a[172:175]
    v_mfma_f32_16x16x32_bf16 a[176:179], v[52:55], v[16:19], a[176:179]
    v_mfma_f32_16x16x32_bf16 a[180:183], v[52:55], v[20:23], a[180:183]
    v_mfma_f32_16x16x32_bf16 a[184:187], v[52:55], v[24:27], a[184:187]
    v_mfma_f32_16x16x32_bf16 a[188:191], v[52:55], v[28:31], a[188:191]
    buffer_load_dwordx4 v139, s[8:11], s15 offen offset:2048 lds
    v_mfma_f32_16x16x32_bf16 a[192:195], v[56:59], v[0:3], a[192:195]
    v_mfma_f32_16x16x32_bf16 a[196:199], v[56:59], v[4:7], a[196:199]
    v_mfma_f32_16x16x32_bf16 a[200:203], v[56:59], v[8:11], a[200:203]
    v_mfma_f32_16x16x32_bf16 a[204:207], v[56:59], v[12:15], a[204:207]
    v_mfma_f32_16x16x32_bf16 a[208:211], v[56:59], v[16:19], a[208:211]
    buffer_load_dwordx4 v140, s[8:11], s15 offen offset:3072 lds
    v_mfma_f32_16x16x32_bf16 a[212:215], v[56:59], v[20:23], a[212:215]
    v_mfma_f32_16x16x32_bf16 a[216:219], v[56:59], v[24:27], a[216:219]
    v_mfma_f32_16x16x32_bf16 a[220:223], v[56:59], v[28:31], a[220:223]
    v_mfma_f32_16x16x32_bf16 a[224:227], v[60:63], v[0:3], a[224:227]
    v_mfma_f32_16x16x32_bf16 a[228:231], v[60:63], v[4:7], a[228:231]
    s_add_u32 s15, s15, s17
    v_mfma_f32_16x16x32_bf16 a[232:235], v[60:63], v[8:11], a[232:235]
    v_mfma_f32_16x16x32_bf16 a[236:239], v[60:63], v[12:15], a[236:239]
    v_mfma_f32_16x16x32_bf16 a[240:243], v[60:63], v[16:19], a[240:243]
    v_mfma_f32_16x16x32_bf16 a[244:247], v[60:63], v[20:23], a[244:247]
    v_mfma_f32_16x16x32_bf16 a[248:251], v[60:63], v[24:27], a[248:251]
    v_mfma_f32_16x16x32_bf16 a[252:255], v[60:63], v[28:31], a[252:255]
    s_waitcnt lgkmcnt(0)
    v_mfma_f32_16x16x32_bf16 a[0:3], v[96:99], v[64:67], a[0:3]
    s_waitcnt vmcnt(16)
    s_barrier
    ds_read_b128 v[32:35], v136 offset:32768
    s_add_u32 m0, s20, 16384
    s_nop 0
    v_mfma_f32_16x16x32_bf16 a[4:7], v[96:99], v[68:71], a[4:7]
    ds_read_b64_tr_b16 v[0:1], v128 offset:32768
    v_mfma_f32_16x16x32_bf16 a[8:11], v[96:99], v[72:75], a[8:11]
    ds_read_b64_tr_b16 v[2:3], v128 offset:40960
    v_mfma_f32_16x16x32_bf16 a[12:15], v[96:99], v[76:79], a[12:15]
    ds_read_b64_tr_b16 v[4:5], v129 offset:32768
    v_mfma_f32_16x16x32_bf16 a[16:19], v[96:99], v[80:83], a[16:19]
    ds_read_b64_tr_b16 v[6:7], v129 offset:40960
    v_mfma_f32_16x16x32_bf16 a[20:23], v[96:99], v[84:87], a[20:23]
    ds_read_b64_tr_b16 v[8:9], v130 offset:32768
    buffer_load_dwordx4 v141, s[4:7], s16 offen offset:0 sc1 lds
    v_mfma_f32_16x16x32_bf16 a[24:27], v[96:99], v[88:91], a[24:27]
    ds_read_b64_tr_b16 v[10:11], v130 offset:40960
    v_mfma_f32_16x16x32_bf16 a[28:31], v[96:99], v[92:95], a[28:31]
    ds_read_b64_tr_b16 v[12:13], v131 offset:32768
    v_mfma_f32_16x16x32_bf16 a[32:35], v[100:103], v[64:67], a[32:35]
    ds_read_b64_tr_b16 v[14:15], v131 offset:40960
    v_mfma_f32_16x16x32_bf16 a[36:39], v[100:103], v[68:71], a[36:39]
    ds_read_b64_tr_b16 v[16:17], v132 offset:32768
    v_mfma_f32_16x16x32_bf16 a[40:43], v[100:103], v[72:75], a[40:43]
    ds_read_b64_tr_b16 v[18:19], v132 offset:40960
    buffer_load_dwordx4 v142, s[4:7], s16 offen offset:1024 sc1 lds
    v_mfma_f32_16x16x32_bf16 a[44:47], v[100:103], v[76:79], a[44:47]
    ds_read_b64_tr_b16 v[20:21], v133 offset:32768
    v_mfma_f32_16x16x32_bf16 a[48:51], v[100:103], v[80:83], a[48:51]
    ds_read_b64_tr_b16 v[22:23], v133 offset:40960
    v_mfma_f32_16x16x32_bf16 a[52:55], v[100:103], v[84:87], a[52:55]
    ds_read_b64_tr_b16 v[24:25], v134 offset:32768
    v_mfma_f32_16x16x32_bf16 a[56:59], v[100:103], v[88:91], a[56:59]
    ds_read_b64_tr_b16 v[26:27], v134 offset:40960
    v_mfma_f32_16x16x32_bf16 a[60:63], v[100:103], v[92:95], a[60:63]
    ds_read_b64_tr_b16 v[28:29], v135 offset:32768
    buffer_load_dwordx4 v143, s[4:7], s16 offen offset:2048 sc1 lds
    v_mfma_f32_16x16x32_bf16 a[64:67], v[104:107], v[64:67], a[64:67]
    ds_read_b64_tr_b16 v[30:31], v135 offset:40960
    v_mfma_f32_16x16x32_bf16 a[68:71], v[104:107], v[68:71], a[68:71]
    ds_read_b128 v[36:39], v136 offset:33792
    v_mfma_f32_16x16x32_bf16 a[72:75], v[104:107], v[72:75], a[72:75]
    ds_read_b128 v[40:43], v136 offset:34816
    v_mfma_f32_16x16x32_bf16 a[76:79], v[104:107], v[76:79], a[76:79]
    ds_read_b128 v[44:47], v136 offset:35840
    v_mfma_f32_16x16x32_bf16 a[80:83], v[104:107], v[80:83], a[80:83]
    ds_read_b128 v[48:51], v136 offset:36864
    v_mfma_f32_16x16x32_bf16 a[84:87], v[104:107], v[84:87], a[84:87]
    ds_read_b128 v[52:55], v136 offset:37888
    buffer_load_dwordx4 v144, s[4:7], s16 offen offset:3072 sc1 lds
    v_mfma_f32_16x16x32_bf16 a[88:91], v[104:107], v[88:91], a[88:91]
    ds_read_b128 v[56:59], v136 offset:38912
    v_mfma_f32_16x16x32_bf16 a[92:95], v[104:107], v[92:95], a[92:95]
    ds_read_b128 v[60:63], v136 offset:39936
    v_mfma_f32_16x16x32_bf16 a[96:99], v[108:111], v[64:67], a[96:99]
    v_mfma_f32_16x16x32_bf16 a[100:103], v[108:111], v[68:71], a[100:103]
    v_mfma_f32_16x16x32_bf16 a[104:107], v[108:111], v[72:75], a[104:107]
    s_add_u32 s16, s16, 1024
    v_mfma_f32_16x16x32_bf16 a[108:111], v[108:111], v[76:79], a[108:111]
    v_mfma_f32_16x16x32_bf16 a[112:115], v[108:111], v[80:83], a[112:115]
    v_mfma_f32_16x16x32_bf16 a[116:119], v[108:111], v[84:87], a[116:119]
    v_mfma_f32_16x16x32_bf16 a[120:123], v[108:111], v[88:91], a[120:123]
    v_mfma_f32_16x16x32_bf16 a[124:127], v[108:111], v[92:95], a[124:127]
    s_add_u32 m0, s19, 16384
    s_nop 0
    v_mfma_f32_16x16x32_bf16 a[128:131], v[112:115], v[64:67], a[128:131]
    v_mfma_f32_16x16x32_bf16 a[132:135], v[112:115], v[68:71], a[132:135]
    v_mfma_f32_16x16x32_bf16 a[136:139], v[112:115], v[72:75], a[136:139]
    v_mfma_f32_16x16x32_bf16 a[140:143], v[112:115], v[76:79], a[140:143]
    v_mfma_f32_16x16x32_bf16 a[144:147], v[112:115], v[80:83], a[144:147]
    buffer_load_dwordx4 v137, s[8:11], s15 offen offset:0 lds
    v_mfma_f32_16x16x32_bf16 a[148:151], v[112:115], v[84:87], a[148:151]
    v_mfma_f32_16x16x32_bf16 a[152:155], v[112:115], v[88:91], a[152:155]
    v_mfma_f32_16x16x32_bf16 a[156:159], v[112:115], v[92:95], a[156:159]
    v_mfma_f32_16x16x32_bf16 a[160:163], v[116:119], v[64:67], a[160:163]
    v_mfma_f32_16x16x32_bf16 a[164:167], v[116:119], v[68:71], a[164:167]
    v_mfma_f32_16x16x32_bf16 a[168:171], v[116:119], v[72:75], a[168:171]
    buffer_load_dwordx4 v138, s[8:11], s15 offen offset:1024 lds
    v_mfma_f32_16x16x32_bf16 a[172:175], v[116:119], v[76:79], a[172:175]
    v_mfma_f32_16x16x32_bf16 a[176:179], v[116:119], v[80:83], a[176:179]
    v_mfma_f32_16x16x32_bf16 a[180:183], v[116:119], v[84:87], a[180:183]
    v_mfma_f32_16x16x32_bf16 a[184:187], v[116:119], v[88:91], a[184:187]
    v_mfma_f32_16x16x32_bf16 a[188:191], v[116:119], v[92:95], a[188:191]
    buffer_load_dwordx4 v139, s[8:11], s15 offen offset:2048 lds
    v_mfma_f32_16x16x32_bf16 a[192:195], v[120:123], v[64:67], a[192:195]
    v_mfma_f32_16x16x32_bf16 a[196:199], v[120:123], v[68:71], a[196:199]
    v_mfma_f32_16x16x32_bf16 a[200:203], v[120:123], v[72:75], a[200:203]
    v_mfma_f32_16x16x32_bf16 a[204:207], v[120:123], v[76:79], a[204:207]
    v_mfma_f32_16x16x32_bf16 a[208:211], v[120:123], v[80:83], a[208:211]
    buffer_load_dwordx4 v140, s[8:11], s15 offen offset:3072 lds
    v_mfma_f32_16x16x32_bf16 a[212:215], v[120:123], v[84:87], a[212:215]
    v_mfma_f32_16x16x32_bf16 a[216:219], v[120:123], v[88:91], a[216:219]
    v_mfma_f32_16x16x32_bf16 a[220:223], v[120:123], v[92:95], a[220:223]
    v_mfma_f32_16x16x32_bf16 a[224:227], v[124:127], v[64:67], a[224:227]
    v_mfma_f32_16x16x32_bf16 a[228:231], v[124:127], v[68:71], a[228:231]
    s_add_u32 s15, s15, s17
    v_mfma_f32_16x16x32_bf16 a[232:235], v[124:127], v[72:75], a[232:235]
    v_mfma_f32_16x16x32_bf16 a[236:239], v[124:127], v[76:79], a[236:239]
    v_mfma_f32_16x16x32_bf16 a[240:243], v[124:127], v[80:83], a[240:243]
    v_mfma_f32_16x16x32_bf16 a[244:247], v[124:127], v[84:87], a[244:247]
    v_mfma_f32_16x16x32_bf16 a[248:251], v[124:127], v[88:91], a[248:251]
    v_mfma_f32_16x16x32_bf16 a[252:255], v[124:127], v[92:95], a[252:255]
    s_waitcnt lgkmcnt(0)
    v_mfma_f32_16x16x32_bf16 a[0:3], v[32:35], v[0:3], a[0:3]
    s_waitcnt vmcnt(16)
    s_barrier
    ds_read_b128 v[96:99], v136 offset:49152
    s_add_u32 m0, s20, 32768
    s_nop 0
    v_mfma_f32_16x16x32_bf16 a[4:7], v[32:35], v[4:7], a[4:7]
    ds_read_b64_tr_b16 v[64:65], v128 offset:49152
    v_mfma_f32_16x16x32_bf16 a[8:11], v[32:35], v[8:11], a[8:11]
    ds_read_b64_tr_b16 v[66:67], v128 offset:57344
    v_mfma_f32_16x16x32_bf16 a[12:15], v[32:35], v[12:15], a[12:15]
    ds_read_b64_tr_b16 v[68:69], v129 offset:49152
    v_mfma_f32_16x16x32_bf16 a[16:19], v[32:35], v[16:19], a[16:19]
    ds_read_b64_tr_b16 v[70:71], v129 offset:57344
    v_mfma_f32_16x16x32_bf16 a[20:23], v[32:35], v[20:23], a[20:23]
    ds_read_b64_tr_b16 v[72:73], v130 offset:49152
    buffer_load_dwordx4 v141, s[4:7], s16 offen offset:0 sc1 lds
    v_mfma_f32_16x16x32_bf16 a[24:27], v[32:35], v[24:27], a[24:27]
    ds_read_b64_tr_b16 v[74:75], v130 offset:57344
    v_mfma_f32_16x16x32_bf16 a[28:31], v[32:35], v[28:31], a[28:31]
    ds_read_b64_tr_b16 v[76:77], v131 offset:49152
    v_mfma_f32_16x16x32_bf16 a[32:35], v[36:39], v[0:3], a[32:35]
    ds_read_b64_tr_b16 v[78:79], v131 offset:57344
    v_mfma_f32_16x16x32_bf16 a[36:39], v[36:39], v[4:7], a[36:39]
    ds_read_b64_tr_b16 v[80:81], v132 offset:49152
    v_mfma_f32_16x16x32_bf16 a[40:43], v[36:39], v[8:11], a[40:43]
    ds_read_b64_tr_b16 v[82:83], v132 offset:57344
    buffer_load_dwordx4 v142, s[4:7], s16 offen offset:1024 sc1 lds
    v_mfma_f32_16x16x32_bf16 a[44:47], v[36:39], v[12:15], a[44:47]
    ds_read_b64_tr_b16 v[84:85], v133 offset:49152
    v_mfma_f32_16x16x32_bf16 a[48:51], v[36:39], v[16:19], a[48:51]
    ds_read_b64_tr_b16 v[86:87], v133 offset:57344
    v_mfma_f32_16x16x32_bf16 a[52:55], v[36:39], v[20:23], a[52:55]
    ds_read_b64_tr_b16 v[88:89], v134 offset:49152
    v_mfma_f32_16x16x32_bf16 a[56:59], v[36:39], v[24:27], a[56:59]
    ds_read_b64_tr_b16 v[90:91], v134 offset:57344
    v_mfma_f32_16x16x32_bf16 a[60:63], v[36:39], v[28:31], a[60:63]
    ds_read_b64_tr_b16 v[92:93], v135 offset:49152
    buffer_load_dwordx4 v143, s[4:7], s16 offen offset:2048 sc1 lds
    v_mfma_f32_16x16x32_bf16 a[64:67], v[40:43], v[0:3], a[64:67]
    ds_read_b64_tr_b16 v[94:95], v135 offset:57344
    v_mfma_f32_16x16x32_bf16 a[68:71], v[40:43], v[4:7], a[68:71]
    ds_read_b128 v[100:103], v136 offset:50176
    v_mfma_f32_16x16x32_bf16 a[72:75], v[40:43], v[8:11], a[72:75]
    ds_read_b128 v[104:107], v136 offset:51200
    v_mfma_f32_16x16x32_bf16 a[76:79], v[40:43], v[12:15], a[76:79]
    ds_read_b128 v[108:111], v136 offset:52224
    v_mfma_f32_16x16x32_bf16 a[80:83], v[40:43], v[16:19], a[80:83]
    ds_read_b128 v[112:115], v136 offset:53248
    v_mfma_f32_16x16x32_bf16 a[84:87], v[40:43], v[20:23], a[84:87]
    ds_read_b128 v[116:119], v136 offset:54272
    buffer_load_dwordx4 v144, s[4:7], s16 offen offset:3072 sc1 lds
    v_mfma_f32_16x16x32_bf16 a[88:91], v[40:43], v[24:27], a[88:91]
    ds_read_b128 v[120:123], v136 offset:55296
    v_mfma_f32_16x16x32_bf16 a[92:95], v[40:43], v[28:31], a[92:95]
    ds_read_b128 v[124:127], v136 offset:56320
    v_mfma_f32_16x16x32_bf16 a[96:99], v[44:47], v[0:3], a[96:99]
    v_mfma_f32_16x16x32_bf16 a[100:103], v[44:47], v[4:7], a[100:103]
    v_mfma_f32_16x16x32_bf16 a[104:107], v[44:47], v[8:11], a[104:107]
    s_add_u32 s16, s16, 1024
    v_mfma_f32_16x16x32_bf16 a[108:111], v[44:47], v[12:15], a[108:111]
    v_mfma_f32_16x16x32_bf16 a[112:115], v[44:47], v[16:19], a[112:115]
    v_mfma_f32_16x16x32_bf16 a[116:119], v[44:47], v[20:23], a[116:119]
    v_mfma_f32_16x16x32_bf16 a[120:123], v[44:47], v[24:27], a[120:123]
    v_mfma_f32_16x16x32_bf16 a[124:127], v[44:47], v[28:31], a[124:127]
    s_add_u32 m0, s19, 32768
    s_nop 0
    v_mfma_f32_16x16x32_bf16 a[128:131], v[48:51], v[0:3], a[128:131]
    v_mfma_f32_16x16x32_bf16 a[132:135], v[48:51], v[4:7], a[132:135]
    v_mfma_f32_16x16x32_bf16 a[136:139], v[48:51], v[8:11], a[136:139]
    v_mfma_f32_16x16x32_bf16 a[140:143], v[48:51], v[12:15], a[140:143]
    v_mfma_f32_16x16x32_bf16 a[144:147], v[48:51], v[16:19], a[144:147]
    buffer_load_dwordx4 v137, s[8:11], s15 offen offset:0 lds
    v_mfma_f32_16x16x32_bf16 a[148:151], v[48:51], v[20:23], a[148:151]
    v_mfma_f32_16x16x32_bf16 a[152:155], v[48:51], v[24:27], a[152:155]
    v_mfma_f32_16x16x32_bf16 a[156:159], v[48:51], v[28:31], a[156:159]
    v_mfma_f32_16x16x32_bf16 a[160:163], v[52:55], v[0:3], a[160:163]
    v_mfma_f32_16x16x32_bf16 a[164:167], v[52:55], v[4:7], a[164:167]
    v_mfma_f32_16x16x32_bf16 a[168:171], v[52:55], v[8:11], a[168:171]
    buffer_load_dwordx4 v138, s[8:11], s15 offen offset:1024 lds
    v_mfma_f32_16x16x32_bf16 a[172:175], v[52:55], v[12:15], a[172:175]
    v_mfma_f32_16x16x32_bf16 a[176:179], v[52:55], v[16:19], a[176:179]
    v_mfma_f32_16x16x32_bf16 a[180:183], v[52:55], v[20:23], a[180:183]
    v_mfma_f32_16x16x32_bf16 a[184:187], v[52:55], v[24:27], a[184:187]
    v_mfma_f32_16x16x32_bf16 a[188:191], v[52:55], v[28:31], a[188:191]
    buffer_load_dwordx4 v139, s[8:11], s15 offen offset:2048 lds
    v_mfma_f32_16x16x32_bf16 a[192:195], v[56:59], v[0:3], a[192:195]
    v_mfma_f32_16x16x32_bf16 a[196:199], v[56:59], v[4:7], a[196:199]
    v_mfma_f32_16x16x32_bf16 a[200:203], v[56:59], v[8:11], a[200:203]
    v_mfma_f32_16x16x32_bf16 a[204:207], v[56:59], v[12:15], a[204:207]
    v_mfma_f32_16x16x32_bf16 a[208:211], v[56:59], v[16:19], a[208:211]
    buffer_load_dwordx4 v140, s[8:11], s15 offen offset:3072 lds
    v_mfma_f32_16x16x32_bf16 a[212:215], v[56:59], v[20:23], a[212:215]
    v_mfma_f32_16x16x32_bf16 a[216:219], v[56:59], v[24:27], a[216:219]
    v_mfma_f32_16x16x32_bf16 a[220:223], v[56:59], v[28:31], a[220:223]
    v_mfma_f32_16x16x32_bf16 a[224:227], v[60:63], v[0:3], a[224:227]
    v_mfma_f32_16x16x32_bf16 a[228:231], v[60:63], v[4:7], a[228:231]
    s_add_u32 s15, s15, s17
    v_mfma_f32_16x16x32_bf16 a[232:235], v[60:63], v[8:11], a[232:235]
    v_mfma_f32_16x16x32_bf16 a[236:239], v[60:63], v[12:15], a[236:239]
    v_mfma_f32_16x16x32_bf16 a[240:243], v[60:63], v[16:19], a[240:243]
    v_mfma_f32_16x16x32_bf16 a[244:247], v[60:63], v[20:23], a[244:247]
    v_mfma_f32_16x16x32_bf16 a[248:251], v[60:63], v[24:27], a[248:251]
    v_mfma_f32_16x16x32_bf16 a[252:255], v[60:63], v[28:31], a[252:255]
    s_waitcnt lgkmcnt(0)
    v_mfma_f32_16x16x32_bf16 a[0:3], v[96:99], v[64:67], a[0:3]
    s_waitcnt vmcnt(16)
    s_barrier
    ds_read_b128 v[32:35], v136 offset:0
    s_add_u32 m0, s20, 49152
    s_nop 0
    v_mfma_f32_16x16x32_bf16 a[4:7], v[96:99], v[68:71], a[4:7]
    ds_read_b64_tr_b16 v[0:1], v128 offset:0
    v_mfma_f32_16x16x32_bf16 a[8:11], v[96:99], v[72:75], a[8:11]
    ds_read_b64_tr_b16 v[2:3], v128 offset:8192
    v_mfma_f32_16x16x32_bf16 a[12:15], v[96:99], v[76:79], a[12:15]
    ds_read_b64_tr_b16 v[4:5], v129 offset:0
    v_mfma_f32_16x16x32_bf16 a[16:19], v[96:99], v[80:83], a[16:19]
    ds_read_b64_tr_b16 v[6:7], v129 offset:8192
    v_mfma_f32_16x16x32_bf16 a[20:23], v[96:99], v[84:87], a[20:23]
    ds_read_b64_tr_b16 v[8:9], v130 offset:0
    buffer_load_dwordx4 v141, s[4:7], s16 offen offset:0 sc1 lds
    v_mfma_f32_16x16x32_bf16 a[24:27], v[96:99], v[88:91], a[24:27]
    ds_read_b64_tr_b16 v[10:11], v130 offset:8192
    v_mfma_f32_16x16x32_bf16 a[28:31], v[96:99], v[92:95], a[28:31]
    ds_read_b64_tr_b16 v[12:13], v131 offset:0
    v_mfma_f32_16x16x32_bf16 a[32:35], v[100:103], v[64:67], a[32:35]
    ds_read_b64_tr_b16 v[14:15], v131 offset:8192
    v_mfma_f32_16x16x32_bf16 a[36:39], v[100:103], v[68:71], a[36:39]
    ds_read_b64_tr_b16 v[16:17], v132 offset:0
    v_mfma_f32_16x16x32_bf16 a[40:43], v[100:103], v[72:75], a[40:43]
    ds_read_b64_tr_b16 v[18:19], v132 offset:8192
    buffer_load_dwordx4 v142, s[4:7], s16 offen offset:1024 sc1 lds
    v_mfma_f32_16x16x32_bf16 a[44:47], v[100:103], v[76:79], a[44:47]
    ds_read_b64_tr_b16 v[20:21], v133 offset:0
    v_mfma_f32_16x16x32_bf16 a[48:51], v[100:103], v[80:83], a[48:51]
    ds_read_b64_tr_b16 v[22:23], v133 offset:8192
    v_mfma_f32_16x16x32_bf16 a[52:55], v[100:103], v[84:87], a[52:55]
    ds_read_b64_tr_b16 v[24:25], v134 offset:0
    v_mfma_f32_16x16x32_bf16 a[56:59], v[100:103], v[88:91], a[56:59]
    ds_read_b64_tr_b16 v[26:27], v134 offset:8192
    v_mfma_f32_16x16x32_bf16 a[60:63], v[100:103], v[92:95], a[60:63]
    ds_read_b64_tr_b16 v[28:29], v135 offset:0
    buffer_load_dwordx4 v143, s[4:7], s16 offen offset:2048 sc1 lds
    v_mfma_f32_16x16x32_bf16 a[64:67], v[104:107], v[64:67], a[64:67]
    ds_read_b64_tr_b16 v[30:31], v135 offset:8192
    v_mfma_f32_16x16x32_bf16 a[68:71], v[104:107], v[68:71], a[68:71]
    ds_read_b128 v[36:39], v136 offset:1024
    v_mfma_f32_16x16x32_bf16 a[72:75], v[104:107], v[72:75], a[72:75]
    ds_read_b128 v[40:43], v136 offset:2048
    v_mfma_f32_16x16x32_bf16 a[76:79], v[104:107], v[76:79], a[76:79]
    ds_read_b128 v[44:47], v136 offset:3072
    v_mfma_f32_16x16x32_bf16 a[80:83], v[104:107], v[80:83], a[80:83]
    ds_read_b128 v[48:51], v136 offset:4096
    v_mfma_f32_16x16x32_bf16 a[84:87], v[104:107], v[84:87], a[84:87]
    ds_read_b128 v[52:55], v136 offset:5120
    buffer_load_dwordx4 v144, s[4:7], s16 offen offset:3072 sc1 lds
    v_mfma_f32_16x16x32_bf16 a[88:91], v[104:107], v[88:91], a[88:91]
    ds_read_b128 v[56:59], v136 offset:6144
    v_mfma_f32_16x16x32_bf16 a[92:95], v[104:107], v[92:95], a[92:95]
    ds_read_b128 v[60:63], v136 offset:7168
    v_mfma_f32_16x16x32_bf16 a[96:99], v[108:111], v[64:67], a[96:99]
    v_mfma_f32_16x16x32_bf16 a[100:103], v[108:111], v[68:71], a[100:103]
    v_mfma_f32_16x16x32_bf16 a[104:107], v[108:111], v[72:75], a[104:107]
    s_add_u32 s16, s16, 1024
    v_mfma_f32_16x16x32_bf16 a[108:111], v[108:111], v[76:79], a[108:111]
    v_mfma_f32_16x16x32_bf16 a[112:115], v[108:111], v[80:83], a[112:115]
    v_mfma_f32_16x16x32_bf16 a[116:119], v[108:111], v[84:87], a[116:119]
    v_mfma_f32_16x16x32_bf16 a[120:123], v[108:111], v[88:91], a[120:123]
    v_mfma_f32_16x16x32_bf16 a[124:127], v[108:111], v[92:95], a[124:127]
    s_add_u32 m0, s19, 49152
    s_nop 0
    v_mfma_f32_16x16x32_bf16 a[128:131], v[112:115], v[64:67], a[128:131]
    v_mfma_f32_16x16x32_bf16 a[132:135], v[112:115], v[68:71], a[132:135]
    v_mfma_f32_16x16x32_bf16 a[136:139], v[112:115], v[72:75], a[136:139]
    v_mfma_f32_16x16x32_bf16 a[140:143], v[112:115], v[76:79], a[140:143]
    v_mfma_f32_16x16x32_bf16 a[144:147], v[112:115], v[80:83], a[144:147]
    buffer_load_dwordx4 v137, s[8:11], s15 offen offset:0 lds
    v_mfma_f32_16x16x32_bf16 a[148:151], v[112:115], v[84:87], a[148:151]
    v_mfma_f32_16x16x32_bf16 a[152:155], v[112:115], v[88:91], a[152:155]
    v_mfma_f32_16x16x32_bf16 a[156:159], v[112:115], v[92:95], a[156:159]
    v_mfma_f32_16x16x32_bf16 a[160:163], v[116:119], v[64:67], a[160:163]
    v_mfma_f32_16x16x32_bf16 a[164:167], v[116:119], v[68:71], a[164:167]
    v_mfma_f32_16x16x32_bf16 a[168:171], v[116:119], v[72:75], a[168:171]
    buffer_load_dwordx4 v138, s[8:11], s15 offen offset:1024 lds
    v_mfma_f32_16x16x32_bf16 a[172:175], v[116:119], v[76:79], a[172:175]
    v_mfma_f32_16x16x32_bf16 a[176:179], v[116:119], v[80:83], a[176:179]
    v_mfma_f32_16x16x32_bf16 a[180:183], v[116:119], v[84:87], a[180:183]
    v_mfma_f32_16x16x32_bf16 a[184:187], v[116:119], v[88:91], a[184:187]
    v_mfma_f32_16x16x32_bf16 a[188:191], v[116:119], v[92:95], a[188:191]
    buffer_load_dwordx4 v139, s[8:11], s15 offen offset:2048 lds
    v_mfma_f32_16x16x32_bf16 a[192:195], v[120:123], v[64:67], a[192:195]
    v_mfma_f32_16x16x32_bf16 a[196:199], v[120:123], v[68:71], a[196:199]
    v_mfma_f32_16x16x32_bf16 a[200:203], v[120:123], v[72:75], a[200:203]
    v_mfma_f32_16x16x32_bf16 a[204:207], v[120:123], v[76:79], a[204:207]
    v_mfma_f32_16x16x32_bf16 a[208:211], v[120:123], v[80:83], a[208:211]
    buffer_load_dwordx4 v140, s[8:11], s15 offen offset:3072 lds
    v_mfma_f32_16x16x32_bf16 a[212:215], v[120:123], v[84:87], a[212:215]
    v_mfma_f32_16x16x32_bf16 a[216:219], v[120:123], v[88:91], a[216:219]
    v_mfma_f32_16x16x32_bf16 a[220:223], v[120:123], v[92:95], a[220:223]
    v_mfma_f32_16x16x32_bf16 a[224:227], v[124:127], v[64:67], a[224:227]
    v_mfma_f32_16x16x32_bf16 a[228:231], v[124:127], v[68:71], a[228:231]
    s_add_u32 s15, s15, s17
    v_mfma_f32_16x16x32_bf16 a[232:235], v[124:127], v[72:75], a[232:235]
    v_mfma_f32_16x16x32_bf16 a[236:239], v[124:127], v[76:79], a[236:239]
    v_mfma_f32_16x16x32_bf16 a[240:243], v[124:127], v[80:83], a[240:243]
    v_mfma_f32_16x16x32_bf16 a[244:247], v[124:127], v[84:87], a[244:247]
    v_mfma_f32_16x16x32_bf16 a[248:251], v[124:127], v[88:91], a[248:251]
    v_mfma_f32_16x16x32_bf16 a[252:255], v[124:127], v[92:95], a[252:255]
    s_sub_u32 s18, s18, 1
    s_cmp_lg_u32 s18, 0
    s_cbranch_scc1 main_kernel_w_c2_v_loop
    s_cmp_lg_u32 s14, 0
    s_cbranch_scc1 main_kernel_w_c2_v_nt
    s_lshl_b32 s32, s27, 8
    s_add_u32 s32, s32, 0x841e000
    v_mov_b32 v255, 1
    s_mov_b64 exec, 1
    buffer_atomic_add v255, off, s[4:7], s32 sc0 sc1
    s_mov_b64 exec, -1
main_kernel_w_c2_v_nt:
    s_waitcnt lgkmcnt(0)
    v_mfma_f32_16x16x32_bf16 a[0:3], v[32:35], v[0:3], a[0:3]
    s_waitcnt vmcnt(16)
    s_barrier
    ds_read_b128 v[96:99], v136 offset:16384
    v_mfma_f32_16x16x32_bf16 a[4:7], v[32:35], v[4:7], a[4:7]
    ds_read_b64_tr_b16 v[64:65], v128 offset:16384
    v_mfma_f32_16x16x32_bf16 a[8:11], v[32:35], v[8:11], a[8:11]
    ds_read_b64_tr_b16 v[66:67], v128 offset:24576
    v_mfma_f32_16x16x32_bf16 a[12:15], v[32:35], v[12:15], a[12:15]
    ds_read_b64_tr_b16 v[68:69], v129 offset:16384
    v_mfma_f32_16x16x32_bf16 a[16:19], v[32:35], v[16:19], a[16:19]
    ds_read_b64_tr_b16 v[70:71], v129 offset:24576
    v_mfma_f32_16x16x32_bf16 a[20:23], v[32:35], v[20:23], a[20:23]
    ds_read_b64_tr_b16 v[72:73], v130 offset:16384
    v_mfma_f32_16x16x32_bf16 a[24:27], v[32:35], v[24:27], a[24:27]
    ds_read_b64_tr_b16 v[74:75], v130 offset:24576
    v_mfma_f32_16x16x32_bf16 a[28:31], v[32:35], v[28:31], a[28:31]
    ds_read_b64_tr_b16 v[76:77], v131 offset:16384
    v_mfma_f32_16x16x32_bf16 a[32:35], v[36:39], v[0:3], a[32:35]
    ds_read_b64_tr_b16 v[78:79], v131 offset:24576
    v_mfma_f32_16x16x32_bf16 a[36:39], v[36:39], v[4:7], a[36:39]
    ds_read_b64_tr_b16 v[80:81], v132 offset:16384
    v_mfma_f32_16x16x32_bf16 a[40:43], v[36:39], v[8:11], a[40:43]
    ds_read_b64_tr_b16 v[82:83], v132 offset:24576
    v_mfma_f32_16x16x32_bf16 a[44:47], v[36:39], v[12:15], a[44:47]
    ds_read_b64_tr_b16 v[84:85], v133 offset:16384
    v_mfma_f32_16x16x32_bf16 a[48:51], v[36:39], v[16:19], a[48:51]
    ds_read_b64_tr_b16 v[86:87], v133 offset:24576
    v_mfma_f32_16x16x32_bf16 a[52:55], v[36:39], v[20:23], a[52:55]
    ds_read_b64_tr_b16 v[88:89], v134 offset:16384
    v_mfma_f32_16x16x32_bf16 a[56:59], v[36:39], v[24:27], a[56:59]
    ds_read_b64_tr_b16 v[90:91], v134 offset:24576
    v_mfma_f32_16x16x32_bf16 a[60:63], v[36:39], v[28:31], a[60:63]
    ds_read_b64_tr_b16 v[92:93], v135 offset:16384
    v_mfma_f32_16x16x32_bf16 a[64:67], v[40:43], v[0:3], a[64:67]
    ds_read_b64_tr_b16 v[94:95], v135 offset:24576
    v_mfma_f32_16x16x32_bf16 a[68:71], v[40:43], v[4:7], a[68:71]
    ds_read_b128 v[100:103], v136 offset:17408
    v_mfma_f32_16x16x32_bf16 a[72:75], v[40:43], v[8:11], a[72:75]
    ds_read_b128 v[104:107], v136 offset:18432
    v_mfma_f32_16x16x32_bf16 a[76:79], v[40:43], v[12:15], a[76:79]
    ds_read_b128 v[108:111], v136 offset:19456
    v_mfma_f32_16x16x32_bf16 a[80:83], v[40:43], v[16:19], a[80:83]
    ds_read_b128 v[112:115], v136 offset:20480
    v_mfma_f32_16x16x32_bf16 a[84:87], v[40:43], v[20:23], a[84:87]
    ds_read_b128 v[116:119], v136 offset:21504
    v_mfma_f32_16x16x32_bf16 a[88:91], v[40:43], v[24:27], a[88:91]
    ds_read_b128 v[120:123], v136 offset:22528
    v_mfma_f32_16x16x32_bf16 a[92:95], v[40:43], v[28:31], a[92:95]
    ds_read_b128 v[124:127], v136 offset:23552
    v_mfma_f32_16x16x32_bf16 a[96:99], v[44:47], v[0:3], a[96:99]
    v_mfma_f32_16x16x32_bf16 a[100:103], v[44:47], v[4:7], a[100:103]
    v_mfma_f32_16x16x32_bf16 a[104:107], v[44:47], v[8:11], a[104:107]
    v_mfma_f32_16x16x32_bf16 a[108:111], v[44:47], v[12:15], a[108:111]
    v_mfma_f32_16x16x32_bf16 a[112:115], v[44:47], v[16:19], a[112:115]
    v_mfma_f32_16x16x32_bf16 a[116:119], v[44:47], v[20:23], a[116:119]
    v_mfma_f32_16x16x32_bf16 a[120:123], v[44:47], v[24:27], a[120:123]
    v_mfma_f32_16x16x32_bf16 a[124:127], v[44:47], v[28:31], a[124:127]
    v_mfma_f32_16x16x32_bf16 a[128:131], v[48:51], v[0:3], a[128:131]
    v_mfma_f32_16x16x32_bf16 a[132:135], v[48:51], v[4:7], a[132:135]
    v_mfma_f32_16x16x32_bf16 a[136:139], v[48:51], v[8:11], a[136:139]
    v_mfma_f32_16x16x32_bf16 a[140:143], v[48:51], v[12:15], a[140:143]
    v_mfma_f32_16x16x32_bf16 a[144:147], v[48:51], v[16:19], a[144:147]
    v_mfma_f32_16x16x32_bf16 a[148:151], v[48:51], v[20:23], a[148:151]
    v_mfma_f32_16x16x32_bf16 a[152:155], v[48:51], v[24:27], a[152:155]
    v_mfma_f32_16x16x32_bf16 a[156:159], v[48:51], v[28:31], a[156:159]
    v_mfma_f32_16x16x32_bf16 a[160:163], v[52:55], v[0:3], a[160:163]
    v_mfma_f32_16x16x32_bf16 a[164:167], v[52:55], v[4:7], a[164:167]
    v_mfma_f32_16x16x32_bf16 a[168:171], v[52:55], v[8:11], a[168:171]
    v_mfma_f32_16x16x32_bf16 a[172:175], v[52:55], v[12:15], a[172:175]
    v_mfma_f32_16x16x32_bf16 a[176:179], v[52:55], v[16:19], a[176:179]
    v_mfma_f32_16x16x32_bf16 a[180:183], v[52:55], v[20:23], a[180:183]
    v_mfma_f32_16x16x32_bf16 a[184:187], v[52:55], v[24:27], a[184:187]
    v_mfma_f32_16x16x32_bf16 a[188:191], v[52:55], v[28:31], a[188:191]
    v_mfma_f32_16x16x32_bf16 a[192:195], v[56:59], v[0:3], a[192:195]
    v_mfma_f32_16x16x32_bf16 a[196:199], v[56:59], v[4:7], a[196:199]
    v_mfma_f32_16x16x32_bf16 a[200:203], v[56:59], v[8:11], a[200:203]
    v_mfma_f32_16x16x32_bf16 a[204:207], v[56:59], v[12:15], a[204:207]
    v_mfma_f32_16x16x32_bf16 a[208:211], v[56:59], v[16:19], a[208:211]
    v_mfma_f32_16x16x32_bf16 a[212:215], v[56:59], v[20:23], a[212:215]
    v_mfma_f32_16x16x32_bf16 a[216:219], v[56:59], v[24:27], a[216:219]
    v_mfma_f32_16x16x32_bf16 a[220:223], v[56:59], v[28:31], a[220:223]
    v_mfma_f32_16x16x32_bf16 a[224:227], v[60:63], v[0:3], a[224:227]
    v_mfma_f32_16x16x32_bf16 a[228:231], v[60:63], v[4:7], a[228:231]
    v_mfma_f32_16x16x32_bf16 a[232:235], v[60:63], v[8:11], a[232:235]
    v_mfma_f32_16x16x32_bf16 a[236:239], v[60:63], v[12:15], a[236:239]
    v_mfma_f32_16x16x32_bf16 a[240:243], v[60:63], v[16:19], a[240:243]
    v_mfma_f32_16x16x32_bf16 a[244:247], v[60:63], v[20:23], a[244:247]
    v_mfma_f32_16x16x32_bf16 a[248:251], v[60:63], v[24:27], a[248:251]
    v_mfma_f32_16x16x32_bf16 a[252:255], v[60:63], v[28:31], a[252:255]
    s_waitcnt lgkmcnt(0)
    v_mfma_f32_16x16x32_bf16 a[0:3], v[96:99], v[64:67], a[0:3]
    s_waitcnt vmcnt(8)
    s_barrier
    ds_read_b128 v[32:35], v136 offset:32768
    v_mfma_f32_16x16x32_bf16 a[4:7], v[96:99], v[68:71], a[4:7]
    ds_read_b64_tr_b16 v[0:1], v128 offset:32768
    v_mfma_f32_16x16x32_bf16 a[8:11], v[96:99], v[72:75], a[8:11]
    ds_read_b64_tr_b16 v[2:3], v128 offset:40960
    v_mfma_f32_16x16x32_bf16 a[12:15], v[96:99], v[76:79], a[12:15]
    ds_read_b64_tr_b16 v[4:5], v129 offset:32768
    v_mfma_f32_16x16x32_bf16 a[16:19], v[96:99], v[80:83], a[16:19]
    ds_read_b64_tr_b16 v[6:7], v129 offset:40960
    v_mfma_f32_16x16x32_bf16 a[20:23], v[96:99], v[84:87], a[20:23]
    ds_read_b64_tr_b16 v[8:9], v130 offset:32768
    v_mfma_f32_16x16x32_bf16 a[24:27], v[96:99], v[88:91], a[24:27]
    ds_read_b64_tr_b16 v[10:11], v130 offset:40960
    v_mfma_f32_16x16x32_bf16 a[28:31], v[96:99], v[92:95], a[28:31]
    ds_read_b64_tr_b16 v[12:13], v131 offset:32768
    v_mfma_f32_16x16x32_bf16 a[32:35], v[100:103], v[64:67], a[32:35]
    ds_read_b64_tr_b16 v[14:15], v131 offset:40960
    v_mfma_f32_16x16x32_bf16 a[36:39], v[100:103], v[68:71], a[36:39]
    ds_read_b64_tr_b16 v[16:17], v132 offset:32768
    v_mfma_f32_16x16x32_bf16 a[40:43], v[100:103], v[72:75], a[40:43]
    ds_read_b64_tr_b16 v[18:19], v132 offset:40960
    v_mfma_f32_16x16x32_bf16 a[44:47], v[100:103], v[76:79], a[44:47]
    ds_read_b64_tr_b16 v[20:21], v133 offset:32768
    v_mfma_f32_16x16x32_bf16 a[48:51], v[100:103], v[80:83], a[48:51]
    ds_read_b64_tr_b16 v[22:23], v133 offset:40960
    v_mfma_f32_16x16x32_bf16 a[52:55], v[100:103], v[84:87], a[52:55]
    ds_read_b64_tr_b16 v[24:25], v134 offset:32768
    v_mfma_f32_16x16x32_bf16 a[56:59], v[100:103], v[88:91], a[56:59]
    ds_read_b64_tr_b16 v[26:27], v134 offset:40960
    v_mfma_f32_16x16x32_bf16 a[60:63], v[100:103], v[92:95], a[60:63]
    ds_read_b64_tr_b16 v[28:29], v135 offset:32768
    v_mfma_f32_16x16x32_bf16 a[64:67], v[104:107], v[64:67], a[64:67]
    ds_read_b64_tr_b16 v[30:31], v135 offset:40960
    v_mfma_f32_16x16x32_bf16 a[68:71], v[104:107], v[68:71], a[68:71]
    ds_read_b128 v[36:39], v136 offset:33792
    v_mfma_f32_16x16x32_bf16 a[72:75], v[104:107], v[72:75], a[72:75]
    ds_read_b128 v[40:43], v136 offset:34816
    v_mfma_f32_16x16x32_bf16 a[76:79], v[104:107], v[76:79], a[76:79]
    ds_read_b128 v[44:47], v136 offset:35840
    v_mfma_f32_16x16x32_bf16 a[80:83], v[104:107], v[80:83], a[80:83]
    ds_read_b128 v[48:51], v136 offset:36864
    v_mfma_f32_16x16x32_bf16 a[84:87], v[104:107], v[84:87], a[84:87]
    ds_read_b128 v[52:55], v136 offset:37888
    v_mfma_f32_16x16x32_bf16 a[88:91], v[104:107], v[88:91], a[88:91]
    ds_read_b128 v[56:59], v136 offset:38912
    v_mfma_f32_16x16x32_bf16 a[92:95], v[104:107], v[92:95], a[92:95]
    ds_read_b128 v[60:63], v136 offset:39936
    v_mfma_f32_16x16x32_bf16 a[96:99], v[108:111], v[64:67], a[96:99]
    v_mfma_f32_16x16x32_bf16 a[100:103], v[108:111], v[68:71], a[100:103]
    v_mfma_f32_16x16x32_bf16 a[104:107], v[108:111], v[72:75], a[104:107]
    v_mfma_f32_16x16x32_bf16 a[108:111], v[108:111], v[76:79], a[108:111]
    v_mfma_f32_16x16x32_bf16 a[112:115], v[108:111], v[80:83], a[112:115]
    v_mfma_f32_16x16x32_bf16 a[116:119], v[108:111], v[84:87], a[116:119]
    v_mfma_f32_16x16x32_bf16 a[120:123], v[108:111], v[88:91], a[120:123]
    v_mfma_f32_16x16x32_bf16 a[124:127], v[108:111], v[92:95], a[124:127]
    v_mfma_f32_16x16x32_bf16 a[128:131], v[112:115], v[64:67], a[128:131]
    v_mfma_f32_16x16x32_bf16 a[132:135], v[112:115], v[68:71], a[132:135]
    v_mfma_f32_16x16x32_bf16 a[136:139], v[112:115], v[72:75], a[136:139]
    v_mfma_f32_16x16x32_bf16 a[140:143], v[112:115], v[76:79], a[140:143]
    v_mfma_f32_16x16x32_bf16 a[144:147], v[112:115], v[80:83], a[144:147]
    v_mfma_f32_16x16x32_bf16 a[148:151], v[112:115], v[84:87], a[148:151]
    v_mfma_f32_16x16x32_bf16 a[152:155], v[112:115], v[88:91], a[152:155]
    v_mfma_f32_16x16x32_bf16 a[156:159], v[112:115], v[92:95], a[156:159]
    v_mfma_f32_16x16x32_bf16 a[160:163], v[116:119], v[64:67], a[160:163]
    v_mfma_f32_16x16x32_bf16 a[164:167], v[116:119], v[68:71], a[164:167]
    v_mfma_f32_16x16x32_bf16 a[168:171], v[116:119], v[72:75], a[168:171]
    v_mfma_f32_16x16x32_bf16 a[172:175], v[116:119], v[76:79], a[172:175]
    v_mfma_f32_16x16x32_bf16 a[176:179], v[116:119], v[80:83], a[176:179]
    v_mfma_f32_16x16x32_bf16 a[180:183], v[116:119], v[84:87], a[180:183]
    v_mfma_f32_16x16x32_bf16 a[184:187], v[116:119], v[88:91], a[184:187]
    v_mfma_f32_16x16x32_bf16 a[188:191], v[116:119], v[92:95], a[188:191]
    v_mfma_f32_16x16x32_bf16 a[192:195], v[120:123], v[64:67], a[192:195]
    v_mfma_f32_16x16x32_bf16 a[196:199], v[120:123], v[68:71], a[196:199]
    v_mfma_f32_16x16x32_bf16 a[200:203], v[120:123], v[72:75], a[200:203]
    v_mfma_f32_16x16x32_bf16 a[204:207], v[120:123], v[76:79], a[204:207]
    v_mfma_f32_16x16x32_bf16 a[208:211], v[120:123], v[80:83], a[208:211]
    v_mfma_f32_16x16x32_bf16 a[212:215], v[120:123], v[84:87], a[212:215]
    v_mfma_f32_16x16x32_bf16 a[216:219], v[120:123], v[88:91], a[216:219]
    v_mfma_f32_16x16x32_bf16 a[220:223], v[120:123], v[92:95], a[220:223]
    v_mfma_f32_16x16x32_bf16 a[224:227], v[124:127], v[64:67], a[224:227]
    v_mfma_f32_16x16x32_bf16 a[228:231], v[124:127], v[68:71], a[228:231]
    v_mfma_f32_16x16x32_bf16 a[232:235], v[124:127], v[72:75], a[232:235]
    v_mfma_f32_16x16x32_bf16 a[236:239], v[124:127], v[76:79], a[236:239]
    v_mfma_f32_16x16x32_bf16 a[240:243], v[124:127], v[80:83], a[240:243]
    v_mfma_f32_16x16x32_bf16 a[244:247], v[124:127], v[84:87], a[244:247]
    v_mfma_f32_16x16x32_bf16 a[248:251], v[124:127], v[88:91], a[248:251]
    v_mfma_f32_16x16x32_bf16 a[252:255], v[124:127], v[92:95], a[252:255]
    s_waitcnt lgkmcnt(0)
    v_mfma_f32_16x16x32_bf16 a[0:3], v[32:35], v[0:3], a[0:3]
    s_waitcnt vmcnt(0)
    s_barrier
    ds_read_b128 v[96:99], v136 offset:49152
    v_mfma_f32_16x16x32_bf16 a[4:7], v[32:35], v[4:7], a[4:7]
    ds_read_b64_tr_b16 v[64:65], v128 offset:49152
    v_mfma_f32_16x16x32_bf16 a[8:11], v[32:35], v[8:11], a[8:11]
    ds_read_b64_tr_b16 v[66:67], v128 offset:57344
    v_mfma_f32_16x16x32_bf16 a[12:15], v[32:35], v[12:15], a[12:15]
    ds_read_b64_tr_b16 v[68:69], v129 offset:49152
    v_mfma_f32_16x16x32_bf16 a[16:19], v[32:35], v[16:19], a[16:19]
    ds_read_b64_tr_b16 v[70:71], v129 offset:57344
    v_mfma_f32_16x16x32_bf16 a[20:23], v[32:35], v[20:23], a[20:23]
    ds_read_b64_tr_b16 v[72:73], v130 offset:49152
    v_mfma_f32_16x16x32_bf16 a[24:27], v[32:35], v[24:27], a[24:27]
    ds_read_b64_tr_b16 v[74:75], v130 offset:57344
    v_mfma_f32_16x16x32_bf16 a[28:31], v[32:35], v[28:31], a[28:31]
    ds_read_b64_tr_b16 v[76:77], v131 offset:49152
    v_mfma_f32_16x16x32_bf16 a[32:35], v[36:39], v[0:3], a[32:35]
    ds_read_b64_tr_b16 v[78:79], v131 offset:57344
    v_mfma_f32_16x16x32_bf16 a[36:39], v[36:39], v[4:7], a[36:39]
    ds_read_b64_tr_b16 v[80:81], v132 offset:49152
    v_mfma_f32_16x16x32_bf16 a[40:43], v[36:39], v[8:11], a[40:43]
    ds_read_b64_tr_b16 v[82:83], v132 offset:57344
    v_mfma_f32_16x16x32_bf16 a[44:47], v[36:39], v[12:15], a[44:47]
    ds_read_b64_tr_b16 v[84:85], v133 offset:49152
    v_mfma_f32_16x16x32_bf16 a[48:51], v[36:39], v[16:19], a[48:51]
    ds_read_b64_tr_b16 v[86:87], v133 offset:57344
    v_mfma_f32_16x16x32_bf16 a[52:55], v[36:39], v[20:23], a[52:55]
    ds_read_b64_tr_b16 v[88:89], v134 offset:49152
    v_mfma_f32_16x16x32_bf16 a[56:59], v[36:39], v[24:27], a[56:59]
    ds_read_b64_tr_b16 v[90:91], v134 offset:57344
    v_mfma_f32_16x16x32_bf16 a[60:63], v[36:39], v[28:31], a[60:63]
    ds_read_b64_tr_b16 v[92:93], v135 offset:49152
    v_mfma_f32_16x16x32_bf16 a[64:67], v[40:43], v[0:3], a[64:67]
    ds_read_b64_tr_b16 v[94:95], v135 offset:57344
    v_mfma_f32_16x16x32_bf16 a[68:71], v[40:43], v[4:7], a[68:71]
    ds_read_b128 v[100:103], v136 offset:50176
    v_mfma_f32_16x16x32_bf16 a[72:75], v[40:43], v[8:11], a[72:75]
    ds_read_b128 v[104:107], v136 offset:51200
    v_mfma_f32_16x16x32_bf16 a[76:79], v[40:43], v[12:15], a[76:79]
    ds_read_b128 v[108:111], v136 offset:52224
    v_mfma_f32_16x16x32_bf16 a[80:83], v[40:43], v[16:19], a[80:83]
    ds_read_b128 v[112:115], v136 offset:53248
    v_mfma_f32_16x16x32_bf16 a[84:87], v[40:43], v[20:23], a[84:87]
    ds_read_b128 v[116:119], v136 offset:54272
    v_mfma_f32_16x16x32_bf16 a[88:91], v[40:43], v[24:27], a[88:91]
    ds_read_b128 v[120:123], v136 offset:55296
    v_mfma_f32_16x16x32_bf16 a[92:95], v[40:43], v[28:31], a[92:95]
    ds_read_b128 v[124:127], v136 offset:56320
    v_mfma_f32_16x16x32_bf16 a[96:99], v[44:47], v[0:3], a[96:99]
    v_mfma_f32_16x16x32_bf16 a[100:103], v[44:47], v[4:7], a[100:103]
    v_mfma_f32_16x16x32_bf16 a[104:107], v[44:47], v[8:11], a[104:107]
    v_mfma_f32_16x16x32_bf16 a[108:111], v[44:47], v[12:15], a[108:111]
    v_mfma_f32_16x16x32_bf16 a[112:115], v[44:47], v[16:19], a[112:115]
    v_mfma_f32_16x16x32_bf16 a[116:119], v[44:47], v[20:23], a[116:119]
    v_mfma_f32_16x16x32_bf16 a[120:123], v[44:47], v[24:27], a[120:123]
    v_mfma_f32_16x16x32_bf16 a[124:127], v[44:47], v[28:31], a[124:127]
    v_mfma_f32_16x16x32_bf16 a[128:131], v[48:51], v[0:3], a[128:131]
    v_mfma_f32_16x16x32_bf16 a[132:135], v[48:51], v[4:7], a[132:135]
    v_mfma_f32_16x16x32_bf16 a[136:139], v[48:51], v[8:11], a[136:139]
    v_mfma_f32_16x16x32_bf16 a[140:143], v[48:51], v[12:15], a[140:143]
    v_mfma_f32_16x16x32_bf16 a[144:147], v[48:51], v[16:19], a[144:147]
    v_mfma_f32_16x16x32_bf16 a[148:151], v[48:51], v[20:23], a[148:151]
    v_mfma_f32_16x16x32_bf16 a[152:155], v[48:51], v[24:27], a[152:155]
    v_mfma_f32_16x16x32_bf16 a[156:159], v[48:51], v[28:31], a[156:159]
    v_mfma_f32_16x16x32_bf16 a[160:163], v[52:55], v[0:3], a[160:163]
    v_mfma_f32_16x16x32_bf16 a[164:167], v[52:55], v[4:7], a[164:167]
    v_mfma_f32_16x16x32_bf16 a[168:171], v[52:55], v[8:11], a[168:171]
    v_mfma_f32_16x16x32_bf16 a[172:175], v[52:55], v[12:15], a[172:175]
    v_mfma_f32_16x16x32_bf16 a[176:179], v[52:55], v[16:19], a[176:179]
    v_mfma_f32_16x16x32_bf16 a[180:183], v[52:55], v[20:23], a[180:183]
    v_mfma_f32_16x16x32_bf16 a[184:187], v[52:55], v[24:27], a[184:187]
    v_mfma_f32_16x16x32_bf16 a[188:191], v[52:55], v[28:31], a[188:191]
    v_mfma_f32_16x16x32_bf16 a[192:195], v[56:59], v[0:3], a[192:195]
    v_mfma_f32_16x16x32_bf16 a[196:199], v[56:59], v[4:7], a[196:199]
    v_mfma_f32_16x16x32_bf16 a[200:203], v[56:59], v[8:11], a[200:203]
    v_mfma_f32_16x16x32_bf16 a[204:207], v[56:59], v[12:15], a[204:207]
    v_mfma_f32_16x16x32_bf16 a[208:211], v[56:59], v[16:19], a[208:211]
    v_mfma_f32_16x16x32_bf16 a[212:215], v[56:59], v[20:23], a[212:215]
    v_mfma_f32_16x16x32_bf16 a[216:219], v[56:59], v[24:27], a[216:219]
    v_mfma_f32_16x16x32_bf16 a[220:223], v[56:59], v[28:31], a[220:223]
    v_mfma_f32_16x16x32_bf16 a[224:227], v[60:63], v[0:3], a[224:227]
    v_mfma_f32_16x16x32_bf16 a[228:231], v[60:63], v[4:7], a[228:231]
    v_mfma_f32_16x16x32_bf16 a[232:235], v[60:63], v[8:11], a[232:235]
    v_mfma_f32_16x16x32_bf16 a[236:239], v[60:63], v[12:15], a[236:239]
    v_mfma_f32_16x16x32_bf16 a[240:243], v[60:63], v[16:19], a[240:243]
    v_mfma_f32_16x16x32_bf16 a[244:247], v[60:63], v[20:23], a[244:247]
    v_mfma_f32_16x16x32_bf16 a[248:251], v[60:63], v[24:27], a[248:251]
    v_mfma_f32_16x16x32_bf16 a[252:255], v[60:63], v[28:31], a[252:255]
    v_readfirstlane_b32 s55, v255
    s_waitcnt lgkmcnt(0)
    v_mfma_f32_16x16x32_bf16 a[0:3], v[96:99], v[64:67], a[0:3]
    v_mfma_f32_16x16x32_bf16 a[4:7], v[96:99], v[68:71], a[4:7]
    v_mfma_f32_16x16x32_bf16 a[8:11], v[96:99], v[72:75], a[8:11]
    v_mfma_f32_16x16x32_bf16 a[12:15], v[96:99], v[76:79], a[12:15]
    v_mfma_f32_16x16x32_bf16 a[16:19], v[96:99], v[80:83], a[16:19]
    v_mfma_f32_16x16x32_bf16 a[20:23], v[96:99], v[84:87], a[20:23]
    v_mfma_f32_16x16x32_bf16 a[24:27], v[96:99], v[88:91], a[24:27]
    v_mfma_f32_16x16x32_bf16 a[28:31], v[96:99], v[92:95], a[28:31]
    v_mfma_f32_16x16x32_bf16 a[32:35], v[100:103], v[64:67], a[32:35]
    v_mfma_f32_16x16x32_bf16 a[36:39], v[100:103], v[68:71], a[36:39]
    v_mfma_f32_16x16x32_bf16 a[40:43], v[100:103], v[72:75], a[40:43]
    v_mfma_f32_16x16x32_bf16 a[44:47], v[100:103], v[76:79], a[44:47]
    v_mfma_f32_16x16x32_bf16 a[48:51], v[100:103], v[80:83], a[48:51]
    v_mfma_f32_16x16x32_bf16 a[52:55], v[100:103], v[84:87], a[52:55]
    v_mfma_f32_16x16x32_bf16 a[56:59], v[100:103], v[88:91], a[56:59]
    v_mfma_f32_16x16x32_bf16 a[60:63], v[100:103], v[92:95], a[60:63]
    v_mfma_f32_16x16x32_bf16 a[64:67], v[104:107], v[64:67], a[64:67]
    v_mfma_f32_16x16x32_bf16 a[68:71], v[104:107], v[68:71], a[68:71]
    v_mfma_f32_16x16x32_bf16 a[72:75], v[104:107], v[72:75], a[72:75]
    v_mfma_f32_16x16x32_bf16 a[76:79], v[104:107], v[76:79], a[76:79]
    v_mfma_f32_16x16x32_bf16 a[80:83], v[104:107], v[80:83], a[80:83]
    v_mfma_f32_16x16x32_bf16 a[84:87], v[104:107], v[84:87], a[84:87]
    v_mfma_f32_16x16x32_bf16 a[88:91], v[104:107], v[88:91], a[88:91]
    v_mfma_f32_16x16x32_bf16 a[92:95], v[104:107], v[92:95], a[92:95]
    v_mfma_f32_16x16x32_bf16 a[96:99], v[108:111], v[64:67], a[96:99]
    v_mfma_f32_16x16x32_bf16 a[100:103], v[108:111], v[68:71], a[100:103]
    v_mfma_f32_16x16x32_bf16 a[104:107], v[108:111], v[72:75], a[104:107]
    v_mfma_f32_16x16x32_bf16 a[108:111], v[108:111], v[76:79], a[108:111]
    v_mfma_f32_16x16x32_bf16 a[112:115], v[108:111], v[80:83], a[112:115]
    v_mfma_f32_16x16x32_bf16 a[116:119], v[108:111], v[84:87], a[116:119]
    v_mfma_f32_16x16x32_bf16 a[120:123], v[108:111], v[88:91], a[120:123]
    v_mfma_f32_16x16x32_bf16 a[124:127], v[108:111], v[92:95], a[124:127]
    v_mfma_f32_16x16x32_bf16 a[128:131], v[112:115], v[64:67], a[128:131]
    v_mfma_f32_16x16x32_bf16 a[132:135], v[112:115], v[68:71], a[132:135]
    v_mfma_f32_16x16x32_bf16 a[136:139], v[112:115], v[72:75], a[136:139]
    v_mfma_f32_16x16x32_bf16 a[140:143], v[112:115], v[76:79], a[140:143]
    v_mfma_f32_16x16x32_bf16 a[144:147], v[112:115], v[80:83], a[144:147]
    v_mfma_f32_16x16x32_bf16 a[148:151], v[112:115], v[84:87], a[148:151]
    v_mfma_f32_16x16x32_bf16 a[152:155], v[112:115], v[88:91], a[152:155]
    v_mfma_f32_16x16x32_bf16 a[156:159], v[112:115], v[92:95], a[156:159]
    v_mfma_f32_16x16x32_bf16 a[160:163], v[116:119], v[64:67], a[160:163]
    v_mfma_f32_16x16x32_bf16 a[164:167], v[116:119], v[68:71], a[164:167]
    v_mfma_f32_16x16x32_bf16 a[168:171], v[116:119], v[72:75], a[168:171]
    v_mfma_f32_16x16x32_bf16 a[172:175], v[116:119], v[76:79], a[172:175]
    v_mfma_f32_16x16x32_bf16 a[176:179], v[116:119], v[80:83], a[176:179]
    v_mfma_f32_16x16x32_bf16 a[180:183], v[116:119], v[84:87], a[180:183]
    v_mfma_f32_16x16x32_bf16 a[184:187], v[116:119], v[88:91], a[184:187]
    v_mfma_f32_16x16x32_bf16 a[188:191], v[116:119], v[92:95], a[188:191]
    v_mfma_f32_16x16x32_bf16 a[192:195], v[120:123], v[64:67], a[192:195]
    v_mfma_f32_16x16x32_bf16 a[196:199], v[120:123], v[68:71], a[196:199]
    v_mfma_f32_16x16x32_bf16 a[200:203], v[120:123], v[72:75], a[200:203]
    v_mfma_f32_16x16x32_bf16 a[204:207], v[120:123], v[76:79], a[204:207]
    v_mfma_f32_16x16x32_bf16 a[208:211], v[120:123], v[80:83], a[208:211]
    v_mfma_f32_16x16x32_bf16 a[212:215], v[120:123], v[84:87], a[212:215]
    v_mfma_f32_16x16x32_bf16 a[216:219], v[120:123], v[88:91], a[216:219]
    v_mfma_f32_16x16x32_bf16 a[220:223], v[120:123], v[92:95], a[220:223]
    v_mfma_f32_16x16x32_bf16 a[224:227], v[124:127], v[64:67], a[224:227]
    v_mfma_f32_16x16x32_bf16 a[228:231], v[124:127], v[68:71], a[228:231]
    v_mfma_f32_16x16x32_bf16 a[232:235], v[124:127], v[72:75], a[232:235]
    v_mfma_f32_16x16x32_bf16 a[236:239], v[124:127], v[76:79], a[236:239]
    v_mfma_f32_16x16x32_bf16 a[240:243], v[124:127], v[80:83], a[240:243]
    v_mfma_f32_16x16x32_bf16 a[244:247], v[124:127], v[84:87], a[244:247]
    v_mfma_f32_16x16x32_bf16 a[248:251], v[124:127], v[88:91], a[248:251]
    v_mfma_f32_16x16x32_bf16 a[252:255], v[124:127], v[92:95], a[252:255]
    s_nop 7
    s_mov_b32 s53, s21
    v_accvgpr_read_b32 v0, a0
    v_accvgpr_read_b32 v1, a1
    v_accvgpr_read_b32 v2, a2
    v_accvgpr_read_b32 v3, a3
    v_accvgpr_read_b32 v4, a32
    v_accvgpr_read_b32 v5, a33
    v_accvgpr_read_b32 v6, a34
    v_accvgpr_read_b32 v7, a35
    v_cvt_pk_bf16_f32 v8, v0, v1
    v_cvt_pk_bf16_f32 v9, v2, v3
    v_cvt_pk_bf16_f32 v10, v4, v5
    v_cvt_pk_bf16_f32 v11, v6, v7
    buffer_store_dwordx4 v[8:11], v251, s[4:7], s53 offen offset:0 sc1
    v_accvgpr_read_b32 v16, a4
    v_accvgpr_read_b32 v17, a5
    v_accvgpr_read_b32 v18, a6
    v_accvgpr_read_b32 v19, a7
    v_accvgpr_read_b32 v20, a36
    v_accvgpr_read_b32 v21, a37
    v_accvgpr_read_b32 v22, a38
    v_accvgpr_read_b32 v23, a39
    v_cvt_pk_bf16_f32 v24, v16, v17
    v_cvt_pk_bf16_f32 v25, v18, v19
    v_cvt_pk_bf16_f32 v26, v20, v21
    v_cvt_pk_bf16_f32 v27, v22, v23
    buffer_store_dwordx4 v[24:27], v251, s[4:7], s53 offen offset:1024 sc1
    v_accvgpr_read_b32 v32, a8
    v_accvgpr_read_b32 v33, a9
    v_accvgpr_read_b32 v34, a10
    v_accvgpr_read_b32 v35, a11
    v_accvgpr_read_b32 v36, a40
    v_accvgpr_read_b32 v37, a41
    v_accvgpr_read_b32 v38, a42
    v_accvgpr_read_b32 v39, a43
    v_cvt_pk_bf16_f32 v40, v32, v33
    v_cvt_pk_bf16_f32 v41, v34, v35
    v_cvt_pk_bf16_f32 v42, v36, v37
    v_cvt_pk_bf16_f32 v43, v38, v39
    buffer_store_dwordx4 v[40:43], v251, s[4:7], s53 offen offset:2048 sc1
    v_accvgpr_read_b32 v48, a12
    v_accvgpr_read_b32 v49, a13
    v_accvgpr_read_b32 v50, a14
    v_accvgpr_read_b32 v51, a15
    v_accvgpr_read_b32 v52, a44
    v_accvgpr_read_b32 v53, a45
    v_accvgpr_read_b32 v54, a46
    v_accvgpr_read_b32 v55, a47
    v_cvt_pk_bf16_f32 v56, v48, v49
    v_cvt_pk_bf16_f32 v57, v50, v51
    v_cvt_pk_bf16_f32 v58, v52, v53
    v_cvt_pk_bf16_f32 v59, v54, v55
    buffer_store_dwordx4 v[56:59], v251, s[4:7], s53 offen offset:3072 sc1
    s_add_u32 s53, s53, 4096
    v_accvgpr_read_b32 v0, a16
    v_accvgpr_read_b32 v1, a17
    v_accvgpr_read_b32 v2, a18
    v_accvgpr_read_b32 v3, a19
    v_accvgpr_read_b32 v4, a48
    v_accvgpr_read_b32 v5, a49
    v_accvgpr_read_b32 v6, a50
    v_accvgpr_read_b32 v7, a51
    v_cvt_pk_bf16_f32 v8, v0, v1
    v_cvt_pk_bf16_f32 v9, v2, v3
    v_cvt_pk_bf16_f32 v10, v4, v5
    v_cvt_pk_bf16_f32 v11, v6, v7
    buffer_store_dwordx4 v[8:11], v251, s[4:7], s53 offen offset:0 sc1
    v_accvgpr_read_b32 v16, a20
    v_accvgpr_read_b32 v17, a21
    v_accvgpr_read_b32 v18, a22
    v_accvgpr_read_b32 v19, a23
    v_accvgpr_read_b32 v20, a52
    v_accvgpr_read_b32 v21, a53
    v_accvgpr_read_b32 v22, a54
    v_accvgpr_read_b32 v23, a55
    v_cvt_pk_bf16_f32 v24, v16, v17
    v_cvt_pk_bf16_f32 v25, v18, v19
    v_cvt_pk_bf16_f32 v26, v20, v21
    v_cvt_pk_bf16_f32 v27, v22, v23
    buffer_store_dwordx4 v[24:27], v251, s[4:7], s53 offen offset:1024 sc1
    v_accvgpr_read_b32 v32, a24
    v_accvgpr_read_b32 v33, a25
    v_accvgpr_read_b32 v34, a26
    v_accvgpr_read_b32 v35, a27
    v_accvgpr_read_b32 v36, a56
    v_accvgpr_read_b32 v37, a57
    v_accvgpr_read_b32 v38, a58
    v_accvgpr_read_b32 v39, a59
    v_cvt_pk_bf16_f32 v40, v32, v33
    v_cvt_pk_bf16_f32 v41, v34, v35
    v_cvt_pk_bf16_f32 v42, v36, v37
    v_cvt_pk_bf16_f32 v43, v38, v39
    buffer_store_dwordx4 v[40:43], v251, s[4:7], s53 offen offset:2048 sc1
    v_accvgpr_read_b32 v48, a28
    v_accvgpr_read_b32 v49, a29
    v_accvgpr_read_b32 v50, a30
    v_accvgpr_read_b32 v51, a31
    v_accvgpr_read_b32 v52, a60
    v_accvgpr_read_b32 v53, a61
    v_accvgpr_read_b32 v54, a62
    v_accvgpr_read_b32 v55, a63
    v_cvt_pk_bf16_f32 v56, v48, v49
    v_cvt_pk_bf16_f32 v57, v50, v51
    v_cvt_pk_bf16_f32 v58, v52, v53
    v_cvt_pk_bf16_f32 v59, v54, v55
    buffer_store_dwordx4 v[56:59], v251, s[4:7], s53 offen offset:3072 sc1
    s_add_u32 s53, s53, 258048
    v_accvgpr_read_b32 v0, a64
    v_accvgpr_read_b32 v1, a65
    v_accvgpr_read_b32 v2, a66
    v_accvgpr_read_b32 v3, a67
    v_accvgpr_read_b32 v4, a96
    v_accvgpr_read_b32 v5, a97
    v_accvgpr_read_b32 v6, a98
    v_accvgpr_read_b32 v7, a99
    v_cvt_pk_bf16_f32 v8, v0, v1
    v_cvt_pk_bf16_f32 v9, v2, v3
    v_cvt_pk_bf16_f32 v10, v4, v5
    v_cvt_pk_bf16_f32 v11, v6, v7
    buffer_store_dwordx4 v[8:11], v251, s[4:7], s53 offen offset:0 sc1
    v_accvgpr_read_b32 v16, a68
    v_accvgpr_read_b32 v17, a69
    v_accvgpr_read_b32 v18, a70
    v_accvgpr_read_b32 v19, a71
    v_accvgpr_read_b32 v20, a100
    v_accvgpr_read_b32 v21, a101
    v_accvgpr_read_b32 v22, a102
    v_accvgpr_read_b32 v23, a103
    v_cvt_pk_bf16_f32 v24, v16, v17
    v_cvt_pk_bf16_f32 v25, v18, v19
    v_cvt_pk_bf16_f32 v26, v20, v21
    v_cvt_pk_bf16_f32 v27, v22, v23
    buffer_store_dwordx4 v[24:27], v251, s[4:7], s53 offen offset:1024 sc1
    v_accvgpr_read_b32 v32, a72
    v_accvgpr_read_b32 v33, a73
    v_accvgpr_read_b32 v34, a74
    v_accvgpr_read_b32 v35, a75
    v_accvgpr_read_b32 v36, a104
    v_accvgpr_read_b32 v37, a105
    v_accvgpr_read_b32 v38, a106
    v_accvgpr_read_b32 v39, a107
    v_cvt_pk_bf16_f32 v40, v32, v33
    v_cvt_pk_bf16_f32 v41, v34, v35
    v_cvt_pk_bf16_f32 v42, v36, v37
    v_cvt_pk_bf16_f32 v43, v38, v39
    buffer_store_dwordx4 v[40:43], v251, s[4:7], s53 offen offset:2048 sc1
    v_accvgpr_read_b32 v48, a76
    v_accvgpr_read_b32 v49, a77
    v_accvgpr_read_b32 v50, a78
    v_accvgpr_read_b32 v51, a79
    v_accvgpr_read_b32 v52, a108
    v_accvgpr_read_b32 v53, a109
    v_accvgpr_read_b32 v54, a110
    v_accvgpr_read_b32 v55, a111
    v_cvt_pk_bf16_f32 v56, v48, v49
    v_cvt_pk_bf16_f32 v57, v50, v51
    v_cvt_pk_bf16_f32 v58, v52, v53
    v_cvt_pk_bf16_f32 v59, v54, v55
    buffer_store_dwordx4 v[56:59], v251, s[4:7], s53 offen offset:3072 sc1
    s_add_u32 s53, s53, 4096
    v_accvgpr_read_b32 v0, a80
    v_accvgpr_read_b32 v1, a81
    v_accvgpr_read_b32 v2, a82
    v_accvgpr_read_b32 v3, a83
    v_accvgpr_read_b32 v4, a112
    v_accvgpr_read_b32 v5, a113
    v_accvgpr_read_b32 v6, a114
    v_accvgpr_read_b32 v7, a115
    v_cvt_pk_bf16_f32 v8, v0, v1
    v_cvt_pk_bf16_f32 v9, v2, v3
    v_cvt_pk_bf16_f32 v10, v4, v5
    v_cvt_pk_bf16_f32 v11, v6, v7
    buffer_store_dwordx4 v[8:11], v251, s[4:7], s53 offen offset:0 sc1
    v_accvgpr_read_b32 v16, a84
    v_accvgpr_read_b32 v17, a85
    v_accvgpr_read_b32 v18, a86
    v_accvgpr_read_b32 v19, a87
    v_accvgpr_read_b32 v20, a116
    v_accvgpr_read_b32 v21, a117
    v_accvgpr_read_b32 v22, a118
    v_accvgpr_read_b32 v23, a119
    v_cvt_pk_bf16_f32 v24, v16, v17
    v_cvt_pk_bf16_f32 v25, v18, v19
    v_cvt_pk_bf16_f32 v26, v20, v21
    v_cvt_pk_bf16_f32 v27, v22, v23
    buffer_store_dwordx4 v[24:27], v251, s[4:7], s53 offen offset:1024 sc1
    v_accvgpr_read_b32 v32, a88
    v_accvgpr_read_b32 v33, a89
    v_accvgpr_read_b32 v34, a90
    v_accvgpr_read_b32 v35, a91
    v_accvgpr_read_b32 v36, a120
    v_accvgpr_read_b32 v37, a121
    v_accvgpr_read_b32 v38, a122
    v_accvgpr_read_b32 v39, a123
    v_cvt_pk_bf16_f32 v40, v32, v33
    v_cvt_pk_bf16_f32 v41, v34, v35
    v_cvt_pk_bf16_f32 v42, v36, v37
    v_cvt_pk_bf16_f32 v43, v38, v39
    buffer_store_dwordx4 v[40:43], v251, s[4:7], s53 offen offset:2048 sc1
    v_accvgpr_read_b32 v48, a92
    v_accvgpr_read_b32 v49, a93
    v_accvgpr_read_b32 v50, a94
    v_accvgpr_read_b32 v51, a95
    v_accvgpr_read_b32 v52, a124
    v_accvgpr_read_b32 v53, a125
    v_accvgpr_read_b32 v54, a126
    v_accvgpr_read_b32 v55, a127
    v_cvt_pk_bf16_f32 v56, v48, v49
    v_cvt_pk_bf16_f32 v57, v50, v51
    v_cvt_pk_bf16_f32 v58, v52, v53
    v_cvt_pk_bf16_f32 v59, v54, v55
    buffer_store_dwordx4 v[56:59], v251, s[4:7], s53 offen offset:3072 sc1
    s_add_u32 s53, s53, 258048
    v_accvgpr_read_b32 v0, a128
    v_accvgpr_read_b32 v1, a129
    v_accvgpr_read_b32 v2, a130
    v_accvgpr_read_b32 v3, a131
    v_accvgpr_read_b32 v4, a160
    v_accvgpr_read_b32 v5, a161
    v_accvgpr_read_b32 v6, a162
    v_accvgpr_read_b32 v7, a163
    v_cvt_pk_bf16_f32 v8, v0, v1
    v_cvt_pk_bf16_f32 v9, v2, v3
    v_cvt_pk_bf16_f32 v10, v4, v5
    v_cvt_pk_bf16_f32 v11, v6, v7
    buffer_store_dwordx4 v[8:11], v251, s[4:7], s53 offen offset:0 sc1
    v_accvgpr_read_b32 v16, a132
    v_accvgpr_read_b32 v17, a133
    v_accvgpr_read_b32 v18, a134
    v_accvgpr_read_b32 v19, a135
    v_accvgpr_read_b32 v20, a164
    v_accvgpr_read_b32 v21, a165
    v_accvgpr_read_b32 v22, a166
    v_accvgpr_read_b32 v23, a167
    v_cvt_pk_bf16_f32 v24, v16, v17
    v_cvt_pk_bf16_f32 v25, v18, v19
    v_cvt_pk_bf16_f32 v26, v20, v21
    v_cvt_pk_bf16_f32 v27, v22, v23
    buffer_store_dwordx4 v[24:27], v251, s[4:7], s53 offen offset:1024 sc1
    v_accvgpr_read_b32 v32, a136
    v_accvgpr_read_b32 v33, a137
    v_accvgpr_read_b32 v34, a138
    v_accvgpr_read_b32 v35, a139
    v_accvgpr_read_b32 v36, a168
    v_accvgpr_read_b32 v37, a169
    v_accvgpr_read_b32 v38, a170
    v_accvgpr_read_b32 v39, a171
    v_cvt_pk_bf16_f32 v40, v32, v33
    v_cvt_pk_bf16_f32 v41, v34, v35
    v_cvt_pk_bf16_f32 v42, v36, v37
    v_cvt_pk_bf16_f32 v43, v38, v39
    buffer_store_dwordx4 v[40:43], v251, s[4:7], s53 offen offset:2048 sc1
    v_accvgpr_read_b32 v48, a140
    v_accvgpr_read_b32 v49, a141
    v_accvgpr_read_b32 v50, a142
    v_accvgpr_read_b32 v51, a143
    v_accvgpr_read_b32 v52, a172
    v_accvgpr_read_b32 v53, a173
    v_accvgpr_read_b32 v54, a174
    v_accvgpr_read_b32 v55, a175
    v_cvt_pk_bf16_f32 v56, v48, v49
    v_cvt_pk_bf16_f32 v57, v50, v51
    v_cvt_pk_bf16_f32 v58, v52, v53
    v_cvt_pk_bf16_f32 v59, v54, v55
    buffer_store_dwordx4 v[56:59], v251, s[4:7], s53 offen offset:3072 sc1
    s_add_u32 s53, s53, 4096
    v_accvgpr_read_b32 v0, a144
    v_accvgpr_read_b32 v1, a145
    v_accvgpr_read_b32 v2, a146
    v_accvgpr_read_b32 v3, a147
    v_accvgpr_read_b32 v4, a176
    v_accvgpr_read_b32 v5, a177
    v_accvgpr_read_b32 v6, a178
    v_accvgpr_read_b32 v7, a179
    v_cvt_pk_bf16_f32 v8, v0, v1
    v_cvt_pk_bf16_f32 v9, v2, v3
    v_cvt_pk_bf16_f32 v10, v4, v5
    v_cvt_pk_bf16_f32 v11, v6, v7
    buffer_store_dwordx4 v[8:11], v251, s[4:7], s53 offen offset:0 sc1
    v_accvgpr_read_b32 v16, a148
    v_accvgpr_read_b32 v17, a149
    v_accvgpr_read_b32 v18, a150
    v_accvgpr_read_b32 v19, a151
    v_accvgpr_read_b32 v20, a180
    v_accvgpr_read_b32 v21, a181
    v_accvgpr_read_b32 v22, a182
    v_accvgpr_read_b32 v23, a183
    v_cvt_pk_bf16_f32 v24, v16, v17
    v_cvt_pk_bf16_f32 v25, v18, v19
    v_cvt_pk_bf16_f32 v26, v20, v21
    v_cvt_pk_bf16_f32 v27, v22, v23
    buffer_store_dwordx4 v[24:27], v251, s[4:7], s53 offen offset:1024 sc1
    v_accvgpr_read_b32 v32, a152
    v_accvgpr_read_b32 v33, a153
    v_accvgpr_read_b32 v34, a154
    v_accvgpr_read_b32 v35, a155
    v_accvgpr_read_b32 v36, a184
    v_accvgpr_read_b32 v37, a185
    v_accvgpr_read_b32 v38, a186
    v_accvgpr_read_b32 v39, a187
    v_cvt_pk_bf16_f32 v40, v32, v33
    v_cvt_pk_bf16_f32 v41, v34, v35
    v_cvt_pk_bf16_f32 v42, v36, v37
    v_cvt_pk_bf16_f32 v43, v38, v39
    buffer_store_dwordx4 v[40:43], v251, s[4:7], s53 offen offset:2048 sc1
    v_accvgpr_read_b32 v48, a156
    v_accvgpr_read_b32 v49, a157
    v_accvgpr_read_b32 v50, a158
    v_accvgpr_read_b32 v51, a159
    v_accvgpr_read_b32 v52, a188
    v_accvgpr_read_b32 v53, a189
    v_accvgpr_read_b32 v54, a190
    v_accvgpr_read_b32 v55, a191
    v_cvt_pk_bf16_f32 v56, v48, v49
    v_cvt_pk_bf16_f32 v57, v50, v51
    v_cvt_pk_bf16_f32 v58, v52, v53
    v_cvt_pk_bf16_f32 v59, v54, v55
    buffer_store_dwordx4 v[56:59], v251, s[4:7], s53 offen offset:3072 sc1
    s_add_u32 s53, s53, 258048
    v_accvgpr_read_b32 v0, a192
    v_accvgpr_read_b32 v1, a193
    v_accvgpr_read_b32 v2, a194
    v_accvgpr_read_b32 v3, a195
    v_accvgpr_read_b32 v4, a224
    v_accvgpr_read_b32 v5, a225
    v_accvgpr_read_b32 v6, a226
    v_accvgpr_read_b32 v7, a227
    v_cvt_pk_bf16_f32 v8, v0, v1
    v_cvt_pk_bf16_f32 v9, v2, v3
    v_cvt_pk_bf16_f32 v10, v4, v5
    v_cvt_pk_bf16_f32 v11, v6, v7
    buffer_store_dwordx4 v[8:11], v251, s[4:7], s53 offen offset:0 sc1
    v_accvgpr_read_b32 v16, a196
    v_accvgpr_read_b32 v17, a197
    v_accvgpr_read_b32 v18, a198
    v_accvgpr_read_b32 v19, a199
    v_accvgpr_read_b32 v20, a228
    v_accvgpr_read_b32 v21, a229
    v_accvgpr_read_b32 v22, a230
    v_accvgpr_read_b32 v23, a231
    v_cvt_pk_bf16_f32 v24, v16, v17
    v_cvt_pk_bf16_f32 v25, v18, v19
    v_cvt_pk_bf16_f32 v26, v20, v21
    v_cvt_pk_bf16_f32 v27, v22, v23
    buffer_store_dwordx4 v[24:27], v251, s[4:7], s53 offen offset:1024 sc1
    v_accvgpr_read_b32 v32, a200
    v_accvgpr_read_b32 v33, a201
    v_accvgpr_read_b32 v34, a202
    v_accvgpr_read_b32 v35, a203
    v_accvgpr_read_b32 v36, a232
    v_accvgpr_read_b32 v37, a233
    v_accvgpr_read_b32 v38, a234
    v_accvgpr_read_b32 v39, a235
    v_cvt_pk_bf16_f32 v40, v32, v33
    v_cvt_pk_bf16_f32 v41, v34, v35
    v_cvt_pk_bf16_f32 v42, v36, v37
    v_cvt_pk_bf16_f32 v43, v38, v39
    buffer_store_dwordx4 v[40:43], v251, s[4:7], s53 offen offset:2048 sc1
    v_accvgpr_read_b32 v48, a204
    v_accvgpr_read_b32 v49, a205
    v_accvgpr_read_b32 v50, a206
    v_accvgpr_read_b32 v51, a207
    v_accvgpr_read_b32 v52, a236
    v_accvgpr_read_b32 v53, a237
    v_accvgpr_read_b32 v54, a238
    v_accvgpr_read_b32 v55, a239
    v_cvt_pk_bf16_f32 v56, v48, v49
    v_cvt_pk_bf16_f32 v57, v50, v51
    v_cvt_pk_bf16_f32 v58, v52, v53
    v_cvt_pk_bf16_f32 v59, v54, v55
    buffer_store_dwordx4 v[56:59], v251, s[4:7], s53 offen offset:3072 sc1
    s_add_u32 s53, s53, 4096
    v_accvgpr_read_b32 v0, a208
    v_accvgpr_read_b32 v1, a209
    v_accvgpr_read_b32 v2, a210
    v_accvgpr_read_b32 v3, a211
    v_accvgpr_read_b32 v4, a240
    v_accvgpr_read_b32 v5, a241
    v_accvgpr_read_b32 v6, a242
    v_accvgpr_read_b32 v7, a243
    v_cvt_pk_bf16_f32 v8, v0, v1
    v_cvt_pk_bf16_f32 v9, v2, v3
    v_cvt_pk_bf16_f32 v10, v4, v5
    v_cvt_pk_bf16_f32 v11, v6, v7
    buffer_store_dwordx4 v[8:11], v251, s[4:7], s53 offen offset:0 sc1
    v_accvgpr_read_b32 v16, a212
    v_accvgpr_read_b32 v17, a213
    v_accvgpr_read_b32 v18, a214
    v_accvgpr_read_b32 v19, a215
    v_accvgpr_read_b32 v20, a244
    v_accvgpr_read_b32 v21, a245
    v_accvgpr_read_b32 v22, a246
    v_accvgpr_read_b32 v23, a247
    v_cvt_pk_bf16_f32 v24, v16, v17
    v_cvt_pk_bf16_f32 v25, v18, v19
    v_cvt_pk_bf16_f32 v26, v20, v21
    v_cvt_pk_bf16_f32 v27, v22, v23
    buffer_store_dwordx4 v[24:27], v251, s[4:7], s53 offen offset:1024 sc1
    v_accvgpr_read_b32 v32, a216
    v_accvgpr_read_b32 v33, a217
    v_accvgpr_read_b32 v34, a218
    v_accvgpr_read_b32 v35, a219
    v_accvgpr_read_b32 v36, a248
    v_accvgpr_read_b32 v37, a249
    v_accvgpr_read_b32 v38, a250
    v_accvgpr_read_b32 v39, a251
    v_cvt_pk_bf16_f32 v40, v32, v33
    v_cvt_pk_bf16_f32 v41, v34, v35
    v_cvt_pk_bf16_f32 v42, v36, v37
    v_cvt_pk_bf16_f32 v43, v38, v39
    buffer_store_dwordx4 v[40:43], v251, s[4:7], s53 offen offset:2048 sc1
    v_accvgpr_read_b32 v48, a220
    v_accvgpr_read_b32 v49, a221
    v_accvgpr_read_b32 v50, a222
    v_accvgpr_read_b32 v51, a223
    v_accvgpr_read_b32 v52, a252
    v_accvgpr_read_b32 v53, a253
    v_accvgpr_read_b32 v54, a254
    v_accvgpr_read_b32 v55, a255
    v_cvt_pk_bf16_f32 v56, v48, v49
    v_cvt_pk_bf16_f32 v57, v50, v51
    v_cvt_pk_bf16_f32 v58, v52, v53
    v_cvt_pk_bf16_f32 v59, v54, v55
    buffer_store_dwordx4 v[56:59], v251, s[4:7], s53 offen offset:3072 sc1
    s_add_u32 s53, s53, 258048
    s_branch main_kernel_w_done
main_kernel_w_pref:
    s_cmp_lg_u32 s24, 0
    s_cbranch_scc1 main_kernel_w_pf0
    s_mov_b32 s8, s64
    s_and_b32 s9, s65, 0xffff
    s_mov_b32 s10, 0x200000
    s_mov_b32 s11, 0x20000
    s_branch main_kernel_w_pfg
main_kernel_w_pf0:
    s_cmp_lg_u32 s24, 1
    s_cbranch_scc1 main_kernel_w_pf1
    s_mov_b32 s8, s66
    s_and_b32 s9, s67, 0xffff
    s_mov_b32 s10, 0x200000
    s_mov_b32 s11, 0x20000
    s_branch main_kernel_w_pfg
main_kernel_w_pf1:
    s_cmp_lg_u32 s24, 2
    s_cbranch_scc1 main_kernel_w_pf2
    s_mov_b32 s8, s68
    s_and_b32 s9, s69, 0xffff
    s_mov_b32 s10, 0x700000
    s_mov_b32 s11, 0x20000
    s_branch main_kernel_w_pfg
main_kernel_w_pf2:
    s_mov_b32 s8, s70
    s_and_b32 s9, s71, 0xffff
    s_mov_b32 s10, 0x700000
    s_mov_b32 s11, 0x20000
main_kernel_w_pfg:
    s_lshl_b32 s32, s25, 19
    s_lshl_b32 s33, s14, 17
    s_add_u32 s32, s32, s33
    v_lshlrev_b32 v253, 7, v250
    buffer_load_dword v0, v253, s[8:11], s32 offen
    s_add_u32 s32, s32, 8192
    buffer_load_dword v0, v253, s[8:11], s32 offen
    s_add_u32 s32, s32, 8192
    buffer_load_dword v0, v253, s[8:11], s32 offen
    s_add_u32 s32, s32, 8192
    buffer_load_dword v0, v253, s[8:11], s32 offen
    s_add_u32 s32, s32, 8192
    buffer_load_dword v0, v253, s[8:11], s32 offen
    s_add_u32 s32, s32, 8192
    buffer_load_dword v0, v253, s[8:11], s32 offen
    s_add_u32 s32, s32, 8192
    buffer_load_dword v0, v253, s[8:11], s32 offen
    s_add_u32 s32, s32, 8192
    buffer_load_dword v0, v253, s[8:11], s32 offen
    s_add_u32 s32, s32, 8192
    buffer_load_dword v0, v253, s[8:11], s32 offen
    s_add_u32 s32, s32, 8192
    buffer_load_dword v0, v253, s[8:11], s32 offen
    s_add_u32 s32, s32, 8192
    buffer_load_dword v0, v253, s[8:11], s32 offen
    s_add_u32 s32, s32, 8192
    buffer_load_dword v0, v253, s[8:11], s32 offen
    s_add_u32 s32, s32, 8192
    buffer_load_dword v0, v253, s[8:11], s32 offen
    s_add_u32 s32, s32, 8192
    buffer_load_dword v0, v253, s[8:11], s32 offen
    s_add_u32 s32, s32, 8192
    buffer_load_dword v0, v253, s[8:11], s32 offen
    s_add_u32 s32, s32, 8192
    buffer_load_dword v0, v253, s[8:11], s32 offen
    s_add_u32 s32, s32, 8192
    s_branch main_kernel_w_done
main_kernel_w_fill:
    s_lshl_b32 s32, s24, 2
    s_add_u32 s32, s32, s25
    s_lshl_b32 s33, s32, 16
    s_add_u32 s32, s33, 0x6e00000
    s_add_u32 s35, s33, 0x8c00000
    s_add_u32 s33, s33, 0x8000000
    s_lshl_b32 s34, s14, 12
    v_add_u32 v253, s34, v251
    v_mov_b32 v0, -1
    v_mov_b32 v1, -1
    v_mov_b32 v2, -1
    v_mov_b32 v3, -1
    s_mov_b32 s18, 4
main_kernel_w_fl:
    buffer_store_dwordx4 v[0:3], v253, s[4:7], s32 offen offset:0 sc1
    buffer_store_dwordx4 v[0:3], v253, s[4:7], s32 offen offset:1024 sc1
    buffer_store_dwordx4 v[0:3], v253, s[4:7], s32 offen offset:2048 sc1
    buffer_store_dwordx4 v[0:3], v253, s[4:7], s32 offen offset:3072 sc1
    s_add_u32 s32, s32, 16384
    buffer_store_dwordx4 v[0:3], v253, s[4:7], s33 offen offset:0 sc1
    buffer_store_dwordx4 v[0:3], v253, s[4:7], s33 offen offset:1024 sc1
    buffer_store_dwordx4 v[0:3], v253, s[4:7], s33 offen offset:2048 sc1
    buffer_store_dwordx4 v[0:3], v253, s[4:7], s33 offen offset:3072 sc1
    s_add_u32 s33, s33, 16384
    s_sub_u32 s18, s18, 1
    s_cmp_lg_u32 s18, 0
    s_cbranch_scc1 main_kernel_w_fl
    s_branch main_kernel_w_done
main_kernel_w_ln2:
    s_lshl_b32 s32, s24, 3
    s_mul_i32 s33, s25, 2
    s_add_u32 s32, s32, s33
    s_lshl_b32 s32, s32, 15
    s_lshl_b32 s33, s14, 13
    s_add_u32 s32, s32, s33
    s_add_u32 s21, s32, 0x6800000
    s_add_u32 s32, s32, 0x5000000
    buffer_load_dwordx4 v[0:3], v251, s[4:7], s32 offen offset:0 sc1
    buffer_load_dwordx4 v[4:7], v251, s[4:7], s32 offen offset:1024 sc1
    buffer_load_dwordx4 v[8:11], v251, s[4:7], s32 offen offset:2048 sc1
    buffer_load_dwordx4 v[12:15], v251, s[4:7], s32 offen offset:3072 sc1
    s_add_u32 s32, s32, 4096
    buffer_load_dwordx4 v[16:19], v251, s[4:7], s32 offen offset:0 sc1
    buffer_load_dwordx4 v[20:23], v251, s[4:7], s32 offen offset:1024 sc1
    buffer_load_dwordx4 v[24:27], v251, s[4:7], s32 offen offset:2048 sc1
    buffer_load_dwordx4 v[28:31], v251, s[4:7], s32 offen offset:3072 sc1
    s_add_u32 s32, s32, 28672
    buffer_load_dwordx4 v[32:35], v251, s[4:7], s32 offen offset:0 sc1
    buffer_load_dwordx4 v[36:39], v251, s[4:7], s32 offen offset:1024 sc1
    buffer_load_dwordx4 v[40:43], v251, s[4:7], s32 offen offset:2048 sc1
    buffer_load_dwordx4 v[44:47], v251, s[4:7], s32 offen offset:3072 sc1
    s_add_u32 s32, s32, 4096
    buffer_load_dwordx4 v[48:51], v251, s[4:7], s32 offen offset:0 sc1
    buffer_load_dwordx4 v[52:55], v251, s[4:7], s32 offen offset:1024 sc1
    buffer_load_dwordx4 v[56:59], v251, s[4:7], s32 offen offset:2048 sc1
    buffer_load_dwordx4 v[60:63], v251, s[4:7], s32 offen offset:3072 sc1
    s_add_u32 s32, s32, 28672
    v_and_b32 v255, 15, v250
    v_lshlrev_b32 v254, 6, v255
    v_add_u32 v254, 132096, v254
    v_lshrrev_b32 v255, 4, v250
    v_lshl_add_u32 v253, v255, 2, v254
    v_lshl_add_u32 v253, s14, 4, v253
    s_waitcnt vmcnt(8)
    v_lshlrev_b32 v128, 16, v0
    v_and_b32 v129, 0xffff0000, v0
    v_lshlrev_b32 v130, 16, v1
    v_and_b32 v131, 0xffff0000, v1
    v_lshlrev_b32 v132, 16, v2
    v_and_b32 v133, 0xffff0000, v2
    v_lshlrev_b32 v134, 16, v3
    v_and_b32 v135, 0xffff0000, v3
    v_lshlrev_b32 v136, 16, v4
    v_and_b32 v137, 0xffff0000, v4
    v_lshlrev_b32 v138, 16, v5
    v_and_b32 v139, 0xffff0000, v5
    v_lshlrev_b32 v140, 16, v6
    v_and_b32 v141, 0xffff0000, v6
    v_lshlrev_b32 v142, 16, v7
    v_and_b32 v143, 0xffff0000, v7
    v_lshlrev_b32 v144, 16, v8
    v_and_b32 v145, 0xffff0000, v8
    v_lshlrev_b32 v146, 16, v9
    v_and_b32 v147, 0xffff0000, v9
    v_lshlrev_b32 v148, 16, v10
    v_and_b32 v149, 0xffff0000, v10
    v_lshlrev_b32 v150, 16, v11
    v_and_b32 v151, 0xffff0000, v11
    v_lshlrev_b32 v152, 16, v12
    v_and_b32 v153, 0xffff0000, v12
    v_lshlrev_b32 v154, 16, v13
    v_and_b32 v155, 0xffff0000, v13
    v_lshlrev_b32 v156, 16, v14
    v_and_b32 v157, 0xffff0000, v14
    v_lshlrev_b32 v158, 16, v15
    v_and_b32 v159, 0xffff0000, v15
    v_lshlrev_b32 v160, 16, v16
    v_and_b32 v161, 0xffff0000, v16
    v_lshlrev_b32 v162, 16, v17
    v_and_b32 v163, 0xffff0000, v17
    v_lshlrev_b32 v164, 16, v18
    v_and_b32 v165, 0xffff0000, v18
    v_lshlrev_b32 v166, 16, v19
    v_and_b32 v167, 0xffff0000, v19
    v_lshlrev_b32 v168, 16, v20
    v_and_b32 v169, 0xffff0000, v20
    v_lshlrev_b32 v170, 16, v21
    v_and_b32 v171, 0xffff0000, v21
    v_lshlrev_b32 v172, 16, v22
    v_and_b32 v173, 0xffff0000, v22
    v_lshlrev_b32 v174, 16, v23
    v_and_b32 v175, 0xffff0000, v23
    v_lshlrev_b32 v176, 16, v24
    v_and_b32 v177, 0xffff0000, v24
    v_lshlrev_b32 v178, 16, v25
    v_and_b32 v179, 0xffff0000, v25
    v_lshlrev_b32 v180, 16, v26
    v_and_b32 v181, 0xffff0000, v26
    v_lshlrev_b32 v182, 16, v27
    v_and_b32 v183, 0xffff0000, v27
    v_lshlrev_b32 v184, 16, v28
    v_and_b32 v185, 0xffff0000, v28
    v_lshlrev_b32 v186, 16, v29
    v_and_b32 v187, 0xffff0000, v29
    v_lshlrev_b32 v188, 16, v30
    v_and_b32 v189, 0xffff0000, v30
    v_lshlrev_b32 v190, 16, v31
    v_and_b32 v191, 0xffff0000, v31
    v_pk_add_f32 v[192:193], v[128:129], v[136:137]
    v_pk_add_f32 v[194:195], v[130:131], v[138:139]
    v_pk_add_f32 v[196:197], v[132:133], v[140:141]
    v_pk_add_f32 v[198:199], v[134:135], v[142:143]
    v_pk_add_f32 v[192:193], v[192:193], v[144:145]
    v_pk_add_f32 v[194:195], v[194:195], v[146:147]
    v_pk_add_f32 v[196:197], v[196:197], v[148:149]
    v_pk_add_f32 v[198:199], v[198:199], v[150:151]
    v_pk_add_f32 v[192:193], v[192:193], v[152:153]
    v_pk_add_f32 v[194:195], v[194:195], v[154:155]
    v_pk_add_f32 v[196:197], v[196:197], v[156:157]
    v_pk_add_f32 v[198:199], v[198:199], v[158:159]
    v_pk_add_f32 v[192:193], v[192:193], v[160:161]
    v_pk_add_f32 v[194:195], v[194:195], v[162:163]
    v_pk_add_f32 v[196:197], v[196:197], v[164:165]
    v_pk_add_f32 v[198:199], v[198:199], v[166:167]
    v_pk_add_f32 v[192:193], v[192:193], v[168:169]
    v_pk_add_f32 v[194:195], v[194:195], v[170:171]
    v_pk_add_f32 v[196:197], v[196:197], v[172:173]
    v_pk_add_f32 v[198:199], v[198:199], v[174:175]
    v_pk_add_f32 v[192:193], v[192:193], v[176:177]
    v_pk_add_f32 v[194:195], v[194:195], v[178:179]
    v_pk_add_f32 v[196:197], v[196:197], v[180:181]
    v_pk_add_f32 v[198:199], v[198:199], v[182:183]
    v_pk_add_f32 v[192:193], v[192:193], v[184:185]
    v_pk_add_f32 v[194:195], v[194:195], v[186:187]
    v_pk_add_f32 v[196:197], v[196:197], v[188:189]
    v_pk_add_f32 v[198:199], v[198:199], v[190:191]
    v_pk_add_f32 v[192:193], v[192:193], v[194:195]
    v_pk_add_f32 v[196:197], v[196:197], v[198:199]
    v_pk_add_f32 v[192:193], v[192:193], v[196:197]
    v_add_f32 v192, v192, v193
    ds_write_b32 v253, v192 offset:0
    s_waitcnt lgkmcnt(0)
    s_barrier
    ds_read_b128 v[192:195], v254 offset:0
    ds_read_b128 v[196:199], v254 offset:16
    ds_read_b128 v[200:203], v254 offset:32
    ds_read_b128 v[204:207], v254 offset:48
    s_waitcnt lgkmcnt(2)
    v_pk_add_f32 v[192:193], v[192:193], v[194:195]
    v_pk_add_f32 v[196:197], v[196:197], v[198:199]
    s_waitcnt lgkmcnt(0)
    v_pk_add_f32 v[200:201], v[200:201], v[202:203]
    v_pk_add_f32 v[204:205], v[204:205], v[206:207]
    v_pk_add_f32 v[192:193], v[192:193], v[196:197]
    v_pk_add_f32 v[200:201], v[200:201], v[204:205]
    v_pk_add_f32 v[192:193], v[192:193], v[200:201]
    v_add_f32 v192, v192, v193
    v_mul_f32 v192, 0xba800000, v192
    v_mov_b32 v193, v192
    v_pk_add_f32 v[128:129], v[128:129], v[192:193]
    v_pk_add_f32 v[130:131], v[130:131], v[192:193]
    v_pk_add_f32 v[132:133], v[132:133], v[192:193]
    v_pk_add_f32 v[134:135], v[134:135], v[192:193]
    v_pk_add_f32 v[136:137], v[136:137], v[192:193]
    v_pk_add_f32 v[138:139], v[138:139], v[192:193]
    v_pk_add_f32 v[140:141], v[140:141], v[192:193]
    v_pk_add_f32 v[142:143], v[142:143], v[192:193]
    v_pk_add_f32 v[144:145], v[144:145], v[192:193]
    v_pk_add_f32 v[146:147], v[146:147], v[192:193]
    v_pk_add_f32 v[148:149], v[148:149], v[192:193]
    v_pk_add_f32 v[150:151], v[150:151], v[192:193]
    v_pk_add_f32 v[152:153], v[152:153], v[192:193]
    v_pk_add_f32 v[154:155], v[154:155], v[192:193]
    v_pk_add_f32 v[156:157], v[156:157], v[192:193]
    v_pk_add_f32 v[158:159], v[158:159], v[192:193]
    v_pk_add_f32 v[160:161], v[160:161], v[192:193]
    v_pk_add_f32 v[162:163], v[162:163], v[192:193]
    v_pk_add_f32 v[164:165], v[164:165], v[192:193]
    v_pk_add_f32 v[166:167], v[166:167], v[192:193]
    v_pk_add_f32 v[168:169], v[168:169], v[192:193]
    v_pk_add_f32 v[170:171], v[170:171], v[192:193]
    v_pk_add_f32 v[172:173], v[172:173], v[192:193]
    v_pk_add_f32 v[174:175], v[174:175], v[192:193]
    v_pk_add_f32 v[176:177], v[176:177], v[192:193]
    v_pk_add_f32 v[178:179], v[178:179], v[192:193]
    v_pk_add_f32 v[180:181], v[180:181], v[192:193]
    v_pk_add_f32 v[182:183], v[182:183], v[192:193]
    v_pk_add_f32 v[184:185], v[184:185], v[192:193]
    v_pk_add_f32 v[186:187], v[186:187], v[192:193]
    v_pk_add_f32 v[188:189], v[188:189], v[192:193]
    v_pk_add_f32 v[190:191], v[190:191], v[192:193]
    v_pk_mul_f32 v[192:193], v[128:129], v[128:129]
    v_pk_mul_f32 v[194:195], v[130:131], v[130:131]
    v_pk_mul_f32 v[196:197], v[132:133], v[132:133]
    v_pk_mul_f32 v[198:199], v[134:135], v[134:135]
    v_pk_fma_f32 v[192:193], v[136:137], v[136:137], v[192:193]
    v_pk_fma_f32 v[194:195], v[138:139], v[138:139], v[194:195]
    v_pk_fma_f32 v[196:197], v[140:141], v[140:141], v[196:197]
    v_pk_fma_f32 v[198:199], v[142:143], v[142:143], v[198:199]
    v_pk_fma_f32 v[192:193], v[144:145], v[144:145], v[192:193]
    v_pk_fma_f32 v[194:195], v[146:147], v[146:147], v[194:195]
    v_pk_fma_f32 v[196:197], v[148:149], v[148:149], v[196:197]
    v_pk_fma_f32 v[198:199], v[150:151], v[150:151], v[198:199]
    v_pk_fma_f32 v[192:193], v[152:153], v[152:153], v[192:193]
    v_pk_fma_f32 v[194:195], v[154:155], v[154:155], v[194:195]
    v_pk_fma_f32 v[196:197], v[156:157], v[156:157], v[196:197]
    v_pk_fma_f32 v[198:199], v[158:159], v[158:159], v[198:199]
    v_pk_fma_f32 v[192:193], v[160:161], v[160:161], v[192:193]
    v_pk_fma_f32 v[194:195], v[162:163], v[162:163], v[194:195]
    v_pk_fma_f32 v[196:197], v[164:165], v[164:165], v[196:197]
    v_pk_fma_f32 v[198:199], v[166:167], v[166:167], v[198:199]
    v_pk_fma_f32 v[192:193], v[168:169], v[168:169], v[192:193]
    v_pk_fma_f32 v[194:195], v[170:171], v[170:171], v[194:195]
    v_pk_fma_f32 v[196:197], v[172:173], v[172:173], v[196:197]
    v_pk_fma_f32 v[198:199], v[174:175], v[174:175], v[198:199]
    v_pk_fma_f32 v[192:193], v[176:177], v[176:177], v[192:193]
    v_pk_fma_f32 v[194:195], v[178:179], v[178:179], v[194:195]
    v_pk_fma_f32 v[196:197], v[180:181], v[180:181], v[196:197]
    v_pk_fma_f32 v[198:199], v[182:183], v[182:183], v[198:199]
    v_pk_fma_f32 v[192:193], v[184:185], v[184:185], v[192:193]
    v_pk_fma_f32 v[194:195], v[186:187], v[186:187], v[194:195]
    v_pk_fma_f32 v[196:197], v[188:189], v[188:189], v[196:197]
    v_pk_fma_f32 v[198:199], v[190:191], v[190:191], v[198:199]
    v_pk_add_f32 v[192:193], v[192:193], v[194:195]
    v_pk_add_f32 v[196:197], v[196:197], v[198:199]
    v_pk_add_f32 v[192:193], v[192:193], v[196:197]
    v_add_f32 v192, v192, v193
    ds_write_b32 v253, v192 offset:1024
    s_waitcnt lgkmcnt(0)
    s_barrier
    ds_read_b128 v[192:195], v254 offset:1024
    ds_read_b128 v[196:199], v254 offset:1040
    ds_read_b128 v[200:203], v254 offset:1056
    ds_read_b128 v[204:207], v254 offset:1072
    s_waitcnt lgkmcnt(2)
    v_pk_add_f32 v[192:193], v[192:193], v[194:195]
    v_pk_add_f32 v[196:197], v[196:197], v[198:199]
    s_waitcnt lgkmcnt(0)
    v_pk_add_f32 v[200:201], v[200:201], v[202:203]
    v_pk_add_f32 v[204:205], v[204:205], v[206:207]
    v_pk_add_f32 v[192:193], v[192:193], v[196:197]
    v_pk_add_f32 v[200:201], v[200:201], v[204:205]
    v_pk_add_f32 v[192:193], v[192:193], v[200:201]
    v_add_f32 v192, v192, v193
    v_mov_b32 v193, 0x3727c5ac
    v_fmac_f32 v193, 0x3a800000, v192
    v_rsq_f32 v192, v193
    s_nop 0
    v_mov_b32 v193, v192
    v_pk_mul_f32 v[128:129], v[128:129], v[192:193]
    v_pk_mul_f32 v[130:131], v[130:131], v[192:193]
    v_pk_mul_f32 v[132:133], v[132:133], v[192:193]
    v_pk_mul_f32 v[134:135], v[134:135], v[192:193]
    v_pk_mul_f32 v[136:137], v[136:137], v[192:193]
    v_pk_mul_f32 v[138:139], v[138:139], v[192:193]
    v_pk_mul_f32 v[140:141], v[140:141], v[192:193]
    v_pk_mul_f32 v[142:143], v[142:143], v[192:193]
    v_pk_mul_f32 v[144:145], v[144:145], v[192:193]
    v_pk_mul_f32 v[146:147], v[146:147], v[192:193]
    v_pk_mul_f32 v[148:149], v[148:149], v[192:193]
    v_pk_mul_f32 v[150:151], v[150:151], v[192:193]
    v_pk_mul_f32 v[152:153], v[152:153], v[192:193]
    v_pk_mul_f32 v[154:155], v[154:155], v[192:193]
    v_pk_mul_f32 v[156:157], v[156:157], v[192:193]
    v_pk_mul_f32 v[158:159], v[158:159], v[192:193]
    v_pk_mul_f32 v[160:161], v[160:161], v[192:193]
    v_pk_mul_f32 v[162:163], v[162:163], v[192:193]
    v_pk_mul_f32 v[164:165], v[164:165], v[192:193]
    v_pk_mul_f32 v[166:167], v[166:167], v[192:193]
    v_pk_mul_f32 v[168:169], v[168:169], v[192:193]
    v_pk_mul_f32 v[170:171], v[170:171], v[192:193]
    v_pk_mul_f32 v[172:173], v[172:173], v[192:193]
    v_pk_mul_f32 v[174:175], v[174:175], v[192:193]
    v_pk_mul_f32 v[176:177], v[176:177], v[192:193]
    v_pk_mul_f32 v[178:179], v[178:179], v[192:193]
    v_pk_mul_f32 v[180:181], v[180:181], v[192:193]
    v_pk_mul_f32 v[182:183], v[182:183], v[192:193]
    v_pk_mul_f32 v[184:185], v[184:185], v[192:193]
    v_pk_mul_f32 v[186:187], v[186:187], v[192:193]
    v_pk_mul_f32 v[188:189], v[188:189], v[192:193]
    v_pk_mul_f32 v[190:191], v[190:191], v[192:193]
    v_cvt_pk_bf16_f32 v0, v128, v129
    v_cvt_pk_bf16_f32 v1, v130, v131
    v_cvt_pk_bf16_f32 v2, v132, v133
    v_cvt_pk_bf16_f32 v3, v134, v135
    v_cvt_pk_bf16_f32 v4, v136, v137
    v_cvt_pk_bf16_f32 v5, v138, v139
    v_cvt_pk_bf16_f32 v6, v140, v141
    v_cvt_pk_bf16_f32 v7, v142, v143
    v_cvt_pk_bf16_f32 v8, v144, v145
    v_cvt_pk_bf16_f32 v9, v146, v147
    v_cvt_pk_bf16_f32 v10, v148, v149
    v_cvt_pk_bf16_f32 v11, v150, v151
    v_cvt_pk_bf16_f32 v12, v152, v153
    v_cvt_pk_bf16_f32 v13, v154, v155
    v_cvt_pk_bf16_f32 v14, v156, v157
    v_cvt_pk_bf16_f32 v15, v158, v159
    v_cvt_pk_bf16_f32 v16, v160, v161
    v_cvt_pk_bf16_f32 v17, v162, v163
    v_cvt_pk_bf16_f32 v18, v164, v165
    v_cvt_pk_bf16_f32 v19, v166, v167
    v_cvt_pk_bf16_f32 v20, v168, v169
    v_cvt_pk_bf16_f32 v21, v170, v171
    v_cvt_pk_bf16_f32 v22, v172, v173
    v_cvt_pk_bf16_f32 v23, v174, v175
    v_cvt_pk_bf16_f32 v24, v176, v177
    v_cvt_pk_bf16_f32 v25, v178, v179
    v_cvt_pk_bf16_f32 v26, v180, v181
    v_cvt_pk_bf16_f32 v27, v182, v183
    v_cvt_pk_bf16_f32 v28, v184, v185
    v_cvt_pk_bf16_f32 v29, v186, v187
    v_cvt_pk_bf16_f32 v30, v188, v189
    v_cvt_pk_bf16_f32 v31, v190, v191
    buffer_store_dwordx4 v[0:3], v251, s[4:7], s21 offen offset:0 sc1
    buffer_store_dwordx4 v[4:7], v251, s[4:7], s21 offen offset:1024 sc1
    buffer_store_dwordx4 v[8:11], v251, s[4:7], s21 offen offset:2048 sc1
    buffer_store_dwordx4 v[12:15], v251, s[4:7], s21 offen offset:3072 sc1
    s_add_u32 s21, s21, 4096
    buffer_store_dwordx4 v[16:19], v251, s[4:7], s21 offen offset:0 sc1
    buffer_store_dwordx4 v[20:23], v251, s[4:7], s21 offen offset:1024 sc1
    buffer_store_dwordx4 v[24:27], v251, s[4:7], s21 offen offset:2048 sc1
    buffer_store_dwordx4 v[28:31], v251, s[4:7], s21 offen offset:3072 sc1
    s_add_u32 s21, s21, 28672
    s_waitcnt vmcnt(8)
    v_lshlrev_b32 v128, 16, v32
    v_and_b32 v129, 0xffff0000, v32
    v_lshlrev_b32 v130, 16, v33
    v_and_b32 v131, 0xffff0000, v33
    v_lshlrev_b32 v132, 16, v34
    v_and_b32 v133, 0xffff0000, v34
    v_lshlrev_b32 v134, 16, v35
    v_and_b32 v135, 0xffff0000, v35
    v_lshlrev_b32 v136, 16, v36
    v_and_b32 v137, 0xffff0000, v36
    v_lshlrev_b32 v138, 16, v37
    v_and_b32 v139, 0xffff0000, v37
    v_lshlrev_b32 v140, 16, v38
    v_and_b32 v141, 0xffff0000, v38
    v_lshlrev_b32 v142, 16, v39
    v_and_b32 v143, 0xffff0000, v39
    v_lshlrev_b32 v144, 16, v40
    v_and_b32 v145, 0xffff0000, v40
    v_lshlrev_b32 v146, 16, v41
    v_and_b32 v147, 0xffff0000, v41
    v_lshlrev_b32 v148, 16, v42
    v_and_b32 v149, 0xffff0000, v42
    v_lshlrev_b32 v150, 16, v43
    v_and_b32 v151, 0xffff0000, v43
    v_lshlrev_b32 v152, 16, v44
    v_and_b32 v153, 0xffff0000, v44
    v_lshlrev_b32 v154, 16, v45
    v_and_b32 v155, 0xffff0000, v45
    v_lshlrev_b32 v156, 16, v46
    v_and_b32 v157, 0xffff0000, v46
    v_lshlrev_b32 v158, 16, v47
    v_and_b32 v159, 0xffff0000, v47
    v_lshlrev_b32 v160, 16, v48
    v_and_b32 v161, 0xffff0000, v48
    v_lshlrev_b32 v162, 16, v49
    v_and_b32 v163, 0xffff0000, v49
    v_lshlrev_b32 v164, 16, v50
    v_and_b32 v165, 0xffff0000, v50
    v_lshlrev_b32 v166, 16, v51
    v_and_b32 v167, 0xffff0000, v51
    v_lshlrev_b32 v168, 16, v52
    v_and_b32 v169, 0xffff0000, v52
    v_lshlrev_b32 v170, 16, v53
    v_and_b32 v171, 0xffff0000, v53
    v_lshlrev_b32 v172, 16, v54
    v_and_b32 v173, 0xffff0000, v54
    v_lshlrev_b32 v174, 16, v55
    v_and_b32 v175, 0xffff0000, v55
    v_lshlrev_b32 v176, 16, v56
    v_and_b32 v177, 0xffff0000, v56
    v_lshlrev_b32 v178, 16, v57
    v_and_b32 v179, 0xffff0000, v57
    v_lshlrev_b32 v180, 16, v58
    v_and_b32 v181, 0xffff0000, v58
    v_lshlrev_b32 v182, 16, v59
    v_and_b32 v183, 0xffff0000, v59
    v_lshlrev_b32 v184, 16, v60
    v_and_b32 v185, 0xffff0000, v60
    v_lshlrev_b32 v186, 16, v61
    v_and_b32 v187, 0xffff0000, v61
    v_lshlrev_b32 v188, 16, v62
    v_and_b32 v189, 0xffff0000, v62
    v_lshlrev_b32 v190, 16, v63
    v_and_b32 v191, 0xffff0000, v63
    v_pk_add_f32 v[192:193], v[128:129], v[136:137]
    v_pk_add_f32 v[194:195], v[130:131], v[138:139]
    v_pk_add_f32 v[196:197], v[132:133], v[140:141]
    v_pk_add_f32 v[198:199], v[134:135], v[142:143]
    v_pk_add_f32 v[192:193], v[192:193], v[144:145]
    v_pk_add_f32 v[194:195], v[194:195], v[146:147]
    v_pk_add_f32 v[196:197], v[196:197], v[148:149]
    v_pk_add_f32 v[198:199], v[198:199], v[150:151]
    v_pk_add_f32 v[192:193], v[192:193], v[152:153]
    v_pk_add_f32 v[194:195], v[194:195], v[154:155]
    v_pk_add_f32 v[196:197], v[196:197], v[156:157]
    v_pk_add_f32 v[198:199], v[198:199], v[158:159]
    v_pk_add_f32 v[192:193], v[192:193], v[160:161]
    v_pk_add_f32 v[194:195], v[194:195], v[162:163]
    v_pk_add_f32 v[196:197], v[196:197], v[164:165]
    v_pk_add_f32 v[198:199], v[198:199], v[166:167]
    v_pk_add_f32 v[192:193], v[192:193], v[168:169]
    v_pk_add_f32 v[194:195], v[194:195], v[170:171]
    v_pk_add_f32 v[196:197], v[196:197], v[172:173]
    v_pk_add_f32 v[198:199], v[198:199], v[174:175]
    v_pk_add_f32 v[192:193], v[192:193], v[176:177]
    v_pk_add_f32 v[194:195], v[194:195], v[178:179]
    v_pk_add_f32 v[196:197], v[196:197], v[180:181]
    v_pk_add_f32 v[198:199], v[198:199], v[182:183]
    v_pk_add_f32 v[192:193], v[192:193], v[184:185]
    v_pk_add_f32 v[194:195], v[194:195], v[186:187]
    v_pk_add_f32 v[196:197], v[196:197], v[188:189]
    v_pk_add_f32 v[198:199], v[198:199], v[190:191]
    v_pk_add_f32 v[192:193], v[192:193], v[194:195]
    v_pk_add_f32 v[196:197], v[196:197], v[198:199]
    v_pk_add_f32 v[192:193], v[192:193], v[196:197]
    v_add_f32 v192, v192, v193
    ds_write_b32 v253, v192 offset:0
    s_waitcnt lgkmcnt(0)
    s_barrier
    ds_read_b128 v[192:195], v254 offset:0
    ds_read_b128 v[196:199], v254 offset:16
    ds_read_b128 v[200:203], v254 offset:32
    ds_read_b128 v[204:207], v254 offset:48
    s_waitcnt lgkmcnt(2)
    v_pk_add_f32 v[192:193], v[192:193], v[194:195]
    v_pk_add_f32 v[196:197], v[196:197], v[198:199]
    s_waitcnt lgkmcnt(0)
    v_pk_add_f32 v[200:201], v[200:201], v[202:203]
    v_pk_add_f32 v[204:205], v[204:205], v[206:207]
    v_pk_add_f32 v[192:193], v[192:193], v[196:197]
    v_pk_add_f32 v[200:201], v[200:201], v[204:205]
    v_pk_add_f32 v[192:193], v[192:193], v[200:201]
    v_add_f32 v192, v192, v193
    v_mul_f32 v192, 0xba800000, v192
    v_mov_b32 v193, v192
    v_pk_add_f32 v[128:129], v[128:129], v[192:193]
    v_pk_add_f32 v[130:131], v[130:131], v[192:193]
    v_pk_add_f32 v[132:133], v[132:133], v[192:193]
    v_pk_add_f32 v[134:135], v[134:135], v[192:193]
    v_pk_add_f32 v[136:137], v[136:137], v[192:193]
    v_pk_add_f32 v[138:139], v[138:139], v[192:193]
    v_pk_add_f32 v[140:141], v[140:141], v[192:193]
    v_pk_add_f32 v[142:143], v[142:143], v[192:193]
    v_pk_add_f32 v[144:145], v[144:145], v[192:193]
    v_pk_add_f32 v[146:147], v[146:147], v[192:193]
    v_pk_add_f32 v[148:149], v[148:149], v[192:193]
    v_pk_add_f32 v[150:151], v[150:151], v[192:193]
    v_pk_add_f32 v[152:153], v[152:153], v[192:193]
    v_pk_add_f32 v[154:155], v[154:155], v[192:193]
    v_pk_add_f32 v[156:157], v[156:157], v[192:193]
    v_pk_add_f32 v[158:159], v[158:159], v[192:193]
    v_pk_add_f32 v[160:161], v[160:161], v[192:193]
    v_pk_add_f32 v[162:163], v[162:163], v[192:193]
    v_pk_add_f32 v[164:165], v[164:165], v[192:193]
    v_pk_add_f32 v[166:167], v[166:167], v[192:193]
    v_pk_add_f32 v[168:169], v[168:169], v[192:193]
    v_pk_add_f32 v[170:171], v[170:171], v[192:193]
    v_pk_add_f32 v[172:173], v[172:173], v[192:193]
    v_pk_add_f32 v[174:175], v[174:175], v[192:193]
    v_pk_add_f32 v[176:177], v[176:177], v[192:193]
    v_pk_add_f32 v[178:179], v[178:179], v[192:193]
    v_pk_add_f32 v[180:181], v[180:181], v[192:193]
    v_pk_add_f32 v[182:183], v[182:183], v[192:193]
    v_pk_add_f32 v[184:185], v[184:185], v[192:193]
    v_pk_add_f32 v[186:187], v[186:187], v[192:193]
    v_pk_add_f32 v[188:189], v[188:189], v[192:193]
    v_pk_add_f32 v[190:191], v[190:191], v[192:193]
    v_pk_mul_f32 v[192:193], v[128:129], v[128:129]
    v_pk_mul_f32 v[194:195], v[130:131], v[130:131]
    v_pk_mul_f32 v[196:197], v[132:133], v[132:133]
    v_pk_mul_f32 v[198:199], v[134:135], v[134:135]
    v_pk_fma_f32 v[192:193], v[136:137], v[136:137], v[192:193]
    v_pk_fma_f32 v[194:195], v[138:139], v[138:139], v[194:195]
    v_pk_fma_f32 v[196:197], v[140:141], v[140:141], v[196:197]
    v_pk_fma_f32 v[198:199], v[142:143], v[142:143], v[198:199]
    v_pk_fma_f32 v[192:193], v[144:145], v[144:145], v[192:193]
    v_pk_fma_f32 v[194:195], v[146:147], v[146:147], v[194:195]
    v_pk_fma_f32 v[196:197], v[148:149], v[148:149], v[196:197]
    v_pk_fma_f32 v[198:199], v[150:151], v[150:151], v[198:199]
    v_pk_fma_f32 v[192:193], v[152:153], v[152:153], v[192:193]
    v_pk_fma_f32 v[194:195], v[154:155], v[154:155], v[194:195]
    v_pk_fma_f32 v[196:197], v[156:157], v[156:157], v[196:197]
    v_pk_fma_f32 v[198:199], v[158:159], v[158:159], v[198:199]
    v_pk_fma_f32 v[192:193], v[160:161], v[160:161], v[192:193]
    v_pk_fma_f32 v[194:195], v[162:163], v[162:163], v[194:195]
    v_pk_fma_f32 v[196:197], v[164:165], v[164:165], v[196:197]
    v_pk_fma_f32 v[198:199], v[166:167], v[166:167], v[198:199]
    v_pk_fma_f32 v[192:193], v[168:169], v[168:169], v[192:193]
    v_pk_fma_f32 v[194:195], v[170:171], v[170:171], v[194:195]
    v_pk_fma_f32 v[196:197], v[172:173], v[172:173], v[196:197]
    v_pk_fma_f32 v[198:199], v[174:175], v[174:175], v[198:199]
    v_pk_fma_f32 v[192:193], v[176:177], v[176:177], v[192:193]
    v_pk_fma_f32 v[194:195], v[178:179], v[178:179], v[194:195]
    v_pk_fma_f32 v[196:197], v[180:181], v[180:181], v[196:197]
    v_pk_fma_f32 v[198:199], v[182:183], v[182:183], v[198:199]
    v_pk_fma_f32 v[192:193], v[184:185], v[184:185], v[192:193]
    v_pk_fma_f32 v[194:195], v[186:187], v[186:187], v[194:195]
    v_pk_fma_f32 v[196:197], v[188:189], v[188:189], v[196:197]
    v_pk_fma_f32 v[198:199], v[190:191], v[190:191], v[198:199]
    v_pk_add_f32 v[192:193], v[192:193], v[194:195]
    v_pk_add_f32 v[196:197], v[196:197], v[198:199]
    v_pk_add_f32 v[192:193], v[192:193], v[196:197]
    v_add_f32 v192, v192, v193
    ds_write_b32 v253, v192 offset:1024
    s_waitcnt lgkmcnt(0)
    s_barrier
    ds_read_b128 v[192:195], v254 offset:1024
    ds_read_b128 v[196:199], v254 offset:1040
    ds_read_b128 v[200:203], v254 offset:1056
    ds_read_b128 v[204:207], v254 offset:1072
    s_waitcnt lgkmcnt(2)
    v_pk_add_f32 v[192:193], v[192:193], v[194:195]
    v_pk_add_f32 v[196:197], v[196:197], v[198:199]
    s_waitcnt lgkmcnt(0)
    v_pk_add_f32 v[200:201], v[200:201], v[202:203]
    v_pk_add_f32 v[204:205], v[204:205], v[206:207]
    v_pk_add_f32 v[192:193], v[192:193], v[196:197]
    v_pk_add_f32 v[200:201], v[200:201], v[204:205]
    v_pk_add_f32 v[192:193], v[192:193], v[200:201]
    v_add_f32 v192, v192, v193
    v_mov_b32 v193, 0x3727c5ac
    v_fmac_f32 v193, 0x3a800000, v192
    v_rsq_f32 v192, v193
    s_nop 0
    v_mov_b32 v193, v192
    v_pk_mul_f32 v[128:129], v[128:129], v[192:193]
    v_pk_mul_f32 v[130:131], v[130:131], v[192:193]
    v_pk_mul_f32 v[132:133], v[132:133], v[192:193]
    v_pk_mul_f32 v[134:135], v[134:135], v[192:193]
    v_pk_mul_f32 v[136:137], v[136:137], v[192:193]
    v_pk_mul_f32 v[138:139], v[138:139], v[192:193]
    v_pk_mul_f32 v[140:141], v[140:141], v[192:193]
    v_pk_mul_f32 v[142:143], v[142:143], v[192:193]
    v_pk_mul_f32 v[144:145], v[144:145], v[192:193]
    v_pk_mul_f32 v[146:147], v[146:147], v[192:193]
    v_pk_mul_f32 v[148:149], v[148:149], v[192:193]
    v_pk_mul_f32 v[150:151], v[150:151], v[192:193]
    v_pk_mul_f32 v[152:153], v[152:153], v[192:193]
    v_pk_mul_f32 v[154:155], v[154:155], v[192:193]
    v_pk_mul_f32 v[156:157], v[156:157], v[192:193]
    v_pk_mul_f32 v[158:159], v[158:159], v[192:193]
    v_pk_mul_f32 v[160:161], v[160:161], v[192:193]
    v_pk_mul_f32 v[162:163], v[162:163], v[192:193]
    v_pk_mul_f32 v[164:165], v[164:165], v[192:193]
    v_pk_mul_f32 v[166:167], v[166:167], v[192:193]
    v_pk_mul_f32 v[168:169], v[168:169], v[192:193]
    v_pk_mul_f32 v[170:171], v[170:171], v[192:193]
    v_pk_mul_f32 v[172:173], v[172:173], v[192:193]
    v_pk_mul_f32 v[174:175], v[174:175], v[192:193]
    v_pk_mul_f32 v[176:177], v[176:177], v[192:193]
    v_pk_mul_f32 v[178:179], v[178:179], v[192:193]
    v_pk_mul_f32 v[180:181], v[180:181], v[192:193]
    v_pk_mul_f32 v[182:183], v[182:183], v[192:193]
    v_pk_mul_f32 v[184:185], v[184:185], v[192:193]
    v_pk_mul_f32 v[186:187], v[186:187], v[192:193]
    v_pk_mul_f32 v[188:189], v[188:189], v[192:193]
    v_pk_mul_f32 v[190:191], v[190:191], v[192:193]
    v_cvt_pk_bf16_f32 v32, v128, v129
    v_cvt_pk_bf16_f32 v33, v130, v131
    v_cvt_pk_bf16_f32 v34, v132, v133
    v_cvt_pk_bf16_f32 v35, v134, v135
    v_cvt_pk_bf16_f32 v36, v136, v137
    v_cvt_pk_bf16_f32 v37, v138, v139
    v_cvt_pk_bf16_f32 v38, v140, v141
    v_cvt_pk_bf16_f32 v39, v142, v143
    v_cvt_pk_bf16_f32 v40, v144, v145
    v_cvt_pk_bf16_f32 v41, v146, v147
    v_cvt_pk_bf16_f32 v42, v148, v149
    v_cvt_pk_bf16_f32 v43, v150, v151
    v_cvt_pk_bf16_f32 v44, v152, v153
    v_cvt_pk_bf16_f32 v45, v154, v155
    v_cvt_pk_bf16_f32 v46, v156, v157
    v_cvt_pk_bf16_f32 v47, v158, v159
    v_cvt_pk_bf16_f32 v48, v160, v161
    v_cvt_pk_bf16_f32 v49, v162, v163
    v_cvt_pk_bf16_f32 v50, v164, v165
    v_cvt_pk_bf16_f32 v51, v166, v167
    v_cvt_pk_bf16_f32 v52, v168, v169
    v_cvt_pk_bf16_f32 v53, v170, v171
    v_cvt_pk_bf16_f32 v54, v172, v173
    v_cvt_pk_bf16_f32 v55, v174, v175
    v_cvt_pk_bf16_f32 v56, v176, v177
    v_cvt_pk_bf16_f32 v57, v178, v179
    v_cvt_pk_bf16_f32 v58, v180, v181
    v_cvt_pk_bf16_f32 v59, v182, v183
    v_cvt_pk_bf16_f32 v60, v184, v185
    v_cvt_pk_bf16_f32 v61, v186, v187
    v_cvt_pk_bf16_f32 v62, v188, v189
    v_cvt_pk_bf16_f32 v63, v190, v191
    buffer_store_dwordx4 v[32:35], v251, s[4:7], s21 offen offset:0 sc1
    buffer_store_dwordx4 v[36:39], v251, s[4:7], s21 offen offset:1024 sc1
    buffer_store_dwordx4 v[40:43], v251, s[4:7], s21 offen offset:2048 sc1
    buffer_store_dwordx4 v[44:47], v251, s[4:7], s21 offen offset:3072 sc1
    s_add_u32 s21, s21, 4096
    buffer_store_dwordx4 v[48:51], v251, s[4:7], s21 offen offset:0 sc1
    buffer_store_dwordx4 v[52:55], v251, s[4:7], s21 offen offset:1024 sc1
    buffer_store_dwordx4 v[56:59], v251, s[4:7], s21 offen offset:2048 sc1
    buffer_store_dwordx4 v[60:63], v251, s[4:7], s21 offen offset:3072 sc1
    s_add_u32 s21, s21, 28672
    s_mov_b32 s54, 0
main_kernel_w_done:
    s_cmp_eq_u32 s14, 0
    s_cbranch_scc1 main_kernel_w_dw0
    s_waitcnt vmcnt(0)
    s_barrier
    s_branch main_kernel_w_bar
main_kernel_w_dw0:
    s_add_u32 s32, s23, 1
    s_bitcmp0_b32 s32, 2
    s_cselect_b32 s34, 4, 9
    s_cselect_b32 s35, 8, 4
    s_lshl_b32 s32, s23, 13
    s_add_u32 s56, s32, 0x8404000
    v_lshrrev_b32 v253, 1, v250
    v_add_u32 v253, s24, v253
    v_lshlrev_b32 v253, s34, v253
    v_and_b32 v254, 1, v250
    v_add_u32 v254, s25, v254
    v_lshlrev_b32 v254, s35, v254
    v_add_u32 v249, v254, v253
    s_lshl_b32 s57, 1, s54
    s_mov_b32 s28, s55
    s_cmp_eq_u32 s55, -1
    s_cbranch_scc0 main_kernel_w_have
    s_branch main_kernel_w_try
.section .rodata,"a"
.p2align 6
.amdhsa_kernel main_kernel
  .amdhsa_next_free_vgpr 512
  .amdhsa_next_free_sgpr 102
  .amdhsa_accum_offset 256
  .amdhsa_group_segment_fixed_size 0
  .amdhsa_kernarg_size 120
  .amdhsa_user_sgpr_count 2
  .amdhsa_user_sgpr_kernarg_segment_ptr 1
  .amdhsa_system_sgpr_workgroup_id_x 1
.end_amdhsa_kernel
```

```asm
; @launch kernel=main_kernel grid=(256,1,1) block=(256,1,1) lds=163840
.amdgcn_target "amdgcn-amd-amdhsa--gfx950"
.text
.text
.globl main_kernel
.p2align 8
.type main_kernel,@function
main_kernel:
    s_load_dwordx4 s[20:23], s[0:1], 104
    s_load_dwordx8 s[40:47], s[0:1], 16
    s_load_dwordx8 s[64:71], s[0:1], 64
    s_load_dwordx2 s[72:73], s[0:1], 0
    s_load_dwordx2 s[74:75], s[0:1], 96
    s_load_dwordx2 s[76:77], s[0:1], 8
    s_cmp_ge_u32 s2, 256
    s_cbranch_scc1 main_kernel_end
    v_lshrrev_b32 v126, 6, v0
    v_and_b32 v94, 63, v0
    v_and_b32 v250, 63, v0
    v_readfirstlane_b32 s14, v126
    s_mov_b32 s29, 0x80000
    s_waitcnt lgkmcnt(0)
    s_mov_b32 s60, s20
    s_and_b32 s61, s21, 0xffff
    s_mov_b32 s62, 0x100
    s_mov_b32 s63, 0x20000
    s_mov_b32 s4, s22
    s_and_b32 s5, s23, 0xffff
    s_mov_b32 s6, 0x10000000
    s_mov_b32 s7, 0x20000
    s_cmp_lg_u32 s14, 0
    s_cbranch_scc1 main_kernel_slot_wait
    s_getreg_b32 s12, hwreg(HW_REG_XCC_ID, 0, 4)
    s_and_b32 s12, s12, 7
    s_lshl_b32 s32, s12, 5
    v_mov_b32 v126, 0
    v_mov_b32 v127, 1
    s_mov_b64 exec, 1
    buffer_atomic_add v127, v126, s[60:63], s32 offen sc0 sc1
    s_waitcnt vmcnt(0)
    s_mov_b64 exec, -1
    v_readfirstlane_b32 s13, v127
    s_nop 3
    s_cmp_lt_u32 s13, 32
    s_cbranch_scc1 main_kernel_slot_pub
    v_and_b32 v126, 7, v94
    v_lshlrev_b32 v126, 5, v126
main_kernel_ovf_cnt:
    buffer_load_dword v127, v126, s[60:63], 0 offen sc1
    s_waitcnt vmcnt(0)
    v_readlane_b32 s48, v127, 0
    v_readlane_b32 s49, v127, 1
    v_readlane_b32 s50, v127, 2
    v_readlane_b32 s51, v127, 3
    v_readlane_b32 s52, v127, 4
    v_readlane_b32 s53, v127, 5
    v_readlane_b32 s54, v127, 6
    v_readlane_b32 s55, v127, 7
    s_nop 3
    s_add_u32 s33, s48, s49
    s_add_u32 s33, s33, s50
    s_add_u32 s33, s33, s51
    s_add_u32 s33, s33, s52
    s_add_u32 s33, s33, s53
    s_add_u32 s33, s33, s54
    s_add_u32 s33, s33, s55
    s_cmp_ge_u32 s33, 256
    s_cbranch_scc1 main_kernel_ovf_cnt_ok
    s_sub_u32 s29, s29, 1
    s_cbranch_scc1 main_kernel_end
    s_sleep 4
    s_branch main_kernel_ovf_cnt
main_kernel_ovf_cnt_ok:
    v_mov_b32 v126, 0
    v_mov_b32 v127, 1
    s_mov_b64 exec, 1
    buffer_atomic_add v127, v126, s[60:63], 0 offen offset:8 sc0 sc1
    s_waitcnt vmcnt(0)
    s_mov_b64 exec, -1
    v_readfirstlane_b32 s33, v127
    s_nop 3
    s_min_u32 s34, s48, 32
    s_sub_u32 s35, 32, s34
    s_mov_b32 s12, 0
    s_add_u32 s13, s34, s33
    s_cmp_lt_u32 s33, s35
    s_cbranch_scc1 main_kernel_slot_pub
    s_sub_u32 s33, s33, s35
    s_min_u32 s34, s49, 32
    s_sub_u32 s35, 32, s34
    s_mov_b32 s12, 1
    s_add_u32 s13, s34, s33
    s_cmp_lt_u32 s33, s35
    s_cbranch_scc1 main_kernel_slot_pub
    s_sub_u32 s33, s33, s35
    s_min_u32 s34, s50, 32
    s_sub_u32 s35, 32, s34
    s_mov_b32 s12, 2
    s_add_u32 s13, s34, s33
    s_cmp_lt_u32 s33, s35
    s_cbranch_scc1 main_kernel_slot_pub
    s_sub_u32 s33, s33, s35
    s_min_u32 s34, s51, 32
    s_sub_u32 s35, 32, s34
    s_mov_b32 s12, 3
    s_add_u32 s13, s34, s33
    s_cmp_lt_u32 s33, s35
    s_cbranch_scc1 main_kernel_slot_pub
    s_sub_u32 s33, s33, s35
    s_min_u32 s34, s52, 32
    s_sub_u32 s35, 32, s34
    s_mov_b32 s12, 4
    s_add_u32 s13, s34, s33
    s_cmp_lt_u32 s33, s35
    s_cbranch_scc1 main_kernel_slot_pub
    s_sub_u32 s33, s33, s35
    s_min_u32 s34, s53, 32
    s_sub_u32 s35, 32, s34
    s_mov_b32 s12, 5
    s_add_u32 s13, s34, s33
    s_cmp_lt_u32 s33, s35
    s_cbranch_scc1 main_kernel_slot_pub
    s_sub_u32 s33, s33, s35
    s_min_u32 s34, s54, 32
    s_sub_u32 s35, 32, s34
    s_mov_b32 s12, 6
    s_add_u32 s13, s34, s33
    s_cmp_lt_u32 s33, s35
    s_cbranch_scc1 main_kernel_slot_pub
    s_sub_u32 s33, s33, s35
    s_min_u32 s34, s55, 32
    s_sub_u32 s35, 32, s34
    s_mov_b32 s12, 7
    s_add_u32 s13, s34, s33
    s_cmp_lt_u32 s33, s35
    s_cbranch_scc1 main_kernel_slot_pub
    s_sub_u32 s33, s33, s35
    s_mov_b32 s12, 8
    s_mov_b32 s13, 0
main_kernel_slot_pub:
    v_mov_b32 v126, 0
    v_mov_b32 v127, s12
    v_mov_b32 v95, s13
    ds_write_b32 v126, v127
    ds_write_b32 v126, v95 offset:4
    s_waitcnt lgkmcnt(0)
main_kernel_slot_wait:
    s_barrier
    v_mov_b32 v126, 0
    ds_read_b32 v127, v126
    ds_read_b32 v95, v126 offset:4
    s_waitcnt lgkmcnt(0)
    v_readfirstlane_b32 s12, v127
    v_readfirstlane_b32 s13, v95
    s_nop 3
    s_barrier
    s_cmp_ge_u32 s12, 8
    s_cbranch_scc1 main_kernel_end
    s_cmp_lt_u32 s12, 2
    s_cbranch_scc1 main_kernel_chain
    s_mov_b32 s96, s72
    s_and_b32 s97, s73, 0xffff
    s_mov_b32 s98, 0x400000
    s_mov_b32 s99, 0x20000
    s_mov_b32 s92, s74
    s_and_b32 s93, s75, 0xffff
    s_mov_b32 s94, 0x400000
    s_mov_b32 s95, 0x20000
    v_lshlrev_b32 v1, 4, v0
    v_lshlrev_b32 v251, 4, v250
    v_mov_b32 v4, 0
    v_mov_b32 v8, -1
    v_mov_b32 v5, 0
    v_mov_b32 v9, -1
    v_mov_b32 v6, 0
    v_mov_b32 v10, -1
    v_mov_b32 v7, 0
    v_mov_b32 v11, -1
    v_mul_u32_u24 v12, 128, v0
    s_lshl_b32 s15, s12, 4
    s_and_b32 s32, s12, 1
    s_lshl_b32 s32, s32, 5
    s_cmp_lt_u32 s12, 4
    s_cselect_b32 s15, s32, s15
    s_cselect_b32 s32, 32, 16
    s_add_u32 s15, s15, s13
    s_sub_u32 s16, s15, 80
    s_sub_u32 s27, s12, 2
    s_mov_b32 s52, 0
    s_cmp_lt_u32 s13, s32
    s_cbranch_scc1 main_kernel_s_ln
    s_cmp_lg_u32 s13, 16
    s_cbranch_scc1 main_kernel_s_fill
    s_lshl_b32 s32, s16, 11
    s_add_u32 s32, s32, 0x8400000
    buffer_store_dwordx4 v[4:7], v1, s[4:7], s32 offen sc1
    s_add_u32 s32, s32, 4096
    buffer_store_dwordx4 v[4:7], v1, s[4:7], s32 offen sc1
    s_add_u32 s32, s32, 4096
    buffer_store_dwordx4 v[4:7], v1, s[4:7], s32 offen sc1
    s_add_u32 s32, s32, 4096
    buffer_store_dwordx4 v[4:7], v1, s[4:7], s32 offen sc1
    s_add_u32 s32, s32, 4096
    buffer_store_dwordx4 v[4:7], v1, s[4:7], s32 offen sc1
    s_add_u32 s32, s32, 4096
    buffer_store_dwordx4 v[4:7], v1, s[4:7], s32 offen sc1
    s_add_u32 s32, s32, 4096
    buffer_store_dwordx4 v[4:7], v1, s[4:7], s32 offen sc1
    s_add_u32 s32, s32, 4096
    buffer_store_dwordx4 v[4:7], v1, s[4:7], s32 offen sc1
    s_add_u32 s32, s32, 4096
    v_bfe_u32 v2, v0, 2, 1
    s_lshr_b32 s32, s14, 1
    v_and_b32 v2, s32, v2
    s_bitcmp1_b32 s14, 0
    s_cselect_b32 s32, 15, 0
    s_cselect_b32 s33, 4161536, 0
    v_xor_b32 v2, s32, v2
    v_lshlrev_b32 v2, 4, v2
    v_and_b32 v3, 3, v0
    v_lshl_add_u32 v2, v3, 8, v2
    v_lshrrev_b32 v3, 3, v0
    v_lshl_add_u32 v2, v3, 10, v2
    s_add_u32 s33, s33, 0x4808000
    buffer_store_dwordx4 v[4:7], v2, s[4:7], s33 offen sc1
    s_waitcnt vmcnt(0)
    s_barrier
    s_cmp_lg_u32 s14, 0
    s_cbranch_scc1 main_kernel_s_fill
    v_mov_b32 v2, 1
    s_mov_b64 exec, 1
    buffer_atomic_add v2, v4, s[60:63], 0 offen offset:12 sc1
    s_mov_b64 exec, -1
    s_branch main_kernel_s_fill
main_kernel_s_ln:
    v_and_b32 v3, 15, v250
    v_and_b32 v2, 48, v250
    v_lshl_add_u32 v3, v3, 11, v2
    s_lshl_b32 s34, s15, 15
    s_lshl_b32 s32, s14, 9
    s_add_u32 s32, s34, s32
    buffer_load_dwordx4 v[32:35], v3, s[96:99], s32 offen offset:0
    buffer_load_dwordx4 v[36:39], v3, s[96:99], s32 offen offset:64
    buffer_load_dwordx4 v[40:43], v3, s[96:99], s32 offen offset:128
    buffer_load_dwordx4 v[44:47], v3, s[96:99], s32 offen offset:192
    buffer_load_dwordx4 v[48:51], v3, s[96:99], s32 offen offset:256
    buffer_load_dwordx4 v[52:55], v3, s[96:99], s32 offen offset:320
    buffer_load_dwordx4 v[56:59], v3, s[96:99], s32 offen offset:384
    buffer_load_dwordx4 v[60:63], v3, s[96:99], s32 offen offset:448
    v_and_b32 v255, 15, v250
    v_lshlrev_b32 v254, 6, v255
    v_add_u32 v254, 132096, v254
    v_lshrrev_b32 v255, 4, v250
    v_lshl_add_u32 v253, v255, 2, v254
    v_lshl_add_u32 v253, s14, 4, v253
    s_lshl_b32 s32, s14, 13
    s_add_u32 s34, s34, s32
    s_waitcnt vmcnt(0)
    v_permlane16_swap_b32 v32, v34
    v_permlane16_swap_b32 v33, v35
    v_permlane16_swap_b32 v36, v38
    v_permlane16_swap_b32 v37, v39
    v_permlane16_swap_b32 v40, v42
    v_permlane16_swap_b32 v41, v43
    v_permlane16_swap_b32 v44, v46
    v_permlane16_swap_b32 v45, v47
    v_permlane16_swap_b32 v48, v50
    v_permlane16_swap_b32 v49, v51
    v_permlane16_swap_b32 v52, v54
    v_permlane16_swap_b32 v53, v55
    v_permlane16_swap_b32 v56, v58
    v_permlane16_swap_b32 v57, v59
    v_permlane16_swap_b32 v60, v62
    v_permlane16_swap_b32 v61, v63
    v_permlane32_swap_b32 v32, v34
    v_permlane32_swap_b32 v33, v35
    v_permlane32_swap_b32 v36, v38
    v_permlane32_swap_b32 v37, v39
    v_permlane32_swap_b32 v40, v42
    v_permlane32_swap_b32 v41, v43
    v_permlane32_swap_b32 v44, v46
    v_permlane32_swap_b32 v45, v47
    v_permlane32_swap_b32 v48, v50
    v_permlane32_swap_b32 v49, v51
    v_permlane32_swap_b32 v52, v54
    v_permlane32_swap_b32 v53, v55
    v_permlane32_swap_b32 v56, v58
    v_permlane32_swap_b32 v57, v59
    v_permlane32_swap_b32 v60, v62
    v_permlane32_swap_b32 v61, v63
    s_lshr_b32 s32, s15, 3
    s_lshl_b32 s32, s32, 9
    s_and_b32 s33, s15, 7
    s_lshl_b32 s33, s33, 4
    s_add_u32 s32, s32, s33
    s_add_u32 s16, s32, 0x8416000
    v_lshlrev_b32 v64, 16, v32
    v_and_b32 v65, 0xffff0000, v32
    v_lshlrev_b32 v66, 16, v33
    v_and_b32 v67, 0xffff0000, v33
    v_lshlrev_b32 v68, 16, v34
    v_and_b32 v69, 0xffff0000, v34
    v_lshlrev_b32 v70, 16, v35
    v_and_b32 v71, 0xffff0000, v35
    v_lshlrev_b32 v72, 16, v36
    v_and_b32 v73, 0xffff0000, v36
    v_lshlrev_b32 v74, 16, v37
    v_and_b32 v75, 0xffff0000, v37
    v_lshlrev_b32 v76, 16, v38
    v_and_b32 v77, 0xffff0000, v38
    v_lshlrev_b32 v78, 16, v39
    v_and_b32 v79, 0xffff0000, v39
    v_lshlrev_b32 v80, 16, v40
    v_and_b32 v81, 0xffff0000, v40
    v_lshlrev_b32 v82, 16, v41
    v_and_b32 v83, 0xffff0000, v41
    v_lshlrev_b32 v84, 16, v42
    v_and_b32 v85, 0xffff0000, v42
    v_lshlrev_b32 v86, 16, v43
    v_and_b32 v87, 0xffff0000, v43
    v_lshlrev_b32 v88, 16, v44
    v_and_b32 v89, 0xffff0000, v44
    v_lshlrev_b32 v90, 16, v45
    v_and_b32 v91, 0xffff0000, v45
    v_lshlrev_b32 v92, 16, v46
    v_and_b32 v93, 0xffff0000, v46
    v_lshlrev_b32 v94, 16, v47
    v_and_b32 v95, 0xffff0000, v47
    v_lshlrev_b32 v96, 16, v48
    v_and_b32 v97, 0xffff0000, v48
    v_lshlrev_b32 v98, 16, v49
    v_and_b32 v99, 0xffff0000, v49
    v_lshlrev_b32 v100, 16, v50
    v_and_b32 v101, 0xffff0000, v50
    v_lshlrev_b32 v102, 16, v51
    v_and_b32 v103, 0xffff0000, v51
    v_lshlrev_b32 v104, 16, v52
    v_and_b32 v105, 0xffff0000, v52
    v_lshlrev_b32 v106, 16, v53
    v_and_b32 v107, 0xffff0000, v53
    v_lshlrev_b32 v108, 16, v54
    v_and_b32 v109, 0xffff0000, v54
    v_lshlrev_b32 v110, 16, v55
    v_and_b32 v111, 0xffff0000, v55
    v_lshlrev_b32 v112, 16, v56
    v_and_b32 v113, 0xffff0000, v56
    v_lshlrev_b32 v114, 16, v57
    v_and_b32 v115, 0xffff0000, v57
    v_lshlrev_b32 v116, 16, v58
    v_and_b32 v117, 0xffff0000, v58
    v_lshlrev_b32 v118, 16, v59
    v_and_b32 v119, 0xffff0000, v59
    v_lshlrev_b32 v120, 16, v60
    v_and_b32 v121, 0xffff0000, v60
    v_lshlrev_b32 v122, 16, v61
    v_and_b32 v123, 0xffff0000, v61
    v_lshlrev_b32 v124, 16, v62
    v_and_b32 v125, 0xffff0000, v62
    v_lshlrev_b32 v126, 16, v63
    v_and_b32 v127, 0xffff0000, v63
    v_pk_add_f32 v[16:17], v[64:65], v[72:73]
    v_pk_add_f32 v[18:19], v[66:67], v[74:75]
    v_pk_add_f32 v[20:21], v[68:69], v[76:77]
    v_pk_add_f32 v[22:23], v[70:71], v[78:79]
    v_pk_add_f32 v[16:17], v[16:17], v[80:81]
    v_pk_add_f32 v[18:19], v[18:19], v[82:83]
    v_pk_add_f32 v[20:21], v[20:21], v[84:85]
    v_pk_add_f32 v[22:23], v[22:23], v[86:87]
    v_pk_add_f32 v[16:17], v[16:17], v[88:89]
    v_pk_add_f32 v[18:19], v[18:19], v[90:91]
    v_pk_add_f32 v[20:21], v[20:21], v[92:93]
    v_pk_add_f32 v[22:23], v[22:23], v[94:95]
    v_pk_add_f32 v[16:17], v[16:17], v[96:97]
    v_pk_add_f32 v[18:19], v[18:19], v[98:99]
    v_pk_add_f32 v[20:21], v[20:21], v[100:101]
    v_pk_add_f32 v[22:23], v[22:23], v[102:103]
    v_pk_add_f32 v[16:17], v[16:17], v[104:105]
    v_pk_add_f32 v[18:19], v[18:19], v[106:107]
    v_pk_add_f32 v[20:21], v[20:21], v[108:109]
    v_pk_add_f32 v[22:23], v[22:23], v[110:111]
    v_pk_add_f32 v[16:17], v[16:17], v[112:113]
    v_pk_add_f32 v[18:19], v[18:19], v[114:115]
    v_pk_add_f32 v[20:21], v[20:21], v[116:117]
    v_pk_add_f32 v[22:23], v[22:23], v[118:119]
    v_pk_add_f32 v[16:17], v[16:17], v[120:121]
    v_pk_add_f32 v[18:19], v[18:19], v[122:123]
    v_pk_add_f32 v[20:21], v[20:21], v[124:125]
    v_pk_add_f32 v[22:23], v[22:23], v[126:127]
    v_pk_add_f32 v[16:17], v[16:17], v[18:19]
    v_pk_add_f32 v[20:21], v[20:21], v[22:23]
    v_pk_add_f32 v[16:17], v[16:17], v[20:21]
    v_add_f32 v16, v16, v17
    ds_write_b32 v253, v16 offset:0
    s_waitcnt lgkmcnt(0)
    s_barrier
    ds_read_b128 v[16:19], v254 offset:0
    ds_read_b128 v[20:23], v254 offset:16
    ds_read_b128 v[24:27], v254 offset:32
    ds_read_b128 v[28:31], v254 offset:48
    s_waitcnt lgkmcnt(2)
    v_pk_add_f32 v[16:17], v[16:17], v[18:19]
    v_pk_add_f32 v[20:21], v[20:21], v[22:23]
    s_waitcnt lgkmcnt(0)
    v_pk_add_f32 v[24:25], v[24:25], v[26:27]
    v_pk_add_f32 v[28:29], v[28:29], v[30:31]
    v_pk_add_f32 v[16:17], v[16:17], v[20:21]
    v_pk_add_f32 v[24:25], v[24:25], v[28:29]
    v_pk_add_f32 v[16:17], v[16:17], v[24:25]
    v_add_f32 v16, v16, v17
    v_mul_f32 v16, 0xba800000, v16
    v_mov_b32 v17, v16
    v_pk_add_f32 v[64:65], v[64:65], v[16:17]
    v_pk_add_f32 v[66:67], v[66:67], v[16:17]
    v_pk_add_f32 v[68:69], v[68:69], v[16:17]
    v_pk_add_f32 v[70:71], v[70:71], v[16:17]
    v_pk_add_f32 v[72:73], v[72:73], v[16:17]
    v_pk_add_f32 v[74:75], v[74:75], v[16:17]
    v_pk_add_f32 v[76:77], v[76:77], v[16:17]
    v_pk_add_f32 v[78:79], v[78:79], v[16:17]
    v_pk_add_f32 v[80:81], v[80:81], v[16:17]
    v_pk_add_f32 v[82:83], v[82:83], v[16:17]
    v_pk_add_f32 v[84:85], v[84:85], v[16:17]
    v_pk_add_f32 v[86:87], v[86:87], v[16:17]
    v_pk_add_f32 v[88:89], v[88:89], v[16:17]
    v_pk_add_f32 v[90:91], v[90:91], v[16:17]
    v_pk_add_f32 v[92:93], v[92:93], v[16:17]
    v_pk_add_f32 v[94:95], v[94:95], v[16:17]
    v_pk_add_f32 v[96:97], v[96:97], v[16:17]
    v_pk_add_f32 v[98:99], v[98:99], v[16:17]
    v_pk_add_f32 v[100:101], v[100:101], v[16:17]
    v_pk_add_f32 v[102:103], v[102:103], v[16:17]
    v_pk_add_f32 v[104:105], v[104:105], v[16:17]
    v_pk_add_f32 v[106:107], v[106:107], v[16:17]
    v_pk_add_f32 v[108:109], v[108:109], v[16:17]
    v_pk_add_f32 v[110:111], v[110:111], v[16:17]
    v_pk_add_f32 v[112:113], v[112:113], v[16:17]
    v_pk_add_f32 v[114:115], v[114:115], v[16:17]
    v_pk_add_f32 v[116:117], v[116:117], v[16:17]
    v_pk_add_f32 v[118:119], v[118:119], v[16:17]
    v_pk_add_f32 v[120:121], v[120:121], v[16:17]
    v_pk_add_f32 v[122:123], v[122:123], v[16:17]
    v_pk_add_f32 v[124:125], v[124:125], v[16:17]
    v_pk_add_f32 v[126:127], v[126:127], v[16:17]
    v_pk_mul_f32 v[16:17], v[64:65], v[64:65]
    v_pk_mul_f32 v[18:19], v[66:67], v[66:67]
    v_pk_mul_f32 v[20:21], v[68:69], v[68:69]
    v_pk_mul_f32 v[22:23], v[70:71], v[70:71]
    v_pk_fma_f32 v[16:17], v[72:73], v[72:73], v[16:17]
    v_pk_fma_f32 v[18:19], v[74:75], v[74:75], v[18:19]
    v_pk_fma_f32 v[20:21], v[76:77], v[76:77], v[20:21]
    v_pk_fma_f32 v[22:23], v[78:79], v[78:79], v[22:23]
    v_pk_fma_f32 v[16:17], v[80:81], v[80:81], v[16:17]
    v_pk_fma_f32 v[18:19], v[82:83], v[82:83], v[18:19]
    v_pk_fma_f32 v[20:21], v[84:85], v[84:85], v[20:21]
    v_pk_fma_f32 v[22:23], v[86:87], v[86:87], v[22:23]
    v_pk_fma_f32 v[16:17], v[88:89], v[88:89], v[16:17]
    v_pk_fma_f32 v[18:19], v[90:91], v[90:91], v[18:19]
    v_pk_fma_f32 v[20:21], v[92:93], v[92:93], v[20:21]
    v_pk_fma_f32 v[22:23], v[94:95], v[94:95], v[22:23]
    v_pk_fma_f32 v[16:17], v[96:97], v[96:97], v[16:17]
    v_pk_fma_f32 v[18:19], v[98:99], v[98:99], v[18:19]
    v_pk_fma_f32 v[20:21], v[100:101], v[100:101], v[20:21]
    v_pk_fma_f32 v[22:23], v[102:103], v[102:103], v[22:23]
    v_pk_fma_f32 v[16:17], v[104:105], v[104:105], v[16:17]
    v_pk_fma_f32 v[18:19], v[106:107], v[106:107], v[18:19]
    v_pk_fma_f32 v[20:21], v[108:109], v[108:109], v[20:21]
    v_pk_fma_f32 v[22:23], v[110:111], v[110:111], v[22:23]
    v_pk_fma_f32 v[16:17], v[112:113], v[112:113], v[16:17]
    v_pk_fma_f32 v[18:19], v[114:115], v[114:115], v[18:19]
    v_pk_fma_f32 v[20:21], v[116:117], v[116:117], v[20:21]
    v_pk_fma_f32 v[22:23], v[118:119], v[118:119], v[22:23]
    v_pk_fma_f32 v[16:17], v[120:121], v[120:121], v[16:17]
    v_pk_fma_f32 v[18:19], v[122:123], v[122:123], v[18:19]
    v_pk_fma_f32 v[20:21], v[124:125], v[124:125], v[20:21]
    v_pk_fma_f32 v[22:23], v[126:127], v[126:127], v[22:23]
    v_pk_add_f32 v[16:17], v[16:17], v[18:19]
    v_pk_add_f32 v[20:21], v[20:21], v[22:23]
    v_pk_add_f32 v[16:17], v[16:17], v[20:21]
    v_add_f32 v16, v16, v17
    ds_write_b32 v253, v16 offset:1024
    s_waitcnt lgkmcnt(0)
    s_barrier
    ds_read_b128 v[16:19], v254 offset:1024
    ds_read_b128 v[20:23], v254 offset:1040
    ds_read_b128 v[24:27], v254 offset:1056
    ds_read_b128 v[28:31], v254 offset:1072
    s_waitcnt lgkmcnt(2)
    v_pk_add_f32 v[16:17], v[16:17], v[18:19]
    v_pk_add_f32 v[20:21], v[20:21], v[22:23]
    s_waitcnt lgkmcnt(0)
    v_pk_add_f32 v[24:25], v[24:25], v[26:27]
    v_pk_add_f32 v[28:29], v[28:29], v[30:31]
    v_pk_add_f32 v[16:17], v[16:17], v[20:21]
    v_pk_add_f32 v[24:25], v[24:25], v[28:29]
    v_pk_add_f32 v[16:17], v[16:17], v[24:25]
    v_add_f32 v16, v16, v17
    v_mov_b32 v17, 0x3727c5ac
    v_fmac_f32 v17, 0x3a800000, v16
    v_rsq_f32 v16, v17
    s_nop 0
    v_mov_b32 v17, v16
    v_pk_mul_f32 v[64:65], v[64:65], v[16:17]
    v_pk_mul_f32 v[66:67], v[66:67], v[16:17]
    v_pk_mul_f32 v[68:69], v[68:69], v[16:17]
    v_pk_mul_f32 v[70:71], v[70:71], v[16:17]
    v_pk_mul_f32 v[72:73], v[72:73], v[16:17]
    v_pk_mul_f32 v[74:75], v[74:75], v[16:17]
    v_pk_mul_f32 v[76:77], v[76:77], v[16:17]
    v_pk_mul_f32 v[78:79], v[78:79], v[16:17]
    v_pk_mul_f32 v[80:81], v[80:81], v[16:17]
    v_pk_mul_f32 v[82:83], v[82:83], v[16:17]
    v_pk_mul_f32 v[84:85], v[84:85], v[16:17]
    v_pk_mul_f32 v[86:87], v[86:87], v[16:17]
    v_pk_mul_f32 v[88:89], v[88:89], v[16:17]
    v_pk_mul_f32 v[90:91], v[90:91], v[16:17]
    v_pk_mul_f32 v[92:93], v[92:93], v[16:17]
    v_pk_mul_f32 v[94:95], v[94:95], v[16:17]
    v_pk_mul_f32 v[96:97], v[96:97], v[16:17]
    v_pk_mul_f32 v[98:99], v[98:99], v[16:17]
    v_pk_mul_f32 v[100:101], v[100:101], v[16:17]
    v_pk_mul_f32 v[102:103], v[102:103], v[16:17]
    v_pk_mul_f32 v[104:105], v[104:105], v[16:17]
    v_pk_mul_f32 v[106:107], v[106:107], v[16:17]
    v_pk_mul_f32 v[108:109], v[108:109], v[16:17]
    v_pk_mul_f32 v[110:111], v[110:111], v[16:17]
    v_pk_mul_f32 v[112:113], v[112:113], v[16:17]
    v_pk_mul_f32 v[114:115], v[114:115], v[16:17]
    v_pk_mul_f32 v[116:117], v[116:117], v[16:17]
    v_pk_mul_f32 v[118:119], v[118:119], v[16:17]
    v_pk_mul_f32 v[120:121], v[120:121], v[16:17]
    v_pk_mul_f32 v[122:123], v[122:123], v[16:17]
    v_pk_mul_f32 v[124:125], v[124:125], v[16:17]
    v_pk_mul_f32 v[126:127], v[126:127], v[16:17]
    v_cvt_pk_bf16_f32 v128, v64, v65
    v_cvt_pk_bf16_f32 v129, v66, v67
    v_cvt_pk_bf16_f32 v130, v68, v69
    v_cvt_pk_bf16_f32 v131, v70, v71
    v_cvt_pk_bf16_f32 v132, v72, v73
    v_cvt_pk_bf16_f32 v133, v74, v75
    v_cvt_pk_bf16_f32 v134, v76, v77
    v_cvt_pk_bf16_f32 v135, v78, v79
    v_cvt_pk_bf16_f32 v136, v80, v81
    v_cvt_pk_bf16_f32 v137, v82, v83
    v_cvt_pk_bf16_f32 v138, v84, v85
    v_cvt_pk_bf16_f32 v139, v86, v87
    v_cvt_pk_bf16_f32 v140, v88, v89
    v_cvt_pk_bf16_f32 v141, v90, v91
    v_cvt_pk_bf16_f32 v142, v92, v93
    v_cvt_pk_bf16_f32 v143, v94, v95
    v_cvt_pk_bf16_f32 v144, v96, v97
    v_cvt_pk_bf16_f32 v145, v98, v99
    v_cvt_pk_bf16_f32 v146, v100, v101
    v_cvt_pk_bf16_f32 v147, v102, v103
    v_cvt_pk_bf16_f32 v148, v104, v105
    v_cvt_pk_bf16_f32 v149, v106, v107
    v_cvt_pk_bf16_f32 v150, v108, v109
    v_cvt_pk_bf16_f32 v151, v110, v111
    v_cvt_pk_bf16_f32 v152, v112, v113
    v_cvt_pk_bf16_f32 v153, v114, v115
    v_cvt_pk_bf16_f32 v154, v116, v117
    v_cvt_pk_bf16_f32 v155, v118, v119
    v_cvt_pk_bf16_f32 v156, v120, v121
    v_cvt_pk_bf16_f32 v157, v122, v123
    v_cvt_pk_bf16_f32 v158, v124, v125
    v_cvt_pk_bf16_f32 v159, v126, v127
    s_add_u32 s32, s34, 0x0
    s_add_u32 s33, s32, 4096
    buffer_store_dwordx4 v[128:131], v251, s[4:7], s32 offen offset:0 sc1
    buffer_store_dwordx4 v[132:135], v251, s[4:7], s32 offen offset:1024 sc1
    buffer_store_dwordx4 v[136:139], v251, s[4:7], s32 offen offset:2048 sc1
    buffer_store_dwordx4 v[140:143], v251, s[4:7], s32 offen offset:3072 sc1
    buffer_store_dwordx4 v[144:147], v251, s[4:7], s33 offen offset:0 sc1
    buffer_store_dwordx4 v[148:151], v251, s[4:7], s33 offen offset:1024 sc1
    buffer_store_dwordx4 v[152:155], v251, s[4:7], s33 offen offset:2048 sc1
    buffer_store_dwordx4 v[156:159], v251, s[4:7], s33 offen offset:3072 sc1
    buffer_load_dword v2, v4, s[60:63], 0 offen offset:12 sc1
    v_lshlrev_b32 v64, 16, v128
    v_and_b32 v65, 0xffff0000, v128
    v_lshlrev_b32 v66, 16, v129
    v_and_b32 v67, 0xffff0000, v129
    v_lshlrev_b32 v68, 16, v130
    v_and_b32 v69, 0xffff0000, v130
    v_lshlrev_b32 v70, 16, v131
    v_and_b32 v71, 0xffff0000, v131
    v_lshlrev_b32 v72, 16, v132
    v_and_b32 v73, 0xffff0000, v132
    v_lshlrev_b32 v74, 16, v133
    v_and_b32 v75, 0xffff0000, v133
    v_lshlrev_b32 v76, 16, v134
    v_and_b32 v77, 0xffff0000, v134
    v_lshlrev_b32 v78, 16, v135
    v_and_b32 v79, 0xffff0000, v135
    v_lshlrev_b32 v80, 16, v136
    v_and_b32 v81, 0xffff0000, v136
    v_lshlrev_b32 v82, 16, v137
    v_and_b32 v83, 0xffff0000, v137
    v_lshlrev_b32 v84, 16, v138
    v_and_b32 v85, 0xffff0000, v138
    v_lshlrev_b32 v86, 16, v139
    v_and_b32 v87, 0xffff0000, v139
    v_lshlrev_b32 v88, 16, v140
    v_and_b32 v89, 0xffff0000, v140
    v_lshlrev_b32 v90, 16, v141
    v_and_b32 v91, 0xffff0000, v141
    v_lshlrev_b32 v92, 16, v142
    v_and_b32 v93, 0xffff0000, v142
    v_lshlrev_b32 v94, 16, v143
    v_and_b32 v95, 0xffff0000, v143
    v_lshlrev_b32 v96, 16, v144
    v_and_b32 v97, 0xffff0000, v144
    v_lshlrev_b32 v98, 16, v145
    v_and_b32 v99, 0xffff0000, v145
    v_lshlrev_b32 v100, 16, v146
    v_and_b32 v101, 0xffff0000, v146
    v_lshlrev_b32 v102, 16, v147
    v_and_b32 v103, 0xffff0000, v147
    v_lshlrev_b32 v104, 16, v148
    v_and_b32 v105, 0xffff0000, v148
    v_lshlrev_b32 v106, 16, v149
    v_and_b32 v107, 0xffff0000, v149
    v_lshlrev_b32 v108, 16, v150
    v_and_b32 v109, 0xffff0000, v150
    v_lshlrev_b32 v110, 16, v151
    v_and_b32 v111, 0xffff0000, v151
    v_lshlrev_b32 v112, 16, v152
    v_and_b32 v113, 0xffff0000, v152
    v_lshlrev_b32 v114, 16, v153
    v_and_b32 v115, 0xffff0000, v153
    v_lshlrev_b32 v116, 16, v154
    v_and_b32 v117, 0xffff0000, v154
    v_lshlrev_b32 v118, 16, v155
    v_and_b32 v119, 0xffff0000, v155
    v_lshlrev_b32 v120, 16, v156
    v_and_b32 v121, 0xffff0000, v156
    v_lshlrev_b32 v122, 16, v157
    v_and_b32 v123, 0xffff0000, v157
    v_lshlrev_b32 v124, 16, v158
    v_and_b32 v125, 0xffff0000, v158
    v_lshlrev_b32 v126, 16, v159
    v_and_b32 v127, 0xffff0000, v159
    v_pk_add_f32 v[16:17], v[64:65], v[72:73]
    v_pk_add_f32 v[18:19], v[66:67], v[74:75]
    v_pk_add_f32 v[20:21], v[68:69], v[76:77]
    v_pk_add_f32 v[22:23], v[70:71], v[78:79]
    v_pk_add_f32 v[16:17], v[16:17], v[80:81]
    v_pk_add_f32 v[18:19], v[18:19], v[82:83]
    v_pk_add_f32 v[20:21], v[20:21], v[84:85]
    v_pk_add_f32 v[22:23], v[22:23], v[86:87]
    v_pk_add_f32 v[16:17], v[16:17], v[88:89]
    v_pk_add_f32 v[18:19], v[18:19], v[90:91]
    v_pk_add_f32 v[20:21], v[20:21], v[92:93]
    v_pk_add_f32 v[22:23], v[22:23], v[94:95]
    v_pk_add_f32 v[16:17], v[16:17], v[96:97]
    v_pk_add_f32 v[18:19], v[18:19], v[98:99]
    v_pk_add_f32 v[20:21], v[20:21], v[100:101]
    v_pk_add_f32 v[22:23], v[22:23], v[102:103]
    v_pk_add_f32 v[16:17], v[16:17], v[104:105]
    v_pk_add_f32 v[18:19], v[18:19], v[106:107]
    v_pk_add_f32 v[20:21], v[20:21], v[108:109]
    v_pk_add_f32 v[22:23], v[22:23], v[110:111]
    v_pk_add_f32 v[16:17], v[16:17], v[112:113]
    v_pk_add_f32 v[18:19], v[18:19], v[114:115]
    v_pk_add_f32 v[20:21], v[20:21], v[116:117]
    v_pk_add_f32 v[22:23], v[22:23], v[118:119]
    v_pk_add_f32 v[16:17], v[16:17], v[120:121]
    v_pk_add_f32 v[18:19], v[18:19], v[122:123]
    v_pk_add_f32 v[20:21], v[20:21], v[124:125]
    v_pk_add_f32 v[22:23], v[22:23], v[126:127]
    v_pk_add_f32 v[16:17], v[16:17], v[18:19]
    v_pk_add_f32 v[20:21], v[20:21], v[22:23]
    v_pk_add_f32 v[16:17], v[16:17], v[20:21]
    v_add_f32 v16, v16, v17
    ds_write_b32 v253, v16 offset:0
    s_waitcnt lgkmcnt(0)
    s_barrier
    ds_read_b128 v[16:19], v254 offset:0
    ds_read_b128 v[20:23], v254 offset:16
    ds_read_b128 v[24:27], v254 offset:32
    ds_read_b128 v[28:31], v254 offset:48
    s_waitcnt lgkmcnt(2)
    v_pk_add_f32 v[16:17], v[16:17], v[18:19]
    v_pk_add_f32 v[20:21], v[20:21], v[22:23]
    s_waitcnt lgkmcnt(0)
    v_pk_add_f32 v[24:25], v[24:25], v[26:27]
    v_pk_add_f32 v[28:29], v[28:29], v[30:31]
    v_pk_add_f32 v[16:17], v[16:17], v[20:21]
    v_pk_add_f32 v[24:25], v[24:25], v[28:29]
    v_pk_add_f32 v[16:17], v[16:17], v[24:25]
    v_add_f32 v16, v16, v17
    v_mul_f32 v16, 0xba800000, v16
    v_mov_b32 v17, v16
    v_pk_add_f32 v[64:65], v[64:65], v[16:17]
    v_pk_add_f32 v[66:67], v[66:67], v[16:17]
    v_pk_add_f32 v[68:69], v[68:69], v[16:17]
    v_pk_add_f32 v[70:71], v[70:71], v[16:17]
    v_pk_add_f32 v[72:73], v[72:73], v[16:17]
    v_pk_add_f32 v[74:75], v[74:75], v[16:17]
    v_pk_add_f32 v[76:77], v[76:77], v[16:17]
    v_pk_add_f32 v[78:79], v[78:79], v[16:17]
    v_pk_add_f32 v[80:81], v[80:81], v[16:17]
    v_pk_add_f32 v[82:83], v[82:83], v[16:17]
    v_pk_add_f32 v[84:85], v[84:85], v[16:17]
    v_pk_add_f32 v[86:87], v[86:87], v[16:17]
    v_pk_add_f32 v[88:89], v[88:89], v[16:17]
    v_pk_add_f32 v[90:91], v[90:91], v[16:17]
    v_pk_add_f32 v[92:93], v[92:93], v[16:17]
    v_pk_add_f32 v[94:95], v[94:95], v[16:17]
    v_pk_add_f32 v[96:97], v[96:97], v[16:17]
    v_pk_add_f32 v[98:99], v[98:99], v[16:17]
    v_pk_add_f32 v[100:101], v[100:101], v[16:17]
    v_pk_add_f32 v[102:103], v[102:103], v[16:17]
    v_pk_add_f32 v[104:105], v[104:105], v[16:17]
    v_pk_add_f32 v[106:107], v[106:107], v[16:17]
    v_pk_add_f32 v[108:109], v[108:109], v[16:17]
    v_pk_add_f32 v[110:111], v[110:111], v[16:17]
    v_pk_add_f32 v[112:113], v[112:113], v[16:17]
    v_pk_add_f32 v[114:115], v[114:115], v[16:17]
    v_pk_add_f32 v[116:117], v[116:117], v[16:17]
    v_pk_add_f32 v[118:119], v[118:119], v[16:17]
    v_pk_add_f32 v[120:121], v[120:121], v[16:17]
    v_pk_add_f32 v[122:123], v[122:123], v[16:17]
    v_pk_add_f32 v[124:125], v[124:125], v[16:17]
    v_pk_add_f32 v[126:127], v[126:127], v[16:17]
    v_pk_mul_f32 v[16:17], v[64:65], v[64:65]
    v_pk_mul_f32 v[18:19], v[66:67], v[66:67]
    v_pk_mul_f32 v[20:21], v[68:69], v[68:69]
    v_pk_mul_f32 v[22:23], v[70:71], v[70:71]
    v_pk_fma_f32 v[16:17], v[72:73], v[72:73], v[16:17]
    v_pk_fma_f32 v[18:19], v[74:75], v[74:75], v[18:19]
    v_pk_fma_f32 v[20:21], v[76:77], v[76:77], v[20:21]
    v_pk_fma_f32 v[22:23], v[78:79], v[78:79], v[22:23]
    v_pk_fma_f32 v[16:17], v[80:81], v[80:81], v[16:17]
    v_pk_fma_f32 v[18:19], v[82:83], v[82:83], v[18:19]
    v_pk_fma_f32 v[20:21], v[84:85], v[84:85], v[20:21]
    v_pk_fma_f32 v[22:23], v[86:87], v[86:87], v[22:23]
    v_pk_fma_f32 v[16:17], v[88:89], v[88:89], v[16:17]
    v_pk_fma_f32 v[18:19], v[90:91], v[90:91], v[18:19]
    v_pk_fma_f32 v[20:21], v[92:93], v[92:93], v[20:21]
    v_pk_fma_f32 v[22:23], v[94:95], v[94:95], v[22:23]
    v_pk_fma_f32 v[16:17], v[96:97], v[96:97], v[16:17]
    v_pk_fma_f32 v[18:19], v[98:99], v[98:99], v[18:19]
    v_pk_fma_f32 v[20:21], v[100:101], v[100:101], v[20:21]
    v_pk_fma_f32 v[22:23], v[102:103], v[102:103], v[22:23]
    v_pk_fma_f32 v[16:17], v[104:105], v[104:105], v[16:17]
    v_pk_fma_f32 v[18:19], v[106:107], v[106:107], v[18:19]
    v_pk_fma_f32 v[20:21], v[108:109], v[108:109], v[20:21]
    v_pk_fma_f32 v[22:23], v[110:111], v[110:111], v[22:23]
    v_pk_fma_f32 v[16:17], v[112:113], v[112:113], v[16:17]
    v_pk_fma_f32 v[18:19], v[114:115], v[114:115], v[18:19]
    v_pk_fma_f32 v[20:21], v[116:117], v[116:117], v[20:21]
    v_pk_fma_f32 v[22:23], v[118:119], v[118:119], v[22:23]
    v_pk_fma_f32 v[16:17], v[120:121], v[120:121], v[16:17]
    v_pk_fma_f32 v[18:19], v[122:123], v[122:123], v[18:19]
    v_pk_fma_f32 v[20:21], v[124:125], v[124:125], v[20:21]
    v_pk_fma_f32 v[22:23], v[126:127], v[126:127], v[22:23]
    v_pk_add_f32 v[16:17], v[16:17], v[18:19]
    v_pk_add_f32 v[20:21], v[20:21], v[22:23]
    v_pk_add_f32 v[16:17], v[16:17], v[20:21]
    v_add_f32 v16, v16, v17
    ds_write_b32 v253, v16 offset:1024
    s_waitcnt lgkmcnt(0)
    s_waitcnt vmcnt(0)
    s_barrier
    s_cmp_lg_u32 s14, 0
    s_cbranch_scc1 main_kernel_s_nf
    v_cmp_gt_u32 vcc, 4, v2
    s_cbranch_vccz main_kernel_s_wa1_ok
    v_mov_b32 v2, 0
main_kernel_s_wa1:
    buffer_load_dword v3, v2, s[60:63], 0 offen offset:12 sc1
    s_waitcnt vmcnt(0)
    v_cmp_gt_u32 vcc, 4, v3
    s_cbranch_vccz main_kernel_s_wa1_ok
    s_sleep 4
    s_sub_u32 s29, s29, 1
    s_cbranch_scc0 main_kernel_s_wa1
    s_branch main_kernel_end
main_kernel_s_wa1_ok:
    s_mov_b64 exec, 1
    buffer_store_dword v8, v4, s[4:7], s16 offen sc1
    s_mov_b64 exec, -1
main_kernel_s_nf:
    ds_read_b128 v[16:19], v254 offset:1024
    ds_read_b128 v[20:23], v254 offset:1040
    ds_read_b128 v[24:27], v254 offset:1056
    ds_read_b128 v[28:31], v254 offset:1072
    s_waitcnt lgkmcnt(2)
    v_pk_add_f32 v[16:17], v[16:17], v[18:19]
    v_pk_add_f32 v[20:21], v[20:21], v[22:23]
    s_waitcnt lgkmcnt(0)
    v_pk_add_f32 v[24:25], v[24:25], v[26:27]
    v_pk_add_f32 v[28:29], v[28:29], v[30:31]
    v_pk_add_f32 v[16:17], v[16:17], v[20:21]
    v_pk_add_f32 v[24:25], v[24:25], v[28:29]
    v_pk_add_f32 v[16:17], v[16:17], v[24:25]
    v_add_f32 v16, v16, v17
    v_mov_b32 v17, 0x3727c5ac
    v_fmac_f32 v17, 0x3a800000, v16
    v_rsq_f32 v16, v17
    s_nop 0
    v_mov_b32 v17, v16
    v_pk_mul_f32 v[64:65], v[64:65], v[16:17]
    v_pk_mul_f32 v[66:67], v[66:67], v[16:17]
    v_pk_mul_f32 v[68:69], v[68:69], v[16:17]
    v_pk_mul_f32 v[70:71], v[70:71], v[16:17]
    v_pk_mul_f32 v[72:73], v[72:73], v[16:17]
    v_pk_mul_f32 v[74:75], v[74:75], v[16:17]
    v_pk_mul_f32 v[76:77], v[76:77], v[16:17]
    v_pk_mul_f32 v[78:79], v[78:79], v[16:17]
    v_pk_mul_f32 v[80:81], v[80:81], v[16:17]
    v_pk_mul_f32 v[82:83], v[82:83], v[16:17]
    v_pk_mul_f32 v[84:85], v[84:85], v[16:17]
    v_pk_mul_f32 v[86:87], v[86:87], v[16:17]
    v_pk_mul_f32 v[88:89], v[88:89], v[16:17]
    v_pk_mul_f32 v[90:91], v[90:91], v[16:17]
    v_pk_mul_f32 v[92:93], v[92:93], v[16:17]
    v_pk_mul_f32 v[94:95], v[94:95], v[16:17]
    v_pk_mul_f32 v[96:97], v[96:97], v[16:17]
    v_pk_mul_f32 v[98:99], v[98:99], v[16:17]
    v_pk_mul_f32 v[100:101], v[100:101], v[16:17]
    v_pk_mul_f32 v[102:103], v[102:103], v[16:17]
    v_pk_mul_f32 v[104:105], v[104:105], v[16:17]
    v_pk_mul_f32 v[106:107], v[106:107], v[16:17]
    v_pk_mul_f32 v[108:109], v[108:109], v[16:17]
    v_pk_mul_f32 v[110:111], v[110:111], v[16:17]
    v_pk_mul_f32 v[112:113], v[112:113], v[16:17]
    v_pk_mul_f32 v[114:115], v[114:115], v[16:17]
    v_pk_mul_f32 v[116:117], v[116:117], v[16:17]
    v_pk_mul_f32 v[118:119], v[118:119], v[16:17]
    v_pk_mul_f32 v[120:121], v[120:121], v[16:17]
    v_pk_mul_f32 v[122:123], v[122:123], v[16:17]
    v_pk_mul_f32 v[124:125], v[124:125], v[16:17]
    v_pk_mul_f32 v[126:127], v[126:127], v[16:17]
    v_cvt_pk_bf16_f32 v32, v64, v65
    v_cvt_pk_bf16_f32 v33, v66, v67
    v_cvt_pk_bf16_f32 v34, v68, v69
    v_cvt_pk_bf16_f32 v35, v70, v71
    v_cvt_pk_bf16_f32 v36, v72, v73
    v_cvt_pk_bf16_f32 v37, v74, v75
    v_cvt_pk_bf16_f32 v38, v76, v77
    v_cvt_pk_bf16_f32 v39, v78, v79
    v_cvt_pk_bf16_f32 v40, v80, v81
    v_cvt_pk_bf16_f32 v41, v82, v83
    v_cvt_pk_bf16_f32 v42, v84, v85
    v_cvt_pk_bf16_f32 v43, v86, v87
    v_cvt_pk_bf16_f32 v44, v88, v89
    v_cvt_pk_bf16_f32 v45, v90, v91
    v_cvt_pk_bf16_f32 v46, v92, v93
    v_cvt_pk_bf16_f32 v47, v94, v95
    v_cvt_pk_bf16_f32 v48, v96, v97
    v_cvt_pk_bf16_f32 v49, v98, v99
    v_cvt_pk_bf16_f32 v50, v100, v101
    v_cvt_pk_bf16_f32 v51, v102, v103
    v_cvt_pk_bf16_f32 v52, v104, v105
    v_cvt_pk_bf16_f32 v53, v106, v107
    v_cvt_pk_bf16_f32 v54, v108, v109
    v_cvt_pk_bf16_f32 v55, v110, v111
    v_cvt_pk_bf16_f32 v56, v112, v113
    v_cvt_pk_bf16_f32 v57, v114, v115
    v_cvt_pk_bf16_f32 v58, v116, v117
    v_cvt_pk_bf16_f32 v59, v118, v119
    v_cvt_pk_bf16_f32 v60, v120, v121
    v_cvt_pk_bf16_f32 v61, v122, v123
    v_cvt_pk_bf16_f32 v62, v124, v125
    v_cvt_pk_bf16_f32 v63, v126, v127
    s_add_u32 s32, s34, 0x400000
    s_add_u32 s33, s32, 4096
    buffer_store_dwordx4 v[32:35], v251, s[4:7], s32 offen offset:0 sc1
    buffer_store_dwordx4 v[36:39], v251, s[4:7], s32 offen offset:1024 sc1
    buffer_store_dwordx4 v[40:43], v251, s[4:7], s32 offen offset:2048 sc1
    buffer_store_dwordx4 v[44:47], v251, s[4:7], s32 offen offset:3072 sc1
    buffer_store_dwordx4 v[48:51], v251, s[4:7], s33 offen offset:0 sc1
    buffer_store_dwordx4 v[52:55], v251, s[4:7], s33 offen offset:1024 sc1
    buffer_store_dwordx4 v[56:59], v251, s[4:7], s33 offen offset:2048 sc1
    buffer_store_dwordx4 v[60:63], v251, s[4:7], s33 offen offset:3072 sc1
    s_add_u32 s16, s16, 4
    s_branch main_kernel_s_wa2_ok
main_kernel_s_fill:
    s_lshl_b32 s32, s16, 14
    s_add_u32 s34, s32, 0x6c00000
    buffer_store_dwordx4 v[8:11], v1, s[4:7], s34 offen sc1
    s_add_u32 s34, s32, 0x6c01000
    buffer_store_dwordx4 v[8:11], v1, s[4:7], s34 offen sc1
    s_add_u32 s34, s32, 0x6c02000
    buffer_store_dwordx4 v[8:11], v1, s[4:7], s34 offen sc1
    s_add_u32 s34, s32, 0x6c03000
    buffer_store_dwordx4 v[8:11], v1, s[4:7], s34 offen sc1
    s_lshl_b32 s32, s16, 14
    s_add_u32 s34, s32, 0x8c00000
    buffer_store_dwordx4 v[8:11], v1, s[4:7], s34 offen sc1
    s_add_u32 s34, s32, 0x8c01000
    buffer_store_dwordx4 v[8:11], v1, s[4:7], s34 offen sc1
    s_add_u32 s34, s32, 0x8c02000
    buffer_store_dwordx4 v[8:11], v1, s[4:7], s34 offen sc1
    s_add_u32 s34, s32, 0x8c03000
    buffer_store_dwordx4 v[8:11], v1, s[4:7], s34 offen sc1
    s_add_u32 s34, s32, 0x8d00000
    buffer_store_dwordx4 v[8:11], v1, s[4:7], s34 offen sc1
    s_add_u32 s34, s32, 0x8d01000
    buffer_store_dwordx4 v[8:11], v1, s[4:7], s34 offen sc1
    s_add_u32 s34, s32, 0x8d02000
    buffer_store_dwordx4 v[8:11], v1, s[4:7], s34 offen sc1
    s_add_u32 s34, s32, 0x8d03000
    buffer_store_dwordx4 v[8:11], v1, s[4:7], s34 offen sc1
    s_lshl_b32 s32, s16, 2
    s_lshl_b32 s32, s16, 12
    s_add_u32 s33, s32, 0x8c00000
    s_add_u32 s34, s32, 0x6e00000
    buffer_store_dwordx4 v[8:11], v1, s[4:7], s34 offen sc1
    s_add_u32 s32, s32, 0x8000000
    buffer_store_dwordx4 v[8:11], v1, s[4:7], s32 offen sc1
    s_lshl_b32 s16, s16, 2
    s_add_u32 s16, s16, 0x841f000
    s_cmp_lg_u32 s16, 0x841f034
    s_cbranch_scc1 main_kernel_s_fd
    s_mov_b32 s8, s76
    s_and_b32 s9, s77, 0xffff
    s_mov_b32 s10, 0x4000
    s_mov_b32 s11, 0x20000
    v_and_b32 v2, 7, v0
    v_lshlrev_b32 v2, 11, v2
    v_lshrrev_b32 v3, 6, v0
    v_lshl_add_u32 v2, v3, 7, v2
    v_bfe_u32 v3, v0, 4, 2
    v_lshl_add_u32 v2, v3, 5, v2
    v_bfe_u32 v3, v0, 3, 1
    v_lshl_add_u32 v2, v3, 4, v2
    buffer_load_dwordx4 v[16:19], v2, s[8:11], 0 offen offset:0
    buffer_load_dwordx4 v[20:23], v2, s[8:11], 0 offen offset:512
    buffer_load_dwordx4 v[24:27], v2, s[8:11], 0 offen offset:1024
    buffer_load_dwordx4 v[28:31], v2, s[8:11], 0 offen offset:1536
    s_mov_b32 s32, 0x6d00000
    s_waitcnt vmcnt(0)
    buffer_store_dwordx4 v[16:19], v1, s[4:7], s32 offen sc1
    s_add_u32 s32, s32, 4096
    buffer_store_dwordx4 v[20:23], v1, s[4:7], s32 offen sc1
    s_add_u32 s32, s32, 4096
    buffer_store_dwordx4 v[24:27], v1, s[4:7], s32 offen sc1
    s_add_u32 s32, s32, 4096
    buffer_store_dwordx4 v[28:31], v1, s[4:7], s32 offen sc1
    s_add_u32 s32, s32, 4096
    buffer_store_dwordx4 v[8:11], v1, s[4:7], s32 offen sc1
    s_add_u32 s32, s32, 4096
    buffer_store_dwordx4 v[8:11], v1, s[4:7], s32 offen sc1
    s_add_u32 s32, s32, 4096
    buffer_store_dwordx4 v[8:11], v1, s[4:7], s32 offen sc1
    s_add_u32 s32, s32, 4096
    buffer_store_dwordx4 v[8:11], v1, s[4:7], s32 offen sc1
    s_add_u32 s32, s32, 4096
    v_xor_b32 v2, 0, v1
    v_mov_b32 v2, 0
main_kernel_s_wa3:
    buffer_load_dword v3, v2, s[60:63], 0 offen offset:12 sc1
    s_waitcnt vmcnt(0)
    v_cmp_gt_u32 vcc, 4, v3
    s_cbranch_vccz main_kernel_s_wa3_ok
    s_sleep 4
    s_sub_u32 s29, s29, 1
    s_cbranch_scc0 main_kernel_s_wa3
    s_branch main_kernel_end
main_kernel_s_wa3_ok:
    v_lshlrev_b32 v2, 8, v250
    s_mov_b32 s32, 0x8418100
    s_mov_b64 exec, 15
    buffer_store_dwordx4 v[8:11], v2, s[4:7], s32 offen sc1
    s_mov_b64 exec, -1
main_kernel_s_fd:
    s_cmp_lg_u32 s14, 0
    s_cbranch_scc1 main_kernel_s_wa2_ok
    v_mov_b32 v2, 0
main_kernel_s_wa2:
    buffer_load_dword v3, v2, s[60:63], 0 offen offset:12 sc1
    s_waitcnt vmcnt(0)
    v_cmp_gt_u32 vcc, 4, v3
    s_cbranch_vccz main_kernel_s_wa2_ok
    s_sleep 4
    s_sub_u32 s29, s29, 1
    s_cbranch_scc0 main_kernel_s_wa2
    s_branch main_kernel_end
main_kernel_s_wa2_ok:
    s_waitcnt vmcnt(0)
    s_barrier
    s_cmp_lg_u32 s14, 0
    s_cbranch_scc1 main_kernel_s_end
    s_mov_b64 exec, 1
    buffer_store_dword v8, v4, s[4:7], s16 offen sc1
    s_mov_b64 exec, -1
main_kernel_s_end:
    s_lshl_b32 s32, s12, 5
    s_add_u32 s32, s32, s13
    s_sub_u32 s32, s32, 96
    s_cmp_lt_u32 s32, 16
    s_cbranch_scc1 main_kernel_att
    s_branch main_kernel_worker
main_kernel_end:
    s_endpgm
main_kernel_chain:
    s_lshl_b32 s36, s14, 15
    s_add_u32 s36, s36, 32768
    v_lshlrev_b32 v116, 4, v94
    v_add_u32 v113, s36, v116
    v_lshrrev_b32 v126, 4, v94
    v_and_b32 v127, 15, v94
    v_lshlrev_b32 v95, 2, v126
    v_xor_b32 v127, v127, v95
    v_lshlrev_b32 v127, 4, v127
    v_and_b32 v95, 1, v126
    v_lshrrev_b32 v126, 1, v126
    v_lshl_add_u32 v127, v126, 15, v127
    v_lshl_add_u32 v65, v95, 13, v127
    v_lshl_add_u32 v66, v95, 11, v127
    s_lshr_b32 s32, s14, 1
    s_lshl_b32 s32, s32, 5
    v_xor_b32 v64, s32, v65
    v_bfe_u32 v127, v94, 2, 1
    v_bfe_u32 v95, v94, 4, 1
    v_lshl_add_u32 v78, v95, 1, v127
    v_lshl_add_u32 v126, v126, 3, v78
    v_and_b32 v127, 3, v94
    v_lshlrev_b32 v127, 3, v127
    v_lshl_add_u32 v71, v126, 8, v127
    v_bfe_u32 v95, v94, 3, 1
    v_lshl_add_u32 v71, v95, 5, v71
    v_xor_b32 v126, s14, v78
    v_lshl_add_u32 v126, v126, 6, v71
    v_add_u32 v69, 32768, v126
    v_add_u32 v70, 0x10000, v69
    v_lshl_add_u32 v126, v78, 6, v71
    v_add_u32 v80, s36, v126
    s_lshl_b32 s32, s14, 5
    s_add_u32 s32, s32, 32768
    v_xor_b32 v126, s32, v126
    v_lshl_add_u32 v67, v95, 16, v126
    v_xor_b32 v68, 0x80, v67
    v_xor_b32 v81, 64, v80
    v_xor_b32 v82, 128, v80
    v_xor_b32 v83, 192, v80
    v_and_b32 v126, 7, v94
    v_lshl_add_u32 v126, s13, 3, v126
    v_lshlrev_b32 v77, 10, v126
    s_lshl_b32 s32, s12, 22
    s_lshl_b32 s33, s13, 8
    s_add_u32 s32, s32, s33
    s_lshl_b32 s33, s14, 18
    s_add_u32 s35, s32, s33
    s_bitset0_b32 s33, 19
    s_add_u32 s34, s32, s33
    s_lshl_b32 s3, s13, 18
    s_lshl2_add_u32 s32, s12, s14
    s_lshl_b32 s32, s32, 8
    s_add_u32 s3, s3, s32
    s_cmp_lt_u32 s14, 2
    s_cbranch_scc1 main_kernel_c_pq
    s_mov_b64 s[40:41], s[42:43]
main_kernel_c_pq:
    v_min_u32 v73, 8, v94
    v_lshlrev_b32 v73, 5, v73
    v_mov_b32 v126, 12
    v_cmp_gt_u32 vcc, 8, v94
    v_lshlrev_b32 v74, 2, v94
    v_add_u32 v74, 0x841f000, v74
    v_cndmask_b32 v73, v126, v73, vcc
    v_and_b32 v75, 1, v94
    s_lshl_b32 s32, s13, 8
    s_add_u32 s32, s32, 0x8406000
    v_lshl_add_u32 v75, v75, 13, s32
    s_mov_b32 s8, s44
    s_and_b32 s9, s45, 0xffff
    s_mov_b32 s10, 0x800000
    s_mov_b32 s11, 0x20000
    s_sub_u32 s39, 511, s44
    s_and_b32 s39, s39, 0x380
    s_andn2_b32 s32, s35, 0x1fff
    s_add_u32 s39, s39, s32
    s_add_u32 s32, s39, 0x0
    buffer_load_dword v86, v77, s[8:11], s32 offen
    s_add_u32 s32, s35, 0x0
    s_add_u32 m0, s36, 0
    s_nop 0
    buffer_load_dwordx4 v65, s[8:11], s32 offen lds
    s_add_u32 s32, s35, 0x4000
    s_add_u32 m0, s36, 1024
    s_nop 0
    buffer_load_dwordx4 v65, s[8:11], s32 offen lds
    s_add_u32 s32, s35, 0x10000
    s_add_u32 m0, s36, 2048
    s_nop 0
    buffer_load_dwordx4 v65, s[8:11], s32 offen lds
    s_add_u32 s32, s35, 0x14000
    s_add_u32 m0, s36, 3072
    s_nop 0
    buffer_load_dwordx4 v65, s[8:11], s32 offen lds
    s_add_u32 s32, s35, 0x20000
    s_add_u32 m0, s36, 4096
    s_nop 0
    buffer_load_dwordx4 v65, s[8:11], s32 offen lds
    s_add_u32 s32, s35, 0x24000
    s_add_u32 m0, s36, 5120
    s_nop 0
    buffer_load_dwordx4 v65, s[8:11], s32 offen lds
    s_add_u32 s32, s35, 0x30000
    s_add_u32 m0, s36, 6144
    s_nop 0
    buffer_load_dwordx4 v65, s[8:11], s32 offen lds
    s_add_u32 s32, s35, 0x34000
    s_add_u32 m0, s36, 7168
    s_nop 0
    buffer_load_dwordx4 v65, s[8:11], s32 offen lds
    s_add_u32 s32, s39, 0x100000
    buffer_load_dword v86, v77, s[8:11], s32 offen
    s_add_u32 s32, s35, 0x100000
    s_add_u32 m0, s36, 8192
    s_nop 0
    buffer_load_dwordx4 v65, s[8:11], s32 offen lds
    s_add_u32 s32, s35, 0x104000
    s_add_u32 m0, s36, 9216
    s_nop 0
    buffer_load_dwordx4 v65, s[8:11], s32 offen lds
    s_add_u32 s32, s35, 0x110000
    s_add_u32 m0, s36, 10240
    s_nop 0
    buffer_load_dwordx4 v65, s[8:11], s32 offen lds
    s_add_u32 s32, s35, 0x114000
    s_add_u32 m0, s36, 11264
    s_nop 0
    buffer_load_dwordx4 v65, s[8:11], s32 offen lds
    s_add_u32 s32, s35, 0x120000
    s_add_u32 m0, s36, 12288
    s_nop 0
    buffer_load_dwordx4 v65, s[8:11], s32 offen lds
    s_add_u32 s32, s35, 0x124000
    s_add_u32 m0, s36, 13312
    s_nop 0
    buffer_load_dwordx4 v65, s[8:11], s32 offen lds
    s_add_u32 s32, s35, 0x130000
    s_add_u32 m0, s36, 14336
    s_nop 0
    buffer_load_dwordx4 v65, s[8:11], s32 offen lds
    s_add_u32 s32, s35, 0x134000
    s_add_u32 m0, s36, 15360
    s_nop 0
    buffer_load_dwordx4 v65, s[8:11], s32 offen lds
    s_mov_b32 s8, s40
    s_and_b32 s9, s41, 0xffff
    s_mov_b32 s10, 0x800000
    s_mov_b32 s11, 0x20000
    s_sub_u32 s39, 511, s40
    s_and_b32 s39, s39, 0x380
    s_andn2_b32 s32, s34, 0x1fff
    s_add_u32 s39, s39, s32
    s_add_u32 s32, s39, 0x0
    buffer_load_dword v86, v77, s[8:11], s32 offen
    s_add_u32 s32, s34, 0x0
    s_add_u32 m0, s36, 16384
    s_nop 0
    buffer_load_dwordx4 v64, s[8:11], s32 offen lds
    s_add_u32 s32, s34, 0x4000
    s_add_u32 m0, s36, 17408
    s_nop 0
    buffer_load_dwordx4 v64, s[8:11], s32 offen lds
    s_add_u32 s32, s34, 0x10000
    s_add_u32 m0, s36, 18432
    s_nop 0
    buffer_load_dwordx4 v64, s[8:11], s32 offen lds
    s_add_u32 s32, s34, 0x14000
    s_add_u32 m0, s36, 19456
    s_nop 0
    buffer_load_dwordx4 v64, s[8:11], s32 offen lds
    s_add_u32 s32, s34, 0x20000
    s_add_u32 m0, s36, 20480
    s_nop 0
    buffer_load_dwordx4 v64, s[8:11], s32 offen lds
    s_add_u32 s32, s34, 0x24000
    s_add_u32 m0, s36, 21504
    s_nop 0
    buffer_load_dwordx4 v64, s[8:11], s32 offen lds
    s_add_u32 s32, s34, 0x30000
    s_add_u32 m0, s36, 22528
    s_nop 0
    buffer_load_dwordx4 v64, s[8:11], s32 offen lds
    s_add_u32 s32, s34, 0x34000
    s_add_u32 m0, s36, 23552
    s_nop 0
    buffer_load_dwordx4 v64, s[8:11], s32 offen lds
    s_add_u32 s32, s39, 0x80000
    buffer_load_dword v86, v77, s[8:11], s32 offen
    s_add_u32 s32, s34, 0x80000
    s_add_u32 m0, s36, 24576
    s_nop 0
    buffer_load_dwordx4 v64, s[8:11], s32 offen lds
    s_add_u32 s32, s34, 0x84000
    s_add_u32 m0, s36, 25600
    s_nop 0
    buffer_load_dwordx4 v64, s[8:11], s32 offen lds
    s_add_u32 s32, s34, 0x90000
    s_add_u32 m0, s36, 26624
    s_nop 0
    buffer_load_dwordx4 v64, s[8:11], s32 offen lds
    s_add_u32 s32, s34, 0x94000
    s_add_u32 m0, s36, 27648
    s_nop 0
    buffer_load_dwordx4 v64, s[8:11], s32 offen lds
    s_add_u32 s32, s34, 0xa0000
    s_add_u32 m0, s36, 28672
    s_nop 0
    buffer_load_dwordx4 v64, s[8:11], s32 offen lds
    s_add_u32 s32, s34, 0xa4000
    s_add_u32 m0, s36, 29696
    s_nop 0
    buffer_load_dwordx4 v64, s[8:11], s32 offen lds
    s_add_u32 s32, s34, 0xb0000
    s_add_u32 m0, s36, 30720
    s_nop 0
    buffer_load_dwordx4 v64, s[8:11], s32 offen lds
    s_add_u32 s32, s34, 0xb4000
    s_add_u32 m0, s36, 31744
    s_nop 0
    buffer_load_dwordx4 v64, s[8:11], s32 offen lds
    s_waitcnt vmcnt(27)
    s_barrier
    ds_read_b64_tr_b16 v[128:129], v69 offset:0
    ds_read_b64_tr_b16 v[130:131], v69 offset:1024
    ds_read_b64_tr_b16 v[132:133], v69 offset:4096
    ds_read_b64_tr_b16 v[134:135], v69 offset:5120
    ds_read_b64_tr_b16 v[136:137], v69 offset:32768
    ds_read_b64_tr_b16 v[138:139], v69 offset:33792
    ds_read_b64_tr_b16 v[140:141], v69 offset:36864
    ds_read_b64_tr_b16 v[142:143], v69 offset:37888
    ds_read_b64_tr_b16 v[144:145], v70 offset:0
    ds_read_b64_tr_b16 v[146:147], v70 offset:1024
    ds_read_b64_tr_b16 v[148:149], v70 offset:4096
    ds_read_b64_tr_b16 v[150:151], v70 offset:5120
    ds_read_b64_tr_b16 v[152:153], v70 offset:32768
    ds_read_b64_tr_b16 v[154:155], v70 offset:33792
    ds_read_b64_tr_b16 v[156:157], v70 offset:36864
    ds_read_b64_tr_b16 v[158:159], v70 offset:37888
    s_waitcnt lgkmcnt(0)
    s_waitcnt vmcnt(18)
    s_barrier
    s_add_u32 s32, s39, 0x100000
    buffer_load_dword v86, v77, s[8:11], s32 offen
    s_add_u32 s32, s34, 0x100000
    s_add_u32 m0, s36, 0
    s_nop 0
    buffer_load_dwordx4 v64, s[8:11], s32 offen lds
    s_add_u32 s32, s34, 0x104000
    s_add_u32 m0, s36, 1024
    s_nop 0
    buffer_load_dwordx4 v64, s[8:11], s32 offen lds
    s_add_u32 s32, s34, 0x110000
    s_add_u32 m0, s36, 2048
    s_nop 0
    buffer_load_dwordx4 v64, s[8:11], s32 offen lds
    s_add_u32 s32, s34, 0x114000
    s_add_u32 m0, s36, 3072
    s_nop 0
    buffer_load_dwordx4 v64, s[8:11], s32 offen lds
    s_add_u32 s32, s34, 0x120000
    s_add_u32 m0, s36, 4096
    s_nop 0
    buffer_load_dwordx4 v64, s[8:11], s32 offen lds
    s_add_u32 s32, s34, 0x124000
    s_add_u32 m0, s36, 5120
    s_nop 0
    buffer_load_dwordx4 v64, s[8:11], s32 offen lds
    s_add_u32 s32, s34, 0x130000
    s_add_u32 m0, s36, 6144
    s_nop 0
    buffer_load_dwordx4 v64, s[8:11], s32 offen lds
    s_add_u32 s32, s34, 0x134000
    s_add_u32 m0, s36, 7168
    s_nop 0
    buffer_load_dwordx4 v64, s[8:11], s32 offen lds
    ds_read_b64_tr_b16 v[160:161], v69 offset:8192
    ds_read_b64_tr_b16 v[162:163], v69 offset:9216
    ds_read_b64_tr_b16 v[164:165], v69 offset:12288
    ds_read_b64_tr_b16 v[166:167], v69 offset:13312
    ds_read_b64_tr_b16 v[168:169], v69 offset:40960
    ds_read_b64_tr_b16 v[170:171], v69 offset:41984
    ds_read_b64_tr_b16 v[172:173], v69 offset:45056
    ds_read_b64_tr_b16 v[174:175], v69 offset:46080
    ds_read_b64_tr_b16 v[176:177], v70 offset:8192
    ds_read_b64_tr_b16 v[178:179], v70 offset:9216
    ds_read_b64_tr_b16 v[180:181], v70 offset:12288
    ds_read_b64_tr_b16 v[182:183], v70 offset:13312
    ds_read_b64_tr_b16 v[184:185], v70 offset:40960
    ds_read_b64_tr_b16 v[186:187], v70 offset:41984
    ds_read_b64_tr_b16 v[188:189], v70 offset:45056
    ds_read_b64_tr_b16 v[190:191], v70 offset:46080
    s_waitcnt lgkmcnt(0)
    s_waitcnt vmcnt(18)
    s_barrier
    s_add_u32 s32, s39, 0x180000
    buffer_load_dword v86, v77, s[8:11], s32 offen
    s_add_u32 s32, s34, 0x180000
    s_add_u32 m0, s36, 8192
    s_nop 0
    buffer_load_dwordx4 v64, s[8:11], s32 offen lds
    s_add_u32 s32, s34, 0x184000
    s_add_u32 m0, s36, 9216
    s_nop 0
    buffer_load_dwordx4 v64, s[8:11], s32 offen lds
    s_add_u32 s32, s34, 0x190000
    s_add_u32 m0, s36, 10240
    s_nop 0
    buffer_load_dwordx4 v64, s[8:11], s32 offen lds
    s_add_u32 s32, s34, 0x194000
    s_add_u32 m0, s36, 11264
    s_nop 0
    buffer_load_dwordx4 v64, s[8:11], s32 offen lds
    s_add_u32 s32, s34, 0x1a0000
    s_add_u32 m0, s36, 12288
    s_nop 0
    buffer_load_dwordx4 v64, s[8:11], s32 offen lds
    s_add_u32 s32, s34, 0x1a4000
    s_add_u32 m0, s36, 13312
    s_nop 0
    buffer_load_dwordx4 v64, s[8:11], s32 offen lds
    s_add_u32 s32, s34, 0x1b0000
    s_add_u32 m0, s36, 14336
    s_nop 0
    buffer_load_dwordx4 v64, s[8:11], s32 offen lds
    s_add_u32 s32, s34, 0x1b4000
    s_add_u32 m0, s36, 15360
    s_nop 0
    buffer_load_dwordx4 v64, s[8:11], s32 offen lds
    ds_read_b64_tr_b16 a[0:1], v67 offset:16384
    ds_read_b64_tr_b16 a[2:3], v67 offset:17408
    ds_read_b64_tr_b16 a[4:5], v67 offset:20480
    ds_read_b64_tr_b16 a[6:7], v67 offset:21504
    ds_read_b64_tr_b16 a[8:9], v67 offset:49152
    ds_read_b64_tr_b16 a[10:11], v67 offset:50176
    ds_read_b64_tr_b16 a[12:13], v67 offset:53248
    ds_read_b64_tr_b16 a[14:15], v67 offset:54272
    ds_read_b64_tr_b16 a[128:129], v68 offset:16384
    ds_read_b64_tr_b16 a[130:131], v68 offset:17408
    ds_read_b64_tr_b16 a[132:133], v68 offset:20480
    ds_read_b64_tr_b16 a[134:135], v68 offset:21504
    ds_read_b64_tr_b16 a[136:137], v68 offset:49152
    ds_read_b64_tr_b16 a[138:139], v68 offset:50176
    ds_read_b64_tr_b16 a[140:141], v68 offset:53248
    ds_read_b64_tr_b16 a[142:143], v68 offset:54272
    s_waitcnt lgkmcnt(0)
    s_waitcnt vmcnt(18)
    s_barrier
    s_add_u32 s32, s39, 0x200000
    buffer_load_dword v86, v77, s[8:11], s32 offen
    s_add_u32 s32, s34, 0x200000
    s_add_u32 m0, s36, 16384
    s_nop 0
    buffer_load_dwordx4 v64, s[8:11], s32 offen lds
    s_add_u32 s32, s34, 0x204000
    s_add_u32 m0, s36, 17408
    s_nop 0
    buffer_load_dwordx4 v64, s[8:11], s32 offen lds
    s_add_u32 s32, s34, 0x210000
    s_add_u32 m0, s36, 18432
    s_nop 0
    buffer_load_dwordx4 v64, s[8:11], s32 offen lds
    s_add_u32 s32, s34, 0x214000
    s_add_u32 m0, s36, 19456
    s_nop 0
    buffer_load_dwordx4 v64, s[8:11], s32 offen lds
    s_add_u32 s32, s34, 0x220000
    s_add_u32 m0, s36, 20480
    s_nop 0
    buffer_load_dwordx4 v64, s[8:11], s32 offen lds
    s_add_u32 s32, s34, 0x224000
    s_add_u32 m0, s36, 21504
    s_nop 0
    buffer_load_dwordx4 v64, s[8:11], s32 offen lds
    s_add_u32 s32, s34, 0x230000
    s_add_u32 m0, s36, 22528
    s_nop 0
    buffer_load_dwordx4 v64, s[8:11], s32 offen lds
    s_add_u32 s32, s34, 0x234000
    s_add_u32 m0, s36, 23552
    s_nop 0
    buffer_load_dwordx4 v64, s[8:11], s32 offen lds
    ds_read_b64_tr_b16 a[16:17], v67 offset:24576
    ds_read_b64_tr_b16 a[18:19], v67 offset:25600
    ds_read_b64_tr_b16 a[20:21], v67 offset:28672
    ds_read_b64_tr_b16 a[22:23], v67 offset:29696
    ds_read_b64_tr_b16 a[24:25], v67 offset:57344
    ds_read_b64_tr_b16 a[26:27], v67 offset:58368
    ds_read_b64_tr_b16 a[28:29], v67 offset:61440
    ds_read_b64_tr_b16 a[30:31], v67 offset:62464
    ds_read_b64_tr_b16 a[144:145], v68 offset:24576
    ds_read_b64_tr_b16 a[146:147], v68 offset:25600
    ds_read_b64_tr_b16 a[148:149], v68 offset:28672
    ds_read_b64_tr_b16 a[150:151], v68 offset:29696
    ds_read_b64_tr_b16 a[152:153], v68 offset:57344
    ds_read_b64_tr_b16 a[154:155], v68 offset:58368
    ds_read_b64_tr_b16 a[156:157], v68 offset:61440
    ds_read_b64_tr_b16 a[158:159], v68 offset:62464
    s_waitcnt lgkmcnt(0)
    s_waitcnt vmcnt(18)
    s_barrier
    s_add_u32 s32, s39, 0x280000
    buffer_load_dword v86, v77, s[8:11], s32 offen
    s_add_u32 s32, s34, 0x280000
    s_add_u32 m0, s36, 24576
    s_nop 0
    buffer_load_dwordx4 v64, s[8:11], s32 offen lds
    s_add_u32 s32, s34, 0x284000
    s_add_u32 m0, s36, 25600
    s_nop 0
    buffer_load_dwordx4 v64, s[8:11], s32 offen lds
    s_add_u32 s32, s34, 0x290000
    s_add_u32 m0, s36, 26624
    s_nop 0
    buffer_load_dwordx4 v64, s[8:11], s32 offen lds
    s_add_u32 s32, s34, 0x294000
    s_add_u32 m0, s36, 27648
    s_nop 0
    buffer_load_dwordx4 v64, s[8:11], s32 offen lds
    s_add_u32 s32, s34, 0x2a0000
    s_add_u32 m0, s36, 28672
    s_nop 0
    buffer_load_dwordx4 v64, s[8:11], s32 offen lds
    s_add_u32 s32, s34, 0x2a4000
    s_add_u32 m0, s36, 29696
    s_nop 0
    buffer_load_dwordx4 v64, s[8:11], s32 offen lds
    s_add_u32 s32, s34, 0x2b0000
    s_add_u32 m0, s36, 30720
    s_nop 0
    buffer_load_dwordx4 v64, s[8:11], s32 offen lds
    s_add_u32 s32, s34, 0x2b4000
    s_add_u32 m0, s36, 31744
    s_nop 0
    buffer_load_dwordx4 v64, s[8:11], s32 offen lds
    ds_read_b64_tr_b16 a[32:33], v67 offset:0
    ds_read_b64_tr_b16 a[34:35], v67 offset:1024
    ds_read_b64_tr_b16 a[36:37], v67 offset:4096
    ds_read_b64_tr_b16 a[38:39], v67 offset:5120
    ds_read_b64_tr_b16 a[40:41], v67 offset:32768
    ds_read_b64_tr_b16 a[42:43], v67 offset:33792
    ds_read_b64_tr_b16 a[44:45], v67 offset:36864
    ds_read_b64_tr_b16 a[46:47], v67 offset:37888
    ds_read_b64_tr_b16 a[160:161], v68 offset:0
    ds_read_b64_tr_b16 a[162:163], v68 offset:1024
    ds_read_b64_tr_b16 a[164:165], v68 offset:4096
    ds_read_b64_tr_b16 a[166:167], v68 offset:5120
    ds_read_b64_tr_b16 a[168:169], v68 offset:32768
    ds_read_b64_tr_b16 a[170:171], v68 offset:33792
    ds_read_b64_tr_b16 a[172:173], v68 offset:36864
    ds_read_b64_tr_b16 a[174:175], v68 offset:37888
    s_waitcnt lgkmcnt(0)
    s_waitcnt vmcnt(18)
    s_barrier
    s_add_u32 s32, s39, 0x300000
    buffer_load_dword v86, v77, s[8:11], s32 offen
    s_add_u32 s32, s34, 0x300000
    s_add_u32 m0, s36, 0
    s_nop 0
    buffer_load_dwordx4 v64, s[8:11], s32 offen lds
    s_add_u32 s32, s34, 0x304000
    s_add_u32 m0, s36, 1024
    s_nop 0
    buffer_load_dwordx4 v64, s[8:11], s32 offen lds
    s_add_u32 s32, s34, 0x310000
    s_add_u32 m0, s36, 2048
    s_nop 0
    buffer_load_dwordx4 v64, s[8:11], s32 offen lds
    s_add_u32 s32, s34, 0x314000
    s_add_u32 m0, s36, 3072
    s_nop 0
    buffer_load_dwordx4 v64, s[8:11], s32 offen lds
    s_add_u32 s32, s34, 0x320000
    s_add_u32 m0, s36, 4096
    s_nop 0
    buffer_load_dwordx4 v64, s[8:11], s32 offen lds
    s_add_u32 s32, s34, 0x324000
    s_add_u32 m0, s36, 5120
    s_nop 0
    buffer_load_dwordx4 v64, s[8:11], s32 offen lds
    s_add_u32 s32, s34, 0x330000
    s_add_u32 m0, s36, 6144
    s_nop 0
    buffer_load_dwordx4 v64, s[8:11], s32 offen lds
    s_add_u32 s32, s34, 0x334000
    s_add_u32 m0, s36, 7168
    s_nop 0
    buffer_load_dwordx4 v64, s[8:11], s32 offen lds
    ds_read_b64_tr_b16 a[48:49], v67 offset:8192
    ds_read_b64_tr_b16 a[50:51], v67 offset:9216
    ds_read_b64_tr_b16 a[52:53], v67 offset:12288
    ds_read_b64_tr_b16 a[54:55], v67 offset:13312
    ds_read_b64_tr_b16 a[56:57], v67 offset:40960
    ds_read_b64_tr_b16 a[58:59], v67 offset:41984
    ds_read_b64_tr_b16 a[60:61], v67 offset:45056
    ds_read_b64_tr_b16 a[62:63], v67 offset:46080
    ds_read_b64_tr_b16 a[176:177], v68 offset:8192
    ds_read_b64_tr_b16 a[178:179], v68 offset:9216
    ds_read_b64_tr_b16 a[180:181], v68 offset:12288
    ds_read_b64_tr_b16 a[182:183], v68 offset:13312
    ds_read_b64_tr_b16 a[184:185], v68 offset:40960
    ds_read_b64_tr_b16 a[186:187], v68 offset:41984
    ds_read_b64_tr_b16 a[188:189], v68 offset:45056
    ds_read_b64_tr_b16 a[190:191], v68 offset:46080
    s_waitcnt lgkmcnt(0)
    s_waitcnt vmcnt(18)
    s_barrier
    s_add_u32 s32, s39, 0x380000
    buffer_load_dword v86, v77, s[8:11], s32 offen
    s_add_u32 s32, s34, 0x380000
    s_add_u32 m0, s36, 8192
    s_nop 0
    buffer_load_dwordx4 v64, s[8:11], s32 offen lds
    s_add_u32 s32, s34, 0x384000
    s_add_u32 m0, s36, 9216
    s_nop 0
    buffer_load_dwordx4 v64, s[8:11], s32 offen lds
    s_add_u32 s32, s34, 0x390000
    s_add_u32 m0, s36, 10240
    s_nop 0
    buffer_load_dwordx4 v64, s[8:11], s32 offen lds
    s_add_u32 s32, s34, 0x394000
    s_add_u32 m0, s36, 11264
    s_nop 0
    buffer_load_dwordx4 v64, s[8:11], s32 offen lds
    s_add_u32 s32, s34, 0x3a0000
    s_add_u32 m0, s36, 12288
    s_nop 0
    buffer_load_dwordx4 v64, s[8:11], s32 offen lds
    s_add_u32 s32, s34, 0x3a4000
    s_add_u32 m0, s36, 13312
    s_nop 0
    buffer_load_dwordx4 v64, s[8:11], s32 offen lds
    s_add_u32 s32, s34, 0x3b0000
    s_add_u32 m0, s36, 14336
    s_nop 0
    buffer_load_dwordx4 v64, s[8:11], s32 offen lds
    s_add_u32 s32, s34, 0x3b4000
    s_add_u32 m0, s36, 15360
    s_nop 0
    buffer_load_dwordx4 v64, s[8:11], s32 offen lds
    ds_read_b64_tr_b16 a[64:65], v67 offset:16384
    ds_read_b64_tr_b16 a[66:67], v67 offset:17408
    ds_read_b64_tr_b16 a[68:69], v67 offset:20480
    ds_read_b64_tr_b16 a[70:71], v67 offset:21504
    ds_read_b64_tr_b16 a[72:73], v67 offset:49152
    ds_read_b64_tr_b16 a[74:75], v67 offset:50176
    ds_read_b64_tr_b16 a[76:77], v67 offset:53248
    ds_read_b64_tr_b16 a[78:79], v67 offset:54272
    ds_read_b64_tr_b16 a[192:193], v68 offset:16384
    ds_read_b64_tr_b16 a[194:195], v68 offset:17408
    ds_read_b64_tr_b16 a[196:197], v68 offset:20480
    ds_read_b64_tr_b16 a[198:199], v68 offset:21504
    ds_read_b64_tr_b16 a[200:201], v68 offset:49152
    ds_read_b64_tr_b16 a[202:203], v68 offset:50176
    ds_read_b64_tr_b16 a[204:205], v68 offset:53248
    ds_read_b64_tr_b16 a[206:207], v68 offset:54272
    s_waitcnt lgkmcnt(0)
    buffer_load_dword v72, v73, s[60:63], 0 offen sc1
    buffer_load_dwordx2 v[84:85], off, s[60:63], 0 offset:16 sc1
    s_waitcnt vmcnt(20)
    s_barrier
    s_mov_b32 s8, s46
    s_and_b32 s9, s47, 0xffff
    s_mov_b32 s10, 0x800000
    s_mov_b32 s11, 0x20000
    s_xor_b32 s32, s3, 0x0
    s_add_u32 m0, s36, 16384
    s_nop 0
    buffer_load_dwordx4 v66, s[8:11], s32 offen lds
    s_xor_b32 s32, s3, 0x1000
    s_add_u32 m0, s36, 17408
    s_nop 0
    buffer_load_dwordx4 v66, s[8:11], s32 offen lds
    s_xor_b32 s32, s3, 0x2000
    s_add_u32 m0, s36, 18432
    s_nop 0
    buffer_load_dwordx4 v66, s[8:11], s32 offen lds
    s_xor_b32 s32, s3, 0x3000
    s_add_u32 m0, s36, 19456
    s_nop 0
    buffer_load_dwordx4 v66, s[8:11], s32 offen lds
    s_xor_b32 s32, s3, 0x4000
    s_add_u32 m0, s36, 20480
    s_nop 0
    buffer_load_dwordx4 v66, s[8:11], s32 offen lds
    s_xor_b32 s32, s3, 0x5000
    s_add_u32 m0, s36, 21504
    s_nop 0
    buffer_load_dwordx4 v66, s[8:11], s32 offen lds
    s_xor_b32 s32, s3, 0x6000
    s_add_u32 m0, s36, 22528
    s_nop 0
    buffer_load_dwordx4 v66, s[8:11], s32 offen lds
    s_xor_b32 s32, s3, 0x7000
    s_add_u32 m0, s36, 23552
    s_nop 0
    buffer_load_dwordx4 v66, s[8:11], s32 offen lds
    ds_read_b64_tr_b16 a[80:81], v67 offset:24576
    ds_read_b64_tr_b16 a[82:83], v67 offset:25600
    ds_read_b64_tr_b16 a[84:85], v67 offset:28672
    ds_read_b64_tr_b16 a[86:87], v67 offset:29696
    ds_read_b64_tr_b16 a[88:89], v67 offset:57344
    ds_read_b64_tr_b16 a[90:91], v67 offset:58368
    ds_read_b64_tr_b16 a[92:93], v67 offset:61440
    ds_read_b64_tr_b16 a[94:95], v67 offset:62464
    ds_read_b64_tr_b16 a[208:209], v68 offset:24576
    ds_read_b64_tr_b16 a[210:211], v68 offset:25600
    ds_read_b64_tr_b16 a[212:213], v68 offset:28672
    ds_read_b64_tr_b16 a[214:215], v68 offset:29696
    ds_read_b64_tr_b16 a[216:217], v68 offset:57344
    ds_read_b64_tr_b16 a[218:219], v68 offset:58368
    ds_read_b64_tr_b16 a[220:221], v68 offset:61440
    ds_read_b64_tr_b16 a[222:223], v68 offset:62464
    s_waitcnt lgkmcnt(0)
    s_waitcnt vmcnt(19)
    s_barrier
    s_xor_b32 s32, s3, 0x10000
    s_add_u32 m0, s36, 24576
    s_nop 0
    buffer_load_dwordx4 v66, s[8:11], s32 offen lds
    s_xor_b32 s32, s3, 0x11000
    s_add_u32 m0, s36, 25600
    s_nop 0
    buffer_load_dwordx4 v66, s[8:11], s32 offen lds
    s_xor_b32 s32, s3, 0x12000
    s_add_u32 m0, s36, 26624
    s_nop 0
    buffer_load_dwordx4 v66, s[8:11], s32 offen lds
    s_xor_b32 s32, s3, 0x13000
    s_add_u32 m0, s36, 27648
    s_nop 0
    buffer_load_dwordx4 v66, s[8:11], s32 offen lds
    s_xor_b32 s32, s3, 0x14000
    s_add_u32 m0, s36, 28672
    s_nop 0
    buffer_load_dwordx4 v66, s[8:11], s32 offen lds
    s_xor_b32 s32, s3, 0x15000
    s_add_u32 m0, s36, 29696
    s_nop 0
    buffer_load_dwordx4 v66, s[8:11], s32 offen lds
    s_xor_b32 s32, s3, 0x16000
    s_add_u32 m0, s36, 30720
    s_nop 0
    buffer_load_dwordx4 v66, s[8:11], s32 offen lds
    s_xor_b32 s32, s3, 0x17000
    s_add_u32 m0, s36, 31744
    s_nop 0
    buffer_load_dwordx4 v66, s[8:11], s32 offen lds
    ds_read_b64_tr_b16 a[96:97], v67 offset:0
    ds_read_b64_tr_b16 a[98:99], v67 offset:1024
    ds_read_b64_tr_b16 a[100:101], v67 offset:4096
    ds_read_b64_tr_b16 a[102:103], v67 offset:5120
    ds_read_b64_tr_b16 a[104:105], v67 offset:32768
    ds_read_b64_tr_b16 a[106:107], v67 offset:33792
    ds_read_b64_tr_b16 a[108:109], v67 offset:36864
    ds_read_b64_tr_b16 a[110:111], v67 offset:37888
    ds_read_b64_tr_b16 a[224:225], v68 offset:0
    ds_read_b64_tr_b16 a[226:227], v68 offset:1024
    ds_read_b64_tr_b16 a[228:229], v68 offset:4096
    ds_read_b64_tr_b16 a[230:231], v68 offset:5120
    ds_read_b64_tr_b16 a[232:233], v68 offset:32768
    ds_read_b64_tr_b16 a[234:235], v68 offset:33792
    ds_read_b64_tr_b16 a[236:237], v68 offset:36864
    ds_read_b64_tr_b16 a[238:239], v68 offset:37888
    s_waitcnt lgkmcnt(0)
    s_waitcnt vmcnt(18)
    s_barrier
    s_mov_b32 s8, s44
    s_and_b32 s9, s45, 0xffff
    s_mov_b32 s10, 0x800000
    s_mov_b32 s11, 0x20000
    s_sub_u32 s39, 511, s44
    s_and_b32 s39, s39, 0x380
    s_andn2_b32 s32, s35, 0x1fff
    s_add_u32 s39, s39, s32
    s_add_u32 s32, s39, 0x200000
    buffer_load_dword v86, v77, s[8:11], s32 offen
    s_add_u32 s32, s35, 0x200000
    s_add_u32 m0, s36, 0
    s_nop 0
    buffer_load_dwordx4 v65, s[8:11], s32 offen lds
    s_add_u32 s32, s35, 0x204000
    s_add_u32 m0, s36, 1024
    s_nop 0
    buffer_load_dwordx4 v65, s[8:11], s32 offen lds
    s_add_u32 s32, s35, 0x210000
    s_add_u32 m0, s36, 2048
    s_nop 0
    buffer_load_dwordx4 v65, s[8:11], s32 offen lds
    s_add_u32 s32, s35, 0x214000
    s_add_u32 m0, s36, 3072
    s_nop 0
    buffer_load_dwordx4 v65, s[8:11], s32 offen lds
    s_add_u32 s32, s35, 0x220000
    s_add_u32 m0, s36, 4096
    s_nop 0
    buffer_load_dwordx4 v65, s[8:11], s32 offen lds
    s_add_u32 s32, s35, 0x224000
    s_add_u32 m0, s36, 5120
    s_nop 0
    buffer_load_dwordx4 v65, s[8:11], s32 offen lds
    s_add_u32 s32, s35, 0x230000
    s_add_u32 m0, s36, 6144
    s_nop 0
    buffer_load_dwordx4 v65, s[8:11], s32 offen lds
    s_add_u32 s32, s35, 0x234000
    s_add_u32 m0, s36, 7168
    s_nop 0
    buffer_load_dwordx4 v65, s[8:11], s32 offen lds
    ds_read_b64_tr_b16 a[112:113], v67 offset:8192
    ds_read_b64_tr_b16 a[114:115], v67 offset:9216
    ds_read_b64_tr_b16 a[116:117], v67 offset:12288
    ds_read_b64_tr_b16 a[118:119], v67 offset:13312
    ds_read_b64_tr_b16 a[120:121], v67 offset:40960
    ds_read_b64_tr_b16 a[122:123], v67 offset:41984
    ds_read_b64_tr_b16 a[124:125], v67 offset:45056
    ds_read_b64_tr_b16 a[126:127], v67 offset:46080
    ds_read_b64_tr_b16 a[240:241], v68 offset:8192
    ds_read_b64_tr_b16 a[242:243], v68 offset:9216
    ds_read_b64_tr_b16 a[244:245], v68 offset:12288
    ds_read_b64_tr_b16 a[246:247], v68 offset:13312
    ds_read_b64_tr_b16 a[248:249], v68 offset:40960
    ds_read_b64_tr_b16 a[250:251], v68 offset:41984
    ds_read_b64_tr_b16 a[252:253], v68 offset:45056
    ds_read_b64_tr_b16 a[254:255], v68 offset:46080
    s_waitcnt lgkmcnt(0)
    s_waitcnt vmcnt(17)
    s_barrier
    s_add_u32 s32, s39, 0x300000
    buffer_load_dword v86, v77, s[8:11], s32 offen
    s_add_u32 s32, s35, 0x300000
    s_add_u32 m0, s36, 8192
    s_nop 0
    buffer_load_dwordx4 v65, s[8:11], s32 offen lds
    s_add_u32 s32, s35, 0x304000
    s_add_u32 m0, s36, 9216
    s_nop 0
    buffer_load_dwordx4 v65, s[8:11], s32 offen lds
    s_add_u32 s32, s35, 0x310000
    s_add_u32 m0, s36, 10240
    s_nop 0
    buffer_load_dwordx4 v65, s[8:11], s32 offen lds
    s_add_u32 s32, s35, 0x314000
    s_add_u32 m0, s36, 11264
    s_nop 0
    buffer_load_dwordx4 v65, s[8:11], s32 offen lds
    s_add_u32 s32, s35, 0x320000
    s_add_u32 m0, s36, 12288
    s_nop 0
    buffer_load_dwordx4 v65, s[8:11], s32 offen lds
    s_add_u32 s32, s35, 0x324000
    s_add_u32 m0, s36, 13312
    s_nop 0
    buffer_load_dwordx4 v65, s[8:11], s32 offen lds
    s_add_u32 s32, s35, 0x330000
    s_add_u32 m0, s36, 14336
    s_nop 0
    buffer_load_dwordx4 v65, s[8:11], s32 offen lds
    s_add_u32 s32, s35, 0x334000
    s_add_u32 m0, s36, 15360
    s_nop 0
    buffer_load_dwordx4 v65, s[8:11], s32 offen lds
    v_readlane_b32 s48, v72, 0
    v_readlane_b32 s49, v72, 1
    v_readlane_b32 s50, v72, 2
    v_readlane_b32 s51, v72, 3
    v_readlane_b32 s52, v72, 4
    v_readlane_b32 s53, v72, 5
    v_readlane_b32 s54, v72, 6
    v_readlane_b32 s55, v72, 7
    v_readlane_b32 s38, v72, 8
    s_nop 3
    s_add_u32 s33, s48, s49
    s_add_u32 s33, s33, s50
    s_add_u32 s33, s33, s51
    s_add_u32 s33, s33, s52
    s_add_u32 s33, s33, s53
    s_add_u32 s33, s33, s54
    s_add_u32 s33, s33, s55
    s_cmp_ge_u32 s38, 4
    s_cselect_b32 s33, s33, 0
    s_cmp_ge_u32 s33, 256
    s_cselect_b32 s38, 0, 1
    ds_read_b64_tr_b16 v[192:193], v80 offset:16384
    ds_read_b64_tr_b16 v[194:195], v80 offset:17408
    ds_read_b64_tr_b16 v[196:197], v80 offset:20480
    ds_read_b64_tr_b16 v[198:199], v80 offset:21504
    ds_read_b64_tr_b16 v[208:209], v81 offset:16384
    ds_read_b64_tr_b16 v[210:211], v81 offset:17408
    ds_read_b64_tr_b16 v[212:213], v81 offset:20480
    ds_read_b64_tr_b16 v[214:215], v81 offset:21504
    ds_read_b64_tr_b16 v[224:225], v82 offset:16384
    ds_read_b64_tr_b16 v[226:227], v82 offset:17408
    ds_read_b64_tr_b16 v[228:229], v82 offset:20480
    ds_read_b64_tr_b16 v[230:231], v82 offset:21504
    ds_read_b64_tr_b16 v[240:241], v83 offset:16384
    ds_read_b64_tr_b16 v[242:243], v83 offset:17408
    ds_read_b64_tr_b16 v[244:245], v83 offset:20480
    ds_read_b64_tr_b16 v[246:247], v83 offset:21504
    s_waitcnt lgkmcnt(0)
    s_waitcnt vmcnt(18)
    s_barrier
    s_mov_b32 s8, s46
    s_and_b32 s9, s47, 0xffff
    s_mov_b32 s10, 0x800000
    s_mov_b32 s11, 0x20000
    s_xor_b32 s32, s3, 0x20000
    s_add_u32 m0, s36, 16384
    s_nop 0
    buffer_load_dwordx4 v66, s[8:11], s32 offen lds
    s_xor_b32 s32, s3, 0x21000
    s_add_u32 m0, s36, 17408
    s_nop 0
    buffer_load_dwordx4 v66, s[8:11], s32 offen lds
    s_xor_b32 s32, s3, 0x22000
    s_add_u32 m0, s36, 18432
    s_nop 0
    buffer_load_dwordx4 v66, s[8:11], s32 offen lds
    s_xor_b32 s32, s3, 0x23000
    s_add_u32 m0, s36, 19456
    s_nop 0
    buffer_load_dwordx4 v66, s[8:11], s32 offen lds
    s_xor_b32 s32, s3, 0x24000
    s_add_u32 m0, s36, 20480
    s_nop 0
    buffer_load_dwordx4 v66, s[8:11], s32 offen lds
    s_xor_b32 s32, s3, 0x25000
    s_add_u32 m0, s36, 21504
    s_nop 0
    buffer_load_dwordx4 v66, s[8:11], s32 offen lds
    s_xor_b32 s32, s3, 0x26000
    s_add_u32 m0, s36, 22528
    s_nop 0
    buffer_load_dwordx4 v66, s[8:11], s32 offen lds
    s_xor_b32 s32, s3, 0x27000
    s_add_u32 m0, s36, 23552
    s_nop 0
    buffer_load_dwordx4 v66, s[8:11], s32 offen lds
    ds_read_b64_tr_b16 v[200:201], v80 offset:24576
    ds_read_b64_tr_b16 v[202:203], v80 offset:25600
    ds_read_b64_tr_b16 v[204:205], v80 offset:28672
    ds_read_b64_tr_b16 v[206:207], v80 offset:29696
    ds_read_b64_tr_b16 v[216:217], v81 offset:24576
    ds_read_b64_tr_b16 v[218:219], v81 offset:25600
    ds_read_b64_tr_b16 v[220:221], v81 offset:28672
    ds_read_b64_tr_b16 v[222:223], v81 offset:29696
    ds_read_b64_tr_b16 v[232:233], v82 offset:24576
    ds_read_b64_tr_b16 v[234:235], v82 offset:25600
    ds_read_b64_tr_b16 v[236:237], v82 offset:28672
    ds_read_b64_tr_b16 v[238:239], v82 offset:29696
    ds_read_b64_tr_b16 v[248:249], v83 offset:24576
    ds_read_b64_tr_b16 v[250:251], v83 offset:25600
    ds_read_b64_tr_b16 v[252:253], v83 offset:28672
    ds_read_b64_tr_b16 v[254:255], v83 offset:29696
    s_waitcnt lgkmcnt(0)
    s_waitcnt vmcnt(17)
    s_barrier
    s_xor_b32 s32, s3, 0x30000
    s_add_u32 m0, s36, 24576
    s_nop 0
    buffer_load_dwordx4 v66, s[8:11], s32 offen lds
    s_xor_b32 s32, s3, 0x31000
    s_add_u32 m0, s36, 25600
    s_nop 0
    buffer_load_dwordx4 v66, s[8:11], s32 offen lds
    s_xor_b32 s32, s3, 0x32000
    s_add_u32 m0, s36, 26624
    s_nop 0
    buffer_load_dwordx4 v66, s[8:11], s32 offen lds
    s_xor_b32 s32, s3, 0x33000
    s_add_u32 m0, s36, 27648
    s_nop 0
    buffer_load_dwordx4 v66, s[8:11], s32 offen lds
    s_xor_b32 s32, s3, 0x34000
    s_add_u32 m0, s36, 28672
    s_nop 0
    buffer_load_dwordx4 v66, s[8:11], s32 offen lds
    s_xor_b32 s32, s3, 0x35000
    s_add_u32 m0, s36, 29696
    s_nop 0
    buffer_load_dwordx4 v66, s[8:11], s32 offen lds
    s_xor_b32 s32, s3, 0x36000
    s_add_u32 m0, s36, 30720
    s_nop 0
    buffer_load_dwordx4 v66, s[8:11], s32 offen lds
    s_xor_b32 s32, s3, 0x37000
    s_add_u32 m0, s36, 31744
    s_nop 0
    buffer_load_dwordx4 v66, s[8:11], s32 offen lds
    ds_read_b64_tr_b16 v[0:1], v69 offset:0
    ds_read_b64_tr_b16 v[2:3], v69 offset:1024
    ds_read_b64_tr_b16 v[4:5], v69 offset:4096
    ds_read_b64_tr_b16 v[6:7], v69 offset:5120
    ds_read_b64_tr_b16 v[8:9], v69 offset:32768
    ds_read_b64_tr_b16 v[10:11], v69 offset:33792
    ds_read_b64_tr_b16 v[12:13], v69 offset:36864
    ds_read_b64_tr_b16 v[14:15], v69 offset:37888
    ds_read_b64_tr_b16 v[16:17], v70 offset:0
    ds_read_b64_tr_b16 v[18:19], v70 offset:1024
    ds_read_b64_tr_b16 v[20:21], v70 offset:4096
    ds_read_b64_tr_b16 v[22:23], v70 offset:5120
    ds_read_b64_tr_b16 v[24:25], v70 offset:32768
    ds_read_b64_tr_b16 v[26:27], v70 offset:33792
    ds_read_b64_tr_b16 v[28:29], v70 offset:36864
    ds_read_b64_tr_b16 v[30:31], v70 offset:37888
    s_waitcnt lgkmcnt(0)
    v_and_b32 v64, 15, v94
    v_lshrrev_b32 v65, 4, v94
    v_mov_b32 v66, 0x3c00
    v_mov_b32 v67, 0x3c000000
    v_cmp_eq_u32 vcc, 0, v64
    s_nop 1
    v_cndmask_b32 v127, 0, v66, vcc
    v_cmp_eq_u32 vcc, 1, v64
    s_nop 1
    v_cndmask_b32 v106, v127, v67, vcc
    v_cmp_eq_u32 vcc, 2, v64
    s_nop 1
    v_cndmask_b32 v127, 0, v66, vcc
    v_cmp_eq_u32 vcc, 3, v64
    s_nop 1
    v_cndmask_b32 v107, v127, v67, vcc
    v_cmp_eq_u32 vcc, 4, v64
    s_nop 1
    v_cndmask_b32 v127, 0, v66, vcc
    v_cmp_eq_u32 vcc, 5, v64
    s_nop 1
    v_cndmask_b32 v108, v127, v67, vcc
    v_cmp_eq_u32 vcc, 6, v64
    s_nop 1
    v_cndmask_b32 v127, 0, v66, vcc
    v_cmp_eq_u32 vcc, 7, v64
    s_nop 1
    v_cndmask_b32 v109, v127, v67, vcc
    v_mov_b32 v66, 0x3f80
    v_mov_b32 v67, 0x3f800000
    v_and_b32 v126, 1, v65
    v_lshrrev_b32 v68, 1, v65
    v_lshl_add_u32 v126, v126, 2, v68
    v_sub_u32 v68, v64, v126
    v_cmp_eq_u32 vcc, 0, v68
    s_nop 1
    v_cndmask_b32 v127, 0, v66, vcc
    v_cmp_eq_u32 vcc, 2, v68
    s_nop 1
    v_cndmask_b32 v102, v127, v67, vcc
    v_cmp_eq_u32 vcc, 0, v68
    s_nop 1
    v_cndmask_b32 v127, 0, v66, vcc
    v_cmp_eq_u32 vcc, 2, v68
    s_nop 1
    v_cndmask_b32 v103, v127, v67, vcc
    v_cmp_eq_u32 vcc, 8, v68
    s_nop 1
    v_cndmask_b32 v127, 0, v66, vcc
    v_cmp_eq_u32 vcc, 10, v68
    s_nop 1
    v_cndmask_b32 v104, v127, v67, vcc
    v_cmp_eq_u32 vcc, 8, v68
    s_nop 1
    v_cndmask_b32 v127, 0, v66, vcc
    v_cmp_eq_u32 vcc, 10, v68
    s_nop 1
    v_cndmask_b32 v105, v127, v67, vcc
    v_mov_b32 v100, 0x3f003f00
    v_mov_b32 v101, 0x3f003f00
    v_and_b32 v126, 7, v64
    v_lshlrev_b32 v126, 4, v126
    v_lshl_add_u32 v114, v65, 7, v126
    v_lshrrev_b32 v126, 3, v64
    v_lshl_add_u32 v119, v126, 3, v114
    v_lshl_add_u32 v118, v126, 11, v114
    v_lshl_add_u32 v118, s14, 9, v118
    v_lshlrev_b32 v126, 4, v64
    v_lshl_add_u32 v120, v65, 13, v126
    v_lshlrev_b32 v123, 3, v94
    s_lshl_b32 s32, s14, 10
    s_add_u32 s32, s32, 16384
    v_and_b32 v126, 32, v94
    v_lshlrev_b32 v126, 1, v126
    v_xor_b32 v126, v126, v123
    v_add_u32 v124, s32, v126
    v_lshrrev_b32 v126, 2, v64
    v_lshrrev_b32 v127, 1, v65
    v_lshl_add_u32 v126, v126, 1, v127
    v_and_b32 v127, 3, v64
    v_lshl_add_u32 v126, v126, 2, v127
    v_and_b32 v127, 1, v65
    v_lshl_add_u32 v126, v126, 1, v127
    v_lshlrev_b32 v126, 3, v126
    v_mov_b32 v95, 0x7f000000
    v_mov_b32 v66, 0x4444
    v_mov_b32 v67, 0xeeee
    v_cmp_gt_u32 vcc, 8, v64
    s_nop 1
    v_cndmask_b32 v122, v95, v126, vcc
    v_cndmask_b32 v125, v114, v95, vcc
    v_cndmask_b32 v110, v67, v66, vcc
    v_lshrrev_b32 v126, 2, v94
    v_lshlrev_b32 v126, 3, v126
    v_and_b32 v127, 2, v94
    v_lshlrev_b32 v127, 5, v127
    v_xor_b32 v126, v126, v127
    v_and_b32 v127, 3, v94
    v_lshl_add_u32 v115, v127, 7, v126
    s_mov_b32 s37, 0x3f80
    s_mov_b32 s57, 0x3f800000
    s_and_b32 s32, s14, 1
    s_lshr_b32 s33, s14, 1
    s_lshl2_add_u32 s32, s32, s33
    s_lshl_b32 s59, s32, 9
    s_mov_b32 s17, 0
    s_mov_b32 s0, 0x00ff00ff
    s_mov_b32 s1, s0
    s_mov_b64 s[44:45], s[0:1]
    s_lshl_b32 s32, s12, 18
    s_lshl2_add_u32 s33, s13, s14
    s_lshl_b32 s34, s33, 11
    s_add_u32 s28, s34, 0x2800000
    s_add_u32 s21, s32, s34
    s_add_u32 s21, s21, 0x6c00000
    s_lshl_b32 s34, s13, 8
    s_add_u32 s23, s32, s34
    s_add_u32 s23, s23, 0x6c80000
    s_lshl_b32 s32, s12, 13
    s_add_u32 s25, s32, 0x6d00000
    s_add_u32 s24, s25, s34
    s_lshl_b32 s34, s33, 9
    s_add_u32 s26, s34, 0x8000000
    s_add_u32 s31, s34, 0x6e00000
    s_cmp_eq_u32 s12, 0
    s_cselect_b32 s26, s26, s31
    s_lshl_b32 s32, s12, 7
    s_add_u32 s32, s32, s33
    s_cmp_eq_u32 s32, 1
    s_mov_b32 s39, 0x7f000000
    s_cselect_b32 s39, 0x841ec04, s39
    s_lshl_b32 s27, s13, 12
    s_lshl_b32 s36, s14, 11
    s_and_b32 s33, s36, 2048
    s_add_u32 s27, s27, s33
    s_lshr_b32 s33, s14, 1
    s_lshl_b32 s33, s33, 17
    s_add_u32 s27, s27, s33
    s_add_u32 s27, s27, 0x1800000
    s_add_u32 s36, s36, 24576
    v_add_u32 v112, 24576, v116
    s_lshl_b32 s32, s12, 12
    s_add_u32 s32, s32, 0x841c000
    s_lshl2_add_u32 s46, s13, s32
    v_lshl_add_u32 v117, v123, 25, v114
    s_and_b32 s33, s13, 3
    s_lshl_b32 s33, s33, 7
    s_add_u32 s47, s32, s33
    s_cmp_eq_u32 s14, 0
    s_cselect_b32 s47, s47, 0x7f000000
    s_cselect_b32 s11, -1, 0
    s_mov_b32 s30, 0x3e0293ee
    v_mov_b32 v121, 0x7f000000
    v_and_b32 v127, 1, v94
    s_mov_b32 exec_lo, 0
    s_mov_b32 exec_hi, 0x300
    s_lshl_b32 s32, s13, 8
    s_add_u32 s32, s32, 0x8406000
    v_lshl_add_u32 v121, v127, 13, s32
    s_mov_b32 exec_hi, 0x3c00
    s_mov_b32 s32, 0x841760c
    v_lshl_add_u32 v121, v64, 8, s32
    s_mov_b64 exec, -1
    s_waitcnt vmcnt(16)
    s_barrier
    ds_write_b128 v113, v[0:3] offset:0
    ds_write_b128 v113, v[4:7] offset:1024
    ds_write_b128 v113, v[8:11] offset:2048
    ds_write_b128 v113, v[12:15] offset:3072
    ds_write_b128 v113, v[16:19] offset:4096
    ds_write_b128 v113, v[20:23] offset:5120
    ds_write_b128 v113, v[24:27] offset:6144
    ds_write_b128 v113, v[28:31] offset:7168
    ds_read_b64_tr_b16 v[32:33], v69 offset:8192
    ds_read_b64_tr_b16 v[34:35], v69 offset:9216
    ds_read_b64_tr_b16 v[36:37], v69 offset:12288
    ds_read_b64_tr_b16 v[38:39], v69 offset:13312
    ds_read_b64_tr_b16 v[40:41], v69 offset:40960
    ds_read_b64_tr_b16 v[42:43], v69 offset:41984
    ds_read_b64_tr_b16 v[44:45], v69 offset:45056
    ds_read_b64_tr_b16 v[46:47], v69 offset:46080
    ds_read_b64_tr_b16 v[48:49], v70 offset:8192
    ds_read_b64_tr_b16 v[50:51], v70 offset:9216
    ds_read_b64_tr_b16 v[52:53], v70 offset:12288
    ds_read_b64_tr_b16 v[54:55], v70 offset:13312
    ds_read_b64_tr_b16 v[56:57], v70 offset:40960
    ds_read_b64_tr_b16 v[58:59], v70 offset:41984
    ds_read_b64_tr_b16 v[60:61], v70 offset:45056
    ds_read_b64_tr_b16 v[62:63], v70 offset:46080
    s_waitcnt lgkmcnt(0)
    s_waitcnt vmcnt(8)
    s_barrier
    ds_write_b128 v113, v[32:35] offset:8192
    ds_write_b128 v113, v[36:39] offset:9216
    ds_write_b128 v113, v[40:43] offset:10240
    ds_write_b128 v113, v[44:47] offset:11264
    ds_write_b128 v113, v[48:51] offset:12288
    ds_write_b128 v113, v[52:55] offset:13312
    ds_write_b128 v113, v[56:59] offset:14336
    ds_write_b128 v113, v[60:63] offset:15360
    buffer_load_dword v76, v74, s[4:7], 0 offen sc1
    buffer_load_dword v79, v75, s[4:7], 0 offen sc1
    ds_read_b64_tr_b16 v[0:1], v80 offset:16384
    ds_read_b64_tr_b16 v[2:3], v80 offset:17408
    ds_read_b64_tr_b16 v[4:5], v80 offset:20480
    ds_read_b64_tr_b16 v[6:7], v80 offset:21504
    ds_read_b64_tr_b16 v[8:9], v81 offset:16384
    ds_read_b64_tr_b16 v[10:11], v81 offset:17408
    ds_read_b64_tr_b16 v[12:13], v81 offset:20480
    ds_read_b64_tr_b16 v[14:15], v81 offset:21504
    ds_read_b64_tr_b16 v[16:17], v82 offset:16384
    ds_read_b64_tr_b16 v[18:19], v82 offset:17408
    ds_read_b64_tr_b16 v[20:21], v82 offset:20480
    ds_read_b64_tr_b16 v[22:23], v82 offset:21504
    ds_read_b64_tr_b16 v[24:25], v83 offset:16384
    ds_read_b64_tr_b16 v[26:27], v83 offset:17408
    ds_read_b64_tr_b16 v[28:29], v83 offset:20480
    ds_read_b64_tr_b16 v[30:31], v83 offset:21504
    s_waitcnt lgkmcnt(0)
    ds_write_b128 v113, v[0:3] offset:16384
    ds_write_b128 v113, v[4:7] offset:17408
    ds_write_b128 v113, v[8:11] offset:18432
    ds_write_b128 v113, v[12:15] offset:19456
    ds_write_b128 v113, v[16:19] offset:20480
    ds_write_b128 v113, v[20:23] offset:21504
    ds_write_b128 v113, v[24:27] offset:22528
    ds_write_b128 v113, v[28:31] offset:23552
    s_waitcnt lgkmcnt(0)
    s_waitcnt vmcnt(2)
    s_waitcnt vmcnt(0)
    v_min_u32 v76, v76, v79
    v_cmp_eq_u32 vcc, 0, v76
    s_cmp_eq_u32 s38, 0
    s_cbranch_scc0 main_kernel_c_sl0
    s_cbranch_vccnz main_kernel_c_sl1
    s_branch main_kernel_c_kv0_ok
main_kernel_c_sl0:
    v_and_b32 v126, 7, v94
    v_lshlrev_b32 v126, 5, v126
main_kernel_c_mode_cnt:
    buffer_load_dword v127, v126, s[60:63], 0 offen sc1
    s_waitcnt vmcnt(0)
    v_readlane_b32 s48, v127, 0
    v_readlane_b32 s49, v127, 1
    v_readlane_b32 s50, v127, 2
    v_readlane_b32 s51, v127, 3
    v_readlane_b32 s52, v127, 4
    v_readlane_b32 s53, v127, 5
    v_readlane_b32 s54, v127, 6
    v_readlane_b32 s55, v127, 7
    s_nop 3
    s_add_u32 s33, s48, s49
    s_add_u32 s33, s33, s50
    s_add_u32 s33, s33, s51
    s_add_u32 s33, s33, s52
    s_add_u32 s33, s33, s53
    s_add_u32 s33, s33, s54
    s_add_u32 s33, s33, s55
    s_cmp_ge_u32 s33, 256
    s_cbranch_scc1 main_kernel_c_mode_cnt_ok
    s_sub_u32 s29, s29, 1
    s_cbranch_scc1 main_kernel_end
    s_sleep 4
    s_branch main_kernel_c_mode_cnt
main_kernel_c_mode_cnt_ok:
    v_mov_b32 v126, 0
main_kernel_c_wa:
    buffer_load_dword v127, v126, s[60:63], 0 offen offset:12 sc1
    s_waitcnt vmcnt(0)
    v_cmp_gt_u32 vcc, 4, v127
    s_cbranch_vccz main_kernel_c_wa_ok
    s_sleep 4
    s_sub_u32 s29, s29, 1
    s_cbranch_scc0 main_kernel_c_wa
    s_branch main_kernel_end
main_kernel_c_wa_ok:
main_kernel_c_sl1:
    v_lshlrev_b32 v126, 2, v94
    s_mov_b32 s32, 0x841f000
main_kernel_c_wf:
    buffer_load_dword v0, v126, s[4:7], s32 offen sc1
    s_waitcnt vmcnt(0)
    v_cmp_eq_u32 vcc, 0, v0
    s_cbranch_vccz main_kernel_c_wf_ok
    s_sleep 4
    s_sub_u32 s29, s29, 1
    s_cbranch_scc0 main_kernel_c_wf
    s_branch main_kernel_end
main_kernel_c_wf_ok:
    s_mov_b32 exec_lo, 0
    s_mov_b32 exec_hi, 0x300
    v_subrev_u32 v127, 0, v121
main_kernel_c_kv0:
    buffer_load_dword v126, v127, s[4:7], 0 offen sc1
    s_waitcnt vmcnt(0)
    v_cmp_eq_u32 vcc, 0, v126
    s_cbranch_vccz main_kernel_c_kv0_ok
    s_sleep 2
    s_sub_u32 s29, s29, 1
    s_cbranch_scc0 main_kernel_c_kv0
    s_branch main_kernel_end
main_kernel_c_kv0_ok:
    s_mov_b32 exec_lo, 0
    s_mov_b32 exec_hi, 0x100
    v_add_u32 v121, 4, v121
    s_mov_b64 exec, -1
    v_add_u32 v121, 4, v121
    v_lshlrev_b32 v126, 3, v116
    v_and_b32 v126, 0x780, v126
    s_mov_b32 m0, s36
    buffer_load_dword v111, v126, s[4:7], s21 offen sc1
    buffer_load_dwordx4 v116, s[4:7], s27 offen offset:0 sc1 lds
    buffer_load_dwordx4 v116, s[4:7], s27 offen offset:1024 sc1 lds
    s_lshl_b32 s32, s14, 11
    s_add_u32 m0, s32, 0
    s_add_u32 s32, s32, s25
    buffer_load_dwordx4 v116, s[4:7], s32 offen offset:0 sc1 lds
    buffer_load_dwordx4 v116, s[4:7], s32 offen offset:1024 sc1 lds
    s_add_u32 s27, s27, 0x40000
    ds_read_b64_tr_b16 v[32:33], v80 offset:24576
    ds_read_b64_tr_b16 v[34:35], v80 offset:25600
    ds_read_b64_tr_b16 v[36:37], v80 offset:28672
    ds_read_b64_tr_b16 v[38:39], v80 offset:29696
    ds_read_b64_tr_b16 v[40:41], v81 offset:24576
    ds_read_b64_tr_b16 v[42:43], v81 offset:25600
    ds_read_b64_tr_b16 v[44:45], v81 offset:28672
    ds_read_b64_tr_b16 v[46:47], v81 offset:29696
    ds_read_b64_tr_b16 v[48:49], v82 offset:24576
    ds_read_b64_tr_b16 v[50:51], v82 offset:25600
    ds_read_b64_tr_b16 v[52:53], v82 offset:28672
    ds_read_b64_tr_b16 v[54:55], v82 offset:29696
    ds_read_b64_tr_b16 v[56:57], v83 offset:24576
    ds_read_b64_tr_b16 v[58:59], v83 offset:25600
    ds_read_b64_tr_b16 v[60:61], v83 offset:28672
    ds_read_b64_tr_b16 v[62:63], v83 offset:29696
    s_waitcnt lgkmcnt(0)
    ds_write_b128 v113, v[32:35] offset:24576
    ds_write_b128 v113, v[36:39] offset:25600
    ds_write_b128 v113, v[40:43] offset:26624
    ds_write_b128 v113, v[44:47] offset:27648
    ds_write_b128 v113, v[48:51] offset:28672
    ds_write_b128 v113, v[52:55] offset:29696
    ds_write_b128 v113, v[56:59] offset:30720
    ds_write_b128 v113, v[60:63] offset:31744
    s_waitcnt lgkmcnt(0)
main_kernel_c_nb:
    v_readfirstlane_b32 s33, v84
    v_readfirstlane_b32 s32, v85
    s_nop 3
    s_and_b32 s34, s32, s33
    s_cbranch_scc1 main_kernel_c_nb_ok
    buffer_load_dwordx2 v[84:85], off, s[60:63], 0 offset:16 sc1
    s_sub_u32 s29, s29, 1
    s_cbranch_scc1 main_kernel_end
    s_waitcnt vmcnt(0)
    s_branch main_kernel_c_nb
main_kernel_c_nb_ok:
    s_and_b32 s33, s33, 1
    s_lshl_b32 s32, s12, 5
    s_add_u32 s32, s32, s13
    s_lshl1_add_u32 s32, s32, s33
    s_lshl2_add_u32 s32, s32, s14
    s_lshl_b32 s32, s32, 11
    s_add_u32 s18, s32, 0x8c00000
    s_xor_b32 s19, s18, 0x80000
    v_mov_b32 v64, 0
    v_mov_b32 v65, 0
    v_mov_b32 v66, 0
    v_mov_b32 v67, 0
    v_mov_b32 v68, 0
    v_mov_b32 v69, 0
    v_mov_b32 v70, 0
    v_mov_b32 v71, 0
    v_mov_b32 v96, 0
    v_mov_b32 v97, 0
    v_mov_b32 v98, 0
    v_mov_b32 v99, 0
    s_xor_b32 s36, s36, 0x4000
    s_waitcnt vmcnt(0)
    buffer_store_dword v64, off, s[4:7], s18 offset:1536 sc1
    s_mov_b32 m0, s36
    buffer_load_dwordx4 v[88:91], v116, s[4:7], s28 offen offset:0 sc1
    buffer_load_dwordx4 v116, s[4:7], s27 offen offset:0 sc1 lds
    buffer_load_dwordx4 v[92:95], v116, s[4:7], s28 offen offset:1024 sc1
    s_barrier
    s_memrealtime s[32:33]
    s_waitcnt lgkmcnt(0)
    s_mul_i32 s32, s32, 22
    s_sub_u32 s20, s32, 0x40000
    s_mov_b32 s9, 0
    s_mov_b32 s10, 0
    s_memtime s[52:53]
    s_waitcnt lgkmcnt(0)
    s_sub_u32 s38, s52, s32
    s_sub_u32 s3, s52, 0x4000
    v_mov_b32 v126, s38
    ds_write_b32 v123, v126 offset:20992
    s_waitcnt lgkmcnt(0)
    s_min_u32 s32, s48, s49
    s_cmp_ge_u32 s32, 32
    s_cbranch_scc0 main_kernel_cs_top
    .p2align 6
main_kernel_cf_top:
    s_barrier
main_kernel_cf_mrd:
    ds_read_b128 v[0:3], v114 offset:0
    ds_read_b128 v[4:7], v114 offset:512
    ds_read_b128 v[8:11], v114 offset:1024
    ds_read_b128 v[12:15], v114 offset:1536
    ds_read_b128 v[16:19], v114 offset:2048
    s_waitcnt lgkmcnt(4)
    v_smfmac_f32_16x16x64_bf16 v[96:99], v[0:3], a[0:7], v110
    ds_read_b128 v[20:23], v114 offset:2560
    s_waitcnt lgkmcnt(4)
    v_smfmac_f32_16x16x64_bf16 v[96:99], v[4:7], a[8:15], v110
    ds_read_b128 v[24:27], v114 offset:3072
    s_waitcnt lgkmcnt(4)
    s_bfe_u32 s22, s17, 0x10001
    v_smfmac_f32_16x16x64_bf16 v[96:99], v[8:11], a[16:23], v110
    ds_read_b128 v[28:31], v114 offset:3584
    s_waitcnt lgkmcnt(4)
    v_smfmac_f32_16x16x64_bf16 v[96:99], v[12:15], a[24:31], v110
    ds_read_b128 v[32:35], v114 offset:4096
    s_waitcnt lgkmcnt(4)
    v_smfmac_f32_16x16x64_bf16 v[96:99], v[16:19], a[32:39], v110
    ds_read_b128 v[36:39], v114 offset:4608
    s_waitcnt lgkmcnt(4)
    v_smfmac_f32_16x16x64_bf16 v[96:99], v[20:23], a[40:47], v110
    ds_read_b128 v[40:43], v114 offset:5120
    s_waitcnt lgkmcnt(4)
    v_smfmac_f32_16x16x64_bf16 v[96:99], v[24:27], a[48:55], v110
    ds_read_b128 v[44:47], v114 offset:5632
    s_waitcnt lgkmcnt(4)
    v_smfmac_f32_16x16x64_bf16 v[96:99], v[28:31], a[56:63], v110
    ds_read_b128 v[48:51], v114 offset:6144
    s_waitcnt lgkmcnt(4)
    v_smfmac_f32_16x16x64_bf16 v[96:99], v[32:35], a[64:71], v110
    ds_read_b128 v[52:55], v114 offset:6656
    s_waitcnt lgkmcnt(4)
    v_smfmac_f32_16x16x64_bf16 v[96:99], v[36:39], a[72:79], v110
    ds_read_b128 v[56:59], v114 offset:7168
    s_waitcnt lgkmcnt(4)
    v_smfmac_f32_16x16x64_bf16 v[96:99], v[40:43], a[80:87], v110
    ds_read_b128 v[60:63], v114 offset:7680
    s_waitcnt lgkmcnt(4)
    v_smfmac_f32_16x16x64_bf16 v[96:99], v[44:47], a[88:95], v110
    s_waitcnt lgkmcnt(3)
    buffer_load_dword v111, v121, s[4:7], 0 offen sc1
    v_smfmac_f32_16x16x64_bf16 v[96:99], v[48:51], a[96:103], v110
    s_waitcnt lgkmcnt(2)
    ds_read_b128 v[80:83], v113 offset:0
    v_smfmac_f32_16x16x64_bf16 v[96:99], v[52:55], a[104:111], v110
    s_waitcnt lgkmcnt(2)
    ds_read_b128 v[84:87], v113 offset:1024
    v_smfmac_f32_16x16x64_bf16 v[96:99], v[56:59], a[112:119], v110
    s_waitcnt lgkmcnt(2)
    v_smfmac_f32_16x16x64_bf16 v[96:99], v[60:63], a[120:127], v110
    v_smfmac_f32_16x16x64_bf16 v[68:71], v[0:3], a[128:135], v110
    ds_read_b128 v[72:75], v113 offset:2048
    v_smfmac_f32_16x16x64_bf16 v[68:71], v[4:7], a[136:143], v110
    s_nop 1
    v_pk_add_f32 v[126:127], v[96:97], v[98:99]
    ds_read_b128 v[76:79], v113 offset:3072
    v_smfmac_f32_16x16x64_bf16 v[68:71], v[8:11], a[144:151], v110
    v_cmp_u_f32 vcc, v126, v127
    v_smfmac_f32_16x16x64_bf16 v[68:71], v[12:15], a[152:159], v110
    v_cvt_pk_bf16_f32 v126, v96, v97
    v_smfmac_f32_16x16x64_bf16 v[68:71], v[16:19], a[160:167], v110
    v_cvt_pk_bf16_f32 v127, v98, v99
    s_and_b64 s[42:43], vcc, s[44:45]
    s_cbranch_scc1 main_kernel_cf_m_f
    v_smfmac_f32_16x16x64_bf16 v[68:71], v[20:23], a[168:175], v110
    v_bfi_b32 v126, 1, s22, v126
    buffer_store_dwordx2 v[126:127], v123, s[4:7], s18 offen sc1
    v_smfmac_f32_16x16x64_bf16 v[68:71], v[24:27], a[176:183], v110
    s_mov_b64 s[44:45], s[0:1]
    v_smfmac_f32_16x16x64_bf16 v[68:71], v[28:31], a[184:191], v110
    s_add_u32 s17, s17, 1
    s_bfe_u32 s40, s17, 0x10001
    v_smfmac_f32_16x16x64_bf16 v[68:71], v[32:35], a[192:199], v110
    s_add_u32 s28, s28, 0x40000
    s_mov_b32 m0, s36
    v_smfmac_f32_16x16x64_bf16 v[68:71], v[36:39], a[200:207], v110
    s_add_u32 s34, s3, 2130
    v_smfmac_f32_16x16x64_bf16 v[68:71], v[40:43], a[208:215], v110
    v_smfmac_f32_16x16x64_bf16 v[68:71], v[44:47], a[216:223], v110
    v_smfmac_f32_16x16x64_bf16 v[68:71], v[48:51], a[224:231], v110
    v_smfmac_f32_16x16x64_bf16 v[68:71], v[52:55], a[232:239], v110
    v_smfmac_f32_16x16x64_bf16 v[68:71], v[56:59], a[240:247], v110
    v_smfmac_f32_16x16x64_bf16 v[68:71], v[60:63], a[248:255], v110
    s_waitcnt lgkmcnt(2)
    v_smfmac_f32_16x16x64_bf16 v[64:67], v[32:35], v[80:87], v110
    s_waitcnt lgkmcnt(0)
    s_nop 3
    v_cvt_pk_bf16_f32 v126, v68, v69
    v_cvt_pk_bf16_f32 v127, v70, v71
    v_bfi_b32 v126, 1, s22, v126
    buffer_store_dwordx2 v[126:127], v123, s[4:7], s18 offen offset:512 sc1
    ds_read_b128 v[80:83], v113 offset:4096
    v_smfmac_f32_16x16x64_bf16 v[64:67], v[36:39], v[72:79], v110
    ds_read_b128 v[84:87], v113 offset:5120
    v_smfmac_f32_16x16x64_bf16 v[64:67], v[0:3], v[128:135], v110
    ds_read_b128 v[72:75], v113 offset:6144
    v_smfmac_f32_16x16x64_bf16 v[64:67], v[4:7], v[136:143], v110
    ds_read_b128 v[76:79], v113 offset:7168
    v_smfmac_f32_16x16x64_bf16 v[64:67], v[8:11], v[144:151], v110
    ds_read_b128 v[32:35], v113 offset:8192
    v_smfmac_f32_16x16x64_bf16 v[64:67], v[12:15], v[152:159], v110
    ds_read_b128 v[36:39], v113 offset:9216
    v_smfmac_f32_16x16x64_bf16 v[64:67], v[16:19], v[160:167], v110
    ds_read_b128 v[0:3], v113 offset:10240
    s_memtime s[52:53]
    v_smfmac_f32_16x16x64_bf16 v[64:67], v[20:23], v[168:175], v110
    ds_read_b128 v[4:7], v113 offset:11264
    s_memtime s[52:53]
    s_xor_b32 s32, s9, s22
    s_bitcmp1_b32 s32, 0
    s_cbranch_scc1 main_kernel_cf_t_p
main_kernel_cf_t_ok:
    s_sub_u32 s32, s9, s10
    v_smfmac_f32_16x16x64_bf16 v[64:67], v[24:27], v[176:183], v110
    ds_read_b128 v[8:11], v113 offset:12288
    s_memtime s[52:53]
    s_max_i32 s32, s32, 0
    s_min_i32 s32, s32, 0x4000
    v_smfmac_f32_16x16x64_bf16 v[64:67], v[28:31], v[184:191], v110
    s_waitcnt lgkmcnt(7)
    ds_read_b128 v[12:15], v113 offset:13312
    s_memtime s[52:53]
    s_add_u32 s34, s34, s32
    s_and_b32 s34, s34, s11
    v_smfmac_f32_16x16x64_bf16 v[64:67], v[40:43], v[80:87], v110
    s_waitcnt lgkmcnt(6)
    ds_read_b128 v[16:19], v113 offset:14336
    s_cmp_lt_u32 s52, s34
    s_cbranch_scc1 main_kernel_cf_t_w
main_kernel_cf_t_go:
    s_barrier
    buffer_load_dwordx2 v[126:127], v123, s[4:7], s19 offen offset:0 sc1
    v_smfmac_f32_16x16x64_bf16 v[64:67], v[44:47], v[72:79], v110
    s_waitcnt lgkmcnt(5)
    ds_read_b128 v[20:23], v113 offset:15360
    v_smfmac_f32_16x16x64_bf16 v[64:67], v[48:51], v[32:39], v110
    s_waitcnt lgkmcnt(4)
    v_smfmac_f32_16x16x64_bf16 v[64:67], v[52:55], v[0:7], v110
    s_waitcnt lgkmcnt(2)
    ds_read_b128 v[24:27], v112 offset:6144
    ds_read_b128 v[28:31], v112 offset:7168
    v_smfmac_f32_16x16x64_bf16 v[64:67], v[56:59], v[8:15], v110
    s_waitcnt lgkmcnt(2)
    ds_read_b128 v[0:3], v112 offset:0
    ds_read_b128 v[4:7], v112 offset:1024
    v_smfmac_f32_16x16x64_bf16 v[64:67], v[60:63], v[16:23], v110
    ds_read_b128 v[8:11], v112 offset:2048
    ds_read_b128 v[12:15], v112 offset:3072
    ds_read_b128 v[16:19], v112 offset:4096
    ds_read_b128 v[20:23], v112 offset:5120
    v_mov_b32 v76, 0
    v_mov_b32 v77, 0
    v_mov_b32 v78, 0
    s_nop 0
    v_permlane32_swap_b32 v64, v65
    v_permlane32_swap_b32 v66, v67
    v_cvt_pk_bf16_f32 v84, v64, v66
    v_cvt_pk_bf16_f32 v85, v65, v67
    v_bfi_b32 v84, 1, s22, v84
    buffer_load_dwordx2 v[42:43], v123, s[4:7], s19 offen offset:512 sc1
    v_mov_b32 v79, 0
    v_mov_b32 v80, 0
    v_mov_b32 v81, 0
    v_mov_b32 v82, 0
    v_mov_b32 v83, 0
    v_mov_b32 v60, 0
    v_mov_b32 v60, 0
    v_mov_b32 v60, 0
    v_mov_b32 v60, 0
    v_mov_b32 v60, 0
    v_mov_b32 v60, 0
    v_mov_b32 v60, 0
    buffer_store_dwordx2 v[84:85], v123, s[4:7], s18 offen offset:1024 sc1
    v_mov_b32 v60, 0
    v_mov_b32 v60, 0
    v_mov_b32 v60, 0
    v_mov_b32 v60, 0
    v_mov_b32 v60, 0
    v_mov_b32 v60, 0
    v_mov_b32 v60, 0
    v_mov_b32 v60, 0
    v_mov_b32 v60, 0
    v_mov_b32 v60, 0
    v_mov_b32 v60, 0
    v_mov_b32 v60, 0
    v_mov_b32 v60, 0
    v_mov_b32 v60, 0
    v_mov_b32 v60, 0
    v_mov_b32 v60, 0
    v_mov_b32 v60, 0
    v_mov_b32 v60, 0
    v_mov_b32 v60, 0
    v_mov_b32 v60, 0
    v_mov_b32 v60, 0
    v_mov_b32 v60, 0
    v_mov_b32 v60, 0
    v_mov_b32 v60, 0
    v_mov_b32 v60, 0
    v_mov_b32 v60, 0
    v_mov_b32 v60, 0
    v_mov_b32 v60, 0
    v_mov_b32 v60, 0
    v_mov_b32 v60, 0
    v_mov_b32 v60, 0
    v_mov_b32 v60, 0
    v_mov_b32 v60, 0
    v_mov_b32 v60, 0
    v_mov_b32 v60, 0
    v_mov_b32 v60, 0
    v_mov_b32 v60, 0
    v_mov_b32 v60, 0
    s_waitcnt vmcnt(2)
main_kernel_cf_z0:
    v_dot2_f32_bf16 v44, v126, s37, v96
    v_dot2_f32_bf16 v45, v126, s57, v97
    v_dot2_f32_bf16 v46, v127, s37, v98
    v_dot2_f32_bf16 v47, v127, s57, v99
    v_bitop3_b32 v60, v126, s22, 1 bitop3:0x28
    v_cvt_pk_bf16_f32 v44, v44, v45
    v_cmp_ne_u32 vcc, 0, v60
    v_cvt_pk_bf16_f32 v45, v46, v47
    ds_write_b64 v124, v[44:45] offset:0
    buffer_load_dwordx2 v[64:65], v123, s[4:7], s19 offen offset:512 sc1
    v_cmp_eq_u32 s[42:43], 0, v111
    s_cbranch_vccnz main_kernel_cf_z0_f
    v_mov_b32 v96, 0x3f803f80
    v_mov_b32 v97, 0x3f803f80
    v_mov_b32 v98, 0x3f803f80
    v_mov_b32 v99, 0x3f803f80
    s_and_b32 s32, s43, 0x3f00
    s_cbranch_scc1 main_kernel_cf_kvw
main_kernel_cf_kvok:
    s_waitcnt lgkmcnt(0)
    s_barrier
    ds_read_b64_tr_b16 v[48:49], v115 offset:16384
    ds_read_b64_tr_b16 v[50:51], v115 offset:17408
    ds_read_b64_tr_b16 v[52:53], v115 offset:18432
    ds_read_b64_tr_b16 v[54:55], v115 offset:19456
    s_waitcnt vmcnt(2)
    s_memtime s[52:53]
    v_dot2_f32_bf16 v44, v42, s37, v68
    v_dot2_f32_bf16 v45, v42, s57, v69
    v_dot2_f32_bf16 v46, v43, s37, v70
    v_dot2_f32_bf16 v47, v43, s57, v71
    v_bitop3_b32 v60, v42, s22, 1 bitop3:0x28
    v_cvt_pk_bf16_f32 v44, v44, v45
    v_cmp_ne_u32 vcc, 0, v60
    v_cvt_pk_bf16_f32 v45, v46, v47
    ds_write_b64 v124, v[44:45] offset:512
    s_waitcnt lgkmcnt(3)
    v_mfma_f32_16x16x32_bf16 v[32:35], v[0:3], v[48:51], 0
    v_mfma_f32_16x16x32_bf16 v[36:39], v[16:19], v[48:51], 0
    s_cbranch_vccnz main_kernel_cf_z1_f
main_kernel_cf_z_ok:
    v_mfma_f32_16x16x32_bf16 v[72:75], v[48:51], v[48:51], 0
    s_waitcnt lgkmcnt(1)
    s_sub_u32 s32, s52, s38
    v_mov_b32 v46, s32
    v_mfma_f32_16x16x32_bf16 v[32:35], v[4:7], v[52:55], v[32:35]
    buffer_load_dwordx2 v[86:87], v123, s[4:7], s19 offen offset:1024 sc1
    buffer_store_dword v46, v117, s[4:7], s46 offen
    s_cmp_eq_u32 s17, 64
    s_waitcnt lgkmcnt(0)
    s_barrier
    ds_read_b64_tr_b16 v[56:57], v115 offset:16896
    ds_read_b64_tr_b16 v[58:59], v115 offset:17920
    ds_read_b64_tr_b16 v[60:61], v115 offset:18944
    ds_read_b64_tr_b16 v[62:63], v115 offset:19968
    s_cbranch_scc1 main_kernel_cf_last
    v_bfe_u32 v47, v123, 1, 7
    buffer_load_dwordx2 v[126:127], v123, s[4:7], s19 offen offset:1024 sc1
    buffer_load_dwordx4 v116, s[4:7], s27 offen offset:1024 sc1 lds
    v_mfma_f32_16x16x32_bf16 v[36:39], v[20:23], v[52:55], v[36:39]
    v_mfma_f32_16x16x32_bf16 v[72:75], v[52:55], v[52:55], v[72:75]
    s_waitcnt lgkmcnt(2)
    v_mfma_f32_16x16x32_bf16 v[72:75], v[56:59], v[56:59], v[72:75]
    v_mfma_f32_16x16x32_bf16 v[32:35], v[8:11], v[56:59], v[32:35]
    s_waitcnt lgkmcnt(0)
    v_mfma_f32_16x16x32_bf16 v[72:75], v[60:63], v[60:63], v[72:75]
    ds_read_b128 v[0:3], v113 offset:16384
    v_mfma_f32_16x16x32_bf16 v[32:35], v[12:15], v[60:63], v[32:35]
    ds_read_b128 v[16:19], v113 offset:18432
    v_mfma_f32_16x16x32_bf16 v[36:39], v[24:27], v[56:59], v[36:39]
    ds_read_b128 v[4:7], v113 offset:17408
    s_nop 0
    v_permlane32_swap_b32 v72, v73
    v_permlane32_swap_b32 v74, v75
    v_mfma_f32_16x16x32_bf16 v[36:39], v[28:31], v[60:63], v[36:39]
    ds_read_b128 v[20:23], v113 offset:19456
    v_mul_f32 v73, s30, v73
    v_mul_f32 v75, s30, v75
    v_exp_f32 v32, v32
    ds_read_b128 v[8:11], v113 offset:24576
    v_exp_f32 v33, v33
    ds_read_b128 v[12:15], v113 offset:25600
    v_exp_f32 v73, v73
    ds_read_b128 v[24:27], v113 offset:26624
    v_exp_f32 v75, v75
    ds_read_b128 v[28:31], v113 offset:27648
    v_exp_f32 v34, v34
    v_cvt_pk_bf16_f32 v72, v73, v75
    v_cvt_pk_bf16_f32 v73, v73, v75
    v_exp_f32 v35, v35
    s_waitcnt vmcnt(4)
    v_mfma_f32_16x16x16_bf16 v[40:43], v[100:101], v[72:73], 0
    v_exp_f32 v36, v36
    v_cvt_pk_bf16_f32 v32, v32, v33
    v_exp_f32 v37, v37
    v_cvt_pk_bf16_f32 v33, v34, v35
    v_exp_f32 v38, v38
    v_exp_f32 v39, v39
    v_cvt_pk_bf16_f32 v34, v36, v37
    v_cvt_pk_bf16_f32 v35, v38, v39
    s_nop 1
    v_mfma_f32_16x16x32_bf16 v[40:43], v[96:99], v[32:35], v[40:43]
    v_mfma_f32_16x16x32_bf16 v[64:67], v[88:91], v[32:35], 0
    v_mfma_f32_16x16x32_bf16 v[68:71], v[92:95], v[32:35], 0
    s_waitcnt vmcnt(3)
main_kernel_cf_v_ok:
    v_bitop3_b32 v44, v86, s22, 1 bitop3:0x28
    v_swap_b32 v85, v86
    v_cmp_ne_u32 vcc, 0, v44
main_kernel_cf_d_ok:
    s_nop 0
    v_mfma_f32_16x16x16_bf16 v[64:67], v[84:85], v[72:73], v[64:67]
    v_mfma_f32_16x16x16_bf16 v[68:71], v[86:87], v[72:73], v[68:71]
    s_cbranch_vccnz main_kernel_cf_v_f
    v_rcp_f32 v42, v40
    v_subrev_u32 v41, 0x21800000, v41
    v_cmp_lt_u32 vcc, 0x3c000000, v41
    s_nop 0
    v_pk_mul_f32 v[64:65], v[64:65], v[42:43] op_sel_hi:[1,0]
    v_pk_mul_f32 v[66:67], v[66:67], v[42:43] op_sel_hi:[1,0]
    v_cvt_pk_bf16_f32 v44, v64, v65
    v_pk_mul_f32 v[68:69], v[68:69], v[42:43] op_sel_hi:[1,0]
    v_cvt_pk_bf16_f32 v45, v66, v67
    v_pk_mul_f32 v[70:71], v[70:71], v[42:43] op_sel_hi:[1,0]
    v_cvt_pk_bf16_f32 v46, v68, v69
    v_cvt_pk_bf16_f32 v47, v70, v71
    ds_write_b128 v118, v[44:47]
    s_and_b64 s[42:43], vcc, s[44:45]
    s_cbranch_scc1 main_kernel_cf_d_f
    s_mov_b64 s[44:45], s[0:1]
    v_mov_b32 v64, 0
    v_mov_b32 v65, 0
    v_mov_b32 v66, 0
    v_mov_b32 v67, 0
    v_mov_b32 v68, 0
    v_mov_b32 v69, 0
    v_mov_b32 v70, 0
    v_mov_b32 v71, 0
    v_bfe_u32 v90, v123, 1, 7
    s_xor_b32 s23, s23, 0x80000
    s_waitcnt lgkmcnt(0)
    s_barrier
    ds_read_b128 v[56:59], v114 offset:1024
    ds_read_b128 v[60:63], v114 offset:1536
    ds_read_b128 v[48:51], v114 offset:0
    ds_read_b128 v[52:55], v114 offset:512
    s_xor_b32 s18, s18, 0x100000
    s_xor_b32 s19, s18, 0x80000
    s_xor_b32 s25, s25, 0x4000
    s_add_u32 s27, s27, 0x40000
    v_add_u32 v121, 4, v121
    v_xor_b32 v112, 0x4000, v112
    s_xor_b32 s36, s36, 0x4000
    s_mov_b32 m0, 0
    s_mov_b32 s54, s24
    s_xor_b32 s24, s24, 0x4000
    s_add_u32 s55, s25, 4096
    v_mov_b32 v89, s17
    s_mov_b32 s15, 0
    s_add_u32 s56, s19, 1536
    s_xor_b32 s9, s11, s40
    s_add_u32 s16, s20, s38
    s_waitcnt lgkmcnt(3)
    v_smfmac_f32_16x16x64_bf16 v[76:79], v[56:59], v[0:7], v110
    s_waitcnt lgkmcnt(2)
    ds_read_b128 v[0:3], v113 offset:20480
    v_smfmac_f32_16x16x64_bf16 v[76:79], v[60:63], v[8:15], v110
    s_waitcnt lgkmcnt(2)
    ds_read_b128 v[4:7], v113 offset:21504
    v_smfmac_f32_16x16x64_bf16 v[76:79], v[48:51], v[192:199], v110
    s_waitcnt lgkmcnt(2)
    ds_read_b128 v[8:11], v113 offset:28672
    v_smfmac_f32_16x16x64_bf16 v[76:79], v[52:55], v[200:207], v110
    ds_read_b128 v[12:15], v113 offset:29696
    buffer_load_dword v111, v90, s[4:7], s47 offen sc1
    v_smfmac_f32_16x16x64_bf16 v[80:83], v[56:59], v[16:23], v110
    ds_read_b128 v[16:19], v113 offset:22528
    v_smfmac_f32_16x16x64_bf16 v[80:83], v[60:63], v[24:31], v110
    ds_read_b128 v[20:23], v113 offset:23552
    v_smfmac_f32_16x16x64_bf16 v[80:83], v[48:51], v[208:215], v110
    ds_read_b128 v[24:27], v113 offset:30720
    v_cvt_pk_f16_f32 v40, v76, v77
    v_smfmac_f32_16x16x64_bf16 v[80:83], v[52:55], v[216:223], v110
    ds_read_b128 v[28:31], v113 offset:31744
    v_cvt_pk_f16_f32 v41, v78, v79
    v_smfmac_f32_16x16x64_bf16 v[64:67], v[48:51], v[224:231], v110
    v_bfi_b32 v40, 1, s22, v40
    v_smfmac_f32_16x16x64_bf16 v[64:67], v[52:55], v[232:239], v110
    s_waitcnt lgkmcnt(6)
    buffer_load_dword v111, v90, s[4:7], s47 offen sc1
    v_smfmac_f32_16x16x64_bf16 v[64:67], v[56:59], v[0:7], v110
    s_waitcnt lgkmcnt(4)
    buffer_store_dwordx2 v[40:41], v119, s[4:7], s21 offen offset:0
    v_cvt_pk_f16_f32 v42, v80, v81
    v_smfmac_f32_16x16x64_bf16 v[64:67], v[60:63], v[8:15], v110
    v_cvt_pk_f16_f32 v43, v82, v83
    v_smfmac_f32_16x16x64_bf16 v[68:71], v[48:51], v[240:247], v110
    v_bfi_b32 v42, 1, s22, v42
    v_smfmac_f32_16x16x64_bf16 v[68:71], v[52:55], v[248:255], v110
    s_waitcnt lgkmcnt(2)
    v_smfmac_f32_16x16x64_bf16 v[68:71], v[56:59], v[16:23], v110
    s_waitcnt lgkmcnt(0)
    buffer_store_dwordx2 v[42:43], v119, s[4:7], s21 offen offset:512
    v_cvt_pk_f16_f32 v44, v64, v65
    v_smfmac_f32_16x16x64_bf16 v[68:71], v[60:63], v[24:31], v110
    v_cvt_pk_f16_f32 v45, v66, v67
    v_bfi_b32 v44, 1, s22, v44
    s_cmp_lg_u32 s14, 0
    buffer_store_dwordx2 v[44:45], v119, s[4:7], s21 offen offset:1024
    s_nop 3
    v_cvt_pk_f16_f32 v46, v68, v69
    v_cvt_pk_f16_f32 v47, v70, v71
    v_bfi_b32 v46, 1, s22, v46
    buffer_store_dwordx2 v[46:47], v119, s[4:7], s21 offen offset:1536
    s_cbranch_scc1 main_kernel_cf_wx
    s_waitcnt vmcnt(5)
    s_xor_b32 s21, s21, 0x80000
main_kernel_cf_rgo:
    v_subrev_u32 v32, s20, v111
    s_memtime s[52:53]
    v_cmp_lt_u32 vcc, 0x100000, v32
    v_max_u32_dpp v32, v32, v32 row_shr:1 row_mask:0xf bank_mask:0xf
    s_nop 0
    s_nop 0
    v_max_u32_dpp v32, v32, v32 row_shr:2 row_mask:0xf bank_mask:0xf
    s_nop 0
    s_cbranch_vccnz main_kernel_cf_fsp
main_kernel_cf_fok:
    s_nop 0
    v_max_u32_dpp v32, v32, v32 row_shr:4 row_mask:0xf bank_mask:0xf
    s_memtime s[52:53]
    s_nop 0
    v_max_u32_dpp v32, v32, v32 row_shr:8 row_mask:0xf bank_mask:0xf
    s_memtime s[52:53]
    s_nop 0
    v_max_u32_dpp v32, v32, v32 row_bcast:15 row_mask:0xa bank_mask:0xf
    s_memtime s[52:53]
    s_sub_u32 s33, s52, s16
    v_readlane_b32 s32, v32, 31
    s_add_u32 s33, s33, 0x400
    s_memtime s[52:53]
    s_add_u32 s34, s16, 1650
    s_memtime s[52:53]
    s_min_u32 s32, s32, s33
    s_max_u32 s32, s32, s15
    s_add_u32 s34, s34, s32
    s_mov_b32 s35, 200
main_kernel_cf_fw:
    s_memtime s[52:53]
    s_cmp_ge_u32 s52, s34
    s_cbranch_scc1 main_kernel_cf_fgo
    s_memtime s[52:53]
    s_cmp_ge_u32 s52, s34
    s_cbranch_scc1 main_kernel_cf_fgo
    s_memtime s[52:53]
    s_cmp_ge_u32 s52, s34
    s_cbranch_scc1 main_kernel_cf_fgo
    s_memtime s[52:53]
    s_cmp_ge_u32 s52, s34
    s_cbranch_scc1 main_kernel_cf_fgo
    s_memtime s[52:53]
    s_cmp_ge_u32 s52, s34
    s_cbranch_scc1 main_kernel_cf_fgo
    s_memtime s[52:53]
    s_cmp_ge_u32 s52, s34
    s_cbranch_scc1 main_kernel_cf_fgo
    s_memtime s[52:53]
    s_cmp_ge_u32 s52, s34
    s_cbranch_scc1 main_kernel_cf_fgo
    s_memtime s[52:53]
    s_cmp_ge_u32 s52, s34
    s_cbranch_scc1 main_kernel_cf_fgo
    s_sub_u32 s35, s35, 1
    s_cbranch_scc0 main_kernel_cf_fw
main_kernel_cf_fgo:
    buffer_load_dwordx4 v[0:3], v120, s[4:7], s23 offen sc1
    s_add_u32 s35, s23, 0x8000
    buffer_load_dwordx4 v[4:7], v120, s[4:7], s35 offen sc1
    s_add_u32 s35, s23, 0x10000
    buffer_load_dwordx4 v[8:11], v120, s[4:7], s35 offen sc1
    ds_read_b32 v33, v123 offset:20992
    s_add_u32 s35, s23, 0x18000
    buffer_load_dwordx4 v[12:15], v120, s[4:7], s35 offen sc1
    s_add_u32 s35, s23, 0x20000
    buffer_load_dwordx4 v[16:19], v120, s[4:7], s35 offen sc1
    s_add_u32 s35, s23, 0x28000
    buffer_load_dwordx4 v[20:23], v120, s[4:7], s35 offen sc1
    s_add_u32 s35, s23, 0x30000
    buffer_load_dwordx4 v[24:27], v120, s[4:7], s35 offen sc1
    s_add_u32 s35, s23, 0x38000
    buffer_load_dwordx4 v[28:31], v120, s[4:7], s35 offen sc1
    s_mov_b64 exec, 1
    s_waitcnt lgkmcnt(0)
    v_sub_u32 v33, s34, v33
    v_bfi_b32 v33, 1, s40, v33
    buffer_store_dword v33, off, s[4:7], s18 offset:1536 sc1
    v_readfirstlane_b32 s10, v33
    s_mov_b64 exec, -1
    s_waitcnt vmcnt(8)
    v_mfma_f32_16x16x32_f16 v[76:79], v[0:3], v[106:109], 0
    v_xor_b32 v36, s22, v0
    v_bitop3_b32 v36, v2, s22, v36 bitop3:0xbe
    s_waitcnt vmcnt(7)
    v_mfma_f32_16x16x32_f16 v[76:79], v[4:7], v[106:109], v[76:79]
    v_bitop3_b32 v36, v4, s22, v36 bitop3:0xbe
    v_bitop3_b32 v36, v6, s22, v36 bitop3:0xbe
    s_waitcnt vmcnt(6)
    v_mfma_f32_16x16x32_f16 v[76:79], v[8:11], v[106:109], v[76:79]
    v_bitop3_b32 v36, v8, s22, v36 bitop3:0xbe
    v_bitop3_b32 v36, v10, s22, v36 bitop3:0xbe
    s_waitcnt vmcnt(5)
    v_mfma_f32_16x16x32_f16 v[76:79], v[12:15], v[106:109], v[76:79]
    v_bitop3_b32 v36, v12, s22, v36 bitop3:0xbe
    v_bitop3_b32 v36, v14, s22, v36 bitop3:0xbe
    s_waitcnt vmcnt(4)
    v_mfma_f32_16x16x32_f16 v[76:79], v[16:19], v[106:109], v[76:79]
    v_bitop3_b32 v36, v16, s22, v36 bitop3:0xbe
    v_bitop3_b32 v36, v18, s22, v36 bitop3:0xbe
    s_waitcnt vmcnt(3)
    v_mfma_f32_16x16x32_f16 v[76:79], v[20:23], v[106:109], v[76:79]
    v_bitop3_b32 v36, v20, s22, v36 bitop3:0xbe
    v_bitop3_b32 v36, v22, s22, v36 bitop3:0xbe
    s_waitcnt vmcnt(2)
    v_mfma_f32_16x16x32_f16 v[76:79], v[24:27], v[106:109], v[76:79]
    v_bitop3_b32 v36, v24, s22, v36 bitop3:0xbe
    v_bitop3_b32 v36, v26, s22, v36 bitop3:0xbe
    s_waitcnt vmcnt(1)
    v_mfma_f32_16x16x32_f16 v[76:79], v[28:31], v[106:109], v[76:79]
    v_bitop3_b32 v36, v28, s22, v36 bitop3:0xbe
    v_bitop3_b32 v36, v30, s22, v36 bitop3:0xbe
    v_and_b32 v36, 1, v36
    v_cmp_ne_u32 vcc, 0, v36
    s_nop 3
    v_cvt_pk_bf16_f32 v126, v76, v77
    v_cvt_pk_bf16_f32 v127, v78, v79
    s_cbranch_vccnz main_kernel_cf_r_f
    buffer_store_dwordx2 v[126:127], v122, s[4:7], s24 offen
    s_sub_u32 s20, s34, s38
    s_mov_b32 s3, s34
    buffer_store_dword v89, v117, s[4:7], s46 offen offset:512
    v_mov_b32 v32, -1
    v_mov_b32 v33, -1
    v_mov_b32 v64, 0
    v_mov_b32 v65, 0
    v_mov_b32 v66, 0
    v_mov_b32 v67, 0
    v_mov_b32 v68, 0
    v_mov_b32 v69, 0
    v_mov_b32 v70, 0
    v_mov_b32 v71, 0
    v_mov_b32 v96, 0
    v_mov_b32 v97, 0
    v_mov_b32 v98, 0
    v_mov_b32 v99, 0
    buffer_store_dwordx2 v[32:33], v122, s[4:7], s54 offen
    s_cmp_eq_u32 s12, 0
    v_add_u32 v56, s59, v115
    s_cbranch_scc0 main_kernel_cf_vma
    ds_read_b64_tr_b16 v[80:81], v56 offset:16384
    ds_read_b64_tr_b16 v[82:83], v56 offset:17408
    s_waitcnt lgkmcnt(0)
    s_nop 15
    s_nop 15
    s_nop 5
    s_buffer_load_dword s9, s[4:7], s56 glc
    buffer_load_dword v111, v90, s[4:7], s47 offen offset:512 sc1
    buffer_load_dwordx4 v116, s[4:7], s25 offen offset:0 sc1 lds
    buffer_load_dwordx4 v116, s[4:7], s25 offen offset:1024 sc1 lds
    buffer_load_dwordx4 v116, s[4:7], s25 offen offset:2048 sc1 lds
    buffer_load_dwordx4 v116, s[4:7], s25 offen offset:3072 sc1 lds
    s_mov_b32 m0, 4096
    s_nop 0
    buffer_load_dwordx4 v116, s[4:7], s55 offen offset:0 sc1 lds
    buffer_load_dwordx4 v116, s[4:7], s55 offen offset:1024 sc1 lds
    buffer_load_dwordx4 v116, s[4:7], s55 offen offset:2048 sc1 lds
    buffer_load_dwordx4 v116, s[4:7], s55 offen offset:3072 sc1 lds
    v_mov_b32 v34, v90
    s_mov_b32 m0, s36
    s_barrier
    ds_read_b32 v35, v123 offset:20480
    buffer_load_dwordx4 v[88:91], v116, s[4:7], s28 offen offset:0 sc1
    buffer_load_dwordx4 v[92:95], v116, s[4:7], s28 offen offset:1024 sc1
    buffer_load_dwordx4 v116, s[4:7], s27 offen offset:0 sc1 lds
    buffer_store_dwordx4 v[80:83], v125, s[4:7], s26 offen sc1
    s_branch main_kernel_cf_kva
main_kernel_cf_vma:
    v_mfma_f32_16x16x32_bf16 v[56:59], v[102:105], v[84:87], 0
    s_nop 7
    v_cvt_pk_bf16_f32 v80, v56, v57
    v_cvt_pk_bf16_f32 v81, v58, v59
    s_nop 15
    s_nop 15
    s_nop 5
    s_buffer_load_dword s9, s[4:7], s56 glc
    buffer_load_dword v111, v90, s[4:7], s47 offen offset:512 sc1
    buffer_load_dwordx4 v116, s[4:7], s25 offen offset:0 sc1 lds
    buffer_load_dwordx4 v116, s[4:7], s25 offen offset:1024 sc1 lds
    buffer_load_dwordx4 v116, s[4:7], s25 offen offset:2048 sc1 lds
    buffer_load_dwordx4 v116, s[4:7], s25 offen offset:3072 sc1 lds
    s_mov_b32 m0, 4096
    s_nop 0
    buffer_load_dwordx4 v116, s[4:7], s55 offen offset:0 sc1 lds
    buffer_load_dwordx4 v116, s[4:7], s55 offen offset:1024 sc1 lds
    buffer_load_dwordx4 v116, s[4:7], s55 offen offset:2048 sc1 lds
    buffer_load_dwordx4 v116, s[4:7], s55 offen offset:3072 sc1 lds
    v_mov_b32 v34, v90
    s_mov_b32 m0, s36
    s_barrier
    ds_read_b32 v35, v123 offset:20480
    buffer_load_dwordx4 v[88:91], v116, s[4:7], s28 offen offset:0 sc1
    buffer_load_dwordx4 v[92:95], v116, s[4:7], s28 offen offset:1024 sc1
    buffer_load_dwordx4 v116, s[4:7], s27 offen offset:0 sc1 lds
    buffer_store_dwordx2 v[80:81], v123, s[4:7], s26 offen sc1
main_kernel_cf_kva:
    s_add_u32 s26, s26, 0x10000
    s_waitcnt vmcnt(12)
    v_cmp_gt_i32 vcc, s17, v111
    v_readfirstlane_b32 s38, v35
    s_cbranch_vccnz main_kernel_cf_mc_f
    s_waitcnt vmcnt(4)
    s_branch main_kernel_cf_top
main_kernel_cf_wx:
    s_cmp_lg_u32 s14, 1
    s_cbranch_scc1 main_kernel_cf_wy
    s_memrealtime s[32:33]
    s_nop 0
    s_nop 0
    s_memrealtime s[32:33]
    s_nop 0
    s_nop 0
    s_memrealtime s[32:33]
    s_nop 0
    s_nop 0
    s_memrealtime s[32:33]
    s_nop 0
    s_nop 0
    s_memrealtime s[32:33]
    s_nop 0
    s_nop 0
    s_memrealtime s[32:33]
    s_nop 0
    s_nop 0
    s_memrealtime s[32:33]
    s_nop 0
    s_nop 0
    s_memrealtime s[32:33]
    s_nop 0
    s_nop 0
    s_memrealtime s[32:33]
    s_nop 0
    s_nop 0
    s_memrealtime s[32:33]
    s_nop 0
    s_nop 0
    s_memrealtime s[32:33]
    s_nop 0
    s_nop 0
    s_memrealtime s[32:33]
    s_nop 0
    s_nop 0
    s_mov_b32 s34, s32
    s_memrealtime s[32:33]
    s_cmp_lg_u32 s32, s34
    s_cbranch_scc1 main_kernel_cf_e1
    s_memrealtime s[32:33]
    s_cmp_lg_u32 s32, s34
    s_cbranch_scc1 main_kernel_cf_e1
    s_memrealtime s[32:33]
    s_cmp_lg_u32 s32, s34
    s_cbranch_scc1 main_kernel_cf_e1
    s_memrealtime s[32:33]
    s_cmp_lg_u32 s32, s34
    s_cbranch_scc1 main_kernel_cf_e1
    s_memrealtime s[32:33]
    s_cmp_lg_u32 s32, s34
    s_cbranch_scc1 main_kernel_cf_e1
    s_memrealtime s[32:33]
    s_cmp_lg_u32 s32, s34
    s_cbranch_scc1 main_kernel_cf_e1
    s_memrealtime s[32:33]
    s_cmp_lg_u32 s32, s34
    s_cbranch_scc1 main_kernel_cf_e1
    s_memrealtime s[32:33]
    s_cmp_lg_u32 s32, s34
    s_cbranch_scc1 main_kernel_cf_e1
    s_memrealtime s[32:33]
    s_cmp_lg_u32 s32, s34
    s_cbranch_scc1 main_kernel_cf_e1
    s_memrealtime s[32:33]
    s_cmp_lg_u32 s32, s34
    s_cbranch_scc1 main_kernel_cf_e1
    s_memrealtime s[32:33]
    s_cmp_lg_u32 s32, s34
    s_cbranch_scc1 main_kernel_cf_e1
    s_memrealtime s[32:33]
    s_cmp_lg_u32 s32, s34
    s_cbranch_scc1 main_kernel_cf_e1
main_kernel_cf_e1:
    s_memtime s[52:53]
    s_mul_i32 s34, s32, 22
    s_waitcnt lgkmcnt(0)
    s_sub_u32 s32, s52, s34
    s_sub_u32 s33, s32, s38
    s_ashr_i32 s34, s33, 1
    s_add_u32 s34, s34, s32
    v_mov_b32 v34, s34
    v_mov_b32 v33, s32
    ds_write2st64_b32 v123, v33, v34 offset0:80 offset1:82
    v_add_u32 v37, s33, v34
main_kernel_cf_wy:
    s_xor_b32 s21, s21, 0x80000
    v_mov_b32 v64, 0
    v_mov_b32 v65, 0
    v_mov_b32 v66, 0
    v_mov_b32 v67, 0
    v_mov_b32 v68, 0
    v_mov_b32 v69, 0
    v_mov_b32 v70, 0
    v_mov_b32 v71, 0
    v_mov_b32 v96, 0
    v_mov_b32 v97, 0
    v_mov_b32 v98, 0
    v_mov_b32 v99, 0
    s_cmp_eq_u32 s12, 0
    v_add_u32 v56, s59, v115
    s_cbranch_scc0 main_kernel_cf_vmb
    ds_read_b64_tr_b16 v[80:81], v56 offset:16384
    ds_read_b64_tr_b16 v[82:83], v56 offset:17408
    s_waitcnt lgkmcnt(0)
    s_waitcnt vmcnt(0)
    s_mov_b32 m0, s36
    s_barrier
    ds_read_b32 v35, v123 offset:20480
    ds_write_b32 v124, v37 offset:3584
    buffer_load_dwordx4 v[88:91], v116, s[4:7], s28 offen offset:0 sc1
    buffer_load_dwordx4 v[92:95], v116, s[4:7], s28 offen offset:1024 sc1
    buffer_load_dwordx4 v116, s[4:7], s27 offen offset:0 sc1 lds
    buffer_store_dwordx4 v[80:83], v125, s[4:7], s26 offen sc1
    s_branch main_kernel_cf_kvb
main_kernel_cf_vmb:
    v_mfma_f32_16x16x32_bf16 v[56:59], v[102:105], v[84:87], 0
    s_nop 7
    v_cvt_pk_bf16_f32 v80, v56, v57
    v_cvt_pk_bf16_f32 v81, v58, v59
    s_waitcnt vmcnt(0)
    s_mov_b32 m0, s36
    s_barrier
    ds_read_b32 v35, v123 offset:20480
    ds_write_b32 v124, v37 offset:3584
    buffer_load_dwordx4 v[88:91], v116, s[4:7], s28 offen offset:0 sc1
    buffer_load_dwordx4 v[92:95], v116, s[4:7], s28 offen offset:1024 sc1
    buffer_load_dwordx4 v116, s[4:7], s27 offen offset:0 sc1 lds
    buffer_store_dwordx2 v[80:81], v123, s[4:7], s26 offen sc1
main_kernel_cf_kvb:
    s_add_u32 s26, s26, 0x10000
    s_mov_b64 exec, 1
    buffer_store_dword v100, off, s[4:7], s39 sc1
    s_mov_b64 exec, -1
    s_add_u32 s39, s39, 4
    s_waitcnt lgkmcnt(0)
    v_readfirstlane_b32 s38, v35
    v_mov_b32 v35, 0
    v_mov_b32 v35, 0
    v_mov_b32 v35, 0
    v_mov_b32 v35, 0
    v_mov_b32 v35, 0
    v_mov_b32 v35, 0
main_kernel_cf_end:
    s_branch main_kernel_cf_top
main_kernel_cf_mc_f:
    s_mov_b32 m0, 0
    s_sub_u32 s29, s29, 1
    s_cbranch_scc1 main_kernel_end
    buffer_load_dword v111, v34, s[4:7], s47 offen offset:512 sc1
    buffer_load_dwordx4 v116, s[4:7], s25 offen offset:0 sc1 lds
    buffer_load_dwordx4 v116, s[4:7], s25 offen offset:1024 sc1 lds
    buffer_load_dwordx4 v116, s[4:7], s25 offen offset:2048 sc1 lds
    buffer_load_dwordx4 v116, s[4:7], s25 offen offset:3072 sc1 lds
    s_mov_b32 m0, 4096
    s_nop 0
    buffer_load_dwordx4 v116, s[4:7], s55 offen offset:0 sc1 lds
    buffer_load_dwordx4 v116, s[4:7], s55 offen offset:1024 sc1 lds
    buffer_load_dwordx4 v116, s[4:7], s55 offen offset:2048 sc1 lds
    buffer_load_dwordx4 v116, s[4:7], s55 offen offset:3072 sc1 lds
    s_waitcnt vmcnt(8)
    v_cmp_gt_i32 vcc, s17, v111
    v_readfirstlane_b32 s38, v35
    s_cbranch_vccnz main_kernel_cf_mc_f
    s_waitcnt vmcnt(0)
    s_branch main_kernel_cf_end
main_kernel_cf_t_w:
    s_mov_b32 s35, 200
main_kernel_cf_t_s:
    s_memtime s[52:53]
    s_cmp_ge_u32 s52, s34
    s_cbranch_scc1 main_kernel_cf_t_go
    s_memtime s[52:53]
    s_cmp_ge_u32 s52, s34
    s_cbranch_scc1 main_kernel_cf_t_go
    s_memtime s[52:53]
    s_cmp_ge_u32 s52, s34
    s_cbranch_scc1 main_kernel_cf_t_go
    s_memtime s[52:53]
    s_cmp_ge_u32 s52, s34
    s_cbranch_scc1 main_kernel_cf_t_go
    s_memtime s[52:53]
    s_cmp_ge_u32 s52, s34
    s_cbranch_scc1 main_kernel_cf_t_go
    s_memtime s[52:53]
    s_cmp_ge_u32 s52, s34
    s_cbranch_scc1 main_kernel_cf_t_go
    s_memtime s[52:53]
    s_cmp_ge_u32 s52, s34
    s_cbranch_scc1 main_kernel_cf_t_go
    s_memtime s[52:53]
    s_cmp_ge_u32 s52, s34
    s_cbranch_scc1 main_kernel_cf_t_go
    s_sub_u32 s35, s35, 1
    s_cbranch_scc0 main_kernel_cf_t_s
    s_branch main_kernel_cf_t_go
main_kernel_cf_t_p:
    s_waitcnt lgkmcnt(0)
    s_xor_b32 s32, s9, s22
    s_bitcmp1_b32 s32, 0
    s_cbranch_scc0 main_kernel_cf_t_ok
    s_buffer_load_dword s9, s[4:7], s56 glc
    s_sub_u32 s29, s29, 1
    s_cbranch_scc1 main_kernel_end
    s_branch main_kernel_cf_t_p
main_kernel_cf_z0_f:
    buffer_load_dwordx2 v[126:127], v123, s[4:7], s19 offen offset:0 sc1
    s_sub_u32 s29, s29, 1
    s_cbranch_scc1 main_kernel_end
    s_waitcnt vmcnt(0)
    s_branch main_kernel_cf_z0
main_kernel_cf_z2_f:
    buffer_load_dwordx2 v[64:65], v123, s[4:7], s19 offen offset:512 sc1
    s_sub_u32 s29, s29, 1
    s_cbranch_scc1 main_kernel_end
    s_waitcnt vmcnt(0)
main_kernel_cf_z1_f:
    s_waitcnt vmcnt(0)
    s_memtime s[52:53]
    v_dot2_f32_bf16 v44, v64, s37, v68
    v_dot2_f32_bf16 v45, v64, s57, v69
    v_dot2_f32_bf16 v46, v65, s37, v70
    v_dot2_f32_bf16 v47, v65, s57, v71
    v_bitop3_b32 v60, v64, s22, 1 bitop3:0x28
    v_cvt_pk_bf16_f32 v44, v44, v45
    v_cmp_ne_u32 vcc, 0, v60
    v_cvt_pk_bf16_f32 v45, v46, v47
    ds_write_b64 v124, v[44:45] offset:512
    s_cbranch_vccnz main_kernel_cf_z2_f
    s_branch main_kernel_cf_z_ok
main_kernel_cf_kvw:
    s_cmp_eq_u32 s17, 64
    s_cbranch_scc1 main_kernel_cf_kvok
    s_waitcnt vmcnt(0)
    s_mov_b32 exec_lo, 0
    s_mov_b32 exec_hi, 0x3f00
    v_subrev_u32 v127, 0, v121
main_kernel_cf_kvp:
    buffer_load_dword v126, v127, s[4:7], 0 offen sc1
    s_waitcnt vmcnt(0)
    v_cmp_eq_u32 vcc, 0, v126
    s_cbranch_vccz main_kernel_cf_kvp_ok
    s_sleep 2
    s_sub_u32 s29, s29, 1
    s_cbranch_scc0 main_kernel_cf_kvp
    s_branch main_kernel_end
main_kernel_cf_kvp_ok:
    s_mov_b64 exec, -1
    s_branch main_kernel_cf_kvok
main_kernel_cf_last:
    buffer_load_dwordx2 v[86:87], v123, s[4:7], s19 offen offset:1024 sc1
    s_sub_u32 s29, s29, 1
    s_cbranch_scc1 main_kernel_end
    s_waitcnt vmcnt(0) lgkmcnt(0)
    v_bitop3_b32 v44, v86, s22, 1 bitop3:0x28
    v_cmp_ne_u32 vcc, 0, v44
    s_cbranch_vccnz main_kernel_cf_last
    v_swap_b32 v85, v86
    s_cmp_eq_u32 s12, 0
    v_add_u32 v56, s59, v115
    s_cbranch_scc0 main_kernel_cf_vmc
    ds_read_b64_tr_b16 v[80:81], v56 offset:16384
    ds_read_b64_tr_b16 v[82:83], v56 offset:17408
    s_waitcnt lgkmcnt(0)
    buffer_store_dwordx4 v[80:83], v125, s[4:7], s26 offen sc1
    s_branch main_kernel_cf_kvc
main_kernel_cf_vmc:
    v_mfma_f32_16x16x32_bf16 v[56:59], v[102:105], v[84:87], 0
    s_nop 7
    v_cvt_pk_bf16_f32 v80, v56, v57
    v_cvt_pk_bf16_f32 v81, v58, v59
    buffer_store_dwordx2 v[80:81], v123, s[4:7], s26 offen sc1
main_kernel_cf_kvc:
    s_add_u32 s26, s26, 0x10000
    s_branch main_kernel_end
main_kernel_cf_m_f:
main_kernel_cf_m_t:
    ds_read_b128 v[0:3], v116 offset:0
    ds_read_b128 v[4:7], v116 offset:1024
    ds_read_b128 v[8:11], v116 offset:2048
    ds_read_b128 v[12:15], v116 offset:3072
    ds_read_b128 v[16:19], v116 offset:4096
    ds_read_b128 v[20:23], v116 offset:5120
    ds_read_b128 v[24:27], v116 offset:6144
    ds_read_b128 v[28:31], v116 offset:7168
    s_waitcnt lgkmcnt(0)
    v_max_u32 v126, v0, v2
    v_max3_u32 v126, v126, v4, v6
    v_max3_u32 v126, v126, v8, v10
    v_max3_u32 v126, v126, v12, v14
    v_max3_u32 v126, v126, v16, v18
    v_max3_u32 v126, v126, v20, v22
    v_max3_u32 v126, v126, v24, v26
    v_max3_u32 v126, v126, v28, v30
    v_cmp_eq_u32 vcc, -1, v126
    s_cbranch_vccz main_kernel_cf_m_g
    s_barrier
    s_lshl_b32 s32, s14, 11
    s_add_u32 m0, s32, 0
    s_add_u32 s32, s32, s25
    buffer_load_dwordx4 v116, s[4:7], s32 offen offset:0 sc1 lds
    buffer_load_dwordx4 v116, s[4:7], s32 offen offset:1024 sc1 lds
    s_sub_u32 s29, s29, 1
    s_cbranch_scc1 main_kernel_end
    s_waitcnt vmcnt(0)
    s_barrier
    s_branch main_kernel_cf_m_t
main_kernel_cf_m_g:
    s_mov_b64 s[44:45], 0
    v_mov_b32 v64, 0
    v_mov_b32 v65, 0
    v_mov_b32 v66, 0
    v_mov_b32 v67, 0
    v_mov_b32 v68, 0
    v_mov_b32 v69, 0
    v_mov_b32 v70, 0
    v_mov_b32 v71, 0
    v_mov_b32 v96, 0
    v_mov_b32 v97, 0
    v_mov_b32 v98, 0
    v_mov_b32 v99, 0
    s_branch main_kernel_cf_mrd
main_kernel_cf_v_f:
    v_swap_b32 v85, v86
    s_nop 7
    s_waitcnt vmcnt(1)
main_kernel_cf_v_t:
    s_memtime s[52:53]
    v_bitop3_b32 v44, v126, s22, 1 bitop3:0x28
    v_cmp_ne_u32 vcc, 0, v44
    s_sub_u32 s29, s29, 1
    s_cbranch_scc1 main_kernel_end
    s_cbranch_vccnz main_kernel_cf_v_g
    v_mfma_f32_16x16x32_bf16 v[64:67], v[88:91], v[32:35], 0
    v_mfma_f32_16x16x32_bf16 v[68:71], v[92:95], v[32:35], 0
    v_mov_b32 v86, v126
    v_mov_b32 v87, v127
    s_waitcnt lgkmcnt(0)
    s_sub_u32 s32, s52, s38
    s_add_u32 s32, s32, -550
    v_mov_b32 v46, s32
    buffer_store_dword v46, v117, s[4:7], s46 offen
    s_branch main_kernel_cf_v_ok
main_kernel_cf_v_g:
    buffer_load_dwordx2 v[126:127], v123, s[4:7], s19 offen offset:1024 sc1
    s_waitcnt lgkmcnt(0)
    s_sub_u32 s32, s52, s38
    s_add_u32 s32, s32, -50
    v_mov_b32 v46, s32
    buffer_store_dword v46, v117, s[4:7], s46 offen
    s_waitcnt vmcnt(0)
    s_branch main_kernel_cf_v_t
main_kernel_cf_d_f:
    s_memtime s[52:53]
    s_waitcnt vmcnt(1) lgkmcnt(0)
    s_sub_u32 s32, s52, s38
    s_add_u32 s32, s32, 300
    v_mov_b32 v46, s32
    buffer_store_dword v46, v117, s[4:7], s46 offen
    ds_read_b128 v[0:3], v112 offset:0
    ds_read_b128 v[4:7], v112 offset:1024
    ds_read_b128 v[8:11], v112 offset:2048
    ds_read_b128 v[12:15], v112 offset:3072
    ds_read_b128 v[16:19], v112 offset:4096
    ds_read_b128 v[20:23], v112 offset:5120
    ds_read_b128 v[24:27], v112 offset:6144
    ds_read_b128 v[28:31], v112 offset:7168
    s_waitcnt lgkmcnt(0)
    v_mfma_f32_16x16x32_bf16 v[32:35], v[0:3], v[48:51], 0
    v_mfma_f32_16x16x32_bf16 v[36:39], v[16:19], v[48:51], 0
    v_mfma_f32_16x16x32_bf16 v[72:75], v[48:51], v[48:51], 0
    v_mfma_f32_16x16x32_bf16 v[32:35], v[4:7], v[52:55], v[32:35]
    v_mfma_f32_16x16x32_bf16 v[36:39], v[20:23], v[52:55], v[36:39]
    v_mfma_f32_16x16x32_bf16 v[72:75], v[52:55], v[52:55], v[72:75]
    v_mfma_f32_16x16x32_bf16 v[32:35], v[8:11], v[56:59], v[32:35]
    v_mfma_f32_16x16x32_bf16 v[36:39], v[24:27], v[56:59], v[36:39]
    v_mfma_f32_16x16x32_bf16 v[72:75], v[56:59], v[56:59], v[72:75]
    v_mfma_f32_16x16x32_bf16 v[32:35], v[12:15], v[60:63], v[32:35]
    v_mfma_f32_16x16x32_bf16 v[36:39], v[28:31], v[60:63], v[36:39]
    v_mfma_f32_16x16x32_bf16 v[72:75], v[60:63], v[60:63], v[72:75]
    s_nop 7
    ds_read_b128 v[0:3], v113 offset:16384
    ds_read_b128 v[16:19], v113 offset:18432
    ds_read_b128 v[4:7], v113 offset:17408
    ds_read_b128 v[20:23], v113 offset:19456
    ds_read_b128 v[8:11], v113 offset:24576
    ds_read_b128 v[24:27], v113 offset:26624
    ds_read_b128 v[12:15], v113 offset:25600
    ds_read_b128 v[28:31], v113 offset:27648
    v_permlane32_swap_b32 v72, v73
    v_permlane32_swap_b32 v74, v75
    v_mul_f32 v73, s30, v73
    v_mul_f32 v75, s30, v75
    v_max_f32 v126, v73, v75
    v_max3_f32 v126, v126, v32, v33
    v_max3_f32 v126, v126, v34, v35
    v_max3_f32 v126, v126, v36, v37
    v_max3_f32 v126, v126, v38, v39
    v_mov_b32 v127, v126
    s_nop 1
    v_permlane32_swap_b32 v126, v127
    v_max_f32 v126, v126, v127
    v_mov_b32 v127, v126
    s_nop 1
    v_permlane16_swap_b32 v126, v127
    v_max_f32 v126, v126, v127
    v_sub_f32 v32, v32, v126
    v_sub_f32 v33, v33, v126
    v_sub_f32 v34, v34, v126
    v_sub_f32 v35, v35, v126
    v_sub_f32 v36, v36, v126
    v_sub_f32 v37, v37, v126
    v_sub_f32 v38, v38, v126
    v_sub_f32 v39, v39, v126
    v_sub_f32 v73, v73, v126
    v_sub_f32 v75, v75, v126
    v_exp_f32 v32, v32
    v_exp_f32 v33, v33
    v_exp_f32 v34, v34
    v_exp_f32 v35, v35
    v_exp_f32 v36, v36
    v_exp_f32 v37, v37
    v_exp_f32 v38, v38
    v_exp_f32 v39, v39
    v_exp_f32 v73, v73
    v_exp_f32 v75, v75
    v_cvt_pk_bf16_f32 v32, v32, v33
    v_cvt_pk_bf16_f32 v33, v34, v35
    v_cvt_pk_bf16_f32 v34, v36, v37
    v_cvt_pk_bf16_f32 v35, v38, v39
    v_cvt_pk_bf16_f32 v72, v73, v75
    v_cvt_pk_bf16_f32 v73, v73, v75
    s_nop 1
    v_mfma_f32_16x16x32_bf16 v[64:67], v[88:91], v[32:35], 0
    v_mfma_f32_16x16x32_bf16 v[68:71], v[92:95], v[32:35], 0
    v_mfma_f32_16x16x32_bf16 v[40:43], v[96:99], v[32:35], 0
    s_nop 3
    s_nop 1
    v_mfma_f32_16x16x16_bf16 v[40:43], v[100:101], v[72:73], v[40:43]
    s_mov_b64 s[44:45], 0
    s_mov_b64 vcc, 0
    s_nop 7
    s_branch main_kernel_cf_d_ok
main_kernel_cf_fsp:
    s_mov_b32 s35, 40
main_kernel_cf_fsl:
    buffer_load_dword v111, v90, s[4:7], s47 offen sc1
    s_waitcnt vmcnt(1)
    v_subrev_u32 v32, s20, v111
    v_cmp_lt_u32 vcc, 0x100000, v32
    s_cbranch_vccz main_kernel_cf_rgo
    s_sub_u32 s35, s35, 1
    s_cbranch_scc0 main_kernel_cf_fsl
    v_mov_b32 v32, 0
    s_branch main_kernel_cf_fok
main_kernel_cf_r_f:
    s_memtime s[52:53]
    buffer_load_dword v111, v90, s[4:7], s47 offen sc1
    s_waitcnt lgkmcnt(0)
    s_sub_u32 s15, s52, s16
    s_add_u32 s15, s15, -1500
    s_waitcnt vmcnt(0)
    s_sub_u32 s29, s29, 1
    s_cbranch_scc1 main_kernel_end
    s_branch main_kernel_cf_rgo
    .p2align 6
main_kernel_cs_top:
    s_barrier
main_kernel_cs_mrd:
    ds_read_b128 v[0:3], v114 offset:0
    ds_read_b128 v[4:7], v114 offset:512
    ds_read_b128 v[8:11], v114 offset:1024
    ds_read_b128 v[12:15], v114 offset:1536
    ds_read_b128 v[16:19], v114 offset:2048
    s_waitcnt lgkmcnt(4)
    v_smfmac_f32_16x16x64_bf16 v[96:99], v[0:3], a[0:7], v110
    ds_read_b128 v[20:23], v114 offset:2560
    s_waitcnt lgkmcnt(4)
    v_smfmac_f32_16x16x64_bf16 v[96:99], v[4:7], a[8:15], v110
    ds_read_b128 v[24:27], v114 offset:3072
    s_waitcnt lgkmcnt(4)
    s_bfe_u32 s22, s17, 0x10001
    v_smfmac_f32_16x16x64_bf16 v[96:99], v[8:11], a[16:23], v110
    ds_read_b128 v[28:31], v114 offset:3584
    s_waitcnt lgkmcnt(4)
    v_smfmac_f32_16x16x64_bf16 v[96:99], v[12:15], a[24:31], v110
    ds_read_b128 v[32:35], v114 offset:4096
    s_waitcnt lgkmcnt(4)
    v_smfmac_f32_16x16x64_bf16 v[96:99], v[16:19], a[32:39], v110
    ds_read_b128 v[36:39], v114 offset:4608
    s_waitcnt lgkmcnt(4)
    v_smfmac_f32_16x16x64_bf16 v[96:99], v[20:23], a[40:47], v110
    ds_read_b128 v[40:43], v114 offset:5120
    s_waitcnt lgkmcnt(4)
    v_smfmac_f32_16x16x64_bf16 v[96:99], v[24:27], a[48:55], v110
    ds_read_b128 v[44:47], v114 offset:5632
    s_waitcnt lgkmcnt(4)
    v_smfmac_f32_16x16x64_bf16 v[96:99], v[28:31], a[56:63], v110
    ds_read_b128 v[48:51], v114 offset:6144
    s_waitcnt lgkmcnt(4)
    v_smfmac_f32_16x16x64_bf16 v[96:99], v[32:35], a[64:71], v110
    ds_read_b128 v[52:55], v114 offset:6656
    s_waitcnt lgkmcnt(4)
    v_smfmac_f32_16x16x64_bf16 v[96:99], v[36:39], a[72:79], v110
    ds_read_b128 v[56:59], v114 offset:7168
    s_waitcnt lgkmcnt(4)
    v_smfmac_f32_16x16x64_bf16 v[96:99], v[40:43], a[80:87], v110
    ds_read_b128 v[60:63], v114 offset:7680
    s_waitcnt lgkmcnt(4)
    v_smfmac_f32_16x16x64_bf16 v[96:99], v[44:47], a[88:95], v110
    s_waitcnt lgkmcnt(3)
    buffer_load_dword v111, v121, s[4:7], 0 offen sc1
    v_smfmac_f32_16x16x64_bf16 v[96:99], v[48:51], a[96:103], v110
    s_waitcnt lgkmcnt(2)
    ds_read_b128 v[80:83], v113 offset:0
    v_smfmac_f32_16x16x64_bf16 v[96:99], v[52:55], a[104:111], v110
    s_waitcnt lgkmcnt(2)
    ds_read_b128 v[84:87], v113 offset:1024
    v_smfmac_f32_16x16x64_bf16 v[96:99], v[56:59], a[112:119], v110
    s_waitcnt lgkmcnt(2)
    v_smfmac_f32_16x16x64_bf16 v[96:99], v[60:63], a[120:127], v110
    v_smfmac_f32_16x16x64_bf16 v[68:71], v[0:3], a[128:135], v110
    ds_read_b128 v[72:75], v113 offset:2048
    v_smfmac_f32_16x16x64_bf16 v[68:71], v[4:7], a[136:143], v110
    s_nop 1
    v_pk_add_f32 v[126:127], v[96:97], v[98:99]
    ds_read_b128 v[76:79], v113 offset:3072
    v_smfmac_f32_16x16x64_bf16 v[68:71], v[8:11], a[144:151], v110
    v_cmp_u_f32 vcc, v126, v127
    v_smfmac_f32_16x16x64_bf16 v[68:71], v[12:15], a[152:159], v110
    v_cvt_pk_bf16_f32 v126, v96, v97
    v_smfmac_f32_16x16x64_bf16 v[68:71], v[16:19], a[160:167], v110
    v_cvt_pk_bf16_f32 v127, v98, v99
    s_and_b64 s[42:43], vcc, s[44:45]
    s_cbranch_scc1 main_kernel_cs_m_f
    v_smfmac_f32_16x16x64_bf16 v[68:71], v[20:23], a[168:175], v110
    v_bfi_b32 v126, 1, s22, v126
    buffer_store_dwordx2 v[126:127], v123, s[4:7], s18 offen sc1
    v_smfmac_f32_16x16x64_bf16 v[68:71], v[24:27], a[176:183], v110
    s_mov_b64 s[44:45], s[0:1]
    v_smfmac_f32_16x16x64_bf16 v[68:71], v[28:31], a[184:191], v110
    s_add_u32 s17, s17, 1
    s_bfe_u32 s40, s17, 0x10001
    v_smfmac_f32_16x16x64_bf16 v[68:71], v[32:35], a[192:199], v110
    s_add_u32 s28, s28, 0x40000
    s_mov_b32 m0, s36
    v_smfmac_f32_16x16x64_bf16 v[68:71], v[36:39], a[200:207], v110
    s_add_u32 s34, s3, 2130
    v_smfmac_f32_16x16x64_bf16 v[68:71], v[40:43], a[208:215], v110
    v_smfmac_f32_16x16x64_bf16 v[68:71], v[44:47], a[216:223], v110
    v_smfmac_f32_16x16x64_bf16 v[68:71], v[48:51], a[224:231], v110
    v_smfmac_f32_16x16x64_bf16 v[68:71], v[52:55], a[232:239], v110
    v_smfmac_f32_16x16x64_bf16 v[68:71], v[56:59], a[240:247], v110
    v_smfmac_f32_16x16x64_bf16 v[68:71], v[60:63], a[248:255], v110
    s_waitcnt lgkmcnt(2)
    v_smfmac_f32_16x16x64_bf16 v[64:67], v[32:35], v[80:87], v110
    s_waitcnt lgkmcnt(0)
    s_nop 3
    v_cvt_pk_bf16_f32 v126, v68, v69
    v_cvt_pk_bf16_f32 v127, v70, v71
    v_bfi_b32 v126, 1, s22, v126
    buffer_store_dwordx2 v[126:127], v123, s[4:7], s18 offen offset:512 sc1
    ds_read_b128 v[80:83], v113 offset:4096
    v_smfmac_f32_16x16x64_bf16 v[64:67], v[36:39], v[72:79], v110
    ds_read_b128 v[84:87], v113 offset:5120
    v_smfmac_f32_16x16x64_bf16 v[64:67], v[0:3], v[128:135], v110
    ds_read_b128 v[72:75], v113 offset:6144
    v_smfmac_f32_16x16x64_bf16 v[64:67], v[4:7], v[136:143], v110
    ds_read_b128 v[76:79], v113 offset:7168
    v_smfmac_f32_16x16x64_bf16 v[64:67], v[8:11], v[144:151], v110
    ds_read_b128 v[32:35], v113 offset:8192
    v_smfmac_f32_16x16x64_bf16 v[64:67], v[12:15], v[152:159], v110
    ds_read_b128 v[36:39], v113 offset:9216
    v_smfmac_f32_16x16x64_bf16 v[64:67], v[16:19], v[160:167], v110
    ds_read_b128 v[0:3], v113 offset:10240
    s_memtime s[52:53]
    v_smfmac_f32_16x16x64_bf16 v[64:67], v[20:23], v[168:175], v110
    ds_read_b128 v[4:7], v113 offset:11264
    s_memtime s[52:53]
    s_xor_b32 s32, s9, s22
    s_bitcmp1_b32 s32, 0
    s_cbranch_scc1 main_kernel_cs_t_p
main_kernel_cs_t_ok:
    s_sub_u32 s32, s9, s10
    v_smfmac_f32_16x16x64_bf16 v[64:67], v[24:27], v[176:183], v110
    ds_read_b128 v[8:11], v113 offset:12288
    s_memtime s[52:53]
    s_max_i32 s32, s32, 0
    s_min_i32 s32, s32, 0x4000
    v_smfmac_f32_16x16x64_bf16 v[64:67], v[28:31], v[184:191], v110
    s_waitcnt lgkmcnt(7)
    ds_read_b128 v[12:15], v113 offset:13312
    s_memtime s[52:53]
    s_add_u32 s34, s34, s32
    s_and_b32 s34, s34, s11
    v_smfmac_f32_16x16x64_bf16 v[64:67], v[40:43], v[80:87], v110
    s_waitcnt lgkmcnt(6)
    ds_read_b128 v[16:19], v113 offset:14336
    s_cmp_lt_u32 s52, s34
    s_cbranch_scc1 main_kernel_cs_t_w
main_kernel_cs_t_go:
    s_barrier
    buffer_load_dwordx2 v[126:127], v123, s[4:7], s19 offen offset:0 sc1
    v_smfmac_f32_16x16x64_bf16 v[64:67], v[44:47], v[72:79], v110
    s_waitcnt lgkmcnt(5)
    ds_read_b128 v[20:23], v113 offset:15360
    v_smfmac_f32_16x16x64_bf16 v[64:67], v[48:51], v[32:39], v110
    s_waitcnt lgkmcnt(4)
    v_smfmac_f32_16x16x64_bf16 v[64:67], v[52:55], v[0:7], v110
    s_waitcnt lgkmcnt(2)
    ds_read_b128 v[24:27], v112 offset:6144
    ds_read_b128 v[28:31], v112 offset:7168
    v_smfmac_f32_16x16x64_bf16 v[64:67], v[56:59], v[8:15], v110
    s_waitcnt lgkmcnt(2)
    ds_read_b128 v[0:3], v112 offset:0
    ds_read_b128 v[4:7], v112 offset:1024
    v_smfmac_f32_16x16x64_bf16 v[64:67], v[60:63], v[16:23], v110
    ds_read_b128 v[8:11], v112 offset:2048
    ds_read_b128 v[12:15], v112 offset:3072
    ds_read_b128 v[16:19], v112 offset:4096
    ds_read_b128 v[20:23], v112 offset:5120
    v_mov_b32 v76, 0
    v_mov_b32 v77, 0
    v_mov_b32 v78, 0
    s_nop 0
    v_permlane32_swap_b32 v64, v65
    v_permlane32_swap_b32 v66, v67
    v_cvt_pk_bf16_f32 v84, v64, v66
    v_cvt_pk_bf16_f32 v85, v65, v67
    v_bfi_b32 v84, 1, s22, v84
    buffer_load_dwordx2 v[42:43], v123, s[4:7], s19 offen offset:512 sc1
    v_mov_b32 v79, 0
    v_mov_b32 v80, 0
    v_mov_b32 v81, 0
    v_mov_b32 v82, 0
    v_mov_b32 v83, 0
    v_mov_b32 v60, 0
    v_mov_b32 v60, 0
    v_mov_b32 v60, 0
    v_mov_b32 v60, 0
    v_mov_b32 v60, 0
    v_mov_b32 v60, 0
    v_mov_b32 v60, 0
    buffer_store_dwordx2 v[84:85], v123, s[4:7], s18 offen offset:1024 sc1
    v_mov_b32 v60, 0
    v_mov_b32 v60, 0
    v_mov_b32 v60, 0
    v_mov_b32 v60, 0
    v_mov_b32 v60, 0
    v_mov_b32 v60, 0
    v_mov_b32 v60, 0
    v_mov_b32 v60, 0
    v_mov_b32 v60, 0
    v_mov_b32 v60, 0
    v_mov_b32 v60, 0
    v_mov_b32 v60, 0
    v_mov_b32 v60, 0
    v_mov_b32 v60, 0
    v_mov_b32 v60, 0
    v_mov_b32 v60, 0
    v_mov_b32 v60, 0
    v_mov_b32 v60, 0
    v_mov_b32 v60, 0
    v_mov_b32 v60, 0
    v_mov_b32 v60, 0
    v_mov_b32 v60, 0
    v_mov_b32 v60, 0
    v_mov_b32 v60, 0
    v_mov_b32 v60, 0
    v_mov_b32 v60, 0
    v_mov_b32 v60, 0
    v_mov_b32 v60, 0
    v_mov_b32 v60, 0
    v_mov_b32 v60, 0
    v_mov_b32 v60, 0
    v_mov_b32 v60, 0
    v_mov_b32 v60, 0
    v_mov_b32 v60, 0
    v_mov_b32 v60, 0
    v_mov_b32 v60, 0
    v_mov_b32 v60, 0
    v_mov_b32 v60, 0
    s_waitcnt vmcnt(2)
main_kernel_cs_z0:
    v_dot2_f32_bf16 v44, v126, s37, v96
    v_dot2_f32_bf16 v45, v126, s57, v97
    v_dot2_f32_bf16 v46, v127, s37, v98
    v_dot2_f32_bf16 v47, v127, s57, v99
    v_bitop3_b32 v60, v126, s22, 1 bitop3:0x28
    v_cvt_pk_bf16_f32 v44, v44, v45
    v_cmp_ne_u32 vcc, 0, v60
    v_cvt_pk_bf16_f32 v45, v46, v47
    ds_write_b64 v124, v[44:45] offset:0
    buffer_load_dwordx2 v[64:65], v123, s[4:7], s19 offen offset:512 sc1
    v_cmp_eq_u32 s[42:43], 0, v111
    s_cbranch_vccnz main_kernel_cs_z0_f
    v_mov_b32 v96, 0x3f803f80
    v_mov_b32 v97, 0x3f803f80
    v_mov_b32 v98, 0x3f803f80
    v_mov_b32 v99, 0x3f803f80
    s_and_b32 s32, s43, 0x3f00
    s_cbranch_scc1 main_kernel_cs_kvw
main_kernel_cs_kvok:
    s_waitcnt lgkmcnt(0)
    s_barrier
    ds_read_b64_tr_b16 v[48:49], v115 offset:16384
    ds_read_b64_tr_b16 v[50:51], v115 offset:17408
    ds_read_b64_tr_b16 v[52:53], v115 offset:18432
    ds_read_b64_tr_b16 v[54:55], v115 offset:19456
    s_waitcnt vmcnt(2)
    s_memtime s[52:53]
    v_dot2_f32_bf16 v44, v42, s37, v68
    v_dot2_f32_bf16 v45, v42, s57, v69
    v_dot2_f32_bf16 v46, v43, s37, v70
    v_dot2_f32_bf16 v47, v43, s57, v71
    v_bitop3_b32 v60, v42, s22, 1 bitop3:0x28
    v_cvt_pk_bf16_f32 v44, v44, v45
    v_cmp_ne_u32 vcc, 0, v60
    v_cvt_pk_bf16_f32 v45, v46, v47
    ds_write_b64 v124, v[44:45] offset:512
    s_waitcnt lgkmcnt(3)
    v_mfma_f32_16x16x32_bf16 v[32:35], v[0:3], v[48:51], 0
    v_mfma_f32_16x16x32_bf16 v[36:39], v[16:19], v[48:51], 0
    s_cbranch_vccnz main_kernel_cs_z1_f
main_kernel_cs_z_ok:
    v_mfma_f32_16x16x32_bf16 v[72:75], v[48:51], v[48:51], 0
    s_waitcnt lgkmcnt(1)
    s_sub_u32 s32, s52, s38
    v_mov_b32 v46, s32
    v_mfma_f32_16x16x32_bf16 v[32:35], v[4:7], v[52:55], v[32:35]
    buffer_load_dwordx2 v[86:87], v123, s[4:7], s19 offen offset:1024 sc1
    buffer_store_dword v46, v117, s[4:7], s46 offen sc1
    s_cmp_eq_u32 s17, 64
    s_waitcnt lgkmcnt(0)
    s_barrier
    ds_read_b64_tr_b16 v[56:57], v115 offset:16896
    ds_read_b64_tr_b16 v[58:59], v115 offset:17920
    ds_read_b64_tr_b16 v[60:61], v115 offset:18944
    ds_read_b64_tr_b16 v[62:63], v115 offset:19968
    s_cbranch_scc1 main_kernel_cs_last
    v_bfe_u32 v47, v123, 1, 7
    buffer_load_dwordx2 v[126:127], v123, s[4:7], s19 offen offset:1024 sc1
    buffer_load_dwordx4 v116, s[4:7], s27 offen offset:1024 sc1 lds
    v_mfma_f32_16x16x32_bf16 v[36:39], v[20:23], v[52:55], v[36:39]
    v_mfma_f32_16x16x32_bf16 v[72:75], v[52:55], v[52:55], v[72:75]
    s_waitcnt lgkmcnt(2)
    v_mfma_f32_16x16x32_bf16 v[72:75], v[56:59], v[56:59], v[72:75]
    v_mfma_f32_16x16x32_bf16 v[32:35], v[8:11], v[56:59], v[32:35]
    s_waitcnt lgkmcnt(0)
    v_mfma_f32_16x16x32_bf16 v[72:75], v[60:63], v[60:63], v[72:75]
    ds_read_b128 v[0:3], v113 offset:16384
    v_mfma_f32_16x16x32_bf16 v[32:35], v[12:15], v[60:63], v[32:35]
    ds_read_b128 v[16:19], v113 offset:18432
    v_mfma_f32_16x16x32_bf16 v[36:39], v[24:27], v[56:59], v[36:39]
    ds_read_b128 v[4:7], v113 offset:17408
    s_nop 0
    v_permlane32_swap_b32 v72, v73
    v_permlane32_swap_b32 v74, v75
    v_mfma_f32_16x16x32_bf16 v[36:39], v[28:31], v[60:63], v[36:39]
    ds_read_b128 v[20:23], v113 offset:19456
    v_mul_f32 v73, s30, v73
    v_mul_f32 v75, s30, v75
    v_exp_f32 v32, v32
    ds_read_b128 v[8:11], v113 offset:24576
    v_exp_f32 v33, v33
    ds_read_b128 v[12:15], v113 offset:25600
    v_exp_f32 v73, v73
    ds_read_b128 v[24:27], v113 offset:26624
    v_exp_f32 v75, v75
    ds_read_b128 v[28:31], v113 offset:27648
    v_exp_f32 v34, v34
    v_cvt_pk_bf16_f32 v72, v73, v75
    v_cvt_pk_bf16_f32 v73, v73, v75
    v_exp_f32 v35, v35
    s_waitcnt vmcnt(4)
    v_mfma_f32_16x16x16_bf16 v[40:43], v[100:101], v[72:73], 0
    v_exp_f32 v36, v36
    v_cvt_pk_bf16_f32 v32, v32, v33
    v_exp_f32 v37, v37
    v_cvt_pk_bf16_f32 v33, v34, v35
    v_exp_f32 v38, v38
    v_exp_f32 v39, v39
    v_cvt_pk_bf16_f32 v34, v36, v37
    v_cvt_pk_bf16_f32 v35, v38, v39
    s_nop 1
    v_mfma_f32_16x16x32_bf16 v[40:43], v[96:99], v[32:35], v[40:43]
    v_mfma_f32_16x16x32_bf16 v[64:67], v[88:91], v[32:35], 0
    v_mfma_f32_16x16x32_bf16 v[68:71], v[92:95], v[32:35], 0
    s_waitcnt vmcnt(3)
main_kernel_cs_v_ok:
    v_bitop3_b32 v44, v86, s22, 1 bitop3:0x28
    v_swap_b32 v85, v86
    v_cmp_ne_u32 vcc, 0, v44
main_kernel_cs_d_ok:
    s_nop 0
    v_mfma_f32_16x16x16_bf16 v[64:67], v[84:85], v[72:73], v[64:67]
    v_mfma_f32_16x16x16_bf16 v[68:71], v[86:87], v[72:73], v[68:71]
    s_cbranch_vccnz main_kernel_cs_v_f
    v_rcp_f32 v42, v40
    v_subrev_u32 v41, 0x21800000, v41
    v_cmp_lt_u32 vcc, 0x3c000000, v41
    s_nop 0
    v_pk_mul_f32 v[64:65], v[64:65], v[42:43] op_sel_hi:[1,0]
    v_pk_mul_f32 v[66:67], v[66:67], v[42:43] op_sel_hi:[1,0]
    v_cvt_pk_bf16_f32 v44, v64, v65
    v_pk_mul_f32 v[68:69], v[68:69], v[42:43] op_sel_hi:[1,0]
    v_cvt_pk_bf16_f32 v45, v66, v67
    v_pk_mul_f32 v[70:71], v[70:71], v[42:43] op_sel_hi:[1,0]
    v_cvt_pk_bf16_f32 v46, v68, v69
    v_cvt_pk_bf16_f32 v47, v70, v71
    ds_write_b128 v118, v[44:47]
    s_and_b64 s[42:43], vcc, s[44:45]
    s_cbranch_scc1 main_kernel_cs_d_f
    s_mov_b64 s[44:45], s[0:1]
    v_mov_b32 v64, 0
    v_mov_b32 v65, 0
    v_mov_b32 v66, 0
    v_mov_b32 v67, 0
    v_mov_b32 v68, 0
    v_mov_b32 v69, 0
    v_mov_b32 v70, 0
    v_mov_b32 v71, 0
    v_bfe_u32 v90, v123, 1, 7
    s_xor_b32 s23, s23, 0x80000
    s_waitcnt lgkmcnt(0)
    s_barrier
    ds_read_b128 v[56:59], v114 offset:1024
    ds_read_b128 v[60:63], v114 offset:1536
    ds_read_b128 v[48:51], v114 offset:0
    ds_read_b128 v[52:55], v114 offset:512
    s_xor_b32 s18, s18, 0x100000
    s_xor_b32 s19, s18, 0x80000
    s_xor_b32 s25, s25, 0x4000
    s_add_u32 s27, s27, 0x40000
    v_add_u32 v121, 4, v121
    v_xor_b32 v112, 0x4000, v112
    s_xor_b32 s36, s36, 0x4000
    s_mov_b32 m0, 0
    s_mov_b32 s54, s24
    s_xor_b32 s24, s24, 0x4000
    s_add_u32 s55, s25, 4096
    v_mov_b32 v89, s17
    s_mov_b32 s15, 0
    s_add_u32 s56, s19, 1536
    s_xor_b32 s9, s11, s40
    s_add_u32 s16, s20, s38
    s_waitcnt lgkmcnt(3)
    v_smfmac_f32_16x16x64_bf16 v[76:79], v[56:59], v[0:7], v110
    s_waitcnt lgkmcnt(2)
    ds_read_b128 v[0:3], v113 offset:20480
    v_smfmac_f32_16x16x64_bf16 v[76:79], v[60:63], v[8:15], v110
    s_waitcnt lgkmcnt(2)
    ds_read_b128 v[4:7], v113 offset:21504
    v_smfmac_f32_16x16x64_bf16 v[76:79], v[48:51], v[192:199], v110
    s_waitcnt lgkmcnt(2)
    ds_read_b128 v[8:11], v113 offset:28672
    v_smfmac_f32_16x16x64_bf16 v[76:79], v[52:55], v[200:207], v110
    ds_read_b128 v[12:15], v113 offset:29696
    buffer_load_dword v111, v90, s[4:7], s47 offen sc1
    v_smfmac_f32_16x16x64_bf16 v[80:83], v[56:59], v[16:23], v110
    ds_read_b128 v[16:19], v113 offset:22528
    v_smfmac_f32_16x16x64_bf16 v[80:83], v[60:63], v[24:31], v110
    ds_read_b128 v[20:23], v113 offset:23552
    v_smfmac_f32_16x16x64_bf16 v[80:83], v[48:51], v[208:215], v110
    ds_read_b128 v[24:27], v113 offset:30720
    v_cvt_pk_f16_f32 v40, v76, v77
    v_smfmac_f32_16x16x64_bf16 v[80:83], v[52:55], v[216:223], v110
    ds_read_b128 v[28:31], v113 offset:31744
    v_cvt_pk_f16_f32 v41, v78, v79
    v_smfmac_f32_16x16x64_bf16 v[64:67], v[48:51], v[224:231], v110
    v_bfi_b32 v40, 1, s22, v40
    v_smfmac_f32_16x16x64_bf16 v[64:67], v[52:55], v[232:239], v110
    s_waitcnt lgkmcnt(6)
    buffer_load_dword v111, v90, s[4:7], s47 offen sc1
    v_smfmac_f32_16x16x64_bf16 v[64:67], v[56:59], v[0:7], v110
    s_waitcnt lgkmcnt(4)
    buffer_store_dwordx2 v[40:41], v119, s[4:7], s21 offen offset:0 sc1
    v_cvt_pk_f16_f32 v42, v80, v81
    v_smfmac_f32_16x16x64_bf16 v[64:67], v[60:63], v[8:15], v110
    v_cvt_pk_f16_f32 v43, v82, v83
    v_smfmac_f32_16x16x64_bf16 v[68:71], v[48:51], v[240:247], v110
    v_bfi_b32 v42, 1, s22, v42
    v_smfmac_f32_16x16x64_bf16 v[68:71], v[52:55], v[248:255], v110
    s_waitcnt lgkmcnt(2)
    v_smfmac_f32_16x16x64_bf16 v[68:71], v[56:59], v[16:23], v110
    s_waitcnt lgkmcnt(0)
    buffer_store_dwordx2 v[42:43], v119, s[4:7], s21 offen offset:512 sc1
    v_cvt_pk_f16_f32 v44, v64, v65
    v_smfmac_f32_16x16x64_bf16 v[68:71], v[60:63], v[24:31], v110
    v_cvt_pk_f16_f32 v45, v66, v67
    v_bfi_b32 v44, 1, s22, v44
    s_cmp_lg_u32 s14, 0
    buffer_store_dwordx2 v[44:45], v119, s[4:7], s21 offen offset:1024 sc1
    s_nop 3
    v_cvt_pk_f16_f32 v46, v68, v69
    v_cvt_pk_f16_f32 v47, v70, v71
    v_bfi_b32 v46, 1, s22, v46
    buffer_store_dwordx2 v[46:47], v119, s[4:7], s21 offen offset:1536 sc1
    s_cbranch_scc1 main_kernel_cs_wx
    s_waitcnt vmcnt(5)
    s_xor_b32 s21, s21, 0x80000
main_kernel_cs_rgo:
    v_subrev_u32 v32, s20, v111
    s_memtime s[52:53]
    v_cmp_lt_u32 vcc, 0x100000, v32
    v_max_u32_dpp v32, v32, v32 row_shr:1 row_mask:0xf bank_mask:0xf
    s_nop 0
    s_nop 0
    v_max_u32_dpp v32, v32, v32 row_shr:2 row_mask:0xf bank_mask:0xf
    s_nop 0
    s_cbranch_vccnz main_kernel_cs_fsp
main_kernel_cs_fok:
    s_nop 0
    v_max_u32_dpp v32, v32, v32 row_shr:4 row_mask:0xf bank_mask:0xf
    s_memtime s[52:53]
    s_nop 0
    v_max_u32_dpp v32, v32, v32 row_shr:8 row_mask:0xf bank_mask:0xf
    s_memtime s[52:53]
    s_nop 0
    v_max_u32_dpp v32, v32, v32 row_bcast:15 row_mask:0xa bank_mask:0xf
    s_memtime s[52:53]
    s_sub_u32 s33, s52, s16
    v_readlane_b32 s32, v32, 31
    s_add_u32 s33, s33, 0x400
    s_memtime s[52:53]
    s_add_u32 s34, s16, 1650
    s_memtime s[52:53]
    s_min_u32 s32, s32, s33
    s_max_u32 s32, s32, s15
    s_add_u32 s34, s34, s32
    s_mov_b32 s35, 200
main_kernel_cs_fw:
    s_memtime s[52:53]
    s_cmp_ge_u32 s52, s34
    s_cbranch_scc1 main_kernel_cs_fgo
    s_memtime s[52:53]
    s_cmp_ge_u32 s52, s34
    s_cbranch_scc1 main_kernel_cs_fgo
    s_memtime s[52:53]
    s_cmp_ge_u32 s52, s34
    s_cbranch_scc1 main_kernel_cs_fgo
    s_memtime s[52:53]
    s_cmp_ge_u32 s52, s34
    s_cbranch_scc1 main_kernel_cs_fgo
    s_memtime s[52:53]
    s_cmp_ge_u32 s52, s34
    s_cbranch_scc1 main_kernel_cs_fgo
    s_memtime s[52:53]
    s_cmp_ge_u32 s52, s34
    s_cbranch_scc1 main_kernel_cs_fgo
    s_memtime s[52:53]
    s_cmp_ge_u32 s52, s34
    s_cbranch_scc1 main_kernel_cs_fgo
    s_memtime s[52:53]
    s_cmp_ge_u32 s52, s34
    s_cbranch_scc1 main_kernel_cs_fgo
    s_sub_u32 s35, s35, 1
    s_cbranch_scc0 main_kernel_cs_fw
main_kernel_cs_fgo:
    buffer_load_dwordx4 v[0:3], v120, s[4:7], s23 offen sc1
    s_add_u32 s35, s23, 0x8000
    buffer_load_dwordx4 v[4:7], v120, s[4:7], s35 offen sc1
    s_add_u32 s35, s23, 0x10000
    buffer_load_dwordx4 v[8:11], v120, s[4:7], s35 offen sc1
    ds_read_b32 v33, v123 offset:20992
    s_add_u32 s35, s23, 0x18000
    buffer_load_dwordx4 v[12:15], v120, s[4:7], s35 offen sc1
    s_add_u32 s35, s23, 0x20000
    buffer_load_dwordx4 v[16:19], v120, s[4:7], s35 offen sc1
    s_add_u32 s35, s23, 0x28000
    buffer_load_dwordx4 v[20:23], v120, s[4:7], s35 offen sc1
    s_add_u32 s35, s23, 0x30000
    buffer_load_dwordx4 v[24:27], v120, s[4:7], s35 offen sc1
    s_add_u32 s35, s23, 0x38000
    buffer_load_dwordx4 v[28:31], v120, s[4:7], s35 offen sc1
    s_mov_b64 exec, 1
    s_waitcnt lgkmcnt(0)
    v_sub_u32 v33, s34, v33
    v_bfi_b32 v33, 1, s40, v33
    buffer_store_dword v33, off, s[4:7], s18 offset:1536 sc1
    v_readfirstlane_b32 s10, v33
    s_mov_b64 exec, -1
    s_waitcnt vmcnt(8)
    v_mfma_f32_16x16x32_f16 v[76:79], v[0:3], v[106:109], 0
    v_xor_b32 v36, s22, v0
    v_bitop3_b32 v36, v2, s22, v36 bitop3:0xbe
    s_waitcnt vmcnt(7)
    v_mfma_f32_16x16x32_f16 v[76:79], v[4:7], v[106:109], v[76:79]
    v_bitop3_b32 v36, v4, s22, v36 bitop3:0xbe
    v_bitop3_b32 v36, v6, s22, v36 bitop3:0xbe
    s_waitcnt vmcnt(6)
    v_mfma_f32_16x16x32_f16 v[76:79], v[8:11], v[106:109], v[76:79]
    v_bitop3_b32 v36, v8, s22, v36 bitop3:0xbe
    v_bitop3_b32 v36, v10, s22, v36 bitop3:0xbe
    s_waitcnt vmcnt(5)
    v_mfma_f32_16x16x32_f16 v[76:79], v[12:15], v[106:109], v[76:79]
    v_bitop3_b32 v36, v12, s22, v36 bitop3:0xbe
    v_bitop3_b32 v36, v14, s22, v36 bitop3:0xbe
    s_waitcnt vmcnt(4)
    v_mfma_f32_16x16x32_f16 v[76:79], v[16:19], v[106:109], v[76:79]
    v_bitop3_b32 v36, v16, s22, v36 bitop3:0xbe
    v_bitop3_b32 v36, v18, s22, v36 bitop3:0xbe
    s_waitcnt vmcnt(3)
    v_mfma_f32_16x16x32_f16 v[76:79], v[20:23], v[106:109], v[76:79]
    v_bitop3_b32 v36, v20, s22, v36 bitop3:0xbe
    v_bitop3_b32 v36, v22, s22, v36 bitop3:0xbe
    s_waitcnt vmcnt(2)
    v_mfma_f32_16x16x32_f16 v[76:79], v[24:27], v[106:109], v[76:79]
    v_bitop3_b32 v36, v24, s22, v36 bitop3:0xbe
    v_bitop3_b32 v36, v26, s22, v36 bitop3:0xbe
    s_waitcnt vmcnt(1)
    v_mfma_f32_16x16x32_f16 v[76:79], v[28:31], v[106:109], v[76:79]
    v_bitop3_b32 v36, v28, s22, v36 bitop3:0xbe
    v_bitop3_b32 v36, v30, s22, v36 bitop3:0xbe
    v_and_b32 v36, 1, v36
    v_cmp_ne_u32 vcc, 0, v36
    s_nop 3
    v_cvt_pk_bf16_f32 v126, v76, v77
    v_cvt_pk_bf16_f32 v127, v78, v79
    s_cbranch_vccnz main_kernel_cs_r_f
    buffer_store_dwordx2 v[126:127], v122, s[4:7], s24 offen sc1
    s_sub_u32 s20, s34, s38
    s_mov_b32 s3, s34
    buffer_store_dword v89, v117, s[4:7], s46 offen offset:512 sc1
    v_mov_b32 v32, -1
    v_mov_b32 v33, -1
    v_mov_b32 v64, 0
    v_mov_b32 v65, 0
    v_mov_b32 v66, 0
    v_mov_b32 v67, 0
    v_mov_b32 v68, 0
    v_mov_b32 v69, 0
    v_mov_b32 v70, 0
    v_mov_b32 v71, 0
    v_mov_b32 v96, 0
    v_mov_b32 v97, 0
    v_mov_b32 v98, 0
    v_mov_b32 v99, 0
    buffer_store_dwordx2 v[32:33], v122, s[4:7], s54 offen sc1
    s_cmp_eq_u32 s12, 0
    v_add_u32 v56, s59, v115
    s_cbranch_scc0 main_kernel_cs_vma
    ds_read_b64_tr_b16 v[80:81], v56 offset:16384
    ds_read_b64_tr_b16 v[82:83], v56 offset:17408
    s_waitcnt lgkmcnt(0)
    s_nop 15
    s_nop 15
    s_nop 5
    s_buffer_load_dword s9, s[4:7], s56 glc
    buffer_load_dword v111, v90, s[4:7], s47 offen offset:512 sc1
    buffer_load_dwordx4 v116, s[4:7], s25 offen offset:0 sc1 lds
    buffer_load_dwordx4 v116, s[4:7], s25 offen offset:1024 sc1 lds
    buffer_load_dwordx4 v116, s[4:7], s25 offen offset:2048 sc1 lds
    buffer_load_dwordx4 v116, s[4:7], s25 offen offset:3072 sc1 lds
    s_mov_b32 m0, 4096
    s_nop 0
    buffer_load_dwordx4 v116, s[4:7], s55 offen offset:0 sc1 lds
    buffer_load_dwordx4 v116, s[4:7], s55 offen offset:1024 sc1 lds
    buffer_load_dwordx4 v116, s[4:7], s55 offen offset:2048 sc1 lds
    buffer_load_dwordx4 v116, s[4:7], s55 offen offset:3072 sc1 lds
    v_mov_b32 v34, v90
    s_mov_b32 m0, s36
    s_barrier
    ds_read_b32 v35, v123 offset:20480
    buffer_load_dwordx4 v[88:91], v116, s[4:7], s28 offen offset:0 sc1
    buffer_load_dwordx4 v[92:95], v116, s[4:7], s28 offen offset:1024 sc1
    buffer_load_dwordx4 v116, s[4:7], s27 offen offset:0 sc1 lds
    buffer_store_dwordx4 v[80:83], v125, s[4:7], s26 offen sc1
    s_branch main_kernel_cs_kva
main_kernel_cs_vma:
    v_mfma_f32_16x16x32_bf16 v[56:59], v[102:105], v[84:87], 0
    s_nop 7
    v_cvt_pk_bf16_f32 v80, v56, v57
    v_cvt_pk_bf16_f32 v81, v58, v59
    s_nop 15
    s_nop 15
    s_nop 5
    s_buffer_load_dword s9, s[4:7], s56 glc
    buffer_load_dword v111, v90, s[4:7], s47 offen offset:512 sc1
    buffer_load_dwordx4 v116, s[4:7], s25 offen offset:0 sc1 lds
    buffer_load_dwordx4 v116, s[4:7], s25 offen offset:1024 sc1 lds
    buffer_load_dwordx4 v116, s[4:7], s25 offen offset:2048 sc1 lds
    buffer_load_dwordx4 v116, s[4:7], s25 offen offset:3072 sc1 lds
    s_mov_b32 m0, 4096
    s_nop 0
    buffer_load_dwordx4 v116, s[4:7], s55 offen offset:0 sc1 lds
    buffer_load_dwordx4 v116, s[4:7], s55 offen offset:1024 sc1 lds
    buffer_load_dwordx4 v116, s[4:7], s55 offen offset:2048 sc1 lds
    buffer_load_dwordx4 v116, s[4:7], s55 offen offset:3072 sc1 lds
    v_mov_b32 v34, v90
    s_mov_b32 m0, s36
    s_barrier
    ds_read_b32 v35, v123 offset:20480
    buffer_load_dwordx4 v[88:91], v116, s[4:7], s28 offen offset:0 sc1
    buffer_load_dwordx4 v[92:95], v116, s[4:7], s28 offen offset:1024 sc1
    buffer_load_dwordx4 v116, s[4:7], s27 offen offset:0 sc1 lds
    buffer_store_dwordx2 v[80:81], v123, s[4:7], s26 offen sc1
main_kernel_cs_kva:
    s_add_u32 s26, s26, 0x10000
    s_waitcnt vmcnt(12)
    v_cmp_gt_i32 vcc, s17, v111
    v_readfirstlane_b32 s38, v35
    s_cbranch_vccnz main_kernel_cs_mc_f
    s_waitcnt vmcnt(4)
    s_branch main_kernel_cs_top
main_kernel_cs_wx:
    s_cmp_lg_u32 s14, 1
    s_cbranch_scc1 main_kernel_cs_wy
    s_memrealtime s[32:33]
    s_nop 0
    s_nop 0
    s_memrealtime s[32:33]
    s_nop 0
    s_nop 0
    s_memrealtime s[32:33]
    s_nop 0
    s_nop 0
    s_memrealtime s[32:33]
    s_nop 0
    s_nop 0
    s_memrealtime s[32:33]
    s_nop 0
    s_nop 0
    s_memrealtime s[32:33]
    s_nop 0
    s_nop 0
    s_memrealtime s[32:33]
    s_nop 0
    s_nop 0
    s_memrealtime s[32:33]
    s_nop 0
    s_nop 0
    s_memrealtime s[32:33]
    s_nop 0
    s_nop 0
    s_memrealtime s[32:33]
    s_nop 0
    s_nop 0
    s_memrealtime s[32:33]
    s_nop 0
    s_nop 0
    s_memrealtime s[32:33]
    s_nop 0
    s_nop 0
    s_mov_b32 s34, s32
    s_memrealtime s[32:33]
    s_cmp_lg_u32 s32, s34
    s_cbranch_scc1 main_kernel_cs_e1
    s_memrealtime s[32:33]
    s_cmp_lg_u32 s32, s34
    s_cbranch_scc1 main_kernel_cs_e1
    s_memrealtime s[32:33]
    s_cmp_lg_u32 s32, s34
    s_cbranch_scc1 main_kernel_cs_e1
    s_memrealtime s[32:33]
    s_cmp_lg_u32 s32, s34
    s_cbranch_scc1 main_kernel_cs_e1
    s_memrealtime s[32:33]
    s_cmp_lg_u32 s32, s34
    s_cbranch_scc1 main_kernel_cs_e1
    s_memrealtime s[32:33]
    s_cmp_lg_u32 s32, s34
    s_cbranch_scc1 main_kernel_cs_e1
    s_memrealtime s[32:33]
    s_cmp_lg_u32 s32, s34
    s_cbranch_scc1 main_kernel_cs_e1
    s_memrealtime s[32:33]
    s_cmp_lg_u32 s32, s34
    s_cbranch_scc1 main_kernel_cs_e1
    s_memrealtime s[32:33]
    s_cmp_lg_u32 s32, s34
    s_cbranch_scc1 main_kernel_cs_e1
    s_memrealtime s[32:33]
    s_cmp_lg_u32 s32, s34
    s_cbranch_scc1 main_kernel_cs_e1
    s_memrealtime s[32:33]
    s_cmp_lg_u32 s32, s34
    s_cbranch_scc1 main_kernel_cs_e1
    s_memrealtime s[32:33]
    s_cmp_lg_u32 s32, s34
    s_cbranch_scc1 main_kernel_cs_e1
main_kernel_cs_e1:
    s_memtime s[52:53]
    s_mul_i32 s34, s32, 22
    s_waitcnt lgkmcnt(0)
    s_sub_u32 s32, s52, s34
    s_sub_u32 s33, s32, s38
    s_ashr_i32 s34, s33, 1
    s_add_u32 s34, s34, s32
    v_mov_b32 v34, s34
    v_mov_b32 v33, s32
    ds_write2st64_b32 v123, v33, v34 offset0:80 offset1:82
    v_add_u32 v37, s33, v34
main_kernel_cs_wy:
    s_xor_b32 s21, s21, 0x80000
    v_mov_b32 v64, 0
    v_mov_b32 v65, 0
    v_mov_b32 v66, 0
    v_mov_b32 v67, 0
    v_mov_b32 v68, 0
    v_mov_b32 v69, 0
    v_mov_b32 v70, 0
    v_mov_b32 v71, 0
    v_mov_b32 v96, 0
    v_mov_b32 v97, 0
    v_mov_b32 v98, 0
    v_mov_b32 v99, 0
    s_cmp_eq_u32 s12, 0
    v_add_u32 v56, s59, v115
    s_cbranch_scc0 main_kernel_cs_vmb
    ds_read_b64_tr_b16 v[80:81], v56 offset:16384
    ds_read_b64_tr_b16 v[82:83], v56 offset:17408
    s_waitcnt lgkmcnt(0)
    s_waitcnt vmcnt(0)
    s_mov_b32 m0, s36
    s_barrier
    ds_read_b32 v35, v123 offset:20480
    ds_write_b32 v124, v37 offset:3584
    buffer_load_dwordx4 v[88:91], v116, s[4:7], s28 offen offset:0 sc1
    buffer_load_dwordx4 v[92:95], v116, s[4:7], s28 offen offset:1024 sc1
    buffer_load_dwordx4 v116, s[4:7], s27 offen offset:0 sc1 lds
    buffer_store_dwordx4 v[80:83], v125, s[4:7], s26 offen sc1
    s_branch main_kernel_cs_kvb
main_kernel_cs_vmb:
    v_mfma_f32_16x16x32_bf16 v[56:59], v[102:105], v[84:87], 0
    s_nop 7
    v_cvt_pk_bf16_f32 v80, v56, v57
    v_cvt_pk_bf16_f32 v81, v58, v59
    s_waitcnt vmcnt(0)
    s_mov_b32 m0, s36
    s_barrier
    ds_read_b32 v35, v123 offset:20480
    ds_write_b32 v124, v37 offset:3584
    buffer_load_dwordx4 v[88:91], v116, s[4:7], s28 offen offset:0 sc1
    buffer_load_dwordx4 v[92:95], v116, s[4:7], s28 offen offset:1024 sc1
    buffer_load_dwordx4 v116, s[4:7], s27 offen offset:0 sc1 lds
    buffer_store_dwordx2 v[80:81], v123, s[4:7], s26 offen sc1
main_kernel_cs_kvb:
    s_add_u32 s26, s26, 0x10000
    s_mov_b64 exec, 1
    buffer_store_dword v100, off, s[4:7], s39 sc1
    s_mov_b64 exec, -1
    s_add_u32 s39, s39, 4
    s_waitcnt lgkmcnt(0)
    v_readfirstlane_b32 s38, v35
    v_mov_b32 v35, 0
    v_mov_b32 v35, 0
    v_mov_b32 v35, 0
    v_mov_b32 v35, 0
    v_mov_b32 v35, 0
    v_mov_b32 v35, 0
main_kernel_cs_end:
    s_branch main_kernel_cs_top
main_kernel_cs_mc_f:
    s_mov_b32 m0, 0
    s_sub_u32 s29, s29, 1
    s_cbranch_scc1 main_kernel_end
    buffer_load_dword v111, v34, s[4:7], s47 offen offset:512 sc1
    buffer_load_dwordx4 v116, s[4:7], s25 offen offset:0 sc1 lds
    buffer_load_dwordx4 v116, s[4:7], s25 offen offset:1024 sc1 lds
    buffer_load_dwordx4 v116, s[4:7], s25 offen offset:2048 sc1 lds
    buffer_load_dwordx4 v116, s[4:7], s25 offen offset:3072 sc1 lds
    s_mov_b32 m0, 4096
    s_nop 0
    buffer_load_dwordx4 v116, s[4:7], s55 offen offset:0 sc1 lds
    buffer_load_dwordx4 v116, s[4:7], s55 offen offset:1024 sc1 lds
    buffer_load_dwordx4 v116, s[4:7], s55 offen offset:2048 sc1 lds
    buffer_load_dwordx4 v116, s[4:7], s55 offen offset:3072 sc1 lds
    s_waitcnt vmcnt(8)
    v_cmp_gt_i32 vcc, s17, v111
    v_readfirstlane_b32 s38, v35
    s_cbranch_vccnz main_kernel_cs_mc_f
    s_waitcnt vmcnt(0)
    s_branch main_kernel_cs_end
main_kernel_cs_t_w:
    s_mov_b32 s35, 200
main_kernel_cs_t_s:
    s_memtime s[52:53]
    s_cmp_ge_u32 s52, s34
    s_cbranch_scc1 main_kernel_cs_t_go
    s_memtime s[52:53]
    s_cmp_ge_u32 s52, s34
    s_cbranch_scc1 main_kernel_cs_t_go
    s_memtime s[52:53]
    s_cmp_ge_u32 s52, s34
    s_cbranch_scc1 main_kernel_cs_t_go
    s_memtime s[52:53]
    s_cmp_ge_u32 s52, s34
    s_cbranch_scc1 main_kernel_cs_t_go
    s_memtime s[52:53]
    s_cmp_ge_u32 s52, s34
    s_cbranch_scc1 main_kernel_cs_t_go
    s_memtime s[52:53]
    s_cmp_ge_u32 s52, s34
    s_cbranch_scc1 main_kernel_cs_t_go
    s_memtime s[52:53]
    s_cmp_ge_u32 s52, s34
    s_cbranch_scc1 main_kernel_cs_t_go
    s_memtime s[52:53]
    s_cmp_ge_u32 s52, s34
    s_cbranch_scc1 main_kernel_cs_t_go
    s_sub_u32 s35, s35, 1
    s_cbranch_scc0 main_kernel_cs_t_s
    s_branch main_kernel_cs_t_go
main_kernel_cs_t_p:
    s_waitcnt lgkmcnt(0)
    s_xor_b32 s32, s9, s22
    s_bitcmp1_b32 s32, 0
    s_cbranch_scc0 main_kernel_cs_t_ok
    s_buffer_load_dword s9, s[4:7], s56 glc
    s_sub_u32 s29, s29, 1
    s_cbranch_scc1 main_kernel_end
    s_branch main_kernel_cs_t_p
main_kernel_cs_z0_f:
    buffer_load_dwordx2 v[126:127], v123, s[4:7], s19 offen offset:0 sc1
    s_sub_u32 s29, s29, 1
    s_cbranch_scc1 main_kernel_end
    s_waitcnt vmcnt(0)
    s_branch main_kernel_cs_z0
main_kernel_cs_z2_f:
    buffer_load_dwordx2 v[64:65], v123, s[4:7], s19 offen offset:512 sc1
    s_sub_u32 s29, s29, 1
    s_cbranch_scc1 main_kernel_end
    s_waitcnt vmcnt(0)
main_kernel_cs_z1_f:
    s_waitcnt vmcnt(0)
    s_memtime s[52:53]
    v_dot2_f32_bf16 v44, v64, s37, v68
    v_dot2_f32_bf16 v45, v64, s57, v69
    v_dot2_f32_bf16 v46, v65, s37, v70
    v_dot2_f32_bf16 v47, v65, s57, v71
    v_bitop3_b32 v60, v64, s22, 1 bitop3:0x28
    v_cvt_pk_bf16_f32 v44, v44, v45
    v_cmp_ne_u32 vcc, 0, v60
    v_cvt_pk_bf16_f32 v45, v46, v47
    ds_write_b64 v124, v[44:45] offset:512
    s_cbranch_vccnz main_kernel_cs_z2_f
    s_branch main_kernel_cs_z_ok
main_kernel_cs_kvw:
    s_cmp_eq_u32 s17, 64
    s_cbranch_scc1 main_kernel_cs_kvok
    s_waitcnt vmcnt(0)
    s_mov_b32 exec_lo, 0
    s_mov_b32 exec_hi, 0x3f00
    v_subrev_u32 v127, 0, v121
main_kernel_cs_kvp:
    buffer_load_dword v126, v127, s[4:7], 0 offen sc1
    s_waitcnt vmcnt(0)
    v_cmp_eq_u32 vcc, 0, v126
    s_cbranch_vccz main_kernel_cs_kvp_ok
    s_sleep 2
    s_sub_u32 s29, s29, 1
    s_cbranch_scc0 main_kernel_cs_kvp
    s_branch main_kernel_end
main_kernel_cs_kvp_ok:
    s_mov_b64 exec, -1
    s_branch main_kernel_cs_kvok
main_kernel_cs_last:
    buffer_load_dwordx2 v[86:87], v123, s[4:7], s19 offen offset:1024 sc1
    s_sub_u32 s29, s29, 1
    s_cbranch_scc1 main_kernel_end
    s_waitcnt vmcnt(0) lgkmcnt(0)
    v_bitop3_b32 v44, v86, s22, 1 bitop3:0x28
    v_cmp_ne_u32 vcc, 0, v44
    s_cbranch_vccnz main_kernel_cs_last
    v_swap_b32 v85, v86
    s_cmp_eq_u32 s12, 0
    v_add_u32 v56, s59, v115
    s_cbranch_scc0 main_kernel_cs_vmc
    ds_read_b64_tr_b16 v[80:81], v56 offset:16384
    ds_read_b64_tr_b16 v[82:83], v56 offset:17408
    s_waitcnt lgkmcnt(0)
    buffer_store_dwordx4 v[80:83], v125, s[4:7], s26 offen sc1
    s_branch main_kernel_cs_kvc
main_kernel_cs_vmc:
    v_mfma_f32_16x16x32_bf16 v[56:59], v[102:105], v[84:87], 0
    s_nop 7
    v_cvt_pk_bf16_f32 v80, v56, v57
    v_cvt_pk_bf16_f32 v81, v58, v59
    buffer_store_dwordx2 v[80:81], v123, s[4:7], s26 offen sc1
main_kernel_cs_kvc:
    s_add_u32 s26, s26, 0x10000
    s_branch main_kernel_end
main_kernel_cs_m_f:
main_kernel_cs_m_t:
    ds_read_b128 v[0:3], v116 offset:0
    ds_read_b128 v[4:7], v116 offset:1024
    ds_read_b128 v[8:11], v116 offset:2048
    ds_read_b128 v[12:15], v116 offset:3072
    ds_read_b128 v[16:19], v116 offset:4096
    ds_read_b128 v[20:23], v116 offset:5120
    ds_read_b128 v[24:27], v116 offset:6144
    ds_read_b128 v[28:31], v116 offset:7168
    s_waitcnt lgkmcnt(0)
    v_max_u32 v126, v0, v2
    v_max3_u32 v126, v126, v4, v6
    v_max3_u32 v126, v126, v8, v10
    v_max3_u32 v126, v126, v12, v14
    v_max3_u32 v126, v126, v16, v18
    v_max3_u32 v126, v126, v20, v22
    v_max3_u32 v126, v126, v24, v26
    v_max3_u32 v126, v126, v28, v30
    v_cmp_eq_u32 vcc, -1, v126
    s_cbranch_vccz main_kernel_cs_m_g
    s_barrier
    s_lshl_b32 s32, s14, 11
    s_add_u32 m0, s32, 0
    s_add_u32 s32, s32, s25
    buffer_load_dwordx4 v116, s[4:7], s32 offen offset:0 sc1 lds
    buffer_load_dwordx4 v116, s[4:7], s32 offen offset:1024 sc1 lds
    s_sub_u32 s29, s29, 1
    s_cbranch_scc1 main_kernel_end
    s_waitcnt vmcnt(0)
    s_barrier
    s_branch main_kernel_cs_m_t
main_kernel_cs_m_g:
    s_mov_b64 s[44:45], 0
    v_mov_b32 v64, 0
    v_mov_b32 v65, 0
    v_mov_b32 v66, 0
    v_mov_b32 v67, 0
    v_mov_b32 v68, 0
    v_mov_b32 v69, 0
    v_mov_b32 v70, 0
    v_mov_b32 v71, 0
    v_mov_b32 v96, 0
    v_mov_b32 v97, 0
    v_mov_b32 v98, 0
    v_mov_b32 v99, 0
    s_branch main_kernel_cs_mrd
main_kernel_cs_v_f:
    v_swap_b32 v85, v86
    s_nop 7
    s_waitcnt vmcnt(1)
main_kernel_cs_v_t:
    s_memtime s[52:53]
    v_bitop3_b32 v44, v126, s22, 1 bitop3:0x28
    v_cmp_ne_u32 vcc, 0, v44
    s_sub_u32 s29, s29, 1
    s_cbranch_scc1 main_kernel_end
    s_cbranch_vccnz main_kernel_cs_v_g
    v_mfma_f32_16x16x32_bf16 v[64:67], v[88:91], v[32:35], 0
    v_mfma_f32_16x16x32_bf16 v[68:71], v[92:95], v[32:35], 0
    v_mov_b32 v86, v126
    v_mov_b32 v87, v127
    s_waitcnt lgkmcnt(0)
    s_sub_u32 s32, s52, s38
    s_add_u32 s32, s32, -550
    v_mov_b32 v46, s32
    buffer_store_dword v46, v117, s[4:7], s46 offen sc1
    s_branch main_kernel_cs_v_ok
main_kernel_cs_v_g:
    buffer_load_dwordx2 v[126:127], v123, s[4:7], s19 offen offset:1024 sc1
    s_waitcnt lgkmcnt(0)
    s_sub_u32 s32, s52, s38
    s_add_u32 s32, s32, -50
    v_mov_b32 v46, s32
    buffer_store_dword v46, v117, s[4:7], s46 offen sc1
    s_waitcnt vmcnt(0)
    s_branch main_kernel_cs_v_t
main_kernel_cs_d_f:
    s_memtime s[52:53]
    s_waitcnt vmcnt(1) lgkmcnt(0)
    s_sub_u32 s32, s52, s38
    s_add_u32 s32, s32, 300
    v_mov_b32 v46, s32
    buffer_store_dword v46, v117, s[4:7], s46 offen sc1
    ds_read_b128 v[0:3], v112 offset:0
    ds_read_b128 v[4:7], v112 offset:1024
    ds_read_b128 v[8:11], v112 offset:2048
    ds_read_b128 v[12:15], v112 offset:3072
    ds_read_b128 v[16:19], v112 offset:4096
    ds_read_b128 v[20:23], v112 offset:5120
    ds_read_b128 v[24:27], v112 offset:6144
    ds_read_b128 v[28:31], v112 offset:7168
    s_waitcnt lgkmcnt(0)
    v_mfma_f32_16x16x32_bf16 v[32:35], v[0:3], v[48:51], 0
    v_mfma_f32_16x16x32_bf16 v[36:39], v[16:19], v[48:51], 0
    v_mfma_f32_16x16x32_bf16 v[72:75], v[48:51], v[48:51], 0
    v_mfma_f32_16x16x32_bf16 v[32:35], v[4:7], v[52:55], v[32:35]
    v_mfma_f32_16x16x32_bf16 v[36:39], v[20:23], v[52:55], v[36:39]
    v_mfma_f32_16x16x32_bf16 v[72:75], v[52:55], v[52:55], v[72:75]
    v_mfma_f32_16x16x32_bf16 v[32:35], v[8:11], v[56:59], v[32:35]
    v_mfma_f32_16x16x32_bf16 v[36:39], v[24:27], v[56:59], v[36:39]
    v_mfma_f32_16x16x32_bf16 v[72:75], v[56:59], v[56:59], v[72:75]
    v_mfma_f32_16x16x32_bf16 v[32:35], v[12:15], v[60:63], v[32:35]
    v_mfma_f32_16x16x32_bf16 v[36:39], v[28:31], v[60:63], v[36:39]
    v_mfma_f32_16x16x32_bf16 v[72:75], v[60:63], v[60:63], v[72:75]
    s_nop 7
    ds_read_b128 v[0:3], v113 offset:16384
    ds_read_b128 v[16:19], v113 offset:18432
    ds_read_b128 v[4:7], v113 offset:17408
    ds_read_b128 v[20:23], v113 offset:19456
    ds_read_b128 v[8:11], v113 offset:24576
    ds_read_b128 v[24:27], v113 offset:26624
    ds_read_b128 v[12:15], v113 offset:25600
    ds_read_b128 v[28:31], v113 offset:27648
    v_permlane32_swap_b32 v72, v73
    v_permlane32_swap_b32 v74, v75
    v_mul_f32 v73, s30, v73
    v_mul_f32 v75, s30, v75
    v_max_f32 v126, v73, v75
    v_max3_f32 v126, v126, v32, v33
    v_max3_f32 v126, v126, v34, v35
    v_max3_f32 v126, v126, v36, v37
    v_max3_f32 v126, v126, v38, v39
    v_mov_b32 v127, v126
    s_nop 1
    v_permlane32_swap_b32 v126, v127
    v_max_f32 v126, v126, v127
    v_mov_b32 v127, v126
    s_nop 1
    v_permlane16_swap_b32 v126, v127
    v_max_f32 v126, v126, v127
    v_sub_f32 v32, v32, v126
    v_sub_f32 v33, v33, v126
    v_sub_f32 v34, v34, v126
    v_sub_f32 v35, v35, v126
    v_sub_f32 v36, v36, v126
    v_sub_f32 v37, v37, v126
    v_sub_f32 v38, v38, v126
    v_sub_f32 v39, v39, v126
    v_sub_f32 v73, v73, v126
    v_sub_f32 v75, v75, v126
    v_exp_f32 v32, v32
    v_exp_f32 v33, v33
    v_exp_f32 v34, v34
    v_exp_f32 v35, v35
    v_exp_f32 v36, v36
    v_exp_f32 v37, v37
    v_exp_f32 v38, v38
    v_exp_f32 v39, v39
    v_exp_f32 v73, v73
    v_exp_f32 v75, v75
    v_cvt_pk_bf16_f32 v32, v32, v33
    v_cvt_pk_bf16_f32 v33, v34, v35
    v_cvt_pk_bf16_f32 v34, v36, v37
    v_cvt_pk_bf16_f32 v35, v38, v39
    v_cvt_pk_bf16_f32 v72, v73, v75
    v_cvt_pk_bf16_f32 v73, v73, v75
    s_nop 1
    v_mfma_f32_16x16x32_bf16 v[64:67], v[88:91], v[32:35], 0
    v_mfma_f32_16x16x32_bf16 v[68:71], v[92:95], v[32:35], 0
    v_mfma_f32_16x16x32_bf16 v[40:43], v[96:99], v[32:35], 0
    s_nop 3
    s_nop 1
    v_mfma_f32_16x16x16_bf16 v[40:43], v[100:101], v[72:73], v[40:43]
    s_mov_b64 s[44:45], 0
    s_mov_b64 vcc, 0
    s_nop 7
    s_branch main_kernel_cs_d_ok
main_kernel_cs_fsp:
    s_mov_b32 s35, 40
main_kernel_cs_fsl:
    buffer_load_dword v111, v90, s[4:7], s47 offen sc1
    s_waitcnt vmcnt(1)
    v_subrev_u32 v32, s20, v111
    v_cmp_lt_u32 vcc, 0x100000, v32
    s_cbranch_vccz main_kernel_cs_rgo
    s_sub_u32 s35, s35, 1
    s_cbranch_scc0 main_kernel_cs_fsl
    v_mov_b32 v32, 0
    s_branch main_kernel_cs_fok
main_kernel_cs_r_f:
    s_memtime s[52:53]
    buffer_load_dword v111, v90, s[4:7], s47 offen sc1
    s_waitcnt lgkmcnt(0)
    s_sub_u32 s15, s52, s16
    s_add_u32 s15, s15, -1500
    s_waitcnt vmcnt(0)
    s_sub_u32 s29, s29, 1
    s_cbranch_scc1 main_kernel_end
    s_branch main_kernel_cs_rgo
main_kernel_att:
    s_cmp_gt_u32 s13, 1
    s_cbranch_scc1 main_kernel_p_end
    s_cmp_lg_u32 s14, 0
    s_cbranch_scc1 main_kernel_p_bar
    s_lshl_b32 s32, s13, 21
    s_add_u32 s32, s32, 0x8c00000
    v_lshlrev_b32 v2, 2, v250
    v_mov_b32 v3, -1
    s_mov_b64 s[20:21], -1
    s_mov_b32 s34, 12
    s_mov_b32 exec_hi, 0
    s_waitcnt vmcnt(0)
main_kernel_p_lp:
    s_memtime s[16:17]
    s_waitcnt lgkmcnt(0)
    buffer_store_dword v3, v2, s[4:7], s32 offen sc1
    s_waitcnt vmcnt(0)
    s_memtime s[18:19]
    s_xor_b32 s32, s32, 0x2000
    s_waitcnt lgkmcnt(0)
    s_sub_u32 s33, s18, s16
    s_min_u32 s20, s20, s33
    s_memtime s[16:17]
    s_waitcnt lgkmcnt(0)
    buffer_store_dword v3, v2, s[4:7], s32 offen sc1
    s_waitcnt vmcnt(0)
    s_memtime s[18:19]
    s_xor_b32 s32, s32, 0x2000
    s_waitcnt lgkmcnt(0)
    s_sub_u32 s33, s18, s16
    s_min_u32 s21, s21, s33
    s_add_u32 s32, s32, 128
    s_sub_u32 s34, s34, 1
    s_cmp_lg_u32 s34, 0
    s_cbranch_scc1 main_kernel_p_lp
    s_cmp_lt_u32 s21, s20
    s_cselect_b32 s32, 3, 2
    s_lshl_b32 s33, s13, 2
    v_mov_b32 v3, s32
    s_mov_b64 exec, 1
    buffer_store_dword v3, off, s[60:63], s33 offset:16 sc1
    s_mov_b64 exec, -1
main_kernel_p_bar:
    s_barrier
main_kernel_p_end:
    v_lshlrev_b32 v0, 2, v250
    s_mov_b32 s32, 0x841f000
main_kernel_awf:
    buffer_load_dword v2, v0, s[4:7], s32 offen sc1
    s_waitcnt vmcnt(0)
    v_cmp_eq_u32 vcc, 0, v2
    s_cbranch_vccz main_kernel_awf_ok
    s_sleep 4
    s_sub_u32 s29, s29, 1
    s_cbranch_scc0 main_kernel_awf
    s_branch main_kernel_end
main_kernel_awf_ok:
main_kernel_att2:
    s_lshl_b32 s28, s13, 1
    s_lshr_b32 s31, s14, 1
    s_add_u32 s28, s28, s31
    s_and_b32 s30, s14, 1
    v_lshlrev_b32 v204, 4, v250
    v_and_b32 v200, 15, v250
    v_lshrrev_b32 v201, 4, v250
    v_and_b32 v202, 7, v250
    v_lshl_add_u32 v202, v201, 3, v202
    v_lshlrev_b32 v205, 4, v202
    v_bfe_u32 v206, v204, 1, 8
    v_min_u32 v207, 2, v250
    v_lshlrev_b32 v207, 13, v207
    s_lshl_b32 s31, s28, 8
    s_sub_u32 s31, 80912, s31
    s_cmp_eq_u32 s12, 7
    s_cselect_b32 s25, 61, 0
    s_cselect_b32 s32, 16, 0
    s_sub_u32 s31, s31, s32
    s_mov_b64 exec, 0xf0
    v_lshl_add_u32 v207, v250, 8, s31
    s_mov_b64 exec, -1
    v_mov_b32 v208, 1
    v_mov_b32 v209, 0
    s_lshl_b32 s31, s30, 4
    v_add_u32 v200, s31, v200
    v_lshlrev_b32 v202, 2, v201
    v_sub_u32 v200, v200, v202
    v_mov_b32 v202, 0xf149f2ca
    v_cmp_le_i32 vcc, 0, v200
    s_nop 1
    v_cndmask_b32 v124, v202, 0, vcc
    v_cmp_le_i32 vcc, 1, v200
    s_nop 1
    v_cndmask_b32 v125, v202, 0, vcc
    v_cmp_le_i32 vcc, 2, v200
    s_nop 1
    v_cndmask_b32 v126, v202, 0, vcc
    v_cmp_le_i32 vcc, 3, v200
    s_nop 1
    v_cndmask_b32 v127, v202, 0, vcc
    v_cmp_le_i32 vcc, 16, v200
    s_nop 1
    v_cndmask_b32 v128, v202, 0, vcc
    v_cmp_le_i32 vcc, 17, v200
    s_nop 1
    v_cndmask_b32 v129, v202, 0, vcc
    v_cmp_le_i32 vcc, 18, v200
    s_nop 1
    v_cndmask_b32 v130, v202, 0, vcc
    v_cmp_le_i32 vcc, 19, v200
    s_nop 1
    v_cndmask_b32 v131, v202, 0, vcc
    v_cmp_le_u32 vcc, 2, v201
    s_nop 1
    v_cndmask_b32 v132, v202, 0, vcc
    v_mov_b32 v180, 0x3f803f80
    v_cndmask_b32 v133, v202, 0, vcc
    v_mov_b32 v181, 0x3f803f80
    v_cndmask_b32 v134, v202, 0, vcc
    v_mov_b32 v182, 0x3f803f80
    v_cndmask_b32 v135, v202, 0, vcc
    v_mov_b32 v183, 0x3f803f80
    s_mov_b32 s26, 0x3e0293ee
    s_mov_b32 s27, 0xbe0293ee
    s_lshl_b32 s31, s28, 12
    s_add_u32 s16, s31, 0x1800000
    s_add_u32 s17, s16, 131072
    s_lshl_b32 s32, s30, 17
    s_add_u32 s31, s31, s32
    s_add_u32 s15, s31, 0x800000
    s_add_u32 s22, s31, 0x3800000
    s_lshl_b32 s31, s28, 13
    s_add_u32 s18, s31, 0x2800000
    s_add_u32 s19, s18, 4096
    s_lshl_b32 s31, s28, 11
    s_add_u32 s20, s31, 0x8000000
    s_add_u32 s21, s31, 0x6e00000
    s_lshl_b32 s31, s28, 8
    s_add_u32 s23, s31, 0x8404000
    s_lshl_b32 s31, s28, 3
    s_lshl_b32 s32, s30, 2
    s_add_u32 s31, s31, s32
    s_add_u32 s24, s31, 0x8400000
    v_and_b32 v210, 3, v250
    s_mov_b32 s39, 0
    v_lshlrev_b32 v210, 2, v210
    s_mov_b32 s33, 0x841ec00
    s_lshl_b32 s31, s25, 18
    s_add_u32 s15, s15, s31
    s_add_u32 s16, s16, s31
    s_add_u32 s17, s17, s31
    s_add_u32 s18, s18, s31
    s_add_u32 s19, s19, s31
    s_add_u32 s22, s22, s31
    s_lshl_b32 s31, s25, 16
    s_add_u32 s20, s20, s31
    s_add_u32 s21, s21, s31
    s_lshl_b32 s31, s25, 8
    s_add_u32 s24, s24, s31
    s_lshl_b32 s31, s25, 2
    s_add_u32 s23, s23, s31
    s_add_u32 s33, s33, s31
    s_cmp_lg_u32 s25, 0
    s_cbranch_scc1 main_kernel_a_npf
    s_cmp_lt_u32 s13, 14
    s_cbranch_scc0 main_kernel_a_pf4
    s_mov_b32 s8, s68
    s_and_b32 s9, s69, 0xffff
    s_mov_b32 s10, 0x700000
    s_mov_b32 s11, 0x20000
    s_lshl_b32 s31, s13, 19
    s_branch main_kernel_a_pfg
main_kernel_a_pf4:
    s_mov_b32 s8, s70
    s_and_b32 s9, s71, 0xffff
    s_mov_b32 s10, 0x700000
    s_mov_b32 s11, 0x20000
    s_sub_u32 s31, s13, 2
    s_lshl_b32 s31, s31, 19
main_kernel_a_pfg:
    s_lshl_b32 s32, s14, 17
    s_add_u32 s31, s31, s32
    v_lshlrev_b32 v200, 7, v250
    buffer_load_dword v0, v200, s[8:11], s31 offen
    s_add_u32 s31, s31, 8192
    buffer_load_dword v0, v200, s[8:11], s31 offen
    s_add_u32 s31, s31, 8192
    buffer_load_dword v0, v200, s[8:11], s31 offen
    s_add_u32 s31, s31, 8192
    buffer_load_dword v0, v200, s[8:11], s31 offen
    s_add_u32 s31, s31, 8192
    buffer_load_dword v0, v200, s[8:11], s31 offen
    s_add_u32 s31, s31, 8192
    buffer_load_dword v0, v200, s[8:11], s31 offen
    s_add_u32 s31, s31, 8192
    buffer_load_dword v0, v200, s[8:11], s31 offen
    s_add_u32 s31, s31, 8192
    buffer_load_dword v0, v200, s[8:11], s31 offen
    s_add_u32 s31, s31, 8192
    buffer_load_dword v0, v200, s[8:11], s31 offen
    s_add_u32 s31, s31, 8192
    buffer_load_dword v0, v200, s[8:11], s31 offen
    s_add_u32 s31, s31, 8192
    buffer_load_dword v0, v200, s[8:11], s31 offen
    s_add_u32 s31, s31, 8192
    buffer_load_dword v0, v200, s[8:11], s31 offen
    s_add_u32 s31, s31, 8192
    buffer_load_dword v0, v200, s[8:11], s31 offen
    s_add_u32 s31, s31, 8192
    buffer_load_dword v0, v200, s[8:11], s31 offen
    s_add_u32 s31, s31, 8192
    buffer_load_dword v0, v200, s[8:11], s31 offen
    s_add_u32 s31, s31, 8192
    buffer_load_dword v0, v200, s[8:11], s31 offen
    s_add_u32 s31, s31, 8192
    s_mov_b32 s8, s70
    s_and_b32 s9, s71, 0xffff
    s_mov_b32 s10, 0x700000
    s_mov_b32 s11, 0x20000
    s_sub_u32 s31, s13, 0
    s_lshl_b32 s31, s31, 19
    s_cmp_ge_u32 s13, 12
    s_cbranch_scc1 main_kernel_a_npf
    s_lshl_b32 s32, s14, 17
    s_add_u32 s31, s31, s32
    v_lshlrev_b32 v200, 7, v250
    buffer_load_dword v0, v200, s[8:11], s31 offen
    s_add_u32 s31, s31, 8192
    buffer_load_dword v0, v200, s[8:11], s31 offen
    s_add_u32 s31, s31, 8192
    buffer_load_dword v0, v200, s[8:11], s31 offen
    s_add_u32 s31, s31, 8192
    buffer_load_dword v0, v200, s[8:11], s31 offen
    s_add_u32 s31, s31, 8192
    buffer_load_dword v0, v200, s[8:11], s31 offen
    s_add_u32 s31, s31, 8192
    buffer_load_dword v0, v200, s[8:11], s31 offen
    s_add_u32 s31, s31, 8192
    buffer_load_dword v0, v200, s[8:11], s31 offen
    s_add_u32 s31, s31, 8192
    buffer_load_dword v0, v200, s[8:11], s31 offen
    s_add_u32 s31, s31, 8192
    buffer_load_dword v0, v200, s[8:11], s31 offen
    s_add_u32 s31, s31, 8192
    buffer_load_dword v0, v200, s[8:11], s31 offen
    s_add_u32 s31, s31, 8192
    buffer_load_dword v0, v200, s[8:11], s31 offen
    s_add_u32 s31, s31, 8192
    buffer_load_dword v0, v200, s[8:11], s31 offen
    s_add_u32 s31, s31, 8192
    buffer_load_dword v0, v200, s[8:11], s31 offen
    s_add_u32 s31, s31, 8192
    buffer_load_dword v0, v200, s[8:11], s31 offen
    s_add_u32 s31, s31, 8192
    buffer_load_dword v0, v200, s[8:11], s31 offen
    s_add_u32 s31, s31, 8192
    buffer_load_dword v0, v200, s[8:11], s31 offen
    s_add_u32 s31, s31, 8192
    s_waitcnt vmcnt(0)
main_kernel_a_npf:
    s_cmp_eq_u32 s25, 0
    s_cbranch_scc1 main_kernel_a_fp
    s_sub_u32 s32, s24, 1280
main_kernel_a_gp:
    buffer_load_dword v200, v209, s[4:7], s32 offen sc1
    s_waitcnt vmcnt(0)
    v_cmp_eq_u32 vcc, 0, v200
    s_and_b32 s31, vcc_lo, 1
    s_cbranch_scc0 main_kernel_a_fp
    s_sleep 32
    s_sub_u32 s29, s29, 1
    s_cbranch_scc0 main_kernel_a_gp
    s_branch main_kernel_end
main_kernel_a_fp:
    buffer_load_dword v200, v207, s[4:7], s23 offen sc1
    s_waitcnt vmcnt(0)
    v_cmp_eq_u32 vcc, 0, v200
    s_and_b32 s31, vcc_lo, -1
    s_cbranch_scc0 main_kernel_a_fok
    s_sleep 8
    s_sub_u32 s29, s29, 1
    s_cbranch_scc0 main_kernel_a_fp
    s_branch main_kernel_end
main_kernel_a_fok:
    buffer_load_dwordx4 v[0:3], v204, s[4:7], s15 offen offset:0 sc1
    buffer_load_dwordx4 v[16:19], v204, s[4:7], s16 offen offset:0 sc1
    buffer_load_dwordx4 v[32:35], v204, s[4:7], s17 offen offset:0 sc1
    buffer_load_dwordx4 v[4:7], v204, s[4:7], s15 offen offset:1024 sc1
    buffer_load_dwordx4 v[20:23], v204, s[4:7], s16 offen offset:1024 sc1
    buffer_load_dwordx4 v[36:39], v204, s[4:7], s17 offen offset:1024 sc1
    buffer_load_dwordx4 v[8:11], v204, s[4:7], s15 offen offset:2048 sc1
    buffer_load_dwordx4 v[24:27], v204, s[4:7], s16 offen offset:2048 sc1
    buffer_load_dwordx4 v[40:43], v204, s[4:7], s17 offen offset:2048 sc1
    buffer_load_dwordx4 v[12:15], v204, s[4:7], s15 offen offset:3072 sc1
    buffer_load_dwordx4 v[28:31], v204, s[4:7], s16 offen offset:3072 sc1
    buffer_load_dwordx4 v[44:47], v204, s[4:7], s17 offen offset:3072 sc1
    buffer_load_dword v211, v210, s[4:7], s33 offen sc1
    buffer_load_dwordx4 v[48:51], v204, s[4:7], s18 offen offset:0 sc1
    buffer_load_dwordx4 v[52:55], v204, s[4:7], s18 offen offset:1024 sc1
    buffer_load_dwordx4 v[56:59], v204, s[4:7], s18 offen offset:2048 sc1
    buffer_load_dwordx4 v[60:63], v204, s[4:7], s18 offen offset:3072 sc1
    buffer_load_dwordx4 v[64:67], v204, s[4:7], s19 offen offset:0 sc1
    buffer_load_dwordx4 v[68:71], v204, s[4:7], s19 offen offset:1024 sc1
    buffer_load_dwordx4 v[72:75], v204, s[4:7], s19 offen offset:2048 sc1
    buffer_load_dwordx4 v[76:79], v204, s[4:7], s19 offen offset:3072 sc1
    s_waitcnt vmcnt(0)
main_kernel_a_top:
    s_cmp_ge_u32 s25, 60
    s_cselect_b32 s38, 2, 1
    s_lshl_b32 s34, s38, 18
    s_lshl_b32 s35, s38, 16
    s_lshl_b32 s36, s38, 8
    s_lshl_b32 s37, s38, 2
    s_waitcnt vmcnt(19)
    v_mfma_f32_16x16x32_bf16 v[112:115], v[16:19], v[0:3], v[124:127]
    v_mfma_f32_16x16x32_bf16 v[116:119], v[32:35], v[0:3], v[128:131]
    s_waitcnt vmcnt(16)
    v_mfma_f32_16x16x32_bf16 v[112:115], v[20:23], v[4:7], v[112:115]
    v_mfma_f32_16x16x32_bf16 v[116:119], v[36:39], v[4:7], v[116:119]
    s_waitcnt vmcnt(13)
    v_mfma_f32_16x16x32_bf16 v[112:115], v[24:27], v[8:11], v[112:115]
    v_mfma_f32_16x16x32_bf16 v[116:119], v[40:43], v[8:11], v[116:119]
    s_waitcnt vmcnt(10)
    v_mfma_f32_16x16x32_bf16 v[112:115], v[28:31], v[12:15], v[112:115]
    v_mfma_f32_16x16x32_bf16 v[116:119], v[44:47], v[12:15], v[116:119]
    s_add_u32 s15, s15, s34
    s_add_u32 s16, s16, s34
    s_add_u32 s17, s17, s34
    s_add_u32 s18, s18, s34
    s_add_u32 s19, s19, s34
    s_add_u32 s23, s23, s37
    s_waitcnt vmcnt(9)
    v_cmp_eq_u32 vcc, 0, v211
    s_nop 0
    v_max3_f32 v202, v112, v113, v114
    s_nop 1
    v_max3_f32 v202, v202, v115, v116
    v_max3_f32 v202, v202, v117, v118
    v_max_f32 v202, v202, v119
    s_cmp_lg_u32 s39, 0
    s_cbranch_scc1 main_kernel_a_mq
    s_cmp_ge_u32 s25, 56
    s_cselect_b32 s32, 1, 2
    s_and_b32 s31, vcc_lo, s32
    s_cbranch_scc0 main_kernel_a_mp
main_kernel_a_pp:
    buffer_load_dword v200, v210, s[4:7], s33 offen sc1
    s_waitcnt vmcnt(0)
    v_cmp_eq_u32 vcc, 0, v200
    s_and_b32 s31, vcc_lo, s32
    s_cbranch_scc0 main_kernel_a_pok
    s_sleep 2
    s_sub_u32 s29, s29, 1
    s_cbranch_scc0 main_kernel_a_pp
    s_branch main_kernel_end
main_kernel_a_pok:
    s_cmp_eq_u32 s32, 2
    s_cbranch_scc1 main_kernel_a_mp
    s_sleep 2
    s_cmp_eq_u32 s25, 63
    s_cbranch_scc1 main_kernel_a_mp
    s_sleep 40
main_kernel_a_mp:
    s_mov_b32 s39, 0
    buffer_load_dwordx4 v[80:83], v205, s[4:7], s20 offen offset:0 sc1
    buffer_load_dwordx4 v[84:87], v205, s[4:7], s20 offen offset:512 sc1
    buffer_load_dwordx4 v[88:91], v205, s[4:7], s20 offen offset:1024 sc1
    buffer_load_dwordx4 v[92:95], v205, s[4:7], s20 offen offset:1536 sc1
    buffer_load_dwordx2 v[96:97], v206, s[4:7], s21 offen offset:0 sc1
    buffer_load_dwordx2 v[98:99], v206, s[4:7], s21 offen offset:256 sc1
    buffer_load_dwordx2 v[100:101], v206, s[4:7], s21 offen offset:512 sc1
    buffer_load_dwordx2 v[102:103], v206, s[4:7], s21 offen offset:768 sc1
    buffer_load_dwordx2 v[104:105], v206, s[4:7], s21 offen offset:1024 sc1
    buffer_load_dwordx2 v[106:107], v206, s[4:7], s21 offen offset:1280 sc1
    buffer_load_dwordx2 v[108:109], v206, s[4:7], s21 offen offset:1536 sc1
    buffer_load_dwordx2 v[110:111], v206, s[4:7], s21 offen offset:1792 sc1
    buffer_load_dword v212, v207, s[4:7], s23 offen offset:0 sc1
    buffer_load_dword v211, v210, s[4:7], s33 offen sc1
main_kernel_a_mq:
    s_waitcnt vmcnt(13)
    v_mfma_f32_16x16x32_bf16 v[120:123], v[80:83], v[0:3], v[132:135]
    v_max3_u32 v200, v80, v81, v82
    v_max_u32 v200, v200, v83
    s_waitcnt vmcnt(12)
    v_mfma_f32_16x16x32_bf16 v[120:123], v[84:87], v[4:7], v[120:123]
    v_max3_u32 v200, v200, v84, v85
    v_max3_u32 v200, v200, v86, v87
    s_waitcnt vmcnt(11)
    v_mfma_f32_16x16x32_bf16 v[120:123], v[88:91], v[8:11], v[120:123]
    v_max3_u32 v200, v200, v88, v89
    v_max3_u32 v200, v200, v90, v91
    s_waitcnt vmcnt(10)
    v_mfma_f32_16x16x32_bf16 v[120:123], v[92:95], v[12:15], v[120:123]
    v_max3_u32 v200, v200, v92, v93
    v_max3_u32 v200, v200, v94, v95
    s_waitcnt vmcnt(8)
    v_max3_u32 v200, v200, v96, v97
    v_max3_u32 v200, v200, v98, v99
    s_waitcnt vmcnt(6)
    v_max3_u32 v200, v200, v100, v101
    v_max3_u32 v200, v200, v102, v103
    s_waitcnt vmcnt(4)
    v_max3_u32 v200, v200, v104, v105
    v_max3_u32 v200, v200, v106, v107
    s_waitcnt vmcnt(2)
    v_max3_u32 v200, v200, v108, v109
    v_max3_u32 v200, v200, v110, v111
    v_cmp_eq_u32 vcc, -1, v200
    s_cbranch_vccz main_kernel_a_mok
    s_sleep 1
    s_sub_u32 s29, s29, 1
    s_cbranch_scc0 main_kernel_a_mp
    s_branch main_kernel_end
main_kernel_a_mok:
    v_mul_f32 v120, s26, v120
    v_mul_f32 v121, s26, v121
    v_mul_f32 v122, s26, v122
    v_mul_f32 v123, s26, v123
    v_max3_f32 v200, v202, v120, v121
    v_max3_f32 v200, v200, v122, v123
    v_mov_b32 v201, v200
    s_add_u32 s20, s20, s35
    s_add_u32 s21, s21, s35
    v_permlane32_swap_b32 v200, v201
    v_max_f32 v200, v200, v201
    v_mov_b32 v201, v200
    s_nop 1
    v_permlane16_swap_b32 v200, v201
    v_max_f32 v200, v200, v201
    v_sub_f32 v112, v112, v200
    v_sub_f32 v113, v113, v200
    v_sub_f32 v114, v114, v200
    v_sub_f32 v115, v115, v200
    v_sub_f32 v116, v116, v200
    v_sub_f32 v117, v117, v200
    v_sub_f32 v118, v118, v200
    v_sub_f32 v119, v119, v200
    v_sub_f32 v120, v120, v200
    v_sub_f32 v121, v121, v200
    v_sub_f32 v122, v122, v200
    v_sub_f32 v123, v123, v200
    v_exp_f32 v112, v112
    v_exp_f32 v113, v113
    v_exp_f32 v114, v114
    v_cvt_pk_bf16_f32 v136, v112, v113
    v_exp_f32 v115, v115
    v_exp_f32 v116, v116
    v_cvt_pk_bf16_f32 v137, v114, v115
    v_exp_f32 v117, v117
    v_exp_f32 v118, v118
    v_cvt_pk_bf16_f32 v138, v116, v117
    v_exp_f32 v119, v119
    v_exp_f32 v120, v120
    v_cvt_pk_bf16_f32 v139, v118, v119
    v_exp_f32 v121, v121
    v_exp_f32 v122, v122
    v_cvt_pk_bf16_f32 v140, v120, v121
    v_exp_f32 v123, v123
    s_nop 0
    v_cvt_pk_bf16_f32 v141, v122, v123
    s_waitcnt vmcnt(1)
    v_mfma_f32_16x16x32_bf16 v[144:147], v[180:183], v[136:139], 0
    v_mfma_f32_16x16x32_bf16 v[148:151], v[48:51], v[136:139], 0
    s_nop 0
    s_nop 0
    s_nop 0
    v_mfma_f32_16x16x16_bf16 v[144:147], v[180:181], v[140:141], v[144:147]
    v_mfma_f32_16x16x32_bf16 v[152:155], v[52:55], v[136:139], 0
    v_mfma_f32_16x16x32_bf16 v[156:159], v[56:59], v[136:139], 0
    v_mfma_f32_16x16x32_bf16 v[160:163], v[60:63], v[136:139], 0
    v_mfma_f32_16x16x32_bf16 v[164:167], v[64:67], v[136:139], 0
    v_mfma_f32_16x16x32_bf16 v[168:171], v[68:71], v[136:139], 0
    v_mfma_f32_16x16x32_bf16 v[172:175], v[72:75], v[136:139], 0
    v_mfma_f32_16x16x32_bf16 v[176:179], v[76:79], v[136:139], 0
    v_rcp_f32 v200, v144
    v_mfma_f32_16x16x16_bf16 v[148:151], v[96:97], v[140:141], v[148:151]
    v_mfma_f32_16x16x16_bf16 v[152:155], v[98:99], v[140:141], v[152:155]
    v_mfma_f32_16x16x16_bf16 v[156:159], v[100:101], v[140:141], v[156:159]
    v_mfma_f32_16x16x16_bf16 v[160:163], v[102:103], v[140:141], v[160:163]
    v_mfma_f32_16x16x16_bf16 v[164:167], v[104:105], v[140:141], v[164:167]
    v_mfma_f32_16x16x16_bf16 v[168:171], v[106:107], v[140:141], v[168:171]
    v_mfma_f32_16x16x16_bf16 v[172:175], v[108:109], v[140:141], v[172:175]
    v_mfma_f32_16x16x16_bf16 v[176:179], v[110:111], v[140:141], v[176:179]
    v_mov_b32 v201, v200
    s_cmp_lg_u32 s39, 0
    s_cbranch_scc1 main_kernel_a_nw
    s_waitcnt vmcnt(0)
main_kernel_a_nw:
    v_cmp_ne_u32 vcc, 0, v211
    s_and_b32 s39, vcc_lo, 4
    v_cmp_eq_u32 vcc, 0, v212
    v_pk_mul_f32 v[148:149], v[148:149], v[200:201]
    v_pk_mul_f32 v[150:151], v[150:151], v[200:201]
    v_pk_mul_f32 v[152:153], v[152:153], v[200:201]
    v_pk_mul_f32 v[154:155], v[154:155], v[200:201]
    v_cvt_pk_bf16_f32 v184, v148, v149
    v_cvt_pk_bf16_f32 v185, v150, v151
    v_cvt_pk_bf16_f32 v186, v152, v153
    v_cvt_pk_bf16_f32 v187, v154, v155
    buffer_store_dwordx4 v[184:187], v204, s[4:7], s22 offen offset:0 sc1
    v_pk_mul_f32 v[156:157], v[156:157], v[200:201]
    v_pk_mul_f32 v[158:159], v[158:159], v[200:201]
    v_pk_mul_f32 v[160:161], v[160:161], v[200:201]
    v_pk_mul_f32 v[162:163], v[162:163], v[200:201]
    v_cvt_pk_bf16_f32 v188, v156, v157
    v_cvt_pk_bf16_f32 v189, v158, v159
    v_cvt_pk_bf16_f32 v190, v160, v161
    v_cvt_pk_bf16_f32 v191, v162, v163
    buffer_store_dwordx4 v[188:191], v204, s[4:7], s22 offen offset:1024 sc1
    v_pk_mul_f32 v[164:165], v[164:165], v[200:201]
    v_pk_mul_f32 v[166:167], v[166:167], v[200:201]
    v_pk_mul_f32 v[168:169], v[168:169], v[200:201]
    v_pk_mul_f32 v[170:171], v[170:171], v[200:201]
    v_cvt_pk_bf16_f32 v192, v164, v165
    v_cvt_pk_bf16_f32 v193, v166, v167
    v_cvt_pk_bf16_f32 v194, v168, v169
    v_cvt_pk_bf16_f32 v195, v170, v171
    buffer_store_dwordx4 v[192:195], v204, s[4:7], s22 offen offset:2048 sc1
    s_nop 0
    v_pk_mul_f32 v[172:173], v[172:173], v[200:201]
    v_pk_mul_f32 v[174:175], v[174:175], v[200:201]
    v_pk_mul_f32 v[176:177], v[176:177], v[200:201]
    v_pk_mul_f32 v[178:179], v[178:179], v[200:201]
    v_cvt_pk_bf16_f32 v196, v172, v173
    v_cvt_pk_bf16_f32 v197, v174, v175
    v_cvt_pk_bf16_f32 v198, v176, v177
    v_cvt_pk_bf16_f32 v199, v178, v179
    buffer_store_dwordx4 v[196:199], v204, s[4:7], s22 offen offset:3072 sc1
    s_add_u32 s22, s22, s34
    s_add_u32 s33, s33, s37
    s_add_u32 s25, s25, s38
    s_cmp_ge_u32 s25, 64
    s_cbranch_scc1 main_kernel_a_last
    s_cbranch_vccnz main_kernel_a_slow
    s_cmp_gt_u32 s25, 60
    s_cbranch_scc1 main_kernel_a_slow
    s_cmp_ge_u32 s25, 56
    s_cselect_b32 s39, 0, s39
    s_cmp_lg_u32 s39, 0
    s_cbranch_scc1 main_kernel_a_pre
    buffer_load_dwordx4 v[0:3], v204, s[4:7], s15 offen offset:0 sc1
    buffer_load_dwordx4 v[16:19], v204, s[4:7], s16 offen offset:0 sc1
    buffer_load_dwordx4 v[32:35], v204, s[4:7], s17 offen offset:0 sc1
    buffer_load_dwordx4 v[4:7], v204, s[4:7], s15 offen offset:1024 sc1
    buffer_load_dwordx4 v[20:23], v204, s[4:7], s16 offen offset:1024 sc1
    buffer_load_dwordx4 v[36:39], v204, s[4:7], s17 offen offset:1024 sc1
    buffer_load_dwordx4 v[8:11], v204, s[4:7], s15 offen offset:2048 sc1
    buffer_load_dwordx4 v[24:27], v204, s[4:7], s16 offen offset:2048 sc1
    buffer_load_dwordx4 v[40:43], v204, s[4:7], s17 offen offset:2048 sc1
    buffer_load_dwordx4 v[12:15], v204, s[4:7], s15 offen offset:3072 sc1
    buffer_load_dwordx4 v[28:31], v204, s[4:7], s16 offen offset:3072 sc1
    buffer_load_dwordx4 v[44:47], v204, s[4:7], s17 offen offset:3072 sc1
    buffer_load_dword v211, v210, s[4:7], s33 offen sc1
    buffer_load_dwordx4 v[48:51], v204, s[4:7], s18 offen offset:0 sc1
    buffer_load_dwordx4 v[52:55], v204, s[4:7], s18 offen offset:1024 sc1
    buffer_load_dwordx4 v[56:59], v204, s[4:7], s18 offen offset:2048 sc1
    buffer_load_dwordx4 v[60:63], v204, s[4:7], s18 offen offset:3072 sc1
    buffer_load_dwordx4 v[64:67], v204, s[4:7], s19 offen offset:0 sc1
    buffer_load_dwordx4 v[68:71], v204, s[4:7], s19 offen offset:1024 sc1
    buffer_load_dwordx4 v[72:75], v204, s[4:7], s19 offen offset:2048 sc1
    buffer_load_dwordx4 v[76:79], v204, s[4:7], s19 offen offset:3072 sc1
    s_waitcnt vmcnt(21)
    s_mov_b64 exec, 1
    buffer_store_dword v208, v209, s[4:7], s24 offen sc1
    s_mov_b64 exec, -1
    s_add_u32 s24, s24, s36
    s_branch main_kernel_a_top
main_kernel_a_pre:
    buffer_load_dwordx4 v[80:83], v205, s[4:7], s20 offen offset:0 sc1
    buffer_load_dwordx4 v[84:87], v205, s[4:7], s20 offen offset:512 sc1
    buffer_load_dwordx4 v[88:91], v205, s[4:7], s20 offen offset:1024 sc1
    buffer_load_dwordx4 v[92:95], v205, s[4:7], s20 offen offset:1536 sc1
    buffer_load_dwordx2 v[96:97], v206, s[4:7], s21 offen offset:0 sc1
    buffer_load_dwordx2 v[98:99], v206, s[4:7], s21 offen offset:256 sc1
    buffer_load_dwordx2 v[100:101], v206, s[4:7], s21 offen offset:512 sc1
    buffer_load_dwordx2 v[102:103], v206, s[4:7], s21 offen offset:768 sc1
    buffer_load_dwordx2 v[104:105], v206, s[4:7], s21 offen offset:1024 sc1
    buffer_load_dwordx2 v[106:107], v206, s[4:7], s21 offen offset:1280 sc1
    buffer_load_dwordx2 v[108:109], v206, s[4:7], s21 offen offset:1536 sc1
    buffer_load_dwordx2 v[110:111], v206, s[4:7], s21 offen offset:1792 sc1
    buffer_load_dword v212, v207, s[4:7], s23 offen offset:4 sc1
    buffer_load_dwordx4 v[0:3], v204, s[4:7], s15 offen offset:0 sc1
    buffer_load_dwordx4 v[16:19], v204, s[4:7], s16 offen offset:0 sc1
    buffer_load_dwordx4 v[32:35], v204, s[4:7], s17 offen offset:0 sc1
    buffer_load_dwordx4 v[4:7], v204, s[4:7], s15 offen offset:1024 sc1
    buffer_load_dwordx4 v[20:23], v204, s[4:7], s16 offen offset:1024 sc1
    buffer_load_dwordx4 v[36:39], v204, s[4:7], s17 offen offset:1024 sc1
    buffer_load_dwordx4 v[8:11], v204, s[4:7], s15 offen offset:2048 sc1
    buffer_load_dwordx4 v[24:27], v204, s[4:7], s16 offen offset:2048 sc1
    buffer_load_dwordx4 v[40:43], v204, s[4:7], s17 offen offset:2048 sc1
    buffer_load_dwordx4 v[12:15], v204, s[4:7], s15 offen offset:3072 sc1
    buffer_load_dwordx4 v[28:31], v204, s[4:7], s16 offen offset:3072 sc1
    buffer_load_dwordx4 v[44:47], v204, s[4:7], s17 offen offset:3072 sc1
    buffer_load_dword v211, v210, s[4:7], s33 offen sc1
    buffer_load_dwordx4 v[48:51], v204, s[4:7], s18 offen offset:0 sc1
    buffer_load_dwordx4 v[52:55], v204, s[4:7], s18 offen offset:1024 sc1
    buffer_load_dwordx4 v[56:59], v204, s[4:7], s18 offen offset:2048 sc1
    buffer_load_dwordx4 v[60:63], v204, s[4:7], s18 offen offset:3072 sc1
    buffer_load_dwordx4 v[64:67], v204, s[4:7], s19 offen offset:0 sc1
    buffer_load_dwordx4 v[68:71], v204, s[4:7], s19 offen offset:1024 sc1
    buffer_load_dwordx4 v[72:75], v204, s[4:7], s19 offen offset:2048 sc1
    buffer_load_dwordx4 v[76:79], v204, s[4:7], s19 offen offset:3072 sc1
    s_waitcnt vmcnt(34)
    s_mov_b64 exec, 1
    buffer_store_dword v208, v209, s[4:7], s24 offen sc1
    s_mov_b64 exec, -1
    s_add_u32 s24, s24, s36
    s_branch main_kernel_a_top
main_kernel_a_slow:
    s_mov_b32 s39, 0
    s_waitcnt vmcnt(0)
    s_mov_b64 exec, 1
    buffer_store_dword v208, v209, s[4:7], s24 offen sc1
    s_mov_b64 exec, -1
    s_add_u32 s24, s24, s36
    s_branch main_kernel_a_fp
main_kernel_a_last:
    s_waitcnt vmcnt(0)
    s_mov_b64 exec, 1
    buffer_store_dword v208, v209, s[4:7], s24 offen sc1
    s_mov_b64 exec, -1
    s_add_u32 s24, s24, s36
    s_branch main_kernel_end
main_kernel_wo:
    s_mov_b32 s8, s46
    s_and_b32 s9, s47, 0xffff
    s_mov_b32 s10, 0x800000
    s_mov_b32 s11, 0x20000
    v_lshlrev_b32 v170, 4, v250
    s_lshr_b32 s23, s12, 2
    s_sub_u32 s21, s12, 5
    s_cselect_b32 s23, s23, s21
    s_cselect_b32 s18, 44, 63
    v_lshrrev_b32 v178, 2, v250
    v_and_b32 v179, 3, v250
    v_lshlrev_b32 v0, 11, v178
    v_lshl_add_u32 v0, v179, 4, v0
    s_lshl_b32 s19, s14, 15
    v_lshl_add_u32 v1, v178, 6, s19
    v_lshl_add_u32 v1, v179, 3, v1
    s_lshl_b32 s20, s14, 21
    s_lshl_b32 s21, s13, 6
    s_add_u32 s20, s20, s21
    s_add_u32 s21, s20, 0x0
    s_add_u32 m0, s19, 0
    s_nop 0
    buffer_load_dwordx4 v0, s[8:11], s21 offen lds
    s_add_u32 s21, s20, 0x8000
    s_add_u32 m0, s19, 1024
    s_nop 0
    buffer_load_dwordx4 v0, s[8:11], s21 offen lds
    s_add_u32 s21, s20, 0x10000
    s_add_u32 m0, s19, 2048
    s_nop 0
    buffer_load_dwordx4 v0, s[8:11], s21 offen lds
    s_add_u32 s21, s20, 0x18000
    s_add_u32 m0, s19, 3072
    s_nop 0
    buffer_load_dwordx4 v0, s[8:11], s21 offen lds
    s_add_u32 s21, s20, 0x20000
    s_add_u32 m0, s19, 4096
    s_nop 0
    buffer_load_dwordx4 v0, s[8:11], s21 offen lds
    s_add_u32 s21, s20, 0x28000
    s_add_u32 m0, s19, 5120
    s_nop 0
    buffer_load_dwordx4 v0, s[8:11], s21 offen lds
    s_add_u32 s21, s20, 0x30000
    s_add_u32 m0, s19, 6144
    s_nop 0
    buffer_load_dwordx4 v0, s[8:11], s21 offen lds
    s_add_u32 s21, s20, 0x38000
    s_add_u32 m0, s19, 7168
    s_nop 0
    buffer_load_dwordx4 v0, s[8:11], s21 offen lds
    s_add_u32 s21, s20, 0x40000
    s_add_u32 m0, s19, 8192
    s_nop 0
    buffer_load_dwordx4 v0, s[8:11], s21 offen lds
    s_add_u32 s21, s20, 0x48000
    s_add_u32 m0, s19, 9216
    s_nop 0
    buffer_load_dwordx4 v0, s[8:11], s21 offen lds
    s_add_u32 s21, s20, 0x50000
    s_add_u32 m0, s19, 10240
    s_nop 0
    buffer_load_dwordx4 v0, s[8:11], s21 offen lds
    s_add_u32 s21, s20, 0x58000
    s_add_u32 m0, s19, 11264
    s_nop 0
    buffer_load_dwordx4 v0, s[8:11], s21 offen lds
    s_add_u32 s21, s20, 0x60000
    s_add_u32 m0, s19, 12288
    s_nop 0
    buffer_load_dwordx4 v0, s[8:11], s21 offen lds
    s_add_u32 s21, s20, 0x68000
    s_add_u32 m0, s19, 13312
    s_nop 0
    buffer_load_dwordx4 v0, s[8:11], s21 offen lds
    s_add_u32 s21, s20, 0x70000
    s_add_u32 m0, s19, 14336
    s_nop 0
    buffer_load_dwordx4 v0, s[8:11], s21 offen lds
    s_add_u32 s21, s20, 0x78000
    s_add_u32 m0, s19, 15360
    s_nop 0
    buffer_load_dwordx4 v0, s[8:11], s21 offen lds
    s_add_u32 s21, s20, 0x80000
    s_add_u32 m0, s19, 16384
    s_nop 0
    buffer_load_dwordx4 v0, s[8:11], s21 offen lds
    s_add_u32 s21, s20, 0x88000
    s_add_u32 m0, s19, 17408
    s_nop 0
    buffer_load_dwordx4 v0, s[8:11], s21 offen lds
    s_add_u32 s21, s20, 0x90000
    s_add_u32 m0, s19, 18432
    s_nop 0
    buffer_load_dwordx4 v0, s[8:11], s21 offen lds
    s_add_u32 s21, s20, 0x98000
    s_add_u32 m0, s19, 19456
    s_nop 0
    buffer_load_dwordx4 v0, s[8:11], s21 offen lds
    s_add_u32 s21, s20, 0xa0000
    s_add_u32 m0, s19, 20480
    s_nop 0
    buffer_load_dwordx4 v0, s[8:11], s21 offen lds
    s_add_u32 s21, s20, 0xa8000
    s_add_u32 m0, s19, 21504
    s_nop 0
    buffer_load_dwordx4 v0, s[8:11], s21 offen lds
    s_add_u32 s21, s20, 0xb0000
    s_add_u32 m0, s19, 22528
    s_nop 0
    buffer_load_dwordx4 v0, s[8:11], s21 offen lds
    s_add_u32 s21, s20, 0xb8000
    s_add_u32 m0, s19, 23552
    s_nop 0
    buffer_load_dwordx4 v0, s[8:11], s21 offen lds
    s_add_u32 s21, s20, 0xc0000
    s_add_u32 m0, s19, 24576
    s_nop 0
    buffer_load_dwordx4 v0, s[8:11], s21 offen lds
    s_add_u32 s21, s20, 0xc8000
    s_add_u32 m0, s19, 25600
    s_nop 0
    buffer_load_dwordx4 v0, s[8:11], s21 offen lds
    s_add_u32 s21, s20, 0xd0000
    s_add_u32 m0, s19, 26624
    s_nop 0
    buffer_load_dwordx4 v0, s[8:11], s21 offen lds
    s_add_u32 s21, s20, 0xd8000
    s_add_u32 m0, s19, 27648
    s_nop 0
    buffer_load_dwordx4 v0, s[8:11], s21 offen lds
    s_add_u32 s21, s20, 0xe0000
    s_add_u32 m0, s19, 28672
    s_nop 0
    buffer_load_dwordx4 v0, s[8:11], s21 offen lds
    s_add_u32 s21, s20, 0xe8000
    s_add_u32 m0, s19, 29696
    s_nop 0
    buffer_load_dwordx4 v0, s[8:11], s21 offen lds
    s_add_u32 s21, s20, 0xf0000
    s_add_u32 m0, s19, 30720
    s_nop 0
    buffer_load_dwordx4 v0, s[8:11], s21 offen lds
    s_add_u32 s21, s20, 0xf8000
    s_add_u32 m0, s19, 31744
    s_nop 0
    buffer_load_dwordx4 v0, s[8:11], s21 offen lds
    v_and_b32 v178, 15, v250
    v_lshrrev_b32 v179, 4, v250
    v_lshlrev_b32 v175, 11, v178
    v_lshl_add_u32 v175, v179, 3, v175
    s_lshl_b32 s21, s14, 11
    s_add_u32 s21, s21, 131072
    v_add_u32 v176, s21, v170
    s_lshl_b32 s21, s14, 10
    s_add_u32 s21, s21, 131072
    v_add_u32 v177, s21, v170
    s_lshr_b32 s21, s13, 2
    s_lshl_b32 s21, s21, 8
    s_add_u32 s21, s21, 0x8412000
    s_lshl2_add_u32 s21, s18, s21
    v_mov_b32 v172, s21
    v_mov_b32 v173, 4
    s_lshl_b32 s21, s14, 4
    s_add_u32 s21, s21, s23
    s_lshl_b32 s21, s21, 2
    s_add_u32 s21, s21, 0x8400000
    s_lshl_b32 s22, s18, 8
    s_add_u32 s21, s21, s22
    s_mov_b64 exec, 0xff
    v_lshl_add_u32 v172, v250, 3, s21
    v_mov_b32 v173, 0x100
    s_mov_b64 exec, -1
    s_lshl_b32 s15, s14, 15
    s_lshl_b32 s21, s23, 17
    s_add_u32 s15, s15, s21
    s_add_u32 s15, s15, 0x3800000
    s_lshl_b32 s21, s18, 18
    s_add_u32 s15, s15, s21
    s_lshl_b32 s21, s23, 15
    s_lshl_b32 s22, s18, 16
    s_add_u32 s21, s21, s22
    s_and_b32 s22, s14, 1
    s_lshl_b32 s16, s13, 1
    s_add_u32 s16, s16, s22
    s_lshl_b32 s16, s16, 5
    s_add_u32 s16, s16, s21
    s_lshl_b32 s17, s13, 7
    s_add_u32 s17, s17, s22
    s_lshl_b32 s17, s17, 3
    s_add_u32 s17, s17, s21
    s_add_u32 s17, s17, 0x6400000
    s_waitcnt vmcnt(24)
    ds_read_b64_tr_b16 a[0:1], v1 offset:0
    ds_read_b64_tr_b16 a[2:3], v1 offset:1024
    ds_read_b64_tr_b16 a[128:129], v1 offset:32
    ds_read_b64_tr_b16 a[130:131], v1 offset:1056
    ds_read_b64_tr_b16 a[4:5], v1 offset:2048
    ds_read_b64_tr_b16 a[6:7], v1 offset:3072
    ds_read_b64_tr_b16 a[132:133], v1 offset:2080
    ds_read_b64_tr_b16 a[134:135], v1 offset:3104
    ds_read_b64_tr_b16 a[8:9], v1 offset:4096
    ds_read_b64_tr_b16 a[10:11], v1 offset:5120
    ds_read_b64_tr_b16 a[136:137], v1 offset:4128
    ds_read_b64_tr_b16 a[138:139], v1 offset:5152
    ds_read_b64_tr_b16 a[12:13], v1 offset:6144
    ds_read_b64_tr_b16 a[14:15], v1 offset:7168
    ds_read_b64_tr_b16 a[140:141], v1 offset:6176
    ds_read_b64_tr_b16 a[142:143], v1 offset:7200
    s_waitcnt lgkmcnt(0)
    s_add_u32 s21, s20, 0x100000
    s_add_u32 m0, s19, 0
    s_nop 0
    buffer_load_dwordx4 v0, s[8:11], s21 offen lds
    s_add_u32 s21, s20, 0x108000
    s_add_u32 m0, s19, 1024
    s_nop 0
    buffer_load_dwordx4 v0, s[8:11], s21 offen lds
    s_add_u32 s21, s20, 0x110000
    s_add_u32 m0, s19, 2048
    s_nop 0
    buffer_load_dwordx4 v0, s[8:11], s21 offen lds
    s_add_u32 s21, s20, 0x118000
    s_add_u32 m0, s19, 3072
    s_nop 0
    buffer_load_dwordx4 v0, s[8:11], s21 offen lds
    s_add_u32 s21, s20, 0x120000
    s_add_u32 m0, s19, 4096
    s_nop 0
    buffer_load_dwordx4 v0, s[8:11], s21 offen lds
    s_add_u32 s21, s20, 0x128000
    s_add_u32 m0, s19, 5120
    s_nop 0
    buffer_load_dwordx4 v0, s[8:11], s21 offen lds
    s_add_u32 s21, s20, 0x130000
    s_add_u32 m0, s19, 6144
    s_nop 0
    buffer_load_dwordx4 v0, s[8:11], s21 offen lds
    s_add_u32 s21, s20, 0x138000
    s_add_u32 m0, s19, 7168
    s_nop 0
    buffer_load_dwordx4 v0, s[8:11], s21 offen lds
    s_waitcnt vmcnt(24)
    ds_read_b64_tr_b16 a[16:17], v1 offset:8192
    ds_read_b64_tr_b16 a[18:19], v1 offset:9216
    ds_read_b64_tr_b16 a[144:145], v1 offset:8224
    ds_read_b64_tr_b16 a[146:147], v1 offset:9248
    ds_read_b64_tr_b16 a[20:21], v1 offset:10240
    ds_read_b64_tr_b16 a[22:23], v1 offset:11264
    ds_read_b64_tr_b16 a[148:149], v1 offset:10272
    ds_read_b64_tr_b16 a[150:151], v1 offset:11296
    ds_read_b64_tr_b16 a[24:25], v1 offset:12288
    ds_read_b64_tr_b16 a[26:27], v1 offset:13312
    ds_read_b64_tr_b16 a[152:153], v1 offset:12320
    ds_read_b64_tr_b16 a[154:155], v1 offset:13344
    ds_read_b64_tr_b16 a[28:29], v1 offset:14336
    ds_read_b64_tr_b16 a[30:31], v1 offset:15360
    ds_read_b64_tr_b16 a[156:157], v1 offset:14368
    ds_read_b64_tr_b16 a[158:159], v1 offset:15392
    s_waitcnt lgkmcnt(0)
    s_add_u32 s21, s20, 0x140000
    s_add_u32 m0, s19, 8192
    s_nop 0
    buffer_load_dwordx4 v0, s[8:11], s21 offen lds
    s_add_u32 s21, s20, 0x148000
    s_add_u32 m0, s19, 9216
    s_nop 0
    buffer_load_dwordx4 v0, s[8:11], s21 offen lds
    s_add_u32 s21, s20, 0x150000
    s_add_u32 m0, s19, 10240
    s_nop 0
    buffer_load_dwordx4 v0, s[8:11], s21 offen lds
    s_add_u32 s21, s20, 0x158000
    s_add_u32 m0, s19, 11264
    s_nop 0
    buffer_load_dwordx4 v0, s[8:11], s21 offen lds
    s_add_u32 s21, s20, 0x160000
    s_add_u32 m0, s19, 12288
    s_nop 0
    buffer_load_dwordx4 v0, s[8:11], s21 offen lds
    s_add_u32 s21, s20, 0x168000
    s_add_u32 m0, s19, 13312
    s_nop 0
    buffer_load_dwordx4 v0, s[8:11], s21 offen lds
    s_add_u32 s21, s20, 0x170000
    s_add_u32 m0, s19, 14336
    s_nop 0
    buffer_load_dwordx4 v0, s[8:11], s21 offen lds
    s_add_u32 s21, s20, 0x178000
    s_add_u32 m0, s19, 15360
    s_nop 0
    buffer_load_dwordx4 v0, s[8:11], s21 offen lds
    s_waitcnt vmcnt(24)
    ds_read_b64_tr_b16 a[32:33], v1 offset:16384
    ds_read_b64_tr_b16 a[34:35], v1 offset:17408
    ds_read_b64_tr_b16 a[160:161], v1 offset:16416
    ds_read_b64_tr_b16 a[162:163], v1 offset:17440
    ds_read_b64_tr_b16 a[36:37], v1 offset:18432
    ds_read_b64_tr_b16 a[38:39], v1 offset:19456
    ds_read_b64_tr_b16 a[164:165], v1 offset:18464
    ds_read_b64_tr_b16 a[166:167], v1 offset:19488
    ds_read_b64_tr_b16 a[40:41], v1 offset:20480
    ds_read_b64_tr_b16 a[42:43], v1 offset:21504
    ds_read_b64_tr_b16 a[168:169], v1 offset:20512
    ds_read_b64_tr_b16 a[170:171], v1 offset:21536
    ds_read_b64_tr_b16 a[44:45], v1 offset:22528
    ds_read_b64_tr_b16 a[46:47], v1 offset:23552
    ds_read_b64_tr_b16 a[172:173], v1 offset:22560
    ds_read_b64_tr_b16 a[174:175], v1 offset:23584
    s_waitcnt lgkmcnt(0)
    s_add_u32 s21, s20, 0x180000
    s_add_u32 m0, s19, 16384
    s_nop 0
    buffer_load_dwordx4 v0, s[8:11], s21 offen lds
    s_add_u32 s21, s20, 0x188000
    s_add_u32 m0, s19, 17408
    s_nop 0
    buffer_load_dwordx4 v0, s[8:11], s21 offen lds
    s_add_u32 s21, s20, 0x190000
    s_add_u32 m0, s19, 18432
    s_nop 0
    buffer_load_dwordx4 v0, s[8:11], s21 offen lds
    s_add_u32 s21, s20, 0x198000
    s_add_u32 m0, s19, 19456
    s_nop 0
    buffer_load_dwordx4 v0, s[8:11], s21 offen lds
    s_add_u32 s21, s20, 0x1a0000
    s_add_u32 m0, s19, 20480
    s_nop 0
    buffer_load_dwordx4 v0, s[8:11], s21 offen lds
    s_add_u32 s21, s20, 0x1a8000
    s_add_u32 m0, s19, 21504
    s_nop 0
    buffer_load_dwordx4 v0, s[8:11], s21 offen lds
    s_add_u32 s21, s20, 0x1b0000
    s_add_u32 m0, s19, 22528
    s_nop 0
    buffer_load_dwordx4 v0, s[8:11], s21 offen lds
    s_add_u32 s21, s20, 0x1b8000
    s_add_u32 m0, s19, 23552
    s_nop 0
    buffer_load_dwordx4 v0, s[8:11], s21 offen lds
    s_waitcnt vmcnt(24)
    ds_read_b64_tr_b16 a[48:49], v1 offset:24576
    ds_read_b64_tr_b16 a[50:51], v1 offset:25600
    ds_read_b64_tr_b16 a[176:177], v1 offset:24608
    ds_read_b64_tr_b16 a[178:179], v1 offset:25632
    ds_read_b64_tr_b16 a[52:53], v1 offset:26624
    ds_read_b64_tr_b16 a[54:55], v1 offset:27648
    ds_read_b64_tr_b16 a[180:181], v1 offset:26656
    ds_read_b64_tr_b16 a[182:183], v1 offset:27680
    ds_read_b64_tr_b16 a[56:57], v1 offset:28672
    ds_read_b64_tr_b16 a[58:59], v1 offset:29696
    ds_read_b64_tr_b16 a[184:185], v1 offset:28704
    ds_read_b64_tr_b16 a[186:187], v1 offset:29728
    ds_read_b64_tr_b16 a[60:61], v1 offset:30720
    ds_read_b64_tr_b16 a[62:63], v1 offset:31744
    ds_read_b64_tr_b16 a[188:189], v1 offset:30752
    ds_read_b64_tr_b16 a[190:191], v1 offset:31776
    s_waitcnt lgkmcnt(0)
    s_add_u32 s21, s20, 0x1c0000
    s_add_u32 m0, s19, 24576
    s_nop 0
    buffer_load_dwordx4 v0, s[8:11], s21 offen lds
    s_add_u32 s21, s20, 0x1c8000
    s_add_u32 m0, s19, 25600
    s_nop 0
    buffer_load_dwordx4 v0, s[8:11], s21 offen lds
    s_add_u32 s21, s20, 0x1d0000
    s_add_u32 m0, s19, 26624
    s_nop 0
    buffer_load_dwordx4 v0, s[8:11], s21 offen lds
    s_add_u32 s21, s20, 0x1d8000
    s_add_u32 m0, s19, 27648
    s_nop 0
    buffer_load_dwordx4 v0, s[8:11], s21 offen lds
    s_add_u32 s21, s20, 0x1e0000
    s_add_u32 m0, s19, 28672
    s_nop 0
    buffer_load_dwordx4 v0, s[8:11], s21 offen lds
    s_add_u32 s21, s20, 0x1e8000
    s_add_u32 m0, s19, 29696
    s_nop 0
    buffer_load_dwordx4 v0, s[8:11], s21 offen lds
    s_add_u32 s21, s20, 0x1f0000
    s_add_u32 m0, s19, 30720
    s_nop 0
    buffer_load_dwordx4 v0, s[8:11], s21 offen lds
    s_add_u32 s21, s20, 0x1f8000
    s_add_u32 m0, s19, 31744
    s_nop 0
    buffer_load_dwordx4 v0, s[8:11], s21 offen lds
    s_waitcnt vmcnt(24)
    ds_read_b64_tr_b16 a[64:65], v1 offset:0
    ds_read_b64_tr_b16 a[66:67], v1 offset:1024
    ds_read_b64_tr_b16 a[192:193], v1 offset:32
    ds_read_b64_tr_b16 a[194:195], v1 offset:1056
    ds_read_b64_tr_b16 a[68:69], v1 offset:2048
    ds_read_b64_tr_b16 a[70:71], v1 offset:3072
    ds_read_b64_tr_b16 a[196:197], v1 offset:2080
    ds_read_b64_tr_b16 a[198:199], v1 offset:3104
    ds_read_b64_tr_b16 a[72:73], v1 offset:4096
    ds_read_b64_tr_b16 a[74:75], v1 offset:5120
    ds_read_b64_tr_b16 a[200:201], v1 offset:4128
    ds_read_b64_tr_b16 a[202:203], v1 offset:5152
    ds_read_b64_tr_b16 a[76:77], v1 offset:6144
    ds_read_b64_tr_b16 a[78:79], v1 offset:7168
    ds_read_b64_tr_b16 a[204:205], v1 offset:6176
    ds_read_b64_tr_b16 a[206:207], v1 offset:7200
    s_waitcnt lgkmcnt(0)
    s_waitcnt vmcnt(16)
    ds_read_b64_tr_b16 a[80:81], v1 offset:8192
    ds_read_b64_tr_b16 a[82:83], v1 offset:9216
    ds_read_b64_tr_b16 a[208:209], v1 offset:8224
    ds_read_b64_tr_b16 a[210:211], v1 offset:9248
    ds_read_b64_tr_b16 a[84:85], v1 offset:10240
    ds_read_b64_tr_b16 a[86:87], v1 offset:11264
    ds_read_b64_tr_b16 a[212:213], v1 offset:10272
    ds_read_b64_tr_b16 a[214:215], v1 offset:11296
    ds_read_b64_tr_b16 a[88:89], v1 offset:12288
    ds_read_b64_tr_b16 a[90:91], v1 offset:13312
    ds_read_b64_tr_b16 a[216:217], v1 offset:12320
    ds_read_b64_tr_b16 a[218:219], v1 offset:13344
    ds_read_b64_tr_b16 a[92:93], v1 offset:14336
    ds_read_b64_tr_b16 a[94:95], v1 offset:15360
    ds_read_b64_tr_b16 a[220:221], v1 offset:14368
    ds_read_b64_tr_b16 a[222:223], v1 offset:15392
    s_waitcnt lgkmcnt(0)
    s_waitcnt vmcnt(8)
    ds_read_b64_tr_b16 a[96:97], v1 offset:16384
    ds_read_b64_tr_b16 a[98:99], v1 offset:17408
    ds_read_b64_tr_b16 a[224:225], v1 offset:16416
    ds_read_b64_tr_b16 a[226:227], v1 offset:17440
    ds_read_b64_tr_b16 a[100:101], v1 offset:18432
    ds_read_b64_tr_b16 a[102:103], v1 offset:19456
    ds_read_b64_tr_b16 a[228:229], v1 offset:18464
    ds_read_b64_tr_b16 a[230:231], v1 offset:19488
    ds_read_b64_tr_b16 a[104:105], v1 offset:20480
    ds_read_b64_tr_b16 a[106:107], v1 offset:21504
    ds_read_b64_tr_b16 a[232:233], v1 offset:20512
    ds_read_b64_tr_b16 a[234:235], v1 offset:21536
    ds_read_b64_tr_b16 a[108:109], v1 offset:22528
    ds_read_b64_tr_b16 a[110:111], v1 offset:23552
    ds_read_b64_tr_b16 a[236:237], v1 offset:22560
    ds_read_b64_tr_b16 a[238:239], v1 offset:23584
    s_waitcnt lgkmcnt(0)
    s_waitcnt vmcnt(0)
    ds_read_b64_tr_b16 a[112:113], v1 offset:24576
    ds_read_b64_tr_b16 a[114:115], v1 offset:25600
    ds_read_b64_tr_b16 a[240:241], v1 offset:24608
    ds_read_b64_tr_b16 a[242:243], v1 offset:25632
    ds_read_b64_tr_b16 a[116:117], v1 offset:26624
    ds_read_b64_tr_b16 a[118:119], v1 offset:27648
    ds_read_b64_tr_b16 a[244:245], v1 offset:26656
    ds_read_b64_tr_b16 a[246:247], v1 offset:27680
    ds_read_b64_tr_b16 a[120:121], v1 offset:28672
    ds_read_b64_tr_b16 a[122:123], v1 offset:29696
    ds_read_b64_tr_b16 a[248:249], v1 offset:28704
    ds_read_b64_tr_b16 a[250:251], v1 offset:29728
    ds_read_b64_tr_b16 a[124:125], v1 offset:30720
    ds_read_b64_tr_b16 a[126:127], v1 offset:31744
    ds_read_b64_tr_b16 a[252:253], v1 offset:30752
    ds_read_b64_tr_b16 a[254:255], v1 offset:31776
    s_waitcnt lgkmcnt(0)
    s_cmp_lt_u32 s12, 5
    s_cbranch_scc1 main_kernel_o_top
    v_mul_u32_u24 v178, 2, v173
    v_sub_u32 v171, v172, v178
main_kernel_o_gp:
    buffer_load_dword v174, v171, s[4:7], 0 offen sc1
    s_waitcnt vmcnt(0)
    v_cmp_eq_u32 vcc, 0, v174
    s_cbranch_vccz main_kernel_o_top
    s_sleep 32
    s_sub_u32 s29, s29, 1
    s_cbranch_scc0 main_kernel_o_gp
    s_branch main_kernel_end
main_kernel_o_top:
    buffer_load_dword v174, v172, s[4:7], 0 offen sc1
    s_waitcnt vmcnt(0)
    v_cmp_eq_u32 vcc, 0, v174
    s_cbranch_vccz main_kernel_o_go
    s_sleep 1
    s_sub_u32 s29, s29, 1
    s_cbranch_scc0 main_kernel_o_top
    s_branch main_kernel_end
main_kernel_o_go:
    buffer_load_dwordx4 v[0:3], v170, s[4:7], s15 offen offset:0 sc1
    buffer_load_dwordx4 v[4:7], v170, s[4:7], s15 offen offset:1024 sc1
    buffer_load_dwordx4 v[8:11], v170, s[4:7], s15 offen offset:2048 sc1
    buffer_load_dwordx4 v[12:15], v170, s[4:7], s15 offen offset:3072 sc1
    s_add_u32 s15, s15, 4096
    buffer_load_dwordx4 v[16:19], v170, s[4:7], s15 offen offset:0 sc1
    buffer_load_dwordx4 v[20:23], v170, s[4:7], s15 offen offset:1024 sc1
    buffer_load_dwordx4 v[24:27], v170, s[4:7], s15 offen offset:2048 sc1
    buffer_load_dwordx4 v[28:31], v170, s[4:7], s15 offen offset:3072 sc1
    s_add_u32 s15, s15, 4096
    buffer_load_dwordx4 v[32:35], v170, s[4:7], s15 offen offset:0 sc1
    buffer_load_dwordx4 v[36:39], v170, s[4:7], s15 offen offset:1024 sc1
    buffer_load_dwordx4 v[40:43], v170, s[4:7], s15 offen offset:2048 sc1
    buffer_load_dwordx4 v[44:47], v170, s[4:7], s15 offen offset:3072 sc1
    s_add_u32 s15, s15, 4096
    buffer_load_dwordx4 v[48:51], v170, s[4:7], s15 offen offset:0 sc1
    buffer_load_dwordx4 v[52:55], v170, s[4:7], s15 offen offset:1024 sc1
    buffer_load_dwordx4 v[56:59], v170, s[4:7], s15 offen offset:2048 sc1
    buffer_load_dwordx4 v[60:63], v170, s[4:7], s15 offen offset:3072 sc1
    s_add_u32 s15, s15, 4096
    buffer_load_dwordx2 v[160:161], v175, s[96:99], s16 offen
    buffer_load_dwordx2 v[162:163], v170, s[4:7], s17 offen sc1
    buffer_load_dwordx4 v[64:67], v170, s[4:7], s15 offen offset:0 sc1
    buffer_load_dwordx4 v[68:71], v170, s[4:7], s15 offen offset:1024 sc1
    buffer_load_dwordx4 v[72:75], v170, s[4:7], s15 offen offset:2048 sc1
    buffer_load_dwordx4 v[76:79], v170, s[4:7], s15 offen offset:3072 sc1
    s_add_u32 s15, s15, 4096
    buffer_load_dwordx4 v[80:83], v170, s[4:7], s15 offen offset:0 sc1
    buffer_load_dwordx4 v[84:87], v170, s[4:7], s15 offen offset:1024 sc1
    buffer_load_dwordx4 v[88:91], v170, s[4:7], s15 offen offset:2048 sc1
    buffer_load_dwordx4 v[92:95], v170, s[4:7], s15 offen offset:3072 sc1
    s_add_u32 s15, s15, 4096
    buffer_load_dwordx4 v[96:99], v170, s[4:7], s15 offen offset:0 sc1
    buffer_load_dwordx4 v[100:103], v170, s[4:7], s15 offen offset:1024 sc1
    buffer_load_dwordx4 v[104:107], v170, s[4:7], s15 offen offset:2048 sc1
    buffer_load_dwordx4 v[108:111], v170, s[4:7], s15 offen offset:3072 sc1
    s_add_u32 s15, s15, 4096
    buffer_load_dwordx4 v[112:115], v170, s[4:7], s15 offen offset:0 sc1
    buffer_load_dwordx4 v[116:119], v170, s[4:7], s15 offen offset:1024 sc1
    buffer_load_dwordx4 v[120:123], v170, s[4:7], s15 offen offset:2048 sc1
    buffer_load_dwordx4 v[124:127], v170, s[4:7], s15 offen offset:3072 sc1
    s_add_u32 s15, s15, 233472
    v_add_u32 v172, v172, v173
    s_add_u32 s17, s17, 65536
    s_add_u32 s18, s18, 1
    s_waitcnt vmcnt(33)
    v_mfma_f32_16x16x32_bf16 v[128:131], a[0:3], v[0:3], 0
    v_mfma_f32_16x16x32_bf16 v[132:135], a[128:131], v[0:3], 0
    s_waitcnt vmcnt(32)
    v_mfma_f32_16x16x32_bf16 v[128:131], a[4:7], v[4:7], v[128:131]
    v_mfma_f32_16x16x32_bf16 v[132:135], a[132:135], v[4:7], v[132:135]
    s_waitcnt vmcnt(31)
    v_mfma_f32_16x16x32_bf16 v[128:131], a[8:11], v[8:11], v[128:131]
    v_mfma_f32_16x16x32_bf16 v[132:135], a[136:139], v[8:11], v[132:135]
    s_waitcnt vmcnt(30)
    v_mfma_f32_16x16x32_bf16 v[128:131], a[12:15], v[12:15], v[128:131]
    v_mfma_f32_16x16x32_bf16 v[132:135], a[140:143], v[12:15], v[132:135]
    s_waitcnt vmcnt(29)
    v_mfma_f32_16x16x32_bf16 v[128:131], a[16:19], v[16:19], v[128:131]
    v_mfma_f32_16x16x32_bf16 v[132:135], a[144:147], v[16:19], v[132:135]
    s_waitcnt vmcnt(28)
    v_mfma_f32_16x16x32_bf16 v[128:131], a[20:23], v[20:23], v[128:131]
    v_mfma_f32_16x16x32_bf16 v[132:135], a[148:151], v[20:23], v[132:135]
    s_waitcnt vmcnt(27)
    v_mfma_f32_16x16x32_bf16 v[128:131], a[24:27], v[24:27], v[128:131]
    v_mfma_f32_16x16x32_bf16 v[132:135], a[152:155], v[24:27], v[132:135]
    s_waitcnt vmcnt(26)
    v_mfma_f32_16x16x32_bf16 v[128:131], a[28:31], v[28:31], v[128:131]
    v_mfma_f32_16x16x32_bf16 v[132:135], a[156:159], v[28:31], v[132:135]
    s_waitcnt vmcnt(25)
    v_mfma_f32_16x16x32_bf16 v[128:131], a[32:35], v[32:35], v[128:131]
    v_mfma_f32_16x16x32_bf16 v[132:135], a[160:163], v[32:35], v[132:135]
    s_waitcnt vmcnt(24)
    v_mfma_f32_16x16x32_bf16 v[128:131], a[36:39], v[36:39], v[128:131]
    v_mfma_f32_16x16x32_bf16 v[132:135], a[164:167], v[36:39], v[132:135]
    s_waitcnt vmcnt(23)
    v_mfma_f32_16x16x32_bf16 v[128:131], a[40:43], v[40:43], v[128:131]
    v_mfma_f32_16x16x32_bf16 v[132:135], a[168:171], v[40:43], v[132:135]
    s_waitcnt vmcnt(22)
    v_mfma_f32_16x16x32_bf16 v[128:131], a[44:47], v[44:47], v[128:131]
    v_mfma_f32_16x16x32_bf16 v[132:135], a[172:175], v[44:47], v[132:135]
    s_waitcnt vmcnt(21)
    v_mfma_f32_16x16x32_bf16 v[128:131], a[48:51], v[48:51], v[128:131]
    v_mfma_f32_16x16x32_bf16 v[132:135], a[176:179], v[48:51], v[132:135]
    s_waitcnt vmcnt(20)
    v_mfma_f32_16x16x32_bf16 v[128:131], a[52:55], v[52:55], v[128:131]
    v_mfma_f32_16x16x32_bf16 v[132:135], a[180:183], v[52:55], v[132:135]
    s_waitcnt vmcnt(19)
    v_mfma_f32_16x16x32_bf16 v[128:131], a[56:59], v[56:59], v[128:131]
    v_mfma_f32_16x16x32_bf16 v[132:135], a[184:187], v[56:59], v[132:135]
    s_waitcnt vmcnt(18)
    v_mfma_f32_16x16x32_bf16 v[128:131], a[60:63], v[60:63], v[128:131]
    v_mfma_f32_16x16x32_bf16 v[132:135], a[188:191], v[60:63], v[132:135]
    s_waitcnt vmcnt(15)
    v_mfma_f32_16x16x32_bf16 v[128:131], a[64:67], v[64:67], v[128:131]
    v_mfma_f32_16x16x32_bf16 v[132:135], a[192:195], v[64:67], v[132:135]
    s_waitcnt vmcnt(14)
    v_mfma_f32_16x16x32_bf16 v[128:131], a[68:71], v[68:71], v[128:131]
    v_mfma_f32_16x16x32_bf16 v[132:135], a[196:199], v[68:71], v[132:135]
    s_waitcnt vmcnt(13)
    v_mfma_f32_16x16x32_bf16 v[128:131], a[72:75], v[72:75], v[128:131]
    v_mfma_f32_16x16x32_bf16 v[132:135], a[200:203], v[72:75], v[132:135]
    s_waitcnt vmcnt(12)
    v_mfma_f32_16x16x32_bf16 v[128:131], a[76:79], v[76:79], v[128:131]
    v_mfma_f32_16x16x32_bf16 v[132:135], a[204:207], v[76:79], v[132:135]
    s_waitcnt vmcnt(11)
    v_mfma_f32_16x16x32_bf16 v[128:131], a[80:83], v[80:83], v[128:131]
    v_mfma_f32_16x16x32_bf16 v[132:135], a[208:211], v[80:83], v[132:135]
    v_lshlrev_b32 v164, 16, v160
    v_and_b32 v165, 0xffff0000, v160
    v_lshlrev_b32 v166, 16, v161
    v_and_b32 v167, 0xffff0000, v161
    v_lshlrev_b32 v160, 16, v162
    v_and_b32 v161, 0xffff0000, v162
    v_lshlrev_b32 v162, 16, v163
    v_and_b32 v163, 0xffff0000, v163
    s_waitcnt vmcnt(10)
    v_mfma_f32_16x16x32_bf16 v[128:131], a[84:87], v[84:87], v[128:131]
    v_mfma_f32_16x16x32_bf16 v[132:135], a[212:215], v[84:87], v[132:135]
    s_waitcnt vmcnt(9)
    v_mfma_f32_16x16x32_bf16 v[128:131], a[88:91], v[88:91], v[128:131]
    v_mfma_f32_16x16x32_bf16 v[132:135], a[216:219], v[88:91], v[132:135]
    s_waitcnt vmcnt(8)
    v_mfma_f32_16x16x32_bf16 v[128:131], a[92:95], v[92:95], v[128:131]
    v_mfma_f32_16x16x32_bf16 v[132:135], a[220:223], v[92:95], v[132:135]
    s_waitcnt vmcnt(7)
    v_mfma_f32_16x16x32_bf16 v[128:131], a[96:99], v[96:99], v[128:131]
    v_mfma_f32_16x16x32_bf16 v[132:135], a[224:227], v[96:99], v[132:135]
    s_waitcnt vmcnt(6)
    v_mfma_f32_16x16x32_bf16 v[128:131], a[100:103], v[100:103], v[128:131]
    v_mfma_f32_16x16x32_bf16 v[132:135], a[228:231], v[100:103], v[132:135]
    s_waitcnt vmcnt(5)
    v_mfma_f32_16x16x32_bf16 v[128:131], a[104:107], v[104:107], v[128:131]
    v_mfma_f32_16x16x32_bf16 v[132:135], a[232:235], v[104:107], v[132:135]
    s_waitcnt vmcnt(4)
    v_mfma_f32_16x16x32_bf16 v[128:131], a[108:111], v[108:111], v[128:131]
    v_mfma_f32_16x16x32_bf16 v[132:135], a[236:239], v[108:111], v[132:135]
    s_waitcnt vmcnt(3)
    v_mfma_f32_16x16x32_bf16 v[128:131], a[112:115], v[112:115], v[128:131]
    v_mfma_f32_16x16x32_bf16 v[132:135], a[240:243], v[112:115], v[132:135]
    s_waitcnt vmcnt(2)
    v_mfma_f32_16x16x32_bf16 v[128:131], a[116:119], v[116:119], v[128:131]
    v_mfma_f32_16x16x32_bf16 v[132:135], a[244:247], v[116:119], v[132:135]
    s_waitcnt vmcnt(1)
    v_mfma_f32_16x16x32_bf16 v[128:131], a[120:123], v[120:123], v[128:131]
    v_mfma_f32_16x16x32_bf16 v[132:135], a[248:251], v[120:123], v[132:135]
    s_waitcnt vmcnt(0)
    v_mfma_f32_16x16x32_bf16 v[128:131], a[124:127], v[124:127], v[128:131]
    v_mfma_f32_16x16x32_bf16 v[132:135], a[252:255], v[124:127], v[132:135]
    s_cmp_ge_u32 s14, 2
    s_nop 5
    ds_write_b128 v176, v[128:131] offset:0
    ds_write_b128 v176, v[132:135] offset:1024
    v_xor_b32 v176, 0x4000, v176
    s_waitcnt lgkmcnt(0)
    s_barrier
    s_cbranch_scc1 main_kernel_o_nx
    ds_read_b128 v[144:147], v177 offset:0
    ds_read_b128 v[148:151], v177 offset:2048
    ds_read_b128 v[152:155], v177 offset:4096
    ds_read_b128 v[156:159], v177 offset:6144
    v_xor_b32 v177, 0x4000, v177
    s_waitcnt lgkmcnt(2)
    v_pk_add_f32 v[144:145], v[144:145], v[148:149]
    v_pk_add_f32 v[146:147], v[146:147], v[150:151]
    s_waitcnt lgkmcnt(0)
    v_pk_add_f32 v[152:153], v[152:153], v[156:157]
    v_pk_add_f32 v[154:155], v[154:155], v[158:159]
    v_pk_add_f32 v[144:145], v[144:145], v[152:153]
    v_pk_add_f32 v[146:147], v[146:147], v[154:155]
    v_pk_fma_f32 v[144:145], v[144:145], v[160:161], v[164:165]
    v_pk_fma_f32 v[146:147], v[146:147], v[162:163], v[166:167]
    v_cvt_pk_bf16_f32 v148, v144, v145
    v_cvt_pk_bf16_f32 v149, v146, v147
    buffer_store_dwordx2 v[148:149], v175, s[92:95], s16 offen
main_kernel_o_nx:
    s_add_u32 s16, s16, 65536
    s_cmp_le_u32 s18, 62
    s_cbranch_scc1 main_kernel_o_top
    v_add_u32 v172, v172, v173
    s_add_u32 s17, s17, 65536
    s_add_u32 s16, s16, 65536
    s_add_u32 s15, s15, 262144
    s_add_u32 s18, s18, 1
    s_cmp_lt_u32 s18, 64
    s_cbranch_scc1 main_kernel_o_top
    s_branch main_kernel_end
main_kernel_end2:
    s_endpgm
main_kernel_worker:
    v_lshlrev_b32 v251, 4, v250
    v_mov_b32 v240, 0xc0135761
    v_mov_b32 v241, 0xc0135761
    v_mov_b32 v242, 0xbdd2d3e8
    v_mov_b32 v243, 0xbdd2d3e8
    v_mov_b32 v244, 0x3f800000
    v_mov_b32 v245, 0x3f800000
    v_mov_b32 v246, 0xbfb8aa3b
    v_mov_b32 v247, 0xbfb8aa3b
    s_lshr_b32 s37, s14, 1
    s_and_b32 s38, s14, 1
    v_mov_b32 v252, 0
    s_mov_b32 s8, s40
    s_and_b32 s9, s41, 0xffff
    s_mov_b32 s10, 0x0
    s_mov_b32 s11, 0x20000
    s_mov_b32 s57, 0
    s_mov_b32 s56, 0x7f000000
    v_mov_b32 v249, 0
main_kernel_w_next:
    s_cmp_lg_u32 s14, 0
    s_cbranch_scc1 main_kernel_w_bar
main_kernel_w_try:
    s_lshl_b32 s32, s27, 8
    s_add_u32 s32, s32, 0x841e000
    v_mov_b32 v254, 1
    s_mov_b64 exec, 1
    buffer_atomic_add v254, off, s[4:7], s32 sc0 sc1
    s_mov_b64 exec, -1
    s_waitcnt vmcnt(0)
    v_readfirstlane_b32 s28, v254
    s_cmp_eq_u32 s57, 0
    s_cbranch_scc1 main_kernel_w_fl1
    s_waitcnt vmcnt(0)
    s_barrier
    v_mov_b32 v4, 1
    v_mov_b32 v5, 1
    v_mov_b32 v6, 1
    v_mov_b32 v7, 1
    s_bfm_b64 exec, s57, 0
    buffer_store_dwordx4 v[4:7], v249, s[4:7], s56 offen sc1
    s_mov_b64 exec, -1
    s_mov_b32 s57, 0
main_kernel_w_fl1:
    s_nop 3
main_kernel_w_have:
    s_cmp_lg_u32 s27, 0
    s_cbranch_scc1 main_kernel_w_q1
    s_cmp_lt_u32 s28, 96
    s_cbranch_scc0 main_kernel_w_d_1
    s_cmp_lt_u32 s28, 32
    s_cbranch_scc0 main_kernel_w_d_2
    s_cmp_lt_u32 s28, 16
    s_cbranch_scc0 main_kernel_w_d_3
    s_cmp_lt_u32 s28, 8
    s_cbranch_scc0 main_kernel_w_d_4
    s_mov_b32 s36, 0x4045000
    s_branch main_kernel_w_dec
main_kernel_w_d_4:
    s_mov_b32 s36, 0x64091008
    s_branch main_kernel_w_dec
main_kernel_w_d_3:
    s_cmp_lt_u32 s28, 24
    s_cbranch_scc0 main_kernel_w_d_5
    s_mov_b32 s36, 0x42069010
    s_branch main_kernel_w_dec
main_kernel_w_d_5:
    s_mov_b32 s36, 0x4005818
    s_branch main_kernel_w_dec
main_kernel_w_d_2:
    s_cmp_lt_u32 s28, 56
    s_cbranch_scc0 main_kernel_w_d_6
    s_cmp_lt_u32 s28, 48
    s_cbranch_scc0 main_kernel_w_d_7
    s_mov_b32 s36, 0x48189820
    s_branch main_kernel_w_dec
main_kernel_w_d_7:
    s_mov_b32 s36, 0x67091030
    s_branch main_kernel_w_dec
main_kernel_w_d_6:
    s_cmp_lt_u32 s28, 64
    s_cbranch_scc0 main_kernel_w_d_8
    s_mov_b32 s36, 0x67090838
    s_branch main_kernel_w_dec
main_kernel_w_d_8:
    s_cmp_lt_u32 s28, 80
    s_cbranch_scc0 main_kernel_w_d_9
    s_mov_b32 s36, 0x4102040
    s_branch main_kernel_w_dec
main_kernel_w_d_9:
    s_mov_b32 s36, 0x4142050
    s_branch main_kernel_w_dec
main_kernel_w_d_1:
    s_cmp_lt_u32 s28, 164
    s_cbranch_scc0 main_kernel_w_d_10
    s_cmp_lt_u32 s28, 120
    s_cbranch_scc0 main_kernel_w_d_11
    s_cmp_lt_u32 s28, 112
    s_cbranch_scc0 main_kernel_w_d_12
    s_mov_b32 s36, 0x4182060
    s_branch main_kernel_w_dec
main_kernel_w_d_12:
    s_mov_b32 s36, 0x67090070
    s_branch main_kernel_w_dec
main_kernel_w_d_11:
    s_cmp_lt_u32 s28, 136
    s_cbranch_scc0 main_kernel_w_d_13
    s_mov_b32 s36, 0x8082878
    s_branch main_kernel_w_dec
main_kernel_w_d_13:
    s_cmp_lt_u32 s28, 152
    s_cbranch_scc0 main_kernel_w_d_14
    s_mov_b32 s36, 0x49088088
    s_branch main_kernel_w_dec
main_kernel_w_d_14:
    s_mov_b32 s36, 0x4ad0b098
    s_branch main_kernel_w_dec
main_kernel_w_d_10:
    s_cmp_lt_u32 s28, 192
    s_cbranch_scc0 main_kernel_w_d_15
    s_cmp_lt_u32 s28, 176
    s_cbranch_scc0 main_kernel_w_d_16
    s_mov_b32 s36, 0x4a08b0a4
    s_branch main_kernel_w_dec
main_kernel_w_d_16:
    s_mov_b32 s36, 0x4810b0b0
    s_branch main_kernel_w_dec
main_kernel_w_d_15:
    s_cmp_lt_u32 s28, 208
    s_cbranch_scc0 main_kernel_w_d_17
    s_mov_b32 s36, 0x89038c0
    s_branch main_kernel_w_dec
main_kernel_w_d_17:
    s_cmp_lt_u32 s28, 224
    s_cbranch_scc0 main_kernel_w_d_18
    s_mov_b32 s36, 0x81038d0
    s_branch main_kernel_w_dec
main_kernel_w_d_18:
    s_mov_b32 s36, 0xffffffff
    s_branch main_kernel_w_dec
main_kernel_w_q1:
    s_cmp_lg_u32 s27, 1
    s_cbranch_scc1 main_kernel_w_q2
    s_cmp_lt_u32 s28, 68
    s_cbranch_scc0 main_kernel_w_d_19
    s_cmp_lt_u32 s28, 28
    s_cbranch_scc0 main_kernel_w_d_20
    s_cmp_lt_u32 s28, 4
    s_cbranch_scc0 main_kernel_w_d_21
    s_mov_b32 s36, 0x25000
    s_branch main_kernel_w_dec
main_kernel_w_d_21:
    s_cmp_lt_u32 s28, 20
    s_cbranch_scc0 main_kernel_w_d_22
    s_mov_b32 s36, 0x4a088804
    s_branch main_kernel_w_dec
main_kernel_w_d_22:
    s_mov_b32 s36, 0x64090014
    s_branch main_kernel_w_dec
main_kernel_w_d_20:
    s_cmp_lt_u32 s28, 44
    s_cbranch_scc0 main_kernel_w_d_23
    s_mov_b32 s36, 0x4b10881c
    s_branch main_kernel_w_dec
main_kernel_w_d_23:
    s_cmp_lt_u32 s28, 60
    s_cbranch_scc0 main_kernel_w_d_24
    s_mov_b32 s36, 0x41c202c
    s_branch main_kernel_w_dec
main_kernel_w_d_24:
    s_mov_b32 s36, 0x6411083c
    s_branch main_kernel_w_dec
main_kernel_w_d_19:
    s_cmp_lt_u32 s28, 104
    s_cbranch_scc0 main_kernel_w_d_25
    s_cmp_lt_u32 s28, 76
    s_cbranch_scc0 main_kernel_w_d_26
    s_mov_b32 s36, 0x66111044
    s_branch main_kernel_w_dec
main_kernel_w_d_26:
    s_cmp_lt_u32 s28, 88
    s_cbranch_scc0 main_kernel_w_d_27
    s_mov_b32 s36, 0x4ad8b04c
    s_branch main_kernel_w_dec
main_kernel_w_d_27:
    s_mov_b32 s36, 0x8183858
    s_branch main_kernel_w_dec
main_kernel_w_d_25:
    s_cmp_lt_u32 s28, 112
    s_cbranch_scc0 main_kernel_w_d_28
    s_mov_b32 s36, 0x124068
    s_branch main_kernel_w_dec
main_kernel_w_d_28:
    s_cmp_lt_u32 s28, 120
    s_cbranch_scc0 main_kernel_w_d_29
    s_mov_b32 s36, 0x144070
    s_branch main_kernel_w_dec
main_kernel_w_d_29:
    s_mov_b32 s36, 0xffffffff
    s_branch main_kernel_w_dec
main_kernel_w_q2:
    s_cmp_lg_u32 s27, 2
    s_cbranch_scc1 main_kernel_w_q3
    s_cmp_lt_u32 s28, 112
    s_cbranch_scc0 main_kernel_w_d_30
    s_cmp_lt_u32 s28, 48
    s_cbranch_scc0 main_kernel_w_d_31
    s_cmp_lt_u32 s28, 16
    s_cbranch_scc0 main_kernel_w_d_32
    s_cmp_lt_u32 s28, 8
    s_cbranch_scc0 main_kernel_w_d_33
    s_mov_b32 s36, 0x800
    s_branch main_kernel_w_dec
main_kernel_w_d_33:
    s_mov_b32 s36, 0x1008
    s_branch main_kernel_w_dec
main_kernel_w_d_32:
    s_cmp_lt_u32 s28, 24
    s_cbranch_scc0 main_kernel_w_d_34
    s_mov_b32 s36, 0x44028810
    s_branch main_kernel_w_dec
main_kernel_w_d_34:
    s_cmp_lt_u32 s28, 32
    s_cbranch_scc0 main_kernel_w_d_35
    s_mov_b32 s36, 0x44029018
    s_branch main_kernel_w_dec
main_kernel_w_d_35:
    s_mov_b32 s36, 0x48089820
    s_branch main_kernel_w_dec
main_kernel_w_d_31:
    s_cmp_lt_u32 s28, 72
    s_cbranch_scc0 main_kernel_w_d_36
    s_cmp_lt_u32 s28, 56
    s_cbranch_scc0 main_kernel_w_d_37
    s_mov_b32 s36, 0x65091030
    s_branch main_kernel_w_dec
main_kernel_w_d_37:
    s_mov_b32 s36, 0x46008038
    s_branch main_kernel_w_dec
main_kernel_w_d_36:
    s_cmp_lt_u32 s28, 88
    s_cbranch_scc0 main_kernel_w_d_38
    s_mov_b32 s36, 0x4042048
    s_branch main_kernel_w_dec
main_kernel_w_d_38:
    s_cmp_lt_u32 s28, 104
    s_cbranch_scc0 main_kernel_w_d_39
    s_mov_b32 s36, 0x46048058
    s_branch main_kernel_w_dec
main_kernel_w_d_39:
    s_mov_b32 s36, 0x65191068
    s_branch main_kernel_w_dec
main_kernel_w_d_30:
    s_cmp_lt_u32 s28, 152
    s_cbranch_scc0 main_kernel_w_d_40
    s_cmp_lt_u32 s28, 128
    s_cbranch_scc0 main_kernel_w_d_41
    s_cmp_lt_u32 s28, 120
    s_cbranch_scc0 main_kernel_w_d_42
    s_mov_b32 s36, 0x65110070
    s_branch main_kernel_w_dec
main_kernel_w_d_42:
    s_mov_b32 s36, 0x65013078
    s_branch main_kernel_w_dec
main_kernel_w_d_41:
    s_cmp_lt_u32 s28, 136
    s_cbranch_scc0 main_kernel_w_d_43
    s_mov_b32 s36, 0x66110880
    s_branch main_kernel_w_dec
main_kernel_w_d_43:
    s_cmp_lt_u32 s28, 144
    s_cbranch_scc0 main_kernel_w_d_44
    s_mov_b32 s36, 0x64093088
    s_branch main_kernel_w_dec
main_kernel_w_d_44:
    s_mov_b32 s36, 0x67110090
    s_branch main_kernel_w_dec
main_kernel_w_d_40:
    s_cmp_lt_u32 s28, 176
    s_cbranch_scc0 main_kernel_w_d_45
    s_cmp_lt_u32 s28, 160
    s_cbranch_scc0 main_kernel_w_d_46
    s_mov_b32 s36, 0x67190098
    s_branch main_kernel_w_dec
main_kernel_w_d_46:
    s_cmp_lt_u32 s28, 168
    s_cbranch_scc0 main_kernel_w_d_47
    s_mov_b32 s36, 0x671910a0
    s_branch main_kernel_w_dec
main_kernel_w_d_47:
    s_mov_b32 s36, 0x661908a8
    s_branch main_kernel_w_dec
main_kernel_w_d_45:
    s_cmp_lt_u32 s28, 184
    s_cbranch_scc0 main_kernel_w_d_48
    s_mov_b32 s36, 0x661910b0
    s_branch main_kernel_w_dec
main_kernel_w_d_48:
    s_cmp_lt_u32 s28, 200
    s_cbranch_scc0 main_kernel_w_d_49
    s_mov_b32 s36, 0x481880b8
    s_branch main_kernel_w_dec
main_kernel_w_d_49:
    s_mov_b32 s36, 0xffffffff
    s_branch main_kernel_w_dec
main_kernel_w_q3:
    s_cmp_lg_u32 s27, 3
    s_cbranch_scc1 main_kernel_w_q4
    s_cmp_lt_u32 s28, 96
    s_cbranch_scc0 main_kernel_w_d_50
    s_cmp_lt_u32 s28, 40
    s_cbranch_scc0 main_kernel_w_d_51
    s_cmp_lt_u32 s28, 16
    s_cbranch_scc0 main_kernel_w_d_52
    s_cmp_lt_u32 s28, 8
    s_cbranch_scc0 main_kernel_w_d_53
    s_mov_b32 s36, 0x1000800
    s_branch main_kernel_w_dec
main_kernel_w_d_53:
    s_mov_b32 s36, 0x1001008
    s_branch main_kernel_w_dec
main_kernel_w_d_52:
    s_cmp_lt_u32 s28, 24
    s_cbranch_scc0 main_kernel_w_d_54
    s_mov_b32 s36, 0x45028810
    s_branch main_kernel_w_dec
main_kernel_w_d_54:
    s_cmp_lt_u32 s28, 32
    s_cbranch_scc0 main_kernel_w_d_55
    s_mov_b32 s36, 0x45029018
    s_branch main_kernel_w_dec
main_kernel_w_d_55:
    s_mov_b32 s36, 0x40068820
    s_branch main_kernel_w_dec
main_kernel_w_d_51:
    s_cmp_lt_u32 s28, 64
    s_cbranch_scc0 main_kernel_w_d_56
    s_cmp_lt_u32 s28, 48
    s_cbranch_scc0 main_kernel_w_d_57
    s_mov_b32 s36, 0x64190828
    s_branch main_kernel_w_dec
main_kernel_w_d_57:
    s_cmp_lt_u32 s28, 56
    s_cbranch_scc0 main_kernel_w_d_58
    s_mov_b32 s36, 0x66091030
    s_branch main_kernel_w_dec
main_kernel_w_d_58:
    s_mov_b32 s36, 0x65110838
    s_branch main_kernel_w_dec
main_kernel_w_d_56:
    s_cmp_lt_u32 s28, 72
    s_cbranch_scc0 main_kernel_w_d_59
    s_mov_b32 s36, 0x64191040
    s_branch main_kernel_w_dec
main_kernel_w_d_59:
    s_cmp_lt_u32 s28, 88
    s_cbranch_scc0 main_kernel_w_d_60
    s_mov_b32 s36, 0x4082048
    s_branch main_kernel_w_dec
main_kernel_w_d_60:
    s_mov_b32 s36, 0x64110058
    s_branch main_kernel_w_dec
main_kernel_w_d_50:
    s_cmp_lt_u32 s28, 164
    s_cbranch_scc0 main_kernel_w_d_61
    s_cmp_lt_u32 s28, 136
    s_cbranch_scc0 main_kernel_w_d_62
    s_cmp_lt_u32 s28, 112
    s_cbranch_scc0 main_kernel_w_d_63
    s_mov_b32 s36, 0x8185060
    s_branch main_kernel_w_dec
main_kernel_w_d_63:
    s_cmp_lt_u32 s28, 128
    s_cbranch_scc0 main_kernel_w_d_64
    s_mov_b32 s36, 0x4a108070
    s_branch main_kernel_w_dec
main_kernel_w_d_64:
    s_mov_b32 s36, 0x65190880
    s_branch main_kernel_w_dec
main_kernel_w_d_62:
    s_cmp_lt_u32 s28, 144
    s_cbranch_scc0 main_kernel_w_d_65
    s_mov_b32 s36, 0x64013088
    s_branch main_kernel_w_dec
main_kernel_w_d_65:
    s_cmp_lt_u32 s28, 152
    s_cbranch_scc0 main_kernel_w_d_66
    s_mov_b32 s36, 0x64193090
    s_branch main_kernel_w_dec
main_kernel_w_d_66:
    s_mov_b32 s36, 0x4a18b098
    s_branch main_kernel_w_dec
main_kernel_w_d_61:
    s_cmp_lt_u32 s28, 204
    s_cbranch_scc0 main_kernel_w_d_67
    s_cmp_lt_u32 s28, 180
    s_cbranch_scc0 main_kernel_w_d_68
    s_mov_b32 s36, 0x80038a4
    s_branch main_kernel_w_dec
main_kernel_w_d_68:
    s_cmp_lt_u32 s28, 196
    s_cbranch_scc0 main_kernel_w_d_69
    s_mov_b32 s36, 0x88038b4
    s_branch main_kernel_w_dec
main_kernel_w_d_69:
    s_mov_b32 s36, 0xa40c4
    s_branch main_kernel_w_dec
main_kernel_w_d_67:
    s_cmp_lt_u32 s28, 212
    s_cbranch_scc0 main_kernel_w_d_70
    s_mov_b32 s36, 0x1040cc
    s_branch main_kernel_w_dec
main_kernel_w_d_70:
    s_cmp_lt_u32 s28, 220
    s_cbranch_scc0 main_kernel_w_d_71
    s_mov_b32 s36, 0x240d4
    s_branch main_kernel_w_dec
main_kernel_w_d_71:
    s_mov_b32 s36, 0xffffffff
    s_branch main_kernel_w_dec
main_kernel_w_q4:
    s_cmp_lg_u32 s27, 4
    s_cbranch_scc1 main_kernel_w_q5
    s_cmp_lt_u32 s28, 138
    s_cbranch_scc0 main_kernel_w_d_72
    s_cmp_lt_u32 s28, 56
    s_cbranch_scc0 main_kernel_w_d_73
    s_cmp_lt_u32 s28, 24
    s_cbranch_scc0 main_kernel_w_d_74
    s_cmp_lt_u32 s28, 8
    s_cbranch_scc0 main_kernel_w_d_75
    s_mov_b32 s36, 0x2000800
    s_branch main_kernel_w_dec
main_kernel_w_d_75:
    s_cmp_lt_u32 s28, 16
    s_cbranch_scc0 main_kernel_w_d_76
    s_mov_b32 s36, 0x2001008
    s_branch main_kernel_w_dec
main_kernel_w_d_76:
    s_mov_b32 s36, 0x46028810
    s_branch main_kernel_w_dec
main_kernel_w_d_74:
    s_cmp_lt_u32 s28, 32
    s_cbranch_scc0 main_kernel_w_d_77
    s_mov_b32 s36, 0x46029018
    s_branch main_kernel_w_dec
main_kernel_w_d_77:
    s_cmp_lt_u32 s28, 48
    s_cbranch_scc0 main_kernel_w_d_78
    s_mov_b32 s36, 0x48009820
    s_branch main_kernel_w_dec
main_kernel_w_d_78:
    s_mov_b32 s36, 0x64090830
    s_branch main_kernel_w_dec
main_kernel_w_d_73:
    s_cmp_lt_u32 s28, 96
    s_cbranch_scc0 main_kernel_w_d_79
    s_cmp_lt_u32 s28, 64
    s_cbranch_scc0 main_kernel_w_d_80
    s_mov_b32 s36, 0x65090838
    s_branch main_kernel_w_dec
main_kernel_w_d_80:
    s_cmp_lt_u32 s28, 80
    s_cbranch_scc0 main_kernel_w_d_81
    s_mov_b32 s36, 0x4002040
    s_branch main_kernel_w_dec
main_kernel_w_d_81:
    s_mov_b32 s36, 0x44048050
    s_branch main_kernel_w_dec
main_kernel_w_d_79:
    s_cmp_lt_u32 s28, 120
    s_cbranch_scc0 main_kernel_w_d_82
    s_cmp_lt_u32 s28, 112
    s_cbranch_scc0 main_kernel_w_d_83
    s_mov_b32 s36, 0x4b109060
    s_branch main_kernel_w_dec
main_kernel_w_d_83:
    s_mov_b32 s36, 0x64111070
    s_branch main_kernel_w_dec
main_kernel_w_d_82:
    s_cmp_lt_u32 s28, 132
    s_cbranch_scc0 main_kernel_w_d_84
    s_mov_b32 s36, 0x4a00b078
    s_branch main_kernel_w_dec
main_kernel_w_d_84:
    s_mov_b32 s36, 0x66113084
    s_branch main_kernel_w_dec
main_kernel_w_d_72:
    s_cmp_lt_u32 s28, 214
    s_cbranch_scc0 main_kernel_w_d_85
    s_cmp_lt_u32 s28, 182
    s_cbranch_scc0 main_kernel_w_d_86
    s_cmp_lt_u32 s28, 150
    s_cbranch_scc0 main_kernel_w_d_87
    s_mov_b32 s36, 0x4ac0b08a
    s_branch main_kernel_w_dec
main_kernel_w_d_87:
    s_cmp_lt_u32 s28, 166
    s_cbranch_scc0 main_kernel_w_d_88
    s_mov_b32 s36, 0x8105096
    s_branch main_kernel_w_dec
main_kernel_w_d_88:
    s_mov_b32 s36, 0x4908b0a6
    s_branch main_kernel_w_dec
main_kernel_w_d_86:
    s_cmp_lt_u32 s28, 198
    s_cbranch_scc0 main_kernel_w_d_89
    s_mov_b32 s36, 0x80838b6
    s_branch main_kernel_w_dec
main_kernel_w_d_89:
    s_cmp_lt_u32 s28, 206
    s_cbranch_scc0 main_kernel_w_d_90
    s_mov_b32 s36, 0x671908c6
    s_branch main_kernel_w_dec
main_kernel_w_d_90:
    s_mov_b32 s36, 0x661900ce
    s_branch main_kernel_w_dec
main_kernel_w_d_85:
    s_cmp_lt_u32 s28, 238
    s_cbranch_scc0 main_kernel_w_d_91
    s_cmp_lt_u32 s28, 222
    s_cbranch_scc0 main_kernel_w_d_92
    s_mov_b32 s36, 0x40d6
    s_branch main_kernel_w_dec
main_kernel_w_d_92:
    s_cmp_lt_u32 s28, 230
    s_cbranch_scc0 main_kernel_w_d_93
    s_mov_b32 s36, 0x640de
    s_branch main_kernel_w_dec
main_kernel_w_d_93:
    s_mov_b32 s36, 0xc40e6
    s_branch main_kernel_w_dec
main_kernel_w_d_91:
    s_cmp_lt_u32 s28, 254
    s_cbranch_scc0 main_kernel_w_d_94
    s_cmp_lt_u32 s28, 246
    s_cbranch_scc0 main_kernel_w_d_95
    s_mov_b32 s36, 0x840ee
    s_branch main_kernel_w_dec
main_kernel_w_d_95:
    s_mov_b32 s36, 0x440f6
    s_branch main_kernel_w_dec
main_kernel_w_d_94:
    s_cmp_lt_u32 s28, 262
    s_cbranch_scc0 main_kernel_w_d_96
    s_mov_b32 s36, 0xe40fe
    s_branch main_kernel_w_dec
main_kernel_w_d_96:
    s_mov_b32 s36, 0xffffffff
    s_branch main_kernel_w_dec
main_kernel_w_q5:
    s_cmp_lt_u32 s28, 120
    s_cbranch_scc0 main_kernel_w_d_97
    s_cmp_lt_u32 s28, 48
    s_cbranch_scc0 main_kernel_w_d_98
    s_cmp_lt_u32 s28, 16
    s_cbranch_scc0 main_kernel_w_d_99
    s_cmp_lt_u32 s28, 8
    s_cbranch_scc0 main_kernel_w_d_100
    s_mov_b32 s36, 0x3000800
    s_branch main_kernel_w_dec
main_kernel_w_d_100:
    s_mov_b32 s36, 0x3001008
    s_branch main_kernel_w_dec
main_kernel_w_d_99:
    s_cmp_lt_u32 s28, 24
    s_cbranch_scc0 main_kernel_w_d_101
    s_mov_b32 s36, 0x47028810
    s_branch main_kernel_w_dec
main_kernel_w_d_101:
    s_cmp_lt_u32 s28, 32
    s_cbranch_scc0 main_kernel_w_d_102
    s_mov_b32 s36, 0x47029018
    s_branch main_kernel_w_dec
main_kernel_w_d_102:
    s_mov_b32 s36, 0x48109820
    s_branch main_kernel_w_dec
main_kernel_w_d_98:
    s_cmp_lt_u32 s28, 80
    s_cbranch_scc0 main_kernel_w_d_103
    s_cmp_lt_u32 s28, 56
    s_cbranch_scc0 main_kernel_w_d_104
    s_mov_b32 s36, 0x42068830
    s_branch main_kernel_w_dec
main_kernel_w_d_104:
    s_cmp_lt_u32 s28, 64
    s_cbranch_scc0 main_kernel_w_d_105
    s_mov_b32 s36, 0x40069038
    s_branch main_kernel_w_dec
main_kernel_w_d_105:
    s_mov_b32 s36, 0x44008040
    s_branch main_kernel_w_dec
main_kernel_w_d_103:
    s_cmp_lt_u32 s28, 88
    s_cbranch_scc0 main_kernel_w_d_106
    s_mov_b32 s36, 0x65190050
    s_branch main_kernel_w_dec
main_kernel_w_d_106:
    s_cmp_lt_u32 s28, 104
    s_cbranch_scc0 main_kernel_w_d_107
    s_mov_b32 s36, 0x8085058
    s_branch main_kernel_w_dec
main_kernel_w_d_107:
    s_mov_b32 s36, 0x8002868
    s_branch main_kernel_w_dec
main_kernel_w_d_97:
    s_cmp_lt_u32 s28, 184
    s_cbranch_scc0 main_kernel_w_d_108
    s_cmp_lt_u32 s28, 144
    s_cbranch_scc0 main_kernel_w_d_109
    s_cmp_lt_u32 s28, 136
    s_cbranch_scc0 main_kernel_w_d_110
    s_mov_b32 s36, 0x40c2078
    s_branch main_kernel_w_dec
main_kernel_w_d_110:
    s_mov_b32 s36, 0x66090088
    s_branch main_kernel_w_dec
main_kernel_w_d_109:
    s_cmp_lt_u32 s28, 152
    s_cbranch_scc0 main_kernel_w_d_111
    s_mov_b32 s36, 0x65111090
    s_branch main_kernel_w_dec
main_kernel_w_d_111:
    s_cmp_lt_u32 s28, 168
    s_cbranch_scc0 main_kernel_w_d_112
    s_mov_b32 s36, 0x8102898
    s_branch main_kernel_w_dec
main_kernel_w_d_112:
    s_mov_b32 s36, 0x81828a8
    s_branch main_kernel_w_dec
main_kernel_w_d_108:
    s_cmp_lt_u32 s28, 212
    s_cbranch_scc0 main_kernel_w_d_113
    s_cmp_lt_u32 s28, 192
    s_cbranch_scc0 main_kernel_w_d_114
    s_mov_b32 s36, 0x651130b8
    s_branch main_kernel_w_dec
main_kernel_w_d_114:
    s_cmp_lt_u32 s28, 200
    s_cbranch_scc0 main_kernel_w_d_115
    s_mov_b32 s36, 0x651930c0
    s_branch main_kernel_w_dec
main_kernel_w_d_115:
    s_mov_b32 s36, 0x4ac8b0c8
    s_branch main_kernel_w_dec
main_kernel_w_d_113:
    s_cmp_lt_u32 s28, 228
    s_cbranch_scc0 main_kernel_w_d_116
    s_mov_b32 s36, 0x88838d4
    s_branch main_kernel_w_dec
main_kernel_w_d_116:
    s_cmp_lt_u32 s28, 244
    s_cbranch_scc0 main_kernel_w_d_117
    s_mov_b32 s36, 0x89838e4
    s_branch main_kernel_w_dec
main_kernel_w_d_117:
    s_mov_b32 s36, 0xffffffff
    s_branch main_kernel_w_dec
main_kernel_w_dec:
    s_cmp_lg_u32 s36, -1
    s_cbranch_scc1 main_kernel_w_got
    s_add_u32 s27, s27, 1
    s_cmp_ge_u32 s27, 6
    s_cselect_b32 s27, 0, s27
    s_add_u32 s52, s52, 1
    s_lshl_b32 s32, 1, s12
    s_and_b32 s32, s32, 116
    s_cselect_b32 s36, -2, -1
    s_cbranch_scc1 main_kernel_w_pub
    s_lshl_b32 s32, s12, 5
    s_add_u32 s32, s32, s13
    s_sub_u32 s32, s32, 224
    s_cmp_lt_u32 s32, 16
    s_cselect_b32 s52, 6, s52
    s_cmp_lt_u32 s52, 6
    s_cbranch_scc1 main_kernel_w_try
    s_lshl_b32 s32, s12, 5
    s_add_u32 s32, s32, s13
    s_sub_u32 s32, s32, 160
    s_cmp_lt_u32 s32, 80
    s_cselect_b32 s36, -3, -1
    s_cmp_lt_u32 s32, 64
    s_cselect_b32 s36, -2, s36
    s_branch main_kernel_w_pub
main_kernel_w_got:
    s_and_b32 s32, s36, 0x7ff
    s_sub_u32 s28, s28, s32
    s_bfe_u32 s32, s36, 0x3001a
    s_lshr_b32 s25, s28, s32
    s_lshl_b32 s33, s25, s32
    s_sub_u32 s24, s28, s33
    s_bfe_u32 s34, s36, 0x1001d
    s_lshl_b32 s24, s24, s34
    s_bfe_u32 s35, s36, 0x1001e
    s_lshl_b32 s25, s25, s35
    s_bfe_u32 s32, s36, 0x40011
    s_add_u32 s24, s24, s32
    s_bfe_u32 s32, s36, 0x50015
    s_add_u32 s25, s25, s32
    s_bfe_u32 s23, s36, 0x4000b
    s_bfe_u32 s36, s36, 0x6000b
    s_lshl_b32 s32, s24, 8
    s_or_b32 s36, s36, s32
    s_lshl_b32 s32, s25, 16
    s_or_b32 s36, s36, s32
    s_cmp_eq_u32 s23, 8
    s_cbranch_scc1 main_kernel_w_dwo
    s_cmp_ge_u32 s23, 10
    s_cbranch_scc1 main_kernel_w_pub
    s_mov_b32 s48, s24
    s_add_u32 s49, s24, s34
    s_mov_b32 s50, 4
    s_mov_b32 s51, 7
    s_cmp_lg_u32 s23, 4
    s_cbranch_scc1 main_kernel_w_dp1
    s_sub_u32 s48, s48, 1
    s_max_i32 s48, s48, 0
    s_add_u32 s49, s49, 1
    s_min_u32 s49, s49, 15
main_kernel_w_dp1:
    s_cmp_eq_u32 s23, 6
    s_cselect_b32 s51, 3, s51
    s_cmp_eq_u32 s23, 7
    s_cselect_b32 s51, 27, s51
    s_cselect_b32 s50, 5, s50
    v_lshrrev_b32 v253, s50, v250
    v_lshlrev_b32 v254, s50, v253
    v_sub_u32 v254, v250, v254
    v_min_u32 v254, s51, v254
    v_add_u32 v253, s48, v253
    v_min_u32 v253, s49, v253
    v_lshlrev_b32 v253, 9, v253
    v_lshl_add_u32 v253, v254, 4, v253
    s_cmp_lt_u32 s23, 4
    s_cselect_b32 s39, 10, s23
    s_lshl_b32 s39, s39, 13
    s_cmp_eq_u32 s23, 3
    s_cselect_b32 s32, 4, 0
    s_add_u32 s39, s39, s32
    s_add_u32 s39, s39, 0x8402000
main_kernel_w_poll:
    buffer_load_dword v254, v253, s[4:7], s39 offen sc1
    s_waitcnt vmcnt(0)
    v_cmp_eq_u32 vcc, 0, v254
    s_cmp_eq_u32 s57, 0
    s_cbranch_scc1 main_kernel_w_fl2
    s_waitcnt vmcnt(0)
    s_barrier
    v_mov_b32 v4, 1
    v_mov_b32 v5, 1
    v_mov_b32 v6, 1
    v_mov_b32 v7, 1
    s_bfm_b64 exec, s57, 0
    buffer_store_dwordx4 v[4:7], v249, s[4:7], s56 offen sc1
    s_mov_b64 exec, -1
    s_mov_b32 s57, 0
main_kernel_w_fl2:
    s_cbranch_vccz main_kernel_w_pub
    s_sleep 8
    s_sub_u32 s29, s29, 1
    s_cbranch_scc0 main_kernel_w_poll
    s_mov_b32 s36, -1
    s_branch main_kernel_w_pub
main_kernel_w_dwo:
    s_lshl_b32 s39, s24, 10
    s_add_u32 s39, s39, 0x8400000
main_kernel_w_pollo:
    buffer_load_dwordx4 v[0:3], v251, s[4:7], s39 offen sc1
    s_waitcnt vmcnt(0)
    v_min3_u32 v0, v0, v1, v2
    v_min_u32 v0, v0, v3
    v_cmp_eq_u32 vcc, 0, v0
    s_cmp_eq_u32 s57, 0
    s_cbranch_scc1 main_kernel_w_fl3
    s_waitcnt vmcnt(0)
    s_barrier
    v_mov_b32 v4, 1
    v_mov_b32 v5, 1
    v_mov_b32 v6, 1
    v_mov_b32 v7, 1
    s_bfm_b64 exec, s57, 0
    buffer_store_dwordx4 v[4:7], v249, s[4:7], s56 offen sc1
    s_mov_b64 exec, -1
    s_mov_b32 s57, 0
main_kernel_w_fl3:
    s_cbranch_vccz main_kernel_w_pub
    s_sleep 16
    s_sub_u32 s29, s29, 1
    s_cbranch_scc0 main_kernel_w_pollo
    s_mov_b32 s36, -1
    s_branch main_kernel_w_pub
main_kernel_w_oko:
    v_min_u32 v253, s35, v250
    v_add_u32 v253, s25, v253
    v_lshlrev_b32 v253, 8, v253
    s_lshl_b32 s39, s24, 4
    s_add_u32 s39, s39, 0x8412000
    s_branch main_kernel_w_poll
main_kernel_w_pub:
    s_cmp_eq_u32 s57, 0
    s_cbranch_scc1 main_kernel_w_fl4
    s_waitcnt vmcnt(0)
    s_barrier
    v_mov_b32 v4, 1
    v_mov_b32 v5, 1
    v_mov_b32 v6, 1
    v_mov_b32 v7, 1
    s_bfm_b64 exec, s57, 0
    buffer_store_dwordx4 v[4:7], v249, s[4:7], s56 offen sc1
    s_mov_b64 exec, -1
    s_mov_b32 s57, 0
main_kernel_w_fl4:
    v_mov_b32 v253, 131072
    v_mov_b32 v254, s36
    ds_write_b32 v253, v254
    s_waitcnt lgkmcnt(0)
main_kernel_w_bar:
    s_barrier
    v_mov_b32 v253, 131072
    ds_read_b32 v254, v253
    s_waitcnt lgkmcnt(0)
    v_readfirstlane_b32 s36, v254
    s_nop 3
    s_cmp_eq_u32 s36, -1
    s_cbranch_scc1 main_kernel_end2
    s_cmp_eq_u32 s36, -2
    s_cbranch_scc1 main_kernel_wo
    s_cmp_eq_u32 s36, -3
    s_cbranch_scc1 main_kernel_att2
    s_mov_b32 s55, -1
    s_and_b32 s23, s36, 15
    s_bfe_u32 s54, s36, 0x20004
    s_bfe_u32 s24, s36, 0x80008
    s_lshr_b32 s25, s36, 16
    s_cmp_eq_u32 s23, 5
    s_cbranch_scc1 main_kernel_w_ln2
    s_cmp_eq_u32 s23, 10
    s_cbranch_scc1 main_kernel_w_fill
    s_cmp_eq_u32 s23, 11
    s_cbranch_scc1 main_kernel_w_pref
    s_cmp_eq_u32 s54, 1
    s_cbranch_scc1 main_kernel_w_c1_task
    s_cmp_eq_u32 s54, 2
    s_cbranch_scc1 main_kernel_w_c2_task
main_kernel_w_c0_task:
    s_cmp_eq_u32 s23, 1
    s_cbranch_scc1 main_kernel_w_c0_set1
    s_cmp_eq_u32 s23, 2
    s_cbranch_scc1 main_kernel_w_c0_set2
    s_cmp_eq_u32 s23, 4
    s_cbranch_scc1 main_kernel_w_c0_set4
    s_cmp_eq_u32 s23, 7
    s_cbranch_scc1 main_kernel_w_c0_set7
    s_cmp_eq_u32 s23, 8
    s_cbranch_scc1 main_kernel_w_c0_set8
    s_branch main_kernel_w_done
main_kernel_w_c0_set1:
    s_lshl_b32 s32, s25, 8
    s_add_u32 s8, s42, s32
    s_addc_u32 s9, s43, 0
    s_and_b32 s9, s9, 0xffff
    s_sub_u32 s10, 0x800000, s32
    s_mov_b32 s11, 0x20000
    s_mov_b32 s30, 8192
    s_mov_b32 s31, 32768
    s_mul_i32 s16, s24, 262144
    s_add_u32 s16, s16, 0x0
    s_mov_b32 s18, 3
    s_lshl_b32 s32, s24, 3
    s_mul_i32 s33, s38, 4
    s_add_u32 s32, s32, s33
    s_mul_i32 s32, s32, 131072
    s_lshl_b32 s33, s25, 12
    s_add_u32 s32, s32, s33
    s_mul_i32 s33, s37, 2048
    s_add_u32 s32, s32, s33
    s_add_u32 s21, s32, 0x1800000
    s_mov_b32 s22, 131072
    s_mov_b32 s26, -1
    s_branch main_kernel_w_c0_go
main_kernel_w_c0_set2:
    s_lshl_b32 s32, s25, 8
    s_add_u32 s8, s44, s32
    s_addc_u32 s9, s45, 0
    s_and_b32 s9, s9, 0xffff
    s_sub_u32 s10, 0x800000, s32
    s_mov_b32 s11, 0x20000
    s_mov_b32 s30, 8192
    s_mov_b32 s31, 32768
    s_mul_i32 s16, s24, 262144
    s_add_u32 s16, s16, 0x0
    s_mov_b32 s18, 3
    s_lshl_b32 s32, s24, 2
    s_mul_i32 s33, s38, 2
    s_add_u32 s32, s32, s33
    s_lshl_b32 s32, s32, 18
    s_lshl_b32 s33, s25, 13
    s_add_u32 s32, s32, s33
    s_mul_i32 s33, s37, 4096
    s_add_u32 s32, s32, s33
    s_add_u32 s21, s32, 0x2800000
    s_branch main_kernel_w_c0_gov
main_kernel_w_c0_set4:
    s_lshl_b32 s32, s25, 8
    s_add_u32 s8, s66, s32
    s_addc_u32 s9, s67, 0
    s_and_b32 s9, s9, 0xffff
    s_sub_u32 s10, 0x200000, s32
    s_mov_b32 s11, 0x20000
    s_mov_b32 s30, 2048
    s_mov_b32 s31, 32768
    s_mul_i32 s16, s24, 262144
    s_add_u32 s16, s16, 0x4808000
    s_mov_b32 s18, 3
    s_lshl_b32 s32, s24, 3
    s_mul_i32 s33, s38, 4
    s_add_u32 s32, s32, s33
    s_mul_i32 s32, s32, 32768
    s_lshl_b32 s33, s25, 12
    s_add_u32 s32, s32, s33
    s_mul_i32 s33, s37, 2048
    s_add_u32 s32, s32, s33
    s_add_u32 s21, s32, 0x5000000
    s_mov_b32 s22, 32768
    s_add_u32 s26, s32, 0x0
    s_branch main_kernel_w_c0_go
main_kernel_w_c0_set7:
    s_lshl_b32 s32, s25, 8
    s_add_u32 s8, s70, s32
    s_addc_u32 s9, s71, 0
    s_and_b32 s9, s9, 0xffff
    s_sub_u32 s10, 0x700000, s32
    s_mov_b32 s11, 0x20000
    s_mov_b32 s30, 2048
    s_mov_b32 s31, 114688
    s_mul_i32 s16, s24, 917504
    s_add_u32 s16, s16, 0x5400000
    s_mov_b32 s18, 13
    s_lshl_b32 s32, s24, 3
    s_mul_i32 s33, s38, 4
    s_add_u32 s32, s32, s33
    s_mul_i32 s32, s32, 32768
    s_lshl_b32 s33, s25, 12
    s_add_u32 s32, s32, s33
    s_mul_i32 s33, s37, 2048
    s_add_u32 s32, s32, s33
    s_add_u32 s21, s32, 0x6400000
    s_mov_b32 s22, 32768
    s_add_u32 s26, s32, 0x5000000
    s_branch main_kernel_w_c0_go
main_kernel_w_c0_set8:
    s_lshl_b32 s32, s25, 8
    s_add_u32 s8, s46, s32
    s_addc_u32 s9, s47, 0
    s_and_b32 s9, s9, 0xffff
    s_sub_u32 s10, 0x800000, s32
    s_mov_b32 s11, 0x20000
    s_mov_b32 s30, 2048
    s_mov_b32 s31, 131072
    s_mul_i32 s16, s24, 1048576
    s_add_u32 s16, s16, 0x3800000
    s_mov_b32 s18, 15
    s_lshl_b32 s32, s24, 3
    s_mul_i32 s33, s38, 4
    s_add_u32 s32, s32, s33
    s_mul_i32 s32, s32, 32768
    s_lshl_b32 s33, s25, 8
    s_add_u32 s34, s32, s33
    s_mul_i32 s33, s37, 128
    s_add_u32 s34, s34, s33
    s_lshl_b32 s33, s25, 12
    s_add_u32 s32, s32, s33
    s_mul_i32 s33, s37, 2048
    s_add_u32 s32, s32, s33
    s_add_u32 s21, s32, 0x0
    s_mov_b32 s22, 32768
    s_add_u32 s26, s32, 0x6400000
    s_mov_b32 s21, s34
    v_and_b32 v253, 15, v250
    v_and_b32 v254, 48, v250
    v_lshl_add_u32 v252, v253, 11, v254
    s_branch main_kernel_w_c0_go
main_kernel_w_c0_go:
    v_lshrrev_b32 v0, 4, v250
    v_bfe_u32 v1, v250, 2, 2
    v_lshl_add_u32 v4, v0, 2, v1
    v_and_b32 v5, 7, v4
    v_mul_u32_u24 v4, 256, v4
    v_and_b32 v6, 3, v250
    v_lshl_add_u32 v4, v6, 3, v4
    s_mul_i32 s32, s37, 4
    v_xor_b32 v5, s32, v5
    v_lshl_add_u32 v128, v5, 5, v4
    v_xor_b32 v129, 32, v128
    v_xor_b32 v130, 64, v128
    v_xor_b32 v131, 96, v128
    s_mul_i32 s32, s38, 8192
    s_add_u32 s32, s32, 65536
    v_add_u32 v136, s32, v251
    v_lshrrev_b32 v2, 4, v250
    v_and_b32 v3, 15, v250
    s_mul_i32 s32, s14, 16
    v_add_u32 v4, s32, v2
    v_add_u32 v5, 0, v4
    v_and_b32 v6, 7, v5
    v_lshlrev_b32 v6, 1, v6
    v_xor_b32 v6, v6, v3
    v_mul_lo_u32 v5, v5, s30
    v_lshl_add_u32 v5, v6, 4, v5
    v_subrev_u32 v137, 0, v5
    v_add_u32 v5, 4, v4
    v_and_b32 v6, 7, v5
    v_lshlrev_b32 v6, 1, v6
    v_xor_b32 v6, v6, v3
    v_mul_lo_u32 v5, v5, s30
    v_lshl_add_u32 v5, v6, 4, v5
    v_subrev_u32 v138, 1024, v5
    v_add_u32 v5, 8, v4
    v_and_b32 v6, 7, v5
    v_lshlrev_b32 v6, 1, v6
    v_xor_b32 v6, v6, v3
    v_mul_lo_u32 v5, v5, s30
    v_lshl_add_u32 v5, v6, 4, v5
    v_subrev_u32 v139, 2048, v5
    v_add_u32 v5, 12, v4
    v_and_b32 v6, 7, v5
    v_lshlrev_b32 v6, 1, v6
    v_xor_b32 v6, v6, v3
    v_mul_lo_u32 v5, v5, s30
    v_lshl_add_u32 v5, v6, 4, v5
    v_subrev_u32 v140, 3072, v5
    s_mul_i32 s32, s14, 2
    s_mul_i32 s32, s32, s31
    v_add_u32 v141, s32, v251
    s_add_u32 s32, s32, s31
    s_sub_u32 s32, s32, 2048
    v_add_u32 v142, s32, v251
    s_mul_i32 s19, s14, 4096
    s_mul_i32 s20, s14, 4096
    s_add_u32 s20, s20, 65536
    s_mul_i32 s17, s30, 64
    s_mov_b32 s15, 0
    s_add_u32 m0, s20, 0
    s_nop 0
    buffer_load_dwordx4 v141, s[4:7], s16 offen offset:0 sc1 lds
    buffer_load_dwordx4 v141, s[4:7], s16 offen offset:1024 sc1 lds
    buffer_load_dwordx4 v142, s[4:7], s16 offen offset:2048 sc1 lds
    buffer_load_dwordx4 v142, s[4:7], s16 offen offset:3072 sc1 lds
    s_add_u32 s16, s16, 2048
    s_add_u32 m0, s19, 0
    s_nop 0
    buffer_load_dwordx4 v137, s[8:11], s15 offen offset:0 lds
    buffer_load_dwordx4 v138, s[8:11], s15 offen offset:1024 lds
    buffer_load_dwordx4 v139, s[8:11], s15 offen offset:2048 lds
    buffer_load_dwordx4 v140, s[8:11], s15 offen offset:3072 lds
    s_add_u32 s15, s15, s17
    s_add_u32 m0, s20, 16384
    s_nop 0
    buffer_load_dwordx4 v141, s[4:7], s16 offen offset:0 sc1 lds
    buffer_load_dwordx4 v141, s[4:7], s16 offen offset:1024 sc1 lds
    buffer_load_dwordx4 v142, s[4:7], s16 offen offset:2048 sc1 lds
    buffer_load_dwordx4 v142, s[4:7], s16 offen offset:3072 sc1 lds
    s_add_u32 s16, s16, 2048
    s_add_u32 m0, s19, 16384
    s_nop 0
    buffer_load_dwordx4 v137, s[8:11], s15 offen offset:0 lds
    buffer_load_dwordx4 v138, s[8:11], s15 offen offset:1024 lds
    buffer_load_dwordx4 v139, s[8:11], s15 offen offset:2048 lds
    buffer_load_dwordx4 v140, s[8:11], s15 offen offset:3072 lds
    s_add_u32 s15, s15, s17
    s_add_u32 m0, s20, 32768
    s_nop 0
    buffer_load_dwordx4 v141, s[4:7], s16 offen offset:0 sc1 lds
    buffer_load_dwordx4 v141, s[4:7], s16 offen offset:1024 sc1 lds
    buffer_load_dwordx4 v142, s[4:7], s16 offen offset:2048 sc1 lds
    buffer_load_dwordx4 v142, s[4:7], s16 offen offset:3072 sc1 lds
    s_add_u32 s16, s16, 2048
    s_add_u32 m0, s19, 32768
    s_nop 0
    buffer_load_dwordx4 v137, s[8:11], s15 offen offset:0 lds
    buffer_load_dwordx4 v138, s[8:11], s15 offen offset:1024 lds
    buffer_load_dwordx4 v139, s[8:11], s15 offen offset:2048 lds
    buffer_load_dwordx4 v140, s[8:11], s15 offen offset:3072 lds
    s_add_u32 s15, s15, s17
    s_add_u32 m0, s20, 49152
    s_nop 0
    buffer_load_dwordx4 v141, s[4:7], s16 offen offset:0 sc1 lds
    buffer_load_dwordx4 v141, s[4:7], s16 offen offset:1024 sc1 lds
    buffer_load_dwordx4 v142, s[4:7], s16 offen offset:2048 sc1 lds
    buffer_load_dwordx4 v142, s[4:7], s16 offen offset:3072 sc1 lds
    s_add_u32 s16, s16, 2048
    v_mov_b32 v64, 0
    v_mov_b32 v65, 0
    v_mov_b32 v66, 0
    v_mov_b32 v67, 0
    v_mov_b32 v68, 0
    v_mov_b32 v69, 0
    v_mov_b32 v70, 0
    v_mov_b32 v71, 0
    v_mov_b32 v72, 0
    v_mov_b32 v73, 0
    v_mov_b32 v74, 0
    v_mov_b32 v75, 0
    v_mov_b32 v76, 0
    v_mov_b32 v77, 0
    v_mov_b32 v78, 0
    v_mov_b32 v79, 0
    v_mov_b32 v80, 0
    v_mov_b32 v81, 0
    v_mov_b32 v82, 0
    v_mov_b32 v83, 0
    v_mov_b32 v84, 0
    v_mov_b32 v85, 0
    v_mov_b32 v86, 0
    v_mov_b32 v87, 0
    v_mov_b32 v88, 0
    v_mov_b32 v89, 0
    v_mov_b32 v90, 0
    v_mov_b32 v91, 0
    v_mov_b32 v92, 0
    v_mov_b32 v93, 0
    v_mov_b32 v94, 0
    v_mov_b32 v95, 0
    v_mov_b32 v96, 0
    v_mov_b32 v97, 0
    v_mov_b32 v98, 0
    v_mov_b32 v99, 0
    v_mov_b32 v100, 0
    v_mov_b32 v101, 0
    v_mov_b32 v102, 0
    v_mov_b32 v103, 0
    v_mov_b32 v104, 0
    v_mov_b32 v105, 0
    v_mov_b32 v106, 0
    v_mov_b32 v107, 0
    v_mov_b32 v108, 0
    v_mov_b32 v109, 0
    v_mov_b32 v110, 0
    v_mov_b32 v111, 0
    v_mov_b32 v112, 0
    v_mov_b32 v113, 0
    v_mov_b32 v114, 0
    v_mov_b32 v115, 0
    v_mov_b32 v116, 0
    v_mov_b32 v117, 0
    v_mov_b32 v118, 0
    v_mov_b32 v119, 0
    v_mov_b32 v120, 0
    v_mov_b32 v121, 0
    v_mov_b32 v122, 0
    v_mov_b32 v123, 0
    v_mov_b32 v124, 0
    v_mov_b32 v125, 0
    v_mov_b32 v126, 0
    v_mov_b32 v127, 0
    s_waitcnt vmcnt(20)
    s_barrier
    ds_read_b128 v[16:19], v136 offset:0
    ds_read_b64_tr_b16 v[0:1], v128 offset:0
    ds_read_b64_tr_b16 v[2:3], v128 offset:4096
    ds_read_b64_tr_b16 v[4:5], v129 offset:0
    ds_read_b64_tr_b16 v[6:7], v129 offset:4096
    ds_read_b64_tr_b16 v[8:9], v130 offset:0
    ds_read_b64_tr_b16 v[10:11], v130 offset:4096
    ds_read_b64_tr_b16 v[12:13], v131 offset:0
    ds_read_b64_tr_b16 v[14:15], v131 offset:4096
    ds_read_b128 v[20:23], v136 offset:2048
    ds_read_b128 v[24:27], v136 offset:4096
    ds_read_b128 v[28:31], v136 offset:6144
main_kernel_w_c0_n_loop:
    s_waitcnt lgkmcnt(0)
    ds_read_b128 v[48:51], v136 offset:1024
    s_add_u32 m0, s19, 49152
    s_nop 0
    v_mfma_f32_16x16x32_bf16 v[64:67], v[0:3], v[16:19], v[64:67]
    ds_read_b64_tr_b16 v[32:33], v128 offset:8192
    v_mfma_f32_16x16x32_bf16 v[68:71], v[4:7], v[16:19], v[68:71]
    ds_read_b64_tr_b16 v[34:35], v128 offset:12288
    buffer_load_dwordx4 v137, s[8:11], s15 offen offset:0 lds
    v_mfma_f32_16x16x32_bf16 v[72:75], v[8:11], v[16:19], v[72:75]
    ds_read_b64_tr_b16 v[36:37], v129 offset:8192
    v_mfma_f32_16x16x32_bf16 v[76:79], v[12:15], v[16:19], v[76:79]
    ds_read_b64_tr_b16 v[38:39], v129 offset:12288
    v_mfma_f32_16x16x32_bf16 v[80:83], v[0:3], v[20:23], v[80:83]
    ds_read_b64_tr_b16 v[40:41], v130 offset:8192
    buffer_load_dwordx4 v138, s[8:11], s15 offen offset:1024 lds
    v_mfma_f32_16x16x32_bf16 v[84:87], v[4:7], v[20:23], v[84:87]
    ds_read_b64_tr_b16 v[42:43], v130 offset:12288
    v_mfma_f32_16x16x32_bf16 v[88:91], v[8:11], v[20:23], v[88:91]
    ds_read_b64_tr_b16 v[44:45], v131 offset:8192
    v_mfma_f32_16x16x32_bf16 v[92:95], v[12:15], v[20:23], v[92:95]
    ds_read_b64_tr_b16 v[46:47], v131 offset:12288
    buffer_load_dwordx4 v139, s[8:11], s15 offen offset:2048 lds
    v_mfma_f32_16x16x32_bf16 v[96:99], v[0:3], v[24:27], v[96:99]
    ds_read_b128 v[52:55], v136 offset:3072
    v_mfma_f32_16x16x32_bf16 v[100:103], v[4:7], v[24:27], v[100:103]
    ds_read_b128 v[56:59], v136 offset:5120
    buffer_load_dwordx4 v140, s[8:11], s15 offen offset:3072 lds
    v_mfma_f32_16x16x32_bf16 v[104:107], v[8:11], v[24:27], v[104:107]
    ds_read_b128 v[60:63], v136 offset:7168
    v_mfma_f32_16x16x32_bf16 v[108:111], v[12:15], v[24:27], v[108:111]
    v_mfma_f32_16x16x32_bf16 v[112:115], v[0:3], v[28:31], v[112:115]
    s_add_u32 s15, s15, s17
    v_mfma_f32_16x16x32_bf16 v[116:119], v[4:7], v[28:31], v[116:119]
    v_mfma_f32_16x16x32_bf16 v[120:123], v[8:11], v[28:31], v[120:123]
    v_mfma_f32_16x16x32_bf16 v[124:127], v[12:15], v[28:31], v[124:127]
    s_waitcnt lgkmcnt(0)
    v_mfma_f32_16x16x32_bf16 v[64:67], v[32:35], v[48:51], v[64:67]
    s_waitcnt vmcnt(16)
    s_barrier
    ds_read_b128 v[16:19], v136 offset:16384
    s_add_u32 m0, s20, 0
    s_nop 0
    v_mfma_f32_16x16x32_bf16 v[68:71], v[36:39], v[48:51], v[68:71]
    ds_read_b64_tr_b16 v[0:1], v128 offset:16384
    v_mfma_f32_16x16x32_bf16 v[72:75], v[40:43], v[48:51], v[72:75]
    ds_read_b64_tr_b16 v[2:3], v128 offset:20480
    buffer_load_dwordx4 v141, s[4:7], s16 offen offset:0 sc1 lds
    v_mfma_f32_16x16x32_bf16 v[76:79], v[44:47], v[48:51], v[76:79]
    ds_read_b64_tr_b16 v[4:5], v129 offset:16384
    v_mfma_f32_16x16x32_bf16 v[80:83], v[32:35], v[52:55], v[80:83]
    ds_read_b64_tr_b16 v[6:7], v129 offset:20480
    v_mfma_f32_16x16x32_bf16 v[84:87], v[36:39], v[52:55], v[84:87]
    ds_read_b64_tr_b16 v[8:9], v130 offset:16384
    buffer_load_dwordx4 v141, s[4:7], s16 offen offset:1024 sc1 lds
    v_mfma_f32_16x16x32_bf16 v[88:91], v[40:43], v[52:55], v[88:91]
    ds_read_b64_tr_b16 v[10:11], v130 offset:20480
    v_mfma_f32_16x16x32_bf16 v[92:95], v[44:47], v[52:55], v[92:95]
    ds_read_b64_tr_b16 v[12:13], v131 offset:16384
    buffer_load_dwordx4 v142, s[4:7], s16 offen offset:2048 sc1 lds
    v_mfma_f32_16x16x32_bf16 v[96:99], v[32:35], v[56:59], v[96:99]
    ds_read_b64_tr_b16 v[14:15], v131 offset:20480
    v_mfma_f32_16x16x32_bf16 v[100:103], v[36:39], v[56:59], v[100:103]
    ds_read_b128 v[20:23], v136 offset:18432
    v_mfma_f32_16x16x32_bf16 v[104:107], v[40:43], v[56:59], v[104:107]
    ds_read_b128 v[24:27], v136 offset:20480
    buffer_load_dwordx4 v142, s[4:7], s16 offen offset:3072 sc1 lds
    v_mfma_f32_16x16x32_bf16 v[108:111], v[44:47], v[56:59], v[108:111]
    ds_read_b128 v[28:31], v136 offset:22528
    v_mfma_f32_16x16x32_bf16 v[112:115], v[32:35], v[60:63], v[112:115]
    s_add_u32 s16, s16, 2048
    v_mfma_f32_16x16x32_bf16 v[116:119], v[36:39], v[60:63], v[116:119]
    v_mfma_f32_16x16x32_bf16 v[120:123], v[40:43], v[60:63], v[120:123]
    v_mfma_f32_16x16x32_bf16 v[124:127], v[44:47], v[60:63], v[124:127]
    s_waitcnt lgkmcnt(0)
    ds_read_b128 v[48:51], v136 offset:17408
    s_add_u32 m0, s19, 0
    s_nop 0
    v_mfma_f32_16x16x32_bf16 v[64:67], v[0:3], v[16:19], v[64:67]
    ds_read_b64_tr_b16 v[32:33], v128 offset:24576
    v_mfma_f32_16x16x32_bf16 v[68:71], v[4:7], v[16:19], v[68:71]
    ds_read_b64_tr_b16 v[34:35], v128 offset:28672
    buffer_load_dwordx4 v137, s[8:11], s15 offen offset:0 lds
    v_mfma_f32_16x16x32_bf16 v[72:75], v[8:11], v[16:19], v[72:75]
    ds_read_b64_tr_b16 v[36:37], v129 offset:24576
    v_mfma_f32_16x16x32_bf16 v[76:79], v[12:15], v[16:19], v[76:79]
    ds_read_b64_tr_b16 v[38:39], v129 offset:28672
    v_mfma_f32_16x16x32_bf16 v[80:83], v[0:3], v[20:23], v[80:83]
    ds_read_b64_tr_b16 v[40:41], v130 offset:24576
    buffer_load_dwordx4 v138, s[8:11], s15 offen offset:1024 lds
    v_mfma_f32_16x16x32_bf16 v[84:87], v[4:7], v[20:23], v[84:87]
    ds_read_b64_tr_b16 v[42:43], v130 offset:28672
    v_mfma_f32_16x16x32_bf16 v[88:91], v[8:11], v[20:23], v[88:91]
    ds_read_b64_tr_b16 v[44:45], v131 offset:24576
    v_mfma_f32_16x16x32_bf16 v[92:95], v[12:15], v[20:23], v[92:95]
    ds_read_b64_tr_b16 v[46:47], v131 offset:28672
    buffer_load_dwordx4 v139, s[8:11], s15 offen offset:2048 lds
    v_mfma_f32_16x16x32_bf16 v[96:99], v[0:3], v[24:27], v[96:99]
    ds_read_b128 v[52:55], v136 offset:19456
    v_mfma_f32_16x16x32_bf16 v[100:103], v[4:7], v[24:27], v[100:103]
    ds_read_b128 v[56:59], v136 offset:21504
    buffer_load_dwordx4 v140, s[8:11], s15 offen offset:3072 lds
    v_mfma_f32_16x16x32_bf16 v[104:107], v[8:11], v[24:27], v[104:107]
    ds_read_b128 v[60:63], v136 offset:23552
    v_mfma_f32_16x16x32_bf16 v[108:111], v[12:15], v[24:27], v[108:111]
    v_mfma_f32_16x16x32_bf16 v[112:115], v[0:3], v[28:31], v[112:115]
    s_add_u32 s15, s15, s17
    v_mfma_f32_16x16x32_bf16 v[116:119], v[4:7], v[28:31], v[116:119]
    v_mfma_f32_16x16x32_bf16 v[120:123], v[8:11], v[28:31], v[120:123]
    v_mfma_f32_16x16x32_bf16 v[124:127], v[12:15], v[28:31], v[124:127]
    s_waitcnt lgkmcnt(0)
    v_mfma_f32_16x16x32_bf16 v[64:67], v[32:35], v[48:51], v[64:67]
    s_waitcnt vmcnt(16)
    s_barrier
    ds_read_b128 v[16:19], v136 offset:32768
    s_add_u32 m0, s20, 16384
    s_nop 0
    v_mfma_f32_16x16x32_bf16 v[68:71], v[36:39], v[48:51], v[68:71]
    ds_read_b64_tr_b16 v[0:1], v128 offset:32768
    v_mfma_f32_16x16x32_bf16 v[72:75], v[40:43], v[48:51], v[72:75]
    ds_read_b64_tr_b16 v[2:3], v128 offset:36864
    buffer_load_dwordx4 v141, s[4:7], s16 offen offset:0 sc1 lds
    v_mfma_f32_16x16x32_bf16 v[76:79], v[44:47], v[48:51], v[76:79]
    ds_read_b64_tr_b16 v[4:5], v129 offset:32768
    v_mfma_f32_16x16x32_bf16 v[80:83], v[32:35], v[52:55], v[80:83]
    ds_read_b64_tr_b16 v[6:7], v129 offset:36864
    v_mfma_f32_16x16x32_bf16 v[84:87], v[36:39], v[52:55], v[84:87]
    ds_read_b64_tr_b16 v[8:9], v130 offset:32768
    buffer_load_dwordx4 v141, s[4:7], s16 offen offset:1024 sc1 lds
    v_mfma_f32_16x16x32_bf16 v[88:91], v[40:43], v[52:55], v[88:91]
    ds_read_b64_tr_b16 v[10:11], v130 offset:36864
    v_mfma_f32_16x16x32_bf16 v[92:95], v[44:47], v[52:55], v[92:95]
    ds_read_b64_tr_b16 v[12:13], v131 offset:32768
    buffer_load_dwordx4 v142, s[4:7], s16 offen offset:2048 sc1 lds
    v_mfma_f32_16x16x32_bf16 v[96:99], v[32:35], v[56:59], v[96:99]
    ds_read_b64_tr_b16 v[14:15], v131 offset:36864
    v_mfma_f32_16x16x32_bf16 v[100:103], v[36:39], v[56:59], v[100:103]
    ds_read_b128 v[20:23], v136 offset:34816
    v_mfma_f32_16x16x32_bf16 v[104:107], v[40:43], v[56:59], v[104:107]
    ds_read_b128 v[24:27], v136 offset:36864
    buffer_load_dwordx4 v142, s[4:7], s16 offen offset:3072 sc1 lds
    v_mfma_f32_16x16x32_bf16 v[108:111], v[44:47], v[56:59], v[108:111]
    ds_read_b128 v[28:31], v136 offset:38912
    v_mfma_f32_16x16x32_bf16 v[112:115], v[32:35], v[60:63], v[112:115]
    s_add_u32 s16, s16, 2048
    v_mfma_f32_16x16x32_bf16 v[116:119], v[36:39], v[60:63], v[116:119]
    v_mfma_f32_16x16x32_bf16 v[120:123], v[40:43], v[60:63], v[120:123]
    v_mfma_f32_16x16x32_bf16 v[124:127], v[44:47], v[60:63], v[124:127]
    s_waitcnt lgkmcnt(0)
    ds_read_b128 v[48:51], v136 offset:33792
    s_add_u32 m0, s19, 16384
    s_nop 0
    v_mfma_f32_16x16x32_bf16 v[64:67], v[0:3], v[16:19], v[64:67]
    ds_read_b64_tr_b16 v[32:33], v128 offset:40960
    v_mfma_f32_16x16x32_bf16 v[68:71], v[4:7], v[16:19], v[68:71]
    ds_read_b64_tr_b16 v[34:35], v128 offset:45056
    buffer_load_dwordx4 v137, s[8:11], s15 offen offset:0 lds
    v_mfma_f32_16x16x32_bf16 v[72:75], v[8:11], v[16:19], v[72:75]
    ds_read_b64_tr_b16 v[36:37], v129 offset:40960
    v_mfma_f32_16x16x32_bf16 v[76:79], v[12:15], v[16:19], v[76:79]
    ds_read_b64_tr_b16 v[38:39], v129 offset:45056
    v_mfma_f32_16x16x32_bf16 v[80:83], v[0:3], v[20:23], v[80:83]
    ds_read_b64_tr_b16 v[40:41], v130 offset:40960
    buffer_load_dwordx4 v138, s[8:11], s15 offen offset:1024 lds
    v_mfma_f32_16x16x32_bf16 v[84:87], v[4:7], v[20:23], v[84:87]
    ds_read_b64_tr_b16 v[42:43], v130 offset:45056
    v_mfma_f32_16x16x32_bf16 v[88:91], v[8:11], v[20:23], v[88:91]
    ds_read_b64_tr_b16 v[44:45], v131 offset:40960
    v_mfma_f32_16x16x32_bf16 v[92:95], v[12:15], v[20:23], v[92:95]
    ds_read_b64_tr_b16 v[46:47], v131 offset:45056
    buffer_load_dwordx4 v139, s[8:11], s15 offen offset:2048 lds
    v_mfma_f32_16x16x32_bf16 v[96:99], v[0:3], v[24:27], v[96:99]
    ds_read_b128 v[52:55], v136 offset:35840
    v_mfma_f32_16x16x32_bf16 v[100:103], v[4:7], v[24:27], v[100:103]
    ds_read_b128 v[56:59], v136 offset:37888
    buffer_load_dwordx4 v140, s[8:11], s15 offen offset:3072 lds
    v_mfma_f32_16x16x32_bf16 v[104:107], v[8:11], v[24:27], v[104:107]
    ds_read_b128 v[60:63], v136 offset:39936
    v_mfma_f32_16x16x32_bf16 v[108:111], v[12:15], v[24:27], v[108:111]
    v_mfma_f32_16x16x32_bf16 v[112:115], v[0:3], v[28:31], v[112:115]
    s_add_u32 s15, s15, s17
    v_mfma_f32_16x16x32_bf16 v[116:119], v[4:7], v[28:31], v[116:119]
    v_mfma_f32_16x16x32_bf16 v[120:123], v[8:11], v[28:31], v[120:123]
    v_mfma_f32_16x16x32_bf16 v[124:127], v[12:15], v[28:31], v[124:127]
    s_waitcnt lgkmcnt(0)
    v_mfma_f32_16x16x32_bf16 v[64:67], v[32:35], v[48:51], v[64:67]
    s_waitcnt vmcnt(16)
    s_barrier
    ds_read_b128 v[16:19], v136 offset:49152
    s_add_u32 m0, s20, 32768
    s_nop 0
    v_mfma_f32_16x16x32_bf16 v[68:71], v[36:39], v[48:51], v[68:71]
    ds_read_b64_tr_b16 v[0:1], v128 offset:49152
    v_mfma_f32_16x16x32_bf16 v[72:75], v[40:43], v[48:51], v[72:75]
    ds_read_b64_tr_b16 v[2:3], v128 offset:53248
    buffer_load_dwordx4 v141, s[4:7], s16 offen offset:0 sc1 lds
    v_mfma_f32_16x16x32_bf16 v[76:79], v[44:47], v[48:51], v[76:79]
    ds_read_b64_tr_b16 v[4:5], v129 offset:49152
    v_mfma_f32_16x16x32_bf16 v[80:83], v[32:35], v[52:55], v[80:83]
    ds_read_b64_tr_b16 v[6:7], v129 offset:53248
    v_mfma_f32_16x16x32_bf16 v[84:87], v[36:39], v[52:55], v[84:87]
    ds_read_b64_tr_b16 v[8:9], v130 offset:49152
    buffer_load_dwordx4 v141, s[4:7], s16 offen offset:1024 sc1 lds
    v_mfma_f32_16x16x32_bf16 v[88:91], v[40:43], v[52:55], v[88:91]
    ds_read_b64_tr_b16 v[10:11], v130 offset:53248
    v_mfma_f32_16x16x32_bf16 v[92:95], v[44:47], v[52:55], v[92:95]
    ds_read_b64_tr_b16 v[12:13], v131 offset:49152
    buffer_load_dwordx4 v142, s[4:7], s16 offen offset:2048 sc1 lds
    v_mfma_f32_16x16x32_bf16 v[96:99], v[32:35], v[56:59], v[96:99]
    ds_read_b64_tr_b16 v[14:15], v131 offset:53248
    v_mfma_f32_16x16x32_bf16 v[100:103], v[36:39], v[56:59], v[100:103]
    ds_read_b128 v[20:23], v136 offset:51200
    v_mfma_f32_16x16x32_bf16 v[104:107], v[40:43], v[56:59], v[104:107]
    ds_read_b128 v[24:27], v136 offset:53248
    buffer_load_dwordx4 v142, s[4:7], s16 offen offset:3072 sc1 lds
    v_mfma_f32_16x16x32_bf16 v[108:111], v[44:47], v[56:59], v[108:111]
    ds_read_b128 v[28:31], v136 offset:55296
    v_mfma_f32_16x16x32_bf16 v[112:115], v[32:35], v[60:63], v[112:115]
    s_add_u32 s16, s16, 2048
    v_mfma_f32_16x16x32_bf16 v[116:119], v[36:39], v[60:63], v[116:119]
    v_mfma_f32_16x16x32_bf16 v[120:123], v[40:43], v[60:63], v[120:123]
    v_mfma_f32_16x16x32_bf16 v[124:127], v[44:47], v[60:63], v[124:127]
    s_waitcnt lgkmcnt(0)
    ds_read_b128 v[48:51], v136 offset:50176
    s_add_u32 m0, s19, 32768
    s_nop 0
    v_mfma_f32_16x16x32_bf16 v[64:67], v[0:3], v[16:19], v[64:67]
    ds_read_b64_tr_b16 v[32:33], v128 offset:57344
    v_mfma_f32_16x16x32_bf16 v[68:71], v[4:7], v[16:19], v[68:71]
    ds_read_b64_tr_b16 v[34:35], v128 offset:61440
    buffer_load_dwordx4 v137, s[8:11], s15 offen offset:0 lds
    v_mfma_f32_16x16x32_bf16 v[72:75], v[8:11], v[16:19], v[72:75]
    ds_read_b64_tr_b16 v[36:37], v129 offset:57344
    v_mfma_f32_16x16x32_bf16 v[76:79], v[12:15], v[16:19], v[76:79]
    ds_read_b64_tr_b16 v[38:39], v129 offset:61440
    v_mfma_f32_16x16x32_bf16 v[80:83], v[0:3], v[20:23], v[80:83]
    ds_read_b64_tr_b16 v[40:41], v130 offset:57344
    buffer_load_dwordx4 v138, s[8:11], s15 offen offset:1024 lds
    v_mfma_f32_16x16x32_bf16 v[84:87], v[4:7], v[20:23], v[84:87]
    ds_read_b64_tr_b16 v[42:43], v130 offset:61440
    v_mfma_f32_16x16x32_bf16 v[88:91], v[8:11], v[20:23], v[88:91]
    ds_read_b64_tr_b16 v[44:45], v131 offset:57344
    v_mfma_f32_16x16x32_bf16 v[92:95], v[12:15], v[20:23], v[92:95]
    ds_read_b64_tr_b16 v[46:47], v131 offset:61440
    buffer_load_dwordx4 v139, s[8:11], s15 offen offset:2048 lds
    v_mfma_f32_16x16x32_bf16 v[96:99], v[0:3], v[24:27], v[96:99]
    ds_read_b128 v[52:55], v136 offset:52224
    v_mfma_f32_16x16x32_bf16 v[100:103], v[4:7], v[24:27], v[100:103]
    ds_read_b128 v[56:59], v136 offset:54272
    buffer_load_dwordx4 v140, s[8:11], s15 offen offset:3072 lds
    v_mfma_f32_16x16x32_bf16 v[104:107], v[8:11], v[24:27], v[104:107]
    ds_read_b128 v[60:63], v136 offset:56320
    v_mfma_f32_16x16x32_bf16 v[108:111], v[12:15], v[24:27], v[108:111]
    v_mfma_f32_16x16x32_bf16 v[112:115], v[0:3], v[28:31], v[112:115]
    s_add_u32 s15, s15, s17
    v_mfma_f32_16x16x32_bf16 v[116:119], v[4:7], v[28:31], v[116:119]
    v_mfma_f32_16x16x32_bf16 v[120:123], v[8:11], v[28:31], v[120:123]
    v_mfma_f32_16x16x32_bf16 v[124:127], v[12:15], v[28:31], v[124:127]
    s_waitcnt lgkmcnt(0)
    v_mfma_f32_16x16x32_bf16 v[64:67], v[32:35], v[48:51], v[64:67]
    s_waitcnt vmcnt(16)
    s_barrier
    ds_read_b128 v[16:19], v136 offset:0
    s_add_u32 m0, s20, 49152
    s_nop 0
    v_mfma_f32_16x16x32_bf16 v[68:71], v[36:39], v[48:51], v[68:71]
    ds_read_b64_tr_b16 v[0:1], v128 offset:0
    v_mfma_f32_16x16x32_bf16 v[72:75], v[40:43], v[48:51], v[72:75]
    ds_read_b64_tr_b16 v[2:3], v128 offset:4096
    buffer_load_dwordx4 v141, s[4:7], s16 offen offset:0 sc1 lds
    v_mfma_f32_16x16x32_bf16 v[76:79], v[44:47], v[48:51], v[76:79]
    ds_read_b64_tr_b16 v[4:5], v129 offset:0
    v_mfma_f32_16x16x32_bf16 v[80:83], v[32:35], v[52:55], v[80:83]
    ds_read_b64_tr_b16 v[6:7], v129 offset:4096
    v_mfma_f32_16x16x32_bf16 v[84:87], v[36:39], v[52:55], v[84:87]
    ds_read_b64_tr_b16 v[8:9], v130 offset:0
    buffer_load_dwordx4 v141, s[4:7], s16 offen offset:1024 sc1 lds
    v_mfma_f32_16x16x32_bf16 v[88:91], v[40:43], v[52:55], v[88:91]
    ds_read_b64_tr_b16 v[10:11], v130 offset:4096
    v_mfma_f32_16x16x32_bf16 v[92:95], v[44:47], v[52:55], v[92:95]
    ds_read_b64_tr_b16 v[12:13], v131 offset:0
    buffer_load_dwordx4 v142, s[4:7], s16 offen offset:2048 sc1 lds
    v_mfma_f32_16x16x32_bf16 v[96:99], v[32:35], v[56:59], v[96:99]
    ds_read_b64_tr_b16 v[14:15], v131 offset:4096
    v_mfma_f32_16x16x32_bf16 v[100:103], v[36:39], v[56:59], v[100:103]
    ds_read_b128 v[20:23], v136 offset:2048
    v_mfma_f32_16x16x32_bf16 v[104:107], v[40:43], v[56:59], v[104:107]
    ds_read_b128 v[24:27], v136 offset:4096
    buffer_load_dwordx4 v142, s[4:7], s16 offen offset:3072 sc1 lds
    v_mfma_f32_16x16x32_bf16 v[108:111], v[44:47], v[56:59], v[108:111]
    ds_read_b128 v[28:31], v136 offset:6144
    v_mfma_f32_16x16x32_bf16 v[112:115], v[32:35], v[60:63], v[112:115]
    s_add_u32 s16, s16, 2048
    v_mfma_f32_16x16x32_bf16 v[116:119], v[36:39], v[60:63], v[116:119]
    v_mfma_f32_16x16x32_bf16 v[120:123], v[40:43], v[60:63], v[120:123]
    v_mfma_f32_16x16x32_bf16 v[124:127], v[44:47], v[60:63], v[124:127]
    s_sub_u32 s18, s18, 1
    s_cmp_lg_u32 s18, 0
    s_cbranch_scc1 main_kernel_w_c0_n_loop
    s_cmp_lg_u32 s14, 0
    s_cbranch_scc1 main_kernel_w_c0_n_nt
    s_lshl_b32 s32, s27, 8
    s_add_u32 s32, s32, 0x841e000
    v_mov_b32 v255, 1
    s_mov_b64 exec, 1
    buffer_atomic_add v255, off, s[4:7], s32 sc0 sc1
    s_mov_b64 exec, -1
main_kernel_w_c0_n_nt:
    s_cmp_lg_u32 s23, 8
    s_cbranch_scc1 main_kernel_w_c0_nlw
    s_lshl_b32 s18, s25, 4
    s_add_u32 s18, s18, s24
    s_lshl_b32 s18, s18, 4
    s_add_u32 s18, s18, 0x8412000
    buffer_load_dword v192, off, s[4:7], s18 sc1
main_kernel_w_c0_nlw:
    s_waitcnt lgkmcnt(0)
    ds_read_b128 v[48:51], v136 offset:1024
    s_add_u32 m0, s19, 49152
    s_nop 0
    v_mfma_f32_16x16x32_bf16 v[64:67], v[0:3], v[16:19], v[64:67]
    ds_read_b64_tr_b16 v[32:33], v128 offset:8192
    v_mfma_f32_16x16x32_bf16 v[68:71], v[4:7], v[16:19], v[68:71]
    ds_read_b64_tr_b16 v[34:35], v128 offset:12288
    buffer_load_dwordx4 v137, s[8:11], s15 offen offset:0 lds
    v_mfma_f32_16x16x32_bf16 v[72:75], v[8:11], v[16:19], v[72:75]
    ds_read_b64_tr_b16 v[36:37], v129 offset:8192
    v_mfma_f32_16x16x32_bf16 v[76:79], v[12:15], v[16:19], v[76:79]
    ds_read_b64_tr_b16 v[38:39], v129 offset:12288
    v_mfma_f32_16x16x32_bf16 v[80:83], v[0:3], v[20:23], v[80:83]
    ds_read_b64_tr_b16 v[40:41], v130 offset:8192
    buffer_load_dwordx4 v138, s[8:11], s15 offen offset:1024 lds
    v_mfma_f32_16x16x32_bf16 v[84:87], v[4:7], v[20:23], v[84:87]
    ds_read_b64_tr_b16 v[42:43], v130 offset:12288
    v_mfma_f32_16x16x32_bf16 v[88:91], v[8:11], v[20:23], v[88:91]
    ds_read_b64_tr_b16 v[44:45], v131 offset:8192
    v_mfma_f32_16x16x32_bf16 v[92:95], v[12:15], v[20:23], v[92:95]
    ds_read_b64_tr_b16 v[46:47], v131 offset:12288
    buffer_load_dwordx4 v139, s[8:11], s15 offen offset:2048 lds
    v_mfma_f32_16x16x32_bf16 v[96:99], v[0:3], v[24:27], v[96:99]
    ds_read_b128 v[52:55], v136 offset:3072
    v_mfma_f32_16x16x32_bf16 v[100:103], v[4:7], v[24:27], v[100:103]
    ds_read_b128 v[56:59], v136 offset:5120
    buffer_load_dwordx4 v140, s[8:11], s15 offen offset:3072 lds
    v_mfma_f32_16x16x32_bf16 v[104:107], v[8:11], v[24:27], v[104:107]
    ds_read_b128 v[60:63], v136 offset:7168
    v_mfma_f32_16x16x32_bf16 v[108:111], v[12:15], v[24:27], v[108:111]
    v_mfma_f32_16x16x32_bf16 v[112:115], v[0:3], v[28:31], v[112:115]
    s_add_u32 s15, s15, s17
    v_mfma_f32_16x16x32_bf16 v[116:119], v[4:7], v[28:31], v[116:119]
    v_mfma_f32_16x16x32_bf16 v[120:123], v[8:11], v[28:31], v[120:123]
    v_mfma_f32_16x16x32_bf16 v[124:127], v[12:15], v[28:31], v[124:127]
    s_waitcnt lgkmcnt(0)
    v_mfma_f32_16x16x32_bf16 v[64:67], v[32:35], v[48:51], v[64:67]
    s_waitcnt vmcnt(16)
    s_barrier
    ds_read_b128 v[16:19], v136 offset:16384
    v_mfma_f32_16x16x32_bf16 v[68:71], v[36:39], v[48:51], v[68:71]
    ds_read_b64_tr_b16 v[0:1], v128 offset:16384
    v_mfma_f32_16x16x32_bf16 v[72:75], v[40:43], v[48:51], v[72:75]
    ds_read_b64_tr_b16 v[2:3], v128 offset:20480
    v_mfma_f32_16x16x32_bf16 v[76:79], v[44:47], v[48:51], v[76:79]
    ds_read_b64_tr_b16 v[4:5], v129 offset:16384
    v_mfma_f32_16x16x32_bf16 v[80:83], v[32:35], v[52:55], v[80:83]
    ds_read_b64_tr_b16 v[6:7], v129 offset:20480
    v_mfma_f32_16x16x32_bf16 v[84:87], v[36:39], v[52:55], v[84:87]
    ds_read_b64_tr_b16 v[8:9], v130 offset:16384
    v_mfma_f32_16x16x32_bf16 v[88:91], v[40:43], v[52:55], v[88:91]
    ds_read_b64_tr_b16 v[10:11], v130 offset:20480
    v_mfma_f32_16x16x32_bf16 v[92:95], v[44:47], v[52:55], v[92:95]
    ds_read_b64_tr_b16 v[12:13], v131 offset:16384
    v_mfma_f32_16x16x32_bf16 v[96:99], v[32:35], v[56:59], v[96:99]
    ds_read_b64_tr_b16 v[14:15], v131 offset:20480
    v_mfma_f32_16x16x32_bf16 v[100:103], v[36:39], v[56:59], v[100:103]
    ds_read_b128 v[20:23], v136 offset:18432
    v_mfma_f32_16x16x32_bf16 v[104:107], v[40:43], v[56:59], v[104:107]
    ds_read_b128 v[24:27], v136 offset:20480
    v_mfma_f32_16x16x32_bf16 v[108:111], v[44:47], v[56:59], v[108:111]
    ds_read_b128 v[28:31], v136 offset:22528
    v_mfma_f32_16x16x32_bf16 v[112:115], v[32:35], v[60:63], v[112:115]
    v_mfma_f32_16x16x32_bf16 v[116:119], v[36:39], v[60:63], v[116:119]
    v_mfma_f32_16x16x32_bf16 v[120:123], v[40:43], v[60:63], v[120:123]
    v_mfma_f32_16x16x32_bf16 v[124:127], v[44:47], v[60:63], v[124:127]
    s_waitcnt lgkmcnt(0)
    ds_read_b128 v[48:51], v136 offset:17408
    v_mfma_f32_16x16x32_bf16 v[64:67], v[0:3], v[16:19], v[64:67]
    ds_read_b64_tr_b16 v[32:33], v128 offset:24576
    v_mfma_f32_16x16x32_bf16 v[68:71], v[4:7], v[16:19], v[68:71]
    ds_read_b64_tr_b16 v[34:35], v128 offset:28672
    v_mfma_f32_16x16x32_bf16 v[72:75], v[8:11], v[16:19], v[72:75]
    ds_read_b64_tr_b16 v[36:37], v129 offset:24576
    v_mfma_f32_16x16x32_bf16 v[76:79], v[12:15], v[16:19], v[76:79]
    ds_read_b64_tr_b16 v[38:39], v129 offset:28672
    v_mfma_f32_16x16x32_bf16 v[80:83], v[0:3], v[20:23], v[80:83]
    ds_read_b64_tr_b16 v[40:41], v130 offset:24576
    v_mfma_f32_16x16x32_bf16 v[84:87], v[4:7], v[20:23], v[84:87]
    ds_read_b64_tr_b16 v[42:43], v130 offset:28672
    v_mfma_f32_16x16x32_bf16 v[88:91], v[8:11], v[20:23], v[88:91]
    ds_read_b64_tr_b16 v[44:45], v131 offset:24576
    v_mfma_f32_16x16x32_bf16 v[92:95], v[12:15], v[20:23], v[92:95]
    ds_read_b64_tr_b16 v[46:47], v131 offset:28672
    v_mfma_f32_16x16x32_bf16 v[96:99], v[0:3], v[24:27], v[96:99]
    ds_read_b128 v[52:55], v136 offset:19456
    v_mfma_f32_16x16x32_bf16 v[100:103], v[4:7], v[24:27], v[100:103]
    ds_read_b128 v[56:59], v136 offset:21504
    v_mfma_f32_16x16x32_bf16 v[104:107], v[8:11], v[24:27], v[104:107]
    ds_read_b128 v[60:63], v136 offset:23552
    v_mfma_f32_16x16x32_bf16 v[108:111], v[12:15], v[24:27], v[108:111]
    v_mfma_f32_16x16x32_bf16 v[112:115], v[0:3], v[28:31], v[112:115]
    v_mfma_f32_16x16x32_bf16 v[116:119], v[4:7], v[28:31], v[116:119]
    v_mfma_f32_16x16x32_bf16 v[120:123], v[8:11], v[28:31], v[120:123]
    v_mfma_f32_16x16x32_bf16 v[124:127], v[12:15], v[28:31], v[124:127]
    s_waitcnt lgkmcnt(0)
    v_mfma_f32_16x16x32_bf16 v[64:67], v[32:35], v[48:51], v[64:67]
    s_waitcnt vmcnt(8)
    s_barrier
    ds_read_b128 v[16:19], v136 offset:32768
    v_mfma_f32_16x16x32_bf16 v[68:71], v[36:39], v[48:51], v[68:71]
    ds_read_b64_tr_b16 v[0:1], v128 offset:32768
    v_mfma_f32_16x16x32_bf16 v[72:75], v[40:43], v[48:51], v[72:75]
    ds_read_b64_tr_b16 v[2:3], v128 offset:36864
    v_mfma_f32_16x16x32_bf16 v[76:79], v[44:47], v[48:51], v[76:79]
    ds_read_b64_tr_b16 v[4:5], v129 offset:32768
    v_mfma_f32_16x16x32_bf16 v[80:83], v[32:35], v[52:55], v[80:83]
    ds_read_b64_tr_b16 v[6:7], v129 offset:36864
    v_mfma_f32_16x16x32_bf16 v[84:87], v[36:39], v[52:55], v[84:87]
    ds_read_b64_tr_b16 v[8:9], v130 offset:32768
    v_mfma_f32_16x16x32_bf16 v[88:91], v[40:43], v[52:55], v[88:91]
    ds_read_b64_tr_b16 v[10:11], v130 offset:36864
    v_mfma_f32_16x16x32_bf16 v[92:95], v[44:47], v[52:55], v[92:95]
    ds_read_b64_tr_b16 v[12:13], v131 offset:32768
    v_mfma_f32_16x16x32_bf16 v[96:99], v[32:35], v[56:59], v[96:99]
    ds_read_b64_tr_b16 v[14:15], v131 offset:36864
    v_mfma_f32_16x16x32_bf16 v[100:103], v[36:39], v[56:59], v[100:103]
    ds_read_b128 v[20:23], v136 offset:34816
    v_mfma_f32_16x16x32_bf16 v[104:107], v[40:43], v[56:59], v[104:107]
    ds_read_b128 v[24:27], v136 offset:36864
    v_mfma_f32_16x16x32_bf16 v[108:111], v[44:47], v[56:59], v[108:111]
    ds_read_b128 v[28:31], v136 offset:38912
    v_mfma_f32_16x16x32_bf16 v[112:115], v[32:35], v[60:63], v[112:115]
    v_mfma_f32_16x16x32_bf16 v[116:119], v[36:39], v[60:63], v[116:119]
    v_mfma_f32_16x16x32_bf16 v[120:123], v[40:43], v[60:63], v[120:123]
    v_mfma_f32_16x16x32_bf16 v[124:127], v[44:47], v[60:63], v[124:127]
    s_waitcnt lgkmcnt(0)
    ds_read_b128 v[48:51], v136 offset:33792
    v_mfma_f32_16x16x32_bf16 v[64:67], v[0:3], v[16:19], v[64:67]
    ds_read_b64_tr_b16 v[32:33], v128 offset:40960
    v_mfma_f32_16x16x32_bf16 v[68:71], v[4:7], v[16:19], v[68:71]
    ds_read_b64_tr_b16 v[34:35], v128 offset:45056
    v_mfma_f32_16x16x32_bf16 v[72:75], v[8:11], v[16:19], v[72:75]
    ds_read_b64_tr_b16 v[36:37], v129 offset:40960
    v_mfma_f32_16x16x32_bf16 v[76:79], v[12:15], v[16:19], v[76:79]
    ds_read_b64_tr_b16 v[38:39], v129 offset:45056
    v_mfma_f32_16x16x32_bf16 v[80:83], v[0:3], v[20:23], v[80:83]
    ds_read_b64_tr_b16 v[40:41], v130 offset:40960
    v_mfma_f32_16x16x32_bf16 v[84:87], v[4:7], v[20:23], v[84:87]
    ds_read_b64_tr_b16 v[42:43], v130 offset:45056
    v_mfma_f32_16x16x32_bf16 v[88:91], v[8:11], v[20:23], v[88:91]
    ds_read_b64_tr_b16 v[44:45], v131 offset:40960
    v_mfma_f32_16x16x32_bf16 v[92:95], v[12:15], v[20:23], v[92:95]
    ds_read_b64_tr_b16 v[46:47], v131 offset:45056
    v_mfma_f32_16x16x32_bf16 v[96:99], v[0:3], v[24:27], v[96:99]
    ds_read_b128 v[52:55], v136 offset:35840
    v_mfma_f32_16x16x32_bf16 v[100:103], v[4:7], v[24:27], v[100:103]
    ds_read_b128 v[56:59], v136 offset:37888
    v_mfma_f32_16x16x32_bf16 v[104:107], v[8:11], v[24:27], v[104:107]
    ds_read_b128 v[60:63], v136 offset:39936
    v_mfma_f32_16x16x32_bf16 v[108:111], v[12:15], v[24:27], v[108:111]
    v_mfma_f32_16x16x32_bf16 v[112:115], v[0:3], v[28:31], v[112:115]
    v_mfma_f32_16x16x32_bf16 v[116:119], v[4:7], v[28:31], v[116:119]
    v_mfma_f32_16x16x32_bf16 v[120:123], v[8:11], v[28:31], v[120:123]
    v_mfma_f32_16x16x32_bf16 v[124:127], v[12:15], v[28:31], v[124:127]
    s_waitcnt lgkmcnt(0)
    v_mfma_f32_16x16x32_bf16 v[64:67], v[32:35], v[48:51], v[64:67]
    s_waitcnt vmcnt(0)
    s_barrier
    ds_read_b128 v[16:19], v136 offset:49152
    v_mfma_f32_16x16x32_bf16 v[68:71], v[36:39], v[48:51], v[68:71]
    ds_read_b64_tr_b16 v[0:1], v128 offset:49152
    v_mfma_f32_16x16x32_bf16 v[72:75], v[40:43], v[48:51], v[72:75]
    ds_read_b64_tr_b16 v[2:3], v128 offset:53248
    v_mfma_f32_16x16x32_bf16 v[76:79], v[44:47], v[48:51], v[76:79]
    ds_read_b64_tr_b16 v[4:5], v129 offset:49152
    v_mfma_f32_16x16x32_bf16 v[80:83], v[32:35], v[52:55], v[80:83]
    ds_read_b64_tr_b16 v[6:7], v129 offset:53248
    v_mfma_f32_16x16x32_bf16 v[84:87], v[36:39], v[52:55], v[84:87]
    ds_read_b64_tr_b16 v[8:9], v130 offset:49152
    v_mfma_f32_16x16x32_bf16 v[88:91], v[40:43], v[52:55], v[88:91]
    ds_read_b64_tr_b16 v[10:11], v130 offset:53248
    v_mfma_f32_16x16x32_bf16 v[92:95], v[44:47], v[52:55], v[92:95]
    ds_read_b64_tr_b16 v[12:13], v131 offset:49152
    v_mfma_f32_16x16x32_bf16 v[96:99], v[32:35], v[56:59], v[96:99]
    ds_read_b64_tr_b16 v[14:15], v131 offset:53248
    v_mfma_f32_16x16x32_bf16 v[100:103], v[36:39], v[56:59], v[100:103]
    ds_read_b128 v[20:23], v136 offset:51200
    v_mfma_f32_16x16x32_bf16 v[104:107], v[40:43], v[56:59], v[104:107]
    ds_read_b128 v[24:27], v136 offset:53248
    v_mfma_f32_16x16x32_bf16 v[108:111], v[44:47], v[56:59], v[108:111]
    ds_read_b128 v[28:31], v136 offset:55296
    v_mfma_f32_16x16x32_bf16 v[112:115], v[32:35], v[60:63], v[112:115]
    v_mfma_f32_16x16x32_bf16 v[116:119], v[36:39], v[60:63], v[116:119]
    v_mfma_f32_16x16x32_bf16 v[120:123], v[40:43], v[60:63], v[120:123]
    v_mfma_f32_16x16x32_bf16 v[124:127], v[44:47], v[60:63], v[124:127]
    v_readfirstlane_b32 s55, v255
    s_cmp_lg_u32 s23, 8
    s_cbranch_scc1 main_kernel_w_c0_lwk
main_kernel_w_c0_lwp:
    v_cmp_eq_u32 vcc, 0, v192
    s_cbranch_vccz main_kernel_w_c0_lwk
    s_sleep 8
    buffer_load_dword v192, off, s[4:7], s18 sc1
    s_waitcnt vmcnt(0)
    s_sub_u32 s29, s29, 1
    s_cbranch_scc0 main_kernel_w_c0_lwp
main_kernel_w_c0_lwk:
    s_cmp_eq_u32 s26, -1
    s_cbranch_scc1 main_kernel_w_c0_nores
    s_add_u32 s32, s26, 0
    buffer_load_dwordx4 v[192:195], v251, s[4:7], s32 offen offset:0 sc1
    buffer_load_dwordx4 v[196:199], v251, s[4:7], s32 offen offset:1024 sc1
    s_add_u32 s32, s26, 32768
    buffer_load_dwordx4 v[200:203], v251, s[4:7], s32 offen offset:0 sc1
    buffer_load_dwordx4 v[204:207], v251, s[4:7], s32 offen offset:1024 sc1
    s_add_u32 s32, s26, 65536
    buffer_load_dwordx4 v[208:211], v251, s[4:7], s32 offen offset:0 sc1
    buffer_load_dwordx4 v[212:215], v251, s[4:7], s32 offen offset:1024 sc1
    s_add_u32 s32, s26, 98304
    buffer_load_dwordx4 v[216:219], v251, s[4:7], s32 offen offset:0 sc1
    buffer_load_dwordx4 v[220:223], v251, s[4:7], s32 offen offset:1024 sc1
main_kernel_w_c0_nores:
    s_waitcnt lgkmcnt(0)
    ds_read_b128 v[48:51], v136 offset:50176
    v_mfma_f32_16x16x32_bf16 v[64:67], v[0:3], v[16:19], v[64:67]
    ds_read_b64_tr_b16 v[32:33], v128 offset:57344
    v_mfma_f32_16x16x32_bf16 v[68:71], v[4:7], v[16:19], v[68:71]
    ds_read_b64_tr_b16 v[34:35], v128 offset:61440
    v_mfma_f32_16x16x32_bf16 v[72:75], v[8:11], v[16:19], v[72:75]
    ds_read_b64_tr_b16 v[36:37], v129 offset:57344
    v_mfma_f32_16x16x32_bf16 v[76:79], v[12:15], v[16:19], v[76:79]
    ds_read_b64_tr_b16 v[38:39], v129 offset:61440
    v_mfma_f32_16x16x32_bf16 v[80:83], v[0:3], v[20:23], v[80:83]
    ds_read_b64_tr_b16 v[40:41], v130 offset:57344
    v_mfma_f32_16x16x32_bf16 v[84:87], v[4:7], v[20:23], v[84:87]
    ds_read_b64_tr_b16 v[42:43], v130 offset:61440
    v_mfma_f32_16x16x32_bf16 v[88:91], v[8:11], v[20:23], v[88:91]
    ds_read_b64_tr_b16 v[44:45], v131 offset:57344
    v_mfma_f32_16x16x32_bf16 v[92:95], v[12:15], v[20:23], v[92:95]
    ds_read_b64_tr_b16 v[46:47], v131 offset:61440
    v_mfma_f32_16x16x32_bf16 v[96:99], v[0:3], v[24:27], v[96:99]
    ds_read_b128 v[52:55], v136 offset:52224
    v_mfma_f32_16x16x32_bf16 v[100:103], v[4:7], v[24:27], v[100:103]
    ds_read_b128 v[56:59], v136 offset:54272
    v_mfma_f32_16x16x32_bf16 v[104:107], v[8:11], v[24:27], v[104:107]
    ds_read_b128 v[60:63], v136 offset:56320
    v_mfma_f32_16x16x32_bf16 v[108:111], v[12:15], v[24:27], v[108:111]
    v_mfma_f32_16x16x32_bf16 v[112:115], v[0:3], v[28:31], v[112:115]
    v_mfma_f32_16x16x32_bf16 v[116:119], v[4:7], v[28:31], v[116:119]
    v_mfma_f32_16x16x32_bf16 v[120:123], v[8:11], v[28:31], v[120:123]
    v_mfma_f32_16x16x32_bf16 v[124:127], v[12:15], v[28:31], v[124:127]
    s_waitcnt lgkmcnt(0)
    v_mfma_f32_16x16x32_bf16 v[64:67], v[32:35], v[48:51], v[64:67]
    v_mfma_f32_16x16x32_bf16 v[68:71], v[36:39], v[48:51], v[68:71]
    v_mfma_f32_16x16x32_bf16 v[72:75], v[40:43], v[48:51], v[72:75]
    v_mfma_f32_16x16x32_bf16 v[76:79], v[44:47], v[48:51], v[76:79]
    v_mfma_f32_16x16x32_bf16 v[80:83], v[32:35], v[52:55], v[80:83]
    v_mfma_f32_16x16x32_bf16 v[84:87], v[36:39], v[52:55], v[84:87]
    v_mfma_f32_16x16x32_bf16 v[88:91], v[40:43], v[52:55], v[88:91]
    v_mfma_f32_16x16x32_bf16 v[92:95], v[44:47], v[52:55], v[92:95]
    v_mfma_f32_16x16x32_bf16 v[96:99], v[32:35], v[56:59], v[96:99]
    v_mfma_f32_16x16x32_bf16 v[100:103], v[36:39], v[56:59], v[100:103]
    v_mfma_f32_16x16x32_bf16 v[104:107], v[40:43], v[56:59], v[104:107]
    v_mfma_f32_16x16x32_bf16 v[108:111], v[44:47], v[56:59], v[108:111]
    v_mfma_f32_16x16x32_bf16 v[112:115], v[32:35], v[60:63], v[112:115]
    v_mfma_f32_16x16x32_bf16 v[116:119], v[36:39], v[60:63], v[116:119]
    v_mfma_f32_16x16x32_bf16 v[120:123], v[40:43], v[60:63], v[120:123]
    v_mfma_f32_16x16x32_bf16 v[124:127], v[44:47], v[60:63], v[124:127]
    s_nop 7
    s_cmp_eq_u32 s23, 4
    s_cbranch_scc1 main_kernel_w_c0_eadd
    s_cmp_eq_u32 s23, 7
    s_cbranch_scc1 main_kernel_w_c0_esilu
    s_cmp_eq_u32 s23, 8
    s_cbranch_scc1 main_kernel_w_c0_efin
main_kernel_w_c0_escl:
    s_mov_b32 s53, s21
    v_mul_f32 v64, 0x3e0293ee, v64
    v_mul_f32 v65, 0x3e0293ee, v65
    v_mul_f32 v66, 0x3e0293ee, v66
    v_mul_f32 v67, 0x3e0293ee, v67
    v_mul_f32 v68, 0x3e0293ee, v68
    v_mul_f32 v69, 0x3e0293ee, v69
    v_mul_f32 v70, 0x3e0293ee, v70
    v_mul_f32 v71, 0x3e0293ee, v71
    v_cvt_pk_bf16_f32 v16, v64, v65
    v_cvt_pk_bf16_f32 v17, v66, v67
    v_cvt_pk_bf16_f32 v18, v68, v69
    v_cvt_pk_bf16_f32 v19, v70, v71
    buffer_store_dwordx4 v[16:19], v251, s[4:7], s53 offen offset:0 sc1
    v_mul_f32 v72, 0x3e0293ee, v72
    v_mul_f32 v73, 0x3e0293ee, v73
    v_mul_f32 v74, 0x3e0293ee, v74
    v_mul_f32 v75, 0x3e0293ee, v75
    v_mul_f32 v76, 0x3e0293ee, v76
    v_mul_f32 v77, 0x3e0293ee, v77
    v_mul_f32 v78, 0x3e0293ee, v78
    v_mul_f32 v79, 0x3e0293ee, v79
    v_cvt_pk_bf16_f32 v36, v72, v73
    v_cvt_pk_bf16_f32 v37, v74, v75
    v_cvt_pk_bf16_f32 v38, v76, v77
    v_cvt_pk_bf16_f32 v39, v78, v79
    buffer_store_dwordx4 v[36:39], v251, s[4:7], s53 offen offset:1024 sc1
    s_add_u32 s53, s53, s22
    v_mul_f32 v80, 0x3e0293ee, v80
    v_mul_f32 v81, 0x3e0293ee, v81
    v_mul_f32 v82, 0x3e0293ee, v82
    v_mul_f32 v83, 0x3e0293ee, v83
    v_mul_f32 v84, 0x3e0293ee, v84
    v_mul_f32 v85, 0x3e0293ee, v85
    v_mul_f32 v86, 0x3e0293ee, v86
    v_mul_f32 v87, 0x3e0293ee, v87
    v_cvt_pk_bf16_f32 v56, v80, v81
    v_cvt_pk_bf16_f32 v57, v82, v83
    v_cvt_pk_bf16_f32 v58, v84, v85
    v_cvt_pk_bf16_f32 v59, v86, v87
    buffer_store_dwordx4 v[56:59], v251, s[4:7], s53 offen offset:0 sc1
    v_mul_f32 v88, 0x3e0293ee, v88
    v_mul_f32 v89, 0x3e0293ee, v89
    v_mul_f32 v90, 0x3e0293ee, v90
    v_mul_f32 v91, 0x3e0293ee, v91
    v_mul_f32 v92, 0x3e0293ee, v92
    v_mul_f32 v93, 0x3e0293ee, v93
    v_mul_f32 v94, 0x3e0293ee, v94
    v_mul_f32 v95, 0x3e0293ee, v95
    v_cvt_pk_bf16_f32 v16, v88, v89
    v_cvt_pk_bf16_f32 v17, v90, v91
    v_cvt_pk_bf16_f32 v18, v92, v93
    v_cvt_pk_bf16_f32 v19, v94, v95
    buffer_store_dwordx4 v[16:19], v251, s[4:7], s53 offen offset:1024 sc1
    s_add_u32 s53, s53, s22
    v_mul_f32 v96, 0x3e0293ee, v96
    v_mul_f32 v97, 0x3e0293ee, v97
    v_mul_f32 v98, 0x3e0293ee, v98
    v_mul_f32 v99, 0x3e0293ee, v99
    v_mul_f32 v100, 0x3e0293ee, v100
    v_mul_f32 v101, 0x3e0293ee, v101
    v_mul_f32 v102, 0x3e0293ee, v102
    v_mul_f32 v103, 0x3e0293ee, v103
    v_cvt_pk_bf16_f32 v36, v96, v97
    v_cvt_pk_bf16_f32 v37, v98, v99
    v_cvt_pk_bf16_f32 v38, v100, v101
    v_cvt_pk_bf16_f32 v39, v102, v103
    buffer_store_dwordx4 v[36:39], v251, s[4:7], s53 offen offset:0 sc1
    v_mul_f32 v104, 0x3e0293ee, v104
    v_mul_f32 v105, 0x3e0293ee, v105
    v_mul_f32 v106, 0x3e0293ee, v106
    v_mul_f32 v107, 0x3e0293ee, v107
    v_mul_f32 v108, 0x3e0293ee, v108
    v_mul_f32 v109, 0x3e0293ee, v109
    v_mul_f32 v110, 0x3e0293ee, v110
    v_mul_f32 v111, 0x3e0293ee, v111
    v_cvt_pk_bf16_f32 v56, v104, v105
    v_cvt_pk_bf16_f32 v57, v106, v107
    v_cvt_pk_bf16_f32 v58, v108, v109
    v_cvt_pk_bf16_f32 v59, v110, v111
    buffer_store_dwordx4 v[56:59], v251, s[4:7], s53 offen offset:1024 sc1
    s_add_u32 s53, s53, s22
    v_mul_f32 v112, 0x3e0293ee, v112
    v_mul_f32 v113, 0x3e0293ee, v113
    v_mul_f32 v114, 0x3e0293ee, v114
    v_mul_f32 v115, 0x3e0293ee, v115
    v_mul_f32 v116, 0x3e0293ee, v116
    v_mul_f32 v117, 0x3e0293ee, v117
    v_mul_f32 v118, 0x3e0293ee, v118
    v_mul_f32 v119, 0x3e0293ee, v119
    v_cvt_pk_bf16_f32 v16, v112, v113
    v_cvt_pk_bf16_f32 v17, v114, v115
    v_cvt_pk_bf16_f32 v18, v116, v117
    v_cvt_pk_bf16_f32 v19, v118, v119
    buffer_store_dwordx4 v[16:19], v251, s[4:7], s53 offen offset:0 sc1
    v_mul_f32 v120, 0x3e0293ee, v120
    v_mul_f32 v121, 0x3e0293ee, v121
    v_mul_f32 v122, 0x3e0293ee, v122
    v_mul_f32 v123, 0x3e0293ee, v123
    v_mul_f32 v124, 0x3e0293ee, v124
    v_mul_f32 v125, 0x3e0293ee, v125
    v_mul_f32 v126, 0x3e0293ee, v126
    v_mul_f32 v127, 0x3e0293ee, v127
    v_cvt_pk_bf16_f32 v36, v120, v121
    v_cvt_pk_bf16_f32 v37, v122, v123
    v_cvt_pk_bf16_f32 v38, v124, v125
    v_cvt_pk_bf16_f32 v39, v126, v127
    buffer_store_dwordx4 v[36:39], v251, s[4:7], s53 offen offset:1024 sc1
    s_branch main_kernel_w_done
main_kernel_w_c0_eadd:
    s_mov_b32 s53, s21
    s_waitcnt vmcnt(7)
    v_lshlrev_b32 v8, 16, v192
    v_and_b32 v9, 0xffff0000, v192
    v_lshlrev_b32 v10, 16, v193
    v_and_b32 v11, 0xffff0000, v193
    v_lshlrev_b32 v12, 16, v194
    v_and_b32 v13, 0xffff0000, v194
    v_lshlrev_b32 v14, 16, v195
    v_and_b32 v15, 0xffff0000, v195
    v_pk_add_f32 v[64:65], v[64:65], v[8:9]
    v_pk_add_f32 v[66:67], v[66:67], v[10:11]
    v_pk_add_f32 v[68:69], v[68:69], v[12:13]
    v_pk_add_f32 v[70:71], v[70:71], v[14:15]
    v_cvt_pk_bf16_f32 v16, v64, v65
    v_cvt_pk_bf16_f32 v17, v66, v67
    v_cvt_pk_bf16_f32 v18, v68, v69
    v_cvt_pk_bf16_f32 v19, v70, v71
    buffer_store_dwordx4 v[16:19], v251, s[4:7], s53 offen offset:0 sc1
    s_waitcnt vmcnt(7)
    v_lshlrev_b32 v28, 16, v196
    v_and_b32 v29, 0xffff0000, v196
    v_lshlrev_b32 v30, 16, v197
    v_and_b32 v31, 0xffff0000, v197
    v_lshlrev_b32 v32, 16, v198
    v_and_b32 v33, 0xffff0000, v198
    v_lshlrev_b32 v34, 16, v199
    v_and_b32 v35, 0xffff0000, v199
    v_pk_add_f32 v[72:73], v[72:73], v[28:29]
    v_pk_add_f32 v[74:75], v[74:75], v[30:31]
    v_pk_add_f32 v[76:77], v[76:77], v[32:33]
    v_pk_add_f32 v[78:79], v[78:79], v[34:35]
    v_cvt_pk_bf16_f32 v36, v72, v73
    v_cvt_pk_bf16_f32 v37, v74, v75
    v_cvt_pk_bf16_f32 v38, v76, v77
    v_cvt_pk_bf16_f32 v39, v78, v79
    buffer_store_dwordx4 v[36:39], v251, s[4:7], s53 offen offset:1024 sc1
    s_add_u32 s53, s53, s22
    s_waitcnt vmcnt(7)
    v_lshlrev_b32 v48, 16, v200
    v_and_b32 v49, 0xffff0000, v200
    v_lshlrev_b32 v50, 16, v201
    v_and_b32 v51, 0xffff0000, v201
    v_lshlrev_b32 v52, 16, v202
    v_and_b32 v53, 0xffff0000, v202
    v_lshlrev_b32 v54, 16, v203
    v_and_b32 v55, 0xffff0000, v203
    v_pk_add_f32 v[80:81], v[80:81], v[48:49]
    v_pk_add_f32 v[82:83], v[82:83], v[50:51]
    v_pk_add_f32 v[84:85], v[84:85], v[52:53]
    v_pk_add_f32 v[86:87], v[86:87], v[54:55]
    v_cvt_pk_bf16_f32 v56, v80, v81
    v_cvt_pk_bf16_f32 v57, v82, v83
    v_cvt_pk_bf16_f32 v58, v84, v85
    v_cvt_pk_bf16_f32 v59, v86, v87
    buffer_store_dwordx4 v[56:59], v251, s[4:7], s53 offen offset:0 sc1
    s_waitcnt vmcnt(7)
    v_lshlrev_b32 v8, 16, v204
    v_and_b32 v9, 0xffff0000, v204
    v_lshlrev_b32 v10, 16, v205
    v_and_b32 v11, 0xffff0000, v205
    v_lshlrev_b32 v12, 16, v206
    v_and_b32 v13, 0xffff0000, v206
    v_lshlrev_b32 v14, 16, v207
    v_and_b32 v15, 0xffff0000, v207
    v_pk_add_f32 v[88:89], v[88:89], v[8:9]
    v_pk_add_f32 v[90:91], v[90:91], v[10:11]
    v_pk_add_f32 v[92:93], v[92:93], v[12:13]
    v_pk_add_f32 v[94:95], v[94:95], v[14:15]
    v_cvt_pk_bf16_f32 v16, v88, v89
    v_cvt_pk_bf16_f32 v17, v90, v91
    v_cvt_pk_bf16_f32 v18, v92, v93
    v_cvt_pk_bf16_f32 v19, v94, v95
    buffer_store_dwordx4 v[16:19], v251, s[4:7], s53 offen offset:1024 sc1
    s_add_u32 s53, s53, s22
    s_waitcnt vmcnt(7)
    v_lshlrev_b32 v28, 16, v208
    v_and_b32 v29, 0xffff0000, v208
    v_lshlrev_b32 v30, 16, v209
    v_and_b32 v31, 0xffff0000, v209
    v_lshlrev_b32 v32, 16, v210
    v_and_b32 v33, 0xffff0000, v210
    v_lshlrev_b32 v34, 16, v211
    v_and_b32 v35, 0xffff0000, v211
    v_pk_add_f32 v[96:97], v[96:97], v[28:29]
    v_pk_add_f32 v[98:99], v[98:99], v[30:31]
    v_pk_add_f32 v[100:101], v[100:101], v[32:33]
    v_pk_add_f32 v[102:103], v[102:103], v[34:35]
    v_cvt_pk_bf16_f32 v36, v96, v97
    v_cvt_pk_bf16_f32 v37, v98, v99
    v_cvt_pk_bf16_f32 v38, v100, v101
    v_cvt_pk_bf16_f32 v39, v102, v103
    buffer_store_dwordx4 v[36:39], v251, s[4:7], s53 offen offset:0 sc1
    s_waitcnt vmcnt(7)
    v_lshlrev_b32 v48, 16, v212
    v_and_b32 v49, 0xffff0000, v212
    v_lshlrev_b32 v50, 16, v213
    v_and_b32 v51, 0xffff0000, v213
    v_lshlrev_b32 v52, 16, v214
    v_and_b32 v53, 0xffff0000, v214
    v_lshlrev_b32 v54, 16, v215
    v_and_b32 v55, 0xffff0000, v215
    v_pk_add_f32 v[104:105], v[104:105], v[48:49]
    v_pk_add_f32 v[106:107], v[106:107], v[50:51]
    v_pk_add_f32 v[108:109], v[108:109], v[52:53]
    v_pk_add_f32 v[110:111], v[110:111], v[54:55]
    v_cvt_pk_bf16_f32 v56, v104, v105
    v_cvt_pk_bf16_f32 v57, v106, v107
    v_cvt_pk_bf16_f32 v58, v108, v109
    v_cvt_pk_bf16_f32 v59, v110, v111
    buffer_store_dwordx4 v[56:59], v251, s[4:7], s53 offen offset:1024 sc1
    s_add_u32 s53, s53, s22
    s_waitcnt vmcnt(7)
    v_lshlrev_b32 v8, 16, v216
    v_and_b32 v9, 0xffff0000, v216
    v_lshlrev_b32 v10, 16, v217
    v_and_b32 v11, 0xffff0000, v217
    v_lshlrev_b32 v12, 16, v218
    v_and_b32 v13, 0xffff0000, v218
    v_lshlrev_b32 v14, 16, v219
    v_and_b32 v15, 0xffff0000, v219
    v_pk_add_f32 v[112:113], v[112:113], v[8:9]
    v_pk_add_f32 v[114:115], v[114:115], v[10:11]
    v_pk_add_f32 v[116:117], v[116:117], v[12:13]
    v_pk_add_f32 v[118:119], v[118:119], v[14:15]
    v_cvt_pk_bf16_f32 v16, v112, v113
    v_cvt_pk_bf16_f32 v17, v114, v115
    v_cvt_pk_bf16_f32 v18, v116, v117
    v_cvt_pk_bf16_f32 v19, v118, v119
    buffer_store_dwordx4 v[16:19], v251, s[4:7], s53 offen offset:0 sc1
    s_waitcnt vmcnt(7)
    v_lshlrev_b32 v28, 16, v220
    v_and_b32 v29, 0xffff0000, v220
    v_lshlrev_b32 v30, 16, v221
    v_and_b32 v31, 0xffff0000, v221
    v_lshlrev_b32 v32, 16, v222
    v_and_b32 v33, 0xffff0000, v222
    v_lshlrev_b32 v34, 16, v223
    v_and_b32 v35, 0xffff0000, v223
    v_pk_add_f32 v[120:121], v[120:121], v[28:29]
    v_pk_add_f32 v[122:123], v[122:123], v[30:31]
    v_pk_add_f32 v[124:125], v[124:125], v[32:33]
    v_pk_add_f32 v[126:127], v[126:127], v[34:35]
    v_cvt_pk_bf16_f32 v36, v120, v121
    v_cvt_pk_bf16_f32 v37, v122, v123
    v_cvt_pk_bf16_f32 v38, v124, v125
    v_cvt_pk_bf16_f32 v39, v126, v127
    buffer_store_dwordx4 v[36:39], v251, s[4:7], s53 offen offset:1024 sc1
    s_branch main_kernel_w_done
main_kernel_w_c0_esilu:
    s_mov_b32 s53, s21
    s_waitcnt vmcnt(7)
    v_lshlrev_b32 v8, 16, v192
    v_and_b32 v9, 0xffff0000, v192
    v_lshlrev_b32 v10, 16, v193
    v_and_b32 v11, 0xffff0000, v193
    v_lshlrev_b32 v12, 16, v194
    v_and_b32 v13, 0xffff0000, v194
    v_lshlrev_b32 v14, 16, v195
    v_and_b32 v15, 0xffff0000, v195
    v_pk_add_f32 v[64:65], v[64:65], v[8:9]
    v_pk_add_f32 v[66:67], v[66:67], v[10:11]
    v_pk_add_f32 v[68:69], v[68:69], v[12:13]
    v_pk_add_f32 v[70:71], v[70:71], v[14:15]
    v_pk_mul_f32 v[8:9], v[64:65], v[246:247]
    v_pk_mul_f32 v[10:11], v[66:67], v[246:247]
    v_pk_mul_f32 v[12:13], v[68:69], v[246:247]
    v_pk_mul_f32 v[14:15], v[70:71], v[246:247]
    v_exp_f32 v8, v8
    v_exp_f32 v9, v9
    v_exp_f32 v10, v10
    v_exp_f32 v11, v11
    v_exp_f32 v12, v12
    v_exp_f32 v13, v13
    v_exp_f32 v14, v14
    v_exp_f32 v15, v15
    v_pk_add_f32 v[8:9], v[8:9], v[244:245]
    v_pk_add_f32 v[10:11], v[10:11], v[244:245]
    v_pk_add_f32 v[12:13], v[12:13], v[244:245]
    v_pk_add_f32 v[14:15], v[14:15], v[244:245]
    v_rcp_f32 v8, v8
    v_rcp_f32 v9, v9
    v_rcp_f32 v10, v10
    v_rcp_f32 v11, v11
    v_rcp_f32 v12, v12
    v_rcp_f32 v13, v13
    v_rcp_f32 v14, v14
    v_rcp_f32 v15, v15
    v_pk_mul_f32 v[64:65], v[8:9], v[64:65]
    v_pk_mul_f32 v[66:67], v[10:11], v[66:67]
    v_pk_mul_f32 v[68:69], v[12:13], v[68:69]
    v_pk_mul_f32 v[70:71], v[14:15], v[70:71]
    v_cvt_pk_bf16_f32 v16, v64, v65
    v_cvt_pk_bf16_f32 v17, v66, v67
    v_cvt_pk_bf16_f32 v18, v68, v69
    v_cvt_pk_bf16_f32 v19, v70, v71
    buffer_store_dwordx4 v[16:19], v251, s[4:7], s53 offen offset:0 sc1
    s_waitcnt vmcnt(7)
    v_lshlrev_b32 v28, 16, v196
    v_and_b32 v29, 0xffff0000, v196
    v_lshlrev_b32 v30, 16, v197
    v_and_b32 v31, 0xffff0000, v197
    v_lshlrev_b32 v32, 16, v198
    v_and_b32 v33, 0xffff0000, v198
    v_lshlrev_b32 v34, 16, v199
    v_and_b32 v35, 0xffff0000, v199
    v_pk_add_f32 v[72:73], v[72:73], v[28:29]
    v_pk_add_f32 v[74:75], v[74:75], v[30:31]
    v_pk_add_f32 v[76:77], v[76:77], v[32:33]
    v_pk_add_f32 v[78:79], v[78:79], v[34:35]
    v_pk_mul_f32 v[28:29], v[72:73], v[246:247]
    v_pk_mul_f32 v[30:31], v[74:75], v[246:247]
    v_pk_mul_f32 v[32:33], v[76:77], v[246:247]
    v_pk_mul_f32 v[34:35], v[78:79], v[246:247]
    v_exp_f32 v28, v28
    v_exp_f32 v29, v29
    v_exp_f32 v30, v30
    v_exp_f32 v31, v31
    v_exp_f32 v32, v32
    v_exp_f32 v33, v33
    v_exp_f32 v34, v34
    v_exp_f32 v35, v35
    v_pk_add_f32 v[28:29], v[28:29], v[244:245]
    v_pk_add_f32 v[30:31], v[30:31], v[244:245]
    v_pk_add_f32 v[32:33], v[32:33], v[244:245]
    v_pk_add_f32 v[34:35], v[34:35], v[244:245]
    v_rcp_f32 v28, v28
    v_rcp_f32 v29, v29
    v_rcp_f32 v30, v30
    v_rcp_f32 v31, v31
    v_rcp_f32 v32, v32
    v_rcp_f32 v33, v33
    v_rcp_f32 v34, v34
    v_rcp_f32 v35, v35
    v_pk_mul_f32 v[72:73], v[28:29], v[72:73]
    v_pk_mul_f32 v[74:75], v[30:31], v[74:75]
    v_pk_mul_f32 v[76:77], v[32:33], v[76:77]
    v_pk_mul_f32 v[78:79], v[34:35], v[78:79]
    v_cvt_pk_bf16_f32 v36, v72, v73
    v_cvt_pk_bf16_f32 v37, v74, v75
    v_cvt_pk_bf16_f32 v38, v76, v77
    v_cvt_pk_bf16_f32 v39, v78, v79
    buffer_store_dwordx4 v[36:39], v251, s[4:7], s53 offen offset:1024 sc1
    s_add_u32 s53, s53, s22
    s_waitcnt vmcnt(7)
    v_lshlrev_b32 v48, 16, v200
    v_and_b32 v49, 0xffff0000, v200
    v_lshlrev_b32 v50, 16, v201
    v_and_b32 v51, 0xffff0000, v201
    v_lshlrev_b32 v52, 16, v202
    v_and_b32 v53, 0xffff0000, v202
    v_lshlrev_b32 v54, 16, v203
    v_and_b32 v55, 0xffff0000, v203
    v_pk_add_f32 v[80:81], v[80:81], v[48:49]
    v_pk_add_f32 v[82:83], v[82:83], v[50:51]
    v_pk_add_f32 v[84:85], v[84:85], v[52:53]
    v_pk_add_f32 v[86:87], v[86:87], v[54:55]
    v_pk_mul_f32 v[48:49], v[80:81], v[246:247]
    v_pk_mul_f32 v[50:51], v[82:83], v[246:247]
    v_pk_mul_f32 v[52:53], v[84:85], v[246:247]
    v_pk_mul_f32 v[54:55], v[86:87], v[246:247]
    v_exp_f32 v48, v48
    v_exp_f32 v49, v49
    v_exp_f32 v50, v50
    v_exp_f32 v51, v51
    v_exp_f32 v52, v52
    v_exp_f32 v53, v53
    v_exp_f32 v54, v54
    v_exp_f32 v55, v55
    v_pk_add_f32 v[48:49], v[48:49], v[244:245]
    v_pk_add_f32 v[50:51], v[50:51], v[244:245]
    v_pk_add_f32 v[52:53], v[52:53], v[244:245]
    v_pk_add_f32 v[54:55], v[54:55], v[244:245]
    v_rcp_f32 v48, v48
    v_rcp_f32 v49, v49
    v_rcp_f32 v50, v50
    v_rcp_f32 v51, v51
    v_rcp_f32 v52, v52
    v_rcp_f32 v53, v53
    v_rcp_f32 v54, v54
    v_rcp_f32 v55, v55
    v_pk_mul_f32 v[80:81], v[48:49], v[80:81]
    v_pk_mul_f32 v[82:83], v[50:51], v[82:83]
    v_pk_mul_f32 v[84:85], v[52:53], v[84:85]
    v_pk_mul_f32 v[86:87], v[54:55], v[86:87]
    v_cvt_pk_bf16_f32 v56, v80, v81
    v_cvt_pk_bf16_f32 v57, v82, v83
    v_cvt_pk_bf16_f32 v58, v84, v85
    v_cvt_pk_bf16_f32 v59, v86, v87
    buffer_store_dwordx4 v[56:59], v251, s[4:7], s53 offen offset:0 sc1
    s_waitcnt vmcnt(7)
    v_lshlrev_b32 v8, 16, v204
    v_and_b32 v9, 0xffff0000, v204
    v_lshlrev_b32 v10, 16, v205
    v_and_b32 v11, 0xffff0000, v205
    v_lshlrev_b32 v12, 16, v206
    v_and_b32 v13, 0xffff0000, v206
    v_lshlrev_b32 v14, 16, v207
    v_and_b32 v15, 0xffff0000, v207
    v_pk_add_f32 v[88:89], v[88:89], v[8:9]
    v_pk_add_f32 v[90:91], v[90:91], v[10:11]
    v_pk_add_f32 v[92:93], v[92:93], v[12:13]
    v_pk_add_f32 v[94:95], v[94:95], v[14:15]
    v_pk_mul_f32 v[8:9], v[88:89], v[246:247]
    v_pk_mul_f32 v[10:11], v[90:91], v[246:247]
    v_pk_mul_f32 v[12:13], v[92:93], v[246:247]
    v_pk_mul_f32 v[14:15], v[94:95], v[246:247]
    v_exp_f32 v8, v8
    v_exp_f32 v9, v9
    v_exp_f32 v10, v10
    v_exp_f32 v11, v11
    v_exp_f32 v12, v12
    v_exp_f32 v13, v13
    v_exp_f32 v14, v14
    v_exp_f32 v15, v15
    v_pk_add_f32 v[8:9], v[8:9], v[244:245]
    v_pk_add_f32 v[10:11], v[10:11], v[244:245]
    v_pk_add_f32 v[12:13], v[12:13], v[244:245]
    v_pk_add_f32 v[14:15], v[14:15], v[244:245]
    v_rcp_f32 v8, v8
    v_rcp_f32 v9, v9
    v_rcp_f32 v10, v10
    v_rcp_f32 v11, v11
    v_rcp_f32 v12, v12
    v_rcp_f32 v13, v13
    v_rcp_f32 v14, v14
    v_rcp_f32 v15, v15
    v_pk_mul_f32 v[88:89], v[8:9], v[88:89]
    v_pk_mul_f32 v[90:91], v[10:11], v[90:91]
    v_pk_mul_f32 v[92:93], v[12:13], v[92:93]
    v_pk_mul_f32 v[94:95], v[14:15], v[94:95]
    v_cvt_pk_bf16_f32 v16, v88, v89
    v_cvt_pk_bf16_f32 v17, v90, v91
    v_cvt_pk_bf16_f32 v18, v92, v93
    v_cvt_pk_bf16_f32 v19, v94, v95
    buffer_store_dwordx4 v[16:19], v251, s[4:7], s53 offen offset:1024 sc1
    s_add_u32 s53, s53, s22
    s_waitcnt vmcnt(7)
    v_lshlrev_b32 v28, 16, v208
    v_and_b32 v29, 0xffff0000, v208
    v_lshlrev_b32 v30, 16, v209
    v_and_b32 v31, 0xffff0000, v209
    v_lshlrev_b32 v32, 16, v210
    v_and_b32 v33, 0xffff0000, v210
    v_lshlrev_b32 v34, 16, v211
    v_and_b32 v35, 0xffff0000, v211
    v_pk_add_f32 v[96:97], v[96:97], v[28:29]
    v_pk_add_f32 v[98:99], v[98:99], v[30:31]
    v_pk_add_f32 v[100:101], v[100:101], v[32:33]
    v_pk_add_f32 v[102:103], v[102:103], v[34:35]
    v_pk_mul_f32 v[28:29], v[96:97], v[246:247]
    v_pk_mul_f32 v[30:31], v[98:99], v[246:247]
    v_pk_mul_f32 v[32:33], v[100:101], v[246:247]
    v_pk_mul_f32 v[34:35], v[102:103], v[246:247]
    v_exp_f32 v28, v28
    v_exp_f32 v29, v29
    v_exp_f32 v30, v30
    v_exp_f32 v31, v31
    v_exp_f32 v32, v32
    v_exp_f32 v33, v33
    v_exp_f32 v34, v34
    v_exp_f32 v35, v35
    v_pk_add_f32 v[28:29], v[28:29], v[244:245]
    v_pk_add_f32 v[30:31], v[30:31], v[244:245]
    v_pk_add_f32 v[32:33], v[32:33], v[244:245]
    v_pk_add_f32 v[34:35], v[34:35], v[244:245]
    v_rcp_f32 v28, v28
    v_rcp_f32 v29, v29
    v_rcp_f32 v30, v30
    v_rcp_f32 v31, v31
    v_rcp_f32 v32, v32
    v_rcp_f32 v33, v33
    v_rcp_f32 v34, v34
    v_rcp_f32 v35, v35
    v_pk_mul_f32 v[96:97], v[28:29], v[96:97]
    v_pk_mul_f32 v[98:99], v[30:31], v[98:99]
    v_pk_mul_f32 v[100:101], v[32:33], v[100:101]
    v_pk_mul_f32 v[102:103], v[34:35], v[102:103]
    v_cvt_pk_bf16_f32 v36, v96, v97
    v_cvt_pk_bf16_f32 v37, v98, v99
    v_cvt_pk_bf16_f32 v38, v100, v101
    v_cvt_pk_bf16_f32 v39, v102, v103
    buffer_store_dwordx4 v[36:39], v251, s[4:7], s53 offen offset:0 sc1
    s_waitcnt vmcnt(7)
    v_lshlrev_b32 v48, 16, v212
    v_and_b32 v49, 0xffff0000, v212
    v_lshlrev_b32 v50, 16, v213
    v_and_b32 v51, 0xffff0000, v213
    v_lshlrev_b32 v52, 16, v214
    v_and_b32 v53, 0xffff0000, v214
    v_lshlrev_b32 v54, 16, v215
    v_and_b32 v55, 0xffff0000, v215
    v_pk_add_f32 v[104:105], v[104:105], v[48:49]
    v_pk_add_f32 v[106:107], v[106:107], v[50:51]
    v_pk_add_f32 v[108:109], v[108:109], v[52:53]
    v_pk_add_f32 v[110:111], v[110:111], v[54:55]
    v_pk_mul_f32 v[48:49], v[104:105], v[246:247]
    v_pk_mul_f32 v[50:51], v[106:107], v[246:247]
    v_pk_mul_f32 v[52:53], v[108:109], v[246:247]
    v_pk_mul_f32 v[54:55], v[110:111], v[246:247]
    v_exp_f32 v48, v48
    v_exp_f32 v49, v49
    v_exp_f32 v50, v50
    v_exp_f32 v51, v51
    v_exp_f32 v52, v52
    v_exp_f32 v53, v53
    v_exp_f32 v54, v54
    v_exp_f32 v55, v55
    v_pk_add_f32 v[48:49], v[48:49], v[244:245]
    v_pk_add_f32 v[50:51], v[50:51], v[244:245]
    v_pk_add_f32 v[52:53], v[52:53], v[244:245]
    v_pk_add_f32 v[54:55], v[54:55], v[244:245]
    v_rcp_f32 v48, v48
    v_rcp_f32 v49, v49
    v_rcp_f32 v50, v50
    v_rcp_f32 v51, v51
    v_rcp_f32 v52, v52
    v_rcp_f32 v53, v53
    v_rcp_f32 v54, v54
    v_rcp_f32 v55, v55
    v_pk_mul_f32 v[104:105], v[48:49], v[104:105]
    v_pk_mul_f32 v[106:107], v[50:51], v[106:107]
    v_pk_mul_f32 v[108:109], v[52:53], v[108:109]
    v_pk_mul_f32 v[110:111], v[54:55], v[110:111]
    v_cvt_pk_bf16_f32 v56, v104, v105
    v_cvt_pk_bf16_f32 v57, v106, v107
    v_cvt_pk_bf16_f32 v58, v108, v109
    v_cvt_pk_bf16_f32 v59, v110, v111
    buffer_store_dwordx4 v[56:59], v251, s[4:7], s53 offen offset:1024 sc1
    s_add_u32 s53, s53, s22
    s_waitcnt vmcnt(7)
    v_lshlrev_b32 v8, 16, v216
    v_and_b32 v9, 0xffff0000, v216
    v_lshlrev_b32 v10, 16, v217
    v_and_b32 v11, 0xffff0000, v217
    v_lshlrev_b32 v12, 16, v218
    v_and_b32 v13, 0xffff0000, v218
    v_lshlrev_b32 v14, 16, v219
    v_and_b32 v15, 0xffff0000, v219
    v_pk_add_f32 v[112:113], v[112:113], v[8:9]
    v_pk_add_f32 v[114:115], v[114:115], v[10:11]
    v_pk_add_f32 v[116:117], v[116:117], v[12:13]
    v_pk_add_f32 v[118:119], v[118:119], v[14:15]
    v_pk_mul_f32 v[8:9], v[112:113], v[246:247]
    v_pk_mul_f32 v[10:11], v[114:115], v[246:247]
    v_pk_mul_f32 v[12:13], v[116:117], v[246:247]
    v_pk_mul_f32 v[14:15], v[118:119], v[246:247]
    v_exp_f32 v8, v8
    v_exp_f32 v9, v9
    v_exp_f32 v10, v10
    v_exp_f32 v11, v11
    v_exp_f32 v12, v12
    v_exp_f32 v13, v13
    v_exp_f32 v14, v14
    v_exp_f32 v15, v15
    v_pk_add_f32 v[8:9], v[8:9], v[244:245]
    v_pk_add_f32 v[10:11], v[10:11], v[244:245]
    v_pk_add_f32 v[12:13], v[12:13], v[244:245]
    v_pk_add_f32 v[14:15], v[14:15], v[244:245]
    v_rcp_f32 v8, v8
    v_rcp_f32 v9, v9
    v_rcp_f32 v10, v10
    v_rcp_f32 v11, v11
    v_rcp_f32 v12, v12
    v_rcp_f32 v13, v13
    v_rcp_f32 v14, v14
    v_rcp_f32 v15, v15
    v_pk_mul_f32 v[112:113], v[8:9], v[112:113]
    v_pk_mul_f32 v[114:115], v[10:11], v[114:115]
    v_pk_mul_f32 v[116:117], v[12:13], v[116:117]
    v_pk_mul_f32 v[118:119], v[14:15], v[118:119]
    v_cvt_pk_bf16_f32 v16, v112, v113
    v_cvt_pk_bf16_f32 v17, v114, v115
    v_cvt_pk_bf16_f32 v18, v116, v117
    v_cvt_pk_bf16_f32 v19, v118, v119
    buffer_store_dwordx4 v[16:19], v251, s[4:7], s53 offen offset:0 sc1
    s_waitcnt vmcnt(7)
    v_lshlrev_b32 v28, 16, v220
    v_and_b32 v29, 0xffff0000, v220
    v_lshlrev_b32 v30, 16, v221
    v_and_b32 v31, 0xffff0000, v221
    v_lshlrev_b32 v32, 16, v222
    v_and_b32 v33, 0xffff0000, v222
    v_lshlrev_b32 v34, 16, v223
    v_and_b32 v35, 0xffff0000, v223
    v_pk_add_f32 v[120:121], v[120:121], v[28:29]
    v_pk_add_f32 v[122:123], v[122:123], v[30:31]
    v_pk_add_f32 v[124:125], v[124:125], v[32:33]
    v_pk_add_f32 v[126:127], v[126:127], v[34:35]
    v_pk_mul_f32 v[28:29], v[120:121], v[246:247]
    v_pk_mul_f32 v[30:31], v[122:123], v[246:247]
    v_pk_mul_f32 v[32:33], v[124:125], v[246:247]
    v_pk_mul_f32 v[34:35], v[126:127], v[246:247]
    v_exp_f32 v28, v28
    v_exp_f32 v29, v29
    v_exp_f32 v30, v30
    v_exp_f32 v31, v31
    v_exp_f32 v32, v32
    v_exp_f32 v33, v33
    v_exp_f32 v34, v34
    v_exp_f32 v35, v35
    v_pk_add_f32 v[28:29], v[28:29], v[244:245]
    v_pk_add_f32 v[30:31], v[30:31], v[244:245]
    v_pk_add_f32 v[32:33], v[32:33], v[244:245]
    v_pk_add_f32 v[34:35], v[34:35], v[244:245]
    v_rcp_f32 v28, v28
    v_rcp_f32 v29, v29
    v_rcp_f32 v30, v30
    v_rcp_f32 v31, v31
    v_rcp_f32 v32, v32
    v_rcp_f32 v33, v33
    v_rcp_f32 v34, v34
    v_rcp_f32 v35, v35
    v_pk_mul_f32 v[120:121], v[28:29], v[120:121]
    v_pk_mul_f32 v[122:123], v[30:31], v[122:123]
    v_pk_mul_f32 v[124:125], v[32:33], v[124:125]
    v_pk_mul_f32 v[126:127], v[34:35], v[126:127]
    v_cvt_pk_bf16_f32 v36, v120, v121
    v_cvt_pk_bf16_f32 v37, v122, v123
    v_cvt_pk_bf16_f32 v38, v124, v125
    v_cvt_pk_bf16_f32 v39, v126, v127
    buffer_store_dwordx4 v[36:39], v251, s[4:7], s53 offen offset:1024 sc1
    s_branch main_kernel_w_done
main_kernel_w_c0_efin:
    s_mov_b32 s53, s21
    s_add_u32 s32, s21, 0
    buffer_load_dwordx4 v[160:163], v252, s[96:99], s32 offen offset:0
    buffer_load_dwordx4 v[164:167], v252, s[96:99], s32 offen offset:64
    s_add_u32 s32, s21, 32768
    buffer_load_dwordx4 v[168:171], v252, s[96:99], s32 offen offset:0
    buffer_load_dwordx4 v[172:175], v252, s[96:99], s32 offen offset:64
    s_add_u32 s32, s21, 65536
    buffer_load_dwordx4 v[176:179], v252, s[96:99], s32 offen offset:0
    buffer_load_dwordx4 v[180:183], v252, s[96:99], s32 offen offset:64
    s_add_u32 s32, s21, 98304
    buffer_load_dwordx4 v[184:187], v252, s[96:99], s32 offen offset:0
    buffer_load_dwordx4 v[188:191], v252, s[96:99], s32 offen offset:64
    s_waitcnt vmcnt(7)
    v_permlane16_swap_b32 v160, v162
    v_permlane16_swap_b32 v161, v163
    v_lshlrev_b32 v8, 16, v192
    v_and_b32 v9, 0xffff0000, v192
    v_lshlrev_b32 v10, 16, v193
    v_and_b32 v11, 0xffff0000, v193
    v_lshlrev_b32 v12, 16, v194
    v_and_b32 v13, 0xffff0000, v194
    v_lshlrev_b32 v14, 16, v195
    v_and_b32 v15, 0xffff0000, v195
    v_permlane32_swap_b32 v160, v162
    v_permlane32_swap_b32 v161, v163
    v_lshlrev_b32 v16, 16, v160
    v_and_b32 v17, 0xffff0000, v160
    v_lshlrev_b32 v18, 16, v161
    v_and_b32 v19, 0xffff0000, v161
    v_lshlrev_b32 v20, 16, v162
    v_and_b32 v21, 0xffff0000, v162
    v_lshlrev_b32 v22, 16, v163
    v_and_b32 v23, 0xffff0000, v163
    v_pk_fma_f32 v[8:9], v[64:65], v[8:9], v[16:17]
    v_pk_fma_f32 v[10:11], v[66:67], v[10:11], v[18:19]
    v_pk_fma_f32 v[12:13], v[68:69], v[12:13], v[20:21]
    v_pk_fma_f32 v[14:15], v[70:71], v[14:15], v[22:23]
    v_cvt_pk_bf16_f32 v24, v8, v9
    v_cvt_pk_bf16_f32 v25, v10, v11
    v_cvt_pk_bf16_f32 v26, v12, v13
    v_cvt_pk_bf16_f32 v27, v14, v15
    s_nop 0
    v_permlane32_swap_b32 v24, v26
    v_permlane32_swap_b32 v25, v27
    s_nop 0
    v_permlane16_swap_b32 v24, v26
    v_permlane16_swap_b32 v25, v27
    buffer_store_dwordx4 v[24:27], v252, s[92:95], s53 offen offset:0 sc1
    s_waitcnt vmcnt(7)
    v_permlane16_swap_b32 v164, v166
    v_permlane16_swap_b32 v165, v167
    v_lshlrev_b32 v36, 16, v196
    v_and_b32 v37, 0xffff0000, v196
    v_lshlrev_b32 v38, 16, v197
    v_and_b32 v39, 0xffff0000, v197
    v_lshlrev_b32 v40, 16, v198
    v_and_b32 v41, 0xffff0000, v198
    v_lshlrev_b32 v42, 16, v199
    v_and_b32 v43, 0xffff0000, v199
    v_permlane32_swap_b32 v164, v166
    v_permlane32_swap_b32 v165, v167
    v_lshlrev_b32 v44, 16, v164
    v_and_b32 v45, 0xffff0000, v164
    v_lshlrev_b32 v46, 16, v165
    v_and_b32 v47, 0xffff0000, v165
    v_lshlrev_b32 v48, 16, v166
    v_and_b32 v49, 0xffff0000, v166
    v_lshlrev_b32 v50, 16, v167
    v_and_b32 v51, 0xffff0000, v167
    v_pk_fma_f32 v[36:37], v[72:73], v[36:37], v[44:45]
    v_pk_fma_f32 v[38:39], v[74:75], v[38:39], v[46:47]
    v_pk_fma_f32 v[40:41], v[76:77], v[40:41], v[48:49]
    v_pk_fma_f32 v[42:43], v[78:79], v[42:43], v[50:51]
    v_cvt_pk_bf16_f32 v52, v36, v37
    v_cvt_pk_bf16_f32 v53, v38, v39
    v_cvt_pk_bf16_f32 v54, v40, v41
    v_cvt_pk_bf16_f32 v55, v42, v43
    s_nop 0
    v_permlane32_swap_b32 v52, v54
    v_permlane32_swap_b32 v53, v55
    s_nop 0
    v_permlane16_swap_b32 v52, v54
    v_permlane16_swap_b32 v53, v55
    buffer_store_dwordx4 v[52:55], v252, s[92:95], s53 offen offset:64 sc1
    s_add_u32 s53, s53, 32768
    s_waitcnt vmcnt(7)
    v_permlane16_swap_b32 v168, v170
    v_permlane16_swap_b32 v169, v171
    v_lshlrev_b32 v8, 16, v200
    v_and_b32 v9, 0xffff0000, v200
    v_lshlrev_b32 v10, 16, v201
    v_and_b32 v11, 0xffff0000, v201
    v_lshlrev_b32 v12, 16, v202
    v_and_b32 v13, 0xffff0000, v202
    v_lshlrev_b32 v14, 16, v203
    v_and_b32 v15, 0xffff0000, v203
    v_permlane32_swap_b32 v168, v170
    v_permlane32_swap_b32 v169, v171
    v_lshlrev_b32 v16, 16, v168
    v_and_b32 v17, 0xffff0000, v168
    v_lshlrev_b32 v18, 16, v169
    v_and_b32 v19, 0xffff0000, v169
    v_lshlrev_b32 v20, 16, v170
    v_and_b32 v21, 0xffff0000, v170
    v_lshlrev_b32 v22, 16, v171
    v_and_b32 v23, 0xffff0000, v171
    v_pk_fma_f32 v[8:9], v[80:81], v[8:9], v[16:17]
    v_pk_fma_f32 v[10:11], v[82:83], v[10:11], v[18:19]
    v_pk_fma_f32 v[12:13], v[84:85], v[12:13], v[20:21]
    v_pk_fma_f32 v[14:15], v[86:87], v[14:15], v[22:23]
    v_cvt_pk_bf16_f32 v24, v8, v9
    v_cvt_pk_bf16_f32 v25, v10, v11
    v_cvt_pk_bf16_f32 v26, v12, v13
    v_cvt_pk_bf16_f32 v27, v14, v15
    s_nop 0
    v_permlane32_swap_b32 v24, v26
    v_permlane32_swap_b32 v25, v27
    s_nop 0
    v_permlane16_swap_b32 v24, v26
    v_permlane16_swap_b32 v25, v27
    buffer_store_dwordx4 v[24:27], v252, s[92:95], s53 offen offset:0 sc1
    s_waitcnt vmcnt(7)
    v_permlane16_swap_b32 v172, v174
    v_permlane16_swap_b32 v173, v175
    v_lshlrev_b32 v36, 16, v204
    v_and_b32 v37, 0xffff0000, v204
    v_lshlrev_b32 v38, 16, v205
    v_and_b32 v39, 0xffff0000, v205
    v_lshlrev_b32 v40, 16, v206
    v_and_b32 v41, 0xffff0000, v206
    v_lshlrev_b32 v42, 16, v207
    v_and_b32 v43, 0xffff0000, v207
    v_permlane32_swap_b32 v172, v174
    v_permlane32_swap_b32 v173, v175
    v_lshlrev_b32 v44, 16, v172
    v_and_b32 v45, 0xffff0000, v172
    v_lshlrev_b32 v46, 16, v173
    v_and_b32 v47, 0xffff0000, v173
    v_lshlrev_b32 v48, 16, v174
    v_and_b32 v49, 0xffff0000, v174
    v_lshlrev_b32 v50, 16, v175
    v_and_b32 v51, 0xffff0000, v175
    v_pk_fma_f32 v[36:37], v[88:89], v[36:37], v[44:45]
    v_pk_fma_f32 v[38:39], v[90:91], v[38:39], v[46:47]
    v_pk_fma_f32 v[40:41], v[92:93], v[40:41], v[48:49]
    v_pk_fma_f32 v[42:43], v[94:95], v[42:43], v[50:51]
    v_cvt_pk_bf16_f32 v52, v36, v37
    v_cvt_pk_bf16_f32 v53, v38, v39
    v_cvt_pk_bf16_f32 v54, v40, v41
    v_cvt_pk_bf16_f32 v55, v42, v43
    s_nop 0
    v_permlane32_swap_b32 v52, v54
    v_permlane32_swap_b32 v53, v55
    s_nop 0
    v_permlane16_swap_b32 v52, v54
    v_permlane16_swap_b32 v53, v55
    buffer_store_dwordx4 v[52:55], v252, s[92:95], s53 offen offset:64 sc1
    s_add_u32 s53, s53, 32768
    s_waitcnt vmcnt(7)
    v_permlane16_swap_b32 v176, v178
    v_permlane16_swap_b32 v177, v179
    v_lshlrev_b32 v8, 16, v208
    v_and_b32 v9, 0xffff0000, v208
    v_lshlrev_b32 v10, 16, v209
    v_and_b32 v11, 0xffff0000, v209
    v_lshlrev_b32 v12, 16, v210
    v_and_b32 v13, 0xffff0000, v210
    v_lshlrev_b32 v14, 16, v211
    v_and_b32 v15, 0xffff0000, v211
    v_permlane32_swap_b32 v176, v178
    v_permlane32_swap_b32 v177, v179
    v_lshlrev_b32 v16, 16, v176
    v_and_b32 v17, 0xffff0000, v176
    v_lshlrev_b32 v18, 16, v177
    v_and_b32 v19, 0xffff0000, v177
    v_lshlrev_b32 v20, 16, v178
    v_and_b32 v21, 0xffff0000, v178
    v_lshlrev_b32 v22, 16, v179
    v_and_b32 v23, 0xffff0000, v179
    v_pk_fma_f32 v[8:9], v[96:97], v[8:9], v[16:17]
    v_pk_fma_f32 v[10:11], v[98:99], v[10:11], v[18:19]
    v_pk_fma_f32 v[12:13], v[100:101], v[12:13], v[20:21]
    v_pk_fma_f32 v[14:15], v[102:103], v[14:15], v[22:23]
    v_cvt_pk_bf16_f32 v24, v8, v9
    v_cvt_pk_bf16_f32 v25, v10, v11
    v_cvt_pk_bf16_f32 v26, v12, v13
    v_cvt_pk_bf16_f32 v27, v14, v15
    s_nop 0
    v_permlane32_swap_b32 v24, v26
    v_permlane32_swap_b32 v25, v27
    s_nop 0
    v_permlane16_swap_b32 v24, v26
    v_permlane16_swap_b32 v25, v27
    buffer_store_dwordx4 v[24:27], v252, s[92:95], s53 offen offset:0 sc1
    s_waitcnt vmcnt(7)
    v_permlane16_swap_b32 v180, v182
    v_permlane16_swap_b32 v181, v183
    v_lshlrev_b32 v36, 16, v212
    v_and_b32 v37, 0xffff0000, v212
    v_lshlrev_b32 v38, 16, v213
    v_and_b32 v39, 0xffff0000, v213
    v_lshlrev_b32 v40, 16, v214
    v_and_b32 v41, 0xffff0000, v214
    v_lshlrev_b32 v42, 16, v215
    v_and_b32 v43, 0xffff0000, v215
    v_permlane32_swap_b32 v180, v182
    v_permlane32_swap_b32 v181, v183
    v_lshlrev_b32 v44, 16, v180
    v_and_b32 v45, 0xffff0000, v180
    v_lshlrev_b32 v46, 16, v181
    v_and_b32 v47, 0xffff0000, v181
    v_lshlrev_b32 v48, 16, v182
    v_and_b32 v49, 0xffff0000, v182
    v_lshlrev_b32 v50, 16, v183
    v_and_b32 v51, 0xffff0000, v183
    v_pk_fma_f32 v[36:37], v[104:105], v[36:37], v[44:45]
    v_pk_fma_f32 v[38:39], v[106:107], v[38:39], v[46:47]
    v_pk_fma_f32 v[40:41], v[108:109], v[40:41], v[48:49]
    v_pk_fma_f32 v[42:43], v[110:111], v[42:43], v[50:51]
    v_cvt_pk_bf16_f32 v52, v36, v37
    v_cvt_pk_bf16_f32 v53, v38, v39
    v_cvt_pk_bf16_f32 v54, v40, v41
    v_cvt_pk_bf16_f32 v55, v42, v43
    s_nop 0
    v_permlane32_swap_b32 v52, v54
    v_permlane32_swap_b32 v53, v55
    s_nop 0
    v_permlane16_swap_b32 v52, v54
    v_permlane16_swap_b32 v53, v55
    buffer_store_dwordx4 v[52:55], v252, s[92:95], s53 offen offset:64 sc1
    s_add_u32 s53, s53, 32768
    s_waitcnt vmcnt(7)
    v_permlane16_swap_b32 v184, v186
    v_permlane16_swap_b32 v185, v187
    v_lshlrev_b32 v8, 16, v216
    v_and_b32 v9, 0xffff0000, v216
    v_lshlrev_b32 v10, 16, v217
    v_and_b32 v11, 0xffff0000, v217
    v_lshlrev_b32 v12, 16, v218
    v_and_b32 v13, 0xffff0000, v218
    v_lshlrev_b32 v14, 16, v219
    v_and_b32 v15, 0xffff0000, v219
    v_permlane32_swap_b32 v184, v186
    v_permlane32_swap_b32 v185, v187
    v_lshlrev_b32 v16, 16, v184
    v_and_b32 v17, 0xffff0000, v184
    v_lshlrev_b32 v18, 16, v185
    v_and_b32 v19, 0xffff0000, v185
    v_lshlrev_b32 v20, 16, v186
    v_and_b32 v21, 0xffff0000, v186
    v_lshlrev_b32 v22, 16, v187
    v_and_b32 v23, 0xffff0000, v187
    v_pk_fma_f32 v[8:9], v[112:113], v[8:9], v[16:17]
    v_pk_fma_f32 v[10:11], v[114:115], v[10:11], v[18:19]
    v_pk_fma_f32 v[12:13], v[116:117], v[12:13], v[20:21]
    v_pk_fma_f32 v[14:15], v[118:119], v[14:15], v[22:23]
    v_cvt_pk_bf16_f32 v24, v8, v9
    v_cvt_pk_bf16_f32 v25, v10, v11
    v_cvt_pk_bf16_f32 v26, v12, v13
    v_cvt_pk_bf16_f32 v27, v14, v15
    s_nop 0
    v_permlane32_swap_b32 v24, v26
    v_permlane32_swap_b32 v25, v27
    s_nop 0
    v_permlane16_swap_b32 v24, v26
    v_permlane16_swap_b32 v25, v27
    buffer_store_dwordx4 v[24:27], v252, s[92:95], s53 offen offset:0 sc1
    s_waitcnt vmcnt(7)
    v_permlane16_swap_b32 v188, v190
    v_permlane16_swap_b32 v189, v191
    v_lshlrev_b32 v36, 16, v220
    v_and_b32 v37, 0xffff0000, v220
    v_lshlrev_b32 v38, 16, v221
    v_and_b32 v39, 0xffff0000, v221
    v_lshlrev_b32 v40, 16, v222
    v_and_b32 v41, 0xffff0000, v222
    v_lshlrev_b32 v42, 16, v223
    v_and_b32 v43, 0xffff0000, v223
    v_permlane32_swap_b32 v188, v190
    v_permlane32_swap_b32 v189, v191
    v_lshlrev_b32 v44, 16, v188
    v_and_b32 v45, 0xffff0000, v188
    v_lshlrev_b32 v46, 16, v189
    v_and_b32 v47, 0xffff0000, v189
    v_lshlrev_b32 v48, 16, v190
    v_and_b32 v49, 0xffff0000, v190
    v_lshlrev_b32 v50, 16, v191
    v_and_b32 v51, 0xffff0000, v191
    v_pk_fma_f32 v[36:37], v[120:121], v[36:37], v[44:45]
    v_pk_fma_f32 v[38:39], v[122:123], v[38:39], v[46:47]
    v_pk_fma_f32 v[40:41], v[124:125], v[40:41], v[48:49]
    v_pk_fma_f32 v[42:43], v[126:127], v[42:43], v[50:51]
    v_cvt_pk_bf16_f32 v52, v36, v37
    v_cvt_pk_bf16_f32 v53, v38, v39
    v_cvt_pk_bf16_f32 v54, v40, v41
    v_cvt_pk_bf16_f32 v55, v42, v43
    s_nop 0
    v_permlane32_swap_b32 v52, v54
    v_permlane32_swap_b32 v53, v55
    s_nop 0
    v_permlane16_swap_b32 v52, v54
    v_permlane16_swap_b32 v53, v55
    buffer_store_dwordx4 v[52:55], v252, s[92:95], s53 offen offset:64 sc1
    s_branch main_kernel_w_done
main_kernel_w_c0_gov:
    v_lshrrev_b32 v0, 4, v250
    v_bfe_u32 v1, v250, 2, 2
    v_lshl_add_u32 v4, v0, 2, v1
    v_and_b32 v5, 7, v4
    v_mul_u32_u24 v4, 256, v4
    v_and_b32 v6, 3, v250
    v_lshl_add_u32 v4, v6, 3, v4
    s_mul_i32 s32, s37, 4
    v_xor_b32 v5, s32, v5
    v_lshl_add_u32 v128, v5, 5, v4
    v_xor_b32 v129, 32, v128
    v_xor_b32 v130, 64, v128
    v_xor_b32 v131, 96, v128
    s_mul_i32 s32, s38, 8192
    s_add_u32 s32, s32, 65536
    v_add_u32 v136, s32, v251
    v_lshrrev_b32 v2, 4, v250
    v_and_b32 v3, 15, v250
    s_mul_i32 s32, s14, 16
    v_add_u32 v4, s32, v2
    v_add_u32 v5, 0, v4
    v_and_b32 v6, 7, v5
    v_lshlrev_b32 v6, 1, v6
    v_xor_b32 v6, v6, v3
    v_mul_lo_u32 v5, v5, s30
    v_lshl_add_u32 v5, v6, 4, v5
    v_subrev_u32 v137, 0, v5
    v_add_u32 v5, 4, v4
    v_and_b32 v6, 7, v5
    v_lshlrev_b32 v6, 1, v6
    v_xor_b32 v6, v6, v3
    v_mul_lo_u32 v5, v5, s30
    v_lshl_add_u32 v5, v6, 4, v5
    v_subrev_u32 v138, 1024, v5
    v_add_u32 v5, 8, v4
    v_and_b32 v6, 7, v5
    v_lshlrev_b32 v6, 1, v6
    v_xor_b32 v6, v6, v3
    v_mul_lo_u32 v5, v5, s30
    v_lshl_add_u32 v5, v6, 4, v5
    v_subrev_u32 v139, 2048, v5
    v_add_u32 v5, 12, v4
    v_and_b32 v6, 7, v5
    v_lshlrev_b32 v6, 1, v6
    v_xor_b32 v6, v6, v3
    v_mul_lo_u32 v5, v5, s30
    v_lshl_add_u32 v5, v6, 4, v5
    v_subrev_u32 v140, 3072, v5
    s_mul_i32 s32, s14, 2
    s_mul_i32 s32, s32, s31
    v_add_u32 v141, s32, v251
    s_add_u32 s32, s32, s31
    s_sub_u32 s32, s32, 2048
    v_add_u32 v142, s32, v251
    s_mul_i32 s19, s14, 4096
    s_mul_i32 s20, s14, 4096
    s_add_u32 s20, s20, 65536
    s_mul_i32 s17, s30, 64
    s_mov_b32 s15, 0
    s_add_u32 m0, s20, 0
    s_nop 0
    buffer_load_dwordx4 v141, s[4:7], s16 offen offset:0 sc1 lds
    buffer_load_dwordx4 v141, s[4:7], s16 offen offset:1024 sc1 lds
    buffer_load_dwordx4 v142, s[4:7], s16 offen offset:2048 sc1 lds
    buffer_load_dwordx4 v142, s[4:7], s16 offen offset:3072 sc1 lds
    s_add_u32 s16, s16, 2048
    s_add_u32 m0, s19, 0
    s_nop 0
    buffer_load_dwordx4 v137, s[8:11], s15 offen offset:0 lds
    buffer_load_dwordx4 v138, s[8:11], s15 offen offset:1024 lds
    buffer_load_dwordx4 v139, s[8:11], s15 offen offset:2048 lds
    buffer_load_dwordx4 v140, s[8:11], s15 offen offset:3072 lds
    s_add_u32 s15, s15, s17
    s_add_u32 m0, s20, 16384
    s_nop 0
    buffer_load_dwordx4 v141, s[4:7], s16 offen offset:0 sc1 lds
    buffer_load_dwordx4 v141, s[4:7], s16 offen offset:1024 sc1 lds
    buffer_load_dwordx4 v142, s[4:7], s16 offen offset:2048 sc1 lds
    buffer_load_dwordx4 v142, s[4:7], s16 offen offset:3072 sc1 lds
    s_add_u32 s16, s16, 2048
    s_add_u32 m0, s19, 16384
    s_nop 0
    buffer_load_dwordx4 v137, s[8:11], s15 offen offset:0 lds
    buffer_load_dwordx4 v138, s[8:11], s15 offen offset:1024 lds
    buffer_load_dwordx4 v139, s[8:11], s15 offen offset:2048 lds
    buffer_load_dwordx4 v140, s[8:11], s15 offen offset:3072 lds
    s_add_u32 s15, s15, s17
    s_add_u32 m0, s20, 32768
    s_nop 0
    buffer_load_dwordx4 v141, s[4:7], s16 offen offset:0 sc1 lds
    buffer_load_dwordx4 v141, s[4:7], s16 offen offset:1024 sc1 lds
    buffer_load_dwordx4 v142, s[4:7], s16 offen offset:2048 sc1 lds
    buffer_load_dwordx4 v142, s[4:7], s16 offen offset:3072 sc1 lds
    s_add_u32 s16, s16, 2048
    s_add_u32 m0, s19, 32768
    s_nop 0
    buffer_load_dwordx4 v137, s[8:11], s15 offen offset:0 lds
    buffer_load_dwordx4 v138, s[8:11], s15 offen offset:1024 lds
    buffer_load_dwordx4 v139, s[8:11], s15 offen offset:2048 lds
    buffer_load_dwordx4 v140, s[8:11], s15 offen offset:3072 lds
    s_add_u32 s15, s15, s17
    s_add_u32 m0, s20, 49152
    s_nop 0
    buffer_load_dwordx4 v141, s[4:7], s16 offen offset:0 sc1 lds
    buffer_load_dwordx4 v141, s[4:7], s16 offen offset:1024 sc1 lds
    buffer_load_dwordx4 v142, s[4:7], s16 offen offset:2048 sc1 lds
    buffer_load_dwordx4 v142, s[4:7], s16 offen offset:3072 sc1 lds
    s_add_u32 s16, s16, 2048
    v_mov_b32 v64, 0
    v_mov_b32 v65, 0
    v_mov_b32 v66, 0
    v_mov_b32 v67, 0
    v_mov_b32 v68, 0
    v_mov_b32 v69, 0
    v_mov_b32 v70, 0
    v_mov_b32 v71, 0
    v_mov_b32 v72, 0
    v_mov_b32 v73, 0
    v_mov_b32 v74, 0
    v_mov_b32 v75, 0
    v_mov_b32 v76, 0
    v_mov_b32 v77, 0
    v_mov_b32 v78, 0
    v_mov_b32 v79, 0
    v_mov_b32 v80, 0
    v_mov_b32 v81, 0
    v_mov_b32 v82, 0
    v_mov_b32 v83, 0
    v_mov_b32 v84, 0
    v_mov_b32 v85, 0
    v_mov_b32 v86, 0
    v_mov_b32 v87, 0
    v_mov_b32 v88, 0
    v_mov_b32 v89, 0
    v_mov_b32 v90, 0
    v_mov_b32 v91, 0
    v_mov_b32 v92, 0
    v_mov_b32 v93, 0
    v_mov_b32 v94, 0
    v_mov_b32 v95, 0
    v_mov_b32 v96, 0
    v_mov_b32 v97, 0
    v_mov_b32 v98, 0
    v_mov_b32 v99, 0
    v_mov_b32 v100, 0
    v_mov_b32 v101, 0
    v_mov_b32 v102, 0
    v_mov_b32 v103, 0
    v_mov_b32 v104, 0
    v_mov_b32 v105, 0
    v_mov_b32 v106, 0
    v_mov_b32 v107, 0
    v_mov_b32 v108, 0
    v_mov_b32 v109, 0
    v_mov_b32 v110, 0
    v_mov_b32 v111, 0
    v_mov_b32 v112, 0
    v_mov_b32 v113, 0
    v_mov_b32 v114, 0
    v_mov_b32 v115, 0
    v_mov_b32 v116, 0
    v_mov_b32 v117, 0
    v_mov_b32 v118, 0
    v_mov_b32 v119, 0
    v_mov_b32 v120, 0
    v_mov_b32 v121, 0
    v_mov_b32 v122, 0
    v_mov_b32 v123, 0
    v_mov_b32 v124, 0
    v_mov_b32 v125, 0
    v_mov_b32 v126, 0
    v_mov_b32 v127, 0
    s_waitcnt vmcnt(20)
    s_barrier
    ds_read_b128 v[16:19], v136 offset:0
    ds_read_b64_tr_b16 v[0:1], v128 offset:0
    ds_read_b64_tr_b16 v[2:3], v128 offset:4096
    ds_read_b64_tr_b16 v[4:5], v129 offset:0
    ds_read_b64_tr_b16 v[6:7], v129 offset:4096
    ds_read_b64_tr_b16 v[8:9], v130 offset:0
    ds_read_b64_tr_b16 v[10:11], v130 offset:4096
    ds_read_b64_tr_b16 v[12:13], v131 offset:0
    ds_read_b64_tr_b16 v[14:15], v131 offset:4096
    ds_read_b128 v[20:23], v136 offset:2048
    ds_read_b128 v[24:27], v136 offset:4096
    ds_read_b128 v[28:31], v136 offset:6144
main_kernel_w_c0_v_loop:
    s_waitcnt lgkmcnt(0)
    ds_read_b128 v[48:51], v136 offset:1024
    s_add_u32 m0, s19, 49152
    s_nop 0
    v_mfma_f32_16x16x32_bf16 v[64:67], v[16:19], v[0:3], v[64:67]
    ds_read_b64_tr_b16 v[32:33], v128 offset:8192
    v_mfma_f32_16x16x32_bf16 v[68:71], v[16:19], v[4:7], v[68:71]
    ds_read_b64_tr_b16 v[34:35], v128 offset:12288
    buffer_load_dwordx4 v137, s[8:11], s15 offen offset:0 lds
    v_mfma_f32_16x16x32_bf16 v[72:75], v[16:19], v[8:11], v[72:75]
    ds_read_b64_tr_b16 v[36:37], v129 offset:8192
    v_mfma_f32_16x16x32_bf16 v[76:79], v[16:19], v[12:15], v[76:79]
    ds_read_b64_tr_b16 v[38:39], v129 offset:12288
    v_mfma_f32_16x16x32_bf16 v[80:83], v[20:23], v[0:3], v[80:83]
    ds_read_b64_tr_b16 v[40:41], v130 offset:8192
    buffer_load_dwordx4 v138, s[8:11], s15 offen offset:1024 lds
    v_mfma_f32_16x16x32_bf16 v[84:87], v[20:23], v[4:7], v[84:87]
    ds_read_b64_tr_b16 v[42:43], v130 offset:12288
    v_mfma_f32_16x16x32_bf16 v[88:91], v[20:23], v[8:11], v[88:91]
    ds_read_b64_tr_b16 v[44:45], v131 offset:8192
    v_mfma_f32_16x16x32_bf16 v[92:95], v[20:23], v[12:15], v[92:95]
    ds_read_b64_tr_b16 v[46:47], v131 offset:12288
    buffer_load_dwordx4 v139, s[8:11], s15 offen offset:2048 lds
    v_mfma_f32_16x16x32_bf16 v[96:99], v[24:27], v[0:3], v[96:99]
    ds_read_b128 v[52:55], v136 offset:3072
    v_mfma_f32_16x16x32_bf16 v[100:103], v[24:27], v[4:7], v[100:103]
    ds_read_b128 v[56:59], v136 offset:5120
    buffer_load_dwordx4 v140, s[8:11], s15 offen offset:3072 lds
    v_mfma_f32_16x16x32_bf16 v[104:107], v[24:27], v[8:11], v[104:107]
    ds_read_b128 v[60:63], v136 offset:7168
    v_mfma_f32_16x16x32_bf16 v[108:111], v[24:27], v[12:15], v[108:111]
    v_mfma_f32_16x16x32_bf16 v[112:115], v[28:31], v[0:3], v[112:115]
    s_add_u32 s15, s15, s17
    v_mfma_f32_16x16x32_bf16 v[116:119], v[28:31], v[4:7], v[116:119]
    v_mfma_f32_16x16x32_bf16 v[120:123], v[28:31], v[8:11], v[120:123]
    v_mfma_f32_16x16x32_bf16 v[124:127], v[28:31], v[12:15], v[124:127]
    s_waitcnt lgkmcnt(0)
    v_mfma_f32_16x16x32_bf16 v[64:67], v[48:51], v[32:35], v[64:67]
    s_waitcnt vmcnt(16)
    s_barrier
    ds_read_b128 v[16:19], v136 offset:16384
    s_add_u32 m0, s20, 0
    s_nop 0
    v_mfma_f32_16x16x32_bf16 v[68:71], v[48:51], v[36:39], v[68:71]
    ds_read_b64_tr_b16 v[0:1], v128 offset:16384
    v_mfma_f32_16x16x32_bf16 v[72:75], v[48:51], v[40:43], v[72:75]
    ds_read_b64_tr_b16 v[2:3], v128 offset:20480
    buffer_load_dwordx4 v141, s[4:7], s16 offen offset:0 sc1 lds
    v_mfma_f32_16x16x32_bf16 v[76:79], v[48:51], v[44:47], v[76:79]
    ds_read_b64_tr_b16 v[4:5], v129 offset:16384
    v_mfma_f32_16x16x32_bf16 v[80:83], v[52:55], v[32:35], v[80:83]
    ds_read_b64_tr_b16 v[6:7], v129 offset:20480
    v_mfma_f32_16x16x32_bf16 v[84:87], v[52:55], v[36:39], v[84:87]
    ds_read_b64_tr_b16 v[8:9], v130 offset:16384
    buffer_load_dwordx4 v141, s[4:7], s16 offen offset:1024 sc1 lds
    v_mfma_f32_16x16x32_bf16 v[88:91], v[52:55], v[40:43], v[88:91]
    ds_read_b64_tr_b16 v[10:11], v130 offset:20480
    v_mfma_f32_16x16x32_bf16 v[92:95], v[52:55], v[44:47], v[92:95]
    ds_read_b64_tr_b16 v[12:13], v131 offset:16384
    buffer_load_dwordx4 v142, s[4:7], s16 offen offset:2048 sc1 lds
    v_mfma_f32_16x16x32_bf16 v[96:99], v[56:59], v[32:35], v[96:99]
    ds_read_b64_tr_b16 v[14:15], v131 offset:20480
    v_mfma_f32_16x16x32_bf16 v[100:103], v[56:59], v[36:39], v[100:103]
    ds_read_b128 v[20:23], v136 offset:18432
    v_mfma_f32_16x16x32_bf16 v[104:107], v[56:59], v[40:43], v[104:107]
    ds_read_b128 v[24:27], v136 offset:20480
    buffer_load_dwordx4 v142, s[4:7], s16 offen offset:3072 sc1 lds
    v_mfma_f32_16x16x32_bf16 v[108:111], v[56:59], v[44:47], v[108:111]
    ds_read_b128 v[28:31], v136 offset:22528
    v_mfma_f32_16x16x32_bf16 v[112:115], v[60:63], v[32:35], v[112:115]
    s_add_u32 s16, s16, 2048
    v_mfma_f32_16x16x32_bf16 v[116:119], v[60:63], v[36:39], v[116:119]
    v_mfma_f32_16x16x32_bf16 v[120:123], v[60:63], v[40:43], v[120:123]
    v_mfma_f32_16x16x32_bf16 v[124:127], v[60:63], v[44:47], v[124:127]
    s_waitcnt lgkmcnt(0)
    ds_read_b128 v[48:51], v136 offset:17408
    s_add_u32 m0, s19, 0
    s_nop 0
    v_mfma_f32_16x16x32_bf16 v[64:67], v[16:19], v[0:3], v[64:67]
    ds_read_b64_tr_b16 v[32:33], v128 offset:24576
    v_mfma_f32_16x16x32_bf16 v[68:71], v[16:19], v[4:7], v[68:71]
    ds_read_b64_tr_b16 v[34:35], v128 offset:28672
    buffer_load_dwordx4 v137, s[8:11], s15 offen offset:0 lds
    v_mfma_f32_16x16x32_bf16 v[72:75], v[16:19], v[8:11], v[72:75]
    ds_read_b64_tr_b16 v[36:37], v129 offset:24576
    v_mfma_f32_16x16x32_bf16 v[76:79], v[16:19], v[12:15], v[76:79]
    ds_read_b64_tr_b16 v[38:39], v129 offset:28672
    v_mfma_f32_16x16x32_bf16 v[80:83], v[20:23], v[0:3], v[80:83]
    ds_read_b64_tr_b16 v[40:41], v130 offset:24576
    buffer_load_dwordx4 v138, s[8:11], s15 offen offset:1024 lds
    v_mfma_f32_16x16x32_bf16 v[84:87], v[20:23], v[4:7], v[84:87]
    ds_read_b64_tr_b16 v[42:43], v130 offset:28672
    v_mfma_f32_16x16x32_bf16 v[88:91], v[20:23], v[8:11], v[88:91]
    ds_read_b64_tr_b16 v[44:45], v131 offset:24576
    v_mfma_f32_16x16x32_bf16 v[92:95], v[20:23], v[12:15], v[92:95]
    ds_read_b64_tr_b16 v[46:47], v131 offset:28672
    buffer_load_dwordx4 v139, s[8:11], s15 offen offset:2048 lds
    v_mfma_f32_16x16x32_bf16 v[96:99], v[24:27], v[0:3], v[96:99]
    ds_read_b128 v[52:55], v136 offset:19456
    v_mfma_f32_16x16x32_bf16 v[100:103], v[24:27], v[4:7], v[100:103]
    ds_read_b128 v[56:59], v136 offset:21504
    buffer_load_dwordx4 v140, s[8:11], s15 offen offset:3072 lds
    v_mfma_f32_16x16x32_bf16 v[104:107], v[24:27], v[8:11], v[104:107]
    ds_read_b128 v[60:63], v136 offset:23552
    v_mfma_f32_16x16x32_bf16 v[108:111], v[24:27], v[12:15], v[108:111]
    v_mfma_f32_16x16x32_bf16 v[112:115], v[28:31], v[0:3], v[112:115]
    s_add_u32 s15, s15, s17
    v_mfma_f32_16x16x32_bf16 v[116:119], v[28:31], v[4:7], v[116:119]
    v_mfma_f32_16x16x32_bf16 v[120:123], v[28:31], v[8:11], v[120:123]
    v_mfma_f32_16x16x32_bf16 v[124:127], v[28:31], v[12:15], v[124:127]
    s_waitcnt lgkmcnt(0)
    v_mfma_f32_16x16x32_bf16 v[64:67], v[48:51], v[32:35], v[64:67]
    s_waitcnt vmcnt(16)
    s_barrier
    ds_read_b128 v[16:19], v136 offset:32768
    s_add_u32 m0, s20, 16384
    s_nop 0
    v_mfma_f32_16x16x32_bf16 v[68:71], v[48:51], v[36:39], v[68:71]
    ds_read_b64_tr_b16 v[0:1], v128 offset:32768
    v_mfma_f32_16x16x32_bf16 v[72:75], v[48:51], v[40:43], v[72:75]
    ds_read_b64_tr_b16 v[2:3], v128 offset:36864
    buffer_load_dwordx4 v141, s[4:7], s16 offen offset:0 sc1 lds
    v_mfma_f32_16x16x32_bf16 v[76:79], v[48:51], v[44:47], v[76:79]
    ds_read_b64_tr_b16 v[4:5], v129 offset:32768
    v_mfma_f32_16x16x32_bf16 v[80:83], v[52:55], v[32:35], v[80:83]
    ds_read_b64_tr_b16 v[6:7], v129 offset:36864
    v_mfma_f32_16x16x32_bf16 v[84:87], v[52:55], v[36:39], v[84:87]
    ds_read_b64_tr_b16 v[8:9], v130 offset:32768
    buffer_load_dwordx4 v141, s[4:7], s16 offen offset:1024 sc1 lds
    v_mfma_f32_16x16x32_bf16 v[88:91], v[52:55], v[40:43], v[88:91]
    ds_read_b64_tr_b16 v[10:11], v130 offset:36864
    v_mfma_f32_16x16x32_bf16 v[92:95], v[52:55], v[44:47], v[92:95]
    ds_read_b64_tr_b16 v[12:13], v131 offset:32768
    buffer_load_dwordx4 v142, s[4:7], s16 offen offset:2048 sc1 lds
    v_mfma_f32_16x16x32_bf16 v[96:99], v[56:59], v[32:35], v[96:99]
    ds_read_b64_tr_b16 v[14:15], v131 offset:36864
    v_mfma_f32_16x16x32_bf16 v[100:103], v[56:59], v[36:39], v[100:103]
    ds_read_b128 v[20:23], v136 offset:34816
    v_mfma_f32_16x16x32_bf16 v[104:107], v[56:59], v[40:43], v[104:107]
    ds_read_b128 v[24:27], v136 offset:36864
    buffer_load_dwordx4 v142, s[4:7], s16 offen offset:3072 sc1 lds
    v_mfma_f32_16x16x32_bf16 v[108:111], v[56:59], v[44:47], v[108:111]
    ds_read_b128 v[28:31], v136 offset:38912
    v_mfma_f32_16x16x32_bf16 v[112:115], v[60:63], v[32:35], v[112:115]
    s_add_u32 s16, s16, 2048
    v_mfma_f32_16x16x32_bf16 v[116:119], v[60:63], v[36:39], v[116:119]
    v_mfma_f32_16x16x32_bf16 v[120:123], v[60:63], v[40:43], v[120:123]
    v_mfma_f32_16x16x32_bf16 v[124:127], v[60:63], v[44:47], v[124:127]
    s_waitcnt lgkmcnt(0)
    ds_read_b128 v[48:51], v136 offset:33792
    s_add_u32 m0, s19, 16384
    s_nop 0
    v_mfma_f32_16x16x32_bf16 v[64:67], v[16:19], v[0:3], v[64:67]
    ds_read_b64_tr_b16 v[32:33], v128 offset:40960
    v_mfma_f32_16x16x32_bf16 v[68:71], v[16:19], v[4:7], v[68:71]
    ds_read_b64_tr_b16 v[34:35], v128 offset:45056
    buffer_load_dwordx4 v137, s[8:11], s15 offen offset:0 lds
    v_mfma_f32_16x16x32_bf16 v[72:75], v[16:19], v[8:11], v[72:75]
    ds_read_b64_tr_b16 v[36:37], v129 offset:40960
    v_mfma_f32_16x16x32_bf16 v[76:79], v[16:19], v[12:15], v[76:79]
    ds_read_b64_tr_b16 v[38:39], v129 offset:45056
    v_mfma_f32_16x16x32_bf16 v[80:83], v[20:23], v[0:3], v[80:83]
    ds_read_b64_tr_b16 v[40:41], v130 offset:40960
    buffer_load_dwordx4 v138, s[8:11], s15 offen offset:1024 lds
    v_mfma_f32_16x16x32_bf16 v[84:87], v[20:23], v[4:7], v[84:87]
    ds_read_b64_tr_b16 v[42:43], v130 offset:45056
    v_mfma_f32_16x16x32_bf16 v[88:91], v[20:23], v[8:11], v[88:91]
    ds_read_b64_tr_b16 v[44:45], v131 offset:40960
    v_mfma_f32_16x16x32_bf16 v[92:95], v[20:23], v[12:15], v[92:95]
    ds_read_b64_tr_b16 v[46:47], v131 offset:45056
    buffer_load_dwordx4 v139, s[8:11], s15 offen offset:2048 lds
    v_mfma_f32_16x16x32_bf16 v[96:99], v[24:27], v[0:3], v[96:99]
    ds_read_b128 v[52:55], v136 offset:35840
    v_mfma_f32_16x16x32_bf16 v[100:103], v[24:27], v[4:7], v[100:103]
    ds_read_b128 v[56:59], v136 offset:37888
    buffer_load_dwordx4 v140, s[8:11], s15 offen offset:3072 lds
    v_mfma_f32_16x16x32_bf16 v[104:107], v[24:27], v[8:11], v[104:107]
    ds_read_b128 v[60:63], v136 offset:39936
    v_mfma_f32_16x16x32_bf16 v[108:111], v[24:27], v[12:15], v[108:111]
    v_mfma_f32_16x16x32_bf16 v[112:115], v[28:31], v[0:3], v[112:115]
    s_add_u32 s15, s15, s17
    v_mfma_f32_16x16x32_bf16 v[116:119], v[28:31], v[4:7], v[116:119]
    v_mfma_f32_16x16x32_bf16 v[120:123], v[28:31], v[8:11], v[120:123]
    v_mfma_f32_16x16x32_bf16 v[124:127], v[28:31], v[12:15], v[124:127]
    s_waitcnt lgkmcnt(0)
    v_mfma_f32_16x16x32_bf16 v[64:67], v[48:51], v[32:35], v[64:67]
    s_waitcnt vmcnt(16)
    s_barrier
    ds_read_b128 v[16:19], v136 offset:49152
    s_add_u32 m0, s20, 32768
    s_nop 0
    v_mfma_f32_16x16x32_bf16 v[68:71], v[48:51], v[36:39], v[68:71]
    ds_read_b64_tr_b16 v[0:1], v128 offset:49152
    v_mfma_f32_16x16x32_bf16 v[72:75], v[48:51], v[40:43], v[72:75]
    ds_read_b64_tr_b16 v[2:3], v128 offset:53248
    buffer_load_dwordx4 v141, s[4:7], s16 offen offset:0 sc1 lds
    v_mfma_f32_16x16x32_bf16 v[76:79], v[48:51], v[44:47], v[76:79]
    ds_read_b64_tr_b16 v[4:5], v129 offset:49152
    v_mfma_f32_16x16x32_bf16 v[80:83], v[52:55], v[32:35], v[80:83]
    ds_read_b64_tr_b16 v[6:7], v129 offset:53248
    v_mfma_f32_16x16x32_bf16 v[84:87], v[52:55], v[36:39], v[84:87]
    ds_read_b64_tr_b16 v[8:9], v130 offset:49152
    buffer_load_dwordx4 v141, s[4:7], s16 offen offset:1024 sc1 lds
    v_mfma_f32_16x16x32_bf16 v[88:91], v[52:55], v[40:43], v[88:91]
    ds_read_b64_tr_b16 v[10:11], v130 offset:53248
    v_mfma_f32_16x16x32_bf16 v[92:95], v[52:55], v[44:47], v[92:95]
    ds_read_b64_tr_b16 v[12:13], v131 offset:49152
    buffer_load_dwordx4 v142, s[4:7], s16 offen offset:2048 sc1 lds
    v_mfma_f32_16x16x32_bf16 v[96:99], v[56:59], v[32:35], v[96:99]
    ds_read_b64_tr_b16 v[14:15], v131 offset:53248
    v_mfma_f32_16x16x32_bf16 v[100:103], v[56:59], v[36:39], v[100:103]
    ds_read_b128 v[20:23], v136 offset:51200
    v_mfma_f32_16x16x32_bf16 v[104:107], v[56:59], v[40:43], v[104:107]
    ds_read_b128 v[24:27], v136 offset:53248
    buffer_load_dwordx4 v142, s[4:7], s16 offen offset:3072 sc1 lds
    v_mfma_f32_16x16x32_bf16 v[108:111], v[56:59], v[44:47], v[108:111]
    ds_read_b128 v[28:31], v136 offset:55296
    v_mfma_f32_16x16x32_bf16 v[112:115], v[60:63], v[32:35], v[112:115]
    s_add_u32 s16, s16, 2048
    v_mfma_f32_16x16x32_bf16 v[116:119], v[60:63], v[36:39], v[116:119]
    v_mfma_f32_16x16x32_bf16 v[120:123], v[60:63], v[40:43], v[120:123]
    v_mfma_f32_16x16x32_bf16 v[124:127], v[60:63], v[44:47], v[124:127]
    s_waitcnt lgkmcnt(0)
    ds_read_b128 v[48:51], v136 offset:50176
    s_add_u32 m0, s19, 32768
    s_nop 0
    v_mfma_f32_16x16x32_bf16 v[64:67], v[16:19], v[0:3], v[64:67]
    ds_read_b64_tr_b16 v[32:33], v128 offset:57344
    v_mfma_f32_16x16x32_bf16 v[68:71], v[16:19], v[4:7], v[68:71]
    ds_read_b64_tr_b16 v[34:35], v128 offset:61440
    buffer_load_dwordx4 v137, s[8:11], s15 offen offset:0 lds
    v_mfma_f32_16x16x32_bf16 v[72:75], v[16:19], v[8:11], v[72:75]
    ds_read_b64_tr_b16 v[36:37], v129 offset:57344
    v_mfma_f32_16x16x32_bf16 v[76:79], v[16:19], v[12:15], v[76:79]
    ds_read_b64_tr_b16 v[38:39], v129 offset:61440
    v_mfma_f32_16x16x32_bf16 v[80:83], v[20:23], v[0:3], v[80:83]
    ds_read_b64_tr_b16 v[40:41], v130 offset:57344
    buffer_load_dwordx4 v138, s[8:11], s15 offen offset:1024 lds
    v_mfma_f32_16x16x32_bf16 v[84:87], v[20:23], v[4:7], v[84:87]
    ds_read_b64_tr_b16 v[42:43], v130 offset:61440
    v_mfma_f32_16x16x32_bf16 v[88:91], v[20:23], v[8:11], v[88:91]
    ds_read_b64_tr_b16 v[44:45], v131 offset:57344
    v_mfma_f32_16x16x32_bf16 v[92:95], v[20:23], v[12:15], v[92:95]
    ds_read_b64_tr_b16 v[46:47], v131 offset:61440
    buffer_load_dwordx4 v139, s[8:11], s15 offen offset:2048 lds
    v_mfma_f32_16x16x32_bf16 v[96:99], v[24:27], v[0:3], v[96:99]
    ds_read_b128 v[52:55], v136 offset:52224
    v_mfma_f32_16x16x32_bf16 v[100:103], v[24:27], v[4:7], v[100:103]
    ds_read_b128 v[56:59], v136 offset:54272
    buffer_load_dwordx4 v140, s[8:11], s15 offen offset:3072 lds
    v_mfma_f32_16x16x32_bf16 v[104:107], v[24:27], v[8:11], v[104:107]
    ds_read_b128 v[60:63], v136 offset:56320
    v_mfma_f32_16x16x32_bf16 v[108:111], v[24:27], v[12:15], v[108:111]
    v_mfma_f32_16x16x32_bf16 v[112:115], v[28:31], v[0:3], v[112:115]
    s_add_u32 s15, s15, s17
    v_mfma_f32_16x16x32_bf16 v[116:119], v[28:31], v[4:7], v[116:119]
    v_mfma_f32_16x16x32_bf16 v[120:123], v[28:31], v[8:11], v[120:123]
    v_mfma_f32_16x16x32_bf16 v[124:127], v[28:31], v[12:15], v[124:127]
    s_waitcnt lgkmcnt(0)
    v_mfma_f32_16x16x32_bf16 v[64:67], v[48:51], v[32:35], v[64:67]
    s_waitcnt vmcnt(16)
    s_barrier
    ds_read_b128 v[16:19], v136 offset:0
    s_add_u32 m0, s20, 49152
    s_nop 0
    v_mfma_f32_16x16x32_bf16 v[68:71], v[48:51], v[36:39], v[68:71]
    ds_read_b64_tr_b16 v[0:1], v128 offset:0
    v_mfma_f32_16x16x32_bf16 v[72:75], v[48:51], v[40:43], v[72:75]
    ds_read_b64_tr_b16 v[2:3], v128 offset:4096
    buffer_load_dwordx4 v141, s[4:7], s16 offen offset:0 sc1 lds
    v_mfma_f32_16x16x32_bf16 v[76:79], v[48:51], v[44:47], v[76:79]
    ds_read_b64_tr_b16 v[4:5], v129 offset:0
    v_mfma_f32_16x16x32_bf16 v[80:83], v[52:55], v[32:35], v[80:83]
    ds_read_b64_tr_b16 v[6:7], v129 offset:4096
    v_mfma_f32_16x16x32_bf16 v[84:87], v[52:55], v[36:39], v[84:87]
    ds_read_b64_tr_b16 v[8:9], v130 offset:0
    buffer_load_dwordx4 v141, s[4:7], s16 offen offset:1024 sc1 lds
    v_mfma_f32_16x16x32_bf16 v[88:91], v[52:55], v[40:43], v[88:91]
    ds_read_b64_tr_b16 v[10:11], v130 offset:4096
    v_mfma_f32_16x16x32_bf16 v[92:95], v[52:55], v[44:47], v[92:95]
    ds_read_b64_tr_b16 v[12:13], v131 offset:0
    buffer_load_dwordx4 v142, s[4:7], s16 offen offset:2048 sc1 lds
    v_mfma_f32_16x16x32_bf16 v[96:99], v[56:59], v[32:35], v[96:99]
    ds_read_b64_tr_b16 v[14:15], v131 offset:4096
    v_mfma_f32_16x16x32_bf16 v[100:103], v[56:59], v[36:39], v[100:103]
    ds_read_b128 v[20:23], v136 offset:2048
    v_mfma_f32_16x16x32_bf16 v[104:107], v[56:59], v[40:43], v[104:107]
    ds_read_b128 v[24:27], v136 offset:4096
    buffer_load_dwordx4 v142, s[4:7], s16 offen offset:3072 sc1 lds
    v_mfma_f32_16x16x32_bf16 v[108:111], v[56:59], v[44:47], v[108:111]
    ds_read_b128 v[28:31], v136 offset:6144
    v_mfma_f32_16x16x32_bf16 v[112:115], v[60:63], v[32:35], v[112:115]
    s_add_u32 s16, s16, 2048
    v_mfma_f32_16x16x32_bf16 v[116:119], v[60:63], v[36:39], v[116:119]
    v_mfma_f32_16x16x32_bf16 v[120:123], v[60:63], v[40:43], v[120:123]
    v_mfma_f32_16x16x32_bf16 v[124:127], v[60:63], v[44:47], v[124:127]
    s_sub_u32 s18, s18, 1
    s_cmp_lg_u32 s18, 0
    s_cbranch_scc1 main_kernel_w_c0_v_loop
    s_cmp_lg_u32 s14, 0
    s_cbranch_scc1 main_kernel_w_c0_v_nt
    s_lshl_b32 s32, s27, 8
    s_add_u32 s32, s32, 0x841e000
    v_mov_b32 v255, 1
    s_mov_b64 exec, 1
    buffer_atomic_add v255, off, s[4:7], s32 sc0 sc1
    s_mov_b64 exec, -1
main_kernel_w_c0_v_nt:
    s_waitcnt lgkmcnt(0)
    ds_read_b128 v[48:51], v136 offset:1024
    s_add_u32 m0, s19, 49152
    s_nop 0
    v_mfma_f32_16x16x32_bf16 v[64:67], v[16:19], v[0:3], v[64:67]
    ds_read_b64_tr_b16 v[32:33], v128 offset:8192
    v_mfma_f32_16x16x32_bf16 v[68:71], v[16:19], v[4:7], v[68:71]
    ds_read_b64_tr_b16 v[34:35], v128 offset:12288
    buffer_load_dwordx4 v137, s[8:11], s15 offen offset:0 lds
    v_mfma_f32_16x16x32_bf16 v[72:75], v[16:19], v[8:11], v[72:75]
    ds_read_b64_tr_b16 v[36:37], v129 offset:8192
    v_mfma_f32_16x16x32_bf16 v[76:79], v[16:19], v[12:15], v[76:79]
    ds_read_b64_tr_b16 v[38:39], v129 offset:12288
    v_mfma_f32_16x16x32_bf16 v[80:83], v[20:23], v[0:3], v[80:83]
    ds_read_b64_tr_b16 v[40:41], v130 offset:8192
    buffer_load_dwordx4 v138, s[8:11], s15 offen offset:1024 lds
    v_mfma_f32_16x16x32_bf16 v[84:87], v[20:23], v[4:7], v[84:87]
    ds_read_b64_tr_b16 v[42:43], v130 offset:12288
    v_mfma_f32_16x16x32_bf16 v[88:91], v[20:23], v[8:11], v[88:91]
    ds_read_b64_tr_b16 v[44:45], v131 offset:8192
    v_mfma_f32_16x16x32_bf16 v[92:95], v[20:23], v[12:15], v[92:95]
    ds_read_b64_tr_b16 v[46:47], v131 offset:12288
    buffer_load_dwordx4 v139, s[8:11], s15 offen offset:2048 lds
    v_mfma_f32_16x16x32_bf16 v[96:99], v[24:27], v[0:3], v[96:99]
    ds_read_b128 v[52:55], v136 offset:3072
    v_mfma_f32_16x16x32_bf16 v[100:103], v[24:27], v[4:7], v[100:103]
    ds_read_b128 v[56:59], v136 offset:5120
    buffer_load_dwordx4 v140, s[8:11], s15 offen offset:3072 lds
    v_mfma_f32_16x16x32_bf16 v[104:107], v[24:27], v[8:11], v[104:107]
    ds_read_b128 v[60:63], v136 offset:7168
    v_mfma_f32_16x16x32_bf16 v[108:111], v[24:27], v[12:15], v[108:111]
    v_mfma_f32_16x16x32_bf16 v[112:115], v[28:31], v[0:3], v[112:115]
    s_add_u32 s15, s15, s17
    v_mfma_f32_16x16x32_bf16 v[116:119], v[28:31], v[4:7], v[116:119]
    v_mfma_f32_16x16x32_bf16 v[120:123], v[28:31], v[8:11], v[120:123]
    v_mfma_f32_16x16x32_bf16 v[124:127], v[28:31], v[12:15], v[124:127]
    s_waitcnt lgkmcnt(0)
    v_mfma_f32_16x16x32_bf16 v[64:67], v[48:51], v[32:35], v[64:67]
    s_waitcnt vmcnt(16)
    s_barrier
    ds_read_b128 v[16:19], v136 offset:16384
    v_mfma_f32_16x16x32_bf16 v[68:71], v[48:51], v[36:39], v[68:71]
    ds_read_b64_tr_b16 v[0:1], v128 offset:16384
    v_mfma_f32_16x16x32_bf16 v[72:75], v[48:51], v[40:43], v[72:75]
    ds_read_b64_tr_b16 v[2:3], v128 offset:20480
    v_mfma_f32_16x16x32_bf16 v[76:79], v[48:51], v[44:47], v[76:79]
    ds_read_b64_tr_b16 v[4:5], v129 offset:16384
    v_mfma_f32_16x16x32_bf16 v[80:83], v[52:55], v[32:35], v[80:83]
    ds_read_b64_tr_b16 v[6:7], v129 offset:20480
    v_mfma_f32_16x16x32_bf16 v[84:87], v[52:55], v[36:39], v[84:87]
    ds_read_b64_tr_b16 v[8:9], v130 offset:16384
    v_mfma_f32_16x16x32_bf16 v[88:91], v[52:55], v[40:43], v[88:91]
    ds_read_b64_tr_b16 v[10:11], v130 offset:20480
    v_mfma_f32_16x16x32_bf16 v[92:95], v[52:55], v[44:47], v[92:95]
    ds_read_b64_tr_b16 v[12:13], v131 offset:16384
    v_mfma_f32_16x16x32_bf16 v[96:99], v[56:59], v[32:35], v[96:99]
    ds_read_b64_tr_b16 v[14:15], v131 offset:20480
    v_mfma_f32_16x16x32_bf16 v[100:103], v[56:59], v[36:39], v[100:103]
    ds_read_b128 v[20:23], v136 offset:18432
    v_mfma_f32_16x16x32_bf16 v[104:107], v[56:59], v[40:43], v[104:107]
    ds_read_b128 v[24:27], v136 offset:20480
    v_mfma_f32_16x16x32_bf16 v[108:111], v[56:59], v[44:47], v[108:111]
    ds_read_b128 v[28:31], v136 offset:22528
    v_mfma_f32_16x16x32_bf16 v[112:115], v[60:63], v[32:35], v[112:115]
    v_mfma_f32_16x16x32_bf16 v[116:119], v[60:63], v[36:39], v[116:119]
    v_mfma_f32_16x16x32_bf16 v[120:123], v[60:63], v[40:43], v[120:123]
    v_mfma_f32_16x16x32_bf16 v[124:127], v[60:63], v[44:47], v[124:127]
    s_waitcnt lgkmcnt(0)
    ds_read_b128 v[48:51], v136 offset:17408
    v_mfma_f32_16x16x32_bf16 v[64:67], v[16:19], v[0:3], v[64:67]
    ds_read_b64_tr_b16 v[32:33], v128 offset:24576
    v_mfma_f32_16x16x32_bf16 v[68:71], v[16:19], v[4:7], v[68:71]
    ds_read_b64_tr_b16 v[34:35], v128 offset:28672
    v_mfma_f32_16x16x32_bf16 v[72:75], v[16:19], v[8:11], v[72:75]
    ds_read_b64_tr_b16 v[36:37], v129 offset:24576
    v_mfma_f32_16x16x32_bf16 v[76:79], v[16:19], v[12:15], v[76:79]
    ds_read_b64_tr_b16 v[38:39], v129 offset:28672
    v_mfma_f32_16x16x32_bf16 v[80:83], v[20:23], v[0:3], v[80:83]
    ds_read_b64_tr_b16 v[40:41], v130 offset:24576
    v_mfma_f32_16x16x32_bf16 v[84:87], v[20:23], v[4:7], v[84:87]
    ds_read_b64_tr_b16 v[42:43], v130 offset:28672
    v_mfma_f32_16x16x32_bf16 v[88:91], v[20:23], v[8:11], v[88:91]
    ds_read_b64_tr_b16 v[44:45], v131 offset:24576
    v_mfma_f32_16x16x32_bf16 v[92:95], v[20:23], v[12:15], v[92:95]
    ds_read_b64_tr_b16 v[46:47], v131 offset:28672
    v_mfma_f32_16x16x32_bf16 v[96:99], v[24:27], v[0:3], v[96:99]
    ds_read_b128 v[52:55], v136 offset:19456
    v_mfma_f32_16x16x32_bf16 v[100:103], v[24:27], v[4:7], v[100:103]
    ds_read_b128 v[56:59], v136 offset:21504
    v_mfma_f32_16x16x32_bf16 v[104:107], v[24:27], v[8:11], v[104:107]
    ds_read_b128 v[60:63], v136 offset:23552
    v_mfma_f32_16x16x32_bf16 v[108:111], v[24:27], v[12:15], v[108:111]
    v_mfma_f32_16x16x32_bf16 v[112:115], v[28:31], v[0:3], v[112:115]
    v_mfma_f32_16x16x32_bf16 v[116:119], v[28:31], v[4:7], v[116:119]
    v_mfma_f32_16x16x32_bf16 v[120:123], v[28:31], v[8:11], v[120:123]
    v_mfma_f32_16x16x32_bf16 v[124:127], v[28:31], v[12:15], v[124:127]
    s_waitcnt lgkmcnt(0)
    v_mfma_f32_16x16x32_bf16 v[64:67], v[48:51], v[32:35], v[64:67]
    s_waitcnt vmcnt(8)
    s_barrier
    ds_read_b128 v[16:19], v136 offset:32768
    v_mfma_f32_16x16x32_bf16 v[68:71], v[48:51], v[36:39], v[68:71]
    ds_read_b64_tr_b16 v[0:1], v128 offset:32768
    v_mfma_f32_16x16x32_bf16 v[72:75], v[48:51], v[40:43], v[72:75]
    ds_read_b64_tr_b16 v[2:3], v128 offset:36864
    v_mfma_f32_16x16x32_bf16 v[76:79], v[48:51], v[44:47], v[76:79]
    ds_read_b64_tr_b16 v[4:5], v129 offset:32768
    v_mfma_f32_16x16x32_bf16 v[80:83], v[52:55], v[32:35], v[80:83]
    ds_read_b64_tr_b16 v[6:7], v129 offset:36864
    v_mfma_f32_16x16x32_bf16 v[84:87], v[52:55], v[36:39], v[84:87]
    ds_read_b64_tr_b16 v[8:9], v130 offset:32768
    v_mfma_f32_16x16x32_bf16 v[88:91], v[52:55], v[40:43], v[88:91]
    ds_read_b64_tr_b16 v[10:11], v130 offset:36864
    v_mfma_f32_16x16x32_bf16 v[92:95], v[52:55], v[44:47], v[92:95]
    ds_read_b64_tr_b16 v[12:13], v131 offset:32768
    v_mfma_f32_16x16x32_bf16 v[96:99], v[56:59], v[32:35], v[96:99]
    ds_read_b64_tr_b16 v[14:15], v131 offset:36864
    v_mfma_f32_16x16x32_bf16 v[100:103], v[56:59], v[36:39], v[100:103]
    ds_read_b128 v[20:23], v136 offset:34816
    v_mfma_f32_16x16x32_bf16 v[104:107], v[56:59], v[40:43], v[104:107]
    ds_read_b128 v[24:27], v136 offset:36864
    v_mfma_f32_16x16x32_bf16 v[108:111], v[56:59], v[44:47], v[108:111]
    ds_read_b128 v[28:31], v136 offset:38912
    v_mfma_f32_16x16x32_bf16 v[112:115], v[60:63], v[32:35], v[112:115]
    v_mfma_f32_16x16x32_bf16 v[116:119], v[60:63], v[36:39], v[116:119]
    v_mfma_f32_16x16x32_bf16 v[120:123], v[60:63], v[40:43], v[120:123]
    v_mfma_f32_16x16x32_bf16 v[124:127], v[60:63], v[44:47], v[124:127]
    s_waitcnt lgkmcnt(0)
    ds_read_b128 v[48:51], v136 offset:33792
    v_mfma_f32_16x16x32_bf16 v[64:67], v[16:19], v[0:3], v[64:67]
    ds_read_b64_tr_b16 v[32:33], v128 offset:40960
    v_mfma_f32_16x16x32_bf16 v[68:71], v[16:19], v[4:7], v[68:71]
    ds_read_b64_tr_b16 v[34:35], v128 offset:45056
    v_mfma_f32_16x16x32_bf16 v[72:75], v[16:19], v[8:11], v[72:75]
    ds_read_b64_tr_b16 v[36:37], v129 offset:40960
    v_mfma_f32_16x16x32_bf16 v[76:79], v[16:19], v[12:15], v[76:79]
    ds_read_b64_tr_b16 v[38:39], v129 offset:45056
    v_mfma_f32_16x16x32_bf16 v[80:83], v[20:23], v[0:3], v[80:83]
    ds_read_b64_tr_b16 v[40:41], v130 offset:40960
    v_mfma_f32_16x16x32_bf16 v[84:87], v[20:23], v[4:7], v[84:87]
    ds_read_b64_tr_b16 v[42:43], v130 offset:45056
    v_mfma_f32_16x16x32_bf16 v[88:91], v[20:23], v[8:11], v[88:91]
    ds_read_b64_tr_b16 v[44:45], v131 offset:40960
    v_mfma_f32_16x16x32_bf16 v[92:95], v[20:23], v[12:15], v[92:95]
    ds_read_b64_tr_b16 v[46:47], v131 offset:45056
    v_mfma_f32_16x16x32_bf16 v[96:99], v[24:27], v[0:3], v[96:99]
    ds_read_b128 v[52:55], v136 offset:35840
    v_mfma_f32_16x16x32_bf16 v[100:103], v[24:27], v[4:7], v[100:103]
    ds_read_b128 v[56:59], v136 offset:37888
    v_mfma_f32_16x16x32_bf16 v[104:107], v[24:27], v[8:11], v[104:107]
    ds_read_b128 v[60:63], v136 offset:39936
    v_mfma_f32_16x16x32_bf16 v[108:111], v[24:27], v[12:15], v[108:111]
    v_mfma_f32_16x16x32_bf16 v[112:115], v[28:31], v[0:3], v[112:115]
    v_mfma_f32_16x16x32_bf16 v[116:119], v[28:31], v[4:7], v[116:119]
    v_mfma_f32_16x16x32_bf16 v[120:123], v[28:31], v[8:11], v[120:123]
    v_mfma_f32_16x16x32_bf16 v[124:127], v[28:31], v[12:15], v[124:127]
    s_waitcnt lgkmcnt(0)
    v_mfma_f32_16x16x32_bf16 v[64:67], v[48:51], v[32:35], v[64:67]
    s_waitcnt vmcnt(0)
    s_barrier
    ds_read_b128 v[16:19], v136 offset:49152
    v_mfma_f32_16x16x32_bf16 v[68:71], v[48:51], v[36:39], v[68:71]
    ds_read_b64_tr_b16 v[0:1], v128 offset:49152
    v_mfma_f32_16x16x32_bf16 v[72:75], v[48:51], v[40:43], v[72:75]
    ds_read_b64_tr_b16 v[2:3], v128 offset:53248
    v_mfma_f32_16x16x32_bf16 v[76:79], v[48:51], v[44:47], v[76:79]
    ds_read_b64_tr_b16 v[4:5], v129 offset:49152
    v_mfma_f32_16x16x32_bf16 v[80:83], v[52:55], v[32:35], v[80:83]
    ds_read_b64_tr_b16 v[6:7], v129 offset:53248
    v_mfma_f32_16x16x32_bf16 v[84:87], v[52:55], v[36:39], v[84:87]
    ds_read_b64_tr_b16 v[8:9], v130 offset:49152
    v_mfma_f32_16x16x32_bf16 v[88:91], v[52:55], v[40:43], v[88:91]
    ds_read_b64_tr_b16 v[10:11], v130 offset:53248
    v_mfma_f32_16x16x32_bf16 v[92:95], v[52:55], v[44:47], v[92:95]
    ds_read_b64_tr_b16 v[12:13], v131 offset:49152
    v_mfma_f32_16x16x32_bf16 v[96:99], v[56:59], v[32:35], v[96:99]
    ds_read_b64_tr_b16 v[14:15], v131 offset:53248
    v_mfma_f32_16x16x32_bf16 v[100:103], v[56:59], v[36:39], v[100:103]
    ds_read_b128 v[20:23], v136 offset:51200
    v_mfma_f32_16x16x32_bf16 v[104:107], v[56:59], v[40:43], v[104:107]
    ds_read_b128 v[24:27], v136 offset:53248
    v_mfma_f32_16x16x32_bf16 v[108:111], v[56:59], v[44:47], v[108:111]
    ds_read_b128 v[28:31], v136 offset:55296
    v_mfma_f32_16x16x32_bf16 v[112:115], v[60:63], v[32:35], v[112:115]
    v_mfma_f32_16x16x32_bf16 v[116:119], v[60:63], v[36:39], v[116:119]
    v_mfma_f32_16x16x32_bf16 v[120:123], v[60:63], v[40:43], v[120:123]
    v_mfma_f32_16x16x32_bf16 v[124:127], v[60:63], v[44:47], v[124:127]
    v_readfirstlane_b32 s55, v255
    s_waitcnt lgkmcnt(0)
    ds_read_b128 v[48:51], v136 offset:50176
    v_mfma_f32_16x16x32_bf16 v[64:67], v[16:19], v[0:3], v[64:67]
    ds_read_b64_tr_b16 v[32:33], v128 offset:57344
    v_mfma_f32_16x16x32_bf16 v[68:71], v[16:19], v[4:7], v[68:71]
    ds_read_b64_tr_b16 v[34:35], v128 offset:61440
    v_mfma_f32_16x16x32_bf16 v[72:75], v[16:19], v[8:11], v[72:75]
    ds_read_b64_tr_b16 v[36:37], v129 offset:57344
    v_mfma_f32_16x16x32_bf16 v[76:79], v[16:19], v[12:15], v[76:79]
    ds_read_b64_tr_b16 v[38:39], v129 offset:61440
    v_mfma_f32_16x16x32_bf16 v[80:83], v[20:23], v[0:3], v[80:83]
    ds_read_b64_tr_b16 v[40:41], v130 offset:57344
    v_mfma_f32_16x16x32_bf16 v[84:87], v[20:23], v[4:7], v[84:87]
    ds_read_b64_tr_b16 v[42:43], v130 offset:61440
    v_mfma_f32_16x16x32_bf16 v[88:91], v[20:23], v[8:11], v[88:91]
    ds_read_b64_tr_b16 v[44:45], v131 offset:57344
    v_mfma_f32_16x16x32_bf16 v[92:95], v[20:23], v[12:15], v[92:95]
    ds_read_b64_tr_b16 v[46:47], v131 offset:61440
    v_mfma_f32_16x16x32_bf16 v[96:99], v[24:27], v[0:3], v[96:99]
    ds_read_b128 v[52:55], v136 offset:52224
    v_mfma_f32_16x16x32_bf16 v[100:103], v[24:27], v[4:7], v[100:103]
    ds_read_b128 v[56:59], v136 offset:54272
    v_mfma_f32_16x16x32_bf16 v[104:107], v[24:27], v[8:11], v[104:107]
    ds_read_b128 v[60:63], v136 offset:56320
    v_mfma_f32_16x16x32_bf16 v[108:111], v[24:27], v[12:15], v[108:111]
    v_mfma_f32_16x16x32_bf16 v[112:115], v[28:31], v[0:3], v[112:115]
    v_mfma_f32_16x16x32_bf16 v[116:119], v[28:31], v[4:7], v[116:119]
    v_mfma_f32_16x16x32_bf16 v[120:123], v[28:31], v[8:11], v[120:123]
    v_mfma_f32_16x16x32_bf16 v[124:127], v[28:31], v[12:15], v[124:127]
    s_waitcnt lgkmcnt(0)
    v_mfma_f32_16x16x32_bf16 v[64:67], v[48:51], v[32:35], v[64:67]
    v_mfma_f32_16x16x32_bf16 v[68:71], v[48:51], v[36:39], v[68:71]
    v_mfma_f32_16x16x32_bf16 v[72:75], v[48:51], v[40:43], v[72:75]
    v_mfma_f32_16x16x32_bf16 v[76:79], v[48:51], v[44:47], v[76:79]
    v_mfma_f32_16x16x32_bf16 v[80:83], v[52:55], v[32:35], v[80:83]
    v_mfma_f32_16x16x32_bf16 v[84:87], v[52:55], v[36:39], v[84:87]
    v_mfma_f32_16x16x32_bf16 v[88:91], v[52:55], v[40:43], v[88:91]
    v_mfma_f32_16x16x32_bf16 v[92:95], v[52:55], v[44:47], v[92:95]
    v_mfma_f32_16x16x32_bf16 v[96:99], v[56:59], v[32:35], v[96:99]
    v_mfma_f32_16x16x32_bf16 v[100:103], v[56:59], v[36:39], v[100:103]
    v_mfma_f32_16x16x32_bf16 v[104:107], v[56:59], v[40:43], v[104:107]
    v_mfma_f32_16x16x32_bf16 v[108:111], v[56:59], v[44:47], v[108:111]
    v_mfma_f32_16x16x32_bf16 v[112:115], v[60:63], v[32:35], v[112:115]
    v_mfma_f32_16x16x32_bf16 v[116:119], v[60:63], v[36:39], v[116:119]
    v_mfma_f32_16x16x32_bf16 v[120:123], v[60:63], v[40:43], v[120:123]
    v_mfma_f32_16x16x32_bf16 v[124:127], v[60:63], v[44:47], v[124:127]
    s_nop 7
    s_mov_b32 s53, s21
    v_cvt_pk_bf16_f32 v8, v64, v65
    v_cvt_pk_bf16_f32 v9, v66, v67
    v_cvt_pk_bf16_f32 v10, v80, v81
    v_cvt_pk_bf16_f32 v11, v82, v83
    buffer_store_dwordx4 v[8:11], v251, s[4:7], s53 offen offset:0 sc1
    v_cvt_pk_bf16_f32 v24, v68, v69
    v_cvt_pk_bf16_f32 v25, v70, v71
    v_cvt_pk_bf16_f32 v26, v84, v85
    v_cvt_pk_bf16_f32 v27, v86, v87
    buffer_store_dwordx4 v[24:27], v251, s[4:7], s53 offen offset:1024 sc1
    v_cvt_pk_bf16_f32 v40, v72, v73
    v_cvt_pk_bf16_f32 v41, v74, v75
    v_cvt_pk_bf16_f32 v42, v88, v89
    v_cvt_pk_bf16_f32 v43, v90, v91
    buffer_store_dwordx4 v[40:43], v251, s[4:7], s53 offen offset:2048 sc1
    v_cvt_pk_bf16_f32 v56, v76, v77
    v_cvt_pk_bf16_f32 v57, v78, v79
    v_cvt_pk_bf16_f32 v58, v92, v93
    v_cvt_pk_bf16_f32 v59, v94, v95
    buffer_store_dwordx4 v[56:59], v251, s[4:7], s53 offen offset:3072 sc1
    s_add_u32 s53, s53, 262144
    v_cvt_pk_bf16_f32 v8, v96, v97
    v_cvt_pk_bf16_f32 v9, v98, v99
    v_cvt_pk_bf16_f32 v10, v112, v113
    v_cvt_pk_bf16_f32 v11, v114, v115
    buffer_store_dwordx4 v[8:11], v251, s[4:7], s53 offen offset:0 sc1
    v_cvt_pk_bf16_f32 v24, v100, v101
    v_cvt_pk_bf16_f32 v25, v102, v103
    v_cvt_pk_bf16_f32 v26, v116, v117
    v_cvt_pk_bf16_f32 v27, v118, v119
    buffer_store_dwordx4 v[24:27], v251, s[4:7], s53 offen offset:1024 sc1
    v_cvt_pk_bf16_f32 v40, v104, v105
    v_cvt_pk_bf16_f32 v41, v106, v107
    v_cvt_pk_bf16_f32 v42, v120, v121
    v_cvt_pk_bf16_f32 v43, v122, v123
    buffer_store_dwordx4 v[40:43], v251, s[4:7], s53 offen offset:2048 sc1
    v_cvt_pk_bf16_f32 v56, v108, v109
    v_cvt_pk_bf16_f32 v57, v110, v111
    v_cvt_pk_bf16_f32 v58, v124, v125
    v_cvt_pk_bf16_f32 v59, v126, v127
    buffer_store_dwordx4 v[56:59], v251, s[4:7], s53 offen offset:3072 sc1
    s_add_u32 s53, s53, 262144
    s_branch main_kernel_w_done
main_kernel_w_c1_task:
    s_cmp_eq_u32 s23, 0
    s_cbranch_scc1 main_kernel_w_c1_set0
    s_cmp_eq_u32 s23, 1
    s_cbranch_scc1 main_kernel_w_c1_set1
    s_cmp_eq_u32 s23, 2
    s_cbranch_scc1 main_kernel_w_c1_set2
    s_cmp_eq_u32 s23, 3
    s_cbranch_scc1 main_kernel_w_c1_set3
    s_cmp_eq_u32 s23, 6
    s_cbranch_scc1 main_kernel_w_c1_set6
    s_branch main_kernel_w_done
main_kernel_w_c1_set0:
    s_lshl_b32 s32, s25, 8
    s_add_u32 s8, s40, s32
    s_addc_u32 s9, s41, 0
    s_and_b32 s9, s9, 0xffff
    s_sub_u32 s10, 0x800000, s32
    s_mov_b32 s11, 0x20000
    s_mov_b32 s30, 8192
    s_mov_b32 s31, 32768
    s_mul_i32 s16, s24, 262144
    s_add_u32 s16, s16, 0x0
    s_mov_b32 s18, 7
    s_lshl_b32 s32, s24, 3
    s_mul_i32 s33, s38, 4
    s_add_u32 s32, s32, s33
    s_mul_i32 s32, s32, 131072
    s_lshl_b32 s33, s25, 12
    s_add_u32 s32, s32, s33
    s_mul_i32 s33, s37, 4096
    s_add_u32 s32, s32, s33
    s_add_u32 s21, s32, 0x800000
    s_mov_b32 s22, 131072
    s_mov_b32 s26, -1
    s_branch main_kernel_w_c1_go
main_kernel_w_c1_set1:
    s_lshl_b32 s32, s25, 8
    s_add_u32 s8, s42, s32
    s_addc_u32 s9, s43, 0
    s_and_b32 s9, s9, 0xffff
    s_sub_u32 s10, 0x800000, s32
    s_mov_b32 s11, 0x20000
    s_mov_b32 s30, 8192
    s_mov_b32 s31, 32768
    s_mul_i32 s16, s24, 262144
    s_add_u32 s16, s16, 0x0
    s_mov_b32 s18, 7
    s_lshl_b32 s32, s24, 3
    s_mul_i32 s33, s38, 4
    s_add_u32 s32, s32, s33
    s_mul_i32 s32, s32, 131072
    s_lshl_b32 s33, s25, 12
    s_add_u32 s32, s32, s33
    s_mul_i32 s33, s37, 4096
    s_add_u32 s32, s32, s33
    s_add_u32 s21, s32, 0x1800000
    s_mov_b32 s22, 131072
    s_mov_b32 s26, -1
    s_branch main_kernel_w_c1_go
main_kernel_w_c1_set2:
    s_lshl_b32 s32, s25, 8
    s_add_u32 s8, s44, s32
    s_addc_u32 s9, s45, 0
    s_and_b32 s9, s9, 0xffff
    s_sub_u32 s10, 0x800000, s32
    s_mov_b32 s11, 0x20000
    s_mov_b32 s30, 8192
    s_mov_b32 s31, 32768
    s_mul_i32 s16, s24, 262144
    s_add_u32 s16, s16, 0x0
    s_mov_b32 s18, 7
    s_lshl_b32 s32, s24, 2
    s_mul_i32 s33, s38, 2
    s_add_u32 s32, s32, s33
    s_lshl_b32 s32, s32, 18
    s_lshl_b32 s33, s25, 13
    s_add_u32 s32, s32, s33
    s_mul_i32 s33, s37, 8192
    s_add_u32 s32, s32, s33
    s_add_u32 s21, s32, 0x2800000
    s_branch main_kernel_w_c1_gov
main_kernel_w_c1_set3:
    s_lshl_b32 s32, s25, 8
    s_add_u32 s8, s64, s32
    s_addc_u32 s9, s65, 0
    s_and_b32 s9, s9, 0xffff
    s_sub_u32 s10, 0x200000, s32
    s_mov_b32 s11, 0x20000
    s_mov_b32 s30, 2048
    s_mov_b32 s31, 32768
    s_mul_i32 s16, s24, 262144
    s_add_u32 s16, s16, 0x400000
    s_mov_b32 s18, 7
    s_lshl_b32 s32, s24, 3
    s_mul_i32 s33, s38, 4
    s_add_u32 s32, s32, s33
    s_mul_i32 s32, s32, 32768
    s_lshl_b32 s33, s25, 12
    s_add_u32 s32, s32, s33
    s_mul_i32 s33, s37, 4096
    s_add_u32 s32, s32, s33
    s_add_u32 s21, s32, 0x4800000
    s_mov_b32 s22, 32768
    s_mov_b32 s26, -1
    s_lshr_b32 s32, s25, 2
    s_add_u32 s32, s32, 1
    s_sub_u32 s33, 0, s32
    s_bitcmp1_b32 s25, 1
    s_cselect_b32 s32, s33, s32
    s_add_u32 s32, s32, 16
    v_and_b32 v253, 15, v250
    v_add_u32 v253, s32, v253
    v_lshrrev_b32 v254, 4, v253
    v_lshlrev_b32 v254, 15, v254
    v_and_b32 v253, 15, v253
    v_lshl_add_u32 v254, v253, 4, v254
    v_and_b32 v253, 0x300, v251
    v_add_u32 v252, v253, v254
    s_branch main_kernel_w_c1_go
main_kernel_w_c1_set6:
    s_lshl_b32 s32, s25, 8
    s_add_u32 s8, s68, s32
    s_addc_u32 s9, s69, 0
    s_and_b32 s9, s9, 0xffff
    s_sub_u32 s10, 0x700000, s32
    s_mov_b32 s11, 0x20000
    s_mov_b32 s30, 7168
    s_mov_b32 s31, 32768
    s_mul_i32 s16, s24, 262144
    s_add_u32 s16, s16, 0x6800000
    s_mov_b32 s18, 7
    s_lshl_b32 s32, s24, 3
    s_mul_i32 s33, s38, 4
    s_add_u32 s32, s32, s33
    s_mul_i32 s32, s32, 114688
    s_lshl_b32 s33, s25, 12
    s_add_u32 s32, s32, s33
    s_mul_i32 s33, s37, 4096
    s_add_u32 s32, s32, s33
    s_add_u32 s21, s32, 0x5400000
    s_mov_b32 s22, 114688
    s_mov_b32 s26, -1
    s_branch main_kernel_w_c1_go
main_kernel_w_c1_go:
    v_lshrrev_b32 v0, 4, v250
    v_bfe_u32 v1, v250, 2, 2
    v_lshl_add_u32 v4, v0, 2, v1
    v_and_b32 v5, 7, v4
    v_mul_u32_u24 v4, 512, v4
    v_and_b32 v6, 3, v250
    v_lshl_add_u32 v4, v6, 3, v4
    s_mul_i32 s32, s37, 8
    v_xor_b32 v5, s32, v5
    v_lshl_add_u32 v128, v5, 5, v4
    v_xor_b32 v129, 32, v128
    v_xor_b32 v130, 64, v128
    v_xor_b32 v131, 96, v128
    v_xor_b32 v132, 128, v128
    v_xor_b32 v133, 160, v128
    v_xor_b32 v134, 192, v128
    v_xor_b32 v135, 224, v128
    s_mul_i32 s32, s38, 4096
    s_add_u32 s32, s32, 65536
    v_add_u32 v136, s32, v251
    v_lshrrev_b32 v2, 5, v250
    v_and_b32 v3, 31, v250
    s_mul_i32 s32, s14, 8
    v_add_u32 v4, s32, v2
    v_add_u32 v5, 0, v4
    v_and_b32 v6, 7, v5
    v_lshlrev_b32 v6, 1, v6
    v_xor_b32 v6, v6, v3
    v_mul_lo_u32 v5, v5, s30
    v_lshl_add_u32 v5, v6, 4, v5
    v_subrev_u32 v137, 0, v5
    v_add_u32 v5, 2, v4
    v_and_b32 v6, 7, v5
    v_lshlrev_b32 v6, 1, v6
    v_xor_b32 v6, v6, v3
    v_mul_lo_u32 v5, v5, s30
    v_lshl_add_u32 v5, v6, 4, v5
    v_subrev_u32 v138, 1024, v5
    v_add_u32 v5, 4, v4
    v_and_b32 v6, 7, v5
    v_lshlrev_b32 v6, 1, v6
    v_xor_b32 v6, v6, v3
    v_mul_lo_u32 v5, v5, s30
    v_lshl_add_u32 v5, v6, 4, v5
    v_subrev_u32 v139, 2048, v5
    v_add_u32 v5, 6, v4
    v_and_b32 v6, 7, v5
    v_lshlrev_b32 v6, 1, v6
    v_xor_b32 v6, v6, v3
    v_mul_lo_u32 v5, v5, s30
    v_lshl_add_u32 v5, v6, 4, v5
    v_subrev_u32 v140, 3072, v5
    s_mul_i32 s32, s14, 2
    s_mul_i32 s32, s32, s31
    v_add_u32 v141, s32, v251
    s_add_u32 s32, s32, s31
    s_sub_u32 s32, s32, 1024
    v_add_u32 v142, s32, v251
    s_mul_i32 s19, s14, 4096
    s_mul_i32 s20, s14, 2048
    s_add_u32 s20, s20, 65536
    s_mul_i32 s17, s30, 32
    s_mov_b32 s15, 0
    s_add_u32 m0, s20, 0
    s_nop 0
    buffer_load_dwordx4 v141, s[4:7], s16 offen offset:0 sc1 lds
    buffer_load_dwordx4 v142, s[4:7], s16 offen offset:1024 sc1 lds
    s_add_u32 s16, s16, 1024
    s_add_u32 m0, s19, 0
    s_nop 0
    buffer_load_dwordx4 v137, s[8:11], s15 offen offset:0 lds
    buffer_load_dwordx4 v138, s[8:11], s15 offen offset:1024 lds
    buffer_load_dwordx4 v139, s[8:11], s15 offen offset:2048 lds
    buffer_load_dwordx4 v140, s[8:11], s15 offen offset:3072 lds
    s_add_u32 s15, s15, s17
    s_add_u32 m0, s20, 8192
    s_nop 0
    buffer_load_dwordx4 v141, s[4:7], s16 offen offset:0 sc1 lds
    buffer_load_dwordx4 v142, s[4:7], s16 offen offset:1024 sc1 lds
    s_add_u32 s16, s16, 1024
    s_add_u32 m0, s19, 16384
    s_nop 0
    buffer_load_dwordx4 v137, s[8:11], s15 offen offset:0 lds
    buffer_load_dwordx4 v138, s[8:11], s15 offen offset:1024 lds
    buffer_load_dwordx4 v139, s[8:11], s15 offen offset:2048 lds
    buffer_load_dwordx4 v140, s[8:11], s15 offen offset:3072 lds
    s_add_u32 s15, s15, s17
    s_add_u32 m0, s20, 16384
    s_nop 0
    buffer_load_dwordx4 v141, s[4:7], s16 offen offset:0 sc1 lds
    buffer_load_dwordx4 v142, s[4:7], s16 offen offset:1024 sc1 lds
    s_add_u32 s16, s16, 1024
    s_add_u32 m0, s19, 32768
    s_nop 0
    buffer_load_dwordx4 v137, s[8:11], s15 offen offset:0 lds
    buffer_load_dwordx4 v138, s[8:11], s15 offen offset:1024 lds
    buffer_load_dwordx4 v139, s[8:11], s15 offen offset:2048 lds
    buffer_load_dwordx4 v140, s[8:11], s15 offen offset:3072 lds
    s_add_u32 s15, s15, s17
    s_add_u32 m0, s20, 24576
    s_nop 0
    buffer_load_dwordx4 v141, s[4:7], s16 offen offset:0 sc1 lds
    buffer_load_dwordx4 v142, s[4:7], s16 offen offset:1024 sc1 lds
    s_add_u32 s16, s16, 1024
    s_add_u32 m0, s19, 49152
    s_nop 0
    buffer_load_dwordx4 v137, s[8:11], s15 offen offset:0 lds
    buffer_load_dwordx4 v138, s[8:11], s15 offen offset:1024 lds
    buffer_load_dwordx4 v139, s[8:11], s15 offen offset:2048 lds
    buffer_load_dwordx4 v140, s[8:11], s15 offen offset:3072 lds
    s_add_u32 s15, s15, s17
    v_accvgpr_write_b32 a0, 0
    v_accvgpr_write_b32 a1, 0
    v_accvgpr_write_b32 a2, 0
    v_accvgpr_write_b32 a3, 0
    v_accvgpr_write_b32 a4, 0
    v_accvgpr_write_b32 a5, 0
    v_accvgpr_write_b32 a6, 0
    v_accvgpr_write_b32 a7, 0
    v_accvgpr_write_b32 a8, 0
    v_accvgpr_write_b32 a9, 0
    v_accvgpr_write_b32 a10, 0
    v_accvgpr_write_b32 a11, 0
    v_accvgpr_write_b32 a12, 0
    v_accvgpr_write_b32 a13, 0
    v_accvgpr_write_b32 a14, 0
    v_accvgpr_write_b32 a15, 0
    v_accvgpr_write_b32 a16, 0
    v_accvgpr_write_b32 a17, 0
    v_accvgpr_write_b32 a18, 0
    v_accvgpr_write_b32 a19, 0
    v_accvgpr_write_b32 a20, 0
    v_accvgpr_write_b32 a21, 0
    v_accvgpr_write_b32 a22, 0
    v_accvgpr_write_b32 a23, 0
    v_accvgpr_write_b32 a24, 0
    v_accvgpr_write_b32 a25, 0
    v_accvgpr_write_b32 a26, 0
    v_accvgpr_write_b32 a27, 0
    v_accvgpr_write_b32 a28, 0
    v_accvgpr_write_b32 a29, 0
    v_accvgpr_write_b32 a30, 0
    v_accvgpr_write_b32 a31, 0
    v_accvgpr_write_b32 a32, 0
    v_accvgpr_write_b32 a33, 0
    v_accvgpr_write_b32 a34, 0
    v_accvgpr_write_b32 a35, 0
    v_accvgpr_write_b32 a36, 0
    v_accvgpr_write_b32 a37, 0
    v_accvgpr_write_b32 a38, 0
    v_accvgpr_write_b32 a39, 0
    v_accvgpr_write_b32 a40, 0
    v_accvgpr_write_b32 a41, 0
    v_accvgpr_write_b32 a42, 0
    v_accvgpr_write_b32 a43, 0
    v_accvgpr_write_b32 a44, 0
    v_accvgpr_write_b32 a45, 0
    v_accvgpr_write_b32 a46, 0
    v_accvgpr_write_b32 a47, 0
    v_accvgpr_write_b32 a48, 0
    v_accvgpr_write_b32 a49, 0
    v_accvgpr_write_b32 a50, 0
    v_accvgpr_write_b32 a51, 0
    v_accvgpr_write_b32 a52, 0
    v_accvgpr_write_b32 a53, 0
    v_accvgpr_write_b32 a54, 0
    v_accvgpr_write_b32 a55, 0
    v_accvgpr_write_b32 a56, 0
    v_accvgpr_write_b32 a57, 0
    v_accvgpr_write_b32 a58, 0
    v_accvgpr_write_b32 a59, 0
    v_accvgpr_write_b32 a60, 0
    v_accvgpr_write_b32 a61, 0
    v_accvgpr_write_b32 a62, 0
    v_accvgpr_write_b32 a63, 0
    v_accvgpr_write_b32 a64, 0
    v_accvgpr_write_b32 a65, 0
    v_accvgpr_write_b32 a66, 0
    v_accvgpr_write_b32 a67, 0
    v_accvgpr_write_b32 a68, 0
    v_accvgpr_write_b32 a69, 0
    v_accvgpr_write_b32 a70, 0
    v_accvgpr_write_b32 a71, 0
    v_accvgpr_write_b32 a72, 0
    v_accvgpr_write_b32 a73, 0
    v_accvgpr_write_b32 a74, 0
    v_accvgpr_write_b32 a75, 0
    v_accvgpr_write_b32 a76, 0
    v_accvgpr_write_b32 a77, 0
    v_accvgpr_write_b32 a78, 0
    v_accvgpr_write_b32 a79, 0
    v_accvgpr_write_b32 a80, 0
    v_accvgpr_write_b32 a81, 0
    v_accvgpr_write_b32 a82, 0
    v_accvgpr_write_b32 a83, 0
    v_accvgpr_write_b32 a84, 0
    v_accvgpr_write_b32 a85, 0
    v_accvgpr_write_b32 a86, 0
    v_accvgpr_write_b32 a87, 0
    v_accvgpr_write_b32 a88, 0
    v_accvgpr_write_b32 a89, 0
    v_accvgpr_write_b32 a90, 0
    v_accvgpr_write_b32 a91, 0
    v_accvgpr_write_b32 a92, 0
    v_accvgpr_write_b32 a93, 0
    v_accvgpr_write_b32 a94, 0
    v_accvgpr_write_b32 a95, 0
    v_accvgpr_write_b32 a96, 0
    v_accvgpr_write_b32 a97, 0
    v_accvgpr_write_b32 a98, 0
    v_accvgpr_write_b32 a99, 0
    v_accvgpr_write_b32 a100, 0
    v_accvgpr_write_b32 a101, 0
    v_accvgpr_write_b32 a102, 0
    v_accvgpr_write_b32 a103, 0
    v_accvgpr_write_b32 a104, 0
    v_accvgpr_write_b32 a105, 0
    v_accvgpr_write_b32 a106, 0
    v_accvgpr_write_b32 a107, 0
    v_accvgpr_write_b32 a108, 0
    v_accvgpr_write_b32 a109, 0
    v_accvgpr_write_b32 a110, 0
    v_accvgpr_write_b32 a111, 0
    v_accvgpr_write_b32 a112, 0
    v_accvgpr_write_b32 a113, 0
    v_accvgpr_write_b32 a114, 0
    v_accvgpr_write_b32 a115, 0
    v_accvgpr_write_b32 a116, 0
    v_accvgpr_write_b32 a117, 0
    v_accvgpr_write_b32 a118, 0
    v_accvgpr_write_b32 a119, 0
    v_accvgpr_write_b32 a120, 0
    v_accvgpr_write_b32 a121, 0
    v_accvgpr_write_b32 a122, 0
    v_accvgpr_write_b32 a123, 0
    v_accvgpr_write_b32 a124, 0
    v_accvgpr_write_b32 a125, 0
    v_accvgpr_write_b32 a126, 0
    v_accvgpr_write_b32 a127, 0
    s_waitcnt vmcnt(18)
    s_barrier
    ds_read_b128 v[32:35], v136 offset:0
    ds_read_b64_tr_b16 v[0:1], v128 offset:0
    ds_read_b64_tr_b16 v[2:3], v128 offset:8192
    ds_read_b64_tr_b16 v[4:5], v129 offset:0
    ds_read_b64_tr_b16 v[6:7], v129 offset:8192
    ds_read_b64_tr_b16 v[8:9], v130 offset:0
    ds_read_b64_tr_b16 v[10:11], v130 offset:8192
    ds_read_b64_tr_b16 v[12:13], v131 offset:0
    ds_read_b64_tr_b16 v[14:15], v131 offset:8192
    ds_read_b64_tr_b16 v[16:17], v132 offset:0
    ds_read_b64_tr_b16 v[18:19], v132 offset:8192
    ds_read_b64_tr_b16 v[20:21], v133 offset:0
    ds_read_b64_tr_b16 v[22:23], v133 offset:8192
    ds_read_b64_tr_b16 v[24:25], v134 offset:0
    ds_read_b64_tr_b16 v[26:27], v134 offset:8192
    ds_read_b64_tr_b16 v[28:29], v135 offset:0
    ds_read_b64_tr_b16 v[30:31], v135 offset:8192
    ds_read_b128 v[36:39], v136 offset:1024
    ds_read_b128 v[40:43], v136 offset:2048
    ds_read_b128 v[44:47], v136 offset:3072
main_kernel_w_c1_n_loop:
    s_waitcnt lgkmcnt(0)
    v_mfma_f32_16x16x32_bf16 a[0:3], v[0:3], v[32:35], a[0:3]
    s_waitcnt vmcnt(12)
    s_barrier
    ds_read_b128 v[80:83], v136 offset:8192
    s_add_u32 m0, s20, 0
    s_nop 0
    v_mfma_f32_16x16x32_bf16 a[4:7], v[4:7], v[32:35], a[4:7]
    ds_read_b64_tr_b16 v[48:49], v128 offset:16384
    v_mfma_f32_16x16x32_bf16 a[8:11], v[8:11], v[32:35], a[8:11]
    ds_read_b64_tr_b16 v[50:51], v128 offset:24576
    v_mfma_f32_16x16x32_bf16 a[12:15], v[12:15], v[32:35], a[12:15]
    ds_read_b64_tr_b16 v[52:53], v129 offset:16384
    buffer_load_dwordx4 v141, s[4:7], s16 offen offset:0 sc1 lds
    v_mfma_f32_16x16x32_bf16 a[16:19], v[16:19], v[32:35], a[16:19]
    ds_read_b64_tr_b16 v[54:55], v129 offset:24576
    v_mfma_f32_16x16x32_bf16 a[20:23], v[20:23], v[32:35], a[20:23]
    ds_read_b64_tr_b16 v[56:57], v130 offset:16384
    v_mfma_f32_16x16x32_bf16 a[24:27], v[24:27], v[32:35], a[24:27]
    ds_read_b64_tr_b16 v[58:59], v130 offset:24576
    buffer_load_dwordx4 v142, s[4:7], s16 offen offset:1024 sc1 lds
    v_mfma_f32_16x16x32_bf16 a[28:31], v[28:31], v[32:35], a[28:31]
    ds_read_b64_tr_b16 v[60:61], v131 offset:16384
    v_mfma_f32_16x16x32_bf16 a[32:35], v[0:3], v[36:39], a[32:35]
    ds_read_b64_tr_b16 v[62:63], v131 offset:24576
    v_mfma_f32_16x16x32_bf16 a[36:39], v[4:7], v[36:39], a[36:39]
    ds_read_b64_tr_b16 v[64:65], v132 offset:16384
    s_add_u32 s16, s16, 1024
    v_mfma_f32_16x16x32_bf16 a[40:43], v[8:11], v[36:39], a[40:43]
    ds_read_b64_tr_b16 v[66:67], v132 offset:24576
    v_mfma_f32_16x16x32_bf16 a[44:47], v[12:15], v[36:39], a[44:47]
    ds_read_b64_tr_b16 v[68:69], v133 offset:16384
    v_mfma_f32_16x16x32_bf16 a[48:51], v[16:19], v[36:39], a[48:51]
    ds_read_b64_tr_b16 v[70:71], v133 offset:24576
    s_add_u32 m0, s19, 0
    s_nop 0
    v_mfma_f32_16x16x32_bf16 a[52:55], v[20:23], v[36:39], a[52:55]
    ds_read_b64_tr_b16 v[72:73], v134 offset:16384
    v_mfma_f32_16x16x32_bf16 a[56:59], v[24:27], v[36:39], a[56:59]
    ds_read_b64_tr_b16 v[74:75], v134 offset:24576
    v_mfma_f32_16x16x32_bf16 a[60:63], v[28:31], v[36:39], a[60:63]
    ds_read_b64_tr_b16 v[76:77], v135 offset:16384
    buffer_load_dwordx4 v137, s[8:11], s15 offen offset:0 lds
    v_mfma_f32_16x16x32_bf16 a[64:67], v[0:3], v[40:43], a[64:67]
    ds_read_b64_tr_b16 v[78:79], v135 offset:24576
    v_mfma_f32_16x16x32_bf16 a[68:71], v[4:7], v[40:43], a[68:71]
    ds_read_b128 v[84:87], v136 offset:9216
    v_mfma_f32_16x16x32_bf16 a[72:75], v[8:11], v[40:43], a[72:75]
    ds_read_b128 v[88:91], v136 offset:10240
    buffer_load_dwordx4 v138, s[8:11], s15 offen offset:1024 lds
    v_mfma_f32_16x16x32_bf16 a[76:79], v[12:15], v[40:43], a[76:79]
    ds_read_b128 v[92:95], v136 offset:11264
    v_mfma_f32_16x16x32_bf16 a[80:83], v[16:19], v[40:43], a[80:83]
    v_mfma_f32_16x16x32_bf16 a[84:87], v[20:23], v[40:43], a[84:87]
    buffer_load_dwordx4 v139, s[8:11], s15 offen offset:2048 lds
    v_mfma_f32_16x16x32_bf16 a[88:91], v[24:27], v[40:43], a[88:91]
    v_mfma_f32_16x16x32_bf16 a[92:95], v[28:31], v[40:43], a[92:95]
    v_mfma_f32_16x16x32_bf16 a[96:99], v[0:3], v[44:47], a[96:99]
    buffer_load_dwordx4 v140, s[8:11], s15 offen offset:3072 lds
    v_mfma_f32_16x16x32_bf16 a[100:103], v[4:7], v[44:47], a[100:103]
    v_mfma_f32_16x16x32_bf16 a[104:107], v[8:11], v[44:47], a[104:107]
    v_mfma_f32_16x16x32_bf16 a[108:111], v[12:15], v[44:47], a[108:111]
    s_add_u32 s15, s15, s17
    v_mfma_f32_16x16x32_bf16 a[112:115], v[16:19], v[44:47], a[112:115]
    v_mfma_f32_16x16x32_bf16 a[116:119], v[20:23], v[44:47], a[116:119]
    v_mfma_f32_16x16x32_bf16 a[120:123], v[24:27], v[44:47], a[120:123]
    v_mfma_f32_16x16x32_bf16 a[124:127], v[28:31], v[44:47], a[124:127]
    s_waitcnt lgkmcnt(0)
    v_mfma_f32_16x16x32_bf16 a[0:3], v[48:51], v[80:83], a[0:3]
    s_waitcnt vmcnt(12)
    s_barrier
    ds_read_b128 v[32:35], v136 offset:16384
    s_add_u32 m0, s20, 8192
    s_nop 0
    v_mfma_f32_16x16x32_bf16 a[4:7], v[52:55], v[80:83], a[4:7]
    ds_read_b64_tr_b16 v[0:1], v128 offset:32768
    v_mfma_f32_16x16x32_bf16 a[8:11], v[56:59], v[80:83], a[8:11]
    ds_read_b64_tr_b16 v[2:3], v128 offset:40960
    v_mfma_f32_16x16x32_bf16 a[12:15], v[60:63], v[80:83], a[12:15]
    ds_read_b64_tr_b16 v[4:5], v129 offset:32768
    buffer_load_dwordx4 v141, s[4:7], s16 offen offset:0 sc1 lds
    v_mfma_f32_16x16x32_bf16 a[16:19], v[64:67], v[80:83], a[16:19]
    ds_read_b64_tr_b16 v[6:7], v129 offset:40960
    v_mfma_f32_16x16x32_bf16 a[20:23], v[68:71], v[80:83], a[20:23]
    ds_read_b64_tr_b16 v[8:9], v130 offset:32768
    v_mfma_f32_16x16x32_bf16 a[24:27], v[72:75], v[80:83], a[24:27]
    ds_read_b64_tr_b16 v[10:11], v130 offset:40960
    buffer_load_dwordx4 v142, s[4:7], s16 offen offset:1024 sc1 lds
    v_mfma_f32_16x16x32_bf16 a[28:31], v[76:79], v[80:83], a[28:31]
    ds_read_b64_tr_b16 v[12:13], v131 offset:32768
    v_mfma_f32_16x16x32_bf16 a[32:35], v[48:51], v[84:87], a[32:35]
    ds_read_b64_tr_b16 v[14:15], v131 offset:40960
    v_mfma_f32_16x16x32_bf16 a[36:39], v[52:55], v[84:87], a[36:39]
    ds_read_b64_tr_b16 v[16:17], v132 offset:32768
    s_add_u32 s16, s16, 1024
    v_mfma_f32_16x16x32_bf16 a[40:43], v[56:59], v[84:87], a[40:43]
    ds_read_b64_tr_b16 v[18:19], v132 offset:40960
    v_mfma_f32_16x16x32_bf16 a[44:47], v[60:63], v[84:87], a[44:47]
    ds_read_b64_tr_b16 v[20:21], v133 offset:32768
    v_mfma_f32_16x16x32_bf16 a[48:51], v[64:67], v[84:87], a[48:51]
    ds_read_b64_tr_b16 v[22:23], v133 offset:40960
    s_add_u32 m0, s19, 16384
    s_nop 0
    v_mfma_f32_16x16x32_bf16 a[52:55], v[68:71], v[84:87], a[52:55]
    ds_read_b64_tr_b16 v[24:25], v134 offset:32768
    v_mfma_f32_16x16x32_bf16 a[56:59], v[72:75], v[84:87], a[56:59]
    ds_read_b64_tr_b16 v[26:27], v134 offset:40960
    v_mfma_f32_16x16x32_bf16 a[60:63], v[76:79], v[84:87], a[60:63]
    ds_read_b64_tr_b16 v[28:29], v135 offset:32768
    buffer_load_dwordx4 v137, s[8:11], s15 offen offset:0 lds
    v_mfma_f32_16x16x32_bf16 a[64:67], v[48:51], v[88:91], a[64:67]
    ds_read_b64_tr_b16 v[30:31], v135 offset:40960
    v_mfma_f32_16x16x32_bf16 a[68:71], v[52:55], v[88:91], a[68:71]
    ds_read_b128 v[36:39], v136 offset:17408
    v_mfma_f32_16x16x32_bf16 a[72:75], v[56:59], v[88:91], a[72:75]
    ds_read_b128 v[40:43], v136 offset:18432
    buffer_load_dwordx4 v138, s[8:11], s15 offen offset:1024 lds
    v_mfma_f32_16x16x32_bf16 a[76:79], v[60:63], v[88:91], a[76:79]
    ds_read_b128 v[44:47], v136 offset:19456
    v_mfma_f32_16x16x32_bf16 a[80:83], v[64:67], v[88:91], a[80:83]
    v_mfma_f32_16x16x32_bf16 a[84:87], v[68:71], v[88:91], a[84:87]
    buffer_load_dwordx4 v139, s[8:11], s15 offen offset:2048 lds
    v_mfma_f32_16x16x32_bf16 a[88:91], v[72:75], v[88:91], a[88:91]
    v_mfma_f32_16x16x32_bf16 a[92:95], v[76:79], v[88:91], a[92:95]
    v_mfma_f32_16x16x32_bf16 a[96:99], v[48:51], v[92:95], a[96:99]
    buffer_load_dwordx4 v140, s[8:11], s15 offen offset:3072 lds
    v_mfma_f32_16x16x32_bf16 a[100:103], v[52:55], v[92:95], a[100:103]
    v_mfma_f32_16x16x32_bf16 a[104:107], v[56:59], v[92:95], a[104:107]
    v_mfma_f32_16x16x32_bf16 a[108:111], v[60:63], v[92:95], a[108:111]
    s_add_u32 s15, s15, s17
    v_mfma_f32_16x16x32_bf16 a[112:115], v[64:67], v[92:95], a[112:115]
    v_mfma_f32_16x16x32_bf16 a[116:119], v[68:71], v[92:95], a[116:119]
    v_mfma_f32_16x16x32_bf16 a[120:123], v[72:75], v[92:95], a[120:123]
    v_mfma_f32_16x16x32_bf16 a[124:127], v[76:79], v[92:95], a[124:127]
    s_waitcnt lgkmcnt(0)
    v_mfma_f32_16x16x32_bf16 a[0:3], v[0:3], v[32:35], a[0:3]
    s_waitcnt vmcnt(12)
    s_barrier
    ds_read_b128 v[80:83], v136 offset:24576
    s_add_u32 m0, s20, 16384
    s_nop 0
    v_mfma_f32_16x16x32_bf16 a[4:7], v[4:7], v[32:35], a[4:7]
    ds_read_b64_tr_b16 v[48:49], v128 offset:49152
    v_mfma_f32_16x16x32_bf16 a[8:11], v[8:11], v[32:35], a[8:11]
    ds_read_b64_tr_b16 v[50:51], v128 offset:57344
    v_mfma_f32_16x16x32_bf16 a[12:15], v[12:15], v[32:35], a[12:15]
    ds_read_b64_tr_b16 v[52:53], v129 offset:49152
    buffer_load_dwordx4 v141, s[4:7], s16 offen offset:0 sc1 lds
    v_mfma_f32_16x16x32_bf16 a[16:19], v[16:19], v[32:35], a[16:19]
    ds_read_b64_tr_b16 v[54:55], v129 offset:57344
    v_mfma_f32_16x16x32_bf16 a[20:23], v[20:23], v[32:35], a[20:23]
    ds_read_b64_tr_b16 v[56:57], v130 offset:49152
    v_mfma_f32_16x16x32_bf16 a[24:27], v[24:27], v[32:35], a[24:27]
    ds_read_b64_tr_b16 v[58:59], v130 offset:57344
    buffer_load_dwordx4 v142, s[4:7], s16 offen offset:1024 sc1 lds
    v_mfma_f32_16x16x32_bf16 a[28:31], v[28:31], v[32:35], a[28:31]
    ds_read_b64_tr_b16 v[60:61], v131 offset:49152
    v_mfma_f32_16x16x32_bf16 a[32:35], v[0:3], v[36:39], a[32:35]
    ds_read_b64_tr_b16 v[62:63], v131 offset:57344
    v_mfma_f32_16x16x32_bf16 a[36:39], v[4:7], v[36:39], a[36:39]
    ds_read_b64_tr_b16 v[64:65], v132 offset:49152
    s_add_u32 s16, s16, 1024
    v_mfma_f32_16x16x32_bf16 a[40:43], v[8:11], v[36:39], a[40:43]
    ds_read_b64_tr_b16 v[66:67], v132 offset:57344
    v_mfma_f32_16x16x32_bf16 a[44:47], v[12:15], v[36:39], a[44:47]
    ds_read_b64_tr_b16 v[68:69], v133 offset:49152
    v_mfma_f32_16x16x32_bf16 a[48:51], v[16:19], v[36:39], a[48:51]
    ds_read_b64_tr_b16 v[70:71], v133 offset:57344
    s_add_u32 m0, s19, 32768
    s_nop 0
    v_mfma_f32_16x16x32_bf16 a[52:55], v[20:23], v[36:39], a[52:55]
    ds_read_b64_tr_b16 v[72:73], v134 offset:49152
    v_mfma_f32_16x16x32_bf16 a[56:59], v[24:27], v[36:39], a[56:59]
    ds_read_b64_tr_b16 v[74:75], v134 offset:57344
    v_mfma_f32_16x16x32_bf16 a[60:63], v[28:31], v[36:39], a[60:63]
    ds_read_b64_tr_b16 v[76:77], v135 offset:49152
    buffer_load_dwordx4 v137, s[8:11], s15 offen offset:0 lds
    v_mfma_f32_16x16x32_bf16 a[64:67], v[0:3], v[40:43], a[64:67]
    ds_read_b64_tr_b16 v[78:79], v135 offset:57344
    v_mfma_f32_16x16x32_bf16 a[68:71], v[4:7], v[40:43], a[68:71]
    ds_read_b128 v[84:87], v136 offset:25600
    v_mfma_f32_16x16x32_bf16 a[72:75], v[8:11], v[40:43], a[72:75]
    ds_read_b128 v[88:91], v136 offset:26624
    buffer_load_dwordx4 v138, s[8:11], s15 offen offset:1024 lds
    v_mfma_f32_16x16x32_bf16 a[76:79], v[12:15], v[40:43], a[76:79]
    ds_read_b128 v[92:95], v136 offset:27648
    v_mfma_f32_16x16x32_bf16 a[80:83], v[16:19], v[40:43], a[80:83]
    v_mfma_f32_16x16x32_bf16 a[84:87], v[20:23], v[40:43], a[84:87]
    buffer_load_dwordx4 v139, s[8:11], s15 offen offset:2048 lds
    v_mfma_f32_16x16x32_bf16 a[88:91], v[24:27], v[40:43], a[88:91]
    v_mfma_f32_16x16x32_bf16 a[92:95], v[28:31], v[40:43], a[92:95]
    v_mfma_f32_16x16x32_bf16 a[96:99], v[0:3], v[44:47], a[96:99]
    buffer_load_dwordx4 v140, s[8:11], s15 offen offset:3072 lds
    v_mfma_f32_16x16x32_bf16 a[100:103], v[4:7], v[44:47], a[100:103]
    v_mfma_f32_16x16x32_bf16 a[104:107], v[8:11], v[44:47], a[104:107]
    v_mfma_f32_16x16x32_bf16 a[108:111], v[12:15], v[44:47], a[108:111]
    s_add_u32 s15, s15, s17
    v_mfma_f32_16x16x32_bf16 a[112:115], v[16:19], v[44:47], a[112:115]
    v_mfma_f32_16x16x32_bf16 a[116:119], v[20:23], v[44:47], a[116:119]
    v_mfma_f32_16x16x32_bf16 a[120:123], v[24:27], v[44:47], a[120:123]
    v_mfma_f32_16x16x32_bf16 a[124:127], v[28:31], v[44:47], a[124:127]
    s_waitcnt lgkmcnt(0)
    v_mfma_f32_16x16x32_bf16 a[0:3], v[48:51], v[80:83], a[0:3]
    s_waitcnt vmcnt(12)
    s_barrier
    ds_read_b128 v[32:35], v136 offset:0
    s_add_u32 m0, s20, 24576
    s_nop 0
    v_mfma_f32_16x16x32_bf16 a[4:7], v[52:55], v[80:83], a[4:7]
    ds_read_b64_tr_b16 v[0:1], v128 offset:0
    v_mfma_f32_16x16x32_bf16 a[8:11], v[56:59], v[80:83], a[8:11]
    ds_read_b64_tr_b16 v[2:3], v128 offset:8192
    v_mfma_f32_16x16x32_bf16 a[12:15], v[60:63], v[80:83], a[12:15]
    ds_read_b64_tr_b16 v[4:5], v129 offset:0
    buffer_load_dwordx4 v141, s[4:7], s16 offen offset:0 sc1 lds
    v_mfma_f32_16x16x32_bf16 a[16:19], v[64:67], v[80:83], a[16:19]
    ds_read_b64_tr_b16 v[6:7], v129 offset:8192
    v_mfma_f32_16x16x32_bf16 a[20:23], v[68:71], v[80:83], a[20:23]
    ds_read_b64_tr_b16 v[8:9], v130 offset:0
    v_mfma_f32_16x16x32_bf16 a[24:27], v[72:75], v[80:83], a[24:27]
    ds_read_b64_tr_b16 v[10:11], v130 offset:8192
    buffer_load_dwordx4 v142, s[4:7], s16 offen offset:1024 sc1 lds
    v_mfma_f32_16x16x32_bf16 a[28:31], v[76:79], v[80:83], a[28:31]
    ds_read_b64_tr_b16 v[12:13], v131 offset:0
    v_mfma_f32_16x16x32_bf16 a[32:35], v[48:51], v[84:87], a[32:35]
    ds_read_b64_tr_b16 v[14:15], v131 offset:8192
    v_mfma_f32_16x16x32_bf16 a[36:39], v[52:55], v[84:87], a[36:39]
    ds_read_b64_tr_b16 v[16:17], v132 offset:0
    s_add_u32 s16, s16, 1024
    v_mfma_f32_16x16x32_bf16 a[40:43], v[56:59], v[84:87], a[40:43]
    ds_read_b64_tr_b16 v[18:19], v132 offset:8192
    v_mfma_f32_16x16x32_bf16 a[44:47], v[60:63], v[84:87], a[44:47]
    ds_read_b64_tr_b16 v[20:21], v133 offset:0
    v_mfma_f32_16x16x32_bf16 a[48:51], v[64:67], v[84:87], a[48:51]
    ds_read_b64_tr_b16 v[22:23], v133 offset:8192
    s_add_u32 m0, s19, 49152
    s_nop 0
    v_mfma_f32_16x16x32_bf16 a[52:55], v[68:71], v[84:87], a[52:55]
    ds_read_b64_tr_b16 v[24:25], v134 offset:0
    v_mfma_f32_16x16x32_bf16 a[56:59], v[72:75], v[84:87], a[56:59]
    ds_read_b64_tr_b16 v[26:27], v134 offset:8192
    v_mfma_f32_16x16x32_bf16 a[60:63], v[76:79], v[84:87], a[60:63]
    ds_read_b64_tr_b16 v[28:29], v135 offset:0
    buffer_load_dwordx4 v137, s[8:11], s15 offen offset:0 lds
    v_mfma_f32_16x16x32_bf16 a[64:67], v[48:51], v[88:91], a[64:67]
    ds_read_b64_tr_b16 v[30:31], v135 offset:8192
    v_mfma_f32_16x16x32_bf16 a[68:71], v[52:55], v[88:91], a[68:71]
    ds_read_b128 v[36:39], v136 offset:1024
    v_mfma_f32_16x16x32_bf16 a[72:75], v[56:59], v[88:91], a[72:75]
    ds_read_b128 v[40:43], v136 offset:2048
    buffer_load_dwordx4 v138, s[8:11], s15 offen offset:1024 lds
    v_mfma_f32_16x16x32_bf16 a[76:79], v[60:63], v[88:91], a[76:79]
    ds_read_b128 v[44:47], v136 offset:3072
    v_mfma_f32_16x16x32_bf16 a[80:83], v[64:67], v[88:91], a[80:83]
    v_mfma_f32_16x16x32_bf16 a[84:87], v[68:71], v[88:91], a[84:87]
    buffer_load_dwordx4 v139, s[8:11], s15 offen offset:2048 lds
    v_mfma_f32_16x16x32_bf16 a[88:91], v[72:75], v[88:91], a[88:91]
    v_mfma_f32_16x16x32_bf16 a[92:95], v[76:79], v[88:91], a[92:95]
    v_mfma_f32_16x16x32_bf16 a[96:99], v[48:51], v[92:95], a[96:99]
    buffer_load_dwordx4 v140, s[8:11], s15 offen offset:3072 lds
    v_mfma_f32_16x16x32_bf16 a[100:103], v[52:55], v[92:95], a[100:103]
    v_mfma_f32_16x16x32_bf16 a[104:107], v[56:59], v[92:95], a[104:107]
    v_mfma_f32_16x16x32_bf16 a[108:111], v[60:63], v[92:95], a[108:111]
    s_add_u32 s15, s15, s17
    v_mfma_f32_16x16x32_bf16 a[112:115], v[64:67], v[92:95], a[112:115]
    v_mfma_f32_16x16x32_bf16 a[116:119], v[68:71], v[92:95], a[116:119]
    v_mfma_f32_16x16x32_bf16 a[120:123], v[72:75], v[92:95], a[120:123]
    v_mfma_f32_16x16x32_bf16 a[124:127], v[76:79], v[92:95], a[124:127]
    s_sub_u32 s18, s18, 1
    s_cmp_lg_u32 s18, 0
    s_cbranch_scc1 main_kernel_w_c1_n_loop
    s_cmp_lg_u32 s14, 0
    s_cbranch_scc1 main_kernel_w_c1_n_nt
    s_lshl_b32 s32, s27, 8
    s_add_u32 s32, s32, 0x841e000
    v_mov_b32 v255, 1
    s_mov_b64 exec, 1
    buffer_atomic_add v255, off, s[4:7], s32 sc0 sc1
    s_mov_b64 exec, -1
main_kernel_w_c1_n_nt:
    s_waitcnt lgkmcnt(0)
    v_mfma_f32_16x16x32_bf16 a[0:3], v[0:3], v[32:35], a[0:3]
    s_waitcnt vmcnt(12)
    s_barrier
    ds_read_b128 v[80:83], v136 offset:8192
    v_mfma_f32_16x16x32_bf16 a[4:7], v[4:7], v[32:35], a[4:7]
    ds_read_b64_tr_b16 v[48:49], v128 offset:16384
    v_mfma_f32_16x16x32_bf16 a[8:11], v[8:11], v[32:35], a[8:11]
    ds_read_b64_tr_b16 v[50:51], v128 offset:24576
    v_mfma_f32_16x16x32_bf16 a[12:15], v[12:15], v[32:35], a[12:15]
    ds_read_b64_tr_b16 v[52:53], v129 offset:16384
    v_mfma_f32_16x16x32_bf16 a[16:19], v[16:19], v[32:35], a[16:19]
    ds_read_b64_tr_b16 v[54:55], v129 offset:24576
    v_mfma_f32_16x16x32_bf16 a[20:23], v[20:23], v[32:35], a[20:23]
    ds_read_b64_tr_b16 v[56:57], v130 offset:16384
    v_mfma_f32_16x16x32_bf16 a[24:27], v[24:27], v[32:35], a[24:27]
    ds_read_b64_tr_b16 v[58:59], v130 offset:24576
    v_mfma_f32_16x16x32_bf16 a[28:31], v[28:31], v[32:35], a[28:31]
    ds_read_b64_tr_b16 v[60:61], v131 offset:16384
    v_mfma_f32_16x16x32_bf16 a[32:35], v[0:3], v[36:39], a[32:35]
    ds_read_b64_tr_b16 v[62:63], v131 offset:24576
    v_mfma_f32_16x16x32_bf16 a[36:39], v[4:7], v[36:39], a[36:39]
    ds_read_b64_tr_b16 v[64:65], v132 offset:16384
    v_mfma_f32_16x16x32_bf16 a[40:43], v[8:11], v[36:39], a[40:43]
    ds_read_b64_tr_b16 v[66:67], v132 offset:24576
    v_mfma_f32_16x16x32_bf16 a[44:47], v[12:15], v[36:39], a[44:47]
    ds_read_b64_tr_b16 v[68:69], v133 offset:16384
    v_mfma_f32_16x16x32_bf16 a[48:51], v[16:19], v[36:39], a[48:51]
    ds_read_b64_tr_b16 v[70:71], v133 offset:24576
    v_mfma_f32_16x16x32_bf16 a[52:55], v[20:23], v[36:39], a[52:55]
    ds_read_b64_tr_b16 v[72:73], v134 offset:16384
    v_mfma_f32_16x16x32_bf16 a[56:59], v[24:27], v[36:39], a[56:59]
    ds_read_b64_tr_b16 v[74:75], v134 offset:24576
    v_mfma_f32_16x16x32_bf16 a[60:63], v[28:31], v[36:39], a[60:63]
    ds_read_b64_tr_b16 v[76:77], v135 offset:16384
    v_mfma_f32_16x16x32_bf16 a[64:67], v[0:3], v[40:43], a[64:67]
    ds_read_b64_tr_b16 v[78:79], v135 offset:24576
    v_mfma_f32_16x16x32_bf16 a[68:71], v[4:7], v[40:43], a[68:71]
    ds_read_b128 v[84:87], v136 offset:9216
    v_mfma_f32_16x16x32_bf16 a[72:75], v[8:11], v[40:43], a[72:75]
    ds_read_b128 v[88:91], v136 offset:10240
    v_mfma_f32_16x16x32_bf16 a[76:79], v[12:15], v[40:43], a[76:79]
    ds_read_b128 v[92:95], v136 offset:11264
    v_mfma_f32_16x16x32_bf16 a[80:83], v[16:19], v[40:43], a[80:83]
    v_mfma_f32_16x16x32_bf16 a[84:87], v[20:23], v[40:43], a[84:87]
    v_mfma_f32_16x16x32_bf16 a[88:91], v[24:27], v[40:43], a[88:91]
    v_mfma_f32_16x16x32_bf16 a[92:95], v[28:31], v[40:43], a[92:95]
    v_mfma_f32_16x16x32_bf16 a[96:99], v[0:3], v[44:47], a[96:99]
    v_mfma_f32_16x16x32_bf16 a[100:103], v[4:7], v[44:47], a[100:103]
    v_mfma_f32_16x16x32_bf16 a[104:107], v[8:11], v[44:47], a[104:107]
    v_mfma_f32_16x16x32_bf16 a[108:111], v[12:15], v[44:47], a[108:111]
    v_mfma_f32_16x16x32_bf16 a[112:115], v[16:19], v[44:47], a[112:115]
    v_mfma_f32_16x16x32_bf16 a[116:119], v[20:23], v[44:47], a[116:119]
    v_mfma_f32_16x16x32_bf16 a[120:123], v[24:27], v[44:47], a[120:123]
    v_mfma_f32_16x16x32_bf16 a[124:127], v[28:31], v[44:47], a[124:127]
    s_waitcnt lgkmcnt(0)
    v_mfma_f32_16x16x32_bf16 a[0:3], v[48:51], v[80:83], a[0:3]
    s_waitcnt vmcnt(6)
    s_barrier
    ds_read_b128 v[32:35], v136 offset:16384
    v_mfma_f32_16x16x32_bf16 a[4:7], v[52:55], v[80:83], a[4:7]
    ds_read_b64_tr_b16 v[0:1], v128 offset:32768
    v_mfma_f32_16x16x32_bf16 a[8:11], v[56:59], v[80:83], a[8:11]
    ds_read_b64_tr_b16 v[2:3], v128 offset:40960
    v_mfma_f32_16x16x32_bf16 a[12:15], v[60:63], v[80:83], a[12:15]
    ds_read_b64_tr_b16 v[4:5], v129 offset:32768
    v_mfma_f32_16x16x32_bf16 a[16:19], v[64:67], v[80:83], a[16:19]
    ds_read_b64_tr_b16 v[6:7], v129 offset:40960
    v_mfma_f32_16x16x32_bf16 a[20:23], v[68:71], v[80:83], a[20:23]
    ds_read_b64_tr_b16 v[8:9], v130 offset:32768
    v_mfma_f32_16x16x32_bf16 a[24:27], v[72:75], v[80:83], a[24:27]
    ds_read_b64_tr_b16 v[10:11], v130 offset:40960
    v_mfma_f32_16x16x32_bf16 a[28:31], v[76:79], v[80:83], a[28:31]
    ds_read_b64_tr_b16 v[12:13], v131 offset:32768
    v_mfma_f32_16x16x32_bf16 a[32:35], v[48:51], v[84:87], a[32:35]
    ds_read_b64_tr_b16 v[14:15], v131 offset:40960
    v_mfma_f32_16x16x32_bf16 a[36:39], v[52:55], v[84:87], a[36:39]
    ds_read_b64_tr_b16 v[16:17], v132 offset:32768
    v_mfma_f32_16x16x32_bf16 a[40:43], v[56:59], v[84:87], a[40:43]
    ds_read_b64_tr_b16 v[18:19], v132 offset:40960
    v_mfma_f32_16x16x32_bf16 a[44:47], v[60:63], v[84:87], a[44:47]
    ds_read_b64_tr_b16 v[20:21], v133 offset:32768
    v_mfma_f32_16x16x32_bf16 a[48:51], v[64:67], v[84:87], a[48:51]
    ds_read_b64_tr_b16 v[22:23], v133 offset:40960
    v_mfma_f32_16x16x32_bf16 a[52:55], v[68:71], v[84:87], a[52:55]
    ds_read_b64_tr_b16 v[24:25], v134 offset:32768
    v_mfma_f32_16x16x32_bf16 a[56:59], v[72:75], v[84:87], a[56:59]
    ds_read_b64_tr_b16 v[26:27], v134 offset:40960
    v_mfma_f32_16x16x32_bf16 a[60:63], v[76:79], v[84:87], a[60:63]
    ds_read_b64_tr_b16 v[28:29], v135 offset:32768
    v_mfma_f32_16x16x32_bf16 a[64:67], v[48:51], v[88:91], a[64:67]
    ds_read_b64_tr_b16 v[30:31], v135 offset:40960
    v_mfma_f32_16x16x32_bf16 a[68:71], v[52:55], v[88:91], a[68:71]
    ds_read_b128 v[36:39], v136 offset:17408
    v_mfma_f32_16x16x32_bf16 a[72:75], v[56:59], v[88:91], a[72:75]
    ds_read_b128 v[40:43], v136 offset:18432
    v_mfma_f32_16x16x32_bf16 a[76:79], v[60:63], v[88:91], a[76:79]
    ds_read_b128 v[44:47], v136 offset:19456
    v_mfma_f32_16x16x32_bf16 a[80:83], v[64:67], v[88:91], a[80:83]
    v_mfma_f32_16x16x32_bf16 a[84:87], v[68:71], v[88:91], a[84:87]
    v_mfma_f32_16x16x32_bf16 a[88:91], v[72:75], v[88:91], a[88:91]
    v_mfma_f32_16x16x32_bf16 a[92:95], v[76:79], v[88:91], a[92:95]
    v_mfma_f32_16x16x32_bf16 a[96:99], v[48:51], v[92:95], a[96:99]
    v_mfma_f32_16x16x32_bf16 a[100:103], v[52:55], v[92:95], a[100:103]
    v_mfma_f32_16x16x32_bf16 a[104:107], v[56:59], v[92:95], a[104:107]
    v_mfma_f32_16x16x32_bf16 a[108:111], v[60:63], v[92:95], a[108:111]
    v_mfma_f32_16x16x32_bf16 a[112:115], v[64:67], v[92:95], a[112:115]
    v_mfma_f32_16x16x32_bf16 a[116:119], v[68:71], v[92:95], a[116:119]
    v_mfma_f32_16x16x32_bf16 a[120:123], v[72:75], v[92:95], a[120:123]
    v_mfma_f32_16x16x32_bf16 a[124:127], v[76:79], v[92:95], a[124:127]
    s_waitcnt lgkmcnt(0)
    v_mfma_f32_16x16x32_bf16 a[0:3], v[0:3], v[32:35], a[0:3]
    s_waitcnt vmcnt(0)
    s_barrier
    ds_read_b128 v[80:83], v136 offset:24576
    v_mfma_f32_16x16x32_bf16 a[4:7], v[4:7], v[32:35], a[4:7]
    ds_read_b64_tr_b16 v[48:49], v128 offset:49152
    v_mfma_f32_16x16x32_bf16 a[8:11], v[8:11], v[32:35], a[8:11]
    ds_read_b64_tr_b16 v[50:51], v128 offset:57344
    v_mfma_f32_16x16x32_bf16 a[12:15], v[12:15], v[32:35], a[12:15]
    ds_read_b64_tr_b16 v[52:53], v129 offset:49152
    v_mfma_f32_16x16x32_bf16 a[16:19], v[16:19], v[32:35], a[16:19]
    ds_read_b64_tr_b16 v[54:55], v129 offset:57344
    v_mfma_f32_16x16x32_bf16 a[20:23], v[20:23], v[32:35], a[20:23]
    ds_read_b64_tr_b16 v[56:57], v130 offset:49152
    v_mfma_f32_16x16x32_bf16 a[24:27], v[24:27], v[32:35], a[24:27]
    ds_read_b64_tr_b16 v[58:59], v130 offset:57344
    v_mfma_f32_16x16x32_bf16 a[28:31], v[28:31], v[32:35], a[28:31]
    ds_read_b64_tr_b16 v[60:61], v131 offset:49152
    v_mfma_f32_16x16x32_bf16 a[32:35], v[0:3], v[36:39], a[32:35]
    ds_read_b64_tr_b16 v[62:63], v131 offset:57344
    v_mfma_f32_16x16x32_bf16 a[36:39], v[4:7], v[36:39], a[36:39]
    ds_read_b64_tr_b16 v[64:65], v132 offset:49152
    v_mfma_f32_16x16x32_bf16 a[40:43], v[8:11], v[36:39], a[40:43]
    ds_read_b64_tr_b16 v[66:67], v132 offset:57344
    v_mfma_f32_16x16x32_bf16 a[44:47], v[12:15], v[36:39], a[44:47]
    ds_read_b64_tr_b16 v[68:69], v133 offset:49152
    v_mfma_f32_16x16x32_bf16 a[48:51], v[16:19], v[36:39], a[48:51]
    ds_read_b64_tr_b16 v[70:71], v133 offset:57344
    v_mfma_f32_16x16x32_bf16 a[52:55], v[20:23], v[36:39], a[52:55]
    ds_read_b64_tr_b16 v[72:73], v134 offset:49152
    v_mfma_f32_16x16x32_bf16 a[56:59], v[24:27], v[36:39], a[56:59]
    ds_read_b64_tr_b16 v[74:75], v134 offset:57344
    v_mfma_f32_16x16x32_bf16 a[60:63], v[28:31], v[36:39], a[60:63]
    ds_read_b64_tr_b16 v[76:77], v135 offset:49152
    v_mfma_f32_16x16x32_bf16 a[64:67], v[0:3], v[40:43], a[64:67]
    ds_read_b64_tr_b16 v[78:79], v135 offset:57344
    v_mfma_f32_16x16x32_bf16 a[68:71], v[4:7], v[40:43], a[68:71]
    ds_read_b128 v[84:87], v136 offset:25600
    v_mfma_f32_16x16x32_bf16 a[72:75], v[8:11], v[40:43], a[72:75]
    ds_read_b128 v[88:91], v136 offset:26624
    v_mfma_f32_16x16x32_bf16 a[76:79], v[12:15], v[40:43], a[76:79]
    ds_read_b128 v[92:95], v136 offset:27648
    v_mfma_f32_16x16x32_bf16 a[80:83], v[16:19], v[40:43], a[80:83]
    v_mfma_f32_16x16x32_bf16 a[84:87], v[20:23], v[40:43], a[84:87]
    v_mfma_f32_16x16x32_bf16 a[88:91], v[24:27], v[40:43], a[88:91]
    v_mfma_f32_16x16x32_bf16 a[92:95], v[28:31], v[40:43], a[92:95]
    v_mfma_f32_16x16x32_bf16 a[96:99], v[0:3], v[44:47], a[96:99]
    v_mfma_f32_16x16x32_bf16 a[100:103], v[4:7], v[44:47], a[100:103]
    v_mfma_f32_16x16x32_bf16 a[104:107], v[8:11], v[44:47], a[104:107]
    v_mfma_f32_16x16x32_bf16 a[108:111], v[12:15], v[44:47], a[108:111]
    v_mfma_f32_16x16x32_bf16 a[112:115], v[16:19], v[44:47], a[112:115]
    v_mfma_f32_16x16x32_bf16 a[116:119], v[20:23], v[44:47], a[116:119]
    v_mfma_f32_16x16x32_bf16 a[120:123], v[24:27], v[44:47], a[120:123]
    v_mfma_f32_16x16x32_bf16 a[124:127], v[28:31], v[44:47], a[124:127]
    v_readfirstlane_b32 s55, v255
    s_waitcnt lgkmcnt(0)
    v_mfma_f32_16x16x32_bf16 a[0:3], v[48:51], v[80:83], a[0:3]
    v_mfma_f32_16x16x32_bf16 a[4:7], v[52:55], v[80:83], a[4:7]
    v_mfma_f32_16x16x32_bf16 a[8:11], v[56:59], v[80:83], a[8:11]
    v_mfma_f32_16x16x32_bf16 a[12:15], v[60:63], v[80:83], a[12:15]
    v_mfma_f32_16x16x32_bf16 a[16:19], v[64:67], v[80:83], a[16:19]
    v_mfma_f32_16x16x32_bf16 a[20:23], v[68:71], v[80:83], a[20:23]
    v_mfma_f32_16x16x32_bf16 a[24:27], v[72:75], v[80:83], a[24:27]
    v_mfma_f32_16x16x32_bf16 a[28:31], v[76:79], v[80:83], a[28:31]
    v_mfma_f32_16x16x32_bf16 a[32:35], v[48:51], v[84:87], a[32:35]
    v_mfma_f32_16x16x32_bf16 a[36:39], v[52:55], v[84:87], a[36:39]
    v_mfma_f32_16x16x32_bf16 a[40:43], v[56:59], v[84:87], a[40:43]
    v_mfma_f32_16x16x32_bf16 a[44:47], v[60:63], v[84:87], a[44:47]
    v_mfma_f32_16x16x32_bf16 a[48:51], v[64:67], v[84:87], a[48:51]
    v_mfma_f32_16x16x32_bf16 a[52:55], v[68:71], v[84:87], a[52:55]
    v_mfma_f32_16x16x32_bf16 a[56:59], v[72:75], v[84:87], a[56:59]
    v_mfma_f32_16x16x32_bf16 a[60:63], v[76:79], v[84:87], a[60:63]
    v_mfma_f32_16x16x32_bf16 a[64:67], v[48:51], v[88:91], a[64:67]
    v_mfma_f32_16x16x32_bf16 a[68:71], v[52:55], v[88:91], a[68:71]
    v_mfma_f32_16x16x32_bf16 a[72:75], v[56:59], v[88:91], a[72:75]
    v_mfma_f32_16x16x32_bf16 a[76:79], v[60:63], v[88:91], a[76:79]
    v_mfma_f32_16x16x32_bf16 a[80:83], v[64:67], v[88:91], a[80:83]
    v_mfma_f32_16x16x32_bf16 a[84:87], v[68:71], v[88:91], a[84:87]
    v_mfma_f32_16x16x32_bf16 a[88:91], v[72:75], v[88:91], a[88:91]
    v_mfma_f32_16x16x32_bf16 a[92:95], v[76:79], v[88:91], a[92:95]
    v_mfma_f32_16x16x32_bf16 a[96:99], v[48:51], v[92:95], a[96:99]
    v_mfma_f32_16x16x32_bf16 a[100:103], v[52:55], v[92:95], a[100:103]
    v_mfma_f32_16x16x32_bf16 a[104:107], v[56:59], v[92:95], a[104:107]
    v_mfma_f32_16x16x32_bf16 a[108:111], v[60:63], v[92:95], a[108:111]
    v_mfma_f32_16x16x32_bf16 a[112:115], v[64:67], v[92:95], a[112:115]
    v_mfma_f32_16x16x32_bf16 a[116:119], v[68:71], v[92:95], a[116:119]
    v_mfma_f32_16x16x32_bf16 a[120:123], v[72:75], v[92:95], a[120:123]
    v_mfma_f32_16x16x32_bf16 a[124:127], v[76:79], v[92:95], a[124:127]
    s_nop 7
    s_cmp_eq_u32 s23, 1
    s_cbranch_scc1 main_kernel_w_c1_escl
    s_cmp_eq_u32 s23, 3
    s_cbranch_scc1 main_kernel_w_c1_egelus
    s_cmp_eq_u32 s23, 6
    s_cbranch_scc1 main_kernel_w_c1_egelu
main_kernel_w_c1_eplain:
    s_mov_b32 s53, s21
    v_accvgpr_read_b32 v0, a0
    v_accvgpr_read_b32 v1, a1
    v_accvgpr_read_b32 v2, a2
    v_accvgpr_read_b32 v3, a3
    v_accvgpr_read_b32 v4, a4
    v_accvgpr_read_b32 v5, a5
    v_accvgpr_read_b32 v6, a6
    v_accvgpr_read_b32 v7, a7
    v_cvt_pk_bf16_f32 v16, v0, v1
    v_cvt_pk_bf16_f32 v17, v2, v3
    v_cvt_pk_bf16_f32 v18, v4, v5
    v_cvt_pk_bf16_f32 v19, v6, v7
    buffer_store_dwordx4 v[16:19], v251, s[4:7], s53 offen offset:0 sc1
    v_accvgpr_read_b32 v20, a8
    v_accvgpr_read_b32 v21, a9
    v_accvgpr_read_b32 v22, a10
    v_accvgpr_read_b32 v23, a11
    v_accvgpr_read_b32 v24, a12
    v_accvgpr_read_b32 v25, a13
    v_accvgpr_read_b32 v26, a14
    v_accvgpr_read_b32 v27, a15
    v_cvt_pk_bf16_f32 v36, v20, v21
    v_cvt_pk_bf16_f32 v37, v22, v23
    v_cvt_pk_bf16_f32 v38, v24, v25
    v_cvt_pk_bf16_f32 v39, v26, v27
    buffer_store_dwordx4 v[36:39], v251, s[4:7], s53 offen offset:1024 sc1
    v_accvgpr_read_b32 v40, a16
    v_accvgpr_read_b32 v41, a17
    v_accvgpr_read_b32 v42, a18
    v_accvgpr_read_b32 v43, a19
    v_accvgpr_read_b32 v44, a20
    v_accvgpr_read_b32 v45, a21
    v_accvgpr_read_b32 v46, a22
    v_accvgpr_read_b32 v47, a23
    v_cvt_pk_bf16_f32 v56, v40, v41
    v_cvt_pk_bf16_f32 v57, v42, v43
    v_cvt_pk_bf16_f32 v58, v44, v45
    v_cvt_pk_bf16_f32 v59, v46, v47
    buffer_store_dwordx4 v[56:59], v251, s[4:7], s53 offen offset:2048 sc1
    v_accvgpr_read_b32 v0, a24
    v_accvgpr_read_b32 v1, a25
    v_accvgpr_read_b32 v2, a26
    v_accvgpr_read_b32 v3, a27
    v_accvgpr_read_b32 v4, a28
    v_accvgpr_read_b32 v5, a29
    v_accvgpr_read_b32 v6, a30
    v_accvgpr_read_b32 v7, a31
    v_cvt_pk_bf16_f32 v16, v0, v1
    v_cvt_pk_bf16_f32 v17, v2, v3
    v_cvt_pk_bf16_f32 v18, v4, v5
    v_cvt_pk_bf16_f32 v19, v6, v7
    buffer_store_dwordx4 v[16:19], v251, s[4:7], s53 offen offset:3072 sc1
    s_add_u32 s53, s53, s22
    v_accvgpr_read_b32 v20, a32
    v_accvgpr_read_b32 v21, a33
    v_accvgpr_read_b32 v22, a34
    v_accvgpr_read_b32 v23, a35
    v_accvgpr_read_b32 v24, a36
    v_accvgpr_read_b32 v25, a37
    v_accvgpr_read_b32 v26, a38
    v_accvgpr_read_b32 v27, a39
    v_cvt_pk_bf16_f32 v36, v20, v21
    v_cvt_pk_bf16_f32 v37, v22, v23
    v_cvt_pk_bf16_f32 v38, v24, v25
    v_cvt_pk_bf16_f32 v39, v26, v27
    buffer_store_dwordx4 v[36:39], v251, s[4:7], s53 offen offset:0 sc1
    v_accvgpr_read_b32 v40, a40
    v_accvgpr_read_b32 v41, a41
    v_accvgpr_read_b32 v42, a42
    v_accvgpr_read_b32 v43, a43
    v_accvgpr_read_b32 v44, a44
    v_accvgpr_read_b32 v45, a45
    v_accvgpr_read_b32 v46, a46
    v_accvgpr_read_b32 v47, a47
    v_cvt_pk_bf16_f32 v56, v40, v41
    v_cvt_pk_bf16_f32 v57, v42, v43
    v_cvt_pk_bf16_f32 v58, v44, v45
    v_cvt_pk_bf16_f32 v59, v46, v47
    buffer_store_dwordx4 v[56:59], v251, s[4:7], s53 offen offset:1024 sc1
    v_accvgpr_read_b32 v0, a48
    v_accvgpr_read_b32 v1, a49
    v_accvgpr_read_b32 v2, a50
    v_accvgpr_read_b32 v3, a51
    v_accvgpr_read_b32 v4, a52
    v_accvgpr_read_b32 v5, a53
    v_accvgpr_read_b32 v6, a54
    v_accvgpr_read_b32 v7, a55
    v_cvt_pk_bf16_f32 v16, v0, v1
    v_cvt_pk_bf16_f32 v17, v2, v3
    v_cvt_pk_bf16_f32 v18, v4, v5
    v_cvt_pk_bf16_f32 v19, v6, v7
    buffer_store_dwordx4 v[16:19], v251, s[4:7], s53 offen offset:2048 sc1
    v_accvgpr_read_b32 v20, a56
    v_accvgpr_read_b32 v21, a57
    v_accvgpr_read_b32 v22, a58
    v_accvgpr_read_b32 v23, a59
    v_accvgpr_read_b32 v24, a60
    v_accvgpr_read_b32 v25, a61
    v_accvgpr_read_b32 v26, a62
    v_accvgpr_read_b32 v27, a63
    v_cvt_pk_bf16_f32 v36, v20, v21
    v_cvt_pk_bf16_f32 v37, v22, v23
    v_cvt_pk_bf16_f32 v38, v24, v25
    v_cvt_pk_bf16_f32 v39, v26, v27
    buffer_store_dwordx4 v[36:39], v251, s[4:7], s53 offen offset:3072 sc1
    s_add_u32 s53, s53, s22
    v_accvgpr_read_b32 v40, a64
    v_accvgpr_read_b32 v41, a65
    v_accvgpr_read_b32 v42, a66
    v_accvgpr_read_b32 v43, a67
    v_accvgpr_read_b32 v44, a68
    v_accvgpr_read_b32 v45, a69
    v_accvgpr_read_b32 v46, a70
    v_accvgpr_read_b32 v47, a71
    v_cvt_pk_bf16_f32 v56, v40, v41
    v_cvt_pk_bf16_f32 v57, v42, v43
    v_cvt_pk_bf16_f32 v58, v44, v45
    v_cvt_pk_bf16_f32 v59, v46, v47
    buffer_store_dwordx4 v[56:59], v251, s[4:7], s53 offen offset:0 sc1
    v_accvgpr_read_b32 v0, a72
    v_accvgpr_read_b32 v1, a73
    v_accvgpr_read_b32 v2, a74
    v_accvgpr_read_b32 v3, a75
    v_accvgpr_read_b32 v4, a76
    v_accvgpr_read_b32 v5, a77
    v_accvgpr_read_b32 v6, a78
    v_accvgpr_read_b32 v7, a79
    v_cvt_pk_bf16_f32 v16, v0, v1
    v_cvt_pk_bf16_f32 v17, v2, v3
    v_cvt_pk_bf16_f32 v18, v4, v5
    v_cvt_pk_bf16_f32 v19, v6, v7
    buffer_store_dwordx4 v[16:19], v251, s[4:7], s53 offen offset:1024 sc1
    v_accvgpr_read_b32 v20, a80
    v_accvgpr_read_b32 v21, a81
    v_accvgpr_read_b32 v22, a82
    v_accvgpr_read_b32 v23, a83
    v_accvgpr_read_b32 v24, a84
    v_accvgpr_read_b32 v25, a85
    v_accvgpr_read_b32 v26, a86
    v_accvgpr_read_b32 v27, a87
    v_cvt_pk_bf16_f32 v36, v20, v21
    v_cvt_pk_bf16_f32 v37, v22, v23
    v_cvt_pk_bf16_f32 v38, v24, v25
    v_cvt_pk_bf16_f32 v39, v26, v27
    buffer_store_dwordx4 v[36:39], v251, s[4:7], s53 offen offset:2048 sc1
    v_accvgpr_read_b32 v40, a88
    v_accvgpr_read_b32 v41, a89
    v_accvgpr_read_b32 v42, a90
    v_accvgpr_read_b32 v43, a91
    v_accvgpr_read_b32 v44, a92
    v_accvgpr_read_b32 v45, a93
    v_accvgpr_read_b32 v46, a94
    v_accvgpr_read_b32 v47, a95
    v_cvt_pk_bf16_f32 v56, v40, v41
    v_cvt_pk_bf16_f32 v57, v42, v43
    v_cvt_pk_bf16_f32 v58, v44, v45
    v_cvt_pk_bf16_f32 v59, v46, v47
    buffer_store_dwordx4 v[56:59], v251, s[4:7], s53 offen offset:3072 sc1
    s_add_u32 s53, s53, s22
    v_accvgpr_read_b32 v0, a96
    v_accvgpr_read_b32 v1, a97
    v_accvgpr_read_b32 v2, a98
    v_accvgpr_read_b32 v3, a99
    v_accvgpr_read_b32 v4, a100
    v_accvgpr_read_b32 v5, a101
    v_accvgpr_read_b32 v6, a102
    v_accvgpr_read_b32 v7, a103
    v_cvt_pk_bf16_f32 v16, v0, v1
    v_cvt_pk_bf16_f32 v17, v2, v3
    v_cvt_pk_bf16_f32 v18, v4, v5
    v_cvt_pk_bf16_f32 v19, v6, v7
    buffer_store_dwordx4 v[16:19], v251, s[4:7], s53 offen offset:0 sc1
    v_accvgpr_read_b32 v20, a104
    v_accvgpr_read_b32 v21, a105
    v_accvgpr_read_b32 v22, a106
    v_accvgpr_read_b32 v23, a107
    v_accvgpr_read_b32 v24, a108
    v_accvgpr_read_b32 v25, a109
    v_accvgpr_read_b32 v26, a110
    v_accvgpr_read_b32 v27, a111
    v_cvt_pk_bf16_f32 v36, v20, v21
    v_cvt_pk_bf16_f32 v37, v22, v23
    v_cvt_pk_bf16_f32 v38, v24, v25
    v_cvt_pk_bf16_f32 v39, v26, v27
    buffer_store_dwordx4 v[36:39], v251, s[4:7], s53 offen offset:1024 sc1
    v_accvgpr_read_b32 v40, a112
    v_accvgpr_read_b32 v41, a113
    v_accvgpr_read_b32 v42, a114
    v_accvgpr_read_b32 v43, a115
    v_accvgpr_read_b32 v44, a116
    v_accvgpr_read_b32 v45, a117
    v_accvgpr_read_b32 v46, a118
    v_accvgpr_read_b32 v47, a119
    v_cvt_pk_bf16_f32 v56, v40, v41
    v_cvt_pk_bf16_f32 v57, v42, v43
    v_cvt_pk_bf16_f32 v58, v44, v45
    v_cvt_pk_bf16_f32 v59, v46, v47
    buffer_store_dwordx4 v[56:59], v251, s[4:7], s53 offen offset:2048 sc1
    v_accvgpr_read_b32 v0, a120
    v_accvgpr_read_b32 v1, a121
    v_accvgpr_read_b32 v2, a122
    v_accvgpr_read_b32 v3, a123
    v_accvgpr_read_b32 v4, a124
    v_accvgpr_read_b32 v5, a125
    v_accvgpr_read_b32 v6, a126
    v_accvgpr_read_b32 v7, a127
    v_cvt_pk_bf16_f32 v16, v0, v1
    v_cvt_pk_bf16_f32 v17, v2, v3
    v_cvt_pk_bf16_f32 v18, v4, v5
    v_cvt_pk_bf16_f32 v19, v6, v7
    buffer_store_dwordx4 v[16:19], v251, s[4:7], s53 offen offset:3072 sc1
    s_branch main_kernel_w_done
main_kernel_w_c1_escl:
    s_mov_b32 s53, s21
    v_accvgpr_read_b32 v0, a0
    v_accvgpr_read_b32 v1, a1
    v_accvgpr_read_b32 v2, a2
    v_accvgpr_read_b32 v3, a3
    v_accvgpr_read_b32 v4, a4
    v_accvgpr_read_b32 v5, a5
    v_accvgpr_read_b32 v6, a6
    v_accvgpr_read_b32 v7, a7
    v_mul_f32 v0, 0x3e0293ee, v0
    v_mul_f32 v1, 0x3e0293ee, v1
    v_mul_f32 v2, 0x3e0293ee, v2
    v_mul_f32 v3, 0x3e0293ee, v3
    v_mul_f32 v4, 0x3e0293ee, v4
    v_mul_f32 v5, 0x3e0293ee, v5
    v_mul_f32 v6, 0x3e0293ee, v6
    v_mul_f32 v7, 0x3e0293ee, v7
    v_cvt_pk_bf16_f32 v16, v0, v1
    v_cvt_pk_bf16_f32 v17, v2, v3
    v_cvt_pk_bf16_f32 v18, v4, v5
    v_cvt_pk_bf16_f32 v19, v6, v7
    buffer_store_dwordx4 v[16:19], v251, s[4:7], s53 offen offset:0 sc1
    v_accvgpr_read_b32 v20, a8
    v_accvgpr_read_b32 v21, a9
    v_accvgpr_read_b32 v22, a10
    v_accvgpr_read_b32 v23, a11
    v_accvgpr_read_b32 v24, a12
    v_accvgpr_read_b32 v25, a13
    v_accvgpr_read_b32 v26, a14
    v_accvgpr_read_b32 v27, a15
    v_mul_f32 v20, 0x3e0293ee, v20
    v_mul_f32 v21, 0x3e0293ee, v21
    v_mul_f32 v22, 0x3e0293ee, v22
    v_mul_f32 v23, 0x3e0293ee, v23
    v_mul_f32 v24, 0x3e0293ee, v24
    v_mul_f32 v25, 0x3e0293ee, v25
    v_mul_f32 v26, 0x3e0293ee, v26
    v_mul_f32 v27, 0x3e0293ee, v27
    v_cvt_pk_bf16_f32 v36, v20, v21
    v_cvt_pk_bf16_f32 v37, v22, v23
    v_cvt_pk_bf16_f32 v38, v24, v25
    v_cvt_pk_bf16_f32 v39, v26, v27
    buffer_store_dwordx4 v[36:39], v251, s[4:7], s53 offen offset:1024 sc1
    v_accvgpr_read_b32 v40, a16
    v_accvgpr_read_b32 v41, a17
    v_accvgpr_read_b32 v42, a18
    v_accvgpr_read_b32 v43, a19
    v_accvgpr_read_b32 v44, a20
    v_accvgpr_read_b32 v45, a21
    v_accvgpr_read_b32 v46, a22
    v_accvgpr_read_b32 v47, a23
    v_mul_f32 v40, 0x3e0293ee, v40
    v_mul_f32 v41, 0x3e0293ee, v41
    v_mul_f32 v42, 0x3e0293ee, v42
    v_mul_f32 v43, 0x3e0293ee, v43
    v_mul_f32 v44, 0x3e0293ee, v44
    v_mul_f32 v45, 0x3e0293ee, v45
    v_mul_f32 v46, 0x3e0293ee, v46
    v_mul_f32 v47, 0x3e0293ee, v47
    v_cvt_pk_bf16_f32 v56, v40, v41
    v_cvt_pk_bf16_f32 v57, v42, v43
    v_cvt_pk_bf16_f32 v58, v44, v45
    v_cvt_pk_bf16_f32 v59, v46, v47
    buffer_store_dwordx4 v[56:59], v251, s[4:7], s53 offen offset:2048 sc1
    v_accvgpr_read_b32 v0, a24
    v_accvgpr_read_b32 v1, a25
    v_accvgpr_read_b32 v2, a26
    v_accvgpr_read_b32 v3, a27
    v_accvgpr_read_b32 v4, a28
    v_accvgpr_read_b32 v5, a29
    v_accvgpr_read_b32 v6, a30
    v_accvgpr_read_b32 v7, a31
    v_mul_f32 v0, 0x3e0293ee, v0
    v_mul_f32 v1, 0x3e0293ee, v1
    v_mul_f32 v2, 0x3e0293ee, v2
    v_mul_f32 v3, 0x3e0293ee, v3
    v_mul_f32 v4, 0x3e0293ee, v4
    v_mul_f32 v5, 0x3e0293ee, v5
    v_mul_f32 v6, 0x3e0293ee, v6
    v_mul_f32 v7, 0x3e0293ee, v7
    v_cvt_pk_bf16_f32 v16, v0, v1
    v_cvt_pk_bf16_f32 v17, v2, v3
    v_cvt_pk_bf16_f32 v18, v4, v5
    v_cvt_pk_bf16_f32 v19, v6, v7
    buffer_store_dwordx4 v[16:19], v251, s[4:7], s53 offen offset:3072 sc1
    s_add_u32 s53, s53, s22
    v_accvgpr_read_b32 v20, a32
    v_accvgpr_read_b32 v21, a33
    v_accvgpr_read_b32 v22, a34
    v_accvgpr_read_b32 v23, a35
    v_accvgpr_read_b32 v24, a36
    v_accvgpr_read_b32 v25, a37
    v_accvgpr_read_b32 v26, a38
    v_accvgpr_read_b32 v27, a39
    v_mul_f32 v20, 0x3e0293ee, v20
    v_mul_f32 v21, 0x3e0293ee, v21
    v_mul_f32 v22, 0x3e0293ee, v22
    v_mul_f32 v23, 0x3e0293ee, v23
    v_mul_f32 v24, 0x3e0293ee, v24
    v_mul_f32 v25, 0x3e0293ee, v25
    v_mul_f32 v26, 0x3e0293ee, v26
    v_mul_f32 v27, 0x3e0293ee, v27
    v_cvt_pk_bf16_f32 v36, v20, v21
    v_cvt_pk_bf16_f32 v37, v22, v23
    v_cvt_pk_bf16_f32 v38, v24, v25
    v_cvt_pk_bf16_f32 v39, v26, v27
    buffer_store_dwordx4 v[36:39], v251, s[4:7], s53 offen offset:0 sc1
    v_accvgpr_read_b32 v40, a40
    v_accvgpr_read_b32 v41, a41
    v_accvgpr_read_b32 v42, a42
    v_accvgpr_read_b32 v43, a43
    v_accvgpr_read_b32 v44, a44
    v_accvgpr_read_b32 v45, a45
    v_accvgpr_read_b32 v46, a46
    v_accvgpr_read_b32 v47, a47
    v_mul_f32 v40, 0x3e0293ee, v40
    v_mul_f32 v41, 0x3e0293ee, v41
    v_mul_f32 v42, 0x3e0293ee, v42
    v_mul_f32 v43, 0x3e0293ee, v43
    v_mul_f32 v44, 0x3e0293ee, v44
    v_mul_f32 v45, 0x3e0293ee, v45
    v_mul_f32 v46, 0x3e0293ee, v46
    v_mul_f32 v47, 0x3e0293ee, v47
    v_cvt_pk_bf16_f32 v56, v40, v41
    v_cvt_pk_bf16_f32 v57, v42, v43
    v_cvt_pk_bf16_f32 v58, v44, v45
    v_cvt_pk_bf16_f32 v59, v46, v47
    buffer_store_dwordx4 v[56:59], v251, s[4:7], s53 offen offset:1024 sc1
    v_accvgpr_read_b32 v0, a48
    v_accvgpr_read_b32 v1, a49
    v_accvgpr_read_b32 v2, a50
    v_accvgpr_read_b32 v3, a51
    v_accvgpr_read_b32 v4, a52
    v_accvgpr_read_b32 v5, a53
    v_accvgpr_read_b32 v6, a54
    v_accvgpr_read_b32 v7, a55
    v_mul_f32 v0, 0x3e0293ee, v0
    v_mul_f32 v1, 0x3e0293ee, v1
    v_mul_f32 v2, 0x3e0293ee, v2
    v_mul_f32 v3, 0x3e0293ee, v3
    v_mul_f32 v4, 0x3e0293ee, v4
    v_mul_f32 v5, 0x3e0293ee, v5
    v_mul_f32 v6, 0x3e0293ee, v6
    v_mul_f32 v7, 0x3e0293ee, v7
    v_cvt_pk_bf16_f32 v16, v0, v1
    v_cvt_pk_bf16_f32 v17, v2, v3
    v_cvt_pk_bf16_f32 v18, v4, v5
    v_cvt_pk_bf16_f32 v19, v6, v7
    buffer_store_dwordx4 v[16:19], v251, s[4:7], s53 offen offset:2048 sc1
    v_accvgpr_read_b32 v20, a56
    v_accvgpr_read_b32 v21, a57
    v_accvgpr_read_b32 v22, a58
    v_accvgpr_read_b32 v23, a59
    v_accvgpr_read_b32 v24, a60
    v_accvgpr_read_b32 v25, a61
    v_accvgpr_read_b32 v26, a62
    v_accvgpr_read_b32 v27, a63
    v_mul_f32 v20, 0x3e0293ee, v20
    v_mul_f32 v21, 0x3e0293ee, v21
    v_mul_f32 v22, 0x3e0293ee, v22
    v_mul_f32 v23, 0x3e0293ee, v23
    v_mul_f32 v24, 0x3e0293ee, v24
    v_mul_f32 v25, 0x3e0293ee, v25
    v_mul_f32 v26, 0x3e0293ee, v26
    v_mul_f32 v27, 0x3e0293ee, v27
    v_cvt_pk_bf16_f32 v36, v20, v21
    v_cvt_pk_bf16_f32 v37, v22, v23
    v_cvt_pk_bf16_f32 v38, v24, v25
    v_cvt_pk_bf16_f32 v39, v26, v27
    buffer_store_dwordx4 v[36:39], v251, s[4:7], s53 offen offset:3072 sc1
    s_add_u32 s53, s53, s22
    v_accvgpr_read_b32 v40, a64
    v_accvgpr_read_b32 v41, a65
    v_accvgpr_read_b32 v42, a66
    v_accvgpr_read_b32 v43, a67
    v_accvgpr_read_b32 v44, a68
    v_accvgpr_read_b32 v45, a69
    v_accvgpr_read_b32 v46, a70
    v_accvgpr_read_b32 v47, a71
    v_mul_f32 v40, 0x3e0293ee, v40
    v_mul_f32 v41, 0x3e0293ee, v41
    v_mul_f32 v42, 0x3e0293ee, v42
    v_mul_f32 v43, 0x3e0293ee, v43
    v_mul_f32 v44, 0x3e0293ee, v44
    v_mul_f32 v45, 0x3e0293ee, v45
    v_mul_f32 v46, 0x3e0293ee, v46
    v_mul_f32 v47, 0x3e0293ee, v47
    v_cvt_pk_bf16_f32 v56, v40, v41
    v_cvt_pk_bf16_f32 v57, v42, v43
    v_cvt_pk_bf16_f32 v58, v44, v45
    v_cvt_pk_bf16_f32 v59, v46, v47
    buffer_store_dwordx4 v[56:59], v251, s[4:7], s53 offen offset:0 sc1
    v_accvgpr_read_b32 v0, a72
    v_accvgpr_read_b32 v1, a73
    v_accvgpr_read_b32 v2, a74
    v_accvgpr_read_b32 v3, a75
    v_accvgpr_read_b32 v4, a76
    v_accvgpr_read_b32 v5, a77
    v_accvgpr_read_b32 v6, a78
    v_accvgpr_read_b32 v7, a79
    v_mul_f32 v0, 0x3e0293ee, v0
    v_mul_f32 v1, 0x3e0293ee, v1
    v_mul_f32 v2, 0x3e0293ee, v2
    v_mul_f32 v3, 0x3e0293ee, v3
    v_mul_f32 v4, 0x3e0293ee, v4
    v_mul_f32 v5, 0x3e0293ee, v5
    v_mul_f32 v6, 0x3e0293ee, v6
    v_mul_f32 v7, 0x3e0293ee, v7
    v_cvt_pk_bf16_f32 v16, v0, v1
    v_cvt_pk_bf16_f32 v17, v2, v3
    v_cvt_pk_bf16_f32 v18, v4, v5
    v_cvt_pk_bf16_f32 v19, v6, v7
    buffer_store_dwordx4 v[16:19], v251, s[4:7], s53 offen offset:1024 sc1
    v_accvgpr_read_b32 v20, a80
    v_accvgpr_read_b32 v21, a81
    v_accvgpr_read_b32 v22, a82
    v_accvgpr_read_b32 v23, a83
    v_accvgpr_read_b32 v24, a84
    v_accvgpr_read_b32 v25, a85
    v_accvgpr_read_b32 v26, a86
    v_accvgpr_read_b32 v27, a87
    v_mul_f32 v20, 0x3e0293ee, v20
    v_mul_f32 v21, 0x3e0293ee, v21
    v_mul_f32 v22, 0x3e0293ee, v22
    v_mul_f32 v23, 0x3e0293ee, v23
    v_mul_f32 v24, 0x3e0293ee, v24
    v_mul_f32 v25, 0x3e0293ee, v25
    v_mul_f32 v26, 0x3e0293ee, v26
    v_mul_f32 v27, 0x3e0293ee, v27
    v_cvt_pk_bf16_f32 v36, v20, v21
    v_cvt_pk_bf16_f32 v37, v22, v23
    v_cvt_pk_bf16_f32 v38, v24, v25
    v_cvt_pk_bf16_f32 v39, v26, v27
    buffer_store_dwordx4 v[36:39], v251, s[4:7], s53 offen offset:2048 sc1
    v_accvgpr_read_b32 v40, a88
    v_accvgpr_read_b32 v41, a89
    v_accvgpr_read_b32 v42, a90
    v_accvgpr_read_b32 v43, a91
    v_accvgpr_read_b32 v44, a92
    v_accvgpr_read_b32 v45, a93
    v_accvgpr_read_b32 v46, a94
    v_accvgpr_read_b32 v47, a95
    v_mul_f32 v40, 0x3e0293ee, v40
    v_mul_f32 v41, 0x3e0293ee, v41
    v_mul_f32 v42, 0x3e0293ee, v42
    v_mul_f32 v43, 0x3e0293ee, v43
    v_mul_f32 v44, 0x3e0293ee, v44
    v_mul_f32 v45, 0x3e0293ee, v45
    v_mul_f32 v46, 0x3e0293ee, v46
    v_mul_f32 v47, 0x3e0293ee, v47
    v_cvt_pk_bf16_f32 v56, v40, v41
    v_cvt_pk_bf16_f32 v57, v42, v43
    v_cvt_pk_bf16_f32 v58, v44, v45
    v_cvt_pk_bf16_f32 v59, v46, v47
    buffer_store_dwordx4 v[56:59], v251, s[4:7], s53 offen offset:3072 sc1
    s_add_u32 s53, s53, s22
    v_accvgpr_read_b32 v0, a96
    v_accvgpr_read_b32 v1, a97
    v_accvgpr_read_b32 v2, a98
    v_accvgpr_read_b32 v3, a99
    v_accvgpr_read_b32 v4, a100
    v_accvgpr_read_b32 v5, a101
    v_accvgpr_read_b32 v6, a102
    v_accvgpr_read_b32 v7, a103
    v_mul_f32 v0, 0x3e0293ee, v0
    v_mul_f32 v1, 0x3e0293ee, v1
    v_mul_f32 v2, 0x3e0293ee, v2
    v_mul_f32 v3, 0x3e0293ee, v3
    v_mul_f32 v4, 0x3e0293ee, v4
    v_mul_f32 v5, 0x3e0293ee, v5
    v_mul_f32 v6, 0x3e0293ee, v6
    v_mul_f32 v7, 0x3e0293ee, v7
    v_cvt_pk_bf16_f32 v16, v0, v1
    v_cvt_pk_bf16_f32 v17, v2, v3
    v_cvt_pk_bf16_f32 v18, v4, v5
    v_cvt_pk_bf16_f32 v19, v6, v7
    buffer_store_dwordx4 v[16:19], v251, s[4:7], s53 offen offset:0 sc1
    v_accvgpr_read_b32 v20, a104
    v_accvgpr_read_b32 v21, a105
    v_accvgpr_read_b32 v22, a106
    v_accvgpr_read_b32 v23, a107
    v_accvgpr_read_b32 v24, a108
    v_accvgpr_read_b32 v25, a109
    v_accvgpr_read_b32 v26, a110
    v_accvgpr_read_b32 v27, a111
    v_mul_f32 v20, 0x3e0293ee, v20
    v_mul_f32 v21, 0x3e0293ee, v21
    v_mul_f32 v22, 0x3e0293ee, v22
    v_mul_f32 v23, 0x3e0293ee, v23
    v_mul_f32 v24, 0x3e0293ee, v24
    v_mul_f32 v25, 0x3e0293ee, v25
    v_mul_f32 v26, 0x3e0293ee, v26
    v_mul_f32 v27, 0x3e0293ee, v27
    v_cvt_pk_bf16_f32 v36, v20, v21
    v_cvt_pk_bf16_f32 v37, v22, v23
    v_cvt_pk_bf16_f32 v38, v24, v25
    v_cvt_pk_bf16_f32 v39, v26, v27
    buffer_store_dwordx4 v[36:39], v251, s[4:7], s53 offen offset:1024 sc1
    v_accvgpr_read_b32 v40, a112
    v_accvgpr_read_b32 v41, a113
    v_accvgpr_read_b32 v42, a114
    v_accvgpr_read_b32 v43, a115
    v_accvgpr_read_b32 v44, a116
    v_accvgpr_read_b32 v45, a117
    v_accvgpr_read_b32 v46, a118
    v_accvgpr_read_b32 v47, a119
    v_mul_f32 v40, 0x3e0293ee, v40
    v_mul_f32 v41, 0x3e0293ee, v41
    v_mul_f32 v42, 0x3e0293ee, v42
    v_mul_f32 v43, 0x3e0293ee, v43
    v_mul_f32 v44, 0x3e0293ee, v44
    v_mul_f32 v45, 0x3e0293ee, v45
    v_mul_f32 v46, 0x3e0293ee, v46
    v_mul_f32 v47, 0x3e0293ee, v47
    v_cvt_pk_bf16_f32 v56, v40, v41
    v_cvt_pk_bf16_f32 v57, v42, v43
    v_cvt_pk_bf16_f32 v58, v44, v45
    v_cvt_pk_bf16_f32 v59, v46, v47
    buffer_store_dwordx4 v[56:59], v251, s[4:7], s53 offen offset:2048 sc1
    v_accvgpr_read_b32 v0, a120
    v_accvgpr_read_b32 v1, a121
    v_accvgpr_read_b32 v2, a122
    v_accvgpr_read_b32 v3, a123
    v_accvgpr_read_b32 v4, a124
    v_accvgpr_read_b32 v5, a125
    v_accvgpr_read_b32 v6, a126
    v_accvgpr_read_b32 v7, a127
    v_mul_f32 v0, 0x3e0293ee, v0
    v_mul_f32 v1, 0x3e0293ee, v1
    v_mul_f32 v2, 0x3e0293ee, v2
    v_mul_f32 v3, 0x3e0293ee, v3
    v_mul_f32 v4, 0x3e0293ee, v4
    v_mul_f32 v5, 0x3e0293ee, v5
    v_mul_f32 v6, 0x3e0293ee, v6
    v_mul_f32 v7, 0x3e0293ee, v7
    v_cvt_pk_bf16_f32 v16, v0, v1
    v_cvt_pk_bf16_f32 v17, v2, v3
    v_cvt_pk_bf16_f32 v18, v4, v5
    v_cvt_pk_bf16_f32 v19, v6, v7
    buffer_store_dwordx4 v[16:19], v251, s[4:7], s53 offen offset:3072 sc1
    s_branch main_kernel_w_done
main_kernel_w_c1_egelus:
    s_mov_b32 s53, s21
    v_accvgpr_read_b32 v0, a0
    v_accvgpr_read_b32 v1, a1
    v_accvgpr_read_b32 v2, a2
    v_accvgpr_read_b32 v3, a3
    v_accvgpr_read_b32 v4, a4
    v_accvgpr_read_b32 v5, a5
    v_accvgpr_read_b32 v6, a6
    v_accvgpr_read_b32 v7, a7
    v_pk_mul_f32 v[8:9], v[0:1], v[0:1]
    v_pk_mul_f32 v[10:11], v[2:3], v[2:3]
    v_pk_mul_f32 v[12:13], v[4:5], v[4:5]
    v_pk_mul_f32 v[14:15], v[6:7], v[6:7]
    v_pk_fma_f32 v[8:9], v[8:9], v[242:243], v[240:241]
    v_pk_fma_f32 v[10:11], v[10:11], v[242:243], v[240:241]
    v_pk_fma_f32 v[12:13], v[12:13], v[242:243], v[240:241]
    v_pk_fma_f32 v[14:15], v[14:15], v[242:243], v[240:241]
    v_pk_mul_f32 v[8:9], v[8:9], v[0:1]
    v_pk_mul_f32 v[10:11], v[10:11], v[2:3]
    v_pk_mul_f32 v[12:13], v[12:13], v[4:5]
    v_pk_mul_f32 v[14:15], v[14:15], v[6:7]
    v_exp_f32 v8, v8
    v_exp_f32 v9, v9
    v_exp_f32 v10, v10
    v_exp_f32 v11, v11
    v_exp_f32 v12, v12
    v_exp_f32 v13, v13
    v_exp_f32 v14, v14
    v_exp_f32 v15, v15
    v_pk_add_f32 v[8:9], v[8:9], v[244:245]
    v_pk_add_f32 v[10:11], v[10:11], v[244:245]
    v_pk_add_f32 v[12:13], v[12:13], v[244:245]
    v_pk_add_f32 v[14:15], v[14:15], v[244:245]
    v_rcp_f32 v8, v8
    v_rcp_f32 v9, v9
    v_rcp_f32 v10, v10
    v_rcp_f32 v11, v11
    v_rcp_f32 v12, v12
    v_rcp_f32 v13, v13
    v_rcp_f32 v14, v14
    v_rcp_f32 v15, v15
    v_pk_mul_f32 v[0:1], v[8:9], v[0:1]
    v_pk_mul_f32 v[2:3], v[10:11], v[2:3]
    v_pk_mul_f32 v[4:5], v[12:13], v[4:5]
    v_pk_mul_f32 v[6:7], v[14:15], v[6:7]
    v_cvt_pk_bf16_f32 v16, v0, v1
    v_cvt_pk_bf16_f32 v17, v2, v3
    v_cvt_pk_bf16_f32 v18, v4, v5
    v_cvt_pk_bf16_f32 v19, v6, v7
    buffer_store_dwordx4 v[16:19], v252, s[4:7], s53 offen offset:0 sc1
    v_accvgpr_read_b32 v20, a8
    v_accvgpr_read_b32 v21, a9
    v_accvgpr_read_b32 v22, a10
    v_accvgpr_read_b32 v23, a11
    v_accvgpr_read_b32 v24, a12
    v_accvgpr_read_b32 v25, a13
    v_accvgpr_read_b32 v26, a14
    v_accvgpr_read_b32 v27, a15
    v_pk_mul_f32 v[28:29], v[20:21], v[20:21]
    v_pk_mul_f32 v[30:31], v[22:23], v[22:23]
    v_pk_mul_f32 v[32:33], v[24:25], v[24:25]
    v_pk_mul_f32 v[34:35], v[26:27], v[26:27]
    v_pk_fma_f32 v[28:29], v[28:29], v[242:243], v[240:241]
    v_pk_fma_f32 v[30:31], v[30:31], v[242:243], v[240:241]
    v_pk_fma_f32 v[32:33], v[32:33], v[242:243], v[240:241]
    v_pk_fma_f32 v[34:35], v[34:35], v[242:243], v[240:241]
    v_pk_mul_f32 v[28:29], v[28:29], v[20:21]
    v_pk_mul_f32 v[30:31], v[30:31], v[22:23]
    v_pk_mul_f32 v[32:33], v[32:33], v[24:25]
    v_pk_mul_f32 v[34:35], v[34:35], v[26:27]
    v_exp_f32 v28, v28
    v_exp_f32 v29, v29
    v_exp_f32 v30, v30
    v_exp_f32 v31, v31
    v_exp_f32 v32, v32
    v_exp_f32 v33, v33
    v_exp_f32 v34, v34
    v_exp_f32 v35, v35
    v_pk_add_f32 v[28:29], v[28:29], v[244:245]
    v_pk_add_f32 v[30:31], v[30:31], v[244:245]
    v_pk_add_f32 v[32:33], v[32:33], v[244:245]
    v_pk_add_f32 v[34:35], v[34:35], v[244:245]
    v_rcp_f32 v28, v28
    v_rcp_f32 v29, v29
    v_rcp_f32 v30, v30
    v_rcp_f32 v31, v31
    v_rcp_f32 v32, v32
    v_rcp_f32 v33, v33
    v_rcp_f32 v34, v34
    v_rcp_f32 v35, v35
    v_pk_mul_f32 v[20:21], v[28:29], v[20:21]
    v_pk_mul_f32 v[22:23], v[30:31], v[22:23]
    v_pk_mul_f32 v[24:25], v[32:33], v[24:25]
    v_pk_mul_f32 v[26:27], v[34:35], v[26:27]
    v_cvt_pk_bf16_f32 v36, v20, v21
    v_cvt_pk_bf16_f32 v37, v22, v23
    v_cvt_pk_bf16_f32 v38, v24, v25
    v_cvt_pk_bf16_f32 v39, v26, v27
    buffer_store_dwordx4 v[36:39], v252, s[4:7], s53 offen offset:1024 sc1
    v_accvgpr_read_b32 v40, a16
    v_accvgpr_read_b32 v41, a17
    v_accvgpr_read_b32 v42, a18
    v_accvgpr_read_b32 v43, a19
    v_accvgpr_read_b32 v44, a20
    v_accvgpr_read_b32 v45, a21
    v_accvgpr_read_b32 v46, a22
    v_accvgpr_read_b32 v47, a23
    v_pk_mul_f32 v[48:49], v[40:41], v[40:41]
    v_pk_mul_f32 v[50:51], v[42:43], v[42:43]
    v_pk_mul_f32 v[52:53], v[44:45], v[44:45]
    v_pk_mul_f32 v[54:55], v[46:47], v[46:47]
    v_pk_fma_f32 v[48:49], v[48:49], v[242:243], v[240:241]
    v_pk_fma_f32 v[50:51], v[50:51], v[242:243], v[240:241]
    v_pk_fma_f32 v[52:53], v[52:53], v[242:243], v[240:241]
    v_pk_fma_f32 v[54:55], v[54:55], v[242:243], v[240:241]
    v_pk_mul_f32 v[48:49], v[48:49], v[40:41]
    v_pk_mul_f32 v[50:51], v[50:51], v[42:43]
    v_pk_mul_f32 v[52:53], v[52:53], v[44:45]
    v_pk_mul_f32 v[54:55], v[54:55], v[46:47]
    v_exp_f32 v48, v48
    v_exp_f32 v49, v49
    v_exp_f32 v50, v50
    v_exp_f32 v51, v51
    v_exp_f32 v52, v52
    v_exp_f32 v53, v53
    v_exp_f32 v54, v54
    v_exp_f32 v55, v55
    v_pk_add_f32 v[48:49], v[48:49], v[244:245]
    v_pk_add_f32 v[50:51], v[50:51], v[244:245]
    v_pk_add_f32 v[52:53], v[52:53], v[244:245]
    v_pk_add_f32 v[54:55], v[54:55], v[244:245]
    v_rcp_f32 v48, v48
    v_rcp_f32 v49, v49
    v_rcp_f32 v50, v50
    v_rcp_f32 v51, v51
    v_rcp_f32 v52, v52
    v_rcp_f32 v53, v53
    v_rcp_f32 v54, v54
    v_rcp_f32 v55, v55
    v_pk_mul_f32 v[40:41], v[48:49], v[40:41]
    v_pk_mul_f32 v[42:43], v[50:51], v[42:43]
    v_pk_mul_f32 v[44:45], v[52:53], v[44:45]
    v_pk_mul_f32 v[46:47], v[54:55], v[46:47]
    v_cvt_pk_bf16_f32 v56, v40, v41
    v_cvt_pk_bf16_f32 v57, v42, v43
    v_cvt_pk_bf16_f32 v58, v44, v45
    v_cvt_pk_bf16_f32 v59, v46, v47
    buffer_store_dwordx4 v[56:59], v252, s[4:7], s53 offen offset:2048 sc1
    v_accvgpr_read_b32 v0, a24
    v_accvgpr_read_b32 v1, a25
    v_accvgpr_read_b32 v2, a26
    v_accvgpr_read_b32 v3, a27
    v_accvgpr_read_b32 v4, a28
    v_accvgpr_read_b32 v5, a29
    v_accvgpr_read_b32 v6, a30
    v_accvgpr_read_b32 v7, a31
    v_pk_mul_f32 v[8:9], v[0:1], v[0:1]
    v_pk_mul_f32 v[10:11], v[2:3], v[2:3]
    v_pk_mul_f32 v[12:13], v[4:5], v[4:5]
    v_pk_mul_f32 v[14:15], v[6:7], v[6:7]
    v_pk_fma_f32 v[8:9], v[8:9], v[242:243], v[240:241]
    v_pk_fma_f32 v[10:11], v[10:11], v[242:243], v[240:241]
    v_pk_fma_f32 v[12:13], v[12:13], v[242:243], v[240:241]
    v_pk_fma_f32 v[14:15], v[14:15], v[242:243], v[240:241]
    v_pk_mul_f32 v[8:9], v[8:9], v[0:1]
    v_pk_mul_f32 v[10:11], v[10:11], v[2:3]
    v_pk_mul_f32 v[12:13], v[12:13], v[4:5]
    v_pk_mul_f32 v[14:15], v[14:15], v[6:7]
    v_exp_f32 v8, v8
    v_exp_f32 v9, v9
    v_exp_f32 v10, v10
    v_exp_f32 v11, v11
    v_exp_f32 v12, v12
    v_exp_f32 v13, v13
    v_exp_f32 v14, v14
    v_exp_f32 v15, v15
    v_pk_add_f32 v[8:9], v[8:9], v[244:245]
    v_pk_add_f32 v[10:11], v[10:11], v[244:245]
    v_pk_add_f32 v[12:13], v[12:13], v[244:245]
    v_pk_add_f32 v[14:15], v[14:15], v[244:245]
    v_rcp_f32 v8, v8
    v_rcp_f32 v9, v9
    v_rcp_f32 v10, v10
    v_rcp_f32 v11, v11
    v_rcp_f32 v12, v12
    v_rcp_f32 v13, v13
    v_rcp_f32 v14, v14
    v_rcp_f32 v15, v15
    v_pk_mul_f32 v[0:1], v[8:9], v[0:1]
    v_pk_mul_f32 v[2:3], v[10:11], v[2:3]
    v_pk_mul_f32 v[4:5], v[12:13], v[4:5]
    v_pk_mul_f32 v[6:7], v[14:15], v[6:7]
    v_cvt_pk_bf16_f32 v16, v0, v1
    v_cvt_pk_bf16_f32 v17, v2, v3
    v_cvt_pk_bf16_f32 v18, v4, v5
    v_cvt_pk_bf16_f32 v19, v6, v7
    buffer_store_dwordx4 v[16:19], v252, s[4:7], s53 offen offset:3072 sc1
    s_add_u32 s53, s53, s22
    v_accvgpr_read_b32 v20, a32
    v_accvgpr_read_b32 v21, a33
    v_accvgpr_read_b32 v22, a34
    v_accvgpr_read_b32 v23, a35
    v_accvgpr_read_b32 v24, a36
    v_accvgpr_read_b32 v25, a37
    v_accvgpr_read_b32 v26, a38
    v_accvgpr_read_b32 v27, a39
    v_pk_mul_f32 v[28:29], v[20:21], v[20:21]
    v_pk_mul_f32 v[30:31], v[22:23], v[22:23]
    v_pk_mul_f32 v[32:33], v[24:25], v[24:25]
    v_pk_mul_f32 v[34:35], v[26:27], v[26:27]
    v_pk_fma_f32 v[28:29], v[28:29], v[242:243], v[240:241]
    v_pk_fma_f32 v[30:31], v[30:31], v[242:243], v[240:241]
    v_pk_fma_f32 v[32:33], v[32:33], v[242:243], v[240:241]
    v_pk_fma_f32 v[34:35], v[34:35], v[242:243], v[240:241]
    v_pk_mul_f32 v[28:29], v[28:29], v[20:21]
    v_pk_mul_f32 v[30:31], v[30:31], v[22:23]
    v_pk_mul_f32 v[32:33], v[32:33], v[24:25]
    v_pk_mul_f32 v[34:35], v[34:35], v[26:27]
    v_exp_f32 v28, v28
    v_exp_f32 v29, v29
    v_exp_f32 v30, v30
    v_exp_f32 v31, v31
    v_exp_f32 v32, v32
    v_exp_f32 v33, v33
    v_exp_f32 v34, v34
    v_exp_f32 v35, v35
    v_pk_add_f32 v[28:29], v[28:29], v[244:245]
    v_pk_add_f32 v[30:31], v[30:31], v[244:245]
    v_pk_add_f32 v[32:33], v[32:33], v[244:245]
    v_pk_add_f32 v[34:35], v[34:35], v[244:245]
    v_rcp_f32 v28, v28
    v_rcp_f32 v29, v29
    v_rcp_f32 v30, v30
    v_rcp_f32 v31, v31
    v_rcp_f32 v32, v32
    v_rcp_f32 v33, v33
    v_rcp_f32 v34, v34
    v_rcp_f32 v35, v35
    v_pk_mul_f32 v[20:21], v[28:29], v[20:21]
    v_pk_mul_f32 v[22:23], v[30:31], v[22:23]
    v_pk_mul_f32 v[24:25], v[32:33], v[24:25]
    v_pk_mul_f32 v[26:27], v[34:35], v[26:27]
    v_cvt_pk_bf16_f32 v36, v20, v21
    v_cvt_pk_bf16_f32 v37, v22, v23
    v_cvt_pk_bf16_f32 v38, v24, v25
    v_cvt_pk_bf16_f32 v39, v26, v27
    buffer_store_dwordx4 v[36:39], v252, s[4:7], s53 offen offset:0 sc1
    v_accvgpr_read_b32 v40, a40
    v_accvgpr_read_b32 v41, a41
    v_accvgpr_read_b32 v42, a42
    v_accvgpr_read_b32 v43, a43
    v_accvgpr_read_b32 v44, a44
    v_accvgpr_read_b32 v45, a45
    v_accvgpr_read_b32 v46, a46
    v_accvgpr_read_b32 v47, a47
    v_pk_mul_f32 v[48:49], v[40:41], v[40:41]
    v_pk_mul_f32 v[50:51], v[42:43], v[42:43]
    v_pk_mul_f32 v[52:53], v[44:45], v[44:45]
    v_pk_mul_f32 v[54:55], v[46:47], v[46:47]
    v_pk_fma_f32 v[48:49], v[48:49], v[242:243], v[240:241]
    v_pk_fma_f32 v[50:51], v[50:51], v[242:243], v[240:241]
    v_pk_fma_f32 v[52:53], v[52:53], v[242:243], v[240:241]
    v_pk_fma_f32 v[54:55], v[54:55], v[242:243], v[240:241]
    v_pk_mul_f32 v[48:49], v[48:49], v[40:41]
    v_pk_mul_f32 v[50:51], v[50:51], v[42:43]
    v_pk_mul_f32 v[52:53], v[52:53], v[44:45]
    v_pk_mul_f32 v[54:55], v[54:55], v[46:47]
    v_exp_f32 v48, v48
    v_exp_f32 v49, v49
    v_exp_f32 v50, v50
    v_exp_f32 v51, v51
    v_exp_f32 v52, v52
    v_exp_f32 v53, v53
    v_exp_f32 v54, v54
    v_exp_f32 v55, v55
    v_pk_add_f32 v[48:49], v[48:49], v[244:245]
    v_pk_add_f32 v[50:51], v[50:51], v[244:245]
    v_pk_add_f32 v[52:53], v[52:53], v[244:245]
    v_pk_add_f32 v[54:55], v[54:55], v[244:245]
    v_rcp_f32 v48, v48
    v_rcp_f32 v49, v49
    v_rcp_f32 v50, v50
    v_rcp_f32 v51, v51
    v_rcp_f32 v52, v52
    v_rcp_f32 v53, v53
    v_rcp_f32 v54, v54
    v_rcp_f32 v55, v55
    v_pk_mul_f32 v[40:41], v[48:49], v[40:41]
    v_pk_mul_f32 v[42:43], v[50:51], v[42:43]
    v_pk_mul_f32 v[44:45], v[52:53], v[44:45]
    v_pk_mul_f32 v[46:47], v[54:55], v[46:47]
    v_cvt_pk_bf16_f32 v56, v40, v41
    v_cvt_pk_bf16_f32 v57, v42, v43
    v_cvt_pk_bf16_f32 v58, v44, v45
    v_cvt_pk_bf16_f32 v59, v46, v47
    buffer_store_dwordx4 v[56:59], v252, s[4:7], s53 offen offset:1024 sc1
    v_accvgpr_read_b32 v0, a48
    v_accvgpr_read_b32 v1, a49
    v_accvgpr_read_b32 v2, a50
    v_accvgpr_read_b32 v3, a51
    v_accvgpr_read_b32 v4, a52
    v_accvgpr_read_b32 v5, a53
    v_accvgpr_read_b32 v6, a54
    v_accvgpr_read_b32 v7, a55
    v_pk_mul_f32 v[8:9], v[0:1], v[0:1]
    v_pk_mul_f32 v[10:11], v[2:3], v[2:3]
    v_pk_mul_f32 v[12:13], v[4:5], v[4:5]
    v_pk_mul_f32 v[14:15], v[6:7], v[6:7]
    v_pk_fma_f32 v[8:9], v[8:9], v[242:243], v[240:241]
    v_pk_fma_f32 v[10:11], v[10:11], v[242:243], v[240:241]
    v_pk_fma_f32 v[12:13], v[12:13], v[242:243], v[240:241]
    v_pk_fma_f32 v[14:15], v[14:15], v[242:243], v[240:241]
    v_pk_mul_f32 v[8:9], v[8:9], v[0:1]
    v_pk_mul_f32 v[10:11], v[10:11], v[2:3]
    v_pk_mul_f32 v[12:13], v[12:13], v[4:5]
    v_pk_mul_f32 v[14:15], v[14:15], v[6:7]
    v_exp_f32 v8, v8
    v_exp_f32 v9, v9
    v_exp_f32 v10, v10
    v_exp_f32 v11, v11
    v_exp_f32 v12, v12
    v_exp_f32 v13, v13
    v_exp_f32 v14, v14
    v_exp_f32 v15, v15
    v_pk_add_f32 v[8:9], v[8:9], v[244:245]
    v_pk_add_f32 v[10:11], v[10:11], v[244:245]
    v_pk_add_f32 v[12:13], v[12:13], v[244:245]
    v_pk_add_f32 v[14:15], v[14:15], v[244:245]
    v_rcp_f32 v8, v8
    v_rcp_f32 v9, v9
    v_rcp_f32 v10, v10
    v_rcp_f32 v11, v11
    v_rcp_f32 v12, v12
    v_rcp_f32 v13, v13
    v_rcp_f32 v14, v14
    v_rcp_f32 v15, v15
    v_pk_mul_f32 v[0:1], v[8:9], v[0:1]
    v_pk_mul_f32 v[2:3], v[10:11], v[2:3]
    v_pk_mul_f32 v[4:5], v[12:13], v[4:5]
    v_pk_mul_f32 v[6:7], v[14:15], v[6:7]
    v_cvt_pk_bf16_f32 v16, v0, v1
    v_cvt_pk_bf16_f32 v17, v2, v3
    v_cvt_pk_bf16_f32 v18, v4, v5
    v_cvt_pk_bf16_f32 v19, v6, v7
    buffer_store_dwordx4 v[16:19], v252, s[4:7], s53 offen offset:2048 sc1
    v_accvgpr_read_b32 v20, a56
    v_accvgpr_read_b32 v21, a57
    v_accvgpr_read_b32 v22, a58
    v_accvgpr_read_b32 v23, a59
    v_accvgpr_read_b32 v24, a60
    v_accvgpr_read_b32 v25, a61
    v_accvgpr_read_b32 v26, a62
    v_accvgpr_read_b32 v27, a63
    v_pk_mul_f32 v[28:29], v[20:21], v[20:21]
    v_pk_mul_f32 v[30:31], v[22:23], v[22:23]
    v_pk_mul_f32 v[32:33], v[24:25], v[24:25]
    v_pk_mul_f32 v[34:35], v[26:27], v[26:27]
    v_pk_fma_f32 v[28:29], v[28:29], v[242:243], v[240:241]
    v_pk_fma_f32 v[30:31], v[30:31], v[242:243], v[240:241]
    v_pk_fma_f32 v[32:33], v[32:33], v[242:243], v[240:241]
    v_pk_fma_f32 v[34:35], v[34:35], v[242:243], v[240:241]
    v_pk_mul_f32 v[28:29], v[28:29], v[20:21]
    v_pk_mul_f32 v[30:31], v[30:31], v[22:23]
    v_pk_mul_f32 v[32:33], v[32:33], v[24:25]
    v_pk_mul_f32 v[34:35], v[34:35], v[26:27]
    v_exp_f32 v28, v28
    v_exp_f32 v29, v29
    v_exp_f32 v30, v30
    v_exp_f32 v31, v31
    v_exp_f32 v32, v32
    v_exp_f32 v33, v33
    v_exp_f32 v34, v34
    v_exp_f32 v35, v35
    v_pk_add_f32 v[28:29], v[28:29], v[244:245]
    v_pk_add_f32 v[30:31], v[30:31], v[244:245]
    v_pk_add_f32 v[32:33], v[32:33], v[244:245]
    v_pk_add_f32 v[34:35], v[34:35], v[244:245]
    v_rcp_f32 v28, v28
    v_rcp_f32 v29, v29
    v_rcp_f32 v30, v30
    v_rcp_f32 v31, v31
    v_rcp_f32 v32, v32
    v_rcp_f32 v33, v33
    v_rcp_f32 v34, v34
    v_rcp_f32 v35, v35
    v_pk_mul_f32 v[20:21], v[28:29], v[20:21]
    v_pk_mul_f32 v[22:23], v[30:31], v[22:23]
    v_pk_mul_f32 v[24:25], v[32:33], v[24:25]
    v_pk_mul_f32 v[26:27], v[34:35], v[26:27]
    v_cvt_pk_bf16_f32 v36, v20, v21
    v_cvt_pk_bf16_f32 v37, v22, v23
    v_cvt_pk_bf16_f32 v38, v24, v25
    v_cvt_pk_bf16_f32 v39, v26, v27
    buffer_store_dwordx4 v[36:39], v252, s[4:7], s53 offen offset:3072 sc1
    s_add_u32 s53, s53, s22
    v_accvgpr_read_b32 v40, a64
    v_accvgpr_read_b32 v41, a65
    v_accvgpr_read_b32 v42, a66
    v_accvgpr_read_b32 v43, a67
    v_accvgpr_read_b32 v44, a68
    v_accvgpr_read_b32 v45, a69
    v_accvgpr_read_b32 v46, a70
    v_accvgpr_read_b32 v47, a71
    v_pk_mul_f32 v[48:49], v[40:41], v[40:41]
    v_pk_mul_f32 v[50:51], v[42:43], v[42:43]
    v_pk_mul_f32 v[52:53], v[44:45], v[44:45]
    v_pk_mul_f32 v[54:55], v[46:47], v[46:47]
    v_pk_fma_f32 v[48:49], v[48:49], v[242:243], v[240:241]
    v_pk_fma_f32 v[50:51], v[50:51], v[242:243], v[240:241]
    v_pk_fma_f32 v[52:53], v[52:53], v[242:243], v[240:241]
    v_pk_fma_f32 v[54:55], v[54:55], v[242:243], v[240:241]
    v_pk_mul_f32 v[48:49], v[48:49], v[40:41]
    v_pk_mul_f32 v[50:51], v[50:51], v[42:43]
    v_pk_mul_f32 v[52:53], v[52:53], v[44:45]
    v_pk_mul_f32 v[54:55], v[54:55], v[46:47]
    v_exp_f32 v48, v48
    v_exp_f32 v49, v49
    v_exp_f32 v50, v50
    v_exp_f32 v51, v51
    v_exp_f32 v52, v52
    v_exp_f32 v53, v53
    v_exp_f32 v54, v54
    v_exp_f32 v55, v55
    v_pk_add_f32 v[48:49], v[48:49], v[244:245]
    v_pk_add_f32 v[50:51], v[50:51], v[244:245]
    v_pk_add_f32 v[52:53], v[52:53], v[244:245]
    v_pk_add_f32 v[54:55], v[54:55], v[244:245]
    v_rcp_f32 v48, v48
    v_rcp_f32 v49, v49
    v_rcp_f32 v50, v50
    v_rcp_f32 v51, v51
    v_rcp_f32 v52, v52
    v_rcp_f32 v53, v53
    v_rcp_f32 v54, v54
    v_rcp_f32 v55, v55
    v_pk_mul_f32 v[40:41], v[48:49], v[40:41]
    v_pk_mul_f32 v[42:43], v[50:51], v[42:43]
    v_pk_mul_f32 v[44:45], v[52:53], v[44:45]
    v_pk_mul_f32 v[46:47], v[54:55], v[46:47]
    v_cvt_pk_bf16_f32 v56, v40, v41
    v_cvt_pk_bf16_f32 v57, v42, v43
    v_cvt_pk_bf16_f32 v58, v44, v45
    v_cvt_pk_bf16_f32 v59, v46, v47
    buffer_store_dwordx4 v[56:59], v252, s[4:7], s53 offen offset:0 sc1
    v_accvgpr_read_b32 v0, a72
    v_accvgpr_read_b32 v1, a73
    v_accvgpr_read_b32 v2, a74
    v_accvgpr_read_b32 v3, a75
    v_accvgpr_read_b32 v4, a76
    v_accvgpr_read_b32 v5, a77
    v_accvgpr_read_b32 v6, a78
    v_accvgpr_read_b32 v7, a79
    v_pk_mul_f32 v[8:9], v[0:1], v[0:1]
    v_pk_mul_f32 v[10:11], v[2:3], v[2:3]
    v_pk_mul_f32 v[12:13], v[4:5], v[4:5]
    v_pk_mul_f32 v[14:15], v[6:7], v[6:7]
    v_pk_fma_f32 v[8:9], v[8:9], v[242:243], v[240:241]
    v_pk_fma_f32 v[10:11], v[10:11], v[242:243], v[240:241]
    v_pk_fma_f32 v[12:13], v[12:13], v[242:243], v[240:241]
    v_pk_fma_f32 v[14:15], v[14:15], v[242:243], v[240:241]
    v_pk_mul_f32 v[8:9], v[8:9], v[0:1]
    v_pk_mul_f32 v[10:11], v[10:11], v[2:3]
    v_pk_mul_f32 v[12:13], v[12:13], v[4:5]
    v_pk_mul_f32 v[14:15], v[14:15], v[6:7]
    v_exp_f32 v8, v8
    v_exp_f32 v9, v9
    v_exp_f32 v10, v10
    v_exp_f32 v11, v11
    v_exp_f32 v12, v12
    v_exp_f32 v13, v13
    v_exp_f32 v14, v14
    v_exp_f32 v15, v15
    v_pk_add_f32 v[8:9], v[8:9], v[244:245]
    v_pk_add_f32 v[10:11], v[10:11], v[244:245]
    v_pk_add_f32 v[12:13], v[12:13], v[244:245]
    v_pk_add_f32 v[14:15], v[14:15], v[244:245]
    v_rcp_f32 v8, v8
    v_rcp_f32 v9, v9
    v_rcp_f32 v10, v10
    v_rcp_f32 v11, v11
    v_rcp_f32 v12, v12
    v_rcp_f32 v13, v13
    v_rcp_f32 v14, v14
    v_rcp_f32 v15, v15
    v_pk_mul_f32 v[0:1], v[8:9], v[0:1]
    v_pk_mul_f32 v[2:3], v[10:11], v[2:3]
    v_pk_mul_f32 v[4:5], v[12:13], v[4:5]
    v_pk_mul_f32 v[6:7], v[14:15], v[6:7]
    v_cvt_pk_bf16_f32 v16, v0, v1
    v_cvt_pk_bf16_f32 v17, v2, v3
    v_cvt_pk_bf16_f32 v18, v4, v5
    v_cvt_pk_bf16_f32 v19, v6, v7
    buffer_store_dwordx4 v[16:19], v252, s[4:7], s53 offen offset:1024 sc1
    v_accvgpr_read_b32 v20, a80
    v_accvgpr_read_b32 v21, a81
    v_accvgpr_read_b32 v22, a82
    v_accvgpr_read_b32 v23, a83
    v_accvgpr_read_b32 v24, a84
    v_accvgpr_read_b32 v25, a85
    v_accvgpr_read_b32 v26, a86
    v_accvgpr_read_b32 v27, a87
    v_pk_mul_f32 v[28:29], v[20:21], v[20:21]
    v_pk_mul_f32 v[30:31], v[22:23], v[22:23]
    v_pk_mul_f32 v[32:33], v[24:25], v[24:25]
    v_pk_mul_f32 v[34:35], v[26:27], v[26:27]
    v_pk_fma_f32 v[28:29], v[28:29], v[242:243], v[240:241]
    v_pk_fma_f32 v[30:31], v[30:31], v[242:243], v[240:241]
    v_pk_fma_f32 v[32:33], v[32:33], v[242:243], v[240:241]
    v_pk_fma_f32 v[34:35], v[34:35], v[242:243], v[240:241]
    v_pk_mul_f32 v[28:29], v[28:29], v[20:21]
    v_pk_mul_f32 v[30:31], v[30:31], v[22:23]
    v_pk_mul_f32 v[32:33], v[32:33], v[24:25]
    v_pk_mul_f32 v[34:35], v[34:35], v[26:27]
    v_exp_f32 v28, v28
    v_exp_f32 v29, v29
    v_exp_f32 v30, v30
    v_exp_f32 v31, v31
    v_exp_f32 v32, v32
    v_exp_f32 v33, v33
    v_exp_f32 v34, v34
    v_exp_f32 v35, v35
    v_pk_add_f32 v[28:29], v[28:29], v[244:245]
    v_pk_add_f32 v[30:31], v[30:31], v[244:245]
    v_pk_add_f32 v[32:33], v[32:33], v[244:245]
    v_pk_add_f32 v[34:35], v[34:35], v[244:245]
    v_rcp_f32 v28, v28
    v_rcp_f32 v29, v29
    v_rcp_f32 v30, v30
    v_rcp_f32 v31, v31
    v_rcp_f32 v32, v32
    v_rcp_f32 v33, v33
    v_rcp_f32 v34, v34
    v_rcp_f32 v35, v35
    v_pk_mul_f32 v[20:21], v[28:29], v[20:21]
    v_pk_mul_f32 v[22:23], v[30:31], v[22:23]
    v_pk_mul_f32 v[24:25], v[32:33], v[24:25]
    v_pk_mul_f32 v[26:27], v[34:35], v[26:27]
    v_cvt_pk_bf16_f32 v36, v20, v21
    v_cvt_pk_bf16_f32 v37, v22, v23
    v_cvt_pk_bf16_f32 v38, v24, v25
    v_cvt_pk_bf16_f32 v39, v26, v27
    buffer_store_dwordx4 v[36:39], v252, s[4:7], s53 offen offset:2048 sc1
    v_accvgpr_read_b32 v40, a88
    v_accvgpr_read_b32 v41, a89
    v_accvgpr_read_b32 v42, a90
    v_accvgpr_read_b32 v43, a91
    v_accvgpr_read_b32 v44, a92
    v_accvgpr_read_b32 v45, a93
    v_accvgpr_read_b32 v46, a94
    v_accvgpr_read_b32 v47, a95
    v_pk_mul_f32 v[48:49], v[40:41], v[40:41]
    v_pk_mul_f32 v[50:51], v[42:43], v[42:43]
    v_pk_mul_f32 v[52:53], v[44:45], v[44:45]
    v_pk_mul_f32 v[54:55], v[46:47], v[46:47]
    v_pk_fma_f32 v[48:49], v[48:49], v[242:243], v[240:241]
    v_pk_fma_f32 v[50:51], v[50:51], v[242:243], v[240:241]
    v_pk_fma_f32 v[52:53], v[52:53], v[242:243], v[240:241]
    v_pk_fma_f32 v[54:55], v[54:55], v[242:243], v[240:241]
    v_pk_mul_f32 v[48:49], v[48:49], v[40:41]
    v_pk_mul_f32 v[50:51], v[50:51], v[42:43]
    v_pk_mul_f32 v[52:53], v[52:53], v[44:45]
    v_pk_mul_f32 v[54:55], v[54:55], v[46:47]
    v_exp_f32 v48, v48
    v_exp_f32 v49, v49
    v_exp_f32 v50, v50
    v_exp_f32 v51, v51
    v_exp_f32 v52, v52
    v_exp_f32 v53, v53
    v_exp_f32 v54, v54
    v_exp_f32 v55, v55
    v_pk_add_f32 v[48:49], v[48:49], v[244:245]
    v_pk_add_f32 v[50:51], v[50:51], v[244:245]
    v_pk_add_f32 v[52:53], v[52:53], v[244:245]
    v_pk_add_f32 v[54:55], v[54:55], v[244:245]
    v_rcp_f32 v48, v48
    v_rcp_f32 v49, v49
    v_rcp_f32 v50, v50
    v_rcp_f32 v51, v51
    v_rcp_f32 v52, v52
    v_rcp_f32 v53, v53
    v_rcp_f32 v54, v54
    v_rcp_f32 v55, v55
    v_pk_mul_f32 v[40:41], v[48:49], v[40:41]
    v_pk_mul_f32 v[42:43], v[50:51], v[42:43]
    v_pk_mul_f32 v[44:45], v[52:53], v[44:45]
    v_pk_mul_f32 v[46:47], v[54:55], v[46:47]
    v_cvt_pk_bf16_f32 v56, v40, v41
    v_cvt_pk_bf16_f32 v57, v42, v43
    v_cvt_pk_bf16_f32 v58, v44, v45
    v_cvt_pk_bf16_f32 v59, v46, v47
    buffer_store_dwordx4 v[56:59], v252, s[4:7], s53 offen offset:3072 sc1
    s_add_u32 s53, s53, s22
    v_accvgpr_read_b32 v0, a96
    v_accvgpr_read_b32 v1, a97
    v_accvgpr_read_b32 v2, a98
    v_accvgpr_read_b32 v3, a99
    v_accvgpr_read_b32 v4, a100
    v_accvgpr_read_b32 v5, a101
    v_accvgpr_read_b32 v6, a102
    v_accvgpr_read_b32 v7, a103
    v_pk_mul_f32 v[8:9], v[0:1], v[0:1]
    v_pk_mul_f32 v[10:11], v[2:3], v[2:3]
    v_pk_mul_f32 v[12:13], v[4:5], v[4:5]
    v_pk_mul_f32 v[14:15], v[6:7], v[6:7]
    v_pk_fma_f32 v[8:9], v[8:9], v[242:243], v[240:241]
    v_pk_fma_f32 v[10:11], v[10:11], v[242:243], v[240:241]
    v_pk_fma_f32 v[12:13], v[12:13], v[242:243], v[240:241]
    v_pk_fma_f32 v[14:15], v[14:15], v[242:243], v[240:241]
    v_pk_mul_f32 v[8:9], v[8:9], v[0:1]
    v_pk_mul_f32 v[10:11], v[10:11], v[2:3]
    v_pk_mul_f32 v[12:13], v[12:13], v[4:5]
    v_pk_mul_f32 v[14:15], v[14:15], v[6:7]
    v_exp_f32 v8, v8
    v_exp_f32 v9, v9
    v_exp_f32 v10, v10
    v_exp_f32 v11, v11
    v_exp_f32 v12, v12
    v_exp_f32 v13, v13
    v_exp_f32 v14, v14
    v_exp_f32 v15, v15
    v_pk_add_f32 v[8:9], v[8:9], v[244:245]
    v_pk_add_f32 v[10:11], v[10:11], v[244:245]
    v_pk_add_f32 v[12:13], v[12:13], v[244:245]
    v_pk_add_f32 v[14:15], v[14:15], v[244:245]
    v_rcp_f32 v8, v8
    v_rcp_f32 v9, v9
    v_rcp_f32 v10, v10
    v_rcp_f32 v11, v11
    v_rcp_f32 v12, v12
    v_rcp_f32 v13, v13
    v_rcp_f32 v14, v14
    v_rcp_f32 v15, v15
    v_pk_mul_f32 v[0:1], v[8:9], v[0:1]
    v_pk_mul_f32 v[2:3], v[10:11], v[2:3]
    v_pk_mul_f32 v[4:5], v[12:13], v[4:5]
    v_pk_mul_f32 v[6:7], v[14:15], v[6:7]
    v_cvt_pk_bf16_f32 v16, v0, v1
    v_cvt_pk_bf16_f32 v17, v2, v3
    v_cvt_pk_bf16_f32 v18, v4, v5
    v_cvt_pk_bf16_f32 v19, v6, v7
    buffer_store_dwordx4 v[16:19], v252, s[4:7], s53 offen offset:0 sc1
    v_accvgpr_read_b32 v20, a104
    v_accvgpr_read_b32 v21, a105
    v_accvgpr_read_b32 v22, a106
    v_accvgpr_read_b32 v23, a107
    v_accvgpr_read_b32 v24, a108
    v_accvgpr_read_b32 v25, a109
    v_accvgpr_read_b32 v26, a110
    v_accvgpr_read_b32 v27, a111
    v_pk_mul_f32 v[28:29], v[20:21], v[20:21]
    v_pk_mul_f32 v[30:31], v[22:23], v[22:23]
    v_pk_mul_f32 v[32:33], v[24:25], v[24:25]
    v_pk_mul_f32 v[34:35], v[26:27], v[26:27]
    v_pk_fma_f32 v[28:29], v[28:29], v[242:243], v[240:241]
    v_pk_fma_f32 v[30:31], v[30:31], v[242:243], v[240:241]
    v_pk_fma_f32 v[32:33], v[32:33], v[242:243], v[240:241]
    v_pk_fma_f32 v[34:35], v[34:35], v[242:243], v[240:241]
    v_pk_mul_f32 v[28:29], v[28:29], v[20:21]
    v_pk_mul_f32 v[30:31], v[30:31], v[22:23]
    v_pk_mul_f32 v[32:33], v[32:33], v[24:25]
    v_pk_mul_f32 v[34:35], v[34:35], v[26:27]
    v_exp_f32 v28, v28
    v_exp_f32 v29, v29
    v_exp_f32 v30, v30
    v_exp_f32 v31, v31
    v_exp_f32 v32, v32
    v_exp_f32 v33, v33
    v_exp_f32 v34, v34
    v_exp_f32 v35, v35
    v_pk_add_f32 v[28:29], v[28:29], v[244:245]
    v_pk_add_f32 v[30:31], v[30:31], v[244:245]
    v_pk_add_f32 v[32:33], v[32:33], v[244:245]
    v_pk_add_f32 v[34:35], v[34:35], v[244:245]
    v_rcp_f32 v28, v28
    v_rcp_f32 v29, v29
    v_rcp_f32 v30, v30
    v_rcp_f32 v31, v31
    v_rcp_f32 v32, v32
    v_rcp_f32 v33, v33
    v_rcp_f32 v34, v34
    v_rcp_f32 v35, v35
    v_pk_mul_f32 v[20:21], v[28:29], v[20:21]
    v_pk_mul_f32 v[22:23], v[30:31], v[22:23]
    v_pk_mul_f32 v[24:25], v[32:33], v[24:25]
    v_pk_mul_f32 v[26:27], v[34:35], v[26:27]
    v_cvt_pk_bf16_f32 v36, v20, v21
    v_cvt_pk_bf16_f32 v37, v22, v23
    v_cvt_pk_bf16_f32 v38, v24, v25
    v_cvt_pk_bf16_f32 v39, v26, v27
    buffer_store_dwordx4 v[36:39], v252, s[4:7], s53 offen offset:1024 sc1
    v_accvgpr_read_b32 v40, a112
    v_accvgpr_read_b32 v41, a113
    v_accvgpr_read_b32 v42, a114
    v_accvgpr_read_b32 v43, a115
    v_accvgpr_read_b32 v44, a116
    v_accvgpr_read_b32 v45, a117
    v_accvgpr_read_b32 v46, a118
    v_accvgpr_read_b32 v47, a119
    v_pk_mul_f32 v[48:49], v[40:41], v[40:41]
    v_pk_mul_f32 v[50:51], v[42:43], v[42:43]
    v_pk_mul_f32 v[52:53], v[44:45], v[44:45]
    v_pk_mul_f32 v[54:55], v[46:47], v[46:47]
    v_pk_fma_f32 v[48:49], v[48:49], v[242:243], v[240:241]
    v_pk_fma_f32 v[50:51], v[50:51], v[242:243], v[240:241]
    v_pk_fma_f32 v[52:53], v[52:53], v[242:243], v[240:241]
    v_pk_fma_f32 v[54:55], v[54:55], v[242:243], v[240:241]
    v_pk_mul_f32 v[48:49], v[48:49], v[40:41]
    v_pk_mul_f32 v[50:51], v[50:51], v[42:43]
    v_pk_mul_f32 v[52:53], v[52:53], v[44:45]
    v_pk_mul_f32 v[54:55], v[54:55], v[46:47]
    v_exp_f32 v48, v48
    v_exp_f32 v49, v49
    v_exp_f32 v50, v50
    v_exp_f32 v51, v51
    v_exp_f32 v52, v52
    v_exp_f32 v53, v53
    v_exp_f32 v54, v54
    v_exp_f32 v55, v55
    v_pk_add_f32 v[48:49], v[48:49], v[244:245]
    v_pk_add_f32 v[50:51], v[50:51], v[244:245]
    v_pk_add_f32 v[52:53], v[52:53], v[244:245]
    v_pk_add_f32 v[54:55], v[54:55], v[244:245]
    v_rcp_f32 v48, v48
    v_rcp_f32 v49, v49
    v_rcp_f32 v50, v50
    v_rcp_f32 v51, v51
    v_rcp_f32 v52, v52
    v_rcp_f32 v53, v53
    v_rcp_f32 v54, v54
    v_rcp_f32 v55, v55
    v_pk_mul_f32 v[40:41], v[48:49], v[40:41]
    v_pk_mul_f32 v[42:43], v[50:51], v[42:43]
    v_pk_mul_f32 v[44:45], v[52:53], v[44:45]
    v_pk_mul_f32 v[46:47], v[54:55], v[46:47]
    v_cvt_pk_bf16_f32 v56, v40, v41
    v_cvt_pk_bf16_f32 v57, v42, v43
    v_cvt_pk_bf16_f32 v58, v44, v45
    v_cvt_pk_bf16_f32 v59, v46, v47
    buffer_store_dwordx4 v[56:59], v252, s[4:7], s53 offen offset:2048 sc1
    v_accvgpr_read_b32 v0, a120
    v_accvgpr_read_b32 v1, a121
    v_accvgpr_read_b32 v2, a122
    v_accvgpr_read_b32 v3, a123
    v_accvgpr_read_b32 v4, a124
    v_accvgpr_read_b32 v5, a125
    v_accvgpr_read_b32 v6, a126
    v_accvgpr_read_b32 v7, a127
    v_pk_mul_f32 v[8:9], v[0:1], v[0:1]
    v_pk_mul_f32 v[10:11], v[2:3], v[2:3]
    v_pk_mul_f32 v[12:13], v[4:5], v[4:5]
    v_pk_mul_f32 v[14:15], v[6:7], v[6:7]
    v_pk_fma_f32 v[8:9], v[8:9], v[242:243], v[240:241]
    v_pk_fma_f32 v[10:11], v[10:11], v[242:243], v[240:241]
    v_pk_fma_f32 v[12:13], v[12:13], v[242:243], v[240:241]
    v_pk_fma_f32 v[14:15], v[14:15], v[242:243], v[240:241]
    v_pk_mul_f32 v[8:9], v[8:9], v[0:1]
    v_pk_mul_f32 v[10:11], v[10:11], v[2:3]
    v_pk_mul_f32 v[12:13], v[12:13], v[4:5]
    v_pk_mul_f32 v[14:15], v[14:15], v[6:7]
    v_exp_f32 v8, v8
    v_exp_f32 v9, v9
    v_exp_f32 v10, v10
    v_exp_f32 v11, v11
    v_exp_f32 v12, v12
    v_exp_f32 v13, v13
    v_exp_f32 v14, v14
    v_exp_f32 v15, v15
    v_pk_add_f32 v[8:9], v[8:9], v[244:245]
    v_pk_add_f32 v[10:11], v[10:11], v[244:245]
    v_pk_add_f32 v[12:13], v[12:13], v[244:245]
    v_pk_add_f32 v[14:15], v[14:15], v[244:245]
    v_rcp_f32 v8, v8
    v_rcp_f32 v9, v9
    v_rcp_f32 v10, v10
    v_rcp_f32 v11, v11
    v_rcp_f32 v12, v12
    v_rcp_f32 v13, v13
    v_rcp_f32 v14, v14
    v_rcp_f32 v15, v15
    v_pk_mul_f32 v[0:1], v[8:9], v[0:1]
    v_pk_mul_f32 v[2:3], v[10:11], v[2:3]
    v_pk_mul_f32 v[4:5], v[12:13], v[4:5]
    v_pk_mul_f32 v[6:7], v[14:15], v[6:7]
    v_cvt_pk_bf16_f32 v16, v0, v1
    v_cvt_pk_bf16_f32 v17, v2, v3
    v_cvt_pk_bf16_f32 v18, v4, v5
    v_cvt_pk_bf16_f32 v19, v6, v7
    buffer_store_dwordx4 v[16:19], v252, s[4:7], s53 offen offset:3072 sc1
    s_branch main_kernel_w_done
main_kernel_w_c1_egelu:
    s_mov_b32 s53, s21
    v_accvgpr_read_b32 v0, a0
    v_accvgpr_read_b32 v1, a1
    v_accvgpr_read_b32 v2, a2
    v_accvgpr_read_b32 v3, a3
    v_accvgpr_read_b32 v4, a4
    v_accvgpr_read_b32 v5, a5
    v_accvgpr_read_b32 v6, a6
    v_accvgpr_read_b32 v7, a7
    v_pk_mul_f32 v[8:9], v[0:1], v[0:1]
    v_pk_mul_f32 v[10:11], v[2:3], v[2:3]
    v_pk_mul_f32 v[12:13], v[4:5], v[4:5]
    v_pk_mul_f32 v[14:15], v[6:7], v[6:7]
    v_pk_fma_f32 v[8:9], v[8:9], v[242:243], v[240:241]
    v_pk_fma_f32 v[10:11], v[10:11], v[242:243], v[240:241]
    v_pk_fma_f32 v[12:13], v[12:13], v[242:243], v[240:241]
    v_pk_fma_f32 v[14:15], v[14:15], v[242:243], v[240:241]
    v_pk_mul_f32 v[8:9], v[8:9], v[0:1]
    v_pk_mul_f32 v[10:11], v[10:11], v[2:3]
    v_pk_mul_f32 v[12:13], v[12:13], v[4:5]
    v_pk_mul_f32 v[14:15], v[14:15], v[6:7]
    v_exp_f32 v8, v8
    v_exp_f32 v9, v9
    v_exp_f32 v10, v10
    v_exp_f32 v11, v11
    v_exp_f32 v12, v12
    v_exp_f32 v13, v13
    v_exp_f32 v14, v14
    v_exp_f32 v15, v15
    v_pk_add_f32 v[8:9], v[8:9], v[244:245]
    v_pk_add_f32 v[10:11], v[10:11], v[244:245]
    v_pk_add_f32 v[12:13], v[12:13], v[244:245]
    v_pk_add_f32 v[14:15], v[14:15], v[244:245]
    v_rcp_f32 v8, v8
    v_rcp_f32 v9, v9
    v_rcp_f32 v10, v10
    v_rcp_f32 v11, v11
    v_rcp_f32 v12, v12
    v_rcp_f32 v13, v13
    v_rcp_f32 v14, v14
    v_rcp_f32 v15, v15
    v_pk_mul_f32 v[0:1], v[8:9], v[0:1]
    v_pk_mul_f32 v[2:3], v[10:11], v[2:3]
    v_pk_mul_f32 v[4:5], v[12:13], v[4:5]
    v_pk_mul_f32 v[6:7], v[14:15], v[6:7]
    v_cvt_pk_bf16_f32 v16, v0, v1
    v_cvt_pk_bf16_f32 v17, v2, v3
    v_cvt_pk_bf16_f32 v18, v4, v5
    v_cvt_pk_bf16_f32 v19, v6, v7
    buffer_store_dwordx4 v[16:19], v251, s[4:7], s53 offen offset:0 sc1
    v_accvgpr_read_b32 v20, a8
    v_accvgpr_read_b32 v21, a9
    v_accvgpr_read_b32 v22, a10
    v_accvgpr_read_b32 v23, a11
    v_accvgpr_read_b32 v24, a12
    v_accvgpr_read_b32 v25, a13
    v_accvgpr_read_b32 v26, a14
    v_accvgpr_read_b32 v27, a15
    v_pk_mul_f32 v[28:29], v[20:21], v[20:21]
    v_pk_mul_f32 v[30:31], v[22:23], v[22:23]
    v_pk_mul_f32 v[32:33], v[24:25], v[24:25]
    v_pk_mul_f32 v[34:35], v[26:27], v[26:27]
    v_pk_fma_f32 v[28:29], v[28:29], v[242:243], v[240:241]
    v_pk_fma_f32 v[30:31], v[30:31], v[242:243], v[240:241]
    v_pk_fma_f32 v[32:33], v[32:33], v[242:243], v[240:241]
    v_pk_fma_f32 v[34:35], v[34:35], v[242:243], v[240:241]
    v_pk_mul_f32 v[28:29], v[28:29], v[20:21]
    v_pk_mul_f32 v[30:31], v[30:31], v[22:23]
    v_pk_mul_f32 v[32:33], v[32:33], v[24:25]
    v_pk_mul_f32 v[34:35], v[34:35], v[26:27]
    v_exp_f32 v28, v28
    v_exp_f32 v29, v29
    v_exp_f32 v30, v30
    v_exp_f32 v31, v31
    v_exp_f32 v32, v32
    v_exp_f32 v33, v33
    v_exp_f32 v34, v34
    v_exp_f32 v35, v35
    v_pk_add_f32 v[28:29], v[28:29], v[244:245]
    v_pk_add_f32 v[30:31], v[30:31], v[244:245]
    v_pk_add_f32 v[32:33], v[32:33], v[244:245]
    v_pk_add_f32 v[34:35], v[34:35], v[244:245]
    v_rcp_f32 v28, v28
    v_rcp_f32 v29, v29
    v_rcp_f32 v30, v30
    v_rcp_f32 v31, v31
    v_rcp_f32 v32, v32
    v_rcp_f32 v33, v33
    v_rcp_f32 v34, v34
    v_rcp_f32 v35, v35
    v_pk_mul_f32 v[20:21], v[28:29], v[20:21]
    v_pk_mul_f32 v[22:23], v[30:31], v[22:23]
    v_pk_mul_f32 v[24:25], v[32:33], v[24:25]
    v_pk_mul_f32 v[26:27], v[34:35], v[26:27]
    v_cvt_pk_bf16_f32 v36, v20, v21
    v_cvt_pk_bf16_f32 v37, v22, v23
    v_cvt_pk_bf16_f32 v38, v24, v25
    v_cvt_pk_bf16_f32 v39, v26, v27
    buffer_store_dwordx4 v[36:39], v251, s[4:7], s53 offen offset:1024 sc1
    v_accvgpr_read_b32 v40, a16
    v_accvgpr_read_b32 v41, a17
    v_accvgpr_read_b32 v42, a18
    v_accvgpr_read_b32 v43, a19
    v_accvgpr_read_b32 v44, a20
    v_accvgpr_read_b32 v45, a21
    v_accvgpr_read_b32 v46, a22
    v_accvgpr_read_b32 v47, a23
    v_pk_mul_f32 v[48:49], v[40:41], v[40:41]
    v_pk_mul_f32 v[50:51], v[42:43], v[42:43]
    v_pk_mul_f32 v[52:53], v[44:45], v[44:45]
    v_pk_mul_f32 v[54:55], v[46:47], v[46:47]
    v_pk_fma_f32 v[48:49], v[48:49], v[242:243], v[240:241]
    v_pk_fma_f32 v[50:51], v[50:51], v[242:243], v[240:241]
    v_pk_fma_f32 v[52:53], v[52:53], v[242:243], v[240:241]
    v_pk_fma_f32 v[54:55], v[54:55], v[242:243], v[240:241]
    v_pk_mul_f32 v[48:49], v[48:49], v[40:41]
    v_pk_mul_f32 v[50:51], v[50:51], v[42:43]
    v_pk_mul_f32 v[52:53], v[52:53], v[44:45]
    v_pk_mul_f32 v[54:55], v[54:55], v[46:47]
    v_exp_f32 v48, v48
    v_exp_f32 v49, v49
    v_exp_f32 v50, v50
    v_exp_f32 v51, v51
    v_exp_f32 v52, v52
    v_exp_f32 v53, v53
    v_exp_f32 v54, v54
    v_exp_f32 v55, v55
    v_pk_add_f32 v[48:49], v[48:49], v[244:245]
    v_pk_add_f32 v[50:51], v[50:51], v[244:245]
    v_pk_add_f32 v[52:53], v[52:53], v[244:245]
    v_pk_add_f32 v[54:55], v[54:55], v[244:245]
    v_rcp_f32 v48, v48
    v_rcp_f32 v49, v49
    v_rcp_f32 v50, v50
    v_rcp_f32 v51, v51
    v_rcp_f32 v52, v52
    v_rcp_f32 v53, v53
    v_rcp_f32 v54, v54
    v_rcp_f32 v55, v55
    v_pk_mul_f32 v[40:41], v[48:49], v[40:41]
    v_pk_mul_f32 v[42:43], v[50:51], v[42:43]
    v_pk_mul_f32 v[44:45], v[52:53], v[44:45]
    v_pk_mul_f32 v[46:47], v[54:55], v[46:47]
    v_cvt_pk_bf16_f32 v56, v40, v41
    v_cvt_pk_bf16_f32 v57, v42, v43
    v_cvt_pk_bf16_f32 v58, v44, v45
    v_cvt_pk_bf16_f32 v59, v46, v47
    buffer_store_dwordx4 v[56:59], v251, s[4:7], s53 offen offset:2048 sc1
    v_accvgpr_read_b32 v0, a24
    v_accvgpr_read_b32 v1, a25
    v_accvgpr_read_b32 v2, a26
    v_accvgpr_read_b32 v3, a27
    v_accvgpr_read_b32 v4, a28
    v_accvgpr_read_b32 v5, a29
    v_accvgpr_read_b32 v6, a30
    v_accvgpr_read_b32 v7, a31
    v_pk_mul_f32 v[8:9], v[0:1], v[0:1]
    v_pk_mul_f32 v[10:11], v[2:3], v[2:3]
    v_pk_mul_f32 v[12:13], v[4:5], v[4:5]
    v_pk_mul_f32 v[14:15], v[6:7], v[6:7]
    v_pk_fma_f32 v[8:9], v[8:9], v[242:243], v[240:241]
    v_pk_fma_f32 v[10:11], v[10:11], v[242:243], v[240:241]
    v_pk_fma_f32 v[12:13], v[12:13], v[242:243], v[240:241]
    v_pk_fma_f32 v[14:15], v[14:15], v[242:243], v[240:241]
    v_pk_mul_f32 v[8:9], v[8:9], v[0:1]
    v_pk_mul_f32 v[10:11], v[10:11], v[2:3]
    v_pk_mul_f32 v[12:13], v[12:13], v[4:5]
    v_pk_mul_f32 v[14:15], v[14:15], v[6:7]
    v_exp_f32 v8, v8
    v_exp_f32 v9, v9
    v_exp_f32 v10, v10
    v_exp_f32 v11, v11
    v_exp_f32 v12, v12
    v_exp_f32 v13, v13
    v_exp_f32 v14, v14
    v_exp_f32 v15, v15
    v_pk_add_f32 v[8:9], v[8:9], v[244:245]
    v_pk_add_f32 v[10:11], v[10:11], v[244:245]
    v_pk_add_f32 v[12:13], v[12:13], v[244:245]
    v_pk_add_f32 v[14:15], v[14:15], v[244:245]
    v_rcp_f32 v8, v8
    v_rcp_f32 v9, v9
    v_rcp_f32 v10, v10
    v_rcp_f32 v11, v11
    v_rcp_f32 v12, v12
    v_rcp_f32 v13, v13
    v_rcp_f32 v14, v14
    v_rcp_f32 v15, v15
    v_pk_mul_f32 v[0:1], v[8:9], v[0:1]
    v_pk_mul_f32 v[2:3], v[10:11], v[2:3]
    v_pk_mul_f32 v[4:5], v[12:13], v[4:5]
    v_pk_mul_f32 v[6:7], v[14:15], v[6:7]
    v_cvt_pk_bf16_f32 v16, v0, v1
    v_cvt_pk_bf16_f32 v17, v2, v3
    v_cvt_pk_bf16_f32 v18, v4, v5
    v_cvt_pk_bf16_f32 v19, v6, v7
    buffer_store_dwordx4 v[16:19], v251, s[4:7], s53 offen offset:3072 sc1
    s_add_u32 s53, s53, s22
    v_accvgpr_read_b32 v20, a32
    v_accvgpr_read_b32 v21, a33
    v_accvgpr_read_b32 v22, a34
    v_accvgpr_read_b32 v23, a35
    v_accvgpr_read_b32 v24, a36
    v_accvgpr_read_b32 v25, a37
    v_accvgpr_read_b32 v26, a38
    v_accvgpr_read_b32 v27, a39
    v_pk_mul_f32 v[28:29], v[20:21], v[20:21]
    v_pk_mul_f32 v[30:31], v[22:23], v[22:23]
    v_pk_mul_f32 v[32:33], v[24:25], v[24:25]
    v_pk_mul_f32 v[34:35], v[26:27], v[26:27]
    v_pk_fma_f32 v[28:29], v[28:29], v[242:243], v[240:241]
    v_pk_fma_f32 v[30:31], v[30:31], v[242:243], v[240:241]
    v_pk_fma_f32 v[32:33], v[32:33], v[242:243], v[240:241]
    v_pk_fma_f32 v[34:35], v[34:35], v[242:243], v[240:241]
    v_pk_mul_f32 v[28:29], v[28:29], v[20:21]
    v_pk_mul_f32 v[30:31], v[30:31], v[22:23]
    v_pk_mul_f32 v[32:33], v[32:33], v[24:25]
    v_pk_mul_f32 v[34:35], v[34:35], v[26:27]
    v_exp_f32 v28, v28
    v_exp_f32 v29, v29
    v_exp_f32 v30, v30
    v_exp_f32 v31, v31
    v_exp_f32 v32, v32
    v_exp_f32 v33, v33
    v_exp_f32 v34, v34
    v_exp_f32 v35, v35
    v_pk_add_f32 v[28:29], v[28:29], v[244:245]
    v_pk_add_f32 v[30:31], v[30:31], v[244:245]
    v_pk_add_f32 v[32:33], v[32:33], v[244:245]
    v_pk_add_f32 v[34:35], v[34:35], v[244:245]
    v_rcp_f32 v28, v28
    v_rcp_f32 v29, v29
    v_rcp_f32 v30, v30
    v_rcp_f32 v31, v31
    v_rcp_f32 v32, v32
    v_rcp_f32 v33, v33
    v_rcp_f32 v34, v34
    v_rcp_f32 v35, v35
    v_pk_mul_f32 v[20:21], v[28:29], v[20:21]
    v_pk_mul_f32 v[22:23], v[30:31], v[22:23]
    v_pk_mul_f32 v[24:25], v[32:33], v[24:25]
    v_pk_mul_f32 v[26:27], v[34:35], v[26:27]
    v_cvt_pk_bf16_f32 v36, v20, v21
    v_cvt_pk_bf16_f32 v37, v22, v23
    v_cvt_pk_bf16_f32 v38, v24, v25
    v_cvt_pk_bf16_f32 v39, v26, v27
    buffer_store_dwordx4 v[36:39], v251, s[4:7], s53 offen offset:0 sc1
    v_accvgpr_read_b32 v40, a40
    v_accvgpr_read_b32 v41, a41
    v_accvgpr_read_b32 v42, a42
    v_accvgpr_read_b32 v43, a43
    v_accvgpr_read_b32 v44, a44
    v_accvgpr_read_b32 v45, a45
    v_accvgpr_read_b32 v46, a46
    v_accvgpr_read_b32 v47, a47
    v_pk_mul_f32 v[48:49], v[40:41], v[40:41]
    v_pk_mul_f32 v[50:51], v[42:43], v[42:43]
    v_pk_mul_f32 v[52:53], v[44:45], v[44:45]
    v_pk_mul_f32 v[54:55], v[46:47], v[46:47]
    v_pk_fma_f32 v[48:49], v[48:49], v[242:243], v[240:241]
    v_pk_fma_f32 v[50:51], v[50:51], v[242:243], v[240:241]
    v_pk_fma_f32 v[52:53], v[52:53], v[242:243], v[240:241]
    v_pk_fma_f32 v[54:55], v[54:55], v[242:243], v[240:241]
    v_pk_mul_f32 v[48:49], v[48:49], v[40:41]
    v_pk_mul_f32 v[50:51], v[50:51], v[42:43]
    v_pk_mul_f32 v[52:53], v[52:53], v[44:45]
    v_pk_mul_f32 v[54:55], v[54:55], v[46:47]
    v_exp_f32 v48, v48
    v_exp_f32 v49, v49
    v_exp_f32 v50, v50
    v_exp_f32 v51, v51
    v_exp_f32 v52, v52
    v_exp_f32 v53, v53
    v_exp_f32 v54, v54
    v_exp_f32 v55, v55
    v_pk_add_f32 v[48:49], v[48:49], v[244:245]
    v_pk_add_f32 v[50:51], v[50:51], v[244:245]
    v_pk_add_f32 v[52:53], v[52:53], v[244:245]
    v_pk_add_f32 v[54:55], v[54:55], v[244:245]
    v_rcp_f32 v48, v48
    v_rcp_f32 v49, v49
    v_rcp_f32 v50, v50
    v_rcp_f32 v51, v51
    v_rcp_f32 v52, v52
    v_rcp_f32 v53, v53
    v_rcp_f32 v54, v54
    v_rcp_f32 v55, v55
    v_pk_mul_f32 v[40:41], v[48:49], v[40:41]
    v_pk_mul_f32 v[42:43], v[50:51], v[42:43]
    v_pk_mul_f32 v[44:45], v[52:53], v[44:45]
    v_pk_mul_f32 v[46:47], v[54:55], v[46:47]
    v_cvt_pk_bf16_f32 v56, v40, v41
    v_cvt_pk_bf16_f32 v57, v42, v43
    v_cvt_pk_bf16_f32 v58, v44, v45
    v_cvt_pk_bf16_f32 v59, v46, v47
    buffer_store_dwordx4 v[56:59], v251, s[4:7], s53 offen offset:1024 sc1
    v_accvgpr_read_b32 v0, a48
    v_accvgpr_read_b32 v1, a49
    v_accvgpr_read_b32 v2, a50
    v_accvgpr_read_b32 v3, a51
    v_accvgpr_read_b32 v4, a52
    v_accvgpr_read_b32 v5, a53
    v_accvgpr_read_b32 v6, a54
    v_accvgpr_read_b32 v7, a55
    v_pk_mul_f32 v[8:9], v[0:1], v[0:1]
    v_pk_mul_f32 v[10:11], v[2:3], v[2:3]
    v_pk_mul_f32 v[12:13], v[4:5], v[4:5]
    v_pk_mul_f32 v[14:15], v[6:7], v[6:7]
    v_pk_fma_f32 v[8:9], v[8:9], v[242:243], v[240:241]
    v_pk_fma_f32 v[10:11], v[10:11], v[242:243], v[240:241]
    v_pk_fma_f32 v[12:13], v[12:13], v[242:243], v[240:241]
    v_pk_fma_f32 v[14:15], v[14:15], v[242:243], v[240:241]
    v_pk_mul_f32 v[8:9], v[8:9], v[0:1]
    v_pk_mul_f32 v[10:11], v[10:11], v[2:3]
    v_pk_mul_f32 v[12:13], v[12:13], v[4:5]
    v_pk_mul_f32 v[14:15], v[14:15], v[6:7]
    v_exp_f32 v8, v8
    v_exp_f32 v9, v9
    v_exp_f32 v10, v10
    v_exp_f32 v11, v11
    v_exp_f32 v12, v12
    v_exp_f32 v13, v13
    v_exp_f32 v14, v14
    v_exp_f32 v15, v15
    v_pk_add_f32 v[8:9], v[8:9], v[244:245]
    v_pk_add_f32 v[10:11], v[10:11], v[244:245]
    v_pk_add_f32 v[12:13], v[12:13], v[244:245]
    v_pk_add_f32 v[14:15], v[14:15], v[244:245]
    v_rcp_f32 v8, v8
    v_rcp_f32 v9, v9
    v_rcp_f32 v10, v10
    v_rcp_f32 v11, v11
    v_rcp_f32 v12, v12
    v_rcp_f32 v13, v13
    v_rcp_f32 v14, v14
    v_rcp_f32 v15, v15
    v_pk_mul_f32 v[0:1], v[8:9], v[0:1]
    v_pk_mul_f32 v[2:3], v[10:11], v[2:3]
    v_pk_mul_f32 v[4:5], v[12:13], v[4:5]
    v_pk_mul_f32 v[6:7], v[14:15], v[6:7]
    v_cvt_pk_bf16_f32 v16, v0, v1
    v_cvt_pk_bf16_f32 v17, v2, v3
    v_cvt_pk_bf16_f32 v18, v4, v5
    v_cvt_pk_bf16_f32 v19, v6, v7
    buffer_store_dwordx4 v[16:19], v251, s[4:7], s53 offen offset:2048 sc1
    v_accvgpr_read_b32 v20, a56
    v_accvgpr_read_b32 v21, a57
    v_accvgpr_read_b32 v22, a58
    v_accvgpr_read_b32 v23, a59
    v_accvgpr_read_b32 v24, a60
    v_accvgpr_read_b32 v25, a61
    v_accvgpr_read_b32 v26, a62
    v_accvgpr_read_b32 v27, a63
    v_pk_mul_f32 v[28:29], v[20:21], v[20:21]
    v_pk_mul_f32 v[30:31], v[22:23], v[22:23]
    v_pk_mul_f32 v[32:33], v[24:25], v[24:25]
    v_pk_mul_f32 v[34:35], v[26:27], v[26:27]
    v_pk_fma_f32 v[28:29], v[28:29], v[242:243], v[240:241]
    v_pk_fma_f32 v[30:31], v[30:31], v[242:243], v[240:241]
    v_pk_fma_f32 v[32:33], v[32:33], v[242:243], v[240:241]
    v_pk_fma_f32 v[34:35], v[34:35], v[242:243], v[240:241]
    v_pk_mul_f32 v[28:29], v[28:29], v[20:21]
    v_pk_mul_f32 v[30:31], v[30:31], v[22:23]
    v_pk_mul_f32 v[32:33], v[32:33], v[24:25]
    v_pk_mul_f32 v[34:35], v[34:35], v[26:27]
    v_exp_f32 v28, v28
    v_exp_f32 v29, v29
    v_exp_f32 v30, v30
    v_exp_f32 v31, v31
    v_exp_f32 v32, v32
    v_exp_f32 v33, v33
    v_exp_f32 v34, v34
    v_exp_f32 v35, v35
    v_pk_add_f32 v[28:29], v[28:29], v[244:245]
    v_pk_add_f32 v[30:31], v[30:31], v[244:245]
    v_pk_add_f32 v[32:33], v[32:33], v[244:245]
    v_pk_add_f32 v[34:35], v[34:35], v[244:245]
    v_rcp_f32 v28, v28
    v_rcp_f32 v29, v29
    v_rcp_f32 v30, v30
    v_rcp_f32 v31, v31
    v_rcp_f32 v32, v32
    v_rcp_f32 v33, v33
    v_rcp_f32 v34, v34
    v_rcp_f32 v35, v35
    v_pk_mul_f32 v[20:21], v[28:29], v[20:21]
    v_pk_mul_f32 v[22:23], v[30:31], v[22:23]
    v_pk_mul_f32 v[24:25], v[32:33], v[24:25]
    v_pk_mul_f32 v[26:27], v[34:35], v[26:27]
    v_cvt_pk_bf16_f32 v36, v20, v21
    v_cvt_pk_bf16_f32 v37, v22, v23
    v_cvt_pk_bf16_f32 v38, v24, v25
    v_cvt_pk_bf16_f32 v39, v26, v27
    buffer_store_dwordx4 v[36:39], v251, s[4:7], s53 offen offset:3072 sc1
    s_add_u32 s53, s53, s22
    v_accvgpr_read_b32 v40, a64
    v_accvgpr_read_b32 v41, a65
    v_accvgpr_read_b32 v42, a66
    v_accvgpr_read_b32 v43, a67
    v_accvgpr_read_b32 v44, a68
    v_accvgpr_read_b32 v45, a69
    v_accvgpr_read_b32 v46, a70
    v_accvgpr_read_b32 v47, a71
    v_pk_mul_f32 v[48:49], v[40:41], v[40:41]
    v_pk_mul_f32 v[50:51], v[42:43], v[42:43]
    v_pk_mul_f32 v[52:53], v[44:45], v[44:45]
    v_pk_mul_f32 v[54:55], v[46:47], v[46:47]
    v_pk_fma_f32 v[48:49], v[48:49], v[242:243], v[240:241]
    v_pk_fma_f32 v[50:51], v[50:51], v[242:243], v[240:241]
    v_pk_fma_f32 v[52:53], v[52:53], v[242:243], v[240:241]
    v_pk_fma_f32 v[54:55], v[54:55], v[242:243], v[240:241]
    v_pk_mul_f32 v[48:49], v[48:49], v[40:41]
    v_pk_mul_f32 v[50:51], v[50:51], v[42:43]
    v_pk_mul_f32 v[52:53], v[52:53], v[44:45]
    v_pk_mul_f32 v[54:55], v[54:55], v[46:47]
    v_exp_f32 v48, v48
    v_exp_f32 v49, v49
    v_exp_f32 v50, v50
    v_exp_f32 v51, v51
    v_exp_f32 v52, v52
    v_exp_f32 v53, v53
    v_exp_f32 v54, v54
    v_exp_f32 v55, v55
    v_pk_add_f32 v[48:49], v[48:49], v[244:245]
    v_pk_add_f32 v[50:51], v[50:51], v[244:245]
    v_pk_add_f32 v[52:53], v[52:53], v[244:245]
    v_pk_add_f32 v[54:55], v[54:55], v[244:245]
    v_rcp_f32 v48, v48
    v_rcp_f32 v49, v49
    v_rcp_f32 v50, v50
    v_rcp_f32 v51, v51
    v_rcp_f32 v52, v52
    v_rcp_f32 v53, v53
    v_rcp_f32 v54, v54
    v_rcp_f32 v55, v55
    v_pk_mul_f32 v[40:41], v[48:49], v[40:41]
    v_pk_mul_f32 v[42:43], v[50:51], v[42:43]
    v_pk_mul_f32 v[44:45], v[52:53], v[44:45]
    v_pk_mul_f32 v[46:47], v[54:55], v[46:47]
    v_cvt_pk_bf16_f32 v56, v40, v41
    v_cvt_pk_bf16_f32 v57, v42, v43
    v_cvt_pk_bf16_f32 v58, v44, v45
    v_cvt_pk_bf16_f32 v59, v46, v47
    buffer_store_dwordx4 v[56:59], v251, s[4:7], s53 offen offset:0 sc1
    v_accvgpr_read_b32 v0, a72
    v_accvgpr_read_b32 v1, a73
    v_accvgpr_read_b32 v2, a74
    v_accvgpr_read_b32 v3, a75
    v_accvgpr_read_b32 v4, a76
    v_accvgpr_read_b32 v5, a77
    v_accvgpr_read_b32 v6, a78
    v_accvgpr_read_b32 v7, a79
    v_pk_mul_f32 v[8:9], v[0:1], v[0:1]
    v_pk_mul_f32 v[10:11], v[2:3], v[2:3]
    v_pk_mul_f32 v[12:13], v[4:5], v[4:5]
    v_pk_mul_f32 v[14:15], v[6:7], v[6:7]
    v_pk_fma_f32 v[8:9], v[8:9], v[242:243], v[240:241]
    v_pk_fma_f32 v[10:11], v[10:11], v[242:243], v[240:241]
    v_pk_fma_f32 v[12:13], v[12:13], v[242:243], v[240:241]
    v_pk_fma_f32 v[14:15], v[14:15], v[242:243], v[240:241]
    v_pk_mul_f32 v[8:9], v[8:9], v[0:1]
    v_pk_mul_f32 v[10:11], v[10:11], v[2:3]
    v_pk_mul_f32 v[12:13], v[12:13], v[4:5]
    v_pk_mul_f32 v[14:15], v[14:15], v[6:7]
    v_exp_f32 v8, v8
    v_exp_f32 v9, v9
    v_exp_f32 v10, v10
    v_exp_f32 v11, v11
    v_exp_f32 v12, v12
    v_exp_f32 v13, v13
    v_exp_f32 v14, v14
    v_exp_f32 v15, v15
    v_pk_add_f32 v[8:9], v[8:9], v[244:245]
    v_pk_add_f32 v[10:11], v[10:11], v[244:245]
    v_pk_add_f32 v[12:13], v[12:13], v[244:245]
    v_pk_add_f32 v[14:15], v[14:15], v[244:245]
    v_rcp_f32 v8, v8
    v_rcp_f32 v9, v9
    v_rcp_f32 v10, v10
    v_rcp_f32 v11, v11
    v_rcp_f32 v12, v12
    v_rcp_f32 v13, v13
    v_rcp_f32 v14, v14
    v_rcp_f32 v15, v15
    v_pk_mul_f32 v[0:1], v[8:9], v[0:1]
    v_pk_mul_f32 v[2:3], v[10:11], v[2:3]
    v_pk_mul_f32 v[4:5], v[12:13], v[4:5]
    v_pk_mul_f32 v[6:7], v[14:15], v[6:7]
    v_cvt_pk_bf16_f32 v16, v0, v1
    v_cvt_pk_bf16_f32 v17, v2, v3
    v_cvt_pk_bf16_f32 v18, v4, v5
    v_cvt_pk_bf16_f32 v19, v6, v7
    buffer_store_dwordx4 v[16:19], v251, s[4:7], s53 offen offset:1024 sc1
    v_accvgpr_read_b32 v20, a80
    v_accvgpr_read_b32 v21, a81
    v_accvgpr_read_b32 v22, a82
    v_accvgpr_read_b32 v23, a83
    v_accvgpr_read_b32 v24, a84
    v_accvgpr_read_b32 v25, a85
    v_accvgpr_read_b32 v26, a86
    v_accvgpr_read_b32 v27, a87
    v_pk_mul_f32 v[28:29], v[20:21], v[20:21]
    v_pk_mul_f32 v[30:31], v[22:23], v[22:23]
    v_pk_mul_f32 v[32:33], v[24:25], v[24:25]
    v_pk_mul_f32 v[34:35], v[26:27], v[26:27]
    v_pk_fma_f32 v[28:29], v[28:29], v[242:243], v[240:241]
    v_pk_fma_f32 v[30:31], v[30:31], v[242:243], v[240:241]
    v_pk_fma_f32 v[32:33], v[32:33], v[242:243], v[240:241]
    v_pk_fma_f32 v[34:35], v[34:35], v[242:243], v[240:241]
    v_pk_mul_f32 v[28:29], v[28:29], v[20:21]
    v_pk_mul_f32 v[30:31], v[30:31], v[22:23]
    v_pk_mul_f32 v[32:33], v[32:33], v[24:25]
    v_pk_mul_f32 v[34:35], v[34:35], v[26:27]
    v_exp_f32 v28, v28
    v_exp_f32 v29, v29
    v_exp_f32 v30, v30
    v_exp_f32 v31, v31
    v_exp_f32 v32, v32
    v_exp_f32 v33, v33
    v_exp_f32 v34, v34
    v_exp_f32 v35, v35
    v_pk_add_f32 v[28:29], v[28:29], v[244:245]
    v_pk_add_f32 v[30:31], v[30:31], v[244:245]
    v_pk_add_f32 v[32:33], v[32:33], v[244:245]
    v_pk_add_f32 v[34:35], v[34:35], v[244:245]
    v_rcp_f32 v28, v28
    v_rcp_f32 v29, v29
    v_rcp_f32 v30, v30
    v_rcp_f32 v31, v31
    v_rcp_f32 v32, v32
    v_rcp_f32 v33, v33
    v_rcp_f32 v34, v34
    v_rcp_f32 v35, v35
    v_pk_mul_f32 v[20:21], v[28:29], v[20:21]
    v_pk_mul_f32 v[22:23], v[30:31], v[22:23]
    v_pk_mul_f32 v[24:25], v[32:33], v[24:25]
    v_pk_mul_f32 v[26:27], v[34:35], v[26:27]
    v_cvt_pk_bf16_f32 v36, v20, v21
    v_cvt_pk_bf16_f32 v37, v22, v23
    v_cvt_pk_bf16_f32 v38, v24, v25
    v_cvt_pk_bf16_f32 v39, v26, v27
    buffer_store_dwordx4 v[36:39], v251, s[4:7], s53 offen offset:2048 sc1
    v_accvgpr_read_b32 v40, a88
    v_accvgpr_read_b32 v41, a89
    v_accvgpr_read_b32 v42, a90
    v_accvgpr_read_b32 v43, a91
    v_accvgpr_read_b32 v44, a92
    v_accvgpr_read_b32 v45, a93
    v_accvgpr_read_b32 v46, a94
    v_accvgpr_read_b32 v47, a95
    v_pk_mul_f32 v[48:49], v[40:41], v[40:41]
    v_pk_mul_f32 v[50:51], v[42:43], v[42:43]
    v_pk_mul_f32 v[52:53], v[44:45], v[44:45]
    v_pk_mul_f32 v[54:55], v[46:47], v[46:47]
    v_pk_fma_f32 v[48:49], v[48:49], v[242:243], v[240:241]
    v_pk_fma_f32 v[50:51], v[50:51], v[242:243], v[240:241]
    v_pk_fma_f32 v[52:53], v[52:53], v[242:243], v[240:241]
    v_pk_fma_f32 v[54:55], v[54:55], v[242:243], v[240:241]
    v_pk_mul_f32 v[48:49], v[48:49], v[40:41]
    v_pk_mul_f32 v[50:51], v[50:51], v[42:43]
    v_pk_mul_f32 v[52:53], v[52:53], v[44:45]
    v_pk_mul_f32 v[54:55], v[54:55], v[46:47]
    v_exp_f32 v48, v48
    v_exp_f32 v49, v49
    v_exp_f32 v50, v50
    v_exp_f32 v51, v51
    v_exp_f32 v52, v52
    v_exp_f32 v53, v53
    v_exp_f32 v54, v54
    v_exp_f32 v55, v55
    v_pk_add_f32 v[48:49], v[48:49], v[244:245]
    v_pk_add_f32 v[50:51], v[50:51], v[244:245]
    v_pk_add_f32 v[52:53], v[52:53], v[244:245]
    v_pk_add_f32 v[54:55], v[54:55], v[244:245]
    v_rcp_f32 v48, v48
    v_rcp_f32 v49, v49
    v_rcp_f32 v50, v50
    v_rcp_f32 v51, v51
    v_rcp_f32 v52, v52
    v_rcp_f32 v53, v53
    v_rcp_f32 v54, v54
    v_rcp_f32 v55, v55
    v_pk_mul_f32 v[40:41], v[48:49], v[40:41]
    v_pk_mul_f32 v[42:43], v[50:51], v[42:43]
    v_pk_mul_f32 v[44:45], v[52:53], v[44:45]
    v_pk_mul_f32 v[46:47], v[54:55], v[46:47]
    v_cvt_pk_bf16_f32 v56, v40, v41
    v_cvt_pk_bf16_f32 v57, v42, v43
    v_cvt_pk_bf16_f32 v58, v44, v45
    v_cvt_pk_bf16_f32 v59, v46, v47
    buffer_store_dwordx4 v[56:59], v251, s[4:7], s53 offen offset:3072 sc1
    s_add_u32 s53, s53, s22
    v_accvgpr_read_b32 v0, a96
    v_accvgpr_read_b32 v1, a97
    v_accvgpr_read_b32 v2, a98
    v_accvgpr_read_b32 v3, a99
    v_accvgpr_read_b32 v4, a100
    v_accvgpr_read_b32 v5, a101
    v_accvgpr_read_b32 v6, a102
    v_accvgpr_read_b32 v7, a103
    v_pk_mul_f32 v[8:9], v[0:1], v[0:1]
    v_pk_mul_f32 v[10:11], v[2:3], v[2:3]
    v_pk_mul_f32 v[12:13], v[4:5], v[4:5]
    v_pk_mul_f32 v[14:15], v[6:7], v[6:7]
    v_pk_fma_f32 v[8:9], v[8:9], v[242:243], v[240:241]
    v_pk_fma_f32 v[10:11], v[10:11], v[242:243], v[240:241]
    v_pk_fma_f32 v[12:13], v[12:13], v[242:243], v[240:241]
    v_pk_fma_f32 v[14:15], v[14:15], v[242:243], v[240:241]
    v_pk_mul_f32 v[8:9], v[8:9], v[0:1]
    v_pk_mul_f32 v[10:11], v[10:11], v[2:3]
    v_pk_mul_f32 v[12:13], v[12:13], v[4:5]
    v_pk_mul_f32 v[14:15], v[14:15], v[6:7]
    v_exp_f32 v8, v8
    v_exp_f32 v9, v9
    v_exp_f32 v10, v10
    v_exp_f32 v11, v11
    v_exp_f32 v12, v12
    v_exp_f32 v13, v13
    v_exp_f32 v14, v14
    v_exp_f32 v15, v15
    v_pk_add_f32 v[8:9], v[8:9], v[244:245]
    v_pk_add_f32 v[10:11], v[10:11], v[244:245]
    v_pk_add_f32 v[12:13], v[12:13], v[244:245]
    v_pk_add_f32 v[14:15], v[14:15], v[244:245]
    v_rcp_f32 v8, v8
    v_rcp_f32 v9, v9
    v_rcp_f32 v10, v10
    v_rcp_f32 v11, v11
    v_rcp_f32 v12, v12
    v_rcp_f32 v13, v13
    v_rcp_f32 v14, v14
    v_rcp_f32 v15, v15
    v_pk_mul_f32 v[0:1], v[8:9], v[0:1]
    v_pk_mul_f32 v[2:3], v[10:11], v[2:3]
    v_pk_mul_f32 v[4:5], v[12:13], v[4:5]
    v_pk_mul_f32 v[6:7], v[14:15], v[6:7]
    v_cvt_pk_bf16_f32 v16, v0, v1
    v_cvt_pk_bf16_f32 v17, v2, v3
    v_cvt_pk_bf16_f32 v18, v4, v5
    v_cvt_pk_bf16_f32 v19, v6, v7
    buffer_store_dwordx4 v[16:19], v251, s[4:7], s53 offen offset:0 sc1
    v_accvgpr_read_b32 v20, a104
    v_accvgpr_read_b32 v21, a105
    v_accvgpr_read_b32 v22, a106
    v_accvgpr_read_b32 v23, a107
    v_accvgpr_read_b32 v24, a108
    v_accvgpr_read_b32 v25, a109
    v_accvgpr_read_b32 v26, a110
    v_accvgpr_read_b32 v27, a111
    v_pk_mul_f32 v[28:29], v[20:21], v[20:21]
    v_pk_mul_f32 v[30:31], v[22:23], v[22:23]
    v_pk_mul_f32 v[32:33], v[24:25], v[24:25]
    v_pk_mul_f32 v[34:35], v[26:27], v[26:27]
    v_pk_fma_f32 v[28:29], v[28:29], v[242:243], v[240:241]
    v_pk_fma_f32 v[30:31], v[30:31], v[242:243], v[240:241]
    v_pk_fma_f32 v[32:33], v[32:33], v[242:243], v[240:241]
    v_pk_fma_f32 v[34:35], v[34:35], v[242:243], v[240:241]
    v_pk_mul_f32 v[28:29], v[28:29], v[20:21]
    v_pk_mul_f32 v[30:31], v[30:31], v[22:23]
    v_pk_mul_f32 v[32:33], v[32:33], v[24:25]
    v_pk_mul_f32 v[34:35], v[34:35], v[26:27]
    v_exp_f32 v28, v28
    v_exp_f32 v29, v29
    v_exp_f32 v30, v30
    v_exp_f32 v31, v31
    v_exp_f32 v32, v32
    v_exp_f32 v33, v33
    v_exp_f32 v34, v34
    v_exp_f32 v35, v35
    v_pk_add_f32 v[28:29], v[28:29], v[244:245]
    v_pk_add_f32 v[30:31], v[30:31], v[244:245]
    v_pk_add_f32 v[32:33], v[32:33], v[244:245]
    v_pk_add_f32 v[34:35], v[34:35], v[244:245]
    v_rcp_f32 v28, v28
    v_rcp_f32 v29, v29
    v_rcp_f32 v30, v30
    v_rcp_f32 v31, v31
    v_rcp_f32 v32, v32
    v_rcp_f32 v33, v33
    v_rcp_f32 v34, v34
    v_rcp_f32 v35, v35
    v_pk_mul_f32 v[20:21], v[28:29], v[20:21]
    v_pk_mul_f32 v[22:23], v[30:31], v[22:23]
    v_pk_mul_f32 v[24:25], v[32:33], v[24:25]
    v_pk_mul_f32 v[26:27], v[34:35], v[26:27]
    v_cvt_pk_bf16_f32 v36, v20, v21
    v_cvt_pk_bf16_f32 v37, v22, v23
    v_cvt_pk_bf16_f32 v38, v24, v25
    v_cvt_pk_bf16_f32 v39, v26, v27
    buffer_store_dwordx4 v[36:39], v251, s[4:7], s53 offen offset:1024 sc1
    v_accvgpr_read_b32 v40, a112
    v_accvgpr_read_b32 v41, a113
    v_accvgpr_read_b32 v42, a114
    v_accvgpr_read_b32 v43, a115
    v_accvgpr_read_b32 v44, a116
    v_accvgpr_read_b32 v45, a117
    v_accvgpr_read_b32 v46, a118
    v_accvgpr_read_b32 v47, a119
    v_pk_mul_f32 v[48:49], v[40:41], v[40:41]
    v_pk_mul_f32 v[50:51], v[42:43], v[42:43]
    v_pk_mul_f32 v[52:53], v[44:45], v[44:45]
    v_pk_mul_f32 v[54:55], v[46:47], v[46:47]
    v_pk_fma_f32 v[48:49], v[48:49], v[242:243], v[240:241]
    v_pk_fma_f32 v[50:51], v[50:51], v[242:243], v[240:241]
    v_pk_fma_f32 v[52:53], v[52:53], v[242:243], v[240:241]
    v_pk_fma_f32 v[54:55], v[54:55], v[242:243], v[240:241]
    v_pk_mul_f32 v[48:49], v[48:49], v[40:41]
    v_pk_mul_f32 v[50:51], v[50:51], v[42:43]
    v_pk_mul_f32 v[52:53], v[52:53], v[44:45]
    v_pk_mul_f32 v[54:55], v[54:55], v[46:47]
    v_exp_f32 v48, v48
    v_exp_f32 v49, v49
    v_exp_f32 v50, v50
    v_exp_f32 v51, v51
    v_exp_f32 v52, v52
    v_exp_f32 v53, v53
    v_exp_f32 v54, v54
    v_exp_f32 v55, v55
    v_pk_add_f32 v[48:49], v[48:49], v[244:245]
    v_pk_add_f32 v[50:51], v[50:51], v[244:245]
    v_pk_add_f32 v[52:53], v[52:53], v[244:245]
    v_pk_add_f32 v[54:55], v[54:55], v[244:245]
    v_rcp_f32 v48, v48
    v_rcp_f32 v49, v49
    v_rcp_f32 v50, v50
    v_rcp_f32 v51, v51
    v_rcp_f32 v52, v52
    v_rcp_f32 v53, v53
    v_rcp_f32 v54, v54
    v_rcp_f32 v55, v55
    v_pk_mul_f32 v[40:41], v[48:49], v[40:41]
    v_pk_mul_f32 v[42:43], v[50:51], v[42:43]
    v_pk_mul_f32 v[44:45], v[52:53], v[44:45]
    v_pk_mul_f32 v[46:47], v[54:55], v[46:47]
    v_cvt_pk_bf16_f32 v56, v40, v41
    v_cvt_pk_bf16_f32 v57, v42, v43
    v_cvt_pk_bf16_f32 v58, v44, v45
    v_cvt_pk_bf16_f32 v59, v46, v47
    buffer_store_dwordx4 v[56:59], v251, s[4:7], s53 offen offset:2048 sc1
    v_accvgpr_read_b32 v0, a120
    v_accvgpr_read_b32 v1, a121
    v_accvgpr_read_b32 v2, a122
    v_accvgpr_read_b32 v3, a123
    v_accvgpr_read_b32 v4, a124
    v_accvgpr_read_b32 v5, a125
    v_accvgpr_read_b32 v6, a126
    v_accvgpr_read_b32 v7, a127
    v_pk_mul_f32 v[8:9], v[0:1], v[0:1]
    v_pk_mul_f32 v[10:11], v[2:3], v[2:3]
    v_pk_mul_f32 v[12:13], v[4:5], v[4:5]
    v_pk_mul_f32 v[14:15], v[6:7], v[6:7]
    v_pk_fma_f32 v[8:9], v[8:9], v[242:243], v[240:241]
    v_pk_fma_f32 v[10:11], v[10:11], v[242:243], v[240:241]
    v_pk_fma_f32 v[12:13], v[12:13], v[242:243], v[240:241]
    v_pk_fma_f32 v[14:15], v[14:15], v[242:243], v[240:241]
    v_pk_mul_f32 v[8:9], v[8:9], v[0:1]
    v_pk_mul_f32 v[10:11], v[10:11], v[2:3]
    v_pk_mul_f32 v[12:13], v[12:13], v[4:5]
    v_pk_mul_f32 v[14:15], v[14:15], v[6:7]
    v_exp_f32 v8, v8
    v_exp_f32 v9, v9
    v_exp_f32 v10, v10
    v_exp_f32 v11, v11
    v_exp_f32 v12, v12
    v_exp_f32 v13, v13
    v_exp_f32 v14, v14
    v_exp_f32 v15, v15
    v_pk_add_f32 v[8:9], v[8:9], v[244:245]
    v_pk_add_f32 v[10:11], v[10:11], v[244:245]
    v_pk_add_f32 v[12:13], v[12:13], v[244:245]
    v_pk_add_f32 v[14:15], v[14:15], v[244:245]
    v_rcp_f32 v8, v8
    v_rcp_f32 v9, v9
    v_rcp_f32 v10, v10
    v_rcp_f32 v11, v11
    v_rcp_f32 v12, v12
    v_rcp_f32 v13, v13
    v_rcp_f32 v14, v14
    v_rcp_f32 v15, v15
    v_pk_mul_f32 v[0:1], v[8:9], v[0:1]
    v_pk_mul_f32 v[2:3], v[10:11], v[2:3]
    v_pk_mul_f32 v[4:5], v[12:13], v[4:5]
    v_pk_mul_f32 v[6:7], v[14:15], v[6:7]
    v_cvt_pk_bf16_f32 v16, v0, v1
    v_cvt_pk_bf16_f32 v17, v2, v3
    v_cvt_pk_bf16_f32 v18, v4, v5
    v_cvt_pk_bf16_f32 v19, v6, v7
    buffer_store_dwordx4 v[16:19], v251, s[4:7], s53 offen offset:3072 sc1
    s_branch main_kernel_w_done
main_kernel_w_c1_gov:
    v_lshrrev_b32 v0, 4, v250
    v_bfe_u32 v1, v250, 2, 2
    v_lshl_add_u32 v4, v0, 2, v1
    v_and_b32 v5, 7, v4
    v_mul_u32_u24 v4, 512, v4
    v_and_b32 v6, 3, v250
    v_lshl_add_u32 v4, v6, 3, v4
    s_mul_i32 s32, s37, 8
    v_xor_b32 v5, s32, v5
    v_lshl_add_u32 v128, v5, 5, v4
    v_xor_b32 v129, 32, v128
    v_xor_b32 v130, 64, v128
    v_xor_b32 v131, 96, v128
    v_xor_b32 v132, 128, v128
    v_xor_b32 v133, 160, v128
    v_xor_b32 v134, 192, v128
    v_xor_b32 v135, 224, v128
    s_mul_i32 s32, s38, 4096
    s_add_u32 s32, s32, 65536
    v_add_u32 v136, s32, v251
    v_lshrrev_b32 v2, 5, v250
    v_and_b32 v3, 31, v250
    s_mul_i32 s32, s14, 8
    v_add_u32 v4, s32, v2
    v_add_u32 v5, 0, v4
    v_and_b32 v6, 7, v5
    v_lshlrev_b32 v6, 1, v6
    v_xor_b32 v6, v6, v3
    v_mul_lo_u32 v5, v5, s30
    v_lshl_add_u32 v5, v6, 4, v5
    v_subrev_u32 v137, 0, v5
    v_add_u32 v5, 2, v4
    v_and_b32 v6, 7, v5
    v_lshlrev_b32 v6, 1, v6
    v_xor_b32 v6, v6, v3
    v_mul_lo_u32 v5, v5, s30
    v_lshl_add_u32 v5, v6, 4, v5
    v_subrev_u32 v138, 1024, v5
    v_add_u32 v5, 4, v4
    v_and_b32 v6, 7, v5
    v_lshlrev_b32 v6, 1, v6
    v_xor_b32 v6, v6, v3
    v_mul_lo_u32 v5, v5, s30
    v_lshl_add_u32 v5, v6, 4, v5
    v_subrev_u32 v139, 2048, v5
    v_add_u32 v5, 6, v4
    v_and_b32 v6, 7, v5
    v_lshlrev_b32 v6, 1, v6
    v_xor_b32 v6, v6, v3
    v_mul_lo_u32 v5, v5, s30
    v_lshl_add_u32 v5, v6, 4, v5
    v_subrev_u32 v140, 3072, v5
    s_mul_i32 s32, s14, 2
    s_mul_i32 s32, s32, s31
    v_add_u32 v141, s32, v251
    s_add_u32 s32, s32, s31
    s_sub_u32 s32, s32, 1024
    v_add_u32 v142, s32, v251
    s_mul_i32 s19, s14, 4096
    s_mul_i32 s20, s14, 2048
    s_add_u32 s20, s20, 65536
    s_mul_i32 s17, s30, 32
    s_mov_b32 s15, 0
    s_add_u32 m0, s20, 0
    s_nop 0
    buffer_load_dwordx4 v141, s[4:7], s16 offen offset:0 sc1 lds
    buffer_load_dwordx4 v142, s[4:7], s16 offen offset:1024 sc1 lds
    s_add_u32 s16, s16, 1024
    s_add_u32 m0, s19, 0
    s_nop 0
    buffer_load_dwordx4 v137, s[8:11], s15 offen offset:0 lds
    buffer_load_dwordx4 v138, s[8:11], s15 offen offset:1024 lds
    buffer_load_dwordx4 v139, s[8:11], s15 offen offset:2048 lds
    buffer_load_dwordx4 v140, s[8:11], s15 offen offset:3072 lds
    s_add_u32 s15, s15, s17
    s_add_u32 m0, s20, 8192
    s_nop 0
    buffer_load_dwordx4 v141, s[4:7], s16 offen offset:0 sc1 lds
    buffer_load_dwordx4 v142, s[4:7], s16 offen offset:1024 sc1 lds
    s_add_u32 s16, s16, 1024
    s_add_u32 m0, s19, 16384
    s_nop 0
    buffer_load_dwordx4 v137, s[8:11], s15 offen offset:0 lds
    buffer_load_dwordx4 v138, s[8:11], s15 offen offset:1024 lds
    buffer_load_dwordx4 v139, s[8:11], s15 offen offset:2048 lds
    buffer_load_dwordx4 v140, s[8:11], s15 offen offset:3072 lds
    s_add_u32 s15, s15, s17
    s_add_u32 m0, s20, 16384
    s_nop 0
    buffer_load_dwordx4 v141, s[4:7], s16 offen offset:0 sc1 lds
    buffer_load_dwordx4 v142, s[4:7], s16 offen offset:1024 sc1 lds
    s_add_u32 s16, s16, 1024
    s_add_u32 m0, s19, 32768
    s_nop 0
    buffer_load_dwordx4 v137, s[8:11], s15 offen offset:0 lds
    buffer_load_dwordx4 v138, s[8:11], s15 offen offset:1024 lds
    buffer_load_dwordx4 v139, s[8:11], s15 offen offset:2048 lds
    buffer_load_dwordx4 v140, s[8:11], s15 offen offset:3072 lds
    s_add_u32 s15, s15, s17
    s_add_u32 m0, s20, 24576
    s_nop 0
    buffer_load_dwordx4 v141, s[4:7], s16 offen offset:0 sc1 lds
    buffer_load_dwordx4 v142, s[4:7], s16 offen offset:1024 sc1 lds
    s_add_u32 s16, s16, 1024
    s_add_u32 m0, s19, 49152
    s_nop 0
    buffer_load_dwordx4 v137, s[8:11], s15 offen offset:0 lds
    buffer_load_dwordx4 v138, s[8:11], s15 offen offset:1024 lds
    buffer_load_dwordx4 v139, s[8:11], s15 offen offset:2048 lds
    buffer_load_dwordx4 v140, s[8:11], s15 offen offset:3072 lds
    s_add_u32 s15, s15, s17
    v_accvgpr_write_b32 a0, 0
    v_accvgpr_write_b32 a1, 0
    v_accvgpr_write_b32 a2, 0
    v_accvgpr_write_b32 a3, 0
    v_accvgpr_write_b32 a4, 0
    v_accvgpr_write_b32 a5, 0
    v_accvgpr_write_b32 a6, 0
    v_accvgpr_write_b32 a7, 0
    v_accvgpr_write_b32 a8, 0
    v_accvgpr_write_b32 a9, 0
    v_accvgpr_write_b32 a10, 0
    v_accvgpr_write_b32 a11, 0
    v_accvgpr_write_b32 a12, 0
    v_accvgpr_write_b32 a13, 0
    v_accvgpr_write_b32 a14, 0
    v_accvgpr_write_b32 a15, 0
    v_accvgpr_write_b32 a16, 0
    v_accvgpr_write_b32 a17, 0
    v_accvgpr_write_b32 a18, 0
    v_accvgpr_write_b32 a19, 0
    v_accvgpr_write_b32 a20, 0
    v_accvgpr_write_b32 a21, 0
    v_accvgpr_write_b32 a22, 0
    v_accvgpr_write_b32 a23, 0
    v_accvgpr_write_b32 a24, 0
    v_accvgpr_write_b32 a25, 0
    v_accvgpr_write_b32 a26, 0
    v_accvgpr_write_b32 a27, 0
    v_accvgpr_write_b32 a28, 0
    v_accvgpr_write_b32 a29, 0
    v_accvgpr_write_b32 a30, 0
    v_accvgpr_write_b32 a31, 0
    v_accvgpr_write_b32 a32, 0
    v_accvgpr_write_b32 a33, 0
    v_accvgpr_write_b32 a34, 0
    v_accvgpr_write_b32 a35, 0
    v_accvgpr_write_b32 a36, 0
    v_accvgpr_write_b32 a37, 0
    v_accvgpr_write_b32 a38, 0
    v_accvgpr_write_b32 a39, 0
    v_accvgpr_write_b32 a40, 0
    v_accvgpr_write_b32 a41, 0
    v_accvgpr_write_b32 a42, 0
    v_accvgpr_write_b32 a43, 0
    v_accvgpr_write_b32 a44, 0
    v_accvgpr_write_b32 a45, 0
    v_accvgpr_write_b32 a46, 0
    v_accvgpr_write_b32 a47, 0
    v_accvgpr_write_b32 a48, 0
    v_accvgpr_write_b32 a49, 0
    v_accvgpr_write_b32 a50, 0
    v_accvgpr_write_b32 a51, 0
    v_accvgpr_write_b32 a52, 0
    v_accvgpr_write_b32 a53, 0
    v_accvgpr_write_b32 a54, 0
    v_accvgpr_write_b32 a55, 0
    v_accvgpr_write_b32 a56, 0
    v_accvgpr_write_b32 a57, 0
    v_accvgpr_write_b32 a58, 0
    v_accvgpr_write_b32 a59, 0
    v_accvgpr_write_b32 a60, 0
    v_accvgpr_write_b32 a61, 0
    v_accvgpr_write_b32 a62, 0
    v_accvgpr_write_b32 a63, 0
    v_accvgpr_write_b32 a64, 0
    v_accvgpr_write_b32 a65, 0
    v_accvgpr_write_b32 a66, 0
    v_accvgpr_write_b32 a67, 0
    v_accvgpr_write_b32 a68, 0
    v_accvgpr_write_b32 a69, 0
    v_accvgpr_write_b32 a70, 0
    v_accvgpr_write_b32 a71, 0
    v_accvgpr_write_b32 a72, 0
    v_accvgpr_write_b32 a73, 0
    v_accvgpr_write_b32 a74, 0
    v_accvgpr_write_b32 a75, 0
    v_accvgpr_write_b32 a76, 0
    v_accvgpr_write_b32 a77, 0
    v_accvgpr_write_b32 a78, 0
    v_accvgpr_write_b32 a79, 0
    v_accvgpr_write_b32 a80, 0
    v_accvgpr_write_b32 a81, 0
    v_accvgpr_write_b32 a82, 0
    v_accvgpr_write_b32 a83, 0
    v_accvgpr_write_b32 a84, 0
    v_accvgpr_write_b32 a85, 0
    v_accvgpr_write_b32 a86, 0
    v_accvgpr_write_b32 a87, 0
    v_accvgpr_write_b32 a88, 0
    v_accvgpr_write_b32 a89, 0
    v_accvgpr_write_b32 a90, 0
    v_accvgpr_write_b32 a91, 0
    v_accvgpr_write_b32 a92, 0
    v_accvgpr_write_b32 a93, 0
    v_accvgpr_write_b32 a94, 0
    v_accvgpr_write_b32 a95, 0
    v_accvgpr_write_b32 a96, 0
    v_accvgpr_write_b32 a97, 0
    v_accvgpr_write_b32 a98, 0
    v_accvgpr_write_b32 a99, 0
    v_accvgpr_write_b32 a100, 0
    v_accvgpr_write_b32 a101, 0
    v_accvgpr_write_b32 a102, 0
    v_accvgpr_write_b32 a103, 0
    v_accvgpr_write_b32 a104, 0
    v_accvgpr_write_b32 a105, 0
    v_accvgpr_write_b32 a106, 0
    v_accvgpr_write_b32 a107, 0
    v_accvgpr_write_b32 a108, 0
    v_accvgpr_write_b32 a109, 0
    v_accvgpr_write_b32 a110, 0
    v_accvgpr_write_b32 a111, 0
    v_accvgpr_write_b32 a112, 0
    v_accvgpr_write_b32 a113, 0
    v_accvgpr_write_b32 a114, 0
    v_accvgpr_write_b32 a115, 0
    v_accvgpr_write_b32 a116, 0
    v_accvgpr_write_b32 a117, 0
    v_accvgpr_write_b32 a118, 0
    v_accvgpr_write_b32 a119, 0
    v_accvgpr_write_b32 a120, 0
    v_accvgpr_write_b32 a121, 0
    v_accvgpr_write_b32 a122, 0
    v_accvgpr_write_b32 a123, 0
    v_accvgpr_write_b32 a124, 0
    v_accvgpr_write_b32 a125, 0
    v_accvgpr_write_b32 a126, 0
    v_accvgpr_write_b32 a127, 0
    s_waitcnt vmcnt(18)
    s_barrier
    ds_read_b128 v[32:35], v136 offset:0
    ds_read_b64_tr_b16 v[0:1], v128 offset:0
    ds_read_b64_tr_b16 v[2:3], v128 offset:8192
    ds_read_b64_tr_b16 v[4:5], v129 offset:0
    ds_read_b64_tr_b16 v[6:7], v129 offset:8192
    ds_read_b64_tr_b16 v[8:9], v130 offset:0
    ds_read_b64_tr_b16 v[10:11], v130 offset:8192
    ds_read_b64_tr_b16 v[12:13], v131 offset:0
    ds_read_b64_tr_b16 v[14:15], v131 offset:8192
    ds_read_b64_tr_b16 v[16:17], v132 offset:0
    ds_read_b64_tr_b16 v[18:19], v132 offset:8192
    ds_read_b64_tr_b16 v[20:21], v133 offset:0
    ds_read_b64_tr_b16 v[22:23], v133 offset:8192
    ds_read_b64_tr_b16 v[24:25], v134 offset:0
    ds_read_b64_tr_b16 v[26:27], v134 offset:8192
    ds_read_b64_tr_b16 v[28:29], v135 offset:0
    ds_read_b64_tr_b16 v[30:31], v135 offset:8192
    ds_read_b128 v[36:39], v136 offset:1024
    ds_read_b128 v[40:43], v136 offset:2048
    ds_read_b128 v[44:47], v136 offset:3072
main_kernel_w_c1_v_loop:
    s_waitcnt lgkmcnt(0)
    v_mfma_f32_16x16x32_bf16 a[0:3], v[32:35], v[0:3], a[0:3]
    s_waitcnt vmcnt(12)
    s_barrier
    ds_read_b128 v[80:83], v136 offset:8192
    s_add_u32 m0, s20, 0
    s_nop 0
    v_mfma_f32_16x16x32_bf16 a[4:7], v[32:35], v[4:7], a[4:7]
    ds_read_b64_tr_b16 v[48:49], v128 offset:16384
    v_mfma_f32_16x16x32_bf16 a[8:11], v[32:35], v[8:11], a[8:11]
    ds_read_b64_tr_b16 v[50:51], v128 offset:24576
    v_mfma_f32_16x16x32_bf16 a[12:15], v[32:35], v[12:15], a[12:15]
    ds_read_b64_tr_b16 v[52:53], v129 offset:16384
    buffer_load_dwordx4 v141, s[4:7], s16 offen offset:0 sc1 lds
    v_mfma_f32_16x16x32_bf16 a[16:19], v[32:35], v[16:19], a[16:19]
    ds_read_b64_tr_b16 v[54:55], v129 offset:24576
    v_mfma_f32_16x16x32_bf16 a[20:23], v[32:35], v[20:23], a[20:23]
    ds_read_b64_tr_b16 v[56:57], v130 offset:16384
    v_mfma_f32_16x16x32_bf16 a[24:27], v[32:35], v[24:27], a[24:27]
    ds_read_b64_tr_b16 v[58:59], v130 offset:24576
    buffer_load_dwordx4 v142, s[4:7], s16 offen offset:1024 sc1 lds
    v_mfma_f32_16x16x32_bf16 a[28:31], v[32:35], v[28:31], a[28:31]
    ds_read_b64_tr_b16 v[60:61], v131 offset:16384
    v_mfma_f32_16x16x32_bf16 a[32:35], v[36:39], v[0:3], a[32:35]
    ds_read_b64_tr_b16 v[62:63], v131 offset:24576
    v_mfma_f32_16x16x32_bf16 a[36:39], v[36:39], v[4:7], a[36:39]
    ds_read_b64_tr_b16 v[64:65], v132 offset:16384
    s_add_u32 s16, s16, 1024
    v_mfma_f32_16x16x32_bf16 a[40:43], v[36:39], v[8:11], a[40:43]
    ds_read_b64_tr_b16 v[66:67], v132 offset:24576
    v_mfma_f32_16x16x32_bf16 a[44:47], v[36:39], v[12:15], a[44:47]
    ds_read_b64_tr_b16 v[68:69], v133 offset:16384
    v_mfma_f32_16x16x32_bf16 a[48:51], v[36:39], v[16:19], a[48:51]
    ds_read_b64_tr_b16 v[70:71], v133 offset:24576
    s_add_u32 m0, s19, 0
    s_nop 0
    v_mfma_f32_16x16x32_bf16 a[52:55], v[36:39], v[20:23], a[52:55]
    ds_read_b64_tr_b16 v[72:73], v134 offset:16384
    v_mfma_f32_16x16x32_bf16 a[56:59], v[36:39], v[24:27], a[56:59]
    ds_read_b64_tr_b16 v[74:75], v134 offset:24576
    v_mfma_f32_16x16x32_bf16 a[60:63], v[36:39], v[28:31], a[60:63]
    ds_read_b64_tr_b16 v[76:77], v135 offset:16384
    buffer_load_dwordx4 v137, s[8:11], s15 offen offset:0 lds
    v_mfma_f32_16x16x32_bf16 a[64:67], v[40:43], v[0:3], a[64:67]
    ds_read_b64_tr_b16 v[78:79], v135 offset:24576
    v_mfma_f32_16x16x32_bf16 a[68:71], v[40:43], v[4:7], a[68:71]
    ds_read_b128 v[84:87], v136 offset:9216
    v_mfma_f32_16x16x32_bf16 a[72:75], v[40:43], v[8:11], a[72:75]
    ds_read_b128 v[88:91], v136 offset:10240
    buffer_load_dwordx4 v138, s[8:11], s15 offen offset:1024 lds
    v_mfma_f32_16x16x32_bf16 a[76:79], v[40:43], v[12:15], a[76:79]
    ds_read_b128 v[92:95], v136 offset:11264
    v_mfma_f32_16x16x32_bf16 a[80:83], v[40:43], v[16:19], a[80:83]
    v_mfma_f32_16x16x32_bf16 a[84:87], v[40:43], v[20:23], a[84:87]
    buffer_load_dwordx4 v139, s[8:11], s15 offen offset:2048 lds
    v_mfma_f32_16x16x32_bf16 a[88:91], v[40:43], v[24:27], a[88:91]
    v_mfma_f32_16x16x32_bf16 a[92:95], v[40:43], v[28:31], a[92:95]
    v_mfma_f32_16x16x32_bf16 a[96:99], v[44:47], v[0:3], a[96:99]
    buffer_load_dwordx4 v140, s[8:11], s15 offen offset:3072 lds
    v_mfma_f32_16x16x32_bf16 a[100:103], v[44:47], v[4:7], a[100:103]
    v_mfma_f32_16x16x32_bf16 a[104:107], v[44:47], v[8:11], a[104:107]
    v_mfma_f32_16x16x32_bf16 a[108:111], v[44:47], v[12:15], a[108:111]
    s_add_u32 s15, s15, s17
    v_mfma_f32_16x16x32_bf16 a[112:115], v[44:47], v[16:19], a[112:115]
    v_mfma_f32_16x16x32_bf16 a[116:119], v[44:47], v[20:23], a[116:119]
    v_mfma_f32_16x16x32_bf16 a[120:123], v[44:47], v[24:27], a[120:123]
    v_mfma_f32_16x16x32_bf16 a[124:127], v[44:47], v[28:31], a[124:127]
    s_waitcnt lgkmcnt(0)
    v_mfma_f32_16x16x32_bf16 a[0:3], v[80:83], v[48:51], a[0:3]
    s_waitcnt vmcnt(12)
    s_barrier
    ds_read_b128 v[32:35], v136 offset:16384
    s_add_u32 m0, s20, 8192
    s_nop 0
    v_mfma_f32_16x16x32_bf16 a[4:7], v[80:83], v[52:55], a[4:7]
    ds_read_b64_tr_b16 v[0:1], v128 offset:32768
    v_mfma_f32_16x16x32_bf16 a[8:11], v[80:83], v[56:59], a[8:11]
    ds_read_b64_tr_b16 v[2:3], v128 offset:40960
    v_mfma_f32_16x16x32_bf16 a[12:15], v[80:83], v[60:63], a[12:15]
    ds_read_b64_tr_b16 v[4:5], v129 offset:32768
    buffer_load_dwordx4 v141, s[4:7], s16 offen offset:0 sc1 lds
    v_mfma_f32_16x16x32_bf16 a[16:19], v[80:83], v[64:67], a[16:19]
    ds_read_b64_tr_b16 v[6:7], v129 offset:40960
    v_mfma_f32_16x16x32_bf16 a[20:23], v[80:83], v[68:71], a[20:23]
    ds_read_b64_tr_b16 v[8:9], v130 offset:32768
    v_mfma_f32_16x16x32_bf16 a[24:27], v[80:83], v[72:75], a[24:27]
    ds_read_b64_tr_b16 v[10:11], v130 offset:40960
    buffer_load_dwordx4 v142, s[4:7], s16 offen offset:1024 sc1 lds
    v_mfma_f32_16x16x32_bf16 a[28:31], v[80:83], v[76:79], a[28:31]
    ds_read_b64_tr_b16 v[12:13], v131 offset:32768
    v_mfma_f32_16x16x32_bf16 a[32:35], v[84:87], v[48:51], a[32:35]
    ds_read_b64_tr_b16 v[14:15], v131 offset:40960
    v_mfma_f32_16x16x32_bf16 a[36:39], v[84:87], v[52:55], a[36:39]
    ds_read_b64_tr_b16 v[16:17], v132 offset:32768
    s_add_u32 s16, s16, 1024
    v_mfma_f32_16x16x32_bf16 a[40:43], v[84:87], v[56:59], a[40:43]
    ds_read_b64_tr_b16 v[18:19], v132 offset:40960
    v_mfma_f32_16x16x32_bf16 a[44:47], v[84:87], v[60:63], a[44:47]
    ds_read_b64_tr_b16 v[20:21], v133 offset:32768
    v_mfma_f32_16x16x32_bf16 a[48:51], v[84:87], v[64:67], a[48:51]
    ds_read_b64_tr_b16 v[22:23], v133 offset:40960
    s_add_u32 m0, s19, 16384
    s_nop 0
    v_mfma_f32_16x16x32_bf16 a[52:55], v[84:87], v[68:71], a[52:55]
    ds_read_b64_tr_b16 v[24:25], v134 offset:32768
    v_mfma_f32_16x16x32_bf16 a[56:59], v[84:87], v[72:75], a[56:59]
    ds_read_b64_tr_b16 v[26:27], v134 offset:40960
    v_mfma_f32_16x16x32_bf16 a[60:63], v[84:87], v[76:79], a[60:63]
    ds_read_b64_tr_b16 v[28:29], v135 offset:32768
    buffer_load_dwordx4 v137, s[8:11], s15 offen offset:0 lds
    v_mfma_f32_16x16x32_bf16 a[64:67], v[88:91], v[48:51], a[64:67]
    ds_read_b64_tr_b16 v[30:31], v135 offset:40960
    v_mfma_f32_16x16x32_bf16 a[68:71], v[88:91], v[52:55], a[68:71]
    ds_read_b128 v[36:39], v136 offset:17408
    v_mfma_f32_16x16x32_bf16 a[72:75], v[88:91], v[56:59], a[72:75]
    ds_read_b128 v[40:43], v136 offset:18432
    buffer_load_dwordx4 v138, s[8:11], s15 offen offset:1024 lds
    v_mfma_f32_16x16x32_bf16 a[76:79], v[88:91], v[60:63], a[76:79]
    ds_read_b128 v[44:47], v136 offset:19456
    v_mfma_f32_16x16x32_bf16 a[80:83], v[88:91], v[64:67], a[80:83]
    v_mfma_f32_16x16x32_bf16 a[84:87], v[88:91], v[68:71], a[84:87]
    buffer_load_dwordx4 v139, s[8:11], s15 offen offset:2048 lds
    v_mfma_f32_16x16x32_bf16 a[88:91], v[88:91], v[72:75], a[88:91]
    v_mfma_f32_16x16x32_bf16 a[92:95], v[88:91], v[76:79], a[92:95]
    v_mfma_f32_16x16x32_bf16 a[96:99], v[92:95], v[48:51], a[96:99]
    buffer_load_dwordx4 v140, s[8:11], s15 offen offset:3072 lds
    v_mfma_f32_16x16x32_bf16 a[100:103], v[92:95], v[52:55], a[100:103]
    v_mfma_f32_16x16x32_bf16 a[104:107], v[92:95], v[56:59], a[104:107]
    v_mfma_f32_16x16x32_bf16 a[108:111], v[92:95], v[60:63], a[108:111]
    s_add_u32 s15, s15, s17
    v_mfma_f32_16x16x32_bf16 a[112:115], v[92:95], v[64:67], a[112:115]
    v_mfma_f32_16x16x32_bf16 a[116:119], v[92:95], v[68:71], a[116:119]
    v_mfma_f32_16x16x32_bf16 a[120:123], v[92:95], v[72:75], a[120:123]
    v_mfma_f32_16x16x32_bf16 a[124:127], v[92:95], v[76:79], a[124:127]
    s_waitcnt lgkmcnt(0)
    v_mfma_f32_16x16x32_bf16 a[0:3], v[32:35], v[0:3], a[0:3]
    s_waitcnt vmcnt(12)
    s_barrier
    ds_read_b128 v[80:83], v136 offset:24576
    s_add_u32 m0, s20, 16384
    s_nop 0
    v_mfma_f32_16x16x32_bf16 a[4:7], v[32:35], v[4:7], a[4:7]
    ds_read_b64_tr_b16 v[48:49], v128 offset:49152
    v_mfma_f32_16x16x32_bf16 a[8:11], v[32:35], v[8:11], a[8:11]
    ds_read_b64_tr_b16 v[50:51], v128 offset:57344
    v_mfma_f32_16x16x32_bf16 a[12:15], v[32:35], v[12:15], a[12:15]
    ds_read_b64_tr_b16 v[52:53], v129 offset:49152
    buffer_load_dwordx4 v141, s[4:7], s16 offen offset:0 sc1 lds
    v_mfma_f32_16x16x32_bf16 a[16:19], v[32:35], v[16:19], a[16:19]
    ds_read_b64_tr_b16 v[54:55], v129 offset:57344
    v_mfma_f32_16x16x32_bf16 a[20:23], v[32:35], v[20:23], a[20:23]
    ds_read_b64_tr_b16 v[56:57], v130 offset:49152
    v_mfma_f32_16x16x32_bf16 a[24:27], v[32:35], v[24:27], a[24:27]
    ds_read_b64_tr_b16 v[58:59], v130 offset:57344
    buffer_load_dwordx4 v142, s[4:7], s16 offen offset:1024 sc1 lds
    v_mfma_f32_16x16x32_bf16 a[28:31], v[32:35], v[28:31], a[28:31]
    ds_read_b64_tr_b16 v[60:61], v131 offset:49152
    v_mfma_f32_16x16x32_bf16 a[32:35], v[36:39], v[0:3], a[32:35]
    ds_read_b64_tr_b16 v[62:63], v131 offset:57344
    v_mfma_f32_16x16x32_bf16 a[36:39], v[36:39], v[4:7], a[36:39]
    ds_read_b64_tr_b16 v[64:65], v132 offset:49152
    s_add_u32 s16, s16, 1024
    v_mfma_f32_16x16x32_bf16 a[40:43], v[36:39], v[8:11], a[40:43]
    ds_read_b64_tr_b16 v[66:67], v132 offset:57344
    v_mfma_f32_16x16x32_bf16 a[44:47], v[36:39], v[12:15], a[44:47]
    ds_read_b64_tr_b16 v[68:69], v133 offset:49152
    v_mfma_f32_16x16x32_bf16 a[48:51], v[36:39], v[16:19], a[48:51]
    ds_read_b64_tr_b16 v[70:71], v133 offset:57344
    s_add_u32 m0, s19, 32768
    s_nop 0
    v_mfma_f32_16x16x32_bf16 a[52:55], v[36:39], v[20:23], a[52:55]
    ds_read_b64_tr_b16 v[72:73], v134 offset:49152
    v_mfma_f32_16x16x32_bf16 a[56:59], v[36:39], v[24:27], a[56:59]
    ds_read_b64_tr_b16 v[74:75], v134 offset:57344
    v_mfma_f32_16x16x32_bf16 a[60:63], v[36:39], v[28:31], a[60:63]
    ds_read_b64_tr_b16 v[76:77], v135 offset:49152
    buffer_load_dwordx4 v137, s[8:11], s15 offen offset:0 lds
    v_mfma_f32_16x16x32_bf16 a[64:67], v[40:43], v[0:3], a[64:67]
    ds_read_b64_tr_b16 v[78:79], v135 offset:57344
    v_mfma_f32_16x16x32_bf16 a[68:71], v[40:43], v[4:7], a[68:71]
    ds_read_b128 v[84:87], v136 offset:25600
    v_mfma_f32_16x16x32_bf16 a[72:75], v[40:43], v[8:11], a[72:75]
    ds_read_b128 v[88:91], v136 offset:26624
    buffer_load_dwordx4 v138, s[8:11], s15 offen offset:1024 lds
    v_mfma_f32_16x16x32_bf16 a[76:79], v[40:43], v[12:15], a[76:79]
    ds_read_b128 v[92:95], v136 offset:27648
    v_mfma_f32_16x16x32_bf16 a[80:83], v[40:43], v[16:19], a[80:83]
    v_mfma_f32_16x16x32_bf16 a[84:87], v[40:43], v[20:23], a[84:87]
    buffer_load_dwordx4 v139, s[8:11], s15 offen offset:2048 lds
    v_mfma_f32_16x16x32_bf16 a[88:91], v[40:43], v[24:27], a[88:91]
    v_mfma_f32_16x16x32_bf16 a[92:95], v[40:43], v[28:31], a[92:95]
    v_mfma_f32_16x16x32_bf16 a[96:99], v[44:47], v[0:3], a[96:99]
    buffer_load_dwordx4 v140, s[8:11], s15 offen offset:3072 lds
    v_mfma_f32_16x16x32_bf16 a[100:103], v[44:47], v[4:7], a[100:103]
    v_mfma_f32_16x16x32_bf16 a[104:107], v[44:47], v[8:11], a[104:107]
    v_mfma_f32_16x16x32_bf16 a[108:111], v[44:47], v[12:15], a[108:111]
    s_add_u32 s15, s15, s17
    v_mfma_f32_16x16x32_bf16 a[112:115], v[44:47], v[16:19], a[112:115]
    v_mfma_f32_16x16x32_bf16 a[116:119], v[44:47], v[20:23], a[116:119]
    v_mfma_f32_16x16x32_bf16 a[120:123], v[44:47], v[24:27], a[120:123]
    v_mfma_f32_16x16x32_bf16 a[124:127], v[44:47], v[28:31], a[124:127]
    s_waitcnt lgkmcnt(0)
    v_mfma_f32_16x16x32_bf16 a[0:3], v[80:83], v[48:51], a[0:3]
    s_waitcnt vmcnt(12)
    s_barrier
    ds_read_b128 v[32:35], v136 offset:0
    s_add_u32 m0, s20, 24576
    s_nop 0
    v_mfma_f32_16x16x32_bf16 a[4:7], v[80:83], v[52:55], a[4:7]
    ds_read_b64_tr_b16 v[0:1], v128 offset:0
    v_mfma_f32_16x16x32_bf16 a[8:11], v[80:83], v[56:59], a[8:11]
    ds_read_b64_tr_b16 v[2:3], v128 offset:8192
    v_mfma_f32_16x16x32_bf16 a[12:15], v[80:83], v[60:63], a[12:15]
    ds_read_b64_tr_b16 v[4:5], v129 offset:0
    buffer_load_dwordx4 v141, s[4:7], s16 offen offset:0 sc1 lds
    v_mfma_f32_16x16x32_bf16 a[16:19], v[80:83], v[64:67], a[16:19]
    ds_read_b64_tr_b16 v[6:7], v129 offset:8192
    v_mfma_f32_16x16x32_bf16 a[20:23], v[80:83], v[68:71], a[20:23]
    ds_read_b64_tr_b16 v[8:9], v130 offset:0
    v_mfma_f32_16x16x32_bf16 a[24:27], v[80:83], v[72:75], a[24:27]
    ds_read_b64_tr_b16 v[10:11], v130 offset:8192
    buffer_load_dwordx4 v142, s[4:7], s16 offen offset:1024 sc1 lds
    v_mfma_f32_16x16x32_bf16 a[28:31], v[80:83], v[76:79], a[28:31]
    ds_read_b64_tr_b16 v[12:13], v131 offset:0
    v_mfma_f32_16x16x32_bf16 a[32:35], v[84:87], v[48:51], a[32:35]
    ds_read_b64_tr_b16 v[14:15], v131 offset:8192
    v_mfma_f32_16x16x32_bf16 a[36:39], v[84:87], v[52:55], a[36:39]
    ds_read_b64_tr_b16 v[16:17], v132 offset:0
    s_add_u32 s16, s16, 1024
    v_mfma_f32_16x16x32_bf16 a[40:43], v[84:87], v[56:59], a[40:43]
    ds_read_b64_tr_b16 v[18:19], v132 offset:8192
    v_mfma_f32_16x16x32_bf16 a[44:47], v[84:87], v[60:63], a[44:47]
    ds_read_b64_tr_b16 v[20:21], v133 offset:0
    v_mfma_f32_16x16x32_bf16 a[48:51], v[84:87], v[64:67], a[48:51]
    ds_read_b64_tr_b16 v[22:23], v133 offset:8192
    s_add_u32 m0, s19, 49152
    s_nop 0
    v_mfma_f32_16x16x32_bf16 a[52:55], v[84:87], v[68:71], a[52:55]
    ds_read_b64_tr_b16 v[24:25], v134 offset:0
    v_mfma_f32_16x16x32_bf16 a[56:59], v[84:87], v[72:75], a[56:59]
    ds_read_b64_tr_b16 v[26:27], v134 offset:8192
    v_mfma_f32_16x16x32_bf16 a[60:63], v[84:87], v[76:79], a[60:63]
    ds_read_b64_tr_b16 v[28:29], v135 offset:0
    buffer_load_dwordx4 v137, s[8:11], s15 offen offset:0 lds
    v_mfma_f32_16x16x32_bf16 a[64:67], v[88:91], v[48:51], a[64:67]
    ds_read_b64_tr_b16 v[30:31], v135 offset:8192
    v_mfma_f32_16x16x32_bf16 a[68:71], v[88:91], v[52:55], a[68:71]
    ds_read_b128 v[36:39], v136 offset:1024
    v_mfma_f32_16x16x32_bf16 a[72:75], v[88:91], v[56:59], a[72:75]
    ds_read_b128 v[40:43], v136 offset:2048
    buffer_load_dwordx4 v138, s[8:11], s15 offen offset:1024 lds
    v_mfma_f32_16x16x32_bf16 a[76:79], v[88:91], v[60:63], a[76:79]
    ds_read_b128 v[44:47], v136 offset:3072
    v_mfma_f32_16x16x32_bf16 a[80:83], v[88:91], v[64:67], a[80:83]
    v_mfma_f32_16x16x32_bf16 a[84:87], v[88:91], v[68:71], a[84:87]
    buffer_load_dwordx4 v139, s[8:11], s15 offen offset:2048 lds
    v_mfma_f32_16x16x32_bf16 a[88:91], v[88:91], v[72:75], a[88:91]
    v_mfma_f32_16x16x32_bf16 a[92:95], v[88:91], v[76:79], a[92:95]
    v_mfma_f32_16x16x32_bf16 a[96:99], v[92:95], v[48:51], a[96:99]
    buffer_load_dwordx4 v140, s[8:11], s15 offen offset:3072 lds
    v_mfma_f32_16x16x32_bf16 a[100:103], v[92:95], v[52:55], a[100:103]
    v_mfma_f32_16x16x32_bf16 a[104:107], v[92:95], v[56:59], a[104:107]
    v_mfma_f32_16x16x32_bf16 a[108:111], v[92:95], v[60:63], a[108:111]
    s_add_u32 s15, s15, s17
    v_mfma_f32_16x16x32_bf16 a[112:115], v[92:95], v[64:67], a[112:115]
    v_mfma_f32_16x16x32_bf16 a[116:119], v[92:95], v[68:71], a[116:119]
    v_mfma_f32_16x16x32_bf16 a[120:123], v[92:95], v[72:75], a[120:123]
    v_mfma_f32_16x16x32_bf16 a[124:127], v[92:95], v[76:79], a[124:127]
    s_sub_u32 s18, s18, 1
    s_cmp_lg_u32 s18, 0
    s_cbranch_scc1 main_kernel_w_c1_v_loop
    s_cmp_lg_u32 s14, 0
    s_cbranch_scc1 main_kernel_w_c1_v_nt
    s_lshl_b32 s32, s27, 8
    s_add_u32 s32, s32, 0x841e000
    v_mov_b32 v255, 1
    s_mov_b64 exec, 1
    buffer_atomic_add v255, off, s[4:7], s32 sc0 sc1
    s_mov_b64 exec, -1
main_kernel_w_c1_v_nt:
    s_waitcnt lgkmcnt(0)
    v_mfma_f32_16x16x32_bf16 a[0:3], v[32:35], v[0:3], a[0:3]
    s_waitcnt vmcnt(12)
    s_barrier
    ds_read_b128 v[80:83], v136 offset:8192
    v_mfma_f32_16x16x32_bf16 a[4:7], v[32:35], v[4:7], a[4:7]
    ds_read_b64_tr_b16 v[48:49], v128 offset:16384
    v_mfma_f32_16x16x32_bf16 a[8:11], v[32:35], v[8:11], a[8:11]
    ds_read_b64_tr_b16 v[50:51], v128 offset:24576
    v_mfma_f32_16x16x32_bf16 a[12:15], v[32:35], v[12:15], a[12:15]
    ds_read_b64_tr_b16 v[52:53], v129 offset:16384
    v_mfma_f32_16x16x32_bf16 a[16:19], v[32:35], v[16:19], a[16:19]
    ds_read_b64_tr_b16 v[54:55], v129 offset:24576
    v_mfma_f32_16x16x32_bf16 a[20:23], v[32:35], v[20:23], a[20:23]
    ds_read_b64_tr_b16 v[56:57], v130 offset:16384
    v_mfma_f32_16x16x32_bf16 a[24:27], v[32:35], v[24:27], a[24:27]
    ds_read_b64_tr_b16 v[58:59], v130 offset:24576
    v_mfma_f32_16x16x32_bf16 a[28:31], v[32:35], v[28:31], a[28:31]
    ds_read_b64_tr_b16 v[60:61], v131 offset:16384
    v_mfma_f32_16x16x32_bf16 a[32:35], v[36:39], v[0:3], a[32:35]
    ds_read_b64_tr_b16 v[62:63], v131 offset:24576
    v_mfma_f32_16x16x32_bf16 a[36:39], v[36:39], v[4:7], a[36:39]
    ds_read_b64_tr_b16 v[64:65], v132 offset:16384
    v_mfma_f32_16x16x32_bf16 a[40:43], v[36:39], v[8:11], a[40:43]
    ds_read_b64_tr_b16 v[66:67], v132 offset:24576
    v_mfma_f32_16x16x32_bf16 a[44:47], v[36:39], v[12:15], a[44:47]
    ds_read_b64_tr_b16 v[68:69], v133 offset:16384
    v_mfma_f32_16x16x32_bf16 a[48:51], v[36:39], v[16:19], a[48:51]
    ds_read_b64_tr_b16 v[70:71], v133 offset:24576
    v_mfma_f32_16x16x32_bf16 a[52:55], v[36:39], v[20:23], a[52:55]
    ds_read_b64_tr_b16 v[72:73], v134 offset:16384
    v_mfma_f32_16x16x32_bf16 a[56:59], v[36:39], v[24:27], a[56:59]
    ds_read_b64_tr_b16 v[74:75], v134 offset:24576
    v_mfma_f32_16x16x32_bf16 a[60:63], v[36:39], v[28:31], a[60:63]
    ds_read_b64_tr_b16 v[76:77], v135 offset:16384
    v_mfma_f32_16x16x32_bf16 a[64:67], v[40:43], v[0:3], a[64:67]
    ds_read_b64_tr_b16 v[78:79], v135 offset:24576
    v_mfma_f32_16x16x32_bf16 a[68:71], v[40:43], v[4:7], a[68:71]
    ds_read_b128 v[84:87], v136 offset:9216
    v_mfma_f32_16x16x32_bf16 a[72:75], v[40:43], v[8:11], a[72:75]
    ds_read_b128 v[88:91], v136 offset:10240
    v_mfma_f32_16x16x32_bf16 a[76:79], v[40:43], v[12:15], a[76:79]
    ds_read_b128 v[92:95], v136 offset:11264
    v_mfma_f32_16x16x32_bf16 a[80:83], v[40:43], v[16:19], a[80:83]
    v_mfma_f32_16x16x32_bf16 a[84:87], v[40:43], v[20:23], a[84:87]
    v_mfma_f32_16x16x32_bf16 a[88:91], v[40:43], v[24:27], a[88:91]
    v_mfma_f32_16x16x32_bf16 a[92:95], v[40:43], v[28:31], a[92:95]
    v_mfma_f32_16x16x32_bf16 a[96:99], v[44:47], v[0:3], a[96:99]
    v_mfma_f32_16x16x32_bf16 a[100:103], v[44:47], v[4:7], a[100:103]
    v_mfma_f32_16x16x32_bf16 a[104:107], v[44:47], v[8:11], a[104:107]
    v_mfma_f32_16x16x32_bf16 a[108:111], v[44:47], v[12:15], a[108:111]
    v_mfma_f32_16x16x32_bf16 a[112:115], v[44:47], v[16:19], a[112:115]
    v_mfma_f32_16x16x32_bf16 a[116:119], v[44:47], v[20:23], a[116:119]
    v_mfma_f32_16x16x32_bf16 a[120:123], v[44:47], v[24:27], a[120:123]
    v_mfma_f32_16x16x32_bf16 a[124:127], v[44:47], v[28:31], a[124:127]
    s_waitcnt lgkmcnt(0)
    v_mfma_f32_16x16x32_bf16 a[0:3], v[80:83], v[48:51], a[0:3]
    s_waitcnt vmcnt(6)
    s_barrier
    ds_read_b128 v[32:35], v136 offset:16384
    v_mfma_f32_16x16x32_bf16 a[4:7], v[80:83], v[52:55], a[4:7]
    ds_read_b64_tr_b16 v[0:1], v128 offset:32768
    v_mfma_f32_16x16x32_bf16 a[8:11], v[80:83], v[56:59], a[8:11]
    ds_read_b64_tr_b16 v[2:3], v128 offset:40960
    v_mfma_f32_16x16x32_bf16 a[12:15], v[80:83], v[60:63], a[12:15]
    ds_read_b64_tr_b16 v[4:5], v129 offset:32768
    v_mfma_f32_16x16x32_bf16 a[16:19], v[80:83], v[64:67], a[16:19]
    ds_read_b64_tr_b16 v[6:7], v129 offset:40960
    v_mfma_f32_16x16x32_bf16 a[20:23], v[80:83], v[68:71], a[20:23]
    ds_read_b64_tr_b16 v[8:9], v130 offset:32768
    v_mfma_f32_16x16x32_bf16 a[24:27], v[80:83], v[72:75], a[24:27]
    ds_read_b64_tr_b16 v[10:11], v130 offset:40960
    v_mfma_f32_16x16x32_bf16 a[28:31], v[80:83], v[76:79], a[28:31]
    ds_read_b64_tr_b16 v[12:13], v131 offset:32768
    v_mfma_f32_16x16x32_bf16 a[32:35], v[84:87], v[48:51], a[32:35]
    ds_read_b64_tr_b16 v[14:15], v131 offset:40960
    v_mfma_f32_16x16x32_bf16 a[36:39], v[84:87], v[52:55], a[36:39]
    ds_read_b64_tr_b16 v[16:17], v132 offset:32768
    v_mfma_f32_16x16x32_bf16 a[40:43], v[84:87], v[56:59], a[40:43]
    ds_read_b64_tr_b16 v[18:19], v132 offset:40960
    v_mfma_f32_16x16x32_bf16 a[44:47], v[84:87], v[60:63], a[44:47]
    ds_read_b64_tr_b16 v[20:21], v133 offset:32768
    v_mfma_f32_16x16x32_bf16 a[48:51], v[84:87], v[64:67], a[48:51]
    ds_read_b64_tr_b16 v[22:23], v133 offset:40960
    v_mfma_f32_16x16x32_bf16 a[52:55], v[84:87], v[68:71], a[52:55]
    ds_read_b64_tr_b16 v[24:25], v134 offset:32768
    v_mfma_f32_16x16x32_bf16 a[56:59], v[84:87], v[72:75], a[56:59]
    ds_read_b64_tr_b16 v[26:27], v134 offset:40960
    v_mfma_f32_16x16x32_bf16 a[60:63], v[84:87], v[76:79], a[60:63]
    ds_read_b64_tr_b16 v[28:29], v135 offset:32768
    v_mfma_f32_16x16x32_bf16 a[64:67], v[88:91], v[48:51], a[64:67]
    ds_read_b64_tr_b16 v[30:31], v135 offset:40960
    v_mfma_f32_16x16x32_bf16 a[68:71], v[88:91], v[52:55], a[68:71]
    ds_read_b128 v[36:39], v136 offset:17408
    v_mfma_f32_16x16x32_bf16 a[72:75], v[88:91], v[56:59], a[72:75]
    ds_read_b128 v[40:43], v136 offset:18432
    v_mfma_f32_16x16x32_bf16 a[76:79], v[88:91], v[60:63], a[76:79]
    ds_read_b128 v[44:47], v136 offset:19456
    v_mfma_f32_16x16x32_bf16 a[80:83], v[88:91], v[64:67], a[80:83]
    v_mfma_f32_16x16x32_bf16 a[84:87], v[88:91], v[68:71], a[84:87]
    v_mfma_f32_16x16x32_bf16 a[88:91], v[88:91], v[72:75], a[88:91]
    v_mfma_f32_16x16x32_bf16 a[92:95], v[88:91], v[76:79], a[92:95]
    v_mfma_f32_16x16x32_bf16 a[96:99], v[92:95], v[48:51], a[96:99]
    v_mfma_f32_16x16x32_bf16 a[100:103], v[92:95], v[52:55], a[100:103]
    v_mfma_f32_16x16x32_bf16 a[104:107], v[92:95], v[56:59], a[104:107]
    v_mfma_f32_16x16x32_bf16 a[108:111], v[92:95], v[60:63], a[108:111]
    v_mfma_f32_16x16x32_bf16 a[112:115], v[92:95], v[64:67], a[112:115]
    v_mfma_f32_16x16x32_bf16 a[116:119], v[92:95], v[68:71], a[116:119]
    v_mfma_f32_16x16x32_bf16 a[120:123], v[92:95], v[72:75], a[120:123]
    v_mfma_f32_16x16x32_bf16 a[124:127], v[92:95], v[76:79], a[124:127]
    s_waitcnt lgkmcnt(0)
    v_mfma_f32_16x16x32_bf16 a[0:3], v[32:35], v[0:3], a[0:3]
    s_waitcnt vmcnt(0)
    s_barrier
    ds_read_b128 v[80:83], v136 offset:24576
    v_mfma_f32_16x16x32_bf16 a[4:7], v[32:35], v[4:7], a[4:7]
    ds_read_b64_tr_b16 v[48:49], v128 offset:49152
    v_mfma_f32_16x16x32_bf16 a[8:11], v[32:35], v[8:11], a[8:11]
    ds_read_b64_tr_b16 v[50:51], v128 offset:57344
    v_mfma_f32_16x16x32_bf16 a[12:15], v[32:35], v[12:15], a[12:15]
    ds_read_b64_tr_b16 v[52:53], v129 offset:49152
    v_mfma_f32_16x16x32_bf16 a[16:19], v[32:35], v[16:19], a[16:19]
    ds_read_b64_tr_b16 v[54:55], v129 offset:57344
    v_mfma_f32_16x16x32_bf16 a[20:23], v[32:35], v[20:23], a[20:23]
    ds_read_b64_tr_b16 v[56:57], v130 offset:49152
    v_mfma_f32_16x16x32_bf16 a[24:27], v[32:35], v[24:27], a[24:27]
    ds_read_b64_tr_b16 v[58:59], v130 offset:57344
    v_mfma_f32_16x16x32_bf16 a[28:31], v[32:35], v[28:31], a[28:31]
    ds_read_b64_tr_b16 v[60:61], v131 offset:49152
    v_mfma_f32_16x16x32_bf16 a[32:35], v[36:39], v[0:3], a[32:35]
    ds_read_b64_tr_b16 v[62:63], v131 offset:57344
    v_mfma_f32_16x16x32_bf16 a[36:39], v[36:39], v[4:7], a[36:39]
    ds_read_b64_tr_b16 v[64:65], v132 offset:49152
    v_mfma_f32_16x16x32_bf16 a[40:43], v[36:39], v[8:11], a[40:43]
    ds_read_b64_tr_b16 v[66:67], v132 offset:57344
    v_mfma_f32_16x16x32_bf16 a[44:47], v[36:39], v[12:15], a[44:47]
    ds_read_b64_tr_b16 v[68:69], v133 offset:49152
    v_mfma_f32_16x16x32_bf16 a[48:51], v[36:39], v[16:19], a[48:51]
    ds_read_b64_tr_b16 v[70:71], v133 offset:57344
    v_mfma_f32_16x16x32_bf16 a[52:55], v[36:39], v[20:23], a[52:55]
    ds_read_b64_tr_b16 v[72:73], v134 offset:49152
    v_mfma_f32_16x16x32_bf16 a[56:59], v[36:39], v[24:27], a[56:59]
    ds_read_b64_tr_b16 v[74:75], v134 offset:57344
    v_mfma_f32_16x16x32_bf16 a[60:63], v[36:39], v[28:31], a[60:63]
    ds_read_b64_tr_b16 v[76:77], v135 offset:49152
    v_mfma_f32_16x16x32_bf16 a[64:67], v[40:43], v[0:3], a[64:67]
    ds_read_b64_tr_b16 v[78:79], v135 offset:57344
    v_mfma_f32_16x16x32_bf16 a[68:71], v[40:43], v[4:7], a[68:71]
    ds_read_b128 v[84:87], v136 offset:25600
    v_mfma_f32_16x16x32_bf16 a[72:75], v[40:43], v[8:11], a[72:75]
    ds_read_b128 v[88:91], v136 offset:26624
    v_mfma_f32_16x16x32_bf16 a[76:79], v[40:43], v[12:15], a[76:79]
    ds_read_b128 v[92:95], v136 offset:27648
    v_mfma_f32_16x16x32_bf16 a[80:83], v[40:43], v[16:19], a[80:83]
    v_mfma_f32_16x16x32_bf16 a[84:87], v[40:43], v[20:23], a[84:87]
    v_mfma_f32_16x16x32_bf16 a[88:91], v[40:43], v[24:27], a[88:91]
    v_mfma_f32_16x16x32_bf16 a[92:95], v[40:43], v[28:31], a[92:95]
    v_mfma_f32_16x16x32_bf16 a[96:99], v[44:47], v[0:3], a[96:99]
    v_mfma_f32_16x16x32_bf16 a[100:103], v[44:47], v[4:7], a[100:103]
    v_mfma_f32_16x16x32_bf16 a[104:107], v[44:47], v[8:11], a[104:107]
    v_mfma_f32_16x16x32_bf16 a[108:111], v[44:47], v[12:15], a[108:111]
    v_mfma_f32_16x16x32_bf16 a[112:115], v[44:47], v[16:19], a[112:115]
    v_mfma_f32_16x16x32_bf16 a[116:119], v[44:47], v[20:23], a[116:119]
    v_mfma_f32_16x16x32_bf16 a[120:123], v[44:47], v[24:27], a[120:123]
    v_mfma_f32_16x16x32_bf16 a[124:127], v[44:47], v[28:31], a[124:127]
    v_readfirstlane_b32 s55, v255
    s_waitcnt lgkmcnt(0)
    v_mfma_f32_16x16x32_bf16 a[0:3], v[80:83], v[48:51], a[0:3]
    v_mfma_f32_16x16x32_bf16 a[4:7], v[80:83], v[52:55], a[4:7]
    v_mfma_f32_16x16x32_bf16 a[8:11], v[80:83], v[56:59], a[8:11]
    v_mfma_f32_16x16x32_bf16 a[12:15], v[80:83], v[60:63], a[12:15]
    v_mfma_f32_16x16x32_bf16 a[16:19], v[80:83], v[64:67], a[16:19]
    v_mfma_f32_16x16x32_bf16 a[20:23], v[80:83], v[68:71], a[20:23]
    v_mfma_f32_16x16x32_bf16 a[24:27], v[80:83], v[72:75], a[24:27]
    v_mfma_f32_16x16x32_bf16 a[28:31], v[80:83], v[76:79], a[28:31]
    v_mfma_f32_16x16x32_bf16 a[32:35], v[84:87], v[48:51], a[32:35]
    v_mfma_f32_16x16x32_bf16 a[36:39], v[84:87], v[52:55], a[36:39]
    v_mfma_f32_16x16x32_bf16 a[40:43], v[84:87], v[56:59], a[40:43]
    v_mfma_f32_16x16x32_bf16 a[44:47], v[84:87], v[60:63], a[44:47]
    v_mfma_f32_16x16x32_bf16 a[48:51], v[84:87], v[64:67], a[48:51]
    v_mfma_f32_16x16x32_bf16 a[52:55], v[84:87], v[68:71], a[52:55]
    v_mfma_f32_16x16x32_bf16 a[56:59], v[84:87], v[72:75], a[56:59]
    v_mfma_f32_16x16x32_bf16 a[60:63], v[84:87], v[76:79], a[60:63]
    v_mfma_f32_16x16x32_bf16 a[64:67], v[88:91], v[48:51], a[64:67]
    v_mfma_f32_16x16x32_bf16 a[68:71], v[88:91], v[52:55], a[68:71]
    v_mfma_f32_16x16x32_bf16 a[72:75], v[88:91], v[56:59], a[72:75]
    v_mfma_f32_16x16x32_bf16 a[76:79], v[88:91], v[60:63], a[76:79]
    v_mfma_f32_16x16x32_bf16 a[80:83], v[88:91], v[64:67], a[80:83]
    v_mfma_f32_16x16x32_bf16 a[84:87], v[88:91], v[68:71], a[84:87]
    v_mfma_f32_16x16x32_bf16 a[88:91], v[88:91], v[72:75], a[88:91]
    v_mfma_f32_16x16x32_bf16 a[92:95], v[88:91], v[76:79], a[92:95]
    v_mfma_f32_16x16x32_bf16 a[96:99], v[92:95], v[48:51], a[96:99]
    v_mfma_f32_16x16x32_bf16 a[100:103], v[92:95], v[52:55], a[100:103]
    v_mfma_f32_16x16x32_bf16 a[104:107], v[92:95], v[56:59], a[104:107]
    v_mfma_f32_16x16x32_bf16 a[108:111], v[92:95], v[60:63], a[108:111]
    v_mfma_f32_16x16x32_bf16 a[112:115], v[92:95], v[64:67], a[112:115]
    v_mfma_f32_16x16x32_bf16 a[116:119], v[92:95], v[68:71], a[116:119]
    v_mfma_f32_16x16x32_bf16 a[120:123], v[92:95], v[72:75], a[120:123]
    v_mfma_f32_16x16x32_bf16 a[124:127], v[92:95], v[76:79], a[124:127]
    s_nop 7
    s_mov_b32 s53, s21
    v_accvgpr_read_b32 v0, a0
    v_accvgpr_read_b32 v1, a1
    v_accvgpr_read_b32 v2, a2
    v_accvgpr_read_b32 v3, a3
    v_accvgpr_read_b32 v4, a32
    v_accvgpr_read_b32 v5, a33
    v_accvgpr_read_b32 v6, a34
    v_accvgpr_read_b32 v7, a35
    v_cvt_pk_bf16_f32 v8, v0, v1
    v_cvt_pk_bf16_f32 v9, v2, v3
    v_cvt_pk_bf16_f32 v10, v4, v5
    v_cvt_pk_bf16_f32 v11, v6, v7
    buffer_store_dwordx4 v[8:11], v251, s[4:7], s53 offen offset:0 sc1
    v_accvgpr_read_b32 v16, a4
    v_accvgpr_read_b32 v17, a5
    v_accvgpr_read_b32 v18, a6
    v_accvgpr_read_b32 v19, a7
    v_accvgpr_read_b32 v20, a36
    v_accvgpr_read_b32 v21, a37
    v_accvgpr_read_b32 v22, a38
    v_accvgpr_read_b32 v23, a39
    v_cvt_pk_bf16_f32 v24, v16, v17
    v_cvt_pk_bf16_f32 v25, v18, v19
    v_cvt_pk_bf16_f32 v26, v20, v21
    v_cvt_pk_bf16_f32 v27, v22, v23
    buffer_store_dwordx4 v[24:27], v251, s[4:7], s53 offen offset:1024 sc1
    v_accvgpr_read_b32 v32, a8
    v_accvgpr_read_b32 v33, a9
    v_accvgpr_read_b32 v34, a10
    v_accvgpr_read_b32 v35, a11
    v_accvgpr_read_b32 v36, a40
    v_accvgpr_read_b32 v37, a41
    v_accvgpr_read_b32 v38, a42
    v_accvgpr_read_b32 v39, a43
    v_cvt_pk_bf16_f32 v40, v32, v33
    v_cvt_pk_bf16_f32 v41, v34, v35
    v_cvt_pk_bf16_f32 v42, v36, v37
    v_cvt_pk_bf16_f32 v43, v38, v39
    buffer_store_dwordx4 v[40:43], v251, s[4:7], s53 offen offset:2048 sc1
    v_accvgpr_read_b32 v48, a12
    v_accvgpr_read_b32 v49, a13
    v_accvgpr_read_b32 v50, a14
    v_accvgpr_read_b32 v51, a15
    v_accvgpr_read_b32 v52, a44
    v_accvgpr_read_b32 v53, a45
    v_accvgpr_read_b32 v54, a46
    v_accvgpr_read_b32 v55, a47
    v_cvt_pk_bf16_f32 v56, v48, v49
    v_cvt_pk_bf16_f32 v57, v50, v51
    v_cvt_pk_bf16_f32 v58, v52, v53
    v_cvt_pk_bf16_f32 v59, v54, v55
    buffer_store_dwordx4 v[56:59], v251, s[4:7], s53 offen offset:3072 sc1
    s_add_u32 s53, s53, 4096
    v_accvgpr_read_b32 v0, a16
    v_accvgpr_read_b32 v1, a17
    v_accvgpr_read_b32 v2, a18
    v_accvgpr_read_b32 v3, a19
    v_accvgpr_read_b32 v4, a48
    v_accvgpr_read_b32 v5, a49
    v_accvgpr_read_b32 v6, a50
    v_accvgpr_read_b32 v7, a51
    v_cvt_pk_bf16_f32 v8, v0, v1
    v_cvt_pk_bf16_f32 v9, v2, v3
    v_cvt_pk_bf16_f32 v10, v4, v5
    v_cvt_pk_bf16_f32 v11, v6, v7
    buffer_store_dwordx4 v[8:11], v251, s[4:7], s53 offen offset:0 sc1
    v_accvgpr_read_b32 v16, a20
    v_accvgpr_read_b32 v17, a21
    v_accvgpr_read_b32 v18, a22
    v_accvgpr_read_b32 v19, a23
    v_accvgpr_read_b32 v20, a52
    v_accvgpr_read_b32 v21, a53
    v_accvgpr_read_b32 v22, a54
    v_accvgpr_read_b32 v23, a55
    v_cvt_pk_bf16_f32 v24, v16, v17
    v_cvt_pk_bf16_f32 v25, v18, v19
    v_cvt_pk_bf16_f32 v26, v20, v21
    v_cvt_pk_bf16_f32 v27, v22, v23
    buffer_store_dwordx4 v[24:27], v251, s[4:7], s53 offen offset:1024 sc1
    v_accvgpr_read_b32 v32, a24
    v_accvgpr_read_b32 v33, a25
    v_accvgpr_read_b32 v34, a26
    v_accvgpr_read_b32 v35, a27
    v_accvgpr_read_b32 v36, a56
    v_accvgpr_read_b32 v37, a57
    v_accvgpr_read_b32 v38, a58
    v_accvgpr_read_b32 v39, a59
    v_cvt_pk_bf16_f32 v40, v32, v33
    v_cvt_pk_bf16_f32 v41, v34, v35
    v_cvt_pk_bf16_f32 v42, v36, v37
    v_cvt_pk_bf16_f32 v43, v38, v39
    buffer_store_dwordx4 v[40:43], v251, s[4:7], s53 offen offset:2048 sc1
    v_accvgpr_read_b32 v48, a28
    v_accvgpr_read_b32 v49, a29
    v_accvgpr_read_b32 v50, a30
    v_accvgpr_read_b32 v51, a31
    v_accvgpr_read_b32 v52, a60
    v_accvgpr_read_b32 v53, a61
    v_accvgpr_read_b32 v54, a62
    v_accvgpr_read_b32 v55, a63
    v_cvt_pk_bf16_f32 v56, v48, v49
    v_cvt_pk_bf16_f32 v57, v50, v51
    v_cvt_pk_bf16_f32 v58, v52, v53
    v_cvt_pk_bf16_f32 v59, v54, v55
    buffer_store_dwordx4 v[56:59], v251, s[4:7], s53 offen offset:3072 sc1
    s_add_u32 s53, s53, 258048
    v_accvgpr_read_b32 v0, a64
    v_accvgpr_read_b32 v1, a65
    v_accvgpr_read_b32 v2, a66
    v_accvgpr_read_b32 v3, a67
    v_accvgpr_read_b32 v4, a96
    v_accvgpr_read_b32 v5, a97
    v_accvgpr_read_b32 v6, a98
    v_accvgpr_read_b32 v7, a99
    v_cvt_pk_bf16_f32 v8, v0, v1
    v_cvt_pk_bf16_f32 v9, v2, v3
    v_cvt_pk_bf16_f32 v10, v4, v5
    v_cvt_pk_bf16_f32 v11, v6, v7
    buffer_store_dwordx4 v[8:11], v251, s[4:7], s53 offen offset:0 sc1
    v_accvgpr_read_b32 v16, a68
    v_accvgpr_read_b32 v17, a69
    v_accvgpr_read_b32 v18, a70
    v_accvgpr_read_b32 v19, a71
    v_accvgpr_read_b32 v20, a100
    v_accvgpr_read_b32 v21, a101
    v_accvgpr_read_b32 v22, a102
    v_accvgpr_read_b32 v23, a103
    v_cvt_pk_bf16_f32 v24, v16, v17
    v_cvt_pk_bf16_f32 v25, v18, v19
    v_cvt_pk_bf16_f32 v26, v20, v21
    v_cvt_pk_bf16_f32 v27, v22, v23
    buffer_store_dwordx4 v[24:27], v251, s[4:7], s53 offen offset:1024 sc1
    v_accvgpr_read_b32 v32, a72
    v_accvgpr_read_b32 v33, a73
    v_accvgpr_read_b32 v34, a74
    v_accvgpr_read_b32 v35, a75
    v_accvgpr_read_b32 v36, a104
    v_accvgpr_read_b32 v37, a105
    v_accvgpr_read_b32 v38, a106
    v_accvgpr_read_b32 v39, a107
    v_cvt_pk_bf16_f32 v40, v32, v33
    v_cvt_pk_bf16_f32 v41, v34, v35
    v_cvt_pk_bf16_f32 v42, v36, v37
    v_cvt_pk_bf16_f32 v43, v38, v39
    buffer_store_dwordx4 v[40:43], v251, s[4:7], s53 offen offset:2048 sc1
    v_accvgpr_read_b32 v48, a76
    v_accvgpr_read_b32 v49, a77
    v_accvgpr_read_b32 v50, a78
    v_accvgpr_read_b32 v51, a79
    v_accvgpr_read_b32 v52, a108
    v_accvgpr_read_b32 v53, a109
    v_accvgpr_read_b32 v54, a110
    v_accvgpr_read_b32 v55, a111
    v_cvt_pk_bf16_f32 v56, v48, v49
    v_cvt_pk_bf16_f32 v57, v50, v51
    v_cvt_pk_bf16_f32 v58, v52, v53
    v_cvt_pk_bf16_f32 v59, v54, v55
    buffer_store_dwordx4 v[56:59], v251, s[4:7], s53 offen offset:3072 sc1
    s_add_u32 s53, s53, 4096
    v_accvgpr_read_b32 v0, a80
    v_accvgpr_read_b32 v1, a81
    v_accvgpr_read_b32 v2, a82
    v_accvgpr_read_b32 v3, a83
    v_accvgpr_read_b32 v4, a112
    v_accvgpr_read_b32 v5, a113
    v_accvgpr_read_b32 v6, a114
    v_accvgpr_read_b32 v7, a115
    v_cvt_pk_bf16_f32 v8, v0, v1
    v_cvt_pk_bf16_f32 v9, v2, v3
    v_cvt_pk_bf16_f32 v10, v4, v5
    v_cvt_pk_bf16_f32 v11, v6, v7
    buffer_store_dwordx4 v[8:11], v251, s[4:7], s53 offen offset:0 sc1
    v_accvgpr_read_b32 v16, a84
    v_accvgpr_read_b32 v17, a85
    v_accvgpr_read_b32 v18, a86
    v_accvgpr_read_b32 v19, a87
    v_accvgpr_read_b32 v20, a116
    v_accvgpr_read_b32 v21, a117
    v_accvgpr_read_b32 v22, a118
    v_accvgpr_read_b32 v23, a119
    v_cvt_pk_bf16_f32 v24, v16, v17
    v_cvt_pk_bf16_f32 v25, v18, v19
    v_cvt_pk_bf16_f32 v26, v20, v21
    v_cvt_pk_bf16_f32 v27, v22, v23
    buffer_store_dwordx4 v[24:27], v251, s[4:7], s53 offen offset:1024 sc1
    v_accvgpr_read_b32 v32, a88
    v_accvgpr_read_b32 v33, a89
    v_accvgpr_read_b32 v34, a90
    v_accvgpr_read_b32 v35, a91
    v_accvgpr_read_b32 v36, a120
    v_accvgpr_read_b32 v37, a121
    v_accvgpr_read_b32 v38, a122
    v_accvgpr_read_b32 v39, a123
    v_cvt_pk_bf16_f32 v40, v32, v33
    v_cvt_pk_bf16_f32 v41, v34, v35
    v_cvt_pk_bf16_f32 v42, v36, v37
    v_cvt_pk_bf16_f32 v43, v38, v39
    buffer_store_dwordx4 v[40:43], v251, s[4:7], s53 offen offset:2048 sc1
    v_accvgpr_read_b32 v48, a92
    v_accvgpr_read_b32 v49, a93
    v_accvgpr_read_b32 v50, a94
    v_accvgpr_read_b32 v51, a95
    v_accvgpr_read_b32 v52, a124
    v_accvgpr_read_b32 v53, a125
    v_accvgpr_read_b32 v54, a126
    v_accvgpr_read_b32 v55, a127
    v_cvt_pk_bf16_f32 v56, v48, v49
    v_cvt_pk_bf16_f32 v57, v50, v51
    v_cvt_pk_bf16_f32 v58, v52, v53
    v_cvt_pk_bf16_f32 v59, v54, v55
    buffer_store_dwordx4 v[56:59], v251, s[4:7], s53 offen offset:3072 sc1
    s_add_u32 s53, s53, 258048
    s_branch main_kernel_w_done
main_kernel_w_c2_task:
    s_cmp_eq_u32 s23, 0
    s_cbranch_scc1 main_kernel_w_c2_set0
    s_cmp_eq_u32 s23, 1
    s_cbranch_scc1 main_kernel_w_c2_set1
    s_cmp_eq_u32 s23, 2
    s_cbranch_scc1 main_kernel_w_c2_set2
    s_cmp_eq_u32 s23, 6
    s_cbranch_scc1 main_kernel_w_c2_set6
    s_branch main_kernel_w_done
main_kernel_w_c2_set0:
    s_lshl_b32 s32, s25, 8
    s_add_u32 s8, s40, s32
    s_addc_u32 s9, s41, 0
    s_and_b32 s9, s9, 0xffff
    s_sub_u32 s10, 0x800000, s32
    s_mov_b32 s11, 0x20000
    s_mov_b32 s30, 8192
    s_mov_b32 s31, 32768
    s_mul_i32 s16, s24, 262144
    s_add_u32 s16, s16, 0x0
    s_mov_b32 s18, 7
    s_lshl_b32 s32, s24, 3
    s_mul_i32 s33, s38, 8
    s_add_u32 s32, s32, s33
    s_mul_i32 s32, s32, 131072
    s_lshl_b32 s33, s25, 12
    s_add_u32 s32, s32, s33
    s_mul_i32 s33, s37, 4096
    s_add_u32 s32, s32, s33
    s_add_u32 s21, s32, 0x800000
    s_mov_b32 s22, 131072
    s_mov_b32 s26, -1
    s_branch main_kernel_w_c2_go
main_kernel_w_c2_set1:
    s_lshl_b32 s32, s25, 8
    s_add_u32 s8, s42, s32
    s_addc_u32 s9, s43, 0
    s_and_b32 s9, s9, 0xffff
    s_sub_u32 s10, 0x800000, s32
    s_mov_b32 s11, 0x20000
    s_mov_b32 s30, 8192
    s_mov_b32 s31, 32768
    s_mul_i32 s16, s24, 262144
    s_add_u32 s16, s16, 0x0
    s_mov_b32 s18, 7
    s_lshl_b32 s32, s24, 3
    s_mul_i32 s33, s38, 8
    s_add_u32 s32, s32, s33
    s_mul_i32 s32, s32, 131072
    s_lshl_b32 s33, s25, 12
    s_add_u32 s32, s32, s33
    s_mul_i32 s33, s37, 4096
    s_add_u32 s32, s32, s33
    s_add_u32 s21, s32, 0x1800000
    s_mov_b32 s22, 131072
    s_mov_b32 s26, -1
    s_branch main_kernel_w_c2_go
main_kernel_w_c2_set2:
    s_lshl_b32 s32, s25, 8
    s_add_u32 s8, s44, s32
    s_addc_u32 s9, s45, 0
    s_and_b32 s9, s9, 0xffff
    s_sub_u32 s10, 0x800000, s32
    s_mov_b32 s11, 0x20000
    s_mov_b32 s30, 8192
    s_mov_b32 s31, 32768
    s_mul_i32 s16, s24, 262144
    s_add_u32 s16, s16, 0x0
    s_mov_b32 s18, 7
    s_lshl_b32 s32, s24, 2
    s_mul_i32 s33, s38, 4
    s_add_u32 s32, s32, s33
    s_lshl_b32 s32, s32, 18
    s_lshl_b32 s33, s25, 13
    s_add_u32 s32, s32, s33
    s_mul_i32 s33, s37, 8192
    s_add_u32 s32, s32, s33
    s_add_u32 s21, s32, 0x2800000
    s_branch main_kernel_w_c2_gov
main_kernel_w_c2_set6:
    s_lshl_b32 s32, s25, 8
    s_add_u32 s8, s68, s32
    s_addc_u32 s9, s69, 0
    s_and_b32 s9, s9, 0xffff
    s_sub_u32 s10, 0x700000, s32
    s_mov_b32 s11, 0x20000
    s_mov_b32 s30, 7168
    s_mov_b32 s31, 32768
    s_mul_i32 s16, s24, 262144
    s_add_u32 s16, s16, 0x6800000
    s_mov_b32 s18, 7
    s_lshl_b32 s32, s24, 3
    s_mul_i32 s33, s38, 8
    s_add_u32 s32, s32, s33
    s_mul_i32 s32, s32, 114688
    s_lshl_b32 s33, s25, 12
    s_add_u32 s32, s32, s33
    s_mul_i32 s33, s37, 4096
    s_add_u32 s32, s32, s33
    s_add_u32 s21, s32, 0x5400000
    s_mov_b32 s22, 114688
    s_mov_b32 s26, -1
    s_branch main_kernel_w_c2_go
main_kernel_w_c2_go:
    v_lshrrev_b32 v0, 4, v250
    v_bfe_u32 v1, v250, 2, 2
    v_lshl_add_u32 v4, v0, 2, v1
    v_and_b32 v5, 7, v4
    v_mul_u32_u24 v4, 512, v4
    v_and_b32 v6, 3, v250
    v_lshl_add_u32 v4, v6, 3, v4
    s_mul_i32 s32, s37, 8
    v_xor_b32 v5, s32, v5
    v_lshl_add_u32 v128, v5, 5, v4
    v_xor_b32 v129, 32, v128
    v_xor_b32 v130, 64, v128
    v_xor_b32 v131, 96, v128
    v_xor_b32 v132, 128, v128
    v_xor_b32 v133, 160, v128
    v_xor_b32 v134, 192, v128
    v_xor_b32 v135, 224, v128
    s_mul_i32 s32, s38, 8192
    s_add_u32 s32, s32, 65536
    v_add_u32 v136, s32, v251
    v_lshrrev_b32 v2, 5, v250
    v_and_b32 v3, 31, v250
    s_mul_i32 s32, s14, 8
    v_add_u32 v4, s32, v2
    v_add_u32 v5, 0, v4
    v_and_b32 v6, 7, v5
    v_lshlrev_b32 v6, 1, v6
    v_xor_b32 v6, v6, v3
    v_mul_lo_u32 v5, v5, s30
    v_lshl_add_u32 v5, v6, 4, v5
    v_subrev_u32 v137, 0, v5
    v_add_u32 v5, 2, v4
    v_and_b32 v6, 7, v5
    v_lshlrev_b32 v6, 1, v6
    v_xor_b32 v6, v6, v3
    v_mul_lo_u32 v5, v5, s30
    v_lshl_add_u32 v5, v6, 4, v5
    v_subrev_u32 v138, 1024, v5
    v_add_u32 v5, 4, v4
    v_and_b32 v6, 7, v5
    v_lshlrev_b32 v6, 1, v6
    v_xor_b32 v6, v6, v3
    v_mul_lo_u32 v5, v5, s30
    v_lshl_add_u32 v5, v6, 4, v5
    v_subrev_u32 v139, 2048, v5
    v_add_u32 v5, 6, v4
    v_and_b32 v6, 7, v5
    v_lshlrev_b32 v6, 1, v6
    v_xor_b32 v6, v6, v3
    v_mul_lo_u32 v5, v5, s30
    v_lshl_add_u32 v5, v6, 4, v5
    v_subrev_u32 v140, 3072, v5
    s_mul_i32 s32, s14, 4
    s_mul_i32 s32, s32, s31
    v_add_u32 v141, s32, v251
    s_add_u32 s32, s32, s31
    s_sub_u32 s32, s32, 1024
    v_add_u32 v142, s32, v251
    s_add_u32 s32, s32, s31
    s_sub_u32 s32, s32, 1024
    v_add_u32 v143, s32, v251
    s_add_u32 s32, s32, s31
    s_sub_u32 s32, s32, 1024
    v_add_u32 v144, s32, v251
    s_mul_i32 s19, s14, 4096
    s_mul_i32 s20, s14, 4096
    s_add_u32 s20, s20, 65536
    s_mul_i32 s17, s30, 32
    s_mov_b32 s15, 0
    s_add_u32 m0, s20, 0
    s_nop 0
    buffer_load_dwordx4 v141, s[4:7], s16 offen offset:0 sc1 lds
    buffer_load_dwordx4 v142, s[4:7], s16 offen offset:1024 sc1 lds
    buffer_load_dwordx4 v143, s[4:7], s16 offen offset:2048 sc1 lds
    buffer_load_dwordx4 v144, s[4:7], s16 offen offset:3072 sc1 lds
    s_add_u32 s16, s16, 1024
    s_add_u32 m0, s19, 0
    s_nop 0
    buffer_load_dwordx4 v137, s[8:11], s15 offen offset:0 lds
    buffer_load_dwordx4 v138, s[8:11], s15 offen offset:1024 lds
    buffer_load_dwordx4 v139, s[8:11], s15 offen offset:2048 lds
    buffer_load_dwordx4 v140, s[8:11], s15 offen offset:3072 lds
    s_add_u32 s15, s15, s17
    s_add_u32 m0, s20, 16384
    s_nop 0
    buffer_load_dwordx4 v141, s[4:7], s16 offen offset:0 sc1 lds
    buffer_load_dwordx4 v142, s[4:7], s16 offen offset:1024 sc1 lds
    buffer_load_dwordx4 v143, s[4:7], s16 offen offset:2048 sc1 lds
    buffer_load_dwordx4 v144, s[4:7], s16 offen offset:3072 sc1 lds
    s_add_u32 s16, s16, 1024
    s_add_u32 m0, s19, 16384
    s_nop 0
    buffer_load_dwordx4 v137, s[8:11], s15 offen offset:0 lds
    buffer_load_dwordx4 v138, s[8:11], s15 offen offset:1024 lds
    buffer_load_dwordx4 v139, s[8:11], s15 offen offset:2048 lds
    buffer_load_dwordx4 v140, s[8:11], s15 offen offset:3072 lds
    s_add_u32 s15, s15, s17
    s_add_u32 m0, s20, 32768
    s_nop 0
    buffer_load_dwordx4 v141, s[4:7], s16 offen offset:0 sc1 lds
    buffer_load_dwordx4 v142, s[4:7], s16 offen offset:1024 sc1 lds
    buffer_load_dwordx4 v143, s[4:7], s16 offen offset:2048 sc1 lds
    buffer_load_dwordx4 v144, s[4:7], s16 offen offset:3072 sc1 lds
    s_add_u32 s16, s16, 1024
    s_add_u32 m0, s19, 32768
    s_nop 0
    buffer_load_dwordx4 v137, s[8:11], s15 offen offset:0 lds
    buffer_load_dwordx4 v138, s[8:11], s15 offen offset:1024 lds
    buffer_load_dwordx4 v139, s[8:11], s15 offen offset:2048 lds
    buffer_load_dwordx4 v140, s[8:11], s15 offen offset:3072 lds
    s_add_u32 s15, s15, s17
    s_add_u32 m0, s20, 49152
    s_nop 0
    buffer_load_dwordx4 v141, s[4:7], s16 offen offset:0 sc1 lds
    buffer_load_dwordx4 v142, s[4:7], s16 offen offset:1024 sc1 lds
    buffer_load_dwordx4 v143, s[4:7], s16 offen offset:2048 sc1 lds
    buffer_load_dwordx4 v144, s[4:7], s16 offen offset:3072 sc1 lds
    s_add_u32 s16, s16, 1024
    s_add_u32 m0, s19, 49152
    s_nop 0
    buffer_load_dwordx4 v137, s[8:11], s15 offen offset:0 lds
    buffer_load_dwordx4 v138, s[8:11], s15 offen offset:1024 lds
    buffer_load_dwordx4 v139, s[8:11], s15 offen offset:2048 lds
    buffer_load_dwordx4 v140, s[8:11], s15 offen offset:3072 lds
    s_add_u32 s15, s15, s17
    v_accvgpr_write_b32 a0, 0
    v_accvgpr_write_b32 a1, 0
    v_accvgpr_write_b32 a2, 0
    v_accvgpr_write_b32 a3, 0
    v_accvgpr_write_b32 a4, 0
    v_accvgpr_write_b32 a5, 0
    v_accvgpr_write_b32 a6, 0
    v_accvgpr_write_b32 a7, 0
    v_accvgpr_write_b32 a8, 0
    v_accvgpr_write_b32 a9, 0
    v_accvgpr_write_b32 a10, 0
    v_accvgpr_write_b32 a11, 0
    v_accvgpr_write_b32 a12, 0
    v_accvgpr_write_b32 a13, 0
    v_accvgpr_write_b32 a14, 0
    v_accvgpr_write_b32 a15, 0
    v_accvgpr_write_b32 a16, 0
    v_accvgpr_write_b32 a17, 0
    v_accvgpr_write_b32 a18, 0
    v_accvgpr_write_b32 a19, 0
    v_accvgpr_write_b32 a20, 0
    v_accvgpr_write_b32 a21, 0
    v_accvgpr_write_b32 a22, 0
    v_accvgpr_write_b32 a23, 0
    v_accvgpr_write_b32 a24, 0
    v_accvgpr_write_b32 a25, 0
    v_accvgpr_write_b32 a26, 0
    v_accvgpr_write_b32 a27, 0
    v_accvgpr_write_b32 a28, 0
    v_accvgpr_write_b32 a29, 0
    v_accvgpr_write_b32 a30, 0
    v_accvgpr_write_b32 a31, 0
    v_accvgpr_write_b32 a32, 0
    v_accvgpr_write_b32 a33, 0
    v_accvgpr_write_b32 a34, 0
    v_accvgpr_write_b32 a35, 0
    v_accvgpr_write_b32 a36, 0
    v_accvgpr_write_b32 a37, 0
    v_accvgpr_write_b32 a38, 0
    v_accvgpr_write_b32 a39, 0
    v_accvgpr_write_b32 a40, 0
    v_accvgpr_write_b32 a41, 0
    v_accvgpr_write_b32 a42, 0
    v_accvgpr_write_b32 a43, 0
    v_accvgpr_write_b32 a44, 0
    v_accvgpr_write_b32 a45, 0
    v_accvgpr_write_b32 a46, 0
    v_accvgpr_write_b32 a47, 0
    v_accvgpr_write_b32 a48, 0
    v_accvgpr_write_b32 a49, 0
    v_accvgpr_write_b32 a50, 0
    v_accvgpr_write_b32 a51, 0
    v_accvgpr_write_b32 a52, 0
    v_accvgpr_write_b32 a53, 0
    v_accvgpr_write_b32 a54, 0
    v_accvgpr_write_b32 a55, 0
    v_accvgpr_write_b32 a56, 0
    v_accvgpr_write_b32 a57, 0
    v_accvgpr_write_b32 a58, 0
    v_accvgpr_write_b32 a59, 0
    v_accvgpr_write_b32 a60, 0
    v_accvgpr_write_b32 a61, 0
    v_accvgpr_write_b32 a62, 0
    v_accvgpr_write_b32 a63, 0
    v_accvgpr_write_b32 a64, 0
    v_accvgpr_write_b32 a65, 0
    v_accvgpr_write_b32 a66, 0
    v_accvgpr_write_b32 a67, 0
    v_accvgpr_write_b32 a68, 0
    v_accvgpr_write_b32 a69, 0
    v_accvgpr_write_b32 a70, 0
    v_accvgpr_write_b32 a71, 0
    v_accvgpr_write_b32 a72, 0
    v_accvgpr_write_b32 a73, 0
    v_accvgpr_write_b32 a74, 0
    v_accvgpr_write_b32 a75, 0
    v_accvgpr_write_b32 a76, 0
    v_accvgpr_write_b32 a77, 0
    v_accvgpr_write_b32 a78, 0
    v_accvgpr_write_b32 a79, 0
    v_accvgpr_write_b32 a80, 0
    v_accvgpr_write_b32 a81, 0
    v_accvgpr_write_b32 a82, 0
    v_accvgpr_write_b32 a83, 0
    v_accvgpr_write_b32 a84, 0
    v_accvgpr_write_b32 a85, 0
    v_accvgpr_write_b32 a86, 0
    v_accvgpr_write_b32 a87, 0
    v_accvgpr_write_b32 a88, 0
    v_accvgpr_write_b32 a89, 0
    v_accvgpr_write_b32 a90, 0
    v_accvgpr_write_b32 a91, 0
    v_accvgpr_write_b32 a92, 0
    v_accvgpr_write_b32 a93, 0
    v_accvgpr_write_b32 a94, 0
    v_accvgpr_write_b32 a95, 0
    v_accvgpr_write_b32 a96, 0
    v_accvgpr_write_b32 a97, 0
    v_accvgpr_write_b32 a98, 0
    v_accvgpr_write_b32 a99, 0
    v_accvgpr_write_b32 a100, 0
    v_accvgpr_write_b32 a101, 0
    v_accvgpr_write_b32 a102, 0
    v_accvgpr_write_b32 a103, 0
    v_accvgpr_write_b32 a104, 0
    v_accvgpr_write_b32 a105, 0
    v_accvgpr_write_b32 a106, 0
    v_accvgpr_write_b32 a107, 0
    v_accvgpr_write_b32 a108, 0
    v_accvgpr_write_b32 a109, 0
    v_accvgpr_write_b32 a110, 0
    v_accvgpr_write_b32 a111, 0
    v_accvgpr_write_b32 a112, 0
    v_accvgpr_write_b32 a113, 0
    v_accvgpr_write_b32 a114, 0
    v_accvgpr_write_b32 a115, 0
    v_accvgpr_write_b32 a116, 0
    v_accvgpr_write_b32 a117, 0
    v_accvgpr_write_b32 a118, 0
    v_accvgpr_write_b32 a119, 0
    v_accvgpr_write_b32 a120, 0
    v_accvgpr_write_b32 a121, 0
    v_accvgpr_write_b32 a122, 0
    v_accvgpr_write_b32 a123, 0
    v_accvgpr_write_b32 a124, 0
    v_accvgpr_write_b32 a125, 0
    v_accvgpr_write_b32 a126, 0
    v_accvgpr_write_b32 a127, 0
    v_accvgpr_write_b32 a128, 0
    v_accvgpr_write_b32 a129, 0
    v_accvgpr_write_b32 a130, 0
    v_accvgpr_write_b32 a131, 0
    v_accvgpr_write_b32 a132, 0
    v_accvgpr_write_b32 a133, 0
    v_accvgpr_write_b32 a134, 0
    v_accvgpr_write_b32 a135, 0
    v_accvgpr_write_b32 a136, 0
    v_accvgpr_write_b32 a137, 0
    v_accvgpr_write_b32 a138, 0
    v_accvgpr_write_b32 a139, 0
    v_accvgpr_write_b32 a140, 0
    v_accvgpr_write_b32 a141, 0
    v_accvgpr_write_b32 a142, 0
    v_accvgpr_write_b32 a143, 0
    v_accvgpr_write_b32 a144, 0
    v_accvgpr_write_b32 a145, 0
    v_accvgpr_write_b32 a146, 0
    v_accvgpr_write_b32 a147, 0
    v_accvgpr_write_b32 a148, 0
    v_accvgpr_write_b32 a149, 0
    v_accvgpr_write_b32 a150, 0
    v_accvgpr_write_b32 a151, 0
    v_accvgpr_write_b32 a152, 0
    v_accvgpr_write_b32 a153, 0
    v_accvgpr_write_b32 a154, 0
    v_accvgpr_write_b32 a155, 0
    v_accvgpr_write_b32 a156, 0
    v_accvgpr_write_b32 a157, 0
    v_accvgpr_write_b32 a158, 0
    v_accvgpr_write_b32 a159, 0
    v_accvgpr_write_b32 a160, 0
    v_accvgpr_write_b32 a161, 0
    v_accvgpr_write_b32 a162, 0
    v_accvgpr_write_b32 a163, 0
    v_accvgpr_write_b32 a164, 0
    v_accvgpr_write_b32 a165, 0
    v_accvgpr_write_b32 a166, 0
    v_accvgpr_write_b32 a167, 0
    v_accvgpr_write_b32 a168, 0
    v_accvgpr_write_b32 a169, 0
    v_accvgpr_write_b32 a170, 0
    v_accvgpr_write_b32 a171, 0
    v_accvgpr_write_b32 a172, 0
    v_accvgpr_write_b32 a173, 0
    v_accvgpr_write_b32 a174, 0
    v_accvgpr_write_b32 a175, 0
    v_accvgpr_write_b32 a176, 0
    v_accvgpr_write_b32 a177, 0
    v_accvgpr_write_b32 a178, 0
    v_accvgpr_write_b32 a179, 0
    v_accvgpr_write_b32 a180, 0
    v_accvgpr_write_b32 a181, 0
    v_accvgpr_write_b32 a182, 0
    v_accvgpr_write_b32 a183, 0
    v_accvgpr_write_b32 a184, 0
    v_accvgpr_write_b32 a185, 0
    v_accvgpr_write_b32 a186, 0
    v_accvgpr_write_b32 a187, 0
    v_accvgpr_write_b32 a188, 0
    v_accvgpr_write_b32 a189, 0
    v_accvgpr_write_b32 a190, 0
    v_accvgpr_write_b32 a191, 0
    v_accvgpr_write_b32 a192, 0
    v_accvgpr_write_b32 a193, 0
    v_accvgpr_write_b32 a194, 0
    v_accvgpr_write_b32 a195, 0
    v_accvgpr_write_b32 a196, 0
    v_accvgpr_write_b32 a197, 0
    v_accvgpr_write_b32 a198, 0
    v_accvgpr_write_b32 a199, 0
    v_accvgpr_write_b32 a200, 0
    v_accvgpr_write_b32 a201, 0
    v_accvgpr_write_b32 a202, 0
    v_accvgpr_write_b32 a203, 0
    v_accvgpr_write_b32 a204, 0
    v_accvgpr_write_b32 a205, 0
    v_accvgpr_write_b32 a206, 0
    v_accvgpr_write_b32 a207, 0
    v_accvgpr_write_b32 a208, 0
    v_accvgpr_write_b32 a209, 0
    v_accvgpr_write_b32 a210, 0
    v_accvgpr_write_b32 a211, 0
    v_accvgpr_write_b32 a212, 0
    v_accvgpr_write_b32 a213, 0
    v_accvgpr_write_b32 a214, 0
    v_accvgpr_write_b32 a215, 0
    v_accvgpr_write_b32 a216, 0
    v_accvgpr_write_b32 a217, 0
    v_accvgpr_write_b32 a218, 0
    v_accvgpr_write_b32 a219, 0
    v_accvgpr_write_b32 a220, 0
    v_accvgpr_write_b32 a221, 0
    v_accvgpr_write_b32 a222, 0
    v_accvgpr_write_b32 a223, 0
    v_accvgpr_write_b32 a224, 0
    v_accvgpr_write_b32 a225, 0
    v_accvgpr_write_b32 a226, 0
    v_accvgpr_write_b32 a227, 0
    v_accvgpr_write_b32 a228, 0
    v_accvgpr_write_b32 a229, 0
    v_accvgpr_write_b32 a230, 0
    v_accvgpr_write_b32 a231, 0
    v_accvgpr_write_b32 a232, 0
    v_accvgpr_write_b32 a233, 0
    v_accvgpr_write_b32 a234, 0
    v_accvgpr_write_b32 a235, 0
    v_accvgpr_write_b32 a236, 0
    v_accvgpr_write_b32 a237, 0
    v_accvgpr_write_b32 a238, 0
    v_accvgpr_write_b32 a239, 0
    v_accvgpr_write_b32 a240, 0
    v_accvgpr_write_b32 a241, 0
    v_accvgpr_write_b32 a242, 0
    v_accvgpr_write_b32 a243, 0
    v_accvgpr_write_b32 a244, 0
    v_accvgpr_write_b32 a245, 0
    v_accvgpr_write_b32 a246, 0
    v_accvgpr_write_b32 a247, 0
    v_accvgpr_write_b32 a248, 0
    v_accvgpr_write_b32 a249, 0
    v_accvgpr_write_b32 a250, 0
    v_accvgpr_write_b32 a251, 0
    v_accvgpr_write_b32 a252, 0
    v_accvgpr_write_b32 a253, 0
    v_accvgpr_write_b32 a254, 0
    v_accvgpr_write_b32 a255, 0
    s_waitcnt vmcnt(24)
    s_barrier
    ds_read_b128 v[32:35], v136 offset:0
    ds_read_b64_tr_b16 v[0:1], v128 offset:0
    ds_read_b64_tr_b16 v[2:3], v128 offset:8192
    ds_read_b64_tr_b16 v[4:5], v129 offset:0
    ds_read_b64_tr_b16 v[6:7], v129 offset:8192
    ds_read_b64_tr_b16 v[8:9], v130 offset:0
    ds_read_b64_tr_b16 v[10:11], v130 offset:8192
    ds_read_b64_tr_b16 v[12:13], v131 offset:0
    ds_read_b64_tr_b16 v[14:15], v131 offset:8192
    ds_read_b64_tr_b16 v[16:17], v132 offset:0
    ds_read_b64_tr_b16 v[18:19], v132 offset:8192
    ds_read_b64_tr_b16 v[20:21], v133 offset:0
    ds_read_b64_tr_b16 v[22:23], v133 offset:8192
    ds_read_b64_tr_b16 v[24:25], v134 offset:0
    ds_read_b64_tr_b16 v[26:27], v134 offset:8192
    ds_read_b64_tr_b16 v[28:29], v135 offset:0
    ds_read_b64_tr_b16 v[30:31], v135 offset:8192
    ds_read_b128 v[36:39], v136 offset:1024
    ds_read_b128 v[40:43], v136 offset:2048
    ds_read_b128 v[44:47], v136 offset:3072
    ds_read_b128 v[48:51], v136 offset:4096
    ds_read_b128 v[52:55], v136 offset:5120
    ds_read_b128 v[56:59], v136 offset:6144
    ds_read_b128 v[60:63], v136 offset:7168
main_kernel_w_c2_n_loop:
    s_waitcnt lgkmcnt(0)
    v_mfma_f32_16x16x32_bf16 a[0:3], v[0:3], v[32:35], a[0:3]
    s_waitcnt vmcnt(16)
    s_barrier
    ds_read_b128 v[96:99], v136 offset:16384
    s_add_u32 m0, s20, 0
    s_nop 0
    v_mfma_f32_16x16x32_bf16 a[4:7], v[4:7], v[32:35], a[4:7]
    ds_read_b64_tr_b16 v[64:65], v128 offset:16384
    v_mfma_f32_16x16x32_bf16 a[8:11], v[8:11], v[32:35], a[8:11]
    ds_read_b64_tr_b16 v[66:67], v128 offset:24576
    v_mfma_f32_16x16x32_bf16 a[12:15], v[12:15], v[32:35], a[12:15]
    ds_read_b64_tr_b16 v[68:69], v129 offset:16384
    v_mfma_f32_16x16x32_bf16 a[16:19], v[16:19], v[32:35], a[16:19]
    ds_read_b64_tr_b16 v[70:71], v129 offset:24576
    v_mfma_f32_16x16x32_bf16 a[20:23], v[20:23], v[32:35], a[20:23]
    ds_read_b64_tr_b16 v[72:73], v130 offset:16384
    buffer_load_dwordx4 v141, s[4:7], s16 offen offset:0 sc1 lds
    v_mfma_f32_16x16x32_bf16 a[24:27], v[24:27], v[32:35], a[24:27]
    ds_read_b64_tr_b16 v[74:75], v130 offset:24576
    v_mfma_f32_16x16x32_bf16 a[28:31], v[28:31], v[32:35], a[28:31]
    ds_read_b64_tr_b16 v[76:77], v131 offset:16384
    v_mfma_f32_16x16x32_bf16 a[32:35], v[0:3], v[36:39], a[32:35]
    ds_read_b64_tr_b16 v[78:79], v131 offset:24576
    v_mfma_f32_16x16x32_bf16 a[36:39], v[4:7], v[36:39], a[36:39]
    ds_read_b64_tr_b16 v[80:81], v132 offset:16384
    v_mfma_f32_16x16x32_bf16 a[40:43], v[8:11], v[36:39], a[40:43]
    ds_read_b64_tr_b16 v[82:83], v132 offset:24576
    buffer_load_dwordx4 v142, s[4:7], s16 offen offset:1024 sc1 lds
    v_mfma_f32_16x16x32_bf16 a[44:47], v[12:15], v[36:39], a[44:47]
    ds_read_b64_tr_b16 v[84:85], v133 offset:16384
    v_mfma_f32_16x16x32_bf16 a[48:51], v[16:19], v[36:39], a[48:51]
    ds_read_b64_tr_b16 v[86:87], v133 offset:24576
    v_mfma_f32_16x16x32_bf16 a[52:55], v[20:23], v[36:39], a[52:55]
    ds_read_b64_tr_b16 v[88:89], v134 offset:16384
    v_mfma_f32_16x16x32_bf16 a[56:59], v[24:27], v[36:39], a[56:59]
    ds_read_b64_tr_b16 v[90:91], v134 offset:24576
    v_mfma_f32_16x16x32_bf16 a[60:63], v[28:31], v[36:39], a[60:63]
    ds_read_b64_tr_b16 v[92:93], v135 offset:16384
    buffer_load_dwordx4 v143, s[4:7], s16 offen offset:2048 sc1 lds
    v_mfma_f32_16x16x32_bf16 a[64:67], v[0:3], v[40:43], a[64:67]
    ds_read_b64_tr_b16 v[94:95], v135 offset:24576
    v_mfma_f32_16x16x32_bf16 a[68:71], v[4:7], v[40:43], a[68:71]
    ds_read_b128 v[100:103], v136 offset:17408
    v_mfma_f32_16x16x32_bf16 a[72:75], v[8:11], v[40:43], a[72:75]
    ds_read_b128 v[104:107], v136 offset:18432
    v_mfma_f32_16x16x32_bf16 a[76:79], v[12:15], v[40:43], a[76:79]
    ds_read_b128 v[108:111], v136 offset:19456
    v_mfma_f32_16x16x32_bf16 a[80:83], v[16:19], v[40:43], a[80:83]
    ds_read_b128 v[112:115], v136 offset:20480
    v_mfma_f32_16x16x32_bf16 a[84:87], v[20:23], v[40:43], a[84:87]
    ds_read_b128 v[116:119], v136 offset:21504
    buffer_load_dwordx4 v144, s[4:7], s16 offen offset:3072 sc1 lds
    v_mfma_f32_16x16x32_bf16 a[88:91], v[24:27], v[40:43], a[88:91]
    ds_read_b128 v[120:123], v136 offset:22528
    v_mfma_f32_16x16x32_bf16 a[92:95], v[28:31], v[40:43], a[92:95]
    ds_read_b128 v[124:127], v136 offset:23552
    v_mfma_f32_16x16x32_bf16 a[96:99], v[0:3], v[44:47], a[96:99]
    v_mfma_f32_16x16x32_bf16 a[100:103], v[4:7], v[44:47], a[100:103]
    v_mfma_f32_16x16x32_bf16 a[104:107], v[8:11], v[44:47], a[104:107]
    s_add_u32 s16, s16, 1024
    v_mfma_f32_16x16x32_bf16 a[108:111], v[12:15], v[44:47], a[108:111]
    v_mfma_f32_16x16x32_bf16 a[112:115], v[16:19], v[44:47], a[112:115]
    v_mfma_f32_16x16x32_bf16 a[116:119], v[20:23], v[44:47], a[116:119]
    v_mfma_f32_16x16x32_bf16 a[120:123], v[24:27], v[44:47], a[120:123]
    v_mfma_f32_16x16x32_bf16 a[124:127], v[28:31], v[44:47], a[124:127]
    s_add_u32 m0, s19, 0
    s_nop 0
    v_mfma_f32_16x16x32_bf16 a[128:131], v[0:3], v[48:51], a[128:131]
    v_mfma_f32_16x16x32_bf16 a[132:135], v[4:7], v[48:51], a[132:135]
    v_mfma_f32_16x16x32_bf16 a[136:139], v[8:11], v[48:51], a[136:139]
    v_mfma_f32_16x16x32_bf16 a[140:143], v[12:15], v[48:51], a[140:143]
    v_mfma_f32_16x16x32_bf16 a[144:147], v[16:19], v[48:51], a[144:147]
    buffer_load_dwordx4 v137, s[8:11], s15 offen offset:0 lds
    v_mfma_f32_16x16x32_bf16 a[148:151], v[20:23], v[48:51], a[148:151]
    v_mfma_f32_16x16x32_bf16 a[152:155], v[24:27], v[48:51], a[152:155]
    v_mfma_f32_16x16x32_bf16 a[156:159], v[28:31], v[48:51], a[156:159]
    v_mfma_f32_16x16x32_bf16 a[160:163], v[0:3], v[52:55], a[160:163]
    v_mfma_f32_16x16x32_bf16 a[164:167], v[4:7], v[52:55], a[164:167]
    v_mfma_f32_16x16x32_bf16 a[168:171], v[8:11], v[52:55], a[168:171]
    buffer_load_dwordx4 v138, s[8:11], s15 offen offset:1024 lds
    v_mfma_f32_16x16x32_bf16 a[172:175], v[12:15], v[52:55], a[172:175]
    v_mfma_f32_16x16x32_bf16 a[176:179], v[16:19], v[52:55], a[176:179]
    v_mfma_f32_16x16x32_bf16 a[180:183], v[20:23], v[52:55], a[180:183]
    v_mfma_f32_16x16x32_bf16 a[184:187], v[24:27], v[52:55], a[184:187]
    v_mfma_f32_16x16x32_bf16 a[188:191], v[28:31], v[52:55], a[188:191]
    buffer_load_dwordx4 v139, s[8:11], s15 offen offset:2048 lds
    v_mfma_f32_16x16x32_bf16 a[192:195], v[0:3], v[56:59], a[192:195]
    v_mfma_f32_16x16x32_bf16 a[196:199], v[4:7], v[56:59], a[196:199]
    v_mfma_f32_16x16x32_bf16 a[200:203], v[8:11], v[56:59], a[200:203]
    v_mfma_f32_16x16x32_bf16 a[204:207], v[12:15], v[56:59], a[204:207]
    v_mfma_f32_16x16x32_bf16 a[208:211], v[16:19], v[56:59], a[208:211]
    buffer_load_dwordx4 v140, s[8:11], s15 offen offset:3072 lds
    v_mfma_f32_16x16x32_bf16 a[212:215], v[20:23], v[56:59], a[212:215]
    v_mfma_f32_16x16x32_bf16 a[216:219], v[24:27], v[56:59], a[216:219]
    v_mfma_f32_16x16x32_bf16 a[220:223], v[28:31], v[56:59], a[220:223]
    v_mfma_f32_16x16x32_bf16 a[224:227], v[0:3], v[60:63], a[224:227]
    v_mfma_f32_16x16x32_bf16 a[228:231], v[4:7], v[60:63], a[228:231]
    s_add_u32 s15, s15, s17
    v_mfma_f32_16x16x32_bf16 a[232:235], v[8:11], v[60:63], a[232:235]
    v_mfma_f32_16x16x32_bf16 a[236:239], v[12:15], v[60:63], a[236:239]
    v_mfma_f32_16x16x32_bf16 a[240:243], v[16:19], v[60:63], a[240:243]
    v_mfma_f32_16x16x32_bf16 a[244:247], v[20:23], v[60:63], a[244:247]
    v_mfma_f32_16x16x32_bf16 a[248:251], v[24:27], v[60:63], a[248:251]
    v_mfma_f32_16x16x32_bf16 a[252:255], v[28:31], v[60:63], a[252:255]
    s_waitcnt lgkmcnt(0)
    v_mfma_f32_16x16x32_bf16 a[0:3], v[64:67], v[96:99], a[0:3]
    s_waitcnt vmcnt(16)
    s_barrier
    ds_read_b128 v[32:35], v136 offset:32768
    s_add_u32 m0, s20, 16384
    s_nop 0
    v_mfma_f32_16x16x32_bf16 a[4:7], v[68:71], v[96:99], a[4:7]
    ds_read_b64_tr_b16 v[0:1], v128 offset:32768
    v_mfma_f32_16x16x32_bf16 a[8:11], v[72:75], v[96:99], a[8:11]
    ds_read_b64_tr_b16 v[2:3], v128 offset:40960
    v_mfma_f32_16x16x32_bf16 a[12:15], v[76:79], v[96:99], a[12:15]
    ds_read_b64_tr_b16 v[4:5], v129 offset:32768
    v_mfma_f32_16x16x32_bf16 a[16:19], v[80:83], v[96:99], a[16:19]
    ds_read_b64_tr_b16 v[6:7], v129 offset:40960
    v_mfma_f32_16x16x32_bf16 a[20:23], v[84:87], v[96:99], a[20:23]
    ds_read_b64_tr_b16 v[8:9], v130 offset:32768
    buffer_load_dwordx4 v141, s[4:7], s16 offen offset:0 sc1 lds
    v_mfma_f32_16x16x32_bf16 a[24:27], v[88:91], v[96:99], a[24:27]
    ds_read_b64_tr_b16 v[10:11], v130 offset:40960
    v_mfma_f32_16x16x32_bf16 a[28:31], v[92:95], v[96:99], a[28:31]
    ds_read_b64_tr_b16 v[12:13], v131 offset:32768
    v_mfma_f32_16x16x32_bf16 a[32:35], v[64:67], v[100:103], a[32:35]
    ds_read_b64_tr_b16 v[14:15], v131 offset:40960
    v_mfma_f32_16x16x32_bf16 a[36:39], v[68:71], v[100:103], a[36:39]
    ds_read_b64_tr_b16 v[16:17], v132 offset:32768
    v_mfma_f32_16x16x32_bf16 a[40:43], v[72:75], v[100:103], a[40:43]
    ds_read_b64_tr_b16 v[18:19], v132 offset:40960
    buffer_load_dwordx4 v142, s[4:7], s16 offen offset:1024 sc1 lds
    v_mfma_f32_16x16x32_bf16 a[44:47], v[76:79], v[100:103], a[44:47]
    ds_read_b64_tr_b16 v[20:21], v133 offset:32768
    v_mfma_f32_16x16x32_bf16 a[48:51], v[80:83], v[100:103], a[48:51]
    ds_read_b64_tr_b16 v[22:23], v133 offset:40960
    v_mfma_f32_16x16x32_bf16 a[52:55], v[84:87], v[100:103], a[52:55]
    ds_read_b64_tr_b16 v[24:25], v134 offset:32768
    v_mfma_f32_16x16x32_bf16 a[56:59], v[88:91], v[100:103], a[56:59]
    ds_read_b64_tr_b16 v[26:27], v134 offset:40960
    v_mfma_f32_16x16x32_bf16 a[60:63], v[92:95], v[100:103], a[60:63]
    ds_read_b64_tr_b16 v[28:29], v135 offset:32768
    buffer_load_dwordx4 v143, s[4:7], s16 offen offset:2048 sc1 lds
    v_mfma_f32_16x16x32_bf16 a[64:67], v[64:67], v[104:107], a[64:67]
    ds_read_b64_tr_b16 v[30:31], v135 offset:40960
    v_mfma_f32_16x16x32_bf16 a[68:71], v[68:71], v[104:107], a[68:71]
    ds_read_b128 v[36:39], v136 offset:33792
    v_mfma_f32_16x16x32_bf16 a[72:75], v[72:75], v[104:107], a[72:75]
    ds_read_b128 v[40:43], v136 offset:34816
    v_mfma_f32_16x16x32_bf16 a[76:79], v[76:79], v[104:107], a[76:79]
    ds_read_b128 v[44:47], v136 offset:35840
    v_mfma_f32_16x16x32_bf16 a[80:83], v[80:83], v[104:107], a[80:83]
    ds_read_b128 v[48:51], v136 offset:36864
    v_mfma_f32_16x16x32_bf16 a[84:87], v[84:87], v[104:107], a[84:87]
    ds_read_b128 v[52:55], v136 offset:37888
    buffer_load_dwordx4 v144, s[4:7], s16 offen offset:3072 sc1 lds
    v_mfma_f32_16x16x32_bf16 a[88:91], v[88:91], v[104:107], a[88:91]
    ds_read_b128 v[56:59], v136 offset:38912
    v_mfma_f32_16x16x32_bf16 a[92:95], v[92:95], v[104:107], a[92:95]
    ds_read_b128 v[60:63], v136 offset:39936
    v_mfma_f32_16x16x32_bf16 a[96:99], v[64:67], v[108:111], a[96:99]
    v_mfma_f32_16x16x32_bf16 a[100:103], v[68:71], v[108:111], a[100:103]
    v_mfma_f32_16x16x32_bf16 a[104:107], v[72:75], v[108:111], a[104:107]
    s_add_u32 s16, s16, 1024
    v_mfma_f32_16x16x32_bf16 a[108:111], v[76:79], v[108:111], a[108:111]
    v_mfma_f32_16x16x32_bf16 a[112:115], v[80:83], v[108:111], a[112:115]
    v_mfma_f32_16x16x32_bf16 a[116:119], v[84:87], v[108:111], a[116:119]
    v_mfma_f32_16x16x32_bf16 a[120:123], v[88:91], v[108:111], a[120:123]
    v_mfma_f32_16x16x32_bf16 a[124:127], v[92:95], v[108:111], a[124:127]
    s_add_u32 m0, s19, 16384
    s_nop 0
    v_mfma_f32_16x16x32_bf16 a[128:131], v[64:67], v[112:115], a[128:131]
    v_mfma_f32_16x16x32_bf16 a[132:135], v[68:71], v[112:115], a[132:135]
    v_mfma_f32_16x16x32_bf16 a[136:139], v[72:75], v[112:115], a[136:139]
    v_mfma_f32_16x16x32_bf16 a[140:143], v[76:79], v[112:115], a[140:143]
    v_mfma_f32_16x16x32_bf16 a[144:147], v[80:83], v[112:115], a[144:147]
    buffer_load_dwordx4 v137, s[8:11], s15 offen offset:0 lds
    v_mfma_f32_16x16x32_bf16 a[148:151], v[84:87], v[112:115], a[148:151]
    v_mfma_f32_16x16x32_bf16 a[152:155], v[88:91], v[112:115], a[152:155]
    v_mfma_f32_16x16x32_bf16 a[156:159], v[92:95], v[112:115], a[156:159]
    v_mfma_f32_16x16x32_bf16 a[160:163], v[64:67], v[116:119], a[160:163]
    v_mfma_f32_16x16x32_bf16 a[164:167], v[68:71], v[116:119], a[164:167]
    v_mfma_f32_16x16x32_bf16 a[168:171], v[72:75], v[116:119], a[168:171]
    buffer_load_dwordx4 v138, s[8:11], s15 offen offset:1024 lds
    v_mfma_f32_16x16x32_bf16 a[172:175], v[76:79], v[116:119], a[172:175]
    v_mfma_f32_16x16x32_bf16 a[176:179], v[80:83], v[116:119], a[176:179]
    v_mfma_f32_16x16x32_bf16 a[180:183], v[84:87], v[116:119], a[180:183]
    v_mfma_f32_16x16x32_bf16 a[184:187], v[88:91], v[116:119], a[184:187]
    v_mfma_f32_16x16x32_bf16 a[188:191], v[92:95], v[116:119], a[188:191]
    buffer_load_dwordx4 v139, s[8:11], s15 offen offset:2048 lds
    v_mfma_f32_16x16x32_bf16 a[192:195], v[64:67], v[120:123], a[192:195]
    v_mfma_f32_16x16x32_bf16 a[196:199], v[68:71], v[120:123], a[196:199]
    v_mfma_f32_16x16x32_bf16 a[200:203], v[72:75], v[120:123], a[200:203]
    v_mfma_f32_16x16x32_bf16 a[204:207], v[76:79], v[120:123], a[204:207]
    v_mfma_f32_16x16x32_bf16 a[208:211], v[80:83], v[120:123], a[208:211]
    buffer_load_dwordx4 v140, s[8:11], s15 offen offset:3072 lds
    v_mfma_f32_16x16x32_bf16 a[212:215], v[84:87], v[120:123], a[212:215]
    v_mfma_f32_16x16x32_bf16 a[216:219], v[88:91], v[120:123], a[216:219]
    v_mfma_f32_16x16x32_bf16 a[220:223], v[92:95], v[120:123], a[220:223]
    v_mfma_f32_16x16x32_bf16 a[224:227], v[64:67], v[124:127], a[224:227]
    v_mfma_f32_16x16x32_bf16 a[228:231], v[68:71], v[124:127], a[228:231]
    s_add_u32 s15, s15, s17
    v_mfma_f32_16x16x32_bf16 a[232:235], v[72:75], v[124:127], a[232:235]
    v_mfma_f32_16x16x32_bf16 a[236:239], v[76:79], v[124:127], a[236:239]
    v_mfma_f32_16x16x32_bf16 a[240:243], v[80:83], v[124:127], a[240:243]
    v_mfma_f32_16x16x32_bf16 a[244:247], v[84:87], v[124:127], a[244:247]
    v_mfma_f32_16x16x32_bf16 a[248:251], v[88:91], v[124:127], a[248:251]
    v_mfma_f32_16x16x32_bf16 a[252:255], v[92:95], v[124:127], a[252:255]
    s_waitcnt lgkmcnt(0)
    v_mfma_f32_16x16x32_bf16 a[0:3], v[0:3], v[32:35], a[0:3]
    s_waitcnt vmcnt(16)
    s_barrier
    ds_read_b128 v[96:99], v136 offset:49152
    s_add_u32 m0, s20, 32768
    s_nop 0
    v_mfma_f32_16x16x32_bf16 a[4:7], v[4:7], v[32:35], a[4:7]
    ds_read_b64_tr_b16 v[64:65], v128 offset:49152
    v_mfma_f32_16x16x32_bf16 a[8:11], v[8:11], v[32:35], a[8:11]
    ds_read_b64_tr_b16 v[66:67], v128 offset:57344
    v_mfma_f32_16x16x32_bf16 a[12:15], v[12:15], v[32:35], a[12:15]
    ds_read_b64_tr_b16 v[68:69], v129 offset:49152
    v_mfma_f32_16x16x32_bf16 a[16:19], v[16:19], v[32:35], a[16:19]
    ds_read_b64_tr_b16 v[70:71], v129 offset:57344
    v_mfma_f32_16x16x32_bf16 a[20:23], v[20:23], v[32:35], a[20:23]
    ds_read_b64_tr_b16 v[72:73], v130 offset:49152
    buffer_load_dwordx4 v141, s[4:7], s16 offen offset:0 sc1 lds
    v_mfma_f32_16x16x32_bf16 a[24:27], v[24:27], v[32:35], a[24:27]
    ds_read_b64_tr_b16 v[74:75], v130 offset:57344
    v_mfma_f32_16x16x32_bf16 a[28:31], v[28:31], v[32:35], a[28:31]
    ds_read_b64_tr_b16 v[76:77], v131 offset:49152
    v_mfma_f32_16x16x32_bf16 a[32:35], v[0:3], v[36:39], a[32:35]
    ds_read_b64_tr_b16 v[78:79], v131 offset:57344
    v_mfma_f32_16x16x32_bf16 a[36:39], v[4:7], v[36:39], a[36:39]
    ds_read_b64_tr_b16 v[80:81], v132 offset:49152
    v_mfma_f32_16x16x32_bf16 a[40:43], v[8:11], v[36:39], a[40:43]
    ds_read_b64_tr_b16 v[82:83], v132 offset:57344
    buffer_load_dwordx4 v142, s[4:7], s16 offen offset:1024 sc1 lds
    v_mfma_f32_16x16x32_bf16 a[44:47], v[12:15], v[36:39], a[44:47]
    ds_read_b64_tr_b16 v[84:85], v133 offset:49152
    v_mfma_f32_16x16x32_bf16 a[48:51], v[16:19], v[36:39], a[48:51]
    ds_read_b64_tr_b16 v[86:87], v133 offset:57344
    v_mfma_f32_16x16x32_bf16 a[52:55], v[20:23], v[36:39], a[52:55]
    ds_read_b64_tr_b16 v[88:89], v134 offset:49152
    v_mfma_f32_16x16x32_bf16 a[56:59], v[24:27], v[36:39], a[56:59]
    ds_read_b64_tr_b16 v[90:91], v134 offset:57344
    v_mfma_f32_16x16x32_bf16 a[60:63], v[28:31], v[36:39], a[60:63]
    ds_read_b64_tr_b16 v[92:93], v135 offset:49152
    buffer_load_dwordx4 v143, s[4:7], s16 offen offset:2048 sc1 lds
    v_mfma_f32_16x16x32_bf16 a[64:67], v[0:3], v[40:43], a[64:67]
    ds_read_b64_tr_b16 v[94:95], v135 offset:57344
    v_mfma_f32_16x16x32_bf16 a[68:71], v[4:7], v[40:43], a[68:71]
    ds_read_b128 v[100:103], v136 offset:50176
    v_mfma_f32_16x16x32_bf16 a[72:75], v[8:11], v[40:43], a[72:75]
    ds_read_b128 v[104:107], v136 offset:51200
    v_mfma_f32_16x16x32_bf16 a[76:79], v[12:15], v[40:43], a[76:79]
    ds_read_b128 v[108:111], v136 offset:52224
    v_mfma_f32_16x16x32_bf16 a[80:83], v[16:19], v[40:43], a[80:83]
    ds_read_b128 v[112:115], v136 offset:53248
    v_mfma_f32_16x16x32_bf16 a[84:87], v[20:23], v[40:43], a[84:87]
    ds_read_b128 v[116:119], v136 offset:54272
    buffer_load_dwordx4 v144, s[4:7], s16 offen offset:3072 sc1 lds
    v_mfma_f32_16x16x32_bf16 a[88:91], v[24:27], v[40:43], a[88:91]
    ds_read_b128 v[120:123], v136 offset:55296
    v_mfma_f32_16x16x32_bf16 a[92:95], v[28:31], v[40:43], a[92:95]
    ds_read_b128 v[124:127], v136 offset:56320
    v_mfma_f32_16x16x32_bf16 a[96:99], v[0:3], v[44:47], a[96:99]
    v_mfma_f32_16x16x32_bf16 a[100:103], v[4:7], v[44:47], a[100:103]
    v_mfma_f32_16x16x32_bf16 a[104:107], v[8:11], v[44:47], a[104:107]
    s_add_u32 s16, s16, 1024
    v_mfma_f32_16x16x32_bf16 a[108:111], v[12:15], v[44:47], a[108:111]
    v_mfma_f32_16x16x32_bf16 a[112:115], v[16:19], v[44:47], a[112:115]
    v_mfma_f32_16x16x32_bf16 a[116:119], v[20:23], v[44:47], a[116:119]
    v_mfma_f32_16x16x32_bf16 a[120:123], v[24:27], v[44:47], a[120:123]
    v_mfma_f32_16x16x32_bf16 a[124:127], v[28:31], v[44:47], a[124:127]
    s_add_u32 m0, s19, 32768
    s_nop 0
    v_mfma_f32_16x16x32_bf16 a[128:131], v[0:3], v[48:51], a[128:131]
    v_mfma_f32_16x16x32_bf16 a[132:135], v[4:7], v[48:51], a[132:135]
    v_mfma_f32_16x16x32_bf16 a[136:139], v[8:11], v[48:51], a[136:139]
    v_mfma_f32_16x16x32_bf16 a[140:143], v[12:15], v[48:51], a[140:143]
    v_mfma_f32_16x16x32_bf16 a[144:147], v[16:19], v[48:51], a[144:147]
    buffer_load_dwordx4 v137, s[8:11], s15 offen offset:0 lds
    v_mfma_f32_16x16x32_bf16 a[148:151], v[20:23], v[48:51], a[148:151]
    v_mfma_f32_16x16x32_bf16 a[152:155], v[24:27], v[48:51], a[152:155]
    v_mfma_f32_16x16x32_bf16 a[156:159], v[28:31], v[48:51], a[156:159]
    v_mfma_f32_16x16x32_bf16 a[160:163], v[0:3], v[52:55], a[160:163]
    v_mfma_f32_16x16x32_bf16 a[164:167], v[4:7], v[52:55], a[164:167]
    v_mfma_f32_16x16x32_bf16 a[168:171], v[8:11], v[52:55], a[168:171]
    buffer_load_dwordx4 v138, s[8:11], s15 offen offset:1024 lds
    v_mfma_f32_16x16x32_bf16 a[172:175], v[12:15], v[52:55], a[172:175]
    v_mfma_f32_16x16x32_bf16 a[176:179], v[16:19], v[52:55], a[176:179]
    v_mfma_f32_16x16x32_bf16 a[180:183], v[20:23], v[52:55], a[180:183]
    v_mfma_f32_16x16x32_bf16 a[184:187], v[24:27], v[52:55], a[184:187]
    v_mfma_f32_16x16x32_bf16 a[188:191], v[28:31], v[52:55], a[188:191]
    buffer_load_dwordx4 v139, s[8:11], s15 offen offset:2048 lds
    v_mfma_f32_16x16x32_bf16 a[192:195], v[0:3], v[56:59], a[192:195]
    v_mfma_f32_16x16x32_bf16 a[196:199], v[4:7], v[56:59], a[196:199]
    v_mfma_f32_16x16x32_bf16 a[200:203], v[8:11], v[56:59], a[200:203]
    v_mfma_f32_16x16x32_bf16 a[204:207], v[12:15], v[56:59], a[204:207]
    v_mfma_f32_16x16x32_bf16 a[208:211], v[16:19], v[56:59], a[208:211]
    buffer_load_dwordx4 v140, s[8:11], s15 offen offset:3072 lds
    v_mfma_f32_16x16x32_bf16 a[212:215], v[20:23], v[56:59], a[212:215]
    v_mfma_f32_16x16x32_bf16 a[216:219], v[24:27], v[56:59], a[216:219]
    v_mfma_f32_16x16x32_bf16 a[220:223], v[28:31], v[56:59], a[220:223]
    v_mfma_f32_16x16x32_bf16 a[224:227], v[0:3], v[60:63], a[224:227]
    v_mfma_f32_16x16x32_bf16 a[228:231], v[4:7], v[60:63], a[228:231]
    s_add_u32 s15, s15, s17
    v_mfma_f32_16x16x32_bf16 a[232:235], v[8:11], v[60:63], a[232:235]
    v_mfma_f32_16x16x32_bf16 a[236:239], v[12:15], v[60:63], a[236:239]
    v_mfma_f32_16x16x32_bf16 a[240:243], v[16:19], v[60:63], a[240:243]
    v_mfma_f32_16x16x32_bf16 a[244:247], v[20:23], v[60:63], a[244:247]
    v_mfma_f32_16x16x32_bf16 a[248:251], v[24:27], v[60:63], a[248:251]
    v_mfma_f32_16x16x32_bf16 a[252:255], v[28:31], v[60:63], a[252:255]
    s_waitcnt lgkmcnt(0)
    v_mfma_f32_16x16x32_bf16 a[0:3], v[64:67], v[96:99], a[0:3]
    s_waitcnt vmcnt(16)
    s_barrier
    ds_read_b128 v[32:35], v136 offset:0
    s_add_u32 m0, s20, 49152
    s_nop 0
    v_mfma_f32_16x16x32_bf16 a[4:7], v[68:71], v[96:99], a[4:7]
    ds_read_b64_tr_b16 v[0:1], v128 offset:0
    v_mfma_f32_16x16x32_bf16 a[8:11], v[72:75], v[96:99], a[8:11]
    ds_read_b64_tr_b16 v[2:3], v128 offset:8192
    v_mfma_f32_16x16x32_bf16 a[12:15], v[76:79], v[96:99], a[12:15]
    ds_read_b64_tr_b16 v[4:5], v129 offset:0
    v_mfma_f32_16x16x32_bf16 a[16:19], v[80:83], v[96:99], a[16:19]
    ds_read_b64_tr_b16 v[6:7], v129 offset:8192
    v_mfma_f32_16x16x32_bf16 a[20:23], v[84:87], v[96:99], a[20:23]
    ds_read_b64_tr_b16 v[8:9], v130 offset:0
    buffer_load_dwordx4 v141, s[4:7], s16 offen offset:0 sc1 lds
    v_mfma_f32_16x16x32_bf16 a[24:27], v[88:91], v[96:99], a[24:27]
    ds_read_b64_tr_b16 v[10:11], v130 offset:8192
    v_mfma_f32_16x16x32_bf16 a[28:31], v[92:95], v[96:99], a[28:31]
    ds_read_b64_tr_b16 v[12:13], v131 offset:0
    v_mfma_f32_16x16x32_bf16 a[32:35], v[64:67], v[100:103], a[32:35]
    ds_read_b64_tr_b16 v[14:15], v131 offset:8192
    v_mfma_f32_16x16x32_bf16 a[36:39], v[68:71], v[100:103], a[36:39]
    ds_read_b64_tr_b16 v[16:17], v132 offset:0
    v_mfma_f32_16x16x32_bf16 a[40:43], v[72:75], v[100:103], a[40:43]
    ds_read_b64_tr_b16 v[18:19], v132 offset:8192
    buffer_load_dwordx4 v142, s[4:7], s16 offen offset:1024 sc1 lds
    v_mfma_f32_16x16x32_bf16 a[44:47], v[76:79], v[100:103], a[44:47]
    ds_read_b64_tr_b16 v[20:21], v133 offset:0
    v_mfma_f32_16x16x32_bf16 a[48:51], v[80:83], v[100:103], a[48:51]
    ds_read_b64_tr_b16 v[22:23], v133 offset:8192
    v_mfma_f32_16x16x32_bf16 a[52:55], v[84:87], v[100:103], a[52:55]
    ds_read_b64_tr_b16 v[24:25], v134 offset:0
    v_mfma_f32_16x16x32_bf16 a[56:59], v[88:91], v[100:103], a[56:59]
    ds_read_b64_tr_b16 v[26:27], v134 offset:8192
    v_mfma_f32_16x16x32_bf16 a[60:63], v[92:95], v[100:103], a[60:63]
    ds_read_b64_tr_b16 v[28:29], v135 offset:0
    buffer_load_dwordx4 v143, s[4:7], s16 offen offset:2048 sc1 lds
    v_mfma_f32_16x16x32_bf16 a[64:67], v[64:67], v[104:107], a[64:67]
    ds_read_b64_tr_b16 v[30:31], v135 offset:8192
    v_mfma_f32_16x16x32_bf16 a[68:71], v[68:71], v[104:107], a[68:71]
    ds_read_b128 v[36:39], v136 offset:1024
    v_mfma_f32_16x16x32_bf16 a[72:75], v[72:75], v[104:107], a[72:75]
    ds_read_b128 v[40:43], v136 offset:2048
    v_mfma_f32_16x16x32_bf16 a[76:79], v[76:79], v[104:107], a[76:79]
    ds_read_b128 v[44:47], v136 offset:3072
    v_mfma_f32_16x16x32_bf16 a[80:83], v[80:83], v[104:107], a[80:83]
    ds_read_b128 v[48:51], v136 offset:4096
    v_mfma_f32_16x16x32_bf16 a[84:87], v[84:87], v[104:107], a[84:87]
    ds_read_b128 v[52:55], v136 offset:5120
    buffer_load_dwordx4 v144, s[4:7], s16 offen offset:3072 sc1 lds
    v_mfma_f32_16x16x32_bf16 a[88:91], v[88:91], v[104:107], a[88:91]
    ds_read_b128 v[56:59], v136 offset:6144
    v_mfma_f32_16x16x32_bf16 a[92:95], v[92:95], v[104:107], a[92:95]
    ds_read_b128 v[60:63], v136 offset:7168
    v_mfma_f32_16x16x32_bf16 a[96:99], v[64:67], v[108:111], a[96:99]
    v_mfma_f32_16x16x32_bf16 a[100:103], v[68:71], v[108:111], a[100:103]
    v_mfma_f32_16x16x32_bf16 a[104:107], v[72:75], v[108:111], a[104:107]
    s_add_u32 s16, s16, 1024
    v_mfma_f32_16x16x32_bf16 a[108:111], v[76:79], v[108:111], a[108:111]
    v_mfma_f32_16x16x32_bf16 a[112:115], v[80:83], v[108:111], a[112:115]
    v_mfma_f32_16x16x32_bf16 a[116:119], v[84:87], v[108:111], a[116:119]
    v_mfma_f32_16x16x32_bf16 a[120:123], v[88:91], v[108:111], a[120:123]
    v_mfma_f32_16x16x32_bf16 a[124:127], v[92:95], v[108:111], a[124:127]
    s_add_u32 m0, s19, 49152
    s_nop 0
    v_mfma_f32_16x16x32_bf16 a[128:131], v[64:67], v[112:115], a[128:131]
    v_mfma_f32_16x16x32_bf16 a[132:135], v[68:71], v[112:115], a[132:135]
    v_mfma_f32_16x16x32_bf16 a[136:139], v[72:75], v[112:115], a[136:139]
    v_mfma_f32_16x16x32_bf16 a[140:143], v[76:79], v[112:115], a[140:143]
    v_mfma_f32_16x16x32_bf16 a[144:147], v[80:83], v[112:115], a[144:147]
    buffer_load_dwordx4 v137, s[8:11], s15 offen offset:0 lds
    v_mfma_f32_16x16x32_bf16 a[148:151], v[84:87], v[112:115], a[148:151]
    v_mfma_f32_16x16x32_bf16 a[152:155], v[88:91], v[112:115], a[152:155]
    v_mfma_f32_16x16x32_bf16 a[156:159], v[92:95], v[112:115], a[156:159]
    v_mfma_f32_16x16x32_bf16 a[160:163], v[64:67], v[116:119], a[160:163]
    v_mfma_f32_16x16x32_bf16 a[164:167], v[68:71], v[116:119], a[164:167]
    v_mfma_f32_16x16x32_bf16 a[168:171], v[72:75], v[116:119], a[168:171]
    buffer_load_dwordx4 v138, s[8:11], s15 offen offset:1024 lds
    v_mfma_f32_16x16x32_bf16 a[172:175], v[76:79], v[116:119], a[172:175]
    v_mfma_f32_16x16x32_bf16 a[176:179], v[80:83], v[116:119], a[176:179]
    v_mfma_f32_16x16x32_bf16 a[180:183], v[84:87], v[116:119], a[180:183]
    v_mfma_f32_16x16x32_bf16 a[184:187], v[88:91], v[116:119], a[184:187]
    v_mfma_f32_16x16x32_bf16 a[188:191], v[92:95], v[116:119], a[188:191]
    buffer_load_dwordx4 v139, s[8:11], s15 offen offset:2048 lds
    v_mfma_f32_16x16x32_bf16 a[192:195], v[64:67], v[120:123], a[192:195]
    v_mfma_f32_16x16x32_bf16 a[196:199], v[68:71], v[120:123], a[196:199]
    v_mfma_f32_16x16x32_bf16 a[200:203], v[72:75], v[120:123], a[200:203]
    v_mfma_f32_16x16x32_bf16 a[204:207], v[76:79], v[120:123], a[204:207]
    v_mfma_f32_16x16x32_bf16 a[208:211], v[80:83], v[120:123], a[208:211]
    buffer_load_dwordx4 v140, s[8:11], s15 offen offset:3072 lds
    v_mfma_f32_16x16x32_bf16 a[212:215], v[84:87], v[120:123], a[212:215]
    v_mfma_f32_16x16x32_bf16 a[216:219], v[88:91], v[120:123], a[216:219]
    v_mfma_f32_16x16x32_bf16 a[220:223], v[92:95], v[120:123], a[220:223]
    v_mfma_f32_16x16x32_bf16 a[224:227], v[64:67], v[124:127], a[224:227]
    v_mfma_f32_16x16x32_bf16 a[228:231], v[68:71], v[124:127], a[228:231]
    s_add_u32 s15, s15, s17
    v_mfma_f32_16x16x32_bf16 a[232:235], v[72:75], v[124:127], a[232:235]
    v_mfma_f32_16x16x32_bf16 a[236:239], v[76:79], v[124:127], a[236:239]
    v_mfma_f32_16x16x32_bf16 a[240:243], v[80:83], v[124:127], a[240:243]
    v_mfma_f32_16x16x32_bf16 a[244:247], v[84:87], v[124:127], a[244:247]
    v_mfma_f32_16x16x32_bf16 a[248:251], v[88:91], v[124:127], a[248:251]
    v_mfma_f32_16x16x32_bf16 a[252:255], v[92:95], v[124:127], a[252:255]
    s_sub_u32 s18, s18, 1
    s_cmp_lg_u32 s18, 0
    s_cbranch_scc1 main_kernel_w_c2_n_loop
    s_cmp_lg_u32 s14, 0
    s_cbranch_scc1 main_kernel_w_c2_n_nt
    s_lshl_b32 s32, s27, 8
    s_add_u32 s32, s32, 0x841e000
    v_mov_b32 v255, 1
    s_mov_b64 exec, 1
    buffer_atomic_add v255, off, s[4:7], s32 sc0 sc1
    s_mov_b64 exec, -1
main_kernel_w_c2_n_nt:
    s_waitcnt lgkmcnt(0)
    v_mfma_f32_16x16x32_bf16 a[0:3], v[0:3], v[32:35], a[0:3]
    s_waitcnt vmcnt(16)
    s_barrier
    ds_read_b128 v[96:99], v136 offset:16384
    v_mfma_f32_16x16x32_bf16 a[4:7], v[4:7], v[32:35], a[4:7]
    ds_read_b64_tr_b16 v[64:65], v128 offset:16384
    v_mfma_f32_16x16x32_bf16 a[8:11], v[8:11], v[32:35], a[8:11]
    ds_read_b64_tr_b16 v[66:67], v128 offset:24576
    v_mfma_f32_16x16x32_bf16 a[12:15], v[12:15], v[32:35], a[12:15]
    ds_read_b64_tr_b16 v[68:69], v129 offset:16384
    v_mfma_f32_16x16x32_bf16 a[16:19], v[16:19], v[32:35], a[16:19]
    ds_read_b64_tr_b16 v[70:71], v129 offset:24576
    v_mfma_f32_16x16x32_bf16 a[20:23], v[20:23], v[32:35], a[20:23]
    ds_read_b64_tr_b16 v[72:73], v130 offset:16384
    v_mfma_f32_16x16x32_bf16 a[24:27], v[24:27], v[32:35], a[24:27]
    ds_read_b64_tr_b16 v[74:75], v130 offset:24576
    v_mfma_f32_16x16x32_bf16 a[28:31], v[28:31], v[32:35], a[28:31]
    ds_read_b64_tr_b16 v[76:77], v131 offset:16384
    v_mfma_f32_16x16x32_bf16 a[32:35], v[0:3], v[36:39], a[32:35]
    ds_read_b64_tr_b16 v[78:79], v131 offset:24576
    v_mfma_f32_16x16x32_bf16 a[36:39], v[4:7], v[36:39], a[36:39]
    ds_read_b64_tr_b16 v[80:81], v132 offset:16384
    v_mfma_f32_16x16x32_bf16 a[40:43], v[8:11], v[36:39], a[40:43]
    ds_read_b64_tr_b16 v[82:83], v132 offset:24576
    v_mfma_f32_16x16x32_bf16 a[44:47], v[12:15], v[36:39], a[44:47]
    ds_read_b64_tr_b16 v[84:85], v133 offset:16384
    v_mfma_f32_16x16x32_bf16 a[48:51], v[16:19], v[36:39], a[48:51]
    ds_read_b64_tr_b16 v[86:87], v133 offset:24576
    v_mfma_f32_16x16x32_bf16 a[52:55], v[20:23], v[36:39], a[52:55]
    ds_read_b64_tr_b16 v[88:89], v134 offset:16384
    v_mfma_f32_16x16x32_bf16 a[56:59], v[24:27], v[36:39], a[56:59]
    ds_read_b64_tr_b16 v[90:91], v134 offset:24576
    v_mfma_f32_16x16x32_bf16 a[60:63], v[28:31], v[36:39], a[60:63]
    ds_read_b64_tr_b16 v[92:93], v135 offset:16384
    v_mfma_f32_16x16x32_bf16 a[64:67], v[0:3], v[40:43], a[64:67]
    ds_read_b64_tr_b16 v[94:95], v135 offset:24576
    v_mfma_f32_16x16x32_bf16 a[68:71], v[4:7], v[40:43], a[68:71]
    ds_read_b128 v[100:103], v136 offset:17408
    v_mfma_f32_16x16x32_bf16 a[72:75], v[8:11], v[40:43], a[72:75]
    ds_read_b128 v[104:107], v136 offset:18432
    v_mfma_f32_16x16x32_bf16 a[76:79], v[12:15], v[40:43], a[76:79]
    ds_read_b128 v[108:111], v136 offset:19456
    v_mfma_f32_16x16x32_bf16 a[80:83], v[16:19], v[40:43], a[80:83]
    ds_read_b128 v[112:115], v136 offset:20480
    v_mfma_f32_16x16x32_bf16 a[84:87], v[20:23], v[40:43], a[84:87]
    ds_read_b128 v[116:119], v136 offset:21504
    v_mfma_f32_16x16x32_bf16 a[88:91], v[24:27], v[40:43], a[88:91]
    ds_read_b128 v[120:123], v136 offset:22528
    v_mfma_f32_16x16x32_bf16 a[92:95], v[28:31], v[40:43], a[92:95]
    ds_read_b128 v[124:127], v136 offset:23552
    v_mfma_f32_16x16x32_bf16 a[96:99], v[0:3], v[44:47], a[96:99]
    v_mfma_f32_16x16x32_bf16 a[100:103], v[4:7], v[44:47], a[100:103]
    v_mfma_f32_16x16x32_bf16 a[104:107], v[8:11], v[44:47], a[104:107]
    v_mfma_f32_16x16x32_bf16 a[108:111], v[12:15], v[44:47], a[108:111]
    v_mfma_f32_16x16x32_bf16 a[112:115], v[16:19], v[44:47], a[112:115]
    v_mfma_f32_16x16x32_bf16 a[116:119], v[20:23], v[44:47], a[116:119]
    v_mfma_f32_16x16x32_bf16 a[120:123], v[24:27], v[44:47], a[120:123]
    v_mfma_f32_16x16x32_bf16 a[124:127], v[28:31], v[44:47], a[124:127]
    v_mfma_f32_16x16x32_bf16 a[128:131], v[0:3], v[48:51], a[128:131]
    v_mfma_f32_16x16x32_bf16 a[132:135], v[4:7], v[48:51], a[132:135]
    v_mfma_f32_16x16x32_bf16 a[136:139], v[8:11], v[48:51], a[136:139]
    v_mfma_f32_16x16x32_bf16 a[140:143], v[12:15], v[48:51], a[140:143]
    v_mfma_f32_16x16x32_bf16 a[144:147], v[16:19], v[48:51], a[144:147]
    v_mfma_f32_16x16x32_bf16 a[148:151], v[20:23], v[48:51], a[148:151]
    v_mfma_f32_16x16x32_bf16 a[152:155], v[24:27], v[48:51], a[152:155]
    v_mfma_f32_16x16x32_bf16 a[156:159], v[28:31], v[48:51], a[156:159]
    v_mfma_f32_16x16x32_bf16 a[160:163], v[0:3], v[52:55], a[160:163]
    v_mfma_f32_16x16x32_bf16 a[164:167], v[4:7], v[52:55], a[164:167]
    v_mfma_f32_16x16x32_bf16 a[168:171], v[8:11], v[52:55], a[168:171]
    v_mfma_f32_16x16x32_bf16 a[172:175], v[12:15], v[52:55], a[172:175]
    v_mfma_f32_16x16x32_bf16 a[176:179], v[16:19], v[52:55], a[176:179]
    v_mfma_f32_16x16x32_bf16 a[180:183], v[20:23], v[52:55], a[180:183]
    v_mfma_f32_16x16x32_bf16 a[184:187], v[24:27], v[52:55], a[184:187]
    v_mfma_f32_16x16x32_bf16 a[188:191], v[28:31], v[52:55], a[188:191]
    v_mfma_f32_16x16x32_bf16 a[192:195], v[0:3], v[56:59], a[192:195]
    v_mfma_f32_16x16x32_bf16 a[196:199], v[4:7], v[56:59], a[196:199]
    v_mfma_f32_16x16x32_bf16 a[200:203], v[8:11], v[56:59], a[200:203]
    v_mfma_f32_16x16x32_bf16 a[204:207], v[12:15], v[56:59], a[204:207]
    v_mfma_f32_16x16x32_bf16 a[208:211], v[16:19], v[56:59], a[208:211]
    v_mfma_f32_16x16x32_bf16 a[212:215], v[20:23], v[56:59], a[212:215]
    v_mfma_f32_16x16x32_bf16 a[216:219], v[24:27], v[56:59], a[216:219]
    v_mfma_f32_16x16x32_bf16 a[220:223], v[28:31], v[56:59], a[220:223]
    v_mfma_f32_16x16x32_bf16 a[224:227], v[0:3], v[60:63], a[224:227]
    v_mfma_f32_16x16x32_bf16 a[228:231], v[4:7], v[60:63], a[228:231]
    v_mfma_f32_16x16x32_bf16 a[232:235], v[8:11], v[60:63], a[232:235]
    v_mfma_f32_16x16x32_bf16 a[236:239], v[12:15], v[60:63], a[236:239]
    v_mfma_f32_16x16x32_bf16 a[240:243], v[16:19], v[60:63], a[240:243]
    v_mfma_f32_16x16x32_bf16 a[244:247], v[20:23], v[60:63], a[244:247]
    v_mfma_f32_16x16x32_bf16 a[248:251], v[24:27], v[60:63], a[248:251]
    v_mfma_f32_16x16x32_bf16 a[252:255], v[28:31], v[60:63], a[252:255]
    s_waitcnt lgkmcnt(0)
    v_mfma_f32_16x16x32_bf16 a[0:3], v[64:67], v[96:99], a[0:3]
    s_waitcnt vmcnt(8)
    s_barrier
    ds_read_b128 v[32:35], v136 offset:32768
    v_mfma_f32_16x16x32_bf16 a[4:7], v[68:71], v[96:99], a[4:7]
    ds_read_b64_tr_b16 v[0:1], v128 offset:32768
    v_mfma_f32_16x16x32_bf16 a[8:11], v[72:75], v[96:99], a[8:11]
    ds_read_b64_tr_b16 v[2:3], v128 offset:40960
    v_mfma_f32_16x16x32_bf16 a[12:15], v[76:79], v[96:99], a[12:15]
    ds_read_b64_tr_b16 v[4:5], v129 offset:32768
    v_mfma_f32_16x16x32_bf16 a[16:19], v[80:83], v[96:99], a[16:19]
    ds_read_b64_tr_b16 v[6:7], v129 offset:40960
    v_mfma_f32_16x16x32_bf16 a[20:23], v[84:87], v[96:99], a[20:23]
    ds_read_b64_tr_b16 v[8:9], v130 offset:32768
    v_mfma_f32_16x16x32_bf16 a[24:27], v[88:91], v[96:99], a[24:27]
    ds_read_b64_tr_b16 v[10:11], v130 offset:40960
    v_mfma_f32_16x16x32_bf16 a[28:31], v[92:95], v[96:99], a[28:31]
    ds_read_b64_tr_b16 v[12:13], v131 offset:32768
    v_mfma_f32_16x16x32_bf16 a[32:35], v[64:67], v[100:103], a[32:35]
    ds_read_b64_tr_b16 v[14:15], v131 offset:40960
    v_mfma_f32_16x16x32_bf16 a[36:39], v[68:71], v[100:103], a[36:39]
    ds_read_b64_tr_b16 v[16:17], v132 offset:32768
    v_mfma_f32_16x16x32_bf16 a[40:43], v[72:75], v[100:103], a[40:43]
    ds_read_b64_tr_b16 v[18:19], v132 offset:40960
    v_mfma_f32_16x16x32_bf16 a[44:47], v[76:79], v[100:103], a[44:47]
    ds_read_b64_tr_b16 v[20:21], v133 offset:32768
    v_mfma_f32_16x16x32_bf16 a[48:51], v[80:83], v[100:103], a[48:51]
    ds_read_b64_tr_b16 v[22:23], v133 offset:40960
    v_mfma_f32_16x16x32_bf16 a[52:55], v[84:87], v[100:103], a[52:55]
    ds_read_b64_tr_b16 v[24:25], v134 offset:32768
    v_mfma_f32_16x16x32_bf16 a[56:59], v[88:91], v[100:103], a[56:59]
    ds_read_b64_tr_b16 v[26:27], v134 offset:40960
    v_mfma_f32_16x16x32_bf16 a[60:63], v[92:95], v[100:103], a[60:63]
    ds_read_b64_tr_b16 v[28:29], v135 offset:32768
    v_mfma_f32_16x16x32_bf16 a[64:67], v[64:67], v[104:107], a[64:67]
    ds_read_b64_tr_b16 v[30:31], v135 offset:40960
    v_mfma_f32_16x16x32_bf16 a[68:71], v[68:71], v[104:107], a[68:71]
    ds_read_b128 v[36:39], v136 offset:33792
    v_mfma_f32_16x16x32_bf16 a[72:75], v[72:75], v[104:107], a[72:75]
    ds_read_b128 v[40:43], v136 offset:34816
    v_mfma_f32_16x16x32_bf16 a[76:79], v[76:79], v[104:107], a[76:79]
    ds_read_b128 v[44:47], v136 offset:35840
    v_mfma_f32_16x16x32_bf16 a[80:83], v[80:83], v[104:107], a[80:83]
    ds_read_b128 v[48:51], v136 offset:36864
    v_mfma_f32_16x16x32_bf16 a[84:87], v[84:87], v[104:107], a[84:87]
    ds_read_b128 v[52:55], v136 offset:37888
    v_mfma_f32_16x16x32_bf16 a[88:91], v[88:91], v[104:107], a[88:91]
    ds_read_b128 v[56:59], v136 offset:38912
    v_mfma_f32_16x16x32_bf16 a[92:95], v[92:95], v[104:107], a[92:95]
    ds_read_b128 v[60:63], v136 offset:39936
    v_mfma_f32_16x16x32_bf16 a[96:99], v[64:67], v[108:111], a[96:99]
    v_mfma_f32_16x16x32_bf16 a[100:103], v[68:71], v[108:111], a[100:103]
    v_mfma_f32_16x16x32_bf16 a[104:107], v[72:75], v[108:111], a[104:107]
    v_mfma_f32_16x16x32_bf16 a[108:111], v[76:79], v[108:111], a[108:111]
    v_mfma_f32_16x16x32_bf16 a[112:115], v[80:83], v[108:111], a[112:115]
    v_mfma_f32_16x16x32_bf16 a[116:119], v[84:87], v[108:111], a[116:119]
    v_mfma_f32_16x16x32_bf16 a[120:123], v[88:91], v[108:111], a[120:123]
    v_mfma_f32_16x16x32_bf16 a[124:127], v[92:95], v[108:111], a[124:127]
    v_mfma_f32_16x16x32_bf16 a[128:131], v[64:67], v[112:115], a[128:131]
    v_mfma_f32_16x16x32_bf16 a[132:135], v[68:71], v[112:115], a[132:135]
    v_mfma_f32_16x16x32_bf16 a[136:139], v[72:75], v[112:115], a[136:139]
    v_mfma_f32_16x16x32_bf16 a[140:143], v[76:79], v[112:115], a[140:143]
    v_mfma_f32_16x16x32_bf16 a[144:147], v[80:83], v[112:115], a[144:147]
    v_mfma_f32_16x16x32_bf16 a[148:151], v[84:87], v[112:115], a[148:151]
    v_mfma_f32_16x16x32_bf16 a[152:155], v[88:91], v[112:115], a[152:155]
    v_mfma_f32_16x16x32_bf16 a[156:159], v[92:95], v[112:115], a[156:159]
    v_mfma_f32_16x16x32_bf16 a[160:163], v[64:67], v[116:119], a[160:163]
    v_mfma_f32_16x16x32_bf16 a[164:167], v[68:71], v[116:119], a[164:167]
    v_mfma_f32_16x16x32_bf16 a[168:171], v[72:75], v[116:119], a[168:171]
    v_mfma_f32_16x16x32_bf16 a[172:175], v[76:79], v[116:119], a[172:175]
    v_mfma_f32_16x16x32_bf16 a[176:179], v[80:83], v[116:119], a[176:179]
    v_mfma_f32_16x16x32_bf16 a[180:183], v[84:87], v[116:119], a[180:183]
    v_mfma_f32_16x16x32_bf16 a[184:187], v[88:91], v[116:119], a[184:187]
    v_mfma_f32_16x16x32_bf16 a[188:191], v[92:95], v[116:119], a[188:191]
    v_mfma_f32_16x16x32_bf16 a[192:195], v[64:67], v[120:123], a[192:195]
    v_mfma_f32_16x16x32_bf16 a[196:199], v[68:71], v[120:123], a[196:199]
    v_mfma_f32_16x16x32_bf16 a[200:203], v[72:75], v[120:123], a[200:203]
    v_mfma_f32_16x16x32_bf16 a[204:207], v[76:79], v[120:123], a[204:207]
    v_mfma_f32_16x16x32_bf16 a[208:211], v[80:83], v[120:123], a[208:211]
    v_mfma_f32_16x16x32_bf16 a[212:215], v[84:87], v[120:123], a[212:215]
    v_mfma_f32_16x16x32_bf16 a[216:219], v[88:91], v[120:123], a[216:219]
    v_mfma_f32_16x16x32_bf16 a[220:223], v[92:95], v[120:123], a[220:223]
    v_mfma_f32_16x16x32_bf16 a[224:227], v[64:67], v[124:127], a[224:227]
    v_mfma_f32_16x16x32_bf16 a[228:231], v[68:71], v[124:127], a[228:231]
    v_mfma_f32_16x16x32_bf16 a[232:235], v[72:75], v[124:127], a[232:235]
    v_mfma_f32_16x16x32_bf16 a[236:239], v[76:79], v[124:127], a[236:239]
    v_mfma_f32_16x16x32_bf16 a[240:243], v[80:83], v[124:127], a[240:243]
    v_mfma_f32_16x16x32_bf16 a[244:247], v[84:87], v[124:127], a[244:247]
    v_mfma_f32_16x16x32_bf16 a[248:251], v[88:91], v[124:127], a[248:251]
    v_mfma_f32_16x16x32_bf16 a[252:255], v[92:95], v[124:127], a[252:255]
    s_waitcnt lgkmcnt(0)
    v_mfma_f32_16x16x32_bf16 a[0:3], v[0:3], v[32:35], a[0:3]
    s_waitcnt vmcnt(0)
    s_barrier
    ds_read_b128 v[96:99], v136 offset:49152
    v_mfma_f32_16x16x32_bf16 a[4:7], v[4:7], v[32:35], a[4:7]
    ds_read_b64_tr_b16 v[64:65], v128 offset:49152
    v_mfma_f32_16x16x32_bf16 a[8:11], v[8:11], v[32:35], a[8:11]
    ds_read_b64_tr_b16 v[66:67], v128 offset:57344
    v_mfma_f32_16x16x32_bf16 a[12:15], v[12:15], v[32:35], a[12:15]
    ds_read_b64_tr_b16 v[68:69], v129 offset:49152
    v_mfma_f32_16x16x32_bf16 a[16:19], v[16:19], v[32:35], a[16:19]
    ds_read_b64_tr_b16 v[70:71], v129 offset:57344
    v_mfma_f32_16x16x32_bf16 a[20:23], v[20:23], v[32:35], a[20:23]
    ds_read_b64_tr_b16 v[72:73], v130 offset:49152
    v_mfma_f32_16x16x32_bf16 a[24:27], v[24:27], v[32:35], a[24:27]
    ds_read_b64_tr_b16 v[74:75], v130 offset:57344
    v_mfma_f32_16x16x32_bf16 a[28:31], v[28:31], v[32:35], a[28:31]
    ds_read_b64_tr_b16 v[76:77], v131 offset:49152
    v_mfma_f32_16x16x32_bf16 a[32:35], v[0:3], v[36:39], a[32:35]
    ds_read_b64_tr_b16 v[78:79], v131 offset:57344
    v_mfma_f32_16x16x32_bf16 a[36:39], v[4:7], v[36:39], a[36:39]
    ds_read_b64_tr_b16 v[80:81], v132 offset:49152
    v_mfma_f32_16x16x32_bf16 a[40:43], v[8:11], v[36:39], a[40:43]
    ds_read_b64_tr_b16 v[82:83], v132 offset:57344
    v_mfma_f32_16x16x32_bf16 a[44:47], v[12:15], v[36:39], a[44:47]
    ds_read_b64_tr_b16 v[84:85], v133 offset:49152
    v_mfma_f32_16x16x32_bf16 a[48:51], v[16:19], v[36:39], a[48:51]
    ds_read_b64_tr_b16 v[86:87], v133 offset:57344
    v_mfma_f32_16x16x32_bf16 a[52:55], v[20:23], v[36:39], a[52:55]
    ds_read_b64_tr_b16 v[88:89], v134 offset:49152
    v_mfma_f32_16x16x32_bf16 a[56:59], v[24:27], v[36:39], a[56:59]
    ds_read_b64_tr_b16 v[90:91], v134 offset:57344
    v_mfma_f32_16x16x32_bf16 a[60:63], v[28:31], v[36:39], a[60:63]
    ds_read_b64_tr_b16 v[92:93], v135 offset:49152
    v_mfma_f32_16x16x32_bf16 a[64:67], v[0:3], v[40:43], a[64:67]
    ds_read_b64_tr_b16 v[94:95], v135 offset:57344
    v_mfma_f32_16x16x32_bf16 a[68:71], v[4:7], v[40:43], a[68:71]
    ds_read_b128 v[100:103], v136 offset:50176
    v_mfma_f32_16x16x32_bf16 a[72:75], v[8:11], v[40:43], a[72:75]
    ds_read_b128 v[104:107], v136 offset:51200
    v_mfma_f32_16x16x32_bf16 a[76:79], v[12:15], v[40:43], a[76:79]
    ds_read_b128 v[108:111], v136 offset:52224
    v_mfma_f32_16x16x32_bf16 a[80:83], v[16:19], v[40:43], a[80:83]
    ds_read_b128 v[112:115], v136 offset:53248
    v_mfma_f32_16x16x32_bf16 a[84:87], v[20:23], v[40:43], a[84:87]
    ds_read_b128 v[116:119], v136 offset:54272
    v_mfma_f32_16x16x32_bf16 a[88:91], v[24:27], v[40:43], a[88:91]
    ds_read_b128 v[120:123], v136 offset:55296
    v_mfma_f32_16x16x32_bf16 a[92:95], v[28:31], v[40:43], a[92:95]
    ds_read_b128 v[124:127], v136 offset:56320
    v_mfma_f32_16x16x32_bf16 a[96:99], v[0:3], v[44:47], a[96:99]
    v_mfma_f32_16x16x32_bf16 a[100:103], v[4:7], v[44:47], a[100:103]
    v_mfma_f32_16x16x32_bf16 a[104:107], v[8:11], v[44:47], a[104:107]
    v_mfma_f32_16x16x32_bf16 a[108:111], v[12:15], v[44:47], a[108:111]
    v_mfma_f32_16x16x32_bf16 a[112:115], v[16:19], v[44:47], a[112:115]
    v_mfma_f32_16x16x32_bf16 a[116:119], v[20:23], v[44:47], a[116:119]
    v_mfma_f32_16x16x32_bf16 a[120:123], v[24:27], v[44:47], a[120:123]
    v_mfma_f32_16x16x32_bf16 a[124:127], v[28:31], v[44:47], a[124:127]
    v_mfma_f32_16x16x32_bf16 a[128:131], v[0:3], v[48:51], a[128:131]
    v_mfma_f32_16x16x32_bf16 a[132:135], v[4:7], v[48:51], a[132:135]
    v_mfma_f32_16x16x32_bf16 a[136:139], v[8:11], v[48:51], a[136:139]
    v_mfma_f32_16x16x32_bf16 a[140:143], v[12:15], v[48:51], a[140:143]
    v_mfma_f32_16x16x32_bf16 a[144:147], v[16:19], v[48:51], a[144:147]
    v_mfma_f32_16x16x32_bf16 a[148:151], v[20:23], v[48:51], a[148:151]
    v_mfma_f32_16x16x32_bf16 a[152:155], v[24:27], v[48:51], a[152:155]
    v_mfma_f32_16x16x32_bf16 a[156:159], v[28:31], v[48:51], a[156:159]
    v_mfma_f32_16x16x32_bf16 a[160:163], v[0:3], v[52:55], a[160:163]
    v_mfma_f32_16x16x32_bf16 a[164:167], v[4:7], v[52:55], a[164:167]
    v_mfma_f32_16x16x32_bf16 a[168:171], v[8:11], v[52:55], a[168:171]
    v_mfma_f32_16x16x32_bf16 a[172:175], v[12:15], v[52:55], a[172:175]
    v_mfma_f32_16x16x32_bf16 a[176:179], v[16:19], v[52:55], a[176:179]
    v_mfma_f32_16x16x32_bf16 a[180:183], v[20:23], v[52:55], a[180:183]
    v_mfma_f32_16x16x32_bf16 a[184:187], v[24:27], v[52:55], a[184:187]
    v_mfma_f32_16x16x32_bf16 a[188:191], v[28:31], v[52:55], a[188:191]
    v_mfma_f32_16x16x32_bf16 a[192:195], v[0:3], v[56:59], a[192:195]
    v_mfma_f32_16x16x32_bf16 a[196:199], v[4:7], v[56:59], a[196:199]
    v_mfma_f32_16x16x32_bf16 a[200:203], v[8:11], v[56:59], a[200:203]
    v_mfma_f32_16x16x32_bf16 a[204:207], v[12:15], v[56:59], a[204:207]
    v_mfma_f32_16x16x32_bf16 a[208:211], v[16:19], v[56:59], a[208:211]
    v_mfma_f32_16x16x32_bf16 a[212:215], v[20:23], v[56:59], a[212:215]
    v_mfma_f32_16x16x32_bf16 a[216:219], v[24:27], v[56:59], a[216:219]
    v_mfma_f32_16x16x32_bf16 a[220:223], v[28:31], v[56:59], a[220:223]
    v_mfma_f32_16x16x32_bf16 a[224:227], v[0:3], v[60:63], a[224:227]
    v_mfma_f32_16x16x32_bf16 a[228:231], v[4:7], v[60:63], a[228:231]
    v_mfma_f32_16x16x32_bf16 a[232:235], v[8:11], v[60:63], a[232:235]
    v_mfma_f32_16x16x32_bf16 a[236:239], v[12:15], v[60:63], a[236:239]
    v_mfma_f32_16x16x32_bf16 a[240:243], v[16:19], v[60:63], a[240:243]
    v_mfma_f32_16x16x32_bf16 a[244:247], v[20:23], v[60:63], a[244:247]
    v_mfma_f32_16x16x32_bf16 a[248:251], v[24:27], v[60:63], a[248:251]
    v_mfma_f32_16x16x32_bf16 a[252:255], v[28:31], v[60:63], a[252:255]
    v_readfirstlane_b32 s55, v255
    s_waitcnt lgkmcnt(0)
    v_mfma_f32_16x16x32_bf16 a[0:3], v[64:67], v[96:99], a[0:3]
    v_mfma_f32_16x16x32_bf16 a[4:7], v[68:71], v[96:99], a[4:7]
    v_mfma_f32_16x16x32_bf16 a[8:11], v[72:75], v[96:99], a[8:11]
    v_mfma_f32_16x16x32_bf16 a[12:15], v[76:79], v[96:99], a[12:15]
    v_mfma_f32_16x16x32_bf16 a[16:19], v[80:83], v[96:99], a[16:19]
    v_mfma_f32_16x16x32_bf16 a[20:23], v[84:87], v[96:99], a[20:23]
    v_mfma_f32_16x16x32_bf16 a[24:27], v[88:91], v[96:99], a[24:27]
    v_mfma_f32_16x16x32_bf16 a[28:31], v[92:95], v[96:99], a[28:31]
    v_mfma_f32_16x16x32_bf16 a[32:35], v[64:67], v[100:103], a[32:35]
    v_mfma_f32_16x16x32_bf16 a[36:39], v[68:71], v[100:103], a[36:39]
    v_mfma_f32_16x16x32_bf16 a[40:43], v[72:75], v[100:103], a[40:43]
    v_mfma_f32_16x16x32_bf16 a[44:47], v[76:79], v[100:103], a[44:47]
    v_mfma_f32_16x16x32_bf16 a[48:51], v[80:83], v[100:103], a[48:51]
    v_mfma_f32_16x16x32_bf16 a[52:55], v[84:87], v[100:103], a[52:55]
    v_mfma_f32_16x16x32_bf16 a[56:59], v[88:91], v[100:103], a[56:59]
    v_mfma_f32_16x16x32_bf16 a[60:63], v[92:95], v[100:103], a[60:63]
    v_mfma_f32_16x16x32_bf16 a[64:67], v[64:67], v[104:107], a[64:67]
    v_mfma_f32_16x16x32_bf16 a[68:71], v[68:71], v[104:107], a[68:71]
    v_mfma_f32_16x16x32_bf16 a[72:75], v[72:75], v[104:107], a[72:75]
    v_mfma_f32_16x16x32_bf16 a[76:79], v[76:79], v[104:107], a[76:79]
    v_mfma_f32_16x16x32_bf16 a[80:83], v[80:83], v[104:107], a[80:83]
    v_mfma_f32_16x16x32_bf16 a[84:87], v[84:87], v[104:107], a[84:87]
    v_mfma_f32_16x16x32_bf16 a[88:91], v[88:91], v[104:107], a[88:91]
    v_mfma_f32_16x16x32_bf16 a[92:95], v[92:95], v[104:107], a[92:95]
    v_mfma_f32_16x16x32_bf16 a[96:99], v[64:67], v[108:111], a[96:99]
    v_mfma_f32_16x16x32_bf16 a[100:103], v[68:71], v[108:111], a[100:103]
    v_mfma_f32_16x16x32_bf16 a[104:107], v[72:75], v[108:111], a[104:107]
    v_mfma_f32_16x16x32_bf16 a[108:111], v[76:79], v[108:111], a[108:111]
    v_mfma_f32_16x16x32_bf16 a[112:115], v[80:83], v[108:111], a[112:115]
    v_mfma_f32_16x16x32_bf16 a[116:119], v[84:87], v[108:111], a[116:119]
    v_mfma_f32_16x16x32_bf16 a[120:123], v[88:91], v[108:111], a[120:123]
    v_mfma_f32_16x16x32_bf16 a[124:127], v[92:95], v[108:111], a[124:127]
    v_mfma_f32_16x16x32_bf16 a[128:131], v[64:67], v[112:115], a[128:131]
    v_mfma_f32_16x16x32_bf16 a[132:135], v[68:71], v[112:115], a[132:135]
    v_mfma_f32_16x16x32_bf16 a[136:139], v[72:75], v[112:115], a[136:139]
    v_mfma_f32_16x16x32_bf16 a[140:143], v[76:79], v[112:115], a[140:143]
    v_mfma_f32_16x16x32_bf16 a[144:147], v[80:83], v[112:115], a[144:147]
    v_mfma_f32_16x16x32_bf16 a[148:151], v[84:87], v[112:115], a[148:151]
    v_mfma_f32_16x16x32_bf16 a[152:155], v[88:91], v[112:115], a[152:155]
    v_mfma_f32_16x16x32_bf16 a[156:159], v[92:95], v[112:115], a[156:159]
    v_mfma_f32_16x16x32_bf16 a[160:163], v[64:67], v[116:119], a[160:163]
    v_mfma_f32_16x16x32_bf16 a[164:167], v[68:71], v[116:119], a[164:167]
    v_mfma_f32_16x16x32_bf16 a[168:171], v[72:75], v[116:119], a[168:171]
    v_mfma_f32_16x16x32_bf16 a[172:175], v[76:79], v[116:119], a[172:175]
    v_mfma_f32_16x16x32_bf16 a[176:179], v[80:83], v[116:119], a[176:179]
    v_mfma_f32_16x16x32_bf16 a[180:183], v[84:87], v[116:119], a[180:183]
    v_mfma_f32_16x16x32_bf16 a[184:187], v[88:91], v[116:119], a[184:187]
    v_mfma_f32_16x16x32_bf16 a[188:191], v[92:95], v[116:119], a[188:191]
    v_mfma_f32_16x16x32_bf16 a[192:195], v[64:67], v[120:123], a[192:195]
    v_mfma_f32_16x16x32_bf16 a[196:199], v[68:71], v[120:123], a[196:199]
    v_mfma_f32_16x16x32_bf16 a[200:203], v[72:75], v[120:123], a[200:203]
    v_mfma_f32_16x16x32_bf16 a[204:207], v[76:79], v[120:123], a[204:207]
    v_mfma_f32_16x16x32_bf16 a[208:211], v[80:83], v[120:123], a[208:211]
    v_mfma_f32_16x16x32_bf16 a[212:215], v[84:87], v[120:123], a[212:215]
    v_mfma_f32_16x16x32_bf16 a[216:219], v[88:91], v[120:123], a[216:219]
    v_mfma_f32_16x16x32_bf16 a[220:223], v[92:95], v[120:123], a[220:223]
    v_mfma_f32_16x16x32_bf16 a[224:227], v[64:67], v[124:127], a[224:227]
    v_mfma_f32_16x16x32_bf16 a[228:231], v[68:71], v[124:127], a[228:231]
    v_mfma_f32_16x16x32_bf16 a[232:235], v[72:75], v[124:127], a[232:235]
    v_mfma_f32_16x16x32_bf16 a[236:239], v[76:79], v[124:127], a[236:239]
    v_mfma_f32_16x16x32_bf16 a[240:243], v[80:83], v[124:127], a[240:243]
    v_mfma_f32_16x16x32_bf16 a[244:247], v[84:87], v[124:127], a[244:247]
    v_mfma_f32_16x16x32_bf16 a[248:251], v[88:91], v[124:127], a[248:251]
    v_mfma_f32_16x16x32_bf16 a[252:255], v[92:95], v[124:127], a[252:255]
    s_nop 7
    s_cmp_eq_u32 s23, 1
    s_cbranch_scc1 main_kernel_w_c2_escl
    s_cmp_eq_u32 s23, 6
    s_cbranch_scc1 main_kernel_w_c2_egelu
main_kernel_w_c2_eplain:
    s_mov_b32 s53, s21
    v_accvgpr_read_b32 v0, a0
    v_accvgpr_read_b32 v1, a1
    v_accvgpr_read_b32 v2, a2
    v_accvgpr_read_b32 v3, a3
    v_accvgpr_read_b32 v4, a4
    v_accvgpr_read_b32 v5, a5
    v_accvgpr_read_b32 v6, a6
    v_accvgpr_read_b32 v7, a7
    v_cvt_pk_bf16_f32 v16, v0, v1
    v_cvt_pk_bf16_f32 v17, v2, v3
    v_cvt_pk_bf16_f32 v18, v4, v5
    v_cvt_pk_bf16_f32 v19, v6, v7
    buffer_store_dwordx4 v[16:19], v251, s[4:7], s53 offen offset:0 sc1
    v_accvgpr_read_b32 v20, a8
    v_accvgpr_read_b32 v21, a9
    v_accvgpr_read_b32 v22, a10
    v_accvgpr_read_b32 v23, a11
    v_accvgpr_read_b32 v24, a12
    v_accvgpr_read_b32 v25, a13
    v_accvgpr_read_b32 v26, a14
    v_accvgpr_read_b32 v27, a15
    v_cvt_pk_bf16_f32 v36, v20, v21
    v_cvt_pk_bf16_f32 v37, v22, v23
    v_cvt_pk_bf16_f32 v38, v24, v25
    v_cvt_pk_bf16_f32 v39, v26, v27
    buffer_store_dwordx4 v[36:39], v251, s[4:7], s53 offen offset:1024 sc1
    v_accvgpr_read_b32 v40, a16
    v_accvgpr_read_b32 v41, a17
    v_accvgpr_read_b32 v42, a18
    v_accvgpr_read_b32 v43, a19
    v_accvgpr_read_b32 v44, a20
    v_accvgpr_read_b32 v45, a21
    v_accvgpr_read_b32 v46, a22
    v_accvgpr_read_b32 v47, a23
    v_cvt_pk_bf16_f32 v56, v40, v41
    v_cvt_pk_bf16_f32 v57, v42, v43
    v_cvt_pk_bf16_f32 v58, v44, v45
    v_cvt_pk_bf16_f32 v59, v46, v47
    buffer_store_dwordx4 v[56:59], v251, s[4:7], s53 offen offset:2048 sc1
    v_accvgpr_read_b32 v0, a24
    v_accvgpr_read_b32 v1, a25
    v_accvgpr_read_b32 v2, a26
    v_accvgpr_read_b32 v3, a27
    v_accvgpr_read_b32 v4, a28
    v_accvgpr_read_b32 v5, a29
    v_accvgpr_read_b32 v6, a30
    v_accvgpr_read_b32 v7, a31
    v_cvt_pk_bf16_f32 v16, v0, v1
    v_cvt_pk_bf16_f32 v17, v2, v3
    v_cvt_pk_bf16_f32 v18, v4, v5
    v_cvt_pk_bf16_f32 v19, v6, v7
    buffer_store_dwordx4 v[16:19], v251, s[4:7], s53 offen offset:3072 sc1
    s_add_u32 s53, s53, s22
    v_accvgpr_read_b32 v20, a32
    v_accvgpr_read_b32 v21, a33
    v_accvgpr_read_b32 v22, a34
    v_accvgpr_read_b32 v23, a35
    v_accvgpr_read_b32 v24, a36
    v_accvgpr_read_b32 v25, a37
    v_accvgpr_read_b32 v26, a38
    v_accvgpr_read_b32 v27, a39
    v_cvt_pk_bf16_f32 v36, v20, v21
    v_cvt_pk_bf16_f32 v37, v22, v23
    v_cvt_pk_bf16_f32 v38, v24, v25
    v_cvt_pk_bf16_f32 v39, v26, v27
    buffer_store_dwordx4 v[36:39], v251, s[4:7], s53 offen offset:0 sc1
    v_accvgpr_read_b32 v40, a40
    v_accvgpr_read_b32 v41, a41
    v_accvgpr_read_b32 v42, a42
    v_accvgpr_read_b32 v43, a43
    v_accvgpr_read_b32 v44, a44
    v_accvgpr_read_b32 v45, a45
    v_accvgpr_read_b32 v46, a46
    v_accvgpr_read_b32 v47, a47
    v_cvt_pk_bf16_f32 v56, v40, v41
    v_cvt_pk_bf16_f32 v57, v42, v43
    v_cvt_pk_bf16_f32 v58, v44, v45
    v_cvt_pk_bf16_f32 v59, v46, v47
    buffer_store_dwordx4 v[56:59], v251, s[4:7], s53 offen offset:1024 sc1
    v_accvgpr_read_b32 v0, a48
    v_accvgpr_read_b32 v1, a49
    v_accvgpr_read_b32 v2, a50
    v_accvgpr_read_b32 v3, a51
    v_accvgpr_read_b32 v4, a52
    v_accvgpr_read_b32 v5, a53
    v_accvgpr_read_b32 v6, a54
    v_accvgpr_read_b32 v7, a55
    v_cvt_pk_bf16_f32 v16, v0, v1
    v_cvt_pk_bf16_f32 v17, v2, v3
    v_cvt_pk_bf16_f32 v18, v4, v5
    v_cvt_pk_bf16_f32 v19, v6, v7
    buffer_store_dwordx4 v[16:19], v251, s[4:7], s53 offen offset:2048 sc1
    v_accvgpr_read_b32 v20, a56
    v_accvgpr_read_b32 v21, a57
    v_accvgpr_read_b32 v22, a58
    v_accvgpr_read_b32 v23, a59
    v_accvgpr_read_b32 v24, a60
    v_accvgpr_read_b32 v25, a61
    v_accvgpr_read_b32 v26, a62
    v_accvgpr_read_b32 v27, a63
    v_cvt_pk_bf16_f32 v36, v20, v21
    v_cvt_pk_bf16_f32 v37, v22, v23
    v_cvt_pk_bf16_f32 v38, v24, v25
    v_cvt_pk_bf16_f32 v39, v26, v27
    buffer_store_dwordx4 v[36:39], v251, s[4:7], s53 offen offset:3072 sc1
    s_add_u32 s53, s53, s22
    v_accvgpr_read_b32 v40, a64
    v_accvgpr_read_b32 v41, a65
    v_accvgpr_read_b32 v42, a66
    v_accvgpr_read_b32 v43, a67
    v_accvgpr_read_b32 v44, a68
    v_accvgpr_read_b32 v45, a69
    v_accvgpr_read_b32 v46, a70
    v_accvgpr_read_b32 v47, a71
    v_cvt_pk_bf16_f32 v56, v40, v41
    v_cvt_pk_bf16_f32 v57, v42, v43
    v_cvt_pk_bf16_f32 v58, v44, v45
    v_cvt_pk_bf16_f32 v59, v46, v47
    buffer_store_dwordx4 v[56:59], v251, s[4:7], s53 offen offset:0 sc1
    v_accvgpr_read_b32 v0, a72
    v_accvgpr_read_b32 v1, a73
    v_accvgpr_read_b32 v2, a74
    v_accvgpr_read_b32 v3, a75
    v_accvgpr_read_b32 v4, a76
    v_accvgpr_read_b32 v5, a77
    v_accvgpr_read_b32 v6, a78
    v_accvgpr_read_b32 v7, a79
    v_cvt_pk_bf16_f32 v16, v0, v1
    v_cvt_pk_bf16_f32 v17, v2, v3
    v_cvt_pk_bf16_f32 v18, v4, v5
    v_cvt_pk_bf16_f32 v19, v6, v7
    buffer_store_dwordx4 v[16:19], v251, s[4:7], s53 offen offset:1024 sc1
    v_accvgpr_read_b32 v20, a80
    v_accvgpr_read_b32 v21, a81
    v_accvgpr_read_b32 v22, a82
    v_accvgpr_read_b32 v23, a83
    v_accvgpr_read_b32 v24, a84
    v_accvgpr_read_b32 v25, a85
    v_accvgpr_read_b32 v26, a86
    v_accvgpr_read_b32 v27, a87
    v_cvt_pk_bf16_f32 v36, v20, v21
    v_cvt_pk_bf16_f32 v37, v22, v23
    v_cvt_pk_bf16_f32 v38, v24, v25
    v_cvt_pk_bf16_f32 v39, v26, v27
    buffer_store_dwordx4 v[36:39], v251, s[4:7], s53 offen offset:2048 sc1
    v_accvgpr_read_b32 v40, a88
    v_accvgpr_read_b32 v41, a89
    v_accvgpr_read_b32 v42, a90
    v_accvgpr_read_b32 v43, a91
    v_accvgpr_read_b32 v44, a92
    v_accvgpr_read_b32 v45, a93
    v_accvgpr_read_b32 v46, a94
    v_accvgpr_read_b32 v47, a95
    v_cvt_pk_bf16_f32 v56, v40, v41
    v_cvt_pk_bf16_f32 v57, v42, v43
    v_cvt_pk_bf16_f32 v58, v44, v45
    v_cvt_pk_bf16_f32 v59, v46, v47
    buffer_store_dwordx4 v[56:59], v251, s[4:7], s53 offen offset:3072 sc1
    s_add_u32 s53, s53, s22
    v_accvgpr_read_b32 v0, a96
    v_accvgpr_read_b32 v1, a97
    v_accvgpr_read_b32 v2, a98
    v_accvgpr_read_b32 v3, a99
    v_accvgpr_read_b32 v4, a100
    v_accvgpr_read_b32 v5, a101
    v_accvgpr_read_b32 v6, a102
    v_accvgpr_read_b32 v7, a103
    v_cvt_pk_bf16_f32 v16, v0, v1
    v_cvt_pk_bf16_f32 v17, v2, v3
    v_cvt_pk_bf16_f32 v18, v4, v5
    v_cvt_pk_bf16_f32 v19, v6, v7
    buffer_store_dwordx4 v[16:19], v251, s[4:7], s53 offen offset:0 sc1
    v_accvgpr_read_b32 v20, a104
    v_accvgpr_read_b32 v21, a105
    v_accvgpr_read_b32 v22, a106
    v_accvgpr_read_b32 v23, a107
    v_accvgpr_read_b32 v24, a108
    v_accvgpr_read_b32 v25, a109
    v_accvgpr_read_b32 v26, a110
    v_accvgpr_read_b32 v27, a111
    v_cvt_pk_bf16_f32 v36, v20, v21
    v_cvt_pk_bf16_f32 v37, v22, v23
    v_cvt_pk_bf16_f32 v38, v24, v25
    v_cvt_pk_bf16_f32 v39, v26, v27
    buffer_store_dwordx4 v[36:39], v251, s[4:7], s53 offen offset:1024 sc1
    v_accvgpr_read_b32 v40, a112
    v_accvgpr_read_b32 v41, a113
    v_accvgpr_read_b32 v42, a114
    v_accvgpr_read_b32 v43, a115
    v_accvgpr_read_b32 v44, a116
    v_accvgpr_read_b32 v45, a117
    v_accvgpr_read_b32 v46, a118
    v_accvgpr_read_b32 v47, a119
    v_cvt_pk_bf16_f32 v56, v40, v41
    v_cvt_pk_bf16_f32 v57, v42, v43
    v_cvt_pk_bf16_f32 v58, v44, v45
    v_cvt_pk_bf16_f32 v59, v46, v47
    buffer_store_dwordx4 v[56:59], v251, s[4:7], s53 offen offset:2048 sc1
    v_accvgpr_read_b32 v0, a120
    v_accvgpr_read_b32 v1, a121
    v_accvgpr_read_b32 v2, a122
    v_accvgpr_read_b32 v3, a123
    v_accvgpr_read_b32 v4, a124
    v_accvgpr_read_b32 v5, a125
    v_accvgpr_read_b32 v6, a126
    v_accvgpr_read_b32 v7, a127
    v_cvt_pk_bf16_f32 v16, v0, v1
    v_cvt_pk_bf16_f32 v17, v2, v3
    v_cvt_pk_bf16_f32 v18, v4, v5
    v_cvt_pk_bf16_f32 v19, v6, v7
    buffer_store_dwordx4 v[16:19], v251, s[4:7], s53 offen offset:3072 sc1
    s_add_u32 s53, s53, s22
    v_accvgpr_read_b32 v20, a128
    v_accvgpr_read_b32 v21, a129
    v_accvgpr_read_b32 v22, a130
    v_accvgpr_read_b32 v23, a131
    v_accvgpr_read_b32 v24, a132
    v_accvgpr_read_b32 v25, a133
    v_accvgpr_read_b32 v26, a134
    v_accvgpr_read_b32 v27, a135
    v_cvt_pk_bf16_f32 v36, v20, v21
    v_cvt_pk_bf16_f32 v37, v22, v23
    v_cvt_pk_bf16_f32 v38, v24, v25
    v_cvt_pk_bf16_f32 v39, v26, v27
    buffer_store_dwordx4 v[36:39], v251, s[4:7], s53 offen offset:0 sc1
    v_accvgpr_read_b32 v40, a136
    v_accvgpr_read_b32 v41, a137
    v_accvgpr_read_b32 v42, a138
    v_accvgpr_read_b32 v43, a139
    v_accvgpr_read_b32 v44, a140
    v_accvgpr_read_b32 v45, a141
    v_accvgpr_read_b32 v46, a142
    v_accvgpr_read_b32 v47, a143
    v_cvt_pk_bf16_f32 v56, v40, v41
    v_cvt_pk_bf16_f32 v57, v42, v43
    v_cvt_pk_bf16_f32 v58, v44, v45
    v_cvt_pk_bf16_f32 v59, v46, v47
    buffer_store_dwordx4 v[56:59], v251, s[4:7], s53 offen offset:1024 sc1
    v_accvgpr_read_b32 v0, a144
    v_accvgpr_read_b32 v1, a145
    v_accvgpr_read_b32 v2, a146
    v_accvgpr_read_b32 v3, a147
    v_accvgpr_read_b32 v4, a148
    v_accvgpr_read_b32 v5, a149
    v_accvgpr_read_b32 v6, a150
    v_accvgpr_read_b32 v7, a151
    v_cvt_pk_bf16_f32 v16, v0, v1
    v_cvt_pk_bf16_f32 v17, v2, v3
    v_cvt_pk_bf16_f32 v18, v4, v5
    v_cvt_pk_bf16_f32 v19, v6, v7
    buffer_store_dwordx4 v[16:19], v251, s[4:7], s53 offen offset:2048 sc1
    v_accvgpr_read_b32 v20, a152
    v_accvgpr_read_b32 v21, a153
    v_accvgpr_read_b32 v22, a154
    v_accvgpr_read_b32 v23, a155
    v_accvgpr_read_b32 v24, a156
    v_accvgpr_read_b32 v25, a157
    v_accvgpr_read_b32 v26, a158
    v_accvgpr_read_b32 v27, a159
    v_cvt_pk_bf16_f32 v36, v20, v21
    v_cvt_pk_bf16_f32 v37, v22, v23
    v_cvt_pk_bf16_f32 v38, v24, v25
    v_cvt_pk_bf16_f32 v39, v26, v27
    buffer_store_dwordx4 v[36:39], v251, s[4:7], s53 offen offset:3072 sc1
    s_add_u32 s53, s53, s22
    v_accvgpr_read_b32 v40, a160
    v_accvgpr_read_b32 v41, a161
    v_accvgpr_read_b32 v42, a162
    v_accvgpr_read_b32 v43, a163
    v_accvgpr_read_b32 v44, a164
    v_accvgpr_read_b32 v45, a165
    v_accvgpr_read_b32 v46, a166
    v_accvgpr_read_b32 v47, a167
    v_cvt_pk_bf16_f32 v56, v40, v41
    v_cvt_pk_bf16_f32 v57, v42, v43
    v_cvt_pk_bf16_f32 v58, v44, v45
    v_cvt_pk_bf16_f32 v59, v46, v47
    buffer_store_dwordx4 v[56:59], v251, s[4:7], s53 offen offset:0 sc1
    v_accvgpr_read_b32 v0, a168
    v_accvgpr_read_b32 v1, a169
    v_accvgpr_read_b32 v2, a170
    v_accvgpr_read_b32 v3, a171
    v_accvgpr_read_b32 v4, a172
    v_accvgpr_read_b32 v5, a173
    v_accvgpr_read_b32 v6, a174
    v_accvgpr_read_b32 v7, a175
    v_cvt_pk_bf16_f32 v16, v0, v1
    v_cvt_pk_bf16_f32 v17, v2, v3
    v_cvt_pk_bf16_f32 v18, v4, v5
    v_cvt_pk_bf16_f32 v19, v6, v7
    buffer_store_dwordx4 v[16:19], v251, s[4:7], s53 offen offset:1024 sc1
    v_accvgpr_read_b32 v20, a176
    v_accvgpr_read_b32 v21, a177
    v_accvgpr_read_b32 v22, a178
    v_accvgpr_read_b32 v23, a179
    v_accvgpr_read_b32 v24, a180
    v_accvgpr_read_b32 v25, a181
    v_accvgpr_read_b32 v26, a182
    v_accvgpr_read_b32 v27, a183
    v_cvt_pk_bf16_f32 v36, v20, v21
    v_cvt_pk_bf16_f32 v37, v22, v23
    v_cvt_pk_bf16_f32 v38, v24, v25
    v_cvt_pk_bf16_f32 v39, v26, v27
    buffer_store_dwordx4 v[36:39], v251, s[4:7], s53 offen offset:2048 sc1
    v_accvgpr_read_b32 v40, a184
    v_accvgpr_read_b32 v41, a185
    v_accvgpr_read_b32 v42, a186
    v_accvgpr_read_b32 v43, a187
    v_accvgpr_read_b32 v44, a188
    v_accvgpr_read_b32 v45, a189
    v_accvgpr_read_b32 v46, a190
    v_accvgpr_read_b32 v47, a191
    v_cvt_pk_bf16_f32 v56, v40, v41
    v_cvt_pk_bf16_f32 v57, v42, v43
    v_cvt_pk_bf16_f32 v58, v44, v45
    v_cvt_pk_bf16_f32 v59, v46, v47
    buffer_store_dwordx4 v[56:59], v251, s[4:7], s53 offen offset:3072 sc1
    s_add_u32 s53, s53, s22
    v_accvgpr_read_b32 v0, a192
    v_accvgpr_read_b32 v1, a193
    v_accvgpr_read_b32 v2, a194
    v_accvgpr_read_b32 v3, a195
    v_accvgpr_read_b32 v4, a196
    v_accvgpr_read_b32 v5, a197
    v_accvgpr_read_b32 v6, a198
    v_accvgpr_read_b32 v7, a199
    v_cvt_pk_bf16_f32 v16, v0, v1
    v_cvt_pk_bf16_f32 v17, v2, v3
    v_cvt_pk_bf16_f32 v18, v4, v5
    v_cvt_pk_bf16_f32 v19, v6, v7
    buffer_store_dwordx4 v[16:19], v251, s[4:7], s53 offen offset:0 sc1
    v_accvgpr_read_b32 v20, a200
    v_accvgpr_read_b32 v21, a201
    v_accvgpr_read_b32 v22, a202
    v_accvgpr_read_b32 v23, a203
    v_accvgpr_read_b32 v24, a204
    v_accvgpr_read_b32 v25, a205
    v_accvgpr_read_b32 v26, a206
    v_accvgpr_read_b32 v27, a207
    v_cvt_pk_bf16_f32 v36, v20, v21
    v_cvt_pk_bf16_f32 v37, v22, v23
    v_cvt_pk_bf16_f32 v38, v24, v25
    v_cvt_pk_bf16_f32 v39, v26, v27
    buffer_store_dwordx4 v[36:39], v251, s[4:7], s53 offen offset:1024 sc1
    v_accvgpr_read_b32 v40, a208
    v_accvgpr_read_b32 v41, a209
    v_accvgpr_read_b32 v42, a210
    v_accvgpr_read_b32 v43, a211
    v_accvgpr_read_b32 v44, a212
    v_accvgpr_read_b32 v45, a213
    v_accvgpr_read_b32 v46, a214
    v_accvgpr_read_b32 v47, a215
    v_cvt_pk_bf16_f32 v56, v40, v41
    v_cvt_pk_bf16_f32 v57, v42, v43
    v_cvt_pk_bf16_f32 v58, v44, v45
    v_cvt_pk_bf16_f32 v59, v46, v47
    buffer_store_dwordx4 v[56:59], v251, s[4:7], s53 offen offset:2048 sc1
    v_accvgpr_read_b32 v0, a216
    v_accvgpr_read_b32 v1, a217
    v_accvgpr_read_b32 v2, a218
    v_accvgpr_read_b32 v3, a219
    v_accvgpr_read_b32 v4, a220
    v_accvgpr_read_b32 v5, a221
    v_accvgpr_read_b32 v6, a222
    v_accvgpr_read_b32 v7, a223
    v_cvt_pk_bf16_f32 v16, v0, v1
    v_cvt_pk_bf16_f32 v17, v2, v3
    v_cvt_pk_bf16_f32 v18, v4, v5
    v_cvt_pk_bf16_f32 v19, v6, v7
    buffer_store_dwordx4 v[16:19], v251, s[4:7], s53 offen offset:3072 sc1
    s_add_u32 s53, s53, s22
    v_accvgpr_read_b32 v20, a224
    v_accvgpr_read_b32 v21, a225
    v_accvgpr_read_b32 v22, a226
    v_accvgpr_read_b32 v23, a227
    v_accvgpr_read_b32 v24, a228
    v_accvgpr_read_b32 v25, a229
    v_accvgpr_read_b32 v26, a230
    v_accvgpr_read_b32 v27, a231
    v_cvt_pk_bf16_f32 v36, v20, v21
    v_cvt_pk_bf16_f32 v37, v22, v23
    v_cvt_pk_bf16_f32 v38, v24, v25
    v_cvt_pk_bf16_f32 v39, v26, v27
    buffer_store_dwordx4 v[36:39], v251, s[4:7], s53 offen offset:0 sc1
    v_accvgpr_read_b32 v40, a232
    v_accvgpr_read_b32 v41, a233
    v_accvgpr_read_b32 v42, a234
    v_accvgpr_read_b32 v43, a235
    v_accvgpr_read_b32 v44, a236
    v_accvgpr_read_b32 v45, a237
    v_accvgpr_read_b32 v46, a238
    v_accvgpr_read_b32 v47, a239
    v_cvt_pk_bf16_f32 v56, v40, v41
    v_cvt_pk_bf16_f32 v57, v42, v43
    v_cvt_pk_bf16_f32 v58, v44, v45
    v_cvt_pk_bf16_f32 v59, v46, v47
    buffer_store_dwordx4 v[56:59], v251, s[4:7], s53 offen offset:1024 sc1
    v_accvgpr_read_b32 v0, a240
    v_accvgpr_read_b32 v1, a241
    v_accvgpr_read_b32 v2, a242
    v_accvgpr_read_b32 v3, a243
    v_accvgpr_read_b32 v4, a244
    v_accvgpr_read_b32 v5, a245
    v_accvgpr_read_b32 v6, a246
    v_accvgpr_read_b32 v7, a247
    v_cvt_pk_bf16_f32 v16, v0, v1
    v_cvt_pk_bf16_f32 v17, v2, v3
    v_cvt_pk_bf16_f32 v18, v4, v5
    v_cvt_pk_bf16_f32 v19, v6, v7
    buffer_store_dwordx4 v[16:19], v251, s[4:7], s53 offen offset:2048 sc1
    v_accvgpr_read_b32 v20, a248
    v_accvgpr_read_b32 v21, a249
    v_accvgpr_read_b32 v22, a250
    v_accvgpr_read_b32 v23, a251
    v_accvgpr_read_b32 v24, a252
    v_accvgpr_read_b32 v25, a253
    v_accvgpr_read_b32 v26, a254
    v_accvgpr_read_b32 v27, a255
    v_cvt_pk_bf16_f32 v36, v20, v21
    v_cvt_pk_bf16_f32 v37, v22, v23
    v_cvt_pk_bf16_f32 v38, v24, v25
    v_cvt_pk_bf16_f32 v39, v26, v27
    buffer_store_dwordx4 v[36:39], v251, s[4:7], s53 offen offset:3072 sc1
    s_branch main_kernel_w_done
main_kernel_w_c2_escl:
    s_mov_b32 s53, s21
    v_accvgpr_read_b32 v0, a0
    v_accvgpr_read_b32 v1, a1
    v_accvgpr_read_b32 v2, a2
    v_accvgpr_read_b32 v3, a3
    v_accvgpr_read_b32 v4, a4
    v_accvgpr_read_b32 v5, a5
    v_accvgpr_read_b32 v6, a6
    v_accvgpr_read_b32 v7, a7
    v_mul_f32 v0, 0x3e0293ee, v0
    v_mul_f32 v1, 0x3e0293ee, v1
    v_mul_f32 v2, 0x3e0293ee, v2
    v_mul_f32 v3, 0x3e0293ee, v3
    v_mul_f32 v4, 0x3e0293ee, v4
    v_mul_f32 v5, 0x3e0293ee, v5
    v_mul_f32 v6, 0x3e0293ee, v6
    v_mul_f32 v7, 0x3e0293ee, v7
    v_cvt_pk_bf16_f32 v16, v0, v1
    v_cvt_pk_bf16_f32 v17, v2, v3
    v_cvt_pk_bf16_f32 v18, v4, v5
    v_cvt_pk_bf16_f32 v19, v6, v7
    buffer_store_dwordx4 v[16:19], v251, s[4:7], s53 offen offset:0 sc1
    v_accvgpr_read_b32 v20, a8
    v_accvgpr_read_b32 v21, a9
    v_accvgpr_read_b32 v22, a10
    v_accvgpr_read_b32 v23, a11
    v_accvgpr_read_b32 v24, a12
    v_accvgpr_read_b32 v25, a13
    v_accvgpr_read_b32 v26, a14
    v_accvgpr_read_b32 v27, a15
    v_mul_f32 v20, 0x3e0293ee, v20
    v_mul_f32 v21, 0x3e0293ee, v21
    v_mul_f32 v22, 0x3e0293ee, v22
    v_mul_f32 v23, 0x3e0293ee, v23
    v_mul_f32 v24, 0x3e0293ee, v24
    v_mul_f32 v25, 0x3e0293ee, v25
    v_mul_f32 v26, 0x3e0293ee, v26
    v_mul_f32 v27, 0x3e0293ee, v27
    v_cvt_pk_bf16_f32 v36, v20, v21
    v_cvt_pk_bf16_f32 v37, v22, v23
    v_cvt_pk_bf16_f32 v38, v24, v25
    v_cvt_pk_bf16_f32 v39, v26, v27
    buffer_store_dwordx4 v[36:39], v251, s[4:7], s53 offen offset:1024 sc1
    v_accvgpr_read_b32 v40, a16
    v_accvgpr_read_b32 v41, a17
    v_accvgpr_read_b32 v42, a18
    v_accvgpr_read_b32 v43, a19
    v_accvgpr_read_b32 v44, a20
    v_accvgpr_read_b32 v45, a21
    v_accvgpr_read_b32 v46, a22
    v_accvgpr_read_b32 v47, a23
    v_mul_f32 v40, 0x3e0293ee, v40
    v_mul_f32 v41, 0x3e0293ee, v41
    v_mul_f32 v42, 0x3e0293ee, v42
    v_mul_f32 v43, 0x3e0293ee, v43
    v_mul_f32 v44, 0x3e0293ee, v44
    v_mul_f32 v45, 0x3e0293ee, v45
    v_mul_f32 v46, 0x3e0293ee, v46
    v_mul_f32 v47, 0x3e0293ee, v47
    v_cvt_pk_bf16_f32 v56, v40, v41
    v_cvt_pk_bf16_f32 v57, v42, v43
    v_cvt_pk_bf16_f32 v58, v44, v45
    v_cvt_pk_bf16_f32 v59, v46, v47
    buffer_store_dwordx4 v[56:59], v251, s[4:7], s53 offen offset:2048 sc1
    v_accvgpr_read_b32 v0, a24
    v_accvgpr_read_b32 v1, a25
    v_accvgpr_read_b32 v2, a26
    v_accvgpr_read_b32 v3, a27
    v_accvgpr_read_b32 v4, a28
    v_accvgpr_read_b32 v5, a29
    v_accvgpr_read_b32 v6, a30
    v_accvgpr_read_b32 v7, a31
    v_mul_f32 v0, 0x3e0293ee, v0
    v_mul_f32 v1, 0x3e0293ee, v1
    v_mul_f32 v2, 0x3e0293ee, v2
    v_mul_f32 v3, 0x3e0293ee, v3
    v_mul_f32 v4, 0x3e0293ee, v4
    v_mul_f32 v5, 0x3e0293ee, v5
    v_mul_f32 v6, 0x3e0293ee, v6
    v_mul_f32 v7, 0x3e0293ee, v7
    v_cvt_pk_bf16_f32 v16, v0, v1
    v_cvt_pk_bf16_f32 v17, v2, v3
    v_cvt_pk_bf16_f32 v18, v4, v5
    v_cvt_pk_bf16_f32 v19, v6, v7
    buffer_store_dwordx4 v[16:19], v251, s[4:7], s53 offen offset:3072 sc1
    s_add_u32 s53, s53, s22
    v_accvgpr_read_b32 v20, a32
    v_accvgpr_read_b32 v21, a33
    v_accvgpr_read_b32 v22, a34
    v_accvgpr_read_b32 v23, a35
    v_accvgpr_read_b32 v24, a36
    v_accvgpr_read_b32 v25, a37
    v_accvgpr_read_b32 v26, a38
    v_accvgpr_read_b32 v27, a39
    v_mul_f32 v20, 0x3e0293ee, v20
    v_mul_f32 v21, 0x3e0293ee, v21
    v_mul_f32 v22, 0x3e0293ee, v22
    v_mul_f32 v23, 0x3e0293ee, v23
    v_mul_f32 v24, 0x3e0293ee, v24
    v_mul_f32 v25, 0x3e0293ee, v25
    v_mul_f32 v26, 0x3e0293ee, v26
    v_mul_f32 v27, 0x3e0293ee, v27
    v_cvt_pk_bf16_f32 v36, v20, v21
    v_cvt_pk_bf16_f32 v37, v22, v23
    v_cvt_pk_bf16_f32 v38, v24, v25
    v_cvt_pk_bf16_f32 v39, v26, v27
    buffer_store_dwordx4 v[36:39], v251, s[4:7], s53 offen offset:0 sc1
    v_accvgpr_read_b32 v40, a40
    v_accvgpr_read_b32 v41, a41
    v_accvgpr_read_b32 v42, a42
    v_accvgpr_read_b32 v43, a43
    v_accvgpr_read_b32 v44, a44
    v_accvgpr_read_b32 v45, a45
    v_accvgpr_read_b32 v46, a46
    v_accvgpr_read_b32 v47, a47
    v_mul_f32 v40, 0x3e0293ee, v40
    v_mul_f32 v41, 0x3e0293ee, v41
    v_mul_f32 v42, 0x3e0293ee, v42
    v_mul_f32 v43, 0x3e0293ee, v43
    v_mul_f32 v44, 0x3e0293ee, v44
    v_mul_f32 v45, 0x3e0293ee, v45
    v_mul_f32 v46, 0x3e0293ee, v46
    v_mul_f32 v47, 0x3e0293ee, v47
    v_cvt_pk_bf16_f32 v56, v40, v41
    v_cvt_pk_bf16_f32 v57, v42, v43
    v_cvt_pk_bf16_f32 v58, v44, v45
    v_cvt_pk_bf16_f32 v59, v46, v47
    buffer_store_dwordx4 v[56:59], v251, s[4:7], s53 offen offset:1024 sc1
    v_accvgpr_read_b32 v0, a48
    v_accvgpr_read_b32 v1, a49
    v_accvgpr_read_b32 v2, a50
    v_accvgpr_read_b32 v3, a51
    v_accvgpr_read_b32 v4, a52
    v_accvgpr_read_b32 v5, a53
    v_accvgpr_read_b32 v6, a54
    v_accvgpr_read_b32 v7, a55
    v_mul_f32 v0, 0x3e0293ee, v0
    v_mul_f32 v1, 0x3e0293ee, v1
    v_mul_f32 v2, 0x3e0293ee, v2
    v_mul_f32 v3, 0x3e0293ee, v3
    v_mul_f32 v4, 0x3e0293ee, v4
    v_mul_f32 v5, 0x3e0293ee, v5
    v_mul_f32 v6, 0x3e0293ee, v6
    v_mul_f32 v7, 0x3e0293ee, v7
    v_cvt_pk_bf16_f32 v16, v0, v1
    v_cvt_pk_bf16_f32 v17, v2, v3
    v_cvt_pk_bf16_f32 v18, v4, v5
    v_cvt_pk_bf16_f32 v19, v6, v7
    buffer_store_dwordx4 v[16:19], v251, s[4:7], s53 offen offset:2048 sc1
    v_accvgpr_read_b32 v20, a56
    v_accvgpr_read_b32 v21, a57
    v_accvgpr_read_b32 v22, a58
    v_accvgpr_read_b32 v23, a59
    v_accvgpr_read_b32 v24, a60
    v_accvgpr_read_b32 v25, a61
    v_accvgpr_read_b32 v26, a62
    v_accvgpr_read_b32 v27, a63
    v_mul_f32 v20, 0x3e0293ee, v20
    v_mul_f32 v21, 0x3e0293ee, v21
    v_mul_f32 v22, 0x3e0293ee, v22
    v_mul_f32 v23, 0x3e0293ee, v23
    v_mul_f32 v24, 0x3e0293ee, v24
    v_mul_f32 v25, 0x3e0293ee, v25
    v_mul_f32 v26, 0x3e0293ee, v26
    v_mul_f32 v27, 0x3e0293ee, v27
    v_cvt_pk_bf16_f32 v36, v20, v21
    v_cvt_pk_bf16_f32 v37, v22, v23
    v_cvt_pk_bf16_f32 v38, v24, v25
    v_cvt_pk_bf16_f32 v39, v26, v27
    buffer_store_dwordx4 v[36:39], v251, s[4:7], s53 offen offset:3072 sc1
    s_add_u32 s53, s53, s22
    v_accvgpr_read_b32 v40, a64
    v_accvgpr_read_b32 v41, a65
    v_accvgpr_read_b32 v42, a66
    v_accvgpr_read_b32 v43, a67
    v_accvgpr_read_b32 v44, a68
    v_accvgpr_read_b32 v45, a69
    v_accvgpr_read_b32 v46, a70
    v_accvgpr_read_b32 v47, a71
    v_mul_f32 v40, 0x3e0293ee, v40
    v_mul_f32 v41, 0x3e0293ee, v41
    v_mul_f32 v42, 0x3e0293ee, v42
    v_mul_f32 v43, 0x3e0293ee, v43
    v_mul_f32 v44, 0x3e0293ee, v44
    v_mul_f32 v45, 0x3e0293ee, v45
    v_mul_f32 v46, 0x3e0293ee, v46
    v_mul_f32 v47, 0x3e0293ee, v47
    v_cvt_pk_bf16_f32 v56, v40, v41
    v_cvt_pk_bf16_f32 v57, v42, v43
    v_cvt_pk_bf16_f32 v58, v44, v45
    v_cvt_pk_bf16_f32 v59, v46, v47
    buffer_store_dwordx4 v[56:59], v251, s[4:7], s53 offen offset:0 sc1
    v_accvgpr_read_b32 v0, a72
    v_accvgpr_read_b32 v1, a73
    v_accvgpr_read_b32 v2, a74
    v_accvgpr_read_b32 v3, a75
    v_accvgpr_read_b32 v4, a76
    v_accvgpr_read_b32 v5, a77
    v_accvgpr_read_b32 v6, a78
    v_accvgpr_read_b32 v7, a79
    v_mul_f32 v0, 0x3e0293ee, v0
    v_mul_f32 v1, 0x3e0293ee, v1
    v_mul_f32 v2, 0x3e0293ee, v2
    v_mul_f32 v3, 0x3e0293ee, v3
    v_mul_f32 v4, 0x3e0293ee, v4
    v_mul_f32 v5, 0x3e0293ee, v5
    v_mul_f32 v6, 0x3e0293ee, v6
    v_mul_f32 v7, 0x3e0293ee, v7
    v_cvt_pk_bf16_f32 v16, v0, v1
    v_cvt_pk_bf16_f32 v17, v2, v3
    v_cvt_pk_bf16_f32 v18, v4, v5
    v_cvt_pk_bf16_f32 v19, v6, v7
    buffer_store_dwordx4 v[16:19], v251, s[4:7], s53 offen offset:1024 sc1
    v_accvgpr_read_b32 v20, a80
    v_accvgpr_read_b32 v21, a81
    v_accvgpr_read_b32 v22, a82
    v_accvgpr_read_b32 v23, a83
    v_accvgpr_read_b32 v24, a84
    v_accvgpr_read_b32 v25, a85
    v_accvgpr_read_b32 v26, a86
    v_accvgpr_read_b32 v27, a87
    v_mul_f32 v20, 0x3e0293ee, v20
    v_mul_f32 v21, 0x3e0293ee, v21
    v_mul_f32 v22, 0x3e0293ee, v22
    v_mul_f32 v23, 0x3e0293ee, v23
    v_mul_f32 v24, 0x3e0293ee, v24
    v_mul_f32 v25, 0x3e0293ee, v25
    v_mul_f32 v26, 0x3e0293ee, v26
    v_mul_f32 v27, 0x3e0293ee, v27
    v_cvt_pk_bf16_f32 v36, v20, v21
    v_cvt_pk_bf16_f32 v37, v22, v23
    v_cvt_pk_bf16_f32 v38, v24, v25
    v_cvt_pk_bf16_f32 v39, v26, v27
    buffer_store_dwordx4 v[36:39], v251, s[4:7], s53 offen offset:2048 sc1
    v_accvgpr_read_b32 v40, a88
    v_accvgpr_read_b32 v41, a89
    v_accvgpr_read_b32 v42, a90
    v_accvgpr_read_b32 v43, a91
    v_accvgpr_read_b32 v44, a92
    v_accvgpr_read_b32 v45, a93
    v_accvgpr_read_b32 v46, a94
    v_accvgpr_read_b32 v47, a95
    v_mul_f32 v40, 0x3e0293ee, v40
    v_mul_f32 v41, 0x3e0293ee, v41
    v_mul_f32 v42, 0x3e0293ee, v42
    v_mul_f32 v43, 0x3e0293ee, v43
    v_mul_f32 v44, 0x3e0293ee, v44
    v_mul_f32 v45, 0x3e0293ee, v45
    v_mul_f32 v46, 0x3e0293ee, v46
    v_mul_f32 v47, 0x3e0293ee, v47
    v_cvt_pk_bf16_f32 v56, v40, v41
    v_cvt_pk_bf16_f32 v57, v42, v43
    v_cvt_pk_bf16_f32 v58, v44, v45
    v_cvt_pk_bf16_f32 v59, v46, v47
    buffer_store_dwordx4 v[56:59], v251, s[4:7], s53 offen offset:3072 sc1
    s_add_u32 s53, s53, s22
    v_accvgpr_read_b32 v0, a96
    v_accvgpr_read_b32 v1, a97
    v_accvgpr_read_b32 v2, a98
    v_accvgpr_read_b32 v3, a99
    v_accvgpr_read_b32 v4, a100
    v_accvgpr_read_b32 v5, a101
    v_accvgpr_read_b32 v6, a102
    v_accvgpr_read_b32 v7, a103
    v_mul_f32 v0, 0x3e0293ee, v0
    v_mul_f32 v1, 0x3e0293ee, v1
    v_mul_f32 v2, 0x3e0293ee, v2
    v_mul_f32 v3, 0x3e0293ee, v3
    v_mul_f32 v4, 0x3e0293ee, v4
    v_mul_f32 v5, 0x3e0293ee, v5
    v_mul_f32 v6, 0x3e0293ee, v6
    v_mul_f32 v7, 0x3e0293ee, v7
    v_cvt_pk_bf16_f32 v16, v0, v1
    v_cvt_pk_bf16_f32 v17, v2, v3
    v_cvt_pk_bf16_f32 v18, v4, v5
    v_cvt_pk_bf16_f32 v19, v6, v7
    buffer_store_dwordx4 v[16:19], v251, s[4:7], s53 offen offset:0 sc1
    v_accvgpr_read_b32 v20, a104
    v_accvgpr_read_b32 v21, a105
    v_accvgpr_read_b32 v22, a106
    v_accvgpr_read_b32 v23, a107
    v_accvgpr_read_b32 v24, a108
    v_accvgpr_read_b32 v25, a109
    v_accvgpr_read_b32 v26, a110
    v_accvgpr_read_b32 v27, a111
    v_mul_f32 v20, 0x3e0293ee, v20
    v_mul_f32 v21, 0x3e0293ee, v21
    v_mul_f32 v22, 0x3e0293ee, v22
    v_mul_f32 v23, 0x3e0293ee, v23
    v_mul_f32 v24, 0x3e0293ee, v24
    v_mul_f32 v25, 0x3e0293ee, v25
    v_mul_f32 v26, 0x3e0293ee, v26
    v_mul_f32 v27, 0x3e0293ee, v27
    v_cvt_pk_bf16_f32 v36, v20, v21
    v_cvt_pk_bf16_f32 v37, v22, v23
    v_cvt_pk_bf16_f32 v38, v24, v25
    v_cvt_pk_bf16_f32 v39, v26, v27
    buffer_store_dwordx4 v[36:39], v251, s[4:7], s53 offen offset:1024 sc1
    v_accvgpr_read_b32 v40, a112
    v_accvgpr_read_b32 v41, a113
    v_accvgpr_read_b32 v42, a114
    v_accvgpr_read_b32 v43, a115
    v_accvgpr_read_b32 v44, a116
    v_accvgpr_read_b32 v45, a117
    v_accvgpr_read_b32 v46, a118
    v_accvgpr_read_b32 v47, a119
    v_mul_f32 v40, 0x3e0293ee, v40
    v_mul_f32 v41, 0x3e0293ee, v41
    v_mul_f32 v42, 0x3e0293ee, v42
    v_mul_f32 v43, 0x3e0293ee, v43
    v_mul_f32 v44, 0x3e0293ee, v44
    v_mul_f32 v45, 0x3e0293ee, v45
    v_mul_f32 v46, 0x3e0293ee, v46
    v_mul_f32 v47, 0x3e0293ee, v47
    v_cvt_pk_bf16_f32 v56, v40, v41
    v_cvt_pk_bf16_f32 v57, v42, v43
    v_cvt_pk_bf16_f32 v58, v44, v45
    v_cvt_pk_bf16_f32 v59, v46, v47
    buffer_store_dwordx4 v[56:59], v251, s[4:7], s53 offen offset:2048 sc1
    v_accvgpr_read_b32 v0, a120
    v_accvgpr_read_b32 v1, a121
    v_accvgpr_read_b32 v2, a122
    v_accvgpr_read_b32 v3, a123
    v_accvgpr_read_b32 v4, a124
    v_accvgpr_read_b32 v5, a125
    v_accvgpr_read_b32 v6, a126
    v_accvgpr_read_b32 v7, a127
    v_mul_f32 v0, 0x3e0293ee, v0
    v_mul_f32 v1, 0x3e0293ee, v1
    v_mul_f32 v2, 0x3e0293ee, v2
    v_mul_f32 v3, 0x3e0293ee, v3
    v_mul_f32 v4, 0x3e0293ee, v4
    v_mul_f32 v5, 0x3e0293ee, v5
    v_mul_f32 v6, 0x3e0293ee, v6
    v_mul_f32 v7, 0x3e0293ee, v7
    v_cvt_pk_bf16_f32 v16, v0, v1
    v_cvt_pk_bf16_f32 v17, v2, v3
    v_cvt_pk_bf16_f32 v18, v4, v5
    v_cvt_pk_bf16_f32 v19, v6, v7
    buffer_store_dwordx4 v[16:19], v251, s[4:7], s53 offen offset:3072 sc1
    s_add_u32 s53, s53, s22
    v_accvgpr_read_b32 v20, a128
    v_accvgpr_read_b32 v21, a129
    v_accvgpr_read_b32 v22, a130
    v_accvgpr_read_b32 v23, a131
    v_accvgpr_read_b32 v24, a132
    v_accvgpr_read_b32 v25, a133
    v_accvgpr_read_b32 v26, a134
    v_accvgpr_read_b32 v27, a135
    v_mul_f32 v20, 0x3e0293ee, v20
    v_mul_f32 v21, 0x3e0293ee, v21
    v_mul_f32 v22, 0x3e0293ee, v22
    v_mul_f32 v23, 0x3e0293ee, v23
    v_mul_f32 v24, 0x3e0293ee, v24
    v_mul_f32 v25, 0x3e0293ee, v25
    v_mul_f32 v26, 0x3e0293ee, v26
    v_mul_f32 v27, 0x3e0293ee, v27
    v_cvt_pk_bf16_f32 v36, v20, v21
    v_cvt_pk_bf16_f32 v37, v22, v23
    v_cvt_pk_bf16_f32 v38, v24, v25
    v_cvt_pk_bf16_f32 v39, v26, v27
    buffer_store_dwordx4 v[36:39], v251, s[4:7], s53 offen offset:0 sc1
    v_accvgpr_read_b32 v40, a136
    v_accvgpr_read_b32 v41, a137
    v_accvgpr_read_b32 v42, a138
    v_accvgpr_read_b32 v43, a139
    v_accvgpr_read_b32 v44, a140
    v_accvgpr_read_b32 v45, a141
    v_accvgpr_read_b32 v46, a142
    v_accvgpr_read_b32 v47, a143
    v_mul_f32 v40, 0x3e0293ee, v40
    v_mul_f32 v41, 0x3e0293ee, v41
    v_mul_f32 v42, 0x3e0293ee, v42
    v_mul_f32 v43, 0x3e0293ee, v43
    v_mul_f32 v44, 0x3e0293ee, v44
    v_mul_f32 v45, 0x3e0293ee, v45
    v_mul_f32 v46, 0x3e0293ee, v46
    v_mul_f32 v47, 0x3e0293ee, v47
    v_cvt_pk_bf16_f32 v56, v40, v41
    v_cvt_pk_bf16_f32 v57, v42, v43
    v_cvt_pk_bf16_f32 v58, v44, v45
    v_cvt_pk_bf16_f32 v59, v46, v47
    buffer_store_dwordx4 v[56:59], v251, s[4:7], s53 offen offset:1024 sc1
    v_accvgpr_read_b32 v0, a144
    v_accvgpr_read_b32 v1, a145
    v_accvgpr_read_b32 v2, a146
    v_accvgpr_read_b32 v3, a147
    v_accvgpr_read_b32 v4, a148
    v_accvgpr_read_b32 v5, a149
    v_accvgpr_read_b32 v6, a150
    v_accvgpr_read_b32 v7, a151
    v_mul_f32 v0, 0x3e0293ee, v0
    v_mul_f32 v1, 0x3e0293ee, v1
    v_mul_f32 v2, 0x3e0293ee, v2
    v_mul_f32 v3, 0x3e0293ee, v3
    v_mul_f32 v4, 0x3e0293ee, v4
    v_mul_f32 v5, 0x3e0293ee, v5
    v_mul_f32 v6, 0x3e0293ee, v6
    v_mul_f32 v7, 0x3e0293ee, v7
    v_cvt_pk_bf16_f32 v16, v0, v1
    v_cvt_pk_bf16_f32 v17, v2, v3
    v_cvt_pk_bf16_f32 v18, v4, v5
    v_cvt_pk_bf16_f32 v19, v6, v7
    buffer_store_dwordx4 v[16:19], v251, s[4:7], s53 offen offset:2048 sc1
    v_accvgpr_read_b32 v20, a152
    v_accvgpr_read_b32 v21, a153
    v_accvgpr_read_b32 v22, a154
    v_accvgpr_read_b32 v23, a155
    v_accvgpr_read_b32 v24, a156
    v_accvgpr_read_b32 v25, a157
    v_accvgpr_read_b32 v26, a158
    v_accvgpr_read_b32 v27, a159
    v_mul_f32 v20, 0x3e0293ee, v20
    v_mul_f32 v21, 0x3e0293ee, v21
    v_mul_f32 v22, 0x3e0293ee, v22
    v_mul_f32 v23, 0x3e0293ee, v23
    v_mul_f32 v24, 0x3e0293ee, v24
    v_mul_f32 v25, 0x3e0293ee, v25
    v_mul_f32 v26, 0x3e0293ee, v26
    v_mul_f32 v27, 0x3e0293ee, v27
    v_cvt_pk_bf16_f32 v36, v20, v21
    v_cvt_pk_bf16_f32 v37, v22, v23
    v_cvt_pk_bf16_f32 v38, v24, v25
    v_cvt_pk_bf16_f32 v39, v26, v27
    buffer_store_dwordx4 v[36:39], v251, s[4:7], s53 offen offset:3072 sc1
    s_add_u32 s53, s53, s22
    v_accvgpr_read_b32 v40, a160
    v_accvgpr_read_b32 v41, a161
    v_accvgpr_read_b32 v42, a162
    v_accvgpr_read_b32 v43, a163
    v_accvgpr_read_b32 v44, a164
    v_accvgpr_read_b32 v45, a165
    v_accvgpr_read_b32 v46, a166
    v_accvgpr_read_b32 v47, a167
    v_mul_f32 v40, 0x3e0293ee, v40
    v_mul_f32 v41, 0x3e0293ee, v41
    v_mul_f32 v42, 0x3e0293ee, v42
    v_mul_f32 v43, 0x3e0293ee, v43
    v_mul_f32 v44, 0x3e0293ee, v44
    v_mul_f32 v45, 0x3e0293ee, v45
    v_mul_f32 v46, 0x3e0293ee, v46
    v_mul_f32 v47, 0x3e0293ee, v47
    v_cvt_pk_bf16_f32 v56, v40, v41
    v_cvt_pk_bf16_f32 v57, v42, v43
    v_cvt_pk_bf16_f32 v58, v44, v45
    v_cvt_pk_bf16_f32 v59, v46, v47
    buffer_store_dwordx4 v[56:59], v251, s[4:7], s53 offen offset:0 sc1
    v_accvgpr_read_b32 v0, a168
    v_accvgpr_read_b32 v1, a169
    v_accvgpr_read_b32 v2, a170
    v_accvgpr_read_b32 v3, a171
    v_accvgpr_read_b32 v4, a172
    v_accvgpr_read_b32 v5, a173
    v_accvgpr_read_b32 v6, a174
    v_accvgpr_read_b32 v7, a175
    v_mul_f32 v0, 0x3e0293ee, v0
    v_mul_f32 v1, 0x3e0293ee, v1
    v_mul_f32 v2, 0x3e0293ee, v2
    v_mul_f32 v3, 0x3e0293ee, v3
    v_mul_f32 v4, 0x3e0293ee, v4
    v_mul_f32 v5, 0x3e0293ee, v5
    v_mul_f32 v6, 0x3e0293ee, v6
    v_mul_f32 v7, 0x3e0293ee, v7
    v_cvt_pk_bf16_f32 v16, v0, v1
    v_cvt_pk_bf16_f32 v17, v2, v3
    v_cvt_pk_bf16_f32 v18, v4, v5
    v_cvt_pk_bf16_f32 v19, v6, v7
    buffer_store_dwordx4 v[16:19], v251, s[4:7], s53 offen offset:1024 sc1
    v_accvgpr_read_b32 v20, a176
    v_accvgpr_read_b32 v21, a177
    v_accvgpr_read_b32 v22, a178
    v_accvgpr_read_b32 v23, a179
    v_accvgpr_read_b32 v24, a180
    v_accvgpr_read_b32 v25, a181
    v_accvgpr_read_b32 v26, a182
    v_accvgpr_read_b32 v27, a183
    v_mul_f32 v20, 0x3e0293ee, v20
    v_mul_f32 v21, 0x3e0293ee, v21
    v_mul_f32 v22, 0x3e0293ee, v22
    v_mul_f32 v23, 0x3e0293ee, v23
    v_mul_f32 v24, 0x3e0293ee, v24
    v_mul_f32 v25, 0x3e0293ee, v25
    v_mul_f32 v26, 0x3e0293ee, v26
    v_mul_f32 v27, 0x3e0293ee, v27
    v_cvt_pk_bf16_f32 v36, v20, v21
    v_cvt_pk_bf16_f32 v37, v22, v23
    v_cvt_pk_bf16_f32 v38, v24, v25
    v_cvt_pk_bf16_f32 v39, v26, v27
    buffer_store_dwordx4 v[36:39], v251, s[4:7], s53 offen offset:2048 sc1
    v_accvgpr_read_b32 v40, a184
    v_accvgpr_read_b32 v41, a185
    v_accvgpr_read_b32 v42, a186
    v_accvgpr_read_b32 v43, a187
    v_accvgpr_read_b32 v44, a188
    v_accvgpr_read_b32 v45, a189
    v_accvgpr_read_b32 v46, a190
    v_accvgpr_read_b32 v47, a191
    v_mul_f32 v40, 0x3e0293ee, v40
    v_mul_f32 v41, 0x3e0293ee, v41
    v_mul_f32 v42, 0x3e0293ee, v42
    v_mul_f32 v43, 0x3e0293ee, v43
    v_mul_f32 v44, 0x3e0293ee, v44
    v_mul_f32 v45, 0x3e0293ee, v45
    v_mul_f32 v46, 0x3e0293ee, v46
    v_mul_f32 v47, 0x3e0293ee, v47
    v_cvt_pk_bf16_f32 v56, v40, v41
    v_cvt_pk_bf16_f32 v57, v42, v43
    v_cvt_pk_bf16_f32 v58, v44, v45
    v_cvt_pk_bf16_f32 v59, v46, v47
    buffer_store_dwordx4 v[56:59], v251, s[4:7], s53 offen offset:3072 sc1
    s_add_u32 s53, s53, s22
    v_accvgpr_read_b32 v0, a192
    v_accvgpr_read_b32 v1, a193
    v_accvgpr_read_b32 v2, a194
    v_accvgpr_read_b32 v3, a195
    v_accvgpr_read_b32 v4, a196
    v_accvgpr_read_b32 v5, a197
    v_accvgpr_read_b32 v6, a198
    v_accvgpr_read_b32 v7, a199
    v_mul_f32 v0, 0x3e0293ee, v0
    v_mul_f32 v1, 0x3e0293ee, v1
    v_mul_f32 v2, 0x3e0293ee, v2
    v_mul_f32 v3, 0x3e0293ee, v3
    v_mul_f32 v4, 0x3e0293ee, v4
    v_mul_f32 v5, 0x3e0293ee, v5
    v_mul_f32 v6, 0x3e0293ee, v6
    v_mul_f32 v7, 0x3e0293ee, v7
    v_cvt_pk_bf16_f32 v16, v0, v1
    v_cvt_pk_bf16_f32 v17, v2, v3
    v_cvt_pk_bf16_f32 v18, v4, v5
    v_cvt_pk_bf16_f32 v19, v6, v7
    buffer_store_dwordx4 v[16:19], v251, s[4:7], s53 offen offset:0 sc1
    v_accvgpr_read_b32 v20, a200
    v_accvgpr_read_b32 v21, a201
    v_accvgpr_read_b32 v22, a202
    v_accvgpr_read_b32 v23, a203
    v_accvgpr_read_b32 v24, a204
    v_accvgpr_read_b32 v25, a205
    v_accvgpr_read_b32 v26, a206
    v_accvgpr_read_b32 v27, a207
    v_mul_f32 v20, 0x3e0293ee, v20
    v_mul_f32 v21, 0x3e0293ee, v21
    v_mul_f32 v22, 0x3e0293ee, v22
    v_mul_f32 v23, 0x3e0293ee, v23
    v_mul_f32 v24, 0x3e0293ee, v24
    v_mul_f32 v25, 0x3e0293ee, v25
    v_mul_f32 v26, 0x3e0293ee, v26
    v_mul_f32 v27, 0x3e0293ee, v27
    v_cvt_pk_bf16_f32 v36, v20, v21
    v_cvt_pk_bf16_f32 v37, v22, v23
    v_cvt_pk_bf16_f32 v38, v24, v25
    v_cvt_pk_bf16_f32 v39, v26, v27
    buffer_store_dwordx4 v[36:39], v251, s[4:7], s53 offen offset:1024 sc1
    v_accvgpr_read_b32 v40, a208
    v_accvgpr_read_b32 v41, a209
    v_accvgpr_read_b32 v42, a210
    v_accvgpr_read_b32 v43, a211
    v_accvgpr_read_b32 v44, a212
    v_accvgpr_read_b32 v45, a213
    v_accvgpr_read_b32 v46, a214
    v_accvgpr_read_b32 v47, a215
    v_mul_f32 v40, 0x3e0293ee, v40
    v_mul_f32 v41, 0x3e0293ee, v41
    v_mul_f32 v42, 0x3e0293ee, v42
    v_mul_f32 v43, 0x3e0293ee, v43
    v_mul_f32 v44, 0x3e0293ee, v44
    v_mul_f32 v45, 0x3e0293ee, v45
    v_mul_f32 v46, 0x3e0293ee, v46
    v_mul_f32 v47, 0x3e0293ee, v47
    v_cvt_pk_bf16_f32 v56, v40, v41
    v_cvt_pk_bf16_f32 v57, v42, v43
    v_cvt_pk_bf16_f32 v58, v44, v45
    v_cvt_pk_bf16_f32 v59, v46, v47
    buffer_store_dwordx4 v[56:59], v251, s[4:7], s53 offen offset:2048 sc1
    v_accvgpr_read_b32 v0, a216
    v_accvgpr_read_b32 v1, a217
    v_accvgpr_read_b32 v2, a218
    v_accvgpr_read_b32 v3, a219
    v_accvgpr_read_b32 v4, a220
    v_accvgpr_read_b32 v5, a221
    v_accvgpr_read_b32 v6, a222
    v_accvgpr_read_b32 v7, a223
    v_mul_f32 v0, 0x3e0293ee, v0
    v_mul_f32 v1, 0x3e0293ee, v1
    v_mul_f32 v2, 0x3e0293ee, v2
    v_mul_f32 v3, 0x3e0293ee, v3
    v_mul_f32 v4, 0x3e0293ee, v4
    v_mul_f32 v5, 0x3e0293ee, v5
    v_mul_f32 v6, 0x3e0293ee, v6
    v_mul_f32 v7, 0x3e0293ee, v7
    v_cvt_pk_bf16_f32 v16, v0, v1
    v_cvt_pk_bf16_f32 v17, v2, v3
    v_cvt_pk_bf16_f32 v18, v4, v5
    v_cvt_pk_bf16_f32 v19, v6, v7
    buffer_store_dwordx4 v[16:19], v251, s[4:7], s53 offen offset:3072 sc1
    s_add_u32 s53, s53, s22
    v_accvgpr_read_b32 v20, a224
    v_accvgpr_read_b32 v21, a225
    v_accvgpr_read_b32 v22, a226
    v_accvgpr_read_b32 v23, a227
    v_accvgpr_read_b32 v24, a228
    v_accvgpr_read_b32 v25, a229
    v_accvgpr_read_b32 v26, a230
    v_accvgpr_read_b32 v27, a231
    v_mul_f32 v20, 0x3e0293ee, v20
    v_mul_f32 v21, 0x3e0293ee, v21
    v_mul_f32 v22, 0x3e0293ee, v22
    v_mul_f32 v23, 0x3e0293ee, v23
    v_mul_f32 v24, 0x3e0293ee, v24
    v_mul_f32 v25, 0x3e0293ee, v25
    v_mul_f32 v26, 0x3e0293ee, v26
    v_mul_f32 v27, 0x3e0293ee, v27
    v_cvt_pk_bf16_f32 v36, v20, v21
    v_cvt_pk_bf16_f32 v37, v22, v23
    v_cvt_pk_bf16_f32 v38, v24, v25
    v_cvt_pk_bf16_f32 v39, v26, v27
    buffer_store_dwordx4 v[36:39], v251, s[4:7], s53 offen offset:0 sc1
    v_accvgpr_read_b32 v40, a232
    v_accvgpr_read_b32 v41, a233
    v_accvgpr_read_b32 v42, a234
    v_accvgpr_read_b32 v43, a235
    v_accvgpr_read_b32 v44, a236
    v_accvgpr_read_b32 v45, a237
    v_accvgpr_read_b32 v46, a238
    v_accvgpr_read_b32 v47, a239
    v_mul_f32 v40, 0x3e0293ee, v40
    v_mul_f32 v41, 0x3e0293ee, v41
    v_mul_f32 v42, 0x3e0293ee, v42
    v_mul_f32 v43, 0x3e0293ee, v43
    v_mul_f32 v44, 0x3e0293ee, v44
    v_mul_f32 v45, 0x3e0293ee, v45
    v_mul_f32 v46, 0x3e0293ee, v46
    v_mul_f32 v47, 0x3e0293ee, v47
    v_cvt_pk_bf16_f32 v56, v40, v41
    v_cvt_pk_bf16_f32 v57, v42, v43
    v_cvt_pk_bf16_f32 v58, v44, v45
    v_cvt_pk_bf16_f32 v59, v46, v47
    buffer_store_dwordx4 v[56:59], v251, s[4:7], s53 offen offset:1024 sc1
    v_accvgpr_read_b32 v0, a240
    v_accvgpr_read_b32 v1, a241
    v_accvgpr_read_b32 v2, a242
    v_accvgpr_read_b32 v3, a243
    v_accvgpr_read_b32 v4, a244
    v_accvgpr_read_b32 v5, a245
    v_accvgpr_read_b32 v6, a246
    v_accvgpr_read_b32 v7, a247
    v_mul_f32 v0, 0x3e0293ee, v0
    v_mul_f32 v1, 0x3e0293ee, v1
    v_mul_f32 v2, 0x3e0293ee, v2
    v_mul_f32 v3, 0x3e0293ee, v3
    v_mul_f32 v4, 0x3e0293ee, v4
    v_mul_f32 v5, 0x3e0293ee, v5
    v_mul_f32 v6, 0x3e0293ee, v6
    v_mul_f32 v7, 0x3e0293ee, v7
    v_cvt_pk_bf16_f32 v16, v0, v1
    v_cvt_pk_bf16_f32 v17, v2, v3
    v_cvt_pk_bf16_f32 v18, v4, v5
    v_cvt_pk_bf16_f32 v19, v6, v7
    buffer_store_dwordx4 v[16:19], v251, s[4:7], s53 offen offset:2048 sc1
    v_accvgpr_read_b32 v20, a248
    v_accvgpr_read_b32 v21, a249
    v_accvgpr_read_b32 v22, a250
    v_accvgpr_read_b32 v23, a251
    v_accvgpr_read_b32 v24, a252
    v_accvgpr_read_b32 v25, a253
    v_accvgpr_read_b32 v26, a254
    v_accvgpr_read_b32 v27, a255
    v_mul_f32 v20, 0x3e0293ee, v20
    v_mul_f32 v21, 0x3e0293ee, v21
    v_mul_f32 v22, 0x3e0293ee, v22
    v_mul_f32 v23, 0x3e0293ee, v23
    v_mul_f32 v24, 0x3e0293ee, v24
    v_mul_f32 v25, 0x3e0293ee, v25
    v_mul_f32 v26, 0x3e0293ee, v26
    v_mul_f32 v27, 0x3e0293ee, v27
    v_cvt_pk_bf16_f32 v36, v20, v21
    v_cvt_pk_bf16_f32 v37, v22, v23
    v_cvt_pk_bf16_f32 v38, v24, v25
    v_cvt_pk_bf16_f32 v39, v26, v27
    buffer_store_dwordx4 v[36:39], v251, s[4:7], s53 offen offset:3072 sc1
    s_branch main_kernel_w_done
main_kernel_w_c2_egelu:
    s_mov_b32 s53, s21
    v_accvgpr_read_b32 v0, a0
    v_accvgpr_read_b32 v1, a1
    v_accvgpr_read_b32 v2, a2
    v_accvgpr_read_b32 v3, a3
    v_accvgpr_read_b32 v4, a4
    v_accvgpr_read_b32 v5, a5
    v_accvgpr_read_b32 v6, a6
    v_accvgpr_read_b32 v7, a7
    v_pk_mul_f32 v[8:9], v[0:1], v[0:1]
    v_pk_mul_f32 v[10:11], v[2:3], v[2:3]
    v_pk_mul_f32 v[12:13], v[4:5], v[4:5]
    v_pk_mul_f32 v[14:15], v[6:7], v[6:7]
    v_pk_fma_f32 v[8:9], v[8:9], v[242:243], v[240:241]
    v_pk_fma_f32 v[10:11], v[10:11], v[242:243], v[240:241]
    v_pk_fma_f32 v[12:13], v[12:13], v[242:243], v[240:241]
    v_pk_fma_f32 v[14:15], v[14:15], v[242:243], v[240:241]
    v_pk_mul_f32 v[8:9], v[8:9], v[0:1]
    v_pk_mul_f32 v[10:11], v[10:11], v[2:3]
    v_pk_mul_f32 v[12:13], v[12:13], v[4:5]
    v_pk_mul_f32 v[14:15], v[14:15], v[6:7]
    v_exp_f32 v8, v8
    v_exp_f32 v9, v9
    v_exp_f32 v10, v10
    v_exp_f32 v11, v11
    v_exp_f32 v12, v12
    v_exp_f32 v13, v13
    v_exp_f32 v14, v14
    v_exp_f32 v15, v15
    v_pk_add_f32 v[8:9], v[8:9], v[244:245]
    v_pk_add_f32 v[10:11], v[10:11], v[244:245]
    v_pk_add_f32 v[12:13], v[12:13], v[244:245]
    v_pk_add_f32 v[14:15], v[14:15], v[244:245]
    v_rcp_f32 v8, v8
    v_rcp_f32 v9, v9
    v_rcp_f32 v10, v10
    v_rcp_f32 v11, v11
    v_rcp_f32 v12, v12
    v_rcp_f32 v13, v13
    v_rcp_f32 v14, v14
    v_rcp_f32 v15, v15
    v_pk_mul_f32 v[0:1], v[8:9], v[0:1]
    v_pk_mul_f32 v[2:3], v[10:11], v[2:3]
    v_pk_mul_f32 v[4:5], v[12:13], v[4:5]
    v_pk_mul_f32 v[6:7], v[14:15], v[6:7]
    v_cvt_pk_bf16_f32 v16, v0, v1
    v_cvt_pk_bf16_f32 v17, v2, v3
    v_cvt_pk_bf16_f32 v18, v4, v5
    v_cvt_pk_bf16_f32 v19, v6, v7
    buffer_store_dwordx4 v[16:19], v251, s[4:7], s53 offen offset:0 sc1
    v_accvgpr_read_b32 v20, a8
    v_accvgpr_read_b32 v21, a9
    v_accvgpr_read_b32 v22, a10
    v_accvgpr_read_b32 v23, a11
    v_accvgpr_read_b32 v24, a12
    v_accvgpr_read_b32 v25, a13
    v_accvgpr_read_b32 v26, a14
    v_accvgpr_read_b32 v27, a15
    v_pk_mul_f32 v[28:29], v[20:21], v[20:21]
    v_pk_mul_f32 v[30:31], v[22:23], v[22:23]
    v_pk_mul_f32 v[32:33], v[24:25], v[24:25]
    v_pk_mul_f32 v[34:35], v[26:27], v[26:27]
    v_pk_fma_f32 v[28:29], v[28:29], v[242:243], v[240:241]
    v_pk_fma_f32 v[30:31], v[30:31], v[242:243], v[240:241]
    v_pk_fma_f32 v[32:33], v[32:33], v[242:243], v[240:241]
    v_pk_fma_f32 v[34:35], v[34:35], v[242:243], v[240:241]
    v_pk_mul_f32 v[28:29], v[28:29], v[20:21]
    v_pk_mul_f32 v[30:31], v[30:31], v[22:23]
    v_pk_mul_f32 v[32:33], v[32:33], v[24:25]
    v_pk_mul_f32 v[34:35], v[34:35], v[26:27]
    v_exp_f32 v28, v28
    v_exp_f32 v29, v29
    v_exp_f32 v30, v30
    v_exp_f32 v31, v31
    v_exp_f32 v32, v32
    v_exp_f32 v33, v33
    v_exp_f32 v34, v34
    v_exp_f32 v35, v35
    v_pk_add_f32 v[28:29], v[28:29], v[244:245]
    v_pk_add_f32 v[30:31], v[30:31], v[244:245]
    v_pk_add_f32 v[32:33], v[32:33], v[244:245]
    v_pk_add_f32 v[34:35], v[34:35], v[244:245]
    v_rcp_f32 v28, v28
    v_rcp_f32 v29, v29
    v_rcp_f32 v30, v30
    v_rcp_f32 v31, v31
    v_rcp_f32 v32, v32
    v_rcp_f32 v33, v33
    v_rcp_f32 v34, v34
    v_rcp_f32 v35, v35
    v_pk_mul_f32 v[20:21], v[28:29], v[20:21]
    v_pk_mul_f32 v[22:23], v[30:31], v[22:23]
    v_pk_mul_f32 v[24:25], v[32:33], v[24:25]
    v_pk_mul_f32 v[26:27], v[34:35], v[26:27]
    v_cvt_pk_bf16_f32 v36, v20, v21
    v_cvt_pk_bf16_f32 v37, v22, v23
    v_cvt_pk_bf16_f32 v38, v24, v25
    v_cvt_pk_bf16_f32 v39, v26, v27
    buffer_store_dwordx4 v[36:39], v251, s[4:7], s53 offen offset:1024 sc1
    v_accvgpr_read_b32 v40, a16
    v_accvgpr_read_b32 v41, a17
    v_accvgpr_read_b32 v42, a18
    v_accvgpr_read_b32 v43, a19
    v_accvgpr_read_b32 v44, a20
    v_accvgpr_read_b32 v45, a21
    v_accvgpr_read_b32 v46, a22
    v_accvgpr_read_b32 v47, a23
    v_pk_mul_f32 v[48:49], v[40:41], v[40:41]
    v_pk_mul_f32 v[50:51], v[42:43], v[42:43]
    v_pk_mul_f32 v[52:53], v[44:45], v[44:45]
    v_pk_mul_f32 v[54:55], v[46:47], v[46:47]
    v_pk_fma_f32 v[48:49], v[48:49], v[242:243], v[240:241]
    v_pk_fma_f32 v[50:51], v[50:51], v[242:243], v[240:241]
    v_pk_fma_f32 v[52:53], v[52:53], v[242:243], v[240:241]
    v_pk_fma_f32 v[54:55], v[54:55], v[242:243], v[240:241]
    v_pk_mul_f32 v[48:49], v[48:49], v[40:41]
    v_pk_mul_f32 v[50:51], v[50:51], v[42:43]
    v_pk_mul_f32 v[52:53], v[52:53], v[44:45]
    v_pk_mul_f32 v[54:55], v[54:55], v[46:47]
    v_exp_f32 v48, v48
    v_exp_f32 v49, v49
    v_exp_f32 v50, v50
    v_exp_f32 v51, v51
    v_exp_f32 v52, v52
    v_exp_f32 v53, v53
    v_exp_f32 v54, v54
    v_exp_f32 v55, v55
    v_pk_add_f32 v[48:49], v[48:49], v[244:245]
    v_pk_add_f32 v[50:51], v[50:51], v[244:245]
    v_pk_add_f32 v[52:53], v[52:53], v[244:245]
    v_pk_add_f32 v[54:55], v[54:55], v[244:245]
    v_rcp_f32 v48, v48
    v_rcp_f32 v49, v49
    v_rcp_f32 v50, v50
    v_rcp_f32 v51, v51
    v_rcp_f32 v52, v52
    v_rcp_f32 v53, v53
    v_rcp_f32 v54, v54
    v_rcp_f32 v55, v55
    v_pk_mul_f32 v[40:41], v[48:49], v[40:41]
    v_pk_mul_f32 v[42:43], v[50:51], v[42:43]
    v_pk_mul_f32 v[44:45], v[52:53], v[44:45]
    v_pk_mul_f32 v[46:47], v[54:55], v[46:47]
    v_cvt_pk_bf16_f32 v56, v40, v41
    v_cvt_pk_bf16_f32 v57, v42, v43
    v_cvt_pk_bf16_f32 v58, v44, v45
    v_cvt_pk_bf16_f32 v59, v46, v47
    buffer_store_dwordx4 v[56:59], v251, s[4:7], s53 offen offset:2048 sc1
    v_accvgpr_read_b32 v0, a24
    v_accvgpr_read_b32 v1, a25
    v_accvgpr_read_b32 v2, a26
    v_accvgpr_read_b32 v3, a27
    v_accvgpr_read_b32 v4, a28
    v_accvgpr_read_b32 v5, a29
    v_accvgpr_read_b32 v6, a30
    v_accvgpr_read_b32 v7, a31
    v_pk_mul_f32 v[8:9], v[0:1], v[0:1]
    v_pk_mul_f32 v[10:11], v[2:3], v[2:3]
    v_pk_mul_f32 v[12:13], v[4:5], v[4:5]
    v_pk_mul_f32 v[14:15], v[6:7], v[6:7]
    v_pk_fma_f32 v[8:9], v[8:9], v[242:243], v[240:241]
    v_pk_fma_f32 v[10:11], v[10:11], v[242:243], v[240:241]
    v_pk_fma_f32 v[12:13], v[12:13], v[242:243], v[240:241]
    v_pk_fma_f32 v[14:15], v[14:15], v[242:243], v[240:241]
    v_pk_mul_f32 v[8:9], v[8:9], v[0:1]
    v_pk_mul_f32 v[10:11], v[10:11], v[2:3]
    v_pk_mul_f32 v[12:13], v[12:13], v[4:5]
    v_pk_mul_f32 v[14:15], v[14:15], v[6:7]
    v_exp_f32 v8, v8
    v_exp_f32 v9, v9
    v_exp_f32 v10, v10
    v_exp_f32 v11, v11
    v_exp_f32 v12, v12
    v_exp_f32 v13, v13
    v_exp_f32 v14, v14
    v_exp_f32 v15, v15
    v_pk_add_f32 v[8:9], v[8:9], v[244:245]
    v_pk_add_f32 v[10:11], v[10:11], v[244:245]
    v_pk_add_f32 v[12:13], v[12:13], v[244:245]
    v_pk_add_f32 v[14:15], v[14:15], v[244:245]
    v_rcp_f32 v8, v8
    v_rcp_f32 v9, v9
    v_rcp_f32 v10, v10
    v_rcp_f32 v11, v11
    v_rcp_f32 v12, v12
    v_rcp_f32 v13, v13
    v_rcp_f32 v14, v14
    v_rcp_f32 v15, v15
    v_pk_mul_f32 v[0:1], v[8:9], v[0:1]
    v_pk_mul_f32 v[2:3], v[10:11], v[2:3]
    v_pk_mul_f32 v[4:5], v[12:13], v[4:5]
    v_pk_mul_f32 v[6:7], v[14:15], v[6:7]
    v_cvt_pk_bf16_f32 v16, v0, v1
    v_cvt_pk_bf16_f32 v17, v2, v3
    v_cvt_pk_bf16_f32 v18, v4, v5
    v_cvt_pk_bf16_f32 v19, v6, v7
    buffer_store_dwordx4 v[16:19], v251, s[4:7], s53 offen offset:3072 sc1
    s_add_u32 s53, s53, s22
    v_accvgpr_read_b32 v20, a32
    v_accvgpr_read_b32 v21, a33
    v_accvgpr_read_b32 v22, a34
    v_accvgpr_read_b32 v23, a35
    v_accvgpr_read_b32 v24, a36
    v_accvgpr_read_b32 v25, a37
    v_accvgpr_read_b32 v26, a38
    v_accvgpr_read_b32 v27, a39
    v_pk_mul_f32 v[28:29], v[20:21], v[20:21]
    v_pk_mul_f32 v[30:31], v[22:23], v[22:23]
    v_pk_mul_f32 v[32:33], v[24:25], v[24:25]
    v_pk_mul_f32 v[34:35], v[26:27], v[26:27]
    v_pk_fma_f32 v[28:29], v[28:29], v[242:243], v[240:241]
    v_pk_fma_f32 v[30:31], v[30:31], v[242:243], v[240:241]
    v_pk_fma_f32 v[32:33], v[32:33], v[242:243], v[240:241]
    v_pk_fma_f32 v[34:35], v[34:35], v[242:243], v[240:241]
    v_pk_mul_f32 v[28:29], v[28:29], v[20:21]
    v_pk_mul_f32 v[30:31], v[30:31], v[22:23]
    v_pk_mul_f32 v[32:33], v[32:33], v[24:25]
    v_pk_mul_f32 v[34:35], v[34:35], v[26:27]
    v_exp_f32 v28, v28
    v_exp_f32 v29, v29
    v_exp_f32 v30, v30
    v_exp_f32 v31, v31
    v_exp_f32 v32, v32
    v_exp_f32 v33, v33
    v_exp_f32 v34, v34
    v_exp_f32 v35, v35
    v_pk_add_f32 v[28:29], v[28:29], v[244:245]
    v_pk_add_f32 v[30:31], v[30:31], v[244:245]
    v_pk_add_f32 v[32:33], v[32:33], v[244:245]
    v_pk_add_f32 v[34:35], v[34:35], v[244:245]
    v_rcp_f32 v28, v28
    v_rcp_f32 v29, v29
    v_rcp_f32 v30, v30
    v_rcp_f32 v31, v31
    v_rcp_f32 v32, v32
    v_rcp_f32 v33, v33
    v_rcp_f32 v34, v34
    v_rcp_f32 v35, v35
    v_pk_mul_f32 v[20:21], v[28:29], v[20:21]
    v_pk_mul_f32 v[22:23], v[30:31], v[22:23]
    v_pk_mul_f32 v[24:25], v[32:33], v[24:25]
    v_pk_mul_f32 v[26:27], v[34:35], v[26:27]
    v_cvt_pk_bf16_f32 v36, v20, v21
    v_cvt_pk_bf16_f32 v37, v22, v23
    v_cvt_pk_bf16_f32 v38, v24, v25
    v_cvt_pk_bf16_f32 v39, v26, v27
    buffer_store_dwordx4 v[36:39], v251, s[4:7], s53 offen offset:0 sc1
    v_accvgpr_read_b32 v40, a40
    v_accvgpr_read_b32 v41, a41
    v_accvgpr_read_b32 v42, a42
    v_accvgpr_read_b32 v43, a43
    v_accvgpr_read_b32 v44, a44
    v_accvgpr_read_b32 v45, a45
    v_accvgpr_read_b32 v46, a46
    v_accvgpr_read_b32 v47, a47
    v_pk_mul_f32 v[48:49], v[40:41], v[40:41]
    v_pk_mul_f32 v[50:51], v[42:43], v[42:43]
    v_pk_mul_f32 v[52:53], v[44:45], v[44:45]
    v_pk_mul_f32 v[54:55], v[46:47], v[46:47]
    v_pk_fma_f32 v[48:49], v[48:49], v[242:243], v[240:241]
    v_pk_fma_f32 v[50:51], v[50:51], v[242:243], v[240:241]
    v_pk_fma_f32 v[52:53], v[52:53], v[242:243], v[240:241]
    v_pk_fma_f32 v[54:55], v[54:55], v[242:243], v[240:241]
    v_pk_mul_f32 v[48:49], v[48:49], v[40:41]
    v_pk_mul_f32 v[50:51], v[50:51], v[42:43]
    v_pk_mul_f32 v[52:53], v[52:53], v[44:45]
    v_pk_mul_f32 v[54:55], v[54:55], v[46:47]
    v_exp_f32 v48, v48
    v_exp_f32 v49, v49
    v_exp_f32 v50, v50
    v_exp_f32 v51, v51
    v_exp_f32 v52, v52
    v_exp_f32 v53, v53
    v_exp_f32 v54, v54
    v_exp_f32 v55, v55
    v_pk_add_f32 v[48:49], v[48:49], v[244:245]
    v_pk_add_f32 v[50:51], v[50:51], v[244:245]
    v_pk_add_f32 v[52:53], v[52:53], v[244:245]
    v_pk_add_f32 v[54:55], v[54:55], v[244:245]
    v_rcp_f32 v48, v48
    v_rcp_f32 v49, v49
    v_rcp_f32 v50, v50
    v_rcp_f32 v51, v51
    v_rcp_f32 v52, v52
    v_rcp_f32 v53, v53
    v_rcp_f32 v54, v54
    v_rcp_f32 v55, v55
    v_pk_mul_f32 v[40:41], v[48:49], v[40:41]
    v_pk_mul_f32 v[42:43], v[50:51], v[42:43]
    v_pk_mul_f32 v[44:45], v[52:53], v[44:45]
    v_pk_mul_f32 v[46:47], v[54:55], v[46:47]
    v_cvt_pk_bf16_f32 v56, v40, v41
    v_cvt_pk_bf16_f32 v57, v42, v43
    v_cvt_pk_bf16_f32 v58, v44, v45
    v_cvt_pk_bf16_f32 v59, v46, v47
    buffer_store_dwordx4 v[56:59], v251, s[4:7], s53 offen offset:1024 sc1
    v_accvgpr_read_b32 v0, a48
    v_accvgpr_read_b32 v1, a49
    v_accvgpr_read_b32 v2, a50
    v_accvgpr_read_b32 v3, a51
    v_accvgpr_read_b32 v4, a52
    v_accvgpr_read_b32 v5, a53
    v_accvgpr_read_b32 v6, a54
    v_accvgpr_read_b32 v7, a55
    v_pk_mul_f32 v[8:9], v[0:1], v[0:1]
    v_pk_mul_f32 v[10:11], v[2:3], v[2:3]
    v_pk_mul_f32 v[12:13], v[4:5], v[4:5]
    v_pk_mul_f32 v[14:15], v[6:7], v[6:7]
    v_pk_fma_f32 v[8:9], v[8:9], v[242:243], v[240:241]
    v_pk_fma_f32 v[10:11], v[10:11], v[242:243], v[240:241]
    v_pk_fma_f32 v[12:13], v[12:13], v[242:243], v[240:241]
    v_pk_fma_f32 v[14:15], v[14:15], v[242:243], v[240:241]
    v_pk_mul_f32 v[8:9], v[8:9], v[0:1]
    v_pk_mul_f32 v[10:11], v[10:11], v[2:3]
    v_pk_mul_f32 v[12:13], v[12:13], v[4:5]
    v_pk_mul_f32 v[14:15], v[14:15], v[6:7]
    v_exp_f32 v8, v8
    v_exp_f32 v9, v9
    v_exp_f32 v10, v10
    v_exp_f32 v11, v11
    v_exp_f32 v12, v12
    v_exp_f32 v13, v13
    v_exp_f32 v14, v14
    v_exp_f32 v15, v15
    v_pk_add_f32 v[8:9], v[8:9], v[244:245]
    v_pk_add_f32 v[10:11], v[10:11], v[244:245]
    v_pk_add_f32 v[12:13], v[12:13], v[244:245]
    v_pk_add_f32 v[14:15], v[14:15], v[244:245]
    v_rcp_f32 v8, v8
    v_rcp_f32 v9, v9
    v_rcp_f32 v10, v10
    v_rcp_f32 v11, v11
    v_rcp_f32 v12, v12
    v_rcp_f32 v13, v13
    v_rcp_f32 v14, v14
    v_rcp_f32 v15, v15
    v_pk_mul_f32 v[0:1], v[8:9], v[0:1]
    v_pk_mul_f32 v[2:3], v[10:11], v[2:3]
    v_pk_mul_f32 v[4:5], v[12:13], v[4:5]
    v_pk_mul_f32 v[6:7], v[14:15], v[6:7]
    v_cvt_pk_bf16_f32 v16, v0, v1
    v_cvt_pk_bf16_f32 v17, v2, v3
    v_cvt_pk_bf16_f32 v18, v4, v5
    v_cvt_pk_bf16_f32 v19, v6, v7
    buffer_store_dwordx4 v[16:19], v251, s[4:7], s53 offen offset:2048 sc1
    v_accvgpr_read_b32 v20, a56
    v_accvgpr_read_b32 v21, a57
    v_accvgpr_read_b32 v22, a58
    v_accvgpr_read_b32 v23, a59
    v_accvgpr_read_b32 v24, a60
    v_accvgpr_read_b32 v25, a61
    v_accvgpr_read_b32 v26, a62
    v_accvgpr_read_b32 v27, a63
    v_pk_mul_f32 v[28:29], v[20:21], v[20:21]
    v_pk_mul_f32 v[30:31], v[22:23], v[22:23]
    v_pk_mul_f32 v[32:33], v[24:25], v[24:25]
    v_pk_mul_f32 v[34:35], v[26:27], v[26:27]
    v_pk_fma_f32 v[28:29], v[28:29], v[242:243], v[240:241]
    v_pk_fma_f32 v[30:31], v[30:31], v[242:243], v[240:241]
    v_pk_fma_f32 v[32:33], v[32:33], v[242:243], v[240:241]
    v_pk_fma_f32 v[34:35], v[34:35], v[242:243], v[240:241]
    v_pk_mul_f32 v[28:29], v[28:29], v[20:21]
    v_pk_mul_f32 v[30:31], v[30:31], v[22:23]
    v_pk_mul_f32 v[32:33], v[32:33], v[24:25]
    v_pk_mul_f32 v[34:35], v[34:35], v[26:27]
    v_exp_f32 v28, v28
    v_exp_f32 v29, v29
    v_exp_f32 v30, v30
    v_exp_f32 v31, v31
    v_exp_f32 v32, v32
    v_exp_f32 v33, v33
    v_exp_f32 v34, v34
    v_exp_f32 v35, v35
    v_pk_add_f32 v[28:29], v[28:29], v[244:245]
    v_pk_add_f32 v[30:31], v[30:31], v[244:245]
    v_pk_add_f32 v[32:33], v[32:33], v[244:245]
    v_pk_add_f32 v[34:35], v[34:35], v[244:245]
    v_rcp_f32 v28, v28
    v_rcp_f32 v29, v29
    v_rcp_f32 v30, v30
    v_rcp_f32 v31, v31
    v_rcp_f32 v32, v32
    v_rcp_f32 v33, v33
    v_rcp_f32 v34, v34
    v_rcp_f32 v35, v35
    v_pk_mul_f32 v[20:21], v[28:29], v[20:21]
    v_pk_mul_f32 v[22:23], v[30:31], v[22:23]
    v_pk_mul_f32 v[24:25], v[32:33], v[24:25]
    v_pk_mul_f32 v[26:27], v[34:35], v[26:27]
    v_cvt_pk_bf16_f32 v36, v20, v21
    v_cvt_pk_bf16_f32 v37, v22, v23
    v_cvt_pk_bf16_f32 v38, v24, v25
    v_cvt_pk_bf16_f32 v39, v26, v27
    buffer_store_dwordx4 v[36:39], v251, s[4:7], s53 offen offset:3072 sc1
    s_add_u32 s53, s53, s22
    v_accvgpr_read_b32 v40, a64
    v_accvgpr_read_b32 v41, a65
    v_accvgpr_read_b32 v42, a66
    v_accvgpr_read_b32 v43, a67
    v_accvgpr_read_b32 v44, a68
    v_accvgpr_read_b32 v45, a69
    v_accvgpr_read_b32 v46, a70
    v_accvgpr_read_b32 v47, a71
    v_pk_mul_f32 v[48:49], v[40:41], v[40:41]
    v_pk_mul_f32 v[50:51], v[42:43], v[42:43]
    v_pk_mul_f32 v[52:53], v[44:45], v[44:45]
    v_pk_mul_f32 v[54:55], v[46:47], v[46:47]
    v_pk_fma_f32 v[48:49], v[48:49], v[242:243], v[240:241]
    v_pk_fma_f32 v[50:51], v[50:51], v[242:243], v[240:241]
    v_pk_fma_f32 v[52:53], v[52:53], v[242:243], v[240:241]
    v_pk_fma_f32 v[54:55], v[54:55], v[242:243], v[240:241]
    v_pk_mul_f32 v[48:49], v[48:49], v[40:41]
    v_pk_mul_f32 v[50:51], v[50:51], v[42:43]
    v_pk_mul_f32 v[52:53], v[52:53], v[44:45]
    v_pk_mul_f32 v[54:55], v[54:55], v[46:47]
    v_exp_f32 v48, v48
    v_exp_f32 v49, v49
    v_exp_f32 v50, v50
    v_exp_f32 v51, v51
    v_exp_f32 v52, v52
    v_exp_f32 v53, v53
    v_exp_f32 v54, v54
    v_exp_f32 v55, v55
    v_pk_add_f32 v[48:49], v[48:49], v[244:245]
    v_pk_add_f32 v[50:51], v[50:51], v[244:245]
    v_pk_add_f32 v[52:53], v[52:53], v[244:245]
    v_pk_add_f32 v[54:55], v[54:55], v[244:245]
    v_rcp_f32 v48, v48
    v_rcp_f32 v49, v49
    v_rcp_f32 v50, v50
    v_rcp_f32 v51, v51
    v_rcp_f32 v52, v52
    v_rcp_f32 v53, v53
    v_rcp_f32 v54, v54
    v_rcp_f32 v55, v55
    v_pk_mul_f32 v[40:41], v[48:49], v[40:41]
    v_pk_mul_f32 v[42:43], v[50:51], v[42:43]
    v_pk_mul_f32 v[44:45], v[52:53], v[44:45]
    v_pk_mul_f32 v[46:47], v[54:55], v[46:47]
    v_cvt_pk_bf16_f32 v56, v40, v41
    v_cvt_pk_bf16_f32 v57, v42, v43
    v_cvt_pk_bf16_f32 v58, v44, v45
    v_cvt_pk_bf16_f32 v59, v46, v47
    buffer_store_dwordx4 v[56:59], v251, s[4:7], s53 offen offset:0 sc1
    v_accvgpr_read_b32 v0, a72
    v_accvgpr_read_b32 v1, a73
    v_accvgpr_read_b32 v2, a74
    v_accvgpr_read_b32 v3, a75
    v_accvgpr_read_b32 v4, a76
    v_accvgpr_read_b32 v5, a77
    v_accvgpr_read_b32 v6, a78
    v_accvgpr_read_b32 v7, a79
    v_pk_mul_f32 v[8:9], v[0:1], v[0:1]
    v_pk_mul_f32 v[10:11], v[2:3], v[2:3]
    v_pk_mul_f32 v[12:13], v[4:5], v[4:5]
    v_pk_mul_f32 v[14:15], v[6:7], v[6:7]
    v_pk_fma_f32 v[8:9], v[8:9], v[242:243], v[240:241]
    v_pk_fma_f32 v[10:11], v[10:11], v[242:243], v[240:241]
    v_pk_fma_f32 v[12:13], v[12:13], v[242:243], v[240:241]
    v_pk_fma_f32 v[14:15], v[14:15], v[242:243], v[240:241]
    v_pk_mul_f32 v[8:9], v[8:9], v[0:1]
    v_pk_mul_f32 v[10:11], v[10:11], v[2:3]
    v_pk_mul_f32 v[12:13], v[12:13], v[4:5]
    v_pk_mul_f32 v[14:15], v[14:15], v[6:7]
    v_exp_f32 v8, v8
    v_exp_f32 v9, v9
    v_exp_f32 v10, v10
    v_exp_f32 v11, v11
    v_exp_f32 v12, v12
    v_exp_f32 v13, v13
    v_exp_f32 v14, v14
    v_exp_f32 v15, v15
    v_pk_add_f32 v[8:9], v[8:9], v[244:245]
    v_pk_add_f32 v[10:11], v[10:11], v[244:245]
    v_pk_add_f32 v[12:13], v[12:13], v[244:245]
    v_pk_add_f32 v[14:15], v[14:15], v[244:245]
    v_rcp_f32 v8, v8
    v_rcp_f32 v9, v9
    v_rcp_f32 v10, v10
    v_rcp_f32 v11, v11
    v_rcp_f32 v12, v12
    v_rcp_f32 v13, v13
    v_rcp_f32 v14, v14
    v_rcp_f32 v15, v15
    v_pk_mul_f32 v[0:1], v[8:9], v[0:1]
    v_pk_mul_f32 v[2:3], v[10:11], v[2:3]
    v_pk_mul_f32 v[4:5], v[12:13], v[4:5]
    v_pk_mul_f32 v[6:7], v[14:15], v[6:7]
    v_cvt_pk_bf16_f32 v16, v0, v1
    v_cvt_pk_bf16_f32 v17, v2, v3
    v_cvt_pk_bf16_f32 v18, v4, v5
    v_cvt_pk_bf16_f32 v19, v6, v7
    buffer_store_dwordx4 v[16:19], v251, s[4:7], s53 offen offset:1024 sc1
    v_accvgpr_read_b32 v20, a80
    v_accvgpr_read_b32 v21, a81
    v_accvgpr_read_b32 v22, a82
    v_accvgpr_read_b32 v23, a83
    v_accvgpr_read_b32 v24, a84
    v_accvgpr_read_b32 v25, a85
    v_accvgpr_read_b32 v26, a86
    v_accvgpr_read_b32 v27, a87
    v_pk_mul_f32 v[28:29], v[20:21], v[20:21]
    v_pk_mul_f32 v[30:31], v[22:23], v[22:23]
    v_pk_mul_f32 v[32:33], v[24:25], v[24:25]
    v_pk_mul_f32 v[34:35], v[26:27], v[26:27]
    v_pk_fma_f32 v[28:29], v[28:29], v[242:243], v[240:241]
    v_pk_fma_f32 v[30:31], v[30:31], v[242:243], v[240:241]
    v_pk_fma_f32 v[32:33], v[32:33], v[242:243], v[240:241]
    v_pk_fma_f32 v[34:35], v[34:35], v[242:243], v[240:241]
    v_pk_mul_f32 v[28:29], v[28:29], v[20:21]
    v_pk_mul_f32 v[30:31], v[30:31], v[22:23]
    v_pk_mul_f32 v[32:33], v[32:33], v[24:25]
    v_pk_mul_f32 v[34:35], v[34:35], v[26:27]
    v_exp_f32 v28, v28
    v_exp_f32 v29, v29
    v_exp_f32 v30, v30
    v_exp_f32 v31, v31
    v_exp_f32 v32, v32
    v_exp_f32 v33, v33
    v_exp_f32 v34, v34
    v_exp_f32 v35, v35
    v_pk_add_f32 v[28:29], v[28:29], v[244:245]
    v_pk_add_f32 v[30:31], v[30:31], v[244:245]
    v_pk_add_f32 v[32:33], v[32:33], v[244:245]
    v_pk_add_f32 v[34:35], v[34:35], v[244:245]
    v_rcp_f32 v28, v28
    v_rcp_f32 v29, v29
    v_rcp_f32 v30, v30
    v_rcp_f32 v31, v31
    v_rcp_f32 v32, v32
    v_rcp_f32 v33, v33
    v_rcp_f32 v34, v34
    v_rcp_f32 v35, v35
    v_pk_mul_f32 v[20:21], v[28:29], v[20:21]
    v_pk_mul_f32 v[22:23], v[30:31], v[22:23]
    v_pk_mul_f32 v[24:25], v[32:33], v[24:25]
    v_pk_mul_f32 v[26:27], v[34:35], v[26:27]
    v_cvt_pk_bf16_f32 v36, v20, v21
    v_cvt_pk_bf16_f32 v37, v22, v23
    v_cvt_pk_bf16_f32 v38, v24, v25
    v_cvt_pk_bf16_f32 v39, v26, v27
    buffer_store_dwordx4 v[36:39], v251, s[4:7], s53 offen offset:2048 sc1
    v_accvgpr_read_b32 v40, a88
    v_accvgpr_read_b32 v41, a89
    v_accvgpr_read_b32 v42, a90
    v_accvgpr_read_b32 v43, a91
    v_accvgpr_read_b32 v44, a92
    v_accvgpr_read_b32 v45, a93
    v_accvgpr_read_b32 v46, a94
    v_accvgpr_read_b32 v47, a95
    v_pk_mul_f32 v[48:49], v[40:41], v[40:41]
    v_pk_mul_f32 v[50:51], v[42:43], v[42:43]
    v_pk_mul_f32 v[52:53], v[44:45], v[44:45]
    v_pk_mul_f32 v[54:55], v[46:47], v[46:47]
    v_pk_fma_f32 v[48:49], v[48:49], v[242:243], v[240:241]
    v_pk_fma_f32 v[50:51], v[50:51], v[242:243], v[240:241]
    v_pk_fma_f32 v[52:53], v[52:53], v[242:243], v[240:241]
    v_pk_fma_f32 v[54:55], v[54:55], v[242:243], v[240:241]
    v_pk_mul_f32 v[48:49], v[48:49], v[40:41]
    v_pk_mul_f32 v[50:51], v[50:51], v[42:43]
    v_pk_mul_f32 v[52:53], v[52:53], v[44:45]
    v_pk_mul_f32 v[54:55], v[54:55], v[46:47]
    v_exp_f32 v48, v48
    v_exp_f32 v49, v49
    v_exp_f32 v50, v50
    v_exp_f32 v51, v51
    v_exp_f32 v52, v52
    v_exp_f32 v53, v53
    v_exp_f32 v54, v54
    v_exp_f32 v55, v55
    v_pk_add_f32 v[48:49], v[48:49], v[244:245]
    v_pk_add_f32 v[50:51], v[50:51], v[244:245]
    v_pk_add_f32 v[52:53], v[52:53], v[244:245]
    v_pk_add_f32 v[54:55], v[54:55], v[244:245]
    v_rcp_f32 v48, v48
    v_rcp_f32 v49, v49
    v_rcp_f32 v50, v50
    v_rcp_f32 v51, v51
    v_rcp_f32 v52, v52
    v_rcp_f32 v53, v53
    v_rcp_f32 v54, v54
    v_rcp_f32 v55, v55
    v_pk_mul_f32 v[40:41], v[48:49], v[40:41]
    v_pk_mul_f32 v[42:43], v[50:51], v[42:43]
    v_pk_mul_f32 v[44:45], v[52:53], v[44:45]
    v_pk_mul_f32 v[46:47], v[54:55], v[46:47]
    v_cvt_pk_bf16_f32 v56, v40, v41
    v_cvt_pk_bf16_f32 v57, v42, v43
    v_cvt_pk_bf16_f32 v58, v44, v45
    v_cvt_pk_bf16_f32 v59, v46, v47
    buffer_store_dwordx4 v[56:59], v251, s[4:7], s53 offen offset:3072 sc1
    s_add_u32 s53, s53, s22
    v_accvgpr_read_b32 v0, a96
    v_accvgpr_read_b32 v1, a97
    v_accvgpr_read_b32 v2, a98
    v_accvgpr_read_b32 v3, a99
    v_accvgpr_read_b32 v4, a100
    v_accvgpr_read_b32 v5, a101
    v_accvgpr_read_b32 v6, a102
    v_accvgpr_read_b32 v7, a103
    v_pk_mul_f32 v[8:9], v[0:1], v[0:1]
    v_pk_mul_f32 v[10:11], v[2:3], v[2:3]
    v_pk_mul_f32 v[12:13], v[4:5], v[4:5]
    v_pk_mul_f32 v[14:15], v[6:7], v[6:7]
    v_pk_fma_f32 v[8:9], v[8:9], v[242:243], v[240:241]
    v_pk_fma_f32 v[10:11], v[10:11], v[242:243], v[240:241]
    v_pk_fma_f32 v[12:13], v[12:13], v[242:243], v[240:241]
    v_pk_fma_f32 v[14:15], v[14:15], v[242:243], v[240:241]
    v_pk_mul_f32 v[8:9], v[8:9], v[0:1]
    v_pk_mul_f32 v[10:11], v[10:11], v[2:3]
    v_pk_mul_f32 v[12:13], v[12:13], v[4:5]
    v_pk_mul_f32 v[14:15], v[14:15], v[6:7]
    v_exp_f32 v8, v8
    v_exp_f32 v9, v9
    v_exp_f32 v10, v10
    v_exp_f32 v11, v11
    v_exp_f32 v12, v12
    v_exp_f32 v13, v13
    v_exp_f32 v14, v14
    v_exp_f32 v15, v15
    v_pk_add_f32 v[8:9], v[8:9], v[244:245]
    v_pk_add_f32 v[10:11], v[10:11], v[244:245]
    v_pk_add_f32 v[12:13], v[12:13], v[244:245]
    v_pk_add_f32 v[14:15], v[14:15], v[244:245]
    v_rcp_f32 v8, v8
    v_rcp_f32 v9, v9
    v_rcp_f32 v10, v10
    v_rcp_f32 v11, v11
    v_rcp_f32 v12, v12
    v_rcp_f32 v13, v13
    v_rcp_f32 v14, v14
    v_rcp_f32 v15, v15
    v_pk_mul_f32 v[0:1], v[8:9], v[0:1]
    v_pk_mul_f32 v[2:3], v[10:11], v[2:3]
    v_pk_mul_f32 v[4:5], v[12:13], v[4:5]
    v_pk_mul_f32 v[6:7], v[14:15], v[6:7]
    v_cvt_pk_bf16_f32 v16, v0, v1
    v_cvt_pk_bf16_f32 v17, v2, v3
    v_cvt_pk_bf16_f32 v18, v4, v5
    v_cvt_pk_bf16_f32 v19, v6, v7
    buffer_store_dwordx4 v[16:19], v251, s[4:7], s53 offen offset:0 sc1
    v_accvgpr_read_b32 v20, a104
    v_accvgpr_read_b32 v21, a105
    v_accvgpr_read_b32 v22, a106
    v_accvgpr_read_b32 v23, a107
    v_accvgpr_read_b32 v24, a108
    v_accvgpr_read_b32 v25, a109
    v_accvgpr_read_b32 v26, a110
    v_accvgpr_read_b32 v27, a111
    v_pk_mul_f32 v[28:29], v[20:21], v[20:21]
    v_pk_mul_f32 v[30:31], v[22:23], v[22:23]
    v_pk_mul_f32 v[32:33], v[24:25], v[24:25]
    v_pk_mul_f32 v[34:35], v[26:27], v[26:27]
    v_pk_fma_f32 v[28:29], v[28:29], v[242:243], v[240:241]
    v_pk_fma_f32 v[30:31], v[30:31], v[242:243], v[240:241]
    v_pk_fma_f32 v[32:33], v[32:33], v[242:243], v[240:241]
    v_pk_fma_f32 v[34:35], v[34:35], v[242:243], v[240:241]
    v_pk_mul_f32 v[28:29], v[28:29], v[20:21]
    v_pk_mul_f32 v[30:31], v[30:31], v[22:23]
    v_pk_mul_f32 v[32:33], v[32:33], v[24:25]
    v_pk_mul_f32 v[34:35], v[34:35], v[26:27]
    v_exp_f32 v28, v28
    v_exp_f32 v29, v29
    v_exp_f32 v30, v30
    v_exp_f32 v31, v31
    v_exp_f32 v32, v32
    v_exp_f32 v33, v33
    v_exp_f32 v34, v34
    v_exp_f32 v35, v35
    v_pk_add_f32 v[28:29], v[28:29], v[244:245]
    v_pk_add_f32 v[30:31], v[30:31], v[244:245]
    v_pk_add_f32 v[32:33], v[32:33], v[244:245]
    v_pk_add_f32 v[34:35], v[34:35], v[244:245]
    v_rcp_f32 v28, v28
    v_rcp_f32 v29, v29
    v_rcp_f32 v30, v30
    v_rcp_f32 v31, v31
    v_rcp_f32 v32, v32
    v_rcp_f32 v33, v33
    v_rcp_f32 v34, v34
    v_rcp_f32 v35, v35
    v_pk_mul_f32 v[20:21], v[28:29], v[20:21]
    v_pk_mul_f32 v[22:23], v[30:31], v[22:23]
    v_pk_mul_f32 v[24:25], v[32:33], v[24:25]
    v_pk_mul_f32 v[26:27], v[34:35], v[26:27]
    v_cvt_pk_bf16_f32 v36, v20, v21
    v_cvt_pk_bf16_f32 v37, v22, v23
    v_cvt_pk_bf16_f32 v38, v24, v25
    v_cvt_pk_bf16_f32 v39, v26, v27
    buffer_store_dwordx4 v[36:39], v251, s[4:7], s53 offen offset:1024 sc1
    v_accvgpr_read_b32 v40, a112
    v_accvgpr_read_b32 v41, a113
    v_accvgpr_read_b32 v42, a114
    v_accvgpr_read_b32 v43, a115
    v_accvgpr_read_b32 v44, a116
    v_accvgpr_read_b32 v45, a117
    v_accvgpr_read_b32 v46, a118
    v_accvgpr_read_b32 v47, a119
    v_pk_mul_f32 v[48:49], v[40:41], v[40:41]
    v_pk_mul_f32 v[50:51], v[42:43], v[42:43]
    v_pk_mul_f32 v[52:53], v[44:45], v[44:45]
    v_pk_mul_f32 v[54:55], v[46:47], v[46:47]
    v_pk_fma_f32 v[48:49], v[48:49], v[242:243], v[240:241]
    v_pk_fma_f32 v[50:51], v[50:51], v[242:243], v[240:241]
    v_pk_fma_f32 v[52:53], v[52:53], v[242:243], v[240:241]
    v_pk_fma_f32 v[54:55], v[54:55], v[242:243], v[240:241]
    v_pk_mul_f32 v[48:49], v[48:49], v[40:41]
    v_pk_mul_f32 v[50:51], v[50:51], v[42:43]
    v_pk_mul_f32 v[52:53], v[52:53], v[44:45]
    v_pk_mul_f32 v[54:55], v[54:55], v[46:47]
    v_exp_f32 v48, v48
    v_exp_f32 v49, v49
    v_exp_f32 v50, v50
    v_exp_f32 v51, v51
    v_exp_f32 v52, v52
    v_exp_f32 v53, v53
    v_exp_f32 v54, v54
    v_exp_f32 v55, v55
    v_pk_add_f32 v[48:49], v[48:49], v[244:245]
    v_pk_add_f32 v[50:51], v[50:51], v[244:245]
    v_pk_add_f32 v[52:53], v[52:53], v[244:245]
    v_pk_add_f32 v[54:55], v[54:55], v[244:245]
    v_rcp_f32 v48, v48
    v_rcp_f32 v49, v49
    v_rcp_f32 v50, v50
    v_rcp_f32 v51, v51
    v_rcp_f32 v52, v52
    v_rcp_f32 v53, v53
    v_rcp_f32 v54, v54
    v_rcp_f32 v55, v55
    v_pk_mul_f32 v[40:41], v[48:49], v[40:41]
    v_pk_mul_f32 v[42:43], v[50:51], v[42:43]
    v_pk_mul_f32 v[44:45], v[52:53], v[44:45]
    v_pk_mul_f32 v[46:47], v[54:55], v[46:47]
    v_cvt_pk_bf16_f32 v56, v40, v41
    v_cvt_pk_bf16_f32 v57, v42, v43
    v_cvt_pk_bf16_f32 v58, v44, v45
    v_cvt_pk_bf16_f32 v59, v46, v47
    buffer_store_dwordx4 v[56:59], v251, s[4:7], s53 offen offset:2048 sc1
    v_accvgpr_read_b32 v0, a120
    v_accvgpr_read_b32 v1, a121
    v_accvgpr_read_b32 v2, a122
    v_accvgpr_read_b32 v3, a123
    v_accvgpr_read_b32 v4, a124
    v_accvgpr_read_b32 v5, a125
    v_accvgpr_read_b32 v6, a126
    v_accvgpr_read_b32 v7, a127
    v_pk_mul_f32 v[8:9], v[0:1], v[0:1]
    v_pk_mul_f32 v[10:11], v[2:3], v[2:3]
    v_pk_mul_f32 v[12:13], v[4:5], v[4:5]
    v_pk_mul_f32 v[14:15], v[6:7], v[6:7]
    v_pk_fma_f32 v[8:9], v[8:9], v[242:243], v[240:241]
    v_pk_fma_f32 v[10:11], v[10:11], v[242:243], v[240:241]
    v_pk_fma_f32 v[12:13], v[12:13], v[242:243], v[240:241]
    v_pk_fma_f32 v[14:15], v[14:15], v[242:243], v[240:241]
    v_pk_mul_f32 v[8:9], v[8:9], v[0:1]
    v_pk_mul_f32 v[10:11], v[10:11], v[2:3]
    v_pk_mul_f32 v[12:13], v[12:13], v[4:5]
    v_pk_mul_f32 v[14:15], v[14:15], v[6:7]
    v_exp_f32 v8, v8
    v_exp_f32 v9, v9
    v_exp_f32 v10, v10
    v_exp_f32 v11, v11
    v_exp_f32 v12, v12
    v_exp_f32 v13, v13
    v_exp_f32 v14, v14
    v_exp_f32 v15, v15
    v_pk_add_f32 v[8:9], v[8:9], v[244:245]
    v_pk_add_f32 v[10:11], v[10:11], v[244:245]
    v_pk_add_f32 v[12:13], v[12:13], v[244:245]
    v_pk_add_f32 v[14:15], v[14:15], v[244:245]
    v_rcp_f32 v8, v8
    v_rcp_f32 v9, v9
    v_rcp_f32 v10, v10
    v_rcp_f32 v11, v11
    v_rcp_f32 v12, v12
    v_rcp_f32 v13, v13
    v_rcp_f32 v14, v14
    v_rcp_f32 v15, v15
    v_pk_mul_f32 v[0:1], v[8:9], v[0:1]
    v_pk_mul_f32 v[2:3], v[10:11], v[2:3]
    v_pk_mul_f32 v[4:5], v[12:13], v[4:5]
    v_pk_mul_f32 v[6:7], v[14:15], v[6:7]
    v_cvt_pk_bf16_f32 v16, v0, v1
    v_cvt_pk_bf16_f32 v17, v2, v3
    v_cvt_pk_bf16_f32 v18, v4, v5
    v_cvt_pk_bf16_f32 v19, v6, v7
    buffer_store_dwordx4 v[16:19], v251, s[4:7], s53 offen offset:3072 sc1
    s_add_u32 s53, s53, s22
    v_accvgpr_read_b32 v20, a128
    v_accvgpr_read_b32 v21, a129
    v_accvgpr_read_b32 v22, a130
    v_accvgpr_read_b32 v23, a131
    v_accvgpr_read_b32 v24, a132
    v_accvgpr_read_b32 v25, a133
    v_accvgpr_read_b32 v26, a134
    v_accvgpr_read_b32 v27, a135
    v_pk_mul_f32 v[28:29], v[20:21], v[20:21]
    v_pk_mul_f32 v[30:31], v[22:23], v[22:23]
    v_pk_mul_f32 v[32:33], v[24:25], v[24:25]
    v_pk_mul_f32 v[34:35], v[26:27], v[26:27]
    v_pk_fma_f32 v[28:29], v[28:29], v[242:243], v[240:241]
    v_pk_fma_f32 v[30:31], v[30:31], v[242:243], v[240:241]
    v_pk_fma_f32 v[32:33], v[32:33], v[242:243], v[240:241]
    v_pk_fma_f32 v[34:35], v[34:35], v[242:243], v[240:241]
    v_pk_mul_f32 v[28:29], v[28:29], v[20:21]
    v_pk_mul_f32 v[30:31], v[30:31], v[22:23]
    v_pk_mul_f32 v[32:33], v[32:33], v[24:25]
    v_pk_mul_f32 v[34:35], v[34:35], v[26:27]
    v_exp_f32 v28, v28
    v_exp_f32 v29, v29
    v_exp_f32 v30, v30
    v_exp_f32 v31, v31
    v_exp_f32 v32, v32
    v_exp_f32 v33, v33
    v_exp_f32 v34, v34
    v_exp_f32 v35, v35
    v_pk_add_f32 v[28:29], v[28:29], v[244:245]
    v_pk_add_f32 v[30:31], v[30:31], v[244:245]
    v_pk_add_f32 v[32:33], v[32:33], v[244:245]
    v_pk_add_f32 v[34:35], v[34:35], v[244:245]
    v_rcp_f32 v28, v28
    v_rcp_f32 v29, v29
    v_rcp_f32 v30, v30
    v_rcp_f32 v31, v31
    v_rcp_f32 v32, v32
    v_rcp_f32 v33, v33
    v_rcp_f32 v34, v34
    v_rcp_f32 v35, v35
    v_pk_mul_f32 v[20:21], v[28:29], v[20:21]
    v_pk_mul_f32 v[22:23], v[30:31], v[22:23]
    v_pk_mul_f32 v[24:25], v[32:33], v[24:25]
    v_pk_mul_f32 v[26:27], v[34:35], v[26:27]
    v_cvt_pk_bf16_f32 v36, v20, v21
    v_cvt_pk_bf16_f32 v37, v22, v23
    v_cvt_pk_bf16_f32 v38, v24, v25
    v_cvt_pk_bf16_f32 v39, v26, v27
    buffer_store_dwordx4 v[36:39], v251, s[4:7], s53 offen offset:0 sc1
    v_accvgpr_read_b32 v40, a136
    v_accvgpr_read_b32 v41, a137
    v_accvgpr_read_b32 v42, a138
    v_accvgpr_read_b32 v43, a139
    v_accvgpr_read_b32 v44, a140
    v_accvgpr_read_b32 v45, a141
    v_accvgpr_read_b32 v46, a142
    v_accvgpr_read_b32 v47, a143
    v_pk_mul_f32 v[48:49], v[40:41], v[40:41]
    v_pk_mul_f32 v[50:51], v[42:43], v[42:43]
    v_pk_mul_f32 v[52:53], v[44:45], v[44:45]
    v_pk_mul_f32 v[54:55], v[46:47], v[46:47]
    v_pk_fma_f32 v[48:49], v[48:49], v[242:243], v[240:241]
    v_pk_fma_f32 v[50:51], v[50:51], v[242:243], v[240:241]
    v_pk_fma_f32 v[52:53], v[52:53], v[242:243], v[240:241]
    v_pk_fma_f32 v[54:55], v[54:55], v[242:243], v[240:241]
    v_pk_mul_f32 v[48:49], v[48:49], v[40:41]
    v_pk_mul_f32 v[50:51], v[50:51], v[42:43]
    v_pk_mul_f32 v[52:53], v[52:53], v[44:45]
    v_pk_mul_f32 v[54:55], v[54:55], v[46:47]
    v_exp_f32 v48, v48
    v_exp_f32 v49, v49
    v_exp_f32 v50, v50
    v_exp_f32 v51, v51
    v_exp_f32 v52, v52
    v_exp_f32 v53, v53
    v_exp_f32 v54, v54
    v_exp_f32 v55, v55
    v_pk_add_f32 v[48:49], v[48:49], v[244:245]
    v_pk_add_f32 v[50:51], v[50:51], v[244:245]
    v_pk_add_f32 v[52:53], v[52:53], v[244:245]
    v_pk_add_f32 v[54:55], v[54:55], v[244:245]
    v_rcp_f32 v48, v48
    v_rcp_f32 v49, v49
    v_rcp_f32 v50, v50
    v_rcp_f32 v51, v51
    v_rcp_f32 v52, v52
    v_rcp_f32 v53, v53
    v_rcp_f32 v54, v54
    v_rcp_f32 v55, v55
    v_pk_mul_f32 v[40:41], v[48:49], v[40:41]
    v_pk_mul_f32 v[42:43], v[50:51], v[42:43]
    v_pk_mul_f32 v[44:45], v[52:53], v[44:45]
    v_pk_mul_f32 v[46:47], v[54:55], v[46:47]
    v_cvt_pk_bf16_f32 v56, v40, v41
    v_cvt_pk_bf16_f32 v57, v42, v43
    v_cvt_pk_bf16_f32 v58, v44, v45
    v_cvt_pk_bf16_f32 v59, v46, v47
    buffer_store_dwordx4 v[56:59], v251, s[4:7], s53 offen offset:1024 sc1
    v_accvgpr_read_b32 v0, a144
    v_accvgpr_read_b32 v1, a145
    v_accvgpr_read_b32 v2, a146
    v_accvgpr_read_b32 v3, a147
    v_accvgpr_read_b32 v4, a148
    v_accvgpr_read_b32 v5, a149
    v_accvgpr_read_b32 v6, a150
    v_accvgpr_read_b32 v7, a151
    v_pk_mul_f32 v[8:9], v[0:1], v[0:1]
    v_pk_mul_f32 v[10:11], v[2:3], v[2:3]
    v_pk_mul_f32 v[12:13], v[4:5], v[4:5]
    v_pk_mul_f32 v[14:15], v[6:7], v[6:7]
    v_pk_fma_f32 v[8:9], v[8:9], v[242:243], v[240:241]
    v_pk_fma_f32 v[10:11], v[10:11], v[242:243], v[240:241]
    v_pk_fma_f32 v[12:13], v[12:13], v[242:243], v[240:241]
    v_pk_fma_f32 v[14:15], v[14:15], v[242:243], v[240:241]
    v_pk_mul_f32 v[8:9], v[8:9], v[0:1]
    v_pk_mul_f32 v[10:11], v[10:11], v[2:3]
    v_pk_mul_f32 v[12:13], v[12:13], v[4:5]
    v_pk_mul_f32 v[14:15], v[14:15], v[6:7]
    v_exp_f32 v8, v8
    v_exp_f32 v9, v9
    v_exp_f32 v10, v10
    v_exp_f32 v11, v11
    v_exp_f32 v12, v12
    v_exp_f32 v13, v13
    v_exp_f32 v14, v14
    v_exp_f32 v15, v15
    v_pk_add_f32 v[8:9], v[8:9], v[244:245]
    v_pk_add_f32 v[10:11], v[10:11], v[244:245]
    v_pk_add_f32 v[12:13], v[12:13], v[244:245]
    v_pk_add_f32 v[14:15], v[14:15], v[244:245]
    v_rcp_f32 v8, v8
    v_rcp_f32 v9, v9
    v_rcp_f32 v10, v10
    v_rcp_f32 v11, v11
    v_rcp_f32 v12, v12
    v_rcp_f32 v13, v13
    v_rcp_f32 v14, v14
    v_rcp_f32 v15, v15
    v_pk_mul_f32 v[0:1], v[8:9], v[0:1]
    v_pk_mul_f32 v[2:3], v[10:11], v[2:3]
    v_pk_mul_f32 v[4:5], v[12:13], v[4:5]
    v_pk_mul_f32 v[6:7], v[14:15], v[6:7]
    v_cvt_pk_bf16_f32 v16, v0, v1
    v_cvt_pk_bf16_f32 v17, v2, v3
    v_cvt_pk_bf16_f32 v18, v4, v5
    v_cvt_pk_bf16_f32 v19, v6, v7
    buffer_store_dwordx4 v[16:19], v251, s[4:7], s53 offen offset:2048 sc1
    v_accvgpr_read_b32 v20, a152
    v_accvgpr_read_b32 v21, a153
    v_accvgpr_read_b32 v22, a154
    v_accvgpr_read_b32 v23, a155
    v_accvgpr_read_b32 v24, a156
    v_accvgpr_read_b32 v25, a157
    v_accvgpr_read_b32 v26, a158
    v_accvgpr_read_b32 v27, a159
    v_pk_mul_f32 v[28:29], v[20:21], v[20:21]
    v_pk_mul_f32 v[30:31], v[22:23], v[22:23]
    v_pk_mul_f32 v[32:33], v[24:25], v[24:25]
    v_pk_mul_f32 v[34:35], v[26:27], v[26:27]
    v_pk_fma_f32 v[28:29], v[28:29], v[242:243], v[240:241]
    v_pk_fma_f32 v[30:31], v[30:31], v[242:243], v[240:241]
    v_pk_fma_f32 v[32:33], v[32:33], v[242:243], v[240:241]
    v_pk_fma_f32 v[34:35], v[34:35], v[242:243], v[240:241]
    v_pk_mul_f32 v[28:29], v[28:29], v[20:21]
    v_pk_mul_f32 v[30:31], v[30:31], v[22:23]
    v_pk_mul_f32 v[32:33], v[32:33], v[24:25]
    v_pk_mul_f32 v[34:35], v[34:35], v[26:27]
    v_exp_f32 v28, v28
    v_exp_f32 v29, v29
    v_exp_f32 v30, v30
    v_exp_f32 v31, v31
    v_exp_f32 v32, v32
    v_exp_f32 v33, v33
    v_exp_f32 v34, v34
    v_exp_f32 v35, v35
    v_pk_add_f32 v[28:29], v[28:29], v[244:245]
    v_pk_add_f32 v[30:31], v[30:31], v[244:245]
    v_pk_add_f32 v[32:33], v[32:33], v[244:245]
    v_pk_add_f32 v[34:35], v[34:35], v[244:245]
    v_rcp_f32 v28, v28
    v_rcp_f32 v29, v29
    v_rcp_f32 v30, v30
    v_rcp_f32 v31, v31
    v_rcp_f32 v32, v32
    v_rcp_f32 v33, v33
    v_rcp_f32 v34, v34
    v_rcp_f32 v35, v35
    v_pk_mul_f32 v[20:21], v[28:29], v[20:21]
    v_pk_mul_f32 v[22:23], v[30:31], v[22:23]
    v_pk_mul_f32 v[24:25], v[32:33], v[24:25]
    v_pk_mul_f32 v[26:27], v[34:35], v[26:27]
    v_cvt_pk_bf16_f32 v36, v20, v21
    v_cvt_pk_bf16_f32 v37, v22, v23
    v_cvt_pk_bf16_f32 v38, v24, v25
    v_cvt_pk_bf16_f32 v39, v26, v27
    buffer_store_dwordx4 v[36:39], v251, s[4:7], s53 offen offset:3072 sc1
    s_add_u32 s53, s53, s22
    v_accvgpr_read_b32 v40, a160
    v_accvgpr_read_b32 v41, a161
    v_accvgpr_read_b32 v42, a162
    v_accvgpr_read_b32 v43, a163
    v_accvgpr_read_b32 v44, a164
    v_accvgpr_read_b32 v45, a165
    v_accvgpr_read_b32 v46, a166
    v_accvgpr_read_b32 v47, a167
    v_pk_mul_f32 v[48:49], v[40:41], v[40:41]
    v_pk_mul_f32 v[50:51], v[42:43], v[42:43]
    v_pk_mul_f32 v[52:53], v[44:45], v[44:45]
    v_pk_mul_f32 v[54:55], v[46:47], v[46:47]
    v_pk_fma_f32 v[48:49], v[48:49], v[242:243], v[240:241]
    v_pk_fma_f32 v[50:51], v[50:51], v[242:243], v[240:241]
    v_pk_fma_f32 v[52:53], v[52:53], v[242:243], v[240:241]
    v_pk_fma_f32 v[54:55], v[54:55], v[242:243], v[240:241]
    v_pk_mul_f32 v[48:49], v[48:49], v[40:41]
    v_pk_mul_f32 v[50:51], v[50:51], v[42:43]
    v_pk_mul_f32 v[52:53], v[52:53], v[44:45]
    v_pk_mul_f32 v[54:55], v[54:55], v[46:47]
    v_exp_f32 v48, v48
    v_exp_f32 v49, v49
    v_exp_f32 v50, v50
    v_exp_f32 v51, v51
    v_exp_f32 v52, v52
    v_exp_f32 v53, v53
    v_exp_f32 v54, v54
    v_exp_f32 v55, v55
    v_pk_add_f32 v[48:49], v[48:49], v[244:245]
    v_pk_add_f32 v[50:51], v[50:51], v[244:245]
    v_pk_add_f32 v[52:53], v[52:53], v[244:245]
    v_pk_add_f32 v[54:55], v[54:55], v[244:245]
    v_rcp_f32 v48, v48
    v_rcp_f32 v49, v49
    v_rcp_f32 v50, v50
    v_rcp_f32 v51, v51
    v_rcp_f32 v52, v52
    v_rcp_f32 v53, v53
    v_rcp_f32 v54, v54
    v_rcp_f32 v55, v55
    v_pk_mul_f32 v[40:41], v[48:49], v[40:41]
    v_pk_mul_f32 v[42:43], v[50:51], v[42:43]
    v_pk_mul_f32 v[44:45], v[52:53], v[44:45]
    v_pk_mul_f32 v[46:47], v[54:55], v[46:47]
    v_cvt_pk_bf16_f32 v56, v40, v41
    v_cvt_pk_bf16_f32 v57, v42, v43
    v_cvt_pk_bf16_f32 v58, v44, v45
    v_cvt_pk_bf16_f32 v59, v46, v47
    buffer_store_dwordx4 v[56:59], v251, s[4:7], s53 offen offset:0 sc1
    v_accvgpr_read_b32 v0, a168
    v_accvgpr_read_b32 v1, a169
    v_accvgpr_read_b32 v2, a170
    v_accvgpr_read_b32 v3, a171
    v_accvgpr_read_b32 v4, a172
    v_accvgpr_read_b32 v5, a173
    v_accvgpr_read_b32 v6, a174
    v_accvgpr_read_b32 v7, a175
    v_pk_mul_f32 v[8:9], v[0:1], v[0:1]
    v_pk_mul_f32 v[10:11], v[2:3], v[2:3]
    v_pk_mul_f32 v[12:13], v[4:5], v[4:5]
    v_pk_mul_f32 v[14:15], v[6:7], v[6:7]
    v_pk_fma_f32 v[8:9], v[8:9], v[242:243], v[240:241]
    v_pk_fma_f32 v[10:11], v[10:11], v[242:243], v[240:241]
    v_pk_fma_f32 v[12:13], v[12:13], v[242:243], v[240:241]
    v_pk_fma_f32 v[14:15], v[14:15], v[242:243], v[240:241]
    v_pk_mul_f32 v[8:9], v[8:9], v[0:1]
    v_pk_mul_f32 v[10:11], v[10:11], v[2:3]
    v_pk_mul_f32 v[12:13], v[12:13], v[4:5]
    v_pk_mul_f32 v[14:15], v[14:15], v[6:7]
    v_exp_f32 v8, v8
    v_exp_f32 v9, v9
    v_exp_f32 v10, v10
    v_exp_f32 v11, v11
    v_exp_f32 v12, v12
    v_exp_f32 v13, v13
    v_exp_f32 v14, v14
    v_exp_f32 v15, v15
    v_pk_add_f32 v[8:9], v[8:9], v[244:245]
    v_pk_add_f32 v[10:11], v[10:11], v[244:245]
    v_pk_add_f32 v[12:13], v[12:13], v[244:245]
    v_pk_add_f32 v[14:15], v[14:15], v[244:245]
    v_rcp_f32 v8, v8
    v_rcp_f32 v9, v9
    v_rcp_f32 v10, v10
    v_rcp_f32 v11, v11
    v_rcp_f32 v12, v12
    v_rcp_f32 v13, v13
    v_rcp_f32 v14, v14
    v_rcp_f32 v15, v15
    v_pk_mul_f32 v[0:1], v[8:9], v[0:1]
    v_pk_mul_f32 v[2:3], v[10:11], v[2:3]
    v_pk_mul_f32 v[4:5], v[12:13], v[4:5]
    v_pk_mul_f32 v[6:7], v[14:15], v[6:7]
    v_cvt_pk_bf16_f32 v16, v0, v1
    v_cvt_pk_bf16_f32 v17, v2, v3
    v_cvt_pk_bf16_f32 v18, v4, v5
    v_cvt_pk_bf16_f32 v19, v6, v7
    buffer_store_dwordx4 v[16:19], v251, s[4:7], s53 offen offset:1024 sc1
    v_accvgpr_read_b32 v20, a176
    v_accvgpr_read_b32 v21, a177
    v_accvgpr_read_b32 v22, a178
    v_accvgpr_read_b32 v23, a179
    v_accvgpr_read_b32 v24, a180
    v_accvgpr_read_b32 v25, a181
    v_accvgpr_read_b32 v26, a182
    v_accvgpr_read_b32 v27, a183
    v_pk_mul_f32 v[28:29], v[20:21], v[20:21]
    v_pk_mul_f32 v[30:31], v[22:23], v[22:23]
    v_pk_mul_f32 v[32:33], v[24:25], v[24:25]
    v_pk_mul_f32 v[34:35], v[26:27], v[26:27]
    v_pk_fma_f32 v[28:29], v[28:29], v[242:243], v[240:241]
    v_pk_fma_f32 v[30:31], v[30:31], v[242:243], v[240:241]
    v_pk_fma_f32 v[32:33], v[32:33], v[242:243], v[240:241]
    v_pk_fma_f32 v[34:35], v[34:35], v[242:243], v[240:241]
    v_pk_mul_f32 v[28:29], v[28:29], v[20:21]
    v_pk_mul_f32 v[30:31], v[30:31], v[22:23]
    v_pk_mul_f32 v[32:33], v[32:33], v[24:25]
    v_pk_mul_f32 v[34:35], v[34:35], v[26:27]
    v_exp_f32 v28, v28
    v_exp_f32 v29, v29
    v_exp_f32 v30, v30
    v_exp_f32 v31, v31
    v_exp_f32 v32, v32
    v_exp_f32 v33, v33
    v_exp_f32 v34, v34
    v_exp_f32 v35, v35
    v_pk_add_f32 v[28:29], v[28:29], v[244:245]
    v_pk_add_f32 v[30:31], v[30:31], v[244:245]
    v_pk_add_f32 v[32:33], v[32:33], v[244:245]
    v_pk_add_f32 v[34:35], v[34:35], v[244:245]
    v_rcp_f32 v28, v28
    v_rcp_f32 v29, v29
    v_rcp_f32 v30, v30
    v_rcp_f32 v31, v31
    v_rcp_f32 v32, v32
    v_rcp_f32 v33, v33
    v_rcp_f32 v34, v34
    v_rcp_f32 v35, v35
    v_pk_mul_f32 v[20:21], v[28:29], v[20:21]
    v_pk_mul_f32 v[22:23], v[30:31], v[22:23]
    v_pk_mul_f32 v[24:25], v[32:33], v[24:25]
    v_pk_mul_f32 v[26:27], v[34:35], v[26:27]
    v_cvt_pk_bf16_f32 v36, v20, v21
    v_cvt_pk_bf16_f32 v37, v22, v23
    v_cvt_pk_bf16_f32 v38, v24, v25
    v_cvt_pk_bf16_f32 v39, v26, v27
    buffer_store_dwordx4 v[36:39], v251, s[4:7], s53 offen offset:2048 sc1
    v_accvgpr_read_b32 v40, a184
    v_accvgpr_read_b32 v41, a185
    v_accvgpr_read_b32 v42, a186
    v_accvgpr_read_b32 v43, a187
    v_accvgpr_read_b32 v44, a188
    v_accvgpr_read_b32 v45, a189
    v_accvgpr_read_b32 v46, a190
    v_accvgpr_read_b32 v47, a191
    v_pk_mul_f32 v[48:49], v[40:41], v[40:41]
    v_pk_mul_f32 v[50:51], v[42:43], v[42:43]
    v_pk_mul_f32 v[52:53], v[44:45], v[44:45]
    v_pk_mul_f32 v[54:55], v[46:47], v[46:47]
    v_pk_fma_f32 v[48:49], v[48:49], v[242:243], v[240:241]
    v_pk_fma_f32 v[50:51], v[50:51], v[242:243], v[240:241]
    v_pk_fma_f32 v[52:53], v[52:53], v[242:243], v[240:241]
    v_pk_fma_f32 v[54:55], v[54:55], v[242:243], v[240:241]
    v_pk_mul_f32 v[48:49], v[48:49], v[40:41]
    v_pk_mul_f32 v[50:51], v[50:51], v[42:43]
    v_pk_mul_f32 v[52:53], v[52:53], v[44:45]
    v_pk_mul_f32 v[54:55], v[54:55], v[46:47]
    v_exp_f32 v48, v48
    v_exp_f32 v49, v49
    v_exp_f32 v50, v50
    v_exp_f32 v51, v51
    v_exp_f32 v52, v52
    v_exp_f32 v53, v53
    v_exp_f32 v54, v54
    v_exp_f32 v55, v55
    v_pk_add_f32 v[48:49], v[48:49], v[244:245]
    v_pk_add_f32 v[50:51], v[50:51], v[244:245]
    v_pk_add_f32 v[52:53], v[52:53], v[244:245]
    v_pk_add_f32 v[54:55], v[54:55], v[244:245]
    v_rcp_f32 v48, v48
    v_rcp_f32 v49, v49
    v_rcp_f32 v50, v50
    v_rcp_f32 v51, v51
    v_rcp_f32 v52, v52
    v_rcp_f32 v53, v53
    v_rcp_f32 v54, v54
    v_rcp_f32 v55, v55
    v_pk_mul_f32 v[40:41], v[48:49], v[40:41]
    v_pk_mul_f32 v[42:43], v[50:51], v[42:43]
    v_pk_mul_f32 v[44:45], v[52:53], v[44:45]
    v_pk_mul_f32 v[46:47], v[54:55], v[46:47]
    v_cvt_pk_bf16_f32 v56, v40, v41
    v_cvt_pk_bf16_f32 v57, v42, v43
    v_cvt_pk_bf16_f32 v58, v44, v45
    v_cvt_pk_bf16_f32 v59, v46, v47
    buffer_store_dwordx4 v[56:59], v251, s[4:7], s53 offen offset:3072 sc1
    s_add_u32 s53, s53, s22
    v_accvgpr_read_b32 v0, a192
    v_accvgpr_read_b32 v1, a193
    v_accvgpr_read_b32 v2, a194
    v_accvgpr_read_b32 v3, a195
    v_accvgpr_read_b32 v4, a196
    v_accvgpr_read_b32 v5, a197
    v_accvgpr_read_b32 v6, a198
    v_accvgpr_read_b32 v7, a199
    v_pk_mul_f32 v[8:9], v[0:1], v[0:1]
    v_pk_mul_f32 v[10:11], v[2:3], v[2:3]
    v_pk_mul_f32 v[12:13], v[4:5], v[4:5]
    v_pk_mul_f32 v[14:15], v[6:7], v[6:7]
    v_pk_fma_f32 v[8:9], v[8:9], v[242:243], v[240:241]
    v_pk_fma_f32 v[10:11], v[10:11], v[242:243], v[240:241]
    v_pk_fma_f32 v[12:13], v[12:13], v[242:243], v[240:241]
    v_pk_fma_f32 v[14:15], v[14:15], v[242:243], v[240:241]
    v_pk_mul_f32 v[8:9], v[8:9], v[0:1]
    v_pk_mul_f32 v[10:11], v[10:11], v[2:3]
    v_pk_mul_f32 v[12:13], v[12:13], v[4:5]
    v_pk_mul_f32 v[14:15], v[14:15], v[6:7]
    v_exp_f32 v8, v8
    v_exp_f32 v9, v9
    v_exp_f32 v10, v10
    v_exp_f32 v11, v11
    v_exp_f32 v12, v12
    v_exp_f32 v13, v13
    v_exp_f32 v14, v14
    v_exp_f32 v15, v15
    v_pk_add_f32 v[8:9], v[8:9], v[244:245]
    v_pk_add_f32 v[10:11], v[10:11], v[244:245]
    v_pk_add_f32 v[12:13], v[12:13], v[244:245]
    v_pk_add_f32 v[14:15], v[14:15], v[244:245]
    v_rcp_f32 v8, v8
    v_rcp_f32 v9, v9
    v_rcp_f32 v10, v10
    v_rcp_f32 v11, v11
    v_rcp_f32 v12, v12
    v_rcp_f32 v13, v13
    v_rcp_f32 v14, v14
    v_rcp_f32 v15, v15
    v_pk_mul_f32 v[0:1], v[8:9], v[0:1]
    v_pk_mul_f32 v[2:3], v[10:11], v[2:3]
    v_pk_mul_f32 v[4:5], v[12:13], v[4:5]
    v_pk_mul_f32 v[6:7], v[14:15], v[6:7]
    v_cvt_pk_bf16_f32 v16, v0, v1
    v_cvt_pk_bf16_f32 v17, v2, v3
    v_cvt_pk_bf16_f32 v18, v4, v5
    v_cvt_pk_bf16_f32 v19, v6, v7
    buffer_store_dwordx4 v[16:19], v251, s[4:7], s53 offen offset:0 sc1
    v_accvgpr_read_b32 v20, a200
    v_accvgpr_read_b32 v21, a201
    v_accvgpr_read_b32 v22, a202
    v_accvgpr_read_b32 v23, a203
    v_accvgpr_read_b32 v24, a204
    v_accvgpr_read_b32 v25, a205
    v_accvgpr_read_b32 v26, a206
    v_accvgpr_read_b32 v27, a207
    v_pk_mul_f32 v[28:29], v[20:21], v[20:21]
    v_pk_mul_f32 v[30:31], v[22:23], v[22:23]
    v_pk_mul_f32 v[32:33], v[24:25], v[24:25]
    v_pk_mul_f32 v[34:35], v[26:27], v[26:27]
    v_pk_fma_f32 v[28:29], v[28:29], v[242:243], v[240:241]
    v_pk_fma_f32 v[30:31], v[30:31], v[242:243], v[240:241]
    v_pk_fma_f32 v[32:33], v[32:33], v[242:243], v[240:241]
    v_pk_fma_f32 v[34:35], v[34:35], v[242:243], v[240:241]
    v_pk_mul_f32 v[28:29], v[28:29], v[20:21]
    v_pk_mul_f32 v[30:31], v[30:31], v[22:23]
    v_pk_mul_f32 v[32:33], v[32:33], v[24:25]
    v_pk_mul_f32 v[34:35], v[34:35], v[26:27]
    v_exp_f32 v28, v28
    v_exp_f32 v29, v29
    v_exp_f32 v30, v30
    v_exp_f32 v31, v31
    v_exp_f32 v32, v32
    v_exp_f32 v33, v33
    v_exp_f32 v34, v34
    v_exp_f32 v35, v35
    v_pk_add_f32 v[28:29], v[28:29], v[244:245]
    v_pk_add_f32 v[30:31], v[30:31], v[244:245]
    v_pk_add_f32 v[32:33], v[32:33], v[244:245]
    v_pk_add_f32 v[34:35], v[34:35], v[244:245]
    v_rcp_f32 v28, v28
    v_rcp_f32 v29, v29
    v_rcp_f32 v30, v30
    v_rcp_f32 v31, v31
    v_rcp_f32 v32, v32
    v_rcp_f32 v33, v33
    v_rcp_f32 v34, v34
    v_rcp_f32 v35, v35
    v_pk_mul_f32 v[20:21], v[28:29], v[20:21]
    v_pk_mul_f32 v[22:23], v[30:31], v[22:23]
    v_pk_mul_f32 v[24:25], v[32:33], v[24:25]
    v_pk_mul_f32 v[26:27], v[34:35], v[26:27]
    v_cvt_pk_bf16_f32 v36, v20, v21
    v_cvt_pk_bf16_f32 v37, v22, v23
    v_cvt_pk_bf16_f32 v38, v24, v25
    v_cvt_pk_bf16_f32 v39, v26, v27
    buffer_store_dwordx4 v[36:39], v251, s[4:7], s53 offen offset:1024 sc1
    v_accvgpr_read_b32 v40, a208
    v_accvgpr_read_b32 v41, a209
    v_accvgpr_read_b32 v42, a210
    v_accvgpr_read_b32 v43, a211
    v_accvgpr_read_b32 v44, a212
    v_accvgpr_read_b32 v45, a213
    v_accvgpr_read_b32 v46, a214
    v_accvgpr_read_b32 v47, a215
    v_pk_mul_f32 v[48:49], v[40:41], v[40:41]
    v_pk_mul_f32 v[50:51], v[42:43], v[42:43]
    v_pk_mul_f32 v[52:53], v[44:45], v[44:45]
    v_pk_mul_f32 v[54:55], v[46:47], v[46:47]
    v_pk_fma_f32 v[48:49], v[48:49], v[242:243], v[240:241]
    v_pk_fma_f32 v[50:51], v[50:51], v[242:243], v[240:241]
    v_pk_fma_f32 v[52:53], v[52:53], v[242:243], v[240:241]
    v_pk_fma_f32 v[54:55], v[54:55], v[242:243], v[240:241]
    v_pk_mul_f32 v[48:49], v[48:49], v[40:41]
    v_pk_mul_f32 v[50:51], v[50:51], v[42:43]
    v_pk_mul_f32 v[52:53], v[52:53], v[44:45]
    v_pk_mul_f32 v[54:55], v[54:55], v[46:47]
    v_exp_f32 v48, v48
    v_exp_f32 v49, v49
    v_exp_f32 v50, v50
    v_exp_f32 v51, v51
    v_exp_f32 v52, v52
    v_exp_f32 v53, v53
    v_exp_f32 v54, v54
    v_exp_f32 v55, v55
    v_pk_add_f32 v[48:49], v[48:49], v[244:245]
    v_pk_add_f32 v[50:51], v[50:51], v[244:245]
    v_pk_add_f32 v[52:53], v[52:53], v[244:245]
    v_pk_add_f32 v[54:55], v[54:55], v[244:245]
    v_rcp_f32 v48, v48
    v_rcp_f32 v49, v49
    v_rcp_f32 v50, v50
    v_rcp_f32 v51, v51
    v_rcp_f32 v52, v52
    v_rcp_f32 v53, v53
    v_rcp_f32 v54, v54
    v_rcp_f32 v55, v55
    v_pk_mul_f32 v[40:41], v[48:49], v[40:41]
    v_pk_mul_f32 v[42:43], v[50:51], v[42:43]
    v_pk_mul_f32 v[44:45], v[52:53], v[44:45]
    v_pk_mul_f32 v[46:47], v[54:55], v[46:47]
    v_cvt_pk_bf16_f32 v56, v40, v41
    v_cvt_pk_bf16_f32 v57, v42, v43
    v_cvt_pk_bf16_f32 v58, v44, v45
    v_cvt_pk_bf16_f32 v59, v46, v47
    buffer_store_dwordx4 v[56:59], v251, s[4:7], s53 offen offset:2048 sc1
    v_accvgpr_read_b32 v0, a216
    v_accvgpr_read_b32 v1, a217
    v_accvgpr_read_b32 v2, a218
    v_accvgpr_read_b32 v3, a219
    v_accvgpr_read_b32 v4, a220
    v_accvgpr_read_b32 v5, a221
    v_accvgpr_read_b32 v6, a222
    v_accvgpr_read_b32 v7, a223
    v_pk_mul_f32 v[8:9], v[0:1], v[0:1]
    v_pk_mul_f32 v[10:11], v[2:3], v[2:3]
    v_pk_mul_f32 v[12:13], v[4:5], v[4:5]
    v_pk_mul_f32 v[14:15], v[6:7], v[6:7]
    v_pk_fma_f32 v[8:9], v[8:9], v[242:243], v[240:241]
    v_pk_fma_f32 v[10:11], v[10:11], v[242:243], v[240:241]
    v_pk_fma_f32 v[12:13], v[12:13], v[242:243], v[240:241]
    v_pk_fma_f32 v[14:15], v[14:15], v[242:243], v[240:241]
    v_pk_mul_f32 v[8:9], v[8:9], v[0:1]
    v_pk_mul_f32 v[10:11], v[10:11], v[2:3]
    v_pk_mul_f32 v[12:13], v[12:13], v[4:5]
    v_pk_mul_f32 v[14:15], v[14:15], v[6:7]
    v_exp_f32 v8, v8
    v_exp_f32 v9, v9
    v_exp_f32 v10, v10
    v_exp_f32 v11, v11
    v_exp_f32 v12, v12
    v_exp_f32 v13, v13
    v_exp_f32 v14, v14
    v_exp_f32 v15, v15
    v_pk_add_f32 v[8:9], v[8:9], v[244:245]
    v_pk_add_f32 v[10:11], v[10:11], v[244:245]
    v_pk_add_f32 v[12:13], v[12:13], v[244:245]
    v_pk_add_f32 v[14:15], v[14:15], v[244:245]
    v_rcp_f32 v8, v8
    v_rcp_f32 v9, v9
    v_rcp_f32 v10, v10
    v_rcp_f32 v11, v11
    v_rcp_f32 v12, v12
    v_rcp_f32 v13, v13
    v_rcp_f32 v14, v14
    v_rcp_f32 v15, v15
    v_pk_mul_f32 v[0:1], v[8:9], v[0:1]
    v_pk_mul_f32 v[2:3], v[10:11], v[2:3]
    v_pk_mul_f32 v[4:5], v[12:13], v[4:5]
    v_pk_mul_f32 v[6:7], v[14:15], v[6:7]
    v_cvt_pk_bf16_f32 v16, v0, v1
    v_cvt_pk_bf16_f32 v17, v2, v3
    v_cvt_pk_bf16_f32 v18, v4, v5
    v_cvt_pk_bf16_f32 v19, v6, v7
    buffer_store_dwordx4 v[16:19], v251, s[4:7], s53 offen offset:3072 sc1
    s_add_u32 s53, s53, s22
    v_accvgpr_read_b32 v20, a224
    v_accvgpr_read_b32 v21, a225
    v_accvgpr_read_b32 v22, a226
    v_accvgpr_read_b32 v23, a227
    v_accvgpr_read_b32 v24, a228
    v_accvgpr_read_b32 v25, a229
    v_accvgpr_read_b32 v26, a230
    v_accvgpr_read_b32 v27, a231
    v_pk_mul_f32 v[28:29], v[20:21], v[20:21]
    v_pk_mul_f32 v[30:31], v[22:23], v[22:23]
    v_pk_mul_f32 v[32:33], v[24:25], v[24:25]
    v_pk_mul_f32 v[34:35], v[26:27], v[26:27]
    v_pk_fma_f32 v[28:29], v[28:29], v[242:243], v[240:241]
    v_pk_fma_f32 v[30:31], v[30:31], v[242:243], v[240:241]
    v_pk_fma_f32 v[32:33], v[32:33], v[242:243], v[240:241]
    v_pk_fma_f32 v[34:35], v[34:35], v[242:243], v[240:241]
    v_pk_mul_f32 v[28:29], v[28:29], v[20:21]
    v_pk_mul_f32 v[30:31], v[30:31], v[22:23]
    v_pk_mul_f32 v[32:33], v[32:33], v[24:25]
    v_pk_mul_f32 v[34:35], v[34:35], v[26:27]
    v_exp_f32 v28, v28
    v_exp_f32 v29, v29
    v_exp_f32 v30, v30
    v_exp_f32 v31, v31
    v_exp_f32 v32, v32
    v_exp_f32 v33, v33
    v_exp_f32 v34, v34
    v_exp_f32 v35, v35
    v_pk_add_f32 v[28:29], v[28:29], v[244:245]
    v_pk_add_f32 v[30:31], v[30:31], v[244:245]
    v_pk_add_f32 v[32:33], v[32:33], v[244:245]
    v_pk_add_f32 v[34:35], v[34:35], v[244:245]
    v_rcp_f32 v28, v28
    v_rcp_f32 v29, v29
    v_rcp_f32 v30, v30
    v_rcp_f32 v31, v31
    v_rcp_f32 v32, v32
    v_rcp_f32 v33, v33
    v_rcp_f32 v34, v34
    v_rcp_f32 v35, v35
    v_pk_mul_f32 v[20:21], v[28:29], v[20:21]
    v_pk_mul_f32 v[22:23], v[30:31], v[22:23]
    v_pk_mul_f32 v[24:25], v[32:33], v[24:25]
    v_pk_mul_f32 v[26:27], v[34:35], v[26:27]
    v_cvt_pk_bf16_f32 v36, v20, v21
    v_cvt_pk_bf16_f32 v37, v22, v23
    v_cvt_pk_bf16_f32 v38, v24, v25
    v_cvt_pk_bf16_f32 v39, v26, v27
    buffer_store_dwordx4 v[36:39], v251, s[4:7], s53 offen offset:0 sc1
    v_accvgpr_read_b32 v40, a232
    v_accvgpr_read_b32 v41, a233
    v_accvgpr_read_b32 v42, a234
    v_accvgpr_read_b32 v43, a235
    v_accvgpr_read_b32 v44, a236
    v_accvgpr_read_b32 v45, a237
    v_accvgpr_read_b32 v46, a238
    v_accvgpr_read_b32 v47, a239
    v_pk_mul_f32 v[48:49], v[40:41], v[40:41]
    v_pk_mul_f32 v[50:51], v[42:43], v[42:43]
    v_pk_mul_f32 v[52:53], v[44:45], v[44:45]
    v_pk_mul_f32 v[54:55], v[46:47], v[46:47]
    v_pk_fma_f32 v[48:49], v[48:49], v[242:243], v[240:241]
    v_pk_fma_f32 v[50:51], v[50:51], v[242:243], v[240:241]
    v_pk_fma_f32 v[52:53], v[52:53], v[242:243], v[240:241]
    v_pk_fma_f32 v[54:55], v[54:55], v[242:243], v[240:241]
    v_pk_mul_f32 v[48:49], v[48:49], v[40:41]
    v_pk_mul_f32 v[50:51], v[50:51], v[42:43]
    v_pk_mul_f32 v[52:53], v[52:53], v[44:45]
    v_pk_mul_f32 v[54:55], v[54:55], v[46:47]
    v_exp_f32 v48, v48
    v_exp_f32 v49, v49
    v_exp_f32 v50, v50
    v_exp_f32 v51, v51
    v_exp_f32 v52, v52
    v_exp_f32 v53, v53
    v_exp_f32 v54, v54
    v_exp_f32 v55, v55
    v_pk_add_f32 v[48:49], v[48:49], v[244:245]
    v_pk_add_f32 v[50:51], v[50:51], v[244:245]
    v_pk_add_f32 v[52:53], v[52:53], v[244:245]
    v_pk_add_f32 v[54:55], v[54:55], v[244:245]
    v_rcp_f32 v48, v48
    v_rcp_f32 v49, v49
    v_rcp_f32 v50, v50
    v_rcp_f32 v51, v51
    v_rcp_f32 v52, v52
    v_rcp_f32 v53, v53
    v_rcp_f32 v54, v54
    v_rcp_f32 v55, v55
    v_pk_mul_f32 v[40:41], v[48:49], v[40:41]
    v_pk_mul_f32 v[42:43], v[50:51], v[42:43]
    v_pk_mul_f32 v[44:45], v[52:53], v[44:45]
    v_pk_mul_f32 v[46:47], v[54:55], v[46:47]
    v_cvt_pk_bf16_f32 v56, v40, v41
    v_cvt_pk_bf16_f32 v57, v42, v43
    v_cvt_pk_bf16_f32 v58, v44, v45
    v_cvt_pk_bf16_f32 v59, v46, v47
    buffer_store_dwordx4 v[56:59], v251, s[4:7], s53 offen offset:1024 sc1
    v_accvgpr_read_b32 v0, a240
    v_accvgpr_read_b32 v1, a241
    v_accvgpr_read_b32 v2, a242
    v_accvgpr_read_b32 v3, a243
    v_accvgpr_read_b32 v4, a244
    v_accvgpr_read_b32 v5, a245
    v_accvgpr_read_b32 v6, a246
    v_accvgpr_read_b32 v7, a247
    v_pk_mul_f32 v[8:9], v[0:1], v[0:1]
    v_pk_mul_f32 v[10:11], v[2:3], v[2:3]
    v_pk_mul_f32 v[12:13], v[4:5], v[4:5]
    v_pk_mul_f32 v[14:15], v[6:7], v[6:7]
    v_pk_fma_f32 v[8:9], v[8:9], v[242:243], v[240:241]
    v_pk_fma_f32 v[10:11], v[10:11], v[242:243], v[240:241]
    v_pk_fma_f32 v[12:13], v[12:13], v[242:243], v[240:241]
    v_pk_fma_f32 v[14:15], v[14:15], v[242:243], v[240:241]
    v_pk_mul_f32 v[8:9], v[8:9], v[0:1]
    v_pk_mul_f32 v[10:11], v[10:11], v[2:3]
    v_pk_mul_f32 v[12:13], v[12:13], v[4:5]
    v_pk_mul_f32 v[14:15], v[14:15], v[6:7]
    v_exp_f32 v8, v8
    v_exp_f32 v9, v9
    v_exp_f32 v10, v10
    v_exp_f32 v11, v11
    v_exp_f32 v12, v12
    v_exp_f32 v13, v13
    v_exp_f32 v14, v14
    v_exp_f32 v15, v15
    v_pk_add_f32 v[8:9], v[8:9], v[244:245]
    v_pk_add_f32 v[10:11], v[10:11], v[244:245]
    v_pk_add_f32 v[12:13], v[12:13], v[244:245]
    v_pk_add_f32 v[14:15], v[14:15], v[244:245]
    v_rcp_f32 v8, v8
    v_rcp_f32 v9, v9
    v_rcp_f32 v10, v10
    v_rcp_f32 v11, v11
    v_rcp_f32 v12, v12
    v_rcp_f32 v13, v13
    v_rcp_f32 v14, v14
    v_rcp_f32 v15, v15
    v_pk_mul_f32 v[0:1], v[8:9], v[0:1]
    v_pk_mul_f32 v[2:3], v[10:11], v[2:3]
    v_pk_mul_f32 v[4:5], v[12:13], v[4:5]
    v_pk_mul_f32 v[6:7], v[14:15], v[6:7]
    v_cvt_pk_bf16_f32 v16, v0, v1
    v_cvt_pk_bf16_f32 v17, v2, v3
    v_cvt_pk_bf16_f32 v18, v4, v5
    v_cvt_pk_bf16_f32 v19, v6, v7
    buffer_store_dwordx4 v[16:19], v251, s[4:7], s53 offen offset:2048 sc1
    v_accvgpr_read_b32 v20, a248
    v_accvgpr_read_b32 v21, a249
    v_accvgpr_read_b32 v22, a250
    v_accvgpr_read_b32 v23, a251
    v_accvgpr_read_b32 v24, a252
    v_accvgpr_read_b32 v25, a253
    v_accvgpr_read_b32 v26, a254
    v_accvgpr_read_b32 v27, a255
    v_pk_mul_f32 v[28:29], v[20:21], v[20:21]
    v_pk_mul_f32 v[30:31], v[22:23], v[22:23]
    v_pk_mul_f32 v[32:33], v[24:25], v[24:25]
    v_pk_mul_f32 v[34:35], v[26:27], v[26:27]
    v_pk_fma_f32 v[28:29], v[28:29], v[242:243], v[240:241]
    v_pk_fma_f32 v[30:31], v[30:31], v[242:243], v[240:241]
    v_pk_fma_f32 v[32:33], v[32:33], v[242:243], v[240:241]
    v_pk_fma_f32 v[34:35], v[34:35], v[242:243], v[240:241]
    v_pk_mul_f32 v[28:29], v[28:29], v[20:21]
    v_pk_mul_f32 v[30:31], v[30:31], v[22:23]
    v_pk_mul_f32 v[32:33], v[32:33], v[24:25]
    v_pk_mul_f32 v[34:35], v[34:35], v[26:27]
    v_exp_f32 v28, v28
    v_exp_f32 v29, v29
    v_exp_f32 v30, v30
    v_exp_f32 v31, v31
    v_exp_f32 v32, v32
    v_exp_f32 v33, v33
    v_exp_f32 v34, v34
    v_exp_f32 v35, v35
    v_pk_add_f32 v[28:29], v[28:29], v[244:245]
    v_pk_add_f32 v[30:31], v[30:31], v[244:245]
    v_pk_add_f32 v[32:33], v[32:33], v[244:245]
    v_pk_add_f32 v[34:35], v[34:35], v[244:245]
    v_rcp_f32 v28, v28
    v_rcp_f32 v29, v29
    v_rcp_f32 v30, v30
    v_rcp_f32 v31, v31
    v_rcp_f32 v32, v32
    v_rcp_f32 v33, v33
    v_rcp_f32 v34, v34
    v_rcp_f32 v35, v35
    v_pk_mul_f32 v[20:21], v[28:29], v[20:21]
    v_pk_mul_f32 v[22:23], v[30:31], v[22:23]
    v_pk_mul_f32 v[24:25], v[32:33], v[24:25]
    v_pk_mul_f32 v[26:27], v[34:35], v[26:27]
    v_cvt_pk_bf16_f32 v36, v20, v21
    v_cvt_pk_bf16_f32 v37, v22, v23
    v_cvt_pk_bf16_f32 v38, v24, v25
    v_cvt_pk_bf16_f32 v39, v26, v27
    buffer_store_dwordx4 v[36:39], v251, s[4:7], s53 offen offset:3072 sc1
    s_branch main_kernel_w_done
main_kernel_w_c2_gov:
    v_lshrrev_b32 v0, 4, v250
    v_bfe_u32 v1, v250, 2, 2
    v_lshl_add_u32 v4, v0, 2, v1
    v_and_b32 v5, 7, v4
    v_mul_u32_u24 v4, 512, v4
    v_and_b32 v6, 3, v250
    v_lshl_add_u32 v4, v6, 3, v4
    s_mul_i32 s32, s37, 8
    v_xor_b32 v5, s32, v5
    v_lshl_add_u32 v128, v5, 5, v4
    v_xor_b32 v129, 32, v128
    v_xor_b32 v130, 64, v128
    v_xor_b32 v131, 96, v128
    v_xor_b32 v132, 128, v128
    v_xor_b32 v133, 160, v128
    v_xor_b32 v134, 192, v128
    v_xor_b32 v135, 224, v128
    s_mul_i32 s32, s38, 8192
    s_add_u32 s32, s32, 65536
    v_add_u32 v136, s32, v251
    v_lshrrev_b32 v2, 5, v250
    v_and_b32 v3, 31, v250
    s_mul_i32 s32, s14, 8
    v_add_u32 v4, s32, v2
    v_add_u32 v5, 0, v4
    v_and_b32 v6, 7, v5
    v_lshlrev_b32 v6, 1, v6
    v_xor_b32 v6, v6, v3
    v_mul_lo_u32 v5, v5, s30
    v_lshl_add_u32 v5, v6, 4, v5
    v_subrev_u32 v137, 0, v5
    v_add_u32 v5, 2, v4
    v_and_b32 v6, 7, v5
    v_lshlrev_b32 v6, 1, v6
    v_xor_b32 v6, v6, v3
    v_mul_lo_u32 v5, v5, s30
    v_lshl_add_u32 v5, v6, 4, v5
    v_subrev_u32 v138, 1024, v5
    v_add_u32 v5, 4, v4
    v_and_b32 v6, 7, v5
    v_lshlrev_b32 v6, 1, v6
    v_xor_b32 v6, v6, v3
    v_mul_lo_u32 v5, v5, s30
    v_lshl_add_u32 v5, v6, 4, v5
    v_subrev_u32 v139, 2048, v5
    v_add_u32 v5, 6, v4
    v_and_b32 v6, 7, v5
    v_lshlrev_b32 v6, 1, v6
    v_xor_b32 v6, v6, v3
    v_mul_lo_u32 v5, v5, s30
    v_lshl_add_u32 v5, v6, 4, v5
    v_subrev_u32 v140, 3072, v5
    s_mul_i32 s32, s14, 4
    s_mul_i32 s32, s32, s31
    v_add_u32 v141, s32, v251
    s_add_u32 s32, s32, s31
    s_sub_u32 s32, s32, 1024
    v_add_u32 v142, s32, v251
    s_add_u32 s32, s32, s31
    s_sub_u32 s32, s32, 1024
    v_add_u32 v143, s32, v251
    s_add_u32 s32, s32, s31
    s_sub_u32 s32, s32, 1024
    v_add_u32 v144, s32, v251
    s_mul_i32 s19, s14, 4096
    s_mul_i32 s20, s14, 4096
    s_add_u32 s20, s20, 65536
    s_mul_i32 s17, s30, 32
    s_mov_b32 s15, 0
    s_add_u32 m0, s20, 0
    s_nop 0
    buffer_load_dwordx4 v141, s[4:7], s16 offen offset:0 sc1 lds
    buffer_load_dwordx4 v142, s[4:7], s16 offen offset:1024 sc1 lds
    buffer_load_dwordx4 v143, s[4:7], s16 offen offset:2048 sc1 lds
    buffer_load_dwordx4 v144, s[4:7], s16 offen offset:3072 sc1 lds
    s_add_u32 s16, s16, 1024
    s_add_u32 m0, s19, 0
    s_nop 0
    buffer_load_dwordx4 v137, s[8:11], s15 offen offset:0 lds
    buffer_load_dwordx4 v138, s[8:11], s15 offen offset:1024 lds
    buffer_load_dwordx4 v139, s[8:11], s15 offen offset:2048 lds
    buffer_load_dwordx4 v140, s[8:11], s15 offen offset:3072 lds
    s_add_u32 s15, s15, s17
    s_add_u32 m0, s20, 16384
    s_nop 0
    buffer_load_dwordx4 v141, s[4:7], s16 offen offset:0 sc1 lds
    buffer_load_dwordx4 v142, s[4:7], s16 offen offset:1024 sc1 lds
    buffer_load_dwordx4 v143, s[4:7], s16 offen offset:2048 sc1 lds
    buffer_load_dwordx4 v144, s[4:7], s16 offen offset:3072 sc1 lds
    s_add_u32 s16, s16, 1024
    s_add_u32 m0, s19, 16384
    s_nop 0
    buffer_load_dwordx4 v137, s[8:11], s15 offen offset:0 lds
    buffer_load_dwordx4 v138, s[8:11], s15 offen offset:1024 lds
    buffer_load_dwordx4 v139, s[8:11], s15 offen offset:2048 lds
    buffer_load_dwordx4 v140, s[8:11], s15 offen offset:3072 lds
    s_add_u32 s15, s15, s17
    s_add_u32 m0, s20, 32768
    s_nop 0
    buffer_load_dwordx4 v141, s[4:7], s16 offen offset:0 sc1 lds
    buffer_load_dwordx4 v142, s[4:7], s16 offen offset:1024 sc1 lds
    buffer_load_dwordx4 v143, s[4:7], s16 offen offset:2048 sc1 lds
    buffer_load_dwordx4 v144, s[4:7], s16 offen offset:3072 sc1 lds
    s_add_u32 s16, s16, 1024
    s_add_u32 m0, s19, 32768
    s_nop 0
    buffer_load_dwordx4 v137, s[8:11], s15 offen offset:0 lds
    buffer_load_dwordx4 v138, s[8:11], s15 offen offset:1024 lds
    buffer_load_dwordx4 v139, s[8:11], s15 offen offset:2048 lds
    buffer_load_dwordx4 v140, s[8:11], s15 offen offset:3072 lds
    s_add_u32 s15, s15, s17
    s_add_u32 m0, s20, 49152
    s_nop 0
    buffer_load_dwordx4 v141, s[4:7], s16 offen offset:0 sc1 lds
    buffer_load_dwordx4 v142, s[4:7], s16 offen offset:1024 sc1 lds
    buffer_load_dwordx4 v143, s[4:7], s16 offen offset:2048 sc1 lds
    buffer_load_dwordx4 v144, s[4:7], s16 offen offset:3072 sc1 lds
    s_add_u32 s16, s16, 1024
    s_add_u32 m0, s19, 49152
    s_nop 0
    buffer_load_dwordx4 v137, s[8:11], s15 offen offset:0 lds
    buffer_load_dwordx4 v138, s[8:11], s15 offen offset:1024 lds
    buffer_load_dwordx4 v139, s[8:11], s15 offen offset:2048 lds
    buffer_load_dwordx4 v140, s[8:11], s15 offen offset:3072 lds
    s_add_u32 s15, s15, s17
    v_accvgpr_write_b32 a0, 0
    v_accvgpr_write_b32 a1, 0
    v_accvgpr_write_b32 a2, 0
    v_accvgpr_write_b32 a3, 0
    v_accvgpr_write_b32 a4, 0
    v_accvgpr_write_b32 a5, 0
    v_accvgpr_write_b32 a6, 0
    v_accvgpr_write_b32 a7, 0
    v_accvgpr_write_b32 a8, 0
    v_accvgpr_write_b32 a9, 0
    v_accvgpr_write_b32 a10, 0
    v_accvgpr_write_b32 a11, 0
    v_accvgpr_write_b32 a12, 0
    v_accvgpr_write_b32 a13, 0
    v_accvgpr_write_b32 a14, 0
    v_accvgpr_write_b32 a15, 0
    v_accvgpr_write_b32 a16, 0
    v_accvgpr_write_b32 a17, 0
    v_accvgpr_write_b32 a18, 0
    v_accvgpr_write_b32 a19, 0
    v_accvgpr_write_b32 a20, 0
    v_accvgpr_write_b32 a21, 0
    v_accvgpr_write_b32 a22, 0
    v_accvgpr_write_b32 a23, 0
    v_accvgpr_write_b32 a24, 0
    v_accvgpr_write_b32 a25, 0
    v_accvgpr_write_b32 a26, 0
    v_accvgpr_write_b32 a27, 0
    v_accvgpr_write_b32 a28, 0
    v_accvgpr_write_b32 a29, 0
    v_accvgpr_write_b32 a30, 0
    v_accvgpr_write_b32 a31, 0
    v_accvgpr_write_b32 a32, 0
    v_accvgpr_write_b32 a33, 0
    v_accvgpr_write_b32 a34, 0
    v_accvgpr_write_b32 a35, 0
    v_accvgpr_write_b32 a36, 0
    v_accvgpr_write_b32 a37, 0
    v_accvgpr_write_b32 a38, 0
    v_accvgpr_write_b32 a39, 0
    v_accvgpr_write_b32 a40, 0
    v_accvgpr_write_b32 a41, 0
    v_accvgpr_write_b32 a42, 0
    v_accvgpr_write_b32 a43, 0
    v_accvgpr_write_b32 a44, 0
    v_accvgpr_write_b32 a45, 0
    v_accvgpr_write_b32 a46, 0
    v_accvgpr_write_b32 a47, 0
    v_accvgpr_write_b32 a48, 0
    v_accvgpr_write_b32 a49, 0
    v_accvgpr_write_b32 a50, 0
    v_accvgpr_write_b32 a51, 0
    v_accvgpr_write_b32 a52, 0
    v_accvgpr_write_b32 a53, 0
    v_accvgpr_write_b32 a54, 0
    v_accvgpr_write_b32 a55, 0
    v_accvgpr_write_b32 a56, 0
    v_accvgpr_write_b32 a57, 0
    v_accvgpr_write_b32 a58, 0
    v_accvgpr_write_b32 a59, 0
    v_accvgpr_write_b32 a60, 0
    v_accvgpr_write_b32 a61, 0
    v_accvgpr_write_b32 a62, 0
    v_accvgpr_write_b32 a63, 0
    v_accvgpr_write_b32 a64, 0
    v_accvgpr_write_b32 a65, 0
    v_accvgpr_write_b32 a66, 0
    v_accvgpr_write_b32 a67, 0
    v_accvgpr_write_b32 a68, 0
    v_accvgpr_write_b32 a69, 0
    v_accvgpr_write_b32 a70, 0
    v_accvgpr_write_b32 a71, 0
    v_accvgpr_write_b32 a72, 0
    v_accvgpr_write_b32 a73, 0
    v_accvgpr_write_b32 a74, 0
    v_accvgpr_write_b32 a75, 0
    v_accvgpr_write_b32 a76, 0
    v_accvgpr_write_b32 a77, 0
    v_accvgpr_write_b32 a78, 0
    v_accvgpr_write_b32 a79, 0
    v_accvgpr_write_b32 a80, 0
    v_accvgpr_write_b32 a81, 0
    v_accvgpr_write_b32 a82, 0
    v_accvgpr_write_b32 a83, 0
    v_accvgpr_write_b32 a84, 0
    v_accvgpr_write_b32 a85, 0
    v_accvgpr_write_b32 a86, 0
    v_accvgpr_write_b32 a87, 0
    v_accvgpr_write_b32 a88, 0
    v_accvgpr_write_b32 a89, 0
    v_accvgpr_write_b32 a90, 0
    v_accvgpr_write_b32 a91, 0
    v_accvgpr_write_b32 a92, 0
    v_accvgpr_write_b32 a93, 0
    v_accvgpr_write_b32 a94, 0
    v_accvgpr_write_b32 a95, 0
    v_accvgpr_write_b32 a96, 0
    v_accvgpr_write_b32 a97, 0
    v_accvgpr_write_b32 a98, 0
    v_accvgpr_write_b32 a99, 0
    v_accvgpr_write_b32 a100, 0
    v_accvgpr_write_b32 a101, 0
    v_accvgpr_write_b32 a102, 0
    v_accvgpr_write_b32 a103, 0
    v_accvgpr_write_b32 a104, 0
    v_accvgpr_write_b32 a105, 0
    v_accvgpr_write_b32 a106, 0
    v_accvgpr_write_b32 a107, 0
    v_accvgpr_write_b32 a108, 0
    v_accvgpr_write_b32 a109, 0
    v_accvgpr_write_b32 a110, 0
    v_accvgpr_write_b32 a111, 0
    v_accvgpr_write_b32 a112, 0
    v_accvgpr_write_b32 a113, 0
    v_accvgpr_write_b32 a114, 0
    v_accvgpr_write_b32 a115, 0
    v_accvgpr_write_b32 a116, 0
    v_accvgpr_write_b32 a117, 0
    v_accvgpr_write_b32 a118, 0
    v_accvgpr_write_b32 a119, 0
    v_accvgpr_write_b32 a120, 0
    v_accvgpr_write_b32 a121, 0
    v_accvgpr_write_b32 a122, 0
    v_accvgpr_write_b32 a123, 0
    v_accvgpr_write_b32 a124, 0
    v_accvgpr_write_b32 a125, 0
    v_accvgpr_write_b32 a126, 0
    v_accvgpr_write_b32 a127, 0
    v_accvgpr_write_b32 a128, 0
    v_accvgpr_write_b32 a129, 0
    v_accvgpr_write_b32 a130, 0
    v_accvgpr_write_b32 a131, 0
    v_accvgpr_write_b32 a132, 0
    v_accvgpr_write_b32 a133, 0
    v_accvgpr_write_b32 a134, 0
    v_accvgpr_write_b32 a135, 0
    v_accvgpr_write_b32 a136, 0
    v_accvgpr_write_b32 a137, 0
    v_accvgpr_write_b32 a138, 0
    v_accvgpr_write_b32 a139, 0
    v_accvgpr_write_b32 a140, 0
    v_accvgpr_write_b32 a141, 0
    v_accvgpr_write_b32 a142, 0
    v_accvgpr_write_b32 a143, 0
    v_accvgpr_write_b32 a144, 0
    v_accvgpr_write_b32 a145, 0
    v_accvgpr_write_b32 a146, 0
    v_accvgpr_write_b32 a147, 0
    v_accvgpr_write_b32 a148, 0
    v_accvgpr_write_b32 a149, 0
    v_accvgpr_write_b32 a150, 0
    v_accvgpr_write_b32 a151, 0
    v_accvgpr_write_b32 a152, 0
    v_accvgpr_write_b32 a153, 0
    v_accvgpr_write_b32 a154, 0
    v_accvgpr_write_b32 a155, 0
    v_accvgpr_write_b32 a156, 0
    v_accvgpr_write_b32 a157, 0
    v_accvgpr_write_b32 a158, 0
    v_accvgpr_write_b32 a159, 0
    v_accvgpr_write_b32 a160, 0
    v_accvgpr_write_b32 a161, 0
    v_accvgpr_write_b32 a162, 0
    v_accvgpr_write_b32 a163, 0
    v_accvgpr_write_b32 a164, 0
    v_accvgpr_write_b32 a165, 0
    v_accvgpr_write_b32 a166, 0
    v_accvgpr_write_b32 a167, 0
    v_accvgpr_write_b32 a168, 0
    v_accvgpr_write_b32 a169, 0
    v_accvgpr_write_b32 a170, 0
    v_accvgpr_write_b32 a171, 0
    v_accvgpr_write_b32 a172, 0
    v_accvgpr_write_b32 a173, 0
    v_accvgpr_write_b32 a174, 0
    v_accvgpr_write_b32 a175, 0
    v_accvgpr_write_b32 a176, 0
    v_accvgpr_write_b32 a177, 0
    v_accvgpr_write_b32 a178, 0
    v_accvgpr_write_b32 a179, 0
    v_accvgpr_write_b32 a180, 0
    v_accvgpr_write_b32 a181, 0
    v_accvgpr_write_b32 a182, 0
    v_accvgpr_write_b32 a183, 0
    v_accvgpr_write_b32 a184, 0
    v_accvgpr_write_b32 a185, 0
    v_accvgpr_write_b32 a186, 0
    v_accvgpr_write_b32 a187, 0
    v_accvgpr_write_b32 a188, 0
    v_accvgpr_write_b32 a189, 0
    v_accvgpr_write_b32 a190, 0
    v_accvgpr_write_b32 a191, 0
    v_accvgpr_write_b32 a192, 0
    v_accvgpr_write_b32 a193, 0
    v_accvgpr_write_b32 a194, 0
    v_accvgpr_write_b32 a195, 0
    v_accvgpr_write_b32 a196, 0
    v_accvgpr_write_b32 a197, 0
    v_accvgpr_write_b32 a198, 0
    v_accvgpr_write_b32 a199, 0
    v_accvgpr_write_b32 a200, 0
    v_accvgpr_write_b32 a201, 0
    v_accvgpr_write_b32 a202, 0
    v_accvgpr_write_b32 a203, 0
    v_accvgpr_write_b32 a204, 0
    v_accvgpr_write_b32 a205, 0
    v_accvgpr_write_b32 a206, 0
    v_accvgpr_write_b32 a207, 0
    v_accvgpr_write_b32 a208, 0
    v_accvgpr_write_b32 a209, 0
    v_accvgpr_write_b32 a210, 0
    v_accvgpr_write_b32 a211, 0
    v_accvgpr_write_b32 a212, 0
    v_accvgpr_write_b32 a213, 0
    v_accvgpr_write_b32 a214, 0
    v_accvgpr_write_b32 a215, 0
    v_accvgpr_write_b32 a216, 0
    v_accvgpr_write_b32 a217, 0
    v_accvgpr_write_b32 a218, 0
    v_accvgpr_write_b32 a219, 0
    v_accvgpr_write_b32 a220, 0
    v_accvgpr_write_b32 a221, 0
    v_accvgpr_write_b32 a222, 0
    v_accvgpr_write_b32 a223, 0
    v_accvgpr_write_b32 a224, 0
    v_accvgpr_write_b32 a225, 0
    v_accvgpr_write_b32 a226, 0
    v_accvgpr_write_b32 a227, 0
    v_accvgpr_write_b32 a228, 0
    v_accvgpr_write_b32 a229, 0
    v_accvgpr_write_b32 a230, 0
    v_accvgpr_write_b32 a231, 0
    v_accvgpr_write_b32 a232, 0
    v_accvgpr_write_b32 a233, 0
    v_accvgpr_write_b32 a234, 0
    v_accvgpr_write_b32 a235, 0
    v_accvgpr_write_b32 a236, 0
    v_accvgpr_write_b32 a237, 0
    v_accvgpr_write_b32 a238, 0
    v_accvgpr_write_b32 a239, 0
    v_accvgpr_write_b32 a240, 0
    v_accvgpr_write_b32 a241, 0
    v_accvgpr_write_b32 a242, 0
    v_accvgpr_write_b32 a243, 0
    v_accvgpr_write_b32 a244, 0
    v_accvgpr_write_b32 a245, 0
    v_accvgpr_write_b32 a246, 0
    v_accvgpr_write_b32 a247, 0
    v_accvgpr_write_b32 a248, 0
    v_accvgpr_write_b32 a249, 0
    v_accvgpr_write_b32 a250, 0
    v_accvgpr_write_b32 a251, 0
    v_accvgpr_write_b32 a252, 0
    v_accvgpr_write_b32 a253, 0
    v_accvgpr_write_b32 a254, 0
    v_accvgpr_write_b32 a255, 0
    s_waitcnt vmcnt(24)
    s_barrier
    ds_read_b128 v[32:35], v136 offset:0
    ds_read_b64_tr_b16 v[0:1], v128 offset:0
    ds_read_b64_tr_b16 v[2:3], v128 offset:8192
    ds_read_b64_tr_b16 v[4:5], v129 offset:0
    ds_read_b64_tr_b16 v[6:7], v129 offset:8192
    ds_read_b64_tr_b16 v[8:9], v130 offset:0
    ds_read_b64_tr_b16 v[10:11], v130 offset:8192
    ds_read_b64_tr_b16 v[12:13], v131 offset:0
    ds_read_b64_tr_b16 v[14:15], v131 offset:8192
    ds_read_b64_tr_b16 v[16:17], v132 offset:0
    ds_read_b64_tr_b16 v[18:19], v132 offset:8192
    ds_read_b64_tr_b16 v[20:21], v133 offset:0
    ds_read_b64_tr_b16 v[22:23], v133 offset:8192
    ds_read_b64_tr_b16 v[24:25], v134 offset:0
    ds_read_b64_tr_b16 v[26:27], v134 offset:8192
    ds_read_b64_tr_b16 v[28:29], v135 offset:0
    ds_read_b64_tr_b16 v[30:31], v135 offset:8192
    ds_read_b128 v[36:39], v136 offset:1024
    ds_read_b128 v[40:43], v136 offset:2048
    ds_read_b128 v[44:47], v136 offset:3072
    ds_read_b128 v[48:51], v136 offset:4096
    ds_read_b128 v[52:55], v136 offset:5120
    ds_read_b128 v[56:59], v136 offset:6144
    ds_read_b128 v[60:63], v136 offset:7168
main_kernel_w_c2_v_loop:
    s_waitcnt lgkmcnt(0)
    v_mfma_f32_16x16x32_bf16 a[0:3], v[32:35], v[0:3], a[0:3]
    s_waitcnt vmcnt(16)
    s_barrier
    ds_read_b128 v[96:99], v136 offset:16384
    s_add_u32 m0, s20, 0
    s_nop 0
    v_mfma_f32_16x16x32_bf16 a[4:7], v[32:35], v[4:7], a[4:7]
    ds_read_b64_tr_b16 v[64:65], v128 offset:16384
    v_mfma_f32_16x16x32_bf16 a[8:11], v[32:35], v[8:11], a[8:11]
    ds_read_b64_tr_b16 v[66:67], v128 offset:24576
    v_mfma_f32_16x16x32_bf16 a[12:15], v[32:35], v[12:15], a[12:15]
    ds_read_b64_tr_b16 v[68:69], v129 offset:16384
    v_mfma_f32_16x16x32_bf16 a[16:19], v[32:35], v[16:19], a[16:19]
    ds_read_b64_tr_b16 v[70:71], v129 offset:24576
    v_mfma_f32_16x16x32_bf16 a[20:23], v[32:35], v[20:23], a[20:23]
    ds_read_b64_tr_b16 v[72:73], v130 offset:16384
    buffer_load_dwordx4 v141, s[4:7], s16 offen offset:0 sc1 lds
    v_mfma_f32_16x16x32_bf16 a[24:27], v[32:35], v[24:27], a[24:27]
    ds_read_b64_tr_b16 v[74:75], v130 offset:24576
    v_mfma_f32_16x16x32_bf16 a[28:31], v[32:35], v[28:31], a[28:31]
    ds_read_b64_tr_b16 v[76:77], v131 offset:16384
    v_mfma_f32_16x16x32_bf16 a[32:35], v[36:39], v[0:3], a[32:35]
    ds_read_b64_tr_b16 v[78:79], v131 offset:24576
    v_mfma_f32_16x16x32_bf16 a[36:39], v[36:39], v[4:7], a[36:39]
    ds_read_b64_tr_b16 v[80:81], v132 offset:16384
    v_mfma_f32_16x16x32_bf16 a[40:43], v[36:39], v[8:11], a[40:43]
    ds_read_b64_tr_b16 v[82:83], v132 offset:24576
    buffer_load_dwordx4 v142, s[4:7], s16 offen offset:1024 sc1 lds
    v_mfma_f32_16x16x32_bf16 a[44:47], v[36:39], v[12:15], a[44:47]
    ds_read_b64_tr_b16 v[84:85], v133 offset:16384
    v_mfma_f32_16x16x32_bf16 a[48:51], v[36:39], v[16:19], a[48:51]
    ds_read_b64_tr_b16 v[86:87], v133 offset:24576
    v_mfma_f32_16x16x32_bf16 a[52:55], v[36:39], v[20:23], a[52:55]
    ds_read_b64_tr_b16 v[88:89], v134 offset:16384
    v_mfma_f32_16x16x32_bf16 a[56:59], v[36:39], v[24:27], a[56:59]
    ds_read_b64_tr_b16 v[90:91], v134 offset:24576
    v_mfma_f32_16x16x32_bf16 a[60:63], v[36:39], v[28:31], a[60:63]
    ds_read_b64_tr_b16 v[92:93], v135 offset:16384
    buffer_load_dwordx4 v143, s[4:7], s16 offen offset:2048 sc1 lds
    v_mfma_f32_16x16x32_bf16 a[64:67], v[40:43], v[0:3], a[64:67]
    ds_read_b64_tr_b16 v[94:95], v135 offset:24576
    v_mfma_f32_16x16x32_bf16 a[68:71], v[40:43], v[4:7], a[68:71]
    ds_read_b128 v[100:103], v136 offset:17408
    v_mfma_f32_16x16x32_bf16 a[72:75], v[40:43], v[8:11], a[72:75]
    ds_read_b128 v[104:107], v136 offset:18432
    v_mfma_f32_16x16x32_bf16 a[76:79], v[40:43], v[12:15], a[76:79]
    ds_read_b128 v[108:111], v136 offset:19456
    v_mfma_f32_16x16x32_bf16 a[80:83], v[40:43], v[16:19], a[80:83]
    ds_read_b128 v[112:115], v136 offset:20480
    v_mfma_f32_16x16x32_bf16 a[84:87], v[40:43], v[20:23], a[84:87]
    ds_read_b128 v[116:119], v136 offset:21504
    buffer_load_dwordx4 v144, s[4:7], s16 offen offset:3072 sc1 lds
    v_mfma_f32_16x16x32_bf16 a[88:91], v[40:43], v[24:27], a[88:91]
    ds_read_b128 v[120:123], v136 offset:22528
    v_mfma_f32_16x16x32_bf16 a[92:95], v[40:43], v[28:31], a[92:95]
    ds_read_b128 v[124:127], v136 offset:23552
    v_mfma_f32_16x16x32_bf16 a[96:99], v[44:47], v[0:3], a[96:99]
    v_mfma_f32_16x16x32_bf16 a[100:103], v[44:47], v[4:7], a[100:103]
    v_mfma_f32_16x16x32_bf16 a[104:107], v[44:47], v[8:11], a[104:107]
    s_add_u32 s16, s16, 1024
    v_mfma_f32_16x16x32_bf16 a[108:111], v[44:47], v[12:15], a[108:111]
    v_mfma_f32_16x16x32_bf16 a[112:115], v[44:47], v[16:19], a[112:115]
    v_mfma_f32_16x16x32_bf16 a[116:119], v[44:47], v[20:23], a[116:119]
    v_mfma_f32_16x16x32_bf16 a[120:123], v[44:47], v[24:27], a[120:123]
    v_mfma_f32_16x16x32_bf16 a[124:127], v[44:47], v[28:31], a[124:127]
    s_add_u32 m0, s19, 0
    s_nop 0
    v_mfma_f32_16x16x32_bf16 a[128:131], v[48:51], v[0:3], a[128:131]
    v_mfma_f32_16x16x32_bf16 a[132:135], v[48:51], v[4:7], a[132:135]
    v_mfma_f32_16x16x32_bf16 a[136:139], v[48:51], v[8:11], a[136:139]
    v_mfma_f32_16x16x32_bf16 a[140:143], v[48:51], v[12:15], a[140:143]
    v_mfma_f32_16x16x32_bf16 a[144:147], v[48:51], v[16:19], a[144:147]
    buffer_load_dwordx4 v137, s[8:11], s15 offen offset:0 lds
    v_mfma_f32_16x16x32_bf16 a[148:151], v[48:51], v[20:23], a[148:151]
    v_mfma_f32_16x16x32_bf16 a[152:155], v[48:51], v[24:27], a[152:155]
    v_mfma_f32_16x16x32_bf16 a[156:159], v[48:51], v[28:31], a[156:159]
    v_mfma_f32_16x16x32_bf16 a[160:163], v[52:55], v[0:3], a[160:163]
    v_mfma_f32_16x16x32_bf16 a[164:167], v[52:55], v[4:7], a[164:167]
    v_mfma_f32_16x16x32_bf16 a[168:171], v[52:55], v[8:11], a[168:171]
    buffer_load_dwordx4 v138, s[8:11], s15 offen offset:1024 lds
    v_mfma_f32_16x16x32_bf16 a[172:175], v[52:55], v[12:15], a[172:175]
    v_mfma_f32_16x16x32_bf16 a[176:179], v[52:55], v[16:19], a[176:179]
    v_mfma_f32_16x16x32_bf16 a[180:183], v[52:55], v[20:23], a[180:183]
    v_mfma_f32_16x16x32_bf16 a[184:187], v[52:55], v[24:27], a[184:187]
    v_mfma_f32_16x16x32_bf16 a[188:191], v[52:55], v[28:31], a[188:191]
    buffer_load_dwordx4 v139, s[8:11], s15 offen offset:2048 lds
    v_mfma_f32_16x16x32_bf16 a[192:195], v[56:59], v[0:3], a[192:195]
    v_mfma_f32_16x16x32_bf16 a[196:199], v[56:59], v[4:7], a[196:199]
    v_mfma_f32_16x16x32_bf16 a[200:203], v[56:59], v[8:11], a[200:203]
    v_mfma_f32_16x16x32_bf16 a[204:207], v[56:59], v[12:15], a[204:207]
    v_mfma_f32_16x16x32_bf16 a[208:211], v[56:59], v[16:19], a[208:211]
    buffer_load_dwordx4 v140, s[8:11], s15 offen offset:3072 lds
    v_mfma_f32_16x16x32_bf16 a[212:215], v[56:59], v[20:23], a[212:215]
    v_mfma_f32_16x16x32_bf16 a[216:219], v[56:59], v[24:27], a[216:219]
    v_mfma_f32_16x16x32_bf16 a[220:223], v[56:59], v[28:31], a[220:223]
    v_mfma_f32_16x16x32_bf16 a[224:227], v[60:63], v[0:3], a[224:227]
    v_mfma_f32_16x16x32_bf16 a[228:231], v[60:63], v[4:7], a[228:231]
    s_add_u32 s15, s15, s17
    v_mfma_f32_16x16x32_bf16 a[232:235], v[60:63], v[8:11], a[232:235]
    v_mfma_f32_16x16x32_bf16 a[236:239], v[60:63], v[12:15], a[236:239]
    v_mfma_f32_16x16x32_bf16 a[240:243], v[60:63], v[16:19], a[240:243]
    v_mfma_f32_16x16x32_bf16 a[244:247], v[60:63], v[20:23], a[244:247]
    v_mfma_f32_16x16x32_bf16 a[248:251], v[60:63], v[24:27], a[248:251]
    v_mfma_f32_16x16x32_bf16 a[252:255], v[60:63], v[28:31], a[252:255]
    s_waitcnt lgkmcnt(0)
    v_mfma_f32_16x16x32_bf16 a[0:3], v[96:99], v[64:67], a[0:3]
    s_waitcnt vmcnt(16)
    s_barrier
    ds_read_b128 v[32:35], v136 offset:32768
    s_add_u32 m0, s20, 16384
    s_nop 0
    v_mfma_f32_16x16x32_bf16 a[4:7], v[96:99], v[68:71], a[4:7]
    ds_read_b64_tr_b16 v[0:1], v128 offset:32768
    v_mfma_f32_16x16x32_bf16 a[8:11], v[96:99], v[72:75], a[8:11]
    ds_read_b64_tr_b16 v[2:3], v128 offset:40960
    v_mfma_f32_16x16x32_bf16 a[12:15], v[96:99], v[76:79], a[12:15]
    ds_read_b64_tr_b16 v[4:5], v129 offset:32768
    v_mfma_f32_16x16x32_bf16 a[16:19], v[96:99], v[80:83], a[16:19]
    ds_read_b64_tr_b16 v[6:7], v129 offset:40960
    v_mfma_f32_16x16x32_bf16 a[20:23], v[96:99], v[84:87], a[20:23]
    ds_read_b64_tr_b16 v[8:9], v130 offset:32768
    buffer_load_dwordx4 v141, s[4:7], s16 offen offset:0 sc1 lds
    v_mfma_f32_16x16x32_bf16 a[24:27], v[96:99], v[88:91], a[24:27]
    ds_read_b64_tr_b16 v[10:11], v130 offset:40960
    v_mfma_f32_16x16x32_bf16 a[28:31], v[96:99], v[92:95], a[28:31]
    ds_read_b64_tr_b16 v[12:13], v131 offset:32768
    v_mfma_f32_16x16x32_bf16 a[32:35], v[100:103], v[64:67], a[32:35]
    ds_read_b64_tr_b16 v[14:15], v131 offset:40960
    v_mfma_f32_16x16x32_bf16 a[36:39], v[100:103], v[68:71], a[36:39]
    ds_read_b64_tr_b16 v[16:17], v132 offset:32768
    v_mfma_f32_16x16x32_bf16 a[40:43], v[100:103], v[72:75], a[40:43]
    ds_read_b64_tr_b16 v[18:19], v132 offset:40960
    buffer_load_dwordx4 v142, s[4:7], s16 offen offset:1024 sc1 lds
    v_mfma_f32_16x16x32_bf16 a[44:47], v[100:103], v[76:79], a[44:47]
    ds_read_b64_tr_b16 v[20:21], v133 offset:32768
    v_mfma_f32_16x16x32_bf16 a[48:51], v[100:103], v[80:83], a[48:51]
    ds_read_b64_tr_b16 v[22:23], v133 offset:40960
    v_mfma_f32_16x16x32_bf16 a[52:55], v[100:103], v[84:87], a[52:55]
    ds_read_b64_tr_b16 v[24:25], v134 offset:32768
    v_mfma_f32_16x16x32_bf16 a[56:59], v[100:103], v[88:91], a[56:59]
    ds_read_b64_tr_b16 v[26:27], v134 offset:40960
    v_mfma_f32_16x16x32_bf16 a[60:63], v[100:103], v[92:95], a[60:63]
    ds_read_b64_tr_b16 v[28:29], v135 offset:32768
    buffer_load_dwordx4 v143, s[4:7], s16 offen offset:2048 sc1 lds
    v_mfma_f32_16x16x32_bf16 a[64:67], v[104:107], v[64:67], a[64:67]
    ds_read_b64_tr_b16 v[30:31], v135 offset:40960
    v_mfma_f32_16x16x32_bf16 a[68:71], v[104:107], v[68:71], a[68:71]
    ds_read_b128 v[36:39], v136 offset:33792
    v_mfma_f32_16x16x32_bf16 a[72:75], v[104:107], v[72:75], a[72:75]
    ds_read_b128 v[40:43], v136 offset:34816
    v_mfma_f32_16x16x32_bf16 a[76:79], v[104:107], v[76:79], a[76:79]
    ds_read_b128 v[44:47], v136 offset:35840
    v_mfma_f32_16x16x32_bf16 a[80:83], v[104:107], v[80:83], a[80:83]
    ds_read_b128 v[48:51], v136 offset:36864
    v_mfma_f32_16x16x32_bf16 a[84:87], v[104:107], v[84:87], a[84:87]
    ds_read_b128 v[52:55], v136 offset:37888
    buffer_load_dwordx4 v144, s[4:7], s16 offen offset:3072 sc1 lds
    v_mfma_f32_16x16x32_bf16 a[88:91], v[104:107], v[88:91], a[88:91]
    ds_read_b128 v[56:59], v136 offset:38912
    v_mfma_f32_16x16x32_bf16 a[92:95], v[104:107], v[92:95], a[92:95]
    ds_read_b128 v[60:63], v136 offset:39936
    v_mfma_f32_16x16x32_bf16 a[96:99], v[108:111], v[64:67], a[96:99]
    v_mfma_f32_16x16x32_bf16 a[100:103], v[108:111], v[68:71], a[100:103]
    v_mfma_f32_16x16x32_bf16 a[104:107], v[108:111], v[72:75], a[104:107]
    s_add_u32 s16, s16, 1024
    v_mfma_f32_16x16x32_bf16 a[108:111], v[108:111], v[76:79], a[108:111]
    v_mfma_f32_16x16x32_bf16 a[112:115], v[108:111], v[80:83], a[112:115]
    v_mfma_f32_16x16x32_bf16 a[116:119], v[108:111], v[84:87], a[116:119]
    v_mfma_f32_16x16x32_bf16 a[120:123], v[108:111], v[88:91], a[120:123]
    v_mfma_f32_16x16x32_bf16 a[124:127], v[108:111], v[92:95], a[124:127]
    s_add_u32 m0, s19, 16384
    s_nop 0
    v_mfma_f32_16x16x32_bf16 a[128:131], v[112:115], v[64:67], a[128:131]
    v_mfma_f32_16x16x32_bf16 a[132:135], v[112:115], v[68:71], a[132:135]
    v_mfma_f32_16x16x32_bf16 a[136:139], v[112:115], v[72:75], a[136:139]
    v_mfma_f32_16x16x32_bf16 a[140:143], v[112:115], v[76:79], a[140:143]
    v_mfma_f32_16x16x32_bf16 a[144:147], v[112:115], v[80:83], a[144:147]
    buffer_load_dwordx4 v137, s[8:11], s15 offen offset:0 lds
    v_mfma_f32_16x16x32_bf16 a[148:151], v[112:115], v[84:87], a[148:151]
    v_mfma_f32_16x16x32_bf16 a[152:155], v[112:115], v[88:91], a[152:155]
    v_mfma_f32_16x16x32_bf16 a[156:159], v[112:115], v[92:95], a[156:159]
    v_mfma_f32_16x16x32_bf16 a[160:163], v[116:119], v[64:67], a[160:163]
    v_mfma_f32_16x16x32_bf16 a[164:167], v[116:119], v[68:71], a[164:167]
    v_mfma_f32_16x16x32_bf16 a[168:171], v[116:119], v[72:75], a[168:171]
    buffer_load_dwordx4 v138, s[8:11], s15 offen offset:1024 lds
    v_mfma_f32_16x16x32_bf16 a[172:175], v[116:119], v[76:79], a[172:175]
    v_mfma_f32_16x16x32_bf16 a[176:179], v[116:119], v[80:83], a[176:179]
    v_mfma_f32_16x16x32_bf16 a[180:183], v[116:119], v[84:87], a[180:183]
    v_mfma_f32_16x16x32_bf16 a[184:187], v[116:119], v[88:91], a[184:187]
    v_mfma_f32_16x16x32_bf16 a[188:191], v[116:119], v[92:95], a[188:191]
    buffer_load_dwordx4 v139, s[8:11], s15 offen offset:2048 lds
    v_mfma_f32_16x16x32_bf16 a[192:195], v[120:123], v[64:67], a[192:195]
    v_mfma_f32_16x16x32_bf16 a[196:199], v[120:123], v[68:71], a[196:199]
    v_mfma_f32_16x16x32_bf16 a[200:203], v[120:123], v[72:75], a[200:203]
    v_mfma_f32_16x16x32_bf16 a[204:207], v[120:123], v[76:79], a[204:207]
    v_mfma_f32_16x16x32_bf16 a[208:211], v[120:123], v[80:83], a[208:211]
    buffer_load_dwordx4 v140, s[8:11], s15 offen offset:3072 lds
    v_mfma_f32_16x16x32_bf16 a[212:215], v[120:123], v[84:87], a[212:215]
    v_mfma_f32_16x16x32_bf16 a[216:219], v[120:123], v[88:91], a[216:219]
    v_mfma_f32_16x16x32_bf16 a[220:223], v[120:123], v[92:95], a[220:223]
    v_mfma_f32_16x16x32_bf16 a[224:227], v[124:127], v[64:67], a[224:227]
    v_mfma_f32_16x16x32_bf16 a[228:231], v[124:127], v[68:71], a[228:231]
    s_add_u32 s15, s15, s17
    v_mfma_f32_16x16x32_bf16 a[232:235], v[124:127], v[72:75], a[232:235]
    v_mfma_f32_16x16x32_bf16 a[236:239], v[124:127], v[76:79], a[236:239]
    v_mfma_f32_16x16x32_bf16 a[240:243], v[124:127], v[80:83], a[240:243]
    v_mfma_f32_16x16x32_bf16 a[244:247], v[124:127], v[84:87], a[244:247]
    v_mfma_f32_16x16x32_bf16 a[248:251], v[124:127], v[88:91], a[248:251]
    v_mfma_f32_16x16x32_bf16 a[252:255], v[124:127], v[92:95], a[252:255]
    s_waitcnt lgkmcnt(0)
    v_mfma_f32_16x16x32_bf16 a[0:3], v[32:35], v[0:3], a[0:3]
    s_waitcnt vmcnt(16)
    s_barrier
    ds_read_b128 v[96:99], v136 offset:49152
    s_add_u32 m0, s20, 32768
    s_nop 0
    v_mfma_f32_16x16x32_bf16 a[4:7], v[32:35], v[4:7], a[4:7]
    ds_read_b64_tr_b16 v[64:65], v128 offset:49152
    v_mfma_f32_16x16x32_bf16 a[8:11], v[32:35], v[8:11], a[8:11]
    ds_read_b64_tr_b16 v[66:67], v128 offset:57344
    v_mfma_f32_16x16x32_bf16 a[12:15], v[32:35], v[12:15], a[12:15]
    ds_read_b64_tr_b16 v[68:69], v129 offset:49152
    v_mfma_f32_16x16x32_bf16 a[16:19], v[32:35], v[16:19], a[16:19]
    ds_read_b64_tr_b16 v[70:71], v129 offset:57344
    v_mfma_f32_16x16x32_bf16 a[20:23], v[32:35], v[20:23], a[20:23]
    ds_read_b64_tr_b16 v[72:73], v130 offset:49152
    buffer_load_dwordx4 v141, s[4:7], s16 offen offset:0 sc1 lds
    v_mfma_f32_16x16x32_bf16 a[24:27], v[32:35], v[24:27], a[24:27]
    ds_read_b64_tr_b16 v[74:75], v130 offset:57344
    v_mfma_f32_16x16x32_bf16 a[28:31], v[32:35], v[28:31], a[28:31]
    ds_read_b64_tr_b16 v[76:77], v131 offset:49152
    v_mfma_f32_16x16x32_bf16 a[32:35], v[36:39], v[0:3], a[32:35]
    ds_read_b64_tr_b16 v[78:79], v131 offset:57344
    v_mfma_f32_16x16x32_bf16 a[36:39], v[36:39], v[4:7], a[36:39]
    ds_read_b64_tr_b16 v[80:81], v132 offset:49152
    v_mfma_f32_16x16x32_bf16 a[40:43], v[36:39], v[8:11], a[40:43]
    ds_read_b64_tr_b16 v[82:83], v132 offset:57344
    buffer_load_dwordx4 v142, s[4:7], s16 offen offset:1024 sc1 lds
    v_mfma_f32_16x16x32_bf16 a[44:47], v[36:39], v[12:15], a[44:47]
    ds_read_b64_tr_b16 v[84:85], v133 offset:49152
    v_mfma_f32_16x16x32_bf16 a[48:51], v[36:39], v[16:19], a[48:51]
    ds_read_b64_tr_b16 v[86:87], v133 offset:57344
    v_mfma_f32_16x16x32_bf16 a[52:55], v[36:39], v[20:23], a[52:55]
    ds_read_b64_tr_b16 v[88:89], v134 offset:49152
    v_mfma_f32_16x16x32_bf16 a[56:59], v[36:39], v[24:27], a[56:59]
    ds_read_b64_tr_b16 v[90:91], v134 offset:57344
    v_mfma_f32_16x16x32_bf16 a[60:63], v[36:39], v[28:31], a[60:63]
    ds_read_b64_tr_b16 v[92:93], v135 offset:49152
    buffer_load_dwordx4 v143, s[4:7], s16 offen offset:2048 sc1 lds
    v_mfma_f32_16x16x32_bf16 a[64:67], v[40:43], v[0:3], a[64:67]
    ds_read_b64_tr_b16 v[94:95], v135 offset:57344
    v_mfma_f32_16x16x32_bf16 a[68:71], v[40:43], v[4:7], a[68:71]
    ds_read_b128 v[100:103], v136 offset:50176
    v_mfma_f32_16x16x32_bf16 a[72:75], v[40:43], v[8:11], a[72:75]
    ds_read_b128 v[104:107], v136 offset:51200
    v_mfma_f32_16x16x32_bf16 a[76:79], v[40:43], v[12:15], a[76:79]
    ds_read_b128 v[108:111], v136 offset:52224
    v_mfma_f32_16x16x32_bf16 a[80:83], v[40:43], v[16:19], a[80:83]
    ds_read_b128 v[112:115], v136 offset:53248
    v_mfma_f32_16x16x32_bf16 a[84:87], v[40:43], v[20:23], a[84:87]
    ds_read_b128 v[116:119], v136 offset:54272
    buffer_load_dwordx4 v144, s[4:7], s16 offen offset:3072 sc1 lds
    v_mfma_f32_16x16x32_bf16 a[88:91], v[40:43], v[24:27], a[88:91]
    ds_read_b128 v[120:123], v136 offset:55296
    v_mfma_f32_16x16x32_bf16 a[92:95], v[40:43], v[28:31], a[92:95]
    ds_read_b128 v[124:127], v136 offset:56320
    v_mfma_f32_16x16x32_bf16 a[96:99], v[44:47], v[0:3], a[96:99]
    v_mfma_f32_16x16x32_bf16 a[100:103], v[44:47], v[4:7], a[100:103]
    v_mfma_f32_16x16x32_bf16 a[104:107], v[44:47], v[8:11], a[104:107]
    s_add_u32 s16, s16, 1024
    v_mfma_f32_16x16x32_bf16 a[108:111], v[44:47], v[12:15], a[108:111]
    v_mfma_f32_16x16x32_bf16 a[112:115], v[44:47], v[16:19], a[112:115]
    v_mfma_f32_16x16x32_bf16 a[116:119], v[44:47], v[20:23], a[116:119]
    v_mfma_f32_16x16x32_bf16 a[120:123], v[44:47], v[24:27], a[120:123]
    v_mfma_f32_16x16x32_bf16 a[124:127], v[44:47], v[28:31], a[124:127]
    s_add_u32 m0, s19, 32768
    s_nop 0
    v_mfma_f32_16x16x32_bf16 a[128:131], v[48:51], v[0:3], a[128:131]
    v_mfma_f32_16x16x32_bf16 a[132:135], v[48:51], v[4:7], a[132:135]
    v_mfma_f32_16x16x32_bf16 a[136:139], v[48:51], v[8:11], a[136:139]
    v_mfma_f32_16x16x32_bf16 a[140:143], v[48:51], v[12:15], a[140:143]
    v_mfma_f32_16x16x32_bf16 a[144:147], v[48:51], v[16:19], a[144:147]
    buffer_load_dwordx4 v137, s[8:11], s15 offen offset:0 lds
    v_mfma_f32_16x16x32_bf16 a[148:151], v[48:51], v[20:23], a[148:151]
    v_mfma_f32_16x16x32_bf16 a[152:155], v[48:51], v[24:27], a[152:155]
    v_mfma_f32_16x16x32_bf16 a[156:159], v[48:51], v[28:31], a[156:159]
    v_mfma_f32_16x16x32_bf16 a[160:163], v[52:55], v[0:3], a[160:163]
    v_mfma_f32_16x16x32_bf16 a[164:167], v[52:55], v[4:7], a[164:167]
    v_mfma_f32_16x16x32_bf16 a[168:171], v[52:55], v[8:11], a[168:171]
    buffer_load_dwordx4 v138, s[8:11], s15 offen offset:1024 lds
    v_mfma_f32_16x16x32_bf16 a[172:175], v[52:55], v[12:15], a[172:175]
    v_mfma_f32_16x16x32_bf16 a[176:179], v[52:55], v[16:19], a[176:179]
    v_mfma_f32_16x16x32_bf16 a[180:183], v[52:55], v[20:23], a[180:183]
    v_mfma_f32_16x16x32_bf16 a[184:187], v[52:55], v[24:27], a[184:187]
    v_mfma_f32_16x16x32_bf16 a[188:191], v[52:55], v[28:31], a[188:191]
    buffer_load_dwordx4 v139, s[8:11], s15 offen offset:2048 lds
    v_mfma_f32_16x16x32_bf16 a[192:195], v[56:59], v[0:3], a[192:195]
    v_mfma_f32_16x16x32_bf16 a[196:199], v[56:59], v[4:7], a[196:199]
    v_mfma_f32_16x16x32_bf16 a[200:203], v[56:59], v[8:11], a[200:203]
    v_mfma_f32_16x16x32_bf16 a[204:207], v[56:59], v[12:15], a[204:207]
    v_mfma_f32_16x16x32_bf16 a[208:211], v[56:59], v[16:19], a[208:211]
    buffer_load_dwordx4 v140, s[8:11], s15 offen offset:3072 lds
    v_mfma_f32_16x16x32_bf16 a[212:215], v[56:59], v[20:23], a[212:215]
    v_mfma_f32_16x16x32_bf16 a[216:219], v[56:59], v[24:27], a[216:219]
    v_mfma_f32_16x16x32_bf16 a[220:223], v[56:59], v[28:31], a[220:223]
    v_mfma_f32_16x16x32_bf16 a[224:227], v[60:63], v[0:3], a[224:227]
    v_mfma_f32_16x16x32_bf16 a[228:231], v[60:63], v[4:7], a[228:231]
    s_add_u32 s15, s15, s17
    v_mfma_f32_16x16x32_bf16 a[232:235], v[60:63], v[8:11], a[232:235]
    v_mfma_f32_16x16x32_bf16 a[236:239], v[60:63], v[12:15], a[236:239]
    v_mfma_f32_16x16x32_bf16 a[240:243], v[60:63], v[16:19], a[240:243]
    v_mfma_f32_16x16x32_bf16 a[244:247], v[60:63], v[20:23], a[244:247]
    v_mfma_f32_16x16x32_bf16 a[248:251], v[60:63], v[24:27], a[248:251]
    v_mfma_f32_16x16x32_bf16 a[252:255], v[60:63], v[28:31], a[252:255]
    s_waitcnt lgkmcnt(0)
    v_mfma_f32_16x16x32_bf16 a[0:3], v[96:99], v[64:67], a[0:3]
    s_waitcnt vmcnt(16)
    s_barrier
    ds_read_b128 v[32:35], v136 offset:0
    s_add_u32 m0, s20, 49152
    s_nop 0
    v_mfma_f32_16x16x32_bf16 a[4:7], v[96:99], v[68:71], a[4:7]
    ds_read_b64_tr_b16 v[0:1], v128 offset:0
    v_mfma_f32_16x16x32_bf16 a[8:11], v[96:99], v[72:75], a[8:11]
    ds_read_b64_tr_b16 v[2:3], v128 offset:8192
    v_mfma_f32_16x16x32_bf16 a[12:15], v[96:99], v[76:79], a[12:15]
    ds_read_b64_tr_b16 v[4:5], v129 offset:0
    v_mfma_f32_16x16x32_bf16 a[16:19], v[96:99], v[80:83], a[16:19]
    ds_read_b64_tr_b16 v[6:7], v129 offset:8192
    v_mfma_f32_16x16x32_bf16 a[20:23], v[96:99], v[84:87], a[20:23]
    ds_read_b64_tr_b16 v[8:9], v130 offset:0
    buffer_load_dwordx4 v141, s[4:7], s16 offen offset:0 sc1 lds
    v_mfma_f32_16x16x32_bf16 a[24:27], v[96:99], v[88:91], a[24:27]
    ds_read_b64_tr_b16 v[10:11], v130 offset:8192
    v_mfma_f32_16x16x32_bf16 a[28:31], v[96:99], v[92:95], a[28:31]
    ds_read_b64_tr_b16 v[12:13], v131 offset:0
    v_mfma_f32_16x16x32_bf16 a[32:35], v[100:103], v[64:67], a[32:35]
    ds_read_b64_tr_b16 v[14:15], v131 offset:8192
    v_mfma_f32_16x16x32_bf16 a[36:39], v[100:103], v[68:71], a[36:39]
    ds_read_b64_tr_b16 v[16:17], v132 offset:0
    v_mfma_f32_16x16x32_bf16 a[40:43], v[100:103], v[72:75], a[40:43]
    ds_read_b64_tr_b16 v[18:19], v132 offset:8192
    buffer_load_dwordx4 v142, s[4:7], s16 offen offset:1024 sc1 lds
    v_mfma_f32_16x16x32_bf16 a[44:47], v[100:103], v[76:79], a[44:47]
    ds_read_b64_tr_b16 v[20:21], v133 offset:0
    v_mfma_f32_16x16x32_bf16 a[48:51], v[100:103], v[80:83], a[48:51]
    ds_read_b64_tr_b16 v[22:23], v133 offset:8192
    v_mfma_f32_16x16x32_bf16 a[52:55], v[100:103], v[84:87], a[52:55]
    ds_read_b64_tr_b16 v[24:25], v134 offset:0
    v_mfma_f32_16x16x32_bf16 a[56:59], v[100:103], v[88:91], a[56:59]
    ds_read_b64_tr_b16 v[26:27], v134 offset:8192
    v_mfma_f32_16x16x32_bf16 a[60:63], v[100:103], v[92:95], a[60:63]
    ds_read_b64_tr_b16 v[28:29], v135 offset:0
    buffer_load_dwordx4 v143, s[4:7], s16 offen offset:2048 sc1 lds
    v_mfma_f32_16x16x32_bf16 a[64:67], v[104:107], v[64:67], a[64:67]
    ds_read_b64_tr_b16 v[30:31], v135 offset:8192
    v_mfma_f32_16x16x32_bf16 a[68:71], v[104:107], v[68:71], a[68:71]
    ds_read_b128 v[36:39], v136 offset:1024
    v_mfma_f32_16x16x32_bf16 a[72:75], v[104:107], v[72:75], a[72:75]
    ds_read_b128 v[40:43], v136 offset:2048
    v_mfma_f32_16x16x32_bf16 a[76:79], v[104:107], v[76:79], a[76:79]
    ds_read_b128 v[44:47], v136 offset:3072
    v_mfma_f32_16x16x32_bf16 a[80:83], v[104:107], v[80:83], a[80:83]
    ds_read_b128 v[48:51], v136 offset:4096
    v_mfma_f32_16x16x32_bf16 a[84:87], v[104:107], v[84:87], a[84:87]
    ds_read_b128 v[52:55], v136 offset:5120
    buffer_load_dwordx4 v144, s[4:7], s16 offen offset:3072 sc1 lds
    v_mfma_f32_16x16x32_bf16 a[88:91], v[104:107], v[88:91], a[88:91]
    ds_read_b128 v[56:59], v136 offset:6144
    v_mfma_f32_16x16x32_bf16 a[92:95], v[104:107], v[92:95], a[92:95]
    ds_read_b128 v[60:63], v136 offset:7168
    v_mfma_f32_16x16x32_bf16 a[96:99], v[108:111], v[64:67], a[96:99]
    v_mfma_f32_16x16x32_bf16 a[100:103], v[108:111], v[68:71], a[100:103]
    v_mfma_f32_16x16x32_bf16 a[104:107], v[108:111], v[72:75], a[104:107]
    s_add_u32 s16, s16, 1024
    v_mfma_f32_16x16x32_bf16 a[108:111], v[108:111], v[76:79], a[108:111]
    v_mfma_f32_16x16x32_bf16 a[112:115], v[108:111], v[80:83], a[112:115]
    v_mfma_f32_16x16x32_bf16 a[116:119], v[108:111], v[84:87], a[116:119]
    v_mfma_f32_16x16x32_bf16 a[120:123], v[108:111], v[88:91], a[120:123]
    v_mfma_f32_16x16x32_bf16 a[124:127], v[108:111], v[92:95], a[124:127]
    s_add_u32 m0, s19, 49152
    s_nop 0
    v_mfma_f32_16x16x32_bf16 a[128:131], v[112:115], v[64:67], a[128:131]
    v_mfma_f32_16x16x32_bf16 a[132:135], v[112:115], v[68:71], a[132:135]
    v_mfma_f32_16x16x32_bf16 a[136:139], v[112:115], v[72:75], a[136:139]
    v_mfma_f32_16x16x32_bf16 a[140:143], v[112:115], v[76:79], a[140:143]
    v_mfma_f32_16x16x32_bf16 a[144:147], v[112:115], v[80:83], a[144:147]
    buffer_load_dwordx4 v137, s[8:11], s15 offen offset:0 lds
    v_mfma_f32_16x16x32_bf16 a[148:151], v[112:115], v[84:87], a[148:151]
    v_mfma_f32_16x16x32_bf16 a[152:155], v[112:115], v[88:91], a[152:155]
    v_mfma_f32_16x16x32_bf16 a[156:159], v[112:115], v[92:95], a[156:159]
    v_mfma_f32_16x16x32_bf16 a[160:163], v[116:119], v[64:67], a[160:163]
    v_mfma_f32_16x16x32_bf16 a[164:167], v[116:119], v[68:71], a[164:167]
    v_mfma_f32_16x16x32_bf16 a[168:171], v[116:119], v[72:75], a[168:171]
    buffer_load_dwordx4 v138, s[8:11], s15 offen offset:1024 lds
    v_mfma_f32_16x16x32_bf16 a[172:175], v[116:119], v[76:79], a[172:175]
    v_mfma_f32_16x16x32_bf16 a[176:179], v[116:119], v[80:83], a[176:179]
    v_mfma_f32_16x16x32_bf16 a[180:183], v[116:119], v[84:87], a[180:183]
    v_mfma_f32_16x16x32_bf16 a[184:187], v[116:119], v[88:91], a[184:187]
    v_mfma_f32_16x16x32_bf16 a[188:191], v[116:119], v[92:95], a[188:191]
    buffer_load_dwordx4 v139, s[8:11], s15 offen offset:2048 lds
    v_mfma_f32_16x16x32_bf16 a[192:195], v[120:123], v[64:67], a[192:195]
    v_mfma_f32_16x16x32_bf16 a[196:199], v[120:123], v[68:71], a[196:199]
    v_mfma_f32_16x16x32_bf16 a[200:203], v[120:123], v[72:75], a[200:203]
    v_mfma_f32_16x16x32_bf16 a[204:207], v[120:123], v[76:79], a[204:207]
    v_mfma_f32_16x16x32_bf16 a[208:211], v[120:123], v[80:83], a[208:211]
    buffer_load_dwordx4 v140, s[8:11], s15 offen offset:3072 lds
    v_mfma_f32_16x16x32_bf16 a[212:215], v[120:123], v[84:87], a[212:215]
    v_mfma_f32_16x16x32_bf16 a[216:219], v[120:123], v[88:91], a[216:219]
    v_mfma_f32_16x16x32_bf16 a[220:223], v[120:123], v[92:95], a[220:223]
    v_mfma_f32_16x16x32_bf16 a[224:227], v[124:127], v[64:67], a[224:227]
    v_mfma_f32_16x16x32_bf16 a[228:231], v[124:127], v[68:71], a[228:231]
    s_add_u32 s15, s15, s17
    v_mfma_f32_16x16x32_bf16 a[232:235], v[124:127], v[72:75], a[232:235]
    v_mfma_f32_16x16x32_bf16 a[236:239], v[124:127], v[76:79], a[236:239]
    v_mfma_f32_16x16x32_bf16 a[240:243], v[124:127], v[80:83], a[240:243]
    v_mfma_f32_16x16x32_bf16 a[244:247], v[124:127], v[84:87], a[244:247]
    v_mfma_f32_16x16x32_bf16 a[248:251], v[124:127], v[88:91], a[248:251]
    v_mfma_f32_16x16x32_bf16 a[252:255], v[124:127], v[92:95], a[252:255]
    s_sub_u32 s18, s18, 1
    s_cmp_lg_u32 s18, 0
    s_cbranch_scc1 main_kernel_w_c2_v_loop
    s_cmp_lg_u32 s14, 0
    s_cbranch_scc1 main_kernel_w_c2_v_nt
    s_lshl_b32 s32, s27, 8
    s_add_u32 s32, s32, 0x841e000
    v_mov_b32 v255, 1
    s_mov_b64 exec, 1
    buffer_atomic_add v255, off, s[4:7], s32 sc0 sc1
    s_mov_b64 exec, -1
main_kernel_w_c2_v_nt:
    s_waitcnt lgkmcnt(0)
    v_mfma_f32_16x16x32_bf16 a[0:3], v[32:35], v[0:3], a[0:3]
    s_waitcnt vmcnt(16)
    s_barrier
    ds_read_b128 v[96:99], v136 offset:16384
    v_mfma_f32_16x16x32_bf16 a[4:7], v[32:35], v[4:7], a[4:7]
    ds_read_b64_tr_b16 v[64:65], v128 offset:16384
    v_mfma_f32_16x16x32_bf16 a[8:11], v[32:35], v[8:11], a[8:11]
    ds_read_b64_tr_b16 v[66:67], v128 offset:24576
    v_mfma_f32_16x16x32_bf16 a[12:15], v[32:35], v[12:15], a[12:15]
    ds_read_b64_tr_b16 v[68:69], v129 offset:16384
    v_mfma_f32_16x16x32_bf16 a[16:19], v[32:35], v[16:19], a[16:19]
    ds_read_b64_tr_b16 v[70:71], v129 offset:24576
    v_mfma_f32_16x16x32_bf16 a[20:23], v[32:35], v[20:23], a[20:23]
    ds_read_b64_tr_b16 v[72:73], v130 offset:16384
    v_mfma_f32_16x16x32_bf16 a[24:27], v[32:35], v[24:27], a[24:27]
    ds_read_b64_tr_b16 v[74:75], v130 offset:24576
    v_mfma_f32_16x16x32_bf16 a[28:31], v[32:35], v[28:31], a[28:31]
    ds_read_b64_tr_b16 v[76:77], v131 offset:16384
    v_mfma_f32_16x16x32_bf16 a[32:35], v[36:39], v[0:3], a[32:35]
    ds_read_b64_tr_b16 v[78:79], v131 offset:24576
    v_mfma_f32_16x16x32_bf16 a[36:39], v[36:39], v[4:7], a[36:39]
    ds_read_b64_tr_b16 v[80:81], v132 offset:16384
    v_mfma_f32_16x16x32_bf16 a[40:43], v[36:39], v[8:11], a[40:43]
    ds_read_b64_tr_b16 v[82:83], v132 offset:24576
    v_mfma_f32_16x16x32_bf16 a[44:47], v[36:39], v[12:15], a[44:47]
    ds_read_b64_tr_b16 v[84:85], v133 offset:16384
    v_mfma_f32_16x16x32_bf16 a[48:51], v[36:39], v[16:19], a[48:51]
    ds_read_b64_tr_b16 v[86:87], v133 offset:24576
    v_mfma_f32_16x16x32_bf16 a[52:55], v[36:39], v[20:23], a[52:55]
    ds_read_b64_tr_b16 v[88:89], v134 offset:16384
    v_mfma_f32_16x16x32_bf16 a[56:59], v[36:39], v[24:27], a[56:59]
    ds_read_b64_tr_b16 v[90:91], v134 offset:24576
    v_mfma_f32_16x16x32_bf16 a[60:63], v[36:39], v[28:31], a[60:63]
    ds_read_b64_tr_b16 v[92:93], v135 offset:16384
    v_mfma_f32_16x16x32_bf16 a[64:67], v[40:43], v[0:3], a[64:67]
    ds_read_b64_tr_b16 v[94:95], v135 offset:24576
    v_mfma_f32_16x16x32_bf16 a[68:71], v[40:43], v[4:7], a[68:71]
    ds_read_b128 v[100:103], v136 offset:17408
    v_mfma_f32_16x16x32_bf16 a[72:75], v[40:43], v[8:11], a[72:75]
    ds_read_b128 v[104:107], v136 offset:18432
    v_mfma_f32_16x16x32_bf16 a[76:79], v[40:43], v[12:15], a[76:79]
    ds_read_b128 v[108:111], v136 offset:19456
    v_mfma_f32_16x16x32_bf16 a[80:83], v[40:43], v[16:19], a[80:83]
    ds_read_b128 v[112:115], v136 offset:20480
    v_mfma_f32_16x16x32_bf16 a[84:87], v[40:43], v[20:23], a[84:87]
    ds_read_b128 v[116:119], v136 offset:21504
    v_mfma_f32_16x16x32_bf16 a[88:91], v[40:43], v[24:27], a[88:91]
    ds_read_b128 v[120:123], v136 offset:22528
    v_mfma_f32_16x16x32_bf16 a[92:95], v[40:43], v[28:31], a[92:95]
    ds_read_b128 v[124:127], v136 offset:23552
    v_mfma_f32_16x16x32_bf16 a[96:99], v[44:47], v[0:3], a[96:99]
    v_mfma_f32_16x16x32_bf16 a[100:103], v[44:47], v[4:7], a[100:103]
    v_mfma_f32_16x16x32_bf16 a[104:107], v[44:47], v[8:11], a[104:107]
    v_mfma_f32_16x16x32_bf16 a[108:111], v[44:47], v[12:15], a[108:111]
    v_mfma_f32_16x16x32_bf16 a[112:115], v[44:47], v[16:19], a[112:115]
    v_mfma_f32_16x16x32_bf16 a[116:119], v[44:47], v[20:23], a[116:119]
    v_mfma_f32_16x16x32_bf16 a[120:123], v[44:47], v[24:27], a[120:123]
    v_mfma_f32_16x16x32_bf16 a[124:127], v[44:47], v[28:31], a[124:127]
    v_mfma_f32_16x16x32_bf16 a[128:131], v[48:51], v[0:3], a[128:131]
    v_mfma_f32_16x16x32_bf16 a[132:135], v[48:51], v[4:7], a[132:135]
    v_mfma_f32_16x16x32_bf16 a[136:139], v[48:51], v[8:11], a[136:139]
    v_mfma_f32_16x16x32_bf16 a[140:143], v[48:51], v[12:15], a[140:143]
    v_mfma_f32_16x16x32_bf16 a[144:147], v[48:51], v[16:19], a[144:147]
    v_mfma_f32_16x16x32_bf16 a[148:151], v[48:51], v[20:23], a[148:151]
    v_mfma_f32_16x16x32_bf16 a[152:155], v[48:51], v[24:27], a[152:155]
    v_mfma_f32_16x16x32_bf16 a[156:159], v[48:51], v[28:31], a[156:159]
    v_mfma_f32_16x16x32_bf16 a[160:163], v[52:55], v[0:3], a[160:163]
    v_mfma_f32_16x16x32_bf16 a[164:167], v[52:55], v[4:7], a[164:167]
    v_mfma_f32_16x16x32_bf16 a[168:171], v[52:55], v[8:11], a[168:171]
    v_mfma_f32_16x16x32_bf16 a[172:175], v[52:55], v[12:15], a[172:175]
    v_mfma_f32_16x16x32_bf16 a[176:179], v[52:55], v[16:19], a[176:179]
    v_mfma_f32_16x16x32_bf16 a[180:183], v[52:55], v[20:23], a[180:183]
    v_mfma_f32_16x16x32_bf16 a[184:187], v[52:55], v[24:27], a[184:187]
    v_mfma_f32_16x16x32_bf16 a[188:191], v[52:55], v[28:31], a[188:191]
    v_mfma_f32_16x16x32_bf16 a[192:195], v[56:59], v[0:3], a[192:195]
    v_mfma_f32_16x16x32_bf16 a[196:199], v[56:59], v[4:7], a[196:199]
    v_mfma_f32_16x16x32_bf16 a[200:203], v[56:59], v[8:11], a[200:203]
    v_mfma_f32_16x16x32_bf16 a[204:207], v[56:59], v[12:15], a[204:207]
    v_mfma_f32_16x16x32_bf16 a[208:211], v[56:59], v[16:19], a[208:211]
    v_mfma_f32_16x16x32_bf16 a[212:215], v[56:59], v[20:23], a[212:215]
    v_mfma_f32_16x16x32_bf16 a[216:219], v[56:59], v[24:27], a[216:219]
    v_mfma_f32_16x16x32_bf16 a[220:223], v[56:59], v[28:31], a[220:223]
    v_mfma_f32_16x16x32_bf16 a[224:227], v[60:63], v[0:3], a[224:227]
    v_mfma_f32_16x16x32_bf16 a[228:231], v[60:63], v[4:7], a[228:231]
    v_mfma_f32_16x16x32_bf16 a[232:235], v[60:63], v[8:11], a[232:235]
    v_mfma_f32_16x16x32_bf16 a[236:239], v[60:63], v[12:15], a[236:239]
    v_mfma_f32_16x16x32_bf16 a[240:243], v[60:63], v[16:19], a[240:243]
    v_mfma_f32_16x16x32_bf16 a[244:247], v[60:63], v[20:23], a[244:247]
    v_mfma_f32_16x16x32_bf16 a[248:251], v[60:63], v[24:27], a[248:251]
    v_mfma_f32_16x16x32_bf16 a[252:255], v[60:63], v[28:31], a[252:255]
    s_waitcnt lgkmcnt(0)
    v_mfma_f32_16x16x32_bf16 a[0:3], v[96:99], v[64:67], a[0:3]
    s_waitcnt vmcnt(8)
    s_barrier
    ds_read_b128 v[32:35], v136 offset:32768
    v_mfma_f32_16x16x32_bf16 a[4:7], v[96:99], v[68:71], a[4:7]
    ds_read_b64_tr_b16 v[0:1], v128 offset:32768
    v_mfma_f32_16x16x32_bf16 a[8:11], v[96:99], v[72:75], a[8:11]
    ds_read_b64_tr_b16 v[2:3], v128 offset:40960
    v_mfma_f32_16x16x32_bf16 a[12:15], v[96:99], v[76:79], a[12:15]
    ds_read_b64_tr_b16 v[4:5], v129 offset:32768
    v_mfma_f32_16x16x32_bf16 a[16:19], v[96:99], v[80:83], a[16:19]
    ds_read_b64_tr_b16 v[6:7], v129 offset:40960
    v_mfma_f32_16x16x32_bf16 a[20:23], v[96:99], v[84:87], a[20:23]
    ds_read_b64_tr_b16 v[8:9], v130 offset:32768
    v_mfma_f32_16x16x32_bf16 a[24:27], v[96:99], v[88:91], a[24:27]
    ds_read_b64_tr_b16 v[10:11], v130 offset:40960
    v_mfma_f32_16x16x32_bf16 a[28:31], v[96:99], v[92:95], a[28:31]
    ds_read_b64_tr_b16 v[12:13], v131 offset:32768
    v_mfma_f32_16x16x32_bf16 a[32:35], v[100:103], v[64:67], a[32:35]
    ds_read_b64_tr_b16 v[14:15], v131 offset:40960
    v_mfma_f32_16x16x32_bf16 a[36:39], v[100:103], v[68:71], a[36:39]
    ds_read_b64_tr_b16 v[16:17], v132 offset:32768
    v_mfma_f32_16x16x32_bf16 a[40:43], v[100:103], v[72:75], a[40:43]
    ds_read_b64_tr_b16 v[18:19], v132 offset:40960
    v_mfma_f32_16x16x32_bf16 a[44:47], v[100:103], v[76:79], a[44:47]
    ds_read_b64_tr_b16 v[20:21], v133 offset:32768
    v_mfma_f32_16x16x32_bf16 a[48:51], v[100:103], v[80:83], a[48:51]
    ds_read_b64_tr_b16 v[22:23], v133 offset:40960
    v_mfma_f32_16x16x32_bf16 a[52:55], v[100:103], v[84:87], a[52:55]
    ds_read_b64_tr_b16 v[24:25], v134 offset:32768
    v_mfma_f32_16x16x32_bf16 a[56:59], v[100:103], v[88:91], a[56:59]
    ds_read_b64_tr_b16 v[26:27], v134 offset:40960
    v_mfma_f32_16x16x32_bf16 a[60:63], v[100:103], v[92:95], a[60:63]
    ds_read_b64_tr_b16 v[28:29], v135 offset:32768
    v_mfma_f32_16x16x32_bf16 a[64:67], v[104:107], v[64:67], a[64:67]
    ds_read_b64_tr_b16 v[30:31], v135 offset:40960
    v_mfma_f32_16x16x32_bf16 a[68:71], v[104:107], v[68:71], a[68:71]
    ds_read_b128 v[36:39], v136 offset:33792
    v_mfma_f32_16x16x32_bf16 a[72:75], v[104:107], v[72:75], a[72:75]
    ds_read_b128 v[40:43], v136 offset:34816
    v_mfma_f32_16x16x32_bf16 a[76:79], v[104:107], v[76:79], a[76:79]
    ds_read_b128 v[44:47], v136 offset:35840
    v_mfma_f32_16x16x32_bf16 a[80:83], v[104:107], v[80:83], a[80:83]
    ds_read_b128 v[48:51], v136 offset:36864
    v_mfma_f32_16x16x32_bf16 a[84:87], v[104:107], v[84:87], a[84:87]
    ds_read_b128 v[52:55], v136 offset:37888
    v_mfma_f32_16x16x32_bf16 a[88:91], v[104:107], v[88:91], a[88:91]
    ds_read_b128 v[56:59], v136 offset:38912
    v_mfma_f32_16x16x32_bf16 a[92:95], v[104:107], v[92:95], a[92:95]
    ds_read_b128 v[60:63], v136 offset:39936
    v_mfma_f32_16x16x32_bf16 a[96:99], v[108:111], v[64:67], a[96:99]
    v_mfma_f32_16x16x32_bf16 a[100:103], v[108:111], v[68:71], a[100:103]
    v_mfma_f32_16x16x32_bf16 a[104:107], v[108:111], v[72:75], a[104:107]
    v_mfma_f32_16x16x32_bf16 a[108:111], v[108:111], v[76:79], a[108:111]
    v_mfma_f32_16x16x32_bf16 a[112:115], v[108:111], v[80:83], a[112:115]
    v_mfma_f32_16x16x32_bf16 a[116:119], v[108:111], v[84:87], a[116:119]
    v_mfma_f32_16x16x32_bf16 a[120:123], v[108:111], v[88:91], a[120:123]
    v_mfma_f32_16x16x32_bf16 a[124:127], v[108:111], v[92:95], a[124:127]
    v_mfma_f32_16x16x32_bf16 a[128:131], v[112:115], v[64:67], a[128:131]
    v_mfma_f32_16x16x32_bf16 a[132:135], v[112:115], v[68:71], a[132:135]
    v_mfma_f32_16x16x32_bf16 a[136:139], v[112:115], v[72:75], a[136:139]
    v_mfma_f32_16x16x32_bf16 a[140:143], v[112:115], v[76:79], a[140:143]
    v_mfma_f32_16x16x32_bf16 a[144:147], v[112:115], v[80:83], a[144:147]
    v_mfma_f32_16x16x32_bf16 a[148:151], v[112:115], v[84:87], a[148:151]
    v_mfma_f32_16x16x32_bf16 a[152:155], v[112:115], v[88:91], a[152:155]
    v_mfma_f32_16x16x32_bf16 a[156:159], v[112:115], v[92:95], a[156:159]
    v_mfma_f32_16x16x32_bf16 a[160:163], v[116:119], v[64:67], a[160:163]
    v_mfma_f32_16x16x32_bf16 a[164:167], v[116:119], v[68:71], a[164:167]
    v_mfma_f32_16x16x32_bf16 a[168:171], v[116:119], v[72:75], a[168:171]
    v_mfma_f32_16x16x32_bf16 a[172:175], v[116:119], v[76:79], a[172:175]
    v_mfma_f32_16x16x32_bf16 a[176:179], v[116:119], v[80:83], a[176:179]
    v_mfma_f32_16x16x32_bf16 a[180:183], v[116:119], v[84:87], a[180:183]
    v_mfma_f32_16x16x32_bf16 a[184:187], v[116:119], v[88:91], a[184:187]
    v_mfma_f32_16x16x32_bf16 a[188:191], v[116:119], v[92:95], a[188:191]
    v_mfma_f32_16x16x32_bf16 a[192:195], v[120:123], v[64:67], a[192:195]
    v_mfma_f32_16x16x32_bf16 a[196:199], v[120:123], v[68:71], a[196:199]
    v_mfma_f32_16x16x32_bf16 a[200:203], v[120:123], v[72:75], a[200:203]
    v_mfma_f32_16x16x32_bf16 a[204:207], v[120:123], v[76:79], a[204:207]
    v_mfma_f32_16x16x32_bf16 a[208:211], v[120:123], v[80:83], a[208:211]
    v_mfma_f32_16x16x32_bf16 a[212:215], v[120:123], v[84:87], a[212:215]
    v_mfma_f32_16x16x32_bf16 a[216:219], v[120:123], v[88:91], a[216:219]
    v_mfma_f32_16x16x32_bf16 a[220:223], v[120:123], v[92:95], a[220:223]
    v_mfma_f32_16x16x32_bf16 a[224:227], v[124:127], v[64:67], a[224:227]
    v_mfma_f32_16x16x32_bf16 a[228:231], v[124:127], v[68:71], a[228:231]
    v_mfma_f32_16x16x32_bf16 a[232:235], v[124:127], v[72:75], a[232:235]
    v_mfma_f32_16x16x32_bf16 a[236:239], v[124:127], v[76:79], a[236:239]
    v_mfma_f32_16x16x32_bf16 a[240:243], v[124:127], v[80:83], a[240:243]
    v_mfma_f32_16x16x32_bf16 a[244:247], v[124:127], v[84:87], a[244:247]
    v_mfma_f32_16x16x32_bf16 a[248:251], v[124:127], v[88:91], a[248:251]
    v_mfma_f32_16x16x32_bf16 a[252:255], v[124:127], v[92:95], a[252:255]
    s_waitcnt lgkmcnt(0)
    v_mfma_f32_16x16x32_bf16 a[0:3], v[32:35], v[0:3], a[0:3]
    s_waitcnt vmcnt(0)
    s_barrier
    ds_read_b128 v[96:99], v136 offset:49152
    v_mfma_f32_16x16x32_bf16 a[4:7], v[32:35], v[4:7], a[4:7]
    ds_read_b64_tr_b16 v[64:65], v128 offset:49152
    v_mfma_f32_16x16x32_bf16 a[8:11], v[32:35], v[8:11], a[8:11]
    ds_read_b64_tr_b16 v[66:67], v128 offset:57344
    v_mfma_f32_16x16x32_bf16 a[12:15], v[32:35], v[12:15], a[12:15]
    ds_read_b64_tr_b16 v[68:69], v129 offset:49152
    v_mfma_f32_16x16x32_bf16 a[16:19], v[32:35], v[16:19], a[16:19]
    ds_read_b64_tr_b16 v[70:71], v129 offset:57344
    v_mfma_f32_16x16x32_bf16 a[20:23], v[32:35], v[20:23], a[20:23]
    ds_read_b64_tr_b16 v[72:73], v130 offset:49152
    v_mfma_f32_16x16x32_bf16 a[24:27], v[32:35], v[24:27], a[24:27]
    ds_read_b64_tr_b16 v[74:75], v130 offset:57344
    v_mfma_f32_16x16x32_bf16 a[28:31], v[32:35], v[28:31], a[28:31]
    ds_read_b64_tr_b16 v[76:77], v131 offset:49152
    v_mfma_f32_16x16x32_bf16 a[32:35], v[36:39], v[0:3], a[32:35]
    ds_read_b64_tr_b16 v[78:79], v131 offset:57344
    v_mfma_f32_16x16x32_bf16 a[36:39], v[36:39], v[4:7], a[36:39]
    ds_read_b64_tr_b16 v[80:81], v132 offset:49152
    v_mfma_f32_16x16x32_bf16 a[40:43], v[36:39], v[8:11], a[40:43]
    ds_read_b64_tr_b16 v[82:83], v132 offset:57344
    v_mfma_f32_16x16x32_bf16 a[44:47], v[36:39], v[12:15], a[44:47]
    ds_read_b64_tr_b16 v[84:85], v133 offset:49152
    v_mfma_f32_16x16x32_bf16 a[48:51], v[36:39], v[16:19], a[48:51]
    ds_read_b64_tr_b16 v[86:87], v133 offset:57344
    v_mfma_f32_16x16x32_bf16 a[52:55], v[36:39], v[20:23], a[52:55]
    ds_read_b64_tr_b16 v[88:89], v134 offset:49152
    v_mfma_f32_16x16x32_bf16 a[56:59], v[36:39], v[24:27], a[56:59]
    ds_read_b64_tr_b16 v[90:91], v134 offset:57344
    v_mfma_f32_16x16x32_bf16 a[60:63], v[36:39], v[28:31], a[60:63]
    ds_read_b64_tr_b16 v[92:93], v135 offset:49152
    v_mfma_f32_16x16x32_bf16 a[64:67], v[40:43], v[0:3], a[64:67]
    ds_read_b64_tr_b16 v[94:95], v135 offset:57344
    v_mfma_f32_16x16x32_bf16 a[68:71], v[40:43], v[4:7], a[68:71]
    ds_read_b128 v[100:103], v136 offset:50176
    v_mfma_f32_16x16x32_bf16 a[72:75], v[40:43], v[8:11], a[72:75]
    ds_read_b128 v[104:107], v136 offset:51200
    v_mfma_f32_16x16x32_bf16 a[76:79], v[40:43], v[12:15], a[76:79]
    ds_read_b128 v[108:111], v136 offset:52224
    v_mfma_f32_16x16x32_bf16 a[80:83], v[40:43], v[16:19], a[80:83]
    ds_read_b128 v[112:115], v136 offset:53248
    v_mfma_f32_16x16x32_bf16 a[84:87], v[40:43], v[20:23], a[84:87]
    ds_read_b128 v[116:119], v136 offset:54272
    v_mfma_f32_16x16x32_bf16 a[88:91], v[40:43], v[24:27], a[88:91]
    ds_read_b128 v[120:123], v136 offset:55296
    v_mfma_f32_16x16x32_bf16 a[92:95], v[40:43], v[28:31], a[92:95]
    ds_read_b128 v[124:127], v136 offset:56320
    v_mfma_f32_16x16x32_bf16 a[96:99], v[44:47], v[0:3], a[96:99]
    v_mfma_f32_16x16x32_bf16 a[100:103], v[44:47], v[4:7], a[100:103]
    v_mfma_f32_16x16x32_bf16 a[104:107], v[44:47], v[8:11], a[104:107]
    v_mfma_f32_16x16x32_bf16 a[108:111], v[44:47], v[12:15], a[108:111]
    v_mfma_f32_16x16x32_bf16 a[112:115], v[44:47], v[16:19], a[112:115]
    v_mfma_f32_16x16x32_bf16 a[116:119], v[44:47], v[20:23], a[116:119]
    v_mfma_f32_16x16x32_bf16 a[120:123], v[44:47], v[24:27], a[120:123]
    v_mfma_f32_16x16x32_bf16 a[124:127], v[44:47], v[28:31], a[124:127]
    v_mfma_f32_16x16x32_bf16 a[128:131], v[48:51], v[0:3], a[128:131]
    v_mfma_f32_16x16x32_bf16 a[132:135], v[48:51], v[4:7], a[132:135]
    v_mfma_f32_16x16x32_bf16 a[136:139], v[48:51], v[8:11], a[136:139]
    v_mfma_f32_16x16x32_bf16 a[140:143], v[48:51], v[12:15], a[140:143]
    v_mfma_f32_16x16x32_bf16 a[144:147], v[48:51], v[16:19], a[144:147]
    v_mfma_f32_16x16x32_bf16 a[148:151], v[48:51], v[20:23], a[148:151]
    v_mfma_f32_16x16x32_bf16 a[152:155], v[48:51], v[24:27], a[152:155]
    v_mfma_f32_16x16x32_bf16 a[156:159], v[48:51], v[28:31], a[156:159]
    v_mfma_f32_16x16x32_bf16 a[160:163], v[52:55], v[0:3], a[160:163]
    v_mfma_f32_16x16x32_bf16 a[164:167], v[52:55], v[4:7], a[164:167]
    v_mfma_f32_16x16x32_bf16 a[168:171], v[52:55], v[8:11], a[168:171]
    v_mfma_f32_16x16x32_bf16 a[172:175], v[52:55], v[12:15], a[172:175]
    v_mfma_f32_16x16x32_bf16 a[176:179], v[52:55], v[16:19], a[176:179]
    v_mfma_f32_16x16x32_bf16 a[180:183], v[52:55], v[20:23], a[180:183]
    v_mfma_f32_16x16x32_bf16 a[184:187], v[52:55], v[24:27], a[184:187]
    v_mfma_f32_16x16x32_bf16 a[188:191], v[52:55], v[28:31], a[188:191]
    v_mfma_f32_16x16x32_bf16 a[192:195], v[56:59], v[0:3], a[192:195]
    v_mfma_f32_16x16x32_bf16 a[196:199], v[56:59], v[4:7], a[196:199]
    v_mfma_f32_16x16x32_bf16 a[200:203], v[56:59], v[8:11], a[200:203]
    v_mfma_f32_16x16x32_bf16 a[204:207], v[56:59], v[12:15], a[204:207]
    v_mfma_f32_16x16x32_bf16 a[208:211], v[56:59], v[16:19], a[208:211]
    v_mfma_f32_16x16x32_bf16 a[212:215], v[56:59], v[20:23], a[212:215]
    v_mfma_f32_16x16x32_bf16 a[216:219], v[56:59], v[24:27], a[216:219]
    v_mfma_f32_16x16x32_bf16 a[220:223], v[56:59], v[28:31], a[220:223]
    v_mfma_f32_16x16x32_bf16 a[224:227], v[60:63], v[0:3], a[224:227]
    v_mfma_f32_16x16x32_bf16 a[228:231], v[60:63], v[4:7], a[228:231]
    v_mfma_f32_16x16x32_bf16 a[232:235], v[60:63], v[8:11], a[232:235]
    v_mfma_f32_16x16x32_bf16 a[236:239], v[60:63], v[12:15], a[236:239]
    v_mfma_f32_16x16x32_bf16 a[240:243], v[60:63], v[16:19], a[240:243]
    v_mfma_f32_16x16x32_bf16 a[244:247], v[60:63], v[20:23], a[244:247]
    v_mfma_f32_16x16x32_bf16 a[248:251], v[60:63], v[24:27], a[248:251]
    v_mfma_f32_16x16x32_bf16 a[252:255], v[60:63], v[28:31], a[252:255]
    v_readfirstlane_b32 s55, v255
    s_waitcnt lgkmcnt(0)
    v_mfma_f32_16x16x32_bf16 a[0:3], v[96:99], v[64:67], a[0:3]
    v_mfma_f32_16x16x32_bf16 a[4:7], v[96:99], v[68:71], a[4:7]
    v_mfma_f32_16x16x32_bf16 a[8:11], v[96:99], v[72:75], a[8:11]
    v_mfma_f32_16x16x32_bf16 a[12:15], v[96:99], v[76:79], a[12:15]
    v_mfma_f32_16x16x32_bf16 a[16:19], v[96:99], v[80:83], a[16:19]
    v_mfma_f32_16x16x32_bf16 a[20:23], v[96:99], v[84:87], a[20:23]
    v_mfma_f32_16x16x32_bf16 a[24:27], v[96:99], v[88:91], a[24:27]
    v_mfma_f32_16x16x32_bf16 a[28:31], v[96:99], v[92:95], a[28:31]
    v_mfma_f32_16x16x32_bf16 a[32:35], v[100:103], v[64:67], a[32:35]
    v_mfma_f32_16x16x32_bf16 a[36:39], v[100:103], v[68:71], a[36:39]
    v_mfma_f32_16x16x32_bf16 a[40:43], v[100:103], v[72:75], a[40:43]
    v_mfma_f32_16x16x32_bf16 a[44:47], v[100:103], v[76:79], a[44:47]
    v_mfma_f32_16x16x32_bf16 a[48:51], v[100:103], v[80:83], a[48:51]
    v_mfma_f32_16x16x32_bf16 a[52:55], v[100:103], v[84:87], a[52:55]
    v_mfma_f32_16x16x32_bf16 a[56:59], v[100:103], v[88:91], a[56:59]
    v_mfma_f32_16x16x32_bf16 a[60:63], v[100:103], v[92:95], a[60:63]
    v_mfma_f32_16x16x32_bf16 a[64:67], v[104:107], v[64:67], a[64:67]
    v_mfma_f32_16x16x32_bf16 a[68:71], v[104:107], v[68:71], a[68:71]
    v_mfma_f32_16x16x32_bf16 a[72:75], v[104:107], v[72:75], a[72:75]
    v_mfma_f32_16x16x32_bf16 a[76:79], v[104:107], v[76:79], a[76:79]
    v_mfma_f32_16x16x32_bf16 a[80:83], v[104:107], v[80:83], a[80:83]
    v_mfma_f32_16x16x32_bf16 a[84:87], v[104:107], v[84:87], a[84:87]
    v_mfma_f32_16x16x32_bf16 a[88:91], v[104:107], v[88:91], a[88:91]
    v_mfma_f32_16x16x32_bf16 a[92:95], v[104:107], v[92:95], a[92:95]
    v_mfma_f32_16x16x32_bf16 a[96:99], v[108:111], v[64:67], a[96:99]
    v_mfma_f32_16x16x32_bf16 a[100:103], v[108:111], v[68:71], a[100:103]
    v_mfma_f32_16x16x32_bf16 a[104:107], v[108:111], v[72:75], a[104:107]
    v_mfma_f32_16x16x32_bf16 a[108:111], v[108:111], v[76:79], a[108:111]
    v_mfma_f32_16x16x32_bf16 a[112:115], v[108:111], v[80:83], a[112:115]
    v_mfma_f32_16x16x32_bf16 a[116:119], v[108:111], v[84:87], a[116:119]
    v_mfma_f32_16x16x32_bf16 a[120:123], v[108:111], v[88:91], a[120:123]
    v_mfma_f32_16x16x32_bf16 a[124:127], v[108:111], v[92:95], a[124:127]
    v_mfma_f32_16x16x32_bf16 a[128:131], v[112:115], v[64:67], a[128:131]
    v_mfma_f32_16x16x32_bf16 a[132:135], v[112:115], v[68:71], a[132:135]
    v_mfma_f32_16x16x32_bf16 a[136:139], v[112:115], v[72:75], a[136:139]
    v_mfma_f32_16x16x32_bf16 a[140:143], v[112:115], v[76:79], a[140:143]
    v_mfma_f32_16x16x32_bf16 a[144:147], v[112:115], v[80:83], a[144:147]
    v_mfma_f32_16x16x32_bf16 a[148:151], v[112:115], v[84:87], a[148:151]
    v_mfma_f32_16x16x32_bf16 a[152:155], v[112:115], v[88:91], a[152:155]
    v_mfma_f32_16x16x32_bf16 a[156:159], v[112:115], v[92:95], a[156:159]
    v_mfma_f32_16x16x32_bf16 a[160:163], v[116:119], v[64:67], a[160:163]
    v_mfma_f32_16x16x32_bf16 a[164:167], v[116:119], v[68:71], a[164:167]
    v_mfma_f32_16x16x32_bf16 a[168:171], v[116:119], v[72:75], a[168:171]
    v_mfma_f32_16x16x32_bf16 a[172:175], v[116:119], v[76:79], a[172:175]
    v_mfma_f32_16x16x32_bf16 a[176:179], v[116:119], v[80:83], a[176:179]
    v_mfma_f32_16x16x32_bf16 a[180:183], v[116:119], v[84:87], a[180:183]
    v_mfma_f32_16x16x32_bf16 a[184:187], v[116:119], v[88:91], a[184:187]
    v_mfma_f32_16x16x32_bf16 a[188:191], v[116:119], v[92:95], a[188:191]
    v_mfma_f32_16x16x32_bf16 a[192:195], v[120:123], v[64:67], a[192:195]
    v_mfma_f32_16x16x32_bf16 a[196:199], v[120:123], v[68:71], a[196:199]
    v_mfma_f32_16x16x32_bf16 a[200:203], v[120:123], v[72:75], a[200:203]
    v_mfma_f32_16x16x32_bf16 a[204:207], v[120:123], v[76:79], a[204:207]
    v_mfma_f32_16x16x32_bf16 a[208:211], v[120:123], v[80:83], a[208:211]
    v_mfma_f32_16x16x32_bf16 a[212:215], v[120:123], v[84:87], a[212:215]
    v_mfma_f32_16x16x32_bf16 a[216:219], v[120:123], v[88:91], a[216:219]
    v_mfma_f32_16x16x32_bf16 a[220:223], v[120:123], v[92:95], a[220:223]
    v_mfma_f32_16x16x32_bf16 a[224:227], v[124:127], v[64:67], a[224:227]
    v_mfma_f32_16x16x32_bf16 a[228:231], v[124:127], v[68:71], a[228:231]
    v_mfma_f32_16x16x32_bf16 a[232:235], v[124:127], v[72:75], a[232:235]
    v_mfma_f32_16x16x32_bf16 a[236:239], v[124:127], v[76:79], a[236:239]
    v_mfma_f32_16x16x32_bf16 a[240:243], v[124:127], v[80:83], a[240:243]
    v_mfma_f32_16x16x32_bf16 a[244:247], v[124:127], v[84:87], a[244:247]
    v_mfma_f32_16x16x32_bf16 a[248:251], v[124:127], v[88:91], a[248:251]
    v_mfma_f32_16x16x32_bf16 a[252:255], v[124:127], v[92:95], a[252:255]
    s_nop 7
    s_mov_b32 s53, s21
    v_accvgpr_read_b32 v0, a0
    v_accvgpr_read_b32 v1, a1
    v_accvgpr_read_b32 v2, a2
    v_accvgpr_read_b32 v3, a3
    v_accvgpr_read_b32 v4, a32
    v_accvgpr_read_b32 v5, a33
    v_accvgpr_read_b32 v6, a34
    v_accvgpr_read_b32 v7, a35
    v_cvt_pk_bf16_f32 v8, v0, v1
    v_cvt_pk_bf16_f32 v9, v2, v3
    v_cvt_pk_bf16_f32 v10, v4, v5
    v_cvt_pk_bf16_f32 v11, v6, v7
    buffer_store_dwordx4 v[8:11], v251, s[4:7], s53 offen offset:0 sc1
    v_accvgpr_read_b32 v16, a4
    v_accvgpr_read_b32 v17, a5
    v_accvgpr_read_b32 v18, a6
    v_accvgpr_read_b32 v19, a7
    v_accvgpr_read_b32 v20, a36
    v_accvgpr_read_b32 v21, a37
    v_accvgpr_read_b32 v22, a38
    v_accvgpr_read_b32 v23, a39
    v_cvt_pk_bf16_f32 v24, v16, v17
    v_cvt_pk_bf16_f32 v25, v18, v19
    v_cvt_pk_bf16_f32 v26, v20, v21
    v_cvt_pk_bf16_f32 v27, v22, v23
    buffer_store_dwordx4 v[24:27], v251, s[4:7], s53 offen offset:1024 sc1
    v_accvgpr_read_b32 v32, a8
    v_accvgpr_read_b32 v33, a9
    v_accvgpr_read_b32 v34, a10
    v_accvgpr_read_b32 v35, a11
    v_accvgpr_read_b32 v36, a40
    v_accvgpr_read_b32 v37, a41
    v_accvgpr_read_b32 v38, a42
    v_accvgpr_read_b32 v39, a43
    v_cvt_pk_bf16_f32 v40, v32, v33
    v_cvt_pk_bf16_f32 v41, v34, v35
    v_cvt_pk_bf16_f32 v42, v36, v37
    v_cvt_pk_bf16_f32 v43, v38, v39
    buffer_store_dwordx4 v[40:43], v251, s[4:7], s53 offen offset:2048 sc1
    v_accvgpr_read_b32 v48, a12
    v_accvgpr_read_b32 v49, a13
    v_accvgpr_read_b32 v50, a14
    v_accvgpr_read_b32 v51, a15
    v_accvgpr_read_b32 v52, a44
    v_accvgpr_read_b32 v53, a45
    v_accvgpr_read_b32 v54, a46
    v_accvgpr_read_b32 v55, a47
    v_cvt_pk_bf16_f32 v56, v48, v49
    v_cvt_pk_bf16_f32 v57, v50, v51
    v_cvt_pk_bf16_f32 v58, v52, v53
    v_cvt_pk_bf16_f32 v59, v54, v55
    buffer_store_dwordx4 v[56:59], v251, s[4:7], s53 offen offset:3072 sc1
    s_add_u32 s53, s53, 4096
    v_accvgpr_read_b32 v0, a16
    v_accvgpr_read_b32 v1, a17
    v_accvgpr_read_b32 v2, a18
    v_accvgpr_read_b32 v3, a19
    v_accvgpr_read_b32 v4, a48
    v_accvgpr_read_b32 v5, a49
    v_accvgpr_read_b32 v6, a50
    v_accvgpr_read_b32 v7, a51
    v_cvt_pk_bf16_f32 v8, v0, v1
    v_cvt_pk_bf16_f32 v9, v2, v3
    v_cvt_pk_bf16_f32 v10, v4, v5
    v_cvt_pk_bf16_f32 v11, v6, v7
    buffer_store_dwordx4 v[8:11], v251, s[4:7], s53 offen offset:0 sc1
    v_accvgpr_read_b32 v16, a20
    v_accvgpr_read_b32 v17, a21
    v_accvgpr_read_b32 v18, a22
    v_accvgpr_read_b32 v19, a23
    v_accvgpr_read_b32 v20, a52
    v_accvgpr_read_b32 v21, a53
    v_accvgpr_read_b32 v22, a54
    v_accvgpr_read_b32 v23, a55
    v_cvt_pk_bf16_f32 v24, v16, v17
    v_cvt_pk_bf16_f32 v25, v18, v19
    v_cvt_pk_bf16_f32 v26, v20, v21
    v_cvt_pk_bf16_f32 v27, v22, v23
    buffer_store_dwordx4 v[24:27], v251, s[4:7], s53 offen offset:1024 sc1
    v_accvgpr_read_b32 v32, a24
    v_accvgpr_read_b32 v33, a25
    v_accvgpr_read_b32 v34, a26
    v_accvgpr_read_b32 v35, a27
    v_accvgpr_read_b32 v36, a56
    v_accvgpr_read_b32 v37, a57
    v_accvgpr_read_b32 v38, a58
    v_accvgpr_read_b32 v39, a59
    v_cvt_pk_bf16_f32 v40, v32, v33
    v_cvt_pk_bf16_f32 v41, v34, v35
    v_cvt_pk_bf16_f32 v42, v36, v37
    v_cvt_pk_bf16_f32 v43, v38, v39
    buffer_store_dwordx4 v[40:43], v251, s[4:7], s53 offen offset:2048 sc1
    v_accvgpr_read_b32 v48, a28
    v_accvgpr_read_b32 v49, a29
    v_accvgpr_read_b32 v50, a30
    v_accvgpr_read_b32 v51, a31
    v_accvgpr_read_b32 v52, a60
    v_accvgpr_read_b32 v53, a61
    v_accvgpr_read_b32 v54, a62
    v_accvgpr_read_b32 v55, a63
    v_cvt_pk_bf16_f32 v56, v48, v49
    v_cvt_pk_bf16_f32 v57, v50, v51
    v_cvt_pk_bf16_f32 v58, v52, v53
    v_cvt_pk_bf16_f32 v59, v54, v55
    buffer_store_dwordx4 v[56:59], v251, s[4:7], s53 offen offset:3072 sc1
    s_add_u32 s53, s53, 258048
    v_accvgpr_read_b32 v0, a64
    v_accvgpr_read_b32 v1, a65
    v_accvgpr_read_b32 v2, a66
    v_accvgpr_read_b32 v3, a67
    v_accvgpr_read_b32 v4, a96
    v_accvgpr_read_b32 v5, a97
    v_accvgpr_read_b32 v6, a98
    v_accvgpr_read_b32 v7, a99
    v_cvt_pk_bf16_f32 v8, v0, v1
    v_cvt_pk_bf16_f32 v9, v2, v3
    v_cvt_pk_bf16_f32 v10, v4, v5
    v_cvt_pk_bf16_f32 v11, v6, v7
    buffer_store_dwordx4 v[8:11], v251, s[4:7], s53 offen offset:0 sc1
    v_accvgpr_read_b32 v16, a68
    v_accvgpr_read_b32 v17, a69
    v_accvgpr_read_b32 v18, a70
    v_accvgpr_read_b32 v19, a71
    v_accvgpr_read_b32 v20, a100
    v_accvgpr_read_b32 v21, a101
    v_accvgpr_read_b32 v22, a102
    v_accvgpr_read_b32 v23, a103
    v_cvt_pk_bf16_f32 v24, v16, v17
    v_cvt_pk_bf16_f32 v25, v18, v19
    v_cvt_pk_bf16_f32 v26, v20, v21
    v_cvt_pk_bf16_f32 v27, v22, v23
    buffer_store_dwordx4 v[24:27], v251, s[4:7], s53 offen offset:1024 sc1
    v_accvgpr_read_b32 v32, a72
    v_accvgpr_read_b32 v33, a73
    v_accvgpr_read_b32 v34, a74
    v_accvgpr_read_b32 v35, a75
    v_accvgpr_read_b32 v36, a104
    v_accvgpr_read_b32 v37, a105
    v_accvgpr_read_b32 v38, a106
    v_accvgpr_read_b32 v39, a107
    v_cvt_pk_bf16_f32 v40, v32, v33
    v_cvt_pk_bf16_f32 v41, v34, v35
    v_cvt_pk_bf16_f32 v42, v36, v37
    v_cvt_pk_bf16_f32 v43, v38, v39
    buffer_store_dwordx4 v[40:43], v251, s[4:7], s53 offen offset:2048 sc1
    v_accvgpr_read_b32 v48, a76
    v_accvgpr_read_b32 v49, a77
    v_accvgpr_read_b32 v50, a78
    v_accvgpr_read_b32 v51, a79
    v_accvgpr_read_b32 v52, a108
    v_accvgpr_read_b32 v53, a109
    v_accvgpr_read_b32 v54, a110
    v_accvgpr_read_b32 v55, a111
    v_cvt_pk_bf16_f32 v56, v48, v49
    v_cvt_pk_bf16_f32 v57, v50, v51
    v_cvt_pk_bf16_f32 v58, v52, v53
    v_cvt_pk_bf16_f32 v59, v54, v55
    buffer_store_dwordx4 v[56:59], v251, s[4:7], s53 offen offset:3072 sc1
    s_add_u32 s53, s53, 4096
    v_accvgpr_read_b32 v0, a80
    v_accvgpr_read_b32 v1, a81
    v_accvgpr_read_b32 v2, a82
    v_accvgpr_read_b32 v3, a83
    v_accvgpr_read_b32 v4, a112
    v_accvgpr_read_b32 v5, a113
    v_accvgpr_read_b32 v6, a114
    v_accvgpr_read_b32 v7, a115
    v_cvt_pk_bf16_f32 v8, v0, v1
    v_cvt_pk_bf16_f32 v9, v2, v3
    v_cvt_pk_bf16_f32 v10, v4, v5
    v_cvt_pk_bf16_f32 v11, v6, v7
    buffer_store_dwordx4 v[8:11], v251, s[4:7], s53 offen offset:0 sc1
    v_accvgpr_read_b32 v16, a84
    v_accvgpr_read_b32 v17, a85
    v_accvgpr_read_b32 v18, a86
    v_accvgpr_read_b32 v19, a87
    v_accvgpr_read_b32 v20, a116
    v_accvgpr_read_b32 v21, a117
    v_accvgpr_read_b32 v22, a118
    v_accvgpr_read_b32 v23, a119
    v_cvt_pk_bf16_f32 v24, v16, v17
    v_cvt_pk_bf16_f32 v25, v18, v19
    v_cvt_pk_bf16_f32 v26, v20, v21
    v_cvt_pk_bf16_f32 v27, v22, v23
    buffer_store_dwordx4 v[24:27], v251, s[4:7], s53 offen offset:1024 sc1
    v_accvgpr_read_b32 v32, a88
    v_accvgpr_read_b32 v33, a89
    v_accvgpr_read_b32 v34, a90
    v_accvgpr_read_b32 v35, a91
    v_accvgpr_read_b32 v36, a120
    v_accvgpr_read_b32 v37, a121
    v_accvgpr_read_b32 v38, a122
    v_accvgpr_read_b32 v39, a123
    v_cvt_pk_bf16_f32 v40, v32, v33
    v_cvt_pk_bf16_f32 v41, v34, v35
    v_cvt_pk_bf16_f32 v42, v36, v37
    v_cvt_pk_bf16_f32 v43, v38, v39
    buffer_store_dwordx4 v[40:43], v251, s[4:7], s53 offen offset:2048 sc1
    v_accvgpr_read_b32 v48, a92
    v_accvgpr_read_b32 v49, a93
    v_accvgpr_read_b32 v50, a94
    v_accvgpr_read_b32 v51, a95
    v_accvgpr_read_b32 v52, a124
    v_accvgpr_read_b32 v53, a125
    v_accvgpr_read_b32 v54, a126
    v_accvgpr_read_b32 v55, a127
    v_cvt_pk_bf16_f32 v56, v48, v49
    v_cvt_pk_bf16_f32 v57, v50, v51
    v_cvt_pk_bf16_f32 v58, v52, v53
    v_cvt_pk_bf16_f32 v59, v54, v55
    buffer_store_dwordx4 v[56:59], v251, s[4:7], s53 offen offset:3072 sc1
    s_add_u32 s53, s53, 258048
    v_accvgpr_read_b32 v0, a128
    v_accvgpr_read_b32 v1, a129
    v_accvgpr_read_b32 v2, a130
    v_accvgpr_read_b32 v3, a131
    v_accvgpr_read_b32 v4, a160
    v_accvgpr_read_b32 v5, a161
    v_accvgpr_read_b32 v6, a162
    v_accvgpr_read_b32 v7, a163
    v_cvt_pk_bf16_f32 v8, v0, v1
    v_cvt_pk_bf16_f32 v9, v2, v3
    v_cvt_pk_bf16_f32 v10, v4, v5
    v_cvt_pk_bf16_f32 v11, v6, v7
    buffer_store_dwordx4 v[8:11], v251, s[4:7], s53 offen offset:0 sc1
    v_accvgpr_read_b32 v16, a132
    v_accvgpr_read_b32 v17, a133
    v_accvgpr_read_b32 v18, a134
    v_accvgpr_read_b32 v19, a135
    v_accvgpr_read_b32 v20, a164
    v_accvgpr_read_b32 v21, a165
    v_accvgpr_read_b32 v22, a166
    v_accvgpr_read_b32 v23, a167
    v_cvt_pk_bf16_f32 v24, v16, v17
    v_cvt_pk_bf16_f32 v25, v18, v19
    v_cvt_pk_bf16_f32 v26, v20, v21
    v_cvt_pk_bf16_f32 v27, v22, v23
    buffer_store_dwordx4 v[24:27], v251, s[4:7], s53 offen offset:1024 sc1
    v_accvgpr_read_b32 v32, a136
    v_accvgpr_read_b32 v33, a137
    v_accvgpr_read_b32 v34, a138
    v_accvgpr_read_b32 v35, a139
    v_accvgpr_read_b32 v36, a168
    v_accvgpr_read_b32 v37, a169
    v_accvgpr_read_b32 v38, a170
    v_accvgpr_read_b32 v39, a171
    v_cvt_pk_bf16_f32 v40, v32, v33
    v_cvt_pk_bf16_f32 v41, v34, v35
    v_cvt_pk_bf16_f32 v42, v36, v37
    v_cvt_pk_bf16_f32 v43, v38, v39
    buffer_store_dwordx4 v[40:43], v251, s[4:7], s53 offen offset:2048 sc1
    v_accvgpr_read_b32 v48, a140
    v_accvgpr_read_b32 v49, a141
    v_accvgpr_read_b32 v50, a142
    v_accvgpr_read_b32 v51, a143
    v_accvgpr_read_b32 v52, a172
    v_accvgpr_read_b32 v53, a173
    v_accvgpr_read_b32 v54, a174
    v_accvgpr_read_b32 v55, a175
    v_cvt_pk_bf16_f32 v56, v48, v49
    v_cvt_pk_bf16_f32 v57, v50, v51
    v_cvt_pk_bf16_f32 v58, v52, v53
    v_cvt_pk_bf16_f32 v59, v54, v55
    buffer_store_dwordx4 v[56:59], v251, s[4:7], s53 offen offset:3072 sc1
    s_add_u32 s53, s53, 4096
    v_accvgpr_read_b32 v0, a144
    v_accvgpr_read_b32 v1, a145
    v_accvgpr_read_b32 v2, a146
    v_accvgpr_read_b32 v3, a147
    v_accvgpr_read_b32 v4, a176
    v_accvgpr_read_b32 v5, a177
    v_accvgpr_read_b32 v6, a178
    v_accvgpr_read_b32 v7, a179
    v_cvt_pk_bf16_f32 v8, v0, v1
    v_cvt_pk_bf16_f32 v9, v2, v3
    v_cvt_pk_bf16_f32 v10, v4, v5
    v_cvt_pk_bf16_f32 v11, v6, v7
    buffer_store_dwordx4 v[8:11], v251, s[4:7], s53 offen offset:0 sc1
    v_accvgpr_read_b32 v16, a148
    v_accvgpr_read_b32 v17, a149
    v_accvgpr_read_b32 v18, a150
    v_accvgpr_read_b32 v19, a151
    v_accvgpr_read_b32 v20, a180
    v_accvgpr_read_b32 v21, a181
    v_accvgpr_read_b32 v22, a182
    v_accvgpr_read_b32 v23, a183
    v_cvt_pk_bf16_f32 v24, v16, v17
    v_cvt_pk_bf16_f32 v25, v18, v19
    v_cvt_pk_bf16_f32 v26, v20, v21
    v_cvt_pk_bf16_f32 v27, v22, v23
    buffer_store_dwordx4 v[24:27], v251, s[4:7], s53 offen offset:1024 sc1
    v_accvgpr_read_b32 v32, a152
    v_accvgpr_read_b32 v33, a153
    v_accvgpr_read_b32 v34, a154
    v_accvgpr_read_b32 v35, a155
    v_accvgpr_read_b32 v36, a184
    v_accvgpr_read_b32 v37, a185
    v_accvgpr_read_b32 v38, a186
    v_accvgpr_read_b32 v39, a187
    v_cvt_pk_bf16_f32 v40, v32, v33
    v_cvt_pk_bf16_f32 v41, v34, v35
    v_cvt_pk_bf16_f32 v42, v36, v37
    v_cvt_pk_bf16_f32 v43, v38, v39
    buffer_store_dwordx4 v[40:43], v251, s[4:7], s53 offen offset:2048 sc1
    v_accvgpr_read_b32 v48, a156
    v_accvgpr_read_b32 v49, a157
    v_accvgpr_read_b32 v50, a158
    v_accvgpr_read_b32 v51, a159
    v_accvgpr_read_b32 v52, a188
    v_accvgpr_read_b32 v53, a189
    v_accvgpr_read_b32 v54, a190
    v_accvgpr_read_b32 v55, a191
    v_cvt_pk_bf16_f32 v56, v48, v49
    v_cvt_pk_bf16_f32 v57, v50, v51
    v_cvt_pk_bf16_f32 v58, v52, v53
    v_cvt_pk_bf16_f32 v59, v54, v55
    buffer_store_dwordx4 v[56:59], v251, s[4:7], s53 offen offset:3072 sc1
    s_add_u32 s53, s53, 258048
    v_accvgpr_read_b32 v0, a192
    v_accvgpr_read_b32 v1, a193
    v_accvgpr_read_b32 v2, a194
    v_accvgpr_read_b32 v3, a195
    v_accvgpr_read_b32 v4, a224
    v_accvgpr_read_b32 v5, a225
    v_accvgpr_read_b32 v6, a226
    v_accvgpr_read_b32 v7, a227
    v_cvt_pk_bf16_f32 v8, v0, v1
    v_cvt_pk_bf16_f32 v9, v2, v3
    v_cvt_pk_bf16_f32 v10, v4, v5
    v_cvt_pk_bf16_f32 v11, v6, v7
    buffer_store_dwordx4 v[8:11], v251, s[4:7], s53 offen offset:0 sc1
    v_accvgpr_read_b32 v16, a196
    v_accvgpr_read_b32 v17, a197
    v_accvgpr_read_b32 v18, a198
    v_accvgpr_read_b32 v19, a199
    v_accvgpr_read_b32 v20, a228
    v_accvgpr_read_b32 v21, a229
    v_accvgpr_read_b32 v22, a230
    v_accvgpr_read_b32 v23, a231
    v_cvt_pk_bf16_f32 v24, v16, v17
    v_cvt_pk_bf16_f32 v25, v18, v19
    v_cvt_pk_bf16_f32 v26, v20, v21
    v_cvt_pk_bf16_f32 v27, v22, v23
    buffer_store_dwordx4 v[24:27], v251, s[4:7], s53 offen offset:1024 sc1
    v_accvgpr_read_b32 v32, a200
    v_accvgpr_read_b32 v33, a201
    v_accvgpr_read_b32 v34, a202
    v_accvgpr_read_b32 v35, a203
    v_accvgpr_read_b32 v36, a232
    v_accvgpr_read_b32 v37, a233
    v_accvgpr_read_b32 v38, a234
    v_accvgpr_read_b32 v39, a235
    v_cvt_pk_bf16_f32 v40, v32, v33
    v_cvt_pk_bf16_f32 v41, v34, v35
    v_cvt_pk_bf16_f32 v42, v36, v37
    v_cvt_pk_bf16_f32 v43, v38, v39
    buffer_store_dwordx4 v[40:43], v251, s[4:7], s53 offen offset:2048 sc1
    v_accvgpr_read_b32 v48, a204
    v_accvgpr_read_b32 v49, a205
    v_accvgpr_read_b32 v50, a206
    v_accvgpr_read_b32 v51, a207
    v_accvgpr_read_b32 v52, a236
    v_accvgpr_read_b32 v53, a237
    v_accvgpr_read_b32 v54, a238
    v_accvgpr_read_b32 v55, a239
    v_cvt_pk_bf16_f32 v56, v48, v49
    v_cvt_pk_bf16_f32 v57, v50, v51
    v_cvt_pk_bf16_f32 v58, v52, v53
    v_cvt_pk_bf16_f32 v59, v54, v55
    buffer_store_dwordx4 v[56:59], v251, s[4:7], s53 offen offset:3072 sc1
    s_add_u32 s53, s53, 4096
    v_accvgpr_read_b32 v0, a208
    v_accvgpr_read_b32 v1, a209
    v_accvgpr_read_b32 v2, a210
    v_accvgpr_read_b32 v3, a211
    v_accvgpr_read_b32 v4, a240
    v_accvgpr_read_b32 v5, a241
    v_accvgpr_read_b32 v6, a242
    v_accvgpr_read_b32 v7, a243
    v_cvt_pk_bf16_f32 v8, v0, v1
    v_cvt_pk_bf16_f32 v9, v2, v3
    v_cvt_pk_bf16_f32 v10, v4, v5
    v_cvt_pk_bf16_f32 v11, v6, v7
    buffer_store_dwordx4 v[8:11], v251, s[4:7], s53 offen offset:0 sc1
    v_accvgpr_read_b32 v16, a212
    v_accvgpr_read_b32 v17, a213
    v_accvgpr_read_b32 v18, a214
    v_accvgpr_read_b32 v19, a215
    v_accvgpr_read_b32 v20, a244
    v_accvgpr_read_b32 v21, a245
    v_accvgpr_read_b32 v22, a246
    v_accvgpr_read_b32 v23, a247
    v_cvt_pk_bf16_f32 v24, v16, v17
    v_cvt_pk_bf16_f32 v25, v18, v19
    v_cvt_pk_bf16_f32 v26, v20, v21
    v_cvt_pk_bf16_f32 v27, v22, v23
    buffer_store_dwordx4 v[24:27], v251, s[4:7], s53 offen offset:1024 sc1
    v_accvgpr_read_b32 v32, a216
    v_accvgpr_read_b32 v33, a217
    v_accvgpr_read_b32 v34, a218
    v_accvgpr_read_b32 v35, a219
    v_accvgpr_read_b32 v36, a248
    v_accvgpr_read_b32 v37, a249
    v_accvgpr_read_b32 v38, a250
    v_accvgpr_read_b32 v39, a251
    v_cvt_pk_bf16_f32 v40, v32, v33
    v_cvt_pk_bf16_f32 v41, v34, v35
    v_cvt_pk_bf16_f32 v42, v36, v37
    v_cvt_pk_bf16_f32 v43, v38, v39
    buffer_store_dwordx4 v[40:43], v251, s[4:7], s53 offen offset:2048 sc1
    v_accvgpr_read_b32 v48, a220
    v_accvgpr_read_b32 v49, a221
    v_accvgpr_read_b32 v50, a222
    v_accvgpr_read_b32 v51, a223
    v_accvgpr_read_b32 v52, a252
    v_accvgpr_read_b32 v53, a253
    v_accvgpr_read_b32 v54, a254
    v_accvgpr_read_b32 v55, a255
    v_cvt_pk_bf16_f32 v56, v48, v49
    v_cvt_pk_bf16_f32 v57, v50, v51
    v_cvt_pk_bf16_f32 v58, v52, v53
    v_cvt_pk_bf16_f32 v59, v54, v55
    buffer_store_dwordx4 v[56:59], v251, s[4:7], s53 offen offset:3072 sc1
    s_add_u32 s53, s53, 258048
    s_branch main_kernel_w_done
main_kernel_w_pref:
    s_cmp_lg_u32 s24, 0
    s_cbranch_scc1 main_kernel_w_pf0
    s_mov_b32 s8, s64
    s_and_b32 s9, s65, 0xffff
    s_mov_b32 s10, 0x200000
    s_mov_b32 s11, 0x20000
    s_branch main_kernel_w_pfg
main_kernel_w_pf0:
    s_cmp_lg_u32 s24, 1
    s_cbranch_scc1 main_kernel_w_pf1
    s_mov_b32 s8, s66
    s_and_b32 s9, s67, 0xffff
    s_mov_b32 s10, 0x200000
    s_mov_b32 s11, 0x20000
    s_branch main_kernel_w_pfg
main_kernel_w_pf1:
    s_cmp_lg_u32 s24, 2
    s_cbranch_scc1 main_kernel_w_pf2
    s_mov_b32 s8, s68
    s_and_b32 s9, s69, 0xffff
    s_mov_b32 s10, 0x700000
    s_mov_b32 s11, 0x20000
    s_branch main_kernel_w_pfg
main_kernel_w_pf2:
    s_mov_b32 s8, s70
    s_and_b32 s9, s71, 0xffff
    s_mov_b32 s10, 0x700000
    s_mov_b32 s11, 0x20000
main_kernel_w_pfg:
    s_lshl_b32 s32, s25, 19
    s_lshl_b32 s33, s14, 17
    s_add_u32 s32, s32, s33
    v_lshlrev_b32 v253, 7, v250
    buffer_load_dword v0, v253, s[8:11], s32 offen
    s_add_u32 s32, s32, 8192
    buffer_load_dword v0, v253, s[8:11], s32 offen
    s_add_u32 s32, s32, 8192
    buffer_load_dword v0, v253, s[8:11], s32 offen
    s_add_u32 s32, s32, 8192
    buffer_load_dword v0, v253, s[8:11], s32 offen
    s_add_u32 s32, s32, 8192
    buffer_load_dword v0, v253, s[8:11], s32 offen
    s_add_u32 s32, s32, 8192
    buffer_load_dword v0, v253, s[8:11], s32 offen
    s_add_u32 s32, s32, 8192
    buffer_load_dword v0, v253, s[8:11], s32 offen
    s_add_u32 s32, s32, 8192
    buffer_load_dword v0, v253, s[8:11], s32 offen
    s_add_u32 s32, s32, 8192
    buffer_load_dword v0, v253, s[8:11], s32 offen
    s_add_u32 s32, s32, 8192
    buffer_load_dword v0, v253, s[8:11], s32 offen
    s_add_u32 s32, s32, 8192
    buffer_load_dword v0, v253, s[8:11], s32 offen
    s_add_u32 s32, s32, 8192
    buffer_load_dword v0, v253, s[8:11], s32 offen
    s_add_u32 s32, s32, 8192
    buffer_load_dword v0, v253, s[8:11], s32 offen
    s_add_u32 s32, s32, 8192
    buffer_load_dword v0, v253, s[8:11], s32 offen
    s_add_u32 s32, s32, 8192
    buffer_load_dword v0, v253, s[8:11], s32 offen
    s_add_u32 s32, s32, 8192
    buffer_load_dword v0, v253, s[8:11], s32 offen
    s_add_u32 s32, s32, 8192
    s_branch main_kernel_w_done
main_kernel_w_fill:
    s_lshl_b32 s32, s24, 2
    s_add_u32 s32, s32, s25
    s_lshl_b32 s33, s32, 16
    s_add_u32 s32, s33, 0x6e00000
    s_add_u32 s35, s33, 0x8c00000
    s_add_u32 s33, s33, 0x8000000
    s_lshl_b32 s34, s14, 12
    v_add_u32 v253, s34, v251
    v_mov_b32 v0, -1
    v_mov_b32 v1, -1
    v_mov_b32 v2, -1
    v_mov_b32 v3, -1
    s_mov_b32 s18, 4
main_kernel_w_fl:
    buffer_store_dwordx4 v[0:3], v253, s[4:7], s32 offen offset:0 sc1
    buffer_store_dwordx4 v[0:3], v253, s[4:7], s32 offen offset:1024 sc1
    buffer_store_dwordx4 v[0:3], v253, s[4:7], s32 offen offset:2048 sc1
    buffer_store_dwordx4 v[0:3], v253, s[4:7], s32 offen offset:3072 sc1
    s_add_u32 s32, s32, 16384
    buffer_store_dwordx4 v[0:3], v253, s[4:7], s33 offen offset:0 sc1
    buffer_store_dwordx4 v[0:3], v253, s[4:7], s33 offen offset:1024 sc1
    buffer_store_dwordx4 v[0:3], v253, s[4:7], s33 offen offset:2048 sc1
    buffer_store_dwordx4 v[0:3], v253, s[4:7], s33 offen offset:3072 sc1
    s_add_u32 s33, s33, 16384
    s_sub_u32 s18, s18, 1
    s_cmp_lg_u32 s18, 0
    s_cbranch_scc1 main_kernel_w_fl
    s_branch main_kernel_w_done
main_kernel_w_ln2:
    s_lshl_b32 s32, s24, 3
    s_mul_i32 s33, s25, 2
    s_add_u32 s32, s32, s33
    s_lshl_b32 s32, s32, 15
    s_lshl_b32 s33, s14, 13
    s_add_u32 s32, s32, s33
    s_add_u32 s21, s32, 0x6800000
    s_add_u32 s32, s32, 0x5000000
    buffer_load_dwordx4 v[0:3], v251, s[4:7], s32 offen offset:0 sc1
    buffer_load_dwordx4 v[4:7], v251, s[4:7], s32 offen offset:1024 sc1
    buffer_load_dwordx4 v[8:11], v251, s[4:7], s32 offen offset:2048 sc1
    buffer_load_dwordx4 v[12:15], v251, s[4:7], s32 offen offset:3072 sc1
    s_add_u32 s32, s32, 4096
    buffer_load_dwordx4 v[16:19], v251, s[4:7], s32 offen offset:0 sc1
    buffer_load_dwordx4 v[20:23], v251, s[4:7], s32 offen offset:1024 sc1
    buffer_load_dwordx4 v[24:27], v251, s[4:7], s32 offen offset:2048 sc1
    buffer_load_dwordx4 v[28:31], v251, s[4:7], s32 offen offset:3072 sc1
    s_add_u32 s32, s32, 28672
    buffer_load_dwordx4 v[32:35], v251, s[4:7], s32 offen offset:0 sc1
    buffer_load_dwordx4 v[36:39], v251, s[4:7], s32 offen offset:1024 sc1
    buffer_load_dwordx4 v[40:43], v251, s[4:7], s32 offen offset:2048 sc1
    buffer_load_dwordx4 v[44:47], v251, s[4:7], s32 offen offset:3072 sc1
    s_add_u32 s32, s32, 4096
    buffer_load_dwordx4 v[48:51], v251, s[4:7], s32 offen offset:0 sc1
    buffer_load_dwordx4 v[52:55], v251, s[4:7], s32 offen offset:1024 sc1
    buffer_load_dwordx4 v[56:59], v251, s[4:7], s32 offen offset:2048 sc1
    buffer_load_dwordx4 v[60:63], v251, s[4:7], s32 offen offset:3072 sc1
    s_add_u32 s32, s32, 28672
    v_and_b32 v255, 15, v250
    v_lshlrev_b32 v254, 6, v255
    v_add_u32 v254, 132096, v254
    v_lshrrev_b32 v255, 4, v250
    v_lshl_add_u32 v253, v255, 2, v254
    v_lshl_add_u32 v253, s14, 4, v253
    s_waitcnt vmcnt(8)
    v_lshlrev_b32 v128, 16, v0
    v_and_b32 v129, 0xffff0000, v0
    v_lshlrev_b32 v130, 16, v1
    v_and_b32 v131, 0xffff0000, v1
    v_lshlrev_b32 v132, 16, v2
    v_and_b32 v133, 0xffff0000, v2
    v_lshlrev_b32 v134, 16, v3
    v_and_b32 v135, 0xffff0000, v3
    v_lshlrev_b32 v136, 16, v4
    v_and_b32 v137, 0xffff0000, v4
    v_lshlrev_b32 v138, 16, v5
    v_and_b32 v139, 0xffff0000, v5
    v_lshlrev_b32 v140, 16, v6
    v_and_b32 v141, 0xffff0000, v6
    v_lshlrev_b32 v142, 16, v7
    v_and_b32 v143, 0xffff0000, v7
    v_lshlrev_b32 v144, 16, v8
    v_and_b32 v145, 0xffff0000, v8
    v_lshlrev_b32 v146, 16, v9
    v_and_b32 v147, 0xffff0000, v9
    v_lshlrev_b32 v148, 16, v10
    v_and_b32 v149, 0xffff0000, v10
    v_lshlrev_b32 v150, 16, v11
    v_and_b32 v151, 0xffff0000, v11
    v_lshlrev_b32 v152, 16, v12
    v_and_b32 v153, 0xffff0000, v12
    v_lshlrev_b32 v154, 16, v13
    v_and_b32 v155, 0xffff0000, v13
    v_lshlrev_b32 v156, 16, v14
    v_and_b32 v157, 0xffff0000, v14
    v_lshlrev_b32 v158, 16, v15
    v_and_b32 v159, 0xffff0000, v15
    v_lshlrev_b32 v160, 16, v16
    v_and_b32 v161, 0xffff0000, v16
    v_lshlrev_b32 v162, 16, v17
    v_and_b32 v163, 0xffff0000, v17
    v_lshlrev_b32 v164, 16, v18
    v_and_b32 v165, 0xffff0000, v18
    v_lshlrev_b32 v166, 16, v19
    v_and_b32 v167, 0xffff0000, v19
    v_lshlrev_b32 v168, 16, v20
    v_and_b32 v169, 0xffff0000, v20
    v_lshlrev_b32 v170, 16, v21
    v_and_b32 v171, 0xffff0000, v21
    v_lshlrev_b32 v172, 16, v22
    v_and_b32 v173, 0xffff0000, v22
    v_lshlrev_b32 v174, 16, v23
    v_and_b32 v175, 0xffff0000, v23
    v_lshlrev_b32 v176, 16, v24
    v_and_b32 v177, 0xffff0000, v24
    v_lshlrev_b32 v178, 16, v25
    v_and_b32 v179, 0xffff0000, v25
    v_lshlrev_b32 v180, 16, v26
    v_and_b32 v181, 0xffff0000, v26
    v_lshlrev_b32 v182, 16, v27
    v_and_b32 v183, 0xffff0000, v27
    v_lshlrev_b32 v184, 16, v28
    v_and_b32 v185, 0xffff0000, v28
    v_lshlrev_b32 v186, 16, v29
    v_and_b32 v187, 0xffff0000, v29
    v_lshlrev_b32 v188, 16, v30
    v_and_b32 v189, 0xffff0000, v30
    v_lshlrev_b32 v190, 16, v31
    v_and_b32 v191, 0xffff0000, v31
    v_pk_add_f32 v[192:193], v[128:129], v[136:137]
    v_pk_add_f32 v[194:195], v[130:131], v[138:139]
    v_pk_add_f32 v[196:197], v[132:133], v[140:141]
    v_pk_add_f32 v[198:199], v[134:135], v[142:143]
    v_pk_add_f32 v[192:193], v[192:193], v[144:145]
    v_pk_add_f32 v[194:195], v[194:195], v[146:147]
    v_pk_add_f32 v[196:197], v[196:197], v[148:149]
    v_pk_add_f32 v[198:199], v[198:199], v[150:151]
    v_pk_add_f32 v[192:193], v[192:193], v[152:153]
    v_pk_add_f32 v[194:195], v[194:195], v[154:155]
    v_pk_add_f32 v[196:197], v[196:197], v[156:157]
    v_pk_add_f32 v[198:199], v[198:199], v[158:159]
    v_pk_add_f32 v[192:193], v[192:193], v[160:161]
    v_pk_add_f32 v[194:195], v[194:195], v[162:163]
    v_pk_add_f32 v[196:197], v[196:197], v[164:165]
    v_pk_add_f32 v[198:199], v[198:199], v[166:167]
    v_pk_add_f32 v[192:193], v[192:193], v[168:169]
    v_pk_add_f32 v[194:195], v[194:195], v[170:171]
    v_pk_add_f32 v[196:197], v[196:197], v[172:173]
    v_pk_add_f32 v[198:199], v[198:199], v[174:175]
    v_pk_add_f32 v[192:193], v[192:193], v[176:177]
    v_pk_add_f32 v[194:195], v[194:195], v[178:179]
    v_pk_add_f32 v[196:197], v[196:197], v[180:181]
    v_pk_add_f32 v[198:199], v[198:199], v[182:183]
    v_pk_add_f32 v[192:193], v[192:193], v[184:185]
    v_pk_add_f32 v[194:195], v[194:195], v[186:187]
    v_pk_add_f32 v[196:197], v[196:197], v[188:189]
    v_pk_add_f32 v[198:199], v[198:199], v[190:191]
    v_pk_add_f32 v[192:193], v[192:193], v[194:195]
    v_pk_add_f32 v[196:197], v[196:197], v[198:199]
    v_pk_add_f32 v[192:193], v[192:193], v[196:197]
    v_add_f32 v192, v192, v193
    ds_write_b32 v253, v192 offset:0
    s_waitcnt lgkmcnt(0)
    s_barrier
    ds_read_b128 v[192:195], v254 offset:0
    ds_read_b128 v[196:199], v254 offset:16
    ds_read_b128 v[200:203], v254 offset:32
    ds_read_b128 v[204:207], v254 offset:48
    s_waitcnt lgkmcnt(2)
    v_pk_add_f32 v[192:193], v[192:193], v[194:195]
    v_pk_add_f32 v[196:197], v[196:197], v[198:199]
    s_waitcnt lgkmcnt(0)
    v_pk_add_f32 v[200:201], v[200:201], v[202:203]
    v_pk_add_f32 v[204:205], v[204:205], v[206:207]
    v_pk_add_f32 v[192:193], v[192:193], v[196:197]
    v_pk_add_f32 v[200:201], v[200:201], v[204:205]
    v_pk_add_f32 v[192:193], v[192:193], v[200:201]
    v_add_f32 v192, v192, v193
    v_mul_f32 v192, 0xba800000, v192
    v_mov_b32 v193, v192
    v_pk_add_f32 v[128:129], v[128:129], v[192:193]
    v_pk_add_f32 v[130:131], v[130:131], v[192:193]
    v_pk_add_f32 v[132:133], v[132:133], v[192:193]
    v_pk_add_f32 v[134:135], v[134:135], v[192:193]
    v_pk_add_f32 v[136:137], v[136:137], v[192:193]
    v_pk_add_f32 v[138:139], v[138:139], v[192:193]
    v_pk_add_f32 v[140:141], v[140:141], v[192:193]
    v_pk_add_f32 v[142:143], v[142:143], v[192:193]
    v_pk_add_f32 v[144:145], v[144:145], v[192:193]
    v_pk_add_f32 v[146:147], v[146:147], v[192:193]
    v_pk_add_f32 v[148:149], v[148:149], v[192:193]
    v_pk_add_f32 v[150:151], v[150:151], v[192:193]
    v_pk_add_f32 v[152:153], v[152:153], v[192:193]
    v_pk_add_f32 v[154:155], v[154:155], v[192:193]
    v_pk_add_f32 v[156:157], v[156:157], v[192:193]
    v_pk_add_f32 v[158:159], v[158:159], v[192:193]
    v_pk_add_f32 v[160:161], v[160:161], v[192:193]
    v_pk_add_f32 v[162:163], v[162:163], v[192:193]
    v_pk_add_f32 v[164:165], v[164:165], v[192:193]
    v_pk_add_f32 v[166:167], v[166:167], v[192:193]
    v_pk_add_f32 v[168:169], v[168:169], v[192:193]
    v_pk_add_f32 v[170:171], v[170:171], v[192:193]
    v_pk_add_f32 v[172:173], v[172:173], v[192:193]
    v_pk_add_f32 v[174:175], v[174:175], v[192:193]
    v_pk_add_f32 v[176:177], v[176:177], v[192:193]
    v_pk_add_f32 v[178:179], v[178:179], v[192:193]
    v_pk_add_f32 v[180:181], v[180:181], v[192:193]
    v_pk_add_f32 v[182:183], v[182:183], v[192:193]
    v_pk_add_f32 v[184:185], v[184:185], v[192:193]
    v_pk_add_f32 v[186:187], v[186:187], v[192:193]
    v_pk_add_f32 v[188:189], v[188:189], v[192:193]
    v_pk_add_f32 v[190:191], v[190:191], v[192:193]
    v_pk_mul_f32 v[192:193], v[128:129], v[128:129]
    v_pk_mul_f32 v[194:195], v[130:131], v[130:131]
    v_pk_mul_f32 v[196:197], v[132:133], v[132:133]
    v_pk_mul_f32 v[198:199], v[134:135], v[134:135]
    v_pk_fma_f32 v[192:193], v[136:137], v[136:137], v[192:193]
    v_pk_fma_f32 v[194:195], v[138:139], v[138:139], v[194:195]
    v_pk_fma_f32 v[196:197], v[140:141], v[140:141], v[196:197]
    v_pk_fma_f32 v[198:199], v[142:143], v[142:143], v[198:199]
    v_pk_fma_f32 v[192:193], v[144:145], v[144:145], v[192:193]
    v_pk_fma_f32 v[194:195], v[146:147], v[146:147], v[194:195]
    v_pk_fma_f32 v[196:197], v[148:149], v[148:149], v[196:197]
    v_pk_fma_f32 v[198:199], v[150:151], v[150:151], v[198:199]
    v_pk_fma_f32 v[192:193], v[152:153], v[152:153], v[192:193]
    v_pk_fma_f32 v[194:195], v[154:155], v[154:155], v[194:195]
    v_pk_fma_f32 v[196:197], v[156:157], v[156:157], v[196:197]
    v_pk_fma_f32 v[198:199], v[158:159], v[158:159], v[198:199]
    v_pk_fma_f32 v[192:193], v[160:161], v[160:161], v[192:193]
    v_pk_fma_f32 v[194:195], v[162:163], v[162:163], v[194:195]
    v_pk_fma_f32 v[196:197], v[164:165], v[164:165], v[196:197]
    v_pk_fma_f32 v[198:199], v[166:167], v[166:167], v[198:199]
    v_pk_fma_f32 v[192:193], v[168:169], v[168:169], v[192:193]
    v_pk_fma_f32 v[194:195], v[170:171], v[170:171], v[194:195]
    v_pk_fma_f32 v[196:197], v[172:173], v[172:173], v[196:197]
    v_pk_fma_f32 v[198:199], v[174:175], v[174:175], v[198:199]
    v_pk_fma_f32 v[192:193], v[176:177], v[176:177], v[192:193]
    v_pk_fma_f32 v[194:195], v[178:179], v[178:179], v[194:195]
    v_pk_fma_f32 v[196:197], v[180:181], v[180:181], v[196:197]
    v_pk_fma_f32 v[198:199], v[182:183], v[182:183], v[198:199]
    v_pk_fma_f32 v[192:193], v[184:185], v[184:185], v[192:193]
    v_pk_fma_f32 v[194:195], v[186:187], v[186:187], v[194:195]
    v_pk_fma_f32 v[196:197], v[188:189], v[188:189], v[196:197]
    v_pk_fma_f32 v[198:199], v[190:191], v[190:191], v[198:199]
    v_pk_add_f32 v[192:193], v[192:193], v[194:195]
    v_pk_add_f32 v[196:197], v[196:197], v[198:199]
    v_pk_add_f32 v[192:193], v[192:193], v[196:197]
    v_add_f32 v192, v192, v193
    ds_write_b32 v253, v192 offset:1024
    s_waitcnt lgkmcnt(0)
    s_barrier
    ds_read_b128 v[192:195], v254 offset:1024
    ds_read_b128 v[196:199], v254 offset:1040
    ds_read_b128 v[200:203], v254 offset:1056
    ds_read_b128 v[204:207], v254 offset:1072
    s_waitcnt lgkmcnt(2)
    v_pk_add_f32 v[192:193], v[192:193], v[194:195]
    v_pk_add_f32 v[196:197], v[196:197], v[198:199]
    s_waitcnt lgkmcnt(0)
    v_pk_add_f32 v[200:201], v[200:201], v[202:203]
    v_pk_add_f32 v[204:205], v[204:205], v[206:207]
    v_pk_add_f32 v[192:193], v[192:193], v[196:197]
    v_pk_add_f32 v[200:201], v[200:201], v[204:205]
    v_pk_add_f32 v[192:193], v[192:193], v[200:201]
    v_add_f32 v192, v192, v193
    v_mov_b32 v193, 0x3727c5ac
    v_fmac_f32 v193, 0x3a800000, v192
    v_rsq_f32 v192, v193
    s_nop 0
    v_mov_b32 v193, v192
    v_pk_mul_f32 v[128:129], v[128:129], v[192:193]
    v_pk_mul_f32 v[130:131], v[130:131], v[192:193]
    v_pk_mul_f32 v[132:133], v[132:133], v[192:193]
    v_pk_mul_f32 v[134:135], v[134:135], v[192:193]
    v_pk_mul_f32 v[136:137], v[136:137], v[192:193]
    v_pk_mul_f32 v[138:139], v[138:139], v[192:193]
    v_pk_mul_f32 v[140:141], v[140:141], v[192:193]
    v_pk_mul_f32 v[142:143], v[142:143], v[192:193]
    v_pk_mul_f32 v[144:145], v[144:145], v[192:193]
    v_pk_mul_f32 v[146:147], v[146:147], v[192:193]
    v_pk_mul_f32 v[148:149], v[148:149], v[192:193]
    v_pk_mul_f32 v[150:151], v[150:151], v[192:193]
    v_pk_mul_f32 v[152:153], v[152:153], v[192:193]
    v_pk_mul_f32 v[154:155], v[154:155], v[192:193]
    v_pk_mul_f32 v[156:157], v[156:157], v[192:193]
    v_pk_mul_f32 v[158:159], v[158:159], v[192:193]
    v_pk_mul_f32 v[160:161], v[160:161], v[192:193]
    v_pk_mul_f32 v[162:163], v[162:163], v[192:193]
    v_pk_mul_f32 v[164:165], v[164:165], v[192:193]
    v_pk_mul_f32 v[166:167], v[166:167], v[192:193]
    v_pk_mul_f32 v[168:169], v[168:169], v[192:193]
    v_pk_mul_f32 v[170:171], v[170:171], v[192:193]
    v_pk_mul_f32 v[172:173], v[172:173], v[192:193]
    v_pk_mul_f32 v[174:175], v[174:175], v[192:193]
    v_pk_mul_f32 v[176:177], v[176:177], v[192:193]
    v_pk_mul_f32 v[178:179], v[178:179], v[192:193]
    v_pk_mul_f32 v[180:181], v[180:181], v[192:193]
    v_pk_mul_f32 v[182:183], v[182:183], v[192:193]
    v_pk_mul_f32 v[184:185], v[184:185], v[192:193]
    v_pk_mul_f32 v[186:187], v[186:187], v[192:193]
    v_pk_mul_f32 v[188:189], v[188:189], v[192:193]
    v_pk_mul_f32 v[190:191], v[190:191], v[192:193]
    v_cvt_pk_bf16_f32 v0, v128, v129
    v_cvt_pk_bf16_f32 v1, v130, v131
    v_cvt_pk_bf16_f32 v2, v132, v133
    v_cvt_pk_bf16_f32 v3, v134, v135
    v_cvt_pk_bf16_f32 v4, v136, v137
    v_cvt_pk_bf16_f32 v5, v138, v139
    v_cvt_pk_bf16_f32 v6, v140, v141
    v_cvt_pk_bf16_f32 v7, v142, v143
    v_cvt_pk_bf16_f32 v8, v144, v145
    v_cvt_pk_bf16_f32 v9, v146, v147
    v_cvt_pk_bf16_f32 v10, v148, v149
    v_cvt_pk_bf16_f32 v11, v150, v151
    v_cvt_pk_bf16_f32 v12, v152, v153
    v_cvt_pk_bf16_f32 v13, v154, v155
    v_cvt_pk_bf16_f32 v14, v156, v157
    v_cvt_pk_bf16_f32 v15, v158, v159
    v_cvt_pk_bf16_f32 v16, v160, v161
    v_cvt_pk_bf16_f32 v17, v162, v163
    v_cvt_pk_bf16_f32 v18, v164, v165
    v_cvt_pk_bf16_f32 v19, v166, v167
    v_cvt_pk_bf16_f32 v20, v168, v169
    v_cvt_pk_bf16_f32 v21, v170, v171
    v_cvt_pk_bf16_f32 v22, v172, v173
    v_cvt_pk_bf16_f32 v23, v174, v175
    v_cvt_pk_bf16_f32 v24, v176, v177
    v_cvt_pk_bf16_f32 v25, v178, v179
    v_cvt_pk_bf16_f32 v26, v180, v181
    v_cvt_pk_bf16_f32 v27, v182, v183
    v_cvt_pk_bf16_f32 v28, v184, v185
    v_cvt_pk_bf16_f32 v29, v186, v187
    v_cvt_pk_bf16_f32 v30, v188, v189
    v_cvt_pk_bf16_f32 v31, v190, v191
    buffer_store_dwordx4 v[0:3], v251, s[4:7], s21 offen offset:0 sc1
    buffer_store_dwordx4 v[4:7], v251, s[4:7], s21 offen offset:1024 sc1
    buffer_store_dwordx4 v[8:11], v251, s[4:7], s21 offen offset:2048 sc1
    buffer_store_dwordx4 v[12:15], v251, s[4:7], s21 offen offset:3072 sc1
    s_add_u32 s21, s21, 4096
    buffer_store_dwordx4 v[16:19], v251, s[4:7], s21 offen offset:0 sc1
    buffer_store_dwordx4 v[20:23], v251, s[4:7], s21 offen offset:1024 sc1
    buffer_store_dwordx4 v[24:27], v251, s[4:7], s21 offen offset:2048 sc1
    buffer_store_dwordx4 v[28:31], v251, s[4:7], s21 offen offset:3072 sc1
    s_add_u32 s21, s21, 28672
    s_waitcnt vmcnt(8)
    v_lshlrev_b32 v128, 16, v32
    v_and_b32 v129, 0xffff0000, v32
    v_lshlrev_b32 v130, 16, v33
    v_and_b32 v131, 0xffff0000, v33
    v_lshlrev_b32 v132, 16, v34
    v_and_b32 v133, 0xffff0000, v34
    v_lshlrev_b32 v134, 16, v35
    v_and_b32 v135, 0xffff0000, v35
    v_lshlrev_b32 v136, 16, v36
    v_and_b32 v137, 0xffff0000, v36
    v_lshlrev_b32 v138, 16, v37
    v_and_b32 v139, 0xffff0000, v37
    v_lshlrev_b32 v140, 16, v38
    v_and_b32 v141, 0xffff0000, v38
    v_lshlrev_b32 v142, 16, v39
    v_and_b32 v143, 0xffff0000, v39
    v_lshlrev_b32 v144, 16, v40
    v_and_b32 v145, 0xffff0000, v40
    v_lshlrev_b32 v146, 16, v41
    v_and_b32 v147, 0xffff0000, v41
    v_lshlrev_b32 v148, 16, v42
    v_and_b32 v149, 0xffff0000, v42
    v_lshlrev_b32 v150, 16, v43
    v_and_b32 v151, 0xffff0000, v43
    v_lshlrev_b32 v152, 16, v44
    v_and_b32 v153, 0xffff0000, v44
    v_lshlrev_b32 v154, 16, v45
    v_and_b32 v155, 0xffff0000, v45
    v_lshlrev_b32 v156, 16, v46
    v_and_b32 v157, 0xffff0000, v46
    v_lshlrev_b32 v158, 16, v47
    v_and_b32 v159, 0xffff0000, v47
    v_lshlrev_b32 v160, 16, v48
    v_and_b32 v161, 0xffff0000, v48
    v_lshlrev_b32 v162, 16, v49
    v_and_b32 v163, 0xffff0000, v49
    v_lshlrev_b32 v164, 16, v50
    v_and_b32 v165, 0xffff0000, v50
    v_lshlrev_b32 v166, 16, v51
    v_and_b32 v167, 0xffff0000, v51
    v_lshlrev_b32 v168, 16, v52
    v_and_b32 v169, 0xffff0000, v52
    v_lshlrev_b32 v170, 16, v53
    v_and_b32 v171, 0xffff0000, v53
    v_lshlrev_b32 v172, 16, v54
    v_and_b32 v173, 0xffff0000, v54
    v_lshlrev_b32 v174, 16, v55
    v_and_b32 v175, 0xffff0000, v55
    v_lshlrev_b32 v176, 16, v56
    v_and_b32 v177, 0xffff0000, v56
    v_lshlrev_b32 v178, 16, v57
    v_and_b32 v179, 0xffff0000, v57
    v_lshlrev_b32 v180, 16, v58
    v_and_b32 v181, 0xffff0000, v58
    v_lshlrev_b32 v182, 16, v59
    v_and_b32 v183, 0xffff0000, v59
    v_lshlrev_b32 v184, 16, v60
    v_and_b32 v185, 0xffff0000, v60
    v_lshlrev_b32 v186, 16, v61
    v_and_b32 v187, 0xffff0000, v61
    v_lshlrev_b32 v188, 16, v62
    v_and_b32 v189, 0xffff0000, v62
    v_lshlrev_b32 v190, 16, v63
    v_and_b32 v191, 0xffff0000, v63
    v_pk_add_f32 v[192:193], v[128:129], v[136:137]
    v_pk_add_f32 v[194:195], v[130:131], v[138:139]
    v_pk_add_f32 v[196:197], v[132:133], v[140:141]
    v_pk_add_f32 v[198:199], v[134:135], v[142:143]
    v_pk_add_f32 v[192:193], v[192:193], v[144:145]
    v_pk_add_f32 v[194:195], v[194:195], v[146:147]
    v_pk_add_f32 v[196:197], v[196:197], v[148:149]
    v_pk_add_f32 v[198:199], v[198:199], v[150:151]
    v_pk_add_f32 v[192:193], v[192:193], v[152:153]
    v_pk_add_f32 v[194:195], v[194:195], v[154:155]
    v_pk_add_f32 v[196:197], v[196:197], v[156:157]
    v_pk_add_f32 v[198:199], v[198:199], v[158:159]
    v_pk_add_f32 v[192:193], v[192:193], v[160:161]
    v_pk_add_f32 v[194:195], v[194:195], v[162:163]
    v_pk_add_f32 v[196:197], v[196:197], v[164:165]
    v_pk_add_f32 v[198:199], v[198:199], v[166:167]
    v_pk_add_f32 v[192:193], v[192:193], v[168:169]
    v_pk_add_f32 v[194:195], v[194:195], v[170:171]
    v_pk_add_f32 v[196:197], v[196:197], v[172:173]
    v_pk_add_f32 v[198:199], v[198:199], v[174:175]
    v_pk_add_f32 v[192:193], v[192:193], v[176:177]
    v_pk_add_f32 v[194:195], v[194:195], v[178:179]
    v_pk_add_f32 v[196:197], v[196:197], v[180:181]
    v_pk_add_f32 v[198:199], v[198:199], v[182:183]
    v_pk_add_f32 v[192:193], v[192:193], v[184:185]
    v_pk_add_f32 v[194:195], v[194:195], v[186:187]
    v_pk_add_f32 v[196:197], v[196:197], v[188:189]
    v_pk_add_f32 v[198:199], v[198:199], v[190:191]
    v_pk_add_f32 v[192:193], v[192:193], v[194:195]
    v_pk_add_f32 v[196:197], v[196:197], v[198:199]
    v_pk_add_f32 v[192:193], v[192:193], v[196:197]
    v_add_f32 v192, v192, v193
    ds_write_b32 v253, v192 offset:0
    s_waitcnt lgkmcnt(0)
    s_barrier
    ds_read_b128 v[192:195], v254 offset:0
    ds_read_b128 v[196:199], v254 offset:16
    ds_read_b128 v[200:203], v254 offset:32
    ds_read_b128 v[204:207], v254 offset:48
    s_waitcnt lgkmcnt(2)
    v_pk_add_f32 v[192:193], v[192:193], v[194:195]
    v_pk_add_f32 v[196:197], v[196:197], v[198:199]
    s_waitcnt lgkmcnt(0)
    v_pk_add_f32 v[200:201], v[200:201], v[202:203]
    v_pk_add_f32 v[204:205], v[204:205], v[206:207]
    v_pk_add_f32 v[192:193], v[192:193], v[196:197]
    v_pk_add_f32 v[200:201], v[200:201], v[204:205]
    v_pk_add_f32 v[192:193], v[192:193], v[200:201]
    v_add_f32 v192, v192, v193
    v_mul_f32 v192, 0xba800000, v192
    v_mov_b32 v193, v192
    v_pk_add_f32 v[128:129], v[128:129], v[192:193]
    v_pk_add_f32 v[130:131], v[130:131], v[192:193]
    v_pk_add_f32 v[132:133], v[132:133], v[192:193]
    v_pk_add_f32 v[134:135], v[134:135], v[192:193]
    v_pk_add_f32 v[136:137], v[136:137], v[192:193]
    v_pk_add_f32 v[138:139], v[138:139], v[192:193]
    v_pk_add_f32 v[140:141], v[140:141], v[192:193]
    v_pk_add_f32 v[142:143], v[142:143], v[192:193]
    v_pk_add_f32 v[144:145], v[144:145], v[192:193]
    v_pk_add_f32 v[146:147], v[146:147], v[192:193]
    v_pk_add_f32 v[148:149], v[148:149], v[192:193]
    v_pk_add_f32 v[150:151], v[150:151], v[192:193]
    v_pk_add_f32 v[152:153], v[152:153], v[192:193]
    v_pk_add_f32 v[154:155], v[154:155], v[192:193]
    v_pk_add_f32 v[156:157], v[156:157], v[192:193]
    v_pk_add_f32 v[158:159], v[158:159], v[192:193]
    v_pk_add_f32 v[160:161], v[160:161], v[192:193]
    v_pk_add_f32 v[162:163], v[162:163], v[192:193]
    v_pk_add_f32 v[164:165], v[164:165], v[192:193]
    v_pk_add_f32 v[166:167], v[166:167], v[192:193]
    v_pk_add_f32 v[168:169], v[168:169], v[192:193]
    v_pk_add_f32 v[170:171], v[170:171], v[192:193]
    v_pk_add_f32 v[172:173], v[172:173], v[192:193]
    v_pk_add_f32 v[174:175], v[174:175], v[192:193]
    v_pk_add_f32 v[176:177], v[176:177], v[192:193]
    v_pk_add_f32 v[178:179], v[178:179], v[192:193]
    v_pk_add_f32 v[180:181], v[180:181], v[192:193]
    v_pk_add_f32 v[182:183], v[182:183], v[192:193]
    v_pk_add_f32 v[184:185], v[184:185], v[192:193]
    v_pk_add_f32 v[186:187], v[186:187], v[192:193]
    v_pk_add_f32 v[188:189], v[188:189], v[192:193]
    v_pk_add_f32 v[190:191], v[190:191], v[192:193]
    v_pk_mul_f32 v[192:193], v[128:129], v[128:129]
    v_pk_mul_f32 v[194:195], v[130:131], v[130:131]
    v_pk_mul_f32 v[196:197], v[132:133], v[132:133]
    v_pk_mul_f32 v[198:199], v[134:135], v[134:135]
    v_pk_fma_f32 v[192:193], v[136:137], v[136:137], v[192:193]
    v_pk_fma_f32 v[194:195], v[138:139], v[138:139], v[194:195]
    v_pk_fma_f32 v[196:197], v[140:141], v[140:141], v[196:197]
    v_pk_fma_f32 v[198:199], v[142:143], v[142:143], v[198:199]
    v_pk_fma_f32 v[192:193], v[144:145], v[144:145], v[192:193]
    v_pk_fma_f32 v[194:195], v[146:147], v[146:147], v[194:195]
    v_pk_fma_f32 v[196:197], v[148:149], v[148:149], v[196:197]
    v_pk_fma_f32 v[198:199], v[150:151], v[150:151], v[198:199]
    v_pk_fma_f32 v[192:193], v[152:153], v[152:153], v[192:193]
    v_pk_fma_f32 v[194:195], v[154:155], v[154:155], v[194:195]
    v_pk_fma_f32 v[196:197], v[156:157], v[156:157], v[196:197]
    v_pk_fma_f32 v[198:199], v[158:159], v[158:159], v[198:199]
    v_pk_fma_f32 v[192:193], v[160:161], v[160:161], v[192:193]
    v_pk_fma_f32 v[194:195], v[162:163], v[162:163], v[194:195]
    v_pk_fma_f32 v[196:197], v[164:165], v[164:165], v[196:197]
    v_pk_fma_f32 v[198:199], v[166:167], v[166:167], v[198:199]
    v_pk_fma_f32 v[192:193], v[168:169], v[168:169], v[192:193]
    v_pk_fma_f32 v[194:195], v[170:171], v[170:171], v[194:195]
    v_pk_fma_f32 v[196:197], v[172:173], v[172:173], v[196:197]
    v_pk_fma_f32 v[198:199], v[174:175], v[174:175], v[198:199]
    v_pk_fma_f32 v[192:193], v[176:177], v[176:177], v[192:193]
    v_pk_fma_f32 v[194:195], v[178:179], v[178:179], v[194:195]
    v_pk_fma_f32 v[196:197], v[180:181], v[180:181], v[196:197]
    v_pk_fma_f32 v[198:199], v[182:183], v[182:183], v[198:199]
    v_pk_fma_f32 v[192:193], v[184:185], v[184:185], v[192:193]
    v_pk_fma_f32 v[194:195], v[186:187], v[186:187], v[194:195]
    v_pk_fma_f32 v[196:197], v[188:189], v[188:189], v[196:197]
    v_pk_fma_f32 v[198:199], v[190:191], v[190:191], v[198:199]
    v_pk_add_f32 v[192:193], v[192:193], v[194:195]
    v_pk_add_f32 v[196:197], v[196:197], v[198:199]
    v_pk_add_f32 v[192:193], v[192:193], v[196:197]
    v_add_f32 v192, v192, v193
    ds_write_b32 v253, v192 offset:1024
    s_waitcnt lgkmcnt(0)
    s_barrier
    ds_read_b128 v[192:195], v254 offset:1024
    ds_read_b128 v[196:199], v254 offset:1040
    ds_read_b128 v[200:203], v254 offset:1056
    ds_read_b128 v[204:207], v254 offset:1072
    s_waitcnt lgkmcnt(2)
    v_pk_add_f32 v[192:193], v[192:193], v[194:195]
    v_pk_add_f32 v[196:197], v[196:197], v[198:199]
    s_waitcnt lgkmcnt(0)
    v_pk_add_f32 v[200:201], v[200:201], v[202:203]
    v_pk_add_f32 v[204:205], v[204:205], v[206:207]
    v_pk_add_f32 v[192:193], v[192:193], v[196:197]
    v_pk_add_f32 v[200:201], v[200:201], v[204:205]
    v_pk_add_f32 v[192:193], v[192:193], v[200:201]
    v_add_f32 v192, v192, v193
    v_mov_b32 v193, 0x3727c5ac
    v_fmac_f32 v193, 0x3a800000, v192
    v_rsq_f32 v192, v193
    s_nop 0
    v_mov_b32 v193, v192
    v_pk_mul_f32 v[128:129], v[128:129], v[192:193]
    v_pk_mul_f32 v[130:131], v[130:131], v[192:193]
    v_pk_mul_f32 v[132:133], v[132:133], v[192:193]
    v_pk_mul_f32 v[134:135], v[134:135], v[192:193]
    v_pk_mul_f32 v[136:137], v[136:137], v[192:193]
    v_pk_mul_f32 v[138:139], v[138:139], v[192:193]
    v_pk_mul_f32 v[140:141], v[140:141], v[192:193]
    v_pk_mul_f32 v[142:143], v[142:143], v[192:193]
    v_pk_mul_f32 v[144:145], v[144:145], v[192:193]
    v_pk_mul_f32 v[146:147], v[146:147], v[192:193]
    v_pk_mul_f32 v[148:149], v[148:149], v[192:193]
    v_pk_mul_f32 v[150:151], v[150:151], v[192:193]
    v_pk_mul_f32 v[152:153], v[152:153], v[192:193]
    v_pk_mul_f32 v[154:155], v[154:155], v[192:193]
    v_pk_mul_f32 v[156:157], v[156:157], v[192:193]
    v_pk_mul_f32 v[158:159], v[158:159], v[192:193]
    v_pk_mul_f32 v[160:161], v[160:161], v[192:193]
    v_pk_mul_f32 v[162:163], v[162:163], v[192:193]
    v_pk_mul_f32 v[164:165], v[164:165], v[192:193]
    v_pk_mul_f32 v[166:167], v[166:167], v[192:193]
    v_pk_mul_f32 v[168:169], v[168:169], v[192:193]
    v_pk_mul_f32 v[170:171], v[170:171], v[192:193]
    v_pk_mul_f32 v[172:173], v[172:173], v[192:193]
    v_pk_mul_f32 v[174:175], v[174:175], v[192:193]
    v_pk_mul_f32 v[176:177], v[176:177], v[192:193]
    v_pk_mul_f32 v[178:179], v[178:179], v[192:193]
    v_pk_mul_f32 v[180:181], v[180:181], v[192:193]
    v_pk_mul_f32 v[182:183], v[182:183], v[192:193]
    v_pk_mul_f32 v[184:185], v[184:185], v[192:193]
    v_pk_mul_f32 v[186:187], v[186:187], v[192:193]
    v_pk_mul_f32 v[188:189], v[188:189], v[192:193]
    v_pk_mul_f32 v[190:191], v[190:191], v[192:193]
    v_cvt_pk_bf16_f32 v32, v128, v129
    v_cvt_pk_bf16_f32 v33, v130, v131
    v_cvt_pk_bf16_f32 v34, v132, v133
    v_cvt_pk_bf16_f32 v35, v134, v135
    v_cvt_pk_bf16_f32 v36, v136, v137
    v_cvt_pk_bf16_f32 v37, v138, v139
    v_cvt_pk_bf16_f32 v38, v140, v141
    v_cvt_pk_bf16_f32 v39, v142, v143
    v_cvt_pk_bf16_f32 v40, v144, v145
    v_cvt_pk_bf16_f32 v41, v146, v147
    v_cvt_pk_bf16_f32 v42, v148, v149
    v_cvt_pk_bf16_f32 v43, v150, v151
    v_cvt_pk_bf16_f32 v44, v152, v153
    v_cvt_pk_bf16_f32 v45, v154, v155
    v_cvt_pk_bf16_f32 v46, v156, v157
    v_cvt_pk_bf16_f32 v47, v158, v159
    v_cvt_pk_bf16_f32 v48, v160, v161
    v_cvt_pk_bf16_f32 v49, v162, v163
    v_cvt_pk_bf16_f32 v50, v164, v165
    v_cvt_pk_bf16_f32 v51, v166, v167
    v_cvt_pk_bf16_f32 v52, v168, v169
    v_cvt_pk_bf16_f32 v53, v170, v171
    v_cvt_pk_bf16_f32 v54, v172, v173
    v_cvt_pk_bf16_f32 v55, v174, v175
    v_cvt_pk_bf16_f32 v56, v176, v177
    v_cvt_pk_bf16_f32 v57, v178, v179
    v_cvt_pk_bf16_f32 v58, v180, v181
    v_cvt_pk_bf16_f32 v59, v182, v183
    v_cvt_pk_bf16_f32 v60, v184, v185
    v_cvt_pk_bf16_f32 v61, v186, v187
    v_cvt_pk_bf16_f32 v62, v188, v189
    v_cvt_pk_bf16_f32 v63, v190, v191
    buffer_store_dwordx4 v[32:35], v251, s[4:7], s21 offen offset:0 sc1
    buffer_store_dwordx4 v[36:39], v251, s[4:7], s21 offen offset:1024 sc1
    buffer_store_dwordx4 v[40:43], v251, s[4:7], s21 offen offset:2048 sc1
    buffer_store_dwordx4 v[44:47], v251, s[4:7], s21 offen offset:3072 sc1
    s_add_u32 s21, s21, 4096
    buffer_store_dwordx4 v[48:51], v251, s[4:7], s21 offen offset:0 sc1
    buffer_store_dwordx4 v[52:55], v251, s[4:7], s21 offen offset:1024 sc1
    buffer_store_dwordx4 v[56:59], v251, s[4:7], s21 offen offset:2048 sc1
    buffer_store_dwordx4 v[60:63], v251, s[4:7], s21 offen offset:3072 sc1
    s_add_u32 s21, s21, 28672
    s_mov_b32 s54, 0
main_kernel_w_done:
    s_cmp_eq_u32 s14, 0
    s_cbranch_scc1 main_kernel_w_dw0
    s_waitcnt vmcnt(0)
    s_barrier
    s_branch main_kernel_w_bar
main_kernel_w_dw0:
    s_add_u32 s32, s23, 1
    s_bitcmp0_b32 s32, 2
    s_cselect_b32 s34, 4, 9
    s_cselect_b32 s35, 8, 4
    s_lshl_b32 s32, s23, 13
    s_add_u32 s56, s32, 0x8404000
    v_lshrrev_b32 v253, 1, v250
    v_add_u32 v253, s24, v253
    v_lshlrev_b32 v253, s34, v253
    v_and_b32 v254, 1, v250
    v_add_u32 v254, s25, v254
    v_lshlrev_b32 v254, s35, v254
    v_add_u32 v249, v254, v253
    s_lshl_b32 s57, 1, s54
    s_mov_b32 s28, s55
    s_cmp_eq_u32 s55, -1
    s_cbranch_scc0 main_kernel_w_have
    s_branch main_kernel_w_try
.section .rodata,"a"
.p2align 6
.amdhsa_kernel main_kernel
  .amdhsa_next_free_vgpr 512
  .amdhsa_next_free_sgpr 102
  .amdhsa_accum_offset 256
  .amdhsa_group_segment_fixed_size 0
  .amdhsa_kernarg_size 120
  .amdhsa_user_sgpr_count 2
  .amdhsa_user_sgpr_kernarg_segment_ptr 1
  .amdhsa_system_sgpr_workgroup_id_x 1
.end_amdhsa_kernel
```

```asm
; @launch kernel=main_kernel grid=(256,1,1) block=(256,1,1) lds=163840
.amdgcn_target "amdgcn-amd-amdhsa--gfx950"
.text
.text
.globl main_kernel
.p2align 8
.type main_kernel,@function
main_kernel:
    s_load_dwordx4 s[20:23], s[0:1], 104
    s_load_dwordx8 s[40:47], s[0:1], 16
    s_load_dwordx8 s[64:71], s[0:1], 64
    s_load_dwordx2 s[72:73], s[0:1], 0
    s_load_dwordx2 s[74:75], s[0:1], 96
    s_load_dwordx2 s[76:77], s[0:1], 8
    s_cmp_ge_u32 s2, 256
    s_cbranch_scc1 main_kernel_end
    v_lshrrev_b32 v126, 6, v0
    v_and_b32 v94, 63, v0
    v_and_b32 v250, 63, v0
    v_readfirstlane_b32 s14, v126
    s_mov_b32 s29, 0x80000
    s_waitcnt lgkmcnt(0)
    s_mov_b32 s60, s20
    s_and_b32 s61, s21, 0xffff
    s_mov_b32 s62, 0x100
    s_mov_b32 s63, 0x20000
    s_mov_b32 s4, s22
    s_and_b32 s5, s23, 0xffff
    s_mov_b32 s6, 0x10000000
    s_mov_b32 s7, 0x20000
    s_cmp_lg_u32 s14, 0
    s_cbranch_scc1 main_kernel_slot_wait
    s_getreg_b32 s12, hwreg(HW_REG_XCC_ID, 0, 4)
    s_and_b32 s12, s12, 7
    s_lshl_b32 s32, s12, 5
    v_mov_b32 v126, 0
    v_mov_b32 v127, 1
    s_mov_b64 exec, 1
    buffer_atomic_add v127, v126, s[60:63], s32 offen sc0 sc1
    s_waitcnt vmcnt(0)
    s_mov_b64 exec, -1
    v_readfirstlane_b32 s13, v127
    s_nop 3
    s_cmp_lt_u32 s13, 32
    s_cbranch_scc1 main_kernel_slot_pub
    v_and_b32 v126, 7, v94
    v_lshlrev_b32 v126, 5, v126
main_kernel_ovf_cnt:
    buffer_load_dword v127, v126, s[60:63], 0 offen sc1
    s_waitcnt vmcnt(0)
    v_readlane_b32 s48, v127, 0
    v_readlane_b32 s49, v127, 1
    v_readlane_b32 s50, v127, 2
    v_readlane_b32 s51, v127, 3
    v_readlane_b32 s52, v127, 4
    v_readlane_b32 s53, v127, 5
    v_readlane_b32 s54, v127, 6
    v_readlane_b32 s55, v127, 7
    s_nop 3
    s_add_u32 s33, s48, s49
    s_add_u32 s33, s33, s50
    s_add_u32 s33, s33, s51
    s_add_u32 s33, s33, s52
    s_add_u32 s33, s33, s53
    s_add_u32 s33, s33, s54
    s_add_u32 s33, s33, s55
    s_cmp_ge_u32 s33, 256
    s_cbranch_scc1 main_kernel_ovf_cnt_ok
    s_sub_u32 s29, s29, 1
    s_cbranch_scc1 main_kernel_end
    s_sleep 4
    s_branch main_kernel_ovf_cnt
main_kernel_ovf_cnt_ok:
    v_mov_b32 v126, 0
    v_mov_b32 v127, 1
    s_mov_b64 exec, 1
    buffer_atomic_add v127, v126, s[60:63], 0 offen offset:8 sc0 sc1
    s_waitcnt vmcnt(0)
    s_mov_b64 exec, -1
    v_readfirstlane_b32 s33, v127
    s_nop 3
    s_min_u32 s34, s48, 32
    s_sub_u32 s35, 32, s34
    s_mov_b32 s12, 0
    s_add_u32 s13, s34, s33
    s_cmp_lt_u32 s33, s35
    s_cbranch_scc1 main_kernel_slot_pub
    s_sub_u32 s33, s33, s35
    s_min_u32 s34, s49, 32
    s_sub_u32 s35, 32, s34
    s_mov_b32 s12, 1
    s_add_u32 s13, s34, s33
    s_cmp_lt_u32 s33, s35
    s_cbranch_scc1 main_kernel_slot_pub
    s_sub_u32 s33, s33, s35
    s_min_u32 s34, s50, 32
    s_sub_u32 s35, 32, s34
    s_mov_b32 s12, 2
    s_add_u32 s13, s34, s33
    s_cmp_lt_u32 s33, s35
    s_cbranch_scc1 main_kernel_slot_pub
    s_sub_u32 s33, s33, s35
    s_min_u32 s34, s51, 32
    s_sub_u32 s35, 32, s34
    s_mov_b32 s12, 3
    s_add_u32 s13, s34, s33
    s_cmp_lt_u32 s33, s35
    s_cbranch_scc1 main_kernel_slot_pub
    s_sub_u32 s33, s33, s35
    s_min_u32 s34, s52, 32
    s_sub_u32 s35, 32, s34
    s_mov_b32 s12, 4
    s_add_u32 s13, s34, s33
    s_cmp_lt_u32 s33, s35
    s_cbranch_scc1 main_kernel_slot_pub
    s_sub_u32 s33, s33, s35
    s_min_u32 s34, s53, 32
    s_sub_u32 s35, 32, s34
    s_mov_b32 s12, 5
    s_add_u32 s13, s34, s33
    s_cmp_lt_u32 s33, s35
    s_cbranch_scc1 main_kernel_slot_pub
    s_sub_u32 s33, s33, s35
    s_min_u32 s34, s54, 32
    s_sub_u32 s35, 32, s34
    s_mov_b32 s12, 6
    s_add_u32 s13, s34, s33
    s_cmp_lt_u32 s33, s35
    s_cbranch_scc1 main_kernel_slot_pub
    s_sub_u32 s33, s33, s35
    s_min_u32 s34, s55, 32
    s_sub_u32 s35, 32, s34
    s_mov_b32 s12, 7
    s_add_u32 s13, s34, s33
    s_cmp_lt_u32 s33, s35
    s_cbranch_scc1 main_kernel_slot_pub
    s_sub_u32 s33, s33, s35
    s_mov_b32 s12, 8
    s_mov_b32 s13, 0
main_kernel_slot_pub:
    v_mov_b32 v126, 0
    v_mov_b32 v127, s12
    v_mov_b32 v95, s13
    ds_write_b32 v126, v127
    ds_write_b32 v126, v95 offset:4
    s_waitcnt lgkmcnt(0)
main_kernel_slot_wait:
    s_barrier
    v_mov_b32 v126, 0
    ds_read_b32 v127, v126
    ds_read_b32 v95, v126 offset:4
    s_waitcnt lgkmcnt(0)
    v_readfirstlane_b32 s12, v127
    v_readfirstlane_b32 s13, v95
    s_nop 3
    s_barrier
    s_cmp_ge_u32 s12, 8
    s_cbranch_scc1 main_kernel_end
    s_cmp_lt_u32 s12, 2
    s_cbranch_scc1 main_kernel_chain
    s_mov_b32 s96, s72
    s_and_b32 s97, s73, 0xffff
    s_mov_b32 s98, 0x400000
    s_mov_b32 s99, 0x20000
    s_mov_b32 s92, s74
    s_and_b32 s93, s75, 0xffff
    s_mov_b32 s94, 0x400000
    s_mov_b32 s95, 0x20000
    v_lshlrev_b32 v1, 4, v0
    v_lshlrev_b32 v251, 4, v250
    v_mov_b32 v4, 0
    v_mov_b32 v8, -1
    v_mov_b32 v5, 0
    v_mov_b32 v9, -1
    v_mov_b32 v6, 0
    v_mov_b32 v10, -1
    v_mov_b32 v7, 0
    v_mov_b32 v11, -1
    v_mul_u32_u24 v12, 128, v0
    s_lshl_b32 s15, s12, 4
    s_and_b32 s32, s12, 1
    s_lshl_b32 s32, s32, 5
    s_cmp_lt_u32 s12, 4
    s_cselect_b32 s15, s32, s15
    s_cselect_b32 s32, 32, 16
    s_add_u32 s15, s15, s13
    s_sub_u32 s16, s15, 80
    s_sub_u32 s27, s12, 2
    s_mov_b32 s52, 0
    s_cmp_lt_u32 s13, s32
    s_cbranch_scc1 main_kernel_s_ln
    s_cmp_lg_u32 s13, 16
    s_cbranch_scc1 main_kernel_s_fill
    s_lshl_b32 s32, s16, 11
    s_add_u32 s32, s32, 0x8400000
    buffer_store_dwordx4 v[4:7], v1, s[4:7], s32 offen sc1
    s_add_u32 s32, s32, 4096
    buffer_store_dwordx4 v[4:7], v1, s[4:7], s32 offen sc1
    s_add_u32 s32, s32, 4096
    buffer_store_dwordx4 v[4:7], v1, s[4:7], s32 offen sc1
    s_add_u32 s32, s32, 4096
    buffer_store_dwordx4 v[4:7], v1, s[4:7], s32 offen sc1
    s_add_u32 s32, s32, 4096
    buffer_store_dwordx4 v[4:7], v1, s[4:7], s32 offen sc1
    s_add_u32 s32, s32, 4096
    buffer_store_dwordx4 v[4:7], v1, s[4:7], s32 offen sc1
    s_add_u32 s32, s32, 4096
    buffer_store_dwordx4 v[4:7], v1, s[4:7], s32 offen sc1
    s_add_u32 s32, s32, 4096
    buffer_store_dwordx4 v[4:7], v1, s[4:7], s32 offen sc1
    s_add_u32 s32, s32, 4096
    v_bfe_u32 v2, v0, 2, 1
    s_lshr_b32 s32, s14, 1
    v_and_b32 v2, s32, v2
    s_bitcmp1_b32 s14, 0
    s_cselect_b32 s32, 15, 0
    s_cselect_b32 s33, 4161536, 0
    v_xor_b32 v2, s32, v2
    v_lshlrev_b32 v2, 4, v2
    v_and_b32 v3, 3, v0
    v_lshl_add_u32 v2, v3, 8, v2
    v_lshrrev_b32 v3, 3, v0
    v_lshl_add_u32 v2, v3, 10, v2
    s_add_u32 s33, s33, 0x4808000
    buffer_store_dwordx4 v[4:7], v2, s[4:7], s33 offen sc1
    s_waitcnt vmcnt(0)
    s_barrier
    s_cmp_lg_u32 s14, 0
    s_cbranch_scc1 main_kernel_s_fill
    v_mov_b32 v2, 1
    s_mov_b64 exec, 1
    buffer_atomic_add v2, v4, s[60:63], 0 offen offset:12 sc1
    s_mov_b64 exec, -1
    s_branch main_kernel_s_fill
main_kernel_s_ln:
    v_and_b32 v3, 15, v250
    v_and_b32 v2, 48, v250
    v_lshl_add_u32 v3, v3, 11, v2
    s_lshl_b32 s34, s15, 15
    s_lshl_b32 s32, s14, 9
    s_add_u32 s32, s34, s32
    buffer_load_dwordx4 v[32:35], v3, s[96:99], s32 offen offset:0
    buffer_load_dwordx4 v[36:39], v3, s[96:99], s32 offen offset:64
    buffer_load_dwordx4 v[40:43], v3, s[96:99], s32 offen offset:128
    buffer_load_dwordx4 v[44:47], v3, s[96:99], s32 offen offset:192
    buffer_load_dwordx4 v[48:51], v3, s[96:99], s32 offen offset:256
    buffer_load_dwordx4 v[52:55], v3, s[96:99], s32 offen offset:320
    buffer_load_dwordx4 v[56:59], v3, s[96:99], s32 offen offset:384
    buffer_load_dwordx4 v[60:63], v3, s[96:99], s32 offen offset:448
    v_and_b32 v255, 15, v250
    v_lshlrev_b32 v254, 6, v255
    v_add_u32 v254, 132096, v254
    v_lshrrev_b32 v255, 4, v250
    v_lshl_add_u32 v253, v255, 2, v254
    v_lshl_add_u32 v253, s14, 4, v253
    s_lshl_b32 s32, s14, 13
    s_add_u32 s34, s34, s32
    s_waitcnt vmcnt(0)
    v_permlane16_swap_b32 v32, v34
    v_permlane16_swap_b32 v33, v35
    v_permlane16_swap_b32 v36, v38
    v_permlane16_swap_b32 v37, v39
    v_permlane16_swap_b32 v40, v42
    v_permlane16_swap_b32 v41, v43
    v_permlane16_swap_b32 v44, v46
    v_permlane16_swap_b32 v45, v47
    v_permlane16_swap_b32 v48, v50
    v_permlane16_swap_b32 v49, v51
    v_permlane16_swap_b32 v52, v54
    v_permlane16_swap_b32 v53, v55
    v_permlane16_swap_b32 v56, v58
    v_permlane16_swap_b32 v57, v59
    v_permlane16_swap_b32 v60, v62
    v_permlane16_swap_b32 v61, v63
    v_permlane32_swap_b32 v32, v34
    v_permlane32_swap_b32 v33, v35
    v_permlane32_swap_b32 v36, v38
    v_permlane32_swap_b32 v37, v39
    v_permlane32_swap_b32 v40, v42
    v_permlane32_swap_b32 v41, v43
    v_permlane32_swap_b32 v44, v46
    v_permlane32_swap_b32 v45, v47
    v_permlane32_swap_b32 v48, v50
    v_permlane32_swap_b32 v49, v51
    v_permlane32_swap_b32 v52, v54
    v_permlane32_swap_b32 v53, v55
    v_permlane32_swap_b32 v56, v58
    v_permlane32_swap_b32 v57, v59
    v_permlane32_swap_b32 v60, v62
    v_permlane32_swap_b32 v61, v63
    s_lshr_b32 s32, s15, 3
    s_lshl_b32 s32, s32, 9
    s_and_b32 s33, s15, 7
    s_lshl_b32 s33, s33, 4
    s_add_u32 s32, s32, s33
    s_add_u32 s16, s32, 0x8416000
    v_lshlrev_b32 v64, 16, v32
    v_and_b32 v65, 0xffff0000, v32
    v_lshlrev_b32 v66, 16, v33
    v_and_b32 v67, 0xffff0000, v33
    v_lshlrev_b32 v68, 16, v34
    v_and_b32 v69, 0xffff0000, v34
    v_lshlrev_b32 v70, 16, v35
    v_and_b32 v71, 0xffff0000, v35
    v_lshlrev_b32 v72, 16, v36
    v_and_b32 v73, 0xffff0000, v36
    v_lshlrev_b32 v74, 16, v37
    v_and_b32 v75, 0xffff0000, v37
    v_lshlrev_b32 v76, 16, v38
    v_and_b32 v77, 0xffff0000, v38
    v_lshlrev_b32 v78, 16, v39
    v_and_b32 v79, 0xffff0000, v39
    v_lshlrev_b32 v80, 16, v40
    v_and_b32 v81, 0xffff0000, v40
    v_lshlrev_b32 v82, 16, v41
    v_and_b32 v83, 0xffff0000, v41
    v_lshlrev_b32 v84, 16, v42
    v_and_b32 v85, 0xffff0000, v42
    v_lshlrev_b32 v86, 16, v43
    v_and_b32 v87, 0xffff0000, v43
    v_lshlrev_b32 v88, 16, v44
    v_and_b32 v89, 0xffff0000, v44
    v_lshlrev_b32 v90, 16, v45
    v_and_b32 v91, 0xffff0000, v45
    v_lshlrev_b32 v92, 16, v46
    v_and_b32 v93, 0xffff0000, v46
    v_lshlrev_b32 v94, 16, v47
    v_and_b32 v95, 0xffff0000, v47
    v_lshlrev_b32 v96, 16, v48
    v_and_b32 v97, 0xffff0000, v48
    v_lshlrev_b32 v98, 16, v49
    v_and_b32 v99, 0xffff0000, v49
    v_lshlrev_b32 v100, 16, v50
    v_and_b32 v101, 0xffff0000, v50
    v_lshlrev_b32 v102, 16, v51
    v_and_b32 v103, 0xffff0000, v51
    v_lshlrev_b32 v104, 16, v52
    v_and_b32 v105, 0xffff0000, v52
    v_lshlrev_b32 v106, 16, v53
    v_and_b32 v107, 0xffff0000, v53
    v_lshlrev_b32 v108, 16, v54
    v_and_b32 v109, 0xffff0000, v54
    v_lshlrev_b32 v110, 16, v55
    v_and_b32 v111, 0xffff0000, v55
    v_lshlrev_b32 v112, 16, v56
    v_and_b32 v113, 0xffff0000, v56
    v_lshlrev_b32 v114, 16, v57
    v_and_b32 v115, 0xffff0000, v57
    v_lshlrev_b32 v116, 16, v58
    v_and_b32 v117, 0xffff0000, v58
    v_lshlrev_b32 v118, 16, v59
    v_and_b32 v119, 0xffff0000, v59
    v_lshlrev_b32 v120, 16, v60
    v_and_b32 v121, 0xffff0000, v60
    v_lshlrev_b32 v122, 16, v61
    v_and_b32 v123, 0xffff0000, v61
    v_lshlrev_b32 v124, 16, v62
    v_and_b32 v125, 0xffff0000, v62
    v_lshlrev_b32 v126, 16, v63
    v_and_b32 v127, 0xffff0000, v63
    v_pk_add_f32 v[16:17], v[64:65], v[72:73]
    v_pk_add_f32 v[18:19], v[66:67], v[74:75]
    v_pk_add_f32 v[20:21], v[68:69], v[76:77]
    v_pk_add_f32 v[22:23], v[70:71], v[78:79]
    v_pk_add_f32 v[16:17], v[16:17], v[80:81]
    v_pk_add_f32 v[18:19], v[18:19], v[82:83]
    v_pk_add_f32 v[20:21], v[20:21], v[84:85]
    v_pk_add_f32 v[22:23], v[22:23], v[86:87]
    v_pk_add_f32 v[16:17], v[16:17], v[88:89]
    v_pk_add_f32 v[18:19], v[18:19], v[90:91]
    v_pk_add_f32 v[20:21], v[20:21], v[92:93]
    v_pk_add_f32 v[22:23], v[22:23], v[94:95]
    v_pk_add_f32 v[16:17], v[16:17], v[96:97]
    v_pk_add_f32 v[18:19], v[18:19], v[98:99]
    v_pk_add_f32 v[20:21], v[20:21], v[100:101]
    v_pk_add_f32 v[22:23], v[22:23], v[102:103]
    v_pk_add_f32 v[16:17], v[16:17], v[104:105]
    v_pk_add_f32 v[18:19], v[18:19], v[106:107]
    v_pk_add_f32 v[20:21], v[20:21], v[108:109]
    v_pk_add_f32 v[22:23], v[22:23], v[110:111]
    v_pk_add_f32 v[16:17], v[16:17], v[112:113]
    v_pk_add_f32 v[18:19], v[18:19], v[114:115]
    v_pk_add_f32 v[20:21], v[20:21], v[116:117]
    v_pk_add_f32 v[22:23], v[22:23], v[118:119]
    v_pk_add_f32 v[16:17], v[16:17], v[120:121]
    v_pk_add_f32 v[18:19], v[18:19], v[122:123]
    v_pk_add_f32 v[20:21], v[20:21], v[124:125]
    v_pk_add_f32 v[22:23], v[22:23], v[126:127]
    v_pk_add_f32 v[16:17], v[16:17], v[18:19]
    v_pk_add_f32 v[20:21], v[20:21], v[22:23]
    v_pk_add_f32 v[16:17], v[16:17], v[20:21]
    v_add_f32 v16, v16, v17
    ds_write_b32 v253, v16 offset:0
    s_waitcnt lgkmcnt(0)
    s_barrier
    ds_read_b128 v[16:19], v254 offset:0
    ds_read_b128 v[20:23], v254 offset:16
    ds_read_b128 v[24:27], v254 offset:32
    ds_read_b128 v[28:31], v254 offset:48
    s_waitcnt lgkmcnt(2)
    v_pk_add_f32 v[16:17], v[16:17], v[18:19]
    v_pk_add_f32 v[20:21], v[20:21], v[22:23]
    s_waitcnt lgkmcnt(0)
    v_pk_add_f32 v[24:25], v[24:25], v[26:27]
    v_pk_add_f32 v[28:29], v[28:29], v[30:31]
    v_pk_add_f32 v[16:17], v[16:17], v[20:21]
    v_pk_add_f32 v[24:25], v[24:25], v[28:29]
    v_pk_add_f32 v[16:17], v[16:17], v[24:25]
    v_add_f32 v16, v16, v17
    v_mul_f32 v16, 0xba800000, v16
    v_mov_b32 v17, v16
    v_pk_add_f32 v[64:65], v[64:65], v[16:17]
    v_pk_add_f32 v[66:67], v[66:67], v[16:17]
    v_pk_add_f32 v[68:69], v[68:69], v[16:17]
    v_pk_add_f32 v[70:71], v[70:71], v[16:17]
    v_pk_add_f32 v[72:73], v[72:73], v[16:17]
    v_pk_add_f32 v[74:75], v[74:75], v[16:17]
    v_pk_add_f32 v[76:77], v[76:77], v[16:17]
    v_pk_add_f32 v[78:79], v[78:79], v[16:17]
    v_pk_add_f32 v[80:81], v[80:81], v[16:17]
    v_pk_add_f32 v[82:83], v[82:83], v[16:17]
    v_pk_add_f32 v[84:85], v[84:85], v[16:17]
    v_pk_add_f32 v[86:87], v[86:87], v[16:17]
    v_pk_add_f32 v[88:89], v[88:89], v[16:17]
    v_pk_add_f32 v[90:91], v[90:91], v[16:17]
    v_pk_add_f32 v[92:93], v[92:93], v[16:17]
    v_pk_add_f32 v[94:95], v[94:95], v[16:17]
    v_pk_add_f32 v[96:97], v[96:97], v[16:17]
    v_pk_add_f32 v[98:99], v[98:99], v[16:17]
    v_pk_add_f32 v[100:101], v[100:101], v[16:17]
    v_pk_add_f32 v[102:103], v[102:103], v[16:17]
    v_pk_add_f32 v[104:105], v[104:105], v[16:17]
    v_pk_add_f32 v[106:107], v[106:107], v[16:17]
    v_pk_add_f32 v[108:109], v[108:109], v[16:17]
    v_pk_add_f32 v[110:111], v[110:111], v[16:17]
    v_pk_add_f32 v[112:113], v[112:113], v[16:17]
    v_pk_add_f32 v[114:115], v[114:115], v[16:17]
    v_pk_add_f32 v[116:117], v[116:117], v[16:17]
    v_pk_add_f32 v[118:119], v[118:119], v[16:17]
    v_pk_add_f32 v[120:121], v[120:121], v[16:17]
    v_pk_add_f32 v[122:123], v[122:123], v[16:17]
    v_pk_add_f32 v[124:125], v[124:125], v[16:17]
    v_pk_add_f32 v[126:127], v[126:127], v[16:17]
    v_pk_mul_f32 v[16:17], v[64:65], v[64:65]
    v_pk_mul_f32 v[18:19], v[66:67], v[66:67]
    v_pk_mul_f32 v[20:21], v[68:69], v[68:69]
    v_pk_mul_f32 v[22:23], v[70:71], v[70:71]
    v_pk_fma_f32 v[16:17], v[72:73], v[72:73], v[16:17]
    v_pk_fma_f32 v[18:19], v[74:75], v[74:75], v[18:19]
    v_pk_fma_f32 v[20:21], v[76:77], v[76:77], v[20:21]
    v_pk_fma_f32 v[22:23], v[78:79], v[78:79], v[22:23]
    v_pk_fma_f32 v[16:17], v[80:81], v[80:81], v[16:17]
    v_pk_fma_f32 v[18:19], v[82:83], v[82:83], v[18:19]
    v_pk_fma_f32 v[20:21], v[84:85], v[84:85], v[20:21]
    v_pk_fma_f32 v[22:23], v[86:87], v[86:87], v[22:23]
    v_pk_fma_f32 v[16:17], v[88:89], v[88:89], v[16:17]
    v_pk_fma_f32 v[18:19], v[90:91], v[90:91], v[18:19]
    v_pk_fma_f32 v[20:21], v[92:93], v[92:93], v[20:21]
    v_pk_fma_f32 v[22:23], v[94:95], v[94:95], v[22:23]
    v_pk_fma_f32 v[16:17], v[96:97], v[96:97], v[16:17]
    v_pk_fma_f32 v[18:19], v[98:99], v[98:99], v[18:19]
    v_pk_fma_f32 v[20:21], v[100:101], v[100:101], v[20:21]
    v_pk_fma_f32 v[22:23], v[102:103], v[102:103], v[22:23]
    v_pk_fma_f32 v[16:17], v[104:105], v[104:105], v[16:17]
    v_pk_fma_f32 v[18:19], v[106:107], v[106:107], v[18:19]
    v_pk_fma_f32 v[20:21], v[108:109], v[108:109], v[20:21]
    v_pk_fma_f32 v[22:23], v[110:111], v[110:111], v[22:23]
    v_pk_fma_f32 v[16:17], v[112:113], v[112:113], v[16:17]
    v_pk_fma_f32 v[18:19], v[114:115], v[114:115], v[18:19]
    v_pk_fma_f32 v[20:21], v[116:117], v[116:117], v[20:21]
    v_pk_fma_f32 v[22:23], v[118:119], v[118:119], v[22:23]
    v_pk_fma_f32 v[16:17], v[120:121], v[120:121], v[16:17]
    v_pk_fma_f32 v[18:19], v[122:123], v[122:123], v[18:19]
    v_pk_fma_f32 v[20:21], v[124:125], v[124:125], v[20:21]
    v_pk_fma_f32 v[22:23], v[126:127], v[126:127], v[22:23]
    v_pk_add_f32 v[16:17], v[16:17], v[18:19]
    v_pk_add_f32 v[20:21], v[20:21], v[22:23]
    v_pk_add_f32 v[16:17], v[16:17], v[20:21]
    v_add_f32 v16, v16, v17
    ds_write_b32 v253, v16 offset:1024
    s_waitcnt lgkmcnt(0)
    s_barrier
    ds_read_b128 v[16:19], v254 offset:1024
    ds_read_b128 v[20:23], v254 offset:1040
    ds_read_b128 v[24:27], v254 offset:1056
    ds_read_b128 v[28:31], v254 offset:1072
    s_waitcnt lgkmcnt(2)
    v_pk_add_f32 v[16:17], v[16:17], v[18:19]
    v_pk_add_f32 v[20:21], v[20:21], v[22:23]
    s_waitcnt lgkmcnt(0)
    v_pk_add_f32 v[24:25], v[24:25], v[26:27]
    v_pk_add_f32 v[28:29], v[28:29], v[30:31]
    v_pk_add_f32 v[16:17], v[16:17], v[20:21]
    v_pk_add_f32 v[24:25], v[24:25], v[28:29]
    v_pk_add_f32 v[16:17], v[16:17], v[24:25]
    v_add_f32 v16, v16, v17
    v_mov_b32 v17, 0x3727c5ac
    v_fmac_f32 v17, 0x3a800000, v16
    v_rsq_f32 v16, v17
    s_nop 0
    v_mov_b32 v17, v16
    v_pk_mul_f32 v[64:65], v[64:65], v[16:17]
    v_pk_mul_f32 v[66:67], v[66:67], v[16:17]
    v_pk_mul_f32 v[68:69], v[68:69], v[16:17]
    v_pk_mul_f32 v[70:71], v[70:71], v[16:17]
    v_pk_mul_f32 v[72:73], v[72:73], v[16:17]
    v_pk_mul_f32 v[74:75], v[74:75], v[16:17]
    v_pk_mul_f32 v[76:77], v[76:77], v[16:17]
    v_pk_mul_f32 v[78:79], v[78:79], v[16:17]
    v_pk_mul_f32 v[80:81], v[80:81], v[16:17]
    v_pk_mul_f32 v[82:83], v[82:83], v[16:17]
    v_pk_mul_f32 v[84:85], v[84:85], v[16:17]
    v_pk_mul_f32 v[86:87], v[86:87], v[16:17]
    v_pk_mul_f32 v[88:89], v[88:89], v[16:17]
    v_pk_mul_f32 v[90:91], v[90:91], v[16:17]
    v_pk_mul_f32 v[92:93], v[92:93], v[16:17]
    v_pk_mul_f32 v[94:95], v[94:95], v[16:17]
    v_pk_mul_f32 v[96:97], v[96:97], v[16:17]
    v_pk_mul_f32 v[98:99], v[98:99], v[16:17]
    v_pk_mul_f32 v[100:101], v[100:101], v[16:17]
    v_pk_mul_f32 v[102:103], v[102:103], v[16:17]
    v_pk_mul_f32 v[104:105], v[104:105], v[16:17]
    v_pk_mul_f32 v[106:107], v[106:107], v[16:17]
    v_pk_mul_f32 v[108:109], v[108:109], v[16:17]
    v_pk_mul_f32 v[110:111], v[110:111], v[16:17]
    v_pk_mul_f32 v[112:113], v[112:113], v[16:17]
    v_pk_mul_f32 v[114:115], v[114:115], v[16:17]
    v_pk_mul_f32 v[116:117], v[116:117], v[16:17]
    v_pk_mul_f32 v[118:119], v[118:119], v[16:17]
    v_pk_mul_f32 v[120:121], v[120:121], v[16:17]
    v_pk_mul_f32 v[122:123], v[122:123], v[16:17]
    v_pk_mul_f32 v[124:125], v[124:125], v[16:17]
    v_pk_mul_f32 v[126:127], v[126:127], v[16:17]
    v_cvt_pk_bf16_f32 v128, v64, v65
    v_cvt_pk_bf16_f32 v129, v66, v67
    v_cvt_pk_bf16_f32 v130, v68, v69
    v_cvt_pk_bf16_f32 v131, v70, v71
    v_cvt_pk_bf16_f32 v132, v72, v73
    v_cvt_pk_bf16_f32 v133, v74, v75
    v_cvt_pk_bf16_f32 v134, v76, v77
    v_cvt_pk_bf16_f32 v135, v78, v79
    v_cvt_pk_bf16_f32 v136, v80, v81
    v_cvt_pk_bf16_f32 v137, v82, v83
    v_cvt_pk_bf16_f32 v138, v84, v85
    v_cvt_pk_bf16_f32 v139, v86, v87
    v_cvt_pk_bf16_f32 v140, v88, v89
    v_cvt_pk_bf16_f32 v141, v90, v91
    v_cvt_pk_bf16_f32 v142, v92, v93
    v_cvt_pk_bf16_f32 v143, v94, v95
    v_cvt_pk_bf16_f32 v144, v96, v97
    v_cvt_pk_bf16_f32 v145, v98, v99
    v_cvt_pk_bf16_f32 v146, v100, v101
    v_cvt_pk_bf16_f32 v147, v102, v103
    v_cvt_pk_bf16_f32 v148, v104, v105
    v_cvt_pk_bf16_f32 v149, v106, v107
    v_cvt_pk_bf16_f32 v150, v108, v109
    v_cvt_pk_bf16_f32 v151, v110, v111
    v_cvt_pk_bf16_f32 v152, v112, v113
    v_cvt_pk_bf16_f32 v153, v114, v115
    v_cvt_pk_bf16_f32 v154, v116, v117
    v_cvt_pk_bf16_f32 v155, v118, v119
    v_cvt_pk_bf16_f32 v156, v120, v121
    v_cvt_pk_bf16_f32 v157, v122, v123
    v_cvt_pk_bf16_f32 v158, v124, v125
    v_cvt_pk_bf16_f32 v159, v126, v127
    s_add_u32 s32, s34, 0x0
    s_add_u32 s33, s32, 4096
    buffer_store_dwordx4 v[128:131], v251, s[4:7], s32 offen offset:0 sc1
    buffer_store_dwordx4 v[132:135], v251, s[4:7], s32 offen offset:1024 sc1
    buffer_store_dwordx4 v[136:139], v251, s[4:7], s32 offen offset:2048 sc1
    buffer_store_dwordx4 v[140:143], v251, s[4:7], s32 offen offset:3072 sc1
    buffer_store_dwordx4 v[144:147], v251, s[4:7], s33 offen offset:0 sc1
    buffer_store_dwordx4 v[148:151], v251, s[4:7], s33 offen offset:1024 sc1
    buffer_store_dwordx4 v[152:155], v251, s[4:7], s33 offen offset:2048 sc1
    buffer_store_dwordx4 v[156:159], v251, s[4:7], s33 offen offset:3072 sc1
    buffer_load_dword v2, v4, s[60:63], 0 offen offset:12 sc1
    v_lshlrev_b32 v64, 16, v128
    v_and_b32 v65, 0xffff0000, v128
    v_lshlrev_b32 v66, 16, v129
    v_and_b32 v67, 0xffff0000, v129
    v_lshlrev_b32 v68, 16, v130
    v_and_b32 v69, 0xffff0000, v130
    v_lshlrev_b32 v70, 16, v131
    v_and_b32 v71, 0xffff0000, v131
    v_lshlrev_b32 v72, 16, v132
    v_and_b32 v73, 0xffff0000, v132
    v_lshlrev_b32 v74, 16, v133
    v_and_b32 v75, 0xffff0000, v133
    v_lshlrev_b32 v76, 16, v134
    v_and_b32 v77, 0xffff0000, v134
    v_lshlrev_b32 v78, 16, v135
    v_and_b32 v79, 0xffff0000, v135
    v_lshlrev_b32 v80, 16, v136
    v_and_b32 v81, 0xffff0000, v136
    v_lshlrev_b32 v82, 16, v137
    v_and_b32 v83, 0xffff0000, v137
    v_lshlrev_b32 v84, 16, v138
    v_and_b32 v85, 0xffff0000, v138
    v_lshlrev_b32 v86, 16, v139
    v_and_b32 v87, 0xffff0000, v139
    v_lshlrev_b32 v88, 16, v140
    v_and_b32 v89, 0xffff0000, v140
    v_lshlrev_b32 v90, 16, v141
    v_and_b32 v91, 0xffff0000, v141
    v_lshlrev_b32 v92, 16, v142
    v_and_b32 v93, 0xffff0000, v142
    v_lshlrev_b32 v94, 16, v143
    v_and_b32 v95, 0xffff0000, v143
    v_lshlrev_b32 v96, 16, v144
    v_and_b32 v97, 0xffff0000, v144
    v_lshlrev_b32 v98, 16, v145
    v_and_b32 v99, 0xffff0000, v145
    v_lshlrev_b32 v100, 16, v146
    v_and_b32 v101, 0xffff0000, v146
    v_lshlrev_b32 v102, 16, v147
    v_and_b32 v103, 0xffff0000, v147
    v_lshlrev_b32 v104, 16, v148
    v_and_b32 v105, 0xffff0000, v148
    v_lshlrev_b32 v106, 16, v149
    v_and_b32 v107, 0xffff0000, v149
    v_lshlrev_b32 v108, 16, v150
    v_and_b32 v109, 0xffff0000, v150
    v_lshlrev_b32 v110, 16, v151
    v_and_b32 v111, 0xffff0000, v151
    v_lshlrev_b32 v112, 16, v152
    v_and_b32 v113, 0xffff0000, v152
    v_lshlrev_b32 v114, 16, v153
    v_and_b32 v115, 0xffff0000, v153
    v_lshlrev_b32 v116, 16, v154
    v_and_b32 v117, 0xffff0000, v154
    v_lshlrev_b32 v118, 16, v155
    v_and_b32 v119, 0xffff0000, v155
    v_lshlrev_b32 v120, 16, v156
    v_and_b32 v121, 0xffff0000, v156
    v_lshlrev_b32 v122, 16, v157
    v_and_b32 v123, 0xffff0000, v157
    v_lshlrev_b32 v124, 16, v158
    v_and_b32 v125, 0xffff0000, v158
    v_lshlrev_b32 v126, 16, v159
    v_and_b32 v127, 0xffff0000, v159
    v_pk_add_f32 v[16:17], v[64:65], v[72:73]
    v_pk_add_f32 v[18:19], v[66:67], v[74:75]
    v_pk_add_f32 v[20:21], v[68:69], v[76:77]
    v_pk_add_f32 v[22:23], v[70:71], v[78:79]
    v_pk_add_f32 v[16:17], v[16:17], v[80:81]
    v_pk_add_f32 v[18:19], v[18:19], v[82:83]
    v_pk_add_f32 v[20:21], v[20:21], v[84:85]
    v_pk_add_f32 v[22:23], v[22:23], v[86:87]
    v_pk_add_f32 v[16:17], v[16:17], v[88:89]
    v_pk_add_f32 v[18:19], v[18:19], v[90:91]
    v_pk_add_f32 v[20:21], v[20:21], v[92:93]
    v_pk_add_f32 v[22:23], v[22:23], v[94:95]
    v_pk_add_f32 v[16:17], v[16:17], v[96:97]
    v_pk_add_f32 v[18:19], v[18:19], v[98:99]
    v_pk_add_f32 v[20:21], v[20:21], v[100:101]
    v_pk_add_f32 v[22:23], v[22:23], v[102:103]
    v_pk_add_f32 v[16:17], v[16:17], v[104:105]
    v_pk_add_f32 v[18:19], v[18:19], v[106:107]
    v_pk_add_f32 v[20:21], v[20:21], v[108:109]
    v_pk_add_f32 v[22:23], v[22:23], v[110:111]
    v_pk_add_f32 v[16:17], v[16:17], v[112:113]
    v_pk_add_f32 v[18:19], v[18:19], v[114:115]
    v_pk_add_f32 v[20:21], v[20:21], v[116:117]
    v_pk_add_f32 v[22:23], v[22:23], v[118:119]
    v_pk_add_f32 v[16:17], v[16:17], v[120:121]
    v_pk_add_f32 v[18:19], v[18:19], v[122:123]
    v_pk_add_f32 v[20:21], v[20:21], v[124:125]
    v_pk_add_f32 v[22:23], v[22:23], v[126:127]
    v_pk_add_f32 v[16:17], v[16:17], v[18:19]
    v_pk_add_f32 v[20:21], v[20:21], v[22:23]
    v_pk_add_f32 v[16:17], v[16:17], v[20:21]
    v_add_f32 v16, v16, v17
    ds_write_b32 v253, v16 offset:0
    s_waitcnt lgkmcnt(0)
    s_barrier
    ds_read_b128 v[16:19], v254 offset:0
    ds_read_b128 v[20:23], v254 offset:16
    ds_read_b128 v[24:27], v254 offset:32
    ds_read_b128 v[28:31], v254 offset:48
    s_waitcnt lgkmcnt(2)
    v_pk_add_f32 v[16:17], v[16:17], v[18:19]
    v_pk_add_f32 v[20:21], v[20:21], v[22:23]
    s_waitcnt lgkmcnt(0)
    v_pk_add_f32 v[24:25], v[24:25], v[26:27]
    v_pk_add_f32 v[28:29], v[28:29], v[30:31]
    v_pk_add_f32 v[16:17], v[16:17], v[20:21]
    v_pk_add_f32 v[24:25], v[24:25], v[28:29]
    v_pk_add_f32 v[16:17], v[16:17], v[24:25]
    v_add_f32 v16, v16, v17
    v_mul_f32 v16, 0xba800000, v16
    v_mov_b32 v17, v16
    v_pk_add_f32 v[64:65], v[64:65], v[16:17]
    v_pk_add_f32 v[66:67], v[66:67], v[16:17]
    v_pk_add_f32 v[68:69], v[68:69], v[16:17]
    v_pk_add_f32 v[70:71], v[70:71], v[16:17]
    v_pk_add_f32 v[72:73], v[72:73], v[16:17]
    v_pk_add_f32 v[74:75], v[74:75], v[16:17]
    v_pk_add_f32 v[76:77], v[76:77], v[16:17]
    v_pk_add_f32 v[78:79], v[78:79], v[16:17]
    v_pk_add_f32 v[80:81], v[80:81], v[16:17]
    v_pk_add_f32 v[82:83], v[82:83], v[16:17]
    v_pk_add_f32 v[84:85], v[84:85], v[16:17]
    v_pk_add_f32 v[86:87], v[86:87], v[16:17]
    v_pk_add_f32 v[88:89], v[88:89], v[16:17]
    v_pk_add_f32 v[90:91], v[90:91], v[16:17]
    v_pk_add_f32 v[92:93], v[92:93], v[16:17]
    v_pk_add_f32 v[94:95], v[94:95], v[16:17]
    v_pk_add_f32 v[96:97], v[96:97], v[16:17]
    v_pk_add_f32 v[98:99], v[98:99], v[16:17]
    v_pk_add_f32 v[100:101], v[100:101], v[16:17]
    v_pk_add_f32 v[102:103], v[102:103], v[16:17]
    v_pk_add_f32 v[104:105], v[104:105], v[16:17]
    v_pk_add_f32 v[106:107], v[106:107], v[16:17]
    v_pk_add_f32 v[108:109], v[108:109], v[16:17]
    v_pk_add_f32 v[110:111], v[110:111], v[16:17]
    v_pk_add_f32 v[112:113], v[112:113], v[16:17]
    v_pk_add_f32 v[114:115], v[114:115], v[16:17]
    v_pk_add_f32 v[116:117], v[116:117], v[16:17]
    v_pk_add_f32 v[118:119], v[118:119], v[16:17]
    v_pk_add_f32 v[120:121], v[120:121], v[16:17]
    v_pk_add_f32 v[122:123], v[122:123], v[16:17]
    v_pk_add_f32 v[124:125], v[124:125], v[16:17]
    v_pk_add_f32 v[126:127], v[126:127], v[16:17]
    v_pk_mul_f32 v[16:17], v[64:65], v[64:65]
    v_pk_mul_f32 v[18:19], v[66:67], v[66:67]
    v_pk_mul_f32 v[20:21], v[68:69], v[68:69]
    v_pk_mul_f32 v[22:23], v[70:71], v[70:71]
    v_pk_fma_f32 v[16:17], v[72:73], v[72:73], v[16:17]
    v_pk_fma_f32 v[18:19], v[74:75], v[74:75], v[18:19]
    v_pk_fma_f32 v[20:21], v[76:77], v[76:77], v[20:21]
    v_pk_fma_f32 v[22:23], v[78:79], v[78:79], v[22:23]
    v_pk_fma_f32 v[16:17], v[80:81], v[80:81], v[16:17]
    v_pk_fma_f32 v[18:19], v[82:83], v[82:83], v[18:19]
    v_pk_fma_f32 v[20:21], v[84:85], v[84:85], v[20:21]
    v_pk_fma_f32 v[22:23], v[86:87], v[86:87], v[22:23]
    v_pk_fma_f32 v[16:17], v[88:89], v[88:89], v[16:17]
    v_pk_fma_f32 v[18:19], v[90:91], v[90:91], v[18:19]
    v_pk_fma_f32 v[20:21], v[92:93], v[92:93], v[20:21]
    v_pk_fma_f32 v[22:23], v[94:95], v[94:95], v[22:23]
    v_pk_fma_f32 v[16:17], v[96:97], v[96:97], v[16:17]
    v_pk_fma_f32 v[18:19], v[98:99], v[98:99], v[18:19]
    v_pk_fma_f32 v[20:21], v[100:101], v[100:101], v[20:21]
    v_pk_fma_f32 v[22:23], v[102:103], v[102:103], v[22:23]
    v_pk_fma_f32 v[16:17], v[104:105], v[104:105], v[16:17]
    v_pk_fma_f32 v[18:19], v[106:107], v[106:107], v[18:19]
    v_pk_fma_f32 v[20:21], v[108:109], v[108:109], v[20:21]
    v_pk_fma_f32 v[22:23], v[110:111], v[110:111], v[22:23]
    v_pk_fma_f32 v[16:17], v[112:113], v[112:113], v[16:17]
    v_pk_fma_f32 v[18:19], v[114:115], v[114:115], v[18:19]
    v_pk_fma_f32 v[20:21], v[116:117], v[116:117], v[20:21]
    v_pk_fma_f32 v[22:23], v[118:119], v[118:119], v[22:23]
    v_pk_fma_f32 v[16:17], v[120:121], v[120:121], v[16:17]
    v_pk_fma_f32 v[18:19], v[122:123], v[122:123], v[18:19]
    v_pk_fma_f32 v[20:21], v[124:125], v[124:125], v[20:21]
    v_pk_fma_f32 v[22:23], v[126:127], v[126:127], v[22:23]
    v_pk_add_f32 v[16:17], v[16:17], v[18:19]
    v_pk_add_f32 v[20:21], v[20:21], v[22:23]
    v_pk_add_f32 v[16:17], v[16:17], v[20:21]
    v_add_f32 v16, v16, v17
    ds_write_b32 v253, v16 offset:1024
    s_waitcnt lgkmcnt(0)
    s_waitcnt vmcnt(0)
    s_barrier
    s_cmp_lg_u32 s14, 0
    s_cbranch_scc1 main_kernel_s_nf
    v_cmp_gt_u32 vcc, 4, v2
    s_cbranch_vccz main_kernel_s_wa1_ok
    v_mov_b32 v2, 0
main_kernel_s_wa1:
    buffer_load_dword v3, v2, s[60:63], 0 offen offset:12 sc1
    s_waitcnt vmcnt(0)
    v_cmp_gt_u32 vcc, 4, v3
    s_cbranch_vccz main_kernel_s_wa1_ok
    s_sleep 4
    s_sub_u32 s29, s29, 1
    s_cbranch_scc0 main_kernel_s_wa1
    s_branch main_kernel_end
main_kernel_s_wa1_ok:
    s_mov_b64 exec, 1
    buffer_store_dword v8, v4, s[4:7], s16 offen sc1
    s_mov_b64 exec, -1
main_kernel_s_nf:
    ds_read_b128 v[16:19], v254 offset:1024
    ds_read_b128 v[20:23], v254 offset:1040
    ds_read_b128 v[24:27], v254 offset:1056
    ds_read_b128 v[28:31], v254 offset:1072
    s_waitcnt lgkmcnt(2)
    v_pk_add_f32 v[16:17], v[16:17], v[18:19]
    v_pk_add_f32 v[20:21], v[20:21], v[22:23]
    s_waitcnt lgkmcnt(0)
    v_pk_add_f32 v[24:25], v[24:25], v[26:27]
    v_pk_add_f32 v[28:29], v[28:29], v[30:31]
    v_pk_add_f32 v[16:17], v[16:17], v[20:21]
    v_pk_add_f32 v[24:25], v[24:25], v[28:29]
    v_pk_add_f32 v[16:17], v[16:17], v[24:25]
    v_add_f32 v16, v16, v17
    v_mov_b32 v17, 0x3727c5ac
    v_fmac_f32 v17, 0x3a800000, v16
    v_rsq_f32 v16, v17
    s_nop 0
    v_mov_b32 v17, v16
    v_pk_mul_f32 v[64:65], v[64:65], v[16:17]
    v_pk_mul_f32 v[66:67], v[66:67], v[16:17]
    v_pk_mul_f32 v[68:69], v[68:69], v[16:17]
    v_pk_mul_f32 v[70:71], v[70:71], v[16:17]
    v_pk_mul_f32 v[72:73], v[72:73], v[16:17]
    v_pk_mul_f32 v[74:75], v[74:75], v[16:17]
    v_pk_mul_f32 v[76:77], v[76:77], v[16:17]
    v_pk_mul_f32 v[78:79], v[78:79], v[16:17]
    v_pk_mul_f32 v[80:81], v[80:81], v[16:17]
    v_pk_mul_f32 v[82:83], v[82:83], v[16:17]
    v_pk_mul_f32 v[84:85], v[84:85], v[16:17]
    v_pk_mul_f32 v[86:87], v[86:87], v[16:17]
    v_pk_mul_f32 v[88:89], v[88:89], v[16:17]
    v_pk_mul_f32 v[90:91], v[90:91], v[16:17]
    v_pk_mul_f32 v[92:93], v[92:93], v[16:17]
    v_pk_mul_f32 v[94:95], v[94:95], v[16:17]
    v_pk_mul_f32 v[96:97], v[96:97], v[16:17]
    v_pk_mul_f32 v[98:99], v[98:99], v[16:17]
    v_pk_mul_f32 v[100:101], v[100:101], v[16:17]
    v_pk_mul_f32 v[102:103], v[102:103], v[16:17]
    v_pk_mul_f32 v[104:105], v[104:105], v[16:17]
    v_pk_mul_f32 v[106:107], v[106:107], v[16:17]
    v_pk_mul_f32 v[108:109], v[108:109], v[16:17]
    v_pk_mul_f32 v[110:111], v[110:111], v[16:17]
    v_pk_mul_f32 v[112:113], v[112:113], v[16:17]
    v_pk_mul_f32 v[114:115], v[114:115], v[16:17]
    v_pk_mul_f32 v[116:117], v[116:117], v[16:17]
    v_pk_mul_f32 v[118:119], v[118:119], v[16:17]
    v_pk_mul_f32 v[120:121], v[120:121], v[16:17]
    v_pk_mul_f32 v[122:123], v[122:123], v[16:17]
    v_pk_mul_f32 v[124:125], v[124:125], v[16:17]
    v_pk_mul_f32 v[126:127], v[126:127], v[16:17]
    v_cvt_pk_bf16_f32 v32, v64, v65
    v_cvt_pk_bf16_f32 v33, v66, v67
    v_cvt_pk_bf16_f32 v34, v68, v69
    v_cvt_pk_bf16_f32 v35, v70, v71
    v_cvt_pk_bf16_f32 v36, v72, v73
    v_cvt_pk_bf16_f32 v37, v74, v75
    v_cvt_pk_bf16_f32 v38, v76, v77
    v_cvt_pk_bf16_f32 v39, v78, v79
    v_cvt_pk_bf16_f32 v40, v80, v81
    v_cvt_pk_bf16_f32 v41, v82, v83
    v_cvt_pk_bf16_f32 v42, v84, v85
    v_cvt_pk_bf16_f32 v43, v86, v87
    v_cvt_pk_bf16_f32 v44, v88, v89
    v_cvt_pk_bf16_f32 v45, v90, v91
    v_cvt_pk_bf16_f32 v46, v92, v93
    v_cvt_pk_bf16_f32 v47, v94, v95
    v_cvt_pk_bf16_f32 v48, v96, v97
    v_cvt_pk_bf16_f32 v49, v98, v99
    v_cvt_pk_bf16_f32 v50, v100, v101
    v_cvt_pk_bf16_f32 v51, v102, v103
    v_cvt_pk_bf16_f32 v52, v104, v105
    v_cvt_pk_bf16_f32 v53, v106, v107
    v_cvt_pk_bf16_f32 v54, v108, v109
    v_cvt_pk_bf16_f32 v55, v110, v111
    v_cvt_pk_bf16_f32 v56, v112, v113
    v_cvt_pk_bf16_f32 v57, v114, v115
    v_cvt_pk_bf16_f32 v58, v116, v117
    v_cvt_pk_bf16_f32 v59, v118, v119
    v_cvt_pk_bf16_f32 v60, v120, v121
    v_cvt_pk_bf16_f32 v61, v122, v123
    v_cvt_pk_bf16_f32 v62, v124, v125
    v_cvt_pk_bf16_f32 v63, v126, v127
    s_add_u32 s32, s34, 0x400000
    s_add_u32 s33, s32, 4096
    buffer_store_dwordx4 v[32:35], v251, s[4:7], s32 offen offset:0 sc1
    buffer_store_dwordx4 v[36:39], v251, s[4:7], s32 offen offset:1024 sc1
    buffer_store_dwordx4 v[40:43], v251, s[4:7], s32 offen offset:2048 sc1
    buffer_store_dwordx4 v[44:47], v251, s[4:7], s32 offen offset:3072 sc1
    buffer_store_dwordx4 v[48:51], v251, s[4:7], s33 offen offset:0 sc1
    buffer_store_dwordx4 v[52:55], v251, s[4:7], s33 offen offset:1024 sc1
    buffer_store_dwordx4 v[56:59], v251, s[4:7], s33 offen offset:2048 sc1
    buffer_store_dwordx4 v[60:63], v251, s[4:7], s33 offen offset:3072 sc1
    s_add_u32 s16, s16, 4
    s_branch main_kernel_s_wa2_ok
main_kernel_s_fill:
    s_lshl_b32 s32, s16, 14
    s_add_u32 s34, s32, 0x6c00000
    buffer_store_dwordx4 v[8:11], v1, s[4:7], s34 offen sc1
    s_add_u32 s34, s32, 0x6c01000
    buffer_store_dwordx4 v[8:11], v1, s[4:7], s34 offen sc1
    s_add_u32 s34, s32, 0x6c02000
    buffer_store_dwordx4 v[8:11], v1, s[4:7], s34 offen sc1
    s_add_u32 s34, s32, 0x6c03000
    buffer_store_dwordx4 v[8:11], v1, s[4:7], s34 offen sc1
    s_lshl_b32 s32, s16, 14
    s_add_u32 s34, s32, 0x8c00000
    buffer_store_dwordx4 v[8:11], v1, s[4:7], s34 offen sc1
    s_add_u32 s34, s32, 0x8c01000
    buffer_store_dwordx4 v[8:11], v1, s[4:7], s34 offen sc1
    s_add_u32 s34, s32, 0x8c02000
    buffer_store_dwordx4 v[8:11], v1, s[4:7], s34 offen sc1
    s_add_u32 s34, s32, 0x8c03000
    buffer_store_dwordx4 v[8:11], v1, s[4:7], s34 offen sc1
    s_add_u32 s34, s32, 0x8d00000
    buffer_store_dwordx4 v[8:11], v1, s[4:7], s34 offen sc1
    s_add_u32 s34, s32, 0x8d01000
    buffer_store_dwordx4 v[8:11], v1, s[4:7], s34 offen sc1
    s_add_u32 s34, s32, 0x8d02000
    buffer_store_dwordx4 v[8:11], v1, s[4:7], s34 offen sc1
    s_add_u32 s34, s32, 0x8d03000
    buffer_store_dwordx4 v[8:11], v1, s[4:7], s34 offen sc1
    s_lshl_b32 s32, s16, 2
    s_lshl_b32 s32, s16, 12
    s_add_u32 s33, s32, 0x8c00000
    s_add_u32 s34, s32, 0x6e00000
    buffer_store_dwordx4 v[8:11], v1, s[4:7], s34 offen sc1
    s_add_u32 s32, s32, 0x8000000
    buffer_store_dwordx4 v[8:11], v1, s[4:7], s32 offen sc1
    s_lshl_b32 s16, s16, 2
    s_add_u32 s16, s16, 0x841f000
    s_cmp_lg_u32 s16, 0x841f034
    s_cbranch_scc1 main_kernel_s_fd
    s_mov_b32 s8, s76
    s_and_b32 s9, s77, 0xffff
    s_mov_b32 s10, 0x4000
    s_mov_b32 s11, 0x20000
    v_and_b32 v2, 7, v0
    v_lshlrev_b32 v2, 11, v2
    v_lshrrev_b32 v3, 6, v0
    v_lshl_add_u32 v2, v3, 7, v2
    v_bfe_u32 v3, v0, 4, 2
    v_lshl_add_u32 v2, v3, 5, v2
    v_bfe_u32 v3, v0, 3, 1
    v_lshl_add_u32 v2, v3, 4, v2
    buffer_load_dwordx4 v[16:19], v2, s[8:11], 0 offen offset:0
    buffer_load_dwordx4 v[20:23], v2, s[8:11], 0 offen offset:512
    buffer_load_dwordx4 v[24:27], v2, s[8:11], 0 offen offset:1024
    buffer_load_dwordx4 v[28:31], v2, s[8:11], 0 offen offset:1536
    s_mov_b32 s32, 0x6d00000
    s_waitcnt vmcnt(0)
    buffer_store_dwordx4 v[16:19], v1, s[4:7], s32 offen sc1
    s_add_u32 s32, s32, 4096
    buffer_store_dwordx4 v[20:23], v1, s[4:7], s32 offen sc1
    s_add_u32 s32, s32, 4096
    buffer_store_dwordx4 v[24:27], v1, s[4:7], s32 offen sc1
    s_add_u32 s32, s32, 4096
    buffer_store_dwordx4 v[28:31], v1, s[4:7], s32 offen sc1
    s_add_u32 s32, s32, 4096
    buffer_store_dwordx4 v[8:11], v1, s[4:7], s32 offen sc1
    s_add_u32 s32, s32, 4096
    buffer_store_dwordx4 v[8:11], v1, s[4:7], s32 offen sc1
    s_add_u32 s32, s32, 4096
    buffer_store_dwordx4 v[8:11], v1, s[4:7], s32 offen sc1
    s_add_u32 s32, s32, 4096
    buffer_store_dwordx4 v[8:11], v1, s[4:7], s32 offen sc1
    s_add_u32 s32, s32, 4096
    v_xor_b32 v2, 0, v1
    v_mov_b32 v2, 0
main_kernel_s_wa3:
    buffer_load_dword v3, v2, s[60:63], 0 offen offset:12 sc1
    s_waitcnt vmcnt(0)
    v_cmp_gt_u32 vcc, 4, v3
    s_cbranch_vccz main_kernel_s_wa3_ok
    s_sleep 4
    s_sub_u32 s29, s29, 1
    s_cbranch_scc0 main_kernel_s_wa3
    s_branch main_kernel_end
main_kernel_s_wa3_ok:
    v_lshlrev_b32 v2, 8, v250
    s_mov_b32 s32, 0x8418100
    s_mov_b64 exec, 15
    buffer_store_dwordx4 v[8:11], v2, s[4:7], s32 offen sc1
    s_mov_b64 exec, -1
main_kernel_s_fd:
    s_cmp_lg_u32 s14, 0
    s_cbranch_scc1 main_kernel_s_wa2_ok
    v_mov_b32 v2, 0
main_kernel_s_wa2:
    buffer_load_dword v3, v2, s[60:63], 0 offen offset:12 sc1
    s_waitcnt vmcnt(0)
    v_cmp_gt_u32 vcc, 4, v3
    s_cbranch_vccz main_kernel_s_wa2_ok
    s_sleep 4
    s_sub_u32 s29, s29, 1
    s_cbranch_scc0 main_kernel_s_wa2
    s_branch main_kernel_end
main_kernel_s_wa2_ok:
    s_waitcnt vmcnt(0)
    s_barrier
    s_cmp_lg_u32 s14, 0
    s_cbranch_scc1 main_kernel_s_end
    s_mov_b64 exec, 1
    buffer_store_dword v8, v4, s[4:7], s16 offen sc1
    s_mov_b64 exec, -1
main_kernel_s_end:
    s_lshl_b32 s32, s12, 5
    s_add_u32 s32, s32, s13
    s_sub_u32 s32, s32, 96
    s_cmp_lt_u32 s32, 16
    s_cbranch_scc1 main_kernel_att
    s_branch main_kernel_worker
main_kernel_end:
    s_endpgm
main_kernel_chain:
    s_lshl_b32 s36, s14, 15
    s_add_u32 s36, s36, 32768
    v_lshlrev_b32 v116, 4, v94
    v_add_u32 v113, s36, v116
    v_lshrrev_b32 v126, 4, v94
    v_and_b32 v127, 15, v94
    v_lshlrev_b32 v95, 2, v126
    v_xor_b32 v127, v127, v95
    v_lshlrev_b32 v127, 4, v127
    v_and_b32 v95, 1, v126
    v_lshrrev_b32 v126, 1, v126
    v_lshl_add_u32 v127, v126, 15, v127
    v_lshl_add_u32 v65, v95, 13, v127
    v_lshl_add_u32 v66, v95, 11, v127
    s_lshr_b32 s32, s14, 1
    s_lshl_b32 s32, s32, 5
    v_xor_b32 v64, s32, v65
    v_bfe_u32 v127, v94, 2, 1
    v_bfe_u32 v95, v94, 4, 1
    v_lshl_add_u32 v78, v95, 1, v127
    v_lshl_add_u32 v126, v126, 3, v78
    v_and_b32 v127, 3, v94
    v_lshlrev_b32 v127, 3, v127
    v_lshl_add_u32 v71, v126, 8, v127
    v_bfe_u32 v95, v94, 3, 1
    v_lshl_add_u32 v71, v95, 5, v71
    v_xor_b32 v126, s14, v78
    v_lshl_add_u32 v126, v126, 6, v71
    v_add_u32 v69, 32768, v126
    v_add_u32 v70, 0x10000, v69
    v_lshl_add_u32 v126, v78, 6, v71
    v_add_u32 v80, s36, v126
    s_lshl_b32 s32, s14, 5
    s_add_u32 s32, s32, 32768
    v_xor_b32 v126, s32, v126
    v_lshl_add_u32 v67, v95, 16, v126
    v_xor_b32 v68, 0x80, v67
    v_xor_b32 v81, 64, v80
    v_xor_b32 v82, 128, v80
    v_xor_b32 v83, 192, v80
    v_and_b32 v126, 7, v94
    v_lshl_add_u32 v126, s13, 3, v126
    v_lshlrev_b32 v77, 10, v126
    s_lshl_b32 s32, s12, 22
    s_lshl_b32 s33, s13, 8
    s_add_u32 s32, s32, s33
    s_lshl_b32 s33, s14, 18
    s_add_u32 s35, s32, s33
    s_bitset0_b32 s33, 19
    s_add_u32 s34, s32, s33
    s_lshl_b32 s3, s13, 18
    s_lshl2_add_u32 s32, s12, s14
    s_lshl_b32 s32, s32, 8
    s_add_u32 s3, s3, s32
    s_cmp_lt_u32 s14, 2
    s_cbranch_scc1 main_kernel_c_pq
    s_mov_b64 s[40:41], s[42:43]
main_kernel_c_pq:
    v_min_u32 v73, 8, v94
    v_lshlrev_b32 v73, 5, v73
    v_mov_b32 v126, 12
    v_cmp_gt_u32 vcc, 8, v94
    v_lshlrev_b32 v74, 2, v94
    v_add_u32 v74, 0x841f000, v74
    v_cndmask_b32 v73, v126, v73, vcc
    v_and_b32 v75, 1, v94
    s_lshl_b32 s32, s13, 8
    s_add_u32 s32, s32, 0x8406000
    v_lshl_add_u32 v75, v75, 13, s32
    s_mov_b32 s8, s44
    s_and_b32 s9, s45, 0xffff
    s_mov_b32 s10, 0x800000
    s_mov_b32 s11, 0x20000
    s_sub_u32 s39, 511, s44
    s_and_b32 s39, s39, 0x380
    s_andn2_b32 s32, s35, 0x1fff
    s_add_u32 s39, s39, s32
    s_add_u32 s32, s39, 0x0
    buffer_load_dword v86, v77, s[8:11], s32 offen
    s_add_u32 s32, s35, 0x0
    s_add_u32 m0, s36, 0
    s_nop 0
    buffer_load_dwordx4 v65, s[8:11], s32 offen lds
    s_add_u32 s32, s35, 0x4000
    s_add_u32 m0, s36, 1024
    s_nop 0
    buffer_load_dwordx4 v65, s[8:11], s32 offen lds
    s_add_u32 s32, s35, 0x10000
    s_add_u32 m0, s36, 2048
    s_nop 0
    buffer_load_dwordx4 v65, s[8:11], s32 offen lds
    s_add_u32 s32, s35, 0x14000
    s_add_u32 m0, s36, 3072
    s_nop 0
    buffer_load_dwordx4 v65, s[8:11], s32 offen lds
    s_add_u32 s32, s35, 0x20000
    s_add_u32 m0, s36, 4096
    s_nop 0
    buffer_load_dwordx4 v65, s[8:11], s32 offen lds
    s_add_u32 s32, s35, 0x24000
    s_add_u32 m0, s36, 5120
    s_nop 0
    buffer_load_dwordx4 v65, s[8:11], s32 offen lds
    s_add_u32 s32, s35, 0x30000
    s_add_u32 m0, s36, 6144
    s_nop 0
    buffer_load_dwordx4 v65, s[8:11], s32 offen lds
    s_add_u32 s32, s35, 0x34000
    s_add_u32 m0, s36, 7168
    s_nop 0
    buffer_load_dwordx4 v65, s[8:11], s32 offen lds
    s_add_u32 s32, s39, 0x100000
    buffer_load_dword v86, v77, s[8:11], s32 offen
    s_add_u32 s32, s35, 0x100000
    s_add_u32 m0, s36, 8192
    s_nop 0
    buffer_load_dwordx4 v65, s[8:11], s32 offen lds
    s_add_u32 s32, s35, 0x104000
    s_add_u32 m0, s36, 9216
    s_nop 0
    buffer_load_dwordx4 v65, s[8:11], s32 offen lds
    s_add_u32 s32, s35, 0x110000
    s_add_u32 m0, s36, 10240
    s_nop 0
    buffer_load_dwordx4 v65, s[8:11], s32 offen lds
    s_add_u32 s32, s35, 0x114000
    s_add_u32 m0, s36, 11264
    s_nop 0
    buffer_load_dwordx4 v65, s[8:11], s32 offen lds
    s_add_u32 s32, s35, 0x120000
    s_add_u32 m0, s36, 12288
    s_nop 0
    buffer_load_dwordx4 v65, s[8:11], s32 offen lds
    s_add_u32 s32, s35, 0x124000
    s_add_u32 m0, s36, 13312
    s_nop 0
    buffer_load_dwordx4 v65, s[8:11], s32 offen lds
    s_add_u32 s32, s35, 0x130000
    s_add_u32 m0, s36, 14336
    s_nop 0
    buffer_load_dwordx4 v65, s[8:11], s32 offen lds
    s_add_u32 s32, s35, 0x134000
    s_add_u32 m0, s36, 15360
    s_nop 0
    buffer_load_dwordx4 v65, s[8:11], s32 offen lds
    s_mov_b32 s8, s40
    s_and_b32 s9, s41, 0xffff
    s_mov_b32 s10, 0x800000
    s_mov_b32 s11, 0x20000
    s_sub_u32 s39, 511, s40
    s_and_b32 s39, s39, 0x380
    s_andn2_b32 s32, s34, 0x1fff
    s_add_u32 s39, s39, s32
    s_add_u32 s32, s39, 0x0
    buffer_load_dword v86, v77, s[8:11], s32 offen
    s_add_u32 s32, s34, 0x0
    s_add_u32 m0, s36, 16384
    s_nop 0
    buffer_load_dwordx4 v64, s[8:11], s32 offen lds
    s_add_u32 s32, s34, 0x4000
    s_add_u32 m0, s36, 17408
    s_nop 0
    buffer_load_dwordx4 v64, s[8:11], s32 offen lds
    s_add_u32 s32, s34, 0x10000
    s_add_u32 m0, s36, 18432
    s_nop 0
    buffer_load_dwordx4 v64, s[8:11], s32 offen lds
    s_add_u32 s32, s34, 0x14000
    s_add_u32 m0, s36, 19456
    s_nop 0
    buffer_load_dwordx4 v64, s[8:11], s32 offen lds
    s_add_u32 s32, s34, 0x20000
    s_add_u32 m0, s36, 20480
    s_nop 0
    buffer_load_dwordx4 v64, s[8:11], s32 offen lds
    s_add_u32 s32, s34, 0x24000
    s_add_u32 m0, s36, 21504
    s_nop 0
    buffer_load_dwordx4 v64, s[8:11], s32 offen lds
    s_add_u32 s32, s34, 0x30000
    s_add_u32 m0, s36, 22528
    s_nop 0
    buffer_load_dwordx4 v64, s[8:11], s32 offen lds
    s_add_u32 s32, s34, 0x34000
    s_add_u32 m0, s36, 23552
    s_nop 0
    buffer_load_dwordx4 v64, s[8:11], s32 offen lds
    s_add_u32 s32, s39, 0x80000
    buffer_load_dword v86, v77, s[8:11], s32 offen
    s_add_u32 s32, s34, 0x80000
    s_add_u32 m0, s36, 24576
    s_nop 0
    buffer_load_dwordx4 v64, s[8:11], s32 offen lds
    s_add_u32 s32, s34, 0x84000
    s_add_u32 m0, s36, 25600
    s_nop 0
    buffer_load_dwordx4 v64, s[8:11], s32 offen lds
    s_add_u32 s32, s34, 0x90000
    s_add_u32 m0, s36, 26624
    s_nop 0
    buffer_load_dwordx4 v64, s[8:11], s32 offen lds
    s_add_u32 s32, s34, 0x94000
    s_add_u32 m0, s36, 27648
    s_nop 0
    buffer_load_dwordx4 v64, s[8:11], s32 offen lds
    s_add_u32 s32, s34, 0xa0000
    s_add_u32 m0, s36, 28672
    s_nop 0
    buffer_load_dwordx4 v64, s[8:11], s32 offen lds
    s_add_u32 s32, s34, 0xa4000
    s_add_u32 m0, s36, 29696
    s_nop 0
    buffer_load_dwordx4 v64, s[8:11], s32 offen lds
    s_add_u32 s32, s34, 0xb0000
    s_add_u32 m0, s36, 30720
    s_nop 0
    buffer_load_dwordx4 v64, s[8:11], s32 offen lds
    s_add_u32 s32, s34, 0xb4000
    s_add_u32 m0, s36, 31744
    s_nop 0
    buffer_load_dwordx4 v64, s[8:11], s32 offen lds
    s_waitcnt vmcnt(27)
    s_barrier
    ds_read_b64_tr_b16 v[128:129], v69 offset:0
    ds_read_b64_tr_b16 v[130:131], v69 offset:1024
    ds_read_b64_tr_b16 v[132:133], v69 offset:4096
    ds_read_b64_tr_b16 v[134:135], v69 offset:5120
    ds_read_b64_tr_b16 v[136:137], v69 offset:32768
    ds_read_b64_tr_b16 v[138:139], v69 offset:33792
    ds_read_b64_tr_b16 v[140:141], v69 offset:36864
    ds_read_b64_tr_b16 v[142:143], v69 offset:37888
    ds_read_b64_tr_b16 v[144:145], v70 offset:0
    ds_read_b64_tr_b16 v[146:147], v70 offset:1024
    ds_read_b64_tr_b16 v[148:149], v70 offset:4096
    ds_read_b64_tr_b16 v[150:151], v70 offset:5120
    ds_read_b64_tr_b16 v[152:153], v70 offset:32768
    ds_read_b64_tr_b16 v[154:155], v70 offset:33792
    ds_read_b64_tr_b16 v[156:157], v70 offset:36864
    ds_read_b64_tr_b16 v[158:159], v70 offset:37888
    s_waitcnt lgkmcnt(0)
    s_waitcnt vmcnt(18)
    s_barrier
    s_add_u32 s32, s39, 0x100000
    buffer_load_dword v86, v77, s[8:11], s32 offen
    s_add_u32 s32, s34, 0x100000
    s_add_u32 m0, s36, 0
    s_nop 0
    buffer_load_dwordx4 v64, s[8:11], s32 offen lds
    s_add_u32 s32, s34, 0x104000
    s_add_u32 m0, s36, 1024
    s_nop 0
    buffer_load_dwordx4 v64, s[8:11], s32 offen lds
    s_add_u32 s32, s34, 0x110000
    s_add_u32 m0, s36, 2048
    s_nop 0
    buffer_load_dwordx4 v64, s[8:11], s32 offen lds
    s_add_u32 s32, s34, 0x114000
    s_add_u32 m0, s36, 3072
    s_nop 0
    buffer_load_dwordx4 v64, s[8:11], s32 offen lds
    s_add_u32 s32, s34, 0x120000
    s_add_u32 m0, s36, 4096
    s_nop 0
    buffer_load_dwordx4 v64, s[8:11], s32 offen lds
    s_add_u32 s32, s34, 0x124000
    s_add_u32 m0, s36, 5120
    s_nop 0
    buffer_load_dwordx4 v64, s[8:11], s32 offen lds
    s_add_u32 s32, s34, 0x130000
    s_add_u32 m0, s36, 6144
    s_nop 0
    buffer_load_dwordx4 v64, s[8:11], s32 offen lds
    s_add_u32 s32, s34, 0x134000
    s_add_u32 m0, s36, 7168
    s_nop 0
    buffer_load_dwordx4 v64, s[8:11], s32 offen lds
    ds_read_b64_tr_b16 v[160:161], v69 offset:8192
    ds_read_b64_tr_b16 v[162:163], v69 offset:9216
    ds_read_b64_tr_b16 v[164:165], v69 offset:12288
    ds_read_b64_tr_b16 v[166:167], v69 offset:13312
    ds_read_b64_tr_b16 v[168:169], v69 offset:40960
    ds_read_b64_tr_b16 v[170:171], v69 offset:41984
    ds_read_b64_tr_b16 v[172:173], v69 offset:45056
    ds_read_b64_tr_b16 v[174:175], v69 offset:46080
    ds_read_b64_tr_b16 v[176:177], v70 offset:8192
    ds_read_b64_tr_b16 v[178:179], v70 offset:9216
    ds_read_b64_tr_b16 v[180:181], v70 offset:12288
    ds_read_b64_tr_b16 v[182:183], v70 offset:13312
    ds_read_b64_tr_b16 v[184:185], v70 offset:40960
    ds_read_b64_tr_b16 v[186:187], v70 offset:41984
    ds_read_b64_tr_b16 v[188:189], v70 offset:45056
    ds_read_b64_tr_b16 v[190:191], v70 offset:46080
    s_waitcnt lgkmcnt(0)
    s_waitcnt vmcnt(18)
    s_barrier
    s_add_u32 s32, s39, 0x180000
    buffer_load_dword v86, v77, s[8:11], s32 offen
    s_add_u32 s32, s34, 0x180000
    s_add_u32 m0, s36, 8192
    s_nop 0
    buffer_load_dwordx4 v64, s[8:11], s32 offen lds
    s_add_u32 s32, s34, 0x184000
    s_add_u32 m0, s36, 9216
    s_nop 0
    buffer_load_dwordx4 v64, s[8:11], s32 offen lds
    s_add_u32 s32, s34, 0x190000
    s_add_u32 m0, s36, 10240
    s_nop 0
    buffer_load_dwordx4 v64, s[8:11], s32 offen lds
    s_add_u32 s32, s34, 0x194000
    s_add_u32 m0, s36, 11264
    s_nop 0
    buffer_load_dwordx4 v64, s[8:11], s32 offen lds
    s_add_u32 s32, s34, 0x1a0000
    s_add_u32 m0, s36, 12288
    s_nop 0
    buffer_load_dwordx4 v64, s[8:11], s32 offen lds
    s_add_u32 s32, s34, 0x1a4000
    s_add_u32 m0, s36, 13312
    s_nop 0
    buffer_load_dwordx4 v64, s[8:11], s32 offen lds
    s_add_u32 s32, s34, 0x1b0000
    s_add_u32 m0, s36, 14336
    s_nop 0
    buffer_load_dwordx4 v64, s[8:11], s32 offen lds
    s_add_u32 s32, s34, 0x1b4000
    s_add_u32 m0, s36, 15360
    s_nop 0
    buffer_load_dwordx4 v64, s[8:11], s32 offen lds
    ds_read_b64_tr_b16 a[0:1], v67 offset:16384
    ds_read_b64_tr_b16 a[2:3], v67 offset:17408
    ds_read_b64_tr_b16 a[4:5], v67 offset:20480
    ds_read_b64_tr_b16 a[6:7], v67 offset:21504
    ds_read_b64_tr_b16 a[8:9], v67 offset:49152
    ds_read_b64_tr_b16 a[10:11], v67 offset:50176
    ds_read_b64_tr_b16 a[12:13], v67 offset:53248
    ds_read_b64_tr_b16 a[14:15], v67 offset:54272
    ds_read_b64_tr_b16 a[128:129], v68 offset:16384
    ds_read_b64_tr_b16 a[130:131], v68 offset:17408
    ds_read_b64_tr_b16 a[132:133], v68 offset:20480
    ds_read_b64_tr_b16 a[134:135], v68 offset:21504
    ds_read_b64_tr_b16 a[136:137], v68 offset:49152
    ds_read_b64_tr_b16 a[138:139], v68 offset:50176
    ds_read_b64_tr_b16 a[140:141], v68 offset:53248
    ds_read_b64_tr_b16 a[142:143], v68 offset:54272
    s_waitcnt lgkmcnt(0)
    s_waitcnt vmcnt(18)
    s_barrier
    s_add_u32 s32, s39, 0x200000
    buffer_load_dword v86, v77, s[8:11], s32 offen
    s_add_u32 s32, s34, 0x200000
    s_add_u32 m0, s36, 16384
    s_nop 0
    buffer_load_dwordx4 v64, s[8:11], s32 offen lds
    s_add_u32 s32, s34, 0x204000
    s_add_u32 m0, s36, 17408
    s_nop 0
    buffer_load_dwordx4 v64, s[8:11], s32 offen lds
    s_add_u32 s32, s34, 0x210000
    s_add_u32 m0, s36, 18432
    s_nop 0
    buffer_load_dwordx4 v64, s[8:11], s32 offen lds
    s_add_u32 s32, s34, 0x214000
    s_add_u32 m0, s36, 19456
    s_nop 0
    buffer_load_dwordx4 v64, s[8:11], s32 offen lds
    s_add_u32 s32, s34, 0x220000
    s_add_u32 m0, s36, 20480
    s_nop 0
    buffer_load_dwordx4 v64, s[8:11], s32 offen lds
    s_add_u32 s32, s34, 0x224000
    s_add_u32 m0, s36, 21504
    s_nop 0
    buffer_load_dwordx4 v64, s[8:11], s32 offen lds
    s_add_u32 s32, s34, 0x230000
    s_add_u32 m0, s36, 22528
    s_nop 0
    buffer_load_dwordx4 v64, s[8:11], s32 offen lds
    s_add_u32 s32, s34, 0x234000
    s_add_u32 m0, s36, 23552
    s_nop 0
    buffer_load_dwordx4 v64, s[8:11], s32 offen lds
    ds_read_b64_tr_b16 a[16:17], v67 offset:24576
    ds_read_b64_tr_b16 a[18:19], v67 offset:25600
    ds_read_b64_tr_b16 a[20:21], v67 offset:28672
    ds_read_b64_tr_b16 a[22:23], v67 offset:29696
    ds_read_b64_tr_b16 a[24:25], v67 offset:57344
    ds_read_b64_tr_b16 a[26:27], v67 offset:58368
    ds_read_b64_tr_b16 a[28:29], v67 offset:61440
    ds_read_b64_tr_b16 a[30:31], v67 offset:62464
    ds_read_b64_tr_b16 a[144:145], v68 offset:24576
    ds_read_b64_tr_b16 a[146:147], v68 offset:25600
    ds_read_b64_tr_b16 a[148:149], v68 offset:28672
    ds_read_b64_tr_b16 a[150:151], v68 offset:29696
    ds_read_b64_tr_b16 a[152:153], v68 offset:57344
    ds_read_b64_tr_b16 a[154:155], v68 offset:58368
    ds_read_b64_tr_b16 a[156:157], v68 offset:61440
    ds_read_b64_tr_b16 a[158:159], v68 offset:62464
    s_waitcnt lgkmcnt(0)
    s_waitcnt vmcnt(18)
    s_barrier
    s_add_u32 s32, s39, 0x280000
    buffer_load_dword v86, v77, s[8:11], s32 offen
    s_add_u32 s32, s34, 0x280000
    s_add_u32 m0, s36, 24576
    s_nop 0
    buffer_load_dwordx4 v64, s[8:11], s32 offen lds
    s_add_u32 s32, s34, 0x284000
    s_add_u32 m0, s36, 25600
    s_nop 0
    buffer_load_dwordx4 v64, s[8:11], s32 offen lds
    s_add_u32 s32, s34, 0x290000
    s_add_u32 m0, s36, 26624
    s_nop 0
    buffer_load_dwordx4 v64, s[8:11], s32 offen lds
    s_add_u32 s32, s34, 0x294000
    s_add_u32 m0, s36, 27648
    s_nop 0
    buffer_load_dwordx4 v64, s[8:11], s32 offen lds
    s_add_u32 s32, s34, 0x2a0000
    s_add_u32 m0, s36, 28672
    s_nop 0
    buffer_load_dwordx4 v64, s[8:11], s32 offen lds
    s_add_u32 s32, s34, 0x2a4000
    s_add_u32 m0, s36, 29696
    s_nop 0
    buffer_load_dwordx4 v64, s[8:11], s32 offen lds
    s_add_u32 s32, s34, 0x2b0000
    s_add_u32 m0, s36, 30720
    s_nop 0
    buffer_load_dwordx4 v64, s[8:11], s32 offen lds
    s_add_u32 s32, s34, 0x2b4000
    s_add_u32 m0, s36, 31744
    s_nop 0
    buffer_load_dwordx4 v64, s[8:11], s32 offen lds
    ds_read_b64_tr_b16 a[32:33], v67 offset:0
    ds_read_b64_tr_b16 a[34:35], v67 offset:1024
    ds_read_b64_tr_b16 a[36:37], v67 offset:4096
    ds_read_b64_tr_b16 a[38:39], v67 offset:5120
    ds_read_b64_tr_b16 a[40:41], v67 offset:32768
    ds_read_b64_tr_b16 a[42:43], v67 offset:33792
    ds_read_b64_tr_b16 a[44:45], v67 offset:36864
    ds_read_b64_tr_b16 a[46:47], v67 offset:37888
    ds_read_b64_tr_b16 a[160:161], v68 offset:0
    ds_read_b64_tr_b16 a[162:163], v68 offset:1024
    ds_read_b64_tr_b16 a[164:165], v68 offset:4096
    ds_read_b64_tr_b16 a[166:167], v68 offset:5120
    ds_read_b64_tr_b16 a[168:169], v68 offset:32768
    ds_read_b64_tr_b16 a[170:171], v68 offset:33792
    ds_read_b64_tr_b16 a[172:173], v68 offset:36864
    ds_read_b64_tr_b16 a[174:175], v68 offset:37888
    s_waitcnt lgkmcnt(0)
    s_waitcnt vmcnt(18)
    s_barrier
    s_add_u32 s32, s39, 0x300000
    buffer_load_dword v86, v77, s[8:11], s32 offen
    s_add_u32 s32, s34, 0x300000
    s_add_u32 m0, s36, 0
    s_nop 0
    buffer_load_dwordx4 v64, s[8:11], s32 offen lds
    s_add_u32 s32, s34, 0x304000
    s_add_u32 m0, s36, 1024
    s_nop 0
    buffer_load_dwordx4 v64, s[8:11], s32 offen lds
    s_add_u32 s32, s34, 0x310000
    s_add_u32 m0, s36, 2048
    s_nop 0
    buffer_load_dwordx4 v64, s[8:11], s32 offen lds
    s_add_u32 s32, s34, 0x314000
    s_add_u32 m0, s36, 3072
    s_nop 0
    buffer_load_dwordx4 v64, s[8:11], s32 offen lds
    s_add_u32 s32, s34, 0x320000
    s_add_u32 m0, s36, 4096
    s_nop 0
    buffer_load_dwordx4 v64, s[8:11], s32 offen lds
    s_add_u32 s32, s34, 0x324000
    s_add_u32 m0, s36, 5120
    s_nop 0
    buffer_load_dwordx4 v64, s[8:11], s32 offen lds
    s_add_u32 s32, s34, 0x330000
    s_add_u32 m0, s36, 6144
    s_nop 0
    buffer_load_dwordx4 v64, s[8:11], s32 offen lds
    s_add_u32 s32, s34, 0x334000
    s_add_u32 m0, s36, 7168
    s_nop 0
    buffer_load_dwordx4 v64, s[8:11], s32 offen lds
    ds_read_b64_tr_b16 a[48:49], v67 offset:8192
    ds_read_b64_tr_b16 a[50:51], v67 offset:9216
    ds_read_b64_tr_b16 a[52:53], v67 offset:12288
    ds_read_b64_tr_b16 a[54:55], v67 offset:13312
    ds_read_b64_tr_b16 a[56:57], v67 offset:40960
    ds_read_b64_tr_b16 a[58:59], v67 offset:41984
    ds_read_b64_tr_b16 a[60:61], v67 offset:45056
    ds_read_b64_tr_b16 a[62:63], v67 offset:46080
    ds_read_b64_tr_b16 a[176:177], v68 offset:8192
    ds_read_b64_tr_b16 a[178:179], v68 offset:9216
    ds_read_b64_tr_b16 a[180:181], v68 offset:12288
    ds_read_b64_tr_b16 a[182:183], v68 offset:13312
    ds_read_b64_tr_b16 a[184:185], v68 offset:40960
    ds_read_b64_tr_b16 a[186:187], v68 offset:41984
    ds_read_b64_tr_b16 a[188:189], v68 offset:45056
    ds_read_b64_tr_b16 a[190:191], v68 offset:46080
    s_waitcnt lgkmcnt(0)
    s_waitcnt vmcnt(18)
    s_barrier
    s_add_u32 s32, s39, 0x380000
    buffer_load_dword v86, v77, s[8:11], s32 offen
    s_add_u32 s32, s34, 0x380000
    s_add_u32 m0, s36, 8192
    s_nop 0
    buffer_load_dwordx4 v64, s[8:11], s32 offen lds
    s_add_u32 s32, s34, 0x384000
    s_add_u32 m0, s36, 9216
    s_nop 0
    buffer_load_dwordx4 v64, s[8:11], s32 offen lds
    s_add_u32 s32, s34, 0x390000
    s_add_u32 m0, s36, 10240
    s_nop 0
    buffer_load_dwordx4 v64, s[8:11], s32 offen lds
    s_add_u32 s32, s34, 0x394000
    s_add_u32 m0, s36, 11264
    s_nop 0
    buffer_load_dwordx4 v64, s[8:11], s32 offen lds
    s_add_u32 s32, s34, 0x3a0000
    s_add_u32 m0, s36, 12288
    s_nop 0
    buffer_load_dwordx4 v64, s[8:11], s32 offen lds
    s_add_u32 s32, s34, 0x3a4000
    s_add_u32 m0, s36, 13312
    s_nop 0
    buffer_load_dwordx4 v64, s[8:11], s32 offen lds
    s_add_u32 s32, s34, 0x3b0000
    s_add_u32 m0, s36, 14336
    s_nop 0
    buffer_load_dwordx4 v64, s[8:11], s32 offen lds
    s_add_u32 s32, s34, 0x3b4000
    s_add_u32 m0, s36, 15360
    s_nop 0
    buffer_load_dwordx4 v64, s[8:11], s32 offen lds
    ds_read_b64_tr_b16 a[64:65], v67 offset:16384
    ds_read_b64_tr_b16 a[66:67], v67 offset:17408
    ds_read_b64_tr_b16 a[68:69], v67 offset:20480
    ds_read_b64_tr_b16 a[70:71], v67 offset:21504
    ds_read_b64_tr_b16 a[72:73], v67 offset:49152
    ds_read_b64_tr_b16 a[74:75], v67 offset:50176
    ds_read_b64_tr_b16 a[76:77], v67 offset:53248
    ds_read_b64_tr_b16 a[78:79], v67 offset:54272
    ds_read_b64_tr_b16 a[192:193], v68 offset:16384
    ds_read_b64_tr_b16 a[194:195], v68 offset:17408
    ds_read_b64_tr_b16 a[196:197], v68 offset:20480
    ds_read_b64_tr_b16 a[198:199], v68 offset:21504
    ds_read_b64_tr_b16 a[200:201], v68 offset:49152
    ds_read_b64_tr_b16 a[202:203], v68 offset:50176
    ds_read_b64_tr_b16 a[204:205], v68 offset:53248
    ds_read_b64_tr_b16 a[206:207], v68 offset:54272
    s_waitcnt lgkmcnt(0)
    buffer_load_dword v72, v73, s[60:63], 0 offen sc1
    buffer_load_dwordx2 v[84:85], off, s[60:63], 0 offset:16 sc1
    s_waitcnt vmcnt(20)
    s_barrier
    s_mov_b32 s8, s46
    s_and_b32 s9, s47, 0xffff
    s_mov_b32 s10, 0x800000
    s_mov_b32 s11, 0x20000
    s_xor_b32 s32, s3, 0x0
    s_add_u32 m0, s36, 16384
    s_nop 0
    buffer_load_dwordx4 v66, s[8:11], s32 offen lds
    s_xor_b32 s32, s3, 0x1000
    s_add_u32 m0, s36, 17408
    s_nop 0
    buffer_load_dwordx4 v66, s[8:11], s32 offen lds
    s_xor_b32 s32, s3, 0x2000
    s_add_u32 m0, s36, 18432
    s_nop 0
    buffer_load_dwordx4 v66, s[8:11], s32 offen lds
    s_xor_b32 s32, s3, 0x3000
    s_add_u32 m0, s36, 19456
    s_nop 0
    buffer_load_dwordx4 v66, s[8:11], s32 offen lds
    s_xor_b32 s32, s3, 0x4000
    s_add_u32 m0, s36, 20480
    s_nop 0
    buffer_load_dwordx4 v66, s[8:11], s32 offen lds
    s_xor_b32 s32, s3, 0x5000
    s_add_u32 m0, s36, 21504
    s_nop 0
    buffer_load_dwordx4 v66, s[8:11], s32 offen lds
    s_xor_b32 s32, s3, 0x6000
    s_add_u32 m0, s36, 22528
    s_nop 0
    buffer_load_dwordx4 v66, s[8:11], s32 offen lds
    s_xor_b32 s32, s3, 0x7000
    s_add_u32 m0, s36, 23552
    s_nop 0
    buffer_load_dwordx4 v66, s[8:11], s32 offen lds
    ds_read_b64_tr_b16 a[80:81], v67 offset:24576
    ds_read_b64_tr_b16 a[82:83], v67 offset:25600
    ds_read_b64_tr_b16 a[84:85], v67 offset:28672
    ds_read_b64_tr_b16 a[86:87], v67 offset:29696
    ds_read_b64_tr_b16 a[88:89], v67 offset:57344
    ds_read_b64_tr_b16 a[90:91], v67 offset:58368
    ds_read_b64_tr_b16 a[92:93], v67 offset:61440
    ds_read_b64_tr_b16 a[94:95], v67 offset:62464
    ds_read_b64_tr_b16 a[208:209], v68 offset:24576
    ds_read_b64_tr_b16 a[210:211], v68 offset:25600
    ds_read_b64_tr_b16 a[212:213], v68 offset:28672
    ds_read_b64_tr_b16 a[214:215], v68 offset:29696
    ds_read_b64_tr_b16 a[216:217], v68 offset:57344
    ds_read_b64_tr_b16 a[218:219], v68 offset:58368
    ds_read_b64_tr_b16 a[220:221], v68 offset:61440
    ds_read_b64_tr_b16 a[222:223], v68 offset:62464
    s_waitcnt lgkmcnt(0)
    s_waitcnt vmcnt(19)
    s_barrier
    s_xor_b32 s32, s3, 0x10000
    s_add_u32 m0, s36, 24576
    s_nop 0
    buffer_load_dwordx4 v66, s[8:11], s32 offen lds
    s_xor_b32 s32, s3, 0x11000
    s_add_u32 m0, s36, 25600
    s_nop 0
    buffer_load_dwordx4 v66, s[8:11], s32 offen lds
    s_xor_b32 s32, s3, 0x12000
    s_add_u32 m0, s36, 26624
    s_nop 0
    buffer_load_dwordx4 v66, s[8:11], s32 offen lds
    s_xor_b32 s32, s3, 0x13000
    s_add_u32 m0, s36, 27648
    s_nop 0
    buffer_load_dwordx4 v66, s[8:11], s32 offen lds
    s_xor_b32 s32, s3, 0x14000
    s_add_u32 m0, s36, 28672
    s_nop 0
    buffer_load_dwordx4 v66, s[8:11], s32 offen lds
    s_xor_b32 s32, s3, 0x15000
    s_add_u32 m0, s36, 29696
    s_nop 0
    buffer_load_dwordx4 v66, s[8:11], s32 offen lds
    s_xor_b32 s32, s3, 0x16000
    s_add_u32 m0, s36, 30720
    s_nop 0
    buffer_load_dwordx4 v66, s[8:11], s32 offen lds
    s_xor_b32 s32, s3, 0x17000
    s_add_u32 m0, s36, 31744
    s_nop 0
    buffer_load_dwordx4 v66, s[8:11], s32 offen lds
    ds_read_b64_tr_b16 a[96:97], v67 offset:0
    ds_read_b64_tr_b16 a[98:99], v67 offset:1024
    ds_read_b64_tr_b16 a[100:101], v67 offset:4096
    ds_read_b64_tr_b16 a[102:103], v67 offset:5120
    ds_read_b64_tr_b16 a[104:105], v67 offset:32768
    ds_read_b64_tr_b16 a[106:107], v67 offset:33792
    ds_read_b64_tr_b16 a[108:109], v67 offset:36864
    ds_read_b64_tr_b16 a[110:111], v67 offset:37888
    ds_read_b64_tr_b16 a[224:225], v68 offset:0
    ds_read_b64_tr_b16 a[226:227], v68 offset:1024
    ds_read_b64_tr_b16 a[228:229], v68 offset:4096
    ds_read_b64_tr_b16 a[230:231], v68 offset:5120
    ds_read_b64_tr_b16 a[232:233], v68 offset:32768
    ds_read_b64_tr_b16 a[234:235], v68 offset:33792
    ds_read_b64_tr_b16 a[236:237], v68 offset:36864
    ds_read_b64_tr_b16 a[238:239], v68 offset:37888
    s_waitcnt lgkmcnt(0)
    s_waitcnt vmcnt(18)
    s_barrier
    s_mov_b32 s8, s44
    s_and_b32 s9, s45, 0xffff
    s_mov_b32 s10, 0x800000
    s_mov_b32 s11, 0x20000
    s_sub_u32 s39, 511, s44
    s_and_b32 s39, s39, 0x380
    s_andn2_b32 s32, s35, 0x1fff
    s_add_u32 s39, s39, s32
    s_add_u32 s32, s39, 0x200000
    buffer_load_dword v86, v77, s[8:11], s32 offen
    s_add_u32 s32, s35, 0x200000
    s_add_u32 m0, s36, 0
    s_nop 0
    buffer_load_dwordx4 v65, s[8:11], s32 offen lds
    s_add_u32 s32, s35, 0x204000
    s_add_u32 m0, s36, 1024
    s_nop 0
    buffer_load_dwordx4 v65, s[8:11], s32 offen lds
    s_add_u32 s32, s35, 0x210000
    s_add_u32 m0, s36, 2048
    s_nop 0
    buffer_load_dwordx4 v65, s[8:11], s32 offen lds
    s_add_u32 s32, s35, 0x214000
    s_add_u32 m0, s36, 3072
    s_nop 0
    buffer_load_dwordx4 v65, s[8:11], s32 offen lds
    s_add_u32 s32, s35, 0x220000
    s_add_u32 m0, s36, 4096
    s_nop 0
    buffer_load_dwordx4 v65, s[8:11], s32 offen lds
    s_add_u32 s32, s35, 0x224000
    s_add_u32 m0, s36, 5120
    s_nop 0
    buffer_load_dwordx4 v65, s[8:11], s32 offen lds
    s_add_u32 s32, s35, 0x230000
    s_add_u32 m0, s36, 6144
    s_nop 0
    buffer_load_dwordx4 v65, s[8:11], s32 offen lds
    s_add_u32 s32, s35, 0x234000
    s_add_u32 m0, s36, 7168
    s_nop 0
    buffer_load_dwordx4 v65, s[8:11], s32 offen lds
    ds_read_b64_tr_b16 a[112:113], v67 offset:8192
    ds_read_b64_tr_b16 a[114:115], v67 offset:9216
    ds_read_b64_tr_b16 a[116:117], v67 offset:12288
    ds_read_b64_tr_b16 a[118:119], v67 offset:13312
    ds_read_b64_tr_b16 a[120:121], v67 offset:40960
    ds_read_b64_tr_b16 a[122:123], v67 offset:41984
    ds_read_b64_tr_b16 a[124:125], v67 offset:45056
    ds_read_b64_tr_b16 a[126:127], v67 offset:46080
    ds_read_b64_tr_b16 a[240:241], v68 offset:8192
    ds_read_b64_tr_b16 a[242:243], v68 offset:9216
    ds_read_b64_tr_b16 a[244:245], v68 offset:12288
    ds_read_b64_tr_b16 a[246:247], v68 offset:13312
    ds_read_b64_tr_b16 a[248:249], v68 offset:40960
    ds_read_b64_tr_b16 a[250:251], v68 offset:41984
    ds_read_b64_tr_b16 a[252:253], v68 offset:45056
    ds_read_b64_tr_b16 a[254:255], v68 offset:46080
    s_waitcnt lgkmcnt(0)
    s_waitcnt vmcnt(17)
    s_barrier
    s_add_u32 s32, s39, 0x300000
    buffer_load_dword v86, v77, s[8:11], s32 offen
    s_add_u32 s32, s35, 0x300000
    s_add_u32 m0, s36, 8192
    s_nop 0
    buffer_load_dwordx4 v65, s[8:11], s32 offen lds
    s_add_u32 s32, s35, 0x304000
    s_add_u32 m0, s36, 9216
    s_nop 0
    buffer_load_dwordx4 v65, s[8:11], s32 offen lds
    s_add_u32 s32, s35, 0x310000
    s_add_u32 m0, s36, 10240
    s_nop 0
    buffer_load_dwordx4 v65, s[8:11], s32 offen lds
    s_add_u32 s32, s35, 0x314000
    s_add_u32 m0, s36, 11264
    s_nop 0
    buffer_load_dwordx4 v65, s[8:11], s32 offen lds
    s_add_u32 s32, s35, 0x320000
    s_add_u32 m0, s36, 12288
    s_nop 0
    buffer_load_dwordx4 v65, s[8:11], s32 offen lds
    s_add_u32 s32, s35, 0x324000
    s_add_u32 m0, s36, 13312
    s_nop 0
    buffer_load_dwordx4 v65, s[8:11], s32 offen lds
    s_add_u32 s32, s35, 0x330000
    s_add_u32 m0, s36, 14336
    s_nop 0
    buffer_load_dwordx4 v65, s[8:11], s32 offen lds
    s_add_u32 s32, s35, 0x334000
    s_add_u32 m0, s36, 15360
    s_nop 0
    buffer_load_dwordx4 v65, s[8:11], s32 offen lds
    v_readlane_b32 s48, v72, 0
    v_readlane_b32 s49, v72, 1
    v_readlane_b32 s50, v72, 2
    v_readlane_b32 s51, v72, 3
    v_readlane_b32 s52, v72, 4
    v_readlane_b32 s53, v72, 5
    v_readlane_b32 s54, v72, 6
    v_readlane_b32 s55, v72, 7
    v_readlane_b32 s38, v72, 8
    s_nop 3
    s_add_u32 s33, s48, s49
    s_add_u32 s33, s33, s50
    s_add_u32 s33, s33, s51
    s_add_u32 s33, s33, s52
    s_add_u32 s33, s33, s53
    s_add_u32 s33, s33, s54
    s_add_u32 s33, s33, s55
    s_cmp_ge_u32 s38, 4
    s_cselect_b32 s33, s33, 0
    s_cmp_ge_u32 s33, 256
    s_cselect_b32 s38, 0, 1
    ds_read_b64_tr_b16 v[192:193], v80 offset:16384
    ds_read_b64_tr_b16 v[194:195], v80 offset:17408
    ds_read_b64_tr_b16 v[196:197], v80 offset:20480
    ds_read_b64_tr_b16 v[198:199], v80 offset:21504
    ds_read_b64_tr_b16 v[208:209], v81 offset:16384
    ds_read_b64_tr_b16 v[210:211], v81 offset:17408
    ds_read_b64_tr_b16 v[212:213], v81 offset:20480
    ds_read_b64_tr_b16 v[214:215], v81 offset:21504
    ds_read_b64_tr_b16 v[224:225], v82 offset:16384
    ds_read_b64_tr_b16 v[226:227], v82 offset:17408
    ds_read_b64_tr_b16 v[228:229], v82 offset:20480
    ds_read_b64_tr_b16 v[230:231], v82 offset:21504
    ds_read_b64_tr_b16 v[240:241], v83 offset:16384
    ds_read_b64_tr_b16 v[242:243], v83 offset:17408
    ds_read_b64_tr_b16 v[244:245], v83 offset:20480
    ds_read_b64_tr_b16 v[246:247], v83 offset:21504
    s_waitcnt lgkmcnt(0)
    s_waitcnt vmcnt(18)
    s_barrier
    s_mov_b32 s8, s46
    s_and_b32 s9, s47, 0xffff
    s_mov_b32 s10, 0x800000
    s_mov_b32 s11, 0x20000
    s_xor_b32 s32, s3, 0x20000
    s_add_u32 m0, s36, 16384
    s_nop 0
    buffer_load_dwordx4 v66, s[8:11], s32 offen lds
    s_xor_b32 s32, s3, 0x21000
    s_add_u32 m0, s36, 17408
    s_nop 0
    buffer_load_dwordx4 v66, s[8:11], s32 offen lds
    s_xor_b32 s32, s3, 0x22000
    s_add_u32 m0, s36, 18432
    s_nop 0
    buffer_load_dwordx4 v66, s[8:11], s32 offen lds
    s_xor_b32 s32, s3, 0x23000
    s_add_u32 m0, s36, 19456
    s_nop 0
    buffer_load_dwordx4 v66, s[8:11], s32 offen lds
    s_xor_b32 s32, s3, 0x24000
    s_add_u32 m0, s36, 20480
    s_nop 0
    buffer_load_dwordx4 v66, s[8:11], s32 offen lds
    s_xor_b32 s32, s3, 0x25000
    s_add_u32 m0, s36, 21504
    s_nop 0
    buffer_load_dwordx4 v66, s[8:11], s32 offen lds
    s_xor_b32 s32, s3, 0x26000
    s_add_u32 m0, s36, 22528
    s_nop 0
    buffer_load_dwordx4 v66, s[8:11], s32 offen lds
    s_xor_b32 s32, s3, 0x27000
    s_add_u32 m0, s36, 23552
    s_nop 0
    buffer_load_dwordx4 v66, s[8:11], s32 offen lds
    ds_read_b64_tr_b16 v[200:201], v80 offset:24576
    ds_read_b64_tr_b16 v[202:203], v80 offset:25600
    ds_read_b64_tr_b16 v[204:205], v80 offset:28672
    ds_read_b64_tr_b16 v[206:207], v80 offset:29696
    ds_read_b64_tr_b16 v[216:217], v81 offset:24576
    ds_read_b64_tr_b16 v[218:219], v81 offset:25600
    ds_read_b64_tr_b16 v[220:221], v81 offset:28672
    ds_read_b64_tr_b16 v[222:223], v81 offset:29696
    ds_read_b64_tr_b16 v[232:233], v82 offset:24576
    ds_read_b64_tr_b16 v[234:235], v82 offset:25600
    ds_read_b64_tr_b16 v[236:237], v82 offset:28672
    ds_read_b64_tr_b16 v[238:239], v82 offset:29696
    ds_read_b64_tr_b16 v[248:249], v83 offset:24576
    ds_read_b64_tr_b16 v[250:251], v83 offset:25600
    ds_read_b64_tr_b16 v[252:253], v83 offset:28672
    ds_read_b64_tr_b16 v[254:255], v83 offset:29696
    s_waitcnt lgkmcnt(0)
    s_waitcnt vmcnt(17)
    s_barrier
    s_xor_b32 s32, s3, 0x30000
    s_add_u32 m0, s36, 24576
    s_nop 0
    buffer_load_dwordx4 v66, s[8:11], s32 offen lds
    s_xor_b32 s32, s3, 0x31000
    s_add_u32 m0, s36, 25600
    s_nop 0
    buffer_load_dwordx4 v66, s[8:11], s32 offen lds
    s_xor_b32 s32, s3, 0x32000
    s_add_u32 m0, s36, 26624
    s_nop 0
    buffer_load_dwordx4 v66, s[8:11], s32 offen lds
    s_xor_b32 s32, s3, 0x33000
    s_add_u32 m0, s36, 27648
    s_nop 0
    buffer_load_dwordx4 v66, s[8:11], s32 offen lds
    s_xor_b32 s32, s3, 0x34000
    s_add_u32 m0, s36, 28672
    s_nop 0
    buffer_load_dwordx4 v66, s[8:11], s32 offen lds
    s_xor_b32 s32, s3, 0x35000
    s_add_u32 m0, s36, 29696
    s_nop 0
    buffer_load_dwordx4 v66, s[8:11], s32 offen lds
    s_xor_b32 s32, s3, 0x36000
    s_add_u32 m0, s36, 30720
    s_nop 0
    buffer_load_dwordx4 v66, s[8:11], s32 offen lds
    s_xor_b32 s32, s3, 0x37000
    s_add_u32 m0, s36, 31744
    s_nop 0
    buffer_load_dwordx4 v66, s[8:11], s32 offen lds
    ds_read_b64_tr_b16 v[0:1], v69 offset:0
    ds_read_b64_tr_b16 v[2:3], v69 offset:1024
    ds_read_b64_tr_b16 v[4:5], v69 offset:4096
    ds_read_b64_tr_b16 v[6:7], v69 offset:5120
    ds_read_b64_tr_b16 v[8:9], v69 offset:32768
    ds_read_b64_tr_b16 v[10:11], v69 offset:33792
    ds_read_b64_tr_b16 v[12:13], v69 offset:36864
    ds_read_b64_tr_b16 v[14:15], v69 offset:37888
    ds_read_b64_tr_b16 v[16:17], v70 offset:0
    ds_read_b64_tr_b16 v[18:19], v70 offset:1024
    ds_read_b64_tr_b16 v[20:21], v70 offset:4096
    ds_read_b64_tr_b16 v[22:23], v70 offset:5120
    ds_read_b64_tr_b16 v[24:25], v70 offset:32768
    ds_read_b64_tr_b16 v[26:27], v70 offset:33792
    ds_read_b64_tr_b16 v[28:29], v70 offset:36864
    ds_read_b64_tr_b16 v[30:31], v70 offset:37888
    s_waitcnt lgkmcnt(0)
    v_and_b32 v64, 15, v94
    v_lshrrev_b32 v65, 4, v94
    v_mov_b32 v66, 0x3c00
    v_mov_b32 v67, 0x3c000000
    v_cmp_eq_u32 vcc, 0, v64
    s_nop 1
    v_cndmask_b32 v127, 0, v66, vcc
    v_cmp_eq_u32 vcc, 1, v64
    s_nop 1
    v_cndmask_b32 v106, v127, v67, vcc
    v_cmp_eq_u32 vcc, 2, v64
    s_nop 1
    v_cndmask_b32 v127, 0, v66, vcc
    v_cmp_eq_u32 vcc, 3, v64
    s_nop 1
    v_cndmask_b32 v107, v127, v67, vcc
    v_cmp_eq_u32 vcc, 4, v64
    s_nop 1
    v_cndmask_b32 v127, 0, v66, vcc
    v_cmp_eq_u32 vcc, 5, v64
    s_nop 1
    v_cndmask_b32 v108, v127, v67, vcc
    v_cmp_eq_u32 vcc, 6, v64
    s_nop 1
    v_cndmask_b32 v127, 0, v66, vcc
    v_cmp_eq_u32 vcc, 7, v64
    s_nop 1
    v_cndmask_b32 v109, v127, v67, vcc
    v_mov_b32 v66, 0x3f80
    v_mov_b32 v67, 0x3f800000
    v_and_b32 v126, 1, v65
    v_lshrrev_b32 v68, 1, v65
    v_lshl_add_u32 v126, v126, 2, v68
    v_sub_u32 v68, v64, v126
    v_cmp_eq_u32 vcc, 0, v68
    s_nop 1
    v_cndmask_b32 v127, 0, v66, vcc
    v_cmp_eq_u32 vcc, 2, v68
    s_nop 1
    v_cndmask_b32 v102, v127, v67, vcc
    v_cmp_eq_u32 vcc, 0, v68
    s_nop 1
    v_cndmask_b32 v127, 0, v66, vcc
    v_cmp_eq_u32 vcc, 2, v68
    s_nop 1
    v_cndmask_b32 v103, v127, v67, vcc
    v_cmp_eq_u32 vcc, 8, v68
    s_nop 1
    v_cndmask_b32 v127, 0, v66, vcc
    v_cmp_eq_u32 vcc, 10, v68
    s_nop 1
    v_cndmask_b32 v104, v127, v67, vcc
    v_cmp_eq_u32 vcc, 8, v68
    s_nop 1
    v_cndmask_b32 v127, 0, v66, vcc
    v_cmp_eq_u32 vcc, 10, v68
    s_nop 1
    v_cndmask_b32 v105, v127, v67, vcc
    v_mov_b32 v100, 0x3f003f00
    v_mov_b32 v101, 0x3f003f00
    v_and_b32 v126, 7, v64
    v_lshlrev_b32 v126, 4, v126
    v_lshl_add_u32 v114, v65, 7, v126
    v_lshrrev_b32 v126, 3, v64
    v_lshl_add_u32 v119, v126, 3, v114
    v_lshl_add_u32 v118, v126, 11, v114
    v_lshl_add_u32 v118, s14, 9, v118
    v_lshlrev_b32 v126, 4, v64
    v_lshl_add_u32 v120, v65, 13, v126
    v_lshlrev_b32 v123, 3, v94
    s_lshl_b32 s32, s14, 10
    s_add_u32 s32, s32, 16384
    v_and_b32 v126, 32, v94
    v_lshlrev_b32 v126, 1, v126
    v_xor_b32 v126, v126, v123
    v_add_u32 v124, s32, v126
    v_lshrrev_b32 v126, 2, v64
    v_lshrrev_b32 v127, 1, v65
    v_lshl_add_u32 v126, v126, 1, v127
    v_and_b32 v127, 3, v64
    v_lshl_add_u32 v126, v126, 2, v127
    v_and_b32 v127, 1, v65
    v_lshl_add_u32 v126, v126, 1, v127
    v_lshlrev_b32 v126, 3, v126
    v_mov_b32 v95, 0x7f000000
    v_mov_b32 v66, 0x4444
    v_mov_b32 v67, 0xeeee
    v_cmp_gt_u32 vcc, 8, v64
    s_nop 1
    v_cndmask_b32 v122, v95, v126, vcc
    v_cndmask_b32 v125, v114, v95, vcc
    v_cndmask_b32 v110, v67, v66, vcc
    v_lshrrev_b32 v126, 2, v94
    v_lshlrev_b32 v126, 3, v126
    v_and_b32 v127, 2, v94
    v_lshlrev_b32 v127, 5, v127
    v_xor_b32 v126, v126, v127
    v_and_b32 v127, 3, v94
    v_lshl_add_u32 v115, v127, 7, v126
    s_mov_b32 s37, 0x3f80
    s_mov_b32 s57, 0x3f800000
    s_and_b32 s32, s14, 1
    s_lshr_b32 s33, s14, 1
    s_lshl2_add_u32 s32, s32, s33
    s_lshl_b32 s59, s32, 9
    s_mov_b32 s17, 0
    s_mov_b32 s0, 0x00ff00ff
    s_mov_b32 s1, s0
    s_mov_b64 s[44:45], s[0:1]
    s_lshl_b32 s32, s12, 18
    s_lshl2_add_u32 s33, s13, s14
    s_lshl_b32 s34, s33, 11
    s_add_u32 s28, s34, 0x2800000
    s_add_u32 s21, s32, s34
    s_add_u32 s21, s21, 0x6c00000
    s_lshl_b32 s34, s13, 8
    s_add_u32 s23, s32, s34
    s_add_u32 s23, s23, 0x6c80000
    s_lshl_b32 s32, s12, 13
    s_add_u32 s25, s32, 0x6d00000
    s_add_u32 s24, s25, s34
    s_lshl_b32 s34, s33, 9
    s_add_u32 s26, s34, 0x8000000
    s_add_u32 s31, s34, 0x6e00000
    s_cmp_eq_u32 s12, 0
    s_cselect_b32 s26, s26, s31
    s_lshl_b32 s32, s12, 7
    s_add_u32 s32, s32, s33
    s_cmp_eq_u32 s32, 1
    s_mov_b32 s39, 0x7f000000
    s_cselect_b32 s39, 0x841ec04, s39
    s_lshl_b32 s27, s13, 12
    s_lshl_b32 s36, s14, 11
    s_and_b32 s33, s36, 2048
    s_add_u32 s27, s27, s33
    s_lshr_b32 s33, s14, 1
    s_lshl_b32 s33, s33, 17
    s_add_u32 s27, s27, s33
    s_add_u32 s27, s27, 0x1800000
    s_add_u32 s36, s36, 24576
    v_add_u32 v112, 24576, v116
    s_lshl_b32 s32, s12, 12
    s_add_u32 s32, s32, 0x841c000
    s_lshl2_add_u32 s46, s13, s32
    v_lshl_add_u32 v117, v123, 25, v114
    s_and_b32 s33, s13, 3
    s_lshl_b32 s33, s33, 7
    s_add_u32 s47, s32, s33
    s_cmp_eq_u32 s14, 0
    s_cselect_b32 s47, s47, 0x7f000000
    s_cselect_b32 s11, -1, 0
    s_mov_b32 s30, 0x3e0293ee
    v_mov_b32 v121, 0x7f000000
    v_and_b32 v127, 1, v94
    s_mov_b32 exec_lo, 0
    s_mov_b32 exec_hi, 0x300
    s_lshl_b32 s32, s13, 8
    s_add_u32 s32, s32, 0x8406000
    v_lshl_add_u32 v121, v127, 13, s32
    s_mov_b32 exec_hi, 0x3c00
    s_mov_b32 s32, 0x841760c
    v_lshl_add_u32 v121, v64, 8, s32
    s_mov_b64 exec, -1
    s_waitcnt vmcnt(16)
    s_barrier
    ds_write_b128 v113, v[0:3] offset:0
    ds_write_b128 v113, v[4:7] offset:1024
    ds_write_b128 v113, v[8:11] offset:2048
    ds_write_b128 v113, v[12:15] offset:3072
    ds_write_b128 v113, v[16:19] offset:4096
    ds_write_b128 v113, v[20:23] offset:5120
    ds_write_b128 v113, v[24:27] offset:6144
    ds_write_b128 v113, v[28:31] offset:7168
    ds_read_b64_tr_b16 v[32:33], v69 offset:8192
    ds_read_b64_tr_b16 v[34:35], v69 offset:9216
    ds_read_b64_tr_b16 v[36:37], v69 offset:12288
    ds_read_b64_tr_b16 v[38:39], v69 offset:13312
    ds_read_b64_tr_b16 v[40:41], v69 offset:40960
    ds_read_b64_tr_b16 v[42:43], v69 offset:41984
    ds_read_b64_tr_b16 v[44:45], v69 offset:45056
    ds_read_b64_tr_b16 v[46:47], v69 offset:46080
    ds_read_b64_tr_b16 v[48:49], v70 offset:8192
    ds_read_b64_tr_b16 v[50:51], v70 offset:9216
    ds_read_b64_tr_b16 v[52:53], v70 offset:12288
    ds_read_b64_tr_b16 v[54:55], v70 offset:13312
    ds_read_b64_tr_b16 v[56:57], v70 offset:40960
    ds_read_b64_tr_b16 v[58:59], v70 offset:41984
    ds_read_b64_tr_b16 v[60:61], v70 offset:45056
    ds_read_b64_tr_b16 v[62:63], v70 offset:46080
    s_waitcnt lgkmcnt(0)
    s_waitcnt vmcnt(8)
    s_barrier
    ds_write_b128 v113, v[32:35] offset:8192
    ds_write_b128 v113, v[36:39] offset:9216
    ds_write_b128 v113, v[40:43] offset:10240
    ds_write_b128 v113, v[44:47] offset:11264
    ds_write_b128 v113, v[48:51] offset:12288
    ds_write_b128 v113, v[52:55] offset:13312
    ds_write_b128 v113, v[56:59] offset:14336
    ds_write_b128 v113, v[60:63] offset:15360
    buffer_load_dword v76, v74, s[4:7], 0 offen sc1
    buffer_load_dword v79, v75, s[4:7], 0 offen sc1
    ds_read_b64_tr_b16 v[0:1], v80 offset:16384
    ds_read_b64_tr_b16 v[2:3], v80 offset:17408
    ds_read_b64_tr_b16 v[4:5], v80 offset:20480
    ds_read_b64_tr_b16 v[6:7], v80 offset:21504
    ds_read_b64_tr_b16 v[8:9], v81 offset:16384
    ds_read_b64_tr_b16 v[10:11], v81 offset:17408
    ds_read_b64_tr_b16 v[12:13], v81 offset:20480
    ds_read_b64_tr_b16 v[14:15], v81 offset:21504
    ds_read_b64_tr_b16 v[16:17], v82 offset:16384
    ds_read_b64_tr_b16 v[18:19], v82 offset:17408
    ds_read_b64_tr_b16 v[20:21], v82 offset:20480
    ds_read_b64_tr_b16 v[22:23], v82 offset:21504
    ds_read_b64_tr_b16 v[24:25], v83 offset:16384
    ds_read_b64_tr_b16 v[26:27], v83 offset:17408
    ds_read_b64_tr_b16 v[28:29], v83 offset:20480
    ds_read_b64_tr_b16 v[30:31], v83 offset:21504
    s_waitcnt lgkmcnt(0)
    ds_write_b128 v113, v[0:3] offset:16384
    ds_write_b128 v113, v[4:7] offset:17408
    ds_write_b128 v113, v[8:11] offset:18432
    ds_write_b128 v113, v[12:15] offset:19456
    ds_write_b128 v113, v[16:19] offset:20480
    ds_write_b128 v113, v[20:23] offset:21504
    ds_write_b128 v113, v[24:27] offset:22528
    ds_write_b128 v113, v[28:31] offset:23552
    s_waitcnt lgkmcnt(0)
    s_waitcnt vmcnt(2)
    s_waitcnt vmcnt(0)
    v_min_u32 v76, v76, v79
    v_cmp_eq_u32 vcc, 0, v76
    s_cmp_eq_u32 s38, 0
    s_cbranch_scc0 main_kernel_c_sl0
    s_cbranch_vccnz main_kernel_c_sl1
    s_branch main_kernel_c_kv0_ok
main_kernel_c_sl0:
    v_and_b32 v126, 7, v94
    v_lshlrev_b32 v126, 5, v126
main_kernel_c_mode_cnt:
    buffer_load_dword v127, v126, s[60:63], 0 offen sc1
    s_waitcnt vmcnt(0)
    v_readlane_b32 s48, v127, 0
    v_readlane_b32 s49, v127, 1
    v_readlane_b32 s50, v127, 2
    v_readlane_b32 s51, v127, 3
    v_readlane_b32 s52, v127, 4
    v_readlane_b32 s53, v127, 5
    v_readlane_b32 s54, v127, 6
    v_readlane_b32 s55, v127, 7
    s_nop 3
    s_add_u32 s33, s48, s49
    s_add_u32 s33, s33, s50
    s_add_u32 s33, s33, s51
    s_add_u32 s33, s33, s52
    s_add_u32 s33, s33, s53
    s_add_u32 s33, s33, s54
    s_add_u32 s33, s33, s55
    s_cmp_ge_u32 s33, 256
    s_cbranch_scc1 main_kernel_c_mode_cnt_ok
    s_sub_u32 s29, s29, 1
    s_cbranch_scc1 main_kernel_end
    s_sleep 4
    s_branch main_kernel_c_mode_cnt
main_kernel_c_mode_cnt_ok:
    v_mov_b32 v126, 0
main_kernel_c_wa:
    buffer_load_dword v127, v126, s[60:63], 0 offen offset:12 sc1
    s_waitcnt vmcnt(0)
    v_cmp_gt_u32 vcc, 4, v127
    s_cbranch_vccz main_kernel_c_wa_ok
    s_sleep 4
    s_sub_u32 s29, s29, 1
    s_cbranch_scc0 main_kernel_c_wa
    s_branch main_kernel_end
main_kernel_c_wa_ok:
main_kernel_c_sl1:
    v_lshlrev_b32 v126, 2, v94
    s_mov_b32 s32, 0x841f000
main_kernel_c_wf:
    buffer_load_dword v0, v126, s[4:7], s32 offen sc1
    s_waitcnt vmcnt(0)
    v_cmp_eq_u32 vcc, 0, v0
    s_cbranch_vccz main_kernel_c_wf_ok
    s_sleep 4
    s_sub_u32 s29, s29, 1
    s_cbranch_scc0 main_kernel_c_wf
    s_branch main_kernel_end
main_kernel_c_wf_ok:
    s_mov_b32 exec_lo, 0
    s_mov_b32 exec_hi, 0x300
    v_subrev_u32 v127, 0, v121
main_kernel_c_kv0:
    buffer_load_dword v126, v127, s[4:7], 0 offen sc1
    s_waitcnt vmcnt(0)
    v_cmp_eq_u32 vcc, 0, v126
    s_cbranch_vccz main_kernel_c_kv0_ok
    s_sleep 2
    s_sub_u32 s29, s29, 1
    s_cbranch_scc0 main_kernel_c_kv0
    s_branch main_kernel_end
main_kernel_c_kv0_ok:
    s_mov_b32 exec_lo, 0
    s_mov_b32 exec_hi, 0x100
    v_add_u32 v121, 4, v121
    s_mov_b64 exec, -1
    v_add_u32 v121, 4, v121
    v_lshlrev_b32 v126, 3, v116
    v_and_b32 v126, 0x780, v126
    s_mov_b32 m0, s36
    buffer_load_dword v111, v126, s[4:7], s21 offen sc1
    buffer_load_dwordx4 v116, s[4:7], s27 offen offset:0 sc1 lds
    buffer_load_dwordx4 v116, s[4:7], s27 offen offset:1024 sc1 lds
    s_lshl_b32 s32, s14, 11
    s_add_u32 m0, s32, 0
    s_add_u32 s32, s32, s25
    buffer_load_dwordx4 v116, s[4:7], s32 offen offset:0 sc1 lds
    buffer_load_dwordx4 v116, s[4:7], s32 offen offset:1024 sc1 lds
    s_add_u32 s27, s27, 0x40000
    ds_read_b64_tr_b16 v[32:33], v80 offset:24576
    ds_read_b64_tr_b16 v[34:35], v80 offset:25600
    ds_read_b64_tr_b16 v[36:37], v80 offset:28672
    ds_read_b64_tr_b16 v[38:39], v80 offset:29696
    ds_read_b64_tr_b16 v[40:41], v81 offset:24576
    ds_read_b64_tr_b16 v[42:43], v81 offset:25600
    ds_read_b64_tr_b16 v[44:45], v81 offset:28672
    ds_read_b64_tr_b16 v[46:47], v81 offset:29696
    ds_read_b64_tr_b16 v[48:49], v82 offset:24576
    ds_read_b64_tr_b16 v[50:51], v82 offset:25600
    ds_read_b64_tr_b16 v[52:53], v82 offset:28672
    ds_read_b64_tr_b16 v[54:55], v82 offset:29696
    ds_read_b64_tr_b16 v[56:57], v83 offset:24576
    ds_read_b64_tr_b16 v[58:59], v83 offset:25600
    ds_read_b64_tr_b16 v[60:61], v83 offset:28672
    ds_read_b64_tr_b16 v[62:63], v83 offset:29696
    s_waitcnt lgkmcnt(0)
    ds_write_b128 v113, v[32:35] offset:24576
    ds_write_b128 v113, v[36:39] offset:25600
    ds_write_b128 v113, v[40:43] offset:26624
    ds_write_b128 v113, v[44:47] offset:27648
    ds_write_b128 v113, v[48:51] offset:28672
    ds_write_b128 v113, v[52:55] offset:29696
    ds_write_b128 v113, v[56:59] offset:30720
    ds_write_b128 v113, v[60:63] offset:31744
    s_waitcnt lgkmcnt(0)
main_kernel_c_nb:
    v_readfirstlane_b32 s33, v84
    v_readfirstlane_b32 s32, v85
    s_nop 3
    s_and_b32 s34, s32, s33
    s_cbranch_scc1 main_kernel_c_nb_ok
    buffer_load_dwordx2 v[84:85], off, s[60:63], 0 offset:16 sc1
    s_sub_u32 s29, s29, 1
    s_cbranch_scc1 main_kernel_end
    s_waitcnt vmcnt(0)
    s_branch main_kernel_c_nb
main_kernel_c_nb_ok:
    s_and_b32 s33, s33, 1
    s_lshl_b32 s32, s12, 5
    s_add_u32 s32, s32, s13
    s_lshl1_add_u32 s32, s32, s33
    s_lshl2_add_u32 s32, s32, s14
    s_lshl_b32 s32, s32, 11
    s_add_u32 s18, s32, 0x8c00000
    s_xor_b32 s19, s18, 0x80000
    v_mov_b32 v64, 0
    v_mov_b32 v65, 0
    v_mov_b32 v66, 0
    v_mov_b32 v67, 0
    v_mov_b32 v68, 0
    v_mov_b32 v69, 0
    v_mov_b32 v70, 0
    v_mov_b32 v71, 0
    v_mov_b32 v96, 0
    v_mov_b32 v97, 0
    v_mov_b32 v98, 0
    v_mov_b32 v99, 0
    s_xor_b32 s36, s36, 0x4000
    s_waitcnt vmcnt(0)
    buffer_store_dword v64, off, s[4:7], s18 offset:1536 sc1
    s_mov_b32 m0, s36
    buffer_load_dwordx4 v[88:91], v116, s[4:7], s28 offen offset:0 sc1
    buffer_load_dwordx4 v116, s[4:7], s27 offen offset:0 sc1 lds
    buffer_load_dwordx4 v[92:95], v116, s[4:7], s28 offen offset:1024 sc1
    s_barrier
    s_memrealtime s[32:33]
    s_waitcnt lgkmcnt(0)
    s_mul_i32 s32, s32, 22
    s_sub_u32 s20, s32, 0x40000
    s_mov_b32 s9, 0
    s_mov_b32 s10, 0
    s_memtime s[52:53]
    s_waitcnt lgkmcnt(0)
    s_sub_u32 s38, s52, s32
    s_sub_u32 s3, s52, 0x4000
    v_mov_b32 v126, s38
    ds_write_b32 v123, v126 offset:20992
    s_waitcnt lgkmcnt(0)
    s_min_u32 s32, s48, s49
    s_cmp_ge_u32 s32, 32
    s_cbranch_scc0 main_kernel_cs_top
    .p2align 6
main_kernel_cf_top:
    s_barrier
main_kernel_cf_mrd:
    ds_read_b128 v[0:3], v114 offset:0
    ds_read_b128 v[4:7], v114 offset:512
    ds_read_b128 v[8:11], v114 offset:1024
    ds_read_b128 v[12:15], v114 offset:1536
    ds_read_b128 v[16:19], v114 offset:2048
    s_waitcnt lgkmcnt(4)
    v_smfmac_f32_16x16x64_bf16 v[96:99], v[0:3], a[0:7], v110
    ds_read_b128 v[20:23], v114 offset:2560
    s_waitcnt lgkmcnt(4)
    v_smfmac_f32_16x16x64_bf16 v[96:99], v[4:7], a[8:15], v110
    ds_read_b128 v[24:27], v114 offset:3072
    s_waitcnt lgkmcnt(4)
    s_bfe_u32 s22, s17, 0x10001
    v_smfmac_f32_16x16x64_bf16 v[96:99], v[8:11], a[16:23], v110
    ds_read_b128 v[28:31], v114 offset:3584
    s_waitcnt lgkmcnt(4)
    v_smfmac_f32_16x16x64_bf16 v[96:99], v[12:15], a[24:31], v110
    ds_read_b128 v[32:35], v114 offset:4096
    s_waitcnt lgkmcnt(4)
    v_smfmac_f32_16x16x64_bf16 v[96:99], v[16:19], a[32:39], v110
    ds_read_b128 v[36:39], v114 offset:4608
    s_waitcnt lgkmcnt(4)
    v_smfmac_f32_16x16x64_bf16 v[96:99], v[20:23], a[40:47], v110
    ds_read_b128 v[40:43], v114 offset:5120
    s_waitcnt lgkmcnt(4)
    v_smfmac_f32_16x16x64_bf16 v[96:99], v[24:27], a[48:55], v110
    ds_read_b128 v[44:47], v114 offset:5632
    s_waitcnt lgkmcnt(4)
    v_smfmac_f32_16x16x64_bf16 v[96:99], v[28:31], a[56:63], v110
    ds_read_b128 v[48:51], v114 offset:6144
    s_waitcnt lgkmcnt(4)
    v_smfmac_f32_16x16x64_bf16 v[96:99], v[32:35], a[64:71], v110
    ds_read_b128 v[52:55], v114 offset:6656
    s_waitcnt lgkmcnt(4)
    v_smfmac_f32_16x16x64_bf16 v[96:99], v[36:39], a[72:79], v110
    ds_read_b128 v[56:59], v114 offset:7168
    s_waitcnt lgkmcnt(4)
    v_smfmac_f32_16x16x64_bf16 v[96:99], v[40:43], a[80:87], v110
    ds_read_b128 v[60:63], v114 offset:7680
    s_waitcnt lgkmcnt(4)
    v_smfmac_f32_16x16x64_bf16 v[96:99], v[44:47], a[88:95], v110
    s_waitcnt lgkmcnt(3)
    buffer_load_dword v111, v121, s[4:7], 0 offen sc1
    v_smfmac_f32_16x16x64_bf16 v[96:99], v[48:51], a[96:103], v110
    s_waitcnt lgkmcnt(2)
    ds_read_b128 v[80:83], v113 offset:0
    v_smfmac_f32_16x16x64_bf16 v[96:99], v[52:55], a[104:111], v110
    s_waitcnt lgkmcnt(2)
    ds_read_b128 v[84:87], v113 offset:1024
    v_smfmac_f32_16x16x64_bf16 v[96:99], v[56:59], a[112:119], v110
    s_waitcnt lgkmcnt(2)
    v_smfmac_f32_16x16x64_bf16 v[96:99], v[60:63], a[120:127], v110
    v_smfmac_f32_16x16x64_bf16 v[68:71], v[0:3], a[128:135], v110
    ds_read_b128 v[72:75], v113 offset:2048
    v_smfmac_f32_16x16x64_bf16 v[68:71], v[4:7], a[136:143], v110
    s_nop 1
    v_pk_add_f32 v[126:127], v[96:97], v[98:99]
    ds_read_b128 v[76:79], v113 offset:3072
    v_smfmac_f32_16x16x64_bf16 v[68:71], v[8:11], a[144:151], v110
    v_cmp_u_f32 vcc, v126, v127
    v_smfmac_f32_16x16x64_bf16 v[68:71], v[12:15], a[152:159], v110
    v_cvt_pk_bf16_f32 v126, v96, v97
    v_smfmac_f32_16x16x64_bf16 v[68:71], v[16:19], a[160:167], v110
    v_cvt_pk_bf16_f32 v127, v98, v99
    s_and_b64 s[42:43], vcc, s[44:45]
    s_cbranch_scc1 main_kernel_cf_m_f
    v_smfmac_f32_16x16x64_bf16 v[68:71], v[20:23], a[168:175], v110
    v_bfi_b32 v126, 1, s22, v126
    buffer_store_dwordx2 v[126:127], v123, s[4:7], s18 offen sc1
    v_smfmac_f32_16x16x64_bf16 v[68:71], v[24:27], a[176:183], v110
    s_mov_b64 s[44:45], s[0:1]
    v_smfmac_f32_16x16x64_bf16 v[68:71], v[28:31], a[184:191], v110
    s_add_u32 s17, s17, 1
    s_bfe_u32 s40, s17, 0x10001
    v_smfmac_f32_16x16x64_bf16 v[68:71], v[32:35], a[192:199], v110
    s_add_u32 s28, s28, 0x40000
    s_mov_b32 m0, s36
    v_smfmac_f32_16x16x64_bf16 v[68:71], v[36:39], a[200:207], v110
    s_add_u32 s34, s3, 2100
    v_smfmac_f32_16x16x64_bf16 v[68:71], v[40:43], a[208:215], v110
    v_smfmac_f32_16x16x64_bf16 v[68:71], v[44:47], a[216:223], v110
    v_smfmac_f32_16x16x64_bf16 v[68:71], v[48:51], a[224:231], v110
    v_smfmac_f32_16x16x64_bf16 v[68:71], v[52:55], a[232:239], v110
    v_smfmac_f32_16x16x64_bf16 v[68:71], v[56:59], a[240:247], v110
    v_smfmac_f32_16x16x64_bf16 v[68:71], v[60:63], a[248:255], v110
    s_waitcnt lgkmcnt(2)
    v_smfmac_f32_16x16x64_bf16 v[64:67], v[32:35], v[80:87], v110
    s_waitcnt lgkmcnt(0)
    s_nop 3
    v_cvt_pk_bf16_f32 v126, v68, v69
    v_cvt_pk_bf16_f32 v127, v70, v71
    v_bfi_b32 v126, 1, s22, v126
    buffer_store_dwordx2 v[126:127], v123, s[4:7], s18 offen offset:512 sc1
    ds_read_b128 v[80:83], v113 offset:4096
    v_smfmac_f32_16x16x64_bf16 v[64:67], v[36:39], v[72:79], v110
    ds_read_b128 v[84:87], v113 offset:5120
    v_smfmac_f32_16x16x64_bf16 v[64:67], v[0:3], v[128:135], v110
    ds_read_b128 v[72:75], v113 offset:6144
    v_smfmac_f32_16x16x64_bf16 v[64:67], v[4:7], v[136:143], v110
    ds_read_b128 v[76:79], v113 offset:7168
    v_smfmac_f32_16x16x64_bf16 v[64:67], v[8:11], v[144:151], v110
    ds_read_b128 v[32:35], v113 offset:8192
    v_smfmac_f32_16x16x64_bf16 v[64:67], v[12:15], v[152:159], v110
    ds_read_b128 v[36:39], v113 offset:9216
    v_smfmac_f32_16x16x64_bf16 v[64:67], v[16:19], v[160:167], v110
    ds_read_b128 v[0:3], v113 offset:10240
    s_memtime s[52:53]
    v_smfmac_f32_16x16x64_bf16 v[64:67], v[20:23], v[168:175], v110
    ds_read_b128 v[4:7], v113 offset:11264
    s_memtime s[52:53]
    s_xor_b32 s32, s9, s22
    s_bitcmp1_b32 s32, 0
    s_cbranch_scc1 main_kernel_cf_t_p
main_kernel_cf_t_ok:
    s_sub_u32 s32, s9, s10
    v_smfmac_f32_16x16x64_bf16 v[64:67], v[24:27], v[176:183], v110
    ds_read_b128 v[8:11], v113 offset:12288
    s_memtime s[52:53]
    s_max_i32 s32, s32, 0
    s_min_i32 s32, s32, 0x4000
    v_smfmac_f32_16x16x64_bf16 v[64:67], v[28:31], v[184:191], v110
    s_waitcnt lgkmcnt(7)
    ds_read_b128 v[12:15], v113 offset:13312
    s_memtime s[52:53]
    s_add_u32 s34, s34, s32
    s_and_b32 s34, s34, s11
    v_smfmac_f32_16x16x64_bf16 v[64:67], v[40:43], v[80:87], v110
    s_waitcnt lgkmcnt(6)
    ds_read_b128 v[16:19], v113 offset:14336
    s_cmp_lt_u32 s52, s34
    s_cbranch_scc1 main_kernel_cf_t_w
main_kernel_cf_t_go:
    s_barrier
    buffer_load_dwordx2 v[126:127], v123, s[4:7], s19 offen offset:0 sc1
    v_smfmac_f32_16x16x64_bf16 v[64:67], v[44:47], v[72:79], v110
    s_waitcnt lgkmcnt(5)
    ds_read_b128 v[20:23], v113 offset:15360
    v_smfmac_f32_16x16x64_bf16 v[64:67], v[48:51], v[32:39], v110
    s_waitcnt lgkmcnt(4)
    v_smfmac_f32_16x16x64_bf16 v[64:67], v[52:55], v[0:7], v110
    s_waitcnt lgkmcnt(2)
    ds_read_b128 v[24:27], v112 offset:6144
    ds_read_b128 v[28:31], v112 offset:7168
    v_smfmac_f32_16x16x64_bf16 v[64:67], v[56:59], v[8:15], v110
    s_waitcnt lgkmcnt(2)
    ds_read_b128 v[0:3], v112 offset:0
    ds_read_b128 v[4:7], v112 offset:1024
    v_smfmac_f32_16x16x64_bf16 v[64:67], v[60:63], v[16:23], v110
    ds_read_b128 v[8:11], v112 offset:2048
    ds_read_b128 v[12:15], v112 offset:3072
    ds_read_b128 v[16:19], v112 offset:4096
    ds_read_b128 v[20:23], v112 offset:5120
    v_mov_b32 v76, 0
    v_mov_b32 v77, 0
    v_mov_b32 v78, 0
    s_nop 0
    v_permlane32_swap_b32 v64, v65
    v_permlane32_swap_b32 v66, v67
    v_cvt_pk_bf16_f32 v84, v64, v66
    v_cvt_pk_bf16_f32 v85, v65, v67
    v_bfi_b32 v84, 1, s22, v84
    buffer_load_dwordx2 v[42:43], v123, s[4:7], s19 offen offset:512 sc1
    v_mov_b32 v79, 0
    v_mov_b32 v80, 0
    v_mov_b32 v81, 0
    v_mov_b32 v82, 0
    v_mov_b32 v83, 0
    v_mov_b32 v60, 0
    v_mov_b32 v60, 0
    v_mov_b32 v60, 0
    v_mov_b32 v60, 0
    v_mov_b32 v60, 0
    v_mov_b32 v60, 0
    v_mov_b32 v60, 0
    buffer_store_dwordx2 v[84:85], v123, s[4:7], s18 offen offset:1024 sc1
    v_mov_b32 v60, 0
    v_mov_b32 v60, 0
    v_mov_b32 v60, 0
    v_mov_b32 v60, 0
    v_mov_b32 v60, 0
    v_mov_b32 v60, 0
    v_mov_b32 v60, 0
    v_mov_b32 v60, 0
    v_mov_b32 v60, 0
    v_mov_b32 v60, 0
    v_mov_b32 v60, 0
    v_mov_b32 v60, 0
    v_mov_b32 v60, 0
    v_mov_b32 v60, 0
    v_mov_b32 v60, 0
    v_mov_b32 v60, 0
    v_mov_b32 v60, 0
    v_mov_b32 v60, 0
    v_mov_b32 v60, 0
    v_mov_b32 v60, 0
    v_mov_b32 v60, 0
    v_mov_b32 v60, 0
    v_mov_b32 v60, 0
    v_mov_b32 v60, 0
    v_mov_b32 v60, 0
    v_mov_b32 v60, 0
    v_mov_b32 v60, 0
    v_mov_b32 v60, 0
    v_mov_b32 v60, 0
    v_mov_b32 v60, 0
    v_mov_b32 v60, 0
    v_mov_b32 v60, 0
    v_mov_b32 v60, 0
    v_mov_b32 v60, 0
    v_mov_b32 v60, 0
    v_mov_b32 v60, 0
    v_mov_b32 v60, 0
    v_mov_b32 v60, 0
    s_waitcnt vmcnt(2)
main_kernel_cf_z0:
    v_dot2_f32_bf16 v44, v126, s37, v96
    v_dot2_f32_bf16 v45, v126, s57, v97
    v_dot2_f32_bf16 v46, v127, s37, v98
    v_dot2_f32_bf16 v47, v127, s57, v99
    v_bitop3_b32 v60, v126, s22, 1 bitop3:0x28
    v_cvt_pk_bf16_f32 v44, v44, v45
    v_cmp_ne_u32 vcc, 0, v60
    v_cvt_pk_bf16_f32 v45, v46, v47
    ds_write_b64 v124, v[44:45] offset:0
    buffer_load_dwordx2 v[64:65], v123, s[4:7], s19 offen offset:512 sc1
    v_cmp_eq_u32 s[42:43], 0, v111
    s_cbranch_vccnz main_kernel_cf_z0_f
    v_mov_b32 v96, 0x3f803f80
    v_mov_b32 v97, 0x3f803f80
    v_mov_b32 v98, 0x3f803f80
    v_mov_b32 v99, 0x3f803f80
    s_and_b32 s32, s43, 0x3f00
    s_cbranch_scc1 main_kernel_cf_kvw
main_kernel_cf_kvok:
    s_waitcnt lgkmcnt(0)
    s_barrier
    ds_read_b64_tr_b16 v[48:49], v115 offset:16384
    ds_read_b64_tr_b16 v[50:51], v115 offset:17408
    ds_read_b64_tr_b16 v[52:53], v115 offset:18432
    ds_read_b64_tr_b16 v[54:55], v115 offset:19456
    s_waitcnt vmcnt(2)
    s_memtime s[52:53]
    v_dot2_f32_bf16 v44, v42, s37, v68
    v_dot2_f32_bf16 v45, v42, s57, v69
    v_dot2_f32_bf16 v46, v43, s37, v70
    v_dot2_f32_bf16 v47, v43, s57, v71
    v_bitop3_b32 v60, v42, s22, 1 bitop3:0x28
    v_cvt_pk_bf16_f32 v44, v44, v45
    v_cmp_ne_u32 vcc, 0, v60
    v_cvt_pk_bf16_f32 v45, v46, v47
    ds_write_b64 v124, v[44:45] offset:512
    s_waitcnt lgkmcnt(3)
    v_mfma_f32_16x16x32_bf16 v[32:35], v[0:3], v[48:51], 0
    v_mfma_f32_16x16x32_bf16 v[36:39], v[16:19], v[48:51], 0
    s_cbranch_vccnz main_kernel_cf_z1_f
main_kernel_cf_z_ok:
    v_mfma_f32_16x16x32_bf16 v[72:75], v[48:51], v[48:51], 0
    s_waitcnt lgkmcnt(1)
    s_sub_u32 s32, s52, s38
    v_mov_b32 v46, s32
    v_mfma_f32_16x16x32_bf16 v[32:35], v[4:7], v[52:55], v[32:35]
    buffer_load_dwordx2 v[86:87], v123, s[4:7], s19 offen offset:1024 sc1
    buffer_store_dword v46, v117, s[4:7], s46 offen
    s_cmp_eq_u32 s17, 64
    s_waitcnt lgkmcnt(0)
    s_barrier
    ds_read_b64_tr_b16 v[56:57], v115 offset:16896
    ds_read_b64_tr_b16 v[58:59], v115 offset:17920
    ds_read_b64_tr_b16 v[60:61], v115 offset:18944
    ds_read_b64_tr_b16 v[62:63], v115 offset:19968
    s_cbranch_scc1 main_kernel_cf_last
    v_bfe_u32 v47, v123, 1, 7
    buffer_load_dwordx2 v[126:127], v123, s[4:7], s19 offen offset:1024 sc1
    buffer_load_dwordx4 v116, s[4:7], s27 offen offset:1024 sc1 lds
    v_mfma_f32_16x16x32_bf16 v[36:39], v[20:23], v[52:55], v[36:39]
    v_mfma_f32_16x16x32_bf16 v[72:75], v[52:55], v[52:55], v[72:75]
    s_waitcnt lgkmcnt(2)
    v_mfma_f32_16x16x32_bf16 v[72:75], v[56:59], v[56:59], v[72:75]
    v_mfma_f32_16x16x32_bf16 v[32:35], v[8:11], v[56:59], v[32:35]
    s_waitcnt lgkmcnt(0)
    v_mfma_f32_16x16x32_bf16 v[72:75], v[60:63], v[60:63], v[72:75]
    ds_read_b128 v[0:3], v113 offset:16384
    v_mfma_f32_16x16x32_bf16 v[32:35], v[12:15], v[60:63], v[32:35]
    ds_read_b128 v[16:19], v113 offset:18432
    v_mfma_f32_16x16x32_bf16 v[36:39], v[24:27], v[56:59], v[36:39]
    ds_read_b128 v[4:7], v113 offset:17408
    s_nop 0
    v_permlane32_swap_b32 v72, v73
    v_permlane32_swap_b32 v74, v75
    v_mfma_f32_16x16x32_bf16 v[36:39], v[28:31], v[60:63], v[36:39]
    ds_read_b128 v[20:23], v113 offset:19456
    v_mul_f32 v73, s30, v73
    v_mul_f32 v75, s30, v75
    v_exp_f32 v32, v32
    ds_read_b128 v[8:11], v113 offset:24576
    v_exp_f32 v33, v33
    ds_read_b128 v[12:15], v113 offset:25600
    v_exp_f32 v73, v73
    ds_read_b128 v[24:27], v113 offset:26624
    v_exp_f32 v75, v75
    ds_read_b128 v[28:31], v113 offset:27648
    v_exp_f32 v34, v34
    v_cvt_pk_bf16_f32 v72, v73, v75
    v_cvt_pk_bf16_f32 v73, v73, v75
    v_exp_f32 v35, v35
    s_waitcnt vmcnt(4)
    v_mfma_f32_16x16x16_bf16 v[40:43], v[100:101], v[72:73], 0
    v_exp_f32 v36, v36
    v_cvt_pk_bf16_f32 v32, v32, v33
    v_exp_f32 v37, v37
    v_cvt_pk_bf16_f32 v33, v34, v35
    v_exp_f32 v38, v38
    v_exp_f32 v39, v39
    v_cvt_pk_bf16_f32 v34, v36, v37
    v_cvt_pk_bf16_f32 v35, v38, v39
    s_nop 1
    v_mfma_f32_16x16x32_bf16 v[40:43], v[96:99], v[32:35], v[40:43]
    v_mfma_f32_16x16x32_bf16 v[64:67], v[88:91], v[32:35], 0
    v_mfma_f32_16x16x32_bf16 v[68:71], v[92:95], v[32:35], 0
    s_waitcnt vmcnt(3)
main_kernel_cf_v_ok:
    v_bitop3_b32 v44, v86, s22, 1 bitop3:0x28
    v_swap_b32 v85, v86
    v_cmp_ne_u32 vcc, 0, v44
main_kernel_cf_d_ok:
    s_nop 0
    v_mfma_f32_16x16x16_bf16 v[64:67], v[84:85], v[72:73], v[64:67]
    v_mfma_f32_16x16x16_bf16 v[68:71], v[86:87], v[72:73], v[68:71]
    s_cbranch_vccnz main_kernel_cf_v_f
    v_rcp_f32 v42, v40
    v_subrev_u32 v41, 0x21800000, v41
    v_cmp_lt_u32 vcc, 0x3c000000, v41
    s_nop 0
    v_pk_mul_f32 v[64:65], v[64:65], v[42:43] op_sel_hi:[1,0]
    v_pk_mul_f32 v[66:67], v[66:67], v[42:43] op_sel_hi:[1,0]
    v_cvt_pk_bf16_f32 v44, v64, v65
    v_pk_mul_f32 v[68:69], v[68:69], v[42:43] op_sel_hi:[1,0]
    v_cvt_pk_bf16_f32 v45, v66, v67
    v_pk_mul_f32 v[70:71], v[70:71], v[42:43] op_sel_hi:[1,0]
    v_cvt_pk_bf16_f32 v46, v68, v69
    v_cvt_pk_bf16_f32 v47, v70, v71
    ds_write_b128 v118, v[44:47]
    s_and_b64 s[42:43], vcc, s[44:45]
    s_cbranch_scc1 main_kernel_cf_d_f
    s_mov_b64 s[44:45], s[0:1]
    v_mov_b32 v64, 0
    v_mov_b32 v65, 0
    v_mov_b32 v66, 0
    v_mov_b32 v67, 0
    v_mov_b32 v68, 0
    v_mov_b32 v69, 0
    v_mov_b32 v70, 0
    v_mov_b32 v71, 0
    v_bfe_u32 v90, v123, 1, 7
    s_xor_b32 s23, s23, 0x80000
    s_waitcnt lgkmcnt(0)
    s_barrier
    ds_read_b128 v[56:59], v114 offset:1024
    ds_read_b128 v[60:63], v114 offset:1536
    ds_read_b128 v[48:51], v114 offset:0
    ds_read_b128 v[52:55], v114 offset:512
    s_xor_b32 s18, s18, 0x100000
    s_xor_b32 s19, s18, 0x80000
    s_xor_b32 s25, s25, 0x4000
    s_add_u32 s27, s27, 0x40000
    v_add_u32 v121, 4, v121
    v_xor_b32 v112, 0x4000, v112
    s_xor_b32 s36, s36, 0x4000
    s_mov_b32 m0, 0
    s_mov_b32 s54, s24
    s_xor_b32 s24, s24, 0x4000
    s_add_u32 s55, s25, 4096
    v_mov_b32 v89, s17
    s_mov_b32 s15, 0
    s_add_u32 s56, s19, 1536
    s_xor_b32 s9, s11, s40
    s_add_u32 s16, s20, s38
    s_waitcnt lgkmcnt(3)
    v_smfmac_f32_16x16x64_bf16 v[76:79], v[56:59], v[0:7], v110
    s_waitcnt lgkmcnt(2)
    ds_read_b128 v[0:3], v113 offset:20480
    v_smfmac_f32_16x16x64_bf16 v[76:79], v[60:63], v[8:15], v110
    s_waitcnt lgkmcnt(2)
    ds_read_b128 v[4:7], v113 offset:21504
    v_smfmac_f32_16x16x64_bf16 v[76:79], v[48:51], v[192:199], v110
    s_waitcnt lgkmcnt(2)
    ds_read_b128 v[8:11], v113 offset:28672
    v_smfmac_f32_16x16x64_bf16 v[76:79], v[52:55], v[200:207], v110
    ds_read_b128 v[12:15], v113 offset:29696
    buffer_load_dword v111, v90, s[4:7], s47 offen sc1
    v_smfmac_f32_16x16x64_bf16 v[80:83], v[56:59], v[16:23], v110
    ds_read_b128 v[16:19], v113 offset:22528
    v_smfmac_f32_16x16x64_bf16 v[80:83], v[60:63], v[24:31], v110
    ds_read_b128 v[20:23], v113 offset:23552
    v_smfmac_f32_16x16x64_bf16 v[80:83], v[48:51], v[208:215], v110
    ds_read_b128 v[24:27], v113 offset:30720
    v_cvt_pk_f16_f32 v40, v76, v77
    v_smfmac_f32_16x16x64_bf16 v[80:83], v[52:55], v[216:223], v110
    ds_read_b128 v[28:31], v113 offset:31744
    v_cvt_pk_f16_f32 v41, v78, v79
    v_smfmac_f32_16x16x64_bf16 v[64:67], v[48:51], v[224:231], v110
    v_bfi_b32 v40, 1, s22, v40
    v_smfmac_f32_16x16x64_bf16 v[64:67], v[52:55], v[232:239], v110
    s_waitcnt lgkmcnt(6)
    buffer_load_dword v111, v90, s[4:7], s47 offen sc1
    v_smfmac_f32_16x16x64_bf16 v[64:67], v[56:59], v[0:7], v110
    s_waitcnt lgkmcnt(4)
    buffer_store_dwordx2 v[40:41], v119, s[4:7], s21 offen offset:0
    v_cvt_pk_f16_f32 v42, v80, v81
    v_smfmac_f32_16x16x64_bf16 v[64:67], v[60:63], v[8:15], v110
    v_cvt_pk_f16_f32 v43, v82, v83
    v_smfmac_f32_16x16x64_bf16 v[68:71], v[48:51], v[240:247], v110
    v_bfi_b32 v42, 1, s22, v42
    v_smfmac_f32_16x16x64_bf16 v[68:71], v[52:55], v[248:255], v110
    s_waitcnt lgkmcnt(2)
    v_smfmac_f32_16x16x64_bf16 v[68:71], v[56:59], v[16:23], v110
    s_waitcnt lgkmcnt(0)
    buffer_store_dwordx2 v[42:43], v119, s[4:7], s21 offen offset:512
    v_cvt_pk_f16_f32 v44, v64, v65
    v_smfmac_f32_16x16x64_bf16 v[68:71], v[60:63], v[24:31], v110
    v_cvt_pk_f16_f32 v45, v66, v67
    v_bfi_b32 v44, 1, s22, v44
    s_cmp_lg_u32 s14, 0
    buffer_store_dwordx2 v[44:45], v119, s[4:7], s21 offen offset:1024
    s_nop 3
    v_cvt_pk_f16_f32 v46, v68, v69
    v_cvt_pk_f16_f32 v47, v70, v71
    v_bfi_b32 v46, 1, s22, v46
    buffer_store_dwordx2 v[46:47], v119, s[4:7], s21 offen offset:1536
    s_cbranch_scc1 main_kernel_cf_wx
    s_waitcnt vmcnt(5)
    s_xor_b32 s21, s21, 0x80000
main_kernel_cf_rgo:
    v_subrev_u32 v32, s20, v111
    s_memtime s[52:53]
    v_cmp_lt_u32 vcc, 0x100000, v32
    v_max_u32_dpp v32, v32, v32 row_shr:1 row_mask:0xf bank_mask:0xf
    s_nop 0
    s_nop 0
    v_max_u32_dpp v32, v32, v32 row_shr:2 row_mask:0xf bank_mask:0xf
    s_nop 0
    s_cbranch_vccnz main_kernel_cf_fsp
main_kernel_cf_fok:
    s_nop 0
    v_max_u32_dpp v32, v32, v32 row_shr:4 row_mask:0xf bank_mask:0xf
    s_memtime s[52:53]
    s_nop 0
    v_max_u32_dpp v32, v32, v32 row_shr:8 row_mask:0xf bank_mask:0xf
    s_memtime s[52:53]
    s_nop 0
    v_max_u32_dpp v32, v32, v32 row_bcast:15 row_mask:0xa bank_mask:0xf
    s_memtime s[52:53]
    s_sub_u32 s33, s52, s16
    v_readlane_b32 s32, v32, 31
    s_add_u32 s33, s33, 0x400
    s_memtime s[52:53]
    s_add_u32 s34, s16, 1650
    s_memtime s[52:53]
    s_min_u32 s32, s32, s33
    s_max_u32 s32, s32, s15
    s_add_u32 s34, s34, s32
    s_mov_b32 s35, 200
main_kernel_cf_fw:
    s_memtime s[52:53]
    s_cmp_ge_u32 s52, s34
    s_cbranch_scc1 main_kernel_cf_fgo
    s_memtime s[52:53]
    s_cmp_ge_u32 s52, s34
    s_cbranch_scc1 main_kernel_cf_fgo
    s_memtime s[52:53]
    s_cmp_ge_u32 s52, s34
    s_cbranch_scc1 main_kernel_cf_fgo
    s_memtime s[52:53]
    s_cmp_ge_u32 s52, s34
    s_cbranch_scc1 main_kernel_cf_fgo
    s_memtime s[52:53]
    s_cmp_ge_u32 s52, s34
    s_cbranch_scc1 main_kernel_cf_fgo
    s_memtime s[52:53]
    s_cmp_ge_u32 s52, s34
    s_cbranch_scc1 main_kernel_cf_fgo
    s_memtime s[52:53]
    s_cmp_ge_u32 s52, s34
    s_cbranch_scc1 main_kernel_cf_fgo
    s_memtime s[52:53]
    s_cmp_ge_u32 s52, s34
    s_cbranch_scc1 main_kernel_cf_fgo
    s_sub_u32 s35, s35, 1
    s_cbranch_scc0 main_kernel_cf_fw
main_kernel_cf_fgo:
    buffer_load_dwordx4 v[0:3], v120, s[4:7], s23 offen sc1
    s_add_u32 s35, s23, 0x8000
    buffer_load_dwordx4 v[4:7], v120, s[4:7], s35 offen sc1
    s_add_u32 s35, s23, 0x10000
    buffer_load_dwordx4 v[8:11], v120, s[4:7], s35 offen sc1
    ds_read_b32 v33, v123 offset:20992
    s_add_u32 s35, s23, 0x18000
    buffer_load_dwordx4 v[12:15], v120, s[4:7], s35 offen sc1
    s_add_u32 s35, s23, 0x20000
    buffer_load_dwordx4 v[16:19], v120, s[4:7], s35 offen sc1
    s_add_u32 s35, s23, 0x28000
    buffer_load_dwordx4 v[20:23], v120, s[4:7], s35 offen sc1
    s_add_u32 s35, s23, 0x30000
    buffer_load_dwordx4 v[24:27], v120, s[4:7], s35 offen sc1
    s_add_u32 s35, s23, 0x38000
    buffer_load_dwordx4 v[28:31], v120, s[4:7], s35 offen sc1
    s_mov_b64 exec, 1
    s_waitcnt lgkmcnt(0)
    v_sub_u32 v33, s34, v33
    v_bfi_b32 v33, 1, s40, v33
    buffer_store_dword v33, off, s[4:7], s18 offset:1536 sc1
    v_readfirstlane_b32 s10, v33
    s_mov_b64 exec, -1
    s_waitcnt vmcnt(8)
    v_mfma_f32_16x16x32_f16 v[76:79], v[0:3], v[106:109], 0
    v_xor_b32 v36, s22, v0
    v_bitop3_b32 v36, v2, s22, v36 bitop3:0xbe
    s_waitcnt vmcnt(7)
    v_mfma_f32_16x16x32_f16 v[76:79], v[4:7], v[106:109], v[76:79]
    v_bitop3_b32 v36, v4, s22, v36 bitop3:0xbe
    v_bitop3_b32 v36, v6, s22, v36 bitop3:0xbe
    s_waitcnt vmcnt(6)
    v_mfma_f32_16x16x32_f16 v[76:79], v[8:11], v[106:109], v[76:79]
    v_bitop3_b32 v36, v8, s22, v36 bitop3:0xbe
    v_bitop3_b32 v36, v10, s22, v36 bitop3:0xbe
    s_waitcnt vmcnt(5)
    v_mfma_f32_16x16x32_f16 v[76:79], v[12:15], v[106:109], v[76:79]
    v_bitop3_b32 v36, v12, s22, v36 bitop3:0xbe
    v_bitop3_b32 v36, v14, s22, v36 bitop3:0xbe
    s_waitcnt vmcnt(4)
    v_mfma_f32_16x16x32_f16 v[76:79], v[16:19], v[106:109], v[76:79]
    v_bitop3_b32 v36, v16, s22, v36 bitop3:0xbe
    v_bitop3_b32 v36, v18, s22, v36 bitop3:0xbe
    s_waitcnt vmcnt(3)
    v_mfma_f32_16x16x32_f16 v[76:79], v[20:23], v[106:109], v[76:79]
    v_bitop3_b32 v36, v20, s22, v36 bitop3:0xbe
    v_bitop3_b32 v36, v22, s22, v36 bitop3:0xbe
    s_waitcnt vmcnt(2)
    v_mfma_f32_16x16x32_f16 v[76:79], v[24:27], v[106:109], v[76:79]
    v_bitop3_b32 v36, v24, s22, v36 bitop3:0xbe
    v_bitop3_b32 v36, v26, s22, v36 bitop3:0xbe
    s_waitcnt vmcnt(1)
    v_mfma_f32_16x16x32_f16 v[76:79], v[28:31], v[106:109], v[76:79]
    v_bitop3_b32 v36, v28, s22, v36 bitop3:0xbe
    v_bitop3_b32 v36, v30, s22, v36 bitop3:0xbe
    v_and_b32 v36, 1, v36
    v_cmp_ne_u32 vcc, 0, v36
    s_nop 3
    v_cvt_pk_bf16_f32 v126, v76, v77
    v_cvt_pk_bf16_f32 v127, v78, v79
    s_cbranch_vccnz main_kernel_cf_r_f
    buffer_store_dwordx2 v[126:127], v122, s[4:7], s24 offen
    s_sub_u32 s20, s34, s38
    s_mov_b32 s3, s34
    buffer_store_dword v89, v117, s[4:7], s46 offen offset:512
    v_mov_b32 v32, -1
    v_mov_b32 v33, -1
    v_mov_b32 v64, 0
    v_mov_b32 v65, 0
    v_mov_b32 v66, 0
    v_mov_b32 v67, 0
    v_mov_b32 v68, 0
    v_mov_b32 v69, 0
    v_mov_b32 v70, 0
    v_mov_b32 v71, 0
    v_mov_b32 v96, 0
    v_mov_b32 v97, 0
    v_mov_b32 v98, 0
    v_mov_b32 v99, 0
    buffer_store_dwordx2 v[32:33], v122, s[4:7], s54 offen
    s_cmp_eq_u32 s12, 0
    v_add_u32 v56, s59, v115
    s_cbranch_scc0 main_kernel_cf_vma
    ds_read_b64_tr_b16 v[80:81], v56 offset:16384
    ds_read_b64_tr_b16 v[82:83], v56 offset:17408
    s_waitcnt lgkmcnt(0)
    s_nop 15
    s_nop 15
    s_nop 5
    s_buffer_load_dword s9, s[4:7], s56 glc
    buffer_load_dword v111, v90, s[4:7], s47 offen offset:512 sc1
    buffer_load_dwordx4 v116, s[4:7], s25 offen offset:0 sc1 lds
    buffer_load_dwordx4 v116, s[4:7], s25 offen offset:1024 sc1 lds
    buffer_load_dwordx4 v116, s[4:7], s25 offen offset:2048 sc1 lds
    buffer_load_dwordx4 v116, s[4:7], s25 offen offset:3072 sc1 lds
    s_mov_b32 m0, 4096
    s_nop 0
    buffer_load_dwordx4 v116, s[4:7], s55 offen offset:0 sc1 lds
    buffer_load_dwordx4 v116, s[4:7], s55 offen offset:1024 sc1 lds
    buffer_load_dwordx4 v116, s[4:7], s55 offen offset:2048 sc1 lds
    buffer_load_dwordx4 v116, s[4:7], s55 offen offset:3072 sc1 lds
    v_mov_b32 v34, v90
    s_mov_b32 m0, s36
    s_barrier
    ds_read_b32 v35, v123 offset:20480
    buffer_load_dwordx4 v[88:91], v116, s[4:7], s28 offen offset:0 sc1
    buffer_load_dwordx4 v[92:95], v116, s[4:7], s28 offen offset:1024 sc1
    buffer_load_dwordx4 v116, s[4:7], s27 offen offset:0 sc1 lds
    buffer_store_dwordx4 v[80:83], v125, s[4:7], s26 offen sc1
    s_branch main_kernel_cf_kva
main_kernel_cf_vma:
    v_mfma_f32_16x16x32_bf16 v[56:59], v[102:105], v[84:87], 0
    s_nop 7
    v_cvt_pk_bf16_f32 v80, v56, v57
    v_cvt_pk_bf16_f32 v81, v58, v59
    s_nop 15
    s_nop 15
    s_nop 5
    s_buffer_load_dword s9, s[4:7], s56 glc
    buffer_load_dword v111, v90, s[4:7], s47 offen offset:512 sc1
    buffer_load_dwordx4 v116, s[4:7], s25 offen offset:0 sc1 lds
    buffer_load_dwordx4 v116, s[4:7], s25 offen offset:1024 sc1 lds
    buffer_load_dwordx4 v116, s[4:7], s25 offen offset:2048 sc1 lds
    buffer_load_dwordx4 v116, s[4:7], s25 offen offset:3072 sc1 lds
    s_mov_b32 m0, 4096
    s_nop 0
    buffer_load_dwordx4 v116, s[4:7], s55 offen offset:0 sc1 lds
    buffer_load_dwordx4 v116, s[4:7], s55 offen offset:1024 sc1 lds
    buffer_load_dwordx4 v116, s[4:7], s55 offen offset:2048 sc1 lds
    buffer_load_dwordx4 v116, s[4:7], s55 offen offset:3072 sc1 lds
    v_mov_b32 v34, v90
    s_mov_b32 m0, s36
    s_barrier
    ds_read_b32 v35, v123 offset:20480
    buffer_load_dwordx4 v[88:91], v116, s[4:7], s28 offen offset:0 sc1
    buffer_load_dwordx4 v[92:95], v116, s[4:7], s28 offen offset:1024 sc1
    buffer_load_dwordx4 v116, s[4:7], s27 offen offset:0 sc1 lds
    buffer_store_dwordx2 v[80:81], v123, s[4:7], s26 offen sc1
main_kernel_cf_kva:
    s_add_u32 s26, s26, 0x10000
    s_waitcnt vmcnt(12)
    v_cmp_gt_i32 vcc, s17, v111
    v_readfirstlane_b32 s38, v35
    s_cbranch_vccnz main_kernel_cf_mc_f
    s_waitcnt vmcnt(4)
    s_branch main_kernel_cf_top
main_kernel_cf_wx:
    s_cmp_lg_u32 s14, 1
    s_cbranch_scc1 main_kernel_cf_wy
    s_memrealtime s[32:33]
    s_nop 0
    s_nop 0
    s_memrealtime s[32:33]
    s_nop 0
    s_nop 0
    s_memrealtime s[32:33]
    s_nop 0
    s_nop 0
    s_memrealtime s[32:33]
    s_nop 0
    s_nop 0
    s_memrealtime s[32:33]
    s_nop 0
    s_nop 0
    s_memrealtime s[32:33]
    s_nop 0
    s_nop 0
    s_memrealtime s[32:33]
    s_nop 0
    s_nop 0
    s_memrealtime s[32:33]
    s_nop 0
    s_nop 0
    s_memrealtime s[32:33]
    s_nop 0
    s_nop 0
    s_memrealtime s[32:33]
    s_nop 0
    s_nop 0
    s_memrealtime s[32:33]
    s_nop 0
    s_nop 0
    s_memrealtime s[32:33]
    s_nop 0
    s_nop 0
    s_mov_b32 s34, s32
    s_memrealtime s[32:33]
    s_cmp_lg_u32 s32, s34
    s_cbranch_scc1 main_kernel_cf_e1
    s_memrealtime s[32:33]
    s_cmp_lg_u32 s32, s34
    s_cbranch_scc1 main_kernel_cf_e1
    s_memrealtime s[32:33]
    s_cmp_lg_u32 s32, s34
    s_cbranch_scc1 main_kernel_cf_e1
    s_memrealtime s[32:33]
    s_cmp_lg_u32 s32, s34
    s_cbranch_scc1 main_kernel_cf_e1
    s_memrealtime s[32:33]
    s_cmp_lg_u32 s32, s34
    s_cbranch_scc1 main_kernel_cf_e1
    s_memrealtime s[32:33]
    s_cmp_lg_u32 s32, s34
    s_cbranch_scc1 main_kernel_cf_e1
    s_memrealtime s[32:33]
    s_cmp_lg_u32 s32, s34
    s_cbranch_scc1 main_kernel_cf_e1
    s_memrealtime s[32:33]
    s_cmp_lg_u32 s32, s34
    s_cbranch_scc1 main_kernel_cf_e1
    s_memrealtime s[32:33]
    s_cmp_lg_u32 s32, s34
    s_cbranch_scc1 main_kernel_cf_e1
    s_memrealtime s[32:33]
    s_cmp_lg_u32 s32, s34
    s_cbranch_scc1 main_kernel_cf_e1
    s_memrealtime s[32:33]
    s_cmp_lg_u32 s32, s34
    s_cbranch_scc1 main_kernel_cf_e1
    s_memrealtime s[32:33]
    s_cmp_lg_u32 s32, s34
    s_cbranch_scc1 main_kernel_cf_e1
main_kernel_cf_e1:
    s_memtime s[52:53]
    s_mul_i32 s34, s32, 22
    s_waitcnt lgkmcnt(0)
    s_sub_u32 s32, s52, s34
    s_sub_u32 s33, s32, s38
    s_sub_u32 s33, s33, s10
    s_max_i32 s33, s33, -400
    s_min_i32 s33, s33, 400
    s_ashr_i32 s33, s33, 2
    s_add_u32 s10, s10, s33
    s_mov_b32 s33, s10
    s_ashr_i32 s34, s33, 2
    s_add_u32 s34, s34, s32
    v_mov_b32 v34, s34
    v_mov_b32 v33, s32
    ds_write2st64_b32 v123, v33, v34 offset0:80 offset1:82
    v_add_u32 v37, s33, v34
main_kernel_cf_wy:
    s_xor_b32 s21, s21, 0x80000
    v_mov_b32 v64, 0
    v_mov_b32 v65, 0
    v_mov_b32 v66, 0
    v_mov_b32 v67, 0
    v_mov_b32 v68, 0
    v_mov_b32 v69, 0
    v_mov_b32 v70, 0
    v_mov_b32 v71, 0
    v_mov_b32 v96, 0
    v_mov_b32 v97, 0
    v_mov_b32 v98, 0
    v_mov_b32 v99, 0
    s_cmp_eq_u32 s12, 0
    v_add_u32 v56, s59, v115
    s_cbranch_scc0 main_kernel_cf_vmb
    ds_read_b64_tr_b16 v[80:81], v56 offset:16384
    ds_read_b64_tr_b16 v[82:83], v56 offset:17408
    s_waitcnt lgkmcnt(0)
    s_waitcnt vmcnt(0)
    s_mov_b32 m0, s36
    s_barrier
    ds_read_b32 v35, v123 offset:20480
    ds_write_b32 v124, v37 offset:3584
    buffer_load_dwordx4 v[88:91], v116, s[4:7], s28 offen offset:0 sc1
    buffer_load_dwordx4 v[92:95], v116, s[4:7], s28 offen offset:1024 sc1
    buffer_load_dwordx4 v116, s[4:7], s27 offen offset:0 sc1 lds
    buffer_store_dwordx4 v[80:83], v125, s[4:7], s26 offen sc1
    s_branch main_kernel_cf_kvb
main_kernel_cf_vmb:
    v_mfma_f32_16x16x32_bf16 v[56:59], v[102:105], v[84:87], 0
    s_nop 7
    v_cvt_pk_bf16_f32 v80, v56, v57
    v_cvt_pk_bf16_f32 v81, v58, v59
    s_waitcnt vmcnt(0)
    s_mov_b32 m0, s36
    s_barrier
    ds_read_b32 v35, v123 offset:20480
    ds_write_b32 v124, v37 offset:3584
    buffer_load_dwordx4 v[88:91], v116, s[4:7], s28 offen offset:0 sc1
    buffer_load_dwordx4 v[92:95], v116, s[4:7], s28 offen offset:1024 sc1
    buffer_load_dwordx4 v116, s[4:7], s27 offen offset:0 sc1 lds
    buffer_store_dwordx2 v[80:81], v123, s[4:7], s26 offen sc1
main_kernel_cf_kvb:
    s_add_u32 s26, s26, 0x10000
    s_mov_b64 exec, 1
    buffer_store_dword v100, off, s[4:7], s39 sc1
    s_mov_b64 exec, -1
    s_add_u32 s39, s39, 4
    s_waitcnt lgkmcnt(0)
    v_readfirstlane_b32 s38, v35
    v_mov_b32 v35, 0
    v_mov_b32 v35, 0
    v_mov_b32 v35, 0
    v_mov_b32 v35, 0
    v_mov_b32 v35, 0
    v_mov_b32 v35, 0
main_kernel_cf_end:
    s_branch main_kernel_cf_top
main_kernel_cf_mc_f:
    s_mov_b32 m0, 0
    s_sub_u32 s29, s29, 1
    s_cbranch_scc1 main_kernel_end
    buffer_load_dword v111, v34, s[4:7], s47 offen offset:512 sc1
    buffer_load_dwordx4 v116, s[4:7], s25 offen offset:0 sc1 lds
    buffer_load_dwordx4 v116, s[4:7], s25 offen offset:1024 sc1 lds
    buffer_load_dwordx4 v116, s[4:7], s25 offen offset:2048 sc1 lds
    buffer_load_dwordx4 v116, s[4:7], s25 offen offset:3072 sc1 lds
    s_mov_b32 m0, 4096
    s_nop 0
    buffer_load_dwordx4 v116, s[4:7], s55 offen offset:0 sc1 lds
    buffer_load_dwordx4 v116, s[4:7], s55 offen offset:1024 sc1 lds
    buffer_load_dwordx4 v116, s[4:7], s55 offen offset:2048 sc1 lds
    buffer_load_dwordx4 v116, s[4:7], s55 offen offset:3072 sc1 lds
    s_waitcnt vmcnt(8)
    v_cmp_gt_i32 vcc, s17, v111
    v_readfirstlane_b32 s38, v35
    s_cbranch_vccnz main_kernel_cf_mc_f
    s_waitcnt vmcnt(0)
    s_branch main_kernel_cf_end
main_kernel_cf_t_w:
    s_mov_b32 s35, 200
main_kernel_cf_t_s:
    s_memtime s[52:53]
    s_cmp_ge_u32 s52, s34
    s_cbranch_scc1 main_kernel_cf_t_go
    s_memtime s[52:53]
    s_cmp_ge_u32 s52, s34
    s_cbranch_scc1 main_kernel_cf_t_go
    s_memtime s[52:53]
    s_cmp_ge_u32 s52, s34
    s_cbranch_scc1 main_kernel_cf_t_go
    s_memtime s[52:53]
    s_cmp_ge_u32 s52, s34
    s_cbranch_scc1 main_kernel_cf_t_go
    s_memtime s[52:53]
    s_cmp_ge_u32 s52, s34
    s_cbranch_scc1 main_kernel_cf_t_go
    s_memtime s[52:53]
    s_cmp_ge_u32 s52, s34
    s_cbranch_scc1 main_kernel_cf_t_go
    s_memtime s[52:53]
    s_cmp_ge_u32 s52, s34
    s_cbranch_scc1 main_kernel_cf_t_go
    s_memtime s[52:53]
    s_cmp_ge_u32 s52, s34
    s_cbranch_scc1 main_kernel_cf_t_go
    s_sub_u32 s35, s35, 1
    s_cbranch_scc0 main_kernel_cf_t_s
    s_branch main_kernel_cf_t_go
main_kernel_cf_t_p:
    s_waitcnt lgkmcnt(0)
    s_xor_b32 s32, s9, s22
    s_bitcmp1_b32 s32, 0
    s_cbranch_scc0 main_kernel_cf_t_ok
    s_buffer_load_dword s9, s[4:7], s56 glc
    s_sub_u32 s29, s29, 1
    s_cbranch_scc1 main_kernel_end
    s_branch main_kernel_cf_t_p
main_kernel_cf_z0_f:
    buffer_load_dwordx2 v[126:127], v123, s[4:7], s19 offen offset:0 sc1
    s_sub_u32 s29, s29, 1
    s_cbranch_scc1 main_kernel_end
    s_waitcnt vmcnt(0)
    s_branch main_kernel_cf_z0
main_kernel_cf_z2_f:
    buffer_load_dwordx2 v[64:65], v123, s[4:7], s19 offen offset:512 sc1
    s_sub_u32 s29, s29, 1
    s_cbranch_scc1 main_kernel_end
    s_waitcnt vmcnt(0)
main_kernel_cf_z1_f:
    s_waitcnt vmcnt(0)
    s_memtime s[52:53]
    v_dot2_f32_bf16 v44, v64, s37, v68
    v_dot2_f32_bf16 v45, v64, s57, v69
    v_dot2_f32_bf16 v46, v65, s37, v70
    v_dot2_f32_bf16 v47, v65, s57, v71
    v_bitop3_b32 v60, v64, s22, 1 bitop3:0x28
    v_cvt_pk_bf16_f32 v44, v44, v45
    v_cmp_ne_u32 vcc, 0, v60
    v_cvt_pk_bf16_f32 v45, v46, v47
    ds_write_b64 v124, v[44:45] offset:512
    s_cbranch_vccnz main_kernel_cf_z2_f
    s_branch main_kernel_cf_z_ok
main_kernel_cf_kvw:
    s_cmp_eq_u32 s17, 64
    s_cbranch_scc1 main_kernel_cf_kvok
    s_waitcnt vmcnt(0)
    s_mov_b32 exec_lo, 0
    s_mov_b32 exec_hi, 0x3f00
    v_subrev_u32 v127, 0, v121
main_kernel_cf_kvp:
    buffer_load_dword v126, v127, s[4:7], 0 offen sc1
    s_waitcnt vmcnt(0)
    v_cmp_eq_u32 vcc, 0, v126
    s_cbranch_vccz main_kernel_cf_kvp_ok
    s_sleep 2
    s_sub_u32 s29, s29, 1
    s_cbranch_scc0 main_kernel_cf_kvp
    s_branch main_kernel_end
main_kernel_cf_kvp_ok:
    s_mov_b64 exec, -1
    s_branch main_kernel_cf_kvok
main_kernel_cf_last:
    buffer_load_dwordx2 v[86:87], v123, s[4:7], s19 offen offset:1024 sc1
    s_sub_u32 s29, s29, 1
    s_cbranch_scc1 main_kernel_end
    s_waitcnt vmcnt(0) lgkmcnt(0)
    v_bitop3_b32 v44, v86, s22, 1 bitop3:0x28
    v_cmp_ne_u32 vcc, 0, v44
    s_cbranch_vccnz main_kernel_cf_last
    v_swap_b32 v85, v86
    s_cmp_eq_u32 s12, 0
    v_add_u32 v56, s59, v115
    s_cbranch_scc0 main_kernel_cf_vmc
    ds_read_b64_tr_b16 v[80:81], v56 offset:16384
    ds_read_b64_tr_b16 v[82:83], v56 offset:17408
    s_waitcnt lgkmcnt(0)
    buffer_store_dwordx4 v[80:83], v125, s[4:7], s26 offen sc1
    s_branch main_kernel_cf_kvc
main_kernel_cf_vmc:
    v_mfma_f32_16x16x32_bf16 v[56:59], v[102:105], v[84:87], 0
    s_nop 7
    v_cvt_pk_bf16_f32 v80, v56, v57
    v_cvt_pk_bf16_f32 v81, v58, v59
    buffer_store_dwordx2 v[80:81], v123, s[4:7], s26 offen sc1
main_kernel_cf_kvc:
    s_add_u32 s26, s26, 0x10000
    s_branch main_kernel_end
main_kernel_cf_m_f:
main_kernel_cf_m_t:
    ds_read_b128 v[0:3], v116 offset:0
    ds_read_b128 v[4:7], v116 offset:1024
    ds_read_b128 v[8:11], v116 offset:2048
    ds_read_b128 v[12:15], v116 offset:3072
    ds_read_b128 v[16:19], v116 offset:4096
    ds_read_b128 v[20:23], v116 offset:5120
    ds_read_b128 v[24:27], v116 offset:6144
    ds_read_b128 v[28:31], v116 offset:7168
    s_waitcnt lgkmcnt(0)
    v_max_u32 v126, v0, v2
    v_max3_u32 v126, v126, v4, v6
    v_max3_u32 v126, v126, v8, v10
    v_max3_u32 v126, v126, v12, v14
    v_max3_u32 v126, v126, v16, v18
    v_max3_u32 v126, v126, v20, v22
    v_max3_u32 v126, v126, v24, v26
    v_max3_u32 v126, v126, v28, v30
    v_cmp_eq_u32 vcc, -1, v126
    s_cbranch_vccz main_kernel_cf_m_g
    s_barrier
    s_lshl_b32 s32, s14, 11
    s_add_u32 m0, s32, 0
    s_add_u32 s32, s32, s25
    buffer_load_dwordx4 v116, s[4:7], s32 offen offset:0 sc1 lds
    buffer_load_dwordx4 v116, s[4:7], s32 offen offset:1024 sc1 lds
    s_sub_u32 s29, s29, 1
    s_cbranch_scc1 main_kernel_end
    s_waitcnt vmcnt(0)
    s_barrier
    s_branch main_kernel_cf_m_t
main_kernel_cf_m_g:
    s_mov_b64 s[44:45], 0
    v_mov_b32 v64, 0
    v_mov_b32 v65, 0
    v_mov_b32 v66, 0
    v_mov_b32 v67, 0
    v_mov_b32 v68, 0
    v_mov_b32 v69, 0
    v_mov_b32 v70, 0
    v_mov_b32 v71, 0
    v_mov_b32 v96, 0
    v_mov_b32 v97, 0
    v_mov_b32 v98, 0
    v_mov_b32 v99, 0
    s_branch main_kernel_cf_mrd
main_kernel_cf_v_f:
    v_swap_b32 v85, v86
    s_nop 7
    s_waitcnt vmcnt(1)
main_kernel_cf_v_t:
    s_memtime s[52:53]
    v_bitop3_b32 v44, v126, s22, 1 bitop3:0x28
    v_cmp_ne_u32 vcc, 0, v44
    s_sub_u32 s29, s29, 1
    s_cbranch_scc1 main_kernel_end
    s_cbranch_vccnz main_kernel_cf_v_g
    v_mfma_f32_16x16x32_bf16 v[64:67], v[88:91], v[32:35], 0
    v_mfma_f32_16x16x32_bf16 v[68:71], v[92:95], v[32:35], 0
    v_mov_b32 v86, v126
    v_mov_b32 v87, v127
    s_waitcnt lgkmcnt(0)
    s_sub_u32 s32, s52, s38
    s_add_u32 s32, s32, -550
    v_mov_b32 v46, s32
    buffer_store_dword v46, v117, s[4:7], s46 offen
    s_branch main_kernel_cf_v_ok
main_kernel_cf_v_g:
    buffer_load_dwordx2 v[126:127], v123, s[4:7], s19 offen offset:1024 sc1
    s_waitcnt lgkmcnt(0)
    s_sub_u32 s32, s52, s38
    s_add_u32 s32, s32, -50
    v_mov_b32 v46, s32
    buffer_store_dword v46, v117, s[4:7], s46 offen
    s_waitcnt vmcnt(0)
    s_branch main_kernel_cf_v_t
main_kernel_cf_d_f:
    s_memtime s[52:53]
    s_waitcnt vmcnt(1) lgkmcnt(0)
    s_sub_u32 s32, s52, s38
    s_add_u32 s32, s32, 300
    v_mov_b32 v46, s32
    buffer_store_dword v46, v117, s[4:7], s46 offen
    ds_read_b128 v[0:3], v112 offset:0
    ds_read_b128 v[4:7], v112 offset:1024
    ds_read_b128 v[8:11], v112 offset:2048
    ds_read_b128 v[12:15], v112 offset:3072
    ds_read_b128 v[16:19], v112 offset:4096
    ds_read_b128 v[20:23], v112 offset:5120
    ds_read_b128 v[24:27], v112 offset:6144
    ds_read_b128 v[28:31], v112 offset:7168
    s_waitcnt lgkmcnt(0)
    v_mfma_f32_16x16x32_bf16 v[32:35], v[0:3], v[48:51], 0
    v_mfma_f32_16x16x32_bf16 v[36:39], v[16:19], v[48:51], 0
    v_mfma_f32_16x16x32_bf16 v[72:75], v[48:51], v[48:51], 0
    v_mfma_f32_16x16x32_bf16 v[32:35], v[4:7], v[52:55], v[32:35]
    v_mfma_f32_16x16x32_bf16 v[36:39], v[20:23], v[52:55], v[36:39]
    v_mfma_f32_16x16x32_bf16 v[72:75], v[52:55], v[52:55], v[72:75]
    v_mfma_f32_16x16x32_bf16 v[32:35], v[8:11], v[56:59], v[32:35]
    v_mfma_f32_16x16x32_bf16 v[36:39], v[24:27], v[56:59], v[36:39]
    v_mfma_f32_16x16x32_bf16 v[72:75], v[56:59], v[56:59], v[72:75]
    v_mfma_f32_16x16x32_bf16 v[32:35], v[12:15], v[60:63], v[32:35]
    v_mfma_f32_16x16x32_bf16 v[36:39], v[28:31], v[60:63], v[36:39]
    v_mfma_f32_16x16x32_bf16 v[72:75], v[60:63], v[60:63], v[72:75]
    s_nop 7
    ds_read_b128 v[0:3], v113 offset:16384
    ds_read_b128 v[16:19], v113 offset:18432
    ds_read_b128 v[4:7], v113 offset:17408
    ds_read_b128 v[20:23], v113 offset:19456
    ds_read_b128 v[8:11], v113 offset:24576
    ds_read_b128 v[24:27], v113 offset:26624
    ds_read_b128 v[12:15], v113 offset:25600
    ds_read_b128 v[28:31], v113 offset:27648
    v_permlane32_swap_b32 v72, v73
    v_permlane32_swap_b32 v74, v75
    v_mul_f32 v73, s30, v73
    v_mul_f32 v75, s30, v75
    v_max_f32 v126, v73, v75
    v_max3_f32 v126, v126, v32, v33
    v_max3_f32 v126, v126, v34, v35
    v_max3_f32 v126, v126, v36, v37
    v_max3_f32 v126, v126, v38, v39
    v_mov_b32 v127, v126
    s_nop 1
    v_permlane32_swap_b32 v126, v127
    v_max_f32 v126, v126, v127
    v_mov_b32 v127, v126
    s_nop 1
    v_permlane16_swap_b32 v126, v127
    v_max_f32 v126, v126, v127
    v_sub_f32 v32, v32, v126
    v_sub_f32 v33, v33, v126
    v_sub_f32 v34, v34, v126
    v_sub_f32 v35, v35, v126
    v_sub_f32 v36, v36, v126
    v_sub_f32 v37, v37, v126
    v_sub_f32 v38, v38, v126
    v_sub_f32 v39, v39, v126
    v_sub_f32 v73, v73, v126
    v_sub_f32 v75, v75, v126
    v_exp_f32 v32, v32
    v_exp_f32 v33, v33
    v_exp_f32 v34, v34
    v_exp_f32 v35, v35
    v_exp_f32 v36, v36
    v_exp_f32 v37, v37
    v_exp_f32 v38, v38
    v_exp_f32 v39, v39
    v_exp_f32 v73, v73
    v_exp_f32 v75, v75
    v_cvt_pk_bf16_f32 v32, v32, v33
    v_cvt_pk_bf16_f32 v33, v34, v35
    v_cvt_pk_bf16_f32 v34, v36, v37
    v_cvt_pk_bf16_f32 v35, v38, v39
    v_cvt_pk_bf16_f32 v72, v73, v75
    v_cvt_pk_bf16_f32 v73, v73, v75
    s_nop 1
    v_mfma_f32_16x16x32_bf16 v[64:67], v[88:91], v[32:35], 0
    v_mfma_f32_16x16x32_bf16 v[68:71], v[92:95], v[32:35], 0
    v_mfma_f32_16x16x32_bf16 v[40:43], v[96:99], v[32:35], 0
    s_nop 3
    s_nop 1
    v_mfma_f32_16x16x16_bf16 v[40:43], v[100:101], v[72:73], v[40:43]
    s_mov_b64 s[44:45], 0
    s_mov_b64 vcc, 0
    s_nop 7
    s_branch main_kernel_cf_d_ok
main_kernel_cf_fsp:
    s_mov_b32 s35, 40
main_kernel_cf_fsl:
    buffer_load_dword v111, v90, s[4:7], s47 offen sc1
    s_waitcnt vmcnt(1)
    v_subrev_u32 v32, s20, v111
    v_cmp_lt_u32 vcc, 0x100000, v32
    s_cbranch_vccz main_kernel_cf_rgo
    s_sub_u32 s35, s35, 1
    s_cbranch_scc0 main_kernel_cf_fsl
    v_mov_b32 v32, 0
    s_branch main_kernel_cf_fok
main_kernel_cf_r_f:
    s_memtime s[52:53]
    buffer_load_dword v111, v90, s[4:7], s47 offen sc1
    s_waitcnt lgkmcnt(0)
    s_sub_u32 s15, s52, s16
    s_add_u32 s15, s15, -1500
    s_waitcnt vmcnt(0)
    s_sub_u32 s29, s29, 1
    s_cbranch_scc1 main_kernel_end
    s_branch main_kernel_cf_rgo
    .p2align 6
main_kernel_cs_top:
    s_barrier
main_kernel_cs_mrd:
    ds_read_b128 v[0:3], v114 offset:0
    ds_read_b128 v[4:7], v114 offset:512
    ds_read_b128 v[8:11], v114 offset:1024
    ds_read_b128 v[12:15], v114 offset:1536
    ds_read_b128 v[16:19], v114 offset:2048
    s_waitcnt lgkmcnt(4)
    v_smfmac_f32_16x16x64_bf16 v[96:99], v[0:3], a[0:7], v110
    ds_read_b128 v[20:23], v114 offset:2560
    s_waitcnt lgkmcnt(4)
    v_smfmac_f32_16x16x64_bf16 v[96:99], v[4:7], a[8:15], v110
    ds_read_b128 v[24:27], v114 offset:3072
    s_waitcnt lgkmcnt(4)
    s_bfe_u32 s22, s17, 0x10001
    v_smfmac_f32_16x16x64_bf16 v[96:99], v[8:11], a[16:23], v110
    ds_read_b128 v[28:31], v114 offset:3584
    s_waitcnt lgkmcnt(4)
    v_smfmac_f32_16x16x64_bf16 v[96:99], v[12:15], a[24:31], v110
    ds_read_b128 v[32:35], v114 offset:4096
    s_waitcnt lgkmcnt(4)
    v_smfmac_f32_16x16x64_bf16 v[96:99], v[16:19], a[32:39], v110
    ds_read_b128 v[36:39], v114 offset:4608
    s_waitcnt lgkmcnt(4)
    v_smfmac_f32_16x16x64_bf16 v[96:99], v[20:23], a[40:47], v110
    ds_read_b128 v[40:43], v114 offset:5120
    s_waitcnt lgkmcnt(4)
    v_smfmac_f32_16x16x64_bf16 v[96:99], v[24:27], a[48:55], v110
    ds_read_b128 v[44:47], v114 offset:5632
    s_waitcnt lgkmcnt(4)
    v_smfmac_f32_16x16x64_bf16 v[96:99], v[28:31], a[56:63], v110
    ds_read_b128 v[48:51], v114 offset:6144
    s_waitcnt lgkmcnt(4)
    v_smfmac_f32_16x16x64_bf16 v[96:99], v[32:35], a[64:71], v110
    ds_read_b128 v[52:55], v114 offset:6656
    s_waitcnt lgkmcnt(4)
    v_smfmac_f32_16x16x64_bf16 v[96:99], v[36:39], a[72:79], v110
    ds_read_b128 v[56:59], v114 offset:7168
    s_waitcnt lgkmcnt(4)
    v_smfmac_f32_16x16x64_bf16 v[96:99], v[40:43], a[80:87], v110
    ds_read_b128 v[60:63], v114 offset:7680
    s_waitcnt lgkmcnt(4)
    v_smfmac_f32_16x16x64_bf16 v[96:99], v[44:47], a[88:95], v110
    s_waitcnt lgkmcnt(3)
    buffer_load_dword v111, v121, s[4:7], 0 offen sc1
    v_smfmac_f32_16x16x64_bf16 v[96:99], v[48:51], a[96:103], v110
    s_waitcnt lgkmcnt(2)
    ds_read_b128 v[80:83], v113 offset:0
    v_smfmac_f32_16x16x64_bf16 v[96:99], v[52:55], a[104:111], v110
    s_waitcnt lgkmcnt(2)
    ds_read_b128 v[84:87], v113 offset:1024
    v_smfmac_f32_16x16x64_bf16 v[96:99], v[56:59], a[112:119], v110
    s_waitcnt lgkmcnt(2)
    v_smfmac_f32_16x16x64_bf16 v[96:99], v[60:63], a[120:127], v110
    v_smfmac_f32_16x16x64_bf16 v[68:71], v[0:3], a[128:135], v110
    ds_read_b128 v[72:75], v113 offset:2048
    v_smfmac_f32_16x16x64_bf16 v[68:71], v[4:7], a[136:143], v110
    s_nop 1
    v_pk_add_f32 v[126:127], v[96:97], v[98:99]
    ds_read_b128 v[76:79], v113 offset:3072
    v_smfmac_f32_16x16x64_bf16 v[68:71], v[8:11], a[144:151], v110
    v_cmp_u_f32 vcc, v126, v127
    v_smfmac_f32_16x16x64_bf16 v[68:71], v[12:15], a[152:159], v110
    v_cvt_pk_bf16_f32 v126, v96, v97
    v_smfmac_f32_16x16x64_bf16 v[68:71], v[16:19], a[160:167], v110
    v_cvt_pk_bf16_f32 v127, v98, v99
    s_and_b64 s[42:43], vcc, s[44:45]
    s_cbranch_scc1 main_kernel_cs_m_f
    v_smfmac_f32_16x16x64_bf16 v[68:71], v[20:23], a[168:175], v110
    v_bfi_b32 v126, 1, s22, v126
    buffer_store_dwordx2 v[126:127], v123, s[4:7], s18 offen sc1
    v_smfmac_f32_16x16x64_bf16 v[68:71], v[24:27], a[176:183], v110
    s_mov_b64 s[44:45], s[0:1]
    v_smfmac_f32_16x16x64_bf16 v[68:71], v[28:31], a[184:191], v110
    s_add_u32 s17, s17, 1
    s_bfe_u32 s40, s17, 0x10001
    v_smfmac_f32_16x16x64_bf16 v[68:71], v[32:35], a[192:199], v110
    s_add_u32 s28, s28, 0x40000
    s_mov_b32 m0, s36
    v_smfmac_f32_16x16x64_bf16 v[68:71], v[36:39], a[200:207], v110
    s_add_u32 s34, s3, 2100
    v_smfmac_f32_16x16x64_bf16 v[68:71], v[40:43], a[208:215], v110
    v_smfmac_f32_16x16x64_bf16 v[68:71], v[44:47], a[216:223], v110
    v_smfmac_f32_16x16x64_bf16 v[68:71], v[48:51], a[224:231], v110
    v_smfmac_f32_16x16x64_bf16 v[68:71], v[52:55], a[232:239], v110
    v_smfmac_f32_16x16x64_bf16 v[68:71], v[56:59], a[240:247], v110
    v_smfmac_f32_16x16x64_bf16 v[68:71], v[60:63], a[248:255], v110
    s_waitcnt lgkmcnt(2)
    v_smfmac_f32_16x16x64_bf16 v[64:67], v[32:35], v[80:87], v110
    s_waitcnt lgkmcnt(0)
    s_nop 3
    v_cvt_pk_bf16_f32 v126, v68, v69
    v_cvt_pk_bf16_f32 v127, v70, v71
    v_bfi_b32 v126, 1, s22, v126
    buffer_store_dwordx2 v[126:127], v123, s[4:7], s18 offen offset:512 sc1
    ds_read_b128 v[80:83], v113 offset:4096
    v_smfmac_f32_16x16x64_bf16 v[64:67], v[36:39], v[72:79], v110
    ds_read_b128 v[84:87], v113 offset:5120
    v_smfmac_f32_16x16x64_bf16 v[64:67], v[0:3], v[128:135], v110
    ds_read_b128 v[72:75], v113 offset:6144
    v_smfmac_f32_16x16x64_bf16 v[64:67], v[4:7], v[136:143], v110
    ds_read_b128 v[76:79], v113 offset:7168
    v_smfmac_f32_16x16x64_bf16 v[64:67], v[8:11], v[144:151], v110
    ds_read_b128 v[32:35], v113 offset:8192
    v_smfmac_f32_16x16x64_bf16 v[64:67], v[12:15], v[152:159], v110
    ds_read_b128 v[36:39], v113 offset:9216
    v_smfmac_f32_16x16x64_bf16 v[64:67], v[16:19], v[160:167], v110
    ds_read_b128 v[0:3], v113 offset:10240
    s_memtime s[52:53]
    v_smfmac_f32_16x16x64_bf16 v[64:67], v[20:23], v[168:175], v110
    ds_read_b128 v[4:7], v113 offset:11264
    s_memtime s[52:53]
    s_xor_b32 s32, s9, s22
    s_bitcmp1_b32 s32, 0
    s_cbranch_scc1 main_kernel_cs_t_p
main_kernel_cs_t_ok:
    s_sub_u32 s32, s9, s10
    v_smfmac_f32_16x16x64_bf16 v[64:67], v[24:27], v[176:183], v110
    ds_read_b128 v[8:11], v113 offset:12288
    s_memtime s[52:53]
    s_max_i32 s32, s32, 0
    s_min_i32 s32, s32, 0x4000
    v_smfmac_f32_16x16x64_bf16 v[64:67], v[28:31], v[184:191], v110
    s_waitcnt lgkmcnt(7)
    ds_read_b128 v[12:15], v113 offset:13312
    s_memtime s[52:53]
    s_add_u32 s34, s34, s32
    s_and_b32 s34, s34, s11
    v_smfmac_f32_16x16x64_bf16 v[64:67], v[40:43], v[80:87], v110
    s_waitcnt lgkmcnt(6)
    ds_read_b128 v[16:19], v113 offset:14336
    s_cmp_lt_u32 s52, s34
    s_cbranch_scc1 main_kernel_cs_t_w
main_kernel_cs_t_go:
    s_barrier
    buffer_load_dwordx2 v[126:127], v123, s[4:7], s19 offen offset:0 sc1
    v_smfmac_f32_16x16x64_bf16 v[64:67], v[44:47], v[72:79], v110
    s_waitcnt lgkmcnt(5)
    ds_read_b128 v[20:23], v113 offset:15360
    v_smfmac_f32_16x16x64_bf16 v[64:67], v[48:51], v[32:39], v110
    s_waitcnt lgkmcnt(4)
    v_smfmac_f32_16x16x64_bf16 v[64:67], v[52:55], v[0:7], v110
    s_waitcnt lgkmcnt(2)
    ds_read_b128 v[24:27], v112 offset:6144
    ds_read_b128 v[28:31], v112 offset:7168
    v_smfmac_f32_16x16x64_bf16 v[64:67], v[56:59], v[8:15], v110
    s_waitcnt lgkmcnt(2)
    ds_read_b128 v[0:3], v112 offset:0
    ds_read_b128 v[4:7], v112 offset:1024
    v_smfmac_f32_16x16x64_bf16 v[64:67], v[60:63], v[16:23], v110
    ds_read_b128 v[8:11], v112 offset:2048
    ds_read_b128 v[12:15], v112 offset:3072
    ds_read_b128 v[16:19], v112 offset:4096
    ds_read_b128 v[20:23], v112 offset:5120
    v_mov_b32 v76, 0
    v_mov_b32 v77, 0
    v_mov_b32 v78, 0
    s_nop 0
    v_permlane32_swap_b32 v64, v65
    v_permlane32_swap_b32 v66, v67
    v_cvt_pk_bf16_f32 v84, v64, v66
    v_cvt_pk_bf16_f32 v85, v65, v67
    v_bfi_b32 v84, 1, s22, v84
    buffer_load_dwordx2 v[42:43], v123, s[4:7], s19 offen offset:512 sc1
    v_mov_b32 v79, 0
    v_mov_b32 v80, 0
    v_mov_b32 v81, 0
    v_mov_b32 v82, 0
    v_mov_b32 v83, 0
    v_mov_b32 v60, 0
    v_mov_b32 v60, 0
    v_mov_b32 v60, 0
    v_mov_b32 v60, 0
    v_mov_b32 v60, 0
    v_mov_b32 v60, 0
    v_mov_b32 v60, 0
    buffer_store_dwordx2 v[84:85], v123, s[4:7], s18 offen offset:1024 sc1
    v_mov_b32 v60, 0
    v_mov_b32 v60, 0
    v_mov_b32 v60, 0
    v_mov_b32 v60, 0
    v_mov_b32 v60, 0
    v_mov_b32 v60, 0
    v_mov_b32 v60, 0
    v_mov_b32 v60, 0
    v_mov_b32 v60, 0
    v_mov_b32 v60, 0
    v_mov_b32 v60, 0
    v_mov_b32 v60, 0
    v_mov_b32 v60, 0
    v_mov_b32 v60, 0
    v_mov_b32 v60, 0
    v_mov_b32 v60, 0
    v_mov_b32 v60, 0
    v_mov_b32 v60, 0
    v_mov_b32 v60, 0
    v_mov_b32 v60, 0
    v_mov_b32 v60, 0
    v_mov_b32 v60, 0
    v_mov_b32 v60, 0
    v_mov_b32 v60, 0
    v_mov_b32 v60, 0
    v_mov_b32 v60, 0
    v_mov_b32 v60, 0
    v_mov_b32 v60, 0
    v_mov_b32 v60, 0
    v_mov_b32 v60, 0
    v_mov_b32 v60, 0
    v_mov_b32 v60, 0
    v_mov_b32 v60, 0
    v_mov_b32 v60, 0
    v_mov_b32 v60, 0
    v_mov_b32 v60, 0
    v_mov_b32 v60, 0
    v_mov_b32 v60, 0
    s_waitcnt vmcnt(2)
main_kernel_cs_z0:
    v_dot2_f32_bf16 v44, v126, s37, v96
    v_dot2_f32_bf16 v45, v126, s57, v97
    v_dot2_f32_bf16 v46, v127, s37, v98
    v_dot2_f32_bf16 v47, v127, s57, v99
    v_bitop3_b32 v60, v126, s22, 1 bitop3:0x28
    v_cvt_pk_bf16_f32 v44, v44, v45
    v_cmp_ne_u32 vcc, 0, v60
    v_cvt_pk_bf16_f32 v45, v46, v47
    ds_write_b64 v124, v[44:45] offset:0
    buffer_load_dwordx2 v[64:65], v123, s[4:7], s19 offen offset:512 sc1
    v_cmp_eq_u32 s[42:43], 0, v111
    s_cbranch_vccnz main_kernel_cs_z0_f
    v_mov_b32 v96, 0x3f803f80
    v_mov_b32 v97, 0x3f803f80
    v_mov_b32 v98, 0x3f803f80
    v_mov_b32 v99, 0x3f803f80
    s_and_b32 s32, s43, 0x3f00
    s_cbranch_scc1 main_kernel_cs_kvw
main_kernel_cs_kvok:
    s_waitcnt lgkmcnt(0)
    s_barrier
    ds_read_b64_tr_b16 v[48:49], v115 offset:16384
    ds_read_b64_tr_b16 v[50:51], v115 offset:17408
    ds_read_b64_tr_b16 v[52:53], v115 offset:18432
    ds_read_b64_tr_b16 v[54:55], v115 offset:19456
    s_waitcnt vmcnt(2)
    s_memtime s[52:53]
    v_dot2_f32_bf16 v44, v42, s37, v68
    v_dot2_f32_bf16 v45, v42, s57, v69
    v_dot2_f32_bf16 v46, v43, s37, v70
    v_dot2_f32_bf16 v47, v43, s57, v71
    v_bitop3_b32 v60, v42, s22, 1 bitop3:0x28
    v_cvt_pk_bf16_f32 v44, v44, v45
    v_cmp_ne_u32 vcc, 0, v60
    v_cvt_pk_bf16_f32 v45, v46, v47
    ds_write_b64 v124, v[44:45] offset:512
    s_waitcnt lgkmcnt(3)
    v_mfma_f32_16x16x32_bf16 v[32:35], v[0:3], v[48:51], 0
    v_mfma_f32_16x16x32_bf16 v[36:39], v[16:19], v[48:51], 0
    s_cbranch_vccnz main_kernel_cs_z1_f
main_kernel_cs_z_ok:
    v_mfma_f32_16x16x32_bf16 v[72:75], v[48:51], v[48:51], 0
    s_waitcnt lgkmcnt(1)
    s_sub_u32 s32, s52, s38
    v_mov_b32 v46, s32
    v_mfma_f32_16x16x32_bf16 v[32:35], v[4:7], v[52:55], v[32:35]
    buffer_load_dwordx2 v[86:87], v123, s[4:7], s19 offen offset:1024 sc1
    buffer_store_dword v46, v117, s[4:7], s46 offen sc1
    s_cmp_eq_u32 s17, 64
    s_waitcnt lgkmcnt(0)
    s_barrier
    ds_read_b64_tr_b16 v[56:57], v115 offset:16896
    ds_read_b64_tr_b16 v[58:59], v115 offset:17920
    ds_read_b64_tr_b16 v[60:61], v115 offset:18944
    ds_read_b64_tr_b16 v[62:63], v115 offset:19968
    s_cbranch_scc1 main_kernel_cs_last
    v_bfe_u32 v47, v123, 1, 7
    buffer_load_dwordx2 v[126:127], v123, s[4:7], s19 offen offset:1024 sc1
    buffer_load_dwordx4 v116, s[4:7], s27 offen offset:1024 sc1 lds
    v_mfma_f32_16x16x32_bf16 v[36:39], v[20:23], v[52:55], v[36:39]
    v_mfma_f32_16x16x32_bf16 v[72:75], v[52:55], v[52:55], v[72:75]
    s_waitcnt lgkmcnt(2)
    v_mfma_f32_16x16x32_bf16 v[72:75], v[56:59], v[56:59], v[72:75]
    v_mfma_f32_16x16x32_bf16 v[32:35], v[8:11], v[56:59], v[32:35]
    s_waitcnt lgkmcnt(0)
    v_mfma_f32_16x16x32_bf16 v[72:75], v[60:63], v[60:63], v[72:75]
    ds_read_b128 v[0:3], v113 offset:16384
    v_mfma_f32_16x16x32_bf16 v[32:35], v[12:15], v[60:63], v[32:35]
    ds_read_b128 v[16:19], v113 offset:18432
    v_mfma_f32_16x16x32_bf16 v[36:39], v[24:27], v[56:59], v[36:39]
    ds_read_b128 v[4:7], v113 offset:17408
    s_nop 0
    v_permlane32_swap_b32 v72, v73
    v_permlane32_swap_b32 v74, v75
    v_mfma_f32_16x16x32_bf16 v[36:39], v[28:31], v[60:63], v[36:39]
    ds_read_b128 v[20:23], v113 offset:19456
    v_mul_f32 v73, s30, v73
    v_mul_f32 v75, s30, v75
    v_exp_f32 v32, v32
    ds_read_b128 v[8:11], v113 offset:24576
    v_exp_f32 v33, v33
    ds_read_b128 v[12:15], v113 offset:25600
    v_exp_f32 v73, v73
    ds_read_b128 v[24:27], v113 offset:26624
    v_exp_f32 v75, v75
    ds_read_b128 v[28:31], v113 offset:27648
    v_exp_f32 v34, v34
    v_cvt_pk_bf16_f32 v72, v73, v75
    v_cvt_pk_bf16_f32 v73, v73, v75
    v_exp_f32 v35, v35
    s_waitcnt vmcnt(4)
    v_mfma_f32_16x16x16_bf16 v[40:43], v[100:101], v[72:73], 0
    v_exp_f32 v36, v36
    v_cvt_pk_bf16_f32 v32, v32, v33
    v_exp_f32 v37, v37
    v_cvt_pk_bf16_f32 v33, v34, v35
    v_exp_f32 v38, v38
    v_exp_f32 v39, v39
    v_cvt_pk_bf16_f32 v34, v36, v37
    v_cvt_pk_bf16_f32 v35, v38, v39
    s_nop 1
    v_mfma_f32_16x16x32_bf16 v[40:43], v[96:99], v[32:35], v[40:43]
    v_mfma_f32_16x16x32_bf16 v[64:67], v[88:91], v[32:35], 0
    v_mfma_f32_16x16x32_bf16 v[68:71], v[92:95], v[32:35], 0
    s_waitcnt vmcnt(3)
main_kernel_cs_v_ok:
    v_bitop3_b32 v44, v86, s22, 1 bitop3:0x28
    v_swap_b32 v85, v86
    v_cmp_ne_u32 vcc, 0, v44
main_kernel_cs_d_ok:
    s_nop 0
    v_mfma_f32_16x16x16_bf16 v[64:67], v[84:85], v[72:73], v[64:67]
    v_mfma_f32_16x16x16_bf16 v[68:71], v[86:87], v[72:73], v[68:71]
    s_cbranch_vccnz main_kernel_cs_v_f
    v_rcp_f32 v42, v40
    v_subrev_u32 v41, 0x21800000, v41
    v_cmp_lt_u32 vcc, 0x3c000000, v41
    s_nop 0
    v_pk_mul_f32 v[64:65], v[64:65], v[42:43] op_sel_hi:[1,0]
    v_pk_mul_f32 v[66:67], v[66:67], v[42:43] op_sel_hi:[1,0]
    v_cvt_pk_bf16_f32 v44, v64, v65
    v_pk_mul_f32 v[68:69], v[68:69], v[42:43] op_sel_hi:[1,0]
    v_cvt_pk_bf16_f32 v45, v66, v67
    v_pk_mul_f32 v[70:71], v[70:71], v[42:43] op_sel_hi:[1,0]
    v_cvt_pk_bf16_f32 v46, v68, v69
    v_cvt_pk_bf16_f32 v47, v70, v71
    ds_write_b128 v118, v[44:47]
    s_and_b64 s[42:43], vcc, s[44:45]
    s_cbranch_scc1 main_kernel_cs_d_f
    s_mov_b64 s[44:45], s[0:1]
    v_mov_b32 v64, 0
    v_mov_b32 v65, 0
    v_mov_b32 v66, 0
    v_mov_b32 v67, 0
    v_mov_b32 v68, 0
    v_mov_b32 v69, 0
    v_mov_b32 v70, 0
    v_mov_b32 v71, 0
    v_bfe_u32 v90, v123, 1, 7
    s_xor_b32 s23, s23, 0x80000
    s_waitcnt lgkmcnt(0)
    s_barrier
    ds_read_b128 v[56:59], v114 offset:1024
    ds_read_b128 v[60:63], v114 offset:1536
    ds_read_b128 v[48:51], v114 offset:0
    ds_read_b128 v[52:55], v114 offset:512
    s_xor_b32 s18, s18, 0x100000
    s_xor_b32 s19, s18, 0x80000
    s_xor_b32 s25, s25, 0x4000
    s_add_u32 s27, s27, 0x40000
    v_add_u32 v121, 4, v121
    v_xor_b32 v112, 0x4000, v112
    s_xor_b32 s36, s36, 0x4000
    s_mov_b32 m0, 0
    s_mov_b32 s54, s24
    s_xor_b32 s24, s24, 0x4000
    s_add_u32 s55, s25, 4096
    v_mov_b32 v89, s17
    s_mov_b32 s15, 0
    s_add_u32 s56, s19, 1536
    s_xor_b32 s9, s11, s40
    s_add_u32 s16, s20, s38
    s_waitcnt lgkmcnt(3)
    v_smfmac_f32_16x16x64_bf16 v[76:79], v[56:59], v[0:7], v110
    s_waitcnt lgkmcnt(2)
    ds_read_b128 v[0:3], v113 offset:20480
    v_smfmac_f32_16x16x64_bf16 v[76:79], v[60:63], v[8:15], v110
    s_waitcnt lgkmcnt(2)
    ds_read_b128 v[4:7], v113 offset:21504
    v_smfmac_f32_16x16x64_bf16 v[76:79], v[48:51], v[192:199], v110
    s_waitcnt lgkmcnt(2)
    ds_read_b128 v[8:11], v113 offset:28672
    v_smfmac_f32_16x16x64_bf16 v[76:79], v[52:55], v[200:207], v110
    ds_read_b128 v[12:15], v113 offset:29696
    buffer_load_dword v111, v90, s[4:7], s47 offen sc1
    v_smfmac_f32_16x16x64_bf16 v[80:83], v[56:59], v[16:23], v110
    ds_read_b128 v[16:19], v113 offset:22528
    v_smfmac_f32_16x16x64_bf16 v[80:83], v[60:63], v[24:31], v110
    ds_read_b128 v[20:23], v113 offset:23552
    v_smfmac_f32_16x16x64_bf16 v[80:83], v[48:51], v[208:215], v110
    ds_read_b128 v[24:27], v113 offset:30720
    v_cvt_pk_f16_f32 v40, v76, v77
    v_smfmac_f32_16x16x64_bf16 v[80:83], v[52:55], v[216:223], v110
    ds_read_b128 v[28:31], v113 offset:31744
    v_cvt_pk_f16_f32 v41, v78, v79
    v_smfmac_f32_16x16x64_bf16 v[64:67], v[48:51], v[224:231], v110
    v_bfi_b32 v40, 1, s22, v40
    v_smfmac_f32_16x16x64_bf16 v[64:67], v[52:55], v[232:239], v110
    s_waitcnt lgkmcnt(6)
    buffer_load_dword v111, v90, s[4:7], s47 offen sc1
    v_smfmac_f32_16x16x64_bf16 v[64:67], v[56:59], v[0:7], v110
    s_waitcnt lgkmcnt(4)
    buffer_store_dwordx2 v[40:41], v119, s[4:7], s21 offen offset:0 sc1
    v_cvt_pk_f16_f32 v42, v80, v81
    v_smfmac_f32_16x16x64_bf16 v[64:67], v[60:63], v[8:15], v110
    v_cvt_pk_f16_f32 v43, v82, v83
    v_smfmac_f32_16x16x64_bf16 v[68:71], v[48:51], v[240:247], v110
    v_bfi_b32 v42, 1, s22, v42
    v_smfmac_f32_16x16x64_bf16 v[68:71], v[52:55], v[248:255], v110
    s_waitcnt lgkmcnt(2)
    v_smfmac_f32_16x16x64_bf16 v[68:71], v[56:59], v[16:23], v110
    s_waitcnt lgkmcnt(0)
    buffer_store_dwordx2 v[42:43], v119, s[4:7], s21 offen offset:512 sc1
    v_cvt_pk_f16_f32 v44, v64, v65
    v_smfmac_f32_16x16x64_bf16 v[68:71], v[60:63], v[24:31], v110
    v_cvt_pk_f16_f32 v45, v66, v67
    v_bfi_b32 v44, 1, s22, v44
    s_cmp_lg_u32 s14, 0
    buffer_store_dwordx2 v[44:45], v119, s[4:7], s21 offen offset:1024 sc1
    s_nop 3
    v_cvt_pk_f16_f32 v46, v68, v69
    v_cvt_pk_f16_f32 v47, v70, v71
    v_bfi_b32 v46, 1, s22, v46
    buffer_store_dwordx2 v[46:47], v119, s[4:7], s21 offen offset:1536 sc1
    s_cbranch_scc1 main_kernel_cs_wx
    s_waitcnt vmcnt(5)
    s_xor_b32 s21, s21, 0x80000
main_kernel_cs_rgo:
    v_subrev_u32 v32, s20, v111
    s_memtime s[52:53]
    v_cmp_lt_u32 vcc, 0x100000, v32
    v_max_u32_dpp v32, v32, v32 row_shr:1 row_mask:0xf bank_mask:0xf
    s_nop 0
    s_nop 0
    v_max_u32_dpp v32, v32, v32 row_shr:2 row_mask:0xf bank_mask:0xf
    s_nop 0
    s_cbranch_vccnz main_kernel_cs_fsp
main_kernel_cs_fok:
    s_nop 0
    v_max_u32_dpp v32, v32, v32 row_shr:4 row_mask:0xf bank_mask:0xf
    s_memtime s[52:53]
    s_nop 0
    v_max_u32_dpp v32, v32, v32 row_shr:8 row_mask:0xf bank_mask:0xf
    s_memtime s[52:53]
    s_nop 0
    v_max_u32_dpp v32, v32, v32 row_bcast:15 row_mask:0xa bank_mask:0xf
    s_memtime s[52:53]
    s_sub_u32 s33, s52, s16
    v_readlane_b32 s32, v32, 31
    s_add_u32 s33, s33, 0x400
    s_memtime s[52:53]
    s_add_u32 s34, s16, 1650
    s_memtime s[52:53]
    s_min_u32 s32, s32, s33
    s_max_u32 s32, s32, s15
    s_add_u32 s34, s34, s32
    s_mov_b32 s35, 200
main_kernel_cs_fw:
    s_memtime s[52:53]
    s_cmp_ge_u32 s52, s34
    s_cbranch_scc1 main_kernel_cs_fgo
    s_memtime s[52:53]
    s_cmp_ge_u32 s52, s34
    s_cbranch_scc1 main_kernel_cs_fgo
    s_memtime s[52:53]
    s_cmp_ge_u32 s52, s34
    s_cbranch_scc1 main_kernel_cs_fgo
    s_memtime s[52:53]
    s_cmp_ge_u32 s52, s34
    s_cbranch_scc1 main_kernel_cs_fgo
    s_memtime s[52:53]
    s_cmp_ge_u32 s52, s34
    s_cbranch_scc1 main_kernel_cs_fgo
    s_memtime s[52:53]
    s_cmp_ge_u32 s52, s34
    s_cbranch_scc1 main_kernel_cs_fgo
    s_memtime s[52:53]
    s_cmp_ge_u32 s52, s34
    s_cbranch_scc1 main_kernel_cs_fgo
    s_memtime s[52:53]
    s_cmp_ge_u32 s52, s34
    s_cbranch_scc1 main_kernel_cs_fgo
    s_sub_u32 s35, s35, 1
    s_cbranch_scc0 main_kernel_cs_fw
main_kernel_cs_fgo:
    buffer_load_dwordx4 v[0:3], v120, s[4:7], s23 offen sc1
    s_add_u32 s35, s23, 0x8000
    buffer_load_dwordx4 v[4:7], v120, s[4:7], s35 offen sc1
    s_add_u32 s35, s23, 0x10000
    buffer_load_dwordx4 v[8:11], v120, s[4:7], s35 offen sc1
    ds_read_b32 v33, v123 offset:20992
    s_add_u32 s35, s23, 0x18000
    buffer_load_dwordx4 v[12:15], v120, s[4:7], s35 offen sc1
    s_add_u32 s35, s23, 0x20000
    buffer_load_dwordx4 v[16:19], v120, s[4:7], s35 offen sc1
    s_add_u32 s35, s23, 0x28000
    buffer_load_dwordx4 v[20:23], v120, s[4:7], s35 offen sc1
    s_add_u32 s35, s23, 0x30000
    buffer_load_dwordx4 v[24:27], v120, s[4:7], s35 offen sc1
    s_add_u32 s35, s23, 0x38000
    buffer_load_dwordx4 v[28:31], v120, s[4:7], s35 offen sc1
    s_mov_b64 exec, 1
    s_waitcnt lgkmcnt(0)
    v_sub_u32 v33, s34, v33
    v_bfi_b32 v33, 1, s40, v33
    buffer_store_dword v33, off, s[4:7], s18 offset:1536 sc1
    v_readfirstlane_b32 s10, v33
    s_mov_b64 exec, -1
    s_waitcnt vmcnt(8)
    v_mfma_f32_16x16x32_f16 v[76:79], v[0:3], v[106:109], 0
    v_xor_b32 v36, s22, v0
    v_bitop3_b32 v36, v2, s22, v36 bitop3:0xbe
    s_waitcnt vmcnt(7)
    v_mfma_f32_16x16x32_f16 v[76:79], v[4:7], v[106:109], v[76:79]
    v_bitop3_b32 v36, v4, s22, v36 bitop3:0xbe
    v_bitop3_b32 v36, v6, s22, v36 bitop3:0xbe
    s_waitcnt vmcnt(6)
    v_mfma_f32_16x16x32_f16 v[76:79], v[8:11], v[106:109], v[76:79]
    v_bitop3_b32 v36, v8, s22, v36 bitop3:0xbe
    v_bitop3_b32 v36, v10, s22, v36 bitop3:0xbe
    s_waitcnt vmcnt(5)
    v_mfma_f32_16x16x32_f16 v[76:79], v[12:15], v[106:109], v[76:79]
    v_bitop3_b32 v36, v12, s22, v36 bitop3:0xbe
    v_bitop3_b32 v36, v14, s22, v36 bitop3:0xbe
    s_waitcnt vmcnt(4)
    v_mfma_f32_16x16x32_f16 v[76:79], v[16:19], v[106:109], v[76:79]
    v_bitop3_b32 v36, v16, s22, v36 bitop3:0xbe
    v_bitop3_b32 v36, v18, s22, v36 bitop3:0xbe
    s_waitcnt vmcnt(3)
    v_mfma_f32_16x16x32_f16 v[76:79], v[20:23], v[106:109], v[76:79]
    v_bitop3_b32 v36, v20, s22, v36 bitop3:0xbe
    v_bitop3_b32 v36, v22, s22, v36 bitop3:0xbe
    s_waitcnt vmcnt(2)
    v_mfma_f32_16x16x32_f16 v[76:79], v[24:27], v[106:109], v[76:79]
    v_bitop3_b32 v36, v24, s22, v36 bitop3:0xbe
    v_bitop3_b32 v36, v26, s22, v36 bitop3:0xbe
    s_waitcnt vmcnt(1)
    v_mfma_f32_16x16x32_f16 v[76:79], v[28:31], v[106:109], v[76:79]
    v_bitop3_b32 v36, v28, s22, v36 bitop3:0xbe
    v_bitop3_b32 v36, v30, s22, v36 bitop3:0xbe
    v_and_b32 v36, 1, v36
    v_cmp_ne_u32 vcc, 0, v36
    s_nop 3
    v_cvt_pk_bf16_f32 v126, v76, v77
    v_cvt_pk_bf16_f32 v127, v78, v79
    s_cbranch_vccnz main_kernel_cs_r_f
    buffer_store_dwordx2 v[126:127], v122, s[4:7], s24 offen sc1
    s_sub_u32 s20, s34, s38
    s_mov_b32 s3, s34
    buffer_store_dword v89, v117, s[4:7], s46 offen offset:512 sc1
    v_mov_b32 v32, -1
    v_mov_b32 v33, -1
    v_mov_b32 v64, 0
    v_mov_b32 v65, 0
    v_mov_b32 v66, 0
    v_mov_b32 v67, 0
    v_mov_b32 v68, 0
    v_mov_b32 v69, 0
    v_mov_b32 v70, 0
    v_mov_b32 v71, 0
    v_mov_b32 v96, 0
    v_mov_b32 v97, 0
    v_mov_b32 v98, 0
    v_mov_b32 v99, 0
    buffer_store_dwordx2 v[32:33], v122, s[4:7], s54 offen sc1
    s_cmp_eq_u32 s12, 0
    v_add_u32 v56, s59, v115
    s_cbranch_scc0 main_kernel_cs_vma
    ds_read_b64_tr_b16 v[80:81], v56 offset:16384
    ds_read_b64_tr_b16 v[82:83], v56 offset:17408
    s_waitcnt lgkmcnt(0)
    s_nop 15
    s_nop 15
    s_nop 5
    s_buffer_load_dword s9, s[4:7], s56 glc
    buffer_load_dword v111, v90, s[4:7], s47 offen offset:512 sc1
    buffer_load_dwordx4 v116, s[4:7], s25 offen offset:0 sc1 lds
    buffer_load_dwordx4 v116, s[4:7], s25 offen offset:1024 sc1 lds
    buffer_load_dwordx4 v116, s[4:7], s25 offen offset:2048 sc1 lds
    buffer_load_dwordx4 v116, s[4:7], s25 offen offset:3072 sc1 lds
    s_mov_b32 m0, 4096
    s_nop 0
    buffer_load_dwordx4 v116, s[4:7], s55 offen offset:0 sc1 lds
    buffer_load_dwordx4 v116, s[4:7], s55 offen offset:1024 sc1 lds
    buffer_load_dwordx4 v116, s[4:7], s55 offen offset:2048 sc1 lds
    buffer_load_dwordx4 v116, s[4:7], s55 offen offset:3072 sc1 lds
    v_mov_b32 v34, v90
    s_mov_b32 m0, s36
    s_barrier
    ds_read_b32 v35, v123 offset:20480
    buffer_load_dwordx4 v[88:91], v116, s[4:7], s28 offen offset:0 sc1
    buffer_load_dwordx4 v[92:95], v116, s[4:7], s28 offen offset:1024 sc1
    buffer_load_dwordx4 v116, s[4:7], s27 offen offset:0 sc1 lds
    buffer_store_dwordx4 v[80:83], v125, s[4:7], s26 offen sc1
    s_branch main_kernel_cs_kva
main_kernel_cs_vma:
    v_mfma_f32_16x16x32_bf16 v[56:59], v[102:105], v[84:87], 0
    s_nop 7
    v_cvt_pk_bf16_f32 v80, v56, v57
    v_cvt_pk_bf16_f32 v81, v58, v59
    s_nop 15
    s_nop 15
    s_nop 5
    s_buffer_load_dword s9, s[4:7], s56 glc
    buffer_load_dword v111, v90, s[4:7], s47 offen offset:512 sc1
    buffer_load_dwordx4 v116, s[4:7], s25 offen offset:0 sc1 lds
    buffer_load_dwordx4 v116, s[4:7], s25 offen offset:1024 sc1 lds
    buffer_load_dwordx4 v116, s[4:7], s25 offen offset:2048 sc1 lds
    buffer_load_dwordx4 v116, s[4:7], s25 offen offset:3072 sc1 lds
    s_mov_b32 m0, 4096
    s_nop 0
    buffer_load_dwordx4 v116, s[4:7], s55 offen offset:0 sc1 lds
    buffer_load_dwordx4 v116, s[4:7], s55 offen offset:1024 sc1 lds
    buffer_load_dwordx4 v116, s[4:7], s55 offen offset:2048 sc1 lds
    buffer_load_dwordx4 v116, s[4:7], s55 offen offset:3072 sc1 lds
    v_mov_b32 v34, v90
    s_mov_b32 m0, s36
    s_barrier
    ds_read_b32 v35, v123 offset:20480
    buffer_load_dwordx4 v[88:91], v116, s[4:7], s28 offen offset:0 sc1
    buffer_load_dwordx4 v[92:95], v116, s[4:7], s28 offen offset:1024 sc1
    buffer_load_dwordx4 v116, s[4:7], s27 offen offset:0 sc1 lds
    buffer_store_dwordx2 v[80:81], v123, s[4:7], s26 offen sc1
main_kernel_cs_kva:
    s_add_u32 s26, s26, 0x10000
    s_waitcnt vmcnt(12)
    v_cmp_gt_i32 vcc, s17, v111
    v_readfirstlane_b32 s38, v35
    s_cbranch_vccnz main_kernel_cs_mc_f
    s_waitcnt vmcnt(4)
    s_branch main_kernel_cs_top
main_kernel_cs_wx:
    s_cmp_lg_u32 s14, 1
    s_cbranch_scc1 main_kernel_cs_wy
    s_memrealtime s[32:33]
    s_nop 0
    s_nop 0
    s_memrealtime s[32:33]
    s_nop 0
    s_nop 0
    s_memrealtime s[32:33]
    s_nop 0
    s_nop 0
    s_memrealtime s[32:33]
    s_nop 0
    s_nop 0
    s_memrealtime s[32:33]
    s_nop 0
    s_nop 0
    s_memrealtime s[32:33]
    s_nop 0
    s_nop 0
    s_memrealtime s[32:33]
    s_nop 0
    s_nop 0
    s_memrealtime s[32:33]
    s_nop 0
    s_nop 0
    s_memrealtime s[32:33]
    s_nop 0
    s_nop 0
    s_memrealtime s[32:33]
    s_nop 0
    s_nop 0
    s_memrealtime s[32:33]
    s_nop 0
    s_nop 0
    s_memrealtime s[32:33]
    s_nop 0
    s_nop 0
    s_mov_b32 s34, s32
    s_memrealtime s[32:33]
    s_cmp_lg_u32 s32, s34
    s_cbranch_scc1 main_kernel_cs_e1
    s_memrealtime s[32:33]
    s_cmp_lg_u32 s32, s34
    s_cbranch_scc1 main_kernel_cs_e1
    s_memrealtime s[32:33]
    s_cmp_lg_u32 s32, s34
    s_cbranch_scc1 main_kernel_cs_e1
    s_memrealtime s[32:33]
    s_cmp_lg_u32 s32, s34
    s_cbranch_scc1 main_kernel_cs_e1
    s_memrealtime s[32:33]
    s_cmp_lg_u32 s32, s34
    s_cbranch_scc1 main_kernel_cs_e1
    s_memrealtime s[32:33]
    s_cmp_lg_u32 s32, s34
    s_cbranch_scc1 main_kernel_cs_e1
    s_memrealtime s[32:33]
    s_cmp_lg_u32 s32, s34
    s_cbranch_scc1 main_kernel_cs_e1
    s_memrealtime s[32:33]
    s_cmp_lg_u32 s32, s34
    s_cbranch_scc1 main_kernel_cs_e1
    s_memrealtime s[32:33]
    s_cmp_lg_u32 s32, s34
    s_cbranch_scc1 main_kernel_cs_e1
    s_memrealtime s[32:33]
    s_cmp_lg_u32 s32, s34
    s_cbranch_scc1 main_kernel_cs_e1
    s_memrealtime s[32:33]
    s_cmp_lg_u32 s32, s34
    s_cbranch_scc1 main_kernel_cs_e1
    s_memrealtime s[32:33]
    s_cmp_lg_u32 s32, s34
    s_cbranch_scc1 main_kernel_cs_e1
main_kernel_cs_e1:
    s_memtime s[52:53]
    s_mul_i32 s34, s32, 22
    s_waitcnt lgkmcnt(0)
    s_sub_u32 s32, s52, s34
    s_sub_u32 s33, s32, s38
    s_sub_u32 s33, s33, s10
    s_max_i32 s33, s33, -400
    s_min_i32 s33, s33, 400
    s_ashr_i32 s33, s33, 2
    s_add_u32 s10, s10, s33
    s_mov_b32 s33, s10
    s_ashr_i32 s34, s33, 2
    s_add_u32 s34, s34, s32
    v_mov_b32 v34, s34
    v_mov_b32 v33, s32
    ds_write2st64_b32 v123, v33, v34 offset0:80 offset1:82
    v_add_u32 v37, s33, v34
main_kernel_cs_wy:
    s_xor_b32 s21, s21, 0x80000
    v_mov_b32 v64, 0
    v_mov_b32 v65, 0
    v_mov_b32 v66, 0
    v_mov_b32 v67, 0
    v_mov_b32 v68, 0
    v_mov_b32 v69, 0
    v_mov_b32 v70, 0
    v_mov_b32 v71, 0
    v_mov_b32 v96, 0
    v_mov_b32 v97, 0
    v_mov_b32 v98, 0
    v_mov_b32 v99, 0
    s_cmp_eq_u32 s12, 0
    v_add_u32 v56, s59, v115
    s_cbranch_scc0 main_kernel_cs_vmb
    ds_read_b64_tr_b16 v[80:81], v56 offset:16384
    ds_read_b64_tr_b16 v[82:83], v56 offset:17408
    s_waitcnt lgkmcnt(0)
    s_waitcnt vmcnt(0)
    s_mov_b32 m0, s36
    s_barrier
    ds_read_b32 v35, v123 offset:20480
    ds_write_b32 v124, v37 offset:3584
    buffer_load_dwordx4 v[88:91], v116, s[4:7], s28 offen offset:0 sc1
    buffer_load_dwordx4 v[92:95], v116, s[4:7], s28 offen offset:1024 sc1
    buffer_load_dwordx4 v116, s[4:7], s27 offen offset:0 sc1 lds
    buffer_store_dwordx4 v[80:83], v125, s[4:7], s26 offen sc1
    s_branch main_kernel_cs_kvb
main_kernel_cs_vmb:
    v_mfma_f32_16x16x32_bf16 v[56:59], v[102:105], v[84:87], 0
    s_nop 7
    v_cvt_pk_bf16_f32 v80, v56, v57
    v_cvt_pk_bf16_f32 v81, v58, v59
    s_waitcnt vmcnt(0)
    s_mov_b32 m0, s36
    s_barrier
    ds_read_b32 v35, v123 offset:20480
    ds_write_b32 v124, v37 offset:3584
    buffer_load_dwordx4 v[88:91], v116, s[4:7], s28 offen offset:0 sc1
    buffer_load_dwordx4 v[92:95], v116, s[4:7], s28 offen offset:1024 sc1
    buffer_load_dwordx4 v116, s[4:7], s27 offen offset:0 sc1 lds
    buffer_store_dwordx2 v[80:81], v123, s[4:7], s26 offen sc1
main_kernel_cs_kvb:
    s_add_u32 s26, s26, 0x10000
    s_mov_b64 exec, 1
    buffer_store_dword v100, off, s[4:7], s39 sc1
    s_mov_b64 exec, -1
    s_add_u32 s39, s39, 4
    s_waitcnt lgkmcnt(0)
    v_readfirstlane_b32 s38, v35
    v_mov_b32 v35, 0
    v_mov_b32 v35, 0
    v_mov_b32 v35, 0
    v_mov_b32 v35, 0
    v_mov_b32 v35, 0
    v_mov_b32 v35, 0
main_kernel_cs_end:
    s_branch main_kernel_cs_top
main_kernel_cs_mc_f:
    s_mov_b32 m0, 0
    s_sub_u32 s29, s29, 1
    s_cbranch_scc1 main_kernel_end
    buffer_load_dword v111, v34, s[4:7], s47 offen offset:512 sc1
    buffer_load_dwordx4 v116, s[4:7], s25 offen offset:0 sc1 lds
    buffer_load_dwordx4 v116, s[4:7], s25 offen offset:1024 sc1 lds
    buffer_load_dwordx4 v116, s[4:7], s25 offen offset:2048 sc1 lds
    buffer_load_dwordx4 v116, s[4:7], s25 offen offset:3072 sc1 lds
    s_mov_b32 m0, 4096
    s_nop 0
    buffer_load_dwordx4 v116, s[4:7], s55 offen offset:0 sc1 lds
    buffer_load_dwordx4 v116, s[4:7], s55 offen offset:1024 sc1 lds
    buffer_load_dwordx4 v116, s[4:7], s55 offen offset:2048 sc1 lds
    buffer_load_dwordx4 v116, s[4:7], s55 offen offset:3072 sc1 lds
    s_waitcnt vmcnt(8)
    v_cmp_gt_i32 vcc, s17, v111
    v_readfirstlane_b32 s38, v35
    s_cbranch_vccnz main_kernel_cs_mc_f
    s_waitcnt vmcnt(0)
    s_branch main_kernel_cs_end
main_kernel_cs_t_w:
    s_mov_b32 s35, 200
main_kernel_cs_t_s:
    s_memtime s[52:53]
    s_cmp_ge_u32 s52, s34
    s_cbranch_scc1 main_kernel_cs_t_go
    s_memtime s[52:53]
    s_cmp_ge_u32 s52, s34
    s_cbranch_scc1 main_kernel_cs_t_go
    s_memtime s[52:53]
    s_cmp_ge_u32 s52, s34
    s_cbranch_scc1 main_kernel_cs_t_go
    s_memtime s[52:53]
    s_cmp_ge_u32 s52, s34
    s_cbranch_scc1 main_kernel_cs_t_go
    s_memtime s[52:53]
    s_cmp_ge_u32 s52, s34
    s_cbranch_scc1 main_kernel_cs_t_go
    s_memtime s[52:53]
    s_cmp_ge_u32 s52, s34
    s_cbranch_scc1 main_kernel_cs_t_go
    s_memtime s[52:53]
    s_cmp_ge_u32 s52, s34
    s_cbranch_scc1 main_kernel_cs_t_go
    s_memtime s[52:53]
    s_cmp_ge_u32 s52, s34
    s_cbranch_scc1 main_kernel_cs_t_go
    s_sub_u32 s35, s35, 1
    s_cbranch_scc0 main_kernel_cs_t_s
    s_branch main_kernel_cs_t_go
main_kernel_cs_t_p:
    s_waitcnt lgkmcnt(0)
    s_xor_b32 s32, s9, s22
    s_bitcmp1_b32 s32, 0
    s_cbranch_scc0 main_kernel_cs_t_ok
    s_buffer_load_dword s9, s[4:7], s56 glc
    s_sub_u32 s29, s29, 1
    s_cbranch_scc1 main_kernel_end
    s_branch main_kernel_cs_t_p
main_kernel_cs_z0_f:
    buffer_load_dwordx2 v[126:127], v123, s[4:7], s19 offen offset:0 sc1
    s_sub_u32 s29, s29, 1
    s_cbranch_scc1 main_kernel_end
    s_waitcnt vmcnt(0)
    s_branch main_kernel_cs_z0
main_kernel_cs_z2_f:
    buffer_load_dwordx2 v[64:65], v123, s[4:7], s19 offen offset:512 sc1
    s_sub_u32 s29, s29, 1
    s_cbranch_scc1 main_kernel_end
    s_waitcnt vmcnt(0)
main_kernel_cs_z1_f:
    s_waitcnt vmcnt(0)
    s_memtime s[52:53]
    v_dot2_f32_bf16 v44, v64, s37, v68
    v_dot2_f32_bf16 v45, v64, s57, v69
    v_dot2_f32_bf16 v46, v65, s37, v70
    v_dot2_f32_bf16 v47, v65, s57, v71
    v_bitop3_b32 v60, v64, s22, 1 bitop3:0x28
    v_cvt_pk_bf16_f32 v44, v44, v45
    v_cmp_ne_u32 vcc, 0, v60
    v_cvt_pk_bf16_f32 v45, v46, v47
    ds_write_b64 v124, v[44:45] offset:512
    s_cbranch_vccnz main_kernel_cs_z2_f
    s_branch main_kernel_cs_z_ok
main_kernel_cs_kvw:
    s_cmp_eq_u32 s17, 64
    s_cbranch_scc1 main_kernel_cs_kvok
    s_waitcnt vmcnt(0)
    s_mov_b32 exec_lo, 0
    s_mov_b32 exec_hi, 0x3f00
    v_subrev_u32 v127, 0, v121
main_kernel_cs_kvp:
    buffer_load_dword v126, v127, s[4:7], 0 offen sc1
    s_waitcnt vmcnt(0)
    v_cmp_eq_u32 vcc, 0, v126
    s_cbranch_vccz main_kernel_cs_kvp_ok
    s_sleep 2
    s_sub_u32 s29, s29, 1
    s_cbranch_scc0 main_kernel_cs_kvp
    s_branch main_kernel_end
main_kernel_cs_kvp_ok:
    s_mov_b64 exec, -1
    s_branch main_kernel_cs_kvok
main_kernel_cs_last:
    buffer_load_dwordx2 v[86:87], v123, s[4:7], s19 offen offset:1024 sc1
    s_sub_u32 s29, s29, 1
    s_cbranch_scc1 main_kernel_end
    s_waitcnt vmcnt(0) lgkmcnt(0)
    v_bitop3_b32 v44, v86, s22, 1 bitop3:0x28
    v_cmp_ne_u32 vcc, 0, v44
    s_cbranch_vccnz main_kernel_cs_last
    v_swap_b32 v85, v86
    s_cmp_eq_u32 s12, 0
    v_add_u32 v56, s59, v115
    s_cbranch_scc0 main_kernel_cs_vmc
    ds_read_b64_tr_b16 v[80:81], v56 offset:16384
    ds_read_b64_tr_b16 v[82:83], v56 offset:17408
    s_waitcnt lgkmcnt(0)
    buffer_store_dwordx4 v[80:83], v125, s[4:7], s26 offen sc1
    s_branch main_kernel_cs_kvc
main_kernel_cs_vmc:
    v_mfma_f32_16x16x32_bf16 v[56:59], v[102:105], v[84:87], 0
    s_nop 7
    v_cvt_pk_bf16_f32 v80, v56, v57
    v_cvt_pk_bf16_f32 v81, v58, v59
    buffer_store_dwordx2 v[80:81], v123, s[4:7], s26 offen sc1
main_kernel_cs_kvc:
    s_add_u32 s26, s26, 0x10000
    s_branch main_kernel_end
main_kernel_cs_m_f:
main_kernel_cs_m_t:
    ds_read_b128 v[0:3], v116 offset:0
    ds_read_b128 v[4:7], v116 offset:1024
    ds_read_b128 v[8:11], v116 offset:2048
    ds_read_b128 v[12:15], v116 offset:3072
    ds_read_b128 v[16:19], v116 offset:4096
    ds_read_b128 v[20:23], v116 offset:5120
    ds_read_b128 v[24:27], v116 offset:6144
    ds_read_b128 v[28:31], v116 offset:7168
    s_waitcnt lgkmcnt(0)
    v_max_u32 v126, v0, v2
    v_max3_u32 v126, v126, v4, v6
    v_max3_u32 v126, v126, v8, v10
    v_max3_u32 v126, v126, v12, v14
    v_max3_u32 v126, v126, v16, v18
    v_max3_u32 v126, v126, v20, v22
    v_max3_u32 v126, v126, v24, v26
    v_max3_u32 v126, v126, v28, v30
    v_cmp_eq_u32 vcc, -1, v126
    s_cbranch_vccz main_kernel_cs_m_g
    s_barrier
    s_lshl_b32 s32, s14, 11
    s_add_u32 m0, s32, 0
    s_add_u32 s32, s32, s25
    buffer_load_dwordx4 v116, s[4:7], s32 offen offset:0 sc1 lds
    buffer_load_dwordx4 v116, s[4:7], s32 offen offset:1024 sc1 lds
    s_sub_u32 s29, s29, 1
    s_cbranch_scc1 main_kernel_end
    s_waitcnt vmcnt(0)
    s_barrier
    s_branch main_kernel_cs_m_t
main_kernel_cs_m_g:
    s_mov_b64 s[44:45], 0
    v_mov_b32 v64, 0
    v_mov_b32 v65, 0
    v_mov_b32 v66, 0
    v_mov_b32 v67, 0
    v_mov_b32 v68, 0
    v_mov_b32 v69, 0
    v_mov_b32 v70, 0
    v_mov_b32 v71, 0
    v_mov_b32 v96, 0
    v_mov_b32 v97, 0
    v_mov_b32 v98, 0
    v_mov_b32 v99, 0
    s_branch main_kernel_cs_mrd
main_kernel_cs_v_f:
    v_swap_b32 v85, v86
    s_nop 7
    s_waitcnt vmcnt(1)
main_kernel_cs_v_t:
    s_memtime s[52:53]
    v_bitop3_b32 v44, v126, s22, 1 bitop3:0x28
    v_cmp_ne_u32 vcc, 0, v44
    s_sub_u32 s29, s29, 1
    s_cbranch_scc1 main_kernel_end
    s_cbranch_vccnz main_kernel_cs_v_g
    v_mfma_f32_16x16x32_bf16 v[64:67], v[88:91], v[32:35], 0
    v_mfma_f32_16x16x32_bf16 v[68:71], v[92:95], v[32:35], 0
    v_mov_b32 v86, v126
    v_mov_b32 v87, v127
    s_waitcnt lgkmcnt(0)
    s_sub_u32 s32, s52, s38
    s_add_u32 s32, s32, -550
    v_mov_b32 v46, s32
    buffer_store_dword v46, v117, s[4:7], s46 offen sc1
    s_branch main_kernel_cs_v_ok
main_kernel_cs_v_g:
    buffer_load_dwordx2 v[126:127], v123, s[4:7], s19 offen offset:1024 sc1
    s_waitcnt lgkmcnt(0)
    s_sub_u32 s32, s52, s38
    s_add_u32 s32, s32, -50
    v_mov_b32 v46, s32
    buffer_store_dword v46, v117, s[4:7], s46 offen sc1
    s_waitcnt vmcnt(0)
    s_branch main_kernel_cs_v_t
main_kernel_cs_d_f:
    s_memtime s[52:53]
    s_waitcnt vmcnt(1) lgkmcnt(0)
    s_sub_u32 s32, s52, s38
    s_add_u32 s32, s32, 300
    v_mov_b32 v46, s32
    buffer_store_dword v46, v117, s[4:7], s46 offen sc1
    ds_read_b128 v[0:3], v112 offset:0
    ds_read_b128 v[4:7], v112 offset:1024
    ds_read_b128 v[8:11], v112 offset:2048
    ds_read_b128 v[12:15], v112 offset:3072
    ds_read_b128 v[16:19], v112 offset:4096
    ds_read_b128 v[20:23], v112 offset:5120
    ds_read_b128 v[24:27], v112 offset:6144
    ds_read_b128 v[28:31], v112 offset:7168
    s_waitcnt lgkmcnt(0)
    v_mfma_f32_16x16x32_bf16 v[32:35], v[0:3], v[48:51], 0
    v_mfma_f32_16x16x32_bf16 v[36:39], v[16:19], v[48:51], 0
    v_mfma_f32_16x16x32_bf16 v[72:75], v[48:51], v[48:51], 0
    v_mfma_f32_16x16x32_bf16 v[32:35], v[4:7], v[52:55], v[32:35]
    v_mfma_f32_16x16x32_bf16 v[36:39], v[20:23], v[52:55], v[36:39]
    v_mfma_f32_16x16x32_bf16 v[72:75], v[52:55], v[52:55], v[72:75]
    v_mfma_f32_16x16x32_bf16 v[32:35], v[8:11], v[56:59], v[32:35]
    v_mfma_f32_16x16x32_bf16 v[36:39], v[24:27], v[56:59], v[36:39]
    v_mfma_f32_16x16x32_bf16 v[72:75], v[56:59], v[56:59], v[72:75]
    v_mfma_f32_16x16x32_bf16 v[32:35], v[12:15], v[60:63], v[32:35]
    v_mfma_f32_16x16x32_bf16 v[36:39], v[28:31], v[60:63], v[36:39]
    v_mfma_f32_16x16x32_bf16 v[72:75], v[60:63], v[60:63], v[72:75]
    s_nop 7
    ds_read_b128 v[0:3], v113 offset:16384
    ds_read_b128 v[16:19], v113 offset:18432
    ds_read_b128 v[4:7], v113 offset:17408
    ds_read_b128 v[20:23], v113 offset:19456
    ds_read_b128 v[8:11], v113 offset:24576
    ds_read_b128 v[24:27], v113 offset:26624
    ds_read_b128 v[12:15], v113 offset:25600
    ds_read_b128 v[28:31], v113 offset:27648
    v_permlane32_swap_b32 v72, v73
    v_permlane32_swap_b32 v74, v75
    v_mul_f32 v73, s30, v73
    v_mul_f32 v75, s30, v75
    v_max_f32 v126, v73, v75
    v_max3_f32 v126, v126, v32, v33
    v_max3_f32 v126, v126, v34, v35
    v_max3_f32 v126, v126, v36, v37
    v_max3_f32 v126, v126, v38, v39
    v_mov_b32 v127, v126
    s_nop 1
    v_permlane32_swap_b32 v126, v127
    v_max_f32 v126, v126, v127
    v_mov_b32 v127, v126
    s_nop 1
    v_permlane16_swap_b32 v126, v127
    v_max_f32 v126, v126, v127
    v_sub_f32 v32, v32, v126
    v_sub_f32 v33, v33, v126
    v_sub_f32 v34, v34, v126
    v_sub_f32 v35, v35, v126
    v_sub_f32 v36, v36, v126
    v_sub_f32 v37, v37, v126
    v_sub_f32 v38, v38, v126
    v_sub_f32 v39, v39, v126
    v_sub_f32 v73, v73, v126
    v_sub_f32 v75, v75, v126
    v_exp_f32 v32, v32
    v_exp_f32 v33, v33
    v_exp_f32 v34, v34
    v_exp_f32 v35, v35
    v_exp_f32 v36, v36
    v_exp_f32 v37, v37
    v_exp_f32 v38, v38
    v_exp_f32 v39, v39
    v_exp_f32 v73, v73
    v_exp_f32 v75, v75
    v_cvt_pk_bf16_f32 v32, v32, v33
    v_cvt_pk_bf16_f32 v33, v34, v35
    v_cvt_pk_bf16_f32 v34, v36, v37
    v_cvt_pk_bf16_f32 v35, v38, v39
    v_cvt_pk_bf16_f32 v72, v73, v75
    v_cvt_pk_bf16_f32 v73, v73, v75
    s_nop 1
    v_mfma_f32_16x16x32_bf16 v[64:67], v[88:91], v[32:35], 0
    v_mfma_f32_16x16x32_bf16 v[68:71], v[92:95], v[32:35], 0
    v_mfma_f32_16x16x32_bf16 v[40:43], v[96:99], v[32:35], 0
    s_nop 3
    s_nop 1
    v_mfma_f32_16x16x16_bf16 v[40:43], v[100:101], v[72:73], v[40:43]
    s_mov_b64 s[44:45], 0
    s_mov_b64 vcc, 0
    s_nop 7
    s_branch main_kernel_cs_d_ok
main_kernel_cs_fsp:
    s_mov_b32 s35, 40
main_kernel_cs_fsl:
    buffer_load_dword v111, v90, s[4:7], s47 offen sc1
    s_waitcnt vmcnt(1)
    v_subrev_u32 v32, s20, v111
    v_cmp_lt_u32 vcc, 0x100000, v32
    s_cbranch_vccz main_kernel_cs_rgo
    s_sub_u32 s35, s35, 1
    s_cbranch_scc0 main_kernel_cs_fsl
    v_mov_b32 v32, 0
    s_branch main_kernel_cs_fok
main_kernel_cs_r_f:
    s_memtime s[52:53]
    buffer_load_dword v111, v90, s[4:7], s47 offen sc1
    s_waitcnt lgkmcnt(0)
    s_sub_u32 s15, s52, s16
    s_add_u32 s15, s15, -1500
    s_waitcnt vmcnt(0)
    s_sub_u32 s29, s29, 1
    s_cbranch_scc1 main_kernel_end
    s_branch main_kernel_cs_rgo
main_kernel_att:
    s_cmp_gt_u32 s13, 1
    s_cbranch_scc1 main_kernel_p_end
    s_cmp_lg_u32 s14, 0
    s_cbranch_scc1 main_kernel_p_bar
    s_lshl_b32 s32, s13, 21
    s_add_u32 s32, s32, 0x8c00000
    v_lshlrev_b32 v2, 2, v250
    v_mov_b32 v3, -1
    s_mov_b64 s[20:21], -1
    s_mov_b32 s34, 12
    s_mov_b32 exec_hi, 0
    s_waitcnt vmcnt(0)
main_kernel_p_lp:
    s_memtime s[16:17]
    s_waitcnt lgkmcnt(0)
    buffer_store_dword v3, v2, s[4:7], s32 offen sc1
    s_waitcnt vmcnt(0)
    s_memtime s[18:19]
    s_xor_b32 s32, s32, 0x2000
    s_waitcnt lgkmcnt(0)
    s_sub_u32 s33, s18, s16
    s_min_u32 s20, s20, s33
    s_memtime s[16:17]
    s_waitcnt lgkmcnt(0)
    buffer_store_dword v3, v2, s[4:7], s32 offen sc1
    s_waitcnt vmcnt(0)
    s_memtime s[18:19]
    s_xor_b32 s32, s32, 0x2000
    s_waitcnt lgkmcnt(0)
    s_sub_u32 s33, s18, s16
    s_min_u32 s21, s21, s33
    s_add_u32 s32, s32, 128
    s_sub_u32 s34, s34, 1
    s_cmp_lg_u32 s34, 0
    s_cbranch_scc1 main_kernel_p_lp
    s_cmp_lt_u32 s21, s20
    s_cselect_b32 s32, 3, 2
    s_lshl_b32 s33, s13, 2
    v_mov_b32 v3, s32
    s_mov_b64 exec, 1
    buffer_store_dword v3, off, s[60:63], s33 offset:16 sc1
    s_mov_b64 exec, -1
main_kernel_p_bar:
    s_barrier
main_kernel_p_end:
    v_lshlrev_b32 v0, 2, v250
    s_mov_b32 s32, 0x841f000
main_kernel_awf:
    buffer_load_dword v2, v0, s[4:7], s32 offen sc1
    s_waitcnt vmcnt(0)
    v_cmp_eq_u32 vcc, 0, v2
    s_cbranch_vccz main_kernel_awf_ok
    s_sleep 4
    s_sub_u32 s29, s29, 1
    s_cbranch_scc0 main_kernel_awf
    s_branch main_kernel_end
main_kernel_awf_ok:
main_kernel_att2:
    s_lshl_b32 s28, s13, 1
    s_lshr_b32 s31, s14, 1
    s_add_u32 s28, s28, s31
    s_and_b32 s30, s14, 1
    v_lshlrev_b32 v204, 4, v250
    v_and_b32 v200, 15, v250
    v_lshrrev_b32 v201, 4, v250
    v_and_b32 v202, 7, v250
    v_lshl_add_u32 v202, v201, 3, v202
    v_lshlrev_b32 v205, 4, v202
    v_bfe_u32 v206, v204, 1, 8
    v_min_u32 v207, 2, v250
    v_lshlrev_b32 v207, 13, v207
    s_lshl_b32 s31, s28, 8
    s_sub_u32 s31, 80912, s31
    s_cmp_eq_u32 s12, 7
    s_cselect_b32 s25, 61, 0
    s_cselect_b32 s32, 16, 0
    s_sub_u32 s31, s31, s32
    s_mov_b64 exec, 0xf0
    v_lshl_add_u32 v207, v250, 8, s31
    s_mov_b64 exec, -1
    v_mov_b32 v208, 1
    v_mov_b32 v209, 0
    s_lshl_b32 s31, s30, 4
    v_add_u32 v200, s31, v200
    v_lshlrev_b32 v202, 2, v201
    v_sub_u32 v200, v200, v202
    v_mov_b32 v202, 0xf149f2ca
    v_cmp_le_i32 vcc, 0, v200
    s_nop 1
    v_cndmask_b32 v124, v202, 0, vcc
    v_cmp_le_i32 vcc, 1, v200
    s_nop 1
    v_cndmask_b32 v125, v202, 0, vcc
    v_cmp_le_i32 vcc, 2, v200
    s_nop 1
    v_cndmask_b32 v126, v202, 0, vcc
    v_cmp_le_i32 vcc, 3, v200
    s_nop 1
    v_cndmask_b32 v127, v202, 0, vcc
    v_cmp_le_i32 vcc, 16, v200
    s_nop 1
    v_cndmask_b32 v128, v202, 0, vcc
    v_cmp_le_i32 vcc, 17, v200
    s_nop 1
    v_cndmask_b32 v129, v202, 0, vcc
    v_cmp_le_i32 vcc, 18, v200
    s_nop 1
    v_cndmask_b32 v130, v202, 0, vcc
    v_cmp_le_i32 vcc, 19, v200
    s_nop 1
    v_cndmask_b32 v131, v202, 0, vcc
    v_cmp_le_u32 vcc, 2, v201
    s_nop 1
    v_cndmask_b32 v132, v202, 0, vcc
    v_mov_b32 v180, 0x3f803f80
    v_cndmask_b32 v133, v202, 0, vcc
    v_mov_b32 v181, 0x3f803f80
    v_cndmask_b32 v134, v202, 0, vcc
    v_mov_b32 v182, 0x3f803f80
    v_cndmask_b32 v135, v202, 0, vcc
    v_mov_b32 v183, 0x3f803f80
    s_mov_b32 s26, 0x3e0293ee
    s_mov_b32 s27, 0xbe0293ee
    s_lshl_b32 s31, s28, 12
    s_add_u32 s16, s31, 0x1800000
    s_add_u32 s17, s16, 131072
    s_lshl_b32 s32, s30, 17
    s_add_u32 s31, s31, s32
    s_add_u32 s15, s31, 0x800000
    s_add_u32 s22, s31, 0x3800000
    s_lshl_b32 s31, s28, 13
    s_add_u32 s18, s31, 0x2800000
    s_add_u32 s19, s18, 4096
    s_lshl_b32 s31, s28, 11
    s_add_u32 s20, s31, 0x8000000
    s_add_u32 s21, s31, 0x6e00000
    s_lshl_b32 s31, s28, 8
    s_add_u32 s23, s31, 0x8404000
    s_lshl_b32 s31, s28, 3
    s_lshl_b32 s32, s30, 2
    s_add_u32 s31, s31, s32
    s_add_u32 s24, s31, 0x8400000
    v_and_b32 v210, 3, v250
    s_mov_b32 s39, 0
    v_lshlrev_b32 v210, 2, v210
    s_mov_b32 s33, 0x841ec00
    s_lshl_b32 s31, s25, 18
    s_add_u32 s15, s15, s31
    s_add_u32 s16, s16, s31
    s_add_u32 s17, s17, s31
    s_add_u32 s18, s18, s31
    s_add_u32 s19, s19, s31
    s_add_u32 s22, s22, s31
    s_lshl_b32 s31, s25, 16
    s_add_u32 s20, s20, s31
    s_add_u32 s21, s21, s31
    s_lshl_b32 s31, s25, 8
    s_add_u32 s24, s24, s31
    s_lshl_b32 s31, s25, 2
    s_add_u32 s23, s23, s31
    s_add_u32 s33, s33, s31
    s_cmp_lg_u32 s25, 0
    s_cbranch_scc1 main_kernel_a_npf
    s_cmp_lt_u32 s13, 14
    s_cbranch_scc0 main_kernel_a_pf4
    s_mov_b32 s8, s68
    s_and_b32 s9, s69, 0xffff
    s_mov_b32 s10, 0x700000
    s_mov_b32 s11, 0x20000
    s_lshl_b32 s31, s13, 19
    s_branch main_kernel_a_pfg
main_kernel_a_pf4:
    s_mov_b32 s8, s70
    s_and_b32 s9, s71, 0xffff
    s_mov_b32 s10, 0x700000
    s_mov_b32 s11, 0x20000
    s_sub_u32 s31, s13, 2
    s_lshl_b32 s31, s31, 19
main_kernel_a_pfg:
    s_lshl_b32 s32, s14, 17
    s_add_u32 s31, s31, s32
    v_lshlrev_b32 v200, 7, v250
    buffer_load_dword v0, v200, s[8:11], s31 offen
    s_add_u32 s31, s31, 8192
    buffer_load_dword v0, v200, s[8:11], s31 offen
    s_add_u32 s31, s31, 8192
    buffer_load_dword v0, v200, s[8:11], s31 offen
    s_add_u32 s31, s31, 8192
    buffer_load_dword v0, v200, s[8:11], s31 offen
    s_add_u32 s31, s31, 8192
    buffer_load_dword v0, v200, s[8:11], s31 offen
    s_add_u32 s31, s31, 8192
    buffer_load_dword v0, v200, s[8:11], s31 offen
    s_add_u32 s31, s31, 8192
    buffer_load_dword v0, v200, s[8:11], s31 offen
    s_add_u32 s31, s31, 8192
    buffer_load_dword v0, v200, s[8:11], s31 offen
    s_add_u32 s31, s31, 8192
    buffer_load_dword v0, v200, s[8:11], s31 offen
    s_add_u32 s31, s31, 8192
    buffer_load_dword v0, v200, s[8:11], s31 offen
    s_add_u32 s31, s31, 8192
    buffer_load_dword v0, v200, s[8:11], s31 offen
    s_add_u32 s31, s31, 8192
    buffer_load_dword v0, v200, s[8:11], s31 offen
    s_add_u32 s31, s31, 8192
    buffer_load_dword v0, v200, s[8:11], s31 offen
    s_add_u32 s31, s31, 8192
    buffer_load_dword v0, v200, s[8:11], s31 offen
    s_add_u32 s31, s31, 8192
    buffer_load_dword v0, v200, s[8:11], s31 offen
    s_add_u32 s31, s31, 8192
    buffer_load_dword v0, v200, s[8:11], s31 offen
    s_add_u32 s31, s31, 8192
    s_mov_b32 s8, s70
    s_and_b32 s9, s71, 0xffff
    s_mov_b32 s10, 0x700000
    s_mov_b32 s11, 0x20000
    s_sub_u32 s31, s13, 0
    s_lshl_b32 s31, s31, 19
    s_cmp_ge_u32 s13, 12
    s_cbranch_scc1 main_kernel_a_npf
    s_lshl_b32 s32, s14, 17
    s_add_u32 s31, s31, s32
    v_lshlrev_b32 v200, 7, v250
    buffer_load_dword v0, v200, s[8:11], s31 offen
    s_add_u32 s31, s31, 8192
    buffer_load_dword v0, v200, s[8:11], s31 offen
    s_add_u32 s31, s31, 8192
    buffer_load_dword v0, v200, s[8:11], s31 offen
    s_add_u32 s31, s31, 8192
    buffer_load_dword v0, v200, s[8:11], s31 offen
    s_add_u32 s31, s31, 8192
    buffer_load_dword v0, v200, s[8:11], s31 offen
    s_add_u32 s31, s31, 8192
    buffer_load_dword v0, v200, s[8:11], s31 offen
    s_add_u32 s31, s31, 8192
    buffer_load_dword v0, v200, s[8:11], s31 offen
    s_add_u32 s31, s31, 8192
    buffer_load_dword v0, v200, s[8:11], s31 offen
    s_add_u32 s31, s31, 8192
    buffer_load_dword v0, v200, s[8:11], s31 offen
    s_add_u32 s31, s31, 8192
    buffer_load_dword v0, v200, s[8:11], s31 offen
    s_add_u32 s31, s31, 8192
    buffer_load_dword v0, v200, s[8:11], s31 offen
    s_add_u32 s31, s31, 8192
    buffer_load_dword v0, v200, s[8:11], s31 offen
    s_add_u32 s31, s31, 8192
    buffer_load_dword v0, v200, s[8:11], s31 offen
    s_add_u32 s31, s31, 8192
    buffer_load_dword v0, v200, s[8:11], s31 offen
    s_add_u32 s31, s31, 8192
    buffer_load_dword v0, v200, s[8:11], s31 offen
    s_add_u32 s31, s31, 8192
    buffer_load_dword v0, v200, s[8:11], s31 offen
    s_add_u32 s31, s31, 8192
    s_waitcnt vmcnt(0)
main_kernel_a_npf:
    s_cmp_eq_u32 s25, 0
    s_cbranch_scc1 main_kernel_a_fp
    s_sub_u32 s32, s24, 1280
main_kernel_a_gp:
    buffer_load_dword v200, v209, s[4:7], s32 offen sc1
    s_waitcnt vmcnt(0)
    v_cmp_eq_u32 vcc, 0, v200
    s_and_b32 s31, vcc_lo, 1
    s_cbranch_scc0 main_kernel_a_fp
    s_sleep 32
    s_sub_u32 s29, s29, 1
    s_cbranch_scc0 main_kernel_a_gp
    s_branch main_kernel_end
main_kernel_a_fp:
    buffer_load_dword v200, v207, s[4:7], s23 offen sc1
    s_waitcnt vmcnt(0)
    v_cmp_eq_u32 vcc, 0, v200
    s_and_b32 s31, vcc_lo, -1
    s_cbranch_scc0 main_kernel_a_fok
    s_sleep 8
    s_sub_u32 s29, s29, 1
    s_cbranch_scc0 main_kernel_a_fp
    s_branch main_kernel_end
main_kernel_a_fok:
    buffer_load_dwordx4 v[0:3], v204, s[4:7], s15 offen offset:0 sc1
    buffer_load_dwordx4 v[16:19], v204, s[4:7], s16 offen offset:0 sc1
    buffer_load_dwordx4 v[32:35], v204, s[4:7], s17 offen offset:0 sc1
    buffer_load_dwordx4 v[4:7], v204, s[4:7], s15 offen offset:1024 sc1
    buffer_load_dwordx4 v[20:23], v204, s[4:7], s16 offen offset:1024 sc1
    buffer_load_dwordx4 v[36:39], v204, s[4:7], s17 offen offset:1024 sc1
    buffer_load_dwordx4 v[8:11], v204, s[4:7], s15 offen offset:2048 sc1
    buffer_load_dwordx4 v[24:27], v204, s[4:7], s16 offen offset:2048 sc1
    buffer_load_dwordx4 v[40:43], v204, s[4:7], s17 offen offset:2048 sc1
    buffer_load_dwordx4 v[12:15], v204, s[4:7], s15 offen offset:3072 sc1
    buffer_load_dwordx4 v[28:31], v204, s[4:7], s16 offen offset:3072 sc1
    buffer_load_dwordx4 v[44:47], v204, s[4:7], s17 offen offset:3072 sc1
    buffer_load_dword v211, v210, s[4:7], s33 offen sc1
    buffer_load_dwordx4 v[48:51], v204, s[4:7], s18 offen offset:0 sc1
    buffer_load_dwordx4 v[52:55], v204, s[4:7], s18 offen offset:1024 sc1
    buffer_load_dwordx4 v[56:59], v204, s[4:7], s18 offen offset:2048 sc1
    buffer_load_dwordx4 v[60:63], v204, s[4:7], s18 offen offset:3072 sc1
    buffer_load_dwordx4 v[64:67], v204, s[4:7], s19 offen offset:0 sc1
    buffer_load_dwordx4 v[68:71], v204, s[4:7], s19 offen offset:1024 sc1
    buffer_load_dwordx4 v[72:75], v204, s[4:7], s19 offen offset:2048 sc1
    buffer_load_dwordx4 v[76:79], v204, s[4:7], s19 offen offset:3072 sc1
    s_waitcnt vmcnt(0)
main_kernel_a_top:
    s_cmp_ge_u32 s25, 60
    s_cselect_b32 s38, 2, 1
    s_lshl_b32 s34, s38, 18
    s_lshl_b32 s35, s38, 16
    s_lshl_b32 s36, s38, 8
    s_lshl_b32 s37, s38, 2
    s_waitcnt vmcnt(19)
    v_mfma_f32_16x16x32_bf16 v[112:115], v[16:19], v[0:3], v[124:127]
    v_mfma_f32_16x16x32_bf16 v[116:119], v[32:35], v[0:3], v[128:131]
    s_waitcnt vmcnt(16)
    v_mfma_f32_16x16x32_bf16 v[112:115], v[20:23], v[4:7], v[112:115]
    v_mfma_f32_16x16x32_bf16 v[116:119], v[36:39], v[4:7], v[116:119]
    s_waitcnt vmcnt(13)
    v_mfma_f32_16x16x32_bf16 v[112:115], v[24:27], v[8:11], v[112:115]
    v_mfma_f32_16x16x32_bf16 v[116:119], v[40:43], v[8:11], v[116:119]
    s_waitcnt vmcnt(10)
    v_mfma_f32_16x16x32_bf16 v[112:115], v[28:31], v[12:15], v[112:115]
    v_mfma_f32_16x16x32_bf16 v[116:119], v[44:47], v[12:15], v[116:119]
    s_add_u32 s15, s15, s34
    s_add_u32 s16, s16, s34
    s_add_u32 s17, s17, s34
    s_add_u32 s18, s18, s34
    s_add_u32 s19, s19, s34
    s_add_u32 s23, s23, s37
    s_waitcnt vmcnt(9)
    v_cmp_eq_u32 vcc, 0, v211
    s_nop 0
    v_max3_f32 v202, v112, v113, v114
    s_nop 1
    v_max3_f32 v202, v202, v115, v116
    v_max3_f32 v202, v202, v117, v118
    v_max_f32 v202, v202, v119
    s_cmp_lg_u32 s39, 0
    s_cbranch_scc1 main_kernel_a_mq
    s_cmp_ge_u32 s25, 56
    s_cselect_b32 s32, 1, 2
    s_and_b32 s31, vcc_lo, s32
    s_cbranch_scc0 main_kernel_a_mp
main_kernel_a_pp:
    buffer_load_dword v200, v210, s[4:7], s33 offen sc1
    s_waitcnt vmcnt(0)
    v_cmp_eq_u32 vcc, 0, v200
    s_and_b32 s31, vcc_lo, s32
    s_cbranch_scc0 main_kernel_a_pok
    s_sleep 2
    s_sub_u32 s29, s29, 1
    s_cbranch_scc0 main_kernel_a_pp
    s_branch main_kernel_end
main_kernel_a_pok:
    s_cmp_eq_u32 s32, 2
    s_cbranch_scc1 main_kernel_a_mp
    s_sleep 2
    s_cmp_eq_u32 s25, 63
    s_cbranch_scc1 main_kernel_a_mp
    s_sleep 40
main_kernel_a_mp:
    s_mov_b32 s39, 0
    buffer_load_dwordx4 v[80:83], v205, s[4:7], s20 offen offset:0 sc1
    buffer_load_dwordx4 v[84:87], v205, s[4:7], s20 offen offset:512 sc1
    buffer_load_dwordx4 v[88:91], v205, s[4:7], s20 offen offset:1024 sc1
    buffer_load_dwordx4 v[92:95], v205, s[4:7], s20 offen offset:1536 sc1
    buffer_load_dwordx2 v[96:97], v206, s[4:7], s21 offen offset:0 sc1
    buffer_load_dwordx2 v[98:99], v206, s[4:7], s21 offen offset:256 sc1
    buffer_load_dwordx2 v[100:101], v206, s[4:7], s21 offen offset:512 sc1
    buffer_load_dwordx2 v[102:103], v206, s[4:7], s21 offen offset:768 sc1
    buffer_load_dwordx2 v[104:105], v206, s[4:7], s21 offen offset:1024 sc1
    buffer_load_dwordx2 v[106:107], v206, s[4:7], s21 offen offset:1280 sc1
    buffer_load_dwordx2 v[108:109], v206, s[4:7], s21 offen offset:1536 sc1
    buffer_load_dwordx2 v[110:111], v206, s[4:7], s21 offen offset:1792 sc1
    buffer_load_dword v212, v207, s[4:7], s23 offen offset:0 sc1
    buffer_load_dword v211, v210, s[4:7], s33 offen sc1
main_kernel_a_mq:
    s_waitcnt vmcnt(13)
    v_mfma_f32_16x16x32_bf16 v[120:123], v[80:83], v[0:3], v[132:135]
    v_max3_u32 v200, v80, v81, v82
    v_max_u32 v200, v200, v83
    s_waitcnt vmcnt(12)
    v_mfma_f32_16x16x32_bf16 v[120:123], v[84:87], v[4:7], v[120:123]
    v_max3_u32 v200, v200, v84, v85
    v_max3_u32 v200, v200, v86, v87
    s_waitcnt vmcnt(11)
    v_mfma_f32_16x16x32_bf16 v[120:123], v[88:91], v[8:11], v[120:123]
    v_max3_u32 v200, v200, v88, v89
    v_max3_u32 v200, v200, v90, v91
    s_waitcnt vmcnt(10)
    v_mfma_f32_16x16x32_bf16 v[120:123], v[92:95], v[12:15], v[120:123]
    v_max3_u32 v200, v200, v92, v93
    v_max3_u32 v200, v200, v94, v95
    s_waitcnt vmcnt(8)
    v_max3_u32 v200, v200, v96, v97
    v_max3_u32 v200, v200, v98, v99
    s_waitcnt vmcnt(6)
    v_max3_u32 v200, v200, v100, v101
    v_max3_u32 v200, v200, v102, v103
    s_waitcnt vmcnt(4)
    v_max3_u32 v200, v200, v104, v105
    v_max3_u32 v200, v200, v106, v107
    s_waitcnt vmcnt(2)
    v_max3_u32 v200, v200, v108, v109
    v_max3_u32 v200, v200, v110, v111
    v_cmp_eq_u32 vcc, -1, v200
    s_cbranch_vccz main_kernel_a_mok
    s_sleep 1
    s_sub_u32 s29, s29, 1
    s_cbranch_scc0 main_kernel_a_mp
    s_branch main_kernel_end
main_kernel_a_mok:
    v_mul_f32 v120, s26, v120
    v_mul_f32 v121, s26, v121
    v_mul_f32 v122, s26, v122
    v_mul_f32 v123, s26, v123
    v_max3_f32 v200, v202, v120, v121
    v_max3_f32 v200, v200, v122, v123
    v_mov_b32 v201, v200
    s_add_u32 s20, s20, s35
    s_add_u32 s21, s21, s35
    v_permlane32_swap_b32 v200, v201
    v_max_f32 v200, v200, v201
    v_mov_b32 v201, v200
    s_nop 1
    v_permlane16_swap_b32 v200, v201
    v_max_f32 v200, v200, v201
    v_sub_f32 v112, v112, v200
    v_sub_f32 v113, v113, v200
    v_sub_f32 v114, v114, v200
    v_sub_f32 v115, v115, v200
    v_sub_f32 v116, v116, v200
    v_sub_f32 v117, v117, v200
    v_sub_f32 v118, v118, v200
    v_sub_f32 v119, v119, v200
    v_sub_f32 v120, v120, v200
    v_sub_f32 v121, v121, v200
    v_sub_f32 v122, v122, v200
    v_sub_f32 v123, v123, v200
    v_exp_f32 v112, v112
    v_exp_f32 v113, v113
    v_exp_f32 v114, v114
    v_cvt_pk_bf16_f32 v136, v112, v113
    v_exp_f32 v115, v115
    v_exp_f32 v116, v116
    v_cvt_pk_bf16_f32 v137, v114, v115
    v_exp_f32 v117, v117
    v_exp_f32 v118, v118
    v_cvt_pk_bf16_f32 v138, v116, v117
    v_exp_f32 v119, v119
    v_exp_f32 v120, v120
    v_cvt_pk_bf16_f32 v139, v118, v119
    v_exp_f32 v121, v121
    v_exp_f32 v122, v122
    v_cvt_pk_bf16_f32 v140, v120, v121
    v_exp_f32 v123, v123
    s_nop 0
    v_cvt_pk_bf16_f32 v141, v122, v123
    s_waitcnt vmcnt(1)
    v_mfma_f32_16x16x32_bf16 v[144:147], v[180:183], v[136:139], 0
    v_mfma_f32_16x16x32_bf16 v[148:151], v[48:51], v[136:139], 0
    s_nop 0
    s_nop 0
    s_nop 0
    v_mfma_f32_16x16x16_bf16 v[144:147], v[180:181], v[140:141], v[144:147]
    v_mfma_f32_16x16x32_bf16 v[152:155], v[52:55], v[136:139], 0
    v_mfma_f32_16x16x32_bf16 v[156:159], v[56:59], v[136:139], 0
    v_mfma_f32_16x16x32_bf16 v[160:163], v[60:63], v[136:139], 0
    v_mfma_f32_16x16x32_bf16 v[164:167], v[64:67], v[136:139], 0
    v_mfma_f32_16x16x32_bf16 v[168:171], v[68:71], v[136:139], 0
    v_mfma_f32_16x16x32_bf16 v[172:175], v[72:75], v[136:139], 0
    v_mfma_f32_16x16x32_bf16 v[176:179], v[76:79], v[136:139], 0
    v_rcp_f32 v200, v144
    v_mfma_f32_16x16x16_bf16 v[148:151], v[96:97], v[140:141], v[148:151]
    v_mfma_f32_16x16x16_bf16 v[152:155], v[98:99], v[140:141], v[152:155]
    v_mfma_f32_16x16x16_bf16 v[156:159], v[100:101], v[140:141], v[156:159]
    v_mfma_f32_16x16x16_bf16 v[160:163], v[102:103], v[140:141], v[160:163]
    v_mfma_f32_16x16x16_bf16 v[164:167], v[104:105], v[140:141], v[164:167]
    v_mfma_f32_16x16x16_bf16 v[168:171], v[106:107], v[140:141], v[168:171]
    v_mfma_f32_16x16x16_bf16 v[172:175], v[108:109], v[140:141], v[172:175]
    v_mfma_f32_16x16x16_bf16 v[176:179], v[110:111], v[140:141], v[176:179]
    v_mov_b32 v201, v200
    s_cmp_lg_u32 s39, 0
    s_cbranch_scc1 main_kernel_a_nw
    s_waitcnt vmcnt(0)
main_kernel_a_nw:
    v_cmp_ne_u32 vcc, 0, v211
    s_and_b32 s39, vcc_lo, 4
    v_cmp_eq_u32 vcc, 0, v212
    v_pk_mul_f32 v[148:149], v[148:149], v[200:201]
    v_pk_mul_f32 v[150:151], v[150:151], v[200:201]
    v_pk_mul_f32 v[152:153], v[152:153], v[200:201]
    v_pk_mul_f32 v[154:155], v[154:155], v[200:201]
    v_cvt_pk_bf16_f32 v184, v148, v149
    v_cvt_pk_bf16_f32 v185, v150, v151
    v_cvt_pk_bf16_f32 v186, v152, v153
    v_cvt_pk_bf16_f32 v187, v154, v155
    buffer_store_dwordx4 v[184:187], v204, s[4:7], s22 offen offset:0 sc1
    v_pk_mul_f32 v[156:157], v[156:157], v[200:201]
    v_pk_mul_f32 v[158:159], v[158:159], v[200:201]
    v_pk_mul_f32 v[160:161], v[160:161], v[200:201]
    v_pk_mul_f32 v[162:163], v[162:163], v[200:201]
    v_cvt_pk_bf16_f32 v188, v156, v157
    v_cvt_pk_bf16_f32 v189, v158, v159
    v_cvt_pk_bf16_f32 v190, v160, v161
    v_cvt_pk_bf16_f32 v191, v162, v163
    buffer_store_dwordx4 v[188:191], v204, s[4:7], s22 offen offset:1024 sc1
    v_pk_mul_f32 v[164:165], v[164:165], v[200:201]
    v_pk_mul_f32 v[166:167], v[166:167], v[200:201]
    v_pk_mul_f32 v[168:169], v[168:169], v[200:201]
    v_pk_mul_f32 v[170:171], v[170:171], v[200:201]
    v_cvt_pk_bf16_f32 v192, v164, v165
    v_cvt_pk_bf16_f32 v193, v166, v167
    v_cvt_pk_bf16_f32 v194, v168, v169
    v_cvt_pk_bf16_f32 v195, v170, v171
    buffer_store_dwordx4 v[192:195], v204, s[4:7], s22 offen offset:2048 sc1
    s_nop 0
    v_pk_mul_f32 v[172:173], v[172:173], v[200:201]
    v_pk_mul_f32 v[174:175], v[174:175], v[200:201]
    v_pk_mul_f32 v[176:177], v[176:177], v[200:201]
    v_pk_mul_f32 v[178:179], v[178:179], v[200:201]
    v_cvt_pk_bf16_f32 v196, v172, v173
    v_cvt_pk_bf16_f32 v197, v174, v175
    v_cvt_pk_bf16_f32 v198, v176, v177
    v_cvt_pk_bf16_f32 v199, v178, v179
    buffer_store_dwordx4 v[196:199], v204, s[4:7], s22 offen offset:3072 sc1
    s_add_u32 s22, s22, s34
    s_add_u32 s33, s33, s37
    s_add_u32 s25, s25, s38
    s_cmp_ge_u32 s25, 64
    s_cbranch_scc1 main_kernel_a_last
    s_cbranch_vccnz main_kernel_a_slow
    s_cmp_gt_u32 s25, 60
    s_cbranch_scc1 main_kernel_a_slow
    s_cmp_ge_u32 s25, 56
    s_cselect_b32 s39, 0, s39
    s_cmp_lg_u32 s39, 0
    s_cbranch_scc1 main_kernel_a_pre
    buffer_load_dwordx4 v[0:3], v204, s[4:7], s15 offen offset:0 sc1
    buffer_load_dwordx4 v[16:19], v204, s[4:7], s16 offen offset:0 sc1
    buffer_load_dwordx4 v[32:35], v204, s[4:7], s17 offen offset:0 sc1
    buffer_load_dwordx4 v[4:7], v204, s[4:7], s15 offen offset:1024 sc1
    buffer_load_dwordx4 v[20:23], v204, s[4:7], s16 offen offset:1024 sc1
    buffer_load_dwordx4 v[36:39], v204, s[4:7], s17 offen offset:1024 sc1
    buffer_load_dwordx4 v[8:11], v204, s[4:7], s15 offen offset:2048 sc1
    buffer_load_dwordx4 v[24:27], v204, s[4:7], s16 offen offset:2048 sc1
    buffer_load_dwordx4 v[40:43], v204, s[4:7], s17 offen offset:2048 sc1
    buffer_load_dwordx4 v[12:15], v204, s[4:7], s15 offen offset:3072 sc1
    buffer_load_dwordx4 v[28:31], v204, s[4:7], s16 offen offset:3072 sc1
    buffer_load_dwordx4 v[44:47], v204, s[4:7], s17 offen offset:3072 sc1
    buffer_load_dword v211, v210, s[4:7], s33 offen sc1
    buffer_load_dwordx4 v[48:51], v204, s[4:7], s18 offen offset:0 sc1
    buffer_load_dwordx4 v[52:55], v204, s[4:7], s18 offen offset:1024 sc1
    buffer_load_dwordx4 v[56:59], v204, s[4:7], s18 offen offset:2048 sc1
    buffer_load_dwordx4 v[60:63], v204, s[4:7], s18 offen offset:3072 sc1
    buffer_load_dwordx4 v[64:67], v204, s[4:7], s19 offen offset:0 sc1
    buffer_load_dwordx4 v[68:71], v204, s[4:7], s19 offen offset:1024 sc1
    buffer_load_dwordx4 v[72:75], v204, s[4:7], s19 offen offset:2048 sc1
    buffer_load_dwordx4 v[76:79], v204, s[4:7], s19 offen offset:3072 sc1
    s_waitcnt vmcnt(21)
    s_mov_b64 exec, 1
    buffer_store_dword v208, v209, s[4:7], s24 offen sc1
    s_mov_b64 exec, -1
    s_add_u32 s24, s24, s36
    s_branch main_kernel_a_top
main_kernel_a_pre:
    buffer_load_dwordx4 v[80:83], v205, s[4:7], s20 offen offset:0 sc1
    buffer_load_dwordx4 v[84:87], v205, s[4:7], s20 offen offset:512 sc1
    buffer_load_dwordx4 v[88:91], v205, s[4:7], s20 offen offset:1024 sc1
    buffer_load_dwordx4 v[92:95], v205, s[4:7], s20 offen offset:1536 sc1
    buffer_load_dwordx2 v[96:97], v206, s[4:7], s21 offen offset:0 sc1
    buffer_load_dwordx2 v[98:99], v206, s[4:7], s21 offen offset:256 sc1
    buffer_load_dwordx2 v[100:101], v206, s[4:7], s21 offen offset:512 sc1
    buffer_load_dwordx2 v[102:103], v206, s[4:7], s21 offen offset:768 sc1
    buffer_load_dwordx2 v[104:105], v206, s[4:7], s21 offen offset:1024 sc1
    buffer_load_dwordx2 v[106:107], v206, s[4:7], s21 offen offset:1280 sc1
    buffer_load_dwordx2 v[108:109], v206, s[4:7], s21 offen offset:1536 sc1
    buffer_load_dwordx2 v[110:111], v206, s[4:7], s21 offen offset:1792 sc1
    buffer_load_dword v212, v207, s[4:7], s23 offen offset:4 sc1
    buffer_load_dwordx4 v[0:3], v204, s[4:7], s15 offen offset:0 sc1
    buffer_load_dwordx4 v[16:19], v204, s[4:7], s16 offen offset:0 sc1
    buffer_load_dwordx4 v[32:35], v204, s[4:7], s17 offen offset:0 sc1
    buffer_load_dwordx4 v[4:7], v204, s[4:7], s15 offen offset:1024 sc1
    buffer_load_dwordx4 v[20:23], v204, s[4:7], s16 offen offset:1024 sc1
    buffer_load_dwordx4 v[36:39], v204, s[4:7], s17 offen offset:1024 sc1
    buffer_load_dwordx4 v[8:11], v204, s[4:7], s15 offen offset:2048 sc1
    buffer_load_dwordx4 v[24:27], v204, s[4:7], s16 offen offset:2048 sc1
    buffer_load_dwordx4 v[40:43], v204, s[4:7], s17 offen offset:2048 sc1
    buffer_load_dwordx4 v[12:15], v204, s[4:7], s15 offen offset:3072 sc1
    buffer_load_dwordx4 v[28:31], v204, s[4:7], s16 offen offset:3072 sc1
    buffer_load_dwordx4 v[44:47], v204, s[4:7], s17 offen offset:3072 sc1
    buffer_load_dword v211, v210, s[4:7], s33 offen sc1
    buffer_load_dwordx4 v[48:51], v204, s[4:7], s18 offen offset:0 sc1
    buffer_load_dwordx4 v[52:55], v204, s[4:7], s18 offen offset:1024 sc1
    buffer_load_dwordx4 v[56:59], v204, s[4:7], s18 offen offset:2048 sc1
    buffer_load_dwordx4 v[60:63], v204, s[4:7], s18 offen offset:3072 sc1
    buffer_load_dwordx4 v[64:67], v204, s[4:7], s19 offen offset:0 sc1
    buffer_load_dwordx4 v[68:71], v204, s[4:7], s19 offen offset:1024 sc1
    buffer_load_dwordx4 v[72:75], v204, s[4:7], s19 offen offset:2048 sc1
    buffer_load_dwordx4 v[76:79], v204, s[4:7], s19 offen offset:3072 sc1
    s_waitcnt vmcnt(34)
    s_mov_b64 exec, 1
    buffer_store_dword v208, v209, s[4:7], s24 offen sc1
    s_mov_b64 exec, -1
    s_add_u32 s24, s24, s36
    s_branch main_kernel_a_top
main_kernel_a_slow:
    s_mov_b32 s39, 0
    s_waitcnt vmcnt(0)
    s_mov_b64 exec, 1
    buffer_store_dword v208, v209, s[4:7], s24 offen sc1
    s_mov_b64 exec, -1
    s_add_u32 s24, s24, s36
    s_branch main_kernel_a_fp
main_kernel_a_last:
    s_waitcnt vmcnt(0)
    s_mov_b64 exec, 1
    buffer_store_dword v208, v209, s[4:7], s24 offen sc1
    s_mov_b64 exec, -1
    s_add_u32 s24, s24, s36
    s_branch main_kernel_end
main_kernel_wo:
    s_mov_b32 s8, s46
    s_and_b32 s9, s47, 0xffff
    s_mov_b32 s10, 0x800000
    s_mov_b32 s11, 0x20000
    v_lshlrev_b32 v170, 4, v250
    s_lshr_b32 s23, s12, 2
    s_sub_u32 s21, s12, 5
    s_cselect_b32 s23, s23, s21
    s_cselect_b32 s18, 44, 63
    v_lshrrev_b32 v178, 2, v250
    v_and_b32 v179, 3, v250
    v_lshlrev_b32 v0, 11, v178
    v_lshl_add_u32 v0, v179, 4, v0
    s_lshl_b32 s19, s14, 15
    v_lshl_add_u32 v1, v178, 6, s19
    v_lshl_add_u32 v1, v179, 3, v1
    s_lshl_b32 s20, s14, 21
    s_lshl_b32 s21, s13, 6
    s_add_u32 s20, s20, s21
    s_add_u32 s21, s20, 0x0
    s_add_u32 m0, s19, 0
    s_nop 0
    buffer_load_dwordx4 v0, s[8:11], s21 offen lds
    s_add_u32 s21, s20, 0x8000
    s_add_u32 m0, s19, 1024
    s_nop 0
    buffer_load_dwordx4 v0, s[8:11], s21 offen lds
    s_add_u32 s21, s20, 0x10000
    s_add_u32 m0, s19, 2048
    s_nop 0
    buffer_load_dwordx4 v0, s[8:11], s21 offen lds
    s_add_u32 s21, s20, 0x18000
    s_add_u32 m0, s19, 3072
    s_nop 0
    buffer_load_dwordx4 v0, s[8:11], s21 offen lds
    s_add_u32 s21, s20, 0x20000
    s_add_u32 m0, s19, 4096
    s_nop 0
    buffer_load_dwordx4 v0, s[8:11], s21 offen lds
    s_add_u32 s21, s20, 0x28000
    s_add_u32 m0, s19, 5120
    s_nop 0
    buffer_load_dwordx4 v0, s[8:11], s21 offen lds
    s_add_u32 s21, s20, 0x30000
    s_add_u32 m0, s19, 6144
    s_nop 0
    buffer_load_dwordx4 v0, s[8:11], s21 offen lds
    s_add_u32 s21, s20, 0x38000
    s_add_u32 m0, s19, 7168
    s_nop 0
    buffer_load_dwordx4 v0, s[8:11], s21 offen lds
    s_add_u32 s21, s20, 0x40000
    s_add_u32 m0, s19, 8192
    s_nop 0
    buffer_load_dwordx4 v0, s[8:11], s21 offen lds
    s_add_u32 s21, s20, 0x48000
    s_add_u32 m0, s19, 9216
    s_nop 0
    buffer_load_dwordx4 v0, s[8:11], s21 offen lds
    s_add_u32 s21, s20, 0x50000
    s_add_u32 m0, s19, 10240
    s_nop 0
    buffer_load_dwordx4 v0, s[8:11], s21 offen lds
    s_add_u32 s21, s20, 0x58000
    s_add_u32 m0, s19, 11264
    s_nop 0
    buffer_load_dwordx4 v0, s[8:11], s21 offen lds
    s_add_u32 s21, s20, 0x60000
    s_add_u32 m0, s19, 12288
    s_nop 0
    buffer_load_dwordx4 v0, s[8:11], s21 offen lds
    s_add_u32 s21, s20, 0x68000
    s_add_u32 m0, s19, 13312
    s_nop 0
    buffer_load_dwordx4 v0, s[8:11], s21 offen lds
    s_add_u32 s21, s20, 0x70000
    s_add_u32 m0, s19, 14336
    s_nop 0
    buffer_load_dwordx4 v0, s[8:11], s21 offen lds
    s_add_u32 s21, s20, 0x78000
    s_add_u32 m0, s19, 15360
    s_nop 0
    buffer_load_dwordx4 v0, s[8:11], s21 offen lds
    s_add_u32 s21, s20, 0x80000
    s_add_u32 m0, s19, 16384
    s_nop 0
    buffer_load_dwordx4 v0, s[8:11], s21 offen lds
    s_add_u32 s21, s20, 0x88000
    s_add_u32 m0, s19, 17408
    s_nop 0
    buffer_load_dwordx4 v0, s[8:11], s21 offen lds
    s_add_u32 s21, s20, 0x90000
    s_add_u32 m0, s19, 18432
    s_nop 0
    buffer_load_dwordx4 v0, s[8:11], s21 offen lds
    s_add_u32 s21, s20, 0x98000
    s_add_u32 m0, s19, 19456
    s_nop 0
    buffer_load_dwordx4 v0, s[8:11], s21 offen lds
    s_add_u32 s21, s20, 0xa0000
    s_add_u32 m0, s19, 20480
    s_nop 0
    buffer_load_dwordx4 v0, s[8:11], s21 offen lds
    s_add_u32 s21, s20, 0xa8000
    s_add_u32 m0, s19, 21504
    s_nop 0
    buffer_load_dwordx4 v0, s[8:11], s21 offen lds
    s_add_u32 s21, s20, 0xb0000
    s_add_u32 m0, s19, 22528
    s_nop 0
    buffer_load_dwordx4 v0, s[8:11], s21 offen lds
    s_add_u32 s21, s20, 0xb8000
    s_add_u32 m0, s19, 23552
    s_nop 0
    buffer_load_dwordx4 v0, s[8:11], s21 offen lds
    s_add_u32 s21, s20, 0xc0000
    s_add_u32 m0, s19, 24576
    s_nop 0
    buffer_load_dwordx4 v0, s[8:11], s21 offen lds
    s_add_u32 s21, s20, 0xc8000
    s_add_u32 m0, s19, 25600
    s_nop 0
    buffer_load_dwordx4 v0, s[8:11], s21 offen lds
    s_add_u32 s21, s20, 0xd0000
    s_add_u32 m0, s19, 26624
    s_nop 0
    buffer_load_dwordx4 v0, s[8:11], s21 offen lds
    s_add_u32 s21, s20, 0xd8000
    s_add_u32 m0, s19, 27648
    s_nop 0
    buffer_load_dwordx4 v0, s[8:11], s21 offen lds
    s_add_u32 s21, s20, 0xe0000
    s_add_u32 m0, s19, 28672
    s_nop 0
    buffer_load_dwordx4 v0, s[8:11], s21 offen lds
    s_add_u32 s21, s20, 0xe8000
    s_add_u32 m0, s19, 29696
    s_nop 0
    buffer_load_dwordx4 v0, s[8:11], s21 offen lds
    s_add_u32 s21, s20, 0xf0000
    s_add_u32 m0, s19, 30720
    s_nop 0
    buffer_load_dwordx4 v0, s[8:11], s21 offen lds
    s_add_u32 s21, s20, 0xf8000
    s_add_u32 m0, s19, 31744
    s_nop 0
    buffer_load_dwordx4 v0, s[8:11], s21 offen lds
    v_and_b32 v178, 15, v250
    v_lshrrev_b32 v179, 4, v250
    v_lshlrev_b32 v175, 11, v178
    v_lshl_add_u32 v175, v179, 3, v175
    s_lshl_b32 s21, s14, 11
    s_add_u32 s21, s21, 131072
    v_add_u32 v176, s21, v170
    s_lshl_b32 s21, s14, 10
    s_add_u32 s21, s21, 131072
    v_add_u32 v177, s21, v170
    s_lshr_b32 s21, s13, 2
    s_lshl_b32 s21, s21, 8
    s_add_u32 s21, s21, 0x8412000
    s_lshl2_add_u32 s21, s18, s21
    v_mov_b32 v172, s21
    v_mov_b32 v173, 4
    s_lshl_b32 s21, s14, 4
    s_add_u32 s21, s21, s23
    s_lshl_b32 s21, s21, 2
    s_add_u32 s21, s21, 0x8400000
    s_lshl_b32 s22, s18, 8
    s_add_u32 s21, s21, s22
    s_mov_b64 exec, 0xff
    v_lshl_add_u32 v172, v250, 3, s21
    v_mov_b32 v173, 0x100
    s_mov_b64 exec, -1
    s_lshl_b32 s15, s14, 15
    s_lshl_b32 s21, s23, 17
    s_add_u32 s15, s15, s21
    s_add_u32 s15, s15, 0x3800000
    s_lshl_b32 s21, s18, 18
    s_add_u32 s15, s15, s21
    s_lshl_b32 s21, s23, 15
    s_lshl_b32 s22, s18, 16
    s_add_u32 s21, s21, s22
    s_and_b32 s22, s14, 1
    s_lshl_b32 s16, s13, 1
    s_add_u32 s16, s16, s22
    s_lshl_b32 s16, s16, 5
    s_add_u32 s16, s16, s21
    s_lshl_b32 s17, s13, 7
    s_add_u32 s17, s17, s22
    s_lshl_b32 s17, s17, 3
    s_add_u32 s17, s17, s21
    s_add_u32 s17, s17, 0x6400000
    s_waitcnt vmcnt(24)
    ds_read_b64_tr_b16 a[0:1], v1 offset:0
    ds_read_b64_tr_b16 a[2:3], v1 offset:1024
    ds_read_b64_tr_b16 a[128:129], v1 offset:32
    ds_read_b64_tr_b16 a[130:131], v1 offset:1056
    ds_read_b64_tr_b16 a[4:5], v1 offset:2048
    ds_read_b64_tr_b16 a[6:7], v1 offset:3072
    ds_read_b64_tr_b16 a[132:133], v1 offset:2080
    ds_read_b64_tr_b16 a[134:135], v1 offset:3104
    ds_read_b64_tr_b16 a[8:9], v1 offset:4096
    ds_read_b64_tr_b16 a[10:11], v1 offset:5120
    ds_read_b64_tr_b16 a[136:137], v1 offset:4128
    ds_read_b64_tr_b16 a[138:139], v1 offset:5152
    ds_read_b64_tr_b16 a[12:13], v1 offset:6144
    ds_read_b64_tr_b16 a[14:15], v1 offset:7168
    ds_read_b64_tr_b16 a[140:141], v1 offset:6176
    ds_read_b64_tr_b16 a[142:143], v1 offset:7200
    s_waitcnt lgkmcnt(0)
    s_add_u32 s21, s20, 0x100000
    s_add_u32 m0, s19, 0
    s_nop 0
    buffer_load_dwordx4 v0, s[8:11], s21 offen lds
    s_add_u32 s21, s20, 0x108000
    s_add_u32 m0, s19, 1024
    s_nop 0
    buffer_load_dwordx4 v0, s[8:11], s21 offen lds
    s_add_u32 s21, s20, 0x110000
    s_add_u32 m0, s19, 2048
    s_nop 0
    buffer_load_dwordx4 v0, s[8:11], s21 offen lds
    s_add_u32 s21, s20, 0x118000
    s_add_u32 m0, s19, 3072
    s_nop 0
    buffer_load_dwordx4 v0, s[8:11], s21 offen lds
    s_add_u32 s21, s20, 0x120000
    s_add_u32 m0, s19, 4096
    s_nop 0
    buffer_load_dwordx4 v0, s[8:11], s21 offen lds
    s_add_u32 s21, s20, 0x128000
    s_add_u32 m0, s19, 5120
    s_nop 0
    buffer_load_dwordx4 v0, s[8:11], s21 offen lds
    s_add_u32 s21, s20, 0x130000
    s_add_u32 m0, s19, 6144
    s_nop 0
    buffer_load_dwordx4 v0, s[8:11], s21 offen lds
    s_add_u32 s21, s20, 0x138000
    s_add_u32 m0, s19, 7168
    s_nop 0
    buffer_load_dwordx4 v0, s[8:11], s21 offen lds
    s_waitcnt vmcnt(24)
    ds_read_b64_tr_b16 a[16:17], v1 offset:8192
    ds_read_b64_tr_b16 a[18:19], v1 offset:9216
    ds_read_b64_tr_b16 a[144:145], v1 offset:8224
    ds_read_b64_tr_b16 a[146:147], v1 offset:9248
    ds_read_b64_tr_b16 a[20:21], v1 offset:10240
    ds_read_b64_tr_b16 a[22:23], v1 offset:11264
    ds_read_b64_tr_b16 a[148:149], v1 offset:10272
    ds_read_b64_tr_b16 a[150:151], v1 offset:11296
    ds_read_b64_tr_b16 a[24:25], v1 offset:12288
    ds_read_b64_tr_b16 a[26:27], v1 offset:13312
    ds_read_b64_tr_b16 a[152:153], v1 offset:12320
    ds_read_b64_tr_b16 a[154:155], v1 offset:13344
    ds_read_b64_tr_b16 a[28:29], v1 offset:14336
    ds_read_b64_tr_b16 a[30:31], v1 offset:15360
    ds_read_b64_tr_b16 a[156:157], v1 offset:14368
    ds_read_b64_tr_b16 a[158:159], v1 offset:15392
    s_waitcnt lgkmcnt(0)
    s_add_u32 s21, s20, 0x140000
    s_add_u32 m0, s19, 8192
    s_nop 0
    buffer_load_dwordx4 v0, s[8:11], s21 offen lds
    s_add_u32 s21, s20, 0x148000
    s_add_u32 m0, s19, 9216
    s_nop 0
    buffer_load_dwordx4 v0, s[8:11], s21 offen lds
    s_add_u32 s21, s20, 0x150000
    s_add_u32 m0, s19, 10240
    s_nop 0
    buffer_load_dwordx4 v0, s[8:11], s21 offen lds
    s_add_u32 s21, s20, 0x158000
    s_add_u32 m0, s19, 11264
    s_nop 0
    buffer_load_dwordx4 v0, s[8:11], s21 offen lds
    s_add_u32 s21, s20, 0x160000
    s_add_u32 m0, s19, 12288
    s_nop 0
    buffer_load_dwordx4 v0, s[8:11], s21 offen lds
    s_add_u32 s21, s20, 0x168000
    s_add_u32 m0, s19, 13312
    s_nop 0
    buffer_load_dwordx4 v0, s[8:11], s21 offen lds
    s_add_u32 s21, s20, 0x170000
    s_add_u32 m0, s19, 14336
    s_nop 0
    buffer_load_dwordx4 v0, s[8:11], s21 offen lds
    s_add_u32 s21, s20, 0x178000
    s_add_u32 m0, s19, 15360
    s_nop 0
    buffer_load_dwordx4 v0, s[8:11], s21 offen lds
    s_waitcnt vmcnt(24)
    ds_read_b64_tr_b16 a[32:33], v1 offset:16384
    ds_read_b64_tr_b16 a[34:35], v1 offset:17408
    ds_read_b64_tr_b16 a[160:161], v1 offset:16416
    ds_read_b64_tr_b16 a[162:163], v1 offset:17440
    ds_read_b64_tr_b16 a[36:37], v1 offset:18432
    ds_read_b64_tr_b16 a[38:39], v1 offset:19456
    ds_read_b64_tr_b16 a[164:165], v1 offset:18464
    ds_read_b64_tr_b16 a[166:167], v1 offset:19488
    ds_read_b64_tr_b16 a[40:41], v1 offset:20480
    ds_read_b64_tr_b16 a[42:43], v1 offset:21504
    ds_read_b64_tr_b16 a[168:169], v1 offset:20512
    ds_read_b64_tr_b16 a[170:171], v1 offset:21536
    ds_read_b64_tr_b16 a[44:45], v1 offset:22528
    ds_read_b64_tr_b16 a[46:47], v1 offset:23552
    ds_read_b64_tr_b16 a[172:173], v1 offset:22560
    ds_read_b64_tr_b16 a[174:175], v1 offset:23584
    s_waitcnt lgkmcnt(0)
    s_add_u32 s21, s20, 0x180000
    s_add_u32 m0, s19, 16384
    s_nop 0
    buffer_load_dwordx4 v0, s[8:11], s21 offen lds
    s_add_u32 s21, s20, 0x188000
    s_add_u32 m0, s19, 17408
    s_nop 0
    buffer_load_dwordx4 v0, s[8:11], s21 offen lds
    s_add_u32 s21, s20, 0x190000
    s_add_u32 m0, s19, 18432
    s_nop 0
    buffer_load_dwordx4 v0, s[8:11], s21 offen lds
    s_add_u32 s21, s20, 0x198000
    s_add_u32 m0, s19, 19456
    s_nop 0
    buffer_load_dwordx4 v0, s[8:11], s21 offen lds
    s_add_u32 s21, s20, 0x1a0000
    s_add_u32 m0, s19, 20480
    s_nop 0
    buffer_load_dwordx4 v0, s[8:11], s21 offen lds
    s_add_u32 s21, s20, 0x1a8000
    s_add_u32 m0, s19, 21504
    s_nop 0
    buffer_load_dwordx4 v0, s[8:11], s21 offen lds
    s_add_u32 s21, s20, 0x1b0000
    s_add_u32 m0, s19, 22528
    s_nop 0
    buffer_load_dwordx4 v0, s[8:11], s21 offen lds
    s_add_u32 s21, s20, 0x1b8000
    s_add_u32 m0, s19, 23552
    s_nop 0
    buffer_load_dwordx4 v0, s[8:11], s21 offen lds
    s_waitcnt vmcnt(24)
    ds_read_b64_tr_b16 a[48:49], v1 offset:24576
    ds_read_b64_tr_b16 a[50:51], v1 offset:25600
    ds_read_b64_tr_b16 a[176:177], v1 offset:24608
    ds_read_b64_tr_b16 a[178:179], v1 offset:25632
    ds_read_b64_tr_b16 a[52:53], v1 offset:26624
    ds_read_b64_tr_b16 a[54:55], v1 offset:27648
    ds_read_b64_tr_b16 a[180:181], v1 offset:26656
    ds_read_b64_tr_b16 a[182:183], v1 offset:27680
    ds_read_b64_tr_b16 a[56:57], v1 offset:28672
    ds_read_b64_tr_b16 a[58:59], v1 offset:29696
    ds_read_b64_tr_b16 a[184:185], v1 offset:28704
    ds_read_b64_tr_b16 a[186:187], v1 offset:29728
    ds_read_b64_tr_b16 a[60:61], v1 offset:30720
    ds_read_b64_tr_b16 a[62:63], v1 offset:31744
    ds_read_b64_tr_b16 a[188:189], v1 offset:30752
    ds_read_b64_tr_b16 a[190:191], v1 offset:31776
    s_waitcnt lgkmcnt(0)
    s_add_u32 s21, s20, 0x1c0000
    s_add_u32 m0, s19, 24576
    s_nop 0
    buffer_load_dwordx4 v0, s[8:11], s21 offen lds
    s_add_u32 s21, s20, 0x1c8000
    s_add_u32 m0, s19, 25600
    s_nop 0
    buffer_load_dwordx4 v0, s[8:11], s21 offen lds
    s_add_u32 s21, s20, 0x1d0000
    s_add_u32 m0, s19, 26624
    s_nop 0
    buffer_load_dwordx4 v0, s[8:11], s21 offen lds
    s_add_u32 s21, s20, 0x1d8000
    s_add_u32 m0, s19, 27648
    s_nop 0
    buffer_load_dwordx4 v0, s[8:11], s21 offen lds
    s_add_u32 s21, s20, 0x1e0000
    s_add_u32 m0, s19, 28672
    s_nop 0
    buffer_load_dwordx4 v0, s[8:11], s21 offen lds
    s_add_u32 s21, s20, 0x1e8000
    s_add_u32 m0, s19, 29696
    s_nop 0
    buffer_load_dwordx4 v0, s[8:11], s21 offen lds
    s_add_u32 s21, s20, 0x1f0000
    s_add_u32 m0, s19, 30720
    s_nop 0
    buffer_load_dwordx4 v0, s[8:11], s21 offen lds
    s_add_u32 s21, s20, 0x1f8000
    s_add_u32 m0, s19, 31744
    s_nop 0
    buffer_load_dwordx4 v0, s[8:11], s21 offen lds
    s_waitcnt vmcnt(24)
    ds_read_b64_tr_b16 a[64:65], v1 offset:0
    ds_read_b64_tr_b16 a[66:67], v1 offset:1024
    ds_read_b64_tr_b16 a[192:193], v1 offset:32
    ds_read_b64_tr_b16 a[194:195], v1 offset:1056
    ds_read_b64_tr_b16 a[68:69], v1 offset:2048
    ds_read_b64_tr_b16 a[70:71], v1 offset:3072
    ds_read_b64_tr_b16 a[196:197], v1 offset:2080
    ds_read_b64_tr_b16 a[198:199], v1 offset:3104
    ds_read_b64_tr_b16 a[72:73], v1 offset:4096
    ds_read_b64_tr_b16 a[74:75], v1 offset:5120
    ds_read_b64_tr_b16 a[200:201], v1 offset:4128
    ds_read_b64_tr_b16 a[202:203], v1 offset:5152
    ds_read_b64_tr_b16 a[76:77], v1 offset:6144
    ds_read_b64_tr_b16 a[78:79], v1 offset:7168
    ds_read_b64_tr_b16 a[204:205], v1 offset:6176
    ds_read_b64_tr_b16 a[206:207], v1 offset:7200
    s_waitcnt lgkmcnt(0)
    s_waitcnt vmcnt(16)
    ds_read_b64_tr_b16 a[80:81], v1 offset:8192
    ds_read_b64_tr_b16 a[82:83], v1 offset:9216
    ds_read_b64_tr_b16 a[208:209], v1 offset:8224
    ds_read_b64_tr_b16 a[210:211], v1 offset:9248
    ds_read_b64_tr_b16 a[84:85], v1 offset:10240
    ds_read_b64_tr_b16 a[86:87], v1 offset:11264
    ds_read_b64_tr_b16 a[212:213], v1 offset:10272
    ds_read_b64_tr_b16 a[214:215], v1 offset:11296
    ds_read_b64_tr_b16 a[88:89], v1 offset:12288
    ds_read_b64_tr_b16 a[90:91], v1 offset:13312
    ds_read_b64_tr_b16 a[216:217], v1 offset:12320
    ds_read_b64_tr_b16 a[218:219], v1 offset:13344
    ds_read_b64_tr_b16 a[92:93], v1 offset:14336
    ds_read_b64_tr_b16 a[94:95], v1 offset:15360
    ds_read_b64_tr_b16 a[220:221], v1 offset:14368
    ds_read_b64_tr_b16 a[222:223], v1 offset:15392
    s_waitcnt lgkmcnt(0)
    s_waitcnt vmcnt(8)
    ds_read_b64_tr_b16 a[96:97], v1 offset:16384
    ds_read_b64_tr_b16 a[98:99], v1 offset:17408
    ds_read_b64_tr_b16 a[224:225], v1 offset:16416
    ds_read_b64_tr_b16 a[226:227], v1 offset:17440
    ds_read_b64_tr_b16 a[100:101], v1 offset:18432
    ds_read_b64_tr_b16 a[102:103], v1 offset:19456
    ds_read_b64_tr_b16 a[228:229], v1 offset:18464
    ds_read_b64_tr_b16 a[230:231], v1 offset:19488
    ds_read_b64_tr_b16 a[104:105], v1 offset:20480
    ds_read_b64_tr_b16 a[106:107], v1 offset:21504
    ds_read_b64_tr_b16 a[232:233], v1 offset:20512
    ds_read_b64_tr_b16 a[234:235], v1 offset:21536
    ds_read_b64_tr_b16 a[108:109], v1 offset:22528
    ds_read_b64_tr_b16 a[110:111], v1 offset:23552
    ds_read_b64_tr_b16 a[236:237], v1 offset:22560
    ds_read_b64_tr_b16 a[238:239], v1 offset:23584
    s_waitcnt lgkmcnt(0)
    s_waitcnt vmcnt(0)
    ds_read_b64_tr_b16 a[112:113], v1 offset:24576
    ds_read_b64_tr_b16 a[114:115], v1 offset:25600
    ds_read_b64_tr_b16 a[240:241], v1 offset:24608
    ds_read_b64_tr_b16 a[242:243], v1 offset:25632
    ds_read_b64_tr_b16 a[116:117], v1 offset:26624
    ds_read_b64_tr_b16 a[118:119], v1 offset:27648
    ds_read_b64_tr_b16 a[244:245], v1 offset:26656
    ds_read_b64_tr_b16 a[246:247], v1 offset:27680
    ds_read_b64_tr_b16 a[120:121], v1 offset:28672
    ds_read_b64_tr_b16 a[122:123], v1 offset:29696
    ds_read_b64_tr_b16 a[248:249], v1 offset:28704
    ds_read_b64_tr_b16 a[250:251], v1 offset:29728
    ds_read_b64_tr_b16 a[124:125], v1 offset:30720
    ds_read_b64_tr_b16 a[126:127], v1 offset:31744
    ds_read_b64_tr_b16 a[252:253], v1 offset:30752
    ds_read_b64_tr_b16 a[254:255], v1 offset:31776
    s_waitcnt lgkmcnt(0)
    s_cmp_lt_u32 s12, 5
    s_cbranch_scc1 main_kernel_o_top
    v_mul_u32_u24 v178, 2, v173
    v_sub_u32 v171, v172, v178
main_kernel_o_gp:
    buffer_load_dword v174, v171, s[4:7], 0 offen sc1
    s_waitcnt vmcnt(0)
    v_cmp_eq_u32 vcc, 0, v174
    s_cbranch_vccz main_kernel_o_top
    s_sleep 32
    s_sub_u32 s29, s29, 1
    s_cbranch_scc0 main_kernel_o_gp
    s_branch main_kernel_end
main_kernel_o_top:
    buffer_load_dword v174, v172, s[4:7], 0 offen sc1
    s_waitcnt vmcnt(0)
    v_cmp_eq_u32 vcc, 0, v174
    s_cbranch_vccz main_kernel_o_go
    s_sleep 1
    s_sub_u32 s29, s29, 1
    s_cbranch_scc0 main_kernel_o_top
    s_branch main_kernel_end
main_kernel_o_go:
    v_add_u32 v172, v172, v173
    buffer_load_dword v174, v172, s[4:7], 0 offen sc1
    buffer_load_dwordx4 v[0:3], v170, s[4:7], s15 offen offset:0 sc1
    buffer_load_dwordx4 v[4:7], v170, s[4:7], s15 offen offset:1024 sc1
    buffer_load_dwordx4 v[8:11], v170, s[4:7], s15 offen offset:2048 sc1
    buffer_load_dwordx4 v[12:15], v170, s[4:7], s15 offen offset:3072 sc1
    s_add_u32 s15, s15, 4096
    buffer_load_dwordx4 v[16:19], v170, s[4:7], s15 offen offset:0 sc1
    buffer_load_dwordx4 v[20:23], v170, s[4:7], s15 offen offset:1024 sc1
    buffer_load_dwordx4 v[24:27], v170, s[4:7], s15 offen offset:2048 sc1
    buffer_load_dwordx4 v[28:31], v170, s[4:7], s15 offen offset:3072 sc1
    s_add_u32 s15, s15, 4096
    buffer_load_dwordx4 v[32:35], v170, s[4:7], s15 offen offset:0 sc1
    buffer_load_dwordx4 v[36:39], v170, s[4:7], s15 offen offset:1024 sc1
    buffer_load_dwordx4 v[40:43], v170, s[4:7], s15 offen offset:2048 sc1
    buffer_load_dwordx4 v[44:47], v170, s[4:7], s15 offen offset:3072 sc1
    s_add_u32 s15, s15, 4096
    buffer_load_dwordx4 v[48:51], v170, s[4:7], s15 offen offset:0 sc1
    buffer_load_dwordx4 v[52:55], v170, s[4:7], s15 offen offset:1024 sc1
    buffer_load_dwordx4 v[56:59], v170, s[4:7], s15 offen offset:2048 sc1
    buffer_load_dwordx4 v[60:63], v170, s[4:7], s15 offen offset:3072 sc1
    s_add_u32 s15, s15, 4096
    buffer_load_dwordx4 v[64:67], v170, s[4:7], s15 offen offset:0 sc1
    buffer_load_dwordx4 v[68:71], v170, s[4:7], s15 offen offset:1024 sc1
    buffer_load_dwordx4 v[72:75], v170, s[4:7], s15 offen offset:2048 sc1
    buffer_load_dwordx4 v[76:79], v170, s[4:7], s15 offen offset:3072 sc1
    s_add_u32 s15, s15, 4096
    buffer_load_dwordx4 v[80:83], v170, s[4:7], s15 offen offset:0 sc1
    buffer_load_dwordx4 v[84:87], v170, s[4:7], s15 offen offset:1024 sc1
    buffer_load_dwordx4 v[88:91], v170, s[4:7], s15 offen offset:2048 sc1
    buffer_load_dwordx4 v[92:95], v170, s[4:7], s15 offen offset:3072 sc1
    s_add_u32 s15, s15, 4096
    buffer_load_dwordx4 v[96:99], v170, s[4:7], s15 offen offset:0 sc1
    buffer_load_dwordx4 v[100:103], v170, s[4:7], s15 offen offset:1024 sc1
    buffer_load_dwordx4 v[104:107], v170, s[4:7], s15 offen offset:2048 sc1
    buffer_load_dwordx4 v[108:111], v170, s[4:7], s15 offen offset:3072 sc1
    s_add_u32 s15, s15, 4096
    buffer_load_dwordx4 v[112:115], v170, s[4:7], s15 offen offset:0 sc1
    buffer_load_dwordx4 v[116:119], v170, s[4:7], s15 offen offset:1024 sc1
    buffer_load_dwordx4 v[120:123], v170, s[4:7], s15 offen offset:2048 sc1
    buffer_load_dwordx4 v[124:127], v170, s[4:7], s15 offen offset:3072 sc1
    s_add_u32 s15, s15, 233472
main_kernel_o_x:
    buffer_load_dwordx2 v[160:161], v175, s[96:99], s16 offen
    buffer_load_dwordx2 v[162:163], v170, s[4:7], s17 offen sc1
    s_add_u32 s17, s17, 65536
    s_add_u32 s18, s18, 1
    s_mov_b32 s39, 0
    s_waitcnt vmcnt(34)
    v_cmp_eq_u32 vcc, 0, v174
    s_cmp_le_u32 s18, 62
    s_cbranch_scc0 main_kernel_o_n
    s_cbranch_vccnz main_kernel_o_n
    s_mov_b32 s39, 1
    v_add_u32 v172, v172, v173
    buffer_load_dword v174, v172, s[4:7], 0 offen sc1
    s_waitcnt vmcnt(34)
    v_mfma_f32_16x16x32_bf16 v[128:131], a[0:3], v[0:3], 0
    v_mfma_f32_16x16x32_bf16 v[132:135], a[128:131], v[0:3], 0
    buffer_load_dwordx4 v[0:3], v170, s[4:7], s15 offen offset:0 sc1
    s_waitcnt vmcnt(34)
    v_mfma_f32_16x16x32_bf16 v[128:131], a[4:7], v[4:7], v[128:131]
    v_mfma_f32_16x16x32_bf16 v[132:135], a[132:135], v[4:7], v[132:135]
    buffer_load_dwordx4 v[4:7], v170, s[4:7], s15 offen offset:1024 sc1
    s_waitcnt vmcnt(34)
    v_mfma_f32_16x16x32_bf16 v[128:131], a[8:11], v[8:11], v[128:131]
    v_mfma_f32_16x16x32_bf16 v[132:135], a[136:139], v[8:11], v[132:135]
    buffer_load_dwordx4 v[8:11], v170, s[4:7], s15 offen offset:2048 sc1
    s_waitcnt vmcnt(34)
    v_mfma_f32_16x16x32_bf16 v[128:131], a[12:15], v[12:15], v[128:131]
    v_mfma_f32_16x16x32_bf16 v[132:135], a[140:143], v[12:15], v[132:135]
    buffer_load_dwordx4 v[12:15], v170, s[4:7], s15 offen offset:3072 sc1
    s_add_u32 s15, s15, 4096
    s_waitcnt vmcnt(34)
    v_mfma_f32_16x16x32_bf16 v[128:131], a[16:19], v[16:19], v[128:131]
    v_mfma_f32_16x16x32_bf16 v[132:135], a[144:147], v[16:19], v[132:135]
    buffer_load_dwordx4 v[16:19], v170, s[4:7], s15 offen offset:0 sc1
    s_waitcnt vmcnt(34)
    v_mfma_f32_16x16x32_bf16 v[128:131], a[20:23], v[20:23], v[128:131]
    v_mfma_f32_16x16x32_bf16 v[132:135], a[148:151], v[20:23], v[132:135]
    buffer_load_dwordx4 v[20:23], v170, s[4:7], s15 offen offset:1024 sc1
    s_waitcnt vmcnt(34)
    v_mfma_f32_16x16x32_bf16 v[128:131], a[24:27], v[24:27], v[128:131]
    v_mfma_f32_16x16x32_bf16 v[132:135], a[152:155], v[24:27], v[132:135]
    buffer_load_dwordx4 v[24:27], v170, s[4:7], s15 offen offset:2048 sc1
    s_waitcnt vmcnt(34)
    v_mfma_f32_16x16x32_bf16 v[128:131], a[28:31], v[28:31], v[128:131]
    v_mfma_f32_16x16x32_bf16 v[132:135], a[156:159], v[28:31], v[132:135]
    buffer_load_dwordx4 v[28:31], v170, s[4:7], s15 offen offset:3072 sc1
    s_add_u32 s15, s15, 4096
    s_waitcnt vmcnt(34)
    v_mfma_f32_16x16x32_bf16 v[128:131], a[32:35], v[32:35], v[128:131]
    v_mfma_f32_16x16x32_bf16 v[132:135], a[160:163], v[32:35], v[132:135]
    buffer_load_dwordx4 v[32:35], v170, s[4:7], s15 offen offset:0 sc1
    s_waitcnt vmcnt(34)
    v_mfma_f32_16x16x32_bf16 v[128:131], a[36:39], v[36:39], v[128:131]
    v_mfma_f32_16x16x32_bf16 v[132:135], a[164:167], v[36:39], v[132:135]
    buffer_load_dwordx4 v[36:39], v170, s[4:7], s15 offen offset:1024 sc1
    s_waitcnt vmcnt(34)
    v_mfma_f32_16x16x32_bf16 v[128:131], a[40:43], v[40:43], v[128:131]
    v_mfma_f32_16x16x32_bf16 v[132:135], a[168:171], v[40:43], v[132:135]
    buffer_load_dwordx4 v[40:43], v170, s[4:7], s15 offen offset:2048 sc1
    s_waitcnt vmcnt(34)
    v_mfma_f32_16x16x32_bf16 v[128:131], a[44:47], v[44:47], v[128:131]
    v_mfma_f32_16x16x32_bf16 v[132:135], a[172:175], v[44:47], v[132:135]
    buffer_load_dwordx4 v[44:47], v170, s[4:7], s15 offen offset:3072 sc1
    s_add_u32 s15, s15, 4096
    s_waitcnt vmcnt(34)
    v_mfma_f32_16x16x32_bf16 v[128:131], a[48:51], v[48:51], v[128:131]
    v_mfma_f32_16x16x32_bf16 v[132:135], a[176:179], v[48:51], v[132:135]
    buffer_load_dwordx4 v[48:51], v170, s[4:7], s15 offen offset:0 sc1
    s_waitcnt vmcnt(34)
    v_mfma_f32_16x16x32_bf16 v[128:131], a[52:55], v[52:55], v[128:131]
    v_mfma_f32_16x16x32_bf16 v[132:135], a[180:183], v[52:55], v[132:135]
    buffer_load_dwordx4 v[52:55], v170, s[4:7], s15 offen offset:1024 sc1
    s_waitcnt vmcnt(34)
    v_mfma_f32_16x16x32_bf16 v[128:131], a[56:59], v[56:59], v[128:131]
    v_mfma_f32_16x16x32_bf16 v[132:135], a[184:187], v[56:59], v[132:135]
    buffer_load_dwordx4 v[56:59], v170, s[4:7], s15 offen offset:2048 sc1
    s_waitcnt vmcnt(34)
    v_mfma_f32_16x16x32_bf16 v[128:131], a[60:63], v[60:63], v[128:131]
    v_mfma_f32_16x16x32_bf16 v[132:135], a[188:191], v[60:63], v[132:135]
    buffer_load_dwordx4 v[60:63], v170, s[4:7], s15 offen offset:3072 sc1
    s_add_u32 s15, s15, 4096
    s_waitcnt vmcnt(34)
    v_mfma_f32_16x16x32_bf16 v[128:131], a[64:67], v[64:67], v[128:131]
    v_mfma_f32_16x16x32_bf16 v[132:135], a[192:195], v[64:67], v[132:135]
    buffer_load_dwordx4 v[64:67], v170, s[4:7], s15 offen offset:0 sc1
    s_waitcnt vmcnt(34)
    v_mfma_f32_16x16x32_bf16 v[128:131], a[68:71], v[68:71], v[128:131]
    v_mfma_f32_16x16x32_bf16 v[132:135], a[196:199], v[68:71], v[132:135]
    buffer_load_dwordx4 v[68:71], v170, s[4:7], s15 offen offset:1024 sc1
    s_waitcnt vmcnt(34)
    v_mfma_f32_16x16x32_bf16 v[128:131], a[72:75], v[72:75], v[128:131]
    v_mfma_f32_16x16x32_bf16 v[132:135], a[200:203], v[72:75], v[132:135]
    buffer_load_dwordx4 v[72:75], v170, s[4:7], s15 offen offset:2048 sc1
    s_waitcnt vmcnt(34)
    v_mfma_f32_16x16x32_bf16 v[128:131], a[76:79], v[76:79], v[128:131]
    v_mfma_f32_16x16x32_bf16 v[132:135], a[204:207], v[76:79], v[132:135]
    buffer_load_dwordx4 v[76:79], v170, s[4:7], s15 offen offset:3072 sc1
    s_add_u32 s15, s15, 4096
    s_waitcnt vmcnt(34)
    v_mfma_f32_16x16x32_bf16 v[128:131], a[80:83], v[80:83], v[128:131]
    v_mfma_f32_16x16x32_bf16 v[132:135], a[208:211], v[80:83], v[132:135]
    buffer_load_dwordx4 v[80:83], v170, s[4:7], s15 offen offset:0 sc1
    s_waitcnt vmcnt(34)
    v_mfma_f32_16x16x32_bf16 v[128:131], a[84:87], v[84:87], v[128:131]
    v_mfma_f32_16x16x32_bf16 v[132:135], a[212:215], v[84:87], v[132:135]
    buffer_load_dwordx4 v[84:87], v170, s[4:7], s15 offen offset:1024 sc1
    s_waitcnt vmcnt(34)
    v_mfma_f32_16x16x32_bf16 v[128:131], a[88:91], v[88:91], v[128:131]
    v_mfma_f32_16x16x32_bf16 v[132:135], a[216:219], v[88:91], v[132:135]
    buffer_load_dwordx4 v[88:91], v170, s[4:7], s15 offen offset:2048 sc1
    s_waitcnt vmcnt(34)
    v_mfma_f32_16x16x32_bf16 v[128:131], a[92:95], v[92:95], v[128:131]
    v_mfma_f32_16x16x32_bf16 v[132:135], a[220:223], v[92:95], v[132:135]
    buffer_load_dwordx4 v[92:95], v170, s[4:7], s15 offen offset:3072 sc1
    s_add_u32 s15, s15, 4096
    s_waitcnt vmcnt(34)
    v_mfma_f32_16x16x32_bf16 v[128:131], a[96:99], v[96:99], v[128:131]
    v_mfma_f32_16x16x32_bf16 v[132:135], a[224:227], v[96:99], v[132:135]
    buffer_load_dwordx4 v[96:99], v170, s[4:7], s15 offen offset:0 sc1
    s_waitcnt vmcnt(34)
    v_mfma_f32_16x16x32_bf16 v[128:131], a[100:103], v[100:103], v[128:131]
    v_mfma_f32_16x16x32_bf16 v[132:135], a[228:231], v[100:103], v[132:135]
    buffer_load_dwordx4 v[100:103], v170, s[4:7], s15 offen offset:1024 sc1
    s_waitcnt vmcnt(34)
    v_mfma_f32_16x16x32_bf16 v[128:131], a[104:107], v[104:107], v[128:131]
    v_mfma_f32_16x16x32_bf16 v[132:135], a[232:235], v[104:107], v[132:135]
    buffer_load_dwordx4 v[104:107], v170, s[4:7], s15 offen offset:2048 sc1
    s_waitcnt vmcnt(34)
    v_mfma_f32_16x16x32_bf16 v[128:131], a[108:111], v[108:111], v[128:131]
    v_mfma_f32_16x16x32_bf16 v[132:135], a[236:239], v[108:111], v[132:135]
    buffer_load_dwordx4 v[108:111], v170, s[4:7], s15 offen offset:3072 sc1
    s_add_u32 s15, s15, 4096
    s_waitcnt vmcnt(34)
    v_mfma_f32_16x16x32_bf16 v[128:131], a[112:115], v[112:115], v[128:131]
    v_mfma_f32_16x16x32_bf16 v[132:135], a[240:243], v[112:115], v[132:135]
    buffer_load_dwordx4 v[112:115], v170, s[4:7], s15 offen offset:0 sc1
    s_waitcnt vmcnt(34)
    v_mfma_f32_16x16x32_bf16 v[128:131], a[116:119], v[116:119], v[128:131]
    v_mfma_f32_16x16x32_bf16 v[132:135], a[244:247], v[116:119], v[132:135]
    buffer_load_dwordx4 v[116:119], v170, s[4:7], s15 offen offset:1024 sc1
    s_waitcnt vmcnt(34)
    v_mfma_f32_16x16x32_bf16 v[128:131], a[120:123], v[120:123], v[128:131]
    v_mfma_f32_16x16x32_bf16 v[132:135], a[248:251], v[120:123], v[132:135]
    buffer_load_dwordx4 v[120:123], v170, s[4:7], s15 offen offset:2048 sc1
    s_waitcnt vmcnt(34)
    v_mfma_f32_16x16x32_bf16 v[128:131], a[124:127], v[124:127], v[128:131]
    v_mfma_f32_16x16x32_bf16 v[132:135], a[252:255], v[124:127], v[132:135]
    buffer_load_dwordx4 v[124:127], v170, s[4:7], s15 offen offset:3072 sc1
    s_add_u32 s15, s15, 233472
    s_waitcnt vmcnt(33)
    s_branch main_kernel_o_e
main_kernel_o_n:
    buffer_load_dword v174, v172, s[4:7], 0 offen sc1
    s_waitcnt vmcnt(34)
    v_mfma_f32_16x16x32_bf16 v[128:131], a[0:3], v[0:3], 0
    v_mfma_f32_16x16x32_bf16 v[132:135], a[128:131], v[0:3], 0
    s_waitcnt vmcnt(33)
    v_mfma_f32_16x16x32_bf16 v[128:131], a[4:7], v[4:7], v[128:131]
    v_mfma_f32_16x16x32_bf16 v[132:135], a[132:135], v[4:7], v[132:135]
    s_waitcnt vmcnt(32)
    v_mfma_f32_16x16x32_bf16 v[128:131], a[8:11], v[8:11], v[128:131]
    v_mfma_f32_16x16x32_bf16 v[132:135], a[136:139], v[8:11], v[132:135]
    s_waitcnt vmcnt(31)
    v_mfma_f32_16x16x32_bf16 v[128:131], a[12:15], v[12:15], v[128:131]
    v_mfma_f32_16x16x32_bf16 v[132:135], a[140:143], v[12:15], v[132:135]
    s_waitcnt vmcnt(30)
    v_mfma_f32_16x16x32_bf16 v[128:131], a[16:19], v[16:19], v[128:131]
    v_mfma_f32_16x16x32_bf16 v[132:135], a[144:147], v[16:19], v[132:135]
    s_waitcnt vmcnt(29)
    v_mfma_f32_16x16x32_bf16 v[128:131], a[20:23], v[20:23], v[128:131]
    v_mfma_f32_16x16x32_bf16 v[132:135], a[148:151], v[20:23], v[132:135]
    s_waitcnt vmcnt(28)
    v_mfma_f32_16x16x32_bf16 v[128:131], a[24:27], v[24:27], v[128:131]
    v_mfma_f32_16x16x32_bf16 v[132:135], a[152:155], v[24:27], v[132:135]
    s_waitcnt vmcnt(27)
    v_mfma_f32_16x16x32_bf16 v[128:131], a[28:31], v[28:31], v[128:131]
    v_mfma_f32_16x16x32_bf16 v[132:135], a[156:159], v[28:31], v[132:135]
    s_waitcnt vmcnt(26)
    v_mfma_f32_16x16x32_bf16 v[128:131], a[32:35], v[32:35], v[128:131]
    v_mfma_f32_16x16x32_bf16 v[132:135], a[160:163], v[32:35], v[132:135]
    s_waitcnt vmcnt(25)
    v_mfma_f32_16x16x32_bf16 v[128:131], a[36:39], v[36:39], v[128:131]
    v_mfma_f32_16x16x32_bf16 v[132:135], a[164:167], v[36:39], v[132:135]
    s_waitcnt vmcnt(24)
    v_mfma_f32_16x16x32_bf16 v[128:131], a[40:43], v[40:43], v[128:131]
    v_mfma_f32_16x16x32_bf16 v[132:135], a[168:171], v[40:43], v[132:135]
    s_waitcnt vmcnt(23)
    v_mfma_f32_16x16x32_bf16 v[128:131], a[44:47], v[44:47], v[128:131]
    v_mfma_f32_16x16x32_bf16 v[132:135], a[172:175], v[44:47], v[132:135]
    s_waitcnt vmcnt(22)
    v_mfma_f32_16x16x32_bf16 v[128:131], a[48:51], v[48:51], v[128:131]
    v_mfma_f32_16x16x32_bf16 v[132:135], a[176:179], v[48:51], v[132:135]
    s_waitcnt vmcnt(21)
    v_mfma_f32_16x16x32_bf16 v[128:131], a[52:55], v[52:55], v[128:131]
    v_mfma_f32_16x16x32_bf16 v[132:135], a[180:183], v[52:55], v[132:135]
    s_waitcnt vmcnt(20)
    v_mfma_f32_16x16x32_bf16 v[128:131], a[56:59], v[56:59], v[128:131]
    v_mfma_f32_16x16x32_bf16 v[132:135], a[184:187], v[56:59], v[132:135]
    s_waitcnt vmcnt(19)
    v_mfma_f32_16x16x32_bf16 v[128:131], a[60:63], v[60:63], v[128:131]
    v_mfma_f32_16x16x32_bf16 v[132:135], a[188:191], v[60:63], v[132:135]
    s_waitcnt vmcnt(18)
    v_mfma_f32_16x16x32_bf16 v[128:131], a[64:67], v[64:67], v[128:131]
    v_mfma_f32_16x16x32_bf16 v[132:135], a[192:195], v[64:67], v[132:135]
    s_waitcnt vmcnt(17)
    v_mfma_f32_16x16x32_bf16 v[128:131], a[68:71], v[68:71], v[128:131]
    v_mfma_f32_16x16x32_bf16 v[132:135], a[196:199], v[68:71], v[132:135]
    s_waitcnt vmcnt(16)
    v_mfma_f32_16x16x32_bf16 v[128:131], a[72:75], v[72:75], v[128:131]
    v_mfma_f32_16x16x32_bf16 v[132:135], a[200:203], v[72:75], v[132:135]
    s_waitcnt vmcnt(15)
    v_mfma_f32_16x16x32_bf16 v[128:131], a[76:79], v[76:79], v[128:131]
    v_mfma_f32_16x16x32_bf16 v[132:135], a[204:207], v[76:79], v[132:135]
    s_waitcnt vmcnt(14)
    v_mfma_f32_16x16x32_bf16 v[128:131], a[80:83], v[80:83], v[128:131]
    v_mfma_f32_16x16x32_bf16 v[132:135], a[208:211], v[80:83], v[132:135]
    s_waitcnt vmcnt(13)
    v_mfma_f32_16x16x32_bf16 v[128:131], a[84:87], v[84:87], v[128:131]
    v_mfma_f32_16x16x32_bf16 v[132:135], a[212:215], v[84:87], v[132:135]
    s_waitcnt vmcnt(12)
    v_mfma_f32_16x16x32_bf16 v[128:131], a[88:91], v[88:91], v[128:131]
    v_mfma_f32_16x16x32_bf16 v[132:135], a[216:219], v[88:91], v[132:135]
    s_waitcnt vmcnt(11)
    v_mfma_f32_16x16x32_bf16 v[128:131], a[92:95], v[92:95], v[128:131]
    v_mfma_f32_16x16x32_bf16 v[132:135], a[220:223], v[92:95], v[132:135]
    s_waitcnt vmcnt(10)
    v_mfma_f32_16x16x32_bf16 v[128:131], a[96:99], v[96:99], v[128:131]
    v_mfma_f32_16x16x32_bf16 v[132:135], a[224:227], v[96:99], v[132:135]
    s_waitcnt vmcnt(9)
    v_mfma_f32_16x16x32_bf16 v[128:131], a[100:103], v[100:103], v[128:131]
    v_mfma_f32_16x16x32_bf16 v[132:135], a[228:231], v[100:103], v[132:135]
    s_waitcnt vmcnt(8)
    v_mfma_f32_16x16x32_bf16 v[128:131], a[104:107], v[104:107], v[128:131]
    v_mfma_f32_16x16x32_bf16 v[132:135], a[232:235], v[104:107], v[132:135]
    s_waitcnt vmcnt(7)
    v_mfma_f32_16x16x32_bf16 v[128:131], a[108:111], v[108:111], v[128:131]
    v_mfma_f32_16x16x32_bf16 v[132:135], a[236:239], v[108:111], v[132:135]
    s_waitcnt vmcnt(6)
    v_mfma_f32_16x16x32_bf16 v[128:131], a[112:115], v[112:115], v[128:131]
    v_mfma_f32_16x16x32_bf16 v[132:135], a[240:243], v[112:115], v[132:135]
    s_waitcnt vmcnt(5)
    v_mfma_f32_16x16x32_bf16 v[128:131], a[116:119], v[116:119], v[128:131]
    v_mfma_f32_16x16x32_bf16 v[132:135], a[244:247], v[116:119], v[132:135]
    s_waitcnt vmcnt(4)
    v_mfma_f32_16x16x32_bf16 v[128:131], a[120:123], v[120:123], v[128:131]
    v_mfma_f32_16x16x32_bf16 v[132:135], a[248:251], v[120:123], v[132:135]
    s_waitcnt vmcnt(3)
    v_mfma_f32_16x16x32_bf16 v[128:131], a[124:127], v[124:127], v[128:131]
    v_mfma_f32_16x16x32_bf16 v[132:135], a[252:255], v[124:127], v[132:135]
    s_waitcnt vmcnt(0)
    v_cmp_eq_u32 vcc, 0, v174
main_kernel_o_e:
    v_lshlrev_b32 v164, 16, v160
    v_and_b32 v165, 0xffff0000, v160
    v_lshlrev_b32 v166, 16, v161
    v_and_b32 v167, 0xffff0000, v161
    v_lshlrev_b32 v160, 16, v162
    v_and_b32 v161, 0xffff0000, v162
    v_lshlrev_b32 v162, 16, v163
    v_and_b32 v163, 0xffff0000, v163
    s_cmp_ge_u32 s14, 2
    ds_write_b128 v176, v[128:131] offset:0
    ds_write_b128 v176, v[132:135] offset:1024
    v_xor_b32 v176, 0x4000, v176
    s_waitcnt lgkmcnt(0)
    s_barrier
    s_cbranch_scc1 main_kernel_o_nx
    ds_read_b128 v[144:147], v177 offset:0
    ds_read_b128 v[148:151], v177 offset:2048
    ds_read_b128 v[152:155], v177 offset:4096
    ds_read_b128 v[156:159], v177 offset:6144
    v_xor_b32 v177, 0x4000, v177
    s_waitcnt lgkmcnt(2)
    v_pk_add_f32 v[144:145], v[144:145], v[148:149]
    v_pk_add_f32 v[146:147], v[146:147], v[150:151]
    s_waitcnt lgkmcnt(0)
    v_pk_add_f32 v[152:153], v[152:153], v[156:157]
    v_pk_add_f32 v[154:155], v[154:155], v[158:159]
    v_pk_add_f32 v[144:145], v[144:145], v[152:153]
    v_pk_add_f32 v[146:147], v[146:147], v[154:155]
    v_pk_fma_f32 v[144:145], v[144:145], v[160:161], v[164:165]
    v_pk_fma_f32 v[146:147], v[146:147], v[162:163], v[166:167]
    v_cvt_pk_bf16_f32 v148, v144, v145
    v_cvt_pk_bf16_f32 v149, v146, v147
    buffer_store_dwordx2 v[148:149], v175, s[92:95], s16 offen
main_kernel_o_nx:
    s_add_u32 s16, s16, 65536
    s_cmp_lg_u32 s39, 0
    s_cbranch_scc1 main_kernel_o_x
    s_cmp_le_u32 s18, 62
    s_cbranch_scc0 main_kernel_o_sk
    s_cbranch_vccz main_kernel_o_go
    s_branch main_kernel_o_top
main_kernel_o_sk:
    v_add_u32 v172, v172, v173
    s_add_u32 s17, s17, 65536
    s_add_u32 s16, s16, 65536
    s_add_u32 s15, s15, 262144
    s_add_u32 s18, s18, 1
    s_cmp_lt_u32 s18, 64
    s_cbranch_scc1 main_kernel_o_top
    s_branch main_kernel_end
main_kernel_end2:
    s_endpgm
main_kernel_worker:
    v_lshlrev_b32 v251, 4, v250
    v_mov_b32 v240, 0xc0135761
    v_mov_b32 v241, 0xc0135761
    v_mov_b32 v242, 0xbdd2d3e8
    v_mov_b32 v243, 0xbdd2d3e8
    v_mov_b32 v244, 0x3f800000
    v_mov_b32 v245, 0x3f800000
    v_mov_b32 v246, 0xbfb8aa3b
    v_mov_b32 v247, 0xbfb8aa3b
    s_lshr_b32 s37, s14, 1
    s_and_b32 s38, s14, 1
    v_mov_b32 v252, 0
    s_mov_b32 s8, s40
    s_and_b32 s9, s41, 0xffff
    s_mov_b32 s10, 0x0
    s_mov_b32 s11, 0x20000
    s_mov_b32 s57, 0
    s_mov_b32 s56, 0x7f000000
    v_mov_b32 v249, 0
main_kernel_w_next:
    s_cmp_lg_u32 s14, 0
    s_cbranch_scc1 main_kernel_w_bar
main_kernel_w_try:
    s_lshl_b32 s32, s27, 8
    s_add_u32 s32, s32, 0x841e000
    v_mov_b32 v254, 1
    s_mov_b64 exec, 1
    buffer_atomic_add v254, off, s[4:7], s32 sc0 sc1
    s_mov_b64 exec, -1
    s_waitcnt vmcnt(0)
    v_readfirstlane_b32 s28, v254
    s_cmp_eq_u32 s57, 0
    s_cbranch_scc1 main_kernel_w_fl1
    s_waitcnt vmcnt(0)
    s_barrier
    v_mov_b32 v4, 1
    v_mov_b32 v5, 1
    v_mov_b32 v6, 1
    v_mov_b32 v7, 1
    s_bfm_b64 exec, s57, 0
    buffer_store_dwordx4 v[4:7], v249, s[4:7], s56 offen sc1
    s_mov_b64 exec, -1
    s_mov_b32 s57, 0
main_kernel_w_fl1:
    s_nop 3
main_kernel_w_have:
    s_cmp_lg_u32 s27, 0
    s_cbranch_scc1 main_kernel_w_q1
    s_cmp_lt_u32 s28, 120
    s_cbranch_scc0 main_kernel_w_d_1
    s_cmp_lt_u32 s28, 48
    s_cbranch_scc0 main_kernel_w_d_2
    s_cmp_lt_u32 s28, 24
    s_cbranch_scc0 main_kernel_w_d_3
    s_cmp_lt_u32 s28, 8
    s_cbranch_scc0 main_kernel_w_d_4
    s_mov_b32 s36, 0x4005800
    s_branch main_kernel_w_dec
main_kernel_w_d_4:
    s_mov_b32 s36, 0x8085008
    s_branch main_kernel_w_dec
main_kernel_w_d_3:
    s_cmp_lt_u32 s28, 32
    s_cbranch_scc0 main_kernel_w_d_5
    s_mov_b32 s36, 0x64090818
    s_branch main_kernel_w_dec
main_kernel_w_d_5:
    s_mov_b32 s36, 0x48109820
    s_branch main_kernel_w_dec
main_kernel_w_d_2:
    s_cmp_lt_u32 s28, 72
    s_cbranch_scc0 main_kernel_w_d_6
    s_cmp_lt_u32 s28, 64
    s_cbranch_scc0 main_kernel_w_d_7
    s_mov_b32 s36, 0x8105030
    s_branch main_kernel_w_dec
main_kernel_w_d_7:
    s_mov_b32 s36, 0x65191040
    s_branch main_kernel_w_dec
main_kernel_w_d_6:
    s_cmp_lt_u32 s28, 88
    s_cbranch_scc0 main_kernel_w_d_8
    s_mov_b32 s36, 0x44008048
    s_branch main_kernel_w_dec
main_kernel_w_d_8:
    s_cmp_lt_u32 s28, 104
    s_cbranch_scc0 main_kernel_w_d_9
    s_mov_b32 s36, 0x41c2058
    s_branch main_kernel_w_dec
main_kernel_w_d_9:
    s_mov_b32 s36, 0x46048068
    s_branch main_kernel_w_dec
main_kernel_w_d_1:
    s_cmp_lt_u32 s28, 184
    s_cbranch_scc0 main_kernel_w_d_10
    s_cmp_lt_u32 s28, 152
    s_cbranch_scc0 main_kernel_w_d_11
    s_cmp_lt_u32 s28, 136
    s_cbranch_scc0 main_kernel_w_d_12
    s_mov_b32 s36, 0x4082078
    s_branch main_kernel_w_dec
main_kernel_w_d_12:
    s_mov_b32 s36, 0x8002888
    s_branch main_kernel_w_dec
main_kernel_w_d_11:
    s_cmp_lt_u32 s28, 160
    s_cbranch_scc0 main_kernel_w_d_13
    s_mov_b32 s36, 0x64013098
    s_branch main_kernel_w_dec
main_kernel_w_d_13:
    s_cmp_lt_u32 s28, 176
    s_cbranch_scc0 main_kernel_w_d_14
    s_mov_b32 s36, 0x4b1080a0
    s_branch main_kernel_w_dec
main_kernel_w_d_14:
    s_mov_b32 s36, 0x641130b0
    s_branch main_kernel_w_dec
main_kernel_w_d_10:
    s_cmp_lt_u32 s28, 208
    s_cbranch_scc0 main_kernel_w_d_15
    s_cmp_lt_u32 s28, 200
    s_cbranch_scc0 main_kernel_w_d_16
    s_mov_b32 s36, 0x4918b0b8
    s_branch main_kernel_w_dec
main_kernel_w_d_16:
    s_mov_b32 s36, 0x661908c8
    s_branch main_kernel_w_dec
main_kernel_w_d_15:
    s_cmp_lt_u32 s28, 224
    s_cbranch_scc0 main_kernel_w_d_17
    s_mov_b32 s36, 0x89038d0
    s_branch main_kernel_w_dec
main_kernel_w_d_17:
    s_cmp_lt_u32 s28, 232
    s_cbranch_scc0 main_kernel_w_d_18
    s_mov_b32 s36, 0x641900e0
    s_branch main_kernel_w_dec
main_kernel_w_d_18:
    s_mov_b32 s36, 0xffffffff
    s_branch main_kernel_w_dec
main_kernel_w_q1:
    s_cmp_lg_u32 s27, 1
    s_cbranch_scc1 main_kernel_w_q2
    s_cmp_lt_u32 s28, 68
    s_cbranch_scc0 main_kernel_w_d_19
    s_cmp_lt_u32 s28, 20
    s_cbranch_scc0 main_kernel_w_d_20
    s_cmp_lt_u32 s28, 4
    s_cbranch_scc0 main_kernel_w_d_21
    s_mov_b32 s36, 0x25000
    s_branch main_kernel_w_dec
main_kernel_w_d_21:
    s_cmp_lt_u32 s28, 12
    s_cbranch_scc0 main_kernel_w_d_22
    s_mov_b32 s36, 0x42069004
    s_branch main_kernel_w_dec
main_kernel_w_d_22:
    s_mov_b32 s36, 0x6709100c
    s_branch main_kernel_w_dec
main_kernel_w_d_20:
    s_cmp_lt_u32 s28, 36
    s_cbranch_scc0 main_kernel_w_d_23
    s_mov_b32 s36, 0x46008014
    s_branch main_kernel_w_dec
main_kernel_w_d_23:
    s_cmp_lt_u32 s28, 52
    s_cbranch_scc0 main_kernel_w_d_24
    s_mov_b32 s36, 0x4042024
    s_branch main_kernel_w_dec
main_kernel_w_d_24:
    s_mov_b32 s36, 0x49088034
    s_branch main_kernel_w_dec
main_kernel_w_d_19:
    s_cmp_lt_u32 s28, 112
    s_cbranch_scc0 main_kernel_w_d_25
    s_cmp_lt_u32 s28, 80
    s_cbranch_scc0 main_kernel_w_d_26
    s_mov_b32 s36, 0x4a10b044
    s_branch main_kernel_w_dec
main_kernel_w_d_26:
    s_cmp_lt_u32 s28, 96
    s_cbranch_scc0 main_kernel_w_d_27
    s_mov_b32 s36, 0x4a108050
    s_branch main_kernel_w_dec
main_kernel_w_d_27:
    s_mov_b32 s36, 0x8083860
    s_branch main_kernel_w_dec
main_kernel_w_d_25:
    s_cmp_lt_u32 s28, 120
    s_cbranch_scc0 main_kernel_w_d_28
    s_mov_b32 s36, 0x124070
    s_branch main_kernel_w_dec
main_kernel_w_d_28:
    s_cmp_lt_u32 s28, 128
    s_cbranch_scc0 main_kernel_w_d_29
    s_mov_b32 s36, 0x144078
    s_branch main_kernel_w_dec
main_kernel_w_d_29:
    s_mov_b32 s36, 0xffffffff
    s_branch main_kernel_w_dec
main_kernel_w_q2:
    s_cmp_lg_u32 s27, 2
    s_cbranch_scc1 main_kernel_w_q3
    s_cmp_lt_u32 s28, 112
    s_cbranch_scc0 main_kernel_w_d_30
    s_cmp_lt_u32 s28, 32
    s_cbranch_scc0 main_kernel_w_d_31
    s_cmp_lt_u32 s28, 16
    s_cbranch_scc0 main_kernel_w_d_32
    s_cmp_lt_u32 s28, 8
    s_cbranch_scc0 main_kernel_w_d_33
    s_mov_b32 s36, 0x800
    s_branch main_kernel_w_dec
main_kernel_w_d_33:
    s_mov_b32 s36, 0x1008
    s_branch main_kernel_w_dec
main_kernel_w_d_32:
    s_cmp_lt_u32 s28, 24
    s_cbranch_scc0 main_kernel_w_d_34
    s_mov_b32 s36, 0x44028810
    s_branch main_kernel_w_dec
main_kernel_w_d_34:
    s_mov_b32 s36, 0x44029018
    s_branch main_kernel_w_dec
main_kernel_w_d_31:
    s_cmp_lt_u32 s28, 64
    s_cbranch_scc0 main_kernel_w_d_35
    s_cmp_lt_u32 s28, 48
    s_cbranch_scc0 main_kernel_w_d_36
    s_mov_b32 s36, 0x48189820
    s_branch main_kernel_w_dec
main_kernel_w_d_36:
    s_mov_b32 s36, 0x48009830
    s_branch main_kernel_w_dec
main_kernel_w_d_35:
    s_cmp_lt_u32 s28, 80
    s_cbranch_scc0 main_kernel_w_d_37
    s_mov_b32 s36, 0x4102040
    s_branch main_kernel_w_dec
main_kernel_w_d_37:
    s_cmp_lt_u32 s28, 96
    s_cbranch_scc0 main_kernel_w_d_38
    s_mov_b32 s36, 0x4a109050
    s_branch main_kernel_w_dec
main_kernel_w_d_38:
    s_mov_b32 s36, 0x40c2060
    s_branch main_kernel_w_dec
main_kernel_w_d_30:
    s_cmp_lt_u32 s28, 162
    s_cbranch_scc0 main_kernel_w_d_39
    s_cmp_lt_u32 s28, 136
    s_cbranch_scc0 main_kernel_w_d_40
    s_cmp_lt_u32 s28, 120
    s_cbranch_scc0 main_kernel_w_d_41
    s_mov_b32 s36, 0x67111070
    s_branch main_kernel_w_dec
main_kernel_w_d_41:
    s_mov_b32 s36, 0x49108078
    s_branch main_kernel_w_dec
main_kernel_w_d_40:
    s_cmp_lt_u32 s28, 144
    s_cbranch_scc0 main_kernel_w_d_42
    s_mov_b32 s36, 0x64111088
    s_branch main_kernel_w_dec
main_kernel_w_d_42:
    s_cmp_lt_u32 s28, 150
    s_cbranch_scc0 main_kernel_w_d_43
    s_mov_b32 s36, 0x66c13090
    s_branch main_kernel_w_dec
main_kernel_w_d_43:
    s_mov_b32 s36, 0x4ad0b096
    s_branch main_kernel_w_dec
main_kernel_w_d_39:
    s_cmp_lt_u32 s28, 190
    s_cbranch_scc0 main_kernel_w_d_44
    s_cmp_lt_u32 s28, 174
    s_cbranch_scc0 main_kernel_w_d_45
    s_mov_b32 s36, 0x4ad8b0a2
    s_branch main_kernel_w_dec
main_kernel_w_d_45:
    s_mov_b32 s36, 0x81038ae
    s_branch main_kernel_w_dec
main_kernel_w_d_44:
    s_cmp_lt_u32 s28, 198
    s_cbranch_scc0 main_kernel_w_d_46
    s_mov_b32 s36, 0x671900be
    s_branch main_kernel_w_dec
main_kernel_w_d_46:
    s_cmp_lt_u32 s28, 206
    s_cbranch_scc0 main_kernel_w_d_47
    s_mov_b32 s36, 0x661900c6
    s_branch main_kernel_w_dec
main_kernel_w_d_47:
    s_mov_b32 s36, 0xffffffff
    s_branch main_kernel_w_dec
main_kernel_w_q3:
    s_cmp_lg_u32 s27, 3
    s_cbranch_scc1 main_kernel_w_q4
    s_cmp_lt_u32 s28, 112
    s_cbranch_scc0 main_kernel_w_d_48
    s_cmp_lt_u32 s28, 48
    s_cbranch_scc0 main_kernel_w_d_49
    s_cmp_lt_u32 s28, 16
    s_cbranch_scc0 main_kernel_w_d_50
    s_cmp_lt_u32 s28, 8
    s_cbranch_scc0 main_kernel_w_d_51
    s_mov_b32 s36, 0x1000800
    s_branch main_kernel_w_dec
main_kernel_w_d_51:
    s_mov_b32 s36, 0x1001008
    s_branch main_kernel_w_dec
main_kernel_w_d_50:
    s_cmp_lt_u32 s28, 24
    s_cbranch_scc0 main_kernel_w_d_52
    s_mov_b32 s36, 0x45028810
    s_branch main_kernel_w_dec
main_kernel_w_d_52:
    s_cmp_lt_u32 s28, 32
    s_cbranch_scc0 main_kernel_w_d_53
    s_mov_b32 s36, 0x45029018
    s_branch main_kernel_w_dec
main_kernel_w_d_53:
    s_mov_b32 s36, 0x48089820
    s_branch main_kernel_w_dec
main_kernel_w_d_49:
    s_cmp_lt_u32 s28, 80
    s_cbranch_scc0 main_kernel_w_d_54
    s_cmp_lt_u32 s28, 56
    s_cbranch_scc0 main_kernel_w_d_55
    s_mov_b32 s36, 0x66090830
    s_branch main_kernel_w_dec
main_kernel_w_d_55:
    s_cmp_lt_u32 s28, 64
    s_cbranch_scc0 main_kernel_w_d_56
    s_mov_b32 s36, 0x40068838
    s_branch main_kernel_w_dec
main_kernel_w_d_56:
    s_mov_b32 s36, 0x4142040
    s_branch main_kernel_w_dec
main_kernel_w_d_54:
    s_cmp_lt_u32 s28, 88
    s_cbranch_scc0 main_kernel_w_d_57
    s_mov_b32 s36, 0x67110850
    s_branch main_kernel_w_dec
main_kernel_w_d_57:
    s_cmp_lt_u32 s28, 96
    s_cbranch_scc0 main_kernel_w_d_58
    s_mov_b32 s36, 0x64110858
    s_branch main_kernel_w_dec
main_kernel_w_d_58:
    s_mov_b32 s36, 0x44048060
    s_branch main_kernel_w_dec
main_kernel_w_d_48:
    s_cmp_lt_u32 s28, 168
    s_cbranch_scc0 main_kernel_w_d_59
    s_cmp_lt_u32 s28, 142
    s_cbranch_scc0 main_kernel_w_d_60
    s_cmp_lt_u32 s28, 120
    s_cbranch_scc0 main_kernel_w_d_61
    s_mov_b32 s36, 0x67191070
    s_branch main_kernel_w_dec
main_kernel_w_d_61:
    s_cmp_lt_u32 s28, 136
    s_cbranch_scc0 main_kernel_w_d_62
    s_mov_b32 s36, 0x8082878
    s_branch main_kernel_w_dec
main_kernel_w_d_62:
    s_mov_b32 s36, 0x66013088
    s_branch main_kernel_w_dec
main_kernel_w_d_60:
    s_cmp_lt_u32 s28, 148
    s_cbranch_scc0 main_kernel_w_d_63
    s_mov_b32 s36, 0x6609308e
    s_branch main_kernel_w_dec
main_kernel_w_d_63:
    s_cmp_lt_u32 s28, 156
    s_cbranch_scc0 main_kernel_w_d_64
    s_mov_b32 s36, 0x65093094
    s_branch main_kernel_w_dec
main_kernel_w_d_64:
    s_mov_b32 s36, 0x4ac8b09c
    s_branch main_kernel_w_dec
main_kernel_w_d_59:
    s_cmp_lt_u32 s28, 208
    s_cbranch_scc0 main_kernel_w_d_65
    s_cmp_lt_u32 s28, 184
    s_cbranch_scc0 main_kernel_w_d_66
    s_mov_b32 s36, 0x89838a8
    s_branch main_kernel_w_dec
main_kernel_w_d_66:
    s_cmp_lt_u32 s28, 200
    s_cbranch_scc0 main_kernel_w_d_67
    s_mov_b32 s36, 0x88038b8
    s_branch main_kernel_w_dec
main_kernel_w_d_67:
    s_mov_b32 s36, 0x240c8
    s_branch main_kernel_w_dec
main_kernel_w_d_65:
    s_cmp_lt_u32 s28, 216
    s_cbranch_scc0 main_kernel_w_d_68
    s_mov_b32 s36, 0x840d0
    s_branch main_kernel_w_dec
main_kernel_w_d_68:
    s_cmp_lt_u32 s28, 224
    s_cbranch_scc0 main_kernel_w_d_69
    s_mov_b32 s36, 0x440d8
    s_branch main_kernel_w_dec
main_kernel_w_d_69:
    s_mov_b32 s36, 0xffffffff
    s_branch main_kernel_w_dec
main_kernel_w_q4:
    s_cmp_lg_u32 s27, 4
    s_cbranch_scc1 main_kernel_w_q5
    s_cmp_lt_u32 s28, 112
    s_cbranch_scc0 main_kernel_w_d_70
    s_cmp_lt_u32 s28, 48
    s_cbranch_scc0 main_kernel_w_d_71
    s_cmp_lt_u32 s28, 24
    s_cbranch_scc0 main_kernel_w_d_72
    s_cmp_lt_u32 s28, 8
    s_cbranch_scc0 main_kernel_w_d_73
    s_mov_b32 s36, 0x2000800
    s_branch main_kernel_w_dec
main_kernel_w_d_73:
    s_cmp_lt_u32 s28, 16
    s_cbranch_scc0 main_kernel_w_d_74
    s_mov_b32 s36, 0x2001008
    s_branch main_kernel_w_dec
main_kernel_w_d_74:
    s_mov_b32 s36, 0x46028810
    s_branch main_kernel_w_dec
main_kernel_w_d_72:
    s_cmp_lt_u32 s28, 32
    s_cbranch_scc0 main_kernel_w_d_75
    s_mov_b32 s36, 0x46029018
    s_branch main_kernel_w_dec
main_kernel_w_d_75:
    s_cmp_lt_u32 s28, 40
    s_cbranch_scc0 main_kernel_w_d_76
    s_mov_b32 s36, 0x64091020
    s_branch main_kernel_w_dec
main_kernel_w_d_76:
    s_mov_b32 s36, 0x66091028
    s_branch main_kernel_w_dec
main_kernel_w_d_71:
    s_cmp_lt_u32 s28, 72
    s_cbranch_scc0 main_kernel_w_d_77
    s_cmp_lt_u32 s28, 56
    s_cbranch_scc0 main_kernel_w_d_78
    s_mov_b32 s36, 0x67090830
    s_branch main_kernel_w_dec
main_kernel_w_d_78:
    s_cmp_lt_u32 s28, 64
    s_cbranch_scc0 main_kernel_w_d_79
    s_mov_b32 s36, 0x65090838
    s_branch main_kernel_w_dec
main_kernel_w_d_79:
    s_mov_b32 s36, 0x67090040
    s_branch main_kernel_w_dec
main_kernel_w_d_77:
    s_cmp_lt_u32 s28, 80
    s_cbranch_scc0 main_kernel_w_d_80
    s_mov_b32 s36, 0x65111048
    s_branch main_kernel_w_dec
main_kernel_w_d_80:
    s_cmp_lt_u32 s28, 96
    s_cbranch_scc0 main_kernel_w_d_81
    s_mov_b32 s36, 0x48108050
    s_branch main_kernel_w_dec
main_kernel_w_d_81:
    s_mov_b32 s36, 0x8182860
    s_branch main_kernel_w_dec
main_kernel_w_d_70:
    s_cmp_lt_u32 s28, 172
    s_cbranch_scc0 main_kernel_w_d_82
    s_cmp_lt_u32 s28, 144
    s_cbranch_scc0 main_kernel_w_d_83
    s_cmp_lt_u32 s28, 120
    s_cbranch_scc0 main_kernel_w_d_84
    s_mov_b32 s36, 0x65013070
    s_branch main_kernel_w_dec
main_kernel_w_d_84:
    s_cmp_lt_u32 s28, 136
    s_cbranch_scc0 main_kernel_w_d_85
    s_mov_b32 s36, 0x48188878
    s_branch main_kernel_w_dec
main_kernel_w_d_85:
    s_mov_b32 s36, 0x64193088
    s_branch main_kernel_w_dec
main_kernel_w_d_83:
    s_cmp_lt_u32 s28, 156
    s_cbranch_scc0 main_kernel_w_d_86
    s_mov_b32 s36, 0x4a18b090
    s_branch main_kernel_w_dec
main_kernel_w_d_86:
    s_cmp_lt_u32 s28, 164
    s_cbranch_scc0 main_kernel_w_d_87
    s_mov_b32 s36, 0x6419109c
    s_branch main_kernel_w_dec
main_kernel_w_d_87:
    s_mov_b32 s36, 0x651900a4
    s_branch main_kernel_w_dec
main_kernel_w_d_82:
    s_cmp_lt_u32 s28, 204
    s_cbranch_scc0 main_kernel_w_d_88
    s_cmp_lt_u32 s28, 188
    s_cbranch_scc0 main_kernel_w_d_89
    s_mov_b32 s36, 0x80038ac
    s_branch main_kernel_w_dec
main_kernel_w_d_89:
    s_cmp_lt_u32 s28, 196
    s_cbranch_scc0 main_kernel_w_d_90
    s_mov_b32 s36, 0x640bc
    s_branch main_kernel_w_dec
main_kernel_w_d_90:
    s_mov_b32 s36, 0xa40c4
    s_branch main_kernel_w_dec
main_kernel_w_d_88:
    s_cmp_lt_u32 s28, 212
    s_cbranch_scc0 main_kernel_w_d_91
    s_mov_b32 s36, 0xe40cc
    s_branch main_kernel_w_dec
main_kernel_w_d_91:
    s_cmp_lt_u32 s28, 220
    s_cbranch_scc0 main_kernel_w_d_92
    s_mov_b32 s36, 0x1040d4
    s_branch main_kernel_w_dec
main_kernel_w_d_92:
    s_mov_b32 s36, 0xffffffff
    s_branch main_kernel_w_dec
main_kernel_w_q5:
    s_cmp_lt_u32 s28, 128
    s_cbranch_scc0 main_kernel_w_d_93
    s_cmp_lt_u32 s28, 48
    s_cbranch_scc0 main_kernel_w_d_94
    s_cmp_lt_u32 s28, 24
    s_cbranch_scc0 main_kernel_w_d_95
    s_cmp_lt_u32 s28, 8
    s_cbranch_scc0 main_kernel_w_d_96
    s_mov_b32 s36, 0x3000800
    s_branch main_kernel_w_dec
main_kernel_w_d_96:
    s_cmp_lt_u32 s28, 16
    s_cbranch_scc0 main_kernel_w_d_97
    s_mov_b32 s36, 0x3001008
    s_branch main_kernel_w_dec
main_kernel_w_d_97:
    s_mov_b32 s36, 0x47028810
    s_branch main_kernel_w_dec
main_kernel_w_d_95:
    s_cmp_lt_u32 s28, 32
    s_cbranch_scc0 main_kernel_w_d_98
    s_mov_b32 s36, 0x47029018
    s_branch main_kernel_w_dec
main_kernel_w_d_98:
    s_cmp_lt_u32 s28, 40
    s_cbranch_scc0 main_kernel_w_d_99
    s_mov_b32 s36, 0x65091020
    s_branch main_kernel_w_dec
main_kernel_w_d_99:
    s_mov_b32 s36, 0x4045028
    s_branch main_kernel_w_dec
main_kernel_w_d_94:
    s_cmp_lt_u32 s28, 72
    s_cbranch_scc0 main_kernel_w_d_100
    s_cmp_lt_u32 s28, 56
    s_cbranch_scc0 main_kernel_w_d_101
    s_mov_b32 s36, 0x42068830
    s_branch main_kernel_w_dec
main_kernel_w_d_101:
    s_cmp_lt_u32 s28, 64
    s_cbranch_scc0 main_kernel_w_d_102
    s_mov_b32 s36, 0x66110838
    s_branch main_kernel_w_dec
main_kernel_w_d_102:
    s_mov_b32 s36, 0x40069040
    s_branch main_kernel_w_dec
main_kernel_w_d_100:
    s_cmp_lt_u32 s28, 96
    s_cbranch_scc0 main_kernel_w_d_103
    s_cmp_lt_u32 s28, 80
    s_cbranch_scc0 main_kernel_w_d_104
    s_mov_b32 s36, 0x64090048
    s_branch main_kernel_w_dec
main_kernel_w_d_104:
    s_mov_b32 s36, 0x4182050
    s_branch main_kernel_w_dec
main_kernel_w_d_103:
    s_cmp_lt_u32 s28, 112
    s_cbranch_scc0 main_kernel_w_d_105
    s_mov_b32 s36, 0x8102860
    s_branch main_kernel_w_dec
main_kernel_w_d_105:
    s_mov_b32 s36, 0x4002070
    s_branch main_kernel_w_dec
main_kernel_w_d_93:
    s_cmp_lt_u32 s28, 200
    s_cbranch_scc0 main_kernel_w_d_106
    s_cmp_lt_u32 s28, 160
    s_cbranch_scc0 main_kernel_w_d_107
    s_cmp_lt_u32 s28, 144
    s_cbranch_scc0 main_kernel_w_d_108
    s_mov_b32 s36, 0x8185080
    s_branch main_kernel_w_dec
main_kernel_w_d_108:
    s_cmp_lt_u32 s28, 152
    s_cbranch_scc0 main_kernel_w_d_109
    s_mov_b32 s36, 0x65113090
    s_branch main_kernel_w_dec
main_kernel_w_d_109:
    s_mov_b32 s36, 0x65110898
    s_branch main_kernel_w_dec
main_kernel_w_d_107:
    s_cmp_lt_u32 s28, 176
    s_cbranch_scc0 main_kernel_w_d_110
    s_mov_b32 s36, 0x4a0880a0
    s_branch main_kernel_w_dec
main_kernel_w_d_110:
    s_cmp_lt_u32 s28, 184
    s_cbranch_scc0 main_kernel_w_d_111
    s_mov_b32 s36, 0x651908b0
    s_branch main_kernel_w_dec
main_kernel_w_d_111:
    s_mov_b32 s36, 0x4808b0b8
    s_branch main_kernel_w_dec
main_kernel_w_d_106:
    s_cmp_lt_u32 s28, 232
    s_cbranch_scc0 main_kernel_w_d_112
    s_cmp_lt_u32 s28, 208
    s_cbranch_scc0 main_kernel_w_d_113
    s_mov_b32 s36, 0x671908c8
    s_branch main_kernel_w_dec
main_kernel_w_d_113:
    s_cmp_lt_u32 s28, 216
    s_cbranch_scc0 main_kernel_w_d_114
    s_mov_b32 s36, 0x661910d0
    s_branch main_kernel_w_dec
main_kernel_w_d_114:
    s_mov_b32 s36, 0x81838d8
    s_branch main_kernel_w_dec
main_kernel_w_d_112:
    s_cmp_lt_u32 s28, 256
    s_cbranch_scc0 main_kernel_w_d_115
    s_cmp_lt_u32 s28, 248
    s_cbranch_scc0 main_kernel_w_d_116
    s_mov_b32 s36, 0x88838e8
    s_branch main_kernel_w_dec
main_kernel_w_d_116:
    s_mov_b32 s36, 0x40f8
    s_branch main_kernel_w_dec
main_kernel_w_d_115:
    s_cmp_lt_u32 s28, 264
    s_cbranch_scc0 main_kernel_w_d_117
    s_mov_b32 s36, 0xc4100
    s_branch main_kernel_w_dec
main_kernel_w_d_117:
    s_mov_b32 s36, 0xffffffff
    s_branch main_kernel_w_dec
main_kernel_w_dec:
    s_cmp_lg_u32 s36, -1
    s_cbranch_scc1 main_kernel_w_got
    s_add_u32 s27, s27, 1
    s_cmp_ge_u32 s27, 6
    s_cselect_b32 s27, 0, s27
    s_add_u32 s52, s52, 1
    s_lshl_b32 s32, 1, s12
    s_and_b32 s32, s32, 116
    s_cselect_b32 s36, -2, -1
    s_cbranch_scc1 main_kernel_w_pub
    s_lshl_b32 s32, s12, 5
    s_add_u32 s32, s32, s13
    s_sub_u32 s32, s32, 224
    s_cmp_lt_u32 s32, 16
    s_cselect_b32 s52, 6, s52
    s_cmp_lt_u32 s52, 6
    s_cbranch_scc1 main_kernel_w_try
    s_lshl_b32 s32, s12, 5
    s_add_u32 s32, s32, s13
    s_sub_u32 s32, s32, 160
    s_cmp_lt_u32 s32, 80
    s_cselect_b32 s36, -3, -1
    s_cmp_lt_u32 s32, 64
    s_cselect_b32 s36, -2, s36
    s_branch main_kernel_w_pub
main_kernel_w_got:
    s_and_b32 s32, s36, 0x7ff
    s_sub_u32 s28, s28, s32
    s_bfe_u32 s32, s36, 0x3001a
    s_lshr_b32 s25, s28, s32
    s_lshl_b32 s33, s25, s32
    s_sub_u32 s24, s28, s33
    s_bfe_u32 s34, s36, 0x1001d
    s_lshl_b32 s24, s24, s34
    s_bfe_u32 s35, s36, 0x1001e
    s_lshl_b32 s25, s25, s35
    s_bfe_u32 s32, s36, 0x40011
    s_add_u32 s24, s24, s32
    s_bfe_u32 s32, s36, 0x50015
    s_add_u32 s25, s25, s32
    s_bfe_u32 s23, s36, 0x4000b
    s_bfe_u32 s36, s36, 0x6000b
    s_lshl_b32 s32, s24, 8
    s_or_b32 s36, s36, s32
    s_lshl_b32 s32, s25, 16
    s_or_b32 s36, s36, s32
    s_cmp_eq_u32 s23, 8
    s_cbranch_scc1 main_kernel_w_dwo
    s_cmp_ge_u32 s23, 10
    s_cbranch_scc1 main_kernel_w_pub
    s_mov_b32 s48, s24
    s_add_u32 s49, s24, s34
    s_mov_b32 s50, 4
    s_mov_b32 s51, 7
    s_cmp_lg_u32 s23, 4
    s_cbranch_scc1 main_kernel_w_dp1
    s_sub_u32 s48, s48, 1
    s_max_i32 s48, s48, 0
    s_add_u32 s49, s49, 1
    s_min_u32 s49, s49, 15
main_kernel_w_dp1:
    s_cmp_eq_u32 s23, 6
    s_cselect_b32 s51, 3, s51
    s_cmp_eq_u32 s23, 7
    s_cselect_b32 s51, 27, s51
    s_cselect_b32 s50, 5, s50
    v_lshrrev_b32 v253, s50, v250
    v_lshlrev_b32 v254, s50, v253
    v_sub_u32 v254, v250, v254
    v_min_u32 v254, s51, v254
    v_add_u32 v253, s48, v253
    v_min_u32 v253, s49, v253
    v_lshlrev_b32 v253, 9, v253
    v_lshl_add_u32 v253, v254, 4, v253
    s_cmp_lt_u32 s23, 4
    s_cselect_b32 s39, 10, s23
    s_lshl_b32 s39, s39, 13
    s_cmp_eq_u32 s23, 3
    s_cselect_b32 s32, 4, 0
    s_add_u32 s39, s39, s32
    s_add_u32 s39, s39, 0x8402000
main_kernel_w_poll:
    buffer_load_dword v254, v253, s[4:7], s39 offen sc1
    s_waitcnt vmcnt(0)
    v_cmp_eq_u32 vcc, 0, v254
    s_cmp_eq_u32 s57, 0
    s_cbranch_scc1 main_kernel_w_fl2
    s_waitcnt vmcnt(0)
    s_barrier
    v_mov_b32 v4, 1
    v_mov_b32 v5, 1
    v_mov_b32 v6, 1
    v_mov_b32 v7, 1
    s_bfm_b64 exec, s57, 0
    buffer_store_dwordx4 v[4:7], v249, s[4:7], s56 offen sc1
    s_mov_b64 exec, -1
    s_mov_b32 s57, 0
main_kernel_w_fl2:
    s_cbranch_vccz main_kernel_w_pub
    s_sleep 8
    s_sub_u32 s29, s29, 1
    s_cbranch_scc0 main_kernel_w_poll
    s_mov_b32 s36, -1
    s_branch main_kernel_w_pub
main_kernel_w_dwo:
    s_lshl_b32 s39, s24, 10
    s_add_u32 s39, s39, 0x8400000
main_kernel_w_pollo:
    buffer_load_dwordx4 v[0:3], v251, s[4:7], s39 offen sc1
    s_waitcnt vmcnt(0)
    v_min3_u32 v0, v0, v1, v2
    v_min_u32 v0, v0, v3
    v_cmp_eq_u32 vcc, 0, v0
    s_cmp_eq_u32 s57, 0
    s_cbranch_scc1 main_kernel_w_fl3
    s_waitcnt vmcnt(0)
    s_barrier
    v_mov_b32 v4, 1
    v_mov_b32 v5, 1
    v_mov_b32 v6, 1
    v_mov_b32 v7, 1
    s_bfm_b64 exec, s57, 0
    buffer_store_dwordx4 v[4:7], v249, s[4:7], s56 offen sc1
    s_mov_b64 exec, -1
    s_mov_b32 s57, 0
main_kernel_w_fl3:
    s_cbranch_vccz main_kernel_w_pub
    s_sleep 16
    s_sub_u32 s29, s29, 1
    s_cbranch_scc0 main_kernel_w_pollo
    s_mov_b32 s36, -1
    s_branch main_kernel_w_pub
main_kernel_w_oko:
    v_min_u32 v253, s35, v250
    v_add_u32 v253, s25, v253
    v_lshlrev_b32 v253, 8, v253
    s_lshl_b32 s39, s24, 4
    s_add_u32 s39, s39, 0x8412000
    s_branch main_kernel_w_poll
main_kernel_w_pub:
    s_cmp_eq_u32 s57, 0
    s_cbranch_scc1 main_kernel_w_fl4
    s_waitcnt vmcnt(0)
    s_barrier
    v_mov_b32 v4, 1
    v_mov_b32 v5, 1
    v_mov_b32 v6, 1
    v_mov_b32 v7, 1
    s_bfm_b64 exec, s57, 0
    buffer_store_dwordx4 v[4:7], v249, s[4:7], s56 offen sc1
    s_mov_b64 exec, -1
    s_mov_b32 s57, 0
main_kernel_w_fl4:
    v_mov_b32 v253, 131072
    v_mov_b32 v254, s36
    ds_write_b32 v253, v254
    s_waitcnt lgkmcnt(0)
main_kernel_w_bar:
    s_barrier
    v_mov_b32 v253, 131072
    ds_read_b32 v254, v253
    s_waitcnt lgkmcnt(0)
    v_readfirstlane_b32 s36, v254
    s_nop 3
    s_cmp_eq_u32 s36, -1
    s_cbranch_scc1 main_kernel_end2
    s_cmp_eq_u32 s36, -2
    s_cbranch_scc1 main_kernel_wo
    s_cmp_eq_u32 s36, -3
    s_cbranch_scc1 main_kernel_att2
    s_mov_b32 s55, -1
    s_and_b32 s23, s36, 15
    s_bfe_u32 s54, s36, 0x20004
    s_bfe_u32 s24, s36, 0x80008
    s_lshr_b32 s25, s36, 16
    s_cmp_eq_u32 s23, 5
    s_cbranch_scc1 main_kernel_w_ln2
    s_cmp_eq_u32 s23, 10
    s_cbranch_scc1 main_kernel_w_fill
    s_cmp_eq_u32 s23, 11
    s_cbranch_scc1 main_kernel_w_pref
    s_cmp_eq_u32 s54, 1
    s_cbranch_scc1 main_kernel_w_c1_task
    s_cmp_eq_u32 s54, 2
    s_cbranch_scc1 main_kernel_w_c2_task
main_kernel_w_c0_task:
    s_cmp_eq_u32 s23, 1
    s_cbranch_scc1 main_kernel_w_c0_set1
    s_cmp_eq_u32 s23, 2
    s_cbranch_scc1 main_kernel_w_c0_set2
    s_cmp_eq_u32 s23, 4
    s_cbranch_scc1 main_kernel_w_c0_set4
    s_cmp_eq_u32 s23, 7
    s_cbranch_scc1 main_kernel_w_c0_set7
    s_cmp_eq_u32 s23, 8
    s_cbranch_scc1 main_kernel_w_c0_set8
    s_branch main_kernel_w_done
main_kernel_w_c0_set1:
    s_lshl_b32 s32, s25, 8
    s_add_u32 s8, s42, s32
    s_addc_u32 s9, s43, 0
    s_and_b32 s9, s9, 0xffff
    s_sub_u32 s10, 0x800000, s32
    s_mov_b32 s11, 0x20000
    s_mov_b32 s30, 8192
    s_mov_b32 s31, 32768
    s_mul_i32 s16, s24, 262144
    s_add_u32 s16, s16, 0x0
    s_mov_b32 s18, 3
    s_lshl_b32 s32, s24, 3
    s_mul_i32 s33, s38, 4
    s_add_u32 s32, s32, s33
    s_mul_i32 s32, s32, 131072
    s_lshl_b32 s33, s25, 12
    s_add_u32 s32, s32, s33
    s_mul_i32 s33, s37, 2048
    s_add_u32 s32, s32, s33
    s_add_u32 s21, s32, 0x1800000
    s_mov_b32 s22, 131072
    s_mov_b32 s26, -1
    s_branch main_kernel_w_c0_go
main_kernel_w_c0_set2:
    s_lshl_b32 s32, s25, 8
    s_add_u32 s8, s44, s32
    s_addc_u32 s9, s45, 0
    s_and_b32 s9, s9, 0xffff
    s_sub_u32 s10, 0x800000, s32
    s_mov_b32 s11, 0x20000
    s_mov_b32 s30, 8192
    s_mov_b32 s31, 32768
    s_mul_i32 s16, s24, 262144
    s_add_u32 s16, s16, 0x0
    s_mov_b32 s18, 3
    s_lshl_b32 s32, s24, 2
    s_mul_i32 s33, s38, 2
    s_add_u32 s32, s32, s33
    s_lshl_b32 s32, s32, 18
    s_lshl_b32 s33, s25, 13
    s_add_u32 s32, s32, s33
    s_mul_i32 s33, s37, 4096
    s_add_u32 s32, s32, s33
    s_add_u32 s21, s32, 0x2800000
    s_branch main_kernel_w_c0_gov
main_kernel_w_c0_set4:
    s_lshl_b32 s32, s25, 8
    s_add_u32 s8, s66, s32
    s_addc_u32 s9, s67, 0
    s_and_b32 s9, s9, 0xffff
    s_sub_u32 s10, 0x200000, s32
    s_mov_b32 s11, 0x20000
    s_mov_b32 s30, 2048
    s_mov_b32 s31, 32768
    s_mul_i32 s16, s24, 262144
    s_add_u32 s16, s16, 0x4808000
    s_mov_b32 s18, 3
    s_lshl_b32 s32, s24, 3
    s_mul_i32 s33, s38, 4
    s_add_u32 s32, s32, s33
    s_mul_i32 s32, s32, 32768
    s_lshl_b32 s33, s25, 12
    s_add_u32 s32, s32, s33
    s_mul_i32 s33, s37, 2048
    s_add_u32 s32, s32, s33
    s_add_u32 s21, s32, 0x5000000
    s_mov_b32 s22, 32768
    s_add_u32 s26, s32, 0x0
    s_branch main_kernel_w_c0_go
main_kernel_w_c0_set7:
    s_lshl_b32 s32, s25, 8
    s_add_u32 s8, s70, s32
    s_addc_u32 s9, s71, 0
    s_and_b32 s9, s9, 0xffff
    s_sub_u32 s10, 0x700000, s32
    s_mov_b32 s11, 0x20000
    s_mov_b32 s30, 2048
    s_mov_b32 s31, 114688
    s_mul_i32 s16, s24, 917504
    s_add_u32 s16, s16, 0x5400000
    s_mov_b32 s18, 13
    s_lshl_b32 s32, s24, 3
    s_mul_i32 s33, s38, 4
    s_add_u32 s32, s32, s33
    s_mul_i32 s32, s32, 32768
    s_lshl_b32 s33, s25, 12
    s_add_u32 s32, s32, s33
    s_mul_i32 s33, s37, 2048
    s_add_u32 s32, s32, s33
    s_add_u32 s21, s32, 0x6400000
    s_mov_b32 s22, 32768
    s_add_u32 s26, s32, 0x5000000
    s_branch main_kernel_w_c0_go
main_kernel_w_c0_set8:
    s_lshl_b32 s32, s25, 8
    s_add_u32 s8, s46, s32
    s_addc_u32 s9, s47, 0
    s_and_b32 s9, s9, 0xffff
    s_sub_u32 s10, 0x800000, s32
    s_mov_b32 s11, 0x20000
    s_mov_b32 s30, 2048
    s_mov_b32 s31, 131072
    s_mul_i32 s16, s24, 1048576
    s_add_u32 s16, s16, 0x3800000
    s_mov_b32 s18, 15
    s_lshl_b32 s32, s24, 3
    s_mul_i32 s33, s38, 4
    s_add_u32 s32, s32, s33
    s_mul_i32 s32, s32, 32768
    s_lshl_b32 s33, s25, 8
    s_add_u32 s34, s32, s33
    s_mul_i32 s33, s37, 128
    s_add_u32 s34, s34, s33
    s_lshl_b32 s33, s25, 12
    s_add_u32 s32, s32, s33
    s_mul_i32 s33, s37, 2048
    s_add_u32 s32, s32, s33
    s_add_u32 s21, s32, 0x0
    s_mov_b32 s22, 32768
    s_add_u32 s26, s32, 0x6400000
    s_mov_b32 s21, s34
    v_and_b32 v253, 15, v250
    v_and_b32 v254, 48, v250
    v_lshl_add_u32 v252, v253, 11, v254
    s_branch main_kernel_w_c0_go
main_kernel_w_c0_go:
    v_lshrrev_b32 v0, 4, v250
    v_bfe_u32 v1, v250, 2, 2
    v_lshl_add_u32 v4, v0, 2, v1
    v_and_b32 v5, 7, v4
    v_mul_u32_u24 v4, 256, v4
    v_and_b32 v6, 3, v250
    v_lshl_add_u32 v4, v6, 3, v4
    s_mul_i32 s32, s37, 4
    v_xor_b32 v5, s32, v5
    v_lshl_add_u32 v128, v5, 5, v4
    v_xor_b32 v129, 32, v128
    v_xor_b32 v130, 64, v128
    v_xor_b32 v131, 96, v128
    s_mul_i32 s32, s38, 8192
    s_add_u32 s32, s32, 65536
    v_add_u32 v136, s32, v251
    v_lshrrev_b32 v2, 4, v250
    v_and_b32 v3, 15, v250
    s_mul_i32 s32, s14, 16
    v_add_u32 v4, s32, v2
    v_add_u32 v5, 0, v4
    v_and_b32 v6, 7, v5
    v_lshlrev_b32 v6, 1, v6
    v_xor_b32 v6, v6, v3
    v_mul_lo_u32 v5, v5, s30
    v_lshl_add_u32 v5, v6, 4, v5
    v_subrev_u32 v137, 0, v5
    v_add_u32 v5, 4, v4
    v_and_b32 v6, 7, v5
    v_lshlrev_b32 v6, 1, v6
    v_xor_b32 v6, v6, v3
    v_mul_lo_u32 v5, v5, s30
    v_lshl_add_u32 v5, v6, 4, v5
    v_subrev_u32 v138, 1024, v5
    v_add_u32 v5, 8, v4
    v_and_b32 v6, 7, v5
    v_lshlrev_b32 v6, 1, v6
    v_xor_b32 v6, v6, v3
    v_mul_lo_u32 v5, v5, s30
    v_lshl_add_u32 v5, v6, 4, v5
    v_subrev_u32 v139, 2048, v5
    v_add_u32 v5, 12, v4
    v_and_b32 v6, 7, v5
    v_lshlrev_b32 v6, 1, v6
    v_xor_b32 v6, v6, v3
    v_mul_lo_u32 v5, v5, s30
    v_lshl_add_u32 v5, v6, 4, v5
    v_subrev_u32 v140, 3072, v5
    s_mul_i32 s32, s14, 2
    s_mul_i32 s32, s32, s31
    v_add_u32 v141, s32, v251
    s_add_u32 s32, s32, s31
    s_sub_u32 s32, s32, 2048
    v_add_u32 v142, s32, v251
    s_mul_i32 s19, s14, 4096
    s_mul_i32 s20, s14, 4096
    s_add_u32 s20, s20, 65536
    s_mul_i32 s17, s30, 64
    s_mov_b32 s15, 0
    s_add_u32 m0, s20, 0
    s_nop 0
    buffer_load_dwordx4 v141, s[4:7], s16 offen offset:0 sc1 lds
    buffer_load_dwordx4 v141, s[4:7], s16 offen offset:1024 sc1 lds
    buffer_load_dwordx4 v142, s[4:7], s16 offen offset:2048 sc1 lds
    buffer_load_dwordx4 v142, s[4:7], s16 offen offset:3072 sc1 lds
    s_add_u32 s16, s16, 2048
    s_add_u32 m0, s19, 0
    s_nop 0
    buffer_load_dwordx4 v137, s[8:11], s15 offen offset:0 lds
    buffer_load_dwordx4 v138, s[8:11], s15 offen offset:1024 lds
    buffer_load_dwordx4 v139, s[8:11], s15 offen offset:2048 lds
    buffer_load_dwordx4 v140, s[8:11], s15 offen offset:3072 lds
    s_add_u32 s15, s15, s17
    s_add_u32 m0, s20, 16384
    s_nop 0
    buffer_load_dwordx4 v141, s[4:7], s16 offen offset:0 sc1 lds
    buffer_load_dwordx4 v141, s[4:7], s16 offen offset:1024 sc1 lds
    buffer_load_dwordx4 v142, s[4:7], s16 offen offset:2048 sc1 lds
    buffer_load_dwordx4 v142, s[4:7], s16 offen offset:3072 sc1 lds
    s_add_u32 s16, s16, 2048
    s_add_u32 m0, s19, 16384
    s_nop 0
    buffer_load_dwordx4 v137, s[8:11], s15 offen offset:0 lds
    buffer_load_dwordx4 v138, s[8:11], s15 offen offset:1024 lds
    buffer_load_dwordx4 v139, s[8:11], s15 offen offset:2048 lds
    buffer_load_dwordx4 v140, s[8:11], s15 offen offset:3072 lds
    s_add_u32 s15, s15, s17
    s_add_u32 m0, s20, 32768
    s_nop 0
    buffer_load_dwordx4 v141, s[4:7], s16 offen offset:0 sc1 lds
    buffer_load_dwordx4 v141, s[4:7], s16 offen offset:1024 sc1 lds
    buffer_load_dwordx4 v142, s[4:7], s16 offen offset:2048 sc1 lds
    buffer_load_dwordx4 v142, s[4:7], s16 offen offset:3072 sc1 lds
    s_add_u32 s16, s16, 2048
    s_add_u32 m0, s19, 32768
    s_nop 0
    buffer_load_dwordx4 v137, s[8:11], s15 offen offset:0 lds
    buffer_load_dwordx4 v138, s[8:11], s15 offen offset:1024 lds
    buffer_load_dwordx4 v139, s[8:11], s15 offen offset:2048 lds
    buffer_load_dwordx4 v140, s[8:11], s15 offen offset:3072 lds
    s_add_u32 s15, s15, s17
    s_add_u32 m0, s20, 49152
    s_nop 0
    buffer_load_dwordx4 v141, s[4:7], s16 offen offset:0 sc1 lds
    buffer_load_dwordx4 v141, s[4:7], s16 offen offset:1024 sc1 lds
    buffer_load_dwordx4 v142, s[4:7], s16 offen offset:2048 sc1 lds
    buffer_load_dwordx4 v142, s[4:7], s16 offen offset:3072 sc1 lds
    s_add_u32 s16, s16, 2048
    v_mov_b32 v64, 0
    v_mov_b32 v65, 0
    v_mov_b32 v66, 0
    v_mov_b32 v67, 0
    v_mov_b32 v68, 0
    v_mov_b32 v69, 0
    v_mov_b32 v70, 0
    v_mov_b32 v71, 0
    v_mov_b32 v72, 0
    v_mov_b32 v73, 0
    v_mov_b32 v74, 0
    v_mov_b32 v75, 0
    v_mov_b32 v76, 0
    v_mov_b32 v77, 0
    v_mov_b32 v78, 0
    v_mov_b32 v79, 0
    v_mov_b32 v80, 0
    v_mov_b32 v81, 0
    v_mov_b32 v82, 0
    v_mov_b32 v83, 0
    v_mov_b32 v84, 0
    v_mov_b32 v85, 0
    v_mov_b32 v86, 0
    v_mov_b32 v87, 0
    v_mov_b32 v88, 0
    v_mov_b32 v89, 0
    v_mov_b32 v90, 0
    v_mov_b32 v91, 0
    v_mov_b32 v92, 0
    v_mov_b32 v93, 0
    v_mov_b32 v94, 0
    v_mov_b32 v95, 0
    v_mov_b32 v96, 0
    v_mov_b32 v97, 0
    v_mov_b32 v98, 0
    v_mov_b32 v99, 0
    v_mov_b32 v100, 0
    v_mov_b32 v101, 0
    v_mov_b32 v102, 0
    v_mov_b32 v103, 0
    v_mov_b32 v104, 0
    v_mov_b32 v105, 0
    v_mov_b32 v106, 0
    v_mov_b32 v107, 0
    v_mov_b32 v108, 0
    v_mov_b32 v109, 0
    v_mov_b32 v110, 0
    v_mov_b32 v111, 0
    v_mov_b32 v112, 0
    v_mov_b32 v113, 0
    v_mov_b32 v114, 0
    v_mov_b32 v115, 0
    v_mov_b32 v116, 0
    v_mov_b32 v117, 0
    v_mov_b32 v118, 0
    v_mov_b32 v119, 0
    v_mov_b32 v120, 0
    v_mov_b32 v121, 0
    v_mov_b32 v122, 0
    v_mov_b32 v123, 0
    v_mov_b32 v124, 0
    v_mov_b32 v125, 0
    v_mov_b32 v126, 0
    v_mov_b32 v127, 0
    s_waitcnt vmcnt(20)
    s_barrier
    ds_read_b128 v[16:19], v136 offset:0
    ds_read_b64_tr_b16 v[0:1], v128 offset:0
    ds_read_b64_tr_b16 v[2:3], v128 offset:4096
    ds_read_b64_tr_b16 v[4:5], v129 offset:0
    ds_read_b64_tr_b16 v[6:7], v129 offset:4096
    ds_read_b64_tr_b16 v[8:9], v130 offset:0
    ds_read_b64_tr_b16 v[10:11], v130 offset:4096
    ds_read_b64_tr_b16 v[12:13], v131 offset:0
    ds_read_b64_tr_b16 v[14:15], v131 offset:4096
    ds_read_b128 v[20:23], v136 offset:2048
    ds_read_b128 v[24:27], v136 offset:4096
    ds_read_b128 v[28:31], v136 offset:6144
main_kernel_w_c0_n_loop:
    s_waitcnt lgkmcnt(0)
    ds_read_b128 v[48:51], v136 offset:1024
    s_add_u32 m0, s19, 49152
    s_nop 0
    v_mfma_f32_16x16x32_bf16 v[64:67], v[0:3], v[16:19], v[64:67]
    ds_read_b64_tr_b16 v[32:33], v128 offset:8192
    v_mfma_f32_16x16x32_bf16 v[68:71], v[4:7], v[16:19], v[68:71]
    ds_read_b64_tr_b16 v[34:35], v128 offset:12288
    buffer_load_dwordx4 v137, s[8:11], s15 offen offset:0 lds
    v_mfma_f32_16x16x32_bf16 v[72:75], v[8:11], v[16:19], v[72:75]
    ds_read_b64_tr_b16 v[36:37], v129 offset:8192
    v_mfma_f32_16x16x32_bf16 v[76:79], v[12:15], v[16:19], v[76:79]
    ds_read_b64_tr_b16 v[38:39], v129 offset:12288
    v_mfma_f32_16x16x32_bf16 v[80:83], v[0:3], v[20:23], v[80:83]
    ds_read_b64_tr_b16 v[40:41], v130 offset:8192
    buffer_load_dwordx4 v138, s[8:11], s15 offen offset:1024 lds
    v_mfma_f32_16x16x32_bf16 v[84:87], v[4:7], v[20:23], v[84:87]
    ds_read_b64_tr_b16 v[42:43], v130 offset:12288
    v_mfma_f32_16x16x32_bf16 v[88:91], v[8:11], v[20:23], v[88:91]
    ds_read_b64_tr_b16 v[44:45], v131 offset:8192
    v_mfma_f32_16x16x32_bf16 v[92:95], v[12:15], v[20:23], v[92:95]
    ds_read_b64_tr_b16 v[46:47], v131 offset:12288
    buffer_load_dwordx4 v139, s[8:11], s15 offen offset:2048 lds
    v_mfma_f32_16x16x32_bf16 v[96:99], v[0:3], v[24:27], v[96:99]
    ds_read_b128 v[52:55], v136 offset:3072
    v_mfma_f32_16x16x32_bf16 v[100:103], v[4:7], v[24:27], v[100:103]
    ds_read_b128 v[56:59], v136 offset:5120
    buffer_load_dwordx4 v140, s[8:11], s15 offen offset:3072 lds
    v_mfma_f32_16x16x32_bf16 v[104:107], v[8:11], v[24:27], v[104:107]
    ds_read_b128 v[60:63], v136 offset:7168
    v_mfma_f32_16x16x32_bf16 v[108:111], v[12:15], v[24:27], v[108:111]
    v_mfma_f32_16x16x32_bf16 v[112:115], v[0:3], v[28:31], v[112:115]
    s_add_u32 s15, s15, s17
    v_mfma_f32_16x16x32_bf16 v[116:119], v[4:7], v[28:31], v[116:119]
    v_mfma_f32_16x16x32_bf16 v[120:123], v[8:11], v[28:31], v[120:123]
    v_mfma_f32_16x16x32_bf16 v[124:127], v[12:15], v[28:31], v[124:127]
    s_waitcnt lgkmcnt(0)
    v_mfma_f32_16x16x32_bf16 v[64:67], v[32:35], v[48:51], v[64:67]
    s_waitcnt vmcnt(16)
    s_barrier
    ds_read_b128 v[16:19], v136 offset:16384
    s_add_u32 m0, s20, 0
    s_nop 0
    v_mfma_f32_16x16x32_bf16 v[68:71], v[36:39], v[48:51], v[68:71]
    ds_read_b64_tr_b16 v[0:1], v128 offset:16384
    v_mfma_f32_16x16x32_bf16 v[72:75], v[40:43], v[48:51], v[72:75]
    ds_read_b64_tr_b16 v[2:3], v128 offset:20480
    buffer_load_dwordx4 v141, s[4:7], s16 offen offset:0 sc1 lds
    v_mfma_f32_16x16x32_bf16 v[76:79], v[44:47], v[48:51], v[76:79]
    ds_read_b64_tr_b16 v[4:5], v129 offset:16384
    v_mfma_f32_16x16x32_bf16 v[80:83], v[32:35], v[52:55], v[80:83]
    ds_read_b64_tr_b16 v[6:7], v129 offset:20480
    v_mfma_f32_16x16x32_bf16 v[84:87], v[36:39], v[52:55], v[84:87]
    ds_read_b64_tr_b16 v[8:9], v130 offset:16384
    buffer_load_dwordx4 v141, s[4:7], s16 offen offset:1024 sc1 lds
    v_mfma_f32_16x16x32_bf16 v[88:91], v[40:43], v[52:55], v[88:91]
    ds_read_b64_tr_b16 v[10:11], v130 offset:20480
    v_mfma_f32_16x16x32_bf16 v[92:95], v[44:47], v[52:55], v[92:95]
    ds_read_b64_tr_b16 v[12:13], v131 offset:16384
    buffer_load_dwordx4 v142, s[4:7], s16 offen offset:2048 sc1 lds
    v_mfma_f32_16x16x32_bf16 v[96:99], v[32:35], v[56:59], v[96:99]
    ds_read_b64_tr_b16 v[14:15], v131 offset:20480
    v_mfma_f32_16x16x32_bf16 v[100:103], v[36:39], v[56:59], v[100:103]
    ds_read_b128 v[20:23], v136 offset:18432
    v_mfma_f32_16x16x32_bf16 v[104:107], v[40:43], v[56:59], v[104:107]
    ds_read_b128 v[24:27], v136 offset:20480
    buffer_load_dwordx4 v142, s[4:7], s16 offen offset:3072 sc1 lds
    v_mfma_f32_16x16x32_bf16 v[108:111], v[44:47], v[56:59], v[108:111]
    ds_read_b128 v[28:31], v136 offset:22528
    v_mfma_f32_16x16x32_bf16 v[112:115], v[32:35], v[60:63], v[112:115]
    s_add_u32 s16, s16, 2048
    v_mfma_f32_16x16x32_bf16 v[116:119], v[36:39], v[60:63], v[116:119]
    v_mfma_f32_16x16x32_bf16 v[120:123], v[40:43], v[60:63], v[120:123]
    v_mfma_f32_16x16x32_bf16 v[124:127], v[44:47], v[60:63], v[124:127]
    s_waitcnt lgkmcnt(0)
    ds_read_b128 v[48:51], v136 offset:17408
    s_add_u32 m0, s19, 0
    s_nop 0
    v_mfma_f32_16x16x32_bf16 v[64:67], v[0:3], v[16:19], v[64:67]
    ds_read_b64_tr_b16 v[32:33], v128 offset:24576
    v_mfma_f32_16x16x32_bf16 v[68:71], v[4:7], v[16:19], v[68:71]
    ds_read_b64_tr_b16 v[34:35], v128 offset:28672
    buffer_load_dwordx4 v137, s[8:11], s15 offen offset:0 lds
    v_mfma_f32_16x16x32_bf16 v[72:75], v[8:11], v[16:19], v[72:75]
    ds_read_b64_tr_b16 v[36:37], v129 offset:24576
    v_mfma_f32_16x16x32_bf16 v[76:79], v[12:15], v[16:19], v[76:79]
    ds_read_b64_tr_b16 v[38:39], v129 offset:28672
    v_mfma_f32_16x16x32_bf16 v[80:83], v[0:3], v[20:23], v[80:83]
    ds_read_b64_tr_b16 v[40:41], v130 offset:24576
    buffer_load_dwordx4 v138, s[8:11], s15 offen offset:1024 lds
    v_mfma_f32_16x16x32_bf16 v[84:87], v[4:7], v[20:23], v[84:87]
    ds_read_b64_tr_b16 v[42:43], v130 offset:28672
    v_mfma_f32_16x16x32_bf16 v[88:91], v[8:11], v[20:23], v[88:91]
    ds_read_b64_tr_b16 v[44:45], v131 offset:24576
    v_mfma_f32_16x16x32_bf16 v[92:95], v[12:15], v[20:23], v[92:95]
    ds_read_b64_tr_b16 v[46:47], v131 offset:28672
    buffer_load_dwordx4 v139, s[8:11], s15 offen offset:2048 lds
    v_mfma_f32_16x16x32_bf16 v[96:99], v[0:3], v[24:27], v[96:99]
    ds_read_b128 v[52:55], v136 offset:19456
    v_mfma_f32_16x16x32_bf16 v[100:103], v[4:7], v[24:27], v[100:103]
    ds_read_b128 v[56:59], v136 offset:21504
    buffer_load_dwordx4 v140, s[8:11], s15 offen offset:3072 lds
    v_mfma_f32_16x16x32_bf16 v[104:107], v[8:11], v[24:27], v[104:107]
    ds_read_b128 v[60:63], v136 offset:23552
    v_mfma_f32_16x16x32_bf16 v[108:111], v[12:15], v[24:27], v[108:111]
    v_mfma_f32_16x16x32_bf16 v[112:115], v[0:3], v[28:31], v[112:115]
    s_add_u32 s15, s15, s17
    v_mfma_f32_16x16x32_bf16 v[116:119], v[4:7], v[28:31], v[116:119]
    v_mfma_f32_16x16x32_bf16 v[120:123], v[8:11], v[28:31], v[120:123]
    v_mfma_f32_16x16x32_bf16 v[124:127], v[12:15], v[28:31], v[124:127]
    s_waitcnt lgkmcnt(0)
    v_mfma_f32_16x16x32_bf16 v[64:67], v[32:35], v[48:51], v[64:67]
    s_waitcnt vmcnt(16)
    s_barrier
    ds_read_b128 v[16:19], v136 offset:32768
    s_add_u32 m0, s20, 16384
    s_nop 0
    v_mfma_f32_16x16x32_bf16 v[68:71], v[36:39], v[48:51], v[68:71]
    ds_read_b64_tr_b16 v[0:1], v128 offset:32768
    v_mfma_f32_16x16x32_bf16 v[72:75], v[40:43], v[48:51], v[72:75]
    ds_read_b64_tr_b16 v[2:3], v128 offset:36864
    buffer_load_dwordx4 v141, s[4:7], s16 offen offset:0 sc1 lds
    v_mfma_f32_16x16x32_bf16 v[76:79], v[44:47], v[48:51], v[76:79]
    ds_read_b64_tr_b16 v[4:5], v129 offset:32768
    v_mfma_f32_16x16x32_bf16 v[80:83], v[32:35], v[52:55], v[80:83]
    ds_read_b64_tr_b16 v[6:7], v129 offset:36864
    v_mfma_f32_16x16x32_bf16 v[84:87], v[36:39], v[52:55], v[84:87]
    ds_read_b64_tr_b16 v[8:9], v130 offset:32768
    buffer_load_dwordx4 v141, s[4:7], s16 offen offset:1024 sc1 lds
    v_mfma_f32_16x16x32_bf16 v[88:91], v[40:43], v[52:55], v[88:91]
    ds_read_b64_tr_b16 v[10:11], v130 offset:36864
    v_mfma_f32_16x16x32_bf16 v[92:95], v[44:47], v[52:55], v[92:95]
    ds_read_b64_tr_b16 v[12:13], v131 offset:32768
    buffer_load_dwordx4 v142, s[4:7], s16 offen offset:2048 sc1 lds
    v_mfma_f32_16x16x32_bf16 v[96:99], v[32:35], v[56:59], v[96:99]
    ds_read_b64_tr_b16 v[14:15], v131 offset:36864
    v_mfma_f32_16x16x32_bf16 v[100:103], v[36:39], v[56:59], v[100:103]
    ds_read_b128 v[20:23], v136 offset:34816
    v_mfma_f32_16x16x32_bf16 v[104:107], v[40:43], v[56:59], v[104:107]
    ds_read_b128 v[24:27], v136 offset:36864
    buffer_load_dwordx4 v142, s[4:7], s16 offen offset:3072 sc1 lds
    v_mfma_f32_16x16x32_bf16 v[108:111], v[44:47], v[56:59], v[108:111]
    ds_read_b128 v[28:31], v136 offset:38912
    v_mfma_f32_16x16x32_bf16 v[112:115], v[32:35], v[60:63], v[112:115]
    s_add_u32 s16, s16, 2048
    v_mfma_f32_16x16x32_bf16 v[116:119], v[36:39], v[60:63], v[116:119]
    v_mfma_f32_16x16x32_bf16 v[120:123], v[40:43], v[60:63], v[120:123]
    v_mfma_f32_16x16x32_bf16 v[124:127], v[44:47], v[60:63], v[124:127]
    s_waitcnt lgkmcnt(0)
    ds_read_b128 v[48:51], v136 offset:33792
    s_add_u32 m0, s19, 16384
    s_nop 0
    v_mfma_f32_16x16x32_bf16 v[64:67], v[0:3], v[16:19], v[64:67]
    ds_read_b64_tr_b16 v[32:33], v128 offset:40960
    v_mfma_f32_16x16x32_bf16 v[68:71], v[4:7], v[16:19], v[68:71]
    ds_read_b64_tr_b16 v[34:35], v128 offset:45056
    buffer_load_dwordx4 v137, s[8:11], s15 offen offset:0 lds
    v_mfma_f32_16x16x32_bf16 v[72:75], v[8:11], v[16:19], v[72:75]
    ds_read_b64_tr_b16 v[36:37], v129 offset:40960
    v_mfma_f32_16x16x32_bf16 v[76:79], v[12:15], v[16:19], v[76:79]
    ds_read_b64_tr_b16 v[38:39], v129 offset:45056
    v_mfma_f32_16x16x32_bf16 v[80:83], v[0:3], v[20:23], v[80:83]
    ds_read_b64_tr_b16 v[40:41], v130 offset:40960
    buffer_load_dwordx4 v138, s[8:11], s15 offen offset:1024 lds
    v_mfma_f32_16x16x32_bf16 v[84:87], v[4:7], v[20:23], v[84:87]
    ds_read_b64_tr_b16 v[42:43], v130 offset:45056
    v_mfma_f32_16x16x32_bf16 v[88:91], v[8:11], v[20:23], v[88:91]
    ds_read_b64_tr_b16 v[44:45], v131 offset:40960
    v_mfma_f32_16x16x32_bf16 v[92:95], v[12:15], v[20:23], v[92:95]
    ds_read_b64_tr_b16 v[46:47], v131 offset:45056
    buffer_load_dwordx4 v139, s[8:11], s15 offen offset:2048 lds
    v_mfma_f32_16x16x32_bf16 v[96:99], v[0:3], v[24:27], v[96:99]
    ds_read_b128 v[52:55], v136 offset:35840
    v_mfma_f32_16x16x32_bf16 v[100:103], v[4:7], v[24:27], v[100:103]
    ds_read_b128 v[56:59], v136 offset:37888
    buffer_load_dwordx4 v140, s[8:11], s15 offen offset:3072 lds
    v_mfma_f32_16x16x32_bf16 v[104:107], v[8:11], v[24:27], v[104:107]
    ds_read_b128 v[60:63], v136 offset:39936
    v_mfma_f32_16x16x32_bf16 v[108:111], v[12:15], v[24:27], v[108:111]
    v_mfma_f32_16x16x32_bf16 v[112:115], v[0:3], v[28:31], v[112:115]
    s_add_u32 s15, s15, s17
    v_mfma_f32_16x16x32_bf16 v[116:119], v[4:7], v[28:31], v[116:119]
    v_mfma_f32_16x16x32_bf16 v[120:123], v[8:11], v[28:31], v[120:123]
    v_mfma_f32_16x16x32_bf16 v[124:127], v[12:15], v[28:31], v[124:127]
    s_waitcnt lgkmcnt(0)
    v_mfma_f32_16x16x32_bf16 v[64:67], v[32:35], v[48:51], v[64:67]
    s_waitcnt vmcnt(16)
    s_barrier
    ds_read_b128 v[16:19], v136 offset:49152
    s_add_u32 m0, s20, 32768
    s_nop 0
    v_mfma_f32_16x16x32_bf16 v[68:71], v[36:39], v[48:51], v[68:71]
    ds_read_b64_tr_b16 v[0:1], v128 offset:49152
    v_mfma_f32_16x16x32_bf16 v[72:75], v[40:43], v[48:51], v[72:75]
    ds_read_b64_tr_b16 v[2:3], v128 offset:53248
    buffer_load_dwordx4 v141, s[4:7], s16 offen offset:0 sc1 lds
    v_mfma_f32_16x16x32_bf16 v[76:79], v[44:47], v[48:51], v[76:79]
    ds_read_b64_tr_b16 v[4:5], v129 offset:49152
    v_mfma_f32_16x16x32_bf16 v[80:83], v[32:35], v[52:55], v[80:83]
    ds_read_b64_tr_b16 v[6:7], v129 offset:53248
    v_mfma_f32_16x16x32_bf16 v[84:87], v[36:39], v[52:55], v[84:87]
    ds_read_b64_tr_b16 v[8:9], v130 offset:49152
    buffer_load_dwordx4 v141, s[4:7], s16 offen offset:1024 sc1 lds
    v_mfma_f32_16x16x32_bf16 v[88:91], v[40:43], v[52:55], v[88:91]
    ds_read_b64_tr_b16 v[10:11], v130 offset:53248
    v_mfma_f32_16x16x32_bf16 v[92:95], v[44:47], v[52:55], v[92:95]
    ds_read_b64_tr_b16 v[12:13], v131 offset:49152
    buffer_load_dwordx4 v142, s[4:7], s16 offen offset:2048 sc1 lds
    v_mfma_f32_16x16x32_bf16 v[96:99], v[32:35], v[56:59], v[96:99]
    ds_read_b64_tr_b16 v[14:15], v131 offset:53248
    v_mfma_f32_16x16x32_bf16 v[100:103], v[36:39], v[56:59], v[100:103]
    ds_read_b128 v[20:23], v136 offset:51200
    v_mfma_f32_16x16x32_bf16 v[104:107], v[40:43], v[56:59], v[104:107]
    ds_read_b128 v[24:27], v136 offset:53248
    buffer_load_dwordx4 v142, s[4:7], s16 offen offset:3072 sc1 lds
    v_mfma_f32_16x16x32_bf16 v[108:111], v[44:47], v[56:59], v[108:111]
    ds_read_b128 v[28:31], v136 offset:55296
    v_mfma_f32_16x16x32_bf16 v[112:115], v[32:35], v[60:63], v[112:115]
    s_add_u32 s16, s16, 2048
    v_mfma_f32_16x16x32_bf16 v[116:119], v[36:39], v[60:63], v[116:119]
    v_mfma_f32_16x16x32_bf16 v[120:123], v[40:43], v[60:63], v[120:123]
    v_mfma_f32_16x16x32_bf16 v[124:127], v[44:47], v[60:63], v[124:127]
    s_waitcnt lgkmcnt(0)
    ds_read_b128 v[48:51], v136 offset:50176
    s_add_u32 m0, s19, 32768
    s_nop 0
    v_mfma_f32_16x16x32_bf16 v[64:67], v[0:3], v[16:19], v[64:67]
    ds_read_b64_tr_b16 v[32:33], v128 offset:57344
    v_mfma_f32_16x16x32_bf16 v[68:71], v[4:7], v[16:19], v[68:71]
    ds_read_b64_tr_b16 v[34:35], v128 offset:61440
    buffer_load_dwordx4 v137, s[8:11], s15 offen offset:0 lds
    v_mfma_f32_16x16x32_bf16 v[72:75], v[8:11], v[16:19], v[72:75]
    ds_read_b64_tr_b16 v[36:37], v129 offset:57344
    v_mfma_f32_16x16x32_bf16 v[76:79], v[12:15], v[16:19], v[76:79]
    ds_read_b64_tr_b16 v[38:39], v129 offset:61440
    v_mfma_f32_16x16x32_bf16 v[80:83], v[0:3], v[20:23], v[80:83]
    ds_read_b64_tr_b16 v[40:41], v130 offset:57344
    buffer_load_dwordx4 v138, s[8:11], s15 offen offset:1024 lds
    v_mfma_f32_16x16x32_bf16 v[84:87], v[4:7], v[20:23], v[84:87]
    ds_read_b64_tr_b16 v[42:43], v130 offset:61440
    v_mfma_f32_16x16x32_bf16 v[88:91], v[8:11], v[20:23], v[88:91]
    ds_read_b64_tr_b16 v[44:45], v131 offset:57344
    v_mfma_f32_16x16x32_bf16 v[92:95], v[12:15], v[20:23], v[92:95]
    ds_read_b64_tr_b16 v[46:47], v131 offset:61440
    buffer_load_dwordx4 v139, s[8:11], s15 offen offset:2048 lds
    v_mfma_f32_16x16x32_bf16 v[96:99], v[0:3], v[24:27], v[96:99]
    ds_read_b128 v[52:55], v136 offset:52224
    v_mfma_f32_16x16x32_bf16 v[100:103], v[4:7], v[24:27], v[100:103]
    ds_read_b128 v[56:59], v136 offset:54272
    buffer_load_dwordx4 v140, s[8:11], s15 offen offset:3072 lds
    v_mfma_f32_16x16x32_bf16 v[104:107], v[8:11], v[24:27], v[104:107]
    ds_read_b128 v[60:63], v136 offset:56320
    v_mfma_f32_16x16x32_bf16 v[108:111], v[12:15], v[24:27], v[108:111]
    v_mfma_f32_16x16x32_bf16 v[112:115], v[0:3], v[28:31], v[112:115]
    s_add_u32 s15, s15, s17
    v_mfma_f32_16x16x32_bf16 v[116:119], v[4:7], v[28:31], v[116:119]
    v_mfma_f32_16x16x32_bf16 v[120:123], v[8:11], v[28:31], v[120:123]
    v_mfma_f32_16x16x32_bf16 v[124:127], v[12:15], v[28:31], v[124:127]
    s_waitcnt lgkmcnt(0)
    v_mfma_f32_16x16x32_bf16 v[64:67], v[32:35], v[48:51], v[64:67]
    s_waitcnt vmcnt(16)
    s_barrier
    ds_read_b128 v[16:19], v136 offset:0
    s_add_u32 m0, s20, 49152
    s_nop 0
    v_mfma_f32_16x16x32_bf16 v[68:71], v[36:39], v[48:51], v[68:71]
    ds_read_b64_tr_b16 v[0:1], v128 offset:0
    v_mfma_f32_16x16x32_bf16 v[72:75], v[40:43], v[48:51], v[72:75]
    ds_read_b64_tr_b16 v[2:3], v128 offset:4096
    buffer_load_dwordx4 v141, s[4:7], s16 offen offset:0 sc1 lds
    v_mfma_f32_16x16x32_bf16 v[76:79], v[44:47], v[48:51], v[76:79]
    ds_read_b64_tr_b16 v[4:5], v129 offset:0
    v_mfma_f32_16x16x32_bf16 v[80:83], v[32:35], v[52:55], v[80:83]
    ds_read_b64_tr_b16 v[6:7], v129 offset:4096
    v_mfma_f32_16x16x32_bf16 v[84:87], v[36:39], v[52:55], v[84:87]
    ds_read_b64_tr_b16 v[8:9], v130 offset:0
    buffer_load_dwordx4 v141, s[4:7], s16 offen offset:1024 sc1 lds
    v_mfma_f32_16x16x32_bf16 v[88:91], v[40:43], v[52:55], v[88:91]
    ds_read_b64_tr_b16 v[10:11], v130 offset:4096
    v_mfma_f32_16x16x32_bf16 v[92:95], v[44:47], v[52:55], v[92:95]
    ds_read_b64_tr_b16 v[12:13], v131 offset:0
    buffer_load_dwordx4 v142, s[4:7], s16 offen offset:2048 sc1 lds
    v_mfma_f32_16x16x32_bf16 v[96:99], v[32:35], v[56:59], v[96:99]
    ds_read_b64_tr_b16 v[14:15], v131 offset:4096
    v_mfma_f32_16x16x32_bf16 v[100:103], v[36:39], v[56:59], v[100:103]
    ds_read_b128 v[20:23], v136 offset:2048
    v_mfma_f32_16x16x32_bf16 v[104:107], v[40:43], v[56:59], v[104:107]
    ds_read_b128 v[24:27], v136 offset:4096
    buffer_load_dwordx4 v142, s[4:7], s16 offen offset:3072 sc1 lds
    v_mfma_f32_16x16x32_bf16 v[108:111], v[44:47], v[56:59], v[108:111]
    ds_read_b128 v[28:31], v136 offset:6144
    v_mfma_f32_16x16x32_bf16 v[112:115], v[32:35], v[60:63], v[112:115]
    s_add_u32 s16, s16, 2048
    v_mfma_f32_16x16x32_bf16 v[116:119], v[36:39], v[60:63], v[116:119]
    v_mfma_f32_16x16x32_bf16 v[120:123], v[40:43], v[60:63], v[120:123]
    v_mfma_f32_16x16x32_bf16 v[124:127], v[44:47], v[60:63], v[124:127]
    s_sub_u32 s18, s18, 1
    s_cmp_lg_u32 s18, 0
    s_cbranch_scc1 main_kernel_w_c0_n_loop
    s_cmp_lg_u32 s14, 0
    s_cbranch_scc1 main_kernel_w_c0_n_nt
    s_lshl_b32 s32, s27, 8
    s_add_u32 s32, s32, 0x841e000
    v_mov_b32 v255, 1
    s_mov_b64 exec, 1
    buffer_atomic_add v255, off, s[4:7], s32 sc0 sc1
    s_mov_b64 exec, -1
main_kernel_w_c0_n_nt:
    s_cmp_lg_u32 s23, 8
    s_cbranch_scc1 main_kernel_w_c0_nlw
    s_lshl_b32 s18, s25, 4
    s_add_u32 s18, s18, s24
    s_lshl_b32 s18, s18, 4
    s_add_u32 s18, s18, 0x8412000
    buffer_load_dword v192, off, s[4:7], s18 sc1
main_kernel_w_c0_nlw:
    s_waitcnt lgkmcnt(0)
    ds_read_b128 v[48:51], v136 offset:1024
    s_add_u32 m0, s19, 49152
    s_nop 0
    v_mfma_f32_16x16x32_bf16 v[64:67], v[0:3], v[16:19], v[64:67]
    ds_read_b64_tr_b16 v[32:33], v128 offset:8192
    v_mfma_f32_16x16x32_bf16 v[68:71], v[4:7], v[16:19], v[68:71]
    ds_read_b64_tr_b16 v[34:35], v128 offset:12288
    buffer_load_dwordx4 v137, s[8:11], s15 offen offset:0 lds
    v_mfma_f32_16x16x32_bf16 v[72:75], v[8:11], v[16:19], v[72:75]
    ds_read_b64_tr_b16 v[36:37], v129 offset:8192
    v_mfma_f32_16x16x32_bf16 v[76:79], v[12:15], v[16:19], v[76:79]
    ds_read_b64_tr_b16 v[38:39], v129 offset:12288
    v_mfma_f32_16x16x32_bf16 v[80:83], v[0:3], v[20:23], v[80:83]
    ds_read_b64_tr_b16 v[40:41], v130 offset:8192
    buffer_load_dwordx4 v138, s[8:11], s15 offen offset:1024 lds
    v_mfma_f32_16x16x32_bf16 v[84:87], v[4:7], v[20:23], v[84:87]
    ds_read_b64_tr_b16 v[42:43], v130 offset:12288
    v_mfma_f32_16x16x32_bf16 v[88:91], v[8:11], v[20:23], v[88:91]
    ds_read_b64_tr_b16 v[44:45], v131 offset:8192
    v_mfma_f32_16x16x32_bf16 v[92:95], v[12:15], v[20:23], v[92:95]
    ds_read_b64_tr_b16 v[46:47], v131 offset:12288
    buffer_load_dwordx4 v139, s[8:11], s15 offen offset:2048 lds
    v_mfma_f32_16x16x32_bf16 v[96:99], v[0:3], v[24:27], v[96:99]
    ds_read_b128 v[52:55], v136 offset:3072
    v_mfma_f32_16x16x32_bf16 v[100:103], v[4:7], v[24:27], v[100:103]
    ds_read_b128 v[56:59], v136 offset:5120
    buffer_load_dwordx4 v140, s[8:11], s15 offen offset:3072 lds
    v_mfma_f32_16x16x32_bf16 v[104:107], v[8:11], v[24:27], v[104:107]
    ds_read_b128 v[60:63], v136 offset:7168
    v_mfma_f32_16x16x32_bf16 v[108:111], v[12:15], v[24:27], v[108:111]
    v_mfma_f32_16x16x32_bf16 v[112:115], v[0:3], v[28:31], v[112:115]
    s_add_u32 s15, s15, s17
    v_mfma_f32_16x16x32_bf16 v[116:119], v[4:7], v[28:31], v[116:119]
    v_mfma_f32_16x16x32_bf16 v[120:123], v[8:11], v[28:31], v[120:123]
    v_mfma_f32_16x16x32_bf16 v[124:127], v[12:15], v[28:31], v[124:127]
    s_waitcnt lgkmcnt(0)
    v_mfma_f32_16x16x32_bf16 v[64:67], v[32:35], v[48:51], v[64:67]
    s_waitcnt vmcnt(16)
    s_barrier
    ds_read_b128 v[16:19], v136 offset:16384
    v_mfma_f32_16x16x32_bf16 v[68:71], v[36:39], v[48:51], v[68:71]
    ds_read_b64_tr_b16 v[0:1], v128 offset:16384
    v_mfma_f32_16x16x32_bf16 v[72:75], v[40:43], v[48:51], v[72:75]
    ds_read_b64_tr_b16 v[2:3], v128 offset:20480
    v_mfma_f32_16x16x32_bf16 v[76:79], v[44:47], v[48:51], v[76:79]
    ds_read_b64_tr_b16 v[4:5], v129 offset:16384
    v_mfma_f32_16x16x32_bf16 v[80:83], v[32:35], v[52:55], v[80:83]
    ds_read_b64_tr_b16 v[6:7], v129 offset:20480
    v_mfma_f32_16x16x32_bf16 v[84:87], v[36:39], v[52:55], v[84:87]
    ds_read_b64_tr_b16 v[8:9], v130 offset:16384
    v_mfma_f32_16x16x32_bf16 v[88:91], v[40:43], v[52:55], v[88:91]
    ds_read_b64_tr_b16 v[10:11], v130 offset:20480
    v_mfma_f32_16x16x32_bf16 v[92:95], v[44:47], v[52:55], v[92:95]
    ds_read_b64_tr_b16 v[12:13], v131 offset:16384
    v_mfma_f32_16x16x32_bf16 v[96:99], v[32:35], v[56:59], v[96:99]
    ds_read_b64_tr_b16 v[14:15], v131 offset:20480
    v_mfma_f32_16x16x32_bf16 v[100:103], v[36:39], v[56:59], v[100:103]
    ds_read_b128 v[20:23], v136 offset:18432
    v_mfma_f32_16x16x32_bf16 v[104:107], v[40:43], v[56:59], v[104:107]
    ds_read_b128 v[24:27], v136 offset:20480
    v_mfma_f32_16x16x32_bf16 v[108:111], v[44:47], v[56:59], v[108:111]
    ds_read_b128 v[28:31], v136 offset:22528
    v_mfma_f32_16x16x32_bf16 v[112:115], v[32:35], v[60:63], v[112:115]
    v_mfma_f32_16x16x32_bf16 v[116:119], v[36:39], v[60:63], v[116:119]
    v_mfma_f32_16x16x32_bf16 v[120:123], v[40:43], v[60:63], v[120:123]
    v_mfma_f32_16x16x32_bf16 v[124:127], v[44:47], v[60:63], v[124:127]
    s_waitcnt lgkmcnt(0)
    ds_read_b128 v[48:51], v136 offset:17408
    v_mfma_f32_16x16x32_bf16 v[64:67], v[0:3], v[16:19], v[64:67]
    ds_read_b64_tr_b16 v[32:33], v128 offset:24576
    v_mfma_f32_16x16x32_bf16 v[68:71], v[4:7], v[16:19], v[68:71]
    ds_read_b64_tr_b16 v[34:35], v128 offset:28672
    v_mfma_f32_16x16x32_bf16 v[72:75], v[8:11], v[16:19], v[72:75]
    ds_read_b64_tr_b16 v[36:37], v129 offset:24576
    v_mfma_f32_16x16x32_bf16 v[76:79], v[12:15], v[16:19], v[76:79]
    ds_read_b64_tr_b16 v[38:39], v129 offset:28672
    v_mfma_f32_16x16x32_bf16 v[80:83], v[0:3], v[20:23], v[80:83]
    ds_read_b64_tr_b16 v[40:41], v130 offset:24576
    v_mfma_f32_16x16x32_bf16 v[84:87], v[4:7], v[20:23], v[84:87]
    ds_read_b64_tr_b16 v[42:43], v130 offset:28672
    v_mfma_f32_16x16x32_bf16 v[88:91], v[8:11], v[20:23], v[88:91]
    ds_read_b64_tr_b16 v[44:45], v131 offset:24576
    v_mfma_f32_16x16x32_bf16 v[92:95], v[12:15], v[20:23], v[92:95]
    ds_read_b64_tr_b16 v[46:47], v131 offset:28672
    v_mfma_f32_16x16x32_bf16 v[96:99], v[0:3], v[24:27], v[96:99]
    ds_read_b128 v[52:55], v136 offset:19456
    v_mfma_f32_16x16x32_bf16 v[100:103], v[4:7], v[24:27], v[100:103]
    ds_read_b128 v[56:59], v136 offset:21504
    v_mfma_f32_16x16x32_bf16 v[104:107], v[8:11], v[24:27], v[104:107]
    ds_read_b128 v[60:63], v136 offset:23552
    v_mfma_f32_16x16x32_bf16 v[108:111], v[12:15], v[24:27], v[108:111]
    v_mfma_f32_16x16x32_bf16 v[112:115], v[0:3], v[28:31], v[112:115]
    v_mfma_f32_16x16x32_bf16 v[116:119], v[4:7], v[28:31], v[116:119]
    v_mfma_f32_16x16x32_bf16 v[120:123], v[8:11], v[28:31], v[120:123]
    v_mfma_f32_16x16x32_bf16 v[124:127], v[12:15], v[28:31], v[124:127]
    s_waitcnt lgkmcnt(0)
    v_mfma_f32_16x16x32_bf16 v[64:67], v[32:35], v[48:51], v[64:67]
    s_waitcnt vmcnt(8)
    s_barrier
    ds_read_b128 v[16:19], v136 offset:32768
    v_mfma_f32_16x16x32_bf16 v[68:71], v[36:39], v[48:51], v[68:71]
    ds_read_b64_tr_b16 v[0:1], v128 offset:32768
    v_mfma_f32_16x16x32_bf16 v[72:75], v[40:43], v[48:51], v[72:75]
    ds_read_b64_tr_b16 v[2:3], v128 offset:36864
    v_mfma_f32_16x16x32_bf16 v[76:79], v[44:47], v[48:51], v[76:79]
    ds_read_b64_tr_b16 v[4:5], v129 offset:32768
    v_mfma_f32_16x16x32_bf16 v[80:83], v[32:35], v[52:55], v[80:83]
    ds_read_b64_tr_b16 v[6:7], v129 offset:36864
    v_mfma_f32_16x16x32_bf16 v[84:87], v[36:39], v[52:55], v[84:87]
    ds_read_b64_tr_b16 v[8:9], v130 offset:32768
    v_mfma_f32_16x16x32_bf16 v[88:91], v[40:43], v[52:55], v[88:91]
    ds_read_b64_tr_b16 v[10:11], v130 offset:36864
    v_mfma_f32_16x16x32_bf16 v[92:95], v[44:47], v[52:55], v[92:95]
    ds_read_b64_tr_b16 v[12:13], v131 offset:32768
    v_mfma_f32_16x16x32_bf16 v[96:99], v[32:35], v[56:59], v[96:99]
    ds_read_b64_tr_b16 v[14:15], v131 offset:36864
    v_mfma_f32_16x16x32_bf16 v[100:103], v[36:39], v[56:59], v[100:103]
    ds_read_b128 v[20:23], v136 offset:34816
    v_mfma_f32_16x16x32_bf16 v[104:107], v[40:43], v[56:59], v[104:107]
    ds_read_b128 v[24:27], v136 offset:36864
    v_mfma_f32_16x16x32_bf16 v[108:111], v[44:47], v[56:59], v[108:111]
    ds_read_b128 v[28:31], v136 offset:38912
    v_mfma_f32_16x16x32_bf16 v[112:115], v[32:35], v[60:63], v[112:115]
    v_mfma_f32_16x16x32_bf16 v[116:119], v[36:39], v[60:63], v[116:119]
    v_mfma_f32_16x16x32_bf16 v[120:123], v[40:43], v[60:63], v[120:123]
    v_mfma_f32_16x16x32_bf16 v[124:127], v[44:47], v[60:63], v[124:127]
    s_waitcnt lgkmcnt(0)
    ds_read_b128 v[48:51], v136 offset:33792
    v_mfma_f32_16x16x32_bf16 v[64:67], v[0:3], v[16:19], v[64:67]
    ds_read_b64_tr_b16 v[32:33], v128 offset:40960
    v_mfma_f32_16x16x32_bf16 v[68:71], v[4:7], v[16:19], v[68:71]
    ds_read_b64_tr_b16 v[34:35], v128 offset:45056
    v_mfma_f32_16x16x32_bf16 v[72:75], v[8:11], v[16:19], v[72:75]
    ds_read_b64_tr_b16 v[36:37], v129 offset:40960
    v_mfma_f32_16x16x32_bf16 v[76:79], v[12:15], v[16:19], v[76:79]
    ds_read_b64_tr_b16 v[38:39], v129 offset:45056
    v_mfma_f32_16x16x32_bf16 v[80:83], v[0:3], v[20:23], v[80:83]
    ds_read_b64_tr_b16 v[40:41], v130 offset:40960
    v_mfma_f32_16x16x32_bf16 v[84:87], v[4:7], v[20:23], v[84:87]
    ds_read_b64_tr_b16 v[42:43], v130 offset:45056
    v_mfma_f32_16x16x32_bf16 v[88:91], v[8:11], v[20:23], v[88:91]
    ds_read_b64_tr_b16 v[44:45], v131 offset:40960
    v_mfma_f32_16x16x32_bf16 v[92:95], v[12:15], v[20:23], v[92:95]
    ds_read_b64_tr_b16 v[46:47], v131 offset:45056
    v_mfma_f32_16x16x32_bf16 v[96:99], v[0:3], v[24:27], v[96:99]
    ds_read_b128 v[52:55], v136 offset:35840
    v_mfma_f32_16x16x32_bf16 v[100:103], v[4:7], v[24:27], v[100:103]
    ds_read_b128 v[56:59], v136 offset:37888
    v_mfma_f32_16x16x32_bf16 v[104:107], v[8:11], v[24:27], v[104:107]
    ds_read_b128 v[60:63], v136 offset:39936
    v_mfma_f32_16x16x32_bf16 v[108:111], v[12:15], v[24:27], v[108:111]
    v_mfma_f32_16x16x32_bf16 v[112:115], v[0:3], v[28:31], v[112:115]
    v_mfma_f32_16x16x32_bf16 v[116:119], v[4:7], v[28:31], v[116:119]
    v_mfma_f32_16x16x32_bf16 v[120:123], v[8:11], v[28:31], v[120:123]
    v_mfma_f32_16x16x32_bf16 v[124:127], v[12:15], v[28:31], v[124:127]
    s_waitcnt lgkmcnt(0)
    v_mfma_f32_16x16x32_bf16 v[64:67], v[32:35], v[48:51], v[64:67]
    s_waitcnt vmcnt(0)
    s_barrier
    ds_read_b128 v[16:19], v136 offset:49152
    v_mfma_f32_16x16x32_bf16 v[68:71], v[36:39], v[48:51], v[68:71]
    ds_read_b64_tr_b16 v[0:1], v128 offset:49152
    v_mfma_f32_16x16x32_bf16 v[72:75], v[40:43], v[48:51], v[72:75]
    ds_read_b64_tr_b16 v[2:3], v128 offset:53248
    v_mfma_f32_16x16x32_bf16 v[76:79], v[44:47], v[48:51], v[76:79]
    ds_read_b64_tr_b16 v[4:5], v129 offset:49152
    v_mfma_f32_16x16x32_bf16 v[80:83], v[32:35], v[52:55], v[80:83]
    ds_read_b64_tr_b16 v[6:7], v129 offset:53248
    v_mfma_f32_16x16x32_bf16 v[84:87], v[36:39], v[52:55], v[84:87]
    ds_read_b64_tr_b16 v[8:9], v130 offset:49152
    v_mfma_f32_16x16x32_bf16 v[88:91], v[40:43], v[52:55], v[88:91]
    ds_read_b64_tr_b16 v[10:11], v130 offset:53248
    v_mfma_f32_16x16x32_bf16 v[92:95], v[44:47], v[52:55], v[92:95]
    ds_read_b64_tr_b16 v[12:13], v131 offset:49152
    v_mfma_f32_16x16x32_bf16 v[96:99], v[32:35], v[56:59], v[96:99]
    ds_read_b64_tr_b16 v[14:15], v131 offset:53248
    v_mfma_f32_16x16x32_bf16 v[100:103], v[36:39], v[56:59], v[100:103]
    ds_read_b128 v[20:23], v136 offset:51200
    v_mfma_f32_16x16x32_bf16 v[104:107], v[40:43], v[56:59], v[104:107]
    ds_read_b128 v[24:27], v136 offset:53248
    v_mfma_f32_16x16x32_bf16 v[108:111], v[44:47], v[56:59], v[108:111]
    ds_read_b128 v[28:31], v136 offset:55296
    v_mfma_f32_16x16x32_bf16 v[112:115], v[32:35], v[60:63], v[112:115]
    v_mfma_f32_16x16x32_bf16 v[116:119], v[36:39], v[60:63], v[116:119]
    v_mfma_f32_16x16x32_bf16 v[120:123], v[40:43], v[60:63], v[120:123]
    v_mfma_f32_16x16x32_bf16 v[124:127], v[44:47], v[60:63], v[124:127]
    v_readfirstlane_b32 s55, v255
    s_cmp_lg_u32 s23, 8
    s_cbranch_scc1 main_kernel_w_c0_lwk
main_kernel_w_c0_lwp:
    v_cmp_eq_u32 vcc, 0, v192
    s_cbranch_vccz main_kernel_w_c0_lwk
    s_sleep 8
    buffer_load_dword v192, off, s[4:7], s18 sc1
    s_waitcnt vmcnt(0)
    s_sub_u32 s29, s29, 1
    s_cbranch_scc0 main_kernel_w_c0_lwp
main_kernel_w_c0_lwk:
    s_cmp_eq_u32 s26, -1
    s_cbranch_scc1 main_kernel_w_c0_nores
    s_add_u32 s32, s26, 0
    buffer_load_dwordx4 v[192:195], v251, s[4:7], s32 offen offset:0 sc1
    buffer_load_dwordx4 v[196:199], v251, s[4:7], s32 offen offset:1024 sc1
    s_add_u32 s32, s26, 32768
    buffer_load_dwordx4 v[200:203], v251, s[4:7], s32 offen offset:0 sc1
    buffer_load_dwordx4 v[204:207], v251, s[4:7], s32 offen offset:1024 sc1
    s_add_u32 s32, s26, 65536
    buffer_load_dwordx4 v[208:211], v251, s[4:7], s32 offen offset:0 sc1
    buffer_load_dwordx4 v[212:215], v251, s[4:7], s32 offen offset:1024 sc1
    s_add_u32 s32, s26, 98304
    buffer_load_dwordx4 v[216:219], v251, s[4:7], s32 offen offset:0 sc1
    buffer_load_dwordx4 v[220:223], v251, s[4:7], s32 offen offset:1024 sc1
main_kernel_w_c0_nores:
    s_waitcnt lgkmcnt(0)
    ds_read_b128 v[48:51], v136 offset:50176
    v_mfma_f32_16x16x32_bf16 v[64:67], v[0:3], v[16:19], v[64:67]
    ds_read_b64_tr_b16 v[32:33], v128 offset:57344
    v_mfma_f32_16x16x32_bf16 v[68:71], v[4:7], v[16:19], v[68:71]
    ds_read_b64_tr_b16 v[34:35], v128 offset:61440
    v_mfma_f32_16x16x32_bf16 v[72:75], v[8:11], v[16:19], v[72:75]
    ds_read_b64_tr_b16 v[36:37], v129 offset:57344
    v_mfma_f32_16x16x32_bf16 v[76:79], v[12:15], v[16:19], v[76:79]
    ds_read_b64_tr_b16 v[38:39], v129 offset:61440
    v_mfma_f32_16x16x32_bf16 v[80:83], v[0:3], v[20:23], v[80:83]
    ds_read_b64_tr_b16 v[40:41], v130 offset:57344
    v_mfma_f32_16x16x32_bf16 v[84:87], v[4:7], v[20:23], v[84:87]
    ds_read_b64_tr_b16 v[42:43], v130 offset:61440
    v_mfma_f32_16x16x32_bf16 v[88:91], v[8:11], v[20:23], v[88:91]
    ds_read_b64_tr_b16 v[44:45], v131 offset:57344
    v_mfma_f32_16x16x32_bf16 v[92:95], v[12:15], v[20:23], v[92:95]
    ds_read_b64_tr_b16 v[46:47], v131 offset:61440
    v_mfma_f32_16x16x32_bf16 v[96:99], v[0:3], v[24:27], v[96:99]
    ds_read_b128 v[52:55], v136 offset:52224
    v_mfma_f32_16x16x32_bf16 v[100:103], v[4:7], v[24:27], v[100:103]
    ds_read_b128 v[56:59], v136 offset:54272
    v_mfma_f32_16x16x32_bf16 v[104:107], v[8:11], v[24:27], v[104:107]
    ds_read_b128 v[60:63], v136 offset:56320
    v_mfma_f32_16x16x32_bf16 v[108:111], v[12:15], v[24:27], v[108:111]
    v_mfma_f32_16x16x32_bf16 v[112:115], v[0:3], v[28:31], v[112:115]
    v_mfma_f32_16x16x32_bf16 v[116:119], v[4:7], v[28:31], v[116:119]
    v_mfma_f32_16x16x32_bf16 v[120:123], v[8:11], v[28:31], v[120:123]
    v_mfma_f32_16x16x32_bf16 v[124:127], v[12:15], v[28:31], v[124:127]
    s_waitcnt lgkmcnt(0)
    v_mfma_f32_16x16x32_bf16 v[64:67], v[32:35], v[48:51], v[64:67]
    v_mfma_f32_16x16x32_bf16 v[68:71], v[36:39], v[48:51], v[68:71]
    v_mfma_f32_16x16x32_bf16 v[72:75], v[40:43], v[48:51], v[72:75]
    v_mfma_f32_16x16x32_bf16 v[76:79], v[44:47], v[48:51], v[76:79]
    v_mfma_f32_16x16x32_bf16 v[80:83], v[32:35], v[52:55], v[80:83]
    v_mfma_f32_16x16x32_bf16 v[84:87], v[36:39], v[52:55], v[84:87]
    v_mfma_f32_16x16x32_bf16 v[88:91], v[40:43], v[52:55], v[88:91]
    v_mfma_f32_16x16x32_bf16 v[92:95], v[44:47], v[52:55], v[92:95]
    v_mfma_f32_16x16x32_bf16 v[96:99], v[32:35], v[56:59], v[96:99]
    v_mfma_f32_16x16x32_bf16 v[100:103], v[36:39], v[56:59], v[100:103]
    v_mfma_f32_16x16x32_bf16 v[104:107], v[40:43], v[56:59], v[104:107]
    v_mfma_f32_16x16x32_bf16 v[108:111], v[44:47], v[56:59], v[108:111]
    v_mfma_f32_16x16x32_bf16 v[112:115], v[32:35], v[60:63], v[112:115]
    v_mfma_f32_16x16x32_bf16 v[116:119], v[36:39], v[60:63], v[116:119]
    v_mfma_f32_16x16x32_bf16 v[120:123], v[40:43], v[60:63], v[120:123]
    v_mfma_f32_16x16x32_bf16 v[124:127], v[44:47], v[60:63], v[124:127]
    s_nop 7
    s_cmp_eq_u32 s23, 4
    s_cbranch_scc1 main_kernel_w_c0_eadd
    s_cmp_eq_u32 s23, 7
    s_cbranch_scc1 main_kernel_w_c0_esilu
    s_cmp_eq_u32 s23, 8
    s_cbranch_scc1 main_kernel_w_c0_efin
main_kernel_w_c0_escl:
    s_mov_b32 s53, s21
    v_mul_f32 v64, 0x3e0293ee, v64
    v_mul_f32 v65, 0x3e0293ee, v65
    v_mul_f32 v66, 0x3e0293ee, v66
    v_mul_f32 v67, 0x3e0293ee, v67
    v_mul_f32 v68, 0x3e0293ee, v68
    v_mul_f32 v69, 0x3e0293ee, v69
    v_mul_f32 v70, 0x3e0293ee, v70
    v_mul_f32 v71, 0x3e0293ee, v71
    v_cvt_pk_bf16_f32 v16, v64, v65
    v_cvt_pk_bf16_f32 v17, v66, v67
    v_cvt_pk_bf16_f32 v18, v68, v69
    v_cvt_pk_bf16_f32 v19, v70, v71
    buffer_store_dwordx4 v[16:19], v251, s[4:7], s53 offen offset:0 sc1
    v_mul_f32 v72, 0x3e0293ee, v72
    v_mul_f32 v73, 0x3e0293ee, v73
    v_mul_f32 v74, 0x3e0293ee, v74
    v_mul_f32 v75, 0x3e0293ee, v75
    v_mul_f32 v76, 0x3e0293ee, v76
    v_mul_f32 v77, 0x3e0293ee, v77
    v_mul_f32 v78, 0x3e0293ee, v78
    v_mul_f32 v79, 0x3e0293ee, v79
    v_cvt_pk_bf16_f32 v36, v72, v73
    v_cvt_pk_bf16_f32 v37, v74, v75
    v_cvt_pk_bf16_f32 v38, v76, v77
    v_cvt_pk_bf16_f32 v39, v78, v79
    buffer_store_dwordx4 v[36:39], v251, s[4:7], s53 offen offset:1024 sc1
    s_add_u32 s53, s53, s22
    v_mul_f32 v80, 0x3e0293ee, v80
    v_mul_f32 v81, 0x3e0293ee, v81
    v_mul_f32 v82, 0x3e0293ee, v82
    v_mul_f32 v83, 0x3e0293ee, v83
    v_mul_f32 v84, 0x3e0293ee, v84
    v_mul_f32 v85, 0x3e0293ee, v85
    v_mul_f32 v86, 0x3e0293ee, v86
    v_mul_f32 v87, 0x3e0293ee, v87
    v_cvt_pk_bf16_f32 v56, v80, v81
    v_cvt_pk_bf16_f32 v57, v82, v83
    v_cvt_pk_bf16_f32 v58, v84, v85
    v_cvt_pk_bf16_f32 v59, v86, v87
    buffer_store_dwordx4 v[56:59], v251, s[4:7], s53 offen offset:0 sc1
    v_mul_f32 v88, 0x3e0293ee, v88
    v_mul_f32 v89, 0x3e0293ee, v89
    v_mul_f32 v90, 0x3e0293ee, v90
    v_mul_f32 v91, 0x3e0293ee, v91
    v_mul_f32 v92, 0x3e0293ee, v92
    v_mul_f32 v93, 0x3e0293ee, v93
    v_mul_f32 v94, 0x3e0293ee, v94
    v_mul_f32 v95, 0x3e0293ee, v95
    v_cvt_pk_bf16_f32 v16, v88, v89
    v_cvt_pk_bf16_f32 v17, v90, v91
    v_cvt_pk_bf16_f32 v18, v92, v93
    v_cvt_pk_bf16_f32 v19, v94, v95
    buffer_store_dwordx4 v[16:19], v251, s[4:7], s53 offen offset:1024 sc1
    s_add_u32 s53, s53, s22
    v_mul_f32 v96, 0x3e0293ee, v96
    v_mul_f32 v97, 0x3e0293ee, v97
    v_mul_f32 v98, 0x3e0293ee, v98
    v_mul_f32 v99, 0x3e0293ee, v99
    v_mul_f32 v100, 0x3e0293ee, v100
    v_mul_f32 v101, 0x3e0293ee, v101
    v_mul_f32 v102, 0x3e0293ee, v102
    v_mul_f32 v103, 0x3e0293ee, v103
    v_cvt_pk_bf16_f32 v36, v96, v97
    v_cvt_pk_bf16_f32 v37, v98, v99
    v_cvt_pk_bf16_f32 v38, v100, v101
    v_cvt_pk_bf16_f32 v39, v102, v103
    buffer_store_dwordx4 v[36:39], v251, s[4:7], s53 offen offset:0 sc1
    v_mul_f32 v104, 0x3e0293ee, v104
    v_mul_f32 v105, 0x3e0293ee, v105
    v_mul_f32 v106, 0x3e0293ee, v106
    v_mul_f32 v107, 0x3e0293ee, v107
    v_mul_f32 v108, 0x3e0293ee, v108
    v_mul_f32 v109, 0x3e0293ee, v109
    v_mul_f32 v110, 0x3e0293ee, v110
    v_mul_f32 v111, 0x3e0293ee, v111
    v_cvt_pk_bf16_f32 v56, v104, v105
    v_cvt_pk_bf16_f32 v57, v106, v107
    v_cvt_pk_bf16_f32 v58, v108, v109
    v_cvt_pk_bf16_f32 v59, v110, v111
    buffer_store_dwordx4 v[56:59], v251, s[4:7], s53 offen offset:1024 sc1
    s_add_u32 s53, s53, s22
    v_mul_f32 v112, 0x3e0293ee, v112
    v_mul_f32 v113, 0x3e0293ee, v113
    v_mul_f32 v114, 0x3e0293ee, v114
    v_mul_f32 v115, 0x3e0293ee, v115
    v_mul_f32 v116, 0x3e0293ee, v116
    v_mul_f32 v117, 0x3e0293ee, v117
    v_mul_f32 v118, 0x3e0293ee, v118
    v_mul_f32 v119, 0x3e0293ee, v119
    v_cvt_pk_bf16_f32 v16, v112, v113
    v_cvt_pk_bf16_f32 v17, v114, v115
    v_cvt_pk_bf16_f32 v18, v116, v117
    v_cvt_pk_bf16_f32 v19, v118, v119
    buffer_store_dwordx4 v[16:19], v251, s[4:7], s53 offen offset:0 sc1
    v_mul_f32 v120, 0x3e0293ee, v120
    v_mul_f32 v121, 0x3e0293ee, v121
    v_mul_f32 v122, 0x3e0293ee, v122
    v_mul_f32 v123, 0x3e0293ee, v123
    v_mul_f32 v124, 0x3e0293ee, v124
    v_mul_f32 v125, 0x3e0293ee, v125
    v_mul_f32 v126, 0x3e0293ee, v126
    v_mul_f32 v127, 0x3e0293ee, v127
    v_cvt_pk_bf16_f32 v36, v120, v121
    v_cvt_pk_bf16_f32 v37, v122, v123
    v_cvt_pk_bf16_f32 v38, v124, v125
    v_cvt_pk_bf16_f32 v39, v126, v127
    buffer_store_dwordx4 v[36:39], v251, s[4:7], s53 offen offset:1024 sc1
    s_branch main_kernel_w_done
main_kernel_w_c0_eadd:
    s_mov_b32 s53, s21
    s_waitcnt vmcnt(7)
    v_lshlrev_b32 v8, 16, v192
    v_and_b32 v9, 0xffff0000, v192
    v_lshlrev_b32 v10, 16, v193
    v_and_b32 v11, 0xffff0000, v193
    v_lshlrev_b32 v12, 16, v194
    v_and_b32 v13, 0xffff0000, v194
    v_lshlrev_b32 v14, 16, v195
    v_and_b32 v15, 0xffff0000, v195
    v_pk_add_f32 v[64:65], v[64:65], v[8:9]
    v_pk_add_f32 v[66:67], v[66:67], v[10:11]
    v_pk_add_f32 v[68:69], v[68:69], v[12:13]
    v_pk_add_f32 v[70:71], v[70:71], v[14:15]
    v_cvt_pk_bf16_f32 v16, v64, v65
    v_cvt_pk_bf16_f32 v17, v66, v67
    v_cvt_pk_bf16_f32 v18, v68, v69
    v_cvt_pk_bf16_f32 v19, v70, v71
    buffer_store_dwordx4 v[16:19], v251, s[4:7], s53 offen offset:0 sc1
    s_waitcnt vmcnt(7)
    v_lshlrev_b32 v28, 16, v196
    v_and_b32 v29, 0xffff0000, v196
    v_lshlrev_b32 v30, 16, v197
    v_and_b32 v31, 0xffff0000, v197
    v_lshlrev_b32 v32, 16, v198
    v_and_b32 v33, 0xffff0000, v198
    v_lshlrev_b32 v34, 16, v199
    v_and_b32 v35, 0xffff0000, v199
    v_pk_add_f32 v[72:73], v[72:73], v[28:29]
    v_pk_add_f32 v[74:75], v[74:75], v[30:31]
    v_pk_add_f32 v[76:77], v[76:77], v[32:33]
    v_pk_add_f32 v[78:79], v[78:79], v[34:35]
    v_cvt_pk_bf16_f32 v36, v72, v73
    v_cvt_pk_bf16_f32 v37, v74, v75
    v_cvt_pk_bf16_f32 v38, v76, v77
    v_cvt_pk_bf16_f32 v39, v78, v79
    buffer_store_dwordx4 v[36:39], v251, s[4:7], s53 offen offset:1024 sc1
    s_add_u32 s53, s53, s22
    s_waitcnt vmcnt(7)
    v_lshlrev_b32 v48, 16, v200
    v_and_b32 v49, 0xffff0000, v200
    v_lshlrev_b32 v50, 16, v201
    v_and_b32 v51, 0xffff0000, v201
    v_lshlrev_b32 v52, 16, v202
    v_and_b32 v53, 0xffff0000, v202
    v_lshlrev_b32 v54, 16, v203
    v_and_b32 v55, 0xffff0000, v203
    v_pk_add_f32 v[80:81], v[80:81], v[48:49]
    v_pk_add_f32 v[82:83], v[82:83], v[50:51]
    v_pk_add_f32 v[84:85], v[84:85], v[52:53]
    v_pk_add_f32 v[86:87], v[86:87], v[54:55]
    v_cvt_pk_bf16_f32 v56, v80, v81
    v_cvt_pk_bf16_f32 v57, v82, v83
    v_cvt_pk_bf16_f32 v58, v84, v85
    v_cvt_pk_bf16_f32 v59, v86, v87
    buffer_store_dwordx4 v[56:59], v251, s[4:7], s53 offen offset:0 sc1
    s_waitcnt vmcnt(7)
    v_lshlrev_b32 v8, 16, v204
    v_and_b32 v9, 0xffff0000, v204
    v_lshlrev_b32 v10, 16, v205
    v_and_b32 v11, 0xffff0000, v205
    v_lshlrev_b32 v12, 16, v206
    v_and_b32 v13, 0xffff0000, v206
    v_lshlrev_b32 v14, 16, v207
    v_and_b32 v15, 0xffff0000, v207
    v_pk_add_f32 v[88:89], v[88:89], v[8:9]
    v_pk_add_f32 v[90:91], v[90:91], v[10:11]
    v_pk_add_f32 v[92:93], v[92:93], v[12:13]
    v_pk_add_f32 v[94:95], v[94:95], v[14:15]
    v_cvt_pk_bf16_f32 v16, v88, v89
    v_cvt_pk_bf16_f32 v17, v90, v91
    v_cvt_pk_bf16_f32 v18, v92, v93
    v_cvt_pk_bf16_f32 v19, v94, v95
    buffer_store_dwordx4 v[16:19], v251, s[4:7], s53 offen offset:1024 sc1
    s_add_u32 s53, s53, s22
    s_waitcnt vmcnt(7)
    v_lshlrev_b32 v28, 16, v208
    v_and_b32 v29, 0xffff0000, v208
    v_lshlrev_b32 v30, 16, v209
    v_and_b32 v31, 0xffff0000, v209
    v_lshlrev_b32 v32, 16, v210
    v_and_b32 v33, 0xffff0000, v210
    v_lshlrev_b32 v34, 16, v211
    v_and_b32 v35, 0xffff0000, v211
    v_pk_add_f32 v[96:97], v[96:97], v[28:29]
    v_pk_add_f32 v[98:99], v[98:99], v[30:31]
    v_pk_add_f32 v[100:101], v[100:101], v[32:33]
    v_pk_add_f32 v[102:103], v[102:103], v[34:35]
    v_cvt_pk_bf16_f32 v36, v96, v97
    v_cvt_pk_bf16_f32 v37, v98, v99
    v_cvt_pk_bf16_f32 v38, v100, v101
    v_cvt_pk_bf16_f32 v39, v102, v103
    buffer_store_dwordx4 v[36:39], v251, s[4:7], s53 offen offset:0 sc1
    s_waitcnt vmcnt(7)
    v_lshlrev_b32 v48, 16, v212
    v_and_b32 v49, 0xffff0000, v212
    v_lshlrev_b32 v50, 16, v213
    v_and_b32 v51, 0xffff0000, v213
    v_lshlrev_b32 v52, 16, v214
    v_and_b32 v53, 0xffff0000, v214
    v_lshlrev_b32 v54, 16, v215
    v_and_b32 v55, 0xffff0000, v215
    v_pk_add_f32 v[104:105], v[104:105], v[48:49]
    v_pk_add_f32 v[106:107], v[106:107], v[50:51]
    v_pk_add_f32 v[108:109], v[108:109], v[52:53]
    v_pk_add_f32 v[110:111], v[110:111], v[54:55]
    v_cvt_pk_bf16_f32 v56, v104, v105
    v_cvt_pk_bf16_f32 v57, v106, v107
    v_cvt_pk_bf16_f32 v58, v108, v109
    v_cvt_pk_bf16_f32 v59, v110, v111
    buffer_store_dwordx4 v[56:59], v251, s[4:7], s53 offen offset:1024 sc1
    s_add_u32 s53, s53, s22
    s_waitcnt vmcnt(7)
    v_lshlrev_b32 v8, 16, v216
    v_and_b32 v9, 0xffff0000, v216
    v_lshlrev_b32 v10, 16, v217
    v_and_b32 v11, 0xffff0000, v217
    v_lshlrev_b32 v12, 16, v218
    v_and_b32 v13, 0xffff0000, v218
    v_lshlrev_b32 v14, 16, v219
    v_and_b32 v15, 0xffff0000, v219
    v_pk_add_f32 v[112:113], v[112:113], v[8:9]
    v_pk_add_f32 v[114:115], v[114:115], v[10:11]
    v_pk_add_f32 v[116:117], v[116:117], v[12:13]
    v_pk_add_f32 v[118:119], v[118:119], v[14:15]
    v_cvt_pk_bf16_f32 v16, v112, v113
    v_cvt_pk_bf16_f32 v17, v114, v115
    v_cvt_pk_bf16_f32 v18, v116, v117
    v_cvt_pk_bf16_f32 v19, v118, v119
    buffer_store_dwordx4 v[16:19], v251, s[4:7], s53 offen offset:0 sc1
    s_waitcnt vmcnt(7)
    v_lshlrev_b32 v28, 16, v220
    v_and_b32 v29, 0xffff0000, v220
    v_lshlrev_b32 v30, 16, v221
    v_and_b32 v31, 0xffff0000, v221
    v_lshlrev_b32 v32, 16, v222
    v_and_b32 v33, 0xffff0000, v222
    v_lshlrev_b32 v34, 16, v223
    v_and_b32 v35, 0xffff0000, v223
    v_pk_add_f32 v[120:121], v[120:121], v[28:29]
    v_pk_add_f32 v[122:123], v[122:123], v[30:31]
    v_pk_add_f32 v[124:125], v[124:125], v[32:33]
    v_pk_add_f32 v[126:127], v[126:127], v[34:35]
    v_cvt_pk_bf16_f32 v36, v120, v121
    v_cvt_pk_bf16_f32 v37, v122, v123
    v_cvt_pk_bf16_f32 v38, v124, v125
    v_cvt_pk_bf16_f32 v39, v126, v127
    buffer_store_dwordx4 v[36:39], v251, s[4:7], s53 offen offset:1024 sc1
    s_branch main_kernel_w_done
main_kernel_w_c0_esilu:
    s_mov_b32 s53, s21
    s_waitcnt vmcnt(7)
    v_lshlrev_b32 v8, 16, v192
    v_and_b32 v9, 0xffff0000, v192
    v_lshlrev_b32 v10, 16, v193
    v_and_b32 v11, 0xffff0000, v193
    v_lshlrev_b32 v12, 16, v194
    v_and_b32 v13, 0xffff0000, v194
    v_lshlrev_b32 v14, 16, v195
    v_and_b32 v15, 0xffff0000, v195
    v_pk_add_f32 v[64:65], v[64:65], v[8:9]
    v_pk_add_f32 v[66:67], v[66:67], v[10:11]
    v_pk_add_f32 v[68:69], v[68:69], v[12:13]
    v_pk_add_f32 v[70:71], v[70:71], v[14:15]
    v_pk_mul_f32 v[8:9], v[64:65], v[246:247]
    v_pk_mul_f32 v[10:11], v[66:67], v[246:247]
    v_pk_mul_f32 v[12:13], v[68:69], v[246:247]
    v_pk_mul_f32 v[14:15], v[70:71], v[246:247]
    v_exp_f32 v8, v8
    v_exp_f32 v9, v9
    v_exp_f32 v10, v10
    v_exp_f32 v11, v11
    v_exp_f32 v12, v12
    v_exp_f32 v13, v13
    v_exp_f32 v14, v14
    v_exp_f32 v15, v15
    v_pk_add_f32 v[8:9], v[8:9], v[244:245]
    v_pk_add_f32 v[10:11], v[10:11], v[244:245]
    v_pk_add_f32 v[12:13], v[12:13], v[244:245]
    v_pk_add_f32 v[14:15], v[14:15], v[244:245]
    v_rcp_f32 v8, v8
    v_rcp_f32 v9, v9
    v_rcp_f32 v10, v10
    v_rcp_f32 v11, v11
    v_rcp_f32 v12, v12
    v_rcp_f32 v13, v13
    v_rcp_f32 v14, v14
    v_rcp_f32 v15, v15
    v_pk_mul_f32 v[64:65], v[8:9], v[64:65]
    v_pk_mul_f32 v[66:67], v[10:11], v[66:67]
    v_pk_mul_f32 v[68:69], v[12:13], v[68:69]
    v_pk_mul_f32 v[70:71], v[14:15], v[70:71]
    v_cvt_pk_bf16_f32 v16, v64, v65
    v_cvt_pk_bf16_f32 v17, v66, v67
    v_cvt_pk_bf16_f32 v18, v68, v69
    v_cvt_pk_bf16_f32 v19, v70, v71
    buffer_store_dwordx4 v[16:19], v251, s[4:7], s53 offen offset:0 sc1
    s_waitcnt vmcnt(7)
    v_lshlrev_b32 v28, 16, v196
    v_and_b32 v29, 0xffff0000, v196
    v_lshlrev_b32 v30, 16, v197
    v_and_b32 v31, 0xffff0000, v197
    v_lshlrev_b32 v32, 16, v198
    v_and_b32 v33, 0xffff0000, v198
    v_lshlrev_b32 v34, 16, v199
    v_and_b32 v35, 0xffff0000, v199
    v_pk_add_f32 v[72:73], v[72:73], v[28:29]
    v_pk_add_f32 v[74:75], v[74:75], v[30:31]
    v_pk_add_f32 v[76:77], v[76:77], v[32:33]
    v_pk_add_f32 v[78:79], v[78:79], v[34:35]
    v_pk_mul_f32 v[28:29], v[72:73], v[246:247]
    v_pk_mul_f32 v[30:31], v[74:75], v[246:247]
    v_pk_mul_f32 v[32:33], v[76:77], v[246:247]
    v_pk_mul_f32 v[34:35], v[78:79], v[246:247]
    v_exp_f32 v28, v28
    v_exp_f32 v29, v29
    v_exp_f32 v30, v30
    v_exp_f32 v31, v31
    v_exp_f32 v32, v32
    v_exp_f32 v33, v33
    v_exp_f32 v34, v34
    v_exp_f32 v35, v35
    v_pk_add_f32 v[28:29], v[28:29], v[244:245]
    v_pk_add_f32 v[30:31], v[30:31], v[244:245]
    v_pk_add_f32 v[32:33], v[32:33], v[244:245]
    v_pk_add_f32 v[34:35], v[34:35], v[244:245]
    v_rcp_f32 v28, v28
    v_rcp_f32 v29, v29
    v_rcp_f32 v30, v30
    v_rcp_f32 v31, v31
    v_rcp_f32 v32, v32
    v_rcp_f32 v33, v33
    v_rcp_f32 v34, v34
    v_rcp_f32 v35, v35
    v_pk_mul_f32 v[72:73], v[28:29], v[72:73]
    v_pk_mul_f32 v[74:75], v[30:31], v[74:75]
    v_pk_mul_f32 v[76:77], v[32:33], v[76:77]
    v_pk_mul_f32 v[78:79], v[34:35], v[78:79]
    v_cvt_pk_bf16_f32 v36, v72, v73
    v_cvt_pk_bf16_f32 v37, v74, v75
    v_cvt_pk_bf16_f32 v38, v76, v77
    v_cvt_pk_bf16_f32 v39, v78, v79
    buffer_store_dwordx4 v[36:39], v251, s[4:7], s53 offen offset:1024 sc1
    s_add_u32 s53, s53, s22
    s_waitcnt vmcnt(7)
    v_lshlrev_b32 v48, 16, v200
    v_and_b32 v49, 0xffff0000, v200
    v_lshlrev_b32 v50, 16, v201
    v_and_b32 v51, 0xffff0000, v201
    v_lshlrev_b32 v52, 16, v202
    v_and_b32 v53, 0xffff0000, v202
    v_lshlrev_b32 v54, 16, v203
    v_and_b32 v55, 0xffff0000, v203
    v_pk_add_f32 v[80:81], v[80:81], v[48:49]
    v_pk_add_f32 v[82:83], v[82:83], v[50:51]
    v_pk_add_f32 v[84:85], v[84:85], v[52:53]
    v_pk_add_f32 v[86:87], v[86:87], v[54:55]
    v_pk_mul_f32 v[48:49], v[80:81], v[246:247]
    v_pk_mul_f32 v[50:51], v[82:83], v[246:247]
    v_pk_mul_f32 v[52:53], v[84:85], v[246:247]
    v_pk_mul_f32 v[54:55], v[86:87], v[246:247]
    v_exp_f32 v48, v48
    v_exp_f32 v49, v49
    v_exp_f32 v50, v50
    v_exp_f32 v51, v51
    v_exp_f32 v52, v52
    v_exp_f32 v53, v53
    v_exp_f32 v54, v54
    v_exp_f32 v55, v55
    v_pk_add_f32 v[48:49], v[48:49], v[244:245]
    v_pk_add_f32 v[50:51], v[50:51], v[244:245]
    v_pk_add_f32 v[52:53], v[52:53], v[244:245]
    v_pk_add_f32 v[54:55], v[54:55], v[244:245]
    v_rcp_f32 v48, v48
    v_rcp_f32 v49, v49
    v_rcp_f32 v50, v50
    v_rcp_f32 v51, v51
    v_rcp_f32 v52, v52
    v_rcp_f32 v53, v53
    v_rcp_f32 v54, v54
    v_rcp_f32 v55, v55
    v_pk_mul_f32 v[80:81], v[48:49], v[80:81]
    v_pk_mul_f32 v[82:83], v[50:51], v[82:83]
    v_pk_mul_f32 v[84:85], v[52:53], v[84:85]
    v_pk_mul_f32 v[86:87], v[54:55], v[86:87]
    v_cvt_pk_bf16_f32 v56, v80, v81
    v_cvt_pk_bf16_f32 v57, v82, v83
    v_cvt_pk_bf16_f32 v58, v84, v85
    v_cvt_pk_bf16_f32 v59, v86, v87
    buffer_store_dwordx4 v[56:59], v251, s[4:7], s53 offen offset:0 sc1
    s_waitcnt vmcnt(7)
    v_lshlrev_b32 v8, 16, v204
    v_and_b32 v9, 0xffff0000, v204
    v_lshlrev_b32 v10, 16, v205
    v_and_b32 v11, 0xffff0000, v205
    v_lshlrev_b32 v12, 16, v206
    v_and_b32 v13, 0xffff0000, v206
    v_lshlrev_b32 v14, 16, v207
    v_and_b32 v15, 0xffff0000, v207
    v_pk_add_f32 v[88:89], v[88:89], v[8:9]
    v_pk_add_f32 v[90:91], v[90:91], v[10:11]
    v_pk_add_f32 v[92:93], v[92:93], v[12:13]
    v_pk_add_f32 v[94:95], v[94:95], v[14:15]
    v_pk_mul_f32 v[8:9], v[88:89], v[246:247]
    v_pk_mul_f32 v[10:11], v[90:91], v[246:247]
    v_pk_mul_f32 v[12:13], v[92:93], v[246:247]
    v_pk_mul_f32 v[14:15], v[94:95], v[246:247]
    v_exp_f32 v8, v8
    v_exp_f32 v9, v9
    v_exp_f32 v10, v10
    v_exp_f32 v11, v11
    v_exp_f32 v12, v12
    v_exp_f32 v13, v13
    v_exp_f32 v14, v14
    v_exp_f32 v15, v15
    v_pk_add_f32 v[8:9], v[8:9], v[244:245]
    v_pk_add_f32 v[10:11], v[10:11], v[244:245]
    v_pk_add_f32 v[12:13], v[12:13], v[244:245]
    v_pk_add_f32 v[14:15], v[14:15], v[244:245]
    v_rcp_f32 v8, v8
    v_rcp_f32 v9, v9
    v_rcp_f32 v10, v10
    v_rcp_f32 v11, v11
    v_rcp_f32 v12, v12
    v_rcp_f32 v13, v13
    v_rcp_f32 v14, v14
    v_rcp_f32 v15, v15
    v_pk_mul_f32 v[88:89], v[8:9], v[88:89]
    v_pk_mul_f32 v[90:91], v[10:11], v[90:91]
    v_pk_mul_f32 v[92:93], v[12:13], v[92:93]
    v_pk_mul_f32 v[94:95], v[14:15], v[94:95]
    v_cvt_pk_bf16_f32 v16, v88, v89
    v_cvt_pk_bf16_f32 v17, v90, v91
    v_cvt_pk_bf16_f32 v18, v92, v93
    v_cvt_pk_bf16_f32 v19, v94, v95
    buffer_store_dwordx4 v[16:19], v251, s[4:7], s53 offen offset:1024 sc1
    s_add_u32 s53, s53, s22
    s_waitcnt vmcnt(7)
    v_lshlrev_b32 v28, 16, v208
    v_and_b32 v29, 0xffff0000, v208
    v_lshlrev_b32 v30, 16, v209
    v_and_b32 v31, 0xffff0000, v209
    v_lshlrev_b32 v32, 16, v210
    v_and_b32 v33, 0xffff0000, v210
    v_lshlrev_b32 v34, 16, v211
    v_and_b32 v35, 0xffff0000, v211
    v_pk_add_f32 v[96:97], v[96:97], v[28:29]
    v_pk_add_f32 v[98:99], v[98:99], v[30:31]
    v_pk_add_f32 v[100:101], v[100:101], v[32:33]
    v_pk_add_f32 v[102:103], v[102:103], v[34:35]
    v_pk_mul_f32 v[28:29], v[96:97], v[246:247]
    v_pk_mul_f32 v[30:31], v[98:99], v[246:247]
    v_pk_mul_f32 v[32:33], v[100:101], v[246:247]
    v_pk_mul_f32 v[34:35], v[102:103], v[246:247]
    v_exp_f32 v28, v28
    v_exp_f32 v29, v29
    v_exp_f32 v30, v30
    v_exp_f32 v31, v31
    v_exp_f32 v32, v32
    v_exp_f32 v33, v33
    v_exp_f32 v34, v34
    v_exp_f32 v35, v35
    v_pk_add_f32 v[28:29], v[28:29], v[244:245]
    v_pk_add_f32 v[30:31], v[30:31], v[244:245]
    v_pk_add_f32 v[32:33], v[32:33], v[244:245]
    v_pk_add_f32 v[34:35], v[34:35], v[244:245]
    v_rcp_f32 v28, v28
    v_rcp_f32 v29, v29
    v_rcp_f32 v30, v30
    v_rcp_f32 v31, v31
    v_rcp_f32 v32, v32
    v_rcp_f32 v33, v33
    v_rcp_f32 v34, v34
    v_rcp_f32 v35, v35
    v_pk_mul_f32 v[96:97], v[28:29], v[96:97]
    v_pk_mul_f32 v[98:99], v[30:31], v[98:99]
    v_pk_mul_f32 v[100:101], v[32:33], v[100:101]
    v_pk_mul_f32 v[102:103], v[34:35], v[102:103]
    v_cvt_pk_bf16_f32 v36, v96, v97
    v_cvt_pk_bf16_f32 v37, v98, v99
    v_cvt_pk_bf16_f32 v38, v100, v101
    v_cvt_pk_bf16_f32 v39, v102, v103
    buffer_store_dwordx4 v[36:39], v251, s[4:7], s53 offen offset:0 sc1
    s_waitcnt vmcnt(7)
    v_lshlrev_b32 v48, 16, v212
    v_and_b32 v49, 0xffff0000, v212
    v_lshlrev_b32 v50, 16, v213
    v_and_b32 v51, 0xffff0000, v213
    v_lshlrev_b32 v52, 16, v214
    v_and_b32 v53, 0xffff0000, v214
    v_lshlrev_b32 v54, 16, v215
    v_and_b32 v55, 0xffff0000, v215
    v_pk_add_f32 v[104:105], v[104:105], v[48:49]
    v_pk_add_f32 v[106:107], v[106:107], v[50:51]
    v_pk_add_f32 v[108:109], v[108:109], v[52:53]
    v_pk_add_f32 v[110:111], v[110:111], v[54:55]
    v_pk_mul_f32 v[48:49], v[104:105], v[246:247]
    v_pk_mul_f32 v[50:51], v[106:107], v[246:247]
    v_pk_mul_f32 v[52:53], v[108:109], v[246:247]
    v_pk_mul_f32 v[54:55], v[110:111], v[246:247]
    v_exp_f32 v48, v48
    v_exp_f32 v49, v49
    v_exp_f32 v50, v50
    v_exp_f32 v51, v51
    v_exp_f32 v52, v52
    v_exp_f32 v53, v53
    v_exp_f32 v54, v54
    v_exp_f32 v55, v55
    v_pk_add_f32 v[48:49], v[48:49], v[244:245]
    v_pk_add_f32 v[50:51], v[50:51], v[244:245]
    v_pk_add_f32 v[52:53], v[52:53], v[244:245]
    v_pk_add_f32 v[54:55], v[54:55], v[244:245]
    v_rcp_f32 v48, v48
    v_rcp_f32 v49, v49
    v_rcp_f32 v50, v50
    v_rcp_f32 v51, v51
    v_rcp_f32 v52, v52
    v_rcp_f32 v53, v53
    v_rcp_f32 v54, v54
    v_rcp_f32 v55, v55
    v_pk_mul_f32 v[104:105], v[48:49], v[104:105]
    v_pk_mul_f32 v[106:107], v[50:51], v[106:107]
    v_pk_mul_f32 v[108:109], v[52:53], v[108:109]
    v_pk_mul_f32 v[110:111], v[54:55], v[110:111]
    v_cvt_pk_bf16_f32 v56, v104, v105
    v_cvt_pk_bf16_f32 v57, v106, v107
    v_cvt_pk_bf16_f32 v58, v108, v109
    v_cvt_pk_bf16_f32 v59, v110, v111
    buffer_store_dwordx4 v[56:59], v251, s[4:7], s53 offen offset:1024 sc1
    s_add_u32 s53, s53, s22
    s_waitcnt vmcnt(7)
    v_lshlrev_b32 v8, 16, v216
    v_and_b32 v9, 0xffff0000, v216
    v_lshlrev_b32 v10, 16, v217
    v_and_b32 v11, 0xffff0000, v217
    v_lshlrev_b32 v12, 16, v218
    v_and_b32 v13, 0xffff0000, v218
    v_lshlrev_b32 v14, 16, v219
    v_and_b32 v15, 0xffff0000, v219
    v_pk_add_f32 v[112:113], v[112:113], v[8:9]
    v_pk_add_f32 v[114:115], v[114:115], v[10:11]
    v_pk_add_f32 v[116:117], v[116:117], v[12:13]
    v_pk_add_f32 v[118:119], v[118:119], v[14:15]
    v_pk_mul_f32 v[8:9], v[112:113], v[246:247]
    v_pk_mul_f32 v[10:11], v[114:115], v[246:247]
    v_pk_mul_f32 v[12:13], v[116:117], v[246:247]
    v_pk_mul_f32 v[14:15], v[118:119], v[246:247]
    v_exp_f32 v8, v8
    v_exp_f32 v9, v9
    v_exp_f32 v10, v10
    v_exp_f32 v11, v11
    v_exp_f32 v12, v12
    v_exp_f32 v13, v13
    v_exp_f32 v14, v14
    v_exp_f32 v15, v15
    v_pk_add_f32 v[8:9], v[8:9], v[244:245]
    v_pk_add_f32 v[10:11], v[10:11], v[244:245]
    v_pk_add_f32 v[12:13], v[12:13], v[244:245]
    v_pk_add_f32 v[14:15], v[14:15], v[244:245]
    v_rcp_f32 v8, v8
    v_rcp_f32 v9, v9
    v_rcp_f32 v10, v10
    v_rcp_f32 v11, v11
    v_rcp_f32 v12, v12
    v_rcp_f32 v13, v13
    v_rcp_f32 v14, v14
    v_rcp_f32 v15, v15
    v_pk_mul_f32 v[112:113], v[8:9], v[112:113]
    v_pk_mul_f32 v[114:115], v[10:11], v[114:115]
    v_pk_mul_f32 v[116:117], v[12:13], v[116:117]
    v_pk_mul_f32 v[118:119], v[14:15], v[118:119]
    v_cvt_pk_bf16_f32 v16, v112, v113
    v_cvt_pk_bf16_f32 v17, v114, v115
    v_cvt_pk_bf16_f32 v18, v116, v117
    v_cvt_pk_bf16_f32 v19, v118, v119
    buffer_store_dwordx4 v[16:19], v251, s[4:7], s53 offen offset:0 sc1
    s_waitcnt vmcnt(7)
    v_lshlrev_b32 v28, 16, v220
    v_and_b32 v29, 0xffff0000, v220
    v_lshlrev_b32 v30, 16, v221
    v_and_b32 v31, 0xffff0000, v221
    v_lshlrev_b32 v32, 16, v222
    v_and_b32 v33, 0xffff0000, v222
    v_lshlrev_b32 v34, 16, v223
    v_and_b32 v35, 0xffff0000, v223
    v_pk_add_f32 v[120:121], v[120:121], v[28:29]
    v_pk_add_f32 v[122:123], v[122:123], v[30:31]
    v_pk_add_f32 v[124:125], v[124:125], v[32:33]
    v_pk_add_f32 v[126:127], v[126:127], v[34:35]
    v_pk_mul_f32 v[28:29], v[120:121], v[246:247]
    v_pk_mul_f32 v[30:31], v[122:123], v[246:247]
    v_pk_mul_f32 v[32:33], v[124:125], v[246:247]
    v_pk_mul_f32 v[34:35], v[126:127], v[246:247]
    v_exp_f32 v28, v28
    v_exp_f32 v29, v29
    v_exp_f32 v30, v30
    v_exp_f32 v31, v31
    v_exp_f32 v32, v32
    v_exp_f32 v33, v33
    v_exp_f32 v34, v34
    v_exp_f32 v35, v35
    v_pk_add_f32 v[28:29], v[28:29], v[244:245]
    v_pk_add_f32 v[30:31], v[30:31], v[244:245]
    v_pk_add_f32 v[32:33], v[32:33], v[244:245]
    v_pk_add_f32 v[34:35], v[34:35], v[244:245]
    v_rcp_f32 v28, v28
    v_rcp_f32 v29, v29
    v_rcp_f32 v30, v30
    v_rcp_f32 v31, v31
    v_rcp_f32 v32, v32
    v_rcp_f32 v33, v33
    v_rcp_f32 v34, v34
    v_rcp_f32 v35, v35
    v_pk_mul_f32 v[120:121], v[28:29], v[120:121]
    v_pk_mul_f32 v[122:123], v[30:31], v[122:123]
    v_pk_mul_f32 v[124:125], v[32:33], v[124:125]
    v_pk_mul_f32 v[126:127], v[34:35], v[126:127]
    v_cvt_pk_bf16_f32 v36, v120, v121
    v_cvt_pk_bf16_f32 v37, v122, v123
    v_cvt_pk_bf16_f32 v38, v124, v125
    v_cvt_pk_bf16_f32 v39, v126, v127
    buffer_store_dwordx4 v[36:39], v251, s[4:7], s53 offen offset:1024 sc1
    s_branch main_kernel_w_done
main_kernel_w_c0_efin:
    s_mov_b32 s53, s21
    s_add_u32 s32, s21, 0
    buffer_load_dwordx4 v[160:163], v252, s[96:99], s32 offen offset:0
    buffer_load_dwordx4 v[164:167], v252, s[96:99], s32 offen offset:64
    s_add_u32 s32, s21, 32768
    buffer_load_dwordx4 v[168:171], v252, s[96:99], s32 offen offset:0
    buffer_load_dwordx4 v[172:175], v252, s[96:99], s32 offen offset:64
    s_add_u32 s32, s21, 65536
    buffer_load_dwordx4 v[176:179], v252, s[96:99], s32 offen offset:0
    buffer_load_dwordx4 v[180:183], v252, s[96:99], s32 offen offset:64
    s_add_u32 s32, s21, 98304
    buffer_load_dwordx4 v[184:187], v252, s[96:99], s32 offen offset:0
    buffer_load_dwordx4 v[188:191], v252, s[96:99], s32 offen offset:64
    s_waitcnt vmcnt(7)
    v_permlane16_swap_b32 v160, v162
    v_permlane16_swap_b32 v161, v163
    v_lshlrev_b32 v8, 16, v192
    v_and_b32 v9, 0xffff0000, v192
    v_lshlrev_b32 v10, 16, v193
    v_and_b32 v11, 0xffff0000, v193
    v_lshlrev_b32 v12, 16, v194
    v_and_b32 v13, 0xffff0000, v194
    v_lshlrev_b32 v14, 16, v195
    v_and_b32 v15, 0xffff0000, v195
    v_permlane32_swap_b32 v160, v162
    v_permlane32_swap_b32 v161, v163
    v_lshlrev_b32 v16, 16, v160
    v_and_b32 v17, 0xffff0000, v160
    v_lshlrev_b32 v18, 16, v161
    v_and_b32 v19, 0xffff0000, v161
    v_lshlrev_b32 v20, 16, v162
    v_and_b32 v21, 0xffff0000, v162
    v_lshlrev_b32 v22, 16, v163
    v_and_b32 v23, 0xffff0000, v163
    v_pk_fma_f32 v[8:9], v[64:65], v[8:9], v[16:17]
    v_pk_fma_f32 v[10:11], v[66:67], v[10:11], v[18:19]
    v_pk_fma_f32 v[12:13], v[68:69], v[12:13], v[20:21]
    v_pk_fma_f32 v[14:15], v[70:71], v[14:15], v[22:23]
    v_cvt_pk_bf16_f32 v24, v8, v9
    v_cvt_pk_bf16_f32 v25, v10, v11
    v_cvt_pk_bf16_f32 v26, v12, v13
    v_cvt_pk_bf16_f32 v27, v14, v15
    s_nop 0
    v_permlane32_swap_b32 v24, v26
    v_permlane32_swap_b32 v25, v27
    s_nop 0
    v_permlane16_swap_b32 v24, v26
    v_permlane16_swap_b32 v25, v27
    buffer_store_dwordx4 v[24:27], v252, s[92:95], s53 offen offset:0 sc1
    s_waitcnt vmcnt(7)
    v_permlane16_swap_b32 v164, v166
    v_permlane16_swap_b32 v165, v167
    v_lshlrev_b32 v36, 16, v196
    v_and_b32 v37, 0xffff0000, v196
    v_lshlrev_b32 v38, 16, v197
    v_and_b32 v39, 0xffff0000, v197
    v_lshlrev_b32 v40, 16, v198
    v_and_b32 v41, 0xffff0000, v198
    v_lshlrev_b32 v42, 16, v199
    v_and_b32 v43, 0xffff0000, v199
    v_permlane32_swap_b32 v164, v166
    v_permlane32_swap_b32 v165, v167
    v_lshlrev_b32 v44, 16, v164
    v_and_b32 v45, 0xffff0000, v164
    v_lshlrev_b32 v46, 16, v165
    v_and_b32 v47, 0xffff0000, v165
    v_lshlrev_b32 v48, 16, v166
    v_and_b32 v49, 0xffff0000, v166
    v_lshlrev_b32 v50, 16, v167
    v_and_b32 v51, 0xffff0000, v167
    v_pk_fma_f32 v[36:37], v[72:73], v[36:37], v[44:45]
    v_pk_fma_f32 v[38:39], v[74:75], v[38:39], v[46:47]
    v_pk_fma_f32 v[40:41], v[76:77], v[40:41], v[48:49]
    v_pk_fma_f32 v[42:43], v[78:79], v[42:43], v[50:51]
    v_cvt_pk_bf16_f32 v52, v36, v37
    v_cvt_pk_bf16_f32 v53, v38, v39
    v_cvt_pk_bf16_f32 v54, v40, v41
    v_cvt_pk_bf16_f32 v55, v42, v43
    s_nop 0
    v_permlane32_swap_b32 v52, v54
    v_permlane32_swap_b32 v53, v55
    s_nop 0
    v_permlane16_swap_b32 v52, v54
    v_permlane16_swap_b32 v53, v55
    buffer_store_dwordx4 v[52:55], v252, s[92:95], s53 offen offset:64 sc1
    s_add_u32 s53, s53, 32768
    s_waitcnt vmcnt(7)
    v_permlane16_swap_b32 v168, v170
    v_permlane16_swap_b32 v169, v171
    v_lshlrev_b32 v8, 16, v200
    v_and_b32 v9, 0xffff0000, v200
    v_lshlrev_b32 v10, 16, v201
    v_and_b32 v11, 0xffff0000, v201
    v_lshlrev_b32 v12, 16, v202
    v_and_b32 v13, 0xffff0000, v202
    v_lshlrev_b32 v14, 16, v203
    v_and_b32 v15, 0xffff0000, v203
    v_permlane32_swap_b32 v168, v170
    v_permlane32_swap_b32 v169, v171
    v_lshlrev_b32 v16, 16, v168
    v_and_b32 v17, 0xffff0000, v168
    v_lshlrev_b32 v18, 16, v169
    v_and_b32 v19, 0xffff0000, v169
    v_lshlrev_b32 v20, 16, v170
    v_and_b32 v21, 0xffff0000, v170
    v_lshlrev_b32 v22, 16, v171
    v_and_b32 v23, 0xffff0000, v171
    v_pk_fma_f32 v[8:9], v[80:81], v[8:9], v[16:17]
    v_pk_fma_f32 v[10:11], v[82:83], v[10:11], v[18:19]
    v_pk_fma_f32 v[12:13], v[84:85], v[12:13], v[20:21]
    v_pk_fma_f32 v[14:15], v[86:87], v[14:15], v[22:23]
    v_cvt_pk_bf16_f32 v24, v8, v9
    v_cvt_pk_bf16_f32 v25, v10, v11
    v_cvt_pk_bf16_f32 v26, v12, v13
    v_cvt_pk_bf16_f32 v27, v14, v15
    s_nop 0
    v_permlane32_swap_b32 v24, v26
    v_permlane32_swap_b32 v25, v27
    s_nop 0
    v_permlane16_swap_b32 v24, v26
    v_permlane16_swap_b32 v25, v27
    buffer_store_dwordx4 v[24:27], v252, s[92:95], s53 offen offset:0 sc1
    s_waitcnt vmcnt(7)
    v_permlane16_swap_b32 v172, v174
    v_permlane16_swap_b32 v173, v175
    v_lshlrev_b32 v36, 16, v204
    v_and_b32 v37, 0xffff0000, v204
    v_lshlrev_b32 v38, 16, v205
    v_and_b32 v39, 0xffff0000, v205
    v_lshlrev_b32 v40, 16, v206
    v_and_b32 v41, 0xffff0000, v206
    v_lshlrev_b32 v42, 16, v207
    v_and_b32 v43, 0xffff0000, v207
    v_permlane32_swap_b32 v172, v174
    v_permlane32_swap_b32 v173, v175
    v_lshlrev_b32 v44, 16, v172
    v_and_b32 v45, 0xffff0000, v172
    v_lshlrev_b32 v46, 16, v173
    v_and_b32 v47, 0xffff0000, v173
    v_lshlrev_b32 v48, 16, v174
    v_and_b32 v49, 0xffff0000, v174
    v_lshlrev_b32 v50, 16, v175
    v_and_b32 v51, 0xffff0000, v175
    v_pk_fma_f32 v[36:37], v[88:89], v[36:37], v[44:45]
    v_pk_fma_f32 v[38:39], v[90:91], v[38:39], v[46:47]
    v_pk_fma_f32 v[40:41], v[92:93], v[40:41], v[48:49]
    v_pk_fma_f32 v[42:43], v[94:95], v[42:43], v[50:51]
    v_cvt_pk_bf16_f32 v52, v36, v37
    v_cvt_pk_bf16_f32 v53, v38, v39
    v_cvt_pk_bf16_f32 v54, v40, v41
    v_cvt_pk_bf16_f32 v55, v42, v43
    s_nop 0
    v_permlane32_swap_b32 v52, v54
    v_permlane32_swap_b32 v53, v55
    s_nop 0
    v_permlane16_swap_b32 v52, v54
    v_permlane16_swap_b32 v53, v55
    buffer_store_dwordx4 v[52:55], v252, s[92:95], s53 offen offset:64 sc1
    s_add_u32 s53, s53, 32768
    s_waitcnt vmcnt(7)
    v_permlane16_swap_b32 v176, v178
    v_permlane16_swap_b32 v177, v179
    v_lshlrev_b32 v8, 16, v208
    v_and_b32 v9, 0xffff0000, v208
    v_lshlrev_b32 v10, 16, v209
    v_and_b32 v11, 0xffff0000, v209
    v_lshlrev_b32 v12, 16, v210
    v_and_b32 v13, 0xffff0000, v210
    v_lshlrev_b32 v14, 16, v211
    v_and_b32 v15, 0xffff0000, v211
    v_permlane32_swap_b32 v176, v178
    v_permlane32_swap_b32 v177, v179
    v_lshlrev_b32 v16, 16, v176
    v_and_b32 v17, 0xffff0000, v176
    v_lshlrev_b32 v18, 16, v177
    v_and_b32 v19, 0xffff0000, v177
    v_lshlrev_b32 v20, 16, v178
    v_and_b32 v21, 0xffff0000, v178
    v_lshlrev_b32 v22, 16, v179
    v_and_b32 v23, 0xffff0000, v179
    v_pk_fma_f32 v[8:9], v[96:97], v[8:9], v[16:17]
    v_pk_fma_f32 v[10:11], v[98:99], v[10:11], v[18:19]
    v_pk_fma_f32 v[12:13], v[100:101], v[12:13], v[20:21]
    v_pk_fma_f32 v[14:15], v[102:103], v[14:15], v[22:23]
    v_cvt_pk_bf16_f32 v24, v8, v9
    v_cvt_pk_bf16_f32 v25, v10, v11
    v_cvt_pk_bf16_f32 v26, v12, v13
    v_cvt_pk_bf16_f32 v27, v14, v15
    s_nop 0
    v_permlane32_swap_b32 v24, v26
    v_permlane32_swap_b32 v25, v27
    s_nop 0
    v_permlane16_swap_b32 v24, v26
    v_permlane16_swap_b32 v25, v27
    buffer_store_dwordx4 v[24:27], v252, s[92:95], s53 offen offset:0 sc1
    s_waitcnt vmcnt(7)
    v_permlane16_swap_b32 v180, v182
    v_permlane16_swap_b32 v181, v183
    v_lshlrev_b32 v36, 16, v212
    v_and_b32 v37, 0xffff0000, v212
    v_lshlrev_b32 v38, 16, v213
    v_and_b32 v39, 0xffff0000, v213
    v_lshlrev_b32 v40, 16, v214
    v_and_b32 v41, 0xffff0000, v214
    v_lshlrev_b32 v42, 16, v215
    v_and_b32 v43, 0xffff0000, v215
    v_permlane32_swap_b32 v180, v182
    v_permlane32_swap_b32 v181, v183
    v_lshlrev_b32 v44, 16, v180
    v_and_b32 v45, 0xffff0000, v180
    v_lshlrev_b32 v46, 16, v181
    v_and_b32 v47, 0xffff0000, v181
    v_lshlrev_b32 v48, 16, v182
    v_and_b32 v49, 0xffff0000, v182
    v_lshlrev_b32 v50, 16, v183
    v_and_b32 v51, 0xffff0000, v183
    v_pk_fma_f32 v[36:37], v[104:105], v[36:37], v[44:45]
    v_pk_fma_f32 v[38:39], v[106:107], v[38:39], v[46:47]
    v_pk_fma_f32 v[40:41], v[108:109], v[40:41], v[48:49]
    v_pk_fma_f32 v[42:43], v[110:111], v[42:43], v[50:51]
    v_cvt_pk_bf16_f32 v52, v36, v37
    v_cvt_pk_bf16_f32 v53, v38, v39
    v_cvt_pk_bf16_f32 v54, v40, v41
    v_cvt_pk_bf16_f32 v55, v42, v43
    s_nop 0
    v_permlane32_swap_b32 v52, v54
    v_permlane32_swap_b32 v53, v55
    s_nop 0
    v_permlane16_swap_b32 v52, v54
    v_permlane16_swap_b32 v53, v55
    buffer_store_dwordx4 v[52:55], v252, s[92:95], s53 offen offset:64 sc1
    s_add_u32 s53, s53, 32768
    s_waitcnt vmcnt(7)
    v_permlane16_swap_b32 v184, v186
    v_permlane16_swap_b32 v185, v187
    v_lshlrev_b32 v8, 16, v216
    v_and_b32 v9, 0xffff0000, v216
    v_lshlrev_b32 v10, 16, v217
    v_and_b32 v11, 0xffff0000, v217
    v_lshlrev_b32 v12, 16, v218
    v_and_b32 v13, 0xffff0000, v218
    v_lshlrev_b32 v14, 16, v219
    v_and_b32 v15, 0xffff0000, v219
    v_permlane32_swap_b32 v184, v186
    v_permlane32_swap_b32 v185, v187
    v_lshlrev_b32 v16, 16, v184
    v_and_b32 v17, 0xffff0000, v184
    v_lshlrev_b32 v18, 16, v185
    v_and_b32 v19, 0xffff0000, v185
    v_lshlrev_b32 v20, 16, v186
    v_and_b32 v21, 0xffff0000, v186
    v_lshlrev_b32 v22, 16, v187
    v_and_b32 v23, 0xffff0000, v187
    v_pk_fma_f32 v[8:9], v[112:113], v[8:9], v[16:17]
    v_pk_fma_f32 v[10:11], v[114:115], v[10:11], v[18:19]
    v_pk_fma_f32 v[12:13], v[116:117], v[12:13], v[20:21]
    v_pk_fma_f32 v[14:15], v[118:119], v[14:15], v[22:23]
    v_cvt_pk_bf16_f32 v24, v8, v9
    v_cvt_pk_bf16_f32 v25, v10, v11
    v_cvt_pk_bf16_f32 v26, v12, v13
    v_cvt_pk_bf16_f32 v27, v14, v15
    s_nop 0
    v_permlane32_swap_b32 v24, v26
    v_permlane32_swap_b32 v25, v27
    s_nop 0
    v_permlane16_swap_b32 v24, v26
    v_permlane16_swap_b32 v25, v27
    buffer_store_dwordx4 v[24:27], v252, s[92:95], s53 offen offset:0 sc1
    s_waitcnt vmcnt(7)
    v_permlane16_swap_b32 v188, v190
    v_permlane16_swap_b32 v189, v191
    v_lshlrev_b32 v36, 16, v220
    v_and_b32 v37, 0xffff0000, v220
    v_lshlrev_b32 v38, 16, v221
    v_and_b32 v39, 0xffff0000, v221
    v_lshlrev_b32 v40, 16, v222
    v_and_b32 v41, 0xffff0000, v222
    v_lshlrev_b32 v42, 16, v223
    v_and_b32 v43, 0xffff0000, v223
    v_permlane32_swap_b32 v188, v190
    v_permlane32_swap_b32 v189, v191
    v_lshlrev_b32 v44, 16, v188
    v_and_b32 v45, 0xffff0000, v188
    v_lshlrev_b32 v46, 16, v189
    v_and_b32 v47, 0xffff0000, v189
    v_lshlrev_b32 v48, 16, v190
    v_and_b32 v49, 0xffff0000, v190
    v_lshlrev_b32 v50, 16, v191
    v_and_b32 v51, 0xffff0000, v191
    v_pk_fma_f32 v[36:37], v[120:121], v[36:37], v[44:45]
    v_pk_fma_f32 v[38:39], v[122:123], v[38:39], v[46:47]
    v_pk_fma_f32 v[40:41], v[124:125], v[40:41], v[48:49]
    v_pk_fma_f32 v[42:43], v[126:127], v[42:43], v[50:51]
    v_cvt_pk_bf16_f32 v52, v36, v37
    v_cvt_pk_bf16_f32 v53, v38, v39
    v_cvt_pk_bf16_f32 v54, v40, v41
    v_cvt_pk_bf16_f32 v55, v42, v43
    s_nop 0
    v_permlane32_swap_b32 v52, v54
    v_permlane32_swap_b32 v53, v55
    s_nop 0
    v_permlane16_swap_b32 v52, v54
    v_permlane16_swap_b32 v53, v55
    buffer_store_dwordx4 v[52:55], v252, s[92:95], s53 offen offset:64 sc1
    s_branch main_kernel_w_done
main_kernel_w_c0_gov:
    v_lshrrev_b32 v0, 4, v250
    v_bfe_u32 v1, v250, 2, 2
    v_lshl_add_u32 v4, v0, 2, v1
    v_and_b32 v5, 7, v4
    v_mul_u32_u24 v4, 256, v4
    v_and_b32 v6, 3, v250
    v_lshl_add_u32 v4, v6, 3, v4
    s_mul_i32 s32, s37, 4
    v_xor_b32 v5, s32, v5
    v_lshl_add_u32 v128, v5, 5, v4
    v_xor_b32 v129, 32, v128
    v_xor_b32 v130, 64, v128
    v_xor_b32 v131, 96, v128
    s_mul_i32 s32, s38, 8192
    s_add_u32 s32, s32, 65536
    v_add_u32 v136, s32, v251
    v_lshrrev_b32 v2, 4, v250
    v_and_b32 v3, 15, v250
    s_mul_i32 s32, s14, 16
    v_add_u32 v4, s32, v2
    v_add_u32 v5, 0, v4
    v_and_b32 v6, 7, v5
    v_lshlrev_b32 v6, 1, v6
    v_xor_b32 v6, v6, v3
    v_mul_lo_u32 v5, v5, s30
    v_lshl_add_u32 v5, v6, 4, v5
    v_subrev_u32 v137, 0, v5
    v_add_u32 v5, 4, v4
    v_and_b32 v6, 7, v5
    v_lshlrev_b32 v6, 1, v6
    v_xor_b32 v6, v6, v3
    v_mul_lo_u32 v5, v5, s30
    v_lshl_add_u32 v5, v6, 4, v5
    v_subrev_u32 v138, 1024, v5
    v_add_u32 v5, 8, v4
    v_and_b32 v6, 7, v5
    v_lshlrev_b32 v6, 1, v6
    v_xor_b32 v6, v6, v3
    v_mul_lo_u32 v5, v5, s30
    v_lshl_add_u32 v5, v6, 4, v5
    v_subrev_u32 v139, 2048, v5
    v_add_u32 v5, 12, v4
    v_and_b32 v6, 7, v5
    v_lshlrev_b32 v6, 1, v6
    v_xor_b32 v6, v6, v3
    v_mul_lo_u32 v5, v5, s30
    v_lshl_add_u32 v5, v6, 4, v5
    v_subrev_u32 v140, 3072, v5
    s_mul_i32 s32, s14, 2
    s_mul_i32 s32, s32, s31
    v_add_u32 v141, s32, v251
    s_add_u32 s32, s32, s31
    s_sub_u32 s32, s32, 2048
    v_add_u32 v142, s32, v251
    s_mul_i32 s19, s14, 4096
    s_mul_i32 s20, s14, 4096
    s_add_u32 s20, s20, 65536
    s_mul_i32 s17, s30, 64
    s_mov_b32 s15, 0
    s_add_u32 m0, s20, 0
    s_nop 0
    buffer_load_dwordx4 v141, s[4:7], s16 offen offset:0 sc1 lds
    buffer_load_dwordx4 v141, s[4:7], s16 offen offset:1024 sc1 lds
    buffer_load_dwordx4 v142, s[4:7], s16 offen offset:2048 sc1 lds
    buffer_load_dwordx4 v142, s[4:7], s16 offen offset:3072 sc1 lds
    s_add_u32 s16, s16, 2048
    s_add_u32 m0, s19, 0
    s_nop 0
    buffer_load_dwordx4 v137, s[8:11], s15 offen offset:0 lds
    buffer_load_dwordx4 v138, s[8:11], s15 offen offset:1024 lds
    buffer_load_dwordx4 v139, s[8:11], s15 offen offset:2048 lds
    buffer_load_dwordx4 v140, s[8:11], s15 offen offset:3072 lds
    s_add_u32 s15, s15, s17
    s_add_u32 m0, s20, 16384
    s_nop 0
    buffer_load_dwordx4 v141, s[4:7], s16 offen offset:0 sc1 lds
    buffer_load_dwordx4 v141, s[4:7], s16 offen offset:1024 sc1 lds
    buffer_load_dwordx4 v142, s[4:7], s16 offen offset:2048 sc1 lds
    buffer_load_dwordx4 v142, s[4:7], s16 offen offset:3072 sc1 lds
    s_add_u32 s16, s16, 2048
    s_add_u32 m0, s19, 16384
    s_nop 0
    buffer_load_dwordx4 v137, s[8:11], s15 offen offset:0 lds
    buffer_load_dwordx4 v138, s[8:11], s15 offen offset:1024 lds
    buffer_load_dwordx4 v139, s[8:11], s15 offen offset:2048 lds
    buffer_load_dwordx4 v140, s[8:11], s15 offen offset:3072 lds
    s_add_u32 s15, s15, s17
    s_add_u32 m0, s20, 32768
    s_nop 0
    buffer_load_dwordx4 v141, s[4:7], s16 offen offset:0 sc1 lds
    buffer_load_dwordx4 v141, s[4:7], s16 offen offset:1024 sc1 lds
    buffer_load_dwordx4 v142, s[4:7], s16 offen offset:2048 sc1 lds
    buffer_load_dwordx4 v142, s[4:7], s16 offen offset:3072 sc1 lds
    s_add_u32 s16, s16, 2048
    s_add_u32 m0, s19, 32768
    s_nop 0
    buffer_load_dwordx4 v137, s[8:11], s15 offen offset:0 lds
    buffer_load_dwordx4 v138, s[8:11], s15 offen offset:1024 lds
    buffer_load_dwordx4 v139, s[8:11], s15 offen offset:2048 lds
    buffer_load_dwordx4 v140, s[8:11], s15 offen offset:3072 lds
    s_add_u32 s15, s15, s17
    s_add_u32 m0, s20, 49152
    s_nop 0
    buffer_load_dwordx4 v141, s[4:7], s16 offen offset:0 sc1 lds
    buffer_load_dwordx4 v141, s[4:7], s16 offen offset:1024 sc1 lds
    buffer_load_dwordx4 v142, s[4:7], s16 offen offset:2048 sc1 lds
    buffer_load_dwordx4 v142, s[4:7], s16 offen offset:3072 sc1 lds
    s_add_u32 s16, s16, 2048
    v_mov_b32 v64, 0
    v_mov_b32 v65, 0
    v_mov_b32 v66, 0
    v_mov_b32 v67, 0
    v_mov_b32 v68, 0
    v_mov_b32 v69, 0
    v_mov_b32 v70, 0
    v_mov_b32 v71, 0
    v_mov_b32 v72, 0
    v_mov_b32 v73, 0
    v_mov_b32 v74, 0
    v_mov_b32 v75, 0
    v_mov_b32 v76, 0
    v_mov_b32 v77, 0
    v_mov_b32 v78, 0
    v_mov_b32 v79, 0
    v_mov_b32 v80, 0
    v_mov_b32 v81, 0
    v_mov_b32 v82, 0
    v_mov_b32 v83, 0
    v_mov_b32 v84, 0
    v_mov_b32 v85, 0
    v_mov_b32 v86, 0
    v_mov_b32 v87, 0
    v_mov_b32 v88, 0
    v_mov_b32 v89, 0
    v_mov_b32 v90, 0
    v_mov_b32 v91, 0
    v_mov_b32 v92, 0
    v_mov_b32 v93, 0
    v_mov_b32 v94, 0
    v_mov_b32 v95, 0
    v_mov_b32 v96, 0
    v_mov_b32 v97, 0
    v_mov_b32 v98, 0
    v_mov_b32 v99, 0
    v_mov_b32 v100, 0
    v_mov_b32 v101, 0
    v_mov_b32 v102, 0
    v_mov_b32 v103, 0
    v_mov_b32 v104, 0
    v_mov_b32 v105, 0
    v_mov_b32 v106, 0
    v_mov_b32 v107, 0
    v_mov_b32 v108, 0
    v_mov_b32 v109, 0
    v_mov_b32 v110, 0
    v_mov_b32 v111, 0
    v_mov_b32 v112, 0
    v_mov_b32 v113, 0
    v_mov_b32 v114, 0
    v_mov_b32 v115, 0
    v_mov_b32 v116, 0
    v_mov_b32 v117, 0
    v_mov_b32 v118, 0
    v_mov_b32 v119, 0
    v_mov_b32 v120, 0
    v_mov_b32 v121, 0
    v_mov_b32 v122, 0
    v_mov_b32 v123, 0
    v_mov_b32 v124, 0
    v_mov_b32 v125, 0
    v_mov_b32 v126, 0
    v_mov_b32 v127, 0
    s_waitcnt vmcnt(20)
    s_barrier
    ds_read_b128 v[16:19], v136 offset:0
    ds_read_b64_tr_b16 v[0:1], v128 offset:0
    ds_read_b64_tr_b16 v[2:3], v128 offset:4096
    ds_read_b64_tr_b16 v[4:5], v129 offset:0
    ds_read_b64_tr_b16 v[6:7], v129 offset:4096
    ds_read_b64_tr_b16 v[8:9], v130 offset:0
    ds_read_b64_tr_b16 v[10:11], v130 offset:4096
    ds_read_b64_tr_b16 v[12:13], v131 offset:0
    ds_read_b64_tr_b16 v[14:15], v131 offset:4096
    ds_read_b128 v[20:23], v136 offset:2048
    ds_read_b128 v[24:27], v136 offset:4096
    ds_read_b128 v[28:31], v136 offset:6144
main_kernel_w_c0_v_loop:
    s_waitcnt lgkmcnt(0)
    ds_read_b128 v[48:51], v136 offset:1024
    s_add_u32 m0, s19, 49152
    s_nop 0
    v_mfma_f32_16x16x32_bf16 v[64:67], v[16:19], v[0:3], v[64:67]
    ds_read_b64_tr_b16 v[32:33], v128 offset:8192
    v_mfma_f32_16x16x32_bf16 v[68:71], v[16:19], v[4:7], v[68:71]
    ds_read_b64_tr_b16 v[34:35], v128 offset:12288
    buffer_load_dwordx4 v137, s[8:11], s15 offen offset:0 lds
    v_mfma_f32_16x16x32_bf16 v[72:75], v[16:19], v[8:11], v[72:75]
    ds_read_b64_tr_b16 v[36:37], v129 offset:8192
    v_mfma_f32_16x16x32_bf16 v[76:79], v[16:19], v[12:15], v[76:79]
    ds_read_b64_tr_b16 v[38:39], v129 offset:12288
    v_mfma_f32_16x16x32_bf16 v[80:83], v[20:23], v[0:3], v[80:83]
    ds_read_b64_tr_b16 v[40:41], v130 offset:8192
    buffer_load_dwordx4 v138, s[8:11], s15 offen offset:1024 lds
    v_mfma_f32_16x16x32_bf16 v[84:87], v[20:23], v[4:7], v[84:87]
    ds_read_b64_tr_b16 v[42:43], v130 offset:12288
    v_mfma_f32_16x16x32_bf16 v[88:91], v[20:23], v[8:11], v[88:91]
    ds_read_b64_tr_b16 v[44:45], v131 offset:8192
    v_mfma_f32_16x16x32_bf16 v[92:95], v[20:23], v[12:15], v[92:95]
    ds_read_b64_tr_b16 v[46:47], v131 offset:12288
    buffer_load_dwordx4 v139, s[8:11], s15 offen offset:2048 lds
    v_mfma_f32_16x16x32_bf16 v[96:99], v[24:27], v[0:3], v[96:99]
    ds_read_b128 v[52:55], v136 offset:3072
    v_mfma_f32_16x16x32_bf16 v[100:103], v[24:27], v[4:7], v[100:103]
    ds_read_b128 v[56:59], v136 offset:5120
    buffer_load_dwordx4 v140, s[8:11], s15 offen offset:3072 lds
    v_mfma_f32_16x16x32_bf16 v[104:107], v[24:27], v[8:11], v[104:107]
    ds_read_b128 v[60:63], v136 offset:7168
    v_mfma_f32_16x16x32_bf16 v[108:111], v[24:27], v[12:15], v[108:111]
    v_mfma_f32_16x16x32_bf16 v[112:115], v[28:31], v[0:3], v[112:115]
    s_add_u32 s15, s15, s17
    v_mfma_f32_16x16x32_bf16 v[116:119], v[28:31], v[4:7], v[116:119]
    v_mfma_f32_16x16x32_bf16 v[120:123], v[28:31], v[8:11], v[120:123]
    v_mfma_f32_16x16x32_bf16 v[124:127], v[28:31], v[12:15], v[124:127]
    s_waitcnt lgkmcnt(0)
    v_mfma_f32_16x16x32_bf16 v[64:67], v[48:51], v[32:35], v[64:67]
    s_waitcnt vmcnt(16)
    s_barrier
    ds_read_b128 v[16:19], v136 offset:16384
    s_add_u32 m0, s20, 0
    s_nop 0
    v_mfma_f32_16x16x32_bf16 v[68:71], v[48:51], v[36:39], v[68:71]
    ds_read_b64_tr_b16 v[0:1], v128 offset:16384
    v_mfma_f32_16x16x32_bf16 v[72:75], v[48:51], v[40:43], v[72:75]
    ds_read_b64_tr_b16 v[2:3], v128 offset:20480
    buffer_load_dwordx4 v141, s[4:7], s16 offen offset:0 sc1 lds
    v_mfma_f32_16x16x32_bf16 v[76:79], v[48:51], v[44:47], v[76:79]
    ds_read_b64_tr_b16 v[4:5], v129 offset:16384
    v_mfma_f32_16x16x32_bf16 v[80:83], v[52:55], v[32:35], v[80:83]
    ds_read_b64_tr_b16 v[6:7], v129 offset:20480
    v_mfma_f32_16x16x32_bf16 v[84:87], v[52:55], v[36:39], v[84:87]
    ds_read_b64_tr_b16 v[8:9], v130 offset:16384
    buffer_load_dwordx4 v141, s[4:7], s16 offen offset:1024 sc1 lds
    v_mfma_f32_16x16x32_bf16 v[88:91], v[52:55], v[40:43], v[88:91]
    ds_read_b64_tr_b16 v[10:11], v130 offset:20480
    v_mfma_f32_16x16x32_bf16 v[92:95], v[52:55], v[44:47], v[92:95]
    ds_read_b64_tr_b16 v[12:13], v131 offset:16384
    buffer_load_dwordx4 v142, s[4:7], s16 offen offset:2048 sc1 lds
    v_mfma_f32_16x16x32_bf16 v[96:99], v[56:59], v[32:35], v[96:99]
    ds_read_b64_tr_b16 v[14:15], v131 offset:20480
    v_mfma_f32_16x16x32_bf16 v[100:103], v[56:59], v[36:39], v[100:103]
    ds_read_b128 v[20:23], v136 offset:18432
    v_mfma_f32_16x16x32_bf16 v[104:107], v[56:59], v[40:43], v[104:107]
    ds_read_b128 v[24:27], v136 offset:20480
    buffer_load_dwordx4 v142, s[4:7], s16 offen offset:3072 sc1 lds
    v_mfma_f32_16x16x32_bf16 v[108:111], v[56:59], v[44:47], v[108:111]
    ds_read_b128 v[28:31], v136 offset:22528
    v_mfma_f32_16x16x32_bf16 v[112:115], v[60:63], v[32:35], v[112:115]
    s_add_u32 s16, s16, 2048
    v_mfma_f32_16x16x32_bf16 v[116:119], v[60:63], v[36:39], v[116:119]
    v_mfma_f32_16x16x32_bf16 v[120:123], v[60:63], v[40:43], v[120:123]
    v_mfma_f32_16x16x32_bf16 v[124:127], v[60:63], v[44:47], v[124:127]
    s_waitcnt lgkmcnt(0)
    ds_read_b128 v[48:51], v136 offset:17408
    s_add_u32 m0, s19, 0
    s_nop 0
    v_mfma_f32_16x16x32_bf16 v[64:67], v[16:19], v[0:3], v[64:67]
    ds_read_b64_tr_b16 v[32:33], v128 offset:24576
    v_mfma_f32_16x16x32_bf16 v[68:71], v[16:19], v[4:7], v[68:71]
    ds_read_b64_tr_b16 v[34:35], v128 offset:28672
    buffer_load_dwordx4 v137, s[8:11], s15 offen offset:0 lds
    v_mfma_f32_16x16x32_bf16 v[72:75], v[16:19], v[8:11], v[72:75]
    ds_read_b64_tr_b16 v[36:37], v129 offset:24576
    v_mfma_f32_16x16x32_bf16 v[76:79], v[16:19], v[12:15], v[76:79]
    ds_read_b64_tr_b16 v[38:39], v129 offset:28672
    v_mfma_f32_16x16x32_bf16 v[80:83], v[20:23], v[0:3], v[80:83]
    ds_read_b64_tr_b16 v[40:41], v130 offset:24576
    buffer_load_dwordx4 v138, s[8:11], s15 offen offset:1024 lds
    v_mfma_f32_16x16x32_bf16 v[84:87], v[20:23], v[4:7], v[84:87]
    ds_read_b64_tr_b16 v[42:43], v130 offset:28672
    v_mfma_f32_16x16x32_bf16 v[88:91], v[20:23], v[8:11], v[88:91]
    ds_read_b64_tr_b16 v[44:45], v131 offset:24576
    v_mfma_f32_16x16x32_bf16 v[92:95], v[20:23], v[12:15], v[92:95]
    ds_read_b64_tr_b16 v[46:47], v131 offset:28672
    buffer_load_dwordx4 v139, s[8:11], s15 offen offset:2048 lds
    v_mfma_f32_16x16x32_bf16 v[96:99], v[24:27], v[0:3], v[96:99]
    ds_read_b128 v[52:55], v136 offset:19456
    v_mfma_f32_16x16x32_bf16 v[100:103], v[24:27], v[4:7], v[100:103]
    ds_read_b128 v[56:59], v136 offset:21504
    buffer_load_dwordx4 v140, s[8:11], s15 offen offset:3072 lds
    v_mfma_f32_16x16x32_bf16 v[104:107], v[24:27], v[8:11], v[104:107]
    ds_read_b128 v[60:63], v136 offset:23552
    v_mfma_f32_16x16x32_bf16 v[108:111], v[24:27], v[12:15], v[108:111]
    v_mfma_f32_16x16x32_bf16 v[112:115], v[28:31], v[0:3], v[112:115]
    s_add_u32 s15, s15, s17
    v_mfma_f32_16x16x32_bf16 v[116:119], v[28:31], v[4:7], v[116:119]
    v_mfma_f32_16x16x32_bf16 v[120:123], v[28:31], v[8:11], v[120:123]
    v_mfma_f32_16x16x32_bf16 v[124:127], v[28:31], v[12:15], v[124:127]
    s_waitcnt lgkmcnt(0)
    v_mfma_f32_16x16x32_bf16 v[64:67], v[48:51], v[32:35], v[64:67]
    s_waitcnt vmcnt(16)
    s_barrier
    ds_read_b128 v[16:19], v136 offset:32768
    s_add_u32 m0, s20, 16384
    s_nop 0
    v_mfma_f32_16x16x32_bf16 v[68:71], v[48:51], v[36:39], v[68:71]
    ds_read_b64_tr_b16 v[0:1], v128 offset:32768
    v_mfma_f32_16x16x32_bf16 v[72:75], v[48:51], v[40:43], v[72:75]
    ds_read_b64_tr_b16 v[2:3], v128 offset:36864
    buffer_load_dwordx4 v141, s[4:7], s16 offen offset:0 sc1 lds
    v_mfma_f32_16x16x32_bf16 v[76:79], v[48:51], v[44:47], v[76:79]
    ds_read_b64_tr_b16 v[4:5], v129 offset:32768
    v_mfma_f32_16x16x32_bf16 v[80:83], v[52:55], v[32:35], v[80:83]
    ds_read_b64_tr_b16 v[6:7], v129 offset:36864
    v_mfma_f32_16x16x32_bf16 v[84:87], v[52:55], v[36:39], v[84:87]
    ds_read_b64_tr_b16 v[8:9], v130 offset:32768
    buffer_load_dwordx4 v141, s[4:7], s16 offen offset:1024 sc1 lds
    v_mfma_f32_16x16x32_bf16 v[88:91], v[52:55], v[40:43], v[88:91]
    ds_read_b64_tr_b16 v[10:11], v130 offset:36864
    v_mfma_f32_16x16x32_bf16 v[92:95], v[52:55], v[44:47], v[92:95]
    ds_read_b64_tr_b16 v[12:13], v131 offset:32768
    buffer_load_dwordx4 v142, s[4:7], s16 offen offset:2048 sc1 lds
    v_mfma_f32_16x16x32_bf16 v[96:99], v[56:59], v[32:35], v[96:99]
    ds_read_b64_tr_b16 v[14:15], v131 offset:36864
    v_mfma_f32_16x16x32_bf16 v[100:103], v[56:59], v[36:39], v[100:103]
    ds_read_b128 v[20:23], v136 offset:34816
    v_mfma_f32_16x16x32_bf16 v[104:107], v[56:59], v[40:43], v[104:107]
    ds_read_b128 v[24:27], v136 offset:36864
    buffer_load_dwordx4 v142, s[4:7], s16 offen offset:3072 sc1 lds
    v_mfma_f32_16x16x32_bf16 v[108:111], v[56:59], v[44:47], v[108:111]
    ds_read_b128 v[28:31], v136 offset:38912
    v_mfma_f32_16x16x32_bf16 v[112:115], v[60:63], v[32:35], v[112:115]
    s_add_u32 s16, s16, 2048
    v_mfma_f32_16x16x32_bf16 v[116:119], v[60:63], v[36:39], v[116:119]
    v_mfma_f32_16x16x32_bf16 v[120:123], v[60:63], v[40:43], v[120:123]
    v_mfma_f32_16x16x32_bf16 v[124:127], v[60:63], v[44:47], v[124:127]
    s_waitcnt lgkmcnt(0)
    ds_read_b128 v[48:51], v136 offset:33792
    s_add_u32 m0, s19, 16384
    s_nop 0
    v_mfma_f32_16x16x32_bf16 v[64:67], v[16:19], v[0:3], v[64:67]
    ds_read_b64_tr_b16 v[32:33], v128 offset:40960
    v_mfma_f32_16x16x32_bf16 v[68:71], v[16:19], v[4:7], v[68:71]
    ds_read_b64_tr_b16 v[34:35], v128 offset:45056
    buffer_load_dwordx4 v137, s[8:11], s15 offen offset:0 lds
    v_mfma_f32_16x16x32_bf16 v[72:75], v[16:19], v[8:11], v[72:75]
    ds_read_b64_tr_b16 v[36:37], v129 offset:40960
    v_mfma_f32_16x16x32_bf16 v[76:79], v[16:19], v[12:15], v[76:79]
    ds_read_b64_tr_b16 v[38:39], v129 offset:45056
    v_mfma_f32_16x16x32_bf16 v[80:83], v[20:23], v[0:3], v[80:83]
    ds_read_b64_tr_b16 v[40:41], v130 offset:40960
    buffer_load_dwordx4 v138, s[8:11], s15 offen offset:1024 lds
    v_mfma_f32_16x16x32_bf16 v[84:87], v[20:23], v[4:7], v[84:87]
    ds_read_b64_tr_b16 v[42:43], v130 offset:45056
    v_mfma_f32_16x16x32_bf16 v[88:91], v[20:23], v[8:11], v[88:91]
    ds_read_b64_tr_b16 v[44:45], v131 offset:40960
    v_mfma_f32_16x16x32_bf16 v[92:95], v[20:23], v[12:15], v[92:95]
    ds_read_b64_tr_b16 v[46:47], v131 offset:45056
    buffer_load_dwordx4 v139, s[8:11], s15 offen offset:2048 lds
    v_mfma_f32_16x16x32_bf16 v[96:99], v[24:27], v[0:3], v[96:99]
    ds_read_b128 v[52:55], v136 offset:35840
    v_mfma_f32_16x16x32_bf16 v[100:103], v[24:27], v[4:7], v[100:103]
    ds_read_b128 v[56:59], v136 offset:37888
    buffer_load_dwordx4 v140, s[8:11], s15 offen offset:3072 lds
    v_mfma_f32_16x16x32_bf16 v[104:107], v[24:27], v[8:11], v[104:107]
    ds_read_b128 v[60:63], v136 offset:39936
    v_mfma_f32_16x16x32_bf16 v[108:111], v[24:27], v[12:15], v[108:111]
    v_mfma_f32_16x16x32_bf16 v[112:115], v[28:31], v[0:3], v[112:115]
    s_add_u32 s15, s15, s17
    v_mfma_f32_16x16x32_bf16 v[116:119], v[28:31], v[4:7], v[116:119]
    v_mfma_f32_16x16x32_bf16 v[120:123], v[28:31], v[8:11], v[120:123]
    v_mfma_f32_16x16x32_bf16 v[124:127], v[28:31], v[12:15], v[124:127]
    s_waitcnt lgkmcnt(0)
    v_mfma_f32_16x16x32_bf16 v[64:67], v[48:51], v[32:35], v[64:67]
    s_waitcnt vmcnt(16)
    s_barrier
    ds_read_b128 v[16:19], v136 offset:49152
    s_add_u32 m0, s20, 32768
    s_nop 0
    v_mfma_f32_16x16x32_bf16 v[68:71], v[48:51], v[36:39], v[68:71]
    ds_read_b64_tr_b16 v[0:1], v128 offset:49152
    v_mfma_f32_16x16x32_bf16 v[72:75], v[48:51], v[40:43], v[72:75]
    ds_read_b64_tr_b16 v[2:3], v128 offset:53248
    buffer_load_dwordx4 v141, s[4:7], s16 offen offset:0 sc1 lds
    v_mfma_f32_16x16x32_bf16 v[76:79], v[48:51], v[44:47], v[76:79]
    ds_read_b64_tr_b16 v[4:5], v129 offset:49152
    v_mfma_f32_16x16x32_bf16 v[80:83], v[52:55], v[32:35], v[80:83]
    ds_read_b64_tr_b16 v[6:7], v129 offset:53248
    v_mfma_f32_16x16x32_bf16 v[84:87], v[52:55], v[36:39], v[84:87]
    ds_read_b64_tr_b16 v[8:9], v130 offset:49152
    buffer_load_dwordx4 v141, s[4:7], s16 offen offset:1024 sc1 lds
    v_mfma_f32_16x16x32_bf16 v[88:91], v[52:55], v[40:43], v[88:91]
    ds_read_b64_tr_b16 v[10:11], v130 offset:53248
    v_mfma_f32_16x16x32_bf16 v[92:95], v[52:55], v[44:47], v[92:95]
    ds_read_b64_tr_b16 v[12:13], v131 offset:49152
    buffer_load_dwordx4 v142, s[4:7], s16 offen offset:2048 sc1 lds
    v_mfma_f32_16x16x32_bf16 v[96:99], v[56:59], v[32:35], v[96:99]
    ds_read_b64_tr_b16 v[14:15], v131 offset:53248
    v_mfma_f32_16x16x32_bf16 v[100:103], v[56:59], v[36:39], v[100:103]
    ds_read_b128 v[20:23], v136 offset:51200
    v_mfma_f32_16x16x32_bf16 v[104:107], v[56:59], v[40:43], v[104:107]
    ds_read_b128 v[24:27], v136 offset:53248
    buffer_load_dwordx4 v142, s[4:7], s16 offen offset:3072 sc1 lds
    v_mfma_f32_16x16x32_bf16 v[108:111], v[56:59], v[44:47], v[108:111]
    ds_read_b128 v[28:31], v136 offset:55296
    v_mfma_f32_16x16x32_bf16 v[112:115], v[60:63], v[32:35], v[112:115]
    s_add_u32 s16, s16, 2048
    v_mfma_f32_16x16x32_bf16 v[116:119], v[60:63], v[36:39], v[116:119]
    v_mfma_f32_16x16x32_bf16 v[120:123], v[60:63], v[40:43], v[120:123]
    v_mfma_f32_16x16x32_bf16 v[124:127], v[60:63], v[44:47], v[124:127]
    s_waitcnt lgkmcnt(0)
    ds_read_b128 v[48:51], v136 offset:50176
    s_add_u32 m0, s19, 32768
    s_nop 0
    v_mfma_f32_16x16x32_bf16 v[64:67], v[16:19], v[0:3], v[64:67]
    ds_read_b64_tr_b16 v[32:33], v128 offset:57344
    v_mfma_f32_16x16x32_bf16 v[68:71], v[16:19], v[4:7], v[68:71]
    ds_read_b64_tr_b16 v[34:35], v128 offset:61440
    buffer_load_dwordx4 v137, s[8:11], s15 offen offset:0 lds
    v_mfma_f32_16x16x32_bf16 v[72:75], v[16:19], v[8:11], v[72:75]
    ds_read_b64_tr_b16 v[36:37], v129 offset:57344
    v_mfma_f32_16x16x32_bf16 v[76:79], v[16:19], v[12:15], v[76:79]
    ds_read_b64_tr_b16 v[38:39], v129 offset:61440
    v_mfma_f32_16x16x32_bf16 v[80:83], v[20:23], v[0:3], v[80:83]
    ds_read_b64_tr_b16 v[40:41], v130 offset:57344
    buffer_load_dwordx4 v138, s[8:11], s15 offen offset:1024 lds
    v_mfma_f32_16x16x32_bf16 v[84:87], v[20:23], v[4:7], v[84:87]
    ds_read_b64_tr_b16 v[42:43], v130 offset:61440
    v_mfma_f32_16x16x32_bf16 v[88:91], v[20:23], v[8:11], v[88:91]
    ds_read_b64_tr_b16 v[44:45], v131 offset:57344
    v_mfma_f32_16x16x32_bf16 v[92:95], v[20:23], v[12:15], v[92:95]
    ds_read_b64_tr_b16 v[46:47], v131 offset:61440
    buffer_load_dwordx4 v139, s[8:11], s15 offen offset:2048 lds
    v_mfma_f32_16x16x32_bf16 v[96:99], v[24:27], v[0:3], v[96:99]
    ds_read_b128 v[52:55], v136 offset:52224
    v_mfma_f32_16x16x32_bf16 v[100:103], v[24:27], v[4:7], v[100:103]
    ds_read_b128 v[56:59], v136 offset:54272
    buffer_load_dwordx4 v140, s[8:11], s15 offen offset:3072 lds
    v_mfma_f32_16x16x32_bf16 v[104:107], v[24:27], v[8:11], v[104:107]
    ds_read_b128 v[60:63], v136 offset:56320
    v_mfma_f32_16x16x32_bf16 v[108:111], v[24:27], v[12:15], v[108:111]
    v_mfma_f32_16x16x32_bf16 v[112:115], v[28:31], v[0:3], v[112:115]
    s_add_u32 s15, s15, s17
    v_mfma_f32_16x16x32_bf16 v[116:119], v[28:31], v[4:7], v[116:119]
    v_mfma_f32_16x16x32_bf16 v[120:123], v[28:31], v[8:11], v[120:123]
    v_mfma_f32_16x16x32_bf16 v[124:127], v[28:31], v[12:15], v[124:127]
    s_waitcnt lgkmcnt(0)
    v_mfma_f32_16x16x32_bf16 v[64:67], v[48:51], v[32:35], v[64:67]
    s_waitcnt vmcnt(16)
    s_barrier
    ds_read_b128 v[16:19], v136 offset:0
    s_add_u32 m0, s20, 49152
    s_nop 0
    v_mfma_f32_16x16x32_bf16 v[68:71], v[48:51], v[36:39], v[68:71]
    ds_read_b64_tr_b16 v[0:1], v128 offset:0
    v_mfma_f32_16x16x32_bf16 v[72:75], v[48:51], v[40:43], v[72:75]
    ds_read_b64_tr_b16 v[2:3], v128 offset:4096
    buffer_load_dwordx4 v141, s[4:7], s16 offen offset:0 sc1 lds
    v_mfma_f32_16x16x32_bf16 v[76:79], v[48:51], v[44:47], v[76:79]
    ds_read_b64_tr_b16 v[4:5], v129 offset:0
    v_mfma_f32_16x16x32_bf16 v[80:83], v[52:55], v[32:35], v[80:83]
    ds_read_b64_tr_b16 v[6:7], v129 offset:4096
    v_mfma_f32_16x16x32_bf16 v[84:87], v[52:55], v[36:39], v[84:87]
    ds_read_b64_tr_b16 v[8:9], v130 offset:0
    buffer_load_dwordx4 v141, s[4:7], s16 offen offset:1024 sc1 lds
    v_mfma_f32_16x16x32_bf16 v[88:91], v[52:55], v[40:43], v[88:91]
    ds_read_b64_tr_b16 v[10:11], v130 offset:4096
    v_mfma_f32_16x16x32_bf16 v[92:95], v[52:55], v[44:47], v[92:95]
    ds_read_b64_tr_b16 v[12:13], v131 offset:0
    buffer_load_dwordx4 v142, s[4:7], s16 offen offset:2048 sc1 lds
    v_mfma_f32_16x16x32_bf16 v[96:99], v[56:59], v[32:35], v[96:99]
    ds_read_b64_tr_b16 v[14:15], v131 offset:4096
    v_mfma_f32_16x16x32_bf16 v[100:103], v[56:59], v[36:39], v[100:103]
    ds_read_b128 v[20:23], v136 offset:2048
    v_mfma_f32_16x16x32_bf16 v[104:107], v[56:59], v[40:43], v[104:107]
    ds_read_b128 v[24:27], v136 offset:4096
    buffer_load_dwordx4 v142, s[4:7], s16 offen offset:3072 sc1 lds
    v_mfma_f32_16x16x32_bf16 v[108:111], v[56:59], v[44:47], v[108:111]
    ds_read_b128 v[28:31], v136 offset:6144
    v_mfma_f32_16x16x32_bf16 v[112:115], v[60:63], v[32:35], v[112:115]
    s_add_u32 s16, s16, 2048
    v_mfma_f32_16x16x32_bf16 v[116:119], v[60:63], v[36:39], v[116:119]
    v_mfma_f32_16x16x32_bf16 v[120:123], v[60:63], v[40:43], v[120:123]
    v_mfma_f32_16x16x32_bf16 v[124:127], v[60:63], v[44:47], v[124:127]
    s_sub_u32 s18, s18, 1
    s_cmp_lg_u32 s18, 0
    s_cbranch_scc1 main_kernel_w_c0_v_loop
    s_cmp_lg_u32 s14, 0
    s_cbranch_scc1 main_kernel_w_c0_v_nt
    s_lshl_b32 s32, s27, 8
    s_add_u32 s32, s32, 0x841e000
    v_mov_b32 v255, 1
    s_mov_b64 exec, 1
    buffer_atomic_add v255, off, s[4:7], s32 sc0 sc1
    s_mov_b64 exec, -1
main_kernel_w_c0_v_nt:
    s_waitcnt lgkmcnt(0)
    ds_read_b128 v[48:51], v136 offset:1024
    s_add_u32 m0, s19, 49152
    s_nop 0
    v_mfma_f32_16x16x32_bf16 v[64:67], v[16:19], v[0:3], v[64:67]
    ds_read_b64_tr_b16 v[32:33], v128 offset:8192
    v_mfma_f32_16x16x32_bf16 v[68:71], v[16:19], v[4:7], v[68:71]
    ds_read_b64_tr_b16 v[34:35], v128 offset:12288
    buffer_load_dwordx4 v137, s[8:11], s15 offen offset:0 lds
    v_mfma_f32_16x16x32_bf16 v[72:75], v[16:19], v[8:11], v[72:75]
    ds_read_b64_tr_b16 v[36:37], v129 offset:8192
    v_mfma_f32_16x16x32_bf16 v[76:79], v[16:19], v[12:15], v[76:79]
    ds_read_b64_tr_b16 v[38:39], v129 offset:12288
    v_mfma_f32_16x16x32_bf16 v[80:83], v[20:23], v[0:3], v[80:83]
    ds_read_b64_tr_b16 v[40:41], v130 offset:8192
    buffer_load_dwordx4 v138, s[8:11], s15 offen offset:1024 lds
    v_mfma_f32_16x16x32_bf16 v[84:87], v[20:23], v[4:7], v[84:87]
    ds_read_b64_tr_b16 v[42:43], v130 offset:12288
    v_mfma_f32_16x16x32_bf16 v[88:91], v[20:23], v[8:11], v[88:91]
    ds_read_b64_tr_b16 v[44:45], v131 offset:8192
    v_mfma_f32_16x16x32_bf16 v[92:95], v[20:23], v[12:15], v[92:95]
    ds_read_b64_tr_b16 v[46:47], v131 offset:12288
    buffer_load_dwordx4 v139, s[8:11], s15 offen offset:2048 lds
    v_mfma_f32_16x16x32_bf16 v[96:99], v[24:27], v[0:3], v[96:99]
    ds_read_b128 v[52:55], v136 offset:3072
    v_mfma_f32_16x16x32_bf16 v[100:103], v[24:27], v[4:7], v[100:103]
    ds_read_b128 v[56:59], v136 offset:5120
    buffer_load_dwordx4 v140, s[8:11], s15 offen offset:3072 lds
    v_mfma_f32_16x16x32_bf16 v[104:107], v[24:27], v[8:11], v[104:107]
    ds_read_b128 v[60:63], v136 offset:7168
    v_mfma_f32_16x16x32_bf16 v[108:111], v[24:27], v[12:15], v[108:111]
    v_mfma_f32_16x16x32_bf16 v[112:115], v[28:31], v[0:3], v[112:115]
    s_add_u32 s15, s15, s17
    v_mfma_f32_16x16x32_bf16 v[116:119], v[28:31], v[4:7], v[116:119]
    v_mfma_f32_16x16x32_bf16 v[120:123], v[28:31], v[8:11], v[120:123]
    v_mfma_f32_16x16x32_bf16 v[124:127], v[28:31], v[12:15], v[124:127]
    s_waitcnt lgkmcnt(0)
    v_mfma_f32_16x16x32_bf16 v[64:67], v[48:51], v[32:35], v[64:67]
    s_waitcnt vmcnt(16)
    s_barrier
    ds_read_b128 v[16:19], v136 offset:16384
    v_mfma_f32_16x16x32_bf16 v[68:71], v[48:51], v[36:39], v[68:71]
    ds_read_b64_tr_b16 v[0:1], v128 offset:16384
    v_mfma_f32_16x16x32_bf16 v[72:75], v[48:51], v[40:43], v[72:75]
    ds_read_b64_tr_b16 v[2:3], v128 offset:20480
    v_mfma_f32_16x16x32_bf16 v[76:79], v[48:51], v[44:47], v[76:79]
    ds_read_b64_tr_b16 v[4:5], v129 offset:16384
    v_mfma_f32_16x16x32_bf16 v[80:83], v[52:55], v[32:35], v[80:83]
    ds_read_b64_tr_b16 v[6:7], v129 offset:20480
    v_mfma_f32_16x16x32_bf16 v[84:87], v[52:55], v[36:39], v[84:87]
    ds_read_b64_tr_b16 v[8:9], v130 offset:16384
    v_mfma_f32_16x16x32_bf16 v[88:91], v[52:55], v[40:43], v[88:91]
    ds_read_b64_tr_b16 v[10:11], v130 offset:20480
    v_mfma_f32_16x16x32_bf16 v[92:95], v[52:55], v[44:47], v[92:95]
    ds_read_b64_tr_b16 v[12:13], v131 offset:16384
    v_mfma_f32_16x16x32_bf16 v[96:99], v[56:59], v[32:35], v[96:99]
    ds_read_b64_tr_b16 v[14:15], v131 offset:20480
    v_mfma_f32_16x16x32_bf16 v[100:103], v[56:59], v[36:39], v[100:103]
    ds_read_b128 v[20:23], v136 offset:18432
    v_mfma_f32_16x16x32_bf16 v[104:107], v[56:59], v[40:43], v[104:107]
    ds_read_b128 v[24:27], v136 offset:20480
    v_mfma_f32_16x16x32_bf16 v[108:111], v[56:59], v[44:47], v[108:111]
    ds_read_b128 v[28:31], v136 offset:22528
    v_mfma_f32_16x16x32_bf16 v[112:115], v[60:63], v[32:35], v[112:115]
    v_mfma_f32_16x16x32_bf16 v[116:119], v[60:63], v[36:39], v[116:119]
    v_mfma_f32_16x16x32_bf16 v[120:123], v[60:63], v[40:43], v[120:123]
    v_mfma_f32_16x16x32_bf16 v[124:127], v[60:63], v[44:47], v[124:127]
    s_waitcnt lgkmcnt(0)
    ds_read_b128 v[48:51], v136 offset:17408
    v_mfma_f32_16x16x32_bf16 v[64:67], v[16:19], v[0:3], v[64:67]
    ds_read_b64_tr_b16 v[32:33], v128 offset:24576
    v_mfma_f32_16x16x32_bf16 v[68:71], v[16:19], v[4:7], v[68:71]
    ds_read_b64_tr_b16 v[34:35], v128 offset:28672
    v_mfma_f32_16x16x32_bf16 v[72:75], v[16:19], v[8:11], v[72:75]
    ds_read_b64_tr_b16 v[36:37], v129 offset:24576
    v_mfma_f32_16x16x32_bf16 v[76:79], v[16:19], v[12:15], v[76:79]
    ds_read_b64_tr_b16 v[38:39], v129 offset:28672
    v_mfma_f32_16x16x32_bf16 v[80:83], v[20:23], v[0:3], v[80:83]
    ds_read_b64_tr_b16 v[40:41], v130 offset:24576
    v_mfma_f32_16x16x32_bf16 v[84:87], v[20:23], v[4:7], v[84:87]
    ds_read_b64_tr_b16 v[42:43], v130 offset:28672
    v_mfma_f32_16x16x32_bf16 v[88:91], v[20:23], v[8:11], v[88:91]
    ds_read_b64_tr_b16 v[44:45], v131 offset:24576
    v_mfma_f32_16x16x32_bf16 v[92:95], v[20:23], v[12:15], v[92:95]
    ds_read_b64_tr_b16 v[46:47], v131 offset:28672
    v_mfma_f32_16x16x32_bf16 v[96:99], v[24:27], v[0:3], v[96:99]
    ds_read_b128 v[52:55], v136 offset:19456
    v_mfma_f32_16x16x32_bf16 v[100:103], v[24:27], v[4:7], v[100:103]
    ds_read_b128 v[56:59], v136 offset:21504
    v_mfma_f32_16x16x32_bf16 v[104:107], v[24:27], v[8:11], v[104:107]
    ds_read_b128 v[60:63], v136 offset:23552
    v_mfma_f32_16x16x32_bf16 v[108:111], v[24:27], v[12:15], v[108:111]
    v_mfma_f32_16x16x32_bf16 v[112:115], v[28:31], v[0:3], v[112:115]
    v_mfma_f32_16x16x32_bf16 v[116:119], v[28:31], v[4:7], v[116:119]
    v_mfma_f32_16x16x32_bf16 v[120:123], v[28:31], v[8:11], v[120:123]
    v_mfma_f32_16x16x32_bf16 v[124:127], v[28:31], v[12:15], v[124:127]
    s_waitcnt lgkmcnt(0)
    v_mfma_f32_16x16x32_bf16 v[64:67], v[48:51], v[32:35], v[64:67]
    s_waitcnt vmcnt(8)
    s_barrier
    ds_read_b128 v[16:19], v136 offset:32768
    v_mfma_f32_16x16x32_bf16 v[68:71], v[48:51], v[36:39], v[68:71]
    ds_read_b64_tr_b16 v[0:1], v128 offset:32768
    v_mfma_f32_16x16x32_bf16 v[72:75], v[48:51], v[40:43], v[72:75]
    ds_read_b64_tr_b16 v[2:3], v128 offset:36864
    v_mfma_f32_16x16x32_bf16 v[76:79], v[48:51], v[44:47], v[76:79]
    ds_read_b64_tr_b16 v[4:5], v129 offset:32768
    v_mfma_f32_16x16x32_bf16 v[80:83], v[52:55], v[32:35], v[80:83]
    ds_read_b64_tr_b16 v[6:7], v129 offset:36864
    v_mfma_f32_16x16x32_bf16 v[84:87], v[52:55], v[36:39], v[84:87]
    ds_read_b64_tr_b16 v[8:9], v130 offset:32768
    v_mfma_f32_16x16x32_bf16 v[88:91], v[52:55], v[40:43], v[88:91]
    ds_read_b64_tr_b16 v[10:11], v130 offset:36864
    v_mfma_f32_16x16x32_bf16 v[92:95], v[52:55], v[44:47], v[92:95]
    ds_read_b64_tr_b16 v[12:13], v131 offset:32768
    v_mfma_f32_16x16x32_bf16 v[96:99], v[56:59], v[32:35], v[96:99]
    ds_read_b64_tr_b16 v[14:15], v131 offset:36864
    v_mfma_f32_16x16x32_bf16 v[100:103], v[56:59], v[36:39], v[100:103]
    ds_read_b128 v[20:23], v136 offset:34816
    v_mfma_f32_16x16x32_bf16 v[104:107], v[56:59], v[40:43], v[104:107]
    ds_read_b128 v[24:27], v136 offset:36864
    v_mfma_f32_16x16x32_bf16 v[108:111], v[56:59], v[44:47], v[108:111]
    ds_read_b128 v[28:31], v136 offset:38912
    v_mfma_f32_16x16x32_bf16 v[112:115], v[60:63], v[32:35], v[112:115]
    v_mfma_f32_16x16x32_bf16 v[116:119], v[60:63], v[36:39], v[116:119]
    v_mfma_f32_16x16x32_bf16 v[120:123], v[60:63], v[40:43], v[120:123]
    v_mfma_f32_16x16x32_bf16 v[124:127], v[60:63], v[44:47], v[124:127]
    s_waitcnt lgkmcnt(0)
    ds_read_b128 v[48:51], v136 offset:33792
    v_mfma_f32_16x16x32_bf16 v[64:67], v[16:19], v[0:3], v[64:67]
    ds_read_b64_tr_b16 v[32:33], v128 offset:40960
    v_mfma_f32_16x16x32_bf16 v[68:71], v[16:19], v[4:7], v[68:71]
    ds_read_b64_tr_b16 v[34:35], v128 offset:45056
    v_mfma_f32_16x16x32_bf16 v[72:75], v[16:19], v[8:11], v[72:75]
    ds_read_b64_tr_b16 v[36:37], v129 offset:40960
    v_mfma_f32_16x16x32_bf16 v[76:79], v[16:19], v[12:15], v[76:79]
    ds_read_b64_tr_b16 v[38:39], v129 offset:45056
    v_mfma_f32_16x16x32_bf16 v[80:83], v[20:23], v[0:3], v[80:83]
    ds_read_b64_tr_b16 v[40:41], v130 offset:40960
    v_mfma_f32_16x16x32_bf16 v[84:87], v[20:23], v[4:7], v[84:87]
    ds_read_b64_tr_b16 v[42:43], v130 offset:45056
    v_mfma_f32_16x16x32_bf16 v[88:91], v[20:23], v[8:11], v[88:91]
    ds_read_b64_tr_b16 v[44:45], v131 offset:40960
    v_mfma_f32_16x16x32_bf16 v[92:95], v[20:23], v[12:15], v[92:95]
    ds_read_b64_tr_b16 v[46:47], v131 offset:45056
    v_mfma_f32_16x16x32_bf16 v[96:99], v[24:27], v[0:3], v[96:99]
    ds_read_b128 v[52:55], v136 offset:35840
    v_mfma_f32_16x16x32_bf16 v[100:103], v[24:27], v[4:7], v[100:103]
    ds_read_b128 v[56:59], v136 offset:37888
    v_mfma_f32_16x16x32_bf16 v[104:107], v[24:27], v[8:11], v[104:107]
    ds_read_b128 v[60:63], v136 offset:39936
    v_mfma_f32_16x16x32_bf16 v[108:111], v[24:27], v[12:15], v[108:111]
    v_mfma_f32_16x16x32_bf16 v[112:115], v[28:31], v[0:3], v[112:115]
    v_mfma_f32_16x16x32_bf16 v[116:119], v[28:31], v[4:7], v[116:119]
    v_mfma_f32_16x16x32_bf16 v[120:123], v[28:31], v[8:11], v[120:123]
    v_mfma_f32_16x16x32_bf16 v[124:127], v[28:31], v[12:15], v[124:127]
    s_waitcnt lgkmcnt(0)
    v_mfma_f32_16x16x32_bf16 v[64:67], v[48:51], v[32:35], v[64:67]
    s_waitcnt vmcnt(0)
    s_barrier
    ds_read_b128 v[16:19], v136 offset:49152
    v_mfma_f32_16x16x32_bf16 v[68:71], v[48:51], v[36:39], v[68:71]
    ds_read_b64_tr_b16 v[0:1], v128 offset:49152
    v_mfma_f32_16x16x32_bf16 v[72:75], v[48:51], v[40:43], v[72:75]
    ds_read_b64_tr_b16 v[2:3], v128 offset:53248
    v_mfma_f32_16x16x32_bf16 v[76:79], v[48:51], v[44:47], v[76:79]
    ds_read_b64_tr_b16 v[4:5], v129 offset:49152
    v_mfma_f32_16x16x32_bf16 v[80:83], v[52:55], v[32:35], v[80:83]
    ds_read_b64_tr_b16 v[6:7], v129 offset:53248
    v_mfma_f32_16x16x32_bf16 v[84:87], v[52:55], v[36:39], v[84:87]
    ds_read_b64_tr_b16 v[8:9], v130 offset:49152
    v_mfma_f32_16x16x32_bf16 v[88:91], v[52:55], v[40:43], v[88:91]
    ds_read_b64_tr_b16 v[10:11], v130 offset:53248
    v_mfma_f32_16x16x32_bf16 v[92:95], v[52:55], v[44:47], v[92:95]
    ds_read_b64_tr_b16 v[12:13], v131 offset:49152
    v_mfma_f32_16x16x32_bf16 v[96:99], v[56:59], v[32:35], v[96:99]
    ds_read_b64_tr_b16 v[14:15], v131 offset:53248
    v_mfma_f32_16x16x32_bf16 v[100:103], v[56:59], v[36:39], v[100:103]
    ds_read_b128 v[20:23], v136 offset:51200
    v_mfma_f32_16x16x32_bf16 v[104:107], v[56:59], v[40:43], v[104:107]
    ds_read_b128 v[24:27], v136 offset:53248
    v_mfma_f32_16x16x32_bf16 v[108:111], v[56:59], v[44:47], v[108:111]
    ds_read_b128 v[28:31], v136 offset:55296
    v_mfma_f32_16x16x32_bf16 v[112:115], v[60:63], v[32:35], v[112:115]
    v_mfma_f32_16x16x32_bf16 v[116:119], v[60:63], v[36:39], v[116:119]
    v_mfma_f32_16x16x32_bf16 v[120:123], v[60:63], v[40:43], v[120:123]
    v_mfma_f32_16x16x32_bf16 v[124:127], v[60:63], v[44:47], v[124:127]
    v_readfirstlane_b32 s55, v255
    s_waitcnt lgkmcnt(0)
    ds_read_b128 v[48:51], v136 offset:50176
    v_mfma_f32_16x16x32_bf16 v[64:67], v[16:19], v[0:3], v[64:67]
    ds_read_b64_tr_b16 v[32:33], v128 offset:57344
    v_mfma_f32_16x16x32_bf16 v[68:71], v[16:19], v[4:7], v[68:71]
    ds_read_b64_tr_b16 v[34:35], v128 offset:61440
    v_mfma_f32_16x16x32_bf16 v[72:75], v[16:19], v[8:11], v[72:75]
    ds_read_b64_tr_b16 v[36:37], v129 offset:57344
    v_mfma_f32_16x16x32_bf16 v[76:79], v[16:19], v[12:15], v[76:79]
    ds_read_b64_tr_b16 v[38:39], v129 offset:61440
    v_mfma_f32_16x16x32_bf16 v[80:83], v[20:23], v[0:3], v[80:83]
    ds_read_b64_tr_b16 v[40:41], v130 offset:57344
    v_mfma_f32_16x16x32_bf16 v[84:87], v[20:23], v[4:7], v[84:87]
    ds_read_b64_tr_b16 v[42:43], v130 offset:61440
    v_mfma_f32_16x16x32_bf16 v[88:91], v[20:23], v[8:11], v[88:91]
    ds_read_b64_tr_b16 v[44:45], v131 offset:57344
    v_mfma_f32_16x16x32_bf16 v[92:95], v[20:23], v[12:15], v[92:95]
    ds_read_b64_tr_b16 v[46:47], v131 offset:61440
    v_mfma_f32_16x16x32_bf16 v[96:99], v[24:27], v[0:3], v[96:99]
    ds_read_b128 v[52:55], v136 offset:52224
    v_mfma_f32_16x16x32_bf16 v[100:103], v[24:27], v[4:7], v[100:103]
    ds_read_b128 v[56:59], v136 offset:54272
    v_mfma_f32_16x16x32_bf16 v[104:107], v[24:27], v[8:11], v[104:107]
    ds_read_b128 v[60:63], v136 offset:56320
    v_mfma_f32_16x16x32_bf16 v[108:111], v[24:27], v[12:15], v[108:111]
    v_mfma_f32_16x16x32_bf16 v[112:115], v[28:31], v[0:3], v[112:115]
    v_mfma_f32_16x16x32_bf16 v[116:119], v[28:31], v[4:7], v[116:119]
    v_mfma_f32_16x16x32_bf16 v[120:123], v[28:31], v[8:11], v[120:123]
    v_mfma_f32_16x16x32_bf16 v[124:127], v[28:31], v[12:15], v[124:127]
    s_waitcnt lgkmcnt(0)
    v_mfma_f32_16x16x32_bf16 v[64:67], v[48:51], v[32:35], v[64:67]
    v_mfma_f32_16x16x32_bf16 v[68:71], v[48:51], v[36:39], v[68:71]
    v_mfma_f32_16x16x32_bf16 v[72:75], v[48:51], v[40:43], v[72:75]
    v_mfma_f32_16x16x32_bf16 v[76:79], v[48:51], v[44:47], v[76:79]
    v_mfma_f32_16x16x32_bf16 v[80:83], v[52:55], v[32:35], v[80:83]
    v_mfma_f32_16x16x32_bf16 v[84:87], v[52:55], v[36:39], v[84:87]
    v_mfma_f32_16x16x32_bf16 v[88:91], v[52:55], v[40:43], v[88:91]
    v_mfma_f32_16x16x32_bf16 v[92:95], v[52:55], v[44:47], v[92:95]
    v_mfma_f32_16x16x32_bf16 v[96:99], v[56:59], v[32:35], v[96:99]
    v_mfma_f32_16x16x32_bf16 v[100:103], v[56:59], v[36:39], v[100:103]
    v_mfma_f32_16x16x32_bf16 v[104:107], v[56:59], v[40:43], v[104:107]
    v_mfma_f32_16x16x32_bf16 v[108:111], v[56:59], v[44:47], v[108:111]
    v_mfma_f32_16x16x32_bf16 v[112:115], v[60:63], v[32:35], v[112:115]
    v_mfma_f32_16x16x32_bf16 v[116:119], v[60:63], v[36:39], v[116:119]
    v_mfma_f32_16x16x32_bf16 v[120:123], v[60:63], v[40:43], v[120:123]
    v_mfma_f32_16x16x32_bf16 v[124:127], v[60:63], v[44:47], v[124:127]
    s_nop 7
    s_mov_b32 s53, s21
    v_cvt_pk_bf16_f32 v8, v64, v65
    v_cvt_pk_bf16_f32 v9, v66, v67
    v_cvt_pk_bf16_f32 v10, v80, v81
    v_cvt_pk_bf16_f32 v11, v82, v83
    buffer_store_dwordx4 v[8:11], v251, s[4:7], s53 offen offset:0 sc1
    v_cvt_pk_bf16_f32 v24, v68, v69
    v_cvt_pk_bf16_f32 v25, v70, v71
    v_cvt_pk_bf16_f32 v26, v84, v85
    v_cvt_pk_bf16_f32 v27, v86, v87
    buffer_store_dwordx4 v[24:27], v251, s[4:7], s53 offen offset:1024 sc1
    v_cvt_pk_bf16_f32 v40, v72, v73
    v_cvt_pk_bf16_f32 v41, v74, v75
    v_cvt_pk_bf16_f32 v42, v88, v89
    v_cvt_pk_bf16_f32 v43, v90, v91
    buffer_store_dwordx4 v[40:43], v251, s[4:7], s53 offen offset:2048 sc1
    v_cvt_pk_bf16_f32 v56, v76, v77
    v_cvt_pk_bf16_f32 v57, v78, v79
    v_cvt_pk_bf16_f32 v58, v92, v93
    v_cvt_pk_bf16_f32 v59, v94, v95
    buffer_store_dwordx4 v[56:59], v251, s[4:7], s53 offen offset:3072 sc1
    s_add_u32 s53, s53, 262144
    v_cvt_pk_bf16_f32 v8, v96, v97
    v_cvt_pk_bf16_f32 v9, v98, v99
    v_cvt_pk_bf16_f32 v10, v112, v113
    v_cvt_pk_bf16_f32 v11, v114, v115
    buffer_store_dwordx4 v[8:11], v251, s[4:7], s53 offen offset:0 sc1
    v_cvt_pk_bf16_f32 v24, v100, v101
    v_cvt_pk_bf16_f32 v25, v102, v103
    v_cvt_pk_bf16_f32 v26, v116, v117
    v_cvt_pk_bf16_f32 v27, v118, v119
    buffer_store_dwordx4 v[24:27], v251, s[4:7], s53 offen offset:1024 sc1
    v_cvt_pk_bf16_f32 v40, v104, v105
    v_cvt_pk_bf16_f32 v41, v106, v107
    v_cvt_pk_bf16_f32 v42, v120, v121
    v_cvt_pk_bf16_f32 v43, v122, v123
    buffer_store_dwordx4 v[40:43], v251, s[4:7], s53 offen offset:2048 sc1
    v_cvt_pk_bf16_f32 v56, v108, v109
    v_cvt_pk_bf16_f32 v57, v110, v111
    v_cvt_pk_bf16_f32 v58, v124, v125
    v_cvt_pk_bf16_f32 v59, v126, v127
    buffer_store_dwordx4 v[56:59], v251, s[4:7], s53 offen offset:3072 sc1
    s_add_u32 s53, s53, 262144
    s_branch main_kernel_w_done
main_kernel_w_c1_task:
    s_cmp_eq_u32 s23, 0
    s_cbranch_scc1 main_kernel_w_c1_set0
    s_cmp_eq_u32 s23, 1
    s_cbranch_scc1 main_kernel_w_c1_set1
    s_cmp_eq_u32 s23, 2
    s_cbranch_scc1 main_kernel_w_c1_set2
    s_cmp_eq_u32 s23, 3
    s_cbranch_scc1 main_kernel_w_c1_set3
    s_cmp_eq_u32 s23, 6
    s_cbranch_scc1 main_kernel_w_c1_set6
    s_branch main_kernel_w_done
main_kernel_w_c1_set0:
    s_lshl_b32 s32, s25, 8
    s_add_u32 s8, s40, s32
    s_addc_u32 s9, s41, 0
    s_and_b32 s9, s9, 0xffff
    s_sub_u32 s10, 0x800000, s32
    s_mov_b32 s11, 0x20000
    s_mov_b32 s30, 8192
    s_mov_b32 s31, 32768
    s_mul_i32 s16, s24, 262144
    s_add_u32 s16, s16, 0x0
    s_mov_b32 s18, 7
    s_lshl_b32 s32, s24, 3
    s_mul_i32 s33, s38, 4
    s_add_u32 s32, s32, s33
    s_mul_i32 s32, s32, 131072
    s_lshl_b32 s33, s25, 12
    s_add_u32 s32, s32, s33
    s_mul_i32 s33, s37, 4096
    s_add_u32 s32, s32, s33
    s_add_u32 s21, s32, 0x800000
    s_mov_b32 s22, 131072
    s_mov_b32 s26, -1
    s_branch main_kernel_w_c1_go
main_kernel_w_c1_set1:
    s_lshl_b32 s32, s25, 8
    s_add_u32 s8, s42, s32
    s_addc_u32 s9, s43, 0
    s_and_b32 s9, s9, 0xffff
    s_sub_u32 s10, 0x800000, s32
    s_mov_b32 s11, 0x20000
    s_mov_b32 s30, 8192
    s_mov_b32 s31, 32768
    s_mul_i32 s16, s24, 262144
    s_add_u32 s16, s16, 0x0
    s_mov_b32 s18, 7
    s_lshl_b32 s32, s24, 3
    s_mul_i32 s33, s38, 4
    s_add_u32 s32, s32, s33
    s_mul_i32 s32, s32, 131072
    s_lshl_b32 s33, s25, 12
    s_add_u32 s32, s32, s33
    s_mul_i32 s33, s37, 4096
    s_add_u32 s32, s32, s33
    s_add_u32 s21, s32, 0x1800000
    s_mov_b32 s22, 131072
    s_mov_b32 s26, -1
    s_branch main_kernel_w_c1_go
main_kernel_w_c1_set2:
    s_lshl_b32 s32, s25, 8
    s_add_u32 s8, s44, s32
    s_addc_u32 s9, s45, 0
    s_and_b32 s9, s9, 0xffff
    s_sub_u32 s10, 0x800000, s32
    s_mov_b32 s11, 0x20000
    s_mov_b32 s30, 8192
    s_mov_b32 s31, 32768
    s_mul_i32 s16, s24, 262144
    s_add_u32 s16, s16, 0x0
    s_mov_b32 s18, 7
    s_lshl_b32 s32, s24, 2
    s_mul_i32 s33, s38, 2
    s_add_u32 s32, s32, s33
    s_lshl_b32 s32, s32, 18
    s_lshl_b32 s33, s25, 13
    s_add_u32 s32, s32, s33
    s_mul_i32 s33, s37, 8192
    s_add_u32 s32, s32, s33
    s_add_u32 s21, s32, 0x2800000
    s_branch main_kernel_w_c1_gov
main_kernel_w_c1_set3:
    s_lshl_b32 s32, s25, 8
    s_add_u32 s8, s64, s32
    s_addc_u32 s9, s65, 0
    s_and_b32 s9, s9, 0xffff
    s_sub_u32 s10, 0x200000, s32
    s_mov_b32 s11, 0x20000
    s_mov_b32 s30, 2048
    s_mov_b32 s31, 32768
    s_mul_i32 s16, s24, 262144
    s_add_u32 s16, s16, 0x400000
    s_mov_b32 s18, 7
    s_lshl_b32 s32, s24, 3
    s_mul_i32 s33, s38, 4
    s_add_u32 s32, s32, s33
    s_mul_i32 s32, s32, 32768
    s_lshl_b32 s33, s25, 12
    s_add_u32 s32, s32, s33
    s_mul_i32 s33, s37, 4096
    s_add_u32 s32, s32, s33
    s_add_u32 s21, s32, 0x4800000
    s_mov_b32 s22, 32768
    s_mov_b32 s26, -1
    s_lshr_b32 s32, s25, 2
    s_add_u32 s32, s32, 1
    s_sub_u32 s33, 0, s32
    s_bitcmp1_b32 s25, 1
    s_cselect_b32 s32, s33, s32
    s_add_u32 s32, s32, 16
    v_and_b32 v253, 15, v250
    v_add_u32 v253, s32, v253
    v_lshrrev_b32 v254, 4, v253
    v_lshlrev_b32 v254, 15, v254
    v_and_b32 v253, 15, v253
    v_lshl_add_u32 v254, v253, 4, v254
    v_and_b32 v253, 0x300, v251
    v_add_u32 v252, v253, v254
    s_branch main_kernel_w_c1_go
main_kernel_w_c1_set6:
    s_lshl_b32 s32, s25, 8
    s_add_u32 s8, s68, s32
    s_addc_u32 s9, s69, 0
    s_and_b32 s9, s9, 0xffff
    s_sub_u32 s10, 0x700000, s32
    s_mov_b32 s11, 0x20000
    s_mov_b32 s30, 7168
    s_mov_b32 s31, 32768
    s_mul_i32 s16, s24, 262144
    s_add_u32 s16, s16, 0x6800000
    s_mov_b32 s18, 7
    s_lshl_b32 s32, s24, 3
    s_mul_i32 s33, s38, 4
    s_add_u32 s32, s32, s33
    s_mul_i32 s32, s32, 114688
    s_lshl_b32 s33, s25, 12
    s_add_u32 s32, s32, s33
    s_mul_i32 s33, s37, 4096
    s_add_u32 s32, s32, s33
    s_add_u32 s21, s32, 0x5400000
    s_mov_b32 s22, 114688
    s_mov_b32 s26, -1
    s_branch main_kernel_w_c1_go
main_kernel_w_c1_go:
    v_lshrrev_b32 v0, 4, v250
    v_bfe_u32 v1, v250, 2, 2
    v_lshl_add_u32 v4, v0, 2, v1
    v_and_b32 v5, 7, v4
    v_mul_u32_u24 v4, 512, v4
    v_and_b32 v6, 3, v250
    v_lshl_add_u32 v4, v6, 3, v4
    s_mul_i32 s32, s37, 8
    v_xor_b32 v5, s32, v5
    v_lshl_add_u32 v128, v5, 5, v4
    v_xor_b32 v129, 32, v128
    v_xor_b32 v130, 64, v128
    v_xor_b32 v131, 96, v128
    v_xor_b32 v132, 128, v128
    v_xor_b32 v133, 160, v128
    v_xor_b32 v134, 192, v128
    v_xor_b32 v135, 224, v128
    s_mul_i32 s32, s38, 4096
    s_add_u32 s32, s32, 65536
    v_add_u32 v136, s32, v251
    v_lshrrev_b32 v2, 5, v250
    v_and_b32 v3, 31, v250
    s_mul_i32 s32, s14, 8
    v_add_u32 v4, s32, v2
    v_add_u32 v5, 0, v4
    v_and_b32 v6, 7, v5
    v_lshlrev_b32 v6, 1, v6
    v_xor_b32 v6, v6, v3
    v_mul_lo_u32 v5, v5, s30
    v_lshl_add_u32 v5, v6, 4, v5
    v_subrev_u32 v137, 0, v5
    v_add_u32 v5, 2, v4
    v_and_b32 v6, 7, v5
    v_lshlrev_b32 v6, 1, v6
    v_xor_b32 v6, v6, v3
    v_mul_lo_u32 v5, v5, s30
    v_lshl_add_u32 v5, v6, 4, v5
    v_subrev_u32 v138, 1024, v5
    v_add_u32 v5, 4, v4
    v_and_b32 v6, 7, v5
    v_lshlrev_b32 v6, 1, v6
    v_xor_b32 v6, v6, v3
    v_mul_lo_u32 v5, v5, s30
    v_lshl_add_u32 v5, v6, 4, v5
    v_subrev_u32 v139, 2048, v5
    v_add_u32 v5, 6, v4
    v_and_b32 v6, 7, v5
    v_lshlrev_b32 v6, 1, v6
    v_xor_b32 v6, v6, v3
    v_mul_lo_u32 v5, v5, s30
    v_lshl_add_u32 v5, v6, 4, v5
    v_subrev_u32 v140, 3072, v5
    s_mul_i32 s32, s14, 2
    s_mul_i32 s32, s32, s31
    v_add_u32 v141, s32, v251
    s_add_u32 s32, s32, s31
    s_sub_u32 s32, s32, 1024
    v_add_u32 v142, s32, v251
    s_mul_i32 s19, s14, 4096
    s_mul_i32 s20, s14, 2048
    s_add_u32 s20, s20, 65536
    s_mul_i32 s17, s30, 32
    s_mov_b32 s15, 0
    s_add_u32 m0, s20, 0
    s_nop 0
    buffer_load_dwordx4 v141, s[4:7], s16 offen offset:0 sc1 lds
    buffer_load_dwordx4 v142, s[4:7], s16 offen offset:1024 sc1 lds
    s_add_u32 s16, s16, 1024
    s_add_u32 m0, s19, 0
    s_nop 0
    buffer_load_dwordx4 v137, s[8:11], s15 offen offset:0 lds
    buffer_load_dwordx4 v138, s[8:11], s15 offen offset:1024 lds
    buffer_load_dwordx4 v139, s[8:11], s15 offen offset:2048 lds
    buffer_load_dwordx4 v140, s[8:11], s15 offen offset:3072 lds
    s_add_u32 s15, s15, s17
    s_add_u32 m0, s20, 8192
    s_nop 0
    buffer_load_dwordx4 v141, s[4:7], s16 offen offset:0 sc1 lds
    buffer_load_dwordx4 v142, s[4:7], s16 offen offset:1024 sc1 lds
    s_add_u32 s16, s16, 1024
    s_add_u32 m0, s19, 16384
    s_nop 0
    buffer_load_dwordx4 v137, s[8:11], s15 offen offset:0 lds
    buffer_load_dwordx4 v138, s[8:11], s15 offen offset:1024 lds
    buffer_load_dwordx4 v139, s[8:11], s15 offen offset:2048 lds
    buffer_load_dwordx4 v140, s[8:11], s15 offen offset:3072 lds
    s_add_u32 s15, s15, s17
    s_add_u32 m0, s20, 16384
    s_nop 0
    buffer_load_dwordx4 v141, s[4:7], s16 offen offset:0 sc1 lds
    buffer_load_dwordx4 v142, s[4:7], s16 offen offset:1024 sc1 lds
    s_add_u32 s16, s16, 1024
    s_add_u32 m0, s19, 32768
    s_nop 0
    buffer_load_dwordx4 v137, s[8:11], s15 offen offset:0 lds
    buffer_load_dwordx4 v138, s[8:11], s15 offen offset:1024 lds
    buffer_load_dwordx4 v139, s[8:11], s15 offen offset:2048 lds
    buffer_load_dwordx4 v140, s[8:11], s15 offen offset:3072 lds
    s_add_u32 s15, s15, s17
    s_add_u32 m0, s20, 24576
    s_nop 0
    buffer_load_dwordx4 v141, s[4:7], s16 offen offset:0 sc1 lds
    buffer_load_dwordx4 v142, s[4:7], s16 offen offset:1024 sc1 lds
    s_add_u32 s16, s16, 1024
    s_add_u32 m0, s19, 49152
    s_nop 0
    buffer_load_dwordx4 v137, s[8:11], s15 offen offset:0 lds
    buffer_load_dwordx4 v138, s[8:11], s15 offen offset:1024 lds
    buffer_load_dwordx4 v139, s[8:11], s15 offen offset:2048 lds
    buffer_load_dwordx4 v140, s[8:11], s15 offen offset:3072 lds
    s_add_u32 s15, s15, s17
    v_accvgpr_write_b32 a0, 0
    v_accvgpr_write_b32 a1, 0
    v_accvgpr_write_b32 a2, 0
    v_accvgpr_write_b32 a3, 0
    v_accvgpr_write_b32 a4, 0
    v_accvgpr_write_b32 a5, 0
    v_accvgpr_write_b32 a6, 0
    v_accvgpr_write_b32 a7, 0
    v_accvgpr_write_b32 a8, 0
    v_accvgpr_write_b32 a9, 0
    v_accvgpr_write_b32 a10, 0
    v_accvgpr_write_b32 a11, 0
    v_accvgpr_write_b32 a12, 0
    v_accvgpr_write_b32 a13, 0
    v_accvgpr_write_b32 a14, 0
    v_accvgpr_write_b32 a15, 0
    v_accvgpr_write_b32 a16, 0
    v_accvgpr_write_b32 a17, 0
    v_accvgpr_write_b32 a18, 0
    v_accvgpr_write_b32 a19, 0
    v_accvgpr_write_b32 a20, 0
    v_accvgpr_write_b32 a21, 0
    v_accvgpr_write_b32 a22, 0
    v_accvgpr_write_b32 a23, 0
    v_accvgpr_write_b32 a24, 0
    v_accvgpr_write_b32 a25, 0
    v_accvgpr_write_b32 a26, 0
    v_accvgpr_write_b32 a27, 0
    v_accvgpr_write_b32 a28, 0
    v_accvgpr_write_b32 a29, 0
    v_accvgpr_write_b32 a30, 0
    v_accvgpr_write_b32 a31, 0
    v_accvgpr_write_b32 a32, 0
    v_accvgpr_write_b32 a33, 0
    v_accvgpr_write_b32 a34, 0
    v_accvgpr_write_b32 a35, 0
    v_accvgpr_write_b32 a36, 0
    v_accvgpr_write_b32 a37, 0
    v_accvgpr_write_b32 a38, 0
    v_accvgpr_write_b32 a39, 0
    v_accvgpr_write_b32 a40, 0
    v_accvgpr_write_b32 a41, 0
    v_accvgpr_write_b32 a42, 0
    v_accvgpr_write_b32 a43, 0
    v_accvgpr_write_b32 a44, 0
    v_accvgpr_write_b32 a45, 0
    v_accvgpr_write_b32 a46, 0
    v_accvgpr_write_b32 a47, 0
    v_accvgpr_write_b32 a48, 0
    v_accvgpr_write_b32 a49, 0
    v_accvgpr_write_b32 a50, 0
    v_accvgpr_write_b32 a51, 0
    v_accvgpr_write_b32 a52, 0
    v_accvgpr_write_b32 a53, 0
    v_accvgpr_write_b32 a54, 0
    v_accvgpr_write_b32 a55, 0
    v_accvgpr_write_b32 a56, 0
    v_accvgpr_write_b32 a57, 0
    v_accvgpr_write_b32 a58, 0
    v_accvgpr_write_b32 a59, 0
    v_accvgpr_write_b32 a60, 0
    v_accvgpr_write_b32 a61, 0
    v_accvgpr_write_b32 a62, 0
    v_accvgpr_write_b32 a63, 0
    v_accvgpr_write_b32 a64, 0
    v_accvgpr_write_b32 a65, 0
    v_accvgpr_write_b32 a66, 0
    v_accvgpr_write_b32 a67, 0
    v_accvgpr_write_b32 a68, 0
    v_accvgpr_write_b32 a69, 0
    v_accvgpr_write_b32 a70, 0
    v_accvgpr_write_b32 a71, 0
    v_accvgpr_write_b32 a72, 0
    v_accvgpr_write_b32 a73, 0
    v_accvgpr_write_b32 a74, 0
    v_accvgpr_write_b32 a75, 0
    v_accvgpr_write_b32 a76, 0
    v_accvgpr_write_b32 a77, 0
    v_accvgpr_write_b32 a78, 0
    v_accvgpr_write_b32 a79, 0
    v_accvgpr_write_b32 a80, 0
    v_accvgpr_write_b32 a81, 0
    v_accvgpr_write_b32 a82, 0
    v_accvgpr_write_b32 a83, 0
    v_accvgpr_write_b32 a84, 0
    v_accvgpr_write_b32 a85, 0
    v_accvgpr_write_b32 a86, 0
    v_accvgpr_write_b32 a87, 0
    v_accvgpr_write_b32 a88, 0
    v_accvgpr_write_b32 a89, 0
    v_accvgpr_write_b32 a90, 0
    v_accvgpr_write_b32 a91, 0
    v_accvgpr_write_b32 a92, 0
    v_accvgpr_write_b32 a93, 0
    v_accvgpr_write_b32 a94, 0
    v_accvgpr_write_b32 a95, 0
    v_accvgpr_write_b32 a96, 0
    v_accvgpr_write_b32 a97, 0
    v_accvgpr_write_b32 a98, 0
    v_accvgpr_write_b32 a99, 0
    v_accvgpr_write_b32 a100, 0
    v_accvgpr_write_b32 a101, 0
    v_accvgpr_write_b32 a102, 0
    v_accvgpr_write_b32 a103, 0
    v_accvgpr_write_b32 a104, 0
    v_accvgpr_write_b32 a105, 0
    v_accvgpr_write_b32 a106, 0
    v_accvgpr_write_b32 a107, 0
    v_accvgpr_write_b32 a108, 0
    v_accvgpr_write_b32 a109, 0
    v_accvgpr_write_b32 a110, 0
    v_accvgpr_write_b32 a111, 0
    v_accvgpr_write_b32 a112, 0
    v_accvgpr_write_b32 a113, 0
    v_accvgpr_write_b32 a114, 0
    v_accvgpr_write_b32 a115, 0
    v_accvgpr_write_b32 a116, 0
    v_accvgpr_write_b32 a117, 0
    v_accvgpr_write_b32 a118, 0
    v_accvgpr_write_b32 a119, 0
    v_accvgpr_write_b32 a120, 0
    v_accvgpr_write_b32 a121, 0
    v_accvgpr_write_b32 a122, 0
    v_accvgpr_write_b32 a123, 0
    v_accvgpr_write_b32 a124, 0
    v_accvgpr_write_b32 a125, 0
    v_accvgpr_write_b32 a126, 0
    v_accvgpr_write_b32 a127, 0
    s_waitcnt vmcnt(18)
    s_barrier
    ds_read_b128 v[32:35], v136 offset:0
    ds_read_b64_tr_b16 v[0:1], v128 offset:0
    ds_read_b64_tr_b16 v[2:3], v128 offset:8192
    ds_read_b64_tr_b16 v[4:5], v129 offset:0
    ds_read_b64_tr_b16 v[6:7], v129 offset:8192
    ds_read_b64_tr_b16 v[8:9], v130 offset:0
    ds_read_b64_tr_b16 v[10:11], v130 offset:8192
    ds_read_b64_tr_b16 v[12:13], v131 offset:0
    ds_read_b64_tr_b16 v[14:15], v131 offset:8192
    ds_read_b64_tr_b16 v[16:17], v132 offset:0
    ds_read_b64_tr_b16 v[18:19], v132 offset:8192
    ds_read_b64_tr_b16 v[20:21], v133 offset:0
    ds_read_b64_tr_b16 v[22:23], v133 offset:8192
    ds_read_b64_tr_b16 v[24:25], v134 offset:0
    ds_read_b64_tr_b16 v[26:27], v134 offset:8192
    ds_read_b64_tr_b16 v[28:29], v135 offset:0
    ds_read_b64_tr_b16 v[30:31], v135 offset:8192
    ds_read_b128 v[36:39], v136 offset:1024
    ds_read_b128 v[40:43], v136 offset:2048
    ds_read_b128 v[44:47], v136 offset:3072
main_kernel_w_c1_n_loop:
    s_waitcnt lgkmcnt(0)
    v_mfma_f32_16x16x32_bf16 a[0:3], v[0:3], v[32:35], a[0:3]
    s_waitcnt vmcnt(12)
    s_barrier
    ds_read_b128 v[80:83], v136 offset:8192
    s_add_u32 m0, s20, 0
    s_nop 0
    v_mfma_f32_16x16x32_bf16 a[4:7], v[4:7], v[32:35], a[4:7]
    ds_read_b64_tr_b16 v[48:49], v128 offset:16384
    v_mfma_f32_16x16x32_bf16 a[8:11], v[8:11], v[32:35], a[8:11]
    ds_read_b64_tr_b16 v[50:51], v128 offset:24576
    v_mfma_f32_16x16x32_bf16 a[12:15], v[12:15], v[32:35], a[12:15]
    ds_read_b64_tr_b16 v[52:53], v129 offset:16384
    buffer_load_dwordx4 v141, s[4:7], s16 offen offset:0 sc1 lds
    v_mfma_f32_16x16x32_bf16 a[16:19], v[16:19], v[32:35], a[16:19]
    ds_read_b64_tr_b16 v[54:55], v129 offset:24576
    v_mfma_f32_16x16x32_bf16 a[20:23], v[20:23], v[32:35], a[20:23]
    ds_read_b64_tr_b16 v[56:57], v130 offset:16384
    v_mfma_f32_16x16x32_bf16 a[24:27], v[24:27], v[32:35], a[24:27]
    ds_read_b64_tr_b16 v[58:59], v130 offset:24576
    buffer_load_dwordx4 v142, s[4:7], s16 offen offset:1024 sc1 lds
    v_mfma_f32_16x16x32_bf16 a[28:31], v[28:31], v[32:35], a[28:31]
    ds_read_b64_tr_b16 v[60:61], v131 offset:16384
    v_mfma_f32_16x16x32_bf16 a[32:35], v[0:3], v[36:39], a[32:35]
    ds_read_b64_tr_b16 v[62:63], v131 offset:24576
    v_mfma_f32_16x16x32_bf16 a[36:39], v[4:7], v[36:39], a[36:39]
    ds_read_b64_tr_b16 v[64:65], v132 offset:16384
    s_add_u32 s16, s16, 1024
    v_mfma_f32_16x16x32_bf16 a[40:43], v[8:11], v[36:39], a[40:43]
    ds_read_b64_tr_b16 v[66:67], v132 offset:24576
    v_mfma_f32_16x16x32_bf16 a[44:47], v[12:15], v[36:39], a[44:47]
    ds_read_b64_tr_b16 v[68:69], v133 offset:16384
    v_mfma_f32_16x16x32_bf16 a[48:51], v[16:19], v[36:39], a[48:51]
    ds_read_b64_tr_b16 v[70:71], v133 offset:24576
    s_add_u32 m0, s19, 0
    s_nop 0
    v_mfma_f32_16x16x32_bf16 a[52:55], v[20:23], v[36:39], a[52:55]
    ds_read_b64_tr_b16 v[72:73], v134 offset:16384
    v_mfma_f32_16x16x32_bf16 a[56:59], v[24:27], v[36:39], a[56:59]
    ds_read_b64_tr_b16 v[74:75], v134 offset:24576
    v_mfma_f32_16x16x32_bf16 a[60:63], v[28:31], v[36:39], a[60:63]
    ds_read_b64_tr_b16 v[76:77], v135 offset:16384
    buffer_load_dwordx4 v137, s[8:11], s15 offen offset:0 lds
    v_mfma_f32_16x16x32_bf16 a[64:67], v[0:3], v[40:43], a[64:67]
    ds_read_b64_tr_b16 v[78:79], v135 offset:24576
    v_mfma_f32_16x16x32_bf16 a[68:71], v[4:7], v[40:43], a[68:71]
    ds_read_b128 v[84:87], v136 offset:9216
    v_mfma_f32_16x16x32_bf16 a[72:75], v[8:11], v[40:43], a[72:75]
    ds_read_b128 v[88:91], v136 offset:10240
    buffer_load_dwordx4 v138, s[8:11], s15 offen offset:1024 lds
    v_mfma_f32_16x16x32_bf16 a[76:79], v[12:15], v[40:43], a[76:79]
    ds_read_b128 v[92:95], v136 offset:11264
    v_mfma_f32_16x16x32_bf16 a[80:83], v[16:19], v[40:43], a[80:83]
    v_mfma_f32_16x16x32_bf16 a[84:87], v[20:23], v[40:43], a[84:87]
    buffer_load_dwordx4 v139, s[8:11], s15 offen offset:2048 lds
    v_mfma_f32_16x16x32_bf16 a[88:91], v[24:27], v[40:43], a[88:91]
    v_mfma_f32_16x16x32_bf16 a[92:95], v[28:31], v[40:43], a[92:95]
    v_mfma_f32_16x16x32_bf16 a[96:99], v[0:3], v[44:47], a[96:99]
    buffer_load_dwordx4 v140, s[8:11], s15 offen offset:3072 lds
    v_mfma_f32_16x16x32_bf16 a[100:103], v[4:7], v[44:47], a[100:103]
    v_mfma_f32_16x16x32_bf16 a[104:107], v[8:11], v[44:47], a[104:107]
    v_mfma_f32_16x16x32_bf16 a[108:111], v[12:15], v[44:47], a[108:111]
    s_add_u32 s15, s15, s17
    v_mfma_f32_16x16x32_bf16 a[112:115], v[16:19], v[44:47], a[112:115]
    v_mfma_f32_16x16x32_bf16 a[116:119], v[20:23], v[44:47], a[116:119]
    v_mfma_f32_16x16x32_bf16 a[120:123], v[24:27], v[44:47], a[120:123]
    v_mfma_f32_16x16x32_bf16 a[124:127], v[28:31], v[44:47], a[124:127]
    s_waitcnt lgkmcnt(0)
    v_mfma_f32_16x16x32_bf16 a[0:3], v[48:51], v[80:83], a[0:3]
    s_waitcnt vmcnt(12)
    s_barrier
    ds_read_b128 v[32:35], v136 offset:16384
    s_add_u32 m0, s20, 8192
    s_nop 0
    v_mfma_f32_16x16x32_bf16 a[4:7], v[52:55], v[80:83], a[4:7]
    ds_read_b64_tr_b16 v[0:1], v128 offset:32768
    v_mfma_f32_16x16x32_bf16 a[8:11], v[56:59], v[80:83], a[8:11]
    ds_read_b64_tr_b16 v[2:3], v128 offset:40960
    v_mfma_f32_16x16x32_bf16 a[12:15], v[60:63], v[80:83], a[12:15]
    ds_read_b64_tr_b16 v[4:5], v129 offset:32768
    buffer_load_dwordx4 v141, s[4:7], s16 offen offset:0 sc1 lds
    v_mfma_f32_16x16x32_bf16 a[16:19], v[64:67], v[80:83], a[16:19]
    ds_read_b64_tr_b16 v[6:7], v129 offset:40960
    v_mfma_f32_16x16x32_bf16 a[20:23], v[68:71], v[80:83], a[20:23]
    ds_read_b64_tr_b16 v[8:9], v130 offset:32768
    v_mfma_f32_16x16x32_bf16 a[24:27], v[72:75], v[80:83], a[24:27]
    ds_read_b64_tr_b16 v[10:11], v130 offset:40960
    buffer_load_dwordx4 v142, s[4:7], s16 offen offset:1024 sc1 lds
    v_mfma_f32_16x16x32_bf16 a[28:31], v[76:79], v[80:83], a[28:31]
    ds_read_b64_tr_b16 v[12:13], v131 offset:32768
    v_mfma_f32_16x16x32_bf16 a[32:35], v[48:51], v[84:87], a[32:35]
    ds_read_b64_tr_b16 v[14:15], v131 offset:40960
    v_mfma_f32_16x16x32_bf16 a[36:39], v[52:55], v[84:87], a[36:39]
    ds_read_b64_tr_b16 v[16:17], v132 offset:32768
    s_add_u32 s16, s16, 1024
    v_mfma_f32_16x16x32_bf16 a[40:43], v[56:59], v[84:87], a[40:43]
    ds_read_b64_tr_b16 v[18:19], v132 offset:40960
    v_mfma_f32_16x16x32_bf16 a[44:47], v[60:63], v[84:87], a[44:47]
    ds_read_b64_tr_b16 v[20:21], v133 offset:32768
    v_mfma_f32_16x16x32_bf16 a[48:51], v[64:67], v[84:87], a[48:51]
    ds_read_b64_tr_b16 v[22:23], v133 offset:40960
    s_add_u32 m0, s19, 16384
    s_nop 0
    v_mfma_f32_16x16x32_bf16 a[52:55], v[68:71], v[84:87], a[52:55]
    ds_read_b64_tr_b16 v[24:25], v134 offset:32768
    v_mfma_f32_16x16x32_bf16 a[56:59], v[72:75], v[84:87], a[56:59]
    ds_read_b64_tr_b16 v[26:27], v134 offset:40960
    v_mfma_f32_16x16x32_bf16 a[60:63], v[76:79], v[84:87], a[60:63]
    ds_read_b64_tr_b16 v[28:29], v135 offset:32768
    buffer_load_dwordx4 v137, s[8:11], s15 offen offset:0 lds
    v_mfma_f32_16x16x32_bf16 a[64:67], v[48:51], v[88:91], a[64:67]
    ds_read_b64_tr_b16 v[30:31], v135 offset:40960
    v_mfma_f32_16x16x32_bf16 a[68:71], v[52:55], v[88:91], a[68:71]
    ds_read_b128 v[36:39], v136 offset:17408
    v_mfma_f32_16x16x32_bf16 a[72:75], v[56:59], v[88:91], a[72:75]
    ds_read_b128 v[40:43], v136 offset:18432
    buffer_load_dwordx4 v138, s[8:11], s15 offen offset:1024 lds
    v_mfma_f32_16x16x32_bf16 a[76:79], v[60:63], v[88:91], a[76:79]
    ds_read_b128 v[44:47], v136 offset:19456
    v_mfma_f32_16x16x32_bf16 a[80:83], v[64:67], v[88:91], a[80:83]
    v_mfma_f32_16x16x32_bf16 a[84:87], v[68:71], v[88:91], a[84:87]
    buffer_load_dwordx4 v139, s[8:11], s15 offen offset:2048 lds
    v_mfma_f32_16x16x32_bf16 a[88:91], v[72:75], v[88:91], a[88:91]
    v_mfma_f32_16x16x32_bf16 a[92:95], v[76:79], v[88:91], a[92:95]
    v_mfma_f32_16x16x32_bf16 a[96:99], v[48:51], v[92:95], a[96:99]
    buffer_load_dwordx4 v140, s[8:11], s15 offen offset:3072 lds
    v_mfma_f32_16x16x32_bf16 a[100:103], v[52:55], v[92:95], a[100:103]
    v_mfma_f32_16x16x32_bf16 a[104:107], v[56:59], v[92:95], a[104:107]
    v_mfma_f32_16x16x32_bf16 a[108:111], v[60:63], v[92:95], a[108:111]
    s_add_u32 s15, s15, s17
    v_mfma_f32_16x16x32_bf16 a[112:115], v[64:67], v[92:95], a[112:115]
    v_mfma_f32_16x16x32_bf16 a[116:119], v[68:71], v[92:95], a[116:119]
    v_mfma_f32_16x16x32_bf16 a[120:123], v[72:75], v[92:95], a[120:123]
    v_mfma_f32_16x16x32_bf16 a[124:127], v[76:79], v[92:95], a[124:127]
    s_waitcnt lgkmcnt(0)
    v_mfma_f32_16x16x32_bf16 a[0:3], v[0:3], v[32:35], a[0:3]
    s_waitcnt vmcnt(12)
    s_barrier
    ds_read_b128 v[80:83], v136 offset:24576
    s_add_u32 m0, s20, 16384
    s_nop 0
    v_mfma_f32_16x16x32_bf16 a[4:7], v[4:7], v[32:35], a[4:7]
    ds_read_b64_tr_b16 v[48:49], v128 offset:49152
    v_mfma_f32_16x16x32_bf16 a[8:11], v[8:11], v[32:35], a[8:11]
    ds_read_b64_tr_b16 v[50:51], v128 offset:57344
    v_mfma_f32_16x16x32_bf16 a[12:15], v[12:15], v[32:35], a[12:15]
    ds_read_b64_tr_b16 v[52:53], v129 offset:49152
    buffer_load_dwordx4 v141, s[4:7], s16 offen offset:0 sc1 lds
    v_mfma_f32_16x16x32_bf16 a[16:19], v[16:19], v[32:35], a[16:19]
    ds_read_b64_tr_b16 v[54:55], v129 offset:57344
    v_mfma_f32_16x16x32_bf16 a[20:23], v[20:23], v[32:35], a[20:23]
    ds_read_b64_tr_b16 v[56:57], v130 offset:49152
    v_mfma_f32_16x16x32_bf16 a[24:27], v[24:27], v[32:35], a[24:27]
    ds_read_b64_tr_b16 v[58:59], v130 offset:57344
    buffer_load_dwordx4 v142, s[4:7], s16 offen offset:1024 sc1 lds
    v_mfma_f32_16x16x32_bf16 a[28:31], v[28:31], v[32:35], a[28:31]
    ds_read_b64_tr_b16 v[60:61], v131 offset:49152
    v_mfma_f32_16x16x32_bf16 a[32:35], v[0:3], v[36:39], a[32:35]
    ds_read_b64_tr_b16 v[62:63], v131 offset:57344
    v_mfma_f32_16x16x32_bf16 a[36:39], v[4:7], v[36:39], a[36:39]
    ds_read_b64_tr_b16 v[64:65], v132 offset:49152
    s_add_u32 s16, s16, 1024
    v_mfma_f32_16x16x32_bf16 a[40:43], v[8:11], v[36:39], a[40:43]
    ds_read_b64_tr_b16 v[66:67], v132 offset:57344
    v_mfma_f32_16x16x32_bf16 a[44:47], v[12:15], v[36:39], a[44:47]
    ds_read_b64_tr_b16 v[68:69], v133 offset:49152
    v_mfma_f32_16x16x32_bf16 a[48:51], v[16:19], v[36:39], a[48:51]
    ds_read_b64_tr_b16 v[70:71], v133 offset:57344
    s_add_u32 m0, s19, 32768
    s_nop 0
    v_mfma_f32_16x16x32_bf16 a[52:55], v[20:23], v[36:39], a[52:55]
    ds_read_b64_tr_b16 v[72:73], v134 offset:49152
    v_mfma_f32_16x16x32_bf16 a[56:59], v[24:27], v[36:39], a[56:59]
    ds_read_b64_tr_b16 v[74:75], v134 offset:57344
    v_mfma_f32_16x16x32_bf16 a[60:63], v[28:31], v[36:39], a[60:63]
    ds_read_b64_tr_b16 v[76:77], v135 offset:49152
    buffer_load_dwordx4 v137, s[8:11], s15 offen offset:0 lds
    v_mfma_f32_16x16x32_bf16 a[64:67], v[0:3], v[40:43], a[64:67]
    ds_read_b64_tr_b16 v[78:79], v135 offset:57344
    v_mfma_f32_16x16x32_bf16 a[68:71], v[4:7], v[40:43], a[68:71]
    ds_read_b128 v[84:87], v136 offset:25600
    v_mfma_f32_16x16x32_bf16 a[72:75], v[8:11], v[40:43], a[72:75]
    ds_read_b128 v[88:91], v136 offset:26624
    buffer_load_dwordx4 v138, s[8:11], s15 offen offset:1024 lds
    v_mfma_f32_16x16x32_bf16 a[76:79], v[12:15], v[40:43], a[76:79]
    ds_read_b128 v[92:95], v136 offset:27648
    v_mfma_f32_16x16x32_bf16 a[80:83], v[16:19], v[40:43], a[80:83]
    v_mfma_f32_16x16x32_bf16 a[84:87], v[20:23], v[40:43], a[84:87]
    buffer_load_dwordx4 v139, s[8:11], s15 offen offset:2048 lds
    v_mfma_f32_16x16x32_bf16 a[88:91], v[24:27], v[40:43], a[88:91]
    v_mfma_f32_16x16x32_bf16 a[92:95], v[28:31], v[40:43], a[92:95]
    v_mfma_f32_16x16x32_bf16 a[96:99], v[0:3], v[44:47], a[96:99]
    buffer_load_dwordx4 v140, s[8:11], s15 offen offset:3072 lds
    v_mfma_f32_16x16x32_bf16 a[100:103], v[4:7], v[44:47], a[100:103]
    v_mfma_f32_16x16x32_bf16 a[104:107], v[8:11], v[44:47], a[104:107]
    v_mfma_f32_16x16x32_bf16 a[108:111], v[12:15], v[44:47], a[108:111]
    s_add_u32 s15, s15, s17
    v_mfma_f32_16x16x32_bf16 a[112:115], v[16:19], v[44:47], a[112:115]
    v_mfma_f32_16x16x32_bf16 a[116:119], v[20:23], v[44:47], a[116:119]
    v_mfma_f32_16x16x32_bf16 a[120:123], v[24:27], v[44:47], a[120:123]
    v_mfma_f32_16x16x32_bf16 a[124:127], v[28:31], v[44:47], a[124:127]
    s_waitcnt lgkmcnt(0)
    v_mfma_f32_16x16x32_bf16 a[0:3], v[48:51], v[80:83], a[0:3]
    s_waitcnt vmcnt(12)
    s_barrier
    ds_read_b128 v[32:35], v136 offset:0
    s_add_u32 m0, s20, 24576
    s_nop 0
    v_mfma_f32_16x16x32_bf16 a[4:7], v[52:55], v[80:83], a[4:7]
    ds_read_b64_tr_b16 v[0:1], v128 offset:0
    v_mfma_f32_16x16x32_bf16 a[8:11], v[56:59], v[80:83], a[8:11]
    ds_read_b64_tr_b16 v[2:3], v128 offset:8192
    v_mfma_f32_16x16x32_bf16 a[12:15], v[60:63], v[80:83], a[12:15]
    ds_read_b64_tr_b16 v[4:5], v129 offset:0
    buffer_load_dwordx4 v141, s[4:7], s16 offen offset:0 sc1 lds
    v_mfma_f32_16x16x32_bf16 a[16:19], v[64:67], v[80:83], a[16:19]
    ds_read_b64_tr_b16 v[6:7], v129 offset:8192
    v_mfma_f32_16x16x32_bf16 a[20:23], v[68:71], v[80:83], a[20:23]
    ds_read_b64_tr_b16 v[8:9], v130 offset:0
    v_mfma_f32_16x16x32_bf16 a[24:27], v[72:75], v[80:83], a[24:27]
    ds_read_b64_tr_b16 v[10:11], v130 offset:8192
    buffer_load_dwordx4 v142, s[4:7], s16 offen offset:1024 sc1 lds
    v_mfma_f32_16x16x32_bf16 a[28:31], v[76:79], v[80:83], a[28:31]
    ds_read_b64_tr_b16 v[12:13], v131 offset:0
    v_mfma_f32_16x16x32_bf16 a[32:35], v[48:51], v[84:87], a[32:35]
    ds_read_b64_tr_b16 v[14:15], v131 offset:8192
    v_mfma_f32_16x16x32_bf16 a[36:39], v[52:55], v[84:87], a[36:39]
    ds_read_b64_tr_b16 v[16:17], v132 offset:0
    s_add_u32 s16, s16, 1024
    v_mfma_f32_16x16x32_bf16 a[40:43], v[56:59], v[84:87], a[40:43]
    ds_read_b64_tr_b16 v[18:19], v132 offset:8192
    v_mfma_f32_16x16x32_bf16 a[44:47], v[60:63], v[84:87], a[44:47]
    ds_read_b64_tr_b16 v[20:21], v133 offset:0
    v_mfma_f32_16x16x32_bf16 a[48:51], v[64:67], v[84:87], a[48:51]
    ds_read_b64_tr_b16 v[22:23], v133 offset:8192
    s_add_u32 m0, s19, 49152
    s_nop 0
    v_mfma_f32_16x16x32_bf16 a[52:55], v[68:71], v[84:87], a[52:55]
    ds_read_b64_tr_b16 v[24:25], v134 offset:0
    v_mfma_f32_16x16x32_bf16 a[56:59], v[72:75], v[84:87], a[56:59]
    ds_read_b64_tr_b16 v[26:27], v134 offset:8192
    v_mfma_f32_16x16x32_bf16 a[60:63], v[76:79], v[84:87], a[60:63]
    ds_read_b64_tr_b16 v[28:29], v135 offset:0
    buffer_load_dwordx4 v137, s[8:11], s15 offen offset:0 lds
    v_mfma_f32_16x16x32_bf16 a[64:67], v[48:51], v[88:91], a[64:67]
    ds_read_b64_tr_b16 v[30:31], v135 offset:8192
    v_mfma_f32_16x16x32_bf16 a[68:71], v[52:55], v[88:91], a[68:71]
    ds_read_b128 v[36:39], v136 offset:1024
    v_mfma_f32_16x16x32_bf16 a[72:75], v[56:59], v[88:91], a[72:75]
    ds_read_b128 v[40:43], v136 offset:2048
    buffer_load_dwordx4 v138, s[8:11], s15 offen offset:1024 lds
    v_mfma_f32_16x16x32_bf16 a[76:79], v[60:63], v[88:91], a[76:79]
    ds_read_b128 v[44:47], v136 offset:3072
    v_mfma_f32_16x16x32_bf16 a[80:83], v[64:67], v[88:91], a[80:83]
    v_mfma_f32_16x16x32_bf16 a[84:87], v[68:71], v[88:91], a[84:87]
    buffer_load_dwordx4 v139, s[8:11], s15 offen offset:2048 lds
    v_mfma_f32_16x16x32_bf16 a[88:91], v[72:75], v[88:91], a[88:91]
    v_mfma_f32_16x16x32_bf16 a[92:95], v[76:79], v[88:91], a[92:95]
    v_mfma_f32_16x16x32_bf16 a[96:99], v[48:51], v[92:95], a[96:99]
    buffer_load_dwordx4 v140, s[8:11], s15 offen offset:3072 lds
    v_mfma_f32_16x16x32_bf16 a[100:103], v[52:55], v[92:95], a[100:103]
    v_mfma_f32_16x16x32_bf16 a[104:107], v[56:59], v[92:95], a[104:107]
    v_mfma_f32_16x16x32_bf16 a[108:111], v[60:63], v[92:95], a[108:111]
    s_add_u32 s15, s15, s17
    v_mfma_f32_16x16x32_bf16 a[112:115], v[64:67], v[92:95], a[112:115]
    v_mfma_f32_16x16x32_bf16 a[116:119], v[68:71], v[92:95], a[116:119]
    v_mfma_f32_16x16x32_bf16 a[120:123], v[72:75], v[92:95], a[120:123]
    v_mfma_f32_16x16x32_bf16 a[124:127], v[76:79], v[92:95], a[124:127]
    s_sub_u32 s18, s18, 1
    s_cmp_lg_u32 s18, 0
    s_cbranch_scc1 main_kernel_w_c1_n_loop
    s_cmp_lg_u32 s14, 0
    s_cbranch_scc1 main_kernel_w_c1_n_nt
    s_lshl_b32 s32, s27, 8
    s_add_u32 s32, s32, 0x841e000
    v_mov_b32 v255, 1
    s_mov_b64 exec, 1
    buffer_atomic_add v255, off, s[4:7], s32 sc0 sc1
    s_mov_b64 exec, -1
main_kernel_w_c1_n_nt:
    s_waitcnt lgkmcnt(0)
    v_mfma_f32_16x16x32_bf16 a[0:3], v[0:3], v[32:35], a[0:3]
    s_waitcnt vmcnt(12)
    s_barrier
    ds_read_b128 v[80:83], v136 offset:8192
    v_mfma_f32_16x16x32_bf16 a[4:7], v[4:7], v[32:35], a[4:7]
    ds_read_b64_tr_b16 v[48:49], v128 offset:16384
    v_mfma_f32_16x16x32_bf16 a[8:11], v[8:11], v[32:35], a[8:11]
    ds_read_b64_tr_b16 v[50:51], v128 offset:24576
    v_mfma_f32_16x16x32_bf16 a[12:15], v[12:15], v[32:35], a[12:15]
    ds_read_b64_tr_b16 v[52:53], v129 offset:16384
    v_mfma_f32_16x16x32_bf16 a[16:19], v[16:19], v[32:35], a[16:19]
    ds_read_b64_tr_b16 v[54:55], v129 offset:24576
    v_mfma_f32_16x16x32_bf16 a[20:23], v[20:23], v[32:35], a[20:23]
    ds_read_b64_tr_b16 v[56:57], v130 offset:16384
    v_mfma_f32_16x16x32_bf16 a[24:27], v[24:27], v[32:35], a[24:27]
    ds_read_b64_tr_b16 v[58:59], v130 offset:24576
    v_mfma_f32_16x16x32_bf16 a[28:31], v[28:31], v[32:35], a[28:31]
    ds_read_b64_tr_b16 v[60:61], v131 offset:16384
    v_mfma_f32_16x16x32_bf16 a[32:35], v[0:3], v[36:39], a[32:35]
    ds_read_b64_tr_b16 v[62:63], v131 offset:24576
    v_mfma_f32_16x16x32_bf16 a[36:39], v[4:7], v[36:39], a[36:39]
    ds_read_b64_tr_b16 v[64:65], v132 offset:16384
    v_mfma_f32_16x16x32_bf16 a[40:43], v[8:11], v[36:39], a[40:43]
    ds_read_b64_tr_b16 v[66:67], v132 offset:24576
    v_mfma_f32_16x16x32_bf16 a[44:47], v[12:15], v[36:39], a[44:47]
    ds_read_b64_tr_b16 v[68:69], v133 offset:16384
    v_mfma_f32_16x16x32_bf16 a[48:51], v[16:19], v[36:39], a[48:51]
    ds_read_b64_tr_b16 v[70:71], v133 offset:24576
    v_mfma_f32_16x16x32_bf16 a[52:55], v[20:23], v[36:39], a[52:55]
    ds_read_b64_tr_b16 v[72:73], v134 offset:16384
    v_mfma_f32_16x16x32_bf16 a[56:59], v[24:27], v[36:39], a[56:59]
    ds_read_b64_tr_b16 v[74:75], v134 offset:24576
    v_mfma_f32_16x16x32_bf16 a[60:63], v[28:31], v[36:39], a[60:63]
    ds_read_b64_tr_b16 v[76:77], v135 offset:16384
    v_mfma_f32_16x16x32_bf16 a[64:67], v[0:3], v[40:43], a[64:67]
    ds_read_b64_tr_b16 v[78:79], v135 offset:24576
    v_mfma_f32_16x16x32_bf16 a[68:71], v[4:7], v[40:43], a[68:71]
    ds_read_b128 v[84:87], v136 offset:9216
    v_mfma_f32_16x16x32_bf16 a[72:75], v[8:11], v[40:43], a[72:75]
    ds_read_b128 v[88:91], v136 offset:10240
    v_mfma_f32_16x16x32_bf16 a[76:79], v[12:15], v[40:43], a[76:79]
    ds_read_b128 v[92:95], v136 offset:11264
    v_mfma_f32_16x16x32_bf16 a[80:83], v[16:19], v[40:43], a[80:83]
    v_mfma_f32_16x16x32_bf16 a[84:87], v[20:23], v[40:43], a[84:87]
    v_mfma_f32_16x16x32_bf16 a[88:91], v[24:27], v[40:43], a[88:91]
    v_mfma_f32_16x16x32_bf16 a[92:95], v[28:31], v[40:43], a[92:95]
    v_mfma_f32_16x16x32_bf16 a[96:99], v[0:3], v[44:47], a[96:99]
    v_mfma_f32_16x16x32_bf16 a[100:103], v[4:7], v[44:47], a[100:103]
    v_mfma_f32_16x16x32_bf16 a[104:107], v[8:11], v[44:47], a[104:107]
    v_mfma_f32_16x16x32_bf16 a[108:111], v[12:15], v[44:47], a[108:111]
    v_mfma_f32_16x16x32_bf16 a[112:115], v[16:19], v[44:47], a[112:115]
    v_mfma_f32_16x16x32_bf16 a[116:119], v[20:23], v[44:47], a[116:119]
    v_mfma_f32_16x16x32_bf16 a[120:123], v[24:27], v[44:47], a[120:123]
    v_mfma_f32_16x16x32_bf16 a[124:127], v[28:31], v[44:47], a[124:127]
    s_waitcnt lgkmcnt(0)
    v_mfma_f32_16x16x32_bf16 a[0:3], v[48:51], v[80:83], a[0:3]
    s_waitcnt vmcnt(6)
    s_barrier
    ds_read_b128 v[32:35], v136 offset:16384
    v_mfma_f32_16x16x32_bf16 a[4:7], v[52:55], v[80:83], a[4:7]
    ds_read_b64_tr_b16 v[0:1], v128 offset:32768
    v_mfma_f32_16x16x32_bf16 a[8:11], v[56:59], v[80:83], a[8:11]
    ds_read_b64_tr_b16 v[2:3], v128 offset:40960
    v_mfma_f32_16x16x32_bf16 a[12:15], v[60:63], v[80:83], a[12:15]
    ds_read_b64_tr_b16 v[4:5], v129 offset:32768
    v_mfma_f32_16x16x32_bf16 a[16:19], v[64:67], v[80:83], a[16:19]
    ds_read_b64_tr_b16 v[6:7], v129 offset:40960
    v_mfma_f32_16x16x32_bf16 a[20:23], v[68:71], v[80:83], a[20:23]
    ds_read_b64_tr_b16 v[8:9], v130 offset:32768
    v_mfma_f32_16x16x32_bf16 a[24:27], v[72:75], v[80:83], a[24:27]
    ds_read_b64_tr_b16 v[10:11], v130 offset:40960
    v_mfma_f32_16x16x32_bf16 a[28:31], v[76:79], v[80:83], a[28:31]
    ds_read_b64_tr_b16 v[12:13], v131 offset:32768
    v_mfma_f32_16x16x32_bf16 a[32:35], v[48:51], v[84:87], a[32:35]
    ds_read_b64_tr_b16 v[14:15], v131 offset:40960
    v_mfma_f32_16x16x32_bf16 a[36:39], v[52:55], v[84:87], a[36:39]
    ds_read_b64_tr_b16 v[16:17], v132 offset:32768
    v_mfma_f32_16x16x32_bf16 a[40:43], v[56:59], v[84:87], a[40:43]
    ds_read_b64_tr_b16 v[18:19], v132 offset:40960
    v_mfma_f32_16x16x32_bf16 a[44:47], v[60:63], v[84:87], a[44:47]
    ds_read_b64_tr_b16 v[20:21], v133 offset:32768
    v_mfma_f32_16x16x32_bf16 a[48:51], v[64:67], v[84:87], a[48:51]
    ds_read_b64_tr_b16 v[22:23], v133 offset:40960
    v_mfma_f32_16x16x32_bf16 a[52:55], v[68:71], v[84:87], a[52:55]
    ds_read_b64_tr_b16 v[24:25], v134 offset:32768
    v_mfma_f32_16x16x32_bf16 a[56:59], v[72:75], v[84:87], a[56:59]
    ds_read_b64_tr_b16 v[26:27], v134 offset:40960
    v_mfma_f32_16x16x32_bf16 a[60:63], v[76:79], v[84:87], a[60:63]
    ds_read_b64_tr_b16 v[28:29], v135 offset:32768
    v_mfma_f32_16x16x32_bf16 a[64:67], v[48:51], v[88:91], a[64:67]
    ds_read_b64_tr_b16 v[30:31], v135 offset:40960
    v_mfma_f32_16x16x32_bf16 a[68:71], v[52:55], v[88:91], a[68:71]
    ds_read_b128 v[36:39], v136 offset:17408
    v_mfma_f32_16x16x32_bf16 a[72:75], v[56:59], v[88:91], a[72:75]
    ds_read_b128 v[40:43], v136 offset:18432
    v_mfma_f32_16x16x32_bf16 a[76:79], v[60:63], v[88:91], a[76:79]
    ds_read_b128 v[44:47], v136 offset:19456
    v_mfma_f32_16x16x32_bf16 a[80:83], v[64:67], v[88:91], a[80:83]
    v_mfma_f32_16x16x32_bf16 a[84:87], v[68:71], v[88:91], a[84:87]
    v_mfma_f32_16x16x32_bf16 a[88:91], v[72:75], v[88:91], a[88:91]
    v_mfma_f32_16x16x32_bf16 a[92:95], v[76:79], v[88:91], a[92:95]
    v_mfma_f32_16x16x32_bf16 a[96:99], v[48:51], v[92:95], a[96:99]
    v_mfma_f32_16x16x32_bf16 a[100:103], v[52:55], v[92:95], a[100:103]
    v_mfma_f32_16x16x32_bf16 a[104:107], v[56:59], v[92:95], a[104:107]
    v_mfma_f32_16x16x32_bf16 a[108:111], v[60:63], v[92:95], a[108:111]
    v_mfma_f32_16x16x32_bf16 a[112:115], v[64:67], v[92:95], a[112:115]
    v_mfma_f32_16x16x32_bf16 a[116:119], v[68:71], v[92:95], a[116:119]
    v_mfma_f32_16x16x32_bf16 a[120:123], v[72:75], v[92:95], a[120:123]
    v_mfma_f32_16x16x32_bf16 a[124:127], v[76:79], v[92:95], a[124:127]
    s_waitcnt lgkmcnt(0)
    v_mfma_f32_16x16x32_bf16 a[0:3], v[0:3], v[32:35], a[0:3]
    s_waitcnt vmcnt(0)
    s_barrier
    ds_read_b128 v[80:83], v136 offset:24576
    v_mfma_f32_16x16x32_bf16 a[4:7], v[4:7], v[32:35], a[4:7]
    ds_read_b64_tr_b16 v[48:49], v128 offset:49152
    v_mfma_f32_16x16x32_bf16 a[8:11], v[8:11], v[32:35], a[8:11]
    ds_read_b64_tr_b16 v[50:51], v128 offset:57344
    v_mfma_f32_16x16x32_bf16 a[12:15], v[12:15], v[32:35], a[12:15]
    ds_read_b64_tr_b16 v[52:53], v129 offset:49152
    v_mfma_f32_16x16x32_bf16 a[16:19], v[16:19], v[32:35], a[16:19]
    ds_read_b64_tr_b16 v[54:55], v129 offset:57344
    v_mfma_f32_16x16x32_bf16 a[20:23], v[20:23], v[32:35], a[20:23]
    ds_read_b64_tr_b16 v[56:57], v130 offset:49152
    v_mfma_f32_16x16x32_bf16 a[24:27], v[24:27], v[32:35], a[24:27]
    ds_read_b64_tr_b16 v[58:59], v130 offset:57344
    v_mfma_f32_16x16x32_bf16 a[28:31], v[28:31], v[32:35], a[28:31]
    ds_read_b64_tr_b16 v[60:61], v131 offset:49152
    v_mfma_f32_16x16x32_bf16 a[32:35], v[0:3], v[36:39], a[32:35]
    ds_read_b64_tr_b16 v[62:63], v131 offset:57344
    v_mfma_f32_16x16x32_bf16 a[36:39], v[4:7], v[36:39], a[36:39]
    ds_read_b64_tr_b16 v[64:65], v132 offset:49152
    v_mfma_f32_16x16x32_bf16 a[40:43], v[8:11], v[36:39], a[40:43]
    ds_read_b64_tr_b16 v[66:67], v132 offset:57344
    v_mfma_f32_16x16x32_bf16 a[44:47], v[12:15], v[36:39], a[44:47]
    ds_read_b64_tr_b16 v[68:69], v133 offset:49152
    v_mfma_f32_16x16x32_bf16 a[48:51], v[16:19], v[36:39], a[48:51]
    ds_read_b64_tr_b16 v[70:71], v133 offset:57344
    v_mfma_f32_16x16x32_bf16 a[52:55], v[20:23], v[36:39], a[52:55]
    ds_read_b64_tr_b16 v[72:73], v134 offset:49152
    v_mfma_f32_16x16x32_bf16 a[56:59], v[24:27], v[36:39], a[56:59]
    ds_read_b64_tr_b16 v[74:75], v134 offset:57344
    v_mfma_f32_16x16x32_bf16 a[60:63], v[28:31], v[36:39], a[60:63]
    ds_read_b64_tr_b16 v[76:77], v135 offset:49152
    v_mfma_f32_16x16x32_bf16 a[64:67], v[0:3], v[40:43], a[64:67]
    ds_read_b64_tr_b16 v[78:79], v135 offset:57344
    v_mfma_f32_16x16x32_bf16 a[68:71], v[4:7], v[40:43], a[68:71]
    ds_read_b128 v[84:87], v136 offset:25600
    v_mfma_f32_16x16x32_bf16 a[72:75], v[8:11], v[40:43], a[72:75]
    ds_read_b128 v[88:91], v136 offset:26624
    v_mfma_f32_16x16x32_bf16 a[76:79], v[12:15], v[40:43], a[76:79]
    ds_read_b128 v[92:95], v136 offset:27648
    v_mfma_f32_16x16x32_bf16 a[80:83], v[16:19], v[40:43], a[80:83]
    v_mfma_f32_16x16x32_bf16 a[84:87], v[20:23], v[40:43], a[84:87]
    v_mfma_f32_16x16x32_bf16 a[88:91], v[24:27], v[40:43], a[88:91]
    v_mfma_f32_16x16x32_bf16 a[92:95], v[28:31], v[40:43], a[92:95]
    v_mfma_f32_16x16x32_bf16 a[96:99], v[0:3], v[44:47], a[96:99]
    v_mfma_f32_16x16x32_bf16 a[100:103], v[4:7], v[44:47], a[100:103]
    v_mfma_f32_16x16x32_bf16 a[104:107], v[8:11], v[44:47], a[104:107]
    v_mfma_f32_16x16x32_bf16 a[108:111], v[12:15], v[44:47], a[108:111]
    v_mfma_f32_16x16x32_bf16 a[112:115], v[16:19], v[44:47], a[112:115]
    v_mfma_f32_16x16x32_bf16 a[116:119], v[20:23], v[44:47], a[116:119]
    v_mfma_f32_16x16x32_bf16 a[120:123], v[24:27], v[44:47], a[120:123]
    v_mfma_f32_16x16x32_bf16 a[124:127], v[28:31], v[44:47], a[124:127]
    v_readfirstlane_b32 s55, v255
    s_waitcnt lgkmcnt(0)
    v_mfma_f32_16x16x32_bf16 a[0:3], v[48:51], v[80:83], a[0:3]
    v_mfma_f32_16x16x32_bf16 a[4:7], v[52:55], v[80:83], a[4:7]
    v_mfma_f32_16x16x32_bf16 a[8:11], v[56:59], v[80:83], a[8:11]
    v_mfma_f32_16x16x32_bf16 a[12:15], v[60:63], v[80:83], a[12:15]
    v_mfma_f32_16x16x32_bf16 a[16:19], v[64:67], v[80:83], a[16:19]
    v_mfma_f32_16x16x32_bf16 a[20:23], v[68:71], v[80:83], a[20:23]
    v_mfma_f32_16x16x32_bf16 a[24:27], v[72:75], v[80:83], a[24:27]
    v_mfma_f32_16x16x32_bf16 a[28:31], v[76:79], v[80:83], a[28:31]
    v_mfma_f32_16x16x32_bf16 a[32:35], v[48:51], v[84:87], a[32:35]
    v_mfma_f32_16x16x32_bf16 a[36:39], v[52:55], v[84:87], a[36:39]
    v_mfma_f32_16x16x32_bf16 a[40:43], v[56:59], v[84:87], a[40:43]
    v_mfma_f32_16x16x32_bf16 a[44:47], v[60:63], v[84:87], a[44:47]
    v_mfma_f32_16x16x32_bf16 a[48:51], v[64:67], v[84:87], a[48:51]
    v_mfma_f32_16x16x32_bf16 a[52:55], v[68:71], v[84:87], a[52:55]
    v_mfma_f32_16x16x32_bf16 a[56:59], v[72:75], v[84:87], a[56:59]
    v_mfma_f32_16x16x32_bf16 a[60:63], v[76:79], v[84:87], a[60:63]
    v_mfma_f32_16x16x32_bf16 a[64:67], v[48:51], v[88:91], a[64:67]
    v_mfma_f32_16x16x32_bf16 a[68:71], v[52:55], v[88:91], a[68:71]
    v_mfma_f32_16x16x32_bf16 a[72:75], v[56:59], v[88:91], a[72:75]
    v_mfma_f32_16x16x32_bf16 a[76:79], v[60:63], v[88:91], a[76:79]
    v_mfma_f32_16x16x32_bf16 a[80:83], v[64:67], v[88:91], a[80:83]
    v_mfma_f32_16x16x32_bf16 a[84:87], v[68:71], v[88:91], a[84:87]
    v_mfma_f32_16x16x32_bf16 a[88:91], v[72:75], v[88:91], a[88:91]
    v_mfma_f32_16x16x32_bf16 a[92:95], v[76:79], v[88:91], a[92:95]
    v_mfma_f32_16x16x32_bf16 a[96:99], v[48:51], v[92:95], a[96:99]
    v_mfma_f32_16x16x32_bf16 a[100:103], v[52:55], v[92:95], a[100:103]
    v_mfma_f32_16x16x32_bf16 a[104:107], v[56:59], v[92:95], a[104:107]
    v_mfma_f32_16x16x32_bf16 a[108:111], v[60:63], v[92:95], a[108:111]
    v_mfma_f32_16x16x32_bf16 a[112:115], v[64:67], v[92:95], a[112:115]
    v_mfma_f32_16x16x32_bf16 a[116:119], v[68:71], v[92:95], a[116:119]
    v_mfma_f32_16x16x32_bf16 a[120:123], v[72:75], v[92:95], a[120:123]
    v_mfma_f32_16x16x32_bf16 a[124:127], v[76:79], v[92:95], a[124:127]
    s_nop 7
    s_cmp_eq_u32 s23, 1
    s_cbranch_scc1 main_kernel_w_c1_escl
    s_cmp_eq_u32 s23, 3
    s_cbranch_scc1 main_kernel_w_c1_egelus
    s_cmp_eq_u32 s23, 6
    s_cbranch_scc1 main_kernel_w_c1_egelu
main_kernel_w_c1_eplain:
    s_mov_b32 s53, s21
    v_accvgpr_read_b32 v0, a0
    v_accvgpr_read_b32 v1, a1
    v_accvgpr_read_b32 v2, a2
    v_accvgpr_read_b32 v3, a3
    v_accvgpr_read_b32 v4, a4
    v_accvgpr_read_b32 v5, a5
    v_accvgpr_read_b32 v6, a6
    v_accvgpr_read_b32 v7, a7
    v_cvt_pk_bf16_f32 v16, v0, v1
    v_cvt_pk_bf16_f32 v17, v2, v3
    v_cvt_pk_bf16_f32 v18, v4, v5
    v_cvt_pk_bf16_f32 v19, v6, v7
    buffer_store_dwordx4 v[16:19], v251, s[4:7], s53 offen offset:0 sc1
    v_accvgpr_read_b32 v20, a8
    v_accvgpr_read_b32 v21, a9
    v_accvgpr_read_b32 v22, a10
    v_accvgpr_read_b32 v23, a11
    v_accvgpr_read_b32 v24, a12
    v_accvgpr_read_b32 v25, a13
    v_accvgpr_read_b32 v26, a14
    v_accvgpr_read_b32 v27, a15
    v_cvt_pk_bf16_f32 v36, v20, v21
    v_cvt_pk_bf16_f32 v37, v22, v23
    v_cvt_pk_bf16_f32 v38, v24, v25
    v_cvt_pk_bf16_f32 v39, v26, v27
    buffer_store_dwordx4 v[36:39], v251, s[4:7], s53 offen offset:1024 sc1
    v_accvgpr_read_b32 v40, a16
    v_accvgpr_read_b32 v41, a17
    v_accvgpr_read_b32 v42, a18
    v_accvgpr_read_b32 v43, a19
    v_accvgpr_read_b32 v44, a20
    v_accvgpr_read_b32 v45, a21
    v_accvgpr_read_b32 v46, a22
    v_accvgpr_read_b32 v47, a23
    v_cvt_pk_bf16_f32 v56, v40, v41
    v_cvt_pk_bf16_f32 v57, v42, v43
    v_cvt_pk_bf16_f32 v58, v44, v45
    v_cvt_pk_bf16_f32 v59, v46, v47
    buffer_store_dwordx4 v[56:59], v251, s[4:7], s53 offen offset:2048 sc1
    v_accvgpr_read_b32 v0, a24
    v_accvgpr_read_b32 v1, a25
    v_accvgpr_read_b32 v2, a26
    v_accvgpr_read_b32 v3, a27
    v_accvgpr_read_b32 v4, a28
    v_accvgpr_read_b32 v5, a29
    v_accvgpr_read_b32 v6, a30
    v_accvgpr_read_b32 v7, a31
    v_cvt_pk_bf16_f32 v16, v0, v1
    v_cvt_pk_bf16_f32 v17, v2, v3
    v_cvt_pk_bf16_f32 v18, v4, v5
    v_cvt_pk_bf16_f32 v19, v6, v7
    buffer_store_dwordx4 v[16:19], v251, s[4:7], s53 offen offset:3072 sc1
    s_add_u32 s53, s53, s22
    v_accvgpr_read_b32 v20, a32
    v_accvgpr_read_b32 v21, a33
    v_accvgpr_read_b32 v22, a34
    v_accvgpr_read_b32 v23, a35
    v_accvgpr_read_b32 v24, a36
    v_accvgpr_read_b32 v25, a37
    v_accvgpr_read_b32 v26, a38
    v_accvgpr_read_b32 v27, a39
    v_cvt_pk_bf16_f32 v36, v20, v21
    v_cvt_pk_bf16_f32 v37, v22, v23
    v_cvt_pk_bf16_f32 v38, v24, v25
    v_cvt_pk_bf16_f32 v39, v26, v27
    buffer_store_dwordx4 v[36:39], v251, s[4:7], s53 offen offset:0 sc1
    v_accvgpr_read_b32 v40, a40
    v_accvgpr_read_b32 v41, a41
    v_accvgpr_read_b32 v42, a42
    v_accvgpr_read_b32 v43, a43
    v_accvgpr_read_b32 v44, a44
    v_accvgpr_read_b32 v45, a45
    v_accvgpr_read_b32 v46, a46
    v_accvgpr_read_b32 v47, a47
    v_cvt_pk_bf16_f32 v56, v40, v41
    v_cvt_pk_bf16_f32 v57, v42, v43
    v_cvt_pk_bf16_f32 v58, v44, v45
    v_cvt_pk_bf16_f32 v59, v46, v47
    buffer_store_dwordx4 v[56:59], v251, s[4:7], s53 offen offset:1024 sc1
    v_accvgpr_read_b32 v0, a48
    v_accvgpr_read_b32 v1, a49
    v_accvgpr_read_b32 v2, a50
    v_accvgpr_read_b32 v3, a51
    v_accvgpr_read_b32 v4, a52
    v_accvgpr_read_b32 v5, a53
    v_accvgpr_read_b32 v6, a54
    v_accvgpr_read_b32 v7, a55
    v_cvt_pk_bf16_f32 v16, v0, v1
    v_cvt_pk_bf16_f32 v17, v2, v3
    v_cvt_pk_bf16_f32 v18, v4, v5
    v_cvt_pk_bf16_f32 v19, v6, v7
    buffer_store_dwordx4 v[16:19], v251, s[4:7], s53 offen offset:2048 sc1
    v_accvgpr_read_b32 v20, a56
    v_accvgpr_read_b32 v21, a57
    v_accvgpr_read_b32 v22, a58
    v_accvgpr_read_b32 v23, a59
    v_accvgpr_read_b32 v24, a60
    v_accvgpr_read_b32 v25, a61
    v_accvgpr_read_b32 v26, a62
    v_accvgpr_read_b32 v27, a63
    v_cvt_pk_bf16_f32 v36, v20, v21
    v_cvt_pk_bf16_f32 v37, v22, v23
    v_cvt_pk_bf16_f32 v38, v24, v25
    v_cvt_pk_bf16_f32 v39, v26, v27
    buffer_store_dwordx4 v[36:39], v251, s[4:7], s53 offen offset:3072 sc1
    s_add_u32 s53, s53, s22
    v_accvgpr_read_b32 v40, a64
    v_accvgpr_read_b32 v41, a65
    v_accvgpr_read_b32 v42, a66
    v_accvgpr_read_b32 v43, a67
    v_accvgpr_read_b32 v44, a68
    v_accvgpr_read_b32 v45, a69
    v_accvgpr_read_b32 v46, a70
    v_accvgpr_read_b32 v47, a71
    v_cvt_pk_bf16_f32 v56, v40, v41
    v_cvt_pk_bf16_f32 v57, v42, v43
    v_cvt_pk_bf16_f32 v58, v44, v45
    v_cvt_pk_bf16_f32 v59, v46, v47
    buffer_store_dwordx4 v[56:59], v251, s[4:7], s53 offen offset:0 sc1
    v_accvgpr_read_b32 v0, a72
    v_accvgpr_read_b32 v1, a73
    v_accvgpr_read_b32 v2, a74
    v_accvgpr_read_b32 v3, a75
    v_accvgpr_read_b32 v4, a76
    v_accvgpr_read_b32 v5, a77
    v_accvgpr_read_b32 v6, a78
    v_accvgpr_read_b32 v7, a79
    v_cvt_pk_bf16_f32 v16, v0, v1
    v_cvt_pk_bf16_f32 v17, v2, v3
    v_cvt_pk_bf16_f32 v18, v4, v5
    v_cvt_pk_bf16_f32 v19, v6, v7
    buffer_store_dwordx4 v[16:19], v251, s[4:7], s53 offen offset:1024 sc1
    v_accvgpr_read_b32 v20, a80
    v_accvgpr_read_b32 v21, a81
    v_accvgpr_read_b32 v22, a82
    v_accvgpr_read_b32 v23, a83
    v_accvgpr_read_b32 v24, a84
    v_accvgpr_read_b32 v25, a85
    v_accvgpr_read_b32 v26, a86
    v_accvgpr_read_b32 v27, a87
    v_cvt_pk_bf16_f32 v36, v20, v21
    v_cvt_pk_bf16_f32 v37, v22, v23
    v_cvt_pk_bf16_f32 v38, v24, v25
    v_cvt_pk_bf16_f32 v39, v26, v27
    buffer_store_dwordx4 v[36:39], v251, s[4:7], s53 offen offset:2048 sc1
    v_accvgpr_read_b32 v40, a88
    v_accvgpr_read_b32 v41, a89
    v_accvgpr_read_b32 v42, a90
    v_accvgpr_read_b32 v43, a91
    v_accvgpr_read_b32 v44, a92
    v_accvgpr_read_b32 v45, a93
    v_accvgpr_read_b32 v46, a94
    v_accvgpr_read_b32 v47, a95
    v_cvt_pk_bf16_f32 v56, v40, v41
    v_cvt_pk_bf16_f32 v57, v42, v43
    v_cvt_pk_bf16_f32 v58, v44, v45
    v_cvt_pk_bf16_f32 v59, v46, v47
    buffer_store_dwordx4 v[56:59], v251, s[4:7], s53 offen offset:3072 sc1
    s_add_u32 s53, s53, s22
    v_accvgpr_read_b32 v0, a96
    v_accvgpr_read_b32 v1, a97
    v_accvgpr_read_b32 v2, a98
    v_accvgpr_read_b32 v3, a99
    v_accvgpr_read_b32 v4, a100
    v_accvgpr_read_b32 v5, a101
    v_accvgpr_read_b32 v6, a102
    v_accvgpr_read_b32 v7, a103
    v_cvt_pk_bf16_f32 v16, v0, v1
    v_cvt_pk_bf16_f32 v17, v2, v3
    v_cvt_pk_bf16_f32 v18, v4, v5
    v_cvt_pk_bf16_f32 v19, v6, v7
    buffer_store_dwordx4 v[16:19], v251, s[4:7], s53 offen offset:0 sc1
    v_accvgpr_read_b32 v20, a104
    v_accvgpr_read_b32 v21, a105
    v_accvgpr_read_b32 v22, a106
    v_accvgpr_read_b32 v23, a107
    v_accvgpr_read_b32 v24, a108
    v_accvgpr_read_b32 v25, a109
    v_accvgpr_read_b32 v26, a110
    v_accvgpr_read_b32 v27, a111
    v_cvt_pk_bf16_f32 v36, v20, v21
    v_cvt_pk_bf16_f32 v37, v22, v23
    v_cvt_pk_bf16_f32 v38, v24, v25
    v_cvt_pk_bf16_f32 v39, v26, v27
    buffer_store_dwordx4 v[36:39], v251, s[4:7], s53 offen offset:1024 sc1
    v_accvgpr_read_b32 v40, a112
    v_accvgpr_read_b32 v41, a113
    v_accvgpr_read_b32 v42, a114
    v_accvgpr_read_b32 v43, a115
    v_accvgpr_read_b32 v44, a116
    v_accvgpr_read_b32 v45, a117
    v_accvgpr_read_b32 v46, a118
    v_accvgpr_read_b32 v47, a119
    v_cvt_pk_bf16_f32 v56, v40, v41
    v_cvt_pk_bf16_f32 v57, v42, v43
    v_cvt_pk_bf16_f32 v58, v44, v45
    v_cvt_pk_bf16_f32 v59, v46, v47
    buffer_store_dwordx4 v[56:59], v251, s[4:7], s53 offen offset:2048 sc1
    v_accvgpr_read_b32 v0, a120
    v_accvgpr_read_b32 v1, a121
    v_accvgpr_read_b32 v2, a122
    v_accvgpr_read_b32 v3, a123
    v_accvgpr_read_b32 v4, a124
    v_accvgpr_read_b32 v5, a125
    v_accvgpr_read_b32 v6, a126
    v_accvgpr_read_b32 v7, a127
    v_cvt_pk_bf16_f32 v16, v0, v1
    v_cvt_pk_bf16_f32 v17, v2, v3
    v_cvt_pk_bf16_f32 v18, v4, v5
    v_cvt_pk_bf16_f32 v19, v6, v7
    buffer_store_dwordx4 v[16:19], v251, s[4:7], s53 offen offset:3072 sc1
    s_branch main_kernel_w_done
main_kernel_w_c1_escl:
    s_mov_b32 s53, s21
    v_accvgpr_read_b32 v0, a0
    v_accvgpr_read_b32 v1, a1
    v_accvgpr_read_b32 v2, a2
    v_accvgpr_read_b32 v3, a3
    v_accvgpr_read_b32 v4, a4
    v_accvgpr_read_b32 v5, a5
    v_accvgpr_read_b32 v6, a6
    v_accvgpr_read_b32 v7, a7
    v_mul_f32 v0, 0x3e0293ee, v0
    v_mul_f32 v1, 0x3e0293ee, v1
    v_mul_f32 v2, 0x3e0293ee, v2
    v_mul_f32 v3, 0x3e0293ee, v3
    v_mul_f32 v4, 0x3e0293ee, v4
    v_mul_f32 v5, 0x3e0293ee, v5
    v_mul_f32 v6, 0x3e0293ee, v6
    v_mul_f32 v7, 0x3e0293ee, v7
    v_cvt_pk_bf16_f32 v16, v0, v1
    v_cvt_pk_bf16_f32 v17, v2, v3
    v_cvt_pk_bf16_f32 v18, v4, v5
    v_cvt_pk_bf16_f32 v19, v6, v7
    buffer_store_dwordx4 v[16:19], v251, s[4:7], s53 offen offset:0 sc1
    v_accvgpr_read_b32 v20, a8
    v_accvgpr_read_b32 v21, a9
    v_accvgpr_read_b32 v22, a10
    v_accvgpr_read_b32 v23, a11
    v_accvgpr_read_b32 v24, a12
    v_accvgpr_read_b32 v25, a13
    v_accvgpr_read_b32 v26, a14
    v_accvgpr_read_b32 v27, a15
    v_mul_f32 v20, 0x3e0293ee, v20
    v_mul_f32 v21, 0x3e0293ee, v21
    v_mul_f32 v22, 0x3e0293ee, v22
    v_mul_f32 v23, 0x3e0293ee, v23
    v_mul_f32 v24, 0x3e0293ee, v24
    v_mul_f32 v25, 0x3e0293ee, v25
    v_mul_f32 v26, 0x3e0293ee, v26
    v_mul_f32 v27, 0x3e0293ee, v27
    v_cvt_pk_bf16_f32 v36, v20, v21
    v_cvt_pk_bf16_f32 v37, v22, v23
    v_cvt_pk_bf16_f32 v38, v24, v25
    v_cvt_pk_bf16_f32 v39, v26, v27
    buffer_store_dwordx4 v[36:39], v251, s[4:7], s53 offen offset:1024 sc1
    v_accvgpr_read_b32 v40, a16
    v_accvgpr_read_b32 v41, a17
    v_accvgpr_read_b32 v42, a18
    v_accvgpr_read_b32 v43, a19
    v_accvgpr_read_b32 v44, a20
    v_accvgpr_read_b32 v45, a21
    v_accvgpr_read_b32 v46, a22
    v_accvgpr_read_b32 v47, a23
    v_mul_f32 v40, 0x3e0293ee, v40
    v_mul_f32 v41, 0x3e0293ee, v41
    v_mul_f32 v42, 0x3e0293ee, v42
    v_mul_f32 v43, 0x3e0293ee, v43
    v_mul_f32 v44, 0x3e0293ee, v44
    v_mul_f32 v45, 0x3e0293ee, v45
    v_mul_f32 v46, 0x3e0293ee, v46
    v_mul_f32 v47, 0x3e0293ee, v47
    v_cvt_pk_bf16_f32 v56, v40, v41
    v_cvt_pk_bf16_f32 v57, v42, v43
    v_cvt_pk_bf16_f32 v58, v44, v45
    v_cvt_pk_bf16_f32 v59, v46, v47
    buffer_store_dwordx4 v[56:59], v251, s[4:7], s53 offen offset:2048 sc1
    v_accvgpr_read_b32 v0, a24
    v_accvgpr_read_b32 v1, a25
    v_accvgpr_read_b32 v2, a26
    v_accvgpr_read_b32 v3, a27
    v_accvgpr_read_b32 v4, a28
    v_accvgpr_read_b32 v5, a29
    v_accvgpr_read_b32 v6, a30
    v_accvgpr_read_b32 v7, a31
    v_mul_f32 v0, 0x3e0293ee, v0
    v_mul_f32 v1, 0x3e0293ee, v1
    v_mul_f32 v2, 0x3e0293ee, v2
    v_mul_f32 v3, 0x3e0293ee, v3
    v_mul_f32 v4, 0x3e0293ee, v4
    v_mul_f32 v5, 0x3e0293ee, v5
    v_mul_f32 v6, 0x3e0293ee, v6
    v_mul_f32 v7, 0x3e0293ee, v7
    v_cvt_pk_bf16_f32 v16, v0, v1
    v_cvt_pk_bf16_f32 v17, v2, v3
    v_cvt_pk_bf16_f32 v18, v4, v5
    v_cvt_pk_bf16_f32 v19, v6, v7
    buffer_store_dwordx4 v[16:19], v251, s[4:7], s53 offen offset:3072 sc1
    s_add_u32 s53, s53, s22
    v_accvgpr_read_b32 v20, a32
    v_accvgpr_read_b32 v21, a33
    v_accvgpr_read_b32 v22, a34
    v_accvgpr_read_b32 v23, a35
    v_accvgpr_read_b32 v24, a36
    v_accvgpr_read_b32 v25, a37
    v_accvgpr_read_b32 v26, a38
    v_accvgpr_read_b32 v27, a39
    v_mul_f32 v20, 0x3e0293ee, v20
    v_mul_f32 v21, 0x3e0293ee, v21
    v_mul_f32 v22, 0x3e0293ee, v22
    v_mul_f32 v23, 0x3e0293ee, v23
    v_mul_f32 v24, 0x3e0293ee, v24
    v_mul_f32 v25, 0x3e0293ee, v25
    v_mul_f32 v26, 0x3e0293ee, v26
    v_mul_f32 v27, 0x3e0293ee, v27
    v_cvt_pk_bf16_f32 v36, v20, v21
    v_cvt_pk_bf16_f32 v37, v22, v23
    v_cvt_pk_bf16_f32 v38, v24, v25
    v_cvt_pk_bf16_f32 v39, v26, v27
    buffer_store_dwordx4 v[36:39], v251, s[4:7], s53 offen offset:0 sc1
    v_accvgpr_read_b32 v40, a40
    v_accvgpr_read_b32 v41, a41
    v_accvgpr_read_b32 v42, a42
    v_accvgpr_read_b32 v43, a43
    v_accvgpr_read_b32 v44, a44
    v_accvgpr_read_b32 v45, a45
    v_accvgpr_read_b32 v46, a46
    v_accvgpr_read_b32 v47, a47
    v_mul_f32 v40, 0x3e0293ee, v40
    v_mul_f32 v41, 0x3e0293ee, v41
    v_mul_f32 v42, 0x3e0293ee, v42
    v_mul_f32 v43, 0x3e0293ee, v43
    v_mul_f32 v44, 0x3e0293ee, v44
    v_mul_f32 v45, 0x3e0293ee, v45
    v_mul_f32 v46, 0x3e0293ee, v46
    v_mul_f32 v47, 0x3e0293ee, v47
    v_cvt_pk_bf16_f32 v56, v40, v41
    v_cvt_pk_bf16_f32 v57, v42, v43
    v_cvt_pk_bf16_f32 v58, v44, v45
    v_cvt_pk_bf16_f32 v59, v46, v47
    buffer_store_dwordx4 v[56:59], v251, s[4:7], s53 offen offset:1024 sc1
    v_accvgpr_read_b32 v0, a48
    v_accvgpr_read_b32 v1, a49
    v_accvgpr_read_b32 v2, a50
    v_accvgpr_read_b32 v3, a51
    v_accvgpr_read_b32 v4, a52
    v_accvgpr_read_b32 v5, a53
    v_accvgpr_read_b32 v6, a54
    v_accvgpr_read_b32 v7, a55
    v_mul_f32 v0, 0x3e0293ee, v0
    v_mul_f32 v1, 0x3e0293ee, v1
    v_mul_f32 v2, 0x3e0293ee, v2
    v_mul_f32 v3, 0x3e0293ee, v3
    v_mul_f32 v4, 0x3e0293ee, v4
    v_mul_f32 v5, 0x3e0293ee, v5
    v_mul_f32 v6, 0x3e0293ee, v6
    v_mul_f32 v7, 0x3e0293ee, v7
    v_cvt_pk_bf16_f32 v16, v0, v1
    v_cvt_pk_bf16_f32 v17, v2, v3
    v_cvt_pk_bf16_f32 v18, v4, v5
    v_cvt_pk_bf16_f32 v19, v6, v7
    buffer_store_dwordx4 v[16:19], v251, s[4:7], s53 offen offset:2048 sc1
    v_accvgpr_read_b32 v20, a56
    v_accvgpr_read_b32 v21, a57
    v_accvgpr_read_b32 v22, a58
    v_accvgpr_read_b32 v23, a59
    v_accvgpr_read_b32 v24, a60
    v_accvgpr_read_b32 v25, a61
    v_accvgpr_read_b32 v26, a62
    v_accvgpr_read_b32 v27, a63
    v_mul_f32 v20, 0x3e0293ee, v20
    v_mul_f32 v21, 0x3e0293ee, v21
    v_mul_f32 v22, 0x3e0293ee, v22
    v_mul_f32 v23, 0x3e0293ee, v23
    v_mul_f32 v24, 0x3e0293ee, v24
    v_mul_f32 v25, 0x3e0293ee, v25
    v_mul_f32 v26, 0x3e0293ee, v26
    v_mul_f32 v27, 0x3e0293ee, v27
    v_cvt_pk_bf16_f32 v36, v20, v21
    v_cvt_pk_bf16_f32 v37, v22, v23
    v_cvt_pk_bf16_f32 v38, v24, v25
    v_cvt_pk_bf16_f32 v39, v26, v27
    buffer_store_dwordx4 v[36:39], v251, s[4:7], s53 offen offset:3072 sc1
    s_add_u32 s53, s53, s22
    v_accvgpr_read_b32 v40, a64
    v_accvgpr_read_b32 v41, a65
    v_accvgpr_read_b32 v42, a66
    v_accvgpr_read_b32 v43, a67
    v_accvgpr_read_b32 v44, a68
    v_accvgpr_read_b32 v45, a69
    v_accvgpr_read_b32 v46, a70
    v_accvgpr_read_b32 v47, a71
    v_mul_f32 v40, 0x3e0293ee, v40
    v_mul_f32 v41, 0x3e0293ee, v41
    v_mul_f32 v42, 0x3e0293ee, v42
    v_mul_f32 v43, 0x3e0293ee, v43
    v_mul_f32 v44, 0x3e0293ee, v44
    v_mul_f32 v45, 0x3e0293ee, v45
    v_mul_f32 v46, 0x3e0293ee, v46
    v_mul_f32 v47, 0x3e0293ee, v47
    v_cvt_pk_bf16_f32 v56, v40, v41
    v_cvt_pk_bf16_f32 v57, v42, v43
    v_cvt_pk_bf16_f32 v58, v44, v45
    v_cvt_pk_bf16_f32 v59, v46, v47
    buffer_store_dwordx4 v[56:59], v251, s[4:7], s53 offen offset:0 sc1
    v_accvgpr_read_b32 v0, a72
    v_accvgpr_read_b32 v1, a73
    v_accvgpr_read_b32 v2, a74
    v_accvgpr_read_b32 v3, a75
    v_accvgpr_read_b32 v4, a76
    v_accvgpr_read_b32 v5, a77
    v_accvgpr_read_b32 v6, a78
    v_accvgpr_read_b32 v7, a79
    v_mul_f32 v0, 0x3e0293ee, v0
    v_mul_f32 v1, 0x3e0293ee, v1
    v_mul_f32 v2, 0x3e0293ee, v2
    v_mul_f32 v3, 0x3e0293ee, v3
    v_mul_f32 v4, 0x3e0293ee, v4
    v_mul_f32 v5, 0x3e0293ee, v5
    v_mul_f32 v6, 0x3e0293ee, v6
    v_mul_f32 v7, 0x3e0293ee, v7
    v_cvt_pk_bf16_f32 v16, v0, v1
    v_cvt_pk_bf16_f32 v17, v2, v3
    v_cvt_pk_bf16_f32 v18, v4, v5
    v_cvt_pk_bf16_f32 v19, v6, v7
    buffer_store_dwordx4 v[16:19], v251, s[4:7], s53 offen offset:1024 sc1
    v_accvgpr_read_b32 v20, a80
    v_accvgpr_read_b32 v21, a81
    v_accvgpr_read_b32 v22, a82
    v_accvgpr_read_b32 v23, a83
    v_accvgpr_read_b32 v24, a84
    v_accvgpr_read_b32 v25, a85
    v_accvgpr_read_b32 v26, a86
    v_accvgpr_read_b32 v27, a87
    v_mul_f32 v20, 0x3e0293ee, v20
    v_mul_f32 v21, 0x3e0293ee, v21
    v_mul_f32 v22, 0x3e0293ee, v22
    v_mul_f32 v23, 0x3e0293ee, v23
    v_mul_f32 v24, 0x3e0293ee, v24
    v_mul_f32 v25, 0x3e0293ee, v25
    v_mul_f32 v26, 0x3e0293ee, v26
    v_mul_f32 v27, 0x3e0293ee, v27
    v_cvt_pk_bf16_f32 v36, v20, v21
    v_cvt_pk_bf16_f32 v37, v22, v23
    v_cvt_pk_bf16_f32 v38, v24, v25
    v_cvt_pk_bf16_f32 v39, v26, v27
    buffer_store_dwordx4 v[36:39], v251, s[4:7], s53 offen offset:2048 sc1
    v_accvgpr_read_b32 v40, a88
    v_accvgpr_read_b32 v41, a89
    v_accvgpr_read_b32 v42, a90
    v_accvgpr_read_b32 v43, a91
    v_accvgpr_read_b32 v44, a92
    v_accvgpr_read_b32 v45, a93
    v_accvgpr_read_b32 v46, a94
    v_accvgpr_read_b32 v47, a95
    v_mul_f32 v40, 0x3e0293ee, v40
    v_mul_f32 v41, 0x3e0293ee, v41
    v_mul_f32 v42, 0x3e0293ee, v42
    v_mul_f32 v43, 0x3e0293ee, v43
    v_mul_f32 v44, 0x3e0293ee, v44
    v_mul_f32 v45, 0x3e0293ee, v45
    v_mul_f32 v46, 0x3e0293ee, v46
    v_mul_f32 v47, 0x3e0293ee, v47
    v_cvt_pk_bf16_f32 v56, v40, v41
    v_cvt_pk_bf16_f32 v57, v42, v43
    v_cvt_pk_bf16_f32 v58, v44, v45
    v_cvt_pk_bf16_f32 v59, v46, v47
    buffer_store_dwordx4 v[56:59], v251, s[4:7], s53 offen offset:3072 sc1
    s_add_u32 s53, s53, s22
    v_accvgpr_read_b32 v0, a96
    v_accvgpr_read_b32 v1, a97
    v_accvgpr_read_b32 v2, a98
    v_accvgpr_read_b32 v3, a99
    v_accvgpr_read_b32 v4, a100
    v_accvgpr_read_b32 v5, a101
    v_accvgpr_read_b32 v6, a102
    v_accvgpr_read_b32 v7, a103
    v_mul_f32 v0, 0x3e0293ee, v0
    v_mul_f32 v1, 0x3e0293ee, v1
    v_mul_f32 v2, 0x3e0293ee, v2
    v_mul_f32 v3, 0x3e0293ee, v3
    v_mul_f32 v4, 0x3e0293ee, v4
    v_mul_f32 v5, 0x3e0293ee, v5
    v_mul_f32 v6, 0x3e0293ee, v6
    v_mul_f32 v7, 0x3e0293ee, v7
    v_cvt_pk_bf16_f32 v16, v0, v1
    v_cvt_pk_bf16_f32 v17, v2, v3
    v_cvt_pk_bf16_f32 v18, v4, v5
    v_cvt_pk_bf16_f32 v19, v6, v7
    buffer_store_dwordx4 v[16:19], v251, s[4:7], s53 offen offset:0 sc1
    v_accvgpr_read_b32 v20, a104
    v_accvgpr_read_b32 v21, a105
    v_accvgpr_read_b32 v22, a106
    v_accvgpr_read_b32 v23, a107
    v_accvgpr_read_b32 v24, a108
    v_accvgpr_read_b32 v25, a109
    v_accvgpr_read_b32 v26, a110
    v_accvgpr_read_b32 v27, a111
    v_mul_f32 v20, 0x3e0293ee, v20
    v_mul_f32 v21, 0x3e0293ee, v21
    v_mul_f32 v22, 0x3e0293ee, v22
    v_mul_f32 v23, 0x3e0293ee, v23
    v_mul_f32 v24, 0x3e0293ee, v24
    v_mul_f32 v25, 0x3e0293ee, v25
    v_mul_f32 v26, 0x3e0293ee, v26
    v_mul_f32 v27, 0x3e0293ee, v27
    v_cvt_pk_bf16_f32 v36, v20, v21
    v_cvt_pk_bf16_f32 v37, v22, v23
    v_cvt_pk_bf16_f32 v38, v24, v25
    v_cvt_pk_bf16_f32 v39, v26, v27
    buffer_store_dwordx4 v[36:39], v251, s[4:7], s53 offen offset:1024 sc1
    v_accvgpr_read_b32 v40, a112
    v_accvgpr_read_b32 v41, a113
    v_accvgpr_read_b32 v42, a114
    v_accvgpr_read_b32 v43, a115
    v_accvgpr_read_b32 v44, a116
    v_accvgpr_read_b32 v45, a117
    v_accvgpr_read_b32 v46, a118
    v_accvgpr_read_b32 v47, a119
    v_mul_f32 v40, 0x3e0293ee, v40
    v_mul_f32 v41, 0x3e0293ee, v41
    v_mul_f32 v42, 0x3e0293ee, v42
    v_mul_f32 v43, 0x3e0293ee, v43
    v_mul_f32 v44, 0x3e0293ee, v44
    v_mul_f32 v45, 0x3e0293ee, v45
    v_mul_f32 v46, 0x3e0293ee, v46
    v_mul_f32 v47, 0x3e0293ee, v47
    v_cvt_pk_bf16_f32 v56, v40, v41
    v_cvt_pk_bf16_f32 v57, v42, v43
    v_cvt_pk_bf16_f32 v58, v44, v45
    v_cvt_pk_bf16_f32 v59, v46, v47
    buffer_store_dwordx4 v[56:59], v251, s[4:7], s53 offen offset:2048 sc1
    v_accvgpr_read_b32 v0, a120
    v_accvgpr_read_b32 v1, a121
    v_accvgpr_read_b32 v2, a122
    v_accvgpr_read_b32 v3, a123
    v_accvgpr_read_b32 v4, a124
    v_accvgpr_read_b32 v5, a125
    v_accvgpr_read_b32 v6, a126
    v_accvgpr_read_b32 v7, a127
    v_mul_f32 v0, 0x3e0293ee, v0
    v_mul_f32 v1, 0x3e0293ee, v1
    v_mul_f32 v2, 0x3e0293ee, v2
    v_mul_f32 v3, 0x3e0293ee, v3
    v_mul_f32 v4, 0x3e0293ee, v4
    v_mul_f32 v5, 0x3e0293ee, v5
    v_mul_f32 v6, 0x3e0293ee, v6
    v_mul_f32 v7, 0x3e0293ee, v7
    v_cvt_pk_bf16_f32 v16, v0, v1
    v_cvt_pk_bf16_f32 v17, v2, v3
    v_cvt_pk_bf16_f32 v18, v4, v5
    v_cvt_pk_bf16_f32 v19, v6, v7
    buffer_store_dwordx4 v[16:19], v251, s[4:7], s53 offen offset:3072 sc1
    s_branch main_kernel_w_done
main_kernel_w_c1_egelus:
    s_mov_b32 s53, s21
    v_accvgpr_read_b32 v0, a0
    v_accvgpr_read_b32 v1, a1
    v_accvgpr_read_b32 v2, a2
    v_accvgpr_read_b32 v3, a3
    v_accvgpr_read_b32 v4, a4
    v_accvgpr_read_b32 v5, a5
    v_accvgpr_read_b32 v6, a6
    v_accvgpr_read_b32 v7, a7
    v_pk_mul_f32 v[8:9], v[0:1], v[0:1]
    v_pk_mul_f32 v[10:11], v[2:3], v[2:3]
    v_pk_mul_f32 v[12:13], v[4:5], v[4:5]
    v_pk_mul_f32 v[14:15], v[6:7], v[6:7]
    v_pk_fma_f32 v[8:9], v[8:9], v[242:243], v[240:241]
    v_pk_fma_f32 v[10:11], v[10:11], v[242:243], v[240:241]
    v_pk_fma_f32 v[12:13], v[12:13], v[242:243], v[240:241]
    v_pk_fma_f32 v[14:15], v[14:15], v[242:243], v[240:241]
    v_pk_mul_f32 v[8:9], v[8:9], v[0:1]
    v_pk_mul_f32 v[10:11], v[10:11], v[2:3]
    v_pk_mul_f32 v[12:13], v[12:13], v[4:5]
    v_pk_mul_f32 v[14:15], v[14:15], v[6:7]
    v_exp_f32 v8, v8
    v_exp_f32 v9, v9
    v_exp_f32 v10, v10
    v_exp_f32 v11, v11
    v_exp_f32 v12, v12
    v_exp_f32 v13, v13
    v_exp_f32 v14, v14
    v_exp_f32 v15, v15
    v_pk_add_f32 v[8:9], v[8:9], v[244:245]
    v_pk_add_f32 v[10:11], v[10:11], v[244:245]
    v_pk_add_f32 v[12:13], v[12:13], v[244:245]
    v_pk_add_f32 v[14:15], v[14:15], v[244:245]
    v_rcp_f32 v8, v8
    v_rcp_f32 v9, v9
    v_rcp_f32 v10, v10
    v_rcp_f32 v11, v11
    v_rcp_f32 v12, v12
    v_rcp_f32 v13, v13
    v_rcp_f32 v14, v14
    v_rcp_f32 v15, v15
    v_pk_mul_f32 v[0:1], v[8:9], v[0:1]
    v_pk_mul_f32 v[2:3], v[10:11], v[2:3]
    v_pk_mul_f32 v[4:5], v[12:13], v[4:5]
    v_pk_mul_f32 v[6:7], v[14:15], v[6:7]
    v_cvt_pk_bf16_f32 v16, v0, v1
    v_cvt_pk_bf16_f32 v17, v2, v3
    v_cvt_pk_bf16_f32 v18, v4, v5
    v_cvt_pk_bf16_f32 v19, v6, v7
    buffer_store_dwordx4 v[16:19], v252, s[4:7], s53 offen offset:0 sc1
    v_accvgpr_read_b32 v20, a8
    v_accvgpr_read_b32 v21, a9
    v_accvgpr_read_b32 v22, a10
    v_accvgpr_read_b32 v23, a11
    v_accvgpr_read_b32 v24, a12
    v_accvgpr_read_b32 v25, a13
    v_accvgpr_read_b32 v26, a14
    v_accvgpr_read_b32 v27, a15
    v_pk_mul_f32 v[28:29], v[20:21], v[20:21]
    v_pk_mul_f32 v[30:31], v[22:23], v[22:23]
    v_pk_mul_f32 v[32:33], v[24:25], v[24:25]
    v_pk_mul_f32 v[34:35], v[26:27], v[26:27]
    v_pk_fma_f32 v[28:29], v[28:29], v[242:243], v[240:241]
    v_pk_fma_f32 v[30:31], v[30:31], v[242:243], v[240:241]
    v_pk_fma_f32 v[32:33], v[32:33], v[242:243], v[240:241]
    v_pk_fma_f32 v[34:35], v[34:35], v[242:243], v[240:241]
    v_pk_mul_f32 v[28:29], v[28:29], v[20:21]
    v_pk_mul_f32 v[30:31], v[30:31], v[22:23]
    v_pk_mul_f32 v[32:33], v[32:33], v[24:25]
    v_pk_mul_f32 v[34:35], v[34:35], v[26:27]
    v_exp_f32 v28, v28
    v_exp_f32 v29, v29
    v_exp_f32 v30, v30
    v_exp_f32 v31, v31
    v_exp_f32 v32, v32
    v_exp_f32 v33, v33
    v_exp_f32 v34, v34
    v_exp_f32 v35, v35
    v_pk_add_f32 v[28:29], v[28:29], v[244:245]
    v_pk_add_f32 v[30:31], v[30:31], v[244:245]
    v_pk_add_f32 v[32:33], v[32:33], v[244:245]
    v_pk_add_f32 v[34:35], v[34:35], v[244:245]
    v_rcp_f32 v28, v28
    v_rcp_f32 v29, v29
    v_rcp_f32 v30, v30
    v_rcp_f32 v31, v31
    v_rcp_f32 v32, v32
    v_rcp_f32 v33, v33
    v_rcp_f32 v34, v34
    v_rcp_f32 v35, v35
    v_pk_mul_f32 v[20:21], v[28:29], v[20:21]
    v_pk_mul_f32 v[22:23], v[30:31], v[22:23]
    v_pk_mul_f32 v[24:25], v[32:33], v[24:25]
    v_pk_mul_f32 v[26:27], v[34:35], v[26:27]
    v_cvt_pk_bf16_f32 v36, v20, v21
    v_cvt_pk_bf16_f32 v37, v22, v23
    v_cvt_pk_bf16_f32 v38, v24, v25
    v_cvt_pk_bf16_f32 v39, v26, v27
    buffer_store_dwordx4 v[36:39], v252, s[4:7], s53 offen offset:1024 sc1
    v_accvgpr_read_b32 v40, a16
    v_accvgpr_read_b32 v41, a17
    v_accvgpr_read_b32 v42, a18
    v_accvgpr_read_b32 v43, a19
    v_accvgpr_read_b32 v44, a20
    v_accvgpr_read_b32 v45, a21
    v_accvgpr_read_b32 v46, a22
    v_accvgpr_read_b32 v47, a23
    v_pk_mul_f32 v[48:49], v[40:41], v[40:41]
    v_pk_mul_f32 v[50:51], v[42:43], v[42:43]
    v_pk_mul_f32 v[52:53], v[44:45], v[44:45]
    v_pk_mul_f32 v[54:55], v[46:47], v[46:47]
    v_pk_fma_f32 v[48:49], v[48:49], v[242:243], v[240:241]
    v_pk_fma_f32 v[50:51], v[50:51], v[242:243], v[240:241]
    v_pk_fma_f32 v[52:53], v[52:53], v[242:243], v[240:241]
    v_pk_fma_f32 v[54:55], v[54:55], v[242:243], v[240:241]
    v_pk_mul_f32 v[48:49], v[48:49], v[40:41]
    v_pk_mul_f32 v[50:51], v[50:51], v[42:43]
    v_pk_mul_f32 v[52:53], v[52:53], v[44:45]
    v_pk_mul_f32 v[54:55], v[54:55], v[46:47]
    v_exp_f32 v48, v48
    v_exp_f32 v49, v49
    v_exp_f32 v50, v50
    v_exp_f32 v51, v51
    v_exp_f32 v52, v52
    v_exp_f32 v53, v53
    v_exp_f32 v54, v54
    v_exp_f32 v55, v55
    v_pk_add_f32 v[48:49], v[48:49], v[244:245]
    v_pk_add_f32 v[50:51], v[50:51], v[244:245]
    v_pk_add_f32 v[52:53], v[52:53], v[244:245]
    v_pk_add_f32 v[54:55], v[54:55], v[244:245]
    v_rcp_f32 v48, v48
    v_rcp_f32 v49, v49
    v_rcp_f32 v50, v50
    v_rcp_f32 v51, v51
    v_rcp_f32 v52, v52
    v_rcp_f32 v53, v53
    v_rcp_f32 v54, v54
    v_rcp_f32 v55, v55
    v_pk_mul_f32 v[40:41], v[48:49], v[40:41]
    v_pk_mul_f32 v[42:43], v[50:51], v[42:43]
    v_pk_mul_f32 v[44:45], v[52:53], v[44:45]
    v_pk_mul_f32 v[46:47], v[54:55], v[46:47]
    v_cvt_pk_bf16_f32 v56, v40, v41
    v_cvt_pk_bf16_f32 v57, v42, v43
    v_cvt_pk_bf16_f32 v58, v44, v45
    v_cvt_pk_bf16_f32 v59, v46, v47
    buffer_store_dwordx4 v[56:59], v252, s[4:7], s53 offen offset:2048 sc1
    v_accvgpr_read_b32 v0, a24
    v_accvgpr_read_b32 v1, a25
    v_accvgpr_read_b32 v2, a26
    v_accvgpr_read_b32 v3, a27
    v_accvgpr_read_b32 v4, a28
    v_accvgpr_read_b32 v5, a29
    v_accvgpr_read_b32 v6, a30
    v_accvgpr_read_b32 v7, a31
    v_pk_mul_f32 v[8:9], v[0:1], v[0:1]
    v_pk_mul_f32 v[10:11], v[2:3], v[2:3]
    v_pk_mul_f32 v[12:13], v[4:5], v[4:5]
    v_pk_mul_f32 v[14:15], v[6:7], v[6:7]
    v_pk_fma_f32 v[8:9], v[8:9], v[242:243], v[240:241]
    v_pk_fma_f32 v[10:11], v[10:11], v[242:243], v[240:241]
    v_pk_fma_f32 v[12:13], v[12:13], v[242:243], v[240:241]
    v_pk_fma_f32 v[14:15], v[14:15], v[242:243], v[240:241]
    v_pk_mul_f32 v[8:9], v[8:9], v[0:1]
    v_pk_mul_f32 v[10:11], v[10:11], v[2:3]
    v_pk_mul_f32 v[12:13], v[12:13], v[4:5]
    v_pk_mul_f32 v[14:15], v[14:15], v[6:7]
    v_exp_f32 v8, v8
    v_exp_f32 v9, v9
    v_exp_f32 v10, v10
    v_exp_f32 v11, v11
    v_exp_f32 v12, v12
    v_exp_f32 v13, v13
    v_exp_f32 v14, v14
    v_exp_f32 v15, v15
    v_pk_add_f32 v[8:9], v[8:9], v[244:245]
    v_pk_add_f32 v[10:11], v[10:11], v[244:245]
    v_pk_add_f32 v[12:13], v[12:13], v[244:245]
    v_pk_add_f32 v[14:15], v[14:15], v[244:245]
    v_rcp_f32 v8, v8
    v_rcp_f32 v9, v9
    v_rcp_f32 v10, v10
    v_rcp_f32 v11, v11
    v_rcp_f32 v12, v12
    v_rcp_f32 v13, v13
    v_rcp_f32 v14, v14
    v_rcp_f32 v15, v15
    v_pk_mul_f32 v[0:1], v[8:9], v[0:1]
    v_pk_mul_f32 v[2:3], v[10:11], v[2:3]
    v_pk_mul_f32 v[4:5], v[12:13], v[4:5]
    v_pk_mul_f32 v[6:7], v[14:15], v[6:7]
    v_cvt_pk_bf16_f32 v16, v0, v1
    v_cvt_pk_bf16_f32 v17, v2, v3
    v_cvt_pk_bf16_f32 v18, v4, v5
    v_cvt_pk_bf16_f32 v19, v6, v7
    buffer_store_dwordx4 v[16:19], v252, s[4:7], s53 offen offset:3072 sc1
    s_add_u32 s53, s53, s22
    v_accvgpr_read_b32 v20, a32
    v_accvgpr_read_b32 v21, a33
    v_accvgpr_read_b32 v22, a34
    v_accvgpr_read_b32 v23, a35
    v_accvgpr_read_b32 v24, a36
    v_accvgpr_read_b32 v25, a37
    v_accvgpr_read_b32 v26, a38
    v_accvgpr_read_b32 v27, a39
    v_pk_mul_f32 v[28:29], v[20:21], v[20:21]
    v_pk_mul_f32 v[30:31], v[22:23], v[22:23]
    v_pk_mul_f32 v[32:33], v[24:25], v[24:25]
    v_pk_mul_f32 v[34:35], v[26:27], v[26:27]
    v_pk_fma_f32 v[28:29], v[28:29], v[242:243], v[240:241]
    v_pk_fma_f32 v[30:31], v[30:31], v[242:243], v[240:241]
    v_pk_fma_f32 v[32:33], v[32:33], v[242:243], v[240:241]
    v_pk_fma_f32 v[34:35], v[34:35], v[242:243], v[240:241]
    v_pk_mul_f32 v[28:29], v[28:29], v[20:21]
    v_pk_mul_f32 v[30:31], v[30:31], v[22:23]
    v_pk_mul_f32 v[32:33], v[32:33], v[24:25]
    v_pk_mul_f32 v[34:35], v[34:35], v[26:27]
    v_exp_f32 v28, v28
    v_exp_f32 v29, v29
    v_exp_f32 v30, v30
    v_exp_f32 v31, v31
    v_exp_f32 v32, v32
    v_exp_f32 v33, v33
    v_exp_f32 v34, v34
    v_exp_f32 v35, v35
    v_pk_add_f32 v[28:29], v[28:29], v[244:245]
    v_pk_add_f32 v[30:31], v[30:31], v[244:245]
    v_pk_add_f32 v[32:33], v[32:33], v[244:245]
    v_pk_add_f32 v[34:35], v[34:35], v[244:245]
    v_rcp_f32 v28, v28
    v_rcp_f32 v29, v29
    v_rcp_f32 v30, v30
    v_rcp_f32 v31, v31
    v_rcp_f32 v32, v32
    v_rcp_f32 v33, v33
    v_rcp_f32 v34, v34
    v_rcp_f32 v35, v35
    v_pk_mul_f32 v[20:21], v[28:29], v[20:21]
    v_pk_mul_f32 v[22:23], v[30:31], v[22:23]
    v_pk_mul_f32 v[24:25], v[32:33], v[24:25]
    v_pk_mul_f32 v[26:27], v[34:35], v[26:27]
    v_cvt_pk_bf16_f32 v36, v20, v21
    v_cvt_pk_bf16_f32 v37, v22, v23
    v_cvt_pk_bf16_f32 v38, v24, v25
    v_cvt_pk_bf16_f32 v39, v26, v27
    buffer_store_dwordx4 v[36:39], v252, s[4:7], s53 offen offset:0 sc1
    v_accvgpr_read_b32 v40, a40
    v_accvgpr_read_b32 v41, a41
    v_accvgpr_read_b32 v42, a42
    v_accvgpr_read_b32 v43, a43
    v_accvgpr_read_b32 v44, a44
    v_accvgpr_read_b32 v45, a45
    v_accvgpr_read_b32 v46, a46
    v_accvgpr_read_b32 v47, a47
    v_pk_mul_f32 v[48:49], v[40:41], v[40:41]
    v_pk_mul_f32 v[50:51], v[42:43], v[42:43]
    v_pk_mul_f32 v[52:53], v[44:45], v[44:45]
    v_pk_mul_f32 v[54:55], v[46:47], v[46:47]
    v_pk_fma_f32 v[48:49], v[48:49], v[242:243], v[240:241]
    v_pk_fma_f32 v[50:51], v[50:51], v[242:243], v[240:241]
    v_pk_fma_f32 v[52:53], v[52:53], v[242:243], v[240:241]
    v_pk_fma_f32 v[54:55], v[54:55], v[242:243], v[240:241]
    v_pk_mul_f32 v[48:49], v[48:49], v[40:41]
    v_pk_mul_f32 v[50:51], v[50:51], v[42:43]
    v_pk_mul_f32 v[52:53], v[52:53], v[44:45]
    v_pk_mul_f32 v[54:55], v[54:55], v[46:47]
    v_exp_f32 v48, v48
    v_exp_f32 v49, v49
    v_exp_f32 v50, v50
    v_exp_f32 v51, v51
    v_exp_f32 v52, v52
    v_exp_f32 v53, v53
    v_exp_f32 v54, v54
    v_exp_f32 v55, v55
    v_pk_add_f32 v[48:49], v[48:49], v[244:245]
    v_pk_add_f32 v[50:51], v[50:51], v[244:245]
    v_pk_add_f32 v[52:53], v[52:53], v[244:245]
    v_pk_add_f32 v[54:55], v[54:55], v[244:245]
    v_rcp_f32 v48, v48
    v_rcp_f32 v49, v49
    v_rcp_f32 v50, v50
    v_rcp_f32 v51, v51
    v_rcp_f32 v52, v52
    v_rcp_f32 v53, v53
    v_rcp_f32 v54, v54
    v_rcp_f32 v55, v55
    v_pk_mul_f32 v[40:41], v[48:49], v[40:41]
    v_pk_mul_f32 v[42:43], v[50:51], v[42:43]
    v_pk_mul_f32 v[44:45], v[52:53], v[44:45]
    v_pk_mul_f32 v[46:47], v[54:55], v[46:47]
    v_cvt_pk_bf16_f32 v56, v40, v41
    v_cvt_pk_bf16_f32 v57, v42, v43
    v_cvt_pk_bf16_f32 v58, v44, v45
    v_cvt_pk_bf16_f32 v59, v46, v47
    buffer_store_dwordx4 v[56:59], v252, s[4:7], s53 offen offset:1024 sc1
    v_accvgpr_read_b32 v0, a48
    v_accvgpr_read_b32 v1, a49
    v_accvgpr_read_b32 v2, a50
    v_accvgpr_read_b32 v3, a51
    v_accvgpr_read_b32 v4, a52
    v_accvgpr_read_b32 v5, a53
    v_accvgpr_read_b32 v6, a54
    v_accvgpr_read_b32 v7, a55
    v_pk_mul_f32 v[8:9], v[0:1], v[0:1]
    v_pk_mul_f32 v[10:11], v[2:3], v[2:3]
    v_pk_mul_f32 v[12:13], v[4:5], v[4:5]
    v_pk_mul_f32 v[14:15], v[6:7], v[6:7]
    v_pk_fma_f32 v[8:9], v[8:9], v[242:243], v[240:241]
    v_pk_fma_f32 v[10:11], v[10:11], v[242:243], v[240:241]
    v_pk_fma_f32 v[12:13], v[12:13], v[242:243], v[240:241]
    v_pk_fma_f32 v[14:15], v[14:15], v[242:243], v[240:241]
    v_pk_mul_f32 v[8:9], v[8:9], v[0:1]
    v_pk_mul_f32 v[10:11], v[10:11], v[2:3]
    v_pk_mul_f32 v[12:13], v[12:13], v[4:5]
    v_pk_mul_f32 v[14:15], v[14:15], v[6:7]
    v_exp_f32 v8, v8
    v_exp_f32 v9, v9
    v_exp_f32 v10, v10
    v_exp_f32 v11, v11
    v_exp_f32 v12, v12
    v_exp_f32 v13, v13
    v_exp_f32 v14, v14
    v_exp_f32 v15, v15
    v_pk_add_f32 v[8:9], v[8:9], v[244:245]
    v_pk_add_f32 v[10:11], v[10:11], v[244:245]
    v_pk_add_f32 v[12:13], v[12:13], v[244:245]
    v_pk_add_f32 v[14:15], v[14:15], v[244:245]
    v_rcp_f32 v8, v8
    v_rcp_f32 v9, v9
    v_rcp_f32 v10, v10
    v_rcp_f32 v11, v11
    v_rcp_f32 v12, v12
    v_rcp_f32 v13, v13
    v_rcp_f32 v14, v14
    v_rcp_f32 v15, v15
    v_pk_mul_f32 v[0:1], v[8:9], v[0:1]
    v_pk_mul_f32 v[2:3], v[10:11], v[2:3]
    v_pk_mul_f32 v[4:5], v[12:13], v[4:5]
    v_pk_mul_f32 v[6:7], v[14:15], v[6:7]
    v_cvt_pk_bf16_f32 v16, v0, v1
    v_cvt_pk_bf16_f32 v17, v2, v3
    v_cvt_pk_bf16_f32 v18, v4, v5
    v_cvt_pk_bf16_f32 v19, v6, v7
    buffer_store_dwordx4 v[16:19], v252, s[4:7], s53 offen offset:2048 sc1
    v_accvgpr_read_b32 v20, a56
    v_accvgpr_read_b32 v21, a57
    v_accvgpr_read_b32 v22, a58
    v_accvgpr_read_b32 v23, a59
    v_accvgpr_read_b32 v24, a60
    v_accvgpr_read_b32 v25, a61
    v_accvgpr_read_b32 v26, a62
    v_accvgpr_read_b32 v27, a63
    v_pk_mul_f32 v[28:29], v[20:21], v[20:21]
    v_pk_mul_f32 v[30:31], v[22:23], v[22:23]
    v_pk_mul_f32 v[32:33], v[24:25], v[24:25]
    v_pk_mul_f32 v[34:35], v[26:27], v[26:27]
    v_pk_fma_f32 v[28:29], v[28:29], v[242:243], v[240:241]
    v_pk_fma_f32 v[30:31], v[30:31], v[242:243], v[240:241]
    v_pk_fma_f32 v[32:33], v[32:33], v[242:243], v[240:241]
    v_pk_fma_f32 v[34:35], v[34:35], v[242:243], v[240:241]
    v_pk_mul_f32 v[28:29], v[28:29], v[20:21]
    v_pk_mul_f32 v[30:31], v[30:31], v[22:23]
    v_pk_mul_f32 v[32:33], v[32:33], v[24:25]
    v_pk_mul_f32 v[34:35], v[34:35], v[26:27]
    v_exp_f32 v28, v28
    v_exp_f32 v29, v29
    v_exp_f32 v30, v30
    v_exp_f32 v31, v31
    v_exp_f32 v32, v32
    v_exp_f32 v33, v33
    v_exp_f32 v34, v34
    v_exp_f32 v35, v35
    v_pk_add_f32 v[28:29], v[28:29], v[244:245]
    v_pk_add_f32 v[30:31], v[30:31], v[244:245]
    v_pk_add_f32 v[32:33], v[32:33], v[244:245]
    v_pk_add_f32 v[34:35], v[34:35], v[244:245]
    v_rcp_f32 v28, v28
    v_rcp_f32 v29, v29
    v_rcp_f32 v30, v30
    v_rcp_f32 v31, v31
    v_rcp_f32 v32, v32
    v_rcp_f32 v33, v33
    v_rcp_f32 v34, v34
    v_rcp_f32 v35, v35
    v_pk_mul_f32 v[20:21], v[28:29], v[20:21]
    v_pk_mul_f32 v[22:23], v[30:31], v[22:23]
    v_pk_mul_f32 v[24:25], v[32:33], v[24:25]
    v_pk_mul_f32 v[26:27], v[34:35], v[26:27]
    v_cvt_pk_bf16_f32 v36, v20, v21
    v_cvt_pk_bf16_f32 v37, v22, v23
    v_cvt_pk_bf16_f32 v38, v24, v25
    v_cvt_pk_bf16_f32 v39, v26, v27
    buffer_store_dwordx4 v[36:39], v252, s[4:7], s53 offen offset:3072 sc1
    s_add_u32 s53, s53, s22
    v_accvgpr_read_b32 v40, a64
    v_accvgpr_read_b32 v41, a65
    v_accvgpr_read_b32 v42, a66
    v_accvgpr_read_b32 v43, a67
    v_accvgpr_read_b32 v44, a68
    v_accvgpr_read_b32 v45, a69
    v_accvgpr_read_b32 v46, a70
    v_accvgpr_read_b32 v47, a71
    v_pk_mul_f32 v[48:49], v[40:41], v[40:41]
    v_pk_mul_f32 v[50:51], v[42:43], v[42:43]
    v_pk_mul_f32 v[52:53], v[44:45], v[44:45]
    v_pk_mul_f32 v[54:55], v[46:47], v[46:47]
    v_pk_fma_f32 v[48:49], v[48:49], v[242:243], v[240:241]
    v_pk_fma_f32 v[50:51], v[50:51], v[242:243], v[240:241]
    v_pk_fma_f32 v[52:53], v[52:53], v[242:243], v[240:241]
    v_pk_fma_f32 v[54:55], v[54:55], v[242:243], v[240:241]
    v_pk_mul_f32 v[48:49], v[48:49], v[40:41]
    v_pk_mul_f32 v[50:51], v[50:51], v[42:43]
    v_pk_mul_f32 v[52:53], v[52:53], v[44:45]
    v_pk_mul_f32 v[54:55], v[54:55], v[46:47]
    v_exp_f32 v48, v48
    v_exp_f32 v49, v49
    v_exp_f32 v50, v50
    v_exp_f32 v51, v51
    v_exp_f32 v52, v52
    v_exp_f32 v53, v53
    v_exp_f32 v54, v54
    v_exp_f32 v55, v55
    v_pk_add_f32 v[48:49], v[48:49], v[244:245]
    v_pk_add_f32 v[50:51], v[50:51], v[244:245]
    v_pk_add_f32 v[52:53], v[52:53], v[244:245]
    v_pk_add_f32 v[54:55], v[54:55], v[244:245]
    v_rcp_f32 v48, v48
    v_rcp_f32 v49, v49
    v_rcp_f32 v50, v50
    v_rcp_f32 v51, v51
    v_rcp_f32 v52, v52
    v_rcp_f32 v53, v53
    v_rcp_f32 v54, v54
    v_rcp_f32 v55, v55
    v_pk_mul_f32 v[40:41], v[48:49], v[40:41]
    v_pk_mul_f32 v[42:43], v[50:51], v[42:43]
    v_pk_mul_f32 v[44:45], v[52:53], v[44:45]
    v_pk_mul_f32 v[46:47], v[54:55], v[46:47]
    v_cvt_pk_bf16_f32 v56, v40, v41
    v_cvt_pk_bf16_f32 v57, v42, v43
    v_cvt_pk_bf16_f32 v58, v44, v45
    v_cvt_pk_bf16_f32 v59, v46, v47
    buffer_store_dwordx4 v[56:59], v252, s[4:7], s53 offen offset:0 sc1
    v_accvgpr_read_b32 v0, a72
    v_accvgpr_read_b32 v1, a73
    v_accvgpr_read_b32 v2, a74
    v_accvgpr_read_b32 v3, a75
    v_accvgpr_read_b32 v4, a76
    v_accvgpr_read_b32 v5, a77
    v_accvgpr_read_b32 v6, a78
    v_accvgpr_read_b32 v7, a79
    v_pk_mul_f32 v[8:9], v[0:1], v[0:1]
    v_pk_mul_f32 v[10:11], v[2:3], v[2:3]
    v_pk_mul_f32 v[12:13], v[4:5], v[4:5]
    v_pk_mul_f32 v[14:15], v[6:7], v[6:7]
    v_pk_fma_f32 v[8:9], v[8:9], v[242:243], v[240:241]
    v_pk_fma_f32 v[10:11], v[10:11], v[242:243], v[240:241]
    v_pk_fma_f32 v[12:13], v[12:13], v[242:243], v[240:241]
    v_pk_fma_f32 v[14:15], v[14:15], v[242:243], v[240:241]
    v_pk_mul_f32 v[8:9], v[8:9], v[0:1]
    v_pk_mul_f32 v[10:11], v[10:11], v[2:3]
    v_pk_mul_f32 v[12:13], v[12:13], v[4:5]
    v_pk_mul_f32 v[14:15], v[14:15], v[6:7]
    v_exp_f32 v8, v8
    v_exp_f32 v9, v9
    v_exp_f32 v10, v10
    v_exp_f32 v11, v11
    v_exp_f32 v12, v12
    v_exp_f32 v13, v13
    v_exp_f32 v14, v14
    v_exp_f32 v15, v15
    v_pk_add_f32 v[8:9], v[8:9], v[244:245]
    v_pk_add_f32 v[10:11], v[10:11], v[244:245]
    v_pk_add_f32 v[12:13], v[12:13], v[244:245]
    v_pk_add_f32 v[14:15], v[14:15], v[244:245]
    v_rcp_f32 v8, v8
    v_rcp_f32 v9, v9
    v_rcp_f32 v10, v10
    v_rcp_f32 v11, v11
    v_rcp_f32 v12, v12
    v_rcp_f32 v13, v13
    v_rcp_f32 v14, v14
    v_rcp_f32 v15, v15
    v_pk_mul_f32 v[0:1], v[8:9], v[0:1]
    v_pk_mul_f32 v[2:3], v[10:11], v[2:3]
    v_pk_mul_f32 v[4:5], v[12:13], v[4:5]
    v_pk_mul_f32 v[6:7], v[14:15], v[6:7]
    v_cvt_pk_bf16_f32 v16, v0, v1
    v_cvt_pk_bf16_f32 v17, v2, v3
    v_cvt_pk_bf16_f32 v18, v4, v5
    v_cvt_pk_bf16_f32 v19, v6, v7
    buffer_store_dwordx4 v[16:19], v252, s[4:7], s53 offen offset:1024 sc1
    v_accvgpr_read_b32 v20, a80
    v_accvgpr_read_b32 v21, a81
    v_accvgpr_read_b32 v22, a82
    v_accvgpr_read_b32 v23, a83
    v_accvgpr_read_b32 v24, a84
    v_accvgpr_read_b32 v25, a85
    v_accvgpr_read_b32 v26, a86
    v_accvgpr_read_b32 v27, a87
    v_pk_mul_f32 v[28:29], v[20:21], v[20:21]
    v_pk_mul_f32 v[30:31], v[22:23], v[22:23]
    v_pk_mul_f32 v[32:33], v[24:25], v[24:25]
    v_pk_mul_f32 v[34:35], v[26:27], v[26:27]
    v_pk_fma_f32 v[28:29], v[28:29], v[242:243], v[240:241]
    v_pk_fma_f32 v[30:31], v[30:31], v[242:243], v[240:241]
    v_pk_fma_f32 v[32:33], v[32:33], v[242:243], v[240:241]
    v_pk_fma_f32 v[34:35], v[34:35], v[242:243], v[240:241]
    v_pk_mul_f32 v[28:29], v[28:29], v[20:21]
    v_pk_mul_f32 v[30:31], v[30:31], v[22:23]
    v_pk_mul_f32 v[32:33], v[32:33], v[24:25]
    v_pk_mul_f32 v[34:35], v[34:35], v[26:27]
    v_exp_f32 v28, v28
    v_exp_f32 v29, v29
    v_exp_f32 v30, v30
    v_exp_f32 v31, v31
    v_exp_f32 v32, v32
    v_exp_f32 v33, v33
    v_exp_f32 v34, v34
    v_exp_f32 v35, v35
    v_pk_add_f32 v[28:29], v[28:29], v[244:245]
    v_pk_add_f32 v[30:31], v[30:31], v[244:245]
    v_pk_add_f32 v[32:33], v[32:33], v[244:245]
    v_pk_add_f32 v[34:35], v[34:35], v[244:245]
    v_rcp_f32 v28, v28
    v_rcp_f32 v29, v29
    v_rcp_f32 v30, v30
    v_rcp_f32 v31, v31
    v_rcp_f32 v32, v32
    v_rcp_f32 v33, v33
    v_rcp_f32 v34, v34
    v_rcp_f32 v35, v35
    v_pk_mul_f32 v[20:21], v[28:29], v[20:21]
    v_pk_mul_f32 v[22:23], v[30:31], v[22:23]
    v_pk_mul_f32 v[24:25], v[32:33], v[24:25]
    v_pk_mul_f32 v[26:27], v[34:35], v[26:27]
    v_cvt_pk_bf16_f32 v36, v20, v21
    v_cvt_pk_bf16_f32 v37, v22, v23
    v_cvt_pk_bf16_f32 v38, v24, v25
    v_cvt_pk_bf16_f32 v39, v26, v27
    buffer_store_dwordx4 v[36:39], v252, s[4:7], s53 offen offset:2048 sc1
    v_accvgpr_read_b32 v40, a88
    v_accvgpr_read_b32 v41, a89
    v_accvgpr_read_b32 v42, a90
    v_accvgpr_read_b32 v43, a91
    v_accvgpr_read_b32 v44, a92
    v_accvgpr_read_b32 v45, a93
    v_accvgpr_read_b32 v46, a94
    v_accvgpr_read_b32 v47, a95
    v_pk_mul_f32 v[48:49], v[40:41], v[40:41]
    v_pk_mul_f32 v[50:51], v[42:43], v[42:43]
    v_pk_mul_f32 v[52:53], v[44:45], v[44:45]
    v_pk_mul_f32 v[54:55], v[46:47], v[46:47]
    v_pk_fma_f32 v[48:49], v[48:49], v[242:243], v[240:241]
    v_pk_fma_f32 v[50:51], v[50:51], v[242:243], v[240:241]
    v_pk_fma_f32 v[52:53], v[52:53], v[242:243], v[240:241]
    v_pk_fma_f32 v[54:55], v[54:55], v[242:243], v[240:241]
    v_pk_mul_f32 v[48:49], v[48:49], v[40:41]
    v_pk_mul_f32 v[50:51], v[50:51], v[42:43]
    v_pk_mul_f32 v[52:53], v[52:53], v[44:45]
    v_pk_mul_f32 v[54:55], v[54:55], v[46:47]
    v_exp_f32 v48, v48
    v_exp_f32 v49, v49
    v_exp_f32 v50, v50
    v_exp_f32 v51, v51
    v_exp_f32 v52, v52
    v_exp_f32 v53, v53
    v_exp_f32 v54, v54
    v_exp_f32 v55, v55
    v_pk_add_f32 v[48:49], v[48:49], v[244:245]
    v_pk_add_f32 v[50:51], v[50:51], v[244:245]
    v_pk_add_f32 v[52:53], v[52:53], v[244:245]
    v_pk_add_f32 v[54:55], v[54:55], v[244:245]
    v_rcp_f32 v48, v48
    v_rcp_f32 v49, v49
    v_rcp_f32 v50, v50
    v_rcp_f32 v51, v51
    v_rcp_f32 v52, v52
    v_rcp_f32 v53, v53
    v_rcp_f32 v54, v54
    v_rcp_f32 v55, v55
    v_pk_mul_f32 v[40:41], v[48:49], v[40:41]
    v_pk_mul_f32 v[42:43], v[50:51], v[42:43]
    v_pk_mul_f32 v[44:45], v[52:53], v[44:45]
    v_pk_mul_f32 v[46:47], v[54:55], v[46:47]
    v_cvt_pk_bf16_f32 v56, v40, v41
    v_cvt_pk_bf16_f32 v57, v42, v43
    v_cvt_pk_bf16_f32 v58, v44, v45
    v_cvt_pk_bf16_f32 v59, v46, v47
    buffer_store_dwordx4 v[56:59], v252, s[4:7], s53 offen offset:3072 sc1
    s_add_u32 s53, s53, s22
    v_accvgpr_read_b32 v0, a96
    v_accvgpr_read_b32 v1, a97
    v_accvgpr_read_b32 v2, a98
    v_accvgpr_read_b32 v3, a99
    v_accvgpr_read_b32 v4, a100
    v_accvgpr_read_b32 v5, a101
    v_accvgpr_read_b32 v6, a102
    v_accvgpr_read_b32 v7, a103
    v_pk_mul_f32 v[8:9], v[0:1], v[0:1]
    v_pk_mul_f32 v[10:11], v[2:3], v[2:3]
    v_pk_mul_f32 v[12:13], v[4:5], v[4:5]
    v_pk_mul_f32 v[14:15], v[6:7], v[6:7]
    v_pk_fma_f32 v[8:9], v[8:9], v[242:243], v[240:241]
    v_pk_fma_f32 v[10:11], v[10:11], v[242:243], v[240:241]
    v_pk_fma_f32 v[12:13], v[12:13], v[242:243], v[240:241]
    v_pk_fma_f32 v[14:15], v[14:15], v[242:243], v[240:241]
    v_pk_mul_f32 v[8:9], v[8:9], v[0:1]
    v_pk_mul_f32 v[10:11], v[10:11], v[2:3]
    v_pk_mul_f32 v[12:13], v[12:13], v[4:5]
    v_pk_mul_f32 v[14:15], v[14:15], v[6:7]
    v_exp_f32 v8, v8
    v_exp_f32 v9, v9
    v_exp_f32 v10, v10
    v_exp_f32 v11, v11
    v_exp_f32 v12, v12
    v_exp_f32 v13, v13
    v_exp_f32 v14, v14
    v_exp_f32 v15, v15
    v_pk_add_f32 v[8:9], v[8:9], v[244:245]
    v_pk_add_f32 v[10:11], v[10:11], v[244:245]
    v_pk_add_f32 v[12:13], v[12:13], v[244:245]
    v_pk_add_f32 v[14:15], v[14:15], v[244:245]
    v_rcp_f32 v8, v8
    v_rcp_f32 v9, v9
    v_rcp_f32 v10, v10
    v_rcp_f32 v11, v11
    v_rcp_f32 v12, v12
    v_rcp_f32 v13, v13
    v_rcp_f32 v14, v14
    v_rcp_f32 v15, v15
    v_pk_mul_f32 v[0:1], v[8:9], v[0:1]
    v_pk_mul_f32 v[2:3], v[10:11], v[2:3]
    v_pk_mul_f32 v[4:5], v[12:13], v[4:5]
    v_pk_mul_f32 v[6:7], v[14:15], v[6:7]
    v_cvt_pk_bf16_f32 v16, v0, v1
    v_cvt_pk_bf16_f32 v17, v2, v3
    v_cvt_pk_bf16_f32 v18, v4, v5
    v_cvt_pk_bf16_f32 v19, v6, v7
    buffer_store_dwordx4 v[16:19], v252, s[4:7], s53 offen offset:0 sc1
    v_accvgpr_read_b32 v20, a104
    v_accvgpr_read_b32 v21, a105
    v_accvgpr_read_b32 v22, a106
    v_accvgpr_read_b32 v23, a107
    v_accvgpr_read_b32 v24, a108
    v_accvgpr_read_b32 v25, a109
    v_accvgpr_read_b32 v26, a110
    v_accvgpr_read_b32 v27, a111
    v_pk_mul_f32 v[28:29], v[20:21], v[20:21]
    v_pk_mul_f32 v[30:31], v[22:23], v[22:23]
    v_pk_mul_f32 v[32:33], v[24:25], v[24:25]
    v_pk_mul_f32 v[34:35], v[26:27], v[26:27]
    v_pk_fma_f32 v[28:29], v[28:29], v[242:243], v[240:241]
    v_pk_fma_f32 v[30:31], v[30:31], v[242:243], v[240:241]
    v_pk_fma_f32 v[32:33], v[32:33], v[242:243], v[240:241]
    v_pk_fma_f32 v[34:35], v[34:35], v[242:243], v[240:241]
    v_pk_mul_f32 v[28:29], v[28:29], v[20:21]
    v_pk_mul_f32 v[30:31], v[30:31], v[22:23]
    v_pk_mul_f32 v[32:33], v[32:33], v[24:25]
    v_pk_mul_f32 v[34:35], v[34:35], v[26:27]
    v_exp_f32 v28, v28
    v_exp_f32 v29, v29
    v_exp_f32 v30, v30
    v_exp_f32 v31, v31
    v_exp_f32 v32, v32
    v_exp_f32 v33, v33
    v_exp_f32 v34, v34
    v_exp_f32 v35, v35
    v_pk_add_f32 v[28:29], v[28:29], v[244:245]
    v_pk_add_f32 v[30:31], v[30:31], v[244:245]
    v_pk_add_f32 v[32:33], v[32:33], v[244:245]
    v_pk_add_f32 v[34:35], v[34:35], v[244:245]
    v_rcp_f32 v28, v28
    v_rcp_f32 v29, v29
    v_rcp_f32 v30, v30
    v_rcp_f32 v31, v31
    v_rcp_f32 v32, v32
    v_rcp_f32 v33, v33
    v_rcp_f32 v34, v34
    v_rcp_f32 v35, v35
    v_pk_mul_f32 v[20:21], v[28:29], v[20:21]
    v_pk_mul_f32 v[22:23], v[30:31], v[22:23]
    v_pk_mul_f32 v[24:25], v[32:33], v[24:25]
    v_pk_mul_f32 v[26:27], v[34:35], v[26:27]
    v_cvt_pk_bf16_f32 v36, v20, v21
    v_cvt_pk_bf16_f32 v37, v22, v23
    v_cvt_pk_bf16_f32 v38, v24, v25
    v_cvt_pk_bf16_f32 v39, v26, v27
    buffer_store_dwordx4 v[36:39], v252, s[4:7], s53 offen offset:1024 sc1
    v_accvgpr_read_b32 v40, a112
    v_accvgpr_read_b32 v41, a113
    v_accvgpr_read_b32 v42, a114
    v_accvgpr_read_b32 v43, a115
    v_accvgpr_read_b32 v44, a116
    v_accvgpr_read_b32 v45, a117
    v_accvgpr_read_b32 v46, a118
    v_accvgpr_read_b32 v47, a119
    v_pk_mul_f32 v[48:49], v[40:41], v[40:41]
    v_pk_mul_f32 v[50:51], v[42:43], v[42:43]
    v_pk_mul_f32 v[52:53], v[44:45], v[44:45]
    v_pk_mul_f32 v[54:55], v[46:47], v[46:47]
    v_pk_fma_f32 v[48:49], v[48:49], v[242:243], v[240:241]
    v_pk_fma_f32 v[50:51], v[50:51], v[242:243], v[240:241]
    v_pk_fma_f32 v[52:53], v[52:53], v[242:243], v[240:241]
    v_pk_fma_f32 v[54:55], v[54:55], v[242:243], v[240:241]
    v_pk_mul_f32 v[48:49], v[48:49], v[40:41]
    v_pk_mul_f32 v[50:51], v[50:51], v[42:43]
    v_pk_mul_f32 v[52:53], v[52:53], v[44:45]
    v_pk_mul_f32 v[54:55], v[54:55], v[46:47]
    v_exp_f32 v48, v48
    v_exp_f32 v49, v49
    v_exp_f32 v50, v50
    v_exp_f32 v51, v51
    v_exp_f32 v52, v52
    v_exp_f32 v53, v53
    v_exp_f32 v54, v54
    v_exp_f32 v55, v55
    v_pk_add_f32 v[48:49], v[48:49], v[244:245]
    v_pk_add_f32 v[50:51], v[50:51], v[244:245]
    v_pk_add_f32 v[52:53], v[52:53], v[244:245]
    v_pk_add_f32 v[54:55], v[54:55], v[244:245]
    v_rcp_f32 v48, v48
    v_rcp_f32 v49, v49
    v_rcp_f32 v50, v50
    v_rcp_f32 v51, v51
    v_rcp_f32 v52, v52
    v_rcp_f32 v53, v53
    v_rcp_f32 v54, v54
    v_rcp_f32 v55, v55
    v_pk_mul_f32 v[40:41], v[48:49], v[40:41]
    v_pk_mul_f32 v[42:43], v[50:51], v[42:43]
    v_pk_mul_f32 v[44:45], v[52:53], v[44:45]
    v_pk_mul_f32 v[46:47], v[54:55], v[46:47]
    v_cvt_pk_bf16_f32 v56, v40, v41
    v_cvt_pk_bf16_f32 v57, v42, v43
    v_cvt_pk_bf16_f32 v58, v44, v45
    v_cvt_pk_bf16_f32 v59, v46, v47
    buffer_store_dwordx4 v[56:59], v252, s[4:7], s53 offen offset:2048 sc1
    v_accvgpr_read_b32 v0, a120
    v_accvgpr_read_b32 v1, a121
    v_accvgpr_read_b32 v2, a122
    v_accvgpr_read_b32 v3, a123
    v_accvgpr_read_b32 v4, a124
    v_accvgpr_read_b32 v5, a125
    v_accvgpr_read_b32 v6, a126
    v_accvgpr_read_b32 v7, a127
    v_pk_mul_f32 v[8:9], v[0:1], v[0:1]
    v_pk_mul_f32 v[10:11], v[2:3], v[2:3]
    v_pk_mul_f32 v[12:13], v[4:5], v[4:5]
    v_pk_mul_f32 v[14:15], v[6:7], v[6:7]
    v_pk_fma_f32 v[8:9], v[8:9], v[242:243], v[240:241]
    v_pk_fma_f32 v[10:11], v[10:11], v[242:243], v[240:241]
    v_pk_fma_f32 v[12:13], v[12:13], v[242:243], v[240:241]
    v_pk_fma_f32 v[14:15], v[14:15], v[242:243], v[240:241]
    v_pk_mul_f32 v[8:9], v[8:9], v[0:1]
    v_pk_mul_f32 v[10:11], v[10:11], v[2:3]
    v_pk_mul_f32 v[12:13], v[12:13], v[4:5]
    v_pk_mul_f32 v[14:15], v[14:15], v[6:7]
    v_exp_f32 v8, v8
    v_exp_f32 v9, v9
    v_exp_f32 v10, v10
    v_exp_f32 v11, v11
    v_exp_f32 v12, v12
    v_exp_f32 v13, v13
    v_exp_f32 v14, v14
    v_exp_f32 v15, v15
    v_pk_add_f32 v[8:9], v[8:9], v[244:245]
    v_pk_add_f32 v[10:11], v[10:11], v[244:245]
    v_pk_add_f32 v[12:13], v[12:13], v[244:245]
    v_pk_add_f32 v[14:15], v[14:15], v[244:245]
    v_rcp_f32 v8, v8
    v_rcp_f32 v9, v9
    v_rcp_f32 v10, v10
    v_rcp_f32 v11, v11
    v_rcp_f32 v12, v12
    v_rcp_f32 v13, v13
    v_rcp_f32 v14, v14
    v_rcp_f32 v15, v15
    v_pk_mul_f32 v[0:1], v[8:9], v[0:1]
    v_pk_mul_f32 v[2:3], v[10:11], v[2:3]
    v_pk_mul_f32 v[4:5], v[12:13], v[4:5]
    v_pk_mul_f32 v[6:7], v[14:15], v[6:7]
    v_cvt_pk_bf16_f32 v16, v0, v1
    v_cvt_pk_bf16_f32 v17, v2, v3
    v_cvt_pk_bf16_f32 v18, v4, v5
    v_cvt_pk_bf16_f32 v19, v6, v7
    buffer_store_dwordx4 v[16:19], v252, s[4:7], s53 offen offset:3072 sc1
    s_branch main_kernel_w_done
main_kernel_w_c1_egelu:
    s_mov_b32 s53, s21
    v_accvgpr_read_b32 v0, a0
    v_accvgpr_read_b32 v1, a1
    v_accvgpr_read_b32 v2, a2
    v_accvgpr_read_b32 v3, a3
    v_accvgpr_read_b32 v4, a4
    v_accvgpr_read_b32 v5, a5
    v_accvgpr_read_b32 v6, a6
    v_accvgpr_read_b32 v7, a7
    v_pk_mul_f32 v[8:9], v[0:1], v[0:1]
    v_pk_mul_f32 v[10:11], v[2:3], v[2:3]
    v_pk_mul_f32 v[12:13], v[4:5], v[4:5]
    v_pk_mul_f32 v[14:15], v[6:7], v[6:7]
    v_pk_fma_f32 v[8:9], v[8:9], v[242:243], v[240:241]
    v_pk_fma_f32 v[10:11], v[10:11], v[242:243], v[240:241]
    v_pk_fma_f32 v[12:13], v[12:13], v[242:243], v[240:241]
    v_pk_fma_f32 v[14:15], v[14:15], v[242:243], v[240:241]
    v_pk_mul_f32 v[8:9], v[8:9], v[0:1]
    v_pk_mul_f32 v[10:11], v[10:11], v[2:3]
    v_pk_mul_f32 v[12:13], v[12:13], v[4:5]
    v_pk_mul_f32 v[14:15], v[14:15], v[6:7]
    v_exp_f32 v8, v8
    v_exp_f32 v9, v9
    v_exp_f32 v10, v10
    v_exp_f32 v11, v11
    v_exp_f32 v12, v12
    v_exp_f32 v13, v13
    v_exp_f32 v14, v14
    v_exp_f32 v15, v15
    v_pk_add_f32 v[8:9], v[8:9], v[244:245]
    v_pk_add_f32 v[10:11], v[10:11], v[244:245]
    v_pk_add_f32 v[12:13], v[12:13], v[244:245]
    v_pk_add_f32 v[14:15], v[14:15], v[244:245]
    v_rcp_f32 v8, v8
    v_rcp_f32 v9, v9
    v_rcp_f32 v10, v10
    v_rcp_f32 v11, v11
    v_rcp_f32 v12, v12
    v_rcp_f32 v13, v13
    v_rcp_f32 v14, v14
    v_rcp_f32 v15, v15
    v_pk_mul_f32 v[0:1], v[8:9], v[0:1]
    v_pk_mul_f32 v[2:3], v[10:11], v[2:3]
    v_pk_mul_f32 v[4:5], v[12:13], v[4:5]
    v_pk_mul_f32 v[6:7], v[14:15], v[6:7]
    v_cvt_pk_bf16_f32 v16, v0, v1
    v_cvt_pk_bf16_f32 v17, v2, v3
    v_cvt_pk_bf16_f32 v18, v4, v5
    v_cvt_pk_bf16_f32 v19, v6, v7
    buffer_store_dwordx4 v[16:19], v251, s[4:7], s53 offen offset:0 sc1
    v_accvgpr_read_b32 v20, a8
    v_accvgpr_read_b32 v21, a9
    v_accvgpr_read_b32 v22, a10
    v_accvgpr_read_b32 v23, a11
    v_accvgpr_read_b32 v24, a12
    v_accvgpr_read_b32 v25, a13
    v_accvgpr_read_b32 v26, a14
    v_accvgpr_read_b32 v27, a15
    v_pk_mul_f32 v[28:29], v[20:21], v[20:21]
    v_pk_mul_f32 v[30:31], v[22:23], v[22:23]
    v_pk_mul_f32 v[32:33], v[24:25], v[24:25]
    v_pk_mul_f32 v[34:35], v[26:27], v[26:27]
    v_pk_fma_f32 v[28:29], v[28:29], v[242:243], v[240:241]
    v_pk_fma_f32 v[30:31], v[30:31], v[242:243], v[240:241]
    v_pk_fma_f32 v[32:33], v[32:33], v[242:243], v[240:241]
    v_pk_fma_f32 v[34:35], v[34:35], v[242:243], v[240:241]
    v_pk_mul_f32 v[28:29], v[28:29], v[20:21]
    v_pk_mul_f32 v[30:31], v[30:31], v[22:23]
    v_pk_mul_f32 v[32:33], v[32:33], v[24:25]
    v_pk_mul_f32 v[34:35], v[34:35], v[26:27]
    v_exp_f32 v28, v28
    v_exp_f32 v29, v29
    v_exp_f32 v30, v30
    v_exp_f32 v31, v31
    v_exp_f32 v32, v32
    v_exp_f32 v33, v33
    v_exp_f32 v34, v34
    v_exp_f32 v35, v35
    v_pk_add_f32 v[28:29], v[28:29], v[244:245]
    v_pk_add_f32 v[30:31], v[30:31], v[244:245]
    v_pk_add_f32 v[32:33], v[32:33], v[244:245]
    v_pk_add_f32 v[34:35], v[34:35], v[244:245]
    v_rcp_f32 v28, v28
    v_rcp_f32 v29, v29
    v_rcp_f32 v30, v30
    v_rcp_f32 v31, v31
    v_rcp_f32 v32, v32
    v_rcp_f32 v33, v33
    v_rcp_f32 v34, v34
    v_rcp_f32 v35, v35
    v_pk_mul_f32 v[20:21], v[28:29], v[20:21]
    v_pk_mul_f32 v[22:23], v[30:31], v[22:23]
    v_pk_mul_f32 v[24:25], v[32:33], v[24:25]
    v_pk_mul_f32 v[26:27], v[34:35], v[26:27]
    v_cvt_pk_bf16_f32 v36, v20, v21
    v_cvt_pk_bf16_f32 v37, v22, v23
    v_cvt_pk_bf16_f32 v38, v24, v25
    v_cvt_pk_bf16_f32 v39, v26, v27
    buffer_store_dwordx4 v[36:39], v251, s[4:7], s53 offen offset:1024 sc1
    v_accvgpr_read_b32 v40, a16
    v_accvgpr_read_b32 v41, a17
    v_accvgpr_read_b32 v42, a18
    v_accvgpr_read_b32 v43, a19
    v_accvgpr_read_b32 v44, a20
    v_accvgpr_read_b32 v45, a21
    v_accvgpr_read_b32 v46, a22
    v_accvgpr_read_b32 v47, a23
    v_pk_mul_f32 v[48:49], v[40:41], v[40:41]
    v_pk_mul_f32 v[50:51], v[42:43], v[42:43]
    v_pk_mul_f32 v[52:53], v[44:45], v[44:45]
    v_pk_mul_f32 v[54:55], v[46:47], v[46:47]
    v_pk_fma_f32 v[48:49], v[48:49], v[242:243], v[240:241]
    v_pk_fma_f32 v[50:51], v[50:51], v[242:243], v[240:241]
    v_pk_fma_f32 v[52:53], v[52:53], v[242:243], v[240:241]
    v_pk_fma_f32 v[54:55], v[54:55], v[242:243], v[240:241]
    v_pk_mul_f32 v[48:49], v[48:49], v[40:41]
    v_pk_mul_f32 v[50:51], v[50:51], v[42:43]
    v_pk_mul_f32 v[52:53], v[52:53], v[44:45]
    v_pk_mul_f32 v[54:55], v[54:55], v[46:47]
    v_exp_f32 v48, v48
    v_exp_f32 v49, v49
    v_exp_f32 v50, v50
    v_exp_f32 v51, v51
    v_exp_f32 v52, v52
    v_exp_f32 v53, v53
    v_exp_f32 v54, v54
    v_exp_f32 v55, v55
    v_pk_add_f32 v[48:49], v[48:49], v[244:245]
    v_pk_add_f32 v[50:51], v[50:51], v[244:245]
    v_pk_add_f32 v[52:53], v[52:53], v[244:245]
    v_pk_add_f32 v[54:55], v[54:55], v[244:245]
    v_rcp_f32 v48, v48
    v_rcp_f32 v49, v49
    v_rcp_f32 v50, v50
    v_rcp_f32 v51, v51
    v_rcp_f32 v52, v52
    v_rcp_f32 v53, v53
    v_rcp_f32 v54, v54
    v_rcp_f32 v55, v55
    v_pk_mul_f32 v[40:41], v[48:49], v[40:41]
    v_pk_mul_f32 v[42:43], v[50:51], v[42:43]
    v_pk_mul_f32 v[44:45], v[52:53], v[44:45]
    v_pk_mul_f32 v[46:47], v[54:55], v[46:47]
    v_cvt_pk_bf16_f32 v56, v40, v41
    v_cvt_pk_bf16_f32 v57, v42, v43
    v_cvt_pk_bf16_f32 v58, v44, v45
    v_cvt_pk_bf16_f32 v59, v46, v47
    buffer_store_dwordx4 v[56:59], v251, s[4:7], s53 offen offset:2048 sc1
    v_accvgpr_read_b32 v0, a24
    v_accvgpr_read_b32 v1, a25
    v_accvgpr_read_b32 v2, a26
    v_accvgpr_read_b32 v3, a27
    v_accvgpr_read_b32 v4, a28
    v_accvgpr_read_b32 v5, a29
    v_accvgpr_read_b32 v6, a30
    v_accvgpr_read_b32 v7, a31
    v_pk_mul_f32 v[8:9], v[0:1], v[0:1]
    v_pk_mul_f32 v[10:11], v[2:3], v[2:3]
    v_pk_mul_f32 v[12:13], v[4:5], v[4:5]
    v_pk_mul_f32 v[14:15], v[6:7], v[6:7]
    v_pk_fma_f32 v[8:9], v[8:9], v[242:243], v[240:241]
    v_pk_fma_f32 v[10:11], v[10:11], v[242:243], v[240:241]
    v_pk_fma_f32 v[12:13], v[12:13], v[242:243], v[240:241]
    v_pk_fma_f32 v[14:15], v[14:15], v[242:243], v[240:241]
    v_pk_mul_f32 v[8:9], v[8:9], v[0:1]
    v_pk_mul_f32 v[10:11], v[10:11], v[2:3]
    v_pk_mul_f32 v[12:13], v[12:13], v[4:5]
    v_pk_mul_f32 v[14:15], v[14:15], v[6:7]
    v_exp_f32 v8, v8
    v_exp_f32 v9, v9
    v_exp_f32 v10, v10
    v_exp_f32 v11, v11
    v_exp_f32 v12, v12
    v_exp_f32 v13, v13
    v_exp_f32 v14, v14
    v_exp_f32 v15, v15
    v_pk_add_f32 v[8:9], v[8:9], v[244:245]
    v_pk_add_f32 v[10:11], v[10:11], v[244:245]
    v_pk_add_f32 v[12:13], v[12:13], v[244:245]
    v_pk_add_f32 v[14:15], v[14:15], v[244:245]
    v_rcp_f32 v8, v8
    v_rcp_f32 v9, v9
    v_rcp_f32 v10, v10
    v_rcp_f32 v11, v11
    v_rcp_f32 v12, v12
    v_rcp_f32 v13, v13
    v_rcp_f32 v14, v14
    v_rcp_f32 v15, v15
    v_pk_mul_f32 v[0:1], v[8:9], v[0:1]
    v_pk_mul_f32 v[2:3], v[10:11], v[2:3]
    v_pk_mul_f32 v[4:5], v[12:13], v[4:5]
    v_pk_mul_f32 v[6:7], v[14:15], v[6:7]
    v_cvt_pk_bf16_f32 v16, v0, v1
    v_cvt_pk_bf16_f32 v17, v2, v3
    v_cvt_pk_bf16_f32 v18, v4, v5
    v_cvt_pk_bf16_f32 v19, v6, v7
    buffer_store_dwordx4 v[16:19], v251, s[4:7], s53 offen offset:3072 sc1
    s_add_u32 s53, s53, s22
    v_accvgpr_read_b32 v20, a32
    v_accvgpr_read_b32 v21, a33
    v_accvgpr_read_b32 v22, a34
    v_accvgpr_read_b32 v23, a35
    v_accvgpr_read_b32 v24, a36
    v_accvgpr_read_b32 v25, a37
    v_accvgpr_read_b32 v26, a38
    v_accvgpr_read_b32 v27, a39
    v_pk_mul_f32 v[28:29], v[20:21], v[20:21]
    v_pk_mul_f32 v[30:31], v[22:23], v[22:23]
    v_pk_mul_f32 v[32:33], v[24:25], v[24:25]
    v_pk_mul_f32 v[34:35], v[26:27], v[26:27]
    v_pk_fma_f32 v[28:29], v[28:29], v[242:243], v[240:241]
    v_pk_fma_f32 v[30:31], v[30:31], v[242:243], v[240:241]
    v_pk_fma_f32 v[32:33], v[32:33], v[242:243], v[240:241]
    v_pk_fma_f32 v[34:35], v[34:35], v[242:243], v[240:241]
    v_pk_mul_f32 v[28:29], v[28:29], v[20:21]
    v_pk_mul_f32 v[30:31], v[30:31], v[22:23]
    v_pk_mul_f32 v[32:33], v[32:33], v[24:25]
    v_pk_mul_f32 v[34:35], v[34:35], v[26:27]
    v_exp_f32 v28, v28
    v_exp_f32 v29, v29
    v_exp_f32 v30, v30
    v_exp_f32 v31, v31
    v_exp_f32 v32, v32
    v_exp_f32 v33, v33
    v_exp_f32 v34, v34
    v_exp_f32 v35, v35
    v_pk_add_f32 v[28:29], v[28:29], v[244:245]
    v_pk_add_f32 v[30:31], v[30:31], v[244:245]
    v_pk_add_f32 v[32:33], v[32:33], v[244:245]
    v_pk_add_f32 v[34:35], v[34:35], v[244:245]
    v_rcp_f32 v28, v28
    v_rcp_f32 v29, v29
    v_rcp_f32 v30, v30
    v_rcp_f32 v31, v31
    v_rcp_f32 v32, v32
    v_rcp_f32 v33, v33
    v_rcp_f32 v34, v34
    v_rcp_f32 v35, v35
    v_pk_mul_f32 v[20:21], v[28:29], v[20:21]
    v_pk_mul_f32 v[22:23], v[30:31], v[22:23]
    v_pk_mul_f32 v[24:25], v[32:33], v[24:25]
    v_pk_mul_f32 v[26:27], v[34:35], v[26:27]
    v_cvt_pk_bf16_f32 v36, v20, v21
    v_cvt_pk_bf16_f32 v37, v22, v23
    v_cvt_pk_bf16_f32 v38, v24, v25
    v_cvt_pk_bf16_f32 v39, v26, v27
    buffer_store_dwordx4 v[36:39], v251, s[4:7], s53 offen offset:0 sc1
    v_accvgpr_read_b32 v40, a40
    v_accvgpr_read_b32 v41, a41
    v_accvgpr_read_b32 v42, a42
    v_accvgpr_read_b32 v43, a43
    v_accvgpr_read_b32 v44, a44
    v_accvgpr_read_b32 v45, a45
    v_accvgpr_read_b32 v46, a46
    v_accvgpr_read_b32 v47, a47
    v_pk_mul_f32 v[48:49], v[40:41], v[40:41]
    v_pk_mul_f32 v[50:51], v[42:43], v[42:43]
    v_pk_mul_f32 v[52:53], v[44:45], v[44:45]
    v_pk_mul_f32 v[54:55], v[46:47], v[46:47]
    v_pk_fma_f32 v[48:49], v[48:49], v[242:243], v[240:241]
    v_pk_fma_f32 v[50:51], v[50:51], v[242:243], v[240:241]
    v_pk_fma_f32 v[52:53], v[52:53], v[242:243], v[240:241]
    v_pk_fma_f32 v[54:55], v[54:55], v[242:243], v[240:241]
    v_pk_mul_f32 v[48:49], v[48:49], v[40:41]
    v_pk_mul_f32 v[50:51], v[50:51], v[42:43]
    v_pk_mul_f32 v[52:53], v[52:53], v[44:45]
    v_pk_mul_f32 v[54:55], v[54:55], v[46:47]
    v_exp_f32 v48, v48
    v_exp_f32 v49, v49
    v_exp_f32 v50, v50
    v_exp_f32 v51, v51
    v_exp_f32 v52, v52
    v_exp_f32 v53, v53
    v_exp_f32 v54, v54
    v_exp_f32 v55, v55
    v_pk_add_f32 v[48:49], v[48:49], v[244:245]
    v_pk_add_f32 v[50:51], v[50:51], v[244:245]
    v_pk_add_f32 v[52:53], v[52:53], v[244:245]
    v_pk_add_f32 v[54:55], v[54:55], v[244:245]
    v_rcp_f32 v48, v48
    v_rcp_f32 v49, v49
    v_rcp_f32 v50, v50
    v_rcp_f32 v51, v51
    v_rcp_f32 v52, v52
    v_rcp_f32 v53, v53
    v_rcp_f32 v54, v54
    v_rcp_f32 v55, v55
    v_pk_mul_f32 v[40:41], v[48:49], v[40:41]
    v_pk_mul_f32 v[42:43], v[50:51], v[42:43]
    v_pk_mul_f32 v[44:45], v[52:53], v[44:45]
    v_pk_mul_f32 v[46:47], v[54:55], v[46:47]
    v_cvt_pk_bf16_f32 v56, v40, v41
    v_cvt_pk_bf16_f32 v57, v42, v43
    v_cvt_pk_bf16_f32 v58, v44, v45
    v_cvt_pk_bf16_f32 v59, v46, v47
    buffer_store_dwordx4 v[56:59], v251, s[4:7], s53 offen offset:1024 sc1
    v_accvgpr_read_b32 v0, a48
    v_accvgpr_read_b32 v1, a49
    v_accvgpr_read_b32 v2, a50
    v_accvgpr_read_b32 v3, a51
    v_accvgpr_read_b32 v4, a52
    v_accvgpr_read_b32 v5, a53
    v_accvgpr_read_b32 v6, a54
    v_accvgpr_read_b32 v7, a55
    v_pk_mul_f32 v[8:9], v[0:1], v[0:1]
    v_pk_mul_f32 v[10:11], v[2:3], v[2:3]
    v_pk_mul_f32 v[12:13], v[4:5], v[4:5]
    v_pk_mul_f32 v[14:15], v[6:7], v[6:7]
    v_pk_fma_f32 v[8:9], v[8:9], v[242:243], v[240:241]
    v_pk_fma_f32 v[10:11], v[10:11], v[242:243], v[240:241]
    v_pk_fma_f32 v[12:13], v[12:13], v[242:243], v[240:241]
    v_pk_fma_f32 v[14:15], v[14:15], v[242:243], v[240:241]
    v_pk_mul_f32 v[8:9], v[8:9], v[0:1]
    v_pk_mul_f32 v[10:11], v[10:11], v[2:3]
    v_pk_mul_f32 v[12:13], v[12:13], v[4:5]
    v_pk_mul_f32 v[14:15], v[14:15], v[6:7]
    v_exp_f32 v8, v8
    v_exp_f32 v9, v9
    v_exp_f32 v10, v10
    v_exp_f32 v11, v11
    v_exp_f32 v12, v12
    v_exp_f32 v13, v13
    v_exp_f32 v14, v14
    v_exp_f32 v15, v15
    v_pk_add_f32 v[8:9], v[8:9], v[244:245]
    v_pk_add_f32 v[10:11], v[10:11], v[244:245]
    v_pk_add_f32 v[12:13], v[12:13], v[244:245]
    v_pk_add_f32 v[14:15], v[14:15], v[244:245]
    v_rcp_f32 v8, v8
    v_rcp_f32 v9, v9
    v_rcp_f32 v10, v10
    v_rcp_f32 v11, v11
    v_rcp_f32 v12, v12
    v_rcp_f32 v13, v13
    v_rcp_f32 v14, v14
    v_rcp_f32 v15, v15
    v_pk_mul_f32 v[0:1], v[8:9], v[0:1]
    v_pk_mul_f32 v[2:3], v[10:11], v[2:3]
    v_pk_mul_f32 v[4:5], v[12:13], v[4:5]
    v_pk_mul_f32 v[6:7], v[14:15], v[6:7]
    v_cvt_pk_bf16_f32 v16, v0, v1
    v_cvt_pk_bf16_f32 v17, v2, v3
    v_cvt_pk_bf16_f32 v18, v4, v5
    v_cvt_pk_bf16_f32 v19, v6, v7
    buffer_store_dwordx4 v[16:19], v251, s[4:7], s53 offen offset:2048 sc1
    v_accvgpr_read_b32 v20, a56
    v_accvgpr_read_b32 v21, a57
    v_accvgpr_read_b32 v22, a58
    v_accvgpr_read_b32 v23, a59
    v_accvgpr_read_b32 v24, a60
    v_accvgpr_read_b32 v25, a61
    v_accvgpr_read_b32 v26, a62
    v_accvgpr_read_b32 v27, a63
    v_pk_mul_f32 v[28:29], v[20:21], v[20:21]
    v_pk_mul_f32 v[30:31], v[22:23], v[22:23]
    v_pk_mul_f32 v[32:33], v[24:25], v[24:25]
    v_pk_mul_f32 v[34:35], v[26:27], v[26:27]
    v_pk_fma_f32 v[28:29], v[28:29], v[242:243], v[240:241]
    v_pk_fma_f32 v[30:31], v[30:31], v[242:243], v[240:241]
    v_pk_fma_f32 v[32:33], v[32:33], v[242:243], v[240:241]
    v_pk_fma_f32 v[34:35], v[34:35], v[242:243], v[240:241]
    v_pk_mul_f32 v[28:29], v[28:29], v[20:21]
    v_pk_mul_f32 v[30:31], v[30:31], v[22:23]
    v_pk_mul_f32 v[32:33], v[32:33], v[24:25]
    v_pk_mul_f32 v[34:35], v[34:35], v[26:27]
    v_exp_f32 v28, v28
    v_exp_f32 v29, v29
    v_exp_f32 v30, v30
    v_exp_f32 v31, v31
    v_exp_f32 v32, v32
    v_exp_f32 v33, v33
    v_exp_f32 v34, v34
    v_exp_f32 v35, v35
    v_pk_add_f32 v[28:29], v[28:29], v[244:245]
    v_pk_add_f32 v[30:31], v[30:31], v[244:245]
    v_pk_add_f32 v[32:33], v[32:33], v[244:245]
    v_pk_add_f32 v[34:35], v[34:35], v[244:245]
    v_rcp_f32 v28, v28
    v_rcp_f32 v29, v29
    v_rcp_f32 v30, v30
    v_rcp_f32 v31, v31
    v_rcp_f32 v32, v32
    v_rcp_f32 v33, v33
    v_rcp_f32 v34, v34
    v_rcp_f32 v35, v35
    v_pk_mul_f32 v[20:21], v[28:29], v[20:21]
    v_pk_mul_f32 v[22:23], v[30:31], v[22:23]
    v_pk_mul_f32 v[24:25], v[32:33], v[24:25]
    v_pk_mul_f32 v[26:27], v[34:35], v[26:27]
    v_cvt_pk_bf16_f32 v36, v20, v21
    v_cvt_pk_bf16_f32 v37, v22, v23
    v_cvt_pk_bf16_f32 v38, v24, v25
    v_cvt_pk_bf16_f32 v39, v26, v27
    buffer_store_dwordx4 v[36:39], v251, s[4:7], s53 offen offset:3072 sc1
    s_add_u32 s53, s53, s22
    v_accvgpr_read_b32 v40, a64
    v_accvgpr_read_b32 v41, a65
    v_accvgpr_read_b32 v42, a66
    v_accvgpr_read_b32 v43, a67
    v_accvgpr_read_b32 v44, a68
    v_accvgpr_read_b32 v45, a69
    v_accvgpr_read_b32 v46, a70
    v_accvgpr_read_b32 v47, a71
    v_pk_mul_f32 v[48:49], v[40:41], v[40:41]
    v_pk_mul_f32 v[50:51], v[42:43], v[42:43]
    v_pk_mul_f32 v[52:53], v[44:45], v[44:45]
    v_pk_mul_f32 v[54:55], v[46:47], v[46:47]
    v_pk_fma_f32 v[48:49], v[48:49], v[242:243], v[240:241]
    v_pk_fma_f32 v[50:51], v[50:51], v[242:243], v[240:241]
    v_pk_fma_f32 v[52:53], v[52:53], v[242:243], v[240:241]
    v_pk_fma_f32 v[54:55], v[54:55], v[242:243], v[240:241]
    v_pk_mul_f32 v[48:49], v[48:49], v[40:41]
    v_pk_mul_f32 v[50:51], v[50:51], v[42:43]
    v_pk_mul_f32 v[52:53], v[52:53], v[44:45]
    v_pk_mul_f32 v[54:55], v[54:55], v[46:47]
    v_exp_f32 v48, v48
    v_exp_f32 v49, v49
    v_exp_f32 v50, v50
    v_exp_f32 v51, v51
    v_exp_f32 v52, v52
    v_exp_f32 v53, v53
    v_exp_f32 v54, v54
    v_exp_f32 v55, v55
    v_pk_add_f32 v[48:49], v[48:49], v[244:245]
    v_pk_add_f32 v[50:51], v[50:51], v[244:245]
    v_pk_add_f32 v[52:53], v[52:53], v[244:245]
    v_pk_add_f32 v[54:55], v[54:55], v[244:245]
    v_rcp_f32 v48, v48
    v_rcp_f32 v49, v49
    v_rcp_f32 v50, v50
    v_rcp_f32 v51, v51
    v_rcp_f32 v52, v52
    v_rcp_f32 v53, v53
    v_rcp_f32 v54, v54
    v_rcp_f32 v55, v55
    v_pk_mul_f32 v[40:41], v[48:49], v[40:41]
    v_pk_mul_f32 v[42:43], v[50:51], v[42:43]
    v_pk_mul_f32 v[44:45], v[52:53], v[44:45]
    v_pk_mul_f32 v[46:47], v[54:55], v[46:47]
    v_cvt_pk_bf16_f32 v56, v40, v41
    v_cvt_pk_bf16_f32 v57, v42, v43
    v_cvt_pk_bf16_f32 v58, v44, v45
    v_cvt_pk_bf16_f32 v59, v46, v47
    buffer_store_dwordx4 v[56:59], v251, s[4:7], s53 offen offset:0 sc1
    v_accvgpr_read_b32 v0, a72
    v_accvgpr_read_b32 v1, a73
    v_accvgpr_read_b32 v2, a74
    v_accvgpr_read_b32 v3, a75
    v_accvgpr_read_b32 v4, a76
    v_accvgpr_read_b32 v5, a77
    v_accvgpr_read_b32 v6, a78
    v_accvgpr_read_b32 v7, a79
    v_pk_mul_f32 v[8:9], v[0:1], v[0:1]
    v_pk_mul_f32 v[10:11], v[2:3], v[2:3]
    v_pk_mul_f32 v[12:13], v[4:5], v[4:5]
    v_pk_mul_f32 v[14:15], v[6:7], v[6:7]
    v_pk_fma_f32 v[8:9], v[8:9], v[242:243], v[240:241]
    v_pk_fma_f32 v[10:11], v[10:11], v[242:243], v[240:241]
    v_pk_fma_f32 v[12:13], v[12:13], v[242:243], v[240:241]
    v_pk_fma_f32 v[14:15], v[14:15], v[242:243], v[240:241]
    v_pk_mul_f32 v[8:9], v[8:9], v[0:1]
    v_pk_mul_f32 v[10:11], v[10:11], v[2:3]
    v_pk_mul_f32 v[12:13], v[12:13], v[4:5]
    v_pk_mul_f32 v[14:15], v[14:15], v[6:7]
    v_exp_f32 v8, v8
    v_exp_f32 v9, v9
    v_exp_f32 v10, v10
    v_exp_f32 v11, v11
    v_exp_f32 v12, v12
    v_exp_f32 v13, v13
    v_exp_f32 v14, v14
    v_exp_f32 v15, v15
    v_pk_add_f32 v[8:9], v[8:9], v[244:245]
    v_pk_add_f32 v[10:11], v[10:11], v[244:245]
    v_pk_add_f32 v[12:13], v[12:13], v[244:245]
    v_pk_add_f32 v[14:15], v[14:15], v[244:245]
    v_rcp_f32 v8, v8
    v_rcp_f32 v9, v9
    v_rcp_f32 v10, v10
    v_rcp_f32 v11, v11
    v_rcp_f32 v12, v12
    v_rcp_f32 v13, v13
    v_rcp_f32 v14, v14
    v_rcp_f32 v15, v15
    v_pk_mul_f32 v[0:1], v[8:9], v[0:1]
    v_pk_mul_f32 v[2:3], v[10:11], v[2:3]
    v_pk_mul_f32 v[4:5], v[12:13], v[4:5]
    v_pk_mul_f32 v[6:7], v[14:15], v[6:7]
    v_cvt_pk_bf16_f32 v16, v0, v1
    v_cvt_pk_bf16_f32 v17, v2, v3
    v_cvt_pk_bf16_f32 v18, v4, v5
    v_cvt_pk_bf16_f32 v19, v6, v7
    buffer_store_dwordx4 v[16:19], v251, s[4:7], s53 offen offset:1024 sc1
    v_accvgpr_read_b32 v20, a80
    v_accvgpr_read_b32 v21, a81
    v_accvgpr_read_b32 v22, a82
    v_accvgpr_read_b32 v23, a83
    v_accvgpr_read_b32 v24, a84
    v_accvgpr_read_b32 v25, a85
    v_accvgpr_read_b32 v26, a86
    v_accvgpr_read_b32 v27, a87
    v_pk_mul_f32 v[28:29], v[20:21], v[20:21]
    v_pk_mul_f32 v[30:31], v[22:23], v[22:23]
    v_pk_mul_f32 v[32:33], v[24:25], v[24:25]
    v_pk_mul_f32 v[34:35], v[26:27], v[26:27]
    v_pk_fma_f32 v[28:29], v[28:29], v[242:243], v[240:241]
    v_pk_fma_f32 v[30:31], v[30:31], v[242:243], v[240:241]
    v_pk_fma_f32 v[32:33], v[32:33], v[242:243], v[240:241]
    v_pk_fma_f32 v[34:35], v[34:35], v[242:243], v[240:241]
    v_pk_mul_f32 v[28:29], v[28:29], v[20:21]
    v_pk_mul_f32 v[30:31], v[30:31], v[22:23]
    v_pk_mul_f32 v[32:33], v[32:33], v[24:25]
    v_pk_mul_f32 v[34:35], v[34:35], v[26:27]
    v_exp_f32 v28, v28
    v_exp_f32 v29, v29
    v_exp_f32 v30, v30
    v_exp_f32 v31, v31
    v_exp_f32 v32, v32
    v_exp_f32 v33, v33
    v_exp_f32 v34, v34
    v_exp_f32 v35, v35
    v_pk_add_f32 v[28:29], v[28:29], v[244:245]
    v_pk_add_f32 v[30:31], v[30:31], v[244:245]
    v_pk_add_f32 v[32:33], v[32:33], v[244:245]
    v_pk_add_f32 v[34:35], v[34:35], v[244:245]
    v_rcp_f32 v28, v28
    v_rcp_f32 v29, v29
    v_rcp_f32 v30, v30
    v_rcp_f32 v31, v31
    v_rcp_f32 v32, v32
    v_rcp_f32 v33, v33
    v_rcp_f32 v34, v34
    v_rcp_f32 v35, v35
    v_pk_mul_f32 v[20:21], v[28:29], v[20:21]
    v_pk_mul_f32 v[22:23], v[30:31], v[22:23]
    v_pk_mul_f32 v[24:25], v[32:33], v[24:25]
    v_pk_mul_f32 v[26:27], v[34:35], v[26:27]
    v_cvt_pk_bf16_f32 v36, v20, v21
    v_cvt_pk_bf16_f32 v37, v22, v23
    v_cvt_pk_bf16_f32 v38, v24, v25
    v_cvt_pk_bf16_f32 v39, v26, v27
    buffer_store_dwordx4 v[36:39], v251, s[4:7], s53 offen offset:2048 sc1
    v_accvgpr_read_b32 v40, a88
    v_accvgpr_read_b32 v41, a89
    v_accvgpr_read_b32 v42, a90
    v_accvgpr_read_b32 v43, a91
    v_accvgpr_read_b32 v44, a92
    v_accvgpr_read_b32 v45, a93
    v_accvgpr_read_b32 v46, a94
    v_accvgpr_read_b32 v47, a95
    v_pk_mul_f32 v[48:49], v[40:41], v[40:41]
    v_pk_mul_f32 v[50:51], v[42:43], v[42:43]
    v_pk_mul_f32 v[52:53], v[44:45], v[44:45]
    v_pk_mul_f32 v[54:55], v[46:47], v[46:47]
    v_pk_fma_f32 v[48:49], v[48:49], v[242:243], v[240:241]
    v_pk_fma_f32 v[50:51], v[50:51], v[242:243], v[240:241]
    v_pk_fma_f32 v[52:53], v[52:53], v[242:243], v[240:241]
    v_pk_fma_f32 v[54:55], v[54:55], v[242:243], v[240:241]
    v_pk_mul_f32 v[48:49], v[48:49], v[40:41]
    v_pk_mul_f32 v[50:51], v[50:51], v[42:43]
    v_pk_mul_f32 v[52:53], v[52:53], v[44:45]
    v_pk_mul_f32 v[54:55], v[54:55], v[46:47]
    v_exp_f32 v48, v48
    v_exp_f32 v49, v49
    v_exp_f32 v50, v50
    v_exp_f32 v51, v51
    v_exp_f32 v52, v52
    v_exp_f32 v53, v53
    v_exp_f32 v54, v54
    v_exp_f32 v55, v55
    v_pk_add_f32 v[48:49], v[48:49], v[244:245]
    v_pk_add_f32 v[50:51], v[50:51], v[244:245]
    v_pk_add_f32 v[52:53], v[52:53], v[244:245]
    v_pk_add_f32 v[54:55], v[54:55], v[244:245]
    v_rcp_f32 v48, v48
    v_rcp_f32 v49, v49
    v_rcp_f32 v50, v50
    v_rcp_f32 v51, v51
    v_rcp_f32 v52, v52
    v_rcp_f32 v53, v53
    v_rcp_f32 v54, v54
    v_rcp_f32 v55, v55
    v_pk_mul_f32 v[40:41], v[48:49], v[40:41]
    v_pk_mul_f32 v[42:43], v[50:51], v[42:43]
    v_pk_mul_f32 v[44:45], v[52:53], v[44:45]
    v_pk_mul_f32 v[46:47], v[54:55], v[46:47]
    v_cvt_pk_bf16_f32 v56, v40, v41
    v_cvt_pk_bf16_f32 v57, v42, v43
    v_cvt_pk_bf16_f32 v58, v44, v45
    v_cvt_pk_bf16_f32 v59, v46, v47
    buffer_store_dwordx4 v[56:59], v251, s[4:7], s53 offen offset:3072 sc1
    s_add_u32 s53, s53, s22
    v_accvgpr_read_b32 v0, a96
    v_accvgpr_read_b32 v1, a97
    v_accvgpr_read_b32 v2, a98
    v_accvgpr_read_b32 v3, a99
    v_accvgpr_read_b32 v4, a100
    v_accvgpr_read_b32 v5, a101
    v_accvgpr_read_b32 v6, a102
    v_accvgpr_read_b32 v7, a103
    v_pk_mul_f32 v[8:9], v[0:1], v[0:1]
    v_pk_mul_f32 v[10:11], v[2:3], v[2:3]
    v_pk_mul_f32 v[12:13], v[4:5], v[4:5]
    v_pk_mul_f32 v[14:15], v[6:7], v[6:7]
    v_pk_fma_f32 v[8:9], v[8:9], v[242:243], v[240:241]
    v_pk_fma_f32 v[10:11], v[10:11], v[242:243], v[240:241]
    v_pk_fma_f32 v[12:13], v[12:13], v[242:243], v[240:241]
    v_pk_fma_f32 v[14:15], v[14:15], v[242:243], v[240:241]
    v_pk_mul_f32 v[8:9], v[8:9], v[0:1]
    v_pk_mul_f32 v[10:11], v[10:11], v[2:3]
    v_pk_mul_f32 v[12:13], v[12:13], v[4:5]
    v_pk_mul_f32 v[14:15], v[14:15], v[6:7]
    v_exp_f32 v8, v8
    v_exp_f32 v9, v9
    v_exp_f32 v10, v10
    v_exp_f32 v11, v11
    v_exp_f32 v12, v12
    v_exp_f32 v13, v13
    v_exp_f32 v14, v14
    v_exp_f32 v15, v15
    v_pk_add_f32 v[8:9], v[8:9], v[244:245]
    v_pk_add_f32 v[10:11], v[10:11], v[244:245]
    v_pk_add_f32 v[12:13], v[12:13], v[244:245]
    v_pk_add_f32 v[14:15], v[14:15], v[244:245]
    v_rcp_f32 v8, v8
    v_rcp_f32 v9, v9
    v_rcp_f32 v10, v10
    v_rcp_f32 v11, v11
    v_rcp_f32 v12, v12
    v_rcp_f32 v13, v13
    v_rcp_f32 v14, v14
    v_rcp_f32 v15, v15
    v_pk_mul_f32 v[0:1], v[8:9], v[0:1]
    v_pk_mul_f32 v[2:3], v[10:11], v[2:3]
    v_pk_mul_f32 v[4:5], v[12:13], v[4:5]
    v_pk_mul_f32 v[6:7], v[14:15], v[6:7]
    v_cvt_pk_bf16_f32 v16, v0, v1
    v_cvt_pk_bf16_f32 v17, v2, v3
    v_cvt_pk_bf16_f32 v18, v4, v5
    v_cvt_pk_bf16_f32 v19, v6, v7
    buffer_store_dwordx4 v[16:19], v251, s[4:7], s53 offen offset:0 sc1
    v_accvgpr_read_b32 v20, a104
    v_accvgpr_read_b32 v21, a105
    v_accvgpr_read_b32 v22, a106
    v_accvgpr_read_b32 v23, a107
    v_accvgpr_read_b32 v24, a108
    v_accvgpr_read_b32 v25, a109
    v_accvgpr_read_b32 v26, a110
    v_accvgpr_read_b32 v27, a111
    v_pk_mul_f32 v[28:29], v[20:21], v[20:21]
    v_pk_mul_f32 v[30:31], v[22:23], v[22:23]
    v_pk_mul_f32 v[32:33], v[24:25], v[24:25]
    v_pk_mul_f32 v[34:35], v[26:27], v[26:27]
    v_pk_fma_f32 v[28:29], v[28:29], v[242:243], v[240:241]
    v_pk_fma_f32 v[30:31], v[30:31], v[242:243], v[240:241]
    v_pk_fma_f32 v[32:33], v[32:33], v[242:243], v[240:241]
    v_pk_fma_f32 v[34:35], v[34:35], v[242:243], v[240:241]
    v_pk_mul_f32 v[28:29], v[28:29], v[20:21]
    v_pk_mul_f32 v[30:31], v[30:31], v[22:23]
    v_pk_mul_f32 v[32:33], v[32:33], v[24:25]
    v_pk_mul_f32 v[34:35], v[34:35], v[26:27]
    v_exp_f32 v28, v28
    v_exp_f32 v29, v29
    v_exp_f32 v30, v30
    v_exp_f32 v31, v31
    v_exp_f32 v32, v32
    v_exp_f32 v33, v33
    v_exp_f32 v34, v34
    v_exp_f32 v35, v35
    v_pk_add_f32 v[28:29], v[28:29], v[244:245]
    v_pk_add_f32 v[30:31], v[30:31], v[244:245]
    v_pk_add_f32 v[32:33], v[32:33], v[244:245]
    v_pk_add_f32 v[34:35], v[34:35], v[244:245]
    v_rcp_f32 v28, v28
    v_rcp_f32 v29, v29
    v_rcp_f32 v30, v30
    v_rcp_f32 v31, v31
    v_rcp_f32 v32, v32
    v_rcp_f32 v33, v33
    v_rcp_f32 v34, v34
    v_rcp_f32 v35, v35
    v_pk_mul_f32 v[20:21], v[28:29], v[20:21]
    v_pk_mul_f32 v[22:23], v[30:31], v[22:23]
    v_pk_mul_f32 v[24:25], v[32:33], v[24:25]
    v_pk_mul_f32 v[26:27], v[34:35], v[26:27]
    v_cvt_pk_bf16_f32 v36, v20, v21
    v_cvt_pk_bf16_f32 v37, v22, v23
    v_cvt_pk_bf16_f32 v38, v24, v25
    v_cvt_pk_bf16_f32 v39, v26, v27
    buffer_store_dwordx4 v[36:39], v251, s[4:7], s53 offen offset:1024 sc1
    v_accvgpr_read_b32 v40, a112
    v_accvgpr_read_b32 v41, a113
    v_accvgpr_read_b32 v42, a114
    v_accvgpr_read_b32 v43, a115
    v_accvgpr_read_b32 v44, a116
    v_accvgpr_read_b32 v45, a117
    v_accvgpr_read_b32 v46, a118
    v_accvgpr_read_b32 v47, a119
    v_pk_mul_f32 v[48:49], v[40:41], v[40:41]
    v_pk_mul_f32 v[50:51], v[42:43], v[42:43]
    v_pk_mul_f32 v[52:53], v[44:45], v[44:45]
    v_pk_mul_f32 v[54:55], v[46:47], v[46:47]
    v_pk_fma_f32 v[48:49], v[48:49], v[242:243], v[240:241]
    v_pk_fma_f32 v[50:51], v[50:51], v[242:243], v[240:241]
    v_pk_fma_f32 v[52:53], v[52:53], v[242:243], v[240:241]
    v_pk_fma_f32 v[54:55], v[54:55], v[242:243], v[240:241]
    v_pk_mul_f32 v[48:49], v[48:49], v[40:41]
    v_pk_mul_f32 v[50:51], v[50:51], v[42:43]
    v_pk_mul_f32 v[52:53], v[52:53], v[44:45]
    v_pk_mul_f32 v[54:55], v[54:55], v[46:47]
    v_exp_f32 v48, v48
    v_exp_f32 v49, v49
    v_exp_f32 v50, v50
    v_exp_f32 v51, v51
    v_exp_f32 v52, v52
    v_exp_f32 v53, v53
    v_exp_f32 v54, v54
    v_exp_f32 v55, v55
    v_pk_add_f32 v[48:49], v[48:49], v[244:245]
    v_pk_add_f32 v[50:51], v[50:51], v[244:245]
    v_pk_add_f32 v[52:53], v[52:53], v[244:245]
    v_pk_add_f32 v[54:55], v[54:55], v[244:245]
    v_rcp_f32 v48, v48
    v_rcp_f32 v49, v49
    v_rcp_f32 v50, v50
    v_rcp_f32 v51, v51
    v_rcp_f32 v52, v52
    v_rcp_f32 v53, v53
    v_rcp_f32 v54, v54
    v_rcp_f32 v55, v55
    v_pk_mul_f32 v[40:41], v[48:49], v[40:41]
    v_pk_mul_f32 v[42:43], v[50:51], v[42:43]
    v_pk_mul_f32 v[44:45], v[52:53], v[44:45]
    v_pk_mul_f32 v[46:47], v[54:55], v[46:47]
    v_cvt_pk_bf16_f32 v56, v40, v41
    v_cvt_pk_bf16_f32 v57, v42, v43
    v_cvt_pk_bf16_f32 v58, v44, v45
    v_cvt_pk_bf16_f32 v59, v46, v47
    buffer_store_dwordx4 v[56:59], v251, s[4:7], s53 offen offset:2048 sc1
    v_accvgpr_read_b32 v0, a120
    v_accvgpr_read_b32 v1, a121
    v_accvgpr_read_b32 v2, a122
    v_accvgpr_read_b32 v3, a123
    v_accvgpr_read_b32 v4, a124
    v_accvgpr_read_b32 v5, a125
    v_accvgpr_read_b32 v6, a126
    v_accvgpr_read_b32 v7, a127
    v_pk_mul_f32 v[8:9], v[0:1], v[0:1]
    v_pk_mul_f32 v[10:11], v[2:3], v[2:3]
    v_pk_mul_f32 v[12:13], v[4:5], v[4:5]
    v_pk_mul_f32 v[14:15], v[6:7], v[6:7]
    v_pk_fma_f32 v[8:9], v[8:9], v[242:243], v[240:241]
    v_pk_fma_f32 v[10:11], v[10:11], v[242:243], v[240:241]
    v_pk_fma_f32 v[12:13], v[12:13], v[242:243], v[240:241]
    v_pk_fma_f32 v[14:15], v[14:15], v[242:243], v[240:241]
    v_pk_mul_f32 v[8:9], v[8:9], v[0:1]
    v_pk_mul_f32 v[10:11], v[10:11], v[2:3]
    v_pk_mul_f32 v[12:13], v[12:13], v[4:5]
    v_pk_mul_f32 v[14:15], v[14:15], v[6:7]
    v_exp_f32 v8, v8
    v_exp_f32 v9, v9
    v_exp_f32 v10, v10
    v_exp_f32 v11, v11
    v_exp_f32 v12, v12
    v_exp_f32 v13, v13
    v_exp_f32 v14, v14
    v_exp_f32 v15, v15
    v_pk_add_f32 v[8:9], v[8:9], v[244:245]
    v_pk_add_f32 v[10:11], v[10:11], v[244:245]
    v_pk_add_f32 v[12:13], v[12:13], v[244:245]
    v_pk_add_f32 v[14:15], v[14:15], v[244:245]
    v_rcp_f32 v8, v8
    v_rcp_f32 v9, v9
    v_rcp_f32 v10, v10
    v_rcp_f32 v11, v11
    v_rcp_f32 v12, v12
    v_rcp_f32 v13, v13
    v_rcp_f32 v14, v14
    v_rcp_f32 v15, v15
    v_pk_mul_f32 v[0:1], v[8:9], v[0:1]
    v_pk_mul_f32 v[2:3], v[10:11], v[2:3]
    v_pk_mul_f32 v[4:5], v[12:13], v[4:5]
    v_pk_mul_f32 v[6:7], v[14:15], v[6:7]
    v_cvt_pk_bf16_f32 v16, v0, v1
    v_cvt_pk_bf16_f32 v17, v2, v3
    v_cvt_pk_bf16_f32 v18, v4, v5
    v_cvt_pk_bf16_f32 v19, v6, v7
    buffer_store_dwordx4 v[16:19], v251, s[4:7], s53 offen offset:3072 sc1
    s_branch main_kernel_w_done
main_kernel_w_c1_gov:
    v_lshrrev_b32 v0, 4, v250
    v_bfe_u32 v1, v250, 2, 2
    v_lshl_add_u32 v4, v0, 2, v1
    v_and_b32 v5, 7, v4
    v_mul_u32_u24 v4, 512, v4
    v_and_b32 v6, 3, v250
    v_lshl_add_u32 v4, v6, 3, v4
    s_mul_i32 s32, s37, 8
    v_xor_b32 v5, s32, v5
    v_lshl_add_u32 v128, v5, 5, v4
    v_xor_b32 v129, 32, v128
    v_xor_b32 v130, 64, v128
    v_xor_b32 v131, 96, v128
    v_xor_b32 v132, 128, v128
    v_xor_b32 v133, 160, v128
    v_xor_b32 v134, 192, v128
    v_xor_b32 v135, 224, v128
    s_mul_i32 s32, s38, 4096
    s_add_u32 s32, s32, 65536
    v_add_u32 v136, s32, v251
    v_lshrrev_b32 v2, 5, v250
    v_and_b32 v3, 31, v250
    s_mul_i32 s32, s14, 8
    v_add_u32 v4, s32, v2
    v_add_u32 v5, 0, v4
    v_and_b32 v6, 7, v5
    v_lshlrev_b32 v6, 1, v6
    v_xor_b32 v6, v6, v3
    v_mul_lo_u32 v5, v5, s30
    v_lshl_add_u32 v5, v6, 4, v5
    v_subrev_u32 v137, 0, v5
    v_add_u32 v5, 2, v4
    v_and_b32 v6, 7, v5
    v_lshlrev_b32 v6, 1, v6
    v_xor_b32 v6, v6, v3
    v_mul_lo_u32 v5, v5, s30
    v_lshl_add_u32 v5, v6, 4, v5
    v_subrev_u32 v138, 1024, v5
    v_add_u32 v5, 4, v4
    v_and_b32 v6, 7, v5
    v_lshlrev_b32 v6, 1, v6
    v_xor_b32 v6, v6, v3
    v_mul_lo_u32 v5, v5, s30
    v_lshl_add_u32 v5, v6, 4, v5
    v_subrev_u32 v139, 2048, v5
    v_add_u32 v5, 6, v4
    v_and_b32 v6, 7, v5
    v_lshlrev_b32 v6, 1, v6
    v_xor_b32 v6, v6, v3
    v_mul_lo_u32 v5, v5, s30
    v_lshl_add_u32 v5, v6, 4, v5
    v_subrev_u32 v140, 3072, v5
    s_mul_i32 s32, s14, 2
    s_mul_i32 s32, s32, s31
    v_add_u32 v141, s32, v251
    s_add_u32 s32, s32, s31
    s_sub_u32 s32, s32, 1024
    v_add_u32 v142, s32, v251
    s_mul_i32 s19, s14, 4096
    s_mul_i32 s20, s14, 2048
    s_add_u32 s20, s20, 65536
    s_mul_i32 s17, s30, 32
    s_mov_b32 s15, 0
    s_add_u32 m0, s20, 0
    s_nop 0
    buffer_load_dwordx4 v141, s[4:7], s16 offen offset:0 sc1 lds
    buffer_load_dwordx4 v142, s[4:7], s16 offen offset:1024 sc1 lds
    s_add_u32 s16, s16, 1024
    s_add_u32 m0, s19, 0
    s_nop 0
    buffer_load_dwordx4 v137, s[8:11], s15 offen offset:0 lds
    buffer_load_dwordx4 v138, s[8:11], s15 offen offset:1024 lds
    buffer_load_dwordx4 v139, s[8:11], s15 offen offset:2048 lds
    buffer_load_dwordx4 v140, s[8:11], s15 offen offset:3072 lds
    s_add_u32 s15, s15, s17
    s_add_u32 m0, s20, 8192
    s_nop 0
    buffer_load_dwordx4 v141, s[4:7], s16 offen offset:0 sc1 lds
    buffer_load_dwordx4 v142, s[4:7], s16 offen offset:1024 sc1 lds
    s_add_u32 s16, s16, 1024
    s_add_u32 m0, s19, 16384
    s_nop 0
    buffer_load_dwordx4 v137, s[8:11], s15 offen offset:0 lds
    buffer_load_dwordx4 v138, s[8:11], s15 offen offset:1024 lds
    buffer_load_dwordx4 v139, s[8:11], s15 offen offset:2048 lds
    buffer_load_dwordx4 v140, s[8:11], s15 offen offset:3072 lds
    s_add_u32 s15, s15, s17
    s_add_u32 m0, s20, 16384
    s_nop 0
    buffer_load_dwordx4 v141, s[4:7], s16 offen offset:0 sc1 lds
    buffer_load_dwordx4 v142, s[4:7], s16 offen offset:1024 sc1 lds
    s_add_u32 s16, s16, 1024
    s_add_u32 m0, s19, 32768
    s_nop 0
    buffer_load_dwordx4 v137, s[8:11], s15 offen offset:0 lds
    buffer_load_dwordx4 v138, s[8:11], s15 offen offset:1024 lds
    buffer_load_dwordx4 v139, s[8:11], s15 offen offset:2048 lds
    buffer_load_dwordx4 v140, s[8:11], s15 offen offset:3072 lds
    s_add_u32 s15, s15, s17
    s_add_u32 m0, s20, 24576
    s_nop 0
    buffer_load_dwordx4 v141, s[4:7], s16 offen offset:0 sc1 lds
    buffer_load_dwordx4 v142, s[4:7], s16 offen offset:1024 sc1 lds
    s_add_u32 s16, s16, 1024
    s_add_u32 m0, s19, 49152
    s_nop 0
    buffer_load_dwordx4 v137, s[8:11], s15 offen offset:0 lds
    buffer_load_dwordx4 v138, s[8:11], s15 offen offset:1024 lds
    buffer_load_dwordx4 v139, s[8:11], s15 offen offset:2048 lds
    buffer_load_dwordx4 v140, s[8:11], s15 offen offset:3072 lds
    s_add_u32 s15, s15, s17
    v_accvgpr_write_b32 a0, 0
    v_accvgpr_write_b32 a1, 0
    v_accvgpr_write_b32 a2, 0
    v_accvgpr_write_b32 a3, 0
    v_accvgpr_write_b32 a4, 0
    v_accvgpr_write_b32 a5, 0
    v_accvgpr_write_b32 a6, 0
    v_accvgpr_write_b32 a7, 0
    v_accvgpr_write_b32 a8, 0
    v_accvgpr_write_b32 a9, 0
    v_accvgpr_write_b32 a10, 0
    v_accvgpr_write_b32 a11, 0
    v_accvgpr_write_b32 a12, 0
    v_accvgpr_write_b32 a13, 0
    v_accvgpr_write_b32 a14, 0
    v_accvgpr_write_b32 a15, 0
    v_accvgpr_write_b32 a16, 0
    v_accvgpr_write_b32 a17, 0
    v_accvgpr_write_b32 a18, 0
    v_accvgpr_write_b32 a19, 0
    v_accvgpr_write_b32 a20, 0
    v_accvgpr_write_b32 a21, 0
    v_accvgpr_write_b32 a22, 0
    v_accvgpr_write_b32 a23, 0
    v_accvgpr_write_b32 a24, 0
    v_accvgpr_write_b32 a25, 0
    v_accvgpr_write_b32 a26, 0
    v_accvgpr_write_b32 a27, 0
    v_accvgpr_write_b32 a28, 0
    v_accvgpr_write_b32 a29, 0
    v_accvgpr_write_b32 a30, 0
    v_accvgpr_write_b32 a31, 0
    v_accvgpr_write_b32 a32, 0
    v_accvgpr_write_b32 a33, 0
    v_accvgpr_write_b32 a34, 0
    v_accvgpr_write_b32 a35, 0
    v_accvgpr_write_b32 a36, 0
    v_accvgpr_write_b32 a37, 0
    v_accvgpr_write_b32 a38, 0
    v_accvgpr_write_b32 a39, 0
    v_accvgpr_write_b32 a40, 0
    v_accvgpr_write_b32 a41, 0
    v_accvgpr_write_b32 a42, 0
    v_accvgpr_write_b32 a43, 0
    v_accvgpr_write_b32 a44, 0
    v_accvgpr_write_b32 a45, 0
    v_accvgpr_write_b32 a46, 0
    v_accvgpr_write_b32 a47, 0
    v_accvgpr_write_b32 a48, 0
    v_accvgpr_write_b32 a49, 0
    v_accvgpr_write_b32 a50, 0
    v_accvgpr_write_b32 a51, 0
    v_accvgpr_write_b32 a52, 0
    v_accvgpr_write_b32 a53, 0
    v_accvgpr_write_b32 a54, 0
    v_accvgpr_write_b32 a55, 0
    v_accvgpr_write_b32 a56, 0
    v_accvgpr_write_b32 a57, 0
    v_accvgpr_write_b32 a58, 0
    v_accvgpr_write_b32 a59, 0
    v_accvgpr_write_b32 a60, 0
    v_accvgpr_write_b32 a61, 0
    v_accvgpr_write_b32 a62, 0
    v_accvgpr_write_b32 a63, 0
    v_accvgpr_write_b32 a64, 0
    v_accvgpr_write_b32 a65, 0
    v_accvgpr_write_b32 a66, 0
    v_accvgpr_write_b32 a67, 0
    v_accvgpr_write_b32 a68, 0
    v_accvgpr_write_b32 a69, 0
    v_accvgpr_write_b32 a70, 0
    v_accvgpr_write_b32 a71, 0
    v_accvgpr_write_b32 a72, 0
    v_accvgpr_write_b32 a73, 0
    v_accvgpr_write_b32 a74, 0
    v_accvgpr_write_b32 a75, 0
    v_accvgpr_write_b32 a76, 0
    v_accvgpr_write_b32 a77, 0
    v_accvgpr_write_b32 a78, 0
    v_accvgpr_write_b32 a79, 0
    v_accvgpr_write_b32 a80, 0
    v_accvgpr_write_b32 a81, 0
    v_accvgpr_write_b32 a82, 0
    v_accvgpr_write_b32 a83, 0
    v_accvgpr_write_b32 a84, 0
    v_accvgpr_write_b32 a85, 0
    v_accvgpr_write_b32 a86, 0
    v_accvgpr_write_b32 a87, 0
    v_accvgpr_write_b32 a88, 0
    v_accvgpr_write_b32 a89, 0
    v_accvgpr_write_b32 a90, 0
    v_accvgpr_write_b32 a91, 0
    v_accvgpr_write_b32 a92, 0
    v_accvgpr_write_b32 a93, 0
    v_accvgpr_write_b32 a94, 0
    v_accvgpr_write_b32 a95, 0
    v_accvgpr_write_b32 a96, 0
    v_accvgpr_write_b32 a97, 0
    v_accvgpr_write_b32 a98, 0
    v_accvgpr_write_b32 a99, 0
    v_accvgpr_write_b32 a100, 0
    v_accvgpr_write_b32 a101, 0
    v_accvgpr_write_b32 a102, 0
    v_accvgpr_write_b32 a103, 0
    v_accvgpr_write_b32 a104, 0
    v_accvgpr_write_b32 a105, 0
    v_accvgpr_write_b32 a106, 0
    v_accvgpr_write_b32 a107, 0
    v_accvgpr_write_b32 a108, 0
    v_accvgpr_write_b32 a109, 0
    v_accvgpr_write_b32 a110, 0
    v_accvgpr_write_b32 a111, 0
    v_accvgpr_write_b32 a112, 0
    v_accvgpr_write_b32 a113, 0
    v_accvgpr_write_b32 a114, 0
    v_accvgpr_write_b32 a115, 0
    v_accvgpr_write_b32 a116, 0
    v_accvgpr_write_b32 a117, 0
    v_accvgpr_write_b32 a118, 0
    v_accvgpr_write_b32 a119, 0
    v_accvgpr_write_b32 a120, 0
    v_accvgpr_write_b32 a121, 0
    v_accvgpr_write_b32 a122, 0
    v_accvgpr_write_b32 a123, 0
    v_accvgpr_write_b32 a124, 0
    v_accvgpr_write_b32 a125, 0
    v_accvgpr_write_b32 a126, 0
    v_accvgpr_write_b32 a127, 0
    s_waitcnt vmcnt(18)
    s_barrier
    ds_read_b128 v[32:35], v136 offset:0
    ds_read_b64_tr_b16 v[0:1], v128 offset:0
    ds_read_b64_tr_b16 v[2:3], v128 offset:8192
    ds_read_b64_tr_b16 v[4:5], v129 offset:0
    ds_read_b64_tr_b16 v[6:7], v129 offset:8192
    ds_read_b64_tr_b16 v[8:9], v130 offset:0
    ds_read_b64_tr_b16 v[10:11], v130 offset:8192
    ds_read_b64_tr_b16 v[12:13], v131 offset:0
    ds_read_b64_tr_b16 v[14:15], v131 offset:8192
    ds_read_b64_tr_b16 v[16:17], v132 offset:0
    ds_read_b64_tr_b16 v[18:19], v132 offset:8192
    ds_read_b64_tr_b16 v[20:21], v133 offset:0
    ds_read_b64_tr_b16 v[22:23], v133 offset:8192
    ds_read_b64_tr_b16 v[24:25], v134 offset:0
    ds_read_b64_tr_b16 v[26:27], v134 offset:8192
    ds_read_b64_tr_b16 v[28:29], v135 offset:0
    ds_read_b64_tr_b16 v[30:31], v135 offset:8192
    ds_read_b128 v[36:39], v136 offset:1024
    ds_read_b128 v[40:43], v136 offset:2048
    ds_read_b128 v[44:47], v136 offset:3072
main_kernel_w_c1_v_loop:
    s_waitcnt lgkmcnt(0)
    v_mfma_f32_16x16x32_bf16 a[0:3], v[32:35], v[0:3], a[0:3]
    s_waitcnt vmcnt(12)
    s_barrier
    ds_read_b128 v[80:83], v136 offset:8192
    s_add_u32 m0, s20, 0
    s_nop 0
    v_mfma_f32_16x16x32_bf16 a[4:7], v[32:35], v[4:7], a[4:7]
    ds_read_b64_tr_b16 v[48:49], v128 offset:16384
    v_mfma_f32_16x16x32_bf16 a[8:11], v[32:35], v[8:11], a[8:11]
    ds_read_b64_tr_b16 v[50:51], v128 offset:24576
    v_mfma_f32_16x16x32_bf16 a[12:15], v[32:35], v[12:15], a[12:15]
    ds_read_b64_tr_b16 v[52:53], v129 offset:16384
    buffer_load_dwordx4 v141, s[4:7], s16 offen offset:0 sc1 lds
    v_mfma_f32_16x16x32_bf16 a[16:19], v[32:35], v[16:19], a[16:19]
    ds_read_b64_tr_b16 v[54:55], v129 offset:24576
    v_mfma_f32_16x16x32_bf16 a[20:23], v[32:35], v[20:23], a[20:23]
    ds_read_b64_tr_b16 v[56:57], v130 offset:16384
    v_mfma_f32_16x16x32_bf16 a[24:27], v[32:35], v[24:27], a[24:27]
    ds_read_b64_tr_b16 v[58:59], v130 offset:24576
    buffer_load_dwordx4 v142, s[4:7], s16 offen offset:1024 sc1 lds
    v_mfma_f32_16x16x32_bf16 a[28:31], v[32:35], v[28:31], a[28:31]
    ds_read_b64_tr_b16 v[60:61], v131 offset:16384
    v_mfma_f32_16x16x32_bf16 a[32:35], v[36:39], v[0:3], a[32:35]
    ds_read_b64_tr_b16 v[62:63], v131 offset:24576
    v_mfma_f32_16x16x32_bf16 a[36:39], v[36:39], v[4:7], a[36:39]
    ds_read_b64_tr_b16 v[64:65], v132 offset:16384
    s_add_u32 s16, s16, 1024
    v_mfma_f32_16x16x32_bf16 a[40:43], v[36:39], v[8:11], a[40:43]
    ds_read_b64_tr_b16 v[66:67], v132 offset:24576
    v_mfma_f32_16x16x32_bf16 a[44:47], v[36:39], v[12:15], a[44:47]
    ds_read_b64_tr_b16 v[68:69], v133 offset:16384
    v_mfma_f32_16x16x32_bf16 a[48:51], v[36:39], v[16:19], a[48:51]
    ds_read_b64_tr_b16 v[70:71], v133 offset:24576
    s_add_u32 m0, s19, 0
    s_nop 0
    v_mfma_f32_16x16x32_bf16 a[52:55], v[36:39], v[20:23], a[52:55]
    ds_read_b64_tr_b16 v[72:73], v134 offset:16384
    v_mfma_f32_16x16x32_bf16 a[56:59], v[36:39], v[24:27], a[56:59]
    ds_read_b64_tr_b16 v[74:75], v134 offset:24576
    v_mfma_f32_16x16x32_bf16 a[60:63], v[36:39], v[28:31], a[60:63]
    ds_read_b64_tr_b16 v[76:77], v135 offset:16384
    buffer_load_dwordx4 v137, s[8:11], s15 offen offset:0 lds
    v_mfma_f32_16x16x32_bf16 a[64:67], v[40:43], v[0:3], a[64:67]
    ds_read_b64_tr_b16 v[78:79], v135 offset:24576
    v_mfma_f32_16x16x32_bf16 a[68:71], v[40:43], v[4:7], a[68:71]
    ds_read_b128 v[84:87], v136 offset:9216
    v_mfma_f32_16x16x32_bf16 a[72:75], v[40:43], v[8:11], a[72:75]
    ds_read_b128 v[88:91], v136 offset:10240
    buffer_load_dwordx4 v138, s[8:11], s15 offen offset:1024 lds
    v_mfma_f32_16x16x32_bf16 a[76:79], v[40:43], v[12:15], a[76:79]
    ds_read_b128 v[92:95], v136 offset:11264
    v_mfma_f32_16x16x32_bf16 a[80:83], v[40:43], v[16:19], a[80:83]
    v_mfma_f32_16x16x32_bf16 a[84:87], v[40:43], v[20:23], a[84:87]
    buffer_load_dwordx4 v139, s[8:11], s15 offen offset:2048 lds
    v_mfma_f32_16x16x32_bf16 a[88:91], v[40:43], v[24:27], a[88:91]
    v_mfma_f32_16x16x32_bf16 a[92:95], v[40:43], v[28:31], a[92:95]
    v_mfma_f32_16x16x32_bf16 a[96:99], v[44:47], v[0:3], a[96:99]
    buffer_load_dwordx4 v140, s[8:11], s15 offen offset:3072 lds
    v_mfma_f32_16x16x32_bf16 a[100:103], v[44:47], v[4:7], a[100:103]
    v_mfma_f32_16x16x32_bf16 a[104:107], v[44:47], v[8:11], a[104:107]
    v_mfma_f32_16x16x32_bf16 a[108:111], v[44:47], v[12:15], a[108:111]
    s_add_u32 s15, s15, s17
    v_mfma_f32_16x16x32_bf16 a[112:115], v[44:47], v[16:19], a[112:115]
    v_mfma_f32_16x16x32_bf16 a[116:119], v[44:47], v[20:23], a[116:119]
    v_mfma_f32_16x16x32_bf16 a[120:123], v[44:47], v[24:27], a[120:123]
    v_mfma_f32_16x16x32_bf16 a[124:127], v[44:47], v[28:31], a[124:127]
    s_waitcnt lgkmcnt(0)
    v_mfma_f32_16x16x32_bf16 a[0:3], v[80:83], v[48:51], a[0:3]
    s_waitcnt vmcnt(12)
    s_barrier
    ds_read_b128 v[32:35], v136 offset:16384
    s_add_u32 m0, s20, 8192
    s_nop 0
    v_mfma_f32_16x16x32_bf16 a[4:7], v[80:83], v[52:55], a[4:7]
    ds_read_b64_tr_b16 v[0:1], v128 offset:32768
    v_mfma_f32_16x16x32_bf16 a[8:11], v[80:83], v[56:59], a[8:11]
    ds_read_b64_tr_b16 v[2:3], v128 offset:40960
    v_mfma_f32_16x16x32_bf16 a[12:15], v[80:83], v[60:63], a[12:15]
    ds_read_b64_tr_b16 v[4:5], v129 offset:32768
    buffer_load_dwordx4 v141, s[4:7], s16 offen offset:0 sc1 lds
    v_mfma_f32_16x16x32_bf16 a[16:19], v[80:83], v[64:67], a[16:19]
    ds_read_b64_tr_b16 v[6:7], v129 offset:40960
    v_mfma_f32_16x16x32_bf16 a[20:23], v[80:83], v[68:71], a[20:23]
    ds_read_b64_tr_b16 v[8:9], v130 offset:32768
    v_mfma_f32_16x16x32_bf16 a[24:27], v[80:83], v[72:75], a[24:27]
    ds_read_b64_tr_b16 v[10:11], v130 offset:40960
    buffer_load_dwordx4 v142, s[4:7], s16 offen offset:1024 sc1 lds
    v_mfma_f32_16x16x32_bf16 a[28:31], v[80:83], v[76:79], a[28:31]
    ds_read_b64_tr_b16 v[12:13], v131 offset:32768
    v_mfma_f32_16x16x32_bf16 a[32:35], v[84:87], v[48:51], a[32:35]
    ds_read_b64_tr_b16 v[14:15], v131 offset:40960
    v_mfma_f32_16x16x32_bf16 a[36:39], v[84:87], v[52:55], a[36:39]
    ds_read_b64_tr_b16 v[16:17], v132 offset:32768
    s_add_u32 s16, s16, 1024
    v_mfma_f32_16x16x32_bf16 a[40:43], v[84:87], v[56:59], a[40:43]
    ds_read_b64_tr_b16 v[18:19], v132 offset:40960
    v_mfma_f32_16x16x32_bf16 a[44:47], v[84:87], v[60:63], a[44:47]
    ds_read_b64_tr_b16 v[20:21], v133 offset:32768
    v_mfma_f32_16x16x32_bf16 a[48:51], v[84:87], v[64:67], a[48:51]
    ds_read_b64_tr_b16 v[22:23], v133 offset:40960
    s_add_u32 m0, s19, 16384
    s_nop 0
    v_mfma_f32_16x16x32_bf16 a[52:55], v[84:87], v[68:71], a[52:55]
    ds_read_b64_tr_b16 v[24:25], v134 offset:32768
    v_mfma_f32_16x16x32_bf16 a[56:59], v[84:87], v[72:75], a[56:59]
    ds_read_b64_tr_b16 v[26:27], v134 offset:40960
    v_mfma_f32_16x16x32_bf16 a[60:63], v[84:87], v[76:79], a[60:63]
    ds_read_b64_tr_b16 v[28:29], v135 offset:32768
    buffer_load_dwordx4 v137, s[8:11], s15 offen offset:0 lds
    v_mfma_f32_16x16x32_bf16 a[64:67], v[88:91], v[48:51], a[64:67]
    ds_read_b64_tr_b16 v[30:31], v135 offset:40960
    v_mfma_f32_16x16x32_bf16 a[68:71], v[88:91], v[52:55], a[68:71]
    ds_read_b128 v[36:39], v136 offset:17408
    v_mfma_f32_16x16x32_bf16 a[72:75], v[88:91], v[56:59], a[72:75]
    ds_read_b128 v[40:43], v136 offset:18432
    buffer_load_dwordx4 v138, s[8:11], s15 offen offset:1024 lds
    v_mfma_f32_16x16x32_bf16 a[76:79], v[88:91], v[60:63], a[76:79]
    ds_read_b128 v[44:47], v136 offset:19456
    v_mfma_f32_16x16x32_bf16 a[80:83], v[88:91], v[64:67], a[80:83]
    v_mfma_f32_16x16x32_bf16 a[84:87], v[88:91], v[68:71], a[84:87]
    buffer_load_dwordx4 v139, s[8:11], s15 offen offset:2048 lds
    v_mfma_f32_16x16x32_bf16 a[88:91], v[88:91], v[72:75], a[88:91]
    v_mfma_f32_16x16x32_bf16 a[92:95], v[88:91], v[76:79], a[92:95]
    v_mfma_f32_16x16x32_bf16 a[96:99], v[92:95], v[48:51], a[96:99]
    buffer_load_dwordx4 v140, s[8:11], s15 offen offset:3072 lds
    v_mfma_f32_16x16x32_bf16 a[100:103], v[92:95], v[52:55], a[100:103]
    v_mfma_f32_16x16x32_bf16 a[104:107], v[92:95], v[56:59], a[104:107]
    v_mfma_f32_16x16x32_bf16 a[108:111], v[92:95], v[60:63], a[108:111]
    s_add_u32 s15, s15, s17
    v_mfma_f32_16x16x32_bf16 a[112:115], v[92:95], v[64:67], a[112:115]
    v_mfma_f32_16x16x32_bf16 a[116:119], v[92:95], v[68:71], a[116:119]
    v_mfma_f32_16x16x32_bf16 a[120:123], v[92:95], v[72:75], a[120:123]
    v_mfma_f32_16x16x32_bf16 a[124:127], v[92:95], v[76:79], a[124:127]
    s_waitcnt lgkmcnt(0)
    v_mfma_f32_16x16x32_bf16 a[0:3], v[32:35], v[0:3], a[0:3]
    s_waitcnt vmcnt(12)
    s_barrier
    ds_read_b128 v[80:83], v136 offset:24576
    s_add_u32 m0, s20, 16384
    s_nop 0
    v_mfma_f32_16x16x32_bf16 a[4:7], v[32:35], v[4:7], a[4:7]
    ds_read_b64_tr_b16 v[48:49], v128 offset:49152
    v_mfma_f32_16x16x32_bf16 a[8:11], v[32:35], v[8:11], a[8:11]
    ds_read_b64_tr_b16 v[50:51], v128 offset:57344
    v_mfma_f32_16x16x32_bf16 a[12:15], v[32:35], v[12:15], a[12:15]
    ds_read_b64_tr_b16 v[52:53], v129 offset:49152
    buffer_load_dwordx4 v141, s[4:7], s16 offen offset:0 sc1 lds
    v_mfma_f32_16x16x32_bf16 a[16:19], v[32:35], v[16:19], a[16:19]
    ds_read_b64_tr_b16 v[54:55], v129 offset:57344
    v_mfma_f32_16x16x32_bf16 a[20:23], v[32:35], v[20:23], a[20:23]
    ds_read_b64_tr_b16 v[56:57], v130 offset:49152
    v_mfma_f32_16x16x32_bf16 a[24:27], v[32:35], v[24:27], a[24:27]
    ds_read_b64_tr_b16 v[58:59], v130 offset:57344
    buffer_load_dwordx4 v142, s[4:7], s16 offen offset:1024 sc1 lds
    v_mfma_f32_16x16x32_bf16 a[28:31], v[32:35], v[28:31], a[28:31]
    ds_read_b64_tr_b16 v[60:61], v131 offset:49152
    v_mfma_f32_16x16x32_bf16 a[32:35], v[36:39], v[0:3], a[32:35]
    ds_read_b64_tr_b16 v[62:63], v131 offset:57344
    v_mfma_f32_16x16x32_bf16 a[36:39], v[36:39], v[4:7], a[36:39]
    ds_read_b64_tr_b16 v[64:65], v132 offset:49152
    s_add_u32 s16, s16, 1024
    v_mfma_f32_16x16x32_bf16 a[40:43], v[36:39], v[8:11], a[40:43]
    ds_read_b64_tr_b16 v[66:67], v132 offset:57344
    v_mfma_f32_16x16x32_bf16 a[44:47], v[36:39], v[12:15], a[44:47]
    ds_read_b64_tr_b16 v[68:69], v133 offset:49152
    v_mfma_f32_16x16x32_bf16 a[48:51], v[36:39], v[16:19], a[48:51]
    ds_read_b64_tr_b16 v[70:71], v133 offset:57344
    s_add_u32 m0, s19, 32768
    s_nop 0
    v_mfma_f32_16x16x32_bf16 a[52:55], v[36:39], v[20:23], a[52:55]
    ds_read_b64_tr_b16 v[72:73], v134 offset:49152
    v_mfma_f32_16x16x32_bf16 a[56:59], v[36:39], v[24:27], a[56:59]
    ds_read_b64_tr_b16 v[74:75], v134 offset:57344
    v_mfma_f32_16x16x32_bf16 a[60:63], v[36:39], v[28:31], a[60:63]
    ds_read_b64_tr_b16 v[76:77], v135 offset:49152
    buffer_load_dwordx4 v137, s[8:11], s15 offen offset:0 lds
    v_mfma_f32_16x16x32_bf16 a[64:67], v[40:43], v[0:3], a[64:67]
    ds_read_b64_tr_b16 v[78:79], v135 offset:57344
    v_mfma_f32_16x16x32_bf16 a[68:71], v[40:43], v[4:7], a[68:71]
    ds_read_b128 v[84:87], v136 offset:25600
    v_mfma_f32_16x16x32_bf16 a[72:75], v[40:43], v[8:11], a[72:75]
    ds_read_b128 v[88:91], v136 offset:26624
    buffer_load_dwordx4 v138, s[8:11], s15 offen offset:1024 lds
    v_mfma_f32_16x16x32_bf16 a[76:79], v[40:43], v[12:15], a[76:79]
    ds_read_b128 v[92:95], v136 offset:27648
    v_mfma_f32_16x16x32_bf16 a[80:83], v[40:43], v[16:19], a[80:83]
    v_mfma_f32_16x16x32_bf16 a[84:87], v[40:43], v[20:23], a[84:87]
    buffer_load_dwordx4 v139, s[8:11], s15 offen offset:2048 lds
    v_mfma_f32_16x16x32_bf16 a[88:91], v[40:43], v[24:27], a[88:91]
    v_mfma_f32_16x16x32_bf16 a[92:95], v[40:43], v[28:31], a[92:95]
    v_mfma_f32_16x16x32_bf16 a[96:99], v[44:47], v[0:3], a[96:99]
    buffer_load_dwordx4 v140, s[8:11], s15 offen offset:3072 lds
    v_mfma_f32_16x16x32_bf16 a[100:103], v[44:47], v[4:7], a[100:103]
    v_mfma_f32_16x16x32_bf16 a[104:107], v[44:47], v[8:11], a[104:107]
    v_mfma_f32_16x16x32_bf16 a[108:111], v[44:47], v[12:15], a[108:111]
    s_add_u32 s15, s15, s17
    v_mfma_f32_16x16x32_bf16 a[112:115], v[44:47], v[16:19], a[112:115]
    v_mfma_f32_16x16x32_bf16 a[116:119], v[44:47], v[20:23], a[116:119]
    v_mfma_f32_16x16x32_bf16 a[120:123], v[44:47], v[24:27], a[120:123]
    v_mfma_f32_16x16x32_bf16 a[124:127], v[44:47], v[28:31], a[124:127]
    s_waitcnt lgkmcnt(0)
    v_mfma_f32_16x16x32_bf16 a[0:3], v[80:83], v[48:51], a[0:3]
    s_waitcnt vmcnt(12)
    s_barrier
    ds_read_b128 v[32:35], v136 offset:0
    s_add_u32 m0, s20, 24576
    s_nop 0
    v_mfma_f32_16x16x32_bf16 a[4:7], v[80:83], v[52:55], a[4:7]
    ds_read_b64_tr_b16 v[0:1], v128 offset:0
    v_mfma_f32_16x16x32_bf16 a[8:11], v[80:83], v[56:59], a[8:11]
    ds_read_b64_tr_b16 v[2:3], v128 offset:8192
    v_mfma_f32_16x16x32_bf16 a[12:15], v[80:83], v[60:63], a[12:15]
    ds_read_b64_tr_b16 v[4:5], v129 offset:0
    buffer_load_dwordx4 v141, s[4:7], s16 offen offset:0 sc1 lds
    v_mfma_f32_16x16x32_bf16 a[16:19], v[80:83], v[64:67], a[16:19]
    ds_read_b64_tr_b16 v[6:7], v129 offset:8192
    v_mfma_f32_16x16x32_bf16 a[20:23], v[80:83], v[68:71], a[20:23]
    ds_read_b64_tr_b16 v[8:9], v130 offset:0
    v_mfma_f32_16x16x32_bf16 a[24:27], v[80:83], v[72:75], a[24:27]
    ds_read_b64_tr_b16 v[10:11], v130 offset:8192
    buffer_load_dwordx4 v142, s[4:7], s16 offen offset:1024 sc1 lds
    v_mfma_f32_16x16x32_bf16 a[28:31], v[80:83], v[76:79], a[28:31]
    ds_read_b64_tr_b16 v[12:13], v131 offset:0
    v_mfma_f32_16x16x32_bf16 a[32:35], v[84:87], v[48:51], a[32:35]
    ds_read_b64_tr_b16 v[14:15], v131 offset:8192
    v_mfma_f32_16x16x32_bf16 a[36:39], v[84:87], v[52:55], a[36:39]
    ds_read_b64_tr_b16 v[16:17], v132 offset:0
    s_add_u32 s16, s16, 1024
    v_mfma_f32_16x16x32_bf16 a[40:43], v[84:87], v[56:59], a[40:43]
    ds_read_b64_tr_b16 v[18:19], v132 offset:8192
    v_mfma_f32_16x16x32_bf16 a[44:47], v[84:87], v[60:63], a[44:47]
    ds_read_b64_tr_b16 v[20:21], v133 offset:0
    v_mfma_f32_16x16x32_bf16 a[48:51], v[84:87], v[64:67], a[48:51]
    ds_read_b64_tr_b16 v[22:23], v133 offset:8192
    s_add_u32 m0, s19, 49152
    s_nop 0
    v_mfma_f32_16x16x32_bf16 a[52:55], v[84:87], v[68:71], a[52:55]
    ds_read_b64_tr_b16 v[24:25], v134 offset:0
    v_mfma_f32_16x16x32_bf16 a[56:59], v[84:87], v[72:75], a[56:59]
    ds_read_b64_tr_b16 v[26:27], v134 offset:8192
    v_mfma_f32_16x16x32_bf16 a[60:63], v[84:87], v[76:79], a[60:63]
    ds_read_b64_tr_b16 v[28:29], v135 offset:0
    buffer_load_dwordx4 v137, s[8:11], s15 offen offset:0 lds
    v_mfma_f32_16x16x32_bf16 a[64:67], v[88:91], v[48:51], a[64:67]
    ds_read_b64_tr_b16 v[30:31], v135 offset:8192
    v_mfma_f32_16x16x32_bf16 a[68:71], v[88:91], v[52:55], a[68:71]
    ds_read_b128 v[36:39], v136 offset:1024
    v_mfma_f32_16x16x32_bf16 a[72:75], v[88:91], v[56:59], a[72:75]
    ds_read_b128 v[40:43], v136 offset:2048
    buffer_load_dwordx4 v138, s[8:11], s15 offen offset:1024 lds
    v_mfma_f32_16x16x32_bf16 a[76:79], v[88:91], v[60:63], a[76:79]
    ds_read_b128 v[44:47], v136 offset:3072
    v_mfma_f32_16x16x32_bf16 a[80:83], v[88:91], v[64:67], a[80:83]
    v_mfma_f32_16x16x32_bf16 a[84:87], v[88:91], v[68:71], a[84:87]
    buffer_load_dwordx4 v139, s[8:11], s15 offen offset:2048 lds
    v_mfma_f32_16x16x32_bf16 a[88:91], v[88:91], v[72:75], a[88:91]
    v_mfma_f32_16x16x32_bf16 a[92:95], v[88:91], v[76:79], a[92:95]
    v_mfma_f32_16x16x32_bf16 a[96:99], v[92:95], v[48:51], a[96:99]
    buffer_load_dwordx4 v140, s[8:11], s15 offen offset:3072 lds
    v_mfma_f32_16x16x32_bf16 a[100:103], v[92:95], v[52:55], a[100:103]
    v_mfma_f32_16x16x32_bf16 a[104:107], v[92:95], v[56:59], a[104:107]
    v_mfma_f32_16x16x32_bf16 a[108:111], v[92:95], v[60:63], a[108:111]
    s_add_u32 s15, s15, s17
    v_mfma_f32_16x16x32_bf16 a[112:115], v[92:95], v[64:67], a[112:115]
    v_mfma_f32_16x16x32_bf16 a[116:119], v[92:95], v[68:71], a[116:119]
    v_mfma_f32_16x16x32_bf16 a[120:123], v[92:95], v[72:75], a[120:123]
    v_mfma_f32_16x16x32_bf16 a[124:127], v[92:95], v[76:79], a[124:127]
    s_sub_u32 s18, s18, 1
    s_cmp_lg_u32 s18, 0
    s_cbranch_scc1 main_kernel_w_c1_v_loop
    s_cmp_lg_u32 s14, 0
    s_cbranch_scc1 main_kernel_w_c1_v_nt
    s_lshl_b32 s32, s27, 8
    s_add_u32 s32, s32, 0x841e000
    v_mov_b32 v255, 1
    s_mov_b64 exec, 1
    buffer_atomic_add v255, off, s[4:7], s32 sc0 sc1
    s_mov_b64 exec, -1
main_kernel_w_c1_v_nt:
    s_waitcnt lgkmcnt(0)
    v_mfma_f32_16x16x32_bf16 a[0:3], v[32:35], v[0:3], a[0:3]
    s_waitcnt vmcnt(12)
    s_barrier
    ds_read_b128 v[80:83], v136 offset:8192
    v_mfma_f32_16x16x32_bf16 a[4:7], v[32:35], v[4:7], a[4:7]
    ds_read_b64_tr_b16 v[48:49], v128 offset:16384
    v_mfma_f32_16x16x32_bf16 a[8:11], v[32:35], v[8:11], a[8:11]
    ds_read_b64_tr_b16 v[50:51], v128 offset:24576
    v_mfma_f32_16x16x32_bf16 a[12:15], v[32:35], v[12:15], a[12:15]
    ds_read_b64_tr_b16 v[52:53], v129 offset:16384
    v_mfma_f32_16x16x32_bf16 a[16:19], v[32:35], v[16:19], a[16:19]
    ds_read_b64_tr_b16 v[54:55], v129 offset:24576
    v_mfma_f32_16x16x32_bf16 a[20:23], v[32:35], v[20:23], a[20:23]
    ds_read_b64_tr_b16 v[56:57], v130 offset:16384
    v_mfma_f32_16x16x32_bf16 a[24:27], v[32:35], v[24:27], a[24:27]
    ds_read_b64_tr_b16 v[58:59], v130 offset:24576
    v_mfma_f32_16x16x32_bf16 a[28:31], v[32:35], v[28:31], a[28:31]
    ds_read_b64_tr_b16 v[60:61], v131 offset:16384
    v_mfma_f32_16x16x32_bf16 a[32:35], v[36:39], v[0:3], a[32:35]
    ds_read_b64_tr_b16 v[62:63], v131 offset:24576
    v_mfma_f32_16x16x32_bf16 a[36:39], v[36:39], v[4:7], a[36:39]
    ds_read_b64_tr_b16 v[64:65], v132 offset:16384
    v_mfma_f32_16x16x32_bf16 a[40:43], v[36:39], v[8:11], a[40:43]
    ds_read_b64_tr_b16 v[66:67], v132 offset:24576
    v_mfma_f32_16x16x32_bf16 a[44:47], v[36:39], v[12:15], a[44:47]
    ds_read_b64_tr_b16 v[68:69], v133 offset:16384
    v_mfma_f32_16x16x32_bf16 a[48:51], v[36:39], v[16:19], a[48:51]
    ds_read_b64_tr_b16 v[70:71], v133 offset:24576
    v_mfma_f32_16x16x32_bf16 a[52:55], v[36:39], v[20:23], a[52:55]
    ds_read_b64_tr_b16 v[72:73], v134 offset:16384
    v_mfma_f32_16x16x32_bf16 a[56:59], v[36:39], v[24:27], a[56:59]
    ds_read_b64_tr_b16 v[74:75], v134 offset:24576
    v_mfma_f32_16x16x32_bf16 a[60:63], v[36:39], v[28:31], a[60:63]
    ds_read_b64_tr_b16 v[76:77], v135 offset:16384
    v_mfma_f32_16x16x32_bf16 a[64:67], v[40:43], v[0:3], a[64:67]
    ds_read_b64_tr_b16 v[78:79], v135 offset:24576
    v_mfma_f32_16x16x32_bf16 a[68:71], v[40:43], v[4:7], a[68:71]
    ds_read_b128 v[84:87], v136 offset:9216
    v_mfma_f32_16x16x32_bf16 a[72:75], v[40:43], v[8:11], a[72:75]
    ds_read_b128 v[88:91], v136 offset:10240
    v_mfma_f32_16x16x32_bf16 a[76:79], v[40:43], v[12:15], a[76:79]
    ds_read_b128 v[92:95], v136 offset:11264
    v_mfma_f32_16x16x32_bf16 a[80:83], v[40:43], v[16:19], a[80:83]
    v_mfma_f32_16x16x32_bf16 a[84:87], v[40:43], v[20:23], a[84:87]
    v_mfma_f32_16x16x32_bf16 a[88:91], v[40:43], v[24:27], a[88:91]
    v_mfma_f32_16x16x32_bf16 a[92:95], v[40:43], v[28:31], a[92:95]
    v_mfma_f32_16x16x32_bf16 a[96:99], v[44:47], v[0:3], a[96:99]
    v_mfma_f32_16x16x32_bf16 a[100:103], v[44:47], v[4:7], a[100:103]
    v_mfma_f32_16x16x32_bf16 a[104:107], v[44:47], v[8:11], a[104:107]
    v_mfma_f32_16x16x32_bf16 a[108:111], v[44:47], v[12:15], a[108:111]
    v_mfma_f32_16x16x32_bf16 a[112:115], v[44:47], v[16:19], a[112:115]
    v_mfma_f32_16x16x32_bf16 a[116:119], v[44:47], v[20:23], a[116:119]
    v_mfma_f32_16x16x32_bf16 a[120:123], v[44:47], v[24:27], a[120:123]
    v_mfma_f32_16x16x32_bf16 a[124:127], v[44:47], v[28:31], a[124:127]
    s_waitcnt lgkmcnt(0)
    v_mfma_f32_16x16x32_bf16 a[0:3], v[80:83], v[48:51], a[0:3]
    s_waitcnt vmcnt(6)
    s_barrier
    ds_read_b128 v[32:35], v136 offset:16384
    v_mfma_f32_16x16x32_bf16 a[4:7], v[80:83], v[52:55], a[4:7]
    ds_read_b64_tr_b16 v[0:1], v128 offset:32768
    v_mfma_f32_16x16x32_bf16 a[8:11], v[80:83], v[56:59], a[8:11]
    ds_read_b64_tr_b16 v[2:3], v128 offset:40960
    v_mfma_f32_16x16x32_bf16 a[12:15], v[80:83], v[60:63], a[12:15]
    ds_read_b64_tr_b16 v[4:5], v129 offset:32768
    v_mfma_f32_16x16x32_bf16 a[16:19], v[80:83], v[64:67], a[16:19]
    ds_read_b64_tr_b16 v[6:7], v129 offset:40960
    v_mfma_f32_16x16x32_bf16 a[20:23], v[80:83], v[68:71], a[20:23]
    ds_read_b64_tr_b16 v[8:9], v130 offset:32768
    v_mfma_f32_16x16x32_bf16 a[24:27], v[80:83], v[72:75], a[24:27]
    ds_read_b64_tr_b16 v[10:11], v130 offset:40960
    v_mfma_f32_16x16x32_bf16 a[28:31], v[80:83], v[76:79], a[28:31]
    ds_read_b64_tr_b16 v[12:13], v131 offset:32768
    v_mfma_f32_16x16x32_bf16 a[32:35], v[84:87], v[48:51], a[32:35]
    ds_read_b64_tr_b16 v[14:15], v131 offset:40960
    v_mfma_f32_16x16x32_bf16 a[36:39], v[84:87], v[52:55], a[36:39]
    ds_read_b64_tr_b16 v[16:17], v132 offset:32768
    v_mfma_f32_16x16x32_bf16 a[40:43], v[84:87], v[56:59], a[40:43]
    ds_read_b64_tr_b16 v[18:19], v132 offset:40960
    v_mfma_f32_16x16x32_bf16 a[44:47], v[84:87], v[60:63], a[44:47]
    ds_read_b64_tr_b16 v[20:21], v133 offset:32768
    v_mfma_f32_16x16x32_bf16 a[48:51], v[84:87], v[64:67], a[48:51]
    ds_read_b64_tr_b16 v[22:23], v133 offset:40960
    v_mfma_f32_16x16x32_bf16 a[52:55], v[84:87], v[68:71], a[52:55]
    ds_read_b64_tr_b16 v[24:25], v134 offset:32768
    v_mfma_f32_16x16x32_bf16 a[56:59], v[84:87], v[72:75], a[56:59]
    ds_read_b64_tr_b16 v[26:27], v134 offset:40960
    v_mfma_f32_16x16x32_bf16 a[60:63], v[84:87], v[76:79], a[60:63]
    ds_read_b64_tr_b16 v[28:29], v135 offset:32768
    v_mfma_f32_16x16x32_bf16 a[64:67], v[88:91], v[48:51], a[64:67]
    ds_read_b64_tr_b16 v[30:31], v135 offset:40960
    v_mfma_f32_16x16x32_bf16 a[68:71], v[88:91], v[52:55], a[68:71]
    ds_read_b128 v[36:39], v136 offset:17408
    v_mfma_f32_16x16x32_bf16 a[72:75], v[88:91], v[56:59], a[72:75]
    ds_read_b128 v[40:43], v136 offset:18432
    v_mfma_f32_16x16x32_bf16 a[76:79], v[88:91], v[60:63], a[76:79]
    ds_read_b128 v[44:47], v136 offset:19456
    v_mfma_f32_16x16x32_bf16 a[80:83], v[88:91], v[64:67], a[80:83]
    v_mfma_f32_16x16x32_bf16 a[84:87], v[88:91], v[68:71], a[84:87]
    v_mfma_f32_16x16x32_bf16 a[88:91], v[88:91], v[72:75], a[88:91]
    v_mfma_f32_16x16x32_bf16 a[92:95], v[88:91], v[76:79], a[92:95]
    v_mfma_f32_16x16x32_bf16 a[96:99], v[92:95], v[48:51], a[96:99]
    v_mfma_f32_16x16x32_bf16 a[100:103], v[92:95], v[52:55], a[100:103]
    v_mfma_f32_16x16x32_bf16 a[104:107], v[92:95], v[56:59], a[104:107]
    v_mfma_f32_16x16x32_bf16 a[108:111], v[92:95], v[60:63], a[108:111]
    v_mfma_f32_16x16x32_bf16 a[112:115], v[92:95], v[64:67], a[112:115]
    v_mfma_f32_16x16x32_bf16 a[116:119], v[92:95], v[68:71], a[116:119]
    v_mfma_f32_16x16x32_bf16 a[120:123], v[92:95], v[72:75], a[120:123]
    v_mfma_f32_16x16x32_bf16 a[124:127], v[92:95], v[76:79], a[124:127]
    s_waitcnt lgkmcnt(0)
    v_mfma_f32_16x16x32_bf16 a[0:3], v[32:35], v[0:3], a[0:3]
    s_waitcnt vmcnt(0)
    s_barrier
    ds_read_b128 v[80:83], v136 offset:24576
    v_mfma_f32_16x16x32_bf16 a[4:7], v[32:35], v[4:7], a[4:7]
    ds_read_b64_tr_b16 v[48:49], v128 offset:49152
    v_mfma_f32_16x16x32_bf16 a[8:11], v[32:35], v[8:11], a[8:11]
    ds_read_b64_tr_b16 v[50:51], v128 offset:57344
    v_mfma_f32_16x16x32_bf16 a[12:15], v[32:35], v[12:15], a[12:15]
    ds_read_b64_tr_b16 v[52:53], v129 offset:49152
    v_mfma_f32_16x16x32_bf16 a[16:19], v[32:35], v[16:19], a[16:19]
    ds_read_b64_tr_b16 v[54:55], v129 offset:57344
    v_mfma_f32_16x16x32_bf16 a[20:23], v[32:35], v[20:23], a[20:23]
    ds_read_b64_tr_b16 v[56:57], v130 offset:49152
    v_mfma_f32_16x16x32_bf16 a[24:27], v[32:35], v[24:27], a[24:27]
    ds_read_b64_tr_b16 v[58:59], v130 offset:57344
    v_mfma_f32_16x16x32_bf16 a[28:31], v[32:35], v[28:31], a[28:31]
    ds_read_b64_tr_b16 v[60:61], v131 offset:49152
    v_mfma_f32_16x16x32_bf16 a[32:35], v[36:39], v[0:3], a[32:35]
    ds_read_b64_tr_b16 v[62:63], v131 offset:57344
    v_mfma_f32_16x16x32_bf16 a[36:39], v[36:39], v[4:7], a[36:39]
    ds_read_b64_tr_b16 v[64:65], v132 offset:49152
    v_mfma_f32_16x16x32_bf16 a[40:43], v[36:39], v[8:11], a[40:43]
    ds_read_b64_tr_b16 v[66:67], v132 offset:57344
    v_mfma_f32_16x16x32_bf16 a[44:47], v[36:39], v[12:15], a[44:47]
    ds_read_b64_tr_b16 v[68:69], v133 offset:49152
    v_mfma_f32_16x16x32_bf16 a[48:51], v[36:39], v[16:19], a[48:51]
    ds_read_b64_tr_b16 v[70:71], v133 offset:57344
    v_mfma_f32_16x16x32_bf16 a[52:55], v[36:39], v[20:23], a[52:55]
    ds_read_b64_tr_b16 v[72:73], v134 offset:49152
    v_mfma_f32_16x16x32_bf16 a[56:59], v[36:39], v[24:27], a[56:59]
    ds_read_b64_tr_b16 v[74:75], v134 offset:57344
    v_mfma_f32_16x16x32_bf16 a[60:63], v[36:39], v[28:31], a[60:63]
    ds_read_b64_tr_b16 v[76:77], v135 offset:49152
    v_mfma_f32_16x16x32_bf16 a[64:67], v[40:43], v[0:3], a[64:67]
    ds_read_b64_tr_b16 v[78:79], v135 offset:57344
    v_mfma_f32_16x16x32_bf16 a[68:71], v[40:43], v[4:7], a[68:71]
    ds_read_b128 v[84:87], v136 offset:25600
    v_mfma_f32_16x16x32_bf16 a[72:75], v[40:43], v[8:11], a[72:75]
    ds_read_b128 v[88:91], v136 offset:26624
    v_mfma_f32_16x16x32_bf16 a[76:79], v[40:43], v[12:15], a[76:79]
    ds_read_b128 v[92:95], v136 offset:27648
    v_mfma_f32_16x16x32_bf16 a[80:83], v[40:43], v[16:19], a[80:83]
    v_mfma_f32_16x16x32_bf16 a[84:87], v[40:43], v[20:23], a[84:87]
    v_mfma_f32_16x16x32_bf16 a[88:91], v[40:43], v[24:27], a[88:91]
    v_mfma_f32_16x16x32_bf16 a[92:95], v[40:43], v[28:31], a[92:95]
    v_mfma_f32_16x16x32_bf16 a[96:99], v[44:47], v[0:3], a[96:99]
    v_mfma_f32_16x16x32_bf16 a[100:103], v[44:47], v[4:7], a[100:103]
    v_mfma_f32_16x16x32_bf16 a[104:107], v[44:47], v[8:11], a[104:107]
    v_mfma_f32_16x16x32_bf16 a[108:111], v[44:47], v[12:15], a[108:111]
    v_mfma_f32_16x16x32_bf16 a[112:115], v[44:47], v[16:19], a[112:115]
    v_mfma_f32_16x16x32_bf16 a[116:119], v[44:47], v[20:23], a[116:119]
    v_mfma_f32_16x16x32_bf16 a[120:123], v[44:47], v[24:27], a[120:123]
    v_mfma_f32_16x16x32_bf16 a[124:127], v[44:47], v[28:31], a[124:127]
    v_readfirstlane_b32 s55, v255
    s_waitcnt lgkmcnt(0)
    v_mfma_f32_16x16x32_bf16 a[0:3], v[80:83], v[48:51], a[0:3]
    v_mfma_f32_16x16x32_bf16 a[4:7], v[80:83], v[52:55], a[4:7]
    v_mfma_f32_16x16x32_bf16 a[8:11], v[80:83], v[56:59], a[8:11]
    v_mfma_f32_16x16x32_bf16 a[12:15], v[80:83], v[60:63], a[12:15]
    v_mfma_f32_16x16x32_bf16 a[16:19], v[80:83], v[64:67], a[16:19]
    v_mfma_f32_16x16x32_bf16 a[20:23], v[80:83], v[68:71], a[20:23]
    v_mfma_f32_16x16x32_bf16 a[24:27], v[80:83], v[72:75], a[24:27]
    v_mfma_f32_16x16x32_bf16 a[28:31], v[80:83], v[76:79], a[28:31]
    v_mfma_f32_16x16x32_bf16 a[32:35], v[84:87], v[48:51], a[32:35]
    v_mfma_f32_16x16x32_bf16 a[36:39], v[84:87], v[52:55], a[36:39]
    v_mfma_f32_16x16x32_bf16 a[40:43], v[84:87], v[56:59], a[40:43]
    v_mfma_f32_16x16x32_bf16 a[44:47], v[84:87], v[60:63], a[44:47]
    v_mfma_f32_16x16x32_bf16 a[48:51], v[84:87], v[64:67], a[48:51]
    v_mfma_f32_16x16x32_bf16 a[52:55], v[84:87], v[68:71], a[52:55]
    v_mfma_f32_16x16x32_bf16 a[56:59], v[84:87], v[72:75], a[56:59]
    v_mfma_f32_16x16x32_bf16 a[60:63], v[84:87], v[76:79], a[60:63]
    v_mfma_f32_16x16x32_bf16 a[64:67], v[88:91], v[48:51], a[64:67]
    v_mfma_f32_16x16x32_bf16 a[68:71], v[88:91], v[52:55], a[68:71]
    v_mfma_f32_16x16x32_bf16 a[72:75], v[88:91], v[56:59], a[72:75]
    v_mfma_f32_16x16x32_bf16 a[76:79], v[88:91], v[60:63], a[76:79]
    v_mfma_f32_16x16x32_bf16 a[80:83], v[88:91], v[64:67], a[80:83]
    v_mfma_f32_16x16x32_bf16 a[84:87], v[88:91], v[68:71], a[84:87]
    v_mfma_f32_16x16x32_bf16 a[88:91], v[88:91], v[72:75], a[88:91]
    v_mfma_f32_16x16x32_bf16 a[92:95], v[88:91], v[76:79], a[92:95]
    v_mfma_f32_16x16x32_bf16 a[96:99], v[92:95], v[48:51], a[96:99]
    v_mfma_f32_16x16x32_bf16 a[100:103], v[92:95], v[52:55], a[100:103]
    v_mfma_f32_16x16x32_bf16 a[104:107], v[92:95], v[56:59], a[104:107]
    v_mfma_f32_16x16x32_bf16 a[108:111], v[92:95], v[60:63], a[108:111]
    v_mfma_f32_16x16x32_bf16 a[112:115], v[92:95], v[64:67], a[112:115]
    v_mfma_f32_16x16x32_bf16 a[116:119], v[92:95], v[68:71], a[116:119]
    v_mfma_f32_16x16x32_bf16 a[120:123], v[92:95], v[72:75], a[120:123]
    v_mfma_f32_16x16x32_bf16 a[124:127], v[92:95], v[76:79], a[124:127]
    s_nop 7
    s_mov_b32 s53, s21
    v_accvgpr_read_b32 v0, a0
    v_accvgpr_read_b32 v1, a1
    v_accvgpr_read_b32 v2, a2
    v_accvgpr_read_b32 v3, a3
    v_accvgpr_read_b32 v4, a32
    v_accvgpr_read_b32 v5, a33
    v_accvgpr_read_b32 v6, a34
    v_accvgpr_read_b32 v7, a35
    v_cvt_pk_bf16_f32 v8, v0, v1
    v_cvt_pk_bf16_f32 v9, v2, v3
    v_cvt_pk_bf16_f32 v10, v4, v5
    v_cvt_pk_bf16_f32 v11, v6, v7
    buffer_store_dwordx4 v[8:11], v251, s[4:7], s53 offen offset:0 sc1
    v_accvgpr_read_b32 v16, a4
    v_accvgpr_read_b32 v17, a5
    v_accvgpr_read_b32 v18, a6
    v_accvgpr_read_b32 v19, a7
    v_accvgpr_read_b32 v20, a36
    v_accvgpr_read_b32 v21, a37
    v_accvgpr_read_b32 v22, a38
    v_accvgpr_read_b32 v23, a39
    v_cvt_pk_bf16_f32 v24, v16, v17
    v_cvt_pk_bf16_f32 v25, v18, v19
    v_cvt_pk_bf16_f32 v26, v20, v21
    v_cvt_pk_bf16_f32 v27, v22, v23
    buffer_store_dwordx4 v[24:27], v251, s[4:7], s53 offen offset:1024 sc1
    v_accvgpr_read_b32 v32, a8
    v_accvgpr_read_b32 v33, a9
    v_accvgpr_read_b32 v34, a10
    v_accvgpr_read_b32 v35, a11
    v_accvgpr_read_b32 v36, a40
    v_accvgpr_read_b32 v37, a41
    v_accvgpr_read_b32 v38, a42
    v_accvgpr_read_b32 v39, a43
    v_cvt_pk_bf16_f32 v40, v32, v33
    v_cvt_pk_bf16_f32 v41, v34, v35
    v_cvt_pk_bf16_f32 v42, v36, v37
    v_cvt_pk_bf16_f32 v43, v38, v39
    buffer_store_dwordx4 v[40:43], v251, s[4:7], s53 offen offset:2048 sc1
    v_accvgpr_read_b32 v48, a12
    v_accvgpr_read_b32 v49, a13
    v_accvgpr_read_b32 v50, a14
    v_accvgpr_read_b32 v51, a15
    v_accvgpr_read_b32 v52, a44
    v_accvgpr_read_b32 v53, a45
    v_accvgpr_read_b32 v54, a46
    v_accvgpr_read_b32 v55, a47
    v_cvt_pk_bf16_f32 v56, v48, v49
    v_cvt_pk_bf16_f32 v57, v50, v51
    v_cvt_pk_bf16_f32 v58, v52, v53
    v_cvt_pk_bf16_f32 v59, v54, v55
    buffer_store_dwordx4 v[56:59], v251, s[4:7], s53 offen offset:3072 sc1
    s_add_u32 s53, s53, 4096
    v_accvgpr_read_b32 v0, a16
    v_accvgpr_read_b32 v1, a17
    v_accvgpr_read_b32 v2, a18
    v_accvgpr_read_b32 v3, a19
    v_accvgpr_read_b32 v4, a48
    v_accvgpr_read_b32 v5, a49
    v_accvgpr_read_b32 v6, a50
    v_accvgpr_read_b32 v7, a51
    v_cvt_pk_bf16_f32 v8, v0, v1
    v_cvt_pk_bf16_f32 v9, v2, v3
    v_cvt_pk_bf16_f32 v10, v4, v5
    v_cvt_pk_bf16_f32 v11, v6, v7
    buffer_store_dwordx4 v[8:11], v251, s[4:7], s53 offen offset:0 sc1
    v_accvgpr_read_b32 v16, a20
    v_accvgpr_read_b32 v17, a21
    v_accvgpr_read_b32 v18, a22
    v_accvgpr_read_b32 v19, a23
    v_accvgpr_read_b32 v20, a52
    v_accvgpr_read_b32 v21, a53
    v_accvgpr_read_b32 v22, a54
    v_accvgpr_read_b32 v23, a55
    v_cvt_pk_bf16_f32 v24, v16, v17
    v_cvt_pk_bf16_f32 v25, v18, v19
    v_cvt_pk_bf16_f32 v26, v20, v21
    v_cvt_pk_bf16_f32 v27, v22, v23
    buffer_store_dwordx4 v[24:27], v251, s[4:7], s53 offen offset:1024 sc1
    v_accvgpr_read_b32 v32, a24
    v_accvgpr_read_b32 v33, a25
    v_accvgpr_read_b32 v34, a26
    v_accvgpr_read_b32 v35, a27
    v_accvgpr_read_b32 v36, a56
    v_accvgpr_read_b32 v37, a57
    v_accvgpr_read_b32 v38, a58
    v_accvgpr_read_b32 v39, a59
    v_cvt_pk_bf16_f32 v40, v32, v33
    v_cvt_pk_bf16_f32 v41, v34, v35
    v_cvt_pk_bf16_f32 v42, v36, v37
    v_cvt_pk_bf16_f32 v43, v38, v39
    buffer_store_dwordx4 v[40:43], v251, s[4:7], s53 offen offset:2048 sc1
    v_accvgpr_read_b32 v48, a28
    v_accvgpr_read_b32 v49, a29
    v_accvgpr_read_b32 v50, a30
    v_accvgpr_read_b32 v51, a31
    v_accvgpr_read_b32 v52, a60
    v_accvgpr_read_b32 v53, a61
    v_accvgpr_read_b32 v54, a62
    v_accvgpr_read_b32 v55, a63
    v_cvt_pk_bf16_f32 v56, v48, v49
    v_cvt_pk_bf16_f32 v57, v50, v51
    v_cvt_pk_bf16_f32 v58, v52, v53
    v_cvt_pk_bf16_f32 v59, v54, v55
    buffer_store_dwordx4 v[56:59], v251, s[4:7], s53 offen offset:3072 sc1
    s_add_u32 s53, s53, 258048
    v_accvgpr_read_b32 v0, a64
    v_accvgpr_read_b32 v1, a65
    v_accvgpr_read_b32 v2, a66
    v_accvgpr_read_b32 v3, a67
    v_accvgpr_read_b32 v4, a96
    v_accvgpr_read_b32 v5, a97
    v_accvgpr_read_b32 v6, a98
    v_accvgpr_read_b32 v7, a99
    v_cvt_pk_bf16_f32 v8, v0, v1
    v_cvt_pk_bf16_f32 v9, v2, v3
    v_cvt_pk_bf16_f32 v10, v4, v5
    v_cvt_pk_bf16_f32 v11, v6, v7
    buffer_store_dwordx4 v[8:11], v251, s[4:7], s53 offen offset:0 sc1
    v_accvgpr_read_b32 v16, a68
    v_accvgpr_read_b32 v17, a69
    v_accvgpr_read_b32 v18, a70
    v_accvgpr_read_b32 v19, a71
    v_accvgpr_read_b32 v20, a100
    v_accvgpr_read_b32 v21, a101
    v_accvgpr_read_b32 v22, a102
    v_accvgpr_read_b32 v23, a103
    v_cvt_pk_bf16_f32 v24, v16, v17
    v_cvt_pk_bf16_f32 v25, v18, v19
    v_cvt_pk_bf16_f32 v26, v20, v21
    v_cvt_pk_bf16_f32 v27, v22, v23
    buffer_store_dwordx4 v[24:27], v251, s[4:7], s53 offen offset:1024 sc1
    v_accvgpr_read_b32 v32, a72
    v_accvgpr_read_b32 v33, a73
    v_accvgpr_read_b32 v34, a74
    v_accvgpr_read_b32 v35, a75
    v_accvgpr_read_b32 v36, a104
    v_accvgpr_read_b32 v37, a105
    v_accvgpr_read_b32 v38, a106
    v_accvgpr_read_b32 v39, a107
    v_cvt_pk_bf16_f32 v40, v32, v33
    v_cvt_pk_bf16_f32 v41, v34, v35
    v_cvt_pk_bf16_f32 v42, v36, v37
    v_cvt_pk_bf16_f32 v43, v38, v39
    buffer_store_dwordx4 v[40:43], v251, s[4:7], s53 offen offset:2048 sc1
    v_accvgpr_read_b32 v48, a76
    v_accvgpr_read_b32 v49, a77
    v_accvgpr_read_b32 v50, a78
    v_accvgpr_read_b32 v51, a79
    v_accvgpr_read_b32 v52, a108
    v_accvgpr_read_b32 v53, a109
    v_accvgpr_read_b32 v54, a110
    v_accvgpr_read_b32 v55, a111
    v_cvt_pk_bf16_f32 v56, v48, v49
    v_cvt_pk_bf16_f32 v57, v50, v51
    v_cvt_pk_bf16_f32 v58, v52, v53
    v_cvt_pk_bf16_f32 v59, v54, v55
    buffer_store_dwordx4 v[56:59], v251, s[4:7], s53 offen offset:3072 sc1
    s_add_u32 s53, s53, 4096
    v_accvgpr_read_b32 v0, a80
    v_accvgpr_read_b32 v1, a81
    v_accvgpr_read_b32 v2, a82
    v_accvgpr_read_b32 v3, a83
    v_accvgpr_read_b32 v4, a112
    v_accvgpr_read_b32 v5, a113
    v_accvgpr_read_b32 v6, a114
    v_accvgpr_read_b32 v7, a115
    v_cvt_pk_bf16_f32 v8, v0, v1
    v_cvt_pk_bf16_f32 v9, v2, v3
    v_cvt_pk_bf16_f32 v10, v4, v5
    v_cvt_pk_bf16_f32 v11, v6, v7
    buffer_store_dwordx4 v[8:11], v251, s[4:7], s53 offen offset:0 sc1
    v_accvgpr_read_b32 v16, a84
    v_accvgpr_read_b32 v17, a85
    v_accvgpr_read_b32 v18, a86
    v_accvgpr_read_b32 v19, a87
    v_accvgpr_read_b32 v20, a116
    v_accvgpr_read_b32 v21, a117
    v_accvgpr_read_b32 v22, a118
    v_accvgpr_read_b32 v23, a119
    v_cvt_pk_bf16_f32 v24, v16, v17
    v_cvt_pk_bf16_f32 v25, v18, v19
    v_cvt_pk_bf16_f32 v26, v20, v21
    v_cvt_pk_bf16_f32 v27, v22, v23
    buffer_store_dwordx4 v[24:27], v251, s[4:7], s53 offen offset:1024 sc1
    v_accvgpr_read_b32 v32, a88
    v_accvgpr_read_b32 v33, a89
    v_accvgpr_read_b32 v34, a90
    v_accvgpr_read_b32 v35, a91
    v_accvgpr_read_b32 v36, a120
    v_accvgpr_read_b32 v37, a121
    v_accvgpr_read_b32 v38, a122
    v_accvgpr_read_b32 v39, a123
    v_cvt_pk_bf16_f32 v40, v32, v33
    v_cvt_pk_bf16_f32 v41, v34, v35
    v_cvt_pk_bf16_f32 v42, v36, v37
    v_cvt_pk_bf16_f32 v43, v38, v39
    buffer_store_dwordx4 v[40:43], v251, s[4:7], s53 offen offset:2048 sc1
    v_accvgpr_read_b32 v48, a92
    v_accvgpr_read_b32 v49, a93
    v_accvgpr_read_b32 v50, a94
    v_accvgpr_read_b32 v51, a95
    v_accvgpr_read_b32 v52, a124
    v_accvgpr_read_b32 v53, a125
    v_accvgpr_read_b32 v54, a126
    v_accvgpr_read_b32 v55, a127
    v_cvt_pk_bf16_f32 v56, v48, v49
    v_cvt_pk_bf16_f32 v57, v50, v51
    v_cvt_pk_bf16_f32 v58, v52, v53
    v_cvt_pk_bf16_f32 v59, v54, v55
    buffer_store_dwordx4 v[56:59], v251, s[4:7], s53 offen offset:3072 sc1
    s_add_u32 s53, s53, 258048
    s_branch main_kernel_w_done
main_kernel_w_c2_task:
    s_cmp_eq_u32 s23, 0
    s_cbranch_scc1 main_kernel_w_c2_set0
    s_cmp_eq_u32 s23, 1
    s_cbranch_scc1 main_kernel_w_c2_set1
    s_cmp_eq_u32 s23, 2
    s_cbranch_scc1 main_kernel_w_c2_set2
    s_cmp_eq_u32 s23, 6
    s_cbranch_scc1 main_kernel_w_c2_set6
    s_branch main_kernel_w_done
main_kernel_w_c2_set0:
    s_lshl_b32 s32, s25, 8
    s_add_u32 s8, s40, s32
    s_addc_u32 s9, s41, 0
    s_and_b32 s9, s9, 0xffff
    s_sub_u32 s10, 0x800000, s32
    s_mov_b32 s11, 0x20000
    s_mov_b32 s30, 8192
    s_mov_b32 s31, 32768
    s_mul_i32 s16, s24, 262144
    s_add_u32 s16, s16, 0x0
    s_mov_b32 s18, 7
    s_lshl_b32 s32, s24, 3
    s_mul_i32 s33, s38, 8
    s_add_u32 s32, s32, s33
    s_mul_i32 s32, s32, 131072
    s_lshl_b32 s33, s25, 12
    s_add_u32 s32, s32, s33
    s_mul_i32 s33, s37, 4096
    s_add_u32 s32, s32, s33
    s_add_u32 s21, s32, 0x800000
    s_mov_b32 s22, 131072
    s_mov_b32 s26, -1
    s_branch main_kernel_w_c2_go
main_kernel_w_c2_set1:
    s_lshl_b32 s32, s25, 8
    s_add_u32 s8, s42, s32
    s_addc_u32 s9, s43, 0
    s_and_b32 s9, s9, 0xffff
    s_sub_u32 s10, 0x800000, s32
    s_mov_b32 s11, 0x20000
    s_mov_b32 s30, 8192
    s_mov_b32 s31, 32768
    s_mul_i32 s16, s24, 262144
    s_add_u32 s16, s16, 0x0
    s_mov_b32 s18, 7
    s_lshl_b32 s32, s24, 3
    s_mul_i32 s33, s38, 8
    s_add_u32 s32, s32, s33
    s_mul_i32 s32, s32, 131072
    s_lshl_b32 s33, s25, 12
    s_add_u32 s32, s32, s33
    s_mul_i32 s33, s37, 4096
    s_add_u32 s32, s32, s33
    s_add_u32 s21, s32, 0x1800000
    s_mov_b32 s22, 131072
    s_mov_b32 s26, -1
    s_branch main_kernel_w_c2_go
main_kernel_w_c2_set2:
    s_lshl_b32 s32, s25, 8
    s_add_u32 s8, s44, s32
    s_addc_u32 s9, s45, 0
    s_and_b32 s9, s9, 0xffff
    s_sub_u32 s10, 0x800000, s32
    s_mov_b32 s11, 0x20000
    s_mov_b32 s30, 8192
    s_mov_b32 s31, 32768
    s_mul_i32 s16, s24, 262144
    s_add_u32 s16, s16, 0x0
    s_mov_b32 s18, 7
    s_lshl_b32 s32, s24, 2
    s_mul_i32 s33, s38, 4
    s_add_u32 s32, s32, s33
    s_lshl_b32 s32, s32, 18
    s_lshl_b32 s33, s25, 13
    s_add_u32 s32, s32, s33
    s_mul_i32 s33, s37, 8192
    s_add_u32 s32, s32, s33
    s_add_u32 s21, s32, 0x2800000
    s_branch main_kernel_w_c2_gov
main_kernel_w_c2_set6:
    s_lshl_b32 s32, s25, 8
    s_add_u32 s8, s68, s32
    s_addc_u32 s9, s69, 0
    s_and_b32 s9, s9, 0xffff
    s_sub_u32 s10, 0x700000, s32
    s_mov_b32 s11, 0x20000
    s_mov_b32 s30, 7168
    s_mov_b32 s31, 32768
    s_mul_i32 s16, s24, 262144
    s_add_u32 s16, s16, 0x6800000
    s_mov_b32 s18, 7
    s_lshl_b32 s32, s24, 3
    s_mul_i32 s33, s38, 8
    s_add_u32 s32, s32, s33
    s_mul_i32 s32, s32, 114688
    s_lshl_b32 s33, s25, 12
    s_add_u32 s32, s32, s33
    s_mul_i32 s33, s37, 4096
    s_add_u32 s32, s32, s33
    s_add_u32 s21, s32, 0x5400000
    s_mov_b32 s22, 114688
    s_mov_b32 s26, -1
    s_branch main_kernel_w_c2_go
main_kernel_w_c2_go:
    v_lshrrev_b32 v0, 4, v250
    v_bfe_u32 v1, v250, 2, 2
    v_lshl_add_u32 v4, v0, 2, v1
    v_and_b32 v5, 7, v4
    v_mul_u32_u24 v4, 512, v4
    v_and_b32 v6, 3, v250
    v_lshl_add_u32 v4, v6, 3, v4
    s_mul_i32 s32, s37, 8
    v_xor_b32 v5, s32, v5
    v_lshl_add_u32 v128, v5, 5, v4
    v_xor_b32 v129, 32, v128
    v_xor_b32 v130, 64, v128
    v_xor_b32 v131, 96, v128
    v_xor_b32 v132, 128, v128
    v_xor_b32 v133, 160, v128
    v_xor_b32 v134, 192, v128
    v_xor_b32 v135, 224, v128
    s_mul_i32 s32, s38, 8192
    s_add_u32 s32, s32, 65536
    v_add_u32 v136, s32, v251
    v_lshrrev_b32 v2, 5, v250
    v_and_b32 v3, 31, v250
    s_mul_i32 s32, s14, 8
    v_add_u32 v4, s32, v2
    v_add_u32 v5, 0, v4
    v_and_b32 v6, 7, v5
    v_lshlrev_b32 v6, 1, v6
    v_xor_b32 v6, v6, v3
    v_mul_lo_u32 v5, v5, s30
    v_lshl_add_u32 v5, v6, 4, v5
    v_subrev_u32 v137, 0, v5
    v_add_u32 v5, 2, v4
    v_and_b32 v6, 7, v5
    v_lshlrev_b32 v6, 1, v6
    v_xor_b32 v6, v6, v3
    v_mul_lo_u32 v5, v5, s30
    v_lshl_add_u32 v5, v6, 4, v5
    v_subrev_u32 v138, 1024, v5
    v_add_u32 v5, 4, v4
    v_and_b32 v6, 7, v5
    v_lshlrev_b32 v6, 1, v6
    v_xor_b32 v6, v6, v3
    v_mul_lo_u32 v5, v5, s30
    v_lshl_add_u32 v5, v6, 4, v5
    v_subrev_u32 v139, 2048, v5
    v_add_u32 v5, 6, v4
    v_and_b32 v6, 7, v5
    v_lshlrev_b32 v6, 1, v6
    v_xor_b32 v6, v6, v3
    v_mul_lo_u32 v5, v5, s30
    v_lshl_add_u32 v5, v6, 4, v5
    v_subrev_u32 v140, 3072, v5
    s_mul_i32 s32, s14, 4
    s_mul_i32 s32, s32, s31
    v_add_u32 v141, s32, v251
    s_add_u32 s32, s32, s31
    s_sub_u32 s32, s32, 1024
    v_add_u32 v142, s32, v251
    s_add_u32 s32, s32, s31
    s_sub_u32 s32, s32, 1024
    v_add_u32 v143, s32, v251
    s_add_u32 s32, s32, s31
    s_sub_u32 s32, s32, 1024
    v_add_u32 v144, s32, v251
    s_mul_i32 s19, s14, 4096
    s_mul_i32 s20, s14, 4096
    s_add_u32 s20, s20, 65536
    s_mul_i32 s17, s30, 32
    s_mov_b32 s15, 0
    s_add_u32 m0, s20, 0
    s_nop 0
    buffer_load_dwordx4 v141, s[4:7], s16 offen offset:0 sc1 lds
    buffer_load_dwordx4 v142, s[4:7], s16 offen offset:1024 sc1 lds
    buffer_load_dwordx4 v143, s[4:7], s16 offen offset:2048 sc1 lds
    buffer_load_dwordx4 v144, s[4:7], s16 offen offset:3072 sc1 lds
    s_add_u32 s16, s16, 1024
    s_add_u32 m0, s19, 0
    s_nop 0
    buffer_load_dwordx4 v137, s[8:11], s15 offen offset:0 lds
    buffer_load_dwordx4 v138, s[8:11], s15 offen offset:1024 lds
    buffer_load_dwordx4 v139, s[8:11], s15 offen offset:2048 lds
    buffer_load_dwordx4 v140, s[8:11], s15 offen offset:3072 lds
    s_add_u32 s15, s15, s17
    s_add_u32 m0, s20, 16384
    s_nop 0
    buffer_load_dwordx4 v141, s[4:7], s16 offen offset:0 sc1 lds
    buffer_load_dwordx4 v142, s[4:7], s16 offen offset:1024 sc1 lds
    buffer_load_dwordx4 v143, s[4:7], s16 offen offset:2048 sc1 lds
    buffer_load_dwordx4 v144, s[4:7], s16 offen offset:3072 sc1 lds
    s_add_u32 s16, s16, 1024
    s_add_u32 m0, s19, 16384
    s_nop 0
    buffer_load_dwordx4 v137, s[8:11], s15 offen offset:0 lds
    buffer_load_dwordx4 v138, s[8:11], s15 offen offset:1024 lds
    buffer_load_dwordx4 v139, s[8:11], s15 offen offset:2048 lds
    buffer_load_dwordx4 v140, s[8:11], s15 offen offset:3072 lds
    s_add_u32 s15, s15, s17
    s_add_u32 m0, s20, 32768
    s_nop 0
    buffer_load_dwordx4 v141, s[4:7], s16 offen offset:0 sc1 lds
    buffer_load_dwordx4 v142, s[4:7], s16 offen offset:1024 sc1 lds
    buffer_load_dwordx4 v143, s[4:7], s16 offen offset:2048 sc1 lds
    buffer_load_dwordx4 v144, s[4:7], s16 offen offset:3072 sc1 lds
    s_add_u32 s16, s16, 1024
    s_add_u32 m0, s19, 32768
    s_nop 0
    buffer_load_dwordx4 v137, s[8:11], s15 offen offset:0 lds
    buffer_load_dwordx4 v138, s[8:11], s15 offen offset:1024 lds
    buffer_load_dwordx4 v139, s[8:11], s15 offen offset:2048 lds
    buffer_load_dwordx4 v140, s[8:11], s15 offen offset:3072 lds
    s_add_u32 s15, s15, s17
    s_add_u32 m0, s20, 49152
    s_nop 0
    buffer_load_dwordx4 v141, s[4:7], s16 offen offset:0 sc1 lds
    buffer_load_dwordx4 v142, s[4:7], s16 offen offset:1024 sc1 lds
    buffer_load_dwordx4 v143, s[4:7], s16 offen offset:2048 sc1 lds
    buffer_load_dwordx4 v144, s[4:7], s16 offen offset:3072 sc1 lds
    s_add_u32 s16, s16, 1024
    s_add_u32 m0, s19, 49152
    s_nop 0
    buffer_load_dwordx4 v137, s[8:11], s15 offen offset:0 lds
    buffer_load_dwordx4 v138, s[8:11], s15 offen offset:1024 lds
    buffer_load_dwordx4 v139, s[8:11], s15 offen offset:2048 lds
    buffer_load_dwordx4 v140, s[8:11], s15 offen offset:3072 lds
    s_add_u32 s15, s15, s17
    v_accvgpr_write_b32 a0, 0
    v_accvgpr_write_b32 a1, 0
    v_accvgpr_write_b32 a2, 0
    v_accvgpr_write_b32 a3, 0
    v_accvgpr_write_b32 a4, 0
    v_accvgpr_write_b32 a5, 0
    v_accvgpr_write_b32 a6, 0
    v_accvgpr_write_b32 a7, 0
    v_accvgpr_write_b32 a8, 0
    v_accvgpr_write_b32 a9, 0
    v_accvgpr_write_b32 a10, 0
    v_accvgpr_write_b32 a11, 0
    v_accvgpr_write_b32 a12, 0
    v_accvgpr_write_b32 a13, 0
    v_accvgpr_write_b32 a14, 0
    v_accvgpr_write_b32 a15, 0
    v_accvgpr_write_b32 a16, 0
    v_accvgpr_write_b32 a17, 0
    v_accvgpr_write_b32 a18, 0
    v_accvgpr_write_b32 a19, 0
    v_accvgpr_write_b32 a20, 0
    v_accvgpr_write_b32 a21, 0
    v_accvgpr_write_b32 a22, 0
    v_accvgpr_write_b32 a23, 0
    v_accvgpr_write_b32 a24, 0
    v_accvgpr_write_b32 a25, 0
    v_accvgpr_write_b32 a26, 0
    v_accvgpr_write_b32 a27, 0
    v_accvgpr_write_b32 a28, 0
    v_accvgpr_write_b32 a29, 0
    v_accvgpr_write_b32 a30, 0
    v_accvgpr_write_b32 a31, 0
    v_accvgpr_write_b32 a32, 0
    v_accvgpr_write_b32 a33, 0
    v_accvgpr_write_b32 a34, 0
    v_accvgpr_write_b32 a35, 0
    v_accvgpr_write_b32 a36, 0
    v_accvgpr_write_b32 a37, 0
    v_accvgpr_write_b32 a38, 0
    v_accvgpr_write_b32 a39, 0
    v_accvgpr_write_b32 a40, 0
    v_accvgpr_write_b32 a41, 0
    v_accvgpr_write_b32 a42, 0
    v_accvgpr_write_b32 a43, 0
    v_accvgpr_write_b32 a44, 0
    v_accvgpr_write_b32 a45, 0
    v_accvgpr_write_b32 a46, 0
    v_accvgpr_write_b32 a47, 0
    v_accvgpr_write_b32 a48, 0
    v_accvgpr_write_b32 a49, 0
    v_accvgpr_write_b32 a50, 0
    v_accvgpr_write_b32 a51, 0
    v_accvgpr_write_b32 a52, 0
    v_accvgpr_write_b32 a53, 0
    v_accvgpr_write_b32 a54, 0
    v_accvgpr_write_b32 a55, 0
    v_accvgpr_write_b32 a56, 0
    v_accvgpr_write_b32 a57, 0
    v_accvgpr_write_b32 a58, 0
    v_accvgpr_write_b32 a59, 0
    v_accvgpr_write_b32 a60, 0
    v_accvgpr_write_b32 a61, 0
    v_accvgpr_write_b32 a62, 0
    v_accvgpr_write_b32 a63, 0
    v_accvgpr_write_b32 a64, 0
    v_accvgpr_write_b32 a65, 0
    v_accvgpr_write_b32 a66, 0
    v_accvgpr_write_b32 a67, 0
    v_accvgpr_write_b32 a68, 0
    v_accvgpr_write_b32 a69, 0
    v_accvgpr_write_b32 a70, 0
    v_accvgpr_write_b32 a71, 0
    v_accvgpr_write_b32 a72, 0
    v_accvgpr_write_b32 a73, 0
    v_accvgpr_write_b32 a74, 0
    v_accvgpr_write_b32 a75, 0
    v_accvgpr_write_b32 a76, 0
    v_accvgpr_write_b32 a77, 0
    v_accvgpr_write_b32 a78, 0
    v_accvgpr_write_b32 a79, 0
    v_accvgpr_write_b32 a80, 0
    v_accvgpr_write_b32 a81, 0
    v_accvgpr_write_b32 a82, 0
    v_accvgpr_write_b32 a83, 0
    v_accvgpr_write_b32 a84, 0
    v_accvgpr_write_b32 a85, 0
    v_accvgpr_write_b32 a86, 0
    v_accvgpr_write_b32 a87, 0
    v_accvgpr_write_b32 a88, 0
    v_accvgpr_write_b32 a89, 0
    v_accvgpr_write_b32 a90, 0
    v_accvgpr_write_b32 a91, 0
    v_accvgpr_write_b32 a92, 0
    v_accvgpr_write_b32 a93, 0
    v_accvgpr_write_b32 a94, 0
    v_accvgpr_write_b32 a95, 0
    v_accvgpr_write_b32 a96, 0
    v_accvgpr_write_b32 a97, 0
    v_accvgpr_write_b32 a98, 0
    v_accvgpr_write_b32 a99, 0
    v_accvgpr_write_b32 a100, 0
    v_accvgpr_write_b32 a101, 0
    v_accvgpr_write_b32 a102, 0
    v_accvgpr_write_b32 a103, 0
    v_accvgpr_write_b32 a104, 0
    v_accvgpr_write_b32 a105, 0
    v_accvgpr_write_b32 a106, 0
    v_accvgpr_write_b32 a107, 0
    v_accvgpr_write_b32 a108, 0
    v_accvgpr_write_b32 a109, 0
    v_accvgpr_write_b32 a110, 0
    v_accvgpr_write_b32 a111, 0
    v_accvgpr_write_b32 a112, 0
    v_accvgpr_write_b32 a113, 0
    v_accvgpr_write_b32 a114, 0
    v_accvgpr_write_b32 a115, 0
    v_accvgpr_write_b32 a116, 0
    v_accvgpr_write_b32 a117, 0
    v_accvgpr_write_b32 a118, 0
    v_accvgpr_write_b32 a119, 0
    v_accvgpr_write_b32 a120, 0
    v_accvgpr_write_b32 a121, 0
    v_accvgpr_write_b32 a122, 0
    v_accvgpr_write_b32 a123, 0
    v_accvgpr_write_b32 a124, 0
    v_accvgpr_write_b32 a125, 0
    v_accvgpr_write_b32 a126, 0
    v_accvgpr_write_b32 a127, 0
    v_accvgpr_write_b32 a128, 0
    v_accvgpr_write_b32 a129, 0
    v_accvgpr_write_b32 a130, 0
    v_accvgpr_write_b32 a131, 0
    v_accvgpr_write_b32 a132, 0
    v_accvgpr_write_b32 a133, 0
    v_accvgpr_write_b32 a134, 0
    v_accvgpr_write_b32 a135, 0
    v_accvgpr_write_b32 a136, 0
    v_accvgpr_write_b32 a137, 0
    v_accvgpr_write_b32 a138, 0
    v_accvgpr_write_b32 a139, 0
    v_accvgpr_write_b32 a140, 0
    v_accvgpr_write_b32 a141, 0
    v_accvgpr_write_b32 a142, 0
    v_accvgpr_write_b32 a143, 0
    v_accvgpr_write_b32 a144, 0
    v_accvgpr_write_b32 a145, 0
    v_accvgpr_write_b32 a146, 0
    v_accvgpr_write_b32 a147, 0
    v_accvgpr_write_b32 a148, 0
    v_accvgpr_write_b32 a149, 0
    v_accvgpr_write_b32 a150, 0
    v_accvgpr_write_b32 a151, 0
    v_accvgpr_write_b32 a152, 0
    v_accvgpr_write_b32 a153, 0
    v_accvgpr_write_b32 a154, 0
    v_accvgpr_write_b32 a155, 0
    v_accvgpr_write_b32 a156, 0
    v_accvgpr_write_b32 a157, 0
    v_accvgpr_write_b32 a158, 0
    v_accvgpr_write_b32 a159, 0
    v_accvgpr_write_b32 a160, 0
    v_accvgpr_write_b32 a161, 0
    v_accvgpr_write_b32 a162, 0
    v_accvgpr_write_b32 a163, 0
    v_accvgpr_write_b32 a164, 0
    v_accvgpr_write_b32 a165, 0
    v_accvgpr_write_b32 a166, 0
    v_accvgpr_write_b32 a167, 0
    v_accvgpr_write_b32 a168, 0
    v_accvgpr_write_b32 a169, 0
    v_accvgpr_write_b32 a170, 0
    v_accvgpr_write_b32 a171, 0
    v_accvgpr_write_b32 a172, 0
    v_accvgpr_write_b32 a173, 0
    v_accvgpr_write_b32 a174, 0
    v_accvgpr_write_b32 a175, 0
    v_accvgpr_write_b32 a176, 0
    v_accvgpr_write_b32 a177, 0
    v_accvgpr_write_b32 a178, 0
    v_accvgpr_write_b32 a179, 0
    v_accvgpr_write_b32 a180, 0
    v_accvgpr_write_b32 a181, 0
    v_accvgpr_write_b32 a182, 0
    v_accvgpr_write_b32 a183, 0
    v_accvgpr_write_b32 a184, 0
    v_accvgpr_write_b32 a185, 0
    v_accvgpr_write_b32 a186, 0
    v_accvgpr_write_b32 a187, 0
    v_accvgpr_write_b32 a188, 0
    v_accvgpr_write_b32 a189, 0
    v_accvgpr_write_b32 a190, 0
    v_accvgpr_write_b32 a191, 0
    v_accvgpr_write_b32 a192, 0
    v_accvgpr_write_b32 a193, 0
    v_accvgpr_write_b32 a194, 0
    v_accvgpr_write_b32 a195, 0
    v_accvgpr_write_b32 a196, 0
    v_accvgpr_write_b32 a197, 0
    v_accvgpr_write_b32 a198, 0
    v_accvgpr_write_b32 a199, 0
    v_accvgpr_write_b32 a200, 0
    v_accvgpr_write_b32 a201, 0
    v_accvgpr_write_b32 a202, 0
    v_accvgpr_write_b32 a203, 0
    v_accvgpr_write_b32 a204, 0
    v_accvgpr_write_b32 a205, 0
    v_accvgpr_write_b32 a206, 0
    v_accvgpr_write_b32 a207, 0
    v_accvgpr_write_b32 a208, 0
    v_accvgpr_write_b32 a209, 0
    v_accvgpr_write_b32 a210, 0
    v_accvgpr_write_b32 a211, 0
    v_accvgpr_write_b32 a212, 0
    v_accvgpr_write_b32 a213, 0
    v_accvgpr_write_b32 a214, 0
    v_accvgpr_write_b32 a215, 0
    v_accvgpr_write_b32 a216, 0
    v_accvgpr_write_b32 a217, 0
    v_accvgpr_write_b32 a218, 0
    v_accvgpr_write_b32 a219, 0
    v_accvgpr_write_b32 a220, 0
    v_accvgpr_write_b32 a221, 0
    v_accvgpr_write_b32 a222, 0
    v_accvgpr_write_b32 a223, 0
    v_accvgpr_write_b32 a224, 0
    v_accvgpr_write_b32 a225, 0
    v_accvgpr_write_b32 a226, 0
    v_accvgpr_write_b32 a227, 0
    v_accvgpr_write_b32 a228, 0
    v_accvgpr_write_b32 a229, 0
    v_accvgpr_write_b32 a230, 0
    v_accvgpr_write_b32 a231, 0
    v_accvgpr_write_b32 a232, 0
    v_accvgpr_write_b32 a233, 0
    v_accvgpr_write_b32 a234, 0
    v_accvgpr_write_b32 a235, 0
    v_accvgpr_write_b32 a236, 0
    v_accvgpr_write_b32 a237, 0
    v_accvgpr_write_b32 a238, 0
    v_accvgpr_write_b32 a239, 0
    v_accvgpr_write_b32 a240, 0
    v_accvgpr_write_b32 a241, 0
    v_accvgpr_write_b32 a242, 0
    v_accvgpr_write_b32 a243, 0
    v_accvgpr_write_b32 a244, 0
    v_accvgpr_write_b32 a245, 0
    v_accvgpr_write_b32 a246, 0
    v_accvgpr_write_b32 a247, 0
    v_accvgpr_write_b32 a248, 0
    v_accvgpr_write_b32 a249, 0
    v_accvgpr_write_b32 a250, 0
    v_accvgpr_write_b32 a251, 0
    v_accvgpr_write_b32 a252, 0
    v_accvgpr_write_b32 a253, 0
    v_accvgpr_write_b32 a254, 0
    v_accvgpr_write_b32 a255, 0
    s_waitcnt vmcnt(24)
    s_barrier
    ds_read_b128 v[32:35], v136 offset:0
    ds_read_b64_tr_b16 v[0:1], v128 offset:0
    ds_read_b64_tr_b16 v[2:3], v128 offset:8192
    ds_read_b64_tr_b16 v[4:5], v129 offset:0
    ds_read_b64_tr_b16 v[6:7], v129 offset:8192
    ds_read_b64_tr_b16 v[8:9], v130 offset:0
    ds_read_b64_tr_b16 v[10:11], v130 offset:8192
    ds_read_b64_tr_b16 v[12:13], v131 offset:0
    ds_read_b64_tr_b16 v[14:15], v131 offset:8192
    ds_read_b64_tr_b16 v[16:17], v132 offset:0
    ds_read_b64_tr_b16 v[18:19], v132 offset:8192
    ds_read_b64_tr_b16 v[20:21], v133 offset:0
    ds_read_b64_tr_b16 v[22:23], v133 offset:8192
    ds_read_b64_tr_b16 v[24:25], v134 offset:0
    ds_read_b64_tr_b16 v[26:27], v134 offset:8192
    ds_read_b64_tr_b16 v[28:29], v135 offset:0
    ds_read_b64_tr_b16 v[30:31], v135 offset:8192
    ds_read_b128 v[36:39], v136 offset:1024
    ds_read_b128 v[40:43], v136 offset:2048
    ds_read_b128 v[44:47], v136 offset:3072
    ds_read_b128 v[48:51], v136 offset:4096
    ds_read_b128 v[52:55], v136 offset:5120
    ds_read_b128 v[56:59], v136 offset:6144
    ds_read_b128 v[60:63], v136 offset:7168
main_kernel_w_c2_n_loop:
    s_waitcnt lgkmcnt(0)
    v_mfma_f32_16x16x32_bf16 a[0:3], v[0:3], v[32:35], a[0:3]
    s_waitcnt vmcnt(16)
    s_barrier
    ds_read_b128 v[96:99], v136 offset:16384
    s_add_u32 m0, s20, 0
    s_nop 0
    v_mfma_f32_16x16x32_bf16 a[4:7], v[4:7], v[32:35], a[4:7]
    ds_read_b64_tr_b16 v[64:65], v128 offset:16384
    v_mfma_f32_16x16x32_bf16 a[8:11], v[8:11], v[32:35], a[8:11]
    ds_read_b64_tr_b16 v[66:67], v128 offset:24576
    v_mfma_f32_16x16x32_bf16 a[12:15], v[12:15], v[32:35], a[12:15]
    ds_read_b64_tr_b16 v[68:69], v129 offset:16384
    v_mfma_f32_16x16x32_bf16 a[16:19], v[16:19], v[32:35], a[16:19]
    ds_read_b64_tr_b16 v[70:71], v129 offset:24576
    v_mfma_f32_16x16x32_bf16 a[20:23], v[20:23], v[32:35], a[20:23]
    ds_read_b64_tr_b16 v[72:73], v130 offset:16384
    buffer_load_dwordx4 v141, s[4:7], s16 offen offset:0 sc1 lds
    v_mfma_f32_16x16x32_bf16 a[24:27], v[24:27], v[32:35], a[24:27]
    ds_read_b64_tr_b16 v[74:75], v130 offset:24576
    v_mfma_f32_16x16x32_bf16 a[28:31], v[28:31], v[32:35], a[28:31]
    ds_read_b64_tr_b16 v[76:77], v131 offset:16384
    v_mfma_f32_16x16x32_bf16 a[32:35], v[0:3], v[36:39], a[32:35]
    ds_read_b64_tr_b16 v[78:79], v131 offset:24576
    v_mfma_f32_16x16x32_bf16 a[36:39], v[4:7], v[36:39], a[36:39]
    ds_read_b64_tr_b16 v[80:81], v132 offset:16384
    v_mfma_f32_16x16x32_bf16 a[40:43], v[8:11], v[36:39], a[40:43]
    ds_read_b64_tr_b16 v[82:83], v132 offset:24576
    buffer_load_dwordx4 v142, s[4:7], s16 offen offset:1024 sc1 lds
    v_mfma_f32_16x16x32_bf16 a[44:47], v[12:15], v[36:39], a[44:47]
    ds_read_b64_tr_b16 v[84:85], v133 offset:16384
    v_mfma_f32_16x16x32_bf16 a[48:51], v[16:19], v[36:39], a[48:51]
    ds_read_b64_tr_b16 v[86:87], v133 offset:24576
    v_mfma_f32_16x16x32_bf16 a[52:55], v[20:23], v[36:39], a[52:55]
    ds_read_b64_tr_b16 v[88:89], v134 offset:16384
    v_mfma_f32_16x16x32_bf16 a[56:59], v[24:27], v[36:39], a[56:59]
    ds_read_b64_tr_b16 v[90:91], v134 offset:24576
    v_mfma_f32_16x16x32_bf16 a[60:63], v[28:31], v[36:39], a[60:63]
    ds_read_b64_tr_b16 v[92:93], v135 offset:16384
    buffer_load_dwordx4 v143, s[4:7], s16 offen offset:2048 sc1 lds
    v_mfma_f32_16x16x32_bf16 a[64:67], v[0:3], v[40:43], a[64:67]
    ds_read_b64_tr_b16 v[94:95], v135 offset:24576
    v_mfma_f32_16x16x32_bf16 a[68:71], v[4:7], v[40:43], a[68:71]
    ds_read_b128 v[100:103], v136 offset:17408
    v_mfma_f32_16x16x32_bf16 a[72:75], v[8:11], v[40:43], a[72:75]
    ds_read_b128 v[104:107], v136 offset:18432
    v_mfma_f32_16x16x32_bf16 a[76:79], v[12:15], v[40:43], a[76:79]
    ds_read_b128 v[108:111], v136 offset:19456
    v_mfma_f32_16x16x32_bf16 a[80:83], v[16:19], v[40:43], a[80:83]
    ds_read_b128 v[112:115], v136 offset:20480
    v_mfma_f32_16x16x32_bf16 a[84:87], v[20:23], v[40:43], a[84:87]
    ds_read_b128 v[116:119], v136 offset:21504
    buffer_load_dwordx4 v144, s[4:7], s16 offen offset:3072 sc1 lds
    v_mfma_f32_16x16x32_bf16 a[88:91], v[24:27], v[40:43], a[88:91]
    ds_read_b128 v[120:123], v136 offset:22528
    v_mfma_f32_16x16x32_bf16 a[92:95], v[28:31], v[40:43], a[92:95]
    ds_read_b128 v[124:127], v136 offset:23552
    v_mfma_f32_16x16x32_bf16 a[96:99], v[0:3], v[44:47], a[96:99]
    v_mfma_f32_16x16x32_bf16 a[100:103], v[4:7], v[44:47], a[100:103]
    v_mfma_f32_16x16x32_bf16 a[104:107], v[8:11], v[44:47], a[104:107]
    s_add_u32 s16, s16, 1024
    v_mfma_f32_16x16x32_bf16 a[108:111], v[12:15], v[44:47], a[108:111]
    v_mfma_f32_16x16x32_bf16 a[112:115], v[16:19], v[44:47], a[112:115]
    v_mfma_f32_16x16x32_bf16 a[116:119], v[20:23], v[44:47], a[116:119]
    v_mfma_f32_16x16x32_bf16 a[120:123], v[24:27], v[44:47], a[120:123]
    v_mfma_f32_16x16x32_bf16 a[124:127], v[28:31], v[44:47], a[124:127]
    s_add_u32 m0, s19, 0
    s_nop 0
    v_mfma_f32_16x16x32_bf16 a[128:131], v[0:3], v[48:51], a[128:131]
    v_mfma_f32_16x16x32_bf16 a[132:135], v[4:7], v[48:51], a[132:135]
    v_mfma_f32_16x16x32_bf16 a[136:139], v[8:11], v[48:51], a[136:139]
    v_mfma_f32_16x16x32_bf16 a[140:143], v[12:15], v[48:51], a[140:143]
    v_mfma_f32_16x16x32_bf16 a[144:147], v[16:19], v[48:51], a[144:147]
    buffer_load_dwordx4 v137, s[8:11], s15 offen offset:0 lds
    v_mfma_f32_16x16x32_bf16 a[148:151], v[20:23], v[48:51], a[148:151]
    v_mfma_f32_16x16x32_bf16 a[152:155], v[24:27], v[48:51], a[152:155]
    v_mfma_f32_16x16x32_bf16 a[156:159], v[28:31], v[48:51], a[156:159]
    v_mfma_f32_16x16x32_bf16 a[160:163], v[0:3], v[52:55], a[160:163]
    v_mfma_f32_16x16x32_bf16 a[164:167], v[4:7], v[52:55], a[164:167]
    v_mfma_f32_16x16x32_bf16 a[168:171], v[8:11], v[52:55], a[168:171]
    buffer_load_dwordx4 v138, s[8:11], s15 offen offset:1024 lds
    v_mfma_f32_16x16x32_bf16 a[172:175], v[12:15], v[52:55], a[172:175]
    v_mfma_f32_16x16x32_bf16 a[176:179], v[16:19], v[52:55], a[176:179]
    v_mfma_f32_16x16x32_bf16 a[180:183], v[20:23], v[52:55], a[180:183]
    v_mfma_f32_16x16x32_bf16 a[184:187], v[24:27], v[52:55], a[184:187]
    v_mfma_f32_16x16x32_bf16 a[188:191], v[28:31], v[52:55], a[188:191]
    buffer_load_dwordx4 v139, s[8:11], s15 offen offset:2048 lds
    v_mfma_f32_16x16x32_bf16 a[192:195], v[0:3], v[56:59], a[192:195]
    v_mfma_f32_16x16x32_bf16 a[196:199], v[4:7], v[56:59], a[196:199]
    v_mfma_f32_16x16x32_bf16 a[200:203], v[8:11], v[56:59], a[200:203]
    v_mfma_f32_16x16x32_bf16 a[204:207], v[12:15], v[56:59], a[204:207]
    v_mfma_f32_16x16x32_bf16 a[208:211], v[16:19], v[56:59], a[208:211]
    buffer_load_dwordx4 v140, s[8:11], s15 offen offset:3072 lds
    v_mfma_f32_16x16x32_bf16 a[212:215], v[20:23], v[56:59], a[212:215]
    v_mfma_f32_16x16x32_bf16 a[216:219], v[24:27], v[56:59], a[216:219]
    v_mfma_f32_16x16x32_bf16 a[220:223], v[28:31], v[56:59], a[220:223]
    v_mfma_f32_16x16x32_bf16 a[224:227], v[0:3], v[60:63], a[224:227]
    v_mfma_f32_16x16x32_bf16 a[228:231], v[4:7], v[60:63], a[228:231]
    s_add_u32 s15, s15, s17
    v_mfma_f32_16x16x32_bf16 a[232:235], v[8:11], v[60:63], a[232:235]
    v_mfma_f32_16x16x32_bf16 a[236:239], v[12:15], v[60:63], a[236:239]
    v_mfma_f32_16x16x32_bf16 a[240:243], v[16:19], v[60:63], a[240:243]
    v_mfma_f32_16x16x32_bf16 a[244:247], v[20:23], v[60:63], a[244:247]
    v_mfma_f32_16x16x32_bf16 a[248:251], v[24:27], v[60:63], a[248:251]
    v_mfma_f32_16x16x32_bf16 a[252:255], v[28:31], v[60:63], a[252:255]
    s_waitcnt lgkmcnt(0)
    v_mfma_f32_16x16x32_bf16 a[0:3], v[64:67], v[96:99], a[0:3]
    s_waitcnt vmcnt(16)
    s_barrier
    ds_read_b128 v[32:35], v136 offset:32768
    s_add_u32 m0, s20, 16384
    s_nop 0
    v_mfma_f32_16x16x32_bf16 a[4:7], v[68:71], v[96:99], a[4:7]
    ds_read_b64_tr_b16 v[0:1], v128 offset:32768
    v_mfma_f32_16x16x32_bf16 a[8:11], v[72:75], v[96:99], a[8:11]
    ds_read_b64_tr_b16 v[2:3], v128 offset:40960
    v_mfma_f32_16x16x32_bf16 a[12:15], v[76:79], v[96:99], a[12:15]
    ds_read_b64_tr_b16 v[4:5], v129 offset:32768
    v_mfma_f32_16x16x32_bf16 a[16:19], v[80:83], v[96:99], a[16:19]
    ds_read_b64_tr_b16 v[6:7], v129 offset:40960
    v_mfma_f32_16x16x32_bf16 a[20:23], v[84:87], v[96:99], a[20:23]
    ds_read_b64_tr_b16 v[8:9], v130 offset:32768
    buffer_load_dwordx4 v141, s[4:7], s16 offen offset:0 sc1 lds
    v_mfma_f32_16x16x32_bf16 a[24:27], v[88:91], v[96:99], a[24:27]
    ds_read_b64_tr_b16 v[10:11], v130 offset:40960
    v_mfma_f32_16x16x32_bf16 a[28:31], v[92:95], v[96:99], a[28:31]
    ds_read_b64_tr_b16 v[12:13], v131 offset:32768
    v_mfma_f32_16x16x32_bf16 a[32:35], v[64:67], v[100:103], a[32:35]
    ds_read_b64_tr_b16 v[14:15], v131 offset:40960
    v_mfma_f32_16x16x32_bf16 a[36:39], v[68:71], v[100:103], a[36:39]
    ds_read_b64_tr_b16 v[16:17], v132 offset:32768
    v_mfma_f32_16x16x32_bf16 a[40:43], v[72:75], v[100:103], a[40:43]
    ds_read_b64_tr_b16 v[18:19], v132 offset:40960
    buffer_load_dwordx4 v142, s[4:7], s16 offen offset:1024 sc1 lds
    v_mfma_f32_16x16x32_bf16 a[44:47], v[76:79], v[100:103], a[44:47]
    ds_read_b64_tr_b16 v[20:21], v133 offset:32768
    v_mfma_f32_16x16x32_bf16 a[48:51], v[80:83], v[100:103], a[48:51]
    ds_read_b64_tr_b16 v[22:23], v133 offset:40960
    v_mfma_f32_16x16x32_bf16 a[52:55], v[84:87], v[100:103], a[52:55]
    ds_read_b64_tr_b16 v[24:25], v134 offset:32768
    v_mfma_f32_16x16x32_bf16 a[56:59], v[88:91], v[100:103], a[56:59]
    ds_read_b64_tr_b16 v[26:27], v134 offset:40960
    v_mfma_f32_16x16x32_bf16 a[60:63], v[92:95], v[100:103], a[60:63]
    ds_read_b64_tr_b16 v[28:29], v135 offset:32768
    buffer_load_dwordx4 v143, s[4:7], s16 offen offset:2048 sc1 lds
    v_mfma_f32_16x16x32_bf16 a[64:67], v[64:67], v[104:107], a[64:67]
    ds_read_b64_tr_b16 v[30:31], v135 offset:40960
    v_mfma_f32_16x16x32_bf16 a[68:71], v[68:71], v[104:107], a[68:71]
    ds_read_b128 v[36:39], v136 offset:33792
    v_mfma_f32_16x16x32_bf16 a[72:75], v[72:75], v[104:107], a[72:75]
    ds_read_b128 v[40:43], v136 offset:34816
    v_mfma_f32_16x16x32_bf16 a[76:79], v[76:79], v[104:107], a[76:79]
    ds_read_b128 v[44:47], v136 offset:35840
    v_mfma_f32_16x16x32_bf16 a[80:83], v[80:83], v[104:107], a[80:83]
    ds_read_b128 v[48:51], v136 offset:36864
    v_mfma_f32_16x16x32_bf16 a[84:87], v[84:87], v[104:107], a[84:87]
    ds_read_b128 v[52:55], v136 offset:37888
    buffer_load_dwordx4 v144, s[4:7], s16 offen offset:3072 sc1 lds
    v_mfma_f32_16x16x32_bf16 a[88:91], v[88:91], v[104:107], a[88:91]
    ds_read_b128 v[56:59], v136 offset:38912
    v_mfma_f32_16x16x32_bf16 a[92:95], v[92:95], v[104:107], a[92:95]
    ds_read_b128 v[60:63], v136 offset:39936
    v_mfma_f32_16x16x32_bf16 a[96:99], v[64:67], v[108:111], a[96:99]
    v_mfma_f32_16x16x32_bf16 a[100:103], v[68:71], v[108:111], a[100:103]
    v_mfma_f32_16x16x32_bf16 a[104:107], v[72:75], v[108:111], a[104:107]
    s_add_u32 s16, s16, 1024
    v_mfma_f32_16x16x32_bf16 a[108:111], v[76:79], v[108:111], a[108:111]
    v_mfma_f32_16x16x32_bf16 a[112:115], v[80:83], v[108:111], a[112:115]
    v_mfma_f32_16x16x32_bf16 a[116:119], v[84:87], v[108:111], a[116:119]
    v_mfma_f32_16x16x32_bf16 a[120:123], v[88:91], v[108:111], a[120:123]
    v_mfma_f32_16x16x32_bf16 a[124:127], v[92:95], v[108:111], a[124:127]
    s_add_u32 m0, s19, 16384
    s_nop 0
    v_mfma_f32_16x16x32_bf16 a[128:131], v[64:67], v[112:115], a[128:131]
    v_mfma_f32_16x16x32_bf16 a[132:135], v[68:71], v[112:115], a[132:135]
    v_mfma_f32_16x16x32_bf16 a[136:139], v[72:75], v[112:115], a[136:139]
    v_mfma_f32_16x16x32_bf16 a[140:143], v[76:79], v[112:115], a[140:143]
    v_mfma_f32_16x16x32_bf16 a[144:147], v[80:83], v[112:115], a[144:147]
    buffer_load_dwordx4 v137, s[8:11], s15 offen offset:0 lds
    v_mfma_f32_16x16x32_bf16 a[148:151], v[84:87], v[112:115], a[148:151]
    v_mfma_f32_16x16x32_bf16 a[152:155], v[88:91], v[112:115], a[152:155]
    v_mfma_f32_16x16x32_bf16 a[156:159], v[92:95], v[112:115], a[156:159]
    v_mfma_f32_16x16x32_bf16 a[160:163], v[64:67], v[116:119], a[160:163]
    v_mfma_f32_16x16x32_bf16 a[164:167], v[68:71], v[116:119], a[164:167]
    v_mfma_f32_16x16x32_bf16 a[168:171], v[72:75], v[116:119], a[168:171]
    buffer_load_dwordx4 v138, s[8:11], s15 offen offset:1024 lds
    v_mfma_f32_16x16x32_bf16 a[172:175], v[76:79], v[116:119], a[172:175]
    v_mfma_f32_16x16x32_bf16 a[176:179], v[80:83], v[116:119], a[176:179]
    v_mfma_f32_16x16x32_bf16 a[180:183], v[84:87], v[116:119], a[180:183]
    v_mfma_f32_16x16x32_bf16 a[184:187], v[88:91], v[116:119], a[184:187]
    v_mfma_f32_16x16x32_bf16 a[188:191], v[92:95], v[116:119], a[188:191]
    buffer_load_dwordx4 v139, s[8:11], s15 offen offset:2048 lds
    v_mfma_f32_16x16x32_bf16 a[192:195], v[64:67], v[120:123], a[192:195]
    v_mfma_f32_16x16x32_bf16 a[196:199], v[68:71], v[120:123], a[196:199]
    v_mfma_f32_16x16x32_bf16 a[200:203], v[72:75], v[120:123], a[200:203]
    v_mfma_f32_16x16x32_bf16 a[204:207], v[76:79], v[120:123], a[204:207]
    v_mfma_f32_16x16x32_bf16 a[208:211], v[80:83], v[120:123], a[208:211]
    buffer_load_dwordx4 v140, s[8:11], s15 offen offset:3072 lds
    v_mfma_f32_16x16x32_bf16 a[212:215], v[84:87], v[120:123], a[212:215]
    v_mfma_f32_16x16x32_bf16 a[216:219], v[88:91], v[120:123], a[216:219]
    v_mfma_f32_16x16x32_bf16 a[220:223], v[92:95], v[120:123], a[220:223]
    v_mfma_f32_16x16x32_bf16 a[224:227], v[64:67], v[124:127], a[224:227]
    v_mfma_f32_16x16x32_bf16 a[228:231], v[68:71], v[124:127], a[228:231]
    s_add_u32 s15, s15, s17
    v_mfma_f32_16x16x32_bf16 a[232:235], v[72:75], v[124:127], a[232:235]
    v_mfma_f32_16x16x32_bf16 a[236:239], v[76:79], v[124:127], a[236:239]
    v_mfma_f32_16x16x32_bf16 a[240:243], v[80:83], v[124:127], a[240:243]
    v_mfma_f32_16x16x32_bf16 a[244:247], v[84:87], v[124:127], a[244:247]
    v_mfma_f32_16x16x32_bf16 a[248:251], v[88:91], v[124:127], a[248:251]
    v_mfma_f32_16x16x32_bf16 a[252:255], v[92:95], v[124:127], a[252:255]
    s_waitcnt lgkmcnt(0)
    v_mfma_f32_16x16x32_bf16 a[0:3], v[0:3], v[32:35], a[0:3]
    s_waitcnt vmcnt(16)
    s_barrier
    ds_read_b128 v[96:99], v136 offset:49152
    s_add_u32 m0, s20, 32768
    s_nop 0
    v_mfma_f32_16x16x32_bf16 a[4:7], v[4:7], v[32:35], a[4:7]
    ds_read_b64_tr_b16 v[64:65], v128 offset:49152
    v_mfma_f32_16x16x32_bf16 a[8:11], v[8:11], v[32:35], a[8:11]
    ds_read_b64_tr_b16 v[66:67], v128 offset:57344
    v_mfma_f32_16x16x32_bf16 a[12:15], v[12:15], v[32:35], a[12:15]
    ds_read_b64_tr_b16 v[68:69], v129 offset:49152
    v_mfma_f32_16x16x32_bf16 a[16:19], v[16:19], v[32:35], a[16:19]
    ds_read_b64_tr_b16 v[70:71], v129 offset:57344
    v_mfma_f32_16x16x32_bf16 a[20:23], v[20:23], v[32:35], a[20:23]
    ds_read_b64_tr_b16 v[72:73], v130 offset:49152
    buffer_load_dwordx4 v141, s[4:7], s16 offen offset:0 sc1 lds
    v_mfma_f32_16x16x32_bf16 a[24:27], v[24:27], v[32:35], a[24:27]
    ds_read_b64_tr_b16 v[74:75], v130 offset:57344
    v_mfma_f32_16x16x32_bf16 a[28:31], v[28:31], v[32:35], a[28:31]
    ds_read_b64_tr_b16 v[76:77], v131 offset:49152
    v_mfma_f32_16x16x32_bf16 a[32:35], v[0:3], v[36:39], a[32:35]
    ds_read_b64_tr_b16 v[78:79], v131 offset:57344
    v_mfma_f32_16x16x32_bf16 a[36:39], v[4:7], v[36:39], a[36:39]
    ds_read_b64_tr_b16 v[80:81], v132 offset:49152
    v_mfma_f32_16x16x32_bf16 a[40:43], v[8:11], v[36:39], a[40:43]
    ds_read_b64_tr_b16 v[82:83], v132 offset:57344
    buffer_load_dwordx4 v142, s[4:7], s16 offen offset:1024 sc1 lds
    v_mfma_f32_16x16x32_bf16 a[44:47], v[12:15], v[36:39], a[44:47]
    ds_read_b64_tr_b16 v[84:85], v133 offset:49152
    v_mfma_f32_16x16x32_bf16 a[48:51], v[16:19], v[36:39], a[48:51]
    ds_read_b64_tr_b16 v[86:87], v133 offset:57344
    v_mfma_f32_16x16x32_bf16 a[52:55], v[20:23], v[36:39], a[52:55]
    ds_read_b64_tr_b16 v[88:89], v134 offset:49152
    v_mfma_f32_16x16x32_bf16 a[56:59], v[24:27], v[36:39], a[56:59]
    ds_read_b64_tr_b16 v[90:91], v134 offset:57344
    v_mfma_f32_16x16x32_bf16 a[60:63], v[28:31], v[36:39], a[60:63]
    ds_read_b64_tr_b16 v[92:93], v135 offset:49152
    buffer_load_dwordx4 v143, s[4:7], s16 offen offset:2048 sc1 lds
    v_mfma_f32_16x16x32_bf16 a[64:67], v[0:3], v[40:43], a[64:67]
    ds_read_b64_tr_b16 v[94:95], v135 offset:57344
    v_mfma_f32_16x16x32_bf16 a[68:71], v[4:7], v[40:43], a[68:71]
    ds_read_b128 v[100:103], v136 offset:50176
    v_mfma_f32_16x16x32_bf16 a[72:75], v[8:11], v[40:43], a[72:75]
    ds_read_b128 v[104:107], v136 offset:51200
    v_mfma_f32_16x16x32_bf16 a[76:79], v[12:15], v[40:43], a[76:79]
    ds_read_b128 v[108:111], v136 offset:52224
    v_mfma_f32_16x16x32_bf16 a[80:83], v[16:19], v[40:43], a[80:83]
    ds_read_b128 v[112:115], v136 offset:53248
    v_mfma_f32_16x16x32_bf16 a[84:87], v[20:23], v[40:43], a[84:87]
    ds_read_b128 v[116:119], v136 offset:54272
    buffer_load_dwordx4 v144, s[4:7], s16 offen offset:3072 sc1 lds
    v_mfma_f32_16x16x32_bf16 a[88:91], v[24:27], v[40:43], a[88:91]
    ds_read_b128 v[120:123], v136 offset:55296
    v_mfma_f32_16x16x32_bf16 a[92:95], v[28:31], v[40:43], a[92:95]
    ds_read_b128 v[124:127], v136 offset:56320
    v_mfma_f32_16x16x32_bf16 a[96:99], v[0:3], v[44:47], a[96:99]
    v_mfma_f32_16x16x32_bf16 a[100:103], v[4:7], v[44:47], a[100:103]
    v_mfma_f32_16x16x32_bf16 a[104:107], v[8:11], v[44:47], a[104:107]
    s_add_u32 s16, s16, 1024
    v_mfma_f32_16x16x32_bf16 a[108:111], v[12:15], v[44:47], a[108:111]
    v_mfma_f32_16x16x32_bf16 a[112:115], v[16:19], v[44:47], a[112:115]
    v_mfma_f32_16x16x32_bf16 a[116:119], v[20:23], v[44:47], a[116:119]
    v_mfma_f32_16x16x32_bf16 a[120:123], v[24:27], v[44:47], a[120:123]
    v_mfma_f32_16x16x32_bf16 a[124:127], v[28:31], v[44:47], a[124:127]
    s_add_u32 m0, s19, 32768
    s_nop 0
    v_mfma_f32_16x16x32_bf16 a[128:131], v[0:3], v[48:51], a[128:131]
    v_mfma_f32_16x16x32_bf16 a[132:135], v[4:7], v[48:51], a[132:135]
    v_mfma_f32_16x16x32_bf16 a[136:139], v[8:11], v[48:51], a[136:139]
    v_mfma_f32_16x16x32_bf16 a[140:143], v[12:15], v[48:51], a[140:143]
    v_mfma_f32_16x16x32_bf16 a[144:147], v[16:19], v[48:51], a[144:147]
    buffer_load_dwordx4 v137, s[8:11], s15 offen offset:0 lds
    v_mfma_f32_16x16x32_bf16 a[148:151], v[20:23], v[48:51], a[148:151]
    v_mfma_f32_16x16x32_bf16 a[152:155], v[24:27], v[48:51], a[152:155]
    v_mfma_f32_16x16x32_bf16 a[156:159], v[28:31], v[48:51], a[156:159]
    v_mfma_f32_16x16x32_bf16 a[160:163], v[0:3], v[52:55], a[160:163]
    v_mfma_f32_16x16x32_bf16 a[164:167], v[4:7], v[52:55], a[164:167]
    v_mfma_f32_16x16x32_bf16 a[168:171], v[8:11], v[52:55], a[168:171]
    buffer_load_dwordx4 v138, s[8:11], s15 offen offset:1024 lds
    v_mfma_f32_16x16x32_bf16 a[172:175], v[12:15], v[52:55], a[172:175]
    v_mfma_f32_16x16x32_bf16 a[176:179], v[16:19], v[52:55], a[176:179]
    v_mfma_f32_16x16x32_bf16 a[180:183], v[20:23], v[52:55], a[180:183]
    v_mfma_f32_16x16x32_bf16 a[184:187], v[24:27], v[52:55], a[184:187]
    v_mfma_f32_16x16x32_bf16 a[188:191], v[28:31], v[52:55], a[188:191]
    buffer_load_dwordx4 v139, s[8:11], s15 offen offset:2048 lds
    v_mfma_f32_16x16x32_bf16 a[192:195], v[0:3], v[56:59], a[192:195]
    v_mfma_f32_16x16x32_bf16 a[196:199], v[4:7], v[56:59], a[196:199]
    v_mfma_f32_16x16x32_bf16 a[200:203], v[8:11], v[56:59], a[200:203]
    v_mfma_f32_16x16x32_bf16 a[204:207], v[12:15], v[56:59], a[204:207]
    v_mfma_f32_16x16x32_bf16 a[208:211], v[16:19], v[56:59], a[208:211]
    buffer_load_dwordx4 v140, s[8:11], s15 offen offset:3072 lds
    v_mfma_f32_16x16x32_bf16 a[212:215], v[20:23], v[56:59], a[212:215]
    v_mfma_f32_16x16x32_bf16 a[216:219], v[24:27], v[56:59], a[216:219]
    v_mfma_f32_16x16x32_bf16 a[220:223], v[28:31], v[56:59], a[220:223]
    v_mfma_f32_16x16x32_bf16 a[224:227], v[0:3], v[60:63], a[224:227]
    v_mfma_f32_16x16x32_bf16 a[228:231], v[4:7], v[60:63], a[228:231]
    s_add_u32 s15, s15, s17
    v_mfma_f32_16x16x32_bf16 a[232:235], v[8:11], v[60:63], a[232:235]
    v_mfma_f32_16x16x32_bf16 a[236:239], v[12:15], v[60:63], a[236:239]
    v_mfma_f32_16x16x32_bf16 a[240:243], v[16:19], v[60:63], a[240:243]
    v_mfma_f32_16x16x32_bf16 a[244:247], v[20:23], v[60:63], a[244:247]
    v_mfma_f32_16x16x32_bf16 a[248:251], v[24:27], v[60:63], a[248:251]
    v_mfma_f32_16x16x32_bf16 a[252:255], v[28:31], v[60:63], a[252:255]
    s_waitcnt lgkmcnt(0)
    v_mfma_f32_16x16x32_bf16 a[0:3], v[64:67], v[96:99], a[0:3]
    s_waitcnt vmcnt(16)
    s_barrier
    ds_read_b128 v[32:35], v136 offset:0
    s_add_u32 m0, s20, 49152
    s_nop 0
    v_mfma_f32_16x16x32_bf16 a[4:7], v[68:71], v[96:99], a[4:7]
    ds_read_b64_tr_b16 v[0:1], v128 offset:0
    v_mfma_f32_16x16x32_bf16 a[8:11], v[72:75], v[96:99], a[8:11]
    ds_read_b64_tr_b16 v[2:3], v128 offset:8192
    v_mfma_f32_16x16x32_bf16 a[12:15], v[76:79], v[96:99], a[12:15]
    ds_read_b64_tr_b16 v[4:5], v129 offset:0
    v_mfma_f32_16x16x32_bf16 a[16:19], v[80:83], v[96:99], a[16:19]
    ds_read_b64_tr_b16 v[6:7], v129 offset:8192
    v_mfma_f32_16x16x32_bf16 a[20:23], v[84:87], v[96:99], a[20:23]
    ds_read_b64_tr_b16 v[8:9], v130 offset:0
    buffer_load_dwordx4 v141, s[4:7], s16 offen offset:0 sc1 lds
    v_mfma_f32_16x16x32_bf16 a[24:27], v[88:91], v[96:99], a[24:27]
    ds_read_b64_tr_b16 v[10:11], v130 offset:8192
    v_mfma_f32_16x16x32_bf16 a[28:31], v[92:95], v[96:99], a[28:31]
    ds_read_b64_tr_b16 v[12:13], v131 offset:0
    v_mfma_f32_16x16x32_bf16 a[32:35], v[64:67], v[100:103], a[32:35]
    ds_read_b64_tr_b16 v[14:15], v131 offset:8192
    v_mfma_f32_16x16x32_bf16 a[36:39], v[68:71], v[100:103], a[36:39]
    ds_read_b64_tr_b16 v[16:17], v132 offset:0
    v_mfma_f32_16x16x32_bf16 a[40:43], v[72:75], v[100:103], a[40:43]
    ds_read_b64_tr_b16 v[18:19], v132 offset:8192
    buffer_load_dwordx4 v142, s[4:7], s16 offen offset:1024 sc1 lds
    v_mfma_f32_16x16x32_bf16 a[44:47], v[76:79], v[100:103], a[44:47]
    ds_read_b64_tr_b16 v[20:21], v133 offset:0
    v_mfma_f32_16x16x32_bf16 a[48:51], v[80:83], v[100:103], a[48:51]
    ds_read_b64_tr_b16 v[22:23], v133 offset:8192
    v_mfma_f32_16x16x32_bf16 a[52:55], v[84:87], v[100:103], a[52:55]
    ds_read_b64_tr_b16 v[24:25], v134 offset:0
    v_mfma_f32_16x16x32_bf16 a[56:59], v[88:91], v[100:103], a[56:59]
    ds_read_b64_tr_b16 v[26:27], v134 offset:8192
    v_mfma_f32_16x16x32_bf16 a[60:63], v[92:95], v[100:103], a[60:63]
    ds_read_b64_tr_b16 v[28:29], v135 offset:0
    buffer_load_dwordx4 v143, s[4:7], s16 offen offset:2048 sc1 lds
    v_mfma_f32_16x16x32_bf16 a[64:67], v[64:67], v[104:107], a[64:67]
    ds_read_b64_tr_b16 v[30:31], v135 offset:8192
    v_mfma_f32_16x16x32_bf16 a[68:71], v[68:71], v[104:107], a[68:71]
    ds_read_b128 v[36:39], v136 offset:1024
    v_mfma_f32_16x16x32_bf16 a[72:75], v[72:75], v[104:107], a[72:75]
    ds_read_b128 v[40:43], v136 offset:2048
    v_mfma_f32_16x16x32_bf16 a[76:79], v[76:79], v[104:107], a[76:79]
    ds_read_b128 v[44:47], v136 offset:3072
    v_mfma_f32_16x16x32_bf16 a[80:83], v[80:83], v[104:107], a[80:83]
    ds_read_b128 v[48:51], v136 offset:4096
    v_mfma_f32_16x16x32_bf16 a[84:87], v[84:87], v[104:107], a[84:87]
    ds_read_b128 v[52:55], v136 offset:5120
    buffer_load_dwordx4 v144, s[4:7], s16 offen offset:3072 sc1 lds
    v_mfma_f32_16x16x32_bf16 a[88:91], v[88:91], v[104:107], a[88:91]
    ds_read_b128 v[56:59], v136 offset:6144
    v_mfma_f32_16x16x32_bf16 a[92:95], v[92:95], v[104:107], a[92:95]
    ds_read_b128 v[60:63], v136 offset:7168
    v_mfma_f32_16x16x32_bf16 a[96:99], v[64:67], v[108:111], a[96:99]
    v_mfma_f32_16x16x32_bf16 a[100:103], v[68:71], v[108:111], a[100:103]
    v_mfma_f32_16x16x32_bf16 a[104:107], v[72:75], v[108:111], a[104:107]
    s_add_u32 s16, s16, 1024
    v_mfma_f32_16x16x32_bf16 a[108:111], v[76:79], v[108:111], a[108:111]
    v_mfma_f32_16x16x32_bf16 a[112:115], v[80:83], v[108:111], a[112:115]
    v_mfma_f32_16x16x32_bf16 a[116:119], v[84:87], v[108:111], a[116:119]
    v_mfma_f32_16x16x32_bf16 a[120:123], v[88:91], v[108:111], a[120:123]
    v_mfma_f32_16x16x32_bf16 a[124:127], v[92:95], v[108:111], a[124:127]
    s_add_u32 m0, s19, 49152
    s_nop 0
    v_mfma_f32_16x16x32_bf16 a[128:131], v[64:67], v[112:115], a[128:131]
    v_mfma_f32_16x16x32_bf16 a[132:135], v[68:71], v[112:115], a[132:135]
    v_mfma_f32_16x16x32_bf16 a[136:139], v[72:75], v[112:115], a[136:139]
    v_mfma_f32_16x16x32_bf16 a[140:143], v[76:79], v[112:115], a[140:143]
    v_mfma_f32_16x16x32_bf16 a[144:147], v[80:83], v[112:115], a[144:147]
    buffer_load_dwordx4 v137, s[8:11], s15 offen offset:0 lds
    v_mfma_f32_16x16x32_bf16 a[148:151], v[84:87], v[112:115], a[148:151]
    v_mfma_f32_16x16x32_bf16 a[152:155], v[88:91], v[112:115], a[152:155]
    v_mfma_f32_16x16x32_bf16 a[156:159], v[92:95], v[112:115], a[156:159]
    v_mfma_f32_16x16x32_bf16 a[160:163], v[64:67], v[116:119], a[160:163]
    v_mfma_f32_16x16x32_bf16 a[164:167], v[68:71], v[116:119], a[164:167]
    v_mfma_f32_16x16x32_bf16 a[168:171], v[72:75], v[116:119], a[168:171]
    buffer_load_dwordx4 v138, s[8:11], s15 offen offset:1024 lds
    v_mfma_f32_16x16x32_bf16 a[172:175], v[76:79], v[116:119], a[172:175]
    v_mfma_f32_16x16x32_bf16 a[176:179], v[80:83], v[116:119], a[176:179]
    v_mfma_f32_16x16x32_bf16 a[180:183], v[84:87], v[116:119], a[180:183]
    v_mfma_f32_16x16x32_bf16 a[184:187], v[88:91], v[116:119], a[184:187]
    v_mfma_f32_16x16x32_bf16 a[188:191], v[92:95], v[116:119], a[188:191]
    buffer_load_dwordx4 v139, s[8:11], s15 offen offset:2048 lds
    v_mfma_f32_16x16x32_bf16 a[192:195], v[64:67], v[120:123], a[192:195]
    v_mfma_f32_16x16x32_bf16 a[196:199], v[68:71], v[120:123], a[196:199]
    v_mfma_f32_16x16x32_bf16 a[200:203], v[72:75], v[120:123], a[200:203]
    v_mfma_f32_16x16x32_bf16 a[204:207], v[76:79], v[120:123], a[204:207]
    v_mfma_f32_16x16x32_bf16 a[208:211], v[80:83], v[120:123], a[208:211]
    buffer_load_dwordx4 v140, s[8:11], s15 offen offset:3072 lds
    v_mfma_f32_16x16x32_bf16 a[212:215], v[84:87], v[120:123], a[212:215]
    v_mfma_f32_16x16x32_bf16 a[216:219], v[88:91], v[120:123], a[216:219]
    v_mfma_f32_16x16x32_bf16 a[220:223], v[92:95], v[120:123], a[220:223]
    v_mfma_f32_16x16x32_bf16 a[224:227], v[64:67], v[124:127], a[224:227]
    v_mfma_f32_16x16x32_bf16 a[228:231], v[68:71], v[124:127], a[228:231]
    s_add_u32 s15, s15, s17
    v_mfma_f32_16x16x32_bf16 a[232:235], v[72:75], v[124:127], a[232:235]
    v_mfma_f32_16x16x32_bf16 a[236:239], v[76:79], v[124:127], a[236:239]
    v_mfma_f32_16x16x32_bf16 a[240:243], v[80:83], v[124:127], a[240:243]
    v_mfma_f32_16x16x32_bf16 a[244:247], v[84:87], v[124:127], a[244:247]
    v_mfma_f32_16x16x32_bf16 a[248:251], v[88:91], v[124:127], a[248:251]
    v_mfma_f32_16x16x32_bf16 a[252:255], v[92:95], v[124:127], a[252:255]
    s_sub_u32 s18, s18, 1
    s_cmp_lg_u32 s18, 0
    s_cbranch_scc1 main_kernel_w_c2_n_loop
    s_cmp_lg_u32 s14, 0
    s_cbranch_scc1 main_kernel_w_c2_n_nt
    s_lshl_b32 s32, s27, 8
    s_add_u32 s32, s32, 0x841e000
    v_mov_b32 v255, 1
    s_mov_b64 exec, 1
    buffer_atomic_add v255, off, s[4:7], s32 sc0 sc1
    s_mov_b64 exec, -1
main_kernel_w_c2_n_nt:
    s_waitcnt lgkmcnt(0)
    v_mfma_f32_16x16x32_bf16 a[0:3], v[0:3], v[32:35], a[0:3]
    s_waitcnt vmcnt(16)
    s_barrier
    ds_read_b128 v[96:99], v136 offset:16384
    v_mfma_f32_16x16x32_bf16 a[4:7], v[4:7], v[32:35], a[4:7]
    ds_read_b64_tr_b16 v[64:65], v128 offset:16384
    v_mfma_f32_16x16x32_bf16 a[8:11], v[8:11], v[32:35], a[8:11]
    ds_read_b64_tr_b16 v[66:67], v128 offset:24576
    v_mfma_f32_16x16x32_bf16 a[12:15], v[12:15], v[32:35], a[12:15]
    ds_read_b64_tr_b16 v[68:69], v129 offset:16384
    v_mfma_f32_16x16x32_bf16 a[16:19], v[16:19], v[32:35], a[16:19]
    ds_read_b64_tr_b16 v[70:71], v129 offset:24576
    v_mfma_f32_16x16x32_bf16 a[20:23], v[20:23], v[32:35], a[20:23]
    ds_read_b64_tr_b16 v[72:73], v130 offset:16384
    v_mfma_f32_16x16x32_bf16 a[24:27], v[24:27], v[32:35], a[24:27]
    ds_read_b64_tr_b16 v[74:75], v130 offset:24576
    v_mfma_f32_16x16x32_bf16 a[28:31], v[28:31], v[32:35], a[28:31]
    ds_read_b64_tr_b16 v[76:77], v131 offset:16384
    v_mfma_f32_16x16x32_bf16 a[32:35], v[0:3], v[36:39], a[32:35]
    ds_read_b64_tr_b16 v[78:79], v131 offset:24576
    v_mfma_f32_16x16x32_bf16 a[36:39], v[4:7], v[36:39], a[36:39]
    ds_read_b64_tr_b16 v[80:81], v132 offset:16384
    v_mfma_f32_16x16x32_bf16 a[40:43], v[8:11], v[36:39], a[40:43]
    ds_read_b64_tr_b16 v[82:83], v132 offset:24576
    v_mfma_f32_16x16x32_bf16 a[44:47], v[12:15], v[36:39], a[44:47]
    ds_read_b64_tr_b16 v[84:85], v133 offset:16384
    v_mfma_f32_16x16x32_bf16 a[48:51], v[16:19], v[36:39], a[48:51]
    ds_read_b64_tr_b16 v[86:87], v133 offset:24576
    v_mfma_f32_16x16x32_bf16 a[52:55], v[20:23], v[36:39], a[52:55]
    ds_read_b64_tr_b16 v[88:89], v134 offset:16384
    v_mfma_f32_16x16x32_bf16 a[56:59], v[24:27], v[36:39], a[56:59]
    ds_read_b64_tr_b16 v[90:91], v134 offset:24576
    v_mfma_f32_16x16x32_bf16 a[60:63], v[28:31], v[36:39], a[60:63]
    ds_read_b64_tr_b16 v[92:93], v135 offset:16384
    v_mfma_f32_16x16x32_bf16 a[64:67], v[0:3], v[40:43], a[64:67]
    ds_read_b64_tr_b16 v[94:95], v135 offset:24576
    v_mfma_f32_16x16x32_bf16 a[68:71], v[4:7], v[40:43], a[68:71]
    ds_read_b128 v[100:103], v136 offset:17408
    v_mfma_f32_16x16x32_bf16 a[72:75], v[8:11], v[40:43], a[72:75]
    ds_read_b128 v[104:107], v136 offset:18432
    v_mfma_f32_16x16x32_bf16 a[76:79], v[12:15], v[40:43], a[76:79]
    ds_read_b128 v[108:111], v136 offset:19456
    v_mfma_f32_16x16x32_bf16 a[80:83], v[16:19], v[40:43], a[80:83]
    ds_read_b128 v[112:115], v136 offset:20480
    v_mfma_f32_16x16x32_bf16 a[84:87], v[20:23], v[40:43], a[84:87]
    ds_read_b128 v[116:119], v136 offset:21504
    v_mfma_f32_16x16x32_bf16 a[88:91], v[24:27], v[40:43], a[88:91]
    ds_read_b128 v[120:123], v136 offset:22528
    v_mfma_f32_16x16x32_bf16 a[92:95], v[28:31], v[40:43], a[92:95]
    ds_read_b128 v[124:127], v136 offset:23552
    v_mfma_f32_16x16x32_bf16 a[96:99], v[0:3], v[44:47], a[96:99]
    v_mfma_f32_16x16x32_bf16 a[100:103], v[4:7], v[44:47], a[100:103]
    v_mfma_f32_16x16x32_bf16 a[104:107], v[8:11], v[44:47], a[104:107]
    v_mfma_f32_16x16x32_bf16 a[108:111], v[12:15], v[44:47], a[108:111]
    v_mfma_f32_16x16x32_bf16 a[112:115], v[16:19], v[44:47], a[112:115]
    v_mfma_f32_16x16x32_bf16 a[116:119], v[20:23], v[44:47], a[116:119]
    v_mfma_f32_16x16x32_bf16 a[120:123], v[24:27], v[44:47], a[120:123]
    v_mfma_f32_16x16x32_bf16 a[124:127], v[28:31], v[44:47], a[124:127]
    v_mfma_f32_16x16x32_bf16 a[128:131], v[0:3], v[48:51], a[128:131]
    v_mfma_f32_16x16x32_bf16 a[132:135], v[4:7], v[48:51], a[132:135]
    v_mfma_f32_16x16x32_bf16 a[136:139], v[8:11], v[48:51], a[136:139]
    v_mfma_f32_16x16x32_bf16 a[140:143], v[12:15], v[48:51], a[140:143]
    v_mfma_f32_16x16x32_bf16 a[144:147], v[16:19], v[48:51], a[144:147]
    v_mfma_f32_16x16x32_bf16 a[148:151], v[20:23], v[48:51], a[148:151]
    v_mfma_f32_16x16x32_bf16 a[152:155], v[24:27], v[48:51], a[152:155]
    v_mfma_f32_16x16x32_bf16 a[156:159], v[28:31], v[48:51], a[156:159]
    v_mfma_f32_16x16x32_bf16 a[160:163], v[0:3], v[52:55], a[160:163]
    v_mfma_f32_16x16x32_bf16 a[164:167], v[4:7], v[52:55], a[164:167]
    v_mfma_f32_16x16x32_bf16 a[168:171], v[8:11], v[52:55], a[168:171]
    v_mfma_f32_16x16x32_bf16 a[172:175], v[12:15], v[52:55], a[172:175]
    v_mfma_f32_16x16x32_bf16 a[176:179], v[16:19], v[52:55], a[176:179]
    v_mfma_f32_16x16x32_bf16 a[180:183], v[20:23], v[52:55], a[180:183]
    v_mfma_f32_16x16x32_bf16 a[184:187], v[24:27], v[52:55], a[184:187]
    v_mfma_f32_16x16x32_bf16 a[188:191], v[28:31], v[52:55], a[188:191]
    v_mfma_f32_16x16x32_bf16 a[192:195], v[0:3], v[56:59], a[192:195]
    v_mfma_f32_16x16x32_bf16 a[196:199], v[4:7], v[56:59], a[196:199]
    v_mfma_f32_16x16x32_bf16 a[200:203], v[8:11], v[56:59], a[200:203]
    v_mfma_f32_16x16x32_bf16 a[204:207], v[12:15], v[56:59], a[204:207]
    v_mfma_f32_16x16x32_bf16 a[208:211], v[16:19], v[56:59], a[208:211]
    v_mfma_f32_16x16x32_bf16 a[212:215], v[20:23], v[56:59], a[212:215]
    v_mfma_f32_16x16x32_bf16 a[216:219], v[24:27], v[56:59], a[216:219]
    v_mfma_f32_16x16x32_bf16 a[220:223], v[28:31], v[56:59], a[220:223]
    v_mfma_f32_16x16x32_bf16 a[224:227], v[0:3], v[60:63], a[224:227]
    v_mfma_f32_16x16x32_bf16 a[228:231], v[4:7], v[60:63], a[228:231]
    v_mfma_f32_16x16x32_bf16 a[232:235], v[8:11], v[60:63], a[232:235]
    v_mfma_f32_16x16x32_bf16 a[236:239], v[12:15], v[60:63], a[236:239]
    v_mfma_f32_16x16x32_bf16 a[240:243], v[16:19], v[60:63], a[240:243]
    v_mfma_f32_16x16x32_bf16 a[244:247], v[20:23], v[60:63], a[244:247]
    v_mfma_f32_16x16x32_bf16 a[248:251], v[24:27], v[60:63], a[248:251]
    v_mfma_f32_16x16x32_bf16 a[252:255], v[28:31], v[60:63], a[252:255]
    s_waitcnt lgkmcnt(0)
    v_mfma_f32_16x16x32_bf16 a[0:3], v[64:67], v[96:99], a[0:3]
    s_waitcnt vmcnt(8)
    s_barrier
    ds_read_b128 v[32:35], v136 offset:32768
    v_mfma_f32_16x16x32_bf16 a[4:7], v[68:71], v[96:99], a[4:7]
    ds_read_b64_tr_b16 v[0:1], v128 offset:32768
    v_mfma_f32_16x16x32_bf16 a[8:11], v[72:75], v[96:99], a[8:11]
    ds_read_b64_tr_b16 v[2:3], v128 offset:40960
    v_mfma_f32_16x16x32_bf16 a[12:15], v[76:79], v[96:99], a[12:15]
    ds_read_b64_tr_b16 v[4:5], v129 offset:32768
    v_mfma_f32_16x16x32_bf16 a[16:19], v[80:83], v[96:99], a[16:19]
    ds_read_b64_tr_b16 v[6:7], v129 offset:40960
    v_mfma_f32_16x16x32_bf16 a[20:23], v[84:87], v[96:99], a[20:23]
    ds_read_b64_tr_b16 v[8:9], v130 offset:32768
    v_mfma_f32_16x16x32_bf16 a[24:27], v[88:91], v[96:99], a[24:27]
    ds_read_b64_tr_b16 v[10:11], v130 offset:40960
    v_mfma_f32_16x16x32_bf16 a[28:31], v[92:95], v[96:99], a[28:31]
    ds_read_b64_tr_b16 v[12:13], v131 offset:32768
    v_mfma_f32_16x16x32_bf16 a[32:35], v[64:67], v[100:103], a[32:35]
    ds_read_b64_tr_b16 v[14:15], v131 offset:40960
    v_mfma_f32_16x16x32_bf16 a[36:39], v[68:71], v[100:103], a[36:39]
    ds_read_b64_tr_b16 v[16:17], v132 offset:32768
    v_mfma_f32_16x16x32_bf16 a[40:43], v[72:75], v[100:103], a[40:43]
    ds_read_b64_tr_b16 v[18:19], v132 offset:40960
    v_mfma_f32_16x16x32_bf16 a[44:47], v[76:79], v[100:103], a[44:47]
    ds_read_b64_tr_b16 v[20:21], v133 offset:32768
    v_mfma_f32_16x16x32_bf16 a[48:51], v[80:83], v[100:103], a[48:51]
    ds_read_b64_tr_b16 v[22:23], v133 offset:40960
    v_mfma_f32_16x16x32_bf16 a[52:55], v[84:87], v[100:103], a[52:55]
    ds_read_b64_tr_b16 v[24:25], v134 offset:32768
    v_mfma_f32_16x16x32_bf16 a[56:59], v[88:91], v[100:103], a[56:59]
    ds_read_b64_tr_b16 v[26:27], v134 offset:40960
    v_mfma_f32_16x16x32_bf16 a[60:63], v[92:95], v[100:103], a[60:63]
    ds_read_b64_tr_b16 v[28:29], v135 offset:32768
    v_mfma_f32_16x16x32_bf16 a[64:67], v[64:67], v[104:107], a[64:67]
    ds_read_b64_tr_b16 v[30:31], v135 offset:40960
    v_mfma_f32_16x16x32_bf16 a[68:71], v[68:71], v[104:107], a[68:71]
    ds_read_b128 v[36:39], v136 offset:33792
    v_mfma_f32_16x16x32_bf16 a[72:75], v[72:75], v[104:107], a[72:75]
    ds_read_b128 v[40:43], v136 offset:34816
    v_mfma_f32_16x16x32_bf16 a[76:79], v[76:79], v[104:107], a[76:79]
    ds_read_b128 v[44:47], v136 offset:35840
    v_mfma_f32_16x16x32_bf16 a[80:83], v[80:83], v[104:107], a[80:83]
    ds_read_b128 v[48:51], v136 offset:36864
    v_mfma_f32_16x16x32_bf16 a[84:87], v[84:87], v[104:107], a[84:87]
    ds_read_b128 v[52:55], v136 offset:37888
    v_mfma_f32_16x16x32_bf16 a[88:91], v[88:91], v[104:107], a[88:91]
    ds_read_b128 v[56:59], v136 offset:38912
    v_mfma_f32_16x16x32_bf16 a[92:95], v[92:95], v[104:107], a[92:95]
    ds_read_b128 v[60:63], v136 offset:39936
    v_mfma_f32_16x16x32_bf16 a[96:99], v[64:67], v[108:111], a[96:99]
    v_mfma_f32_16x16x32_bf16 a[100:103], v[68:71], v[108:111], a[100:103]
    v_mfma_f32_16x16x32_bf16 a[104:107], v[72:75], v[108:111], a[104:107]
    v_mfma_f32_16x16x32_bf16 a[108:111], v[76:79], v[108:111], a[108:111]
    v_mfma_f32_16x16x32_bf16 a[112:115], v[80:83], v[108:111], a[112:115]
    v_mfma_f32_16x16x32_bf16 a[116:119], v[84:87], v[108:111], a[116:119]
    v_mfma_f32_16x16x32_bf16 a[120:123], v[88:91], v[108:111], a[120:123]
    v_mfma_f32_16x16x32_bf16 a[124:127], v[92:95], v[108:111], a[124:127]
    v_mfma_f32_16x16x32_bf16 a[128:131], v[64:67], v[112:115], a[128:131]
    v_mfma_f32_16x16x32_bf16 a[132:135], v[68:71], v[112:115], a[132:135]
    v_mfma_f32_16x16x32_bf16 a[136:139], v[72:75], v[112:115], a[136:139]
    v_mfma_f32_16x16x32_bf16 a[140:143], v[76:79], v[112:115], a[140:143]
    v_mfma_f32_16x16x32_bf16 a[144:147], v[80:83], v[112:115], a[144:147]
    v_mfma_f32_16x16x32_bf16 a[148:151], v[84:87], v[112:115], a[148:151]
    v_mfma_f32_16x16x32_bf16 a[152:155], v[88:91], v[112:115], a[152:155]
    v_mfma_f32_16x16x32_bf16 a[156:159], v[92:95], v[112:115], a[156:159]
    v_mfma_f32_16x16x32_bf16 a[160:163], v[64:67], v[116:119], a[160:163]
    v_mfma_f32_16x16x32_bf16 a[164:167], v[68:71], v[116:119], a[164:167]
    v_mfma_f32_16x16x32_bf16 a[168:171], v[72:75], v[116:119], a[168:171]
    v_mfma_f32_16x16x32_bf16 a[172:175], v[76:79], v[116:119], a[172:175]
    v_mfma_f32_16x16x32_bf16 a[176:179], v[80:83], v[116:119], a[176:179]
    v_mfma_f32_16x16x32_bf16 a[180:183], v[84:87], v[116:119], a[180:183]
    v_mfma_f32_16x16x32_bf16 a[184:187], v[88:91], v[116:119], a[184:187]
    v_mfma_f32_16x16x32_bf16 a[188:191], v[92:95], v[116:119], a[188:191]
    v_mfma_f32_16x16x32_bf16 a[192:195], v[64:67], v[120:123], a[192:195]
    v_mfma_f32_16x16x32_bf16 a[196:199], v[68:71], v[120:123], a[196:199]
    v_mfma_f32_16x16x32_bf16 a[200:203], v[72:75], v[120:123], a[200:203]
    v_mfma_f32_16x16x32_bf16 a[204:207], v[76:79], v[120:123], a[204:207]
    v_mfma_f32_16x16x32_bf16 a[208:211], v[80:83], v[120:123], a[208:211]
    v_mfma_f32_16x16x32_bf16 a[212:215], v[84:87], v[120:123], a[212:215]
    v_mfma_f32_16x16x32_bf16 a[216:219], v[88:91], v[120:123], a[216:219]
    v_mfma_f32_16x16x32_bf16 a[220:223], v[92:95], v[120:123], a[220:223]
    v_mfma_f32_16x16x32_bf16 a[224:227], v[64:67], v[124:127], a[224:227]
    v_mfma_f32_16x16x32_bf16 a[228:231], v[68:71], v[124:127], a[228:231]
    v_mfma_f32_16x16x32_bf16 a[232:235], v[72:75], v[124:127], a[232:235]
    v_mfma_f32_16x16x32_bf16 a[236:239], v[76:79], v[124:127], a[236:239]
    v_mfma_f32_16x16x32_bf16 a[240:243], v[80:83], v[124:127], a[240:243]
    v_mfma_f32_16x16x32_bf16 a[244:247], v[84:87], v[124:127], a[244:247]
    v_mfma_f32_16x16x32_bf16 a[248:251], v[88:91], v[124:127], a[248:251]
    v_mfma_f32_16x16x32_bf16 a[252:255], v[92:95], v[124:127], a[252:255]
    s_waitcnt lgkmcnt(0)
    v_mfma_f32_16x16x32_bf16 a[0:3], v[0:3], v[32:35], a[0:3]
    s_waitcnt vmcnt(0)
    s_barrier
    ds_read_b128 v[96:99], v136 offset:49152
    v_mfma_f32_16x16x32_bf16 a[4:7], v[4:7], v[32:35], a[4:7]
    ds_read_b64_tr_b16 v[64:65], v128 offset:49152
    v_mfma_f32_16x16x32_bf16 a[8:11], v[8:11], v[32:35], a[8:11]
    ds_read_b64_tr_b16 v[66:67], v128 offset:57344
    v_mfma_f32_16x16x32_bf16 a[12:15], v[12:15], v[32:35], a[12:15]
    ds_read_b64_tr_b16 v[68:69], v129 offset:49152
    v_mfma_f32_16x16x32_bf16 a[16:19], v[16:19], v[32:35], a[16:19]
    ds_read_b64_tr_b16 v[70:71], v129 offset:57344
    v_mfma_f32_16x16x32_bf16 a[20:23], v[20:23], v[32:35], a[20:23]
    ds_read_b64_tr_b16 v[72:73], v130 offset:49152
    v_mfma_f32_16x16x32_bf16 a[24:27], v[24:27], v[32:35], a[24:27]
    ds_read_b64_tr_b16 v[74:75], v130 offset:57344
    v_mfma_f32_16x16x32_bf16 a[28:31], v[28:31], v[32:35], a[28:31]
    ds_read_b64_tr_b16 v[76:77], v131 offset:49152
    v_mfma_f32_16x16x32_bf16 a[32:35], v[0:3], v[36:39], a[32:35]
    ds_read_b64_tr_b16 v[78:79], v131 offset:57344
    v_mfma_f32_16x16x32_bf16 a[36:39], v[4:7], v[36:39], a[36:39]
    ds_read_b64_tr_b16 v[80:81], v132 offset:49152
    v_mfma_f32_16x16x32_bf16 a[40:43], v[8:11], v[36:39], a[40:43]
    ds_read_b64_tr_b16 v[82:83], v132 offset:57344
    v_mfma_f32_16x16x32_bf16 a[44:47], v[12:15], v[36:39], a[44:47]
    ds_read_b64_tr_b16 v[84:85], v133 offset:49152
    v_mfma_f32_16x16x32_bf16 a[48:51], v[16:19], v[36:39], a[48:51]
    ds_read_b64_tr_b16 v[86:87], v133 offset:57344
    v_mfma_f32_16x16x32_bf16 a[52:55], v[20:23], v[36:39], a[52:55]
    ds_read_b64_tr_b16 v[88:89], v134 offset:49152
    v_mfma_f32_16x16x32_bf16 a[56:59], v[24:27], v[36:39], a[56:59]
    ds_read_b64_tr_b16 v[90:91], v134 offset:57344
    v_mfma_f32_16x16x32_bf16 a[60:63], v[28:31], v[36:39], a[60:63]
    ds_read_b64_tr_b16 v[92:93], v135 offset:49152
    v_mfma_f32_16x16x32_bf16 a[64:67], v[0:3], v[40:43], a[64:67]
    ds_read_b64_tr_b16 v[94:95], v135 offset:57344
    v_mfma_f32_16x16x32_bf16 a[68:71], v[4:7], v[40:43], a[68:71]
    ds_read_b128 v[100:103], v136 offset:50176
    v_mfma_f32_16x16x32_bf16 a[72:75], v[8:11], v[40:43], a[72:75]
    ds_read_b128 v[104:107], v136 offset:51200
    v_mfma_f32_16x16x32_bf16 a[76:79], v[12:15], v[40:43], a[76:79]
    ds_read_b128 v[108:111], v136 offset:52224
    v_mfma_f32_16x16x32_bf16 a[80:83], v[16:19], v[40:43], a[80:83]
    ds_read_b128 v[112:115], v136 offset:53248
    v_mfma_f32_16x16x32_bf16 a[84:87], v[20:23], v[40:43], a[84:87]
    ds_read_b128 v[116:119], v136 offset:54272
    v_mfma_f32_16x16x32_bf16 a[88:91], v[24:27], v[40:43], a[88:91]
    ds_read_b128 v[120:123], v136 offset:55296
    v_mfma_f32_16x16x32_bf16 a[92:95], v[28:31], v[40:43], a[92:95]
    ds_read_b128 v[124:127], v136 offset:56320
    v_mfma_f32_16x16x32_bf16 a[96:99], v[0:3], v[44:47], a[96:99]
    v_mfma_f32_16x16x32_bf16 a[100:103], v[4:7], v[44:47], a[100:103]
    v_mfma_f32_16x16x32_bf16 a[104:107], v[8:11], v[44:47], a[104:107]
    v_mfma_f32_16x16x32_bf16 a[108:111], v[12:15], v[44:47], a[108:111]
    v_mfma_f32_16x16x32_bf16 a[112:115], v[16:19], v[44:47], a[112:115]
    v_mfma_f32_16x16x32_bf16 a[116:119], v[20:23], v[44:47], a[116:119]
    v_mfma_f32_16x16x32_bf16 a[120:123], v[24:27], v[44:47], a[120:123]
    v_mfma_f32_16x16x32_bf16 a[124:127], v[28:31], v[44:47], a[124:127]
    v_mfma_f32_16x16x32_bf16 a[128:131], v[0:3], v[48:51], a[128:131]
    v_mfma_f32_16x16x32_bf16 a[132:135], v[4:7], v[48:51], a[132:135]
    v_mfma_f32_16x16x32_bf16 a[136:139], v[8:11], v[48:51], a[136:139]
    v_mfma_f32_16x16x32_bf16 a[140:143], v[12:15], v[48:51], a[140:143]
    v_mfma_f32_16x16x32_bf16 a[144:147], v[16:19], v[48:51], a[144:147]
    v_mfma_f32_16x16x32_bf16 a[148:151], v[20:23], v[48:51], a[148:151]
    v_mfma_f32_16x16x32_bf16 a[152:155], v[24:27], v[48:51], a[152:155]
    v_mfma_f32_16x16x32_bf16 a[156:159], v[28:31], v[48:51], a[156:159]
    v_mfma_f32_16x16x32_bf16 a[160:163], v[0:3], v[52:55], a[160:163]
    v_mfma_f32_16x16x32_bf16 a[164:167], v[4:7], v[52:55], a[164:167]
    v_mfma_f32_16x16x32_bf16 a[168:171], v[8:11], v[52:55], a[168:171]
    v_mfma_f32_16x16x32_bf16 a[172:175], v[12:15], v[52:55], a[172:175]
    v_mfma_f32_16x16x32_bf16 a[176:179], v[16:19], v[52:55], a[176:179]
    v_mfma_f32_16x16x32_bf16 a[180:183], v[20:23], v[52:55], a[180:183]
    v_mfma_f32_16x16x32_bf16 a[184:187], v[24:27], v[52:55], a[184:187]
    v_mfma_f32_16x16x32_bf16 a[188:191], v[28:31], v[52:55], a[188:191]
    v_mfma_f32_16x16x32_bf16 a[192:195], v[0:3], v[56:59], a[192:195]
    v_mfma_f32_16x16x32_bf16 a[196:199], v[4:7], v[56:59], a[196:199]
    v_mfma_f32_16x16x32_bf16 a[200:203], v[8:11], v[56:59], a[200:203]
    v_mfma_f32_16x16x32_bf16 a[204:207], v[12:15], v[56:59], a[204:207]
    v_mfma_f32_16x16x32_bf16 a[208:211], v[16:19], v[56:59], a[208:211]
    v_mfma_f32_16x16x32_bf16 a[212:215], v[20:23], v[56:59], a[212:215]
    v_mfma_f32_16x16x32_bf16 a[216:219], v[24:27], v[56:59], a[216:219]
    v_mfma_f32_16x16x32_bf16 a[220:223], v[28:31], v[56:59], a[220:223]
    v_mfma_f32_16x16x32_bf16 a[224:227], v[0:3], v[60:63], a[224:227]
    v_mfma_f32_16x16x32_bf16 a[228:231], v[4:7], v[60:63], a[228:231]
    v_mfma_f32_16x16x32_bf16 a[232:235], v[8:11], v[60:63], a[232:235]
    v_mfma_f32_16x16x32_bf16 a[236:239], v[12:15], v[60:63], a[236:239]
    v_mfma_f32_16x16x32_bf16 a[240:243], v[16:19], v[60:63], a[240:243]
    v_mfma_f32_16x16x32_bf16 a[244:247], v[20:23], v[60:63], a[244:247]
    v_mfma_f32_16x16x32_bf16 a[248:251], v[24:27], v[60:63], a[248:251]
    v_mfma_f32_16x16x32_bf16 a[252:255], v[28:31], v[60:63], a[252:255]
    v_readfirstlane_b32 s55, v255
    s_waitcnt lgkmcnt(0)
    v_mfma_f32_16x16x32_bf16 a[0:3], v[64:67], v[96:99], a[0:3]
    v_mfma_f32_16x16x32_bf16 a[4:7], v[68:71], v[96:99], a[4:7]
    v_mfma_f32_16x16x32_bf16 a[8:11], v[72:75], v[96:99], a[8:11]
    v_mfma_f32_16x16x32_bf16 a[12:15], v[76:79], v[96:99], a[12:15]
    v_mfma_f32_16x16x32_bf16 a[16:19], v[80:83], v[96:99], a[16:19]
    v_mfma_f32_16x16x32_bf16 a[20:23], v[84:87], v[96:99], a[20:23]
    v_mfma_f32_16x16x32_bf16 a[24:27], v[88:91], v[96:99], a[24:27]
    v_mfma_f32_16x16x32_bf16 a[28:31], v[92:95], v[96:99], a[28:31]
    v_mfma_f32_16x16x32_bf16 a[32:35], v[64:67], v[100:103], a[32:35]
    v_mfma_f32_16x16x32_bf16 a[36:39], v[68:71], v[100:103], a[36:39]
    v_mfma_f32_16x16x32_bf16 a[40:43], v[72:75], v[100:103], a[40:43]
    v_mfma_f32_16x16x32_bf16 a[44:47], v[76:79], v[100:103], a[44:47]
    v_mfma_f32_16x16x32_bf16 a[48:51], v[80:83], v[100:103], a[48:51]
    v_mfma_f32_16x16x32_bf16 a[52:55], v[84:87], v[100:103], a[52:55]
    v_mfma_f32_16x16x32_bf16 a[56:59], v[88:91], v[100:103], a[56:59]
    v_mfma_f32_16x16x32_bf16 a[60:63], v[92:95], v[100:103], a[60:63]
    v_mfma_f32_16x16x32_bf16 a[64:67], v[64:67], v[104:107], a[64:67]
    v_mfma_f32_16x16x32_bf16 a[68:71], v[68:71], v[104:107], a[68:71]
    v_mfma_f32_16x16x32_bf16 a[72:75], v[72:75], v[104:107], a[72:75]
    v_mfma_f32_16x16x32_bf16 a[76:79], v[76:79], v[104:107], a[76:79]
    v_mfma_f32_16x16x32_bf16 a[80:83], v[80:83], v[104:107], a[80:83]
    v_mfma_f32_16x16x32_bf16 a[84:87], v[84:87], v[104:107], a[84:87]
    v_mfma_f32_16x16x32_bf16 a[88:91], v[88:91], v[104:107], a[88:91]
    v_mfma_f32_16x16x32_bf16 a[92:95], v[92:95], v[104:107], a[92:95]
    v_mfma_f32_16x16x32_bf16 a[96:99], v[64:67], v[108:111], a[96:99]
    v_mfma_f32_16x16x32_bf16 a[100:103], v[68:71], v[108:111], a[100:103]
    v_mfma_f32_16x16x32_bf16 a[104:107], v[72:75], v[108:111], a[104:107]
    v_mfma_f32_16x16x32_bf16 a[108:111], v[76:79], v[108:111], a[108:111]
    v_mfma_f32_16x16x32_bf16 a[112:115], v[80:83], v[108:111], a[112:115]
    v_mfma_f32_16x16x32_bf16 a[116:119], v[84:87], v[108:111], a[116:119]
    v_mfma_f32_16x16x32_bf16 a[120:123], v[88:91], v[108:111], a[120:123]
    v_mfma_f32_16x16x32_bf16 a[124:127], v[92:95], v[108:111], a[124:127]
    v_mfma_f32_16x16x32_bf16 a[128:131], v[64:67], v[112:115], a[128:131]
    v_mfma_f32_16x16x32_bf16 a[132:135], v[68:71], v[112:115], a[132:135]
    v_mfma_f32_16x16x32_bf16 a[136:139], v[72:75], v[112:115], a[136:139]
    v_mfma_f32_16x16x32_bf16 a[140:143], v[76:79], v[112:115], a[140:143]
    v_mfma_f32_16x16x32_bf16 a[144:147], v[80:83], v[112:115], a[144:147]
    v_mfma_f32_16x16x32_bf16 a[148:151], v[84:87], v[112:115], a[148:151]
    v_mfma_f32_16x16x32_bf16 a[152:155], v[88:91], v[112:115], a[152:155]
    v_mfma_f32_16x16x32_bf16 a[156:159], v[92:95], v[112:115], a[156:159]
    v_mfma_f32_16x16x32_bf16 a[160:163], v[64:67], v[116:119], a[160:163]
    v_mfma_f32_16x16x32_bf16 a[164:167], v[68:71], v[116:119], a[164:167]
    v_mfma_f32_16x16x32_bf16 a[168:171], v[72:75], v[116:119], a[168:171]
    v_mfma_f32_16x16x32_bf16 a[172:175], v[76:79], v[116:119], a[172:175]
    v_mfma_f32_16x16x32_bf16 a[176:179], v[80:83], v[116:119], a[176:179]
    v_mfma_f32_16x16x32_bf16 a[180:183], v[84:87], v[116:119], a[180:183]
    v_mfma_f32_16x16x32_bf16 a[184:187], v[88:91], v[116:119], a[184:187]
    v_mfma_f32_16x16x32_bf16 a[188:191], v[92:95], v[116:119], a[188:191]
    v_mfma_f32_16x16x32_bf16 a[192:195], v[64:67], v[120:123], a[192:195]
    v_mfma_f32_16x16x32_bf16 a[196:199], v[68:71], v[120:123], a[196:199]
    v_mfma_f32_16x16x32_bf16 a[200:203], v[72:75], v[120:123], a[200:203]
    v_mfma_f32_16x16x32_bf16 a[204:207], v[76:79], v[120:123], a[204:207]
    v_mfma_f32_16x16x32_bf16 a[208:211], v[80:83], v[120:123], a[208:211]
    v_mfma_f32_16x16x32_bf16 a[212:215], v[84:87], v[120:123], a[212:215]
    v_mfma_f32_16x16x32_bf16 a[216:219], v[88:91], v[120:123], a[216:219]
    v_mfma_f32_16x16x32_bf16 a[220:223], v[92:95], v[120:123], a[220:223]
    v_mfma_f32_16x16x32_bf16 a[224:227], v[64:67], v[124:127], a[224:227]
    v_mfma_f32_16x16x32_bf16 a[228:231], v[68:71], v[124:127], a[228:231]
    v_mfma_f32_16x16x32_bf16 a[232:235], v[72:75], v[124:127], a[232:235]
    v_mfma_f32_16x16x32_bf16 a[236:239], v[76:79], v[124:127], a[236:239]
    v_mfma_f32_16x16x32_bf16 a[240:243], v[80:83], v[124:127], a[240:243]
    v_mfma_f32_16x16x32_bf16 a[244:247], v[84:87], v[124:127], a[244:247]
    v_mfma_f32_16x16x32_bf16 a[248:251], v[88:91], v[124:127], a[248:251]
    v_mfma_f32_16x16x32_bf16 a[252:255], v[92:95], v[124:127], a[252:255]
    s_nop 7
    s_cmp_eq_u32 s23, 1
    s_cbranch_scc1 main_kernel_w_c2_escl
    s_cmp_eq_u32 s23, 6
    s_cbranch_scc1 main_kernel_w_c2_egelu
main_kernel_w_c2_eplain:
    s_mov_b32 s53, s21
    v_accvgpr_read_b32 v0, a0
    v_accvgpr_read_b32 v1, a1
    v_accvgpr_read_b32 v2, a2
    v_accvgpr_read_b32 v3, a3
    v_accvgpr_read_b32 v4, a4
    v_accvgpr_read_b32 v5, a5
    v_accvgpr_read_b32 v6, a6
    v_accvgpr_read_b32 v7, a7
    v_cvt_pk_bf16_f32 v16, v0, v1
    v_cvt_pk_bf16_f32 v17, v2, v3
    v_cvt_pk_bf16_f32 v18, v4, v5
    v_cvt_pk_bf16_f32 v19, v6, v7
    buffer_store_dwordx4 v[16:19], v251, s[4:7], s53 offen offset:0 sc1
    v_accvgpr_read_b32 v20, a8
    v_accvgpr_read_b32 v21, a9
    v_accvgpr_read_b32 v22, a10
    v_accvgpr_read_b32 v23, a11
    v_accvgpr_read_b32 v24, a12
    v_accvgpr_read_b32 v25, a13
    v_accvgpr_read_b32 v26, a14
    v_accvgpr_read_b32 v27, a15
    v_cvt_pk_bf16_f32 v36, v20, v21
    v_cvt_pk_bf16_f32 v37, v22, v23
    v_cvt_pk_bf16_f32 v38, v24, v25
    v_cvt_pk_bf16_f32 v39, v26, v27
    buffer_store_dwordx4 v[36:39], v251, s[4:7], s53 offen offset:1024 sc1
    v_accvgpr_read_b32 v40, a16
    v_accvgpr_read_b32 v41, a17
    v_accvgpr_read_b32 v42, a18
    v_accvgpr_read_b32 v43, a19
    v_accvgpr_read_b32 v44, a20
    v_accvgpr_read_b32 v45, a21
    v_accvgpr_read_b32 v46, a22
    v_accvgpr_read_b32 v47, a23
    v_cvt_pk_bf16_f32 v56, v40, v41
    v_cvt_pk_bf16_f32 v57, v42, v43
    v_cvt_pk_bf16_f32 v58, v44, v45
    v_cvt_pk_bf16_f32 v59, v46, v47
    buffer_store_dwordx4 v[56:59], v251, s[4:7], s53 offen offset:2048 sc1
    v_accvgpr_read_b32 v0, a24
    v_accvgpr_read_b32 v1, a25
    v_accvgpr_read_b32 v2, a26
    v_accvgpr_read_b32 v3, a27
    v_accvgpr_read_b32 v4, a28
    v_accvgpr_read_b32 v5, a29
    v_accvgpr_read_b32 v6, a30
    v_accvgpr_read_b32 v7, a31
    v_cvt_pk_bf16_f32 v16, v0, v1
    v_cvt_pk_bf16_f32 v17, v2, v3
    v_cvt_pk_bf16_f32 v18, v4, v5
    v_cvt_pk_bf16_f32 v19, v6, v7
    buffer_store_dwordx4 v[16:19], v251, s[4:7], s53 offen offset:3072 sc1
    s_add_u32 s53, s53, s22
    v_accvgpr_read_b32 v20, a32
    v_accvgpr_read_b32 v21, a33
    v_accvgpr_read_b32 v22, a34
    v_accvgpr_read_b32 v23, a35
    v_accvgpr_read_b32 v24, a36
    v_accvgpr_read_b32 v25, a37
    v_accvgpr_read_b32 v26, a38
    v_accvgpr_read_b32 v27, a39
    v_cvt_pk_bf16_f32 v36, v20, v21
    v_cvt_pk_bf16_f32 v37, v22, v23
    v_cvt_pk_bf16_f32 v38, v24, v25
    v_cvt_pk_bf16_f32 v39, v26, v27
    buffer_store_dwordx4 v[36:39], v251, s[4:7], s53 offen offset:0 sc1
    v_accvgpr_read_b32 v40, a40
    v_accvgpr_read_b32 v41, a41
    v_accvgpr_read_b32 v42, a42
    v_accvgpr_read_b32 v43, a43
    v_accvgpr_read_b32 v44, a44
    v_accvgpr_read_b32 v45, a45
    v_accvgpr_read_b32 v46, a46
    v_accvgpr_read_b32 v47, a47
    v_cvt_pk_bf16_f32 v56, v40, v41
    v_cvt_pk_bf16_f32 v57, v42, v43
    v_cvt_pk_bf16_f32 v58, v44, v45
    v_cvt_pk_bf16_f32 v59, v46, v47
    buffer_store_dwordx4 v[56:59], v251, s[4:7], s53 offen offset:1024 sc1
    v_accvgpr_read_b32 v0, a48
    v_accvgpr_read_b32 v1, a49
    v_accvgpr_read_b32 v2, a50
    v_accvgpr_read_b32 v3, a51
    v_accvgpr_read_b32 v4, a52
    v_accvgpr_read_b32 v5, a53
    v_accvgpr_read_b32 v6, a54
    v_accvgpr_read_b32 v7, a55
    v_cvt_pk_bf16_f32 v16, v0, v1
    v_cvt_pk_bf16_f32 v17, v2, v3
    v_cvt_pk_bf16_f32 v18, v4, v5
    v_cvt_pk_bf16_f32 v19, v6, v7
    buffer_store_dwordx4 v[16:19], v251, s[4:7], s53 offen offset:2048 sc1
    v_accvgpr_read_b32 v20, a56
    v_accvgpr_read_b32 v21, a57
    v_accvgpr_read_b32 v22, a58
    v_accvgpr_read_b32 v23, a59
    v_accvgpr_read_b32 v24, a60
    v_accvgpr_read_b32 v25, a61
    v_accvgpr_read_b32 v26, a62
    v_accvgpr_read_b32 v27, a63
    v_cvt_pk_bf16_f32 v36, v20, v21
    v_cvt_pk_bf16_f32 v37, v22, v23
    v_cvt_pk_bf16_f32 v38, v24, v25
    v_cvt_pk_bf16_f32 v39, v26, v27
    buffer_store_dwordx4 v[36:39], v251, s[4:7], s53 offen offset:3072 sc1
    s_add_u32 s53, s53, s22
    v_accvgpr_read_b32 v40, a64
    v_accvgpr_read_b32 v41, a65
    v_accvgpr_read_b32 v42, a66
    v_accvgpr_read_b32 v43, a67
    v_accvgpr_read_b32 v44, a68
    v_accvgpr_read_b32 v45, a69
    v_accvgpr_read_b32 v46, a70
    v_accvgpr_read_b32 v47, a71
    v_cvt_pk_bf16_f32 v56, v40, v41
    v_cvt_pk_bf16_f32 v57, v42, v43
    v_cvt_pk_bf16_f32 v58, v44, v45
    v_cvt_pk_bf16_f32 v59, v46, v47
    buffer_store_dwordx4 v[56:59], v251, s[4:7], s53 offen offset:0 sc1
    v_accvgpr_read_b32 v0, a72
    v_accvgpr_read_b32 v1, a73
    v_accvgpr_read_b32 v2, a74
    v_accvgpr_read_b32 v3, a75
    v_accvgpr_read_b32 v4, a76
    v_accvgpr_read_b32 v5, a77
    v_accvgpr_read_b32 v6, a78
    v_accvgpr_read_b32 v7, a79
    v_cvt_pk_bf16_f32 v16, v0, v1
    v_cvt_pk_bf16_f32 v17, v2, v3
    v_cvt_pk_bf16_f32 v18, v4, v5
    v_cvt_pk_bf16_f32 v19, v6, v7
    buffer_store_dwordx4 v[16:19], v251, s[4:7], s53 offen offset:1024 sc1
    v_accvgpr_read_b32 v20, a80
    v_accvgpr_read_b32 v21, a81
    v_accvgpr_read_b32 v22, a82
    v_accvgpr_read_b32 v23, a83
    v_accvgpr_read_b32 v24, a84
    v_accvgpr_read_b32 v25, a85
    v_accvgpr_read_b32 v26, a86
    v_accvgpr_read_b32 v27, a87
    v_cvt_pk_bf16_f32 v36, v20, v21
    v_cvt_pk_bf16_f32 v37, v22, v23
    v_cvt_pk_bf16_f32 v38, v24, v25
    v_cvt_pk_bf16_f32 v39, v26, v27
    buffer_store_dwordx4 v[36:39], v251, s[4:7], s53 offen offset:2048 sc1
    v_accvgpr_read_b32 v40, a88
    v_accvgpr_read_b32 v41, a89
    v_accvgpr_read_b32 v42, a90
    v_accvgpr_read_b32 v43, a91
    v_accvgpr_read_b32 v44, a92
    v_accvgpr_read_b32 v45, a93
    v_accvgpr_read_b32 v46, a94
    v_accvgpr_read_b32 v47, a95
    v_cvt_pk_bf16_f32 v56, v40, v41
    v_cvt_pk_bf16_f32 v57, v42, v43
    v_cvt_pk_bf16_f32 v58, v44, v45
    v_cvt_pk_bf16_f32 v59, v46, v47
    buffer_store_dwordx4 v[56:59], v251, s[4:7], s53 offen offset:3072 sc1
    s_add_u32 s53, s53, s22
    v_accvgpr_read_b32 v0, a96
    v_accvgpr_read_b32 v1, a97
    v_accvgpr_read_b32 v2, a98
    v_accvgpr_read_b32 v3, a99
    v_accvgpr_read_b32 v4, a100
    v_accvgpr_read_b32 v5, a101
    v_accvgpr_read_b32 v6, a102
    v_accvgpr_read_b32 v7, a103
    v_cvt_pk_bf16_f32 v16, v0, v1
    v_cvt_pk_bf16_f32 v17, v2, v3
    v_cvt_pk_bf16_f32 v18, v4, v5
    v_cvt_pk_bf16_f32 v19, v6, v7
    buffer_store_dwordx4 v[16:19], v251, s[4:7], s53 offen offset:0 sc1
    v_accvgpr_read_b32 v20, a104
    v_accvgpr_read_b32 v21, a105
    v_accvgpr_read_b32 v22, a106
    v_accvgpr_read_b32 v23, a107
    v_accvgpr_read_b32 v24, a108
    v_accvgpr_read_b32 v25, a109
    v_accvgpr_read_b32 v26, a110
    v_accvgpr_read_b32 v27, a111
    v_cvt_pk_bf16_f32 v36, v20, v21
    v_cvt_pk_bf16_f32 v37, v22, v23
    v_cvt_pk_bf16_f32 v38, v24, v25
    v_cvt_pk_bf16_f32 v39, v26, v27
    buffer_store_dwordx4 v[36:39], v251, s[4:7], s53 offen offset:1024 sc1
    v_accvgpr_read_b32 v40, a112
    v_accvgpr_read_b32 v41, a113
    v_accvgpr_read_b32 v42, a114
    v_accvgpr_read_b32 v43, a115
    v_accvgpr_read_b32 v44, a116
    v_accvgpr_read_b32 v45, a117
    v_accvgpr_read_b32 v46, a118
    v_accvgpr_read_b32 v47, a119
    v_cvt_pk_bf16_f32 v56, v40, v41
    v_cvt_pk_bf16_f32 v57, v42, v43
    v_cvt_pk_bf16_f32 v58, v44, v45
    v_cvt_pk_bf16_f32 v59, v46, v47
    buffer_store_dwordx4 v[56:59], v251, s[4:7], s53 offen offset:2048 sc1
    v_accvgpr_read_b32 v0, a120
    v_accvgpr_read_b32 v1, a121
    v_accvgpr_read_b32 v2, a122
    v_accvgpr_read_b32 v3, a123
    v_accvgpr_read_b32 v4, a124
    v_accvgpr_read_b32 v5, a125
    v_accvgpr_read_b32 v6, a126
    v_accvgpr_read_b32 v7, a127
    v_cvt_pk_bf16_f32 v16, v0, v1
    v_cvt_pk_bf16_f32 v17, v2, v3
    v_cvt_pk_bf16_f32 v18, v4, v5
    v_cvt_pk_bf16_f32 v19, v6, v7
    buffer_store_dwordx4 v[16:19], v251, s[4:7], s53 offen offset:3072 sc1
    s_add_u32 s53, s53, s22
    v_accvgpr_read_b32 v20, a128
    v_accvgpr_read_b32 v21, a129
    v_accvgpr_read_b32 v22, a130
    v_accvgpr_read_b32 v23, a131
    v_accvgpr_read_b32 v24, a132
    v_accvgpr_read_b32 v25, a133
    v_accvgpr_read_b32 v26, a134
    v_accvgpr_read_b32 v27, a135
    v_cvt_pk_bf16_f32 v36, v20, v21
    v_cvt_pk_bf16_f32 v37, v22, v23
    v_cvt_pk_bf16_f32 v38, v24, v25
    v_cvt_pk_bf16_f32 v39, v26, v27
    buffer_store_dwordx4 v[36:39], v251, s[4:7], s53 offen offset:0 sc1
    v_accvgpr_read_b32 v40, a136
    v_accvgpr_read_b32 v41, a137
    v_accvgpr_read_b32 v42, a138
    v_accvgpr_read_b32 v43, a139
    v_accvgpr_read_b32 v44, a140
    v_accvgpr_read_b32 v45, a141
    v_accvgpr_read_b32 v46, a142
    v_accvgpr_read_b32 v47, a143
    v_cvt_pk_bf16_f32 v56, v40, v41
    v_cvt_pk_bf16_f32 v57, v42, v43
    v_cvt_pk_bf16_f32 v58, v44, v45
    v_cvt_pk_bf16_f32 v59, v46, v47
    buffer_store_dwordx4 v[56:59], v251, s[4:7], s53 offen offset:1024 sc1
    v_accvgpr_read_b32 v0, a144
    v_accvgpr_read_b32 v1, a145
    v_accvgpr_read_b32 v2, a146
    v_accvgpr_read_b32 v3, a147
    v_accvgpr_read_b32 v4, a148
    v_accvgpr_read_b32 v5, a149
    v_accvgpr_read_b32 v6, a150
    v_accvgpr_read_b32 v7, a151
    v_cvt_pk_bf16_f32 v16, v0, v1
    v_cvt_pk_bf16_f32 v17, v2, v3
    v_cvt_pk_bf16_f32 v18, v4, v5
    v_cvt_pk_bf16_f32 v19, v6, v7
    buffer_store_dwordx4 v[16:19], v251, s[4:7], s53 offen offset:2048 sc1
    v_accvgpr_read_b32 v20, a152
    v_accvgpr_read_b32 v21, a153
    v_accvgpr_read_b32 v22, a154
    v_accvgpr_read_b32 v23, a155
    v_accvgpr_read_b32 v24, a156
    v_accvgpr_read_b32 v25, a157
    v_accvgpr_read_b32 v26, a158
    v_accvgpr_read_b32 v27, a159
    v_cvt_pk_bf16_f32 v36, v20, v21
    v_cvt_pk_bf16_f32 v37, v22, v23
    v_cvt_pk_bf16_f32 v38, v24, v25
    v_cvt_pk_bf16_f32 v39, v26, v27
    buffer_store_dwordx4 v[36:39], v251, s[4:7], s53 offen offset:3072 sc1
    s_add_u32 s53, s53, s22
    v_accvgpr_read_b32 v40, a160
    v_accvgpr_read_b32 v41, a161
    v_accvgpr_read_b32 v42, a162
    v_accvgpr_read_b32 v43, a163
    v_accvgpr_read_b32 v44, a164
    v_accvgpr_read_b32 v45, a165
    v_accvgpr_read_b32 v46, a166
    v_accvgpr_read_b32 v47, a167
    v_cvt_pk_bf16_f32 v56, v40, v41
    v_cvt_pk_bf16_f32 v57, v42, v43
    v_cvt_pk_bf16_f32 v58, v44, v45
    v_cvt_pk_bf16_f32 v59, v46, v47
    buffer_store_dwordx4 v[56:59], v251, s[4:7], s53 offen offset:0 sc1
    v_accvgpr_read_b32 v0, a168
    v_accvgpr_read_b32 v1, a169
    v_accvgpr_read_b32 v2, a170
    v_accvgpr_read_b32 v3, a171
    v_accvgpr_read_b32 v4, a172
    v_accvgpr_read_b32 v5, a173
    v_accvgpr_read_b32 v6, a174
    v_accvgpr_read_b32 v7, a175
    v_cvt_pk_bf16_f32 v16, v0, v1
    v_cvt_pk_bf16_f32 v17, v2, v3
    v_cvt_pk_bf16_f32 v18, v4, v5
    v_cvt_pk_bf16_f32 v19, v6, v7
    buffer_store_dwordx4 v[16:19], v251, s[4:7], s53 offen offset:1024 sc1
    v_accvgpr_read_b32 v20, a176
    v_accvgpr_read_b32 v21, a177
    v_accvgpr_read_b32 v22, a178
    v_accvgpr_read_b32 v23, a179
    v_accvgpr_read_b32 v24, a180
    v_accvgpr_read_b32 v25, a181
    v_accvgpr_read_b32 v26, a182
    v_accvgpr_read_b32 v27, a183
    v_cvt_pk_bf16_f32 v36, v20, v21
    v_cvt_pk_bf16_f32 v37, v22, v23
    v_cvt_pk_bf16_f32 v38, v24, v25
    v_cvt_pk_bf16_f32 v39, v26, v27
    buffer_store_dwordx4 v[36:39], v251, s[4:7], s53 offen offset:2048 sc1
    v_accvgpr_read_b32 v40, a184
    v_accvgpr_read_b32 v41, a185
    v_accvgpr_read_b32 v42, a186
    v_accvgpr_read_b32 v43, a187
    v_accvgpr_read_b32 v44, a188
    v_accvgpr_read_b32 v45, a189
    v_accvgpr_read_b32 v46, a190
    v_accvgpr_read_b32 v47, a191
    v_cvt_pk_bf16_f32 v56, v40, v41
    v_cvt_pk_bf16_f32 v57, v42, v43
    v_cvt_pk_bf16_f32 v58, v44, v45
    v_cvt_pk_bf16_f32 v59, v46, v47
    buffer_store_dwordx4 v[56:59], v251, s[4:7], s53 offen offset:3072 sc1
    s_add_u32 s53, s53, s22
    v_accvgpr_read_b32 v0, a192
    v_accvgpr_read_b32 v1, a193
    v_accvgpr_read_b32 v2, a194
    v_accvgpr_read_b32 v3, a195
    v_accvgpr_read_b32 v4, a196
    v_accvgpr_read_b32 v5, a197
    v_accvgpr_read_b32 v6, a198
    v_accvgpr_read_b32 v7, a199
    v_cvt_pk_bf16_f32 v16, v0, v1
    v_cvt_pk_bf16_f32 v17, v2, v3
    v_cvt_pk_bf16_f32 v18, v4, v5
    v_cvt_pk_bf16_f32 v19, v6, v7
    buffer_store_dwordx4 v[16:19], v251, s[4:7], s53 offen offset:0 sc1
    v_accvgpr_read_b32 v20, a200
    v_accvgpr_read_b32 v21, a201
    v_accvgpr_read_b32 v22, a202
    v_accvgpr_read_b32 v23, a203
    v_accvgpr_read_b32 v24, a204
    v_accvgpr_read_b32 v25, a205
    v_accvgpr_read_b32 v26, a206
    v_accvgpr_read_b32 v27, a207
    v_cvt_pk_bf16_f32 v36, v20, v21
    v_cvt_pk_bf16_f32 v37, v22, v23
    v_cvt_pk_bf16_f32 v38, v24, v25
    v_cvt_pk_bf16_f32 v39, v26, v27
    buffer_store_dwordx4 v[36:39], v251, s[4:7], s53 offen offset:1024 sc1
    v_accvgpr_read_b32 v40, a208
    v_accvgpr_read_b32 v41, a209
    v_accvgpr_read_b32 v42, a210
    v_accvgpr_read_b32 v43, a211
    v_accvgpr_read_b32 v44, a212
    v_accvgpr_read_b32 v45, a213
    v_accvgpr_read_b32 v46, a214
    v_accvgpr_read_b32 v47, a215
    v_cvt_pk_bf16_f32 v56, v40, v41
    v_cvt_pk_bf16_f32 v57, v42, v43
    v_cvt_pk_bf16_f32 v58, v44, v45
    v_cvt_pk_bf16_f32 v59, v46, v47
    buffer_store_dwordx4 v[56:59], v251, s[4:7], s53 offen offset:2048 sc1
    v_accvgpr_read_b32 v0, a216
    v_accvgpr_read_b32 v1, a217
    v_accvgpr_read_b32 v2, a218
    v_accvgpr_read_b32 v3, a219
    v_accvgpr_read_b32 v4, a220
    v_accvgpr_read_b32 v5, a221
    v_accvgpr_read_b32 v6, a222
    v_accvgpr_read_b32 v7, a223
    v_cvt_pk_bf16_f32 v16, v0, v1
    v_cvt_pk_bf16_f32 v17, v2, v3
    v_cvt_pk_bf16_f32 v18, v4, v5
    v_cvt_pk_bf16_f32 v19, v6, v7
    buffer_store_dwordx4 v[16:19], v251, s[4:7], s53 offen offset:3072 sc1
    s_add_u32 s53, s53, s22
    v_accvgpr_read_b32 v20, a224
    v_accvgpr_read_b32 v21, a225
    v_accvgpr_read_b32 v22, a226
    v_accvgpr_read_b32 v23, a227
    v_accvgpr_read_b32 v24, a228
    v_accvgpr_read_b32 v25, a229
    v_accvgpr_read_b32 v26, a230
    v_accvgpr_read_b32 v27, a231
    v_cvt_pk_bf16_f32 v36, v20, v21
    v_cvt_pk_bf16_f32 v37, v22, v23
    v_cvt_pk_bf16_f32 v38, v24, v25
    v_cvt_pk_bf16_f32 v39, v26, v27
    buffer_store_dwordx4 v[36:39], v251, s[4:7], s53 offen offset:0 sc1
    v_accvgpr_read_b32 v40, a232
    v_accvgpr_read_b32 v41, a233
    v_accvgpr_read_b32 v42, a234
    v_accvgpr_read_b32 v43, a235
    v_accvgpr_read_b32 v44, a236
    v_accvgpr_read_b32 v45, a237
    v_accvgpr_read_b32 v46, a238
    v_accvgpr_read_b32 v47, a239
    v_cvt_pk_bf16_f32 v56, v40, v41
    v_cvt_pk_bf16_f32 v57, v42, v43
    v_cvt_pk_bf16_f32 v58, v44, v45
    v_cvt_pk_bf16_f32 v59, v46, v47
    buffer_store_dwordx4 v[56:59], v251, s[4:7], s53 offen offset:1024 sc1
    v_accvgpr_read_b32 v0, a240
    v_accvgpr_read_b32 v1, a241
    v_accvgpr_read_b32 v2, a242
    v_accvgpr_read_b32 v3, a243
    v_accvgpr_read_b32 v4, a244
    v_accvgpr_read_b32 v5, a245
    v_accvgpr_read_b32 v6, a246
    v_accvgpr_read_b32 v7, a247
    v_cvt_pk_bf16_f32 v16, v0, v1
    v_cvt_pk_bf16_f32 v17, v2, v3
    v_cvt_pk_bf16_f32 v18, v4, v5
    v_cvt_pk_bf16_f32 v19, v6, v7
    buffer_store_dwordx4 v[16:19], v251, s[4:7], s53 offen offset:2048 sc1
    v_accvgpr_read_b32 v20, a248
    v_accvgpr_read_b32 v21, a249
    v_accvgpr_read_b32 v22, a250
    v_accvgpr_read_b32 v23, a251
    v_accvgpr_read_b32 v24, a252
    v_accvgpr_read_b32 v25, a253
    v_accvgpr_read_b32 v26, a254
    v_accvgpr_read_b32 v27, a255
    v_cvt_pk_bf16_f32 v36, v20, v21
    v_cvt_pk_bf16_f32 v37, v22, v23
    v_cvt_pk_bf16_f32 v38, v24, v25
    v_cvt_pk_bf16_f32 v39, v26, v27
    buffer_store_dwordx4 v[36:39], v251, s[4:7], s53 offen offset:3072 sc1
    s_branch main_kernel_w_done
main_kernel_w_c2_escl:
    s_mov_b32 s53, s21
    v_accvgpr_read_b32 v0, a0
    v_accvgpr_read_b32 v1, a1
    v_accvgpr_read_b32 v2, a2
    v_accvgpr_read_b32 v3, a3
    v_accvgpr_read_b32 v4, a4
    v_accvgpr_read_b32 v5, a5
    v_accvgpr_read_b32 v6, a6
    v_accvgpr_read_b32 v7, a7
    v_mul_f32 v0, 0x3e0293ee, v0
    v_mul_f32 v1, 0x3e0293ee, v1
    v_mul_f32 v2, 0x3e0293ee, v2
    v_mul_f32 v3, 0x3e0293ee, v3
    v_mul_f32 v4, 0x3e0293ee, v4
    v_mul_f32 v5, 0x3e0293ee, v5
    v_mul_f32 v6, 0x3e0293ee, v6
    v_mul_f32 v7, 0x3e0293ee, v7
    v_cvt_pk_bf16_f32 v16, v0, v1
    v_cvt_pk_bf16_f32 v17, v2, v3
    v_cvt_pk_bf16_f32 v18, v4, v5
    v_cvt_pk_bf16_f32 v19, v6, v7
    buffer_store_dwordx4 v[16:19], v251, s[4:7], s53 offen offset:0 sc1
    v_accvgpr_read_b32 v20, a8
    v_accvgpr_read_b32 v21, a9
    v_accvgpr_read_b32 v22, a10
    v_accvgpr_read_b32 v23, a11
    v_accvgpr_read_b32 v24, a12
    v_accvgpr_read_b32 v25, a13
    v_accvgpr_read_b32 v26, a14
    v_accvgpr_read_b32 v27, a15
    v_mul_f32 v20, 0x3e0293ee, v20
    v_mul_f32 v21, 0x3e0293ee, v21
    v_mul_f32 v22, 0x3e0293ee, v22
    v_mul_f32 v23, 0x3e0293ee, v23
    v_mul_f32 v24, 0x3e0293ee, v24
    v_mul_f32 v25, 0x3e0293ee, v25
    v_mul_f32 v26, 0x3e0293ee, v26
    v_mul_f32 v27, 0x3e0293ee, v27
    v_cvt_pk_bf16_f32 v36, v20, v21
    v_cvt_pk_bf16_f32 v37, v22, v23
    v_cvt_pk_bf16_f32 v38, v24, v25
    v_cvt_pk_bf16_f32 v39, v26, v27
    buffer_store_dwordx4 v[36:39], v251, s[4:7], s53 offen offset:1024 sc1
    v_accvgpr_read_b32 v40, a16
    v_accvgpr_read_b32 v41, a17
    v_accvgpr_read_b32 v42, a18
    v_accvgpr_read_b32 v43, a19
    v_accvgpr_read_b32 v44, a20
    v_accvgpr_read_b32 v45, a21
    v_accvgpr_read_b32 v46, a22
    v_accvgpr_read_b32 v47, a23
    v_mul_f32 v40, 0x3e0293ee, v40
    v_mul_f32 v41, 0x3e0293ee, v41
    v_mul_f32 v42, 0x3e0293ee, v42
    v_mul_f32 v43, 0x3e0293ee, v43
    v_mul_f32 v44, 0x3e0293ee, v44
    v_mul_f32 v45, 0x3e0293ee, v45
    v_mul_f32 v46, 0x3e0293ee, v46
    v_mul_f32 v47, 0x3e0293ee, v47
    v_cvt_pk_bf16_f32 v56, v40, v41
    v_cvt_pk_bf16_f32 v57, v42, v43
    v_cvt_pk_bf16_f32 v58, v44, v45
    v_cvt_pk_bf16_f32 v59, v46, v47
    buffer_store_dwordx4 v[56:59], v251, s[4:7], s53 offen offset:2048 sc1
    v_accvgpr_read_b32 v0, a24
    v_accvgpr_read_b32 v1, a25
    v_accvgpr_read_b32 v2, a26
    v_accvgpr_read_b32 v3, a27
    v_accvgpr_read_b32 v4, a28
    v_accvgpr_read_b32 v5, a29
    v_accvgpr_read_b32 v6, a30
    v_accvgpr_read_b32 v7, a31
    v_mul_f32 v0, 0x3e0293ee, v0
    v_mul_f32 v1, 0x3e0293ee, v1
    v_mul_f32 v2, 0x3e0293ee, v2
    v_mul_f32 v3, 0x3e0293ee, v3
    v_mul_f32 v4, 0x3e0293ee, v4
    v_mul_f32 v5, 0x3e0293ee, v5
    v_mul_f32 v6, 0x3e0293ee, v6
    v_mul_f32 v7, 0x3e0293ee, v7
    v_cvt_pk_bf16_f32 v16, v0, v1
    v_cvt_pk_bf16_f32 v17, v2, v3
    v_cvt_pk_bf16_f32 v18, v4, v5
    v_cvt_pk_bf16_f32 v19, v6, v7
    buffer_store_dwordx4 v[16:19], v251, s[4:7], s53 offen offset:3072 sc1
    s_add_u32 s53, s53, s22
    v_accvgpr_read_b32 v20, a32
    v_accvgpr_read_b32 v21, a33
    v_accvgpr_read_b32 v22, a34
    v_accvgpr_read_b32 v23, a35
    v_accvgpr_read_b32 v24, a36
    v_accvgpr_read_b32 v25, a37
    v_accvgpr_read_b32 v26, a38
    v_accvgpr_read_b32 v27, a39
    v_mul_f32 v20, 0x3e0293ee, v20
    v_mul_f32 v21, 0x3e0293ee, v21
    v_mul_f32 v22, 0x3e0293ee, v22
    v_mul_f32 v23, 0x3e0293ee, v23
    v_mul_f32 v24, 0x3e0293ee, v24
    v_mul_f32 v25, 0x3e0293ee, v25
    v_mul_f32 v26, 0x3e0293ee, v26
    v_mul_f32 v27, 0x3e0293ee, v27
    v_cvt_pk_bf16_f32 v36, v20, v21
    v_cvt_pk_bf16_f32 v37, v22, v23
    v_cvt_pk_bf16_f32 v38, v24, v25
    v_cvt_pk_bf16_f32 v39, v26, v27
    buffer_store_dwordx4 v[36:39], v251, s[4:7], s53 offen offset:0 sc1
    v_accvgpr_read_b32 v40, a40
    v_accvgpr_read_b32 v41, a41
    v_accvgpr_read_b32 v42, a42
    v_accvgpr_read_b32 v43, a43
    v_accvgpr_read_b32 v44, a44
    v_accvgpr_read_b32 v45, a45
    v_accvgpr_read_b32 v46, a46
    v_accvgpr_read_b32 v47, a47
    v_mul_f32 v40, 0x3e0293ee, v40
    v_mul_f32 v41, 0x3e0293ee, v41
    v_mul_f32 v42, 0x3e0293ee, v42
    v_mul_f32 v43, 0x3e0293ee, v43
    v_mul_f32 v44, 0x3e0293ee, v44
    v_mul_f32 v45, 0x3e0293ee, v45
    v_mul_f32 v46, 0x3e0293ee, v46
    v_mul_f32 v47, 0x3e0293ee, v47
    v_cvt_pk_bf16_f32 v56, v40, v41
    v_cvt_pk_bf16_f32 v57, v42, v43
    v_cvt_pk_bf16_f32 v58, v44, v45
    v_cvt_pk_bf16_f32 v59, v46, v47
    buffer_store_dwordx4 v[56:59], v251, s[4:7], s53 offen offset:1024 sc1
    v_accvgpr_read_b32 v0, a48
    v_accvgpr_read_b32 v1, a49
    v_accvgpr_read_b32 v2, a50
    v_accvgpr_read_b32 v3, a51
    v_accvgpr_read_b32 v4, a52
    v_accvgpr_read_b32 v5, a53
    v_accvgpr_read_b32 v6, a54
    v_accvgpr_read_b32 v7, a55
    v_mul_f32 v0, 0x3e0293ee, v0
    v_mul_f32 v1, 0x3e0293ee, v1
    v_mul_f32 v2, 0x3e0293ee, v2
    v_mul_f32 v3, 0x3e0293ee, v3
    v_mul_f32 v4, 0x3e0293ee, v4
    v_mul_f32 v5, 0x3e0293ee, v5
    v_mul_f32 v6, 0x3e0293ee, v6
    v_mul_f32 v7, 0x3e0293ee, v7
    v_cvt_pk_bf16_f32 v16, v0, v1
    v_cvt_pk_bf16_f32 v17, v2, v3
    v_cvt_pk_bf16_f32 v18, v4, v5
    v_cvt_pk_bf16_f32 v19, v6, v7
    buffer_store_dwordx4 v[16:19], v251, s[4:7], s53 offen offset:2048 sc1
    v_accvgpr_read_b32 v20, a56
    v_accvgpr_read_b32 v21, a57
    v_accvgpr_read_b32 v22, a58
    v_accvgpr_read_b32 v23, a59
    v_accvgpr_read_b32 v24, a60
    v_accvgpr_read_b32 v25, a61
    v_accvgpr_read_b32 v26, a62
    v_accvgpr_read_b32 v27, a63
    v_mul_f32 v20, 0x3e0293ee, v20
    v_mul_f32 v21, 0x3e0293ee, v21
    v_mul_f32 v22, 0x3e0293ee, v22
    v_mul_f32 v23, 0x3e0293ee, v23
    v_mul_f32 v24, 0x3e0293ee, v24
    v_mul_f32 v25, 0x3e0293ee, v25
    v_mul_f32 v26, 0x3e0293ee, v26
    v_mul_f32 v27, 0x3e0293ee, v27
    v_cvt_pk_bf16_f32 v36, v20, v21
    v_cvt_pk_bf16_f32 v37, v22, v23
    v_cvt_pk_bf16_f32 v38, v24, v25
    v_cvt_pk_bf16_f32 v39, v26, v27
    buffer_store_dwordx4 v[36:39], v251, s[4:7], s53 offen offset:3072 sc1
    s_add_u32 s53, s53, s22
    v_accvgpr_read_b32 v40, a64
    v_accvgpr_read_b32 v41, a65
    v_accvgpr_read_b32 v42, a66
    v_accvgpr_read_b32 v43, a67
    v_accvgpr_read_b32 v44, a68
    v_accvgpr_read_b32 v45, a69
    v_accvgpr_read_b32 v46, a70
    v_accvgpr_read_b32 v47, a71
    v_mul_f32 v40, 0x3e0293ee, v40
    v_mul_f32 v41, 0x3e0293ee, v41
    v_mul_f32 v42, 0x3e0293ee, v42
    v_mul_f32 v43, 0x3e0293ee, v43
    v_mul_f32 v44, 0x3e0293ee, v44
    v_mul_f32 v45, 0x3e0293ee, v45
    v_mul_f32 v46, 0x3e0293ee, v46
    v_mul_f32 v47, 0x3e0293ee, v47
    v_cvt_pk_bf16_f32 v56, v40, v41
    v_cvt_pk_bf16_f32 v57, v42, v43
    v_cvt_pk_bf16_f32 v58, v44, v45
    v_cvt_pk_bf16_f32 v59, v46, v47
    buffer_store_dwordx4 v[56:59], v251, s[4:7], s53 offen offset:0 sc1
    v_accvgpr_read_b32 v0, a72
    v_accvgpr_read_b32 v1, a73
    v_accvgpr_read_b32 v2, a74
    v_accvgpr_read_b32 v3, a75
    v_accvgpr_read_b32 v4, a76
    v_accvgpr_read_b32 v5, a77
    v_accvgpr_read_b32 v6, a78
    v_accvgpr_read_b32 v7, a79
    v_mul_f32 v0, 0x3e0293ee, v0
    v_mul_f32 v1, 0x3e0293ee, v1
    v_mul_f32 v2, 0x3e0293ee, v2
    v_mul_f32 v3, 0x3e0293ee, v3
    v_mul_f32 v4, 0x3e0293ee, v4
    v_mul_f32 v5, 0x3e0293ee, v5
    v_mul_f32 v6, 0x3e0293ee, v6
    v_mul_f32 v7, 0x3e0293ee, v7
    v_cvt_pk_bf16_f32 v16, v0, v1
    v_cvt_pk_bf16_f32 v17, v2, v3
    v_cvt_pk_bf16_f32 v18, v4, v5
    v_cvt_pk_bf16_f32 v19, v6, v7
    buffer_store_dwordx4 v[16:19], v251, s[4:7], s53 offen offset:1024 sc1
    v_accvgpr_read_b32 v20, a80
    v_accvgpr_read_b32 v21, a81
    v_accvgpr_read_b32 v22, a82
    v_accvgpr_read_b32 v23, a83
    v_accvgpr_read_b32 v24, a84
    v_accvgpr_read_b32 v25, a85
    v_accvgpr_read_b32 v26, a86
    v_accvgpr_read_b32 v27, a87
    v_mul_f32 v20, 0x3e0293ee, v20
    v_mul_f32 v21, 0x3e0293ee, v21
    v_mul_f32 v22, 0x3e0293ee, v22
    v_mul_f32 v23, 0x3e0293ee, v23
    v_mul_f32 v24, 0x3e0293ee, v24
    v_mul_f32 v25, 0x3e0293ee, v25
    v_mul_f32 v26, 0x3e0293ee, v26
    v_mul_f32 v27, 0x3e0293ee, v27
    v_cvt_pk_bf16_f32 v36, v20, v21
    v_cvt_pk_bf16_f32 v37, v22, v23
    v_cvt_pk_bf16_f32 v38, v24, v25
    v_cvt_pk_bf16_f32 v39, v26, v27
    buffer_store_dwordx4 v[36:39], v251, s[4:7], s53 offen offset:2048 sc1
    v_accvgpr_read_b32 v40, a88
    v_accvgpr_read_b32 v41, a89
    v_accvgpr_read_b32 v42, a90
    v_accvgpr_read_b32 v43, a91
    v_accvgpr_read_b32 v44, a92
    v_accvgpr_read_b32 v45, a93
    v_accvgpr_read_b32 v46, a94
    v_accvgpr_read_b32 v47, a95
    v_mul_f32 v40, 0x3e0293ee, v40
    v_mul_f32 v41, 0x3e0293ee, v41
    v_mul_f32 v42, 0x3e0293ee, v42
    v_mul_f32 v43, 0x3e0293ee, v43
    v_mul_f32 v44, 0x3e0293ee, v44
    v_mul_f32 v45, 0x3e0293ee, v45
    v_mul_f32 v46, 0x3e0293ee, v46
    v_mul_f32 v47, 0x3e0293ee, v47
    v_cvt_pk_bf16_f32 v56, v40, v41
    v_cvt_pk_bf16_f32 v57, v42, v43
    v_cvt_pk_bf16_f32 v58, v44, v45
    v_cvt_pk_bf16_f32 v59, v46, v47
    buffer_store_dwordx4 v[56:59], v251, s[4:7], s53 offen offset:3072 sc1
    s_add_u32 s53, s53, s22
    v_accvgpr_read_b32 v0, a96
    v_accvgpr_read_b32 v1, a97
    v_accvgpr_read_b32 v2, a98
    v_accvgpr_read_b32 v3, a99
    v_accvgpr_read_b32 v4, a100
    v_accvgpr_read_b32 v5, a101
    v_accvgpr_read_b32 v6, a102
    v_accvgpr_read_b32 v7, a103
    v_mul_f32 v0, 0x3e0293ee, v0
    v_mul_f32 v1, 0x3e0293ee, v1
    v_mul_f32 v2, 0x3e0293ee, v2
    v_mul_f32 v3, 0x3e0293ee, v3
    v_mul_f32 v4, 0x3e0293ee, v4
    v_mul_f32 v5, 0x3e0293ee, v5
    v_mul_f32 v6, 0x3e0293ee, v6
    v_mul_f32 v7, 0x3e0293ee, v7
    v_cvt_pk_bf16_f32 v16, v0, v1
    v_cvt_pk_bf16_f32 v17, v2, v3
    v_cvt_pk_bf16_f32 v18, v4, v5
    v_cvt_pk_bf16_f32 v19, v6, v7
    buffer_store_dwordx4 v[16:19], v251, s[4:7], s53 offen offset:0 sc1
    v_accvgpr_read_b32 v20, a104
    v_accvgpr_read_b32 v21, a105
    v_accvgpr_read_b32 v22, a106
    v_accvgpr_read_b32 v23, a107
    v_accvgpr_read_b32 v24, a108
    v_accvgpr_read_b32 v25, a109
    v_accvgpr_read_b32 v26, a110
    v_accvgpr_read_b32 v27, a111
    v_mul_f32 v20, 0x3e0293ee, v20
    v_mul_f32 v21, 0x3e0293ee, v21
    v_mul_f32 v22, 0x3e0293ee, v22
    v_mul_f32 v23, 0x3e0293ee, v23
    v_mul_f32 v24, 0x3e0293ee, v24
    v_mul_f32 v25, 0x3e0293ee, v25
    v_mul_f32 v26, 0x3e0293ee, v26
    v_mul_f32 v27, 0x3e0293ee, v27
    v_cvt_pk_bf16_f32 v36, v20, v21
    v_cvt_pk_bf16_f32 v37, v22, v23
    v_cvt_pk_bf16_f32 v38, v24, v25
    v_cvt_pk_bf16_f32 v39, v26, v27
    buffer_store_dwordx4 v[36:39], v251, s[4:7], s53 offen offset:1024 sc1
    v_accvgpr_read_b32 v40, a112
    v_accvgpr_read_b32 v41, a113
    v_accvgpr_read_b32 v42, a114
    v_accvgpr_read_b32 v43, a115
    v_accvgpr_read_b32 v44, a116
    v_accvgpr_read_b32 v45, a117
    v_accvgpr_read_b32 v46, a118
    v_accvgpr_read_b32 v47, a119
    v_mul_f32 v40, 0x3e0293ee, v40
    v_mul_f32 v41, 0x3e0293ee, v41
    v_mul_f32 v42, 0x3e0293ee, v42
    v_mul_f32 v43, 0x3e0293ee, v43
    v_mul_f32 v44, 0x3e0293ee, v44
    v_mul_f32 v45, 0x3e0293ee, v45
    v_mul_f32 v46, 0x3e0293ee, v46
    v_mul_f32 v47, 0x3e0293ee, v47
    v_cvt_pk_bf16_f32 v56, v40, v41
    v_cvt_pk_bf16_f32 v57, v42, v43
    v_cvt_pk_bf16_f32 v58, v44, v45
    v_cvt_pk_bf16_f32 v59, v46, v47
    buffer_store_dwordx4 v[56:59], v251, s[4:7], s53 offen offset:2048 sc1
    v_accvgpr_read_b32 v0, a120
    v_accvgpr_read_b32 v1, a121
    v_accvgpr_read_b32 v2, a122
    v_accvgpr_read_b32 v3, a123
    v_accvgpr_read_b32 v4, a124
    v_accvgpr_read_b32 v5, a125
    v_accvgpr_read_b32 v6, a126
    v_accvgpr_read_b32 v7, a127
    v_mul_f32 v0, 0x3e0293ee, v0
    v_mul_f32 v1, 0x3e0293ee, v1
    v_mul_f32 v2, 0x3e0293ee, v2
    v_mul_f32 v3, 0x3e0293ee, v3
    v_mul_f32 v4, 0x3e0293ee, v4
    v_mul_f32 v5, 0x3e0293ee, v5
    v_mul_f32 v6, 0x3e0293ee, v6
    v_mul_f32 v7, 0x3e0293ee, v7
    v_cvt_pk_bf16_f32 v16, v0, v1
    v_cvt_pk_bf16_f32 v17, v2, v3
    v_cvt_pk_bf16_f32 v18, v4, v5
    v_cvt_pk_bf16_f32 v19, v6, v7
    buffer_store_dwordx4 v[16:19], v251, s[4:7], s53 offen offset:3072 sc1
    s_add_u32 s53, s53, s22
    v_accvgpr_read_b32 v20, a128
    v_accvgpr_read_b32 v21, a129
    v_accvgpr_read_b32 v22, a130
    v_accvgpr_read_b32 v23, a131
    v_accvgpr_read_b32 v24, a132
    v_accvgpr_read_b32 v25, a133
    v_accvgpr_read_b32 v26, a134
    v_accvgpr_read_b32 v27, a135
    v_mul_f32 v20, 0x3e0293ee, v20
    v_mul_f32 v21, 0x3e0293ee, v21
    v_mul_f32 v22, 0x3e0293ee, v22
    v_mul_f32 v23, 0x3e0293ee, v23
    v_mul_f32 v24, 0x3e0293ee, v24
    v_mul_f32 v25, 0x3e0293ee, v25
    v_mul_f32 v26, 0x3e0293ee, v26
    v_mul_f32 v27, 0x3e0293ee, v27
    v_cvt_pk_bf16_f32 v36, v20, v21
    v_cvt_pk_bf16_f32 v37, v22, v23
    v_cvt_pk_bf16_f32 v38, v24, v25
    v_cvt_pk_bf16_f32 v39, v26, v27
    buffer_store_dwordx4 v[36:39], v251, s[4:7], s53 offen offset:0 sc1
    v_accvgpr_read_b32 v40, a136
    v_accvgpr_read_b32 v41, a137
    v_accvgpr_read_b32 v42, a138
    v_accvgpr_read_b32 v43, a139
    v_accvgpr_read_b32 v44, a140
    v_accvgpr_read_b32 v45, a141
    v_accvgpr_read_b32 v46, a142
    v_accvgpr_read_b32 v47, a143
    v_mul_f32 v40, 0x3e0293ee, v40
    v_mul_f32 v41, 0x3e0293ee, v41
    v_mul_f32 v42, 0x3e0293ee, v42
    v_mul_f32 v43, 0x3e0293ee, v43
    v_mul_f32 v44, 0x3e0293ee, v44
    v_mul_f32 v45, 0x3e0293ee, v45
    v_mul_f32 v46, 0x3e0293ee, v46
    v_mul_f32 v47, 0x3e0293ee, v47
    v_cvt_pk_bf16_f32 v56, v40, v41
    v_cvt_pk_bf16_f32 v57, v42, v43
    v_cvt_pk_bf16_f32 v58, v44, v45
    v_cvt_pk_bf16_f32 v59, v46, v47
    buffer_store_dwordx4 v[56:59], v251, s[4:7], s53 offen offset:1024 sc1
    v_accvgpr_read_b32 v0, a144
    v_accvgpr_read_b32 v1, a145
    v_accvgpr_read_b32 v2, a146
    v_accvgpr_read_b32 v3, a147
    v_accvgpr_read_b32 v4, a148
    v_accvgpr_read_b32 v5, a149
    v_accvgpr_read_b32 v6, a150
    v_accvgpr_read_b32 v7, a151
    v_mul_f32 v0, 0x3e0293ee, v0
    v_mul_f32 v1, 0x3e0293ee, v1
    v_mul_f32 v2, 0x3e0293ee, v2
    v_mul_f32 v3, 0x3e0293ee, v3
    v_mul_f32 v4, 0x3e0293ee, v4
    v_mul_f32 v5, 0x3e0293ee, v5
    v_mul_f32 v6, 0x3e0293ee, v6
    v_mul_f32 v7, 0x3e0293ee, v7
    v_cvt_pk_bf16_f32 v16, v0, v1
    v_cvt_pk_bf16_f32 v17, v2, v3
    v_cvt_pk_bf16_f32 v18, v4, v5
    v_cvt_pk_bf16_f32 v19, v6, v7
    buffer_store_dwordx4 v[16:19], v251, s[4:7], s53 offen offset:2048 sc1
    v_accvgpr_read_b32 v20, a152
    v_accvgpr_read_b32 v21, a153
    v_accvgpr_read_b32 v22, a154
    v_accvgpr_read_b32 v23, a155
    v_accvgpr_read_b32 v24, a156
    v_accvgpr_read_b32 v25, a157
    v_accvgpr_read_b32 v26, a158
    v_accvgpr_read_b32 v27, a159
    v_mul_f32 v20, 0x3e0293ee, v20
    v_mul_f32 v21, 0x3e0293ee, v21
    v_mul_f32 v22, 0x3e0293ee, v22
    v_mul_f32 v23, 0x3e0293ee, v23
    v_mul_f32 v24, 0x3e0293ee, v24
    v_mul_f32 v25, 0x3e0293ee, v25
    v_mul_f32 v26, 0x3e0293ee, v26
    v_mul_f32 v27, 0x3e0293ee, v27
    v_cvt_pk_bf16_f32 v36, v20, v21
    v_cvt_pk_bf16_f32 v37, v22, v23
    v_cvt_pk_bf16_f32 v38, v24, v25
    v_cvt_pk_bf16_f32 v39, v26, v27
    buffer_store_dwordx4 v[36:39], v251, s[4:7], s53 offen offset:3072 sc1
    s_add_u32 s53, s53, s22
    v_accvgpr_read_b32 v40, a160
    v_accvgpr_read_b32 v41, a161
    v_accvgpr_read_b32 v42, a162
    v_accvgpr_read_b32 v43, a163
    v_accvgpr_read_b32 v44, a164
    v_accvgpr_read_b32 v45, a165
    v_accvgpr_read_b32 v46, a166
    v_accvgpr_read_b32 v47, a167
    v_mul_f32 v40, 0x3e0293ee, v40
    v_mul_f32 v41, 0x3e0293ee, v41
    v_mul_f32 v42, 0x3e0293ee, v42
    v_mul_f32 v43, 0x3e0293ee, v43
    v_mul_f32 v44, 0x3e0293ee, v44
    v_mul_f32 v45, 0x3e0293ee, v45
    v_mul_f32 v46, 0x3e0293ee, v46
    v_mul_f32 v47, 0x3e0293ee, v47
    v_cvt_pk_bf16_f32 v56, v40, v41
    v_cvt_pk_bf16_f32 v57, v42, v43
    v_cvt_pk_bf16_f32 v58, v44, v45
    v_cvt_pk_bf16_f32 v59, v46, v47
    buffer_store_dwordx4 v[56:59], v251, s[4:7], s53 offen offset:0 sc1
    v_accvgpr_read_b32 v0, a168
    v_accvgpr_read_b32 v1, a169
    v_accvgpr_read_b32 v2, a170
    v_accvgpr_read_b32 v3, a171
    v_accvgpr_read_b32 v4, a172
    v_accvgpr_read_b32 v5, a173
    v_accvgpr_read_b32 v6, a174
    v_accvgpr_read_b32 v7, a175
    v_mul_f32 v0, 0x3e0293ee, v0
    v_mul_f32 v1, 0x3e0293ee, v1
    v_mul_f32 v2, 0x3e0293ee, v2
    v_mul_f32 v3, 0x3e0293ee, v3
    v_mul_f32 v4, 0x3e0293ee, v4
    v_mul_f32 v5, 0x3e0293ee, v5
    v_mul_f32 v6, 0x3e0293ee, v6
    v_mul_f32 v7, 0x3e0293ee, v7
    v_cvt_pk_bf16_f32 v16, v0, v1
    v_cvt_pk_bf16_f32 v17, v2, v3
    v_cvt_pk_bf16_f32 v18, v4, v5
    v_cvt_pk_bf16_f32 v19, v6, v7
    buffer_store_dwordx4 v[16:19], v251, s[4:7], s53 offen offset:1024 sc1
    v_accvgpr_read_b32 v20, a176
    v_accvgpr_read_b32 v21, a177
    v_accvgpr_read_b32 v22, a178
    v_accvgpr_read_b32 v23, a179
    v_accvgpr_read_b32 v24, a180
    v_accvgpr_read_b32 v25, a181
    v_accvgpr_read_b32 v26, a182
    v_accvgpr_read_b32 v27, a183
    v_mul_f32 v20, 0x3e0293ee, v20
    v_mul_f32 v21, 0x3e0293ee, v21
    v_mul_f32 v22, 0x3e0293ee, v22
    v_mul_f32 v23, 0x3e0293ee, v23
    v_mul_f32 v24, 0x3e0293ee, v24
    v_mul_f32 v25, 0x3e0293ee, v25
    v_mul_f32 v26, 0x3e0293ee, v26
    v_mul_f32 v27, 0x3e0293ee, v27
    v_cvt_pk_bf16_f32 v36, v20, v21
    v_cvt_pk_bf16_f32 v37, v22, v23
    v_cvt_pk_bf16_f32 v38, v24, v25
    v_cvt_pk_bf16_f32 v39, v26, v27
    buffer_store_dwordx4 v[36:39], v251, s[4:7], s53 offen offset:2048 sc1
    v_accvgpr_read_b32 v40, a184
    v_accvgpr_read_b32 v41, a185
    v_accvgpr_read_b32 v42, a186
    v_accvgpr_read_b32 v43, a187
    v_accvgpr_read_b32 v44, a188
    v_accvgpr_read_b32 v45, a189
    v_accvgpr_read_b32 v46, a190
    v_accvgpr_read_b32 v47, a191
    v_mul_f32 v40, 0x3e0293ee, v40
    v_mul_f32 v41, 0x3e0293ee, v41
    v_mul_f32 v42, 0x3e0293ee, v42
    v_mul_f32 v43, 0x3e0293ee, v43
    v_mul_f32 v44, 0x3e0293ee, v44
    v_mul_f32 v45, 0x3e0293ee, v45
    v_mul_f32 v46, 0x3e0293ee, v46
    v_mul_f32 v47, 0x3e0293ee, v47
    v_cvt_pk_bf16_f32 v56, v40, v41
    v_cvt_pk_bf16_f32 v57, v42, v43
    v_cvt_pk_bf16_f32 v58, v44, v45
    v_cvt_pk_bf16_f32 v59, v46, v47
    buffer_store_dwordx4 v[56:59], v251, s[4:7], s53 offen offset:3072 sc1
    s_add_u32 s53, s53, s22
    v_accvgpr_read_b32 v0, a192
    v_accvgpr_read_b32 v1, a193
    v_accvgpr_read_b32 v2, a194
    v_accvgpr_read_b32 v3, a195
    v_accvgpr_read_b32 v4, a196
    v_accvgpr_read_b32 v5, a197
    v_accvgpr_read_b32 v6, a198
    v_accvgpr_read_b32 v7, a199
    v_mul_f32 v0, 0x3e0293ee, v0
    v_mul_f32 v1, 0x3e0293ee, v1
    v_mul_f32 v2, 0x3e0293ee, v2
    v_mul_f32 v3, 0x3e0293ee, v3
    v_mul_f32 v4, 0x3e0293ee, v4
    v_mul_f32 v5, 0x3e0293ee, v5
    v_mul_f32 v6, 0x3e0293ee, v6
    v_mul_f32 v7, 0x3e0293ee, v7
    v_cvt_pk_bf16_f32 v16, v0, v1
    v_cvt_pk_bf16_f32 v17, v2, v3
    v_cvt_pk_bf16_f32 v18, v4, v5
    v_cvt_pk_bf16_f32 v19, v6, v7
    buffer_store_dwordx4 v[16:19], v251, s[4:7], s53 offen offset:0 sc1
    v_accvgpr_read_b32 v20, a200
    v_accvgpr_read_b32 v21, a201
    v_accvgpr_read_b32 v22, a202
    v_accvgpr_read_b32 v23, a203
    v_accvgpr_read_b32 v24, a204
    v_accvgpr_read_b32 v25, a205
    v_accvgpr_read_b32 v26, a206
    v_accvgpr_read_b32 v27, a207
    v_mul_f32 v20, 0x3e0293ee, v20
    v_mul_f32 v21, 0x3e0293ee, v21
    v_mul_f32 v22, 0x3e0293ee, v22
    v_mul_f32 v23, 0x3e0293ee, v23
    v_mul_f32 v24, 0x3e0293ee, v24
    v_mul_f32 v25, 0x3e0293ee, v25
    v_mul_f32 v26, 0x3e0293ee, v26
    v_mul_f32 v27, 0x3e0293ee, v27
    v_cvt_pk_bf16_f32 v36, v20, v21
    v_cvt_pk_bf16_f32 v37, v22, v23
    v_cvt_pk_bf16_f32 v38, v24, v25
    v_cvt_pk_bf16_f32 v39, v26, v27
    buffer_store_dwordx4 v[36:39], v251, s[4:7], s53 offen offset:1024 sc1
    v_accvgpr_read_b32 v40, a208
    v_accvgpr_read_b32 v41, a209
    v_accvgpr_read_b32 v42, a210
    v_accvgpr_read_b32 v43, a211
    v_accvgpr_read_b32 v44, a212
    v_accvgpr_read_b32 v45, a213
    v_accvgpr_read_b32 v46, a214
    v_accvgpr_read_b32 v47, a215
    v_mul_f32 v40, 0x3e0293ee, v40
    v_mul_f32 v41, 0x3e0293ee, v41
    v_mul_f32 v42, 0x3e0293ee, v42
    v_mul_f32 v43, 0x3e0293ee, v43
    v_mul_f32 v44, 0x3e0293ee, v44
    v_mul_f32 v45, 0x3e0293ee, v45
    v_mul_f32 v46, 0x3e0293ee, v46
    v_mul_f32 v47, 0x3e0293ee, v47
    v_cvt_pk_bf16_f32 v56, v40, v41
    v_cvt_pk_bf16_f32 v57, v42, v43
    v_cvt_pk_bf16_f32 v58, v44, v45
    v_cvt_pk_bf16_f32 v59, v46, v47
    buffer_store_dwordx4 v[56:59], v251, s[4:7], s53 offen offset:2048 sc1
    v_accvgpr_read_b32 v0, a216
    v_accvgpr_read_b32 v1, a217
    v_accvgpr_read_b32 v2, a218
    v_accvgpr_read_b32 v3, a219
    v_accvgpr_read_b32 v4, a220
    v_accvgpr_read_b32 v5, a221
    v_accvgpr_read_b32 v6, a222
    v_accvgpr_read_b32 v7, a223
    v_mul_f32 v0, 0x3e0293ee, v0
    v_mul_f32 v1, 0x3e0293ee, v1
    v_mul_f32 v2, 0x3e0293ee, v2
    v_mul_f32 v3, 0x3e0293ee, v3
    v_mul_f32 v4, 0x3e0293ee, v4
    v_mul_f32 v5, 0x3e0293ee, v5
    v_mul_f32 v6, 0x3e0293ee, v6
    v_mul_f32 v7, 0x3e0293ee, v7
    v_cvt_pk_bf16_f32 v16, v0, v1
    v_cvt_pk_bf16_f32 v17, v2, v3
    v_cvt_pk_bf16_f32 v18, v4, v5
    v_cvt_pk_bf16_f32 v19, v6, v7
    buffer_store_dwordx4 v[16:19], v251, s[4:7], s53 offen offset:3072 sc1
    s_add_u32 s53, s53, s22
    v_accvgpr_read_b32 v20, a224
    v_accvgpr_read_b32 v21, a225
    v_accvgpr_read_b32 v22, a226
    v_accvgpr_read_b32 v23, a227
    v_accvgpr_read_b32 v24, a228
    v_accvgpr_read_b32 v25, a229
    v_accvgpr_read_b32 v26, a230
    v_accvgpr_read_b32 v27, a231
    v_mul_f32 v20, 0x3e0293ee, v20
    v_mul_f32 v21, 0x3e0293ee, v21
    v_mul_f32 v22, 0x3e0293ee, v22
    v_mul_f32 v23, 0x3e0293ee, v23
    v_mul_f32 v24, 0x3e0293ee, v24
    v_mul_f32 v25, 0x3e0293ee, v25
    v_mul_f32 v26, 0x3e0293ee, v26
    v_mul_f32 v27, 0x3e0293ee, v27
    v_cvt_pk_bf16_f32 v36, v20, v21
    v_cvt_pk_bf16_f32 v37, v22, v23
    v_cvt_pk_bf16_f32 v38, v24, v25
    v_cvt_pk_bf16_f32 v39, v26, v27
    buffer_store_dwordx4 v[36:39], v251, s[4:7], s53 offen offset:0 sc1
    v_accvgpr_read_b32 v40, a232
    v_accvgpr_read_b32 v41, a233
    v_accvgpr_read_b32 v42, a234
    v_accvgpr_read_b32 v43, a235
    v_accvgpr_read_b32 v44, a236
    v_accvgpr_read_b32 v45, a237
    v_accvgpr_read_b32 v46, a238
    v_accvgpr_read_b32 v47, a239
    v_mul_f32 v40, 0x3e0293ee, v40
    v_mul_f32 v41, 0x3e0293ee, v41
    v_mul_f32 v42, 0x3e0293ee, v42
    v_mul_f32 v43, 0x3e0293ee, v43
    v_mul_f32 v44, 0x3e0293ee, v44
    v_mul_f32 v45, 0x3e0293ee, v45
    v_mul_f32 v46, 0x3e0293ee, v46
    v_mul_f32 v47, 0x3e0293ee, v47
    v_cvt_pk_bf16_f32 v56, v40, v41
    v_cvt_pk_bf16_f32 v57, v42, v43
    v_cvt_pk_bf16_f32 v58, v44, v45
    v_cvt_pk_bf16_f32 v59, v46, v47
    buffer_store_dwordx4 v[56:59], v251, s[4:7], s53 offen offset:1024 sc1
    v_accvgpr_read_b32 v0, a240
    v_accvgpr_read_b32 v1, a241
    v_accvgpr_read_b32 v2, a242
    v_accvgpr_read_b32 v3, a243
    v_accvgpr_read_b32 v4, a244
    v_accvgpr_read_b32 v5, a245
    v_accvgpr_read_b32 v6, a246
    v_accvgpr_read_b32 v7, a247
    v_mul_f32 v0, 0x3e0293ee, v0
    v_mul_f32 v1, 0x3e0293ee, v1
    v_mul_f32 v2, 0x3e0293ee, v2
    v_mul_f32 v3, 0x3e0293ee, v3
    v_mul_f32 v4, 0x3e0293ee, v4
    v_mul_f32 v5, 0x3e0293ee, v5
    v_mul_f32 v6, 0x3e0293ee, v6
    v_mul_f32 v7, 0x3e0293ee, v7
    v_cvt_pk_bf16_f32 v16, v0, v1
    v_cvt_pk_bf16_f32 v17, v2, v3
    v_cvt_pk_bf16_f32 v18, v4, v5
    v_cvt_pk_bf16_f32 v19, v6, v7
    buffer_store_dwordx4 v[16:19], v251, s[4:7], s53 offen offset:2048 sc1
    v_accvgpr_read_b32 v20, a248
    v_accvgpr_read_b32 v21, a249
    v_accvgpr_read_b32 v22, a250
    v_accvgpr_read_b32 v23, a251
    v_accvgpr_read_b32 v24, a252
    v_accvgpr_read_b32 v25, a253
    v_accvgpr_read_b32 v26, a254
    v_accvgpr_read_b32 v27, a255
    v_mul_f32 v20, 0x3e0293ee, v20
    v_mul_f32 v21, 0x3e0293ee, v21
    v_mul_f32 v22, 0x3e0293ee, v22
    v_mul_f32 v23, 0x3e0293ee, v23
    v_mul_f32 v24, 0x3e0293ee, v24
    v_mul_f32 v25, 0x3e0293ee, v25
    v_mul_f32 v26, 0x3e0293ee, v26
    v_mul_f32 v27, 0x3e0293ee, v27
    v_cvt_pk_bf16_f32 v36, v20, v21
    v_cvt_pk_bf16_f32 v37, v22, v23
    v_cvt_pk_bf16_f32 v38, v24, v25
    v_cvt_pk_bf16_f32 v39, v26, v27
    buffer_store_dwordx4 v[36:39], v251, s[4:7], s53 offen offset:3072 sc1
    s_branch main_kernel_w_done
main_kernel_w_c2_egelu:
    s_mov_b32 s53, s21
    v_accvgpr_read_b32 v0, a0
    v_accvgpr_read_b32 v1, a1
    v_accvgpr_read_b32 v2, a2
    v_accvgpr_read_b32 v3, a3
    v_accvgpr_read_b32 v4, a4
    v_accvgpr_read_b32 v5, a5
    v_accvgpr_read_b32 v6, a6
    v_accvgpr_read_b32 v7, a7
    v_pk_mul_f32 v[8:9], v[0:1], v[0:1]
    v_pk_mul_f32 v[10:11], v[2:3], v[2:3]
    v_pk_mul_f32 v[12:13], v[4:5], v[4:5]
    v_pk_mul_f32 v[14:15], v[6:7], v[6:7]
    v_pk_fma_f32 v[8:9], v[8:9], v[242:243], v[240:241]
    v_pk_fma_f32 v[10:11], v[10:11], v[242:243], v[240:241]
    v_pk_fma_f32 v[12:13], v[12:13], v[242:243], v[240:241]
    v_pk_fma_f32 v[14:15], v[14:15], v[242:243], v[240:241]
    v_pk_mul_f32 v[8:9], v[8:9], v[0:1]
    v_pk_mul_f32 v[10:11], v[10:11], v[2:3]
    v_pk_mul_f32 v[12:13], v[12:13], v[4:5]
    v_pk_mul_f32 v[14:15], v[14:15], v[6:7]
    v_exp_f32 v8, v8
    v_exp_f32 v9, v9
    v_exp_f32 v10, v10
    v_exp_f32 v11, v11
    v_exp_f32 v12, v12
    v_exp_f32 v13, v13
    v_exp_f32 v14, v14
    v_exp_f32 v15, v15
    v_pk_add_f32 v[8:9], v[8:9], v[244:245]
    v_pk_add_f32 v[10:11], v[10:11], v[244:245]
    v_pk_add_f32 v[12:13], v[12:13], v[244:245]
    v_pk_add_f32 v[14:15], v[14:15], v[244:245]
    v_rcp_f32 v8, v8
    v_rcp_f32 v9, v9
    v_rcp_f32 v10, v10
    v_rcp_f32 v11, v11
    v_rcp_f32 v12, v12
    v_rcp_f32 v13, v13
    v_rcp_f32 v14, v14
    v_rcp_f32 v15, v15
    v_pk_mul_f32 v[0:1], v[8:9], v[0:1]
    v_pk_mul_f32 v[2:3], v[10:11], v[2:3]
    v_pk_mul_f32 v[4:5], v[12:13], v[4:5]
    v_pk_mul_f32 v[6:7], v[14:15], v[6:7]
    v_cvt_pk_bf16_f32 v16, v0, v1
    v_cvt_pk_bf16_f32 v17, v2, v3
    v_cvt_pk_bf16_f32 v18, v4, v5
    v_cvt_pk_bf16_f32 v19, v6, v7
    buffer_store_dwordx4 v[16:19], v251, s[4:7], s53 offen offset:0 sc1
    v_accvgpr_read_b32 v20, a8
    v_accvgpr_read_b32 v21, a9
    v_accvgpr_read_b32 v22, a10
    v_accvgpr_read_b32 v23, a11
    v_accvgpr_read_b32 v24, a12
    v_accvgpr_read_b32 v25, a13
    v_accvgpr_read_b32 v26, a14
    v_accvgpr_read_b32 v27, a15
    v_pk_mul_f32 v[28:29], v[20:21], v[20:21]
    v_pk_mul_f32 v[30:31], v[22:23], v[22:23]
    v_pk_mul_f32 v[32:33], v[24:25], v[24:25]
    v_pk_mul_f32 v[34:35], v[26:27], v[26:27]
    v_pk_fma_f32 v[28:29], v[28:29], v[242:243], v[240:241]
    v_pk_fma_f32 v[30:31], v[30:31], v[242:243], v[240:241]
    v_pk_fma_f32 v[32:33], v[32:33], v[242:243], v[240:241]
    v_pk_fma_f32 v[34:35], v[34:35], v[242:243], v[240:241]
    v_pk_mul_f32 v[28:29], v[28:29], v[20:21]
    v_pk_mul_f32 v[30:31], v[30:31], v[22:23]
    v_pk_mul_f32 v[32:33], v[32:33], v[24:25]
    v_pk_mul_f32 v[34:35], v[34:35], v[26:27]
    v_exp_f32 v28, v28
    v_exp_f32 v29, v29
    v_exp_f32 v30, v30
    v_exp_f32 v31, v31
    v_exp_f32 v32, v32
    v_exp_f32 v33, v33
    v_exp_f32 v34, v34
    v_exp_f32 v35, v35
    v_pk_add_f32 v[28:29], v[28:29], v[244:245]
    v_pk_add_f32 v[30:31], v[30:31], v[244:245]
    v_pk_add_f32 v[32:33], v[32:33], v[244:245]
    v_pk_add_f32 v[34:35], v[34:35], v[244:245]
    v_rcp_f32 v28, v28
    v_rcp_f32 v29, v29
    v_rcp_f32 v30, v30
    v_rcp_f32 v31, v31
    v_rcp_f32 v32, v32
    v_rcp_f32 v33, v33
    v_rcp_f32 v34, v34
    v_rcp_f32 v35, v35
    v_pk_mul_f32 v[20:21], v[28:29], v[20:21]
    v_pk_mul_f32 v[22:23], v[30:31], v[22:23]
    v_pk_mul_f32 v[24:25], v[32:33], v[24:25]
    v_pk_mul_f32 v[26:27], v[34:35], v[26:27]
    v_cvt_pk_bf16_f32 v36, v20, v21
    v_cvt_pk_bf16_f32 v37, v22, v23
    v_cvt_pk_bf16_f32 v38, v24, v25
    v_cvt_pk_bf16_f32 v39, v26, v27
    buffer_store_dwordx4 v[36:39], v251, s[4:7], s53 offen offset:1024 sc1
    v_accvgpr_read_b32 v40, a16
    v_accvgpr_read_b32 v41, a17
    v_accvgpr_read_b32 v42, a18
    v_accvgpr_read_b32 v43, a19
    v_accvgpr_read_b32 v44, a20
    v_accvgpr_read_b32 v45, a21
    v_accvgpr_read_b32 v46, a22
    v_accvgpr_read_b32 v47, a23
    v_pk_mul_f32 v[48:49], v[40:41], v[40:41]
    v_pk_mul_f32 v[50:51], v[42:43], v[42:43]
    v_pk_mul_f32 v[52:53], v[44:45], v[44:45]
    v_pk_mul_f32 v[54:55], v[46:47], v[46:47]
    v_pk_fma_f32 v[48:49], v[48:49], v[242:243], v[240:241]
    v_pk_fma_f32 v[50:51], v[50:51], v[242:243], v[240:241]
    v_pk_fma_f32 v[52:53], v[52:53], v[242:243], v[240:241]
    v_pk_fma_f32 v[54:55], v[54:55], v[242:243], v[240:241]
    v_pk_mul_f32 v[48:49], v[48:49], v[40:41]
    v_pk_mul_f32 v[50:51], v[50:51], v[42:43]
    v_pk_mul_f32 v[52:53], v[52:53], v[44:45]
    v_pk_mul_f32 v[54:55], v[54:55], v[46:47]
    v_exp_f32 v48, v48
    v_exp_f32 v49, v49
    v_exp_f32 v50, v50
    v_exp_f32 v51, v51
    v_exp_f32 v52, v52
    v_exp_f32 v53, v53
    v_exp_f32 v54, v54
    v_exp_f32 v55, v55
    v_pk_add_f32 v[48:49], v[48:49], v[244:245]
    v_pk_add_f32 v[50:51], v[50:51], v[244:245]
    v_pk_add_f32 v[52:53], v[52:53], v[244:245]
    v_pk_add_f32 v[54:55], v[54:55], v[244:245]
    v_rcp_f32 v48, v48
    v_rcp_f32 v49, v49
    v_rcp_f32 v50, v50
    v_rcp_f32 v51, v51
    v_rcp_f32 v52, v52
    v_rcp_f32 v53, v53
    v_rcp_f32 v54, v54
    v_rcp_f32 v55, v55
    v_pk_mul_f32 v[40:41], v[48:49], v[40:41]
    v_pk_mul_f32 v[42:43], v[50:51], v[42:43]
    v_pk_mul_f32 v[44:45], v[52:53], v[44:45]
    v_pk_mul_f32 v[46:47], v[54:55], v[46:47]
    v_cvt_pk_bf16_f32 v56, v40, v41
    v_cvt_pk_bf16_f32 v57, v42, v43
    v_cvt_pk_bf16_f32 v58, v44, v45
    v_cvt_pk_bf16_f32 v59, v46, v47
    buffer_store_dwordx4 v[56:59], v251, s[4:7], s53 offen offset:2048 sc1
    v_accvgpr_read_b32 v0, a24
    v_accvgpr_read_b32 v1, a25
    v_accvgpr_read_b32 v2, a26
    v_accvgpr_read_b32 v3, a27
    v_accvgpr_read_b32 v4, a28
    v_accvgpr_read_b32 v5, a29
    v_accvgpr_read_b32 v6, a30
    v_accvgpr_read_b32 v7, a31
    v_pk_mul_f32 v[8:9], v[0:1], v[0:1]
    v_pk_mul_f32 v[10:11], v[2:3], v[2:3]
    v_pk_mul_f32 v[12:13], v[4:5], v[4:5]
    v_pk_mul_f32 v[14:15], v[6:7], v[6:7]
    v_pk_fma_f32 v[8:9], v[8:9], v[242:243], v[240:241]
    v_pk_fma_f32 v[10:11], v[10:11], v[242:243], v[240:241]
    v_pk_fma_f32 v[12:13], v[12:13], v[242:243], v[240:241]
    v_pk_fma_f32 v[14:15], v[14:15], v[242:243], v[240:241]
    v_pk_mul_f32 v[8:9], v[8:9], v[0:1]
    v_pk_mul_f32 v[10:11], v[10:11], v[2:3]
    v_pk_mul_f32 v[12:13], v[12:13], v[4:5]
    v_pk_mul_f32 v[14:15], v[14:15], v[6:7]
    v_exp_f32 v8, v8
    v_exp_f32 v9, v9
    v_exp_f32 v10, v10
    v_exp_f32 v11, v11
    v_exp_f32 v12, v12
    v_exp_f32 v13, v13
    v_exp_f32 v14, v14
    v_exp_f32 v15, v15
    v_pk_add_f32 v[8:9], v[8:9], v[244:245]
    v_pk_add_f32 v[10:11], v[10:11], v[244:245]
    v_pk_add_f32 v[12:13], v[12:13], v[244:245]
    v_pk_add_f32 v[14:15], v[14:15], v[244:245]
    v_rcp_f32 v8, v8
    v_rcp_f32 v9, v9
    v_rcp_f32 v10, v10
    v_rcp_f32 v11, v11
    v_rcp_f32 v12, v12
    v_rcp_f32 v13, v13
    v_rcp_f32 v14, v14
    v_rcp_f32 v15, v15
    v_pk_mul_f32 v[0:1], v[8:9], v[0:1]
    v_pk_mul_f32 v[2:3], v[10:11], v[2:3]
    v_pk_mul_f32 v[4:5], v[12:13], v[4:5]
    v_pk_mul_f32 v[6:7], v[14:15], v[6:7]
    v_cvt_pk_bf16_f32 v16, v0, v1
    v_cvt_pk_bf16_f32 v17, v2, v3
    v_cvt_pk_bf16_f32 v18, v4, v5
    v_cvt_pk_bf16_f32 v19, v6, v7
    buffer_store_dwordx4 v[16:19], v251, s[4:7], s53 offen offset:3072 sc1
    s_add_u32 s53, s53, s22
    v_accvgpr_read_b32 v20, a32
    v_accvgpr_read_b32 v21, a33
    v_accvgpr_read_b32 v22, a34
    v_accvgpr_read_b32 v23, a35
    v_accvgpr_read_b32 v24, a36
    v_accvgpr_read_b32 v25, a37
    v_accvgpr_read_b32 v26, a38
    v_accvgpr_read_b32 v27, a39
    v_pk_mul_f32 v[28:29], v[20:21], v[20:21]
    v_pk_mul_f32 v[30:31], v[22:23], v[22:23]
    v_pk_mul_f32 v[32:33], v[24:25], v[24:25]
    v_pk_mul_f32 v[34:35], v[26:27], v[26:27]
    v_pk_fma_f32 v[28:29], v[28:29], v[242:243], v[240:241]
    v_pk_fma_f32 v[30:31], v[30:31], v[242:243], v[240:241]
    v_pk_fma_f32 v[32:33], v[32:33], v[242:243], v[240:241]
    v_pk_fma_f32 v[34:35], v[34:35], v[242:243], v[240:241]
    v_pk_mul_f32 v[28:29], v[28:29], v[20:21]
    v_pk_mul_f32 v[30:31], v[30:31], v[22:23]
    v_pk_mul_f32 v[32:33], v[32:33], v[24:25]
    v_pk_mul_f32 v[34:35], v[34:35], v[26:27]
    v_exp_f32 v28, v28
    v_exp_f32 v29, v29
    v_exp_f32 v30, v30
    v_exp_f32 v31, v31
    v_exp_f32 v32, v32
    v_exp_f32 v33, v33
    v_exp_f32 v34, v34
    v_exp_f32 v35, v35
    v_pk_add_f32 v[28:29], v[28:29], v[244:245]
    v_pk_add_f32 v[30:31], v[30:31], v[244:245]
    v_pk_add_f32 v[32:33], v[32:33], v[244:245]
    v_pk_add_f32 v[34:35], v[34:35], v[244:245]
    v_rcp_f32 v28, v28
    v_rcp_f32 v29, v29
    v_rcp_f32 v30, v30
    v_rcp_f32 v31, v31
    v_rcp_f32 v32, v32
    v_rcp_f32 v33, v33
    v_rcp_f32 v34, v34
    v_rcp_f32 v35, v35
    v_pk_mul_f32 v[20:21], v[28:29], v[20:21]
    v_pk_mul_f32 v[22:23], v[30:31], v[22:23]
    v_pk_mul_f32 v[24:25], v[32:33], v[24:25]
    v_pk_mul_f32 v[26:27], v[34:35], v[26:27]
    v_cvt_pk_bf16_f32 v36, v20, v21
    v_cvt_pk_bf16_f32 v37, v22, v23
    v_cvt_pk_bf16_f32 v38, v24, v25
    v_cvt_pk_bf16_f32 v39, v26, v27
    buffer_store_dwordx4 v[36:39], v251, s[4:7], s53 offen offset:0 sc1
    v_accvgpr_read_b32 v40, a40
    v_accvgpr_read_b32 v41, a41
    v_accvgpr_read_b32 v42, a42
    v_accvgpr_read_b32 v43, a43
    v_accvgpr_read_b32 v44, a44
    v_accvgpr_read_b32 v45, a45
    v_accvgpr_read_b32 v46, a46
    v_accvgpr_read_b32 v47, a47
    v_pk_mul_f32 v[48:49], v[40:41], v[40:41]
    v_pk_mul_f32 v[50:51], v[42:43], v[42:43]
    v_pk_mul_f32 v[52:53], v[44:45], v[44:45]
    v_pk_mul_f32 v[54:55], v[46:47], v[46:47]
    v_pk_fma_f32 v[48:49], v[48:49], v[242:243], v[240:241]
    v_pk_fma_f32 v[50:51], v[50:51], v[242:243], v[240:241]
    v_pk_fma_f32 v[52:53], v[52:53], v[242:243], v[240:241]
    v_pk_fma_f32 v[54:55], v[54:55], v[242:243], v[240:241]
    v_pk_mul_f32 v[48:49], v[48:49], v[40:41]
    v_pk_mul_f32 v[50:51], v[50:51], v[42:43]
    v_pk_mul_f32 v[52:53], v[52:53], v[44:45]
    v_pk_mul_f32 v[54:55], v[54:55], v[46:47]
    v_exp_f32 v48, v48
    v_exp_f32 v49, v49
    v_exp_f32 v50, v50
    v_exp_f32 v51, v51
    v_exp_f32 v52, v52
    v_exp_f32 v53, v53
    v_exp_f32 v54, v54
    v_exp_f32 v55, v55
    v_pk_add_f32 v[48:49], v[48:49], v[244:245]
    v_pk_add_f32 v[50:51], v[50:51], v[244:245]
    v_pk_add_f32 v[52:53], v[52:53], v[244:245]
    v_pk_add_f32 v[54:55], v[54:55], v[244:245]
    v_rcp_f32 v48, v48
    v_rcp_f32 v49, v49
    v_rcp_f32 v50, v50
    v_rcp_f32 v51, v51
    v_rcp_f32 v52, v52
    v_rcp_f32 v53, v53
    v_rcp_f32 v54, v54
    v_rcp_f32 v55, v55
    v_pk_mul_f32 v[40:41], v[48:49], v[40:41]
    v_pk_mul_f32 v[42:43], v[50:51], v[42:43]
    v_pk_mul_f32 v[44:45], v[52:53], v[44:45]
    v_pk_mul_f32 v[46:47], v[54:55], v[46:47]
    v_cvt_pk_bf16_f32 v56, v40, v41
    v_cvt_pk_bf16_f32 v57, v42, v43
    v_cvt_pk_bf16_f32 v58, v44, v45
    v_cvt_pk_bf16_f32 v59, v46, v47
    buffer_store_dwordx4 v[56:59], v251, s[4:7], s53 offen offset:1024 sc1
    v_accvgpr_read_b32 v0, a48
    v_accvgpr_read_b32 v1, a49
    v_accvgpr_read_b32 v2, a50
    v_accvgpr_read_b32 v3, a51
    v_accvgpr_read_b32 v4, a52
    v_accvgpr_read_b32 v5, a53
    v_accvgpr_read_b32 v6, a54
    v_accvgpr_read_b32 v7, a55
    v_pk_mul_f32 v[8:9], v[0:1], v[0:1]
    v_pk_mul_f32 v[10:11], v[2:3], v[2:3]
    v_pk_mul_f32 v[12:13], v[4:5], v[4:5]
    v_pk_mul_f32 v[14:15], v[6:7], v[6:7]
    v_pk_fma_f32 v[8:9], v[8:9], v[242:243], v[240:241]
    v_pk_fma_f32 v[10:11], v[10:11], v[242:243], v[240:241]
    v_pk_fma_f32 v[12:13], v[12:13], v[242:243], v[240:241]
    v_pk_fma_f32 v[14:15], v[14:15], v[242:243], v[240:241]
    v_pk_mul_f32 v[8:9], v[8:9], v[0:1]
    v_pk_mul_f32 v[10:11], v[10:11], v[2:3]
    v_pk_mul_f32 v[12:13], v[12:13], v[4:5]
    v_pk_mul_f32 v[14:15], v[14:15], v[6:7]
    v_exp_f32 v8, v8
    v_exp_f32 v9, v9
    v_exp_f32 v10, v10
    v_exp_f32 v11, v11
    v_exp_f32 v12, v12
    v_exp_f32 v13, v13
    v_exp_f32 v14, v14
    v_exp_f32 v15, v15
    v_pk_add_f32 v[8:9], v[8:9], v[244:245]
    v_pk_add_f32 v[10:11], v[10:11], v[244:245]
    v_pk_add_f32 v[12:13], v[12:13], v[244:245]
    v_pk_add_f32 v[14:15], v[14:15], v[244:245]
    v_rcp_f32 v8, v8
    v_rcp_f32 v9, v9
    v_rcp_f32 v10, v10
    v_rcp_f32 v11, v11
    v_rcp_f32 v12, v12
    v_rcp_f32 v13, v13
    v_rcp_f32 v14, v14
    v_rcp_f32 v15, v15
    v_pk_mul_f32 v[0:1], v[8:9], v[0:1]
    v_pk_mul_f32 v[2:3], v[10:11], v[2:3]
    v_pk_mul_f32 v[4:5], v[12:13], v[4:5]
    v_pk_mul_f32 v[6:7], v[14:15], v[6:7]
    v_cvt_pk_bf16_f32 v16, v0, v1
    v_cvt_pk_bf16_f32 v17, v2, v3
    v_cvt_pk_bf16_f32 v18, v4, v5
    v_cvt_pk_bf16_f32 v19, v6, v7
    buffer_store_dwordx4 v[16:19], v251, s[4:7], s53 offen offset:2048 sc1
    v_accvgpr_read_b32 v20, a56
    v_accvgpr_read_b32 v21, a57
    v_accvgpr_read_b32 v22, a58
    v_accvgpr_read_b32 v23, a59
    v_accvgpr_read_b32 v24, a60
    v_accvgpr_read_b32 v25, a61
    v_accvgpr_read_b32 v26, a62
    v_accvgpr_read_b32 v27, a63
    v_pk_mul_f32 v[28:29], v[20:21], v[20:21]
    v_pk_mul_f32 v[30:31], v[22:23], v[22:23]
    v_pk_mul_f32 v[32:33], v[24:25], v[24:25]
    v_pk_mul_f32 v[34:35], v[26:27], v[26:27]
    v_pk_fma_f32 v[28:29], v[28:29], v[242:243], v[240:241]
    v_pk_fma_f32 v[30:31], v[30:31], v[242:243], v[240:241]
    v_pk_fma_f32 v[32:33], v[32:33], v[242:243], v[240:241]
    v_pk_fma_f32 v[34:35], v[34:35], v[242:243], v[240:241]
    v_pk_mul_f32 v[28:29], v[28:29], v[20:21]
    v_pk_mul_f32 v[30:31], v[30:31], v[22:23]
    v_pk_mul_f32 v[32:33], v[32:33], v[24:25]
    v_pk_mul_f32 v[34:35], v[34:35], v[26:27]
    v_exp_f32 v28, v28
    v_exp_f32 v29, v29
    v_exp_f32 v30, v30
    v_exp_f32 v31, v31
    v_exp_f32 v32, v32
    v_exp_f32 v33, v33
    v_exp_f32 v34, v34
    v_exp_f32 v35, v35
    v_pk_add_f32 v[28:29], v[28:29], v[244:245]
    v_pk_add_f32 v[30:31], v[30:31], v[244:245]
    v_pk_add_f32 v[32:33], v[32:33], v[244:245]
    v_pk_add_f32 v[34:35], v[34:35], v[244:245]
    v_rcp_f32 v28, v28
    v_rcp_f32 v29, v29
    v_rcp_f32 v30, v30
    v_rcp_f32 v31, v31
    v_rcp_f32 v32, v32
    v_rcp_f32 v33, v33
    v_rcp_f32 v34, v34
    v_rcp_f32 v35, v35
    v_pk_mul_f32 v[20:21], v[28:29], v[20:21]
    v_pk_mul_f32 v[22:23], v[30:31], v[22:23]
    v_pk_mul_f32 v[24:25], v[32:33], v[24:25]
    v_pk_mul_f32 v[26:27], v[34:35], v[26:27]
    v_cvt_pk_bf16_f32 v36, v20, v21
    v_cvt_pk_bf16_f32 v37, v22, v23
    v_cvt_pk_bf16_f32 v38, v24, v25
    v_cvt_pk_bf16_f32 v39, v26, v27
    buffer_store_dwordx4 v[36:39], v251, s[4:7], s53 offen offset:3072 sc1
    s_add_u32 s53, s53, s22
    v_accvgpr_read_b32 v40, a64
    v_accvgpr_read_b32 v41, a65
    v_accvgpr_read_b32 v42, a66
    v_accvgpr_read_b32 v43, a67
    v_accvgpr_read_b32 v44, a68
    v_accvgpr_read_b32 v45, a69
    v_accvgpr_read_b32 v46, a70
    v_accvgpr_read_b32 v47, a71
    v_pk_mul_f32 v[48:49], v[40:41], v[40:41]
    v_pk_mul_f32 v[50:51], v[42:43], v[42:43]
    v_pk_mul_f32 v[52:53], v[44:45], v[44:45]
    v_pk_mul_f32 v[54:55], v[46:47], v[46:47]
    v_pk_fma_f32 v[48:49], v[48:49], v[242:243], v[240:241]
    v_pk_fma_f32 v[50:51], v[50:51], v[242:243], v[240:241]
    v_pk_fma_f32 v[52:53], v[52:53], v[242:243], v[240:241]
    v_pk_fma_f32 v[54:55], v[54:55], v[242:243], v[240:241]
    v_pk_mul_f32 v[48:49], v[48:49], v[40:41]
    v_pk_mul_f32 v[50:51], v[50:51], v[42:43]
    v_pk_mul_f32 v[52:53], v[52:53], v[44:45]
    v_pk_mul_f32 v[54:55], v[54:55], v[46:47]
    v_exp_f32 v48, v48
    v_exp_f32 v49, v49
    v_exp_f32 v50, v50
    v_exp_f32 v51, v51
    v_exp_f32 v52, v52
    v_exp_f32 v53, v53
    v_exp_f32 v54, v54
    v_exp_f32 v55, v55
    v_pk_add_f32 v[48:49], v[48:49], v[244:245]
    v_pk_add_f32 v[50:51], v[50:51], v[244:245]
    v_pk_add_f32 v[52:53], v[52:53], v[244:245]
    v_pk_add_f32 v[54:55], v[54:55], v[244:245]
    v_rcp_f32 v48, v48
    v_rcp_f32 v49, v49
    v_rcp_f32 v50, v50
    v_rcp_f32 v51, v51
    v_rcp_f32 v52, v52
    v_rcp_f32 v53, v53
    v_rcp_f32 v54, v54
    v_rcp_f32 v55, v55
    v_pk_mul_f32 v[40:41], v[48:49], v[40:41]
    v_pk_mul_f32 v[42:43], v[50:51], v[42:43]
    v_pk_mul_f32 v[44:45], v[52:53], v[44:45]
    v_pk_mul_f32 v[46:47], v[54:55], v[46:47]
    v_cvt_pk_bf16_f32 v56, v40, v41
    v_cvt_pk_bf16_f32 v57, v42, v43
    v_cvt_pk_bf16_f32 v58, v44, v45
    v_cvt_pk_bf16_f32 v59, v46, v47
    buffer_store_dwordx4 v[56:59], v251, s[4:7], s53 offen offset:0 sc1
    v_accvgpr_read_b32 v0, a72
    v_accvgpr_read_b32 v1, a73
    v_accvgpr_read_b32 v2, a74
    v_accvgpr_read_b32 v3, a75
    v_accvgpr_read_b32 v4, a76
    v_accvgpr_read_b32 v5, a77
    v_accvgpr_read_b32 v6, a78
    v_accvgpr_read_b32 v7, a79
    v_pk_mul_f32 v[8:9], v[0:1], v[0:1]
    v_pk_mul_f32 v[10:11], v[2:3], v[2:3]
    v_pk_mul_f32 v[12:13], v[4:5], v[4:5]
    v_pk_mul_f32 v[14:15], v[6:7], v[6:7]
    v_pk_fma_f32 v[8:9], v[8:9], v[242:243], v[240:241]
    v_pk_fma_f32 v[10:11], v[10:11], v[242:243], v[240:241]
    v_pk_fma_f32 v[12:13], v[12:13], v[242:243], v[240:241]
    v_pk_fma_f32 v[14:15], v[14:15], v[242:243], v[240:241]
    v_pk_mul_f32 v[8:9], v[8:9], v[0:1]
    v_pk_mul_f32 v[10:11], v[10:11], v[2:3]
    v_pk_mul_f32 v[12:13], v[12:13], v[4:5]
    v_pk_mul_f32 v[14:15], v[14:15], v[6:7]
    v_exp_f32 v8, v8
    v_exp_f32 v9, v9
    v_exp_f32 v10, v10
    v_exp_f32 v11, v11
    v_exp_f32 v12, v12
    v_exp_f32 v13, v13
    v_exp_f32 v14, v14
    v_exp_f32 v15, v15
    v_pk_add_f32 v[8:9], v[8:9], v[244:245]
    v_pk_add_f32 v[10:11], v[10:11], v[244:245]
    v_pk_add_f32 v[12:13], v[12:13], v[244:245]
    v_pk_add_f32 v[14:15], v[14:15], v[244:245]
    v_rcp_f32 v8, v8
    v_rcp_f32 v9, v9
    v_rcp_f32 v10, v10
    v_rcp_f32 v11, v11
    v_rcp_f32 v12, v12
    v_rcp_f32 v13, v13
    v_rcp_f32 v14, v14
    v_rcp_f32 v15, v15
    v_pk_mul_f32 v[0:1], v[8:9], v[0:1]
    v_pk_mul_f32 v[2:3], v[10:11], v[2:3]
    v_pk_mul_f32 v[4:5], v[12:13], v[4:5]
    v_pk_mul_f32 v[6:7], v[14:15], v[6:7]
    v_cvt_pk_bf16_f32 v16, v0, v1
    v_cvt_pk_bf16_f32 v17, v2, v3
    v_cvt_pk_bf16_f32 v18, v4, v5
    v_cvt_pk_bf16_f32 v19, v6, v7
    buffer_store_dwordx4 v[16:19], v251, s[4:7], s53 offen offset:1024 sc1
    v_accvgpr_read_b32 v20, a80
    v_accvgpr_read_b32 v21, a81
    v_accvgpr_read_b32 v22, a82
    v_accvgpr_read_b32 v23, a83
    v_accvgpr_read_b32 v24, a84
    v_accvgpr_read_b32 v25, a85
    v_accvgpr_read_b32 v26, a86
    v_accvgpr_read_b32 v27, a87
    v_pk_mul_f32 v[28:29], v[20:21], v[20:21]
    v_pk_mul_f32 v[30:31], v[22:23], v[22:23]
    v_pk_mul_f32 v[32:33], v[24:25], v[24:25]
    v_pk_mul_f32 v[34:35], v[26:27], v[26:27]
    v_pk_fma_f32 v[28:29], v[28:29], v[242:243], v[240:241]
    v_pk_fma_f32 v[30:31], v[30:31], v[242:243], v[240:241]
    v_pk_fma_f32 v[32:33], v[32:33], v[242:243], v[240:241]
    v_pk_fma_f32 v[34:35], v[34:35], v[242:243], v[240:241]
    v_pk_mul_f32 v[28:29], v[28:29], v[20:21]
    v_pk_mul_f32 v[30:31], v[30:31], v[22:23]
    v_pk_mul_f32 v[32:33], v[32:33], v[24:25]
    v_pk_mul_f32 v[34:35], v[34:35], v[26:27]
    v_exp_f32 v28, v28
    v_exp_f32 v29, v29
    v_exp_f32 v30, v30
    v_exp_f32 v31, v31
    v_exp_f32 v32, v32
    v_exp_f32 v33, v33
    v_exp_f32 v34, v34
    v_exp_f32 v35, v35
    v_pk_add_f32 v[28:29], v[28:29], v[244:245]
    v_pk_add_f32 v[30:31], v[30:31], v[244:245]
    v_pk_add_f32 v[32:33], v[32:33], v[244:245]
    v_pk_add_f32 v[34:35], v[34:35], v[244:245]
    v_rcp_f32 v28, v28
    v_rcp_f32 v29, v29
    v_rcp_f32 v30, v30
    v_rcp_f32 v31, v31
    v_rcp_f32 v32, v32
    v_rcp_f32 v33, v33
    v_rcp_f32 v34, v34
    v_rcp_f32 v35, v35
    v_pk_mul_f32 v[20:21], v[28:29], v[20:21]
    v_pk_mul_f32 v[22:23], v[30:31], v[22:23]
    v_pk_mul_f32 v[24:25], v[32:33], v[24:25]
    v_pk_mul_f32 v[26:27], v[34:35], v[26:27]
    v_cvt_pk_bf16_f32 v36, v20, v21
    v_cvt_pk_bf16_f32 v37, v22, v23
    v_cvt_pk_bf16_f32 v38, v24, v25
    v_cvt_pk_bf16_f32 v39, v26, v27
    buffer_store_dwordx4 v[36:39], v251, s[4:7], s53 offen offset:2048 sc1
    v_accvgpr_read_b32 v40, a88
    v_accvgpr_read_b32 v41, a89
    v_accvgpr_read_b32 v42, a90
    v_accvgpr_read_b32 v43, a91
    v_accvgpr_read_b32 v44, a92
    v_accvgpr_read_b32 v45, a93
    v_accvgpr_read_b32 v46, a94
    v_accvgpr_read_b32 v47, a95
    v_pk_mul_f32 v[48:49], v[40:41], v[40:41]
    v_pk_mul_f32 v[50:51], v[42:43], v[42:43]
    v_pk_mul_f32 v[52:53], v[44:45], v[44:45]
    v_pk_mul_f32 v[54:55], v[46:47], v[46:47]
    v_pk_fma_f32 v[48:49], v[48:49], v[242:243], v[240:241]
    v_pk_fma_f32 v[50:51], v[50:51], v[242:243], v[240:241]
    v_pk_fma_f32 v[52:53], v[52:53], v[242:243], v[240:241]
    v_pk_fma_f32 v[54:55], v[54:55], v[242:243], v[240:241]
    v_pk_mul_f32 v[48:49], v[48:49], v[40:41]
    v_pk_mul_f32 v[50:51], v[50:51], v[42:43]
    v_pk_mul_f32 v[52:53], v[52:53], v[44:45]
    v_pk_mul_f32 v[54:55], v[54:55], v[46:47]
    v_exp_f32 v48, v48
    v_exp_f32 v49, v49
    v_exp_f32 v50, v50
    v_exp_f32 v51, v51
    v_exp_f32 v52, v52
    v_exp_f32 v53, v53
    v_exp_f32 v54, v54
    v_exp_f32 v55, v55
    v_pk_add_f32 v[48:49], v[48:49], v[244:245]
    v_pk_add_f32 v[50:51], v[50:51], v[244:245]
    v_pk_add_f32 v[52:53], v[52:53], v[244:245]
    v_pk_add_f32 v[54:55], v[54:55], v[244:245]
    v_rcp_f32 v48, v48
    v_rcp_f32 v49, v49
    v_rcp_f32 v50, v50
    v_rcp_f32 v51, v51
    v_rcp_f32 v52, v52
    v_rcp_f32 v53, v53
    v_rcp_f32 v54, v54
    v_rcp_f32 v55, v55
    v_pk_mul_f32 v[40:41], v[48:49], v[40:41]
    v_pk_mul_f32 v[42:43], v[50:51], v[42:43]
    v_pk_mul_f32 v[44:45], v[52:53], v[44:45]
    v_pk_mul_f32 v[46:47], v[54:55], v[46:47]
    v_cvt_pk_bf16_f32 v56, v40, v41
    v_cvt_pk_bf16_f32 v57, v42, v43
    v_cvt_pk_bf16_f32 v58, v44, v45
    v_cvt_pk_bf16_f32 v59, v46, v47
    buffer_store_dwordx4 v[56:59], v251, s[4:7], s53 offen offset:3072 sc1
    s_add_u32 s53, s53, s22
    v_accvgpr_read_b32 v0, a96
    v_accvgpr_read_b32 v1, a97
    v_accvgpr_read_b32 v2, a98
    v_accvgpr_read_b32 v3, a99
    v_accvgpr_read_b32 v4, a100
    v_accvgpr_read_b32 v5, a101
    v_accvgpr_read_b32 v6, a102
    v_accvgpr_read_b32 v7, a103
    v_pk_mul_f32 v[8:9], v[0:1], v[0:1]
    v_pk_mul_f32 v[10:11], v[2:3], v[2:3]
    v_pk_mul_f32 v[12:13], v[4:5], v[4:5]
    v_pk_mul_f32 v[14:15], v[6:7], v[6:7]
    v_pk_fma_f32 v[8:9], v[8:9], v[242:243], v[240:241]
    v_pk_fma_f32 v[10:11], v[10:11], v[242:243], v[240:241]
    v_pk_fma_f32 v[12:13], v[12:13], v[242:243], v[240:241]
    v_pk_fma_f32 v[14:15], v[14:15], v[242:243], v[240:241]
    v_pk_mul_f32 v[8:9], v[8:9], v[0:1]
    v_pk_mul_f32 v[10:11], v[10:11], v[2:3]
    v_pk_mul_f32 v[12:13], v[12:13], v[4:5]
    v_pk_mul_f32 v[14:15], v[14:15], v[6:7]
    v_exp_f32 v8, v8
    v_exp_f32 v9, v9
    v_exp_f32 v10, v10
    v_exp_f32 v11, v11
    v_exp_f32 v12, v12
    v_exp_f32 v13, v13
    v_exp_f32 v14, v14
    v_exp_f32 v15, v15
    v_pk_add_f32 v[8:9], v[8:9], v[244:245]
    v_pk_add_f32 v[10:11], v[10:11], v[244:245]
    v_pk_add_f32 v[12:13], v[12:13], v[244:245]
    v_pk_add_f32 v[14:15], v[14:15], v[244:245]
    v_rcp_f32 v8, v8
    v_rcp_f32 v9, v9
    v_rcp_f32 v10, v10
    v_rcp_f32 v11, v11
    v_rcp_f32 v12, v12
    v_rcp_f32 v13, v13
    v_rcp_f32 v14, v14
    v_rcp_f32 v15, v15
    v_pk_mul_f32 v[0:1], v[8:9], v[0:1]
    v_pk_mul_f32 v[2:3], v[10:11], v[2:3]
    v_pk_mul_f32 v[4:5], v[12:13], v[4:5]
    v_pk_mul_f32 v[6:7], v[14:15], v[6:7]
    v_cvt_pk_bf16_f32 v16, v0, v1
    v_cvt_pk_bf16_f32 v17, v2, v3
    v_cvt_pk_bf16_f32 v18, v4, v5
    v_cvt_pk_bf16_f32 v19, v6, v7
    buffer_store_dwordx4 v[16:19], v251, s[4:7], s53 offen offset:0 sc1
    v_accvgpr_read_b32 v20, a104
    v_accvgpr_read_b32 v21, a105
    v_accvgpr_read_b32 v22, a106
    v_accvgpr_read_b32 v23, a107
    v_accvgpr_read_b32 v24, a108
    v_accvgpr_read_b32 v25, a109
    v_accvgpr_read_b32 v26, a110
    v_accvgpr_read_b32 v27, a111
    v_pk_mul_f32 v[28:29], v[20:21], v[20:21]
    v_pk_mul_f32 v[30:31], v[22:23], v[22:23]
    v_pk_mul_f32 v[32:33], v[24:25], v[24:25]
    v_pk_mul_f32 v[34:35], v[26:27], v[26:27]
    v_pk_fma_f32 v[28:29], v[28:29], v[242:243], v[240:241]
    v_pk_fma_f32 v[30:31], v[30:31], v[242:243], v[240:241]
    v_pk_fma_f32 v[32:33], v[32:33], v[242:243], v[240:241]
    v_pk_fma_f32 v[34:35], v[34:35], v[242:243], v[240:241]
    v_pk_mul_f32 v[28:29], v[28:29], v[20:21]
    v_pk_mul_f32 v[30:31], v[30:31], v[22:23]
    v_pk_mul_f32 v[32:33], v[32:33], v[24:25]
    v_pk_mul_f32 v[34:35], v[34:35], v[26:27]
    v_exp_f32 v28, v28
    v_exp_f32 v29, v29
    v_exp_f32 v30, v30
    v_exp_f32 v31, v31
    v_exp_f32 v32, v32
    v_exp_f32 v33, v33
    v_exp_f32 v34, v34
    v_exp_f32 v35, v35
    v_pk_add_f32 v[28:29], v[28:29], v[244:245]
    v_pk_add_f32 v[30:31], v[30:31], v[244:245]
    v_pk_add_f32 v[32:33], v[32:33], v[244:245]
    v_pk_add_f32 v[34:35], v[34:35], v[244:245]
    v_rcp_f32 v28, v28
    v_rcp_f32 v29, v29
    v_rcp_f32 v30, v30
    v_rcp_f32 v31, v31
    v_rcp_f32 v32, v32
    v_rcp_f32 v33, v33
    v_rcp_f32 v34, v34
    v_rcp_f32 v35, v35
    v_pk_mul_f32 v[20:21], v[28:29], v[20:21]
    v_pk_mul_f32 v[22:23], v[30:31], v[22:23]
    v_pk_mul_f32 v[24:25], v[32:33], v[24:25]
    v_pk_mul_f32 v[26:27], v[34:35], v[26:27]
    v_cvt_pk_bf16_f32 v36, v20, v21
    v_cvt_pk_bf16_f32 v37, v22, v23
    v_cvt_pk_bf16_f32 v38, v24, v25
    v_cvt_pk_bf16_f32 v39, v26, v27
    buffer_store_dwordx4 v[36:39], v251, s[4:7], s53 offen offset:1024 sc1
    v_accvgpr_read_b32 v40, a112
    v_accvgpr_read_b32 v41, a113
    v_accvgpr_read_b32 v42, a114
    v_accvgpr_read_b32 v43, a115
    v_accvgpr_read_b32 v44, a116
    v_accvgpr_read_b32 v45, a117
    v_accvgpr_read_b32 v46, a118
    v_accvgpr_read_b32 v47, a119
    v_pk_mul_f32 v[48:49], v[40:41], v[40:41]
    v_pk_mul_f32 v[50:51], v[42:43], v[42:43]
    v_pk_mul_f32 v[52:53], v[44:45], v[44:45]
    v_pk_mul_f32 v[54:55], v[46:47], v[46:47]
    v_pk_fma_f32 v[48:49], v[48:49], v[242:243], v[240:241]
    v_pk_fma_f32 v[50:51], v[50:51], v[242:243], v[240:241]
    v_pk_fma_f32 v[52:53], v[52:53], v[242:243], v[240:241]
    v_pk_fma_f32 v[54:55], v[54:55], v[242:243], v[240:241]
    v_pk_mul_f32 v[48:49], v[48:49], v[40:41]
    v_pk_mul_f32 v[50:51], v[50:51], v[42:43]
    v_pk_mul_f32 v[52:53], v[52:53], v[44:45]
    v_pk_mul_f32 v[54:55], v[54:55], v[46:47]
    v_exp_f32 v48, v48
    v_exp_f32 v49, v49
    v_exp_f32 v50, v50
    v_exp_f32 v51, v51
    v_exp_f32 v52, v52
    v_exp_f32 v53, v53
    v_exp_f32 v54, v54
    v_exp_f32 v55, v55
    v_pk_add_f32 v[48:49], v[48:49], v[244:245]
    v_pk_add_f32 v[50:51], v[50:51], v[244:245]
    v_pk_add_f32 v[52:53], v[52:53], v[244:245]
    v_pk_add_f32 v[54:55], v[54:55], v[244:245]
    v_rcp_f32 v48, v48
    v_rcp_f32 v49, v49
    v_rcp_f32 v50, v50
    v_rcp_f32 v51, v51
    v_rcp_f32 v52, v52
    v_rcp_f32 v53, v53
    v_rcp_f32 v54, v54
    v_rcp_f32 v55, v55
    v_pk_mul_f32 v[40:41], v[48:49], v[40:41]
    v_pk_mul_f32 v[42:43], v[50:51], v[42:43]
    v_pk_mul_f32 v[44:45], v[52:53], v[44:45]
    v_pk_mul_f32 v[46:47], v[54:55], v[46:47]
    v_cvt_pk_bf16_f32 v56, v40, v41
    v_cvt_pk_bf16_f32 v57, v42, v43
    v_cvt_pk_bf16_f32 v58, v44, v45
    v_cvt_pk_bf16_f32 v59, v46, v47
    buffer_store_dwordx4 v[56:59], v251, s[4:7], s53 offen offset:2048 sc1
    v_accvgpr_read_b32 v0, a120
    v_accvgpr_read_b32 v1, a121
    v_accvgpr_read_b32 v2, a122
    v_accvgpr_read_b32 v3, a123
    v_accvgpr_read_b32 v4, a124
    v_accvgpr_read_b32 v5, a125
    v_accvgpr_read_b32 v6, a126
    v_accvgpr_read_b32 v7, a127
    v_pk_mul_f32 v[8:9], v[0:1], v[0:1]
    v_pk_mul_f32 v[10:11], v[2:3], v[2:3]
    v_pk_mul_f32 v[12:13], v[4:5], v[4:5]
    v_pk_mul_f32 v[14:15], v[6:7], v[6:7]
    v_pk_fma_f32 v[8:9], v[8:9], v[242:243], v[240:241]
    v_pk_fma_f32 v[10:11], v[10:11], v[242:243], v[240:241]
    v_pk_fma_f32 v[12:13], v[12:13], v[242:243], v[240:241]
    v_pk_fma_f32 v[14:15], v[14:15], v[242:243], v[240:241]
    v_pk_mul_f32 v[8:9], v[8:9], v[0:1]
    v_pk_mul_f32 v[10:11], v[10:11], v[2:3]
    v_pk_mul_f32 v[12:13], v[12:13], v[4:5]
    v_pk_mul_f32 v[14:15], v[14:15], v[6:7]
    v_exp_f32 v8, v8
    v_exp_f32 v9, v9
    v_exp_f32 v10, v10
    v_exp_f32 v11, v11
    v_exp_f32 v12, v12
    v_exp_f32 v13, v13
    v_exp_f32 v14, v14
    v_exp_f32 v15, v15
    v_pk_add_f32 v[8:9], v[8:9], v[244:245]
    v_pk_add_f32 v[10:11], v[10:11], v[244:245]
    v_pk_add_f32 v[12:13], v[12:13], v[244:245]
    v_pk_add_f32 v[14:15], v[14:15], v[244:245]
    v_rcp_f32 v8, v8
    v_rcp_f32 v9, v9
    v_rcp_f32 v10, v10
    v_rcp_f32 v11, v11
    v_rcp_f32 v12, v12
    v_rcp_f32 v13, v13
    v_rcp_f32 v14, v14
    v_rcp_f32 v15, v15
    v_pk_mul_f32 v[0:1], v[8:9], v[0:1]
    v_pk_mul_f32 v[2:3], v[10:11], v[2:3]
    v_pk_mul_f32 v[4:5], v[12:13], v[4:5]
    v_pk_mul_f32 v[6:7], v[14:15], v[6:7]
    v_cvt_pk_bf16_f32 v16, v0, v1
    v_cvt_pk_bf16_f32 v17, v2, v3
    v_cvt_pk_bf16_f32 v18, v4, v5
    v_cvt_pk_bf16_f32 v19, v6, v7
    buffer_store_dwordx4 v[16:19], v251, s[4:7], s53 offen offset:3072 sc1
    s_add_u32 s53, s53, s22
    v_accvgpr_read_b32 v20, a128
    v_accvgpr_read_b32 v21, a129
    v_accvgpr_read_b32 v22, a130
    v_accvgpr_read_b32 v23, a131
    v_accvgpr_read_b32 v24, a132
    v_accvgpr_read_b32 v25, a133
    v_accvgpr_read_b32 v26, a134
    v_accvgpr_read_b32 v27, a135
    v_pk_mul_f32 v[28:29], v[20:21], v[20:21]
    v_pk_mul_f32 v[30:31], v[22:23], v[22:23]
    v_pk_mul_f32 v[32:33], v[24:25], v[24:25]
    v_pk_mul_f32 v[34:35], v[26:27], v[26:27]
    v_pk_fma_f32 v[28:29], v[28:29], v[242:243], v[240:241]
    v_pk_fma_f32 v[30:31], v[30:31], v[242:243], v[240:241]
    v_pk_fma_f32 v[32:33], v[32:33], v[242:243], v[240:241]
    v_pk_fma_f32 v[34:35], v[34:35], v[242:243], v[240:241]
    v_pk_mul_f32 v[28:29], v[28:29], v[20:21]
    v_pk_mul_f32 v[30:31], v[30:31], v[22:23]
    v_pk_mul_f32 v[32:33], v[32:33], v[24:25]
    v_pk_mul_f32 v[34:35], v[34:35], v[26:27]
    v_exp_f32 v28, v28
    v_exp_f32 v29, v29
    v_exp_f32 v30, v30
    v_exp_f32 v31, v31
    v_exp_f32 v32, v32
    v_exp_f32 v33, v33
    v_exp_f32 v34, v34
    v_exp_f32 v35, v35
    v_pk_add_f32 v[28:29], v[28:29], v[244:245]
    v_pk_add_f32 v[30:31], v[30:31], v[244:245]
    v_pk_add_f32 v[32:33], v[32:33], v[244:245]
    v_pk_add_f32 v[34:35], v[34:35], v[244:245]
    v_rcp_f32 v28, v28
    v_rcp_f32 v29, v29
    v_rcp_f32 v30, v30
    v_rcp_f32 v31, v31
    v_rcp_f32 v32, v32
    v_rcp_f32 v33, v33
    v_rcp_f32 v34, v34
    v_rcp_f32 v35, v35
    v_pk_mul_f32 v[20:21], v[28:29], v[20:21]
    v_pk_mul_f32 v[22:23], v[30:31], v[22:23]
    v_pk_mul_f32 v[24:25], v[32:33], v[24:25]
    v_pk_mul_f32 v[26:27], v[34:35], v[26:27]
    v_cvt_pk_bf16_f32 v36, v20, v21
    v_cvt_pk_bf16_f32 v37, v22, v23
    v_cvt_pk_bf16_f32 v38, v24, v25
    v_cvt_pk_bf16_f32 v39, v26, v27
    buffer_store_dwordx4 v[36:39], v251, s[4:7], s53 offen offset:0 sc1
    v_accvgpr_read_b32 v40, a136
    v_accvgpr_read_b32 v41, a137
    v_accvgpr_read_b32 v42, a138
    v_accvgpr_read_b32 v43, a139
    v_accvgpr_read_b32 v44, a140
    v_accvgpr_read_b32 v45, a141
    v_accvgpr_read_b32 v46, a142
    v_accvgpr_read_b32 v47, a143
    v_pk_mul_f32 v[48:49], v[40:41], v[40:41]
    v_pk_mul_f32 v[50:51], v[42:43], v[42:43]
    v_pk_mul_f32 v[52:53], v[44:45], v[44:45]
    v_pk_mul_f32 v[54:55], v[46:47], v[46:47]
    v_pk_fma_f32 v[48:49], v[48:49], v[242:243], v[240:241]
    v_pk_fma_f32 v[50:51], v[50:51], v[242:243], v[240:241]
    v_pk_fma_f32 v[52:53], v[52:53], v[242:243], v[240:241]
    v_pk_fma_f32 v[54:55], v[54:55], v[242:243], v[240:241]
    v_pk_mul_f32 v[48:49], v[48:49], v[40:41]
    v_pk_mul_f32 v[50:51], v[50:51], v[42:43]
    v_pk_mul_f32 v[52:53], v[52:53], v[44:45]
    v_pk_mul_f32 v[54:55], v[54:55], v[46:47]
    v_exp_f32 v48, v48
    v_exp_f32 v49, v49
    v_exp_f32 v50, v50
    v_exp_f32 v51, v51
    v_exp_f32 v52, v52
    v_exp_f32 v53, v53
    v_exp_f32 v54, v54
    v_exp_f32 v55, v55
    v_pk_add_f32 v[48:49], v[48:49], v[244:245]
    v_pk_add_f32 v[50:51], v[50:51], v[244:245]
    v_pk_add_f32 v[52:53], v[52:53], v[244:245]
    v_pk_add_f32 v[54:55], v[54:55], v[244:245]
    v_rcp_f32 v48, v48
    v_rcp_f32 v49, v49
    v_rcp_f32 v50, v50
    v_rcp_f32 v51, v51
    v_rcp_f32 v52, v52
    v_rcp_f32 v53, v53
    v_rcp_f32 v54, v54
    v_rcp_f32 v55, v55
    v_pk_mul_f32 v[40:41], v[48:49], v[40:41]
    v_pk_mul_f32 v[42:43], v[50:51], v[42:43]
    v_pk_mul_f32 v[44:45], v[52:53], v[44:45]
    v_pk_mul_f32 v[46:47], v[54:55], v[46:47]
    v_cvt_pk_bf16_f32 v56, v40, v41
    v_cvt_pk_bf16_f32 v57, v42, v43
    v_cvt_pk_bf16_f32 v58, v44, v45
    v_cvt_pk_bf16_f32 v59, v46, v47
    buffer_store_dwordx4 v[56:59], v251, s[4:7], s53 offen offset:1024 sc1
    v_accvgpr_read_b32 v0, a144
    v_accvgpr_read_b32 v1, a145
    v_accvgpr_read_b32 v2, a146
    v_accvgpr_read_b32 v3, a147
    v_accvgpr_read_b32 v4, a148
    v_accvgpr_read_b32 v5, a149
    v_accvgpr_read_b32 v6, a150
    v_accvgpr_read_b32 v7, a151
    v_pk_mul_f32 v[8:9], v[0:1], v[0:1]
    v_pk_mul_f32 v[10:11], v[2:3], v[2:3]
    v_pk_mul_f32 v[12:13], v[4:5], v[4:5]
    v_pk_mul_f32 v[14:15], v[6:7], v[6:7]
    v_pk_fma_f32 v[8:9], v[8:9], v[242:243], v[240:241]
    v_pk_fma_f32 v[10:11], v[10:11], v[242:243], v[240:241]
    v_pk_fma_f32 v[12:13], v[12:13], v[242:243], v[240:241]
    v_pk_fma_f32 v[14:15], v[14:15], v[242:243], v[240:241]
    v_pk_mul_f32 v[8:9], v[8:9], v[0:1]
    v_pk_mul_f32 v[10:11], v[10:11], v[2:3]
    v_pk_mul_f32 v[12:13], v[12:13], v[4:5]
    v_pk_mul_f32 v[14:15], v[14:15], v[6:7]
    v_exp_f32 v8, v8
    v_exp_f32 v9, v9
    v_exp_f32 v10, v10
    v_exp_f32 v11, v11
    v_exp_f32 v12, v12
    v_exp_f32 v13, v13
    v_exp_f32 v14, v14
    v_exp_f32 v15, v15
    v_pk_add_f32 v[8:9], v[8:9], v[244:245]
    v_pk_add_f32 v[10:11], v[10:11], v[244:245]
    v_pk_add_f32 v[12:13], v[12:13], v[244:245]
    v_pk_add_f32 v[14:15], v[14:15], v[244:245]
    v_rcp_f32 v8, v8
    v_rcp_f32 v9, v9
    v_rcp_f32 v10, v10
    v_rcp_f32 v11, v11
    v_rcp_f32 v12, v12
    v_rcp_f32 v13, v13
    v_rcp_f32 v14, v14
    v_rcp_f32 v15, v15
    v_pk_mul_f32 v[0:1], v[8:9], v[0:1]
    v_pk_mul_f32 v[2:3], v[10:11], v[2:3]
    v_pk_mul_f32 v[4:5], v[12:13], v[4:5]
    v_pk_mul_f32 v[6:7], v[14:15], v[6:7]
    v_cvt_pk_bf16_f32 v16, v0, v1
    v_cvt_pk_bf16_f32 v17, v2, v3
    v_cvt_pk_bf16_f32 v18, v4, v5
    v_cvt_pk_bf16_f32 v19, v6, v7
    buffer_store_dwordx4 v[16:19], v251, s[4:7], s53 offen offset:2048 sc1
    v_accvgpr_read_b32 v20, a152
    v_accvgpr_read_b32 v21, a153
    v_accvgpr_read_b32 v22, a154
    v_accvgpr_read_b32 v23, a155
    v_accvgpr_read_b32 v24, a156
    v_accvgpr_read_b32 v25, a157
    v_accvgpr_read_b32 v26, a158
    v_accvgpr_read_b32 v27, a159
    v_pk_mul_f32 v[28:29], v[20:21], v[20:21]
    v_pk_mul_f32 v[30:31], v[22:23], v[22:23]
    v_pk_mul_f32 v[32:33], v[24:25], v[24:25]
    v_pk_mul_f32 v[34:35], v[26:27], v[26:27]
    v_pk_fma_f32 v[28:29], v[28:29], v[242:243], v[240:241]
    v_pk_fma_f32 v[30:31], v[30:31], v[242:243], v[240:241]
    v_pk_fma_f32 v[32:33], v[32:33], v[242:243], v[240:241]
    v_pk_fma_f32 v[34:35], v[34:35], v[242:243], v[240:241]
    v_pk_mul_f32 v[28:29], v[28:29], v[20:21]
    v_pk_mul_f32 v[30:31], v[30:31], v[22:23]
    v_pk_mul_f32 v[32:33], v[32:33], v[24:25]
    v_pk_mul_f32 v[34:35], v[34:35], v[26:27]
    v_exp_f32 v28, v28
    v_exp_f32 v29, v29
    v_exp_f32 v30, v30
    v_exp_f32 v31, v31
    v_exp_f32 v32, v32
    v_exp_f32 v33, v33
    v_exp_f32 v34, v34
    v_exp_f32 v35, v35
    v_pk_add_f32 v[28:29], v[28:29], v[244:245]
    v_pk_add_f32 v[30:31], v[30:31], v[244:245]
    v_pk_add_f32 v[32:33], v[32:33], v[244:245]
    v_pk_add_f32 v[34:35], v[34:35], v[244:245]
    v_rcp_f32 v28, v28
    v_rcp_f32 v29, v29
    v_rcp_f32 v30, v30
    v_rcp_f32 v31, v31
    v_rcp_f32 v32, v32
    v_rcp_f32 v33, v33
    v_rcp_f32 v34, v34
    v_rcp_f32 v35, v35
    v_pk_mul_f32 v[20:21], v[28:29], v[20:21]
    v_pk_mul_f32 v[22:23], v[30:31], v[22:23]
    v_pk_mul_f32 v[24:25], v[32:33], v[24:25]
    v_pk_mul_f32 v[26:27], v[34:35], v[26:27]
    v_cvt_pk_bf16_f32 v36, v20, v21
    v_cvt_pk_bf16_f32 v37, v22, v23
    v_cvt_pk_bf16_f32 v38, v24, v25
    v_cvt_pk_bf16_f32 v39, v26, v27
    buffer_store_dwordx4 v[36:39], v251, s[4:7], s53 offen offset:3072 sc1
    s_add_u32 s53, s53, s22
    v_accvgpr_read_b32 v40, a160
    v_accvgpr_read_b32 v41, a161
    v_accvgpr_read_b32 v42, a162
    v_accvgpr_read_b32 v43, a163
    v_accvgpr_read_b32 v44, a164
    v_accvgpr_read_b32 v45, a165
    v_accvgpr_read_b32 v46, a166
    v_accvgpr_read_b32 v47, a167
    v_pk_mul_f32 v[48:49], v[40:41], v[40:41]
    v_pk_mul_f32 v[50:51], v[42:43], v[42:43]
    v_pk_mul_f32 v[52:53], v[44:45], v[44:45]
    v_pk_mul_f32 v[54:55], v[46:47], v[46:47]
    v_pk_fma_f32 v[48:49], v[48:49], v[242:243], v[240:241]
    v_pk_fma_f32 v[50:51], v[50:51], v[242:243], v[240:241]
    v_pk_fma_f32 v[52:53], v[52:53], v[242:243], v[240:241]
    v_pk_fma_f32 v[54:55], v[54:55], v[242:243], v[240:241]
    v_pk_mul_f32 v[48:49], v[48:49], v[40:41]
    v_pk_mul_f32 v[50:51], v[50:51], v[42:43]
    v_pk_mul_f32 v[52:53], v[52:53], v[44:45]
    v_pk_mul_f32 v[54:55], v[54:55], v[46:47]
    v_exp_f32 v48, v48
    v_exp_f32 v49, v49
    v_exp_f32 v50, v50
    v_exp_f32 v51, v51
    v_exp_f32 v52, v52
    v_exp_f32 v53, v53
    v_exp_f32 v54, v54
    v_exp_f32 v55, v55
    v_pk_add_f32 v[48:49], v[48:49], v[244:245]
    v_pk_add_f32 v[50:51], v[50:51], v[244:245]
    v_pk_add_f32 v[52:53], v[52:53], v[244:245]
    v_pk_add_f32 v[54:55], v[54:55], v[244:245]
    v_rcp_f32 v48, v48
    v_rcp_f32 v49, v49
    v_rcp_f32 v50, v50
    v_rcp_f32 v51, v51
    v_rcp_f32 v52, v52
    v_rcp_f32 v53, v53
    v_rcp_f32 v54, v54
    v_rcp_f32 v55, v55
    v_pk_mul_f32 v[40:41], v[48:49], v[40:41]
    v_pk_mul_f32 v[42:43], v[50:51], v[42:43]
    v_pk_mul_f32 v[44:45], v[52:53], v[44:45]
    v_pk_mul_f32 v[46:47], v[54:55], v[46:47]
    v_cvt_pk_bf16_f32 v56, v40, v41
    v_cvt_pk_bf16_f32 v57, v42, v43
    v_cvt_pk_bf16_f32 v58, v44, v45
    v_cvt_pk_bf16_f32 v59, v46, v47
    buffer_store_dwordx4 v[56:59], v251, s[4:7], s53 offen offset:0 sc1
    v_accvgpr_read_b32 v0, a168
    v_accvgpr_read_b32 v1, a169
    v_accvgpr_read_b32 v2, a170
    v_accvgpr_read_b32 v3, a171
    v_accvgpr_read_b32 v4, a172
    v_accvgpr_read_b32 v5, a173
    v_accvgpr_read_b32 v6, a174
    v_accvgpr_read_b32 v7, a175
    v_pk_mul_f32 v[8:9], v[0:1], v[0:1]
    v_pk_mul_f32 v[10:11], v[2:3], v[2:3]
    v_pk_mul_f32 v[12:13], v[4:5], v[4:5]
    v_pk_mul_f32 v[14:15], v[6:7], v[6:7]
    v_pk_fma_f32 v[8:9], v[8:9], v[242:243], v[240:241]
    v_pk_fma_f32 v[10:11], v[10:11], v[242:243], v[240:241]
    v_pk_fma_f32 v[12:13], v[12:13], v[242:243], v[240:241]
    v_pk_fma_f32 v[14:15], v[14:15], v[242:243], v[240:241]
    v_pk_mul_f32 v[8:9], v[8:9], v[0:1]
    v_pk_mul_f32 v[10:11], v[10:11], v[2:3]
    v_pk_mul_f32 v[12:13], v[12:13], v[4:5]
    v_pk_mul_f32 v[14:15], v[14:15], v[6:7]
    v_exp_f32 v8, v8
    v_exp_f32 v9, v9
    v_exp_f32 v10, v10
    v_exp_f32 v11, v11
    v_exp_f32 v12, v12
    v_exp_f32 v13, v13
    v_exp_f32 v14, v14
    v_exp_f32 v15, v15
    v_pk_add_f32 v[8:9], v[8:9], v[244:245]
    v_pk_add_f32 v[10:11], v[10:11], v[244:245]
    v_pk_add_f32 v[12:13], v[12:13], v[244:245]
    v_pk_add_f32 v[14:15], v[14:15], v[244:245]
    v_rcp_f32 v8, v8
    v_rcp_f32 v9, v9
    v_rcp_f32 v10, v10
    v_rcp_f32 v11, v11
    v_rcp_f32 v12, v12
    v_rcp_f32 v13, v13
    v_rcp_f32 v14, v14
    v_rcp_f32 v15, v15
    v_pk_mul_f32 v[0:1], v[8:9], v[0:1]
    v_pk_mul_f32 v[2:3], v[10:11], v[2:3]
    v_pk_mul_f32 v[4:5], v[12:13], v[4:5]
    v_pk_mul_f32 v[6:7], v[14:15], v[6:7]
    v_cvt_pk_bf16_f32 v16, v0, v1
    v_cvt_pk_bf16_f32 v17, v2, v3
    v_cvt_pk_bf16_f32 v18, v4, v5
    v_cvt_pk_bf16_f32 v19, v6, v7
    buffer_store_dwordx4 v[16:19], v251, s[4:7], s53 offen offset:1024 sc1
    v_accvgpr_read_b32 v20, a176
    v_accvgpr_read_b32 v21, a177
    v_accvgpr_read_b32 v22, a178
    v_accvgpr_read_b32 v23, a179
    v_accvgpr_read_b32 v24, a180
    v_accvgpr_read_b32 v25, a181
    v_accvgpr_read_b32 v26, a182
    v_accvgpr_read_b32 v27, a183
    v_pk_mul_f32 v[28:29], v[20:21], v[20:21]
    v_pk_mul_f32 v[30:31], v[22:23], v[22:23]
    v_pk_mul_f32 v[32:33], v[24:25], v[24:25]
    v_pk_mul_f32 v[34:35], v[26:27], v[26:27]
    v_pk_fma_f32 v[28:29], v[28:29], v[242:243], v[240:241]
    v_pk_fma_f32 v[30:31], v[30:31], v[242:243], v[240:241]
    v_pk_fma_f32 v[32:33], v[32:33], v[242:243], v[240:241]
    v_pk_fma_f32 v[34:35], v[34:35], v[242:243], v[240:241]
    v_pk_mul_f32 v[28:29], v[28:29], v[20:21]
    v_pk_mul_f32 v[30:31], v[30:31], v[22:23]
    v_pk_mul_f32 v[32:33], v[32:33], v[24:25]
    v_pk_mul_f32 v[34:35], v[34:35], v[26:27]
    v_exp_f32 v28, v28
    v_exp_f32 v29, v29
    v_exp_f32 v30, v30
    v_exp_f32 v31, v31
    v_exp_f32 v32, v32
    v_exp_f32 v33, v33
    v_exp_f32 v34, v34
    v_exp_f32 v35, v35
    v_pk_add_f32 v[28:29], v[28:29], v[244:245]
    v_pk_add_f32 v[30:31], v[30:31], v[244:245]
    v_pk_add_f32 v[32:33], v[32:33], v[244:245]
    v_pk_add_f32 v[34:35], v[34:35], v[244:245]
    v_rcp_f32 v28, v28
    v_rcp_f32 v29, v29
    v_rcp_f32 v30, v30
    v_rcp_f32 v31, v31
    v_rcp_f32 v32, v32
    v_rcp_f32 v33, v33
    v_rcp_f32 v34, v34
    v_rcp_f32 v35, v35
    v_pk_mul_f32 v[20:21], v[28:29], v[20:21]
    v_pk_mul_f32 v[22:23], v[30:31], v[22:23]
    v_pk_mul_f32 v[24:25], v[32:33], v[24:25]
    v_pk_mul_f32 v[26:27], v[34:35], v[26:27]
    v_cvt_pk_bf16_f32 v36, v20, v21
    v_cvt_pk_bf16_f32 v37, v22, v23
    v_cvt_pk_bf16_f32 v38, v24, v25
    v_cvt_pk_bf16_f32 v39, v26, v27
    buffer_store_dwordx4 v[36:39], v251, s[4:7], s53 offen offset:2048 sc1
    v_accvgpr_read_b32 v40, a184
    v_accvgpr_read_b32 v41, a185
    v_accvgpr_read_b32 v42, a186
    v_accvgpr_read_b32 v43, a187
    v_accvgpr_read_b32 v44, a188
    v_accvgpr_read_b32 v45, a189
    v_accvgpr_read_b32 v46, a190
    v_accvgpr_read_b32 v47, a191
    v_pk_mul_f32 v[48:49], v[40:41], v[40:41]
    v_pk_mul_f32 v[50:51], v[42:43], v[42:43]
    v_pk_mul_f32 v[52:53], v[44:45], v[44:45]
    v_pk_mul_f32 v[54:55], v[46:47], v[46:47]
    v_pk_fma_f32 v[48:49], v[48:49], v[242:243], v[240:241]
    v_pk_fma_f32 v[50:51], v[50:51], v[242:243], v[240:241]
    v_pk_fma_f32 v[52:53], v[52:53], v[242:243], v[240:241]
    v_pk_fma_f32 v[54:55], v[54:55], v[242:243], v[240:241]
    v_pk_mul_f32 v[48:49], v[48:49], v[40:41]
    v_pk_mul_f32 v[50:51], v[50:51], v[42:43]
    v_pk_mul_f32 v[52:53], v[52:53], v[44:45]
    v_pk_mul_f32 v[54:55], v[54:55], v[46:47]
    v_exp_f32 v48, v48
    v_exp_f32 v49, v49
    v_exp_f32 v50, v50
    v_exp_f32 v51, v51
    v_exp_f32 v52, v52
    v_exp_f32 v53, v53
    v_exp_f32 v54, v54
    v_exp_f32 v55, v55
    v_pk_add_f32 v[48:49], v[48:49], v[244:245]
    v_pk_add_f32 v[50:51], v[50:51], v[244:245]
    v_pk_add_f32 v[52:53], v[52:53], v[244:245]
    v_pk_add_f32 v[54:55], v[54:55], v[244:245]
    v_rcp_f32 v48, v48
    v_rcp_f32 v49, v49
    v_rcp_f32 v50, v50
    v_rcp_f32 v51, v51
    v_rcp_f32 v52, v52
    v_rcp_f32 v53, v53
    v_rcp_f32 v54, v54
    v_rcp_f32 v55, v55
    v_pk_mul_f32 v[40:41], v[48:49], v[40:41]
    v_pk_mul_f32 v[42:43], v[50:51], v[42:43]
    v_pk_mul_f32 v[44:45], v[52:53], v[44:45]
    v_pk_mul_f32 v[46:47], v[54:55], v[46:47]
    v_cvt_pk_bf16_f32 v56, v40, v41
    v_cvt_pk_bf16_f32 v57, v42, v43
    v_cvt_pk_bf16_f32 v58, v44, v45
    v_cvt_pk_bf16_f32 v59, v46, v47
    buffer_store_dwordx4 v[56:59], v251, s[4:7], s53 offen offset:3072 sc1
    s_add_u32 s53, s53, s22
    v_accvgpr_read_b32 v0, a192
    v_accvgpr_read_b32 v1, a193
    v_accvgpr_read_b32 v2, a194
    v_accvgpr_read_b32 v3, a195
    v_accvgpr_read_b32 v4, a196
    v_accvgpr_read_b32 v5, a197
    v_accvgpr_read_b32 v6, a198
    v_accvgpr_read_b32 v7, a199
    v_pk_mul_f32 v[8:9], v[0:1], v[0:1]
    v_pk_mul_f32 v[10:11], v[2:3], v[2:3]
    v_pk_mul_f32 v[12:13], v[4:5], v[4:5]
    v_pk_mul_f32 v[14:15], v[6:7], v[6:7]
    v_pk_fma_f32 v[8:9], v[8:9], v[242:243], v[240:241]
    v_pk_fma_f32 v[10:11], v[10:11], v[242:243], v[240:241]
    v_pk_fma_f32 v[12:13], v[12:13], v[242:243], v[240:241]
    v_pk_fma_f32 v[14:15], v[14:15], v[242:243], v[240:241]
    v_pk_mul_f32 v[8:9], v[8:9], v[0:1]
    v_pk_mul_f32 v[10:11], v[10:11], v[2:3]
    v_pk_mul_f32 v[12:13], v[12:13], v[4:5]
    v_pk_mul_f32 v[14:15], v[14:15], v[6:7]
    v_exp_f32 v8, v8
    v_exp_f32 v9, v9
    v_exp_f32 v10, v10
    v_exp_f32 v11, v11
    v_exp_f32 v12, v12
    v_exp_f32 v13, v13
    v_exp_f32 v14, v14
    v_exp_f32 v15, v15
    v_pk_add_f32 v[8:9], v[8:9], v[244:245]
    v_pk_add_f32 v[10:11], v[10:11], v[244:245]
    v_pk_add_f32 v[12:13], v[12:13], v[244:245]
    v_pk_add_f32 v[14:15], v[14:15], v[244:245]
    v_rcp_f32 v8, v8
    v_rcp_f32 v9, v9
    v_rcp_f32 v10, v10
    v_rcp_f32 v11, v11
    v_rcp_f32 v12, v12
    v_rcp_f32 v13, v13
    v_rcp_f32 v14, v14
    v_rcp_f32 v15, v15
    v_pk_mul_f32 v[0:1], v[8:9], v[0:1]
    v_pk_mul_f32 v[2:3], v[10:11], v[2:3]
    v_pk_mul_f32 v[4:5], v[12:13], v[4:5]
    v_pk_mul_f32 v[6:7], v[14:15], v[6:7]
    v_cvt_pk_bf16_f32 v16, v0, v1
    v_cvt_pk_bf16_f32 v17, v2, v3
    v_cvt_pk_bf16_f32 v18, v4, v5
    v_cvt_pk_bf16_f32 v19, v6, v7
    buffer_store_dwordx4 v[16:19], v251, s[4:7], s53 offen offset:0 sc1
    v_accvgpr_read_b32 v20, a200
    v_accvgpr_read_b32 v21, a201
    v_accvgpr_read_b32 v22, a202
    v_accvgpr_read_b32 v23, a203
    v_accvgpr_read_b32 v24, a204
    v_accvgpr_read_b32 v25, a205
    v_accvgpr_read_b32 v26, a206
    v_accvgpr_read_b32 v27, a207
    v_pk_mul_f32 v[28:29], v[20:21], v[20:21]
    v_pk_mul_f32 v[30:31], v[22:23], v[22:23]
    v_pk_mul_f32 v[32:33], v[24:25], v[24:25]
    v_pk_mul_f32 v[34:35], v[26:27], v[26:27]
    v_pk_fma_f32 v[28:29], v[28:29], v[242:243], v[240:241]
    v_pk_fma_f32 v[30:31], v[30:31], v[242:243], v[240:241]
    v_pk_fma_f32 v[32:33], v[32:33], v[242:243], v[240:241]
    v_pk_fma_f32 v[34:35], v[34:35], v[242:243], v[240:241]
    v_pk_mul_f32 v[28:29], v[28:29], v[20:21]
    v_pk_mul_f32 v[30:31], v[30:31], v[22:23]
    v_pk_mul_f32 v[32:33], v[32:33], v[24:25]
    v_pk_mul_f32 v[34:35], v[34:35], v[26:27]
    v_exp_f32 v28, v28
    v_exp_f32 v29, v29
    v_exp_f32 v30, v30
    v_exp_f32 v31, v31
    v_exp_f32 v32, v32
    v_exp_f32 v33, v33
    v_exp_f32 v34, v34
    v_exp_f32 v35, v35
    v_pk_add_f32 v[28:29], v[28:29], v[244:245]
    v_pk_add_f32 v[30:31], v[30:31], v[244:245]
    v_pk_add_f32 v[32:33], v[32:33], v[244:245]
    v_pk_add_f32 v[34:35], v[34:35], v[244:245]
    v_rcp_f32 v28, v28
    v_rcp_f32 v29, v29
    v_rcp_f32 v30, v30
    v_rcp_f32 v31, v31
    v_rcp_f32 v32, v32
    v_rcp_f32 v33, v33
    v_rcp_f32 v34, v34
    v_rcp_f32 v35, v35
    v_pk_mul_f32 v[20:21], v[28:29], v[20:21]
    v_pk_mul_f32 v[22:23], v[30:31], v[22:23]
    v_pk_mul_f32 v[24:25], v[32:33], v[24:25]
    v_pk_mul_f32 v[26:27], v[34:35], v[26:27]
    v_cvt_pk_bf16_f32 v36, v20, v21
    v_cvt_pk_bf16_f32 v37, v22, v23
    v_cvt_pk_bf16_f32 v38, v24, v25
    v_cvt_pk_bf16_f32 v39, v26, v27
    buffer_store_dwordx4 v[36:39], v251, s[4:7], s53 offen offset:1024 sc1
    v_accvgpr_read_b32 v40, a208
    v_accvgpr_read_b32 v41, a209
    v_accvgpr_read_b32 v42, a210
    v_accvgpr_read_b32 v43, a211
    v_accvgpr_read_b32 v44, a212
    v_accvgpr_read_b32 v45, a213
    v_accvgpr_read_b32 v46, a214
    v_accvgpr_read_b32 v47, a215
    v_pk_mul_f32 v[48:49], v[40:41], v[40:41]
    v_pk_mul_f32 v[50:51], v[42:43], v[42:43]
    v_pk_mul_f32 v[52:53], v[44:45], v[44:45]
    v_pk_mul_f32 v[54:55], v[46:47], v[46:47]
    v_pk_fma_f32 v[48:49], v[48:49], v[242:243], v[240:241]
    v_pk_fma_f32 v[50:51], v[50:51], v[242:243], v[240:241]
    v_pk_fma_f32 v[52:53], v[52:53], v[242:243], v[240:241]
    v_pk_fma_f32 v[54:55], v[54:55], v[242:243], v[240:241]
    v_pk_mul_f32 v[48:49], v[48:49], v[40:41]
    v_pk_mul_f32 v[50:51], v[50:51], v[42:43]
    v_pk_mul_f32 v[52:53], v[52:53], v[44:45]
    v_pk_mul_f32 v[54:55], v[54:55], v[46:47]
    v_exp_f32 v48, v48
    v_exp_f32 v49, v49
    v_exp_f32 v50, v50
    v_exp_f32 v51, v51
    v_exp_f32 v52, v52
    v_exp_f32 v53, v53
    v_exp_f32 v54, v54
    v_exp_f32 v55, v55
    v_pk_add_f32 v[48:49], v[48:49], v[244:245]
    v_pk_add_f32 v[50:51], v[50:51], v[244:245]
    v_pk_add_f32 v[52:53], v[52:53], v[244:245]
    v_pk_add_f32 v[54:55], v[54:55], v[244:245]
    v_rcp_f32 v48, v48
    v_rcp_f32 v49, v49
    v_rcp_f32 v50, v50
    v_rcp_f32 v51, v51
    v_rcp_f32 v52, v52
    v_rcp_f32 v53, v53
    v_rcp_f32 v54, v54
    v_rcp_f32 v55, v55
    v_pk_mul_f32 v[40:41], v[48:49], v[40:41]
    v_pk_mul_f32 v[42:43], v[50:51], v[42:43]
    v_pk_mul_f32 v[44:45], v[52:53], v[44:45]
    v_pk_mul_f32 v[46:47], v[54:55], v[46:47]
    v_cvt_pk_bf16_f32 v56, v40, v41
    v_cvt_pk_bf16_f32 v57, v42, v43
    v_cvt_pk_bf16_f32 v58, v44, v45
    v_cvt_pk_bf16_f32 v59, v46, v47
    buffer_store_dwordx4 v[56:59], v251, s[4:7], s53 offen offset:2048 sc1
    v_accvgpr_read_b32 v0, a216
    v_accvgpr_read_b32 v1, a217
    v_accvgpr_read_b32 v2, a218
    v_accvgpr_read_b32 v3, a219
    v_accvgpr_read_b32 v4, a220
    v_accvgpr_read_b32 v5, a221
    v_accvgpr_read_b32 v6, a222
    v_accvgpr_read_b32 v7, a223
    v_pk_mul_f32 v[8:9], v[0:1], v[0:1]
    v_pk_mul_f32 v[10:11], v[2:3], v[2:3]
    v_pk_mul_f32 v[12:13], v[4:5], v[4:5]
    v_pk_mul_f32 v[14:15], v[6:7], v[6:7]
    v_pk_fma_f32 v[8:9], v[8:9], v[242:243], v[240:241]
    v_pk_fma_f32 v[10:11], v[10:11], v[242:243], v[240:241]
    v_pk_fma_f32 v[12:13], v[12:13], v[242:243], v[240:241]
    v_pk_fma_f32 v[14:15], v[14:15], v[242:243], v[240:241]
    v_pk_mul_f32 v[8:9], v[8:9], v[0:1]
    v_pk_mul_f32 v[10:11], v[10:11], v[2:3]
    v_pk_mul_f32 v[12:13], v[12:13], v[4:5]
    v_pk_mul_f32 v[14:15], v[14:15], v[6:7]
    v_exp_f32 v8, v8
    v_exp_f32 v9, v9
    v_exp_f32 v10, v10
    v_exp_f32 v11, v11
    v_exp_f32 v12, v12
    v_exp_f32 v13, v13
    v_exp_f32 v14, v14
    v_exp_f32 v15, v15
    v_pk_add_f32 v[8:9], v[8:9], v[244:245]
    v_pk_add_f32 v[10:11], v[10:11], v[244:245]
    v_pk_add_f32 v[12:13], v[12:13], v[244:245]
    v_pk_add_f32 v[14:15], v[14:15], v[244:245]
    v_rcp_f32 v8, v8
    v_rcp_f32 v9, v9
    v_rcp_f32 v10, v10
    v_rcp_f32 v11, v11
    v_rcp_f32 v12, v12
    v_rcp_f32 v13, v13
    v_rcp_f32 v14, v14
    v_rcp_f32 v15, v15
    v_pk_mul_f32 v[0:1], v[8:9], v[0:1]
    v_pk_mul_f32 v[2:3], v[10:11], v[2:3]
    v_pk_mul_f32 v[4:5], v[12:13], v[4:5]
    v_pk_mul_f32 v[6:7], v[14:15], v[6:7]
    v_cvt_pk_bf16_f32 v16, v0, v1
    v_cvt_pk_bf16_f32 v17, v2, v3
    v_cvt_pk_bf16_f32 v18, v4, v5
    v_cvt_pk_bf16_f32 v19, v6, v7
    buffer_store_dwordx4 v[16:19], v251, s[4:7], s53 offen offset:3072 sc1
    s_add_u32 s53, s53, s22
    v_accvgpr_read_b32 v20, a224
    v_accvgpr_read_b32 v21, a225
    v_accvgpr_read_b32 v22, a226
    v_accvgpr_read_b32 v23, a227
    v_accvgpr_read_b32 v24, a228
    v_accvgpr_read_b32 v25, a229
    v_accvgpr_read_b32 v26, a230
    v_accvgpr_read_b32 v27, a231
    v_pk_mul_f32 v[28:29], v[20:21], v[20:21]
    v_pk_mul_f32 v[30:31], v[22:23], v[22:23]
    v_pk_mul_f32 v[32:33], v[24:25], v[24:25]
    v_pk_mul_f32 v[34:35], v[26:27], v[26:27]
    v_pk_fma_f32 v[28:29], v[28:29], v[242:243], v[240:241]
    v_pk_fma_f32 v[30:31], v[30:31], v[242:243], v[240:241]
    v_pk_fma_f32 v[32:33], v[32:33], v[242:243], v[240:241]
    v_pk_fma_f32 v[34:35], v[34:35], v[242:243], v[240:241]
    v_pk_mul_f32 v[28:29], v[28:29], v[20:21]
    v_pk_mul_f32 v[30:31], v[30:31], v[22:23]
    v_pk_mul_f32 v[32:33], v[32:33], v[24:25]
    v_pk_mul_f32 v[34:35], v[34:35], v[26:27]
    v_exp_f32 v28, v28
    v_exp_f32 v29, v29
    v_exp_f32 v30, v30
    v_exp_f32 v31, v31
    v_exp_f32 v32, v32
    v_exp_f32 v33, v33
    v_exp_f32 v34, v34
    v_exp_f32 v35, v35
    v_pk_add_f32 v[28:29], v[28:29], v[244:245]
    v_pk_add_f32 v[30:31], v[30:31], v[244:245]
    v_pk_add_f32 v[32:33], v[32:33], v[244:245]
    v_pk_add_f32 v[34:35], v[34:35], v[244:245]
    v_rcp_f32 v28, v28
    v_rcp_f32 v29, v29
    v_rcp_f32 v30, v30
    v_rcp_f32 v31, v31
    v_rcp_f32 v32, v32
    v_rcp_f32 v33, v33
    v_rcp_f32 v34, v34
    v_rcp_f32 v35, v35
    v_pk_mul_f32 v[20:21], v[28:29], v[20:21]
    v_pk_mul_f32 v[22:23], v[30:31], v[22:23]
    v_pk_mul_f32 v[24:25], v[32:33], v[24:25]
    v_pk_mul_f32 v[26:27], v[34:35], v[26:27]
    v_cvt_pk_bf16_f32 v36, v20, v21
    v_cvt_pk_bf16_f32 v37, v22, v23
    v_cvt_pk_bf16_f32 v38, v24, v25
    v_cvt_pk_bf16_f32 v39, v26, v27
    buffer_store_dwordx4 v[36:39], v251, s[4:7], s53 offen offset:0 sc1
    v_accvgpr_read_b32 v40, a232
    v_accvgpr_read_b32 v41, a233
    v_accvgpr_read_b32 v42, a234
    v_accvgpr_read_b32 v43, a235
    v_accvgpr_read_b32 v44, a236
    v_accvgpr_read_b32 v45, a237
    v_accvgpr_read_b32 v46, a238
    v_accvgpr_read_b32 v47, a239
    v_pk_mul_f32 v[48:49], v[40:41], v[40:41]
    v_pk_mul_f32 v[50:51], v[42:43], v[42:43]
    v_pk_mul_f32 v[52:53], v[44:45], v[44:45]
    v_pk_mul_f32 v[54:55], v[46:47], v[46:47]
    v_pk_fma_f32 v[48:49], v[48:49], v[242:243], v[240:241]
    v_pk_fma_f32 v[50:51], v[50:51], v[242:243], v[240:241]
    v_pk_fma_f32 v[52:53], v[52:53], v[242:243], v[240:241]
    v_pk_fma_f32 v[54:55], v[54:55], v[242:243], v[240:241]
    v_pk_mul_f32 v[48:49], v[48:49], v[40:41]
    v_pk_mul_f32 v[50:51], v[50:51], v[42:43]
    v_pk_mul_f32 v[52:53], v[52:53], v[44:45]
    v_pk_mul_f32 v[54:55], v[54:55], v[46:47]
    v_exp_f32 v48, v48
    v_exp_f32 v49, v49
    v_exp_f32 v50, v50
    v_exp_f32 v51, v51
    v_exp_f32 v52, v52
    v_exp_f32 v53, v53
    v_exp_f32 v54, v54
    v_exp_f32 v55, v55
    v_pk_add_f32 v[48:49], v[48:49], v[244:245]
    v_pk_add_f32 v[50:51], v[50:51], v[244:245]
    v_pk_add_f32 v[52:53], v[52:53], v[244:245]
    v_pk_add_f32 v[54:55], v[54:55], v[244:245]
    v_rcp_f32 v48, v48
    v_rcp_f32 v49, v49
    v_rcp_f32 v50, v50
    v_rcp_f32 v51, v51
    v_rcp_f32 v52, v52
    v_rcp_f32 v53, v53
    v_rcp_f32 v54, v54
    v_rcp_f32 v55, v55
    v_pk_mul_f32 v[40:41], v[48:49], v[40:41]
    v_pk_mul_f32 v[42:43], v[50:51], v[42:43]
    v_pk_mul_f32 v[44:45], v[52:53], v[44:45]
    v_pk_mul_f32 v[46:47], v[54:55], v[46:47]
    v_cvt_pk_bf16_f32 v56, v40, v41
    v_cvt_pk_bf16_f32 v57, v42, v43
    v_cvt_pk_bf16_f32 v58, v44, v45
    v_cvt_pk_bf16_f32 v59, v46, v47
    buffer_store_dwordx4 v[56:59], v251, s[4:7], s53 offen offset:1024 sc1
    v_accvgpr_read_b32 v0, a240
    v_accvgpr_read_b32 v1, a241
    v_accvgpr_read_b32 v2, a242
    v_accvgpr_read_b32 v3, a243
    v_accvgpr_read_b32 v4, a244
    v_accvgpr_read_b32 v5, a245
    v_accvgpr_read_b32 v6, a246
    v_accvgpr_read_b32 v7, a247
    v_pk_mul_f32 v[8:9], v[0:1], v[0:1]
    v_pk_mul_f32 v[10:11], v[2:3], v[2:3]
    v_pk_mul_f32 v[12:13], v[4:5], v[4:5]
    v_pk_mul_f32 v[14:15], v[6:7], v[6:7]
    v_pk_fma_f32 v[8:9], v[8:9], v[242:243], v[240:241]
    v_pk_fma_f32 v[10:11], v[10:11], v[242:243], v[240:241]
    v_pk_fma_f32 v[12:13], v[12:13], v[242:243], v[240:241]
    v_pk_fma_f32 v[14:15], v[14:15], v[242:243], v[240:241]
    v_pk_mul_f32 v[8:9], v[8:9], v[0:1]
    v_pk_mul_f32 v[10:11], v[10:11], v[2:3]
    v_pk_mul_f32 v[12:13], v[12:13], v[4:5]
    v_pk_mul_f32 v[14:15], v[14:15], v[6:7]
    v_exp_f32 v8, v8
    v_exp_f32 v9, v9
    v_exp_f32 v10, v10
    v_exp_f32 v11, v11
    v_exp_f32 v12, v12
    v_exp_f32 v13, v13
    v_exp_f32 v14, v14
    v_exp_f32 v15, v15
    v_pk_add_f32 v[8:9], v[8:9], v[244:245]
    v_pk_add_f32 v[10:11], v[10:11], v[244:245]
    v_pk_add_f32 v[12:13], v[12:13], v[244:245]
    v_pk_add_f32 v[14:15], v[14:15], v[244:245]
    v_rcp_f32 v8, v8
    v_rcp_f32 v9, v9
    v_rcp_f32 v10, v10
    v_rcp_f32 v11, v11
    v_rcp_f32 v12, v12
    v_rcp_f32 v13, v13
    v_rcp_f32 v14, v14
    v_rcp_f32 v15, v15
    v_pk_mul_f32 v[0:1], v[8:9], v[0:1]
    v_pk_mul_f32 v[2:3], v[10:11], v[2:3]
    v_pk_mul_f32 v[4:5], v[12:13], v[4:5]
    v_pk_mul_f32 v[6:7], v[14:15], v[6:7]
    v_cvt_pk_bf16_f32 v16, v0, v1
    v_cvt_pk_bf16_f32 v17, v2, v3
    v_cvt_pk_bf16_f32 v18, v4, v5
    v_cvt_pk_bf16_f32 v19, v6, v7
    buffer_store_dwordx4 v[16:19], v251, s[4:7], s53 offen offset:2048 sc1
    v_accvgpr_read_b32 v20, a248
    v_accvgpr_read_b32 v21, a249
    v_accvgpr_read_b32 v22, a250
    v_accvgpr_read_b32 v23, a251
    v_accvgpr_read_b32 v24, a252
    v_accvgpr_read_b32 v25, a253
    v_accvgpr_read_b32 v26, a254
    v_accvgpr_read_b32 v27, a255
    v_pk_mul_f32 v[28:29], v[20:21], v[20:21]
    v_pk_mul_f32 v[30:31], v[22:23], v[22:23]
    v_pk_mul_f32 v[32:33], v[24:25], v[24:25]
    v_pk_mul_f32 v[34:35], v[26:27], v[26:27]
    v_pk_fma_f32 v[28:29], v[28:29], v[242:243], v[240:241]
    v_pk_fma_f32 v[30:31], v[30:31], v[242:243], v[240:241]
    v_pk_fma_f32 v[32:33], v[32:33], v[242:243], v[240:241]
    v_pk_fma_f32 v[34:35], v[34:35], v[242:243], v[240:241]
    v_pk_mul_f32 v[28:29], v[28:29], v[20:21]
    v_pk_mul_f32 v[30:31], v[30:31], v[22:23]
    v_pk_mul_f32 v[32:33], v[32:33], v[24:25]
    v_pk_mul_f32 v[34:35], v[34:35], v[26:27]
    v_exp_f32 v28, v28
    v_exp_f32 v29, v29
    v_exp_f32 v30, v30
    v_exp_f32 v31, v31
    v_exp_f32 v32, v32
    v_exp_f32 v33, v33
    v_exp_f32 v34, v34
    v_exp_f32 v35, v35
    v_pk_add_f32 v[28:29], v[28:29], v[244:245]
    v_pk_add_f32 v[30:31], v[30:31], v[244:245]
    v_pk_add_f32 v[32:33], v[32:33], v[244:245]
    v_pk_add_f32 v[34:35], v[34:35], v[244:245]
    v_rcp_f32 v28, v28
    v_rcp_f32 v29, v29
    v_rcp_f32 v30, v30
    v_rcp_f32 v31, v31
    v_rcp_f32 v32, v32
    v_rcp_f32 v33, v33
    v_rcp_f32 v34, v34
    v_rcp_f32 v35, v35
    v_pk_mul_f32 v[20:21], v[28:29], v[20:21]
    v_pk_mul_f32 v[22:23], v[30:31], v[22:23]
    v_pk_mul_f32 v[24:25], v[32:33], v[24:25]
    v_pk_mul_f32 v[26:27], v[34:35], v[26:27]
    v_cvt_pk_bf16_f32 v36, v20, v21
    v_cvt_pk_bf16_f32 v37, v22, v23
    v_cvt_pk_bf16_f32 v38, v24, v25
    v_cvt_pk_bf16_f32 v39, v26, v27
    buffer_store_dwordx4 v[36:39], v251, s[4:7], s53 offen offset:3072 sc1
    s_branch main_kernel_w_done
main_kernel_w_c2_gov:
    v_lshrrev_b32 v0, 4, v250
    v_bfe_u32 v1, v250, 2, 2
    v_lshl_add_u32 v4, v0, 2, v1
    v_and_b32 v5, 7, v4
    v_mul_u32_u24 v4, 512, v4
    v_and_b32 v6, 3, v250
    v_lshl_add_u32 v4, v6, 3, v4
    s_mul_i32 s32, s37, 8
    v_xor_b32 v5, s32, v5
    v_lshl_add_u32 v128, v5, 5, v4
    v_xor_b32 v129, 32, v128
    v_xor_b32 v130, 64, v128
    v_xor_b32 v131, 96, v128
    v_xor_b32 v132, 128, v128
    v_xor_b32 v133, 160, v128
    v_xor_b32 v134, 192, v128
    v_xor_b32 v135, 224, v128
    s_mul_i32 s32, s38, 8192
    s_add_u32 s32, s32, 65536
    v_add_u32 v136, s32, v251
    v_lshrrev_b32 v2, 5, v250
    v_and_b32 v3, 31, v250
    s_mul_i32 s32, s14, 8
    v_add_u32 v4, s32, v2
    v_add_u32 v5, 0, v4
    v_and_b32 v6, 7, v5
    v_lshlrev_b32 v6, 1, v6
    v_xor_b32 v6, v6, v3
    v_mul_lo_u32 v5, v5, s30
    v_lshl_add_u32 v5, v6, 4, v5
    v_subrev_u32 v137, 0, v5
    v_add_u32 v5, 2, v4
    v_and_b32 v6, 7, v5
    v_lshlrev_b32 v6, 1, v6
    v_xor_b32 v6, v6, v3
    v_mul_lo_u32 v5, v5, s30
    v_lshl_add_u32 v5, v6, 4, v5
    v_subrev_u32 v138, 1024, v5
    v_add_u32 v5, 4, v4
    v_and_b32 v6, 7, v5
    v_lshlrev_b32 v6, 1, v6
    v_xor_b32 v6, v6, v3
    v_mul_lo_u32 v5, v5, s30
    v_lshl_add_u32 v5, v6, 4, v5
    v_subrev_u32 v139, 2048, v5
    v_add_u32 v5, 6, v4
    v_and_b32 v6, 7, v5
    v_lshlrev_b32 v6, 1, v6
    v_xor_b32 v6, v6, v3
    v_mul_lo_u32 v5, v5, s30
    v_lshl_add_u32 v5, v6, 4, v5
    v_subrev_u32 v140, 3072, v5
    s_mul_i32 s32, s14, 4
    s_mul_i32 s32, s32, s31
    v_add_u32 v141, s32, v251
    s_add_u32 s32, s32, s31
    s_sub_u32 s32, s32, 1024
    v_add_u32 v142, s32, v251
    s_add_u32 s32, s32, s31
    s_sub_u32 s32, s32, 1024
    v_add_u32 v143, s32, v251
    s_add_u32 s32, s32, s31
    s_sub_u32 s32, s32, 1024
    v_add_u32 v144, s32, v251
    s_mul_i32 s19, s14, 4096
    s_mul_i32 s20, s14, 4096
    s_add_u32 s20, s20, 65536
    s_mul_i32 s17, s30, 32
    s_mov_b32 s15, 0
    s_add_u32 m0, s20, 0
    s_nop 0
    buffer_load_dwordx4 v141, s[4:7], s16 offen offset:0 sc1 lds
    buffer_load_dwordx4 v142, s[4:7], s16 offen offset:1024 sc1 lds
    buffer_load_dwordx4 v143, s[4:7], s16 offen offset:2048 sc1 lds
    buffer_load_dwordx4 v144, s[4:7], s16 offen offset:3072 sc1 lds
    s_add_u32 s16, s16, 1024
    s_add_u32 m0, s19, 0
    s_nop 0
    buffer_load_dwordx4 v137, s[8:11], s15 offen offset:0 lds
    buffer_load_dwordx4 v138, s[8:11], s15 offen offset:1024 lds
    buffer_load_dwordx4 v139, s[8:11], s15 offen offset:2048 lds
    buffer_load_dwordx4 v140, s[8:11], s15 offen offset:3072 lds
    s_add_u32 s15, s15, s17
    s_add_u32 m0, s20, 16384
    s_nop 0
    buffer_load_dwordx4 v141, s[4:7], s16 offen offset:0 sc1 lds
    buffer_load_dwordx4 v142, s[4:7], s16 offen offset:1024 sc1 lds
    buffer_load_dwordx4 v143, s[4:7], s16 offen offset:2048 sc1 lds
    buffer_load_dwordx4 v144, s[4:7], s16 offen offset:3072 sc1 lds
    s_add_u32 s16, s16, 1024
    s_add_u32 m0, s19, 16384
    s_nop 0
    buffer_load_dwordx4 v137, s[8:11], s15 offen offset:0 lds
    buffer_load_dwordx4 v138, s[8:11], s15 offen offset:1024 lds
    buffer_load_dwordx4 v139, s[8:11], s15 offen offset:2048 lds
    buffer_load_dwordx4 v140, s[8:11], s15 offen offset:3072 lds
    s_add_u32 s15, s15, s17
    s_add_u32 m0, s20, 32768
    s_nop 0
    buffer_load_dwordx4 v141, s[4:7], s16 offen offset:0 sc1 lds
    buffer_load_dwordx4 v142, s[4:7], s16 offen offset:1024 sc1 lds
    buffer_load_dwordx4 v143, s[4:7], s16 offen offset:2048 sc1 lds
    buffer_load_dwordx4 v144, s[4:7], s16 offen offset:3072 sc1 lds
    s_add_u32 s16, s16, 1024
    s_add_u32 m0, s19, 32768
    s_nop 0
    buffer_load_dwordx4 v137, s[8:11], s15 offen offset:0 lds
    buffer_load_dwordx4 v138, s[8:11], s15 offen offset:1024 lds
    buffer_load_dwordx4 v139, s[8:11], s15 offen offset:2048 lds
    buffer_load_dwordx4 v140, s[8:11], s15 offen offset:3072 lds
    s_add_u32 s15, s15, s17
    s_add_u32 m0, s20, 49152
    s_nop 0
    buffer_load_dwordx4 v141, s[4:7], s16 offen offset:0 sc1 lds
    buffer_load_dwordx4 v142, s[4:7], s16 offen offset:1024 sc1 lds
    buffer_load_dwordx4 v143, s[4:7], s16 offen offset:2048 sc1 lds
    buffer_load_dwordx4 v144, s[4:7], s16 offen offset:3072 sc1 lds
    s_add_u32 s16, s16, 1024
    s_add_u32 m0, s19, 49152
    s_nop 0
    buffer_load_dwordx4 v137, s[8:11], s15 offen offset:0 lds
    buffer_load_dwordx4 v138, s[8:11], s15 offen offset:1024 lds
    buffer_load_dwordx4 v139, s[8:11], s15 offen offset:2048 lds
    buffer_load_dwordx4 v140, s[8:11], s15 offen offset:3072 lds
    s_add_u32 s15, s15, s17
    v_accvgpr_write_b32 a0, 0
    v_accvgpr_write_b32 a1, 0
    v_accvgpr_write_b32 a2, 0
    v_accvgpr_write_b32 a3, 0
    v_accvgpr_write_b32 a4, 0
    v_accvgpr_write_b32 a5, 0
    v_accvgpr_write_b32 a6, 0
    v_accvgpr_write_b32 a7, 0
    v_accvgpr_write_b32 a8, 0
    v_accvgpr_write_b32 a9, 0
    v_accvgpr_write_b32 a10, 0
    v_accvgpr_write_b32 a11, 0
    v_accvgpr_write_b32 a12, 0
    v_accvgpr_write_b32 a13, 0
    v_accvgpr_write_b32 a14, 0
    v_accvgpr_write_b32 a15, 0
    v_accvgpr_write_b32 a16, 0
    v_accvgpr_write_b32 a17, 0
    v_accvgpr_write_b32 a18, 0
    v_accvgpr_write_b32 a19, 0
    v_accvgpr_write_b32 a20, 0
    v_accvgpr_write_b32 a21, 0
    v_accvgpr_write_b32 a22, 0
    v_accvgpr_write_b32 a23, 0
    v_accvgpr_write_b32 a24, 0
    v_accvgpr_write_b32 a25, 0
    v_accvgpr_write_b32 a26, 0
    v_accvgpr_write_b32 a27, 0
    v_accvgpr_write_b32 a28, 0
    v_accvgpr_write_b32 a29, 0
    v_accvgpr_write_b32 a30, 0
    v_accvgpr_write_b32 a31, 0
    v_accvgpr_write_b32 a32, 0
    v_accvgpr_write_b32 a33, 0
    v_accvgpr_write_b32 a34, 0
    v_accvgpr_write_b32 a35, 0
    v_accvgpr_write_b32 a36, 0
    v_accvgpr_write_b32 a37, 0
    v_accvgpr_write_b32 a38, 0
    v_accvgpr_write_b32 a39, 0
    v_accvgpr_write_b32 a40, 0
    v_accvgpr_write_b32 a41, 0
    v_accvgpr_write_b32 a42, 0
    v_accvgpr_write_b32 a43, 0
    v_accvgpr_write_b32 a44, 0
    v_accvgpr_write_b32 a45, 0
    v_accvgpr_write_b32 a46, 0
    v_accvgpr_write_b32 a47, 0
    v_accvgpr_write_b32 a48, 0
    v_accvgpr_write_b32 a49, 0
    v_accvgpr_write_b32 a50, 0
    v_accvgpr_write_b32 a51, 0
    v_accvgpr_write_b32 a52, 0
    v_accvgpr_write_b32 a53, 0
    v_accvgpr_write_b32 a54, 0
    v_accvgpr_write_b32 a55, 0
    v_accvgpr_write_b32 a56, 0
    v_accvgpr_write_b32 a57, 0
    v_accvgpr_write_b32 a58, 0
    v_accvgpr_write_b32 a59, 0
    v_accvgpr_write_b32 a60, 0
    v_accvgpr_write_b32 a61, 0
    v_accvgpr_write_b32 a62, 0
    v_accvgpr_write_b32 a63, 0
    v_accvgpr_write_b32 a64, 0
    v_accvgpr_write_b32 a65, 0
    v_accvgpr_write_b32 a66, 0
    v_accvgpr_write_b32 a67, 0
    v_accvgpr_write_b32 a68, 0
    v_accvgpr_write_b32 a69, 0
    v_accvgpr_write_b32 a70, 0
    v_accvgpr_write_b32 a71, 0
    v_accvgpr_write_b32 a72, 0
    v_accvgpr_write_b32 a73, 0
    v_accvgpr_write_b32 a74, 0
    v_accvgpr_write_b32 a75, 0
    v_accvgpr_write_b32 a76, 0
    v_accvgpr_write_b32 a77, 0
    v_accvgpr_write_b32 a78, 0
    v_accvgpr_write_b32 a79, 0
    v_accvgpr_write_b32 a80, 0
    v_accvgpr_write_b32 a81, 0
    v_accvgpr_write_b32 a82, 0
    v_accvgpr_write_b32 a83, 0
    v_accvgpr_write_b32 a84, 0
    v_accvgpr_write_b32 a85, 0
    v_accvgpr_write_b32 a86, 0
    v_accvgpr_write_b32 a87, 0
    v_accvgpr_write_b32 a88, 0
    v_accvgpr_write_b32 a89, 0
    v_accvgpr_write_b32 a90, 0
    v_accvgpr_write_b32 a91, 0
    v_accvgpr_write_b32 a92, 0
    v_accvgpr_write_b32 a93, 0
    v_accvgpr_write_b32 a94, 0
    v_accvgpr_write_b32 a95, 0
    v_accvgpr_write_b32 a96, 0
    v_accvgpr_write_b32 a97, 0
    v_accvgpr_write_b32 a98, 0
    v_accvgpr_write_b32 a99, 0
    v_accvgpr_write_b32 a100, 0
    v_accvgpr_write_b32 a101, 0
    v_accvgpr_write_b32 a102, 0
    v_accvgpr_write_b32 a103, 0
    v_accvgpr_write_b32 a104, 0
    v_accvgpr_write_b32 a105, 0
    v_accvgpr_write_b32 a106, 0
    v_accvgpr_write_b32 a107, 0
    v_accvgpr_write_b32 a108, 0
    v_accvgpr_write_b32 a109, 0
    v_accvgpr_write_b32 a110, 0
    v_accvgpr_write_b32 a111, 0
    v_accvgpr_write_b32 a112, 0
    v_accvgpr_write_b32 a113, 0
    v_accvgpr_write_b32 a114, 0
    v_accvgpr_write_b32 a115, 0
    v_accvgpr_write_b32 a116, 0
    v_accvgpr_write_b32 a117, 0
    v_accvgpr_write_b32 a118, 0
    v_accvgpr_write_b32 a119, 0
    v_accvgpr_write_b32 a120, 0
    v_accvgpr_write_b32 a121, 0
    v_accvgpr_write_b32 a122, 0
    v_accvgpr_write_b32 a123, 0
    v_accvgpr_write_b32 a124, 0
    v_accvgpr_write_b32 a125, 0
    v_accvgpr_write_b32 a126, 0
    v_accvgpr_write_b32 a127, 0
    v_accvgpr_write_b32 a128, 0
    v_accvgpr_write_b32 a129, 0
    v_accvgpr_write_b32 a130, 0
    v_accvgpr_write_b32 a131, 0
    v_accvgpr_write_b32 a132, 0
    v_accvgpr_write_b32 a133, 0
    v_accvgpr_write_b32 a134, 0
    v_accvgpr_write_b32 a135, 0
    v_accvgpr_write_b32 a136, 0
    v_accvgpr_write_b32 a137, 0
    v_accvgpr_write_b32 a138, 0
    v_accvgpr_write_b32 a139, 0
    v_accvgpr_write_b32 a140, 0
    v_accvgpr_write_b32 a141, 0
    v_accvgpr_write_b32 a142, 0
    v_accvgpr_write_b32 a143, 0
    v_accvgpr_write_b32 a144, 0
    v_accvgpr_write_b32 a145, 0
    v_accvgpr_write_b32 a146, 0
    v_accvgpr_write_b32 a147, 0
    v_accvgpr_write_b32 a148, 0
    v_accvgpr_write_b32 a149, 0
    v_accvgpr_write_b32 a150, 0
    v_accvgpr_write_b32 a151, 0
    v_accvgpr_write_b32 a152, 0
    v_accvgpr_write_b32 a153, 0
    v_accvgpr_write_b32 a154, 0
    v_accvgpr_write_b32 a155, 0
    v_accvgpr_write_b32 a156, 0
    v_accvgpr_write_b32 a157, 0
    v_accvgpr_write_b32 a158, 0
    v_accvgpr_write_b32 a159, 0
    v_accvgpr_write_b32 a160, 0
    v_accvgpr_write_b32 a161, 0
    v_accvgpr_write_b32 a162, 0
    v_accvgpr_write_b32 a163, 0
    v_accvgpr_write_b32 a164, 0
    v_accvgpr_write_b32 a165, 0
    v_accvgpr_write_b32 a166, 0
    v_accvgpr_write_b32 a167, 0
    v_accvgpr_write_b32 a168, 0
    v_accvgpr_write_b32 a169, 0
    v_accvgpr_write_b32 a170, 0
    v_accvgpr_write_b32 a171, 0
    v_accvgpr_write_b32 a172, 0
    v_accvgpr_write_b32 a173, 0
    v_accvgpr_write_b32 a174, 0
    v_accvgpr_write_b32 a175, 0
    v_accvgpr_write_b32 a176, 0
    v_accvgpr_write_b32 a177, 0
    v_accvgpr_write_b32 a178, 0
    v_accvgpr_write_b32 a179, 0
    v_accvgpr_write_b32 a180, 0
    v_accvgpr_write_b32 a181, 0
    v_accvgpr_write_b32 a182, 0
    v_accvgpr_write_b32 a183, 0
    v_accvgpr_write_b32 a184, 0
    v_accvgpr_write_b32 a185, 0
    v_accvgpr_write_b32 a186, 0
    v_accvgpr_write_b32 a187, 0
    v_accvgpr_write_b32 a188, 0
    v_accvgpr_write_b32 a189, 0
    v_accvgpr_write_b32 a190, 0
    v_accvgpr_write_b32 a191, 0
    v_accvgpr_write_b32 a192, 0
    v_accvgpr_write_b32 a193, 0
    v_accvgpr_write_b32 a194, 0
    v_accvgpr_write_b32 a195, 0
    v_accvgpr_write_b32 a196, 0
    v_accvgpr_write_b32 a197, 0
    v_accvgpr_write_b32 a198, 0
    v_accvgpr_write_b32 a199, 0
    v_accvgpr_write_b32 a200, 0
    v_accvgpr_write_b32 a201, 0
    v_accvgpr_write_b32 a202, 0
    v_accvgpr_write_b32 a203, 0
    v_accvgpr_write_b32 a204, 0
    v_accvgpr_write_b32 a205, 0
    v_accvgpr_write_b32 a206, 0
    v_accvgpr_write_b32 a207, 0
    v_accvgpr_write_b32 a208, 0
    v_accvgpr_write_b32 a209, 0
    v_accvgpr_write_b32 a210, 0
    v_accvgpr_write_b32 a211, 0
    v_accvgpr_write_b32 a212, 0
    v_accvgpr_write_b32 a213, 0
    v_accvgpr_write_b32 a214, 0
    v_accvgpr_write_b32 a215, 0
    v_accvgpr_write_b32 a216, 0
    v_accvgpr_write_b32 a217, 0
    v_accvgpr_write_b32 a218, 0
    v_accvgpr_write_b32 a219, 0
    v_accvgpr_write_b32 a220, 0
    v_accvgpr_write_b32 a221, 0
    v_accvgpr_write_b32 a222, 0
    v_accvgpr_write_b32 a223, 0
    v_accvgpr_write_b32 a224, 0
    v_accvgpr_write_b32 a225, 0
    v_accvgpr_write_b32 a226, 0
    v_accvgpr_write_b32 a227, 0
    v_accvgpr_write_b32 a228, 0
    v_accvgpr_write_b32 a229, 0
    v_accvgpr_write_b32 a230, 0
    v_accvgpr_write_b32 a231, 0
    v_accvgpr_write_b32 a232, 0
    v_accvgpr_write_b32 a233, 0
    v_accvgpr_write_b32 a234, 0
    v_accvgpr_write_b32 a235, 0
    v_accvgpr_write_b32 a236, 0
    v_accvgpr_write_b32 a237, 0
    v_accvgpr_write_b32 a238, 0
    v_accvgpr_write_b32 a239, 0
    v_accvgpr_write_b32 a240, 0
    v_accvgpr_write_b32 a241, 0
    v_accvgpr_write_b32 a242, 0
    v_accvgpr_write_b32 a243, 0
    v_accvgpr_write_b32 a244, 0
    v_accvgpr_write_b32 a245, 0
    v_accvgpr_write_b32 a246, 0
    v_accvgpr_write_b32 a247, 0
    v_accvgpr_write_b32 a248, 0
    v_accvgpr_write_b32 a249, 0
    v_accvgpr_write_b32 a250, 0
    v_accvgpr_write_b32 a251, 0
    v_accvgpr_write_b32 a252, 0
    v_accvgpr_write_b32 a253, 0
    v_accvgpr_write_b32 a254, 0
    v_accvgpr_write_b32 a255, 0
    s_waitcnt vmcnt(24)
    s_barrier
    ds_read_b128 v[32:35], v136 offset:0
    ds_read_b64_tr_b16 v[0:1], v128 offset:0
    ds_read_b64_tr_b16 v[2:3], v128 offset:8192
    ds_read_b64_tr_b16 v[4:5], v129 offset:0
    ds_read_b64_tr_b16 v[6:7], v129 offset:8192
    ds_read_b64_tr_b16 v[8:9], v130 offset:0
    ds_read_b64_tr_b16 v[10:11], v130 offset:8192
    ds_read_b64_tr_b16 v[12:13], v131 offset:0
    ds_read_b64_tr_b16 v[14:15], v131 offset:8192
    ds_read_b64_tr_b16 v[16:17], v132 offset:0
    ds_read_b64_tr_b16 v[18:19], v132 offset:8192
    ds_read_b64_tr_b16 v[20:21], v133 offset:0
    ds_read_b64_tr_b16 v[22:23], v133 offset:8192
    ds_read_b64_tr_b16 v[24:25], v134 offset:0
    ds_read_b64_tr_b16 v[26:27], v134 offset:8192
    ds_read_b64_tr_b16 v[28:29], v135 offset:0
    ds_read_b64_tr_b16 v[30:31], v135 offset:8192
    ds_read_b128 v[36:39], v136 offset:1024
    ds_read_b128 v[40:43], v136 offset:2048
    ds_read_b128 v[44:47], v136 offset:3072
    ds_read_b128 v[48:51], v136 offset:4096
    ds_read_b128 v[52:55], v136 offset:5120
    ds_read_b128 v[56:59], v136 offset:6144
    ds_read_b128 v[60:63], v136 offset:7168
main_kernel_w_c2_v_loop:
    s_waitcnt lgkmcnt(0)
    v_mfma_f32_16x16x32_bf16 a[0:3], v[32:35], v[0:3], a[0:3]
    s_waitcnt vmcnt(16)
    s_barrier
    ds_read_b128 v[96:99], v136 offset:16384
    s_add_u32 m0, s20, 0
    s_nop 0
    v_mfma_f32_16x16x32_bf16 a[4:7], v[32:35], v[4:7], a[4:7]
    ds_read_b64_tr_b16 v[64:65], v128 offset:16384
    v_mfma_f32_16x16x32_bf16 a[8:11], v[32:35], v[8:11], a[8:11]
    ds_read_b64_tr_b16 v[66:67], v128 offset:24576
    v_mfma_f32_16x16x32_bf16 a[12:15], v[32:35], v[12:15], a[12:15]
    ds_read_b64_tr_b16 v[68:69], v129 offset:16384
    v_mfma_f32_16x16x32_bf16 a[16:19], v[32:35], v[16:19], a[16:19]
    ds_read_b64_tr_b16 v[70:71], v129 offset:24576
    v_mfma_f32_16x16x32_bf16 a[20:23], v[32:35], v[20:23], a[20:23]
    ds_read_b64_tr_b16 v[72:73], v130 offset:16384
    buffer_load_dwordx4 v141, s[4:7], s16 offen offset:0 sc1 lds
    v_mfma_f32_16x16x32_bf16 a[24:27], v[32:35], v[24:27], a[24:27]
    ds_read_b64_tr_b16 v[74:75], v130 offset:24576
    v_mfma_f32_16x16x32_bf16 a[28:31], v[32:35], v[28:31], a[28:31]
    ds_read_b64_tr_b16 v[76:77], v131 offset:16384
    v_mfma_f32_16x16x32_bf16 a[32:35], v[36:39], v[0:3], a[32:35]
    ds_read_b64_tr_b16 v[78:79], v131 offset:24576
    v_mfma_f32_16x16x32_bf16 a[36:39], v[36:39], v[4:7], a[36:39]
    ds_read_b64_tr_b16 v[80:81], v132 offset:16384
    v_mfma_f32_16x16x32_bf16 a[40:43], v[36:39], v[8:11], a[40:43]
    ds_read_b64_tr_b16 v[82:83], v132 offset:24576
    buffer_load_dwordx4 v142, s[4:7], s16 offen offset:1024 sc1 lds
    v_mfma_f32_16x16x32_bf16 a[44:47], v[36:39], v[12:15], a[44:47]
    ds_read_b64_tr_b16 v[84:85], v133 offset:16384
    v_mfma_f32_16x16x32_bf16 a[48:51], v[36:39], v[16:19], a[48:51]
    ds_read_b64_tr_b16 v[86:87], v133 offset:24576
    v_mfma_f32_16x16x32_bf16 a[52:55], v[36:39], v[20:23], a[52:55]
    ds_read_b64_tr_b16 v[88:89], v134 offset:16384
    v_mfma_f32_16x16x32_bf16 a[56:59], v[36:39], v[24:27], a[56:59]
    ds_read_b64_tr_b16 v[90:91], v134 offset:24576
    v_mfma_f32_16x16x32_bf16 a[60:63], v[36:39], v[28:31], a[60:63]
    ds_read_b64_tr_b16 v[92:93], v135 offset:16384
    buffer_load_dwordx4 v143, s[4:7], s16 offen offset:2048 sc1 lds
    v_mfma_f32_16x16x32_bf16 a[64:67], v[40:43], v[0:3], a[64:67]
    ds_read_b64_tr_b16 v[94:95], v135 offset:24576
    v_mfma_f32_16x16x32_bf16 a[68:71], v[40:43], v[4:7], a[68:71]
    ds_read_b128 v[100:103], v136 offset:17408
    v_mfma_f32_16x16x32_bf16 a[72:75], v[40:43], v[8:11], a[72:75]
    ds_read_b128 v[104:107], v136 offset:18432
    v_mfma_f32_16x16x32_bf16 a[76:79], v[40:43], v[12:15], a[76:79]
    ds_read_b128 v[108:111], v136 offset:19456
    v_mfma_f32_16x16x32_bf16 a[80:83], v[40:43], v[16:19], a[80:83]
    ds_read_b128 v[112:115], v136 offset:20480
    v_mfma_f32_16x16x32_bf16 a[84:87], v[40:43], v[20:23], a[84:87]
    ds_read_b128 v[116:119], v136 offset:21504
    buffer_load_dwordx4 v144, s[4:7], s16 offen offset:3072 sc1 lds
    v_mfma_f32_16x16x32_bf16 a[88:91], v[40:43], v[24:27], a[88:91]
    ds_read_b128 v[120:123], v136 offset:22528
    v_mfma_f32_16x16x32_bf16 a[92:95], v[40:43], v[28:31], a[92:95]
    ds_read_b128 v[124:127], v136 offset:23552
    v_mfma_f32_16x16x32_bf16 a[96:99], v[44:47], v[0:3], a[96:99]
    v_mfma_f32_16x16x32_bf16 a[100:103], v[44:47], v[4:7], a[100:103]
    v_mfma_f32_16x16x32_bf16 a[104:107], v[44:47], v[8:11], a[104:107]
    s_add_u32 s16, s16, 1024
    v_mfma_f32_16x16x32_bf16 a[108:111], v[44:47], v[12:15], a[108:111]
    v_mfma_f32_16x16x32_bf16 a[112:115], v[44:47], v[16:19], a[112:115]
    v_mfma_f32_16x16x32_bf16 a[116:119], v[44:47], v[20:23], a[116:119]
    v_mfma_f32_16x16x32_bf16 a[120:123], v[44:47], v[24:27], a[120:123]
    v_mfma_f32_16x16x32_bf16 a[124:127], v[44:47], v[28:31], a[124:127]
    s_add_u32 m0, s19, 0
    s_nop 0
    v_mfma_f32_16x16x32_bf16 a[128:131], v[48:51], v[0:3], a[128:131]
    v_mfma_f32_16x16x32_bf16 a[132:135], v[48:51], v[4:7], a[132:135]
    v_mfma_f32_16x16x32_bf16 a[136:139], v[48:51], v[8:11], a[136:139]
    v_mfma_f32_16x16x32_bf16 a[140:143], v[48:51], v[12:15], a[140:143]
    v_mfma_f32_16x16x32_bf16 a[144:147], v[48:51], v[16:19], a[144:147]
    buffer_load_dwordx4 v137, s[8:11], s15 offen offset:0 lds
    v_mfma_f32_16x16x32_bf16 a[148:151], v[48:51], v[20:23], a[148:151]
    v_mfma_f32_16x16x32_bf16 a[152:155], v[48:51], v[24:27], a[152:155]
    v_mfma_f32_16x16x32_bf16 a[156:159], v[48:51], v[28:31], a[156:159]
    v_mfma_f32_16x16x32_bf16 a[160:163], v[52:55], v[0:3], a[160:163]
    v_mfma_f32_16x16x32_bf16 a[164:167], v[52:55], v[4:7], a[164:167]
    v_mfma_f32_16x16x32_bf16 a[168:171], v[52:55], v[8:11], a[168:171]
    buffer_load_dwordx4 v138, s[8:11], s15 offen offset:1024 lds
    v_mfma_f32_16x16x32_bf16 a[172:175], v[52:55], v[12:15], a[172:175]
    v_mfma_f32_16x16x32_bf16 a[176:179], v[52:55], v[16:19], a[176:179]
    v_mfma_f32_16x16x32_bf16 a[180:183], v[52:55], v[20:23], a[180:183]
    v_mfma_f32_16x16x32_bf16 a[184:187], v[52:55], v[24:27], a[184:187]
    v_mfma_f32_16x16x32_bf16 a[188:191], v[52:55], v[28:31], a[188:191]
    buffer_load_dwordx4 v139, s[8:11], s15 offen offset:2048 lds
    v_mfma_f32_16x16x32_bf16 a[192:195], v[56:59], v[0:3], a[192:195]
    v_mfma_f32_16x16x32_bf16 a[196:199], v[56:59], v[4:7], a[196:199]
    v_mfma_f32_16x16x32_bf16 a[200:203], v[56:59], v[8:11], a[200:203]
    v_mfma_f32_16x16x32_bf16 a[204:207], v[56:59], v[12:15], a[204:207]
    v_mfma_f32_16x16x32_bf16 a[208:211], v[56:59], v[16:19], a[208:211]
    buffer_load_dwordx4 v140, s[8:11], s15 offen offset:3072 lds
    v_mfma_f32_16x16x32_bf16 a[212:215], v[56:59], v[20:23], a[212:215]
    v_mfma_f32_16x16x32_bf16 a[216:219], v[56:59], v[24:27], a[216:219]
    v_mfma_f32_16x16x32_bf16 a[220:223], v[56:59], v[28:31], a[220:223]
    v_mfma_f32_16x16x32_bf16 a[224:227], v[60:63], v[0:3], a[224:227]
    v_mfma_f32_16x16x32_bf16 a[228:231], v[60:63], v[4:7], a[228:231]
    s_add_u32 s15, s15, s17
    v_mfma_f32_16x16x32_bf16 a[232:235], v[60:63], v[8:11], a[232:235]
    v_mfma_f32_16x16x32_bf16 a[236:239], v[60:63], v[12:15], a[236:239]
    v_mfma_f32_16x16x32_bf16 a[240:243], v[60:63], v[16:19], a[240:243]
    v_mfma_f32_16x16x32_bf16 a[244:247], v[60:63], v[20:23], a[244:247]
    v_mfma_f32_16x16x32_bf16 a[248:251], v[60:63], v[24:27], a[248:251]
    v_mfma_f32_16x16x32_bf16 a[252:255], v[60:63], v[28:31], a[252:255]
    s_waitcnt lgkmcnt(0)
    v_mfma_f32_16x16x32_bf16 a[0:3], v[96:99], v[64:67], a[0:3]
    s_waitcnt vmcnt(16)
    s_barrier
    ds_read_b128 v[32:35], v136 offset:32768
    s_add_u32 m0, s20, 16384
    s_nop 0
    v_mfma_f32_16x16x32_bf16 a[4:7], v[96:99], v[68:71], a[4:7]
    ds_read_b64_tr_b16 v[0:1], v128 offset:32768
    v_mfma_f32_16x16x32_bf16 a[8:11], v[96:99], v[72:75], a[8:11]
    ds_read_b64_tr_b16 v[2:3], v128 offset:40960
    v_mfma_f32_16x16x32_bf16 a[12:15], v[96:99], v[76:79], a[12:15]
    ds_read_b64_tr_b16 v[4:5], v129 offset:32768
    v_mfma_f32_16x16x32_bf16 a[16:19], v[96:99], v[80:83], a[16:19]
    ds_read_b64_tr_b16 v[6:7], v129 offset:40960
    v_mfma_f32_16x16x32_bf16 a[20:23], v[96:99], v[84:87], a[20:23]
    ds_read_b64_tr_b16 v[8:9], v130 offset:32768
    buffer_load_dwordx4 v141, s[4:7], s16 offen offset:0 sc1 lds
    v_mfma_f32_16x16x32_bf16 a[24:27], v[96:99], v[88:91], a[24:27]
    ds_read_b64_tr_b16 v[10:11], v130 offset:40960
    v_mfma_f32_16x16x32_bf16 a[28:31], v[96:99], v[92:95], a[28:31]
    ds_read_b64_tr_b16 v[12:13], v131 offset:32768
    v_mfma_f32_16x16x32_bf16 a[32:35], v[100:103], v[64:67], a[32:35]
    ds_read_b64_tr_b16 v[14:15], v131 offset:40960
    v_mfma_f32_16x16x32_bf16 a[36:39], v[100:103], v[68:71], a[36:39]
    ds_read_b64_tr_b16 v[16:17], v132 offset:32768
    v_mfma_f32_16x16x32_bf16 a[40:43], v[100:103], v[72:75], a[40:43]
    ds_read_b64_tr_b16 v[18:19], v132 offset:40960
    buffer_load_dwordx4 v142, s[4:7], s16 offen offset:1024 sc1 lds
    v_mfma_f32_16x16x32_bf16 a[44:47], v[100:103], v[76:79], a[44:47]
    ds_read_b64_tr_b16 v[20:21], v133 offset:32768
    v_mfma_f32_16x16x32_bf16 a[48:51], v[100:103], v[80:83], a[48:51]
    ds_read_b64_tr_b16 v[22:23], v133 offset:40960
    v_mfma_f32_16x16x32_bf16 a[52:55], v[100:103], v[84:87], a[52:55]
    ds_read_b64_tr_b16 v[24:25], v134 offset:32768
    v_mfma_f32_16x16x32_bf16 a[56:59], v[100:103], v[88:91], a[56:59]
    ds_read_b64_tr_b16 v[26:27], v134 offset:40960
    v_mfma_f32_16x16x32_bf16 a[60:63], v[100:103], v[92:95], a[60:63]
    ds_read_b64_tr_b16 v[28:29], v135 offset:32768
    buffer_load_dwordx4 v143, s[4:7], s16 offen offset:2048 sc1 lds
    v_mfma_f32_16x16x32_bf16 a[64:67], v[104:107], v[64:67], a[64:67]
    ds_read_b64_tr_b16 v[30:31], v135 offset:40960
    v_mfma_f32_16x16x32_bf16 a[68:71], v[104:107], v[68:71], a[68:71]
    ds_read_b128 v[36:39], v136 offset:33792
    v_mfma_f32_16x16x32_bf16 a[72:75], v[104:107], v[72:75], a[72:75]
    ds_read_b128 v[40:43], v136 offset:34816
    v_mfma_f32_16x16x32_bf16 a[76:79], v[104:107], v[76:79], a[76:79]
    ds_read_b128 v[44:47], v136 offset:35840
    v_mfma_f32_16x16x32_bf16 a[80:83], v[104:107], v[80:83], a[80:83]
    ds_read_b128 v[48:51], v136 offset:36864
    v_mfma_f32_16x16x32_bf16 a[84:87], v[104:107], v[84:87], a[84:87]
    ds_read_b128 v[52:55], v136 offset:37888
    buffer_load_dwordx4 v144, s[4:7], s16 offen offset:3072 sc1 lds
    v_mfma_f32_16x16x32_bf16 a[88:91], v[104:107], v[88:91], a[88:91]
    ds_read_b128 v[56:59], v136 offset:38912
    v_mfma_f32_16x16x32_bf16 a[92:95], v[104:107], v[92:95], a[92:95]
    ds_read_b128 v[60:63], v136 offset:39936
    v_mfma_f32_16x16x32_bf16 a[96:99], v[108:111], v[64:67], a[96:99]
    v_mfma_f32_16x16x32_bf16 a[100:103], v[108:111], v[68:71], a[100:103]
    v_mfma_f32_16x16x32_bf16 a[104:107], v[108:111], v[72:75], a[104:107]
    s_add_u32 s16, s16, 1024
    v_mfma_f32_16x16x32_bf16 a[108:111], v[108:111], v[76:79], a[108:111]
    v_mfma_f32_16x16x32_bf16 a[112:115], v[108:111], v[80:83], a[112:115]
    v_mfma_f32_16x16x32_bf16 a[116:119], v[108:111], v[84:87], a[116:119]
    v_mfma_f32_16x16x32_bf16 a[120:123], v[108:111], v[88:91], a[120:123]
    v_mfma_f32_16x16x32_bf16 a[124:127], v[108:111], v[92:95], a[124:127]
    s_add_u32 m0, s19, 16384
    s_nop 0
    v_mfma_f32_16x16x32_bf16 a[128:131], v[112:115], v[64:67], a[128:131]
    v_mfma_f32_16x16x32_bf16 a[132:135], v[112:115], v[68:71], a[132:135]
    v_mfma_f32_16x16x32_bf16 a[136:139], v[112:115], v[72:75], a[136:139]
    v_mfma_f32_16x16x32_bf16 a[140:143], v[112:115], v[76:79], a[140:143]
    v_mfma_f32_16x16x32_bf16 a[144:147], v[112:115], v[80:83], a[144:147]
    buffer_load_dwordx4 v137, s[8:11], s15 offen offset:0 lds
    v_mfma_f32_16x16x32_bf16 a[148:151], v[112:115], v[84:87], a[148:151]
    v_mfma_f32_16x16x32_bf16 a[152:155], v[112:115], v[88:91], a[152:155]
    v_mfma_f32_16x16x32_bf16 a[156:159], v[112:115], v[92:95], a[156:159]
    v_mfma_f32_16x16x32_bf16 a[160:163], v[116:119], v[64:67], a[160:163]
    v_mfma_f32_16x16x32_bf16 a[164:167], v[116:119], v[68:71], a[164:167]
    v_mfma_f32_16x16x32_bf16 a[168:171], v[116:119], v[72:75], a[168:171]
    buffer_load_dwordx4 v138, s[8:11], s15 offen offset:1024 lds
    v_mfma_f32_16x16x32_bf16 a[172:175], v[116:119], v[76:79], a[172:175]
    v_mfma_f32_16x16x32_bf16 a[176:179], v[116:119], v[80:83], a[176:179]
    v_mfma_f32_16x16x32_bf16 a[180:183], v[116:119], v[84:87], a[180:183]
    v_mfma_f32_16x16x32_bf16 a[184:187], v[116:119], v[88:91], a[184:187]
    v_mfma_f32_16x16x32_bf16 a[188:191], v[116:119], v[92:95], a[188:191]
    buffer_load_dwordx4 v139, s[8:11], s15 offen offset:2048 lds
    v_mfma_f32_16x16x32_bf16 a[192:195], v[120:123], v[64:67], a[192:195]
    v_mfma_f32_16x16x32_bf16 a[196:199], v[120:123], v[68:71], a[196:199]
    v_mfma_f32_16x16x32_bf16 a[200:203], v[120:123], v[72:75], a[200:203]
    v_mfma_f32_16x16x32_bf16 a[204:207], v[120:123], v[76:79], a[204:207]
    v_mfma_f32_16x16x32_bf16 a[208:211], v[120:123], v[80:83], a[208:211]
    buffer_load_dwordx4 v140, s[8:11], s15 offen offset:3072 lds
    v_mfma_f32_16x16x32_bf16 a[212:215], v[120:123], v[84:87], a[212:215]
    v_mfma_f32_16x16x32_bf16 a[216:219], v[120:123], v[88:91], a[216:219]
    v_mfma_f32_16x16x32_bf16 a[220:223], v[120:123], v[92:95], a[220:223]
    v_mfma_f32_16x16x32_bf16 a[224:227], v[124:127], v[64:67], a[224:227]
    v_mfma_f32_16x16x32_bf16 a[228:231], v[124:127], v[68:71], a[228:231]
    s_add_u32 s15, s15, s17
    v_mfma_f32_16x16x32_bf16 a[232:235], v[124:127], v[72:75], a[232:235]
    v_mfma_f32_16x16x32_bf16 a[236:239], v[124:127], v[76:79], a[236:239]
    v_mfma_f32_16x16x32_bf16 a[240:243], v[124:127], v[80:83], a[240:243]
    v_mfma_f32_16x16x32_bf16 a[244:247], v[124:127], v[84:87], a[244:247]
    v_mfma_f32_16x16x32_bf16 a[248:251], v[124:127], v[88:91], a[248:251]
    v_mfma_f32_16x16x32_bf16 a[252:255], v[124:127], v[92:95], a[252:255]
    s_waitcnt lgkmcnt(0)
    v_mfma_f32_16x16x32_bf16 a[0:3], v[32:35], v[0:3], a[0:3]
    s_waitcnt vmcnt(16)
    s_barrier
    ds_read_b128 v[96:99], v136 offset:49152
    s_add_u32 m0, s20, 32768
    s_nop 0
    v_mfma_f32_16x16x32_bf16 a[4:7], v[32:35], v[4:7], a[4:7]
    ds_read_b64_tr_b16 v[64:65], v128 offset:49152
    v_mfma_f32_16x16x32_bf16 a[8:11], v[32:35], v[8:11], a[8:11]
    ds_read_b64_tr_b16 v[66:67], v128 offset:57344
    v_mfma_f32_16x16x32_bf16 a[12:15], v[32:35], v[12:15], a[12:15]
    ds_read_b64_tr_b16 v[68:69], v129 offset:49152
    v_mfma_f32_16x16x32_bf16 a[16:19], v[32:35], v[16:19], a[16:19]
    ds_read_b64_tr_b16 v[70:71], v129 offset:57344
    v_mfma_f32_16x16x32_bf16 a[20:23], v[32:35], v[20:23], a[20:23]
    ds_read_b64_tr_b16 v[72:73], v130 offset:49152
    buffer_load_dwordx4 v141, s[4:7], s16 offen offset:0 sc1 lds
    v_mfma_f32_16x16x32_bf16 a[24:27], v[32:35], v[24:27], a[24:27]
    ds_read_b64_tr_b16 v[74:75], v130 offset:57344
    v_mfma_f32_16x16x32_bf16 a[28:31], v[32:35], v[28:31], a[28:31]
    ds_read_b64_tr_b16 v[76:77], v131 offset:49152
    v_mfma_f32_16x16x32_bf16 a[32:35], v[36:39], v[0:3], a[32:35]
    ds_read_b64_tr_b16 v[78:79], v131 offset:57344
    v_mfma_f32_16x16x32_bf16 a[36:39], v[36:39], v[4:7], a[36:39]
    ds_read_b64_tr_b16 v[80:81], v132 offset:49152
    v_mfma_f32_16x16x32_bf16 a[40:43], v[36:39], v[8:11], a[40:43]
    ds_read_b64_tr_b16 v[82:83], v132 offset:57344
    buffer_load_dwordx4 v142, s[4:7], s16 offen offset:1024 sc1 lds
    v_mfma_f32_16x16x32_bf16 a[44:47], v[36:39], v[12:15], a[44:47]
    ds_read_b64_tr_b16 v[84:85], v133 offset:49152
    v_mfma_f32_16x16x32_bf16 a[48:51], v[36:39], v[16:19], a[48:51]
    ds_read_b64_tr_b16 v[86:87], v133 offset:57344
    v_mfma_f32_16x16x32_bf16 a[52:55], v[36:39], v[20:23], a[52:55]
    ds_read_b64_tr_b16 v[88:89], v134 offset:49152
    v_mfma_f32_16x16x32_bf16 a[56:59], v[36:39], v[24:27], a[56:59]
    ds_read_b64_tr_b16 v[90:91], v134 offset:57344
    v_mfma_f32_16x16x32_bf16 a[60:63], v[36:39], v[28:31], a[60:63]
    ds_read_b64_tr_b16 v[92:93], v135 offset:49152
    buffer_load_dwordx4 v143, s[4:7], s16 offen offset:2048 sc1 lds
    v_mfma_f32_16x16x32_bf16 a[64:67], v[40:43], v[0:3], a[64:67]
    ds_read_b64_tr_b16 v[94:95], v135 offset:57344
    v_mfma_f32_16x16x32_bf16 a[68:71], v[40:43], v[4:7], a[68:71]
    ds_read_b128 v[100:103], v136 offset:50176
    v_mfma_f32_16x16x32_bf16 a[72:75], v[40:43], v[8:11], a[72:75]
    ds_read_b128 v[104:107], v136 offset:51200
    v_mfma_f32_16x16x32_bf16 a[76:79], v[40:43], v[12:15], a[76:79]
    ds_read_b128 v[108:111], v136 offset:52224
    v_mfma_f32_16x16x32_bf16 a[80:83], v[40:43], v[16:19], a[80:83]
    ds_read_b128 v[112:115], v136 offset:53248
    v_mfma_f32_16x16x32_bf16 a[84:87], v[40:43], v[20:23], a[84:87]
    ds_read_b128 v[116:119], v136 offset:54272
    buffer_load_dwordx4 v144, s[4:7], s16 offen offset:3072 sc1 lds
    v_mfma_f32_16x16x32_bf16 a[88:91], v[40:43], v[24:27], a[88:91]
    ds_read_b128 v[120:123], v136 offset:55296
    v_mfma_f32_16x16x32_bf16 a[92:95], v[40:43], v[28:31], a[92:95]
    ds_read_b128 v[124:127], v136 offset:56320
    v_mfma_f32_16x16x32_bf16 a[96:99], v[44:47], v[0:3], a[96:99]
    v_mfma_f32_16x16x32_bf16 a[100:103], v[44:47], v[4:7], a[100:103]
    v_mfma_f32_16x16x32_bf16 a[104:107], v[44:47], v[8:11], a[104:107]
    s_add_u32 s16, s16, 1024
    v_mfma_f32_16x16x32_bf16 a[108:111], v[44:47], v[12:15], a[108:111]
    v_mfma_f32_16x16x32_bf16 a[112:115], v[44:47], v[16:19], a[112:115]
    v_mfma_f32_16x16x32_bf16 a[116:119], v[44:47], v[20:23], a[116:119]
    v_mfma_f32_16x16x32_bf16 a[120:123], v[44:47], v[24:27], a[120:123]
    v_mfma_f32_16x16x32_bf16 a[124:127], v[44:47], v[28:31], a[124:127]
    s_add_u32 m0, s19, 32768
    s_nop 0
    v_mfma_f32_16x16x32_bf16 a[128:131], v[48:51], v[0:3], a[128:131]
    v_mfma_f32_16x16x32_bf16 a[132:135], v[48:51], v[4:7], a[132:135]
    v_mfma_f32_16x16x32_bf16 a[136:139], v[48:51], v[8:11], a[136:139]
    v_mfma_f32_16x16x32_bf16 a[140:143], v[48:51], v[12:15], a[140:143]
    v_mfma_f32_16x16x32_bf16 a[144:147], v[48:51], v[16:19], a[144:147]
    buffer_load_dwordx4 v137, s[8:11], s15 offen offset:0 lds
    v_mfma_f32_16x16x32_bf16 a[148:151], v[48:51], v[20:23], a[148:151]
    v_mfma_f32_16x16x32_bf16 a[152:155], v[48:51], v[24:27], a[152:155]
    v_mfma_f32_16x16x32_bf16 a[156:159], v[48:51], v[28:31], a[156:159]
    v_mfma_f32_16x16x32_bf16 a[160:163], v[52:55], v[0:3], a[160:163]
    v_mfma_f32_16x16x32_bf16 a[164:167], v[52:55], v[4:7], a[164:167]
    v_mfma_f32_16x16x32_bf16 a[168:171], v[52:55], v[8:11], a[168:171]
    buffer_load_dwordx4 v138, s[8:11], s15 offen offset:1024 lds
    v_mfma_f32_16x16x32_bf16 a[172:175], v[52:55], v[12:15], a[172:175]
    v_mfma_f32_16x16x32_bf16 a[176:179], v[52:55], v[16:19], a[176:179]
    v_mfma_f32_16x16x32_bf16 a[180:183], v[52:55], v[20:23], a[180:183]
    v_mfma_f32_16x16x32_bf16 a[184:187], v[52:55], v[24:27], a[184:187]
    v_mfma_f32_16x16x32_bf16 a[188:191], v[52:55], v[28:31], a[188:191]
    buffer_load_dwordx4 v139, s[8:11], s15 offen offset:2048 lds
    v_mfma_f32_16x16x32_bf16 a[192:195], v[56:59], v[0:3], a[192:195]
    v_mfma_f32_16x16x32_bf16 a[196:199], v[56:59], v[4:7], a[196:199]
    v_mfma_f32_16x16x32_bf16 a[200:203], v[56:59], v[8:11], a[200:203]
    v_mfma_f32_16x16x32_bf16 a[204:207], v[56:59], v[12:15], a[204:207]
    v_mfma_f32_16x16x32_bf16 a[208:211], v[56:59], v[16:19], a[208:211]
    buffer_load_dwordx4 v140, s[8:11], s15 offen offset:3072 lds
    v_mfma_f32_16x16x32_bf16 a[212:215], v[56:59], v[20:23], a[212:215]
    v_mfma_f32_16x16x32_bf16 a[216:219], v[56:59], v[24:27], a[216:219]
    v_mfma_f32_16x16x32_bf16 a[220:223], v[56:59], v[28:31], a[220:223]
    v_mfma_f32_16x16x32_bf16 a[224:227], v[60:63], v[0:3], a[224:227]
    v_mfma_f32_16x16x32_bf16 a[228:231], v[60:63], v[4:7], a[228:231]
    s_add_u32 s15, s15, s17
    v_mfma_f32_16x16x32_bf16 a[232:235], v[60:63], v[8:11], a[232:235]
    v_mfma_f32_16x16x32_bf16 a[236:239], v[60:63], v[12:15], a[236:239]
    v_mfma_f32_16x16x32_bf16 a[240:243], v[60:63], v[16:19], a[240:243]
    v_mfma_f32_16x16x32_bf16 a[244:247], v[60:63], v[20:23], a[244:247]
    v_mfma_f32_16x16x32_bf16 a[248:251], v[60:63], v[24:27], a[248:251]
    v_mfma_f32_16x16x32_bf16 a[252:255], v[60:63], v[28:31], a[252:255]
    s_waitcnt lgkmcnt(0)
    v_mfma_f32_16x16x32_bf16 a[0:3], v[96:99], v[64:67], a[0:3]
    s_waitcnt vmcnt(16)
    s_barrier
    ds_read_b128 v[32:35], v136 offset:0
    s_add_u32 m0, s20, 49152
    s_nop 0
    v_mfma_f32_16x16x32_bf16 a[4:7], v[96:99], v[68:71], a[4:7]
    ds_read_b64_tr_b16 v[0:1], v128 offset:0
    v_mfma_f32_16x16x32_bf16 a[8:11], v[96:99], v[72:75], a[8:11]
    ds_read_b64_tr_b16 v[2:3], v128 offset:8192
    v_mfma_f32_16x16x32_bf16 a[12:15], v[96:99], v[76:79], a[12:15]
    ds_read_b64_tr_b16 v[4:5], v129 offset:0
    v_mfma_f32_16x16x32_bf16 a[16:19], v[96:99], v[80:83], a[16:19]
    ds_read_b64_tr_b16 v[6:7], v129 offset:8192
    v_mfma_f32_16x16x32_bf16 a[20:23], v[96:99], v[84:87], a[20:23]
    ds_read_b64_tr_b16 v[8:9], v130 offset:0
    buffer_load_dwordx4 v141, s[4:7], s16 offen offset:0 sc1 lds
    v_mfma_f32_16x16x32_bf16 a[24:27], v[96:99], v[88:91], a[24:27]
    ds_read_b64_tr_b16 v[10:11], v130 offset:8192
    v_mfma_f32_16x16x32_bf16 a[28:31], v[96:99], v[92:95], a[28:31]
    ds_read_b64_tr_b16 v[12:13], v131 offset:0
    v_mfma_f32_16x16x32_bf16 a[32:35], v[100:103], v[64:67], a[32:35]
    ds_read_b64_tr_b16 v[14:15], v131 offset:8192
    v_mfma_f32_16x16x32_bf16 a[36:39], v[100:103], v[68:71], a[36:39]
    ds_read_b64_tr_b16 v[16:17], v132 offset:0
    v_mfma_f32_16x16x32_bf16 a[40:43], v[100:103], v[72:75], a[40:43]
    ds_read_b64_tr_b16 v[18:19], v132 offset:8192
    buffer_load_dwordx4 v142, s[4:7], s16 offen offset:1024 sc1 lds
    v_mfma_f32_16x16x32_bf16 a[44:47], v[100:103], v[76:79], a[44:47]
    ds_read_b64_tr_b16 v[20:21], v133 offset:0
    v_mfma_f32_16x16x32_bf16 a[48:51], v[100:103], v[80:83], a[48:51]
    ds_read_b64_tr_b16 v[22:23], v133 offset:8192
    v_mfma_f32_16x16x32_bf16 a[52:55], v[100:103], v[84:87], a[52:55]
    ds_read_b64_tr_b16 v[24:25], v134 offset:0
    v_mfma_f32_16x16x32_bf16 a[56:59], v[100:103], v[88:91], a[56:59]
    ds_read_b64_tr_b16 v[26:27], v134 offset:8192
    v_mfma_f32_16x16x32_bf16 a[60:63], v[100:103], v[92:95], a[60:63]
    ds_read_b64_tr_b16 v[28:29], v135 offset:0
    buffer_load_dwordx4 v143, s[4:7], s16 offen offset:2048 sc1 lds
    v_mfma_f32_16x16x32_bf16 a[64:67], v[104:107], v[64:67], a[64:67]
    ds_read_b64_tr_b16 v[30:31], v135 offset:8192
    v_mfma_f32_16x16x32_bf16 a[68:71], v[104:107], v[68:71], a[68:71]
    ds_read_b128 v[36:39], v136 offset:1024
    v_mfma_f32_16x16x32_bf16 a[72:75], v[104:107], v[72:75], a[72:75]
    ds_read_b128 v[40:43], v136 offset:2048
    v_mfma_f32_16x16x32_bf16 a[76:79], v[104:107], v[76:79], a[76:79]
    ds_read_b128 v[44:47], v136 offset:3072
    v_mfma_f32_16x16x32_bf16 a[80:83], v[104:107], v[80:83], a[80:83]
    ds_read_b128 v[48:51], v136 offset:4096
    v_mfma_f32_16x16x32_bf16 a[84:87], v[104:107], v[84:87], a[84:87]
    ds_read_b128 v[52:55], v136 offset:5120
    buffer_load_dwordx4 v144, s[4:7], s16 offen offset:3072 sc1 lds
    v_mfma_f32_16x16x32_bf16 a[88:91], v[104:107], v[88:91], a[88:91]
    ds_read_b128 v[56:59], v136 offset:6144
    v_mfma_f32_16x16x32_bf16 a[92:95], v[104:107], v[92:95], a[92:95]
    ds_read_b128 v[60:63], v136 offset:7168
    v_mfma_f32_16x16x32_bf16 a[96:99], v[108:111], v[64:67], a[96:99]
    v_mfma_f32_16x16x32_bf16 a[100:103], v[108:111], v[68:71], a[100:103]
    v_mfma_f32_16x16x32_bf16 a[104:107], v[108:111], v[72:75], a[104:107]
    s_add_u32 s16, s16, 1024
    v_mfma_f32_16x16x32_bf16 a[108:111], v[108:111], v[76:79], a[108:111]
    v_mfma_f32_16x16x32_bf16 a[112:115], v[108:111], v[80:83], a[112:115]
    v_mfma_f32_16x16x32_bf16 a[116:119], v[108:111], v[84:87], a[116:119]
    v_mfma_f32_16x16x32_bf16 a[120:123], v[108:111], v[88:91], a[120:123]
    v_mfma_f32_16x16x32_bf16 a[124:127], v[108:111], v[92:95], a[124:127]
    s_add_u32 m0, s19, 49152
    s_nop 0
    v_mfma_f32_16x16x32_bf16 a[128:131], v[112:115], v[64:67], a[128:131]
    v_mfma_f32_16x16x32_bf16 a[132:135], v[112:115], v[68:71], a[132:135]
    v_mfma_f32_16x16x32_bf16 a[136:139], v[112:115], v[72:75], a[136:139]
    v_mfma_f32_16x16x32_bf16 a[140:143], v[112:115], v[76:79], a[140:143]
    v_mfma_f32_16x16x32_bf16 a[144:147], v[112:115], v[80:83], a[144:147]
    buffer_load_dwordx4 v137, s[8:11], s15 offen offset:0 lds
    v_mfma_f32_16x16x32_bf16 a[148:151], v[112:115], v[84:87], a[148:151]
    v_mfma_f32_16x16x32_bf16 a[152:155], v[112:115], v[88:91], a[152:155]
    v_mfma_f32_16x16x32_bf16 a[156:159], v[112:115], v[92:95], a[156:159]
    v_mfma_f32_16x16x32_bf16 a[160:163], v[116:119], v[64:67], a[160:163]
    v_mfma_f32_16x16x32_bf16 a[164:167], v[116:119], v[68:71], a[164:167]
    v_mfma_f32_16x16x32_bf16 a[168:171], v[116:119], v[72:75], a[168:171]
    buffer_load_dwordx4 v138, s[8:11], s15 offen offset:1024 lds
    v_mfma_f32_16x16x32_bf16 a[172:175], v[116:119], v[76:79], a[172:175]
    v_mfma_f32_16x16x32_bf16 a[176:179], v[116:119], v[80:83], a[176:179]
    v_mfma_f32_16x16x32_bf16 a[180:183], v[116:119], v[84:87], a[180:183]
    v_mfma_f32_16x16x32_bf16 a[184:187], v[116:119], v[88:91], a[184:187]
    v_mfma_f32_16x16x32_bf16 a[188:191], v[116:119], v[92:95], a[188:191]
    buffer_load_dwordx4 v139, s[8:11], s15 offen offset:2048 lds
    v_mfma_f32_16x16x32_bf16 a[192:195], v[120:123], v[64:67], a[192:195]
    v_mfma_f32_16x16x32_bf16 a[196:199], v[120:123], v[68:71], a[196:199]
    v_mfma_f32_16x16x32_bf16 a[200:203], v[120:123], v[72:75], a[200:203]
    v_mfma_f32_16x16x32_bf16 a[204:207], v[120:123], v[76:79], a[204:207]
    v_mfma_f32_16x16x32_bf16 a[208:211], v[120:123], v[80:83], a[208:211]
    buffer_load_dwordx4 v140, s[8:11], s15 offen offset:3072 lds
    v_mfma_f32_16x16x32_bf16 a[212:215], v[120:123], v[84:87], a[212:215]
    v_mfma_f32_16x16x32_bf16 a[216:219], v[120:123], v[88:91], a[216:219]
    v_mfma_f32_16x16x32_bf16 a[220:223], v[120:123], v[92:95], a[220:223]
    v_mfma_f32_16x16x32_bf16 a[224:227], v[124:127], v[64:67], a[224:227]
    v_mfma_f32_16x16x32_bf16 a[228:231], v[124:127], v[68:71], a[228:231]
    s_add_u32 s15, s15, s17
    v_mfma_f32_16x16x32_bf16 a[232:235], v[124:127], v[72:75], a[232:235]
    v_mfma_f32_16x16x32_bf16 a[236:239], v[124:127], v[76:79], a[236:239]
    v_mfma_f32_16x16x32_bf16 a[240:243], v[124:127], v[80:83], a[240:243]
    v_mfma_f32_16x16x32_bf16 a[244:247], v[124:127], v[84:87], a[244:247]
    v_mfma_f32_16x16x32_bf16 a[248:251], v[124:127], v[88:91], a[248:251]
    v_mfma_f32_16x16x32_bf16 a[252:255], v[124:127], v[92:95], a[252:255]
    s_sub_u32 s18, s18, 1
    s_cmp_lg_u32 s18, 0
    s_cbranch_scc1 main_kernel_w_c2_v_loop
    s_cmp_lg_u32 s14, 0
    s_cbranch_scc1 main_kernel_w_c2_v_nt
    s_lshl_b32 s32, s27, 8
    s_add_u32 s32, s32, 0x841e000
    v_mov_b32 v255, 1
    s_mov_b64 exec, 1
    buffer_atomic_add v255, off, s[4:7], s32 sc0 sc1
    s_mov_b64 exec, -1
main_kernel_w_c2_v_nt:
    s_waitcnt lgkmcnt(0)
    v_mfma_f32_16x16x32_bf16 a[0:3], v[32:35], v[0:3], a[0:3]
    s_waitcnt vmcnt(16)
    s_barrier
    ds_read_b128 v[96:99], v136 offset:16384
    v_mfma_f32_16x16x32_bf16 a[4:7], v[32:35], v[4:7], a[4:7]
    ds_read_b64_tr_b16 v[64:65], v128 offset:16384
    v_mfma_f32_16x16x32_bf16 a[8:11], v[32:35], v[8:11], a[8:11]
    ds_read_b64_tr_b16 v[66:67], v128 offset:24576
    v_mfma_f32_16x16x32_bf16 a[12:15], v[32:35], v[12:15], a[12:15]
    ds_read_b64_tr_b16 v[68:69], v129 offset:16384
    v_mfma_f32_16x16x32_bf16 a[16:19], v[32:35], v[16:19], a[16:19]
    ds_read_b64_tr_b16 v[70:71], v129 offset:24576
    v_mfma_f32_16x16x32_bf16 a[20:23], v[32:35], v[20:23], a[20:23]
    ds_read_b64_tr_b16 v[72:73], v130 offset:16384
    v_mfma_f32_16x16x32_bf16 a[24:27], v[32:35], v[24:27], a[24:27]
    ds_read_b64_tr_b16 v[74:75], v130 offset:24576
    v_mfma_f32_16x16x32_bf16 a[28:31], v[32:35], v[28:31], a[28:31]
    ds_read_b64_tr_b16 v[76:77], v131 offset:16384
    v_mfma_f32_16x16x32_bf16 a[32:35], v[36:39], v[0:3], a[32:35]
    ds_read_b64_tr_b16 v[78:79], v131 offset:24576
    v_mfma_f32_16x16x32_bf16 a[36:39], v[36:39], v[4:7], a[36:39]
    ds_read_b64_tr_b16 v[80:81], v132 offset:16384
    v_mfma_f32_16x16x32_bf16 a[40:43], v[36:39], v[8:11], a[40:43]
    ds_read_b64_tr_b16 v[82:83], v132 offset:24576
    v_mfma_f32_16x16x32_bf16 a[44:47], v[36:39], v[12:15], a[44:47]
    ds_read_b64_tr_b16 v[84:85], v133 offset:16384
    v_mfma_f32_16x16x32_bf16 a[48:51], v[36:39], v[16:19], a[48:51]
    ds_read_b64_tr_b16 v[86:87], v133 offset:24576
    v_mfma_f32_16x16x32_bf16 a[52:55], v[36:39], v[20:23], a[52:55]
    ds_read_b64_tr_b16 v[88:89], v134 offset:16384
    v_mfma_f32_16x16x32_bf16 a[56:59], v[36:39], v[24:27], a[56:59]
    ds_read_b64_tr_b16 v[90:91], v134 offset:24576
    v_mfma_f32_16x16x32_bf16 a[60:63], v[36:39], v[28:31], a[60:63]
    ds_read_b64_tr_b16 v[92:93], v135 offset:16384
    v_mfma_f32_16x16x32_bf16 a[64:67], v[40:43], v[0:3], a[64:67]
    ds_read_b64_tr_b16 v[94:95], v135 offset:24576
    v_mfma_f32_16x16x32_bf16 a[68:71], v[40:43], v[4:7], a[68:71]
    ds_read_b128 v[100:103], v136 offset:17408
    v_mfma_f32_16x16x32_bf16 a[72:75], v[40:43], v[8:11], a[72:75]
    ds_read_b128 v[104:107], v136 offset:18432
    v_mfma_f32_16x16x32_bf16 a[76:79], v[40:43], v[12:15], a[76:79]
    ds_read_b128 v[108:111], v136 offset:19456
    v_mfma_f32_16x16x32_bf16 a[80:83], v[40:43], v[16:19], a[80:83]
    ds_read_b128 v[112:115], v136 offset:20480
    v_mfma_f32_16x16x32_bf16 a[84:87], v[40:43], v[20:23], a[84:87]
    ds_read_b128 v[116:119], v136 offset:21504
    v_mfma_f32_16x16x32_bf16 a[88:91], v[40:43], v[24:27], a[88:91]
    ds_read_b128 v[120:123], v136 offset:22528
    v_mfma_f32_16x16x32_bf16 a[92:95], v[40:43], v[28:31], a[92:95]
    ds_read_b128 v[124:127], v136 offset:23552
    v_mfma_f32_16x16x32_bf16 a[96:99], v[44:47], v[0:3], a[96:99]
    v_mfma_f32_16x16x32_bf16 a[100:103], v[44:47], v[4:7], a[100:103]
    v_mfma_f32_16x16x32_bf16 a[104:107], v[44:47], v[8:11], a[104:107]
    v_mfma_f32_16x16x32_bf16 a[108:111], v[44:47], v[12:15], a[108:111]
    v_mfma_f32_16x16x32_bf16 a[112:115], v[44:47], v[16:19], a[112:115]
    v_mfma_f32_16x16x32_bf16 a[116:119], v[44:47], v[20:23], a[116:119]
    v_mfma_f32_16x16x32_bf16 a[120:123], v[44:47], v[24:27], a[120:123]
    v_mfma_f32_16x16x32_bf16 a[124:127], v[44:47], v[28:31], a[124:127]
    v_mfma_f32_16x16x32_bf16 a[128:131], v[48:51], v[0:3], a[128:131]
    v_mfma_f32_16x16x32_bf16 a[132:135], v[48:51], v[4:7], a[132:135]
    v_mfma_f32_16x16x32_bf16 a[136:139], v[48:51], v[8:11], a[136:139]
    v_mfma_f32_16x16x32_bf16 a[140:143], v[48:51], v[12:15], a[140:143]
    v_mfma_f32_16x16x32_bf16 a[144:147], v[48:51], v[16:19], a[144:147]
    v_mfma_f32_16x16x32_bf16 a[148:151], v[48:51], v[20:23], a[148:151]
    v_mfma_f32_16x16x32_bf16 a[152:155], v[48:51], v[24:27], a[152:155]
    v_mfma_f32_16x16x32_bf16 a[156:159], v[48:51], v[28:31], a[156:159]
    v_mfma_f32_16x16x32_bf16 a[160:163], v[52:55], v[0:3], a[160:163]
    v_mfma_f32_16x16x32_bf16 a[164:167], v[52:55], v[4:7], a[164:167]
    v_mfma_f32_16x16x32_bf16 a[168:171], v[52:55], v[8:11], a[168:171]
    v_mfma_f32_16x16x32_bf16 a[172:175], v[52:55], v[12:15], a[172:175]
    v_mfma_f32_16x16x32_bf16 a[176:179], v[52:55], v[16:19], a[176:179]
    v_mfma_f32_16x16x32_bf16 a[180:183], v[52:55], v[20:23], a[180:183]
    v_mfma_f32_16x16x32_bf16 a[184:187], v[52:55], v[24:27], a[184:187]
    v_mfma_f32_16x16x32_bf16 a[188:191], v[52:55], v[28:31], a[188:191]
    v_mfma_f32_16x16x32_bf16 a[192:195], v[56:59], v[0:3], a[192:195]
    v_mfma_f32_16x16x32_bf16 a[196:199], v[56:59], v[4:7], a[196:199]
    v_mfma_f32_16x16x32_bf16 a[200:203], v[56:59], v[8:11], a[200:203]
    v_mfma_f32_16x16x32_bf16 a[204:207], v[56:59], v[12:15], a[204:207]
    v_mfma_f32_16x16x32_bf16 a[208:211], v[56:59], v[16:19], a[208:211]
    v_mfma_f32_16x16x32_bf16 a[212:215], v[56:59], v[20:23], a[212:215]
    v_mfma_f32_16x16x32_bf16 a[216:219], v[56:59], v[24:27], a[216:219]
    v_mfma_f32_16x16x32_bf16 a[220:223], v[56:59], v[28:31], a[220:223]
    v_mfma_f32_16x16x32_bf16 a[224:227], v[60:63], v[0:3], a[224:227]
    v_mfma_f32_16x16x32_bf16 a[228:231], v[60:63], v[4:7], a[228:231]
    v_mfma_f32_16x16x32_bf16 a[232:235], v[60:63], v[8:11], a[232:235]
    v_mfma_f32_16x16x32_bf16 a[236:239], v[60:63], v[12:15], a[236:239]
    v_mfma_f32_16x16x32_bf16 a[240:243], v[60:63], v[16:19], a[240:243]
    v_mfma_f32_16x16x32_bf16 a[244:247], v[60:63], v[20:23], a[244:247]
    v_mfma_f32_16x16x32_bf16 a[248:251], v[60:63], v[24:27], a[248:251]
    v_mfma_f32_16x16x32_bf16 a[252:255], v[60:63], v[28:31], a[252:255]
    s_waitcnt lgkmcnt(0)
    v_mfma_f32_16x16x32_bf16 a[0:3], v[96:99], v[64:67], a[0:3]
    s_waitcnt vmcnt(8)
    s_barrier
    ds_read_b128 v[32:35], v136 offset:32768
    v_mfma_f32_16x16x32_bf16 a[4:7], v[96:99], v[68:71], a[4:7]
    ds_read_b64_tr_b16 v[0:1], v128 offset:32768
    v_mfma_f32_16x16x32_bf16 a[8:11], v[96:99], v[72:75], a[8:11]
    ds_read_b64_tr_b16 v[2:3], v128 offset:40960
    v_mfma_f32_16x16x32_bf16 a[12:15], v[96:99], v[76:79], a[12:15]
    ds_read_b64_tr_b16 v[4:5], v129 offset:32768
    v_mfma_f32_16x16x32_bf16 a[16:19], v[96:99], v[80:83], a[16:19]
    ds_read_b64_tr_b16 v[6:7], v129 offset:40960
    v_mfma_f32_16x16x32_bf16 a[20:23], v[96:99], v[84:87], a[20:23]
    ds_read_b64_tr_b16 v[8:9], v130 offset:32768
    v_mfma_f32_16x16x32_bf16 a[24:27], v[96:99], v[88:91], a[24:27]
    ds_read_b64_tr_b16 v[10:11], v130 offset:40960
    v_mfma_f32_16x16x32_bf16 a[28:31], v[96:99], v[92:95], a[28:31]
    ds_read_b64_tr_b16 v[12:13], v131 offset:32768
    v_mfma_f32_16x16x32_bf16 a[32:35], v[100:103], v[64:67], a[32:35]
    ds_read_b64_tr_b16 v[14:15], v131 offset:40960
    v_mfma_f32_16x16x32_bf16 a[36:39], v[100:103], v[68:71], a[36:39]
    ds_read_b64_tr_b16 v[16:17], v132 offset:32768
    v_mfma_f32_16x16x32_bf16 a[40:43], v[100:103], v[72:75], a[40:43]
    ds_read_b64_tr_b16 v[18:19], v132 offset:40960
    v_mfma_f32_16x16x32_bf16 a[44:47], v[100:103], v[76:79], a[44:47]
    ds_read_b64_tr_b16 v[20:21], v133 offset:32768
    v_mfma_f32_16x16x32_bf16 a[48:51], v[100:103], v[80:83], a[48:51]
    ds_read_b64_tr_b16 v[22:23], v133 offset:40960
    v_mfma_f32_16x16x32_bf16 a[52:55], v[100:103], v[84:87], a[52:55]
    ds_read_b64_tr_b16 v[24:25], v134 offset:32768
    v_mfma_f32_16x16x32_bf16 a[56:59], v[100:103], v[88:91], a[56:59]
    ds_read_b64_tr_b16 v[26:27], v134 offset:40960
    v_mfma_f32_16x16x32_bf16 a[60:63], v[100:103], v[92:95], a[60:63]
    ds_read_b64_tr_b16 v[28:29], v135 offset:32768
    v_mfma_f32_16x16x32_bf16 a[64:67], v[104:107], v[64:67], a[64:67]
    ds_read_b64_tr_b16 v[30:31], v135 offset:40960
    v_mfma_f32_16x16x32_bf16 a[68:71], v[104:107], v[68:71], a[68:71]
    ds_read_b128 v[36:39], v136 offset:33792
    v_mfma_f32_16x16x32_bf16 a[72:75], v[104:107], v[72:75], a[72:75]
    ds_read_b128 v[40:43], v136 offset:34816
    v_mfma_f32_16x16x32_bf16 a[76:79], v[104:107], v[76:79], a[76:79]
    ds_read_b128 v[44:47], v136 offset:35840
    v_mfma_f32_16x16x32_bf16 a[80:83], v[104:107], v[80:83], a[80:83]
    ds_read_b128 v[48:51], v136 offset:36864
    v_mfma_f32_16x16x32_bf16 a[84:87], v[104:107], v[84:87], a[84:87]
    ds_read_b128 v[52:55], v136 offset:37888
    v_mfma_f32_16x16x32_bf16 a[88:91], v[104:107], v[88:91], a[88:91]
    ds_read_b128 v[56:59], v136 offset:38912
    v_mfma_f32_16x16x32_bf16 a[92:95], v[104:107], v[92:95], a[92:95]
    ds_read_b128 v[60:63], v136 offset:39936
    v_mfma_f32_16x16x32_bf16 a[96:99], v[108:111], v[64:67], a[96:99]
    v_mfma_f32_16x16x32_bf16 a[100:103], v[108:111], v[68:71], a[100:103]
    v_mfma_f32_16x16x32_bf16 a[104:107], v[108:111], v[72:75], a[104:107]
    v_mfma_f32_16x16x32_bf16 a[108:111], v[108:111], v[76:79], a[108:111]
    v_mfma_f32_16x16x32_bf16 a[112:115], v[108:111], v[80:83], a[112:115]
    v_mfma_f32_16x16x32_bf16 a[116:119], v[108:111], v[84:87], a[116:119]
    v_mfma_f32_16x16x32_bf16 a[120:123], v[108:111], v[88:91], a[120:123]
    v_mfma_f32_16x16x32_bf16 a[124:127], v[108:111], v[92:95], a[124:127]
    v_mfma_f32_16x16x32_bf16 a[128:131], v[112:115], v[64:67], a[128:131]
    v_mfma_f32_16x16x32_bf16 a[132:135], v[112:115], v[68:71], a[132:135]
    v_mfma_f32_16x16x32_bf16 a[136:139], v[112:115], v[72:75], a[136:139]
    v_mfma_f32_16x16x32_bf16 a[140:143], v[112:115], v[76:79], a[140:143]
    v_mfma_f32_16x16x32_bf16 a[144:147], v[112:115], v[80:83], a[144:147]
    v_mfma_f32_16x16x32_bf16 a[148:151], v[112:115], v[84:87], a[148:151]
    v_mfma_f32_16x16x32_bf16 a[152:155], v[112:115], v[88:91], a[152:155]
    v_mfma_f32_16x16x32_bf16 a[156:159], v[112:115], v[92:95], a[156:159]
    v_mfma_f32_16x16x32_bf16 a[160:163], v[116:119], v[64:67], a[160:163]
    v_mfma_f32_16x16x32_bf16 a[164:167], v[116:119], v[68:71], a[164:167]
    v_mfma_f32_16x16x32_bf16 a[168:171], v[116:119], v[72:75], a[168:171]
    v_mfma_f32_16x16x32_bf16 a[172:175], v[116:119], v[76:79], a[172:175]
    v_mfma_f32_16x16x32_bf16 a[176:179], v[116:119], v[80:83], a[176:179]
    v_mfma_f32_16x16x32_bf16 a[180:183], v[116:119], v[84:87], a[180:183]
    v_mfma_f32_16x16x32_bf16 a[184:187], v[116:119], v[88:91], a[184:187]
    v_mfma_f32_16x16x32_bf16 a[188:191], v[116:119], v[92:95], a[188:191]
    v_mfma_f32_16x16x32_bf16 a[192:195], v[120:123], v[64:67], a[192:195]
    v_mfma_f32_16x16x32_bf16 a[196:199], v[120:123], v[68:71], a[196:199]
    v_mfma_f32_16x16x32_bf16 a[200:203], v[120:123], v[72:75], a[200:203]
    v_mfma_f32_16x16x32_bf16 a[204:207], v[120:123], v[76:79], a[204:207]
    v_mfma_f32_16x16x32_bf16 a[208:211], v[120:123], v[80:83], a[208:211]
    v_mfma_f32_16x16x32_bf16 a[212:215], v[120:123], v[84:87], a[212:215]
    v_mfma_f32_16x16x32_bf16 a[216:219], v[120:123], v[88:91], a[216:219]
    v_mfma_f32_16x16x32_bf16 a[220:223], v[120:123], v[92:95], a[220:223]
    v_mfma_f32_16x16x32_bf16 a[224:227], v[124:127], v[64:67], a[224:227]
    v_mfma_f32_16x16x32_bf16 a[228:231], v[124:127], v[68:71], a[228:231]
    v_mfma_f32_16x16x32_bf16 a[232:235], v[124:127], v[72:75], a[232:235]
    v_mfma_f32_16x16x32_bf16 a[236:239], v[124:127], v[76:79], a[236:239]
    v_mfma_f32_16x16x32_bf16 a[240:243], v[124:127], v[80:83], a[240:243]
    v_mfma_f32_16x16x32_bf16 a[244:247], v[124:127], v[84:87], a[244:247]
    v_mfma_f32_16x16x32_bf16 a[248:251], v[124:127], v[88:91], a[248:251]
    v_mfma_f32_16x16x32_bf16 a[252:255], v[124:127], v[92:95], a[252:255]
    s_waitcnt lgkmcnt(0)
    v_mfma_f32_16x16x32_bf16 a[0:3], v[32:35], v[0:3], a[0:3]
    s_waitcnt vmcnt(0)
    s_barrier
    ds_read_b128 v[96:99], v136 offset:49152
    v_mfma_f32_16x16x32_bf16 a[4:7], v[32:35], v[4:7], a[4:7]
    ds_read_b64_tr_b16 v[64:65], v128 offset:49152
    v_mfma_f32_16x16x32_bf16 a[8:11], v[32:35], v[8:11], a[8:11]
    ds_read_b64_tr_b16 v[66:67], v128 offset:57344
    v_mfma_f32_16x16x32_bf16 a[12:15], v[32:35], v[12:15], a[12:15]
    ds_read_b64_tr_b16 v[68:69], v129 offset:49152
    v_mfma_f32_16x16x32_bf16 a[16:19], v[32:35], v[16:19], a[16:19]
    ds_read_b64_tr_b16 v[70:71], v129 offset:57344
    v_mfma_f32_16x16x32_bf16 a[20:23], v[32:35], v[20:23], a[20:23]
    ds_read_b64_tr_b16 v[72:73], v130 offset:49152
    v_mfma_f32_16x16x32_bf16 a[24:27], v[32:35], v[24:27], a[24:27]
    ds_read_b64_tr_b16 v[74:75], v130 offset:57344
    v_mfma_f32_16x16x32_bf16 a[28:31], v[32:35], v[28:31], a[28:31]
    ds_read_b64_tr_b16 v[76:77], v131 offset:49152
    v_mfma_f32_16x16x32_bf16 a[32:35], v[36:39], v[0:3], a[32:35]
    ds_read_b64_tr_b16 v[78:79], v131 offset:57344
    v_mfma_f32_16x16x32_bf16 a[36:39], v[36:39], v[4:7], a[36:39]
    ds_read_b64_tr_b16 v[80:81], v132 offset:49152
    v_mfma_f32_16x16x32_bf16 a[40:43], v[36:39], v[8:11], a[40:43]
    ds_read_b64_tr_b16 v[82:83], v132 offset:57344
    v_mfma_f32_16x16x32_bf16 a[44:47], v[36:39], v[12:15], a[44:47]
    ds_read_b64_tr_b16 v[84:85], v133 offset:49152
    v_mfma_f32_16x16x32_bf16 a[48:51], v[36:39], v[16:19], a[48:51]
    ds_read_b64_tr_b16 v[86:87], v133 offset:57344
    v_mfma_f32_16x16x32_bf16 a[52:55], v[36:39], v[20:23], a[52:55]
    ds_read_b64_tr_b16 v[88:89], v134 offset:49152
    v_mfma_f32_16x16x32_bf16 a[56:59], v[36:39], v[24:27], a[56:59]
    ds_read_b64_tr_b16 v[90:91], v134 offset:57344
    v_mfma_f32_16x16x32_bf16 a[60:63], v[36:39], v[28:31], a[60:63]
    ds_read_b64_tr_b16 v[92:93], v135 offset:49152
    v_mfma_f32_16x16x32_bf16 a[64:67], v[40:43], v[0:3], a[64:67]
    ds_read_b64_tr_b16 v[94:95], v135 offset:57344
    v_mfma_f32_16x16x32_bf16 a[68:71], v[40:43], v[4:7], a[68:71]
    ds_read_b128 v[100:103], v136 offset:50176
    v_mfma_f32_16x16x32_bf16 a[72:75], v[40:43], v[8:11], a[72:75]
    ds_read_b128 v[104:107], v136 offset:51200
    v_mfma_f32_16x16x32_bf16 a[76:79], v[40:43], v[12:15], a[76:79]
    ds_read_b128 v[108:111], v136 offset:52224
    v_mfma_f32_16x16x32_bf16 a[80:83], v[40:43], v[16:19], a[80:83]
    ds_read_b128 v[112:115], v136 offset:53248
    v_mfma_f32_16x16x32_bf16 a[84:87], v[40:43], v[20:23], a[84:87]
    ds_read_b128 v[116:119], v136 offset:54272
    v_mfma_f32_16x16x32_bf16 a[88:91], v[40:43], v[24:27], a[88:91]
    ds_read_b128 v[120:123], v136 offset:55296
    v_mfma_f32_16x16x32_bf16 a[92:95], v[40:43], v[28:31], a[92:95]
    ds_read_b128 v[124:127], v136 offset:56320
    v_mfma_f32_16x16x32_bf16 a[96:99], v[44:47], v[0:3], a[96:99]
    v_mfma_f32_16x16x32_bf16 a[100:103], v[44:47], v[4:7], a[100:103]
    v_mfma_f32_16x16x32_bf16 a[104:107], v[44:47], v[8:11], a[104:107]
    v_mfma_f32_16x16x32_bf16 a[108:111], v[44:47], v[12:15], a[108:111]
    v_mfma_f32_16x16x32_bf16 a[112:115], v[44:47], v[16:19], a[112:115]
    v_mfma_f32_16x16x32_bf16 a[116:119], v[44:47], v[20:23], a[116:119]
    v_mfma_f32_16x16x32_bf16 a[120:123], v[44:47], v[24:27], a[120:123]
    v_mfma_f32_16x16x32_bf16 a[124:127], v[44:47], v[28:31], a[124:127]
    v_mfma_f32_16x16x32_bf16 a[128:131], v[48:51], v[0:3], a[128:131]
    v_mfma_f32_16x16x32_bf16 a[132:135], v[48:51], v[4:7], a[132:135]
    v_mfma_f32_16x16x32_bf16 a[136:139], v[48:51], v[8:11], a[136:139]
    v_mfma_f32_16x16x32_bf16 a[140:143], v[48:51], v[12:15], a[140:143]
    v_mfma_f32_16x16x32_bf16 a[144:147], v[48:51], v[16:19], a[144:147]
    v_mfma_f32_16x16x32_bf16 a[148:151], v[48:51], v[20:23], a[148:151]
    v_mfma_f32_16x16x32_bf16 a[152:155], v[48:51], v[24:27], a[152:155]
    v_mfma_f32_16x16x32_bf16 a[156:159], v[48:51], v[28:31], a[156:159]
    v_mfma_f32_16x16x32_bf16 a[160:163], v[52:55], v[0:3], a[160:163]
    v_mfma_f32_16x16x32_bf16 a[164:167], v[52:55], v[4:7], a[164:167]
    v_mfma_f32_16x16x32_bf16 a[168:171], v[52:55], v[8:11], a[168:171]
    v_mfma_f32_16x16x32_bf16 a[172:175], v[52:55], v[12:15], a[172:175]
    v_mfma_f32_16x16x32_bf16 a[176:179], v[52:55], v[16:19], a[176:179]
    v_mfma_f32_16x16x32_bf16 a[180:183], v[52:55], v[20:23], a[180:183]
    v_mfma_f32_16x16x32_bf16 a[184:187], v[52:55], v[24:27], a[184:187]
    v_mfma_f32_16x16x32_bf16 a[188:191], v[52:55], v[28:31], a[188:191]
    v_mfma_f32_16x16x32_bf16 a[192:195], v[56:59], v[0:3], a[192:195]
    v_mfma_f32_16x16x32_bf16 a[196:199], v[56:59], v[4:7], a[196:199]
    v_mfma_f32_16x16x32_bf16 a[200:203], v[56:59], v[8:11], a[200:203]
    v_mfma_f32_16x16x32_bf16 a[204:207], v[56:59], v[12:15], a[204:207]
    v_mfma_f32_16x16x32_bf16 a[208:211], v[56:59], v[16:19], a[208:211]
    v_mfma_f32_16x16x32_bf16 a[212:215], v[56:59], v[20:23], a[212:215]
    v_mfma_f32_16x16x32_bf16 a[216:219], v[56:59], v[24:27], a[216:219]
    v_mfma_f32_16x16x32_bf16 a[220:223], v[56:59], v[28:31], a[220:223]
    v_mfma_f32_16x16x32_bf16 a[224:227], v[60:63], v[0:3], a[224:227]
    v_mfma_f32_16x16x32_bf16 a[228:231], v[60:63], v[4:7], a[228:231]
    v_mfma_f32_16x16x32_bf16 a[232:235], v[60:63], v[8:11], a[232:235]
    v_mfma_f32_16x16x32_bf16 a[236:239], v[60:63], v[12:15], a[236:239]
    v_mfma_f32_16x16x32_bf16 a[240:243], v[60:63], v[16:19], a[240:243]
    v_mfma_f32_16x16x32_bf16 a[244:247], v[60:63], v[20:23], a[244:247]
    v_mfma_f32_16x16x32_bf16 a[248:251], v[60:63], v[24:27], a[248:251]
    v_mfma_f32_16x16x32_bf16 a[252:255], v[60:63], v[28:31], a[252:255]
    v_readfirstlane_b32 s55, v255
    s_waitcnt lgkmcnt(0)
    v_mfma_f32_16x16x32_bf16 a[0:3], v[96:99], v[64:67], a[0:3]
    v_mfma_f32_16x16x32_bf16 a[4:7], v[96:99], v[68:71], a[4:7]
    v_mfma_f32_16x16x32_bf16 a[8:11], v[96:99], v[72:75], a[8:11]
    v_mfma_f32_16x16x32_bf16 a[12:15], v[96:99], v[76:79], a[12:15]
    v_mfma_f32_16x16x32_bf16 a[16:19], v[96:99], v[80:83], a[16:19]
    v_mfma_f32_16x16x32_bf16 a[20:23], v[96:99], v[84:87], a[20:23]
    v_mfma_f32_16x16x32_bf16 a[24:27], v[96:99], v[88:91], a[24:27]
    v_mfma_f32_16x16x32_bf16 a[28:31], v[96:99], v[92:95], a[28:31]
    v_mfma_f32_16x16x32_bf16 a[32:35], v[100:103], v[64:67], a[32:35]
    v_mfma_f32_16x16x32_bf16 a[36:39], v[100:103], v[68:71], a[36:39]
    v_mfma_f32_16x16x32_bf16 a[40:43], v[100:103], v[72:75], a[40:43]
    v_mfma_f32_16x16x32_bf16 a[44:47], v[100:103], v[76:79], a[44:47]
    v_mfma_f32_16x16x32_bf16 a[48:51], v[100:103], v[80:83], a[48:51]
    v_mfma_f32_16x16x32_bf16 a[52:55], v[100:103], v[84:87], a[52:55]
    v_mfma_f32_16x16x32_bf16 a[56:59], v[100:103], v[88:91], a[56:59]
    v_mfma_f32_16x16x32_bf16 a[60:63], v[100:103], v[92:95], a[60:63]
    v_mfma_f32_16x16x32_bf16 a[64:67], v[104:107], v[64:67], a[64:67]
    v_mfma_f32_16x16x32_bf16 a[68:71], v[104:107], v[68:71], a[68:71]
    v_mfma_f32_16x16x32_bf16 a[72:75], v[104:107], v[72:75], a[72:75]
    v_mfma_f32_16x16x32_bf16 a[76:79], v[104:107], v[76:79], a[76:79]
    v_mfma_f32_16x16x32_bf16 a[80:83], v[104:107], v[80:83], a[80:83]
    v_mfma_f32_16x16x32_bf16 a[84:87], v[104:107], v[84:87], a[84:87]
    v_mfma_f32_16x16x32_bf16 a[88:91], v[104:107], v[88:91], a[88:91]
    v_mfma_f32_16x16x32_bf16 a[92:95], v[104:107], v[92:95], a[92:95]
    v_mfma_f32_16x16x32_bf16 a[96:99], v[108:111], v[64:67], a[96:99]
    v_mfma_f32_16x16x32_bf16 a[100:103], v[108:111], v[68:71], a[100:103]
    v_mfma_f32_16x16x32_bf16 a[104:107], v[108:111], v[72:75], a[104:107]
    v_mfma_f32_16x16x32_bf16 a[108:111], v[108:111], v[76:79], a[108:111]
    v_mfma_f32_16x16x32_bf16 a[112:115], v[108:111], v[80:83], a[112:115]
    v_mfma_f32_16x16x32_bf16 a[116:119], v[108:111], v[84:87], a[116:119]
    v_mfma_f32_16x16x32_bf16 a[120:123], v[108:111], v[88:91], a[120:123]
    v_mfma_f32_16x16x32_bf16 a[124:127], v[108:111], v[92:95], a[124:127]
    v_mfma_f32_16x16x32_bf16 a[128:131], v[112:115], v[64:67], a[128:131]
    v_mfma_f32_16x16x32_bf16 a[132:135], v[112:115], v[68:71], a[132:135]
    v_mfma_f32_16x16x32_bf16 a[136:139], v[112:115], v[72:75], a[136:139]
    v_mfma_f32_16x16x32_bf16 a[140:143], v[112:115], v[76:79], a[140:143]
    v_mfma_f32_16x16x32_bf16 a[144:147], v[112:115], v[80:83], a[144:147]
    v_mfma_f32_16x16x32_bf16 a[148:151], v[112:115], v[84:87], a[148:151]
    v_mfma_f32_16x16x32_bf16 a[152:155], v[112:115], v[88:91], a[152:155]
    v_mfma_f32_16x16x32_bf16 a[156:159], v[112:115], v[92:95], a[156:159]
    v_mfma_f32_16x16x32_bf16 a[160:163], v[116:119], v[64:67], a[160:163]
    v_mfma_f32_16x16x32_bf16 a[164:167], v[116:119], v[68:71], a[164:167]
    v_mfma_f32_16x16x32_bf16 a[168:171], v[116:119], v[72:75], a[168:171]
    v_mfma_f32_16x16x32_bf16 a[172:175], v[116:119], v[76:79], a[172:175]
    v_mfma_f32_16x16x32_bf16 a[176:179], v[116:119], v[80:83], a[176:179]
    v_mfma_f32_16x16x32_bf16 a[180:183], v[116:119], v[84:87], a[180:183]
    v_mfma_f32_16x16x32_bf16 a[184:187], v[116:119], v[88:91], a[184:187]
    v_mfma_f32_16x16x32_bf16 a[188:191], v[116:119], v[92:95], a[188:191]
    v_mfma_f32_16x16x32_bf16 a[192:195], v[120:123], v[64:67], a[192:195]
    v_mfma_f32_16x16x32_bf16 a[196:199], v[120:123], v[68:71], a[196:199]
    v_mfma_f32_16x16x32_bf16 a[200:203], v[120:123], v[72:75], a[200:203]
    v_mfma_f32_16x16x32_bf16 a[204:207], v[120:123], v[76:79], a[204:207]
    v_mfma_f32_16x16x32_bf16 a[208:211], v[120:123], v[80:83], a[208:211]
    v_mfma_f32_16x16x32_bf16 a[212:215], v[120:123], v[84:87], a[212:215]
    v_mfma_f32_16x16x32_bf16 a[216:219], v[120:123], v[88:91], a[216:219]
    v_mfma_f32_16x16x32_bf16 a[220:223], v[120:123], v[92:95], a[220:223]
    v_mfma_f32_16x16x32_bf16 a[224:227], v[124:127], v[64:67], a[224:227]
    v_mfma_f32_16x16x32_bf16 a[228:231], v[124:127], v[68:71], a[228:231]
    v_mfma_f32_16x16x32_bf16 a[232:235], v[124:127], v[72:75], a[232:235]
    v_mfma_f32_16x16x32_bf16 a[236:239], v[124:127], v[76:79], a[236:239]
    v_mfma_f32_16x16x32_bf16 a[240:243], v[124:127], v[80:83], a[240:243]
    v_mfma_f32_16x16x32_bf16 a[244:247], v[124:127], v[84:87], a[244:247]
    v_mfma_f32_16x16x32_bf16 a[248:251], v[124:127], v[88:91], a[248:251]
    v_mfma_f32_16x16x32_bf16 a[252:255], v[124:127], v[92:95], a[252:255]
    s_nop 7
    s_mov_b32 s53, s21
    v_accvgpr_read_b32 v0, a0
    v_accvgpr_read_b32 v1, a1
    v_accvgpr_read_b32 v2, a2
    v_accvgpr_read_b32 v3, a3
    v_accvgpr_read_b32 v4, a32
    v_accvgpr_read_b32 v5, a33
    v_accvgpr_read_b32 v6, a34
    v_accvgpr_read_b32 v7, a35
    v_cvt_pk_bf16_f32 v8, v0, v1
    v_cvt_pk_bf16_f32 v9, v2, v3
    v_cvt_pk_bf16_f32 v10, v4, v5
    v_cvt_pk_bf16_f32 v11, v6, v7
    buffer_store_dwordx4 v[8:11], v251, s[4:7], s53 offen offset:0 sc1
    v_accvgpr_read_b32 v16, a4
    v_accvgpr_read_b32 v17, a5
    v_accvgpr_read_b32 v18, a6
    v_accvgpr_read_b32 v19, a7
    v_accvgpr_read_b32 v20, a36
    v_accvgpr_read_b32 v21, a37
    v_accvgpr_read_b32 v22, a38
    v_accvgpr_read_b32 v23, a39
    v_cvt_pk_bf16_f32 v24, v16, v17
    v_cvt_pk_bf16_f32 v25, v18, v19
    v_cvt_pk_bf16_f32 v26, v20, v21
    v_cvt_pk_bf16_f32 v27, v22, v23
    buffer_store_dwordx4 v[24:27], v251, s[4:7], s53 offen offset:1024 sc1
    v_accvgpr_read_b32 v32, a8
    v_accvgpr_read_b32 v33, a9
    v_accvgpr_read_b32 v34, a10
    v_accvgpr_read_b32 v35, a11
    v_accvgpr_read_b32 v36, a40
    v_accvgpr_read_b32 v37, a41
    v_accvgpr_read_b32 v38, a42
    v_accvgpr_read_b32 v39, a43
    v_cvt_pk_bf16_f32 v40, v32, v33
    v_cvt_pk_bf16_f32 v41, v34, v35
    v_cvt_pk_bf16_f32 v42, v36, v37
    v_cvt_pk_bf16_f32 v43, v38, v39
    buffer_store_dwordx4 v[40:43], v251, s[4:7], s53 offen offset:2048 sc1
    v_accvgpr_read_b32 v48, a12
    v_accvgpr_read_b32 v49, a13
    v_accvgpr_read_b32 v50, a14
    v_accvgpr_read_b32 v51, a15
    v_accvgpr_read_b32 v52, a44
    v_accvgpr_read_b32 v53, a45
    v_accvgpr_read_b32 v54, a46
    v_accvgpr_read_b32 v55, a47
    v_cvt_pk_bf16_f32 v56, v48, v49
    v_cvt_pk_bf16_f32 v57, v50, v51
    v_cvt_pk_bf16_f32 v58, v52, v53
    v_cvt_pk_bf16_f32 v59, v54, v55
    buffer_store_dwordx4 v[56:59], v251, s[4:7], s53 offen offset:3072 sc1
    s_add_u32 s53, s53, 4096
    v_accvgpr_read_b32 v0, a16
    v_accvgpr_read_b32 v1, a17
    v_accvgpr_read_b32 v2, a18
    v_accvgpr_read_b32 v3, a19
    v_accvgpr_read_b32 v4, a48
    v_accvgpr_read_b32 v5, a49
    v_accvgpr_read_b32 v6, a50
    v_accvgpr_read_b32 v7, a51
    v_cvt_pk_bf16_f32 v8, v0, v1
    v_cvt_pk_bf16_f32 v9, v2, v3
    v_cvt_pk_bf16_f32 v10, v4, v5
    v_cvt_pk_bf16_f32 v11, v6, v7
    buffer_store_dwordx4 v[8:11], v251, s[4:7], s53 offen offset:0 sc1
    v_accvgpr_read_b32 v16, a20
    v_accvgpr_read_b32 v17, a21
    v_accvgpr_read_b32 v18, a22
    v_accvgpr_read_b32 v19, a23
    v_accvgpr_read_b32 v20, a52
    v_accvgpr_read_b32 v21, a53
    v_accvgpr_read_b32 v22, a54
    v_accvgpr_read_b32 v23, a55
    v_cvt_pk_bf16_f32 v24, v16, v17
    v_cvt_pk_bf16_f32 v25, v18, v19
    v_cvt_pk_bf16_f32 v26, v20, v21
    v_cvt_pk_bf16_f32 v27, v22, v23
    buffer_store_dwordx4 v[24:27], v251, s[4:7], s53 offen offset:1024 sc1
    v_accvgpr_read_b32 v32, a24
    v_accvgpr_read_b32 v33, a25
    v_accvgpr_read_b32 v34, a26
    v_accvgpr_read_b32 v35, a27
    v_accvgpr_read_b32 v36, a56
    v_accvgpr_read_b32 v37, a57
    v_accvgpr_read_b32 v38, a58
    v_accvgpr_read_b32 v39, a59
    v_cvt_pk_bf16_f32 v40, v32, v33
    v_cvt_pk_bf16_f32 v41, v34, v35
    v_cvt_pk_bf16_f32 v42, v36, v37
    v_cvt_pk_bf16_f32 v43, v38, v39
    buffer_store_dwordx4 v[40:43], v251, s[4:7], s53 offen offset:2048 sc1
    v_accvgpr_read_b32 v48, a28
    v_accvgpr_read_b32 v49, a29
    v_accvgpr_read_b32 v50, a30
    v_accvgpr_read_b32 v51, a31
    v_accvgpr_read_b32 v52, a60
    v_accvgpr_read_b32 v53, a61
    v_accvgpr_read_b32 v54, a62
    v_accvgpr_read_b32 v55, a63
    v_cvt_pk_bf16_f32 v56, v48, v49
    v_cvt_pk_bf16_f32 v57, v50, v51
    v_cvt_pk_bf16_f32 v58, v52, v53
    v_cvt_pk_bf16_f32 v59, v54, v55
    buffer_store_dwordx4 v[56:59], v251, s[4:7], s53 offen offset:3072 sc1
    s_add_u32 s53, s53, 258048
    v_accvgpr_read_b32 v0, a64
    v_accvgpr_read_b32 v1, a65
    v_accvgpr_read_b32 v2, a66
    v_accvgpr_read_b32 v3, a67
    v_accvgpr_read_b32 v4, a96
    v_accvgpr_read_b32 v5, a97
    v_accvgpr_read_b32 v6, a98
    v_accvgpr_read_b32 v7, a99
    v_cvt_pk_bf16_f32 v8, v0, v1
    v_cvt_pk_bf16_f32 v9, v2, v3
    v_cvt_pk_bf16_f32 v10, v4, v5
    v_cvt_pk_bf16_f32 v11, v6, v7
    buffer_store_dwordx4 v[8:11], v251, s[4:7], s53 offen offset:0 sc1
    v_accvgpr_read_b32 v16, a68
    v_accvgpr_read_b32 v17, a69
    v_accvgpr_read_b32 v18, a70
    v_accvgpr_read_b32 v19, a71
    v_accvgpr_read_b32 v20, a100
    v_accvgpr_read_b32 v21, a101
    v_accvgpr_read_b32 v22, a102
    v_accvgpr_read_b32 v23, a103
    v_cvt_pk_bf16_f32 v24, v16, v17
    v_cvt_pk_bf16_f32 v25, v18, v19
    v_cvt_pk_bf16_f32 v26, v20, v21
    v_cvt_pk_bf16_f32 v27, v22, v23
    buffer_store_dwordx4 v[24:27], v251, s[4:7], s53 offen offset:1024 sc1
    v_accvgpr_read_b32 v32, a72
    v_accvgpr_read_b32 v33, a73
    v_accvgpr_read_b32 v34, a74
    v_accvgpr_read_b32 v35, a75
    v_accvgpr_read_b32 v36, a104
    v_accvgpr_read_b32 v37, a105
    v_accvgpr_read_b32 v38, a106
    v_accvgpr_read_b32 v39, a107
    v_cvt_pk_bf16_f32 v40, v32, v33
    v_cvt_pk_bf16_f32 v41, v34, v35
    v_cvt_pk_bf16_f32 v42, v36, v37
    v_cvt_pk_bf16_f32 v43, v38, v39
    buffer_store_dwordx4 v[40:43], v251, s[4:7], s53 offen offset:2048 sc1
    v_accvgpr_read_b32 v48, a76
    v_accvgpr_read_b32 v49, a77
    v_accvgpr_read_b32 v50, a78
    v_accvgpr_read_b32 v51, a79
    v_accvgpr_read_b32 v52, a108
    v_accvgpr_read_b32 v53, a109
    v_accvgpr_read_b32 v54, a110
    v_accvgpr_read_b32 v55, a111
    v_cvt_pk_bf16_f32 v56, v48, v49
    v_cvt_pk_bf16_f32 v57, v50, v51
    v_cvt_pk_bf16_f32 v58, v52, v53
    v_cvt_pk_bf16_f32 v59, v54, v55
    buffer_store_dwordx4 v[56:59], v251, s[4:7], s53 offen offset:3072 sc1
    s_add_u32 s53, s53, 4096
    v_accvgpr_read_b32 v0, a80
    v_accvgpr_read_b32 v1, a81
    v_accvgpr_read_b32 v2, a82
    v_accvgpr_read_b32 v3, a83
    v_accvgpr_read_b32 v4, a112
    v_accvgpr_read_b32 v5, a113
    v_accvgpr_read_b32 v6, a114
    v_accvgpr_read_b32 v7, a115
    v_cvt_pk_bf16_f32 v8, v0, v1
    v_cvt_pk_bf16_f32 v9, v2, v3
    v_cvt_pk_bf16_f32 v10, v4, v5
    v_cvt_pk_bf16_f32 v11, v6, v7
    buffer_store_dwordx4 v[8:11], v251, s[4:7], s53 offen offset:0 sc1
    v_accvgpr_read_b32 v16, a84
    v_accvgpr_read_b32 v17, a85
    v_accvgpr_read_b32 v18, a86
    v_accvgpr_read_b32 v19, a87
    v_accvgpr_read_b32 v20, a116
    v_accvgpr_read_b32 v21, a117
    v_accvgpr_read_b32 v22, a118
    v_accvgpr_read_b32 v23, a119
    v_cvt_pk_bf16_f32 v24, v16, v17
    v_cvt_pk_bf16_f32 v25, v18, v19
    v_cvt_pk_bf16_f32 v26, v20, v21
    v_cvt_pk_bf16_f32 v27, v22, v23
    buffer_store_dwordx4 v[24:27], v251, s[4:7], s53 offen offset:1024 sc1
    v_accvgpr_read_b32 v32, a88
    v_accvgpr_read_b32 v33, a89
    v_accvgpr_read_b32 v34, a90
    v_accvgpr_read_b32 v35, a91
    v_accvgpr_read_b32 v36, a120
    v_accvgpr_read_b32 v37, a121
    v_accvgpr_read_b32 v38, a122
    v_accvgpr_read_b32 v39, a123
    v_cvt_pk_bf16_f32 v40, v32, v33
    v_cvt_pk_bf16_f32 v41, v34, v35
    v_cvt_pk_bf16_f32 v42, v36, v37
    v_cvt_pk_bf16_f32 v43, v38, v39
    buffer_store_dwordx4 v[40:43], v251, s[4:7], s53 offen offset:2048 sc1
    v_accvgpr_read_b32 v48, a92
    v_accvgpr_read_b32 v49, a93
    v_accvgpr_read_b32 v50, a94
    v_accvgpr_read_b32 v51, a95
    v_accvgpr_read_b32 v52, a124
    v_accvgpr_read_b32 v53, a125
    v_accvgpr_read_b32 v54, a126
    v_accvgpr_read_b32 v55, a127
    v_cvt_pk_bf16_f32 v56, v48, v49
    v_cvt_pk_bf16_f32 v57, v50, v51
    v_cvt_pk_bf16_f32 v58, v52, v53
    v_cvt_pk_bf16_f32 v59, v54, v55
    buffer_store_dwordx4 v[56:59], v251, s[4:7], s53 offen offset:3072 sc1
    s_add_u32 s53, s53, 258048
    v_accvgpr_read_b32 v0, a128
    v_accvgpr_read_b32 v1, a129
    v_accvgpr_read_b32 v2, a130
    v_accvgpr_read_b32 v3, a131
    v_accvgpr_read_b32 v4, a160
    v_accvgpr_read_b32 v5, a161
    v_accvgpr_read_b32 v6, a162
    v_accvgpr_read_b32 v7, a163
    v_cvt_pk_bf16_f32 v8, v0, v1
    v_cvt_pk_bf16_f32 v9, v2, v3
    v_cvt_pk_bf16_f32 v10, v4, v5
    v_cvt_pk_bf16_f32 v11, v6, v7
    buffer_store_dwordx4 v[8:11], v251, s[4:7], s53 offen offset:0 sc1
    v_accvgpr_read_b32 v16, a132
    v_accvgpr_read_b32 v17, a133
    v_accvgpr_read_b32 v18, a134
    v_accvgpr_read_b32 v19, a135
    v_accvgpr_read_b32 v20, a164
    v_accvgpr_read_b32 v21, a165
    v_accvgpr_read_b32 v22, a166
    v_accvgpr_read_b32 v23, a167
    v_cvt_pk_bf16_f32 v24, v16, v17
    v_cvt_pk_bf16_f32 v25, v18, v19
    v_cvt_pk_bf16_f32 v26, v20, v21
    v_cvt_pk_bf16_f32 v27, v22, v23
    buffer_store_dwordx4 v[24:27], v251, s[4:7], s53 offen offset:1024 sc1
    v_accvgpr_read_b32 v32, a136
    v_accvgpr_read_b32 v33, a137
    v_accvgpr_read_b32 v34, a138
    v_accvgpr_read_b32 v35, a139
    v_accvgpr_read_b32 v36, a168
    v_accvgpr_read_b32 v37, a169
    v_accvgpr_read_b32 v38, a170
    v_accvgpr_read_b32 v39, a171
    v_cvt_pk_bf16_f32 v40, v32, v33
    v_cvt_pk_bf16_f32 v41, v34, v35
    v_cvt_pk_bf16_f32 v42, v36, v37
    v_cvt_pk_bf16_f32 v43, v38, v39
    buffer_store_dwordx4 v[40:43], v251, s[4:7], s53 offen offset:2048 sc1
    v_accvgpr_read_b32 v48, a140
    v_accvgpr_read_b32 v49, a141
    v_accvgpr_read_b32 v50, a142
    v_accvgpr_read_b32 v51, a143
    v_accvgpr_read_b32 v52, a172
    v_accvgpr_read_b32 v53, a173
    v_accvgpr_read_b32 v54, a174
    v_accvgpr_read_b32 v55, a175
    v_cvt_pk_bf16_f32 v56, v48, v49
    v_cvt_pk_bf16_f32 v57, v50, v51
    v_cvt_pk_bf16_f32 v58, v52, v53
    v_cvt_pk_bf16_f32 v59, v54, v55
    buffer_store_dwordx4 v[56:59], v251, s[4:7], s53 offen offset:3072 sc1
    s_add_u32 s53, s53, 4096
    v_accvgpr_read_b32 v0, a144
    v_accvgpr_read_b32 v1, a145
    v_accvgpr_read_b32 v2, a146
    v_accvgpr_read_b32 v3, a147
    v_accvgpr_read_b32 v4, a176
    v_accvgpr_read_b32 v5, a177
    v_accvgpr_read_b32 v6, a178
    v_accvgpr_read_b32 v7, a179
    v_cvt_pk_bf16_f32 v8, v0, v1
    v_cvt_pk_bf16_f32 v9, v2, v3
    v_cvt_pk_bf16_f32 v10, v4, v5
    v_cvt_pk_bf16_f32 v11, v6, v7
    buffer_store_dwordx4 v[8:11], v251, s[4:7], s53 offen offset:0 sc1
    v_accvgpr_read_b32 v16, a148
    v_accvgpr_read_b32 v17, a149
    v_accvgpr_read_b32 v18, a150
    v_accvgpr_read_b32 v19, a151
    v_accvgpr_read_b32 v20, a180
    v_accvgpr_read_b32 v21, a181
    v_accvgpr_read_b32 v22, a182
    v_accvgpr_read_b32 v23, a183
    v_cvt_pk_bf16_f32 v24, v16, v17
    v_cvt_pk_bf16_f32 v25, v18, v19
    v_cvt_pk_bf16_f32 v26, v20, v21
    v_cvt_pk_bf16_f32 v27, v22, v23
    buffer_store_dwordx4 v[24:27], v251, s[4:7], s53 offen offset:1024 sc1
    v_accvgpr_read_b32 v32, a152
    v_accvgpr_read_b32 v33, a153
    v_accvgpr_read_b32 v34, a154
    v_accvgpr_read_b32 v35, a155
    v_accvgpr_read_b32 v36, a184
    v_accvgpr_read_b32 v37, a185
    v_accvgpr_read_b32 v38, a186
    v_accvgpr_read_b32 v39, a187
    v_cvt_pk_bf16_f32 v40, v32, v33
    v_cvt_pk_bf16_f32 v41, v34, v35
    v_cvt_pk_bf16_f32 v42, v36, v37
    v_cvt_pk_bf16_f32 v43, v38, v39
    buffer_store_dwordx4 v[40:43], v251, s[4:7], s53 offen offset:2048 sc1
    v_accvgpr_read_b32 v48, a156
    v_accvgpr_read_b32 v49, a157
    v_accvgpr_read_b32 v50, a158
    v_accvgpr_read_b32 v51, a159
    v_accvgpr_read_b32 v52, a188
    v_accvgpr_read_b32 v53, a189
    v_accvgpr_read_b32 v54, a190
    v_accvgpr_read_b32 v55, a191
    v_cvt_pk_bf16_f32 v56, v48, v49
    v_cvt_pk_bf16_f32 v57, v50, v51
    v_cvt_pk_bf16_f32 v58, v52, v53
    v_cvt_pk_bf16_f32 v59, v54, v55
    buffer_store_dwordx4 v[56:59], v251, s[4:7], s53 offen offset:3072 sc1
    s_add_u32 s53, s53, 258048
    v_accvgpr_read_b32 v0, a192
    v_accvgpr_read_b32 v1, a193
    v_accvgpr_read_b32 v2, a194
    v_accvgpr_read_b32 v3, a195
    v_accvgpr_read_b32 v4, a224
    v_accvgpr_read_b32 v5, a225
    v_accvgpr_read_b32 v6, a226
    v_accvgpr_read_b32 v7, a227
    v_cvt_pk_bf16_f32 v8, v0, v1
    v_cvt_pk_bf16_f32 v9, v2, v3
    v_cvt_pk_bf16_f32 v10, v4, v5
    v_cvt_pk_bf16_f32 v11, v6, v7
    buffer_store_dwordx4 v[8:11], v251, s[4:7], s53 offen offset:0 sc1
    v_accvgpr_read_b32 v16, a196
    v_accvgpr_read_b32 v17, a197
    v_accvgpr_read_b32 v18, a198
    v_accvgpr_read_b32 v19, a199
    v_accvgpr_read_b32 v20, a228
    v_accvgpr_read_b32 v21, a229
    v_accvgpr_read_b32 v22, a230
    v_accvgpr_read_b32 v23, a231
    v_cvt_pk_bf16_f32 v24, v16, v17
    v_cvt_pk_bf16_f32 v25, v18, v19
    v_cvt_pk_bf16_f32 v26, v20, v21
    v_cvt_pk_bf16_f32 v27, v22, v23
    buffer_store_dwordx4 v[24:27], v251, s[4:7], s53 offen offset:1024 sc1
    v_accvgpr_read_b32 v32, a200
    v_accvgpr_read_b32 v33, a201
    v_accvgpr_read_b32 v34, a202
    v_accvgpr_read_b32 v35, a203
    v_accvgpr_read_b32 v36, a232
    v_accvgpr_read_b32 v37, a233
    v_accvgpr_read_b32 v38, a234
    v_accvgpr_read_b32 v39, a235
    v_cvt_pk_bf16_f32 v40, v32, v33
    v_cvt_pk_bf16_f32 v41, v34, v35
    v_cvt_pk_bf16_f32 v42, v36, v37
    v_cvt_pk_bf16_f32 v43, v38, v39
    buffer_store_dwordx4 v[40:43], v251, s[4:7], s53 offen offset:2048 sc1
    v_accvgpr_read_b32 v48, a204
    v_accvgpr_read_b32 v49, a205
    v_accvgpr_read_b32 v50, a206
    v_accvgpr_read_b32 v51, a207
    v_accvgpr_read_b32 v52, a236
    v_accvgpr_read_b32 v53, a237
    v_accvgpr_read_b32 v54, a238
    v_accvgpr_read_b32 v55, a239
    v_cvt_pk_bf16_f32 v56, v48, v49
    v_cvt_pk_bf16_f32 v57, v50, v51
    v_cvt_pk_bf16_f32 v58, v52, v53
    v_cvt_pk_bf16_f32 v59, v54, v55
    buffer_store_dwordx4 v[56:59], v251, s[4:7], s53 offen offset:3072 sc1
    s_add_u32 s53, s53, 4096
    v_accvgpr_read_b32 v0, a208
    v_accvgpr_read_b32 v1, a209
    v_accvgpr_read_b32 v2, a210
    v_accvgpr_read_b32 v3, a211
    v_accvgpr_read_b32 v4, a240
    v_accvgpr_read_b32 v5, a241
    v_accvgpr_read_b32 v6, a242
    v_accvgpr_read_b32 v7, a243
    v_cvt_pk_bf16_f32 v8, v0, v1
    v_cvt_pk_bf16_f32 v9, v2, v3
    v_cvt_pk_bf16_f32 v10, v4, v5
    v_cvt_pk_bf16_f32 v11, v6, v7
    buffer_store_dwordx4 v[8:11], v251, s[4:7], s53 offen offset:0 sc1
    v_accvgpr_read_b32 v16, a212
    v_accvgpr_read_b32 v17, a213
    v_accvgpr_read_b32 v18, a214
    v_accvgpr_read_b32 v19, a215
    v_accvgpr_read_b32 v20, a244
    v_accvgpr_read_b32 v21, a245
    v_accvgpr_read_b32 v22, a246
    v_accvgpr_read_b32 v23, a247
    v_cvt_pk_bf16_f32 v24, v16, v17
    v_cvt_pk_bf16_f32 v25, v18, v19
    v_cvt_pk_bf16_f32 v26, v20, v21
    v_cvt_pk_bf16_f32 v27, v22, v23
    buffer_store_dwordx4 v[24:27], v251, s[4:7], s53 offen offset:1024 sc1
    v_accvgpr_read_b32 v32, a216
    v_accvgpr_read_b32 v33, a217
    v_accvgpr_read_b32 v34, a218
    v_accvgpr_read_b32 v35, a219
    v_accvgpr_read_b32 v36, a248
    v_accvgpr_read_b32 v37, a249
    v_accvgpr_read_b32 v38, a250
    v_accvgpr_read_b32 v39, a251
    v_cvt_pk_bf16_f32 v40, v32, v33
    v_cvt_pk_bf16_f32 v41, v34, v35
    v_cvt_pk_bf16_f32 v42, v36, v37
    v_cvt_pk_bf16_f32 v43, v38, v39
    buffer_store_dwordx4 v[40:43], v251, s[4:7], s53 offen offset:2048 sc1
    v_accvgpr_read_b32 v48, a220
    v_accvgpr_read_b32 v49, a221
    v_accvgpr_read_b32 v50, a222
    v_accvgpr_read_b32 v51, a223
    v_accvgpr_read_b32 v52, a252
    v_accvgpr_read_b32 v53, a253
    v_accvgpr_read_b32 v54, a254
    v_accvgpr_read_b32 v55, a255
    v_cvt_pk_bf16_f32 v56, v48, v49
    v_cvt_pk_bf16_f32 v57, v50, v51
    v_cvt_pk_bf16_f32 v58, v52, v53
    v_cvt_pk_bf16_f32 v59, v54, v55
    buffer_store_dwordx4 v[56:59], v251, s[4:7], s53 offen offset:3072 sc1
    s_add_u32 s53, s53, 258048
    s_branch main_kernel_w_done
main_kernel_w_pref:
    s_cmp_lg_u32 s24, 0
    s_cbranch_scc1 main_kernel_w_pf0
    s_mov_b32 s8, s64
    s_and_b32 s9, s65, 0xffff
    s_mov_b32 s10, 0x200000
    s_mov_b32 s11, 0x20000
    s_branch main_kernel_w_pfg
main_kernel_w_pf0:
    s_cmp_lg_u32 s24, 1
    s_cbranch_scc1 main_kernel_w_pf1
    s_mov_b32 s8, s66
    s_and_b32 s9, s67, 0xffff
    s_mov_b32 s10, 0x200000
    s_mov_b32 s11, 0x20000
    s_branch main_kernel_w_pfg
main_kernel_w_pf1:
    s_cmp_lg_u32 s24, 2
    s_cbranch_scc1 main_kernel_w_pf2
    s_mov_b32 s8, s68
    s_and_b32 s9, s69, 0xffff
    s_mov_b32 s10, 0x700000
    s_mov_b32 s11, 0x20000
    s_branch main_kernel_w_pfg
main_kernel_w_pf2:
    s_mov_b32 s8, s70
    s_and_b32 s9, s71, 0xffff
    s_mov_b32 s10, 0x700000
    s_mov_b32 s11, 0x20000
main_kernel_w_pfg:
    s_lshl_b32 s32, s25, 19
    s_lshl_b32 s33, s14, 17
    s_add_u32 s32, s32, s33
    v_lshlrev_b32 v253, 7, v250
    buffer_load_dword v0, v253, s[8:11], s32 offen
    s_add_u32 s32, s32, 8192
    buffer_load_dword v0, v253, s[8:11], s32 offen
    s_add_u32 s32, s32, 8192
    buffer_load_dword v0, v253, s[8:11], s32 offen
    s_add_u32 s32, s32, 8192
    buffer_load_dword v0, v253, s[8:11], s32 offen
    s_add_u32 s32, s32, 8192
    buffer_load_dword v0, v253, s[8:11], s32 offen
    s_add_u32 s32, s32, 8192
    buffer_load_dword v0, v253, s[8:11], s32 offen
    s_add_u32 s32, s32, 8192
    buffer_load_dword v0, v253, s[8:11], s32 offen
    s_add_u32 s32, s32, 8192
    buffer_load_dword v0, v253, s[8:11], s32 offen
    s_add_u32 s32, s32, 8192
    buffer_load_dword v0, v253, s[8:11], s32 offen
    s_add_u32 s32, s32, 8192
    buffer_load_dword v0, v253, s[8:11], s32 offen
    s_add_u32 s32, s32, 8192
    buffer_load_dword v0, v253, s[8:11], s32 offen
    s_add_u32 s32, s32, 8192
    buffer_load_dword v0, v253, s[8:11], s32 offen
    s_add_u32 s32, s32, 8192
    buffer_load_dword v0, v253, s[8:11], s32 offen
    s_add_u32 s32, s32, 8192
    buffer_load_dword v0, v253, s[8:11], s32 offen
    s_add_u32 s32, s32, 8192
    buffer_load_dword v0, v253, s[8:11], s32 offen
    s_add_u32 s32, s32, 8192
    buffer_load_dword v0, v253, s[8:11], s32 offen
    s_add_u32 s32, s32, 8192
    s_branch main_kernel_w_done
main_kernel_w_fill:
    s_lshl_b32 s32, s24, 2
    s_add_u32 s32, s32, s25
    s_lshl_b32 s33, s32, 16
    s_add_u32 s32, s33, 0x6e00000
    s_add_u32 s35, s33, 0x8c00000
    s_add_u32 s33, s33, 0x8000000
    s_lshl_b32 s34, s14, 12
    v_add_u32 v253, s34, v251
    v_mov_b32 v0, -1
    v_mov_b32 v1, -1
    v_mov_b32 v2, -1
    v_mov_b32 v3, -1
    s_mov_b32 s18, 4
main_kernel_w_fl:
    buffer_store_dwordx4 v[0:3], v253, s[4:7], s32 offen offset:0 sc1
    buffer_store_dwordx4 v[0:3], v253, s[4:7], s32 offen offset:1024 sc1
    buffer_store_dwordx4 v[0:3], v253, s[4:7], s32 offen offset:2048 sc1
    buffer_store_dwordx4 v[0:3], v253, s[4:7], s32 offen offset:3072 sc1
    s_add_u32 s32, s32, 16384
    buffer_store_dwordx4 v[0:3], v253, s[4:7], s33 offen offset:0 sc1
    buffer_store_dwordx4 v[0:3], v253, s[4:7], s33 offen offset:1024 sc1
    buffer_store_dwordx4 v[0:3], v253, s[4:7], s33 offen offset:2048 sc1
    buffer_store_dwordx4 v[0:3], v253, s[4:7], s33 offen offset:3072 sc1
    s_add_u32 s33, s33, 16384
    s_sub_u32 s18, s18, 1
    s_cmp_lg_u32 s18, 0
    s_cbranch_scc1 main_kernel_w_fl
    s_branch main_kernel_w_done
main_kernel_w_ln2:
    s_lshl_b32 s32, s24, 3
    s_mul_i32 s33, s25, 2
    s_add_u32 s32, s32, s33
    s_lshl_b32 s32, s32, 15
    s_lshl_b32 s33, s14, 13
    s_add_u32 s32, s32, s33
    s_add_u32 s21, s32, 0x6800000
    s_add_u32 s32, s32, 0x5000000
    buffer_load_dwordx4 v[0:3], v251, s[4:7], s32 offen offset:0 sc1
    buffer_load_dwordx4 v[4:7], v251, s[4:7], s32 offen offset:1024 sc1
    buffer_load_dwordx4 v[8:11], v251, s[4:7], s32 offen offset:2048 sc1
    buffer_load_dwordx4 v[12:15], v251, s[4:7], s32 offen offset:3072 sc1
    s_add_u32 s32, s32, 4096
    buffer_load_dwordx4 v[16:19], v251, s[4:7], s32 offen offset:0 sc1
    buffer_load_dwordx4 v[20:23], v251, s[4:7], s32 offen offset:1024 sc1
    buffer_load_dwordx4 v[24:27], v251, s[4:7], s32 offen offset:2048 sc1
    buffer_load_dwordx4 v[28:31], v251, s[4:7], s32 offen offset:3072 sc1
    s_add_u32 s32, s32, 28672
    buffer_load_dwordx4 v[32:35], v251, s[4:7], s32 offen offset:0 sc1
    buffer_load_dwordx4 v[36:39], v251, s[4:7], s32 offen offset:1024 sc1
    buffer_load_dwordx4 v[40:43], v251, s[4:7], s32 offen offset:2048 sc1
    buffer_load_dwordx4 v[44:47], v251, s[4:7], s32 offen offset:3072 sc1
    s_add_u32 s32, s32, 4096
    buffer_load_dwordx4 v[48:51], v251, s[4:7], s32 offen offset:0 sc1
    buffer_load_dwordx4 v[52:55], v251, s[4:7], s32 offen offset:1024 sc1
    buffer_load_dwordx4 v[56:59], v251, s[4:7], s32 offen offset:2048 sc1
    buffer_load_dwordx4 v[60:63], v251, s[4:7], s32 offen offset:3072 sc1
    s_add_u32 s32, s32, 28672
    v_and_b32 v255, 15, v250
    v_lshlrev_b32 v254, 6, v255
    v_add_u32 v254, 132096, v254
    v_lshrrev_b32 v255, 4, v250
    v_lshl_add_u32 v253, v255, 2, v254
    v_lshl_add_u32 v253, s14, 4, v253
    s_waitcnt vmcnt(8)
    v_lshlrev_b32 v128, 16, v0
    v_and_b32 v129, 0xffff0000, v0
    v_lshlrev_b32 v130, 16, v1
    v_and_b32 v131, 0xffff0000, v1
    v_lshlrev_b32 v132, 16, v2
    v_and_b32 v133, 0xffff0000, v2
    v_lshlrev_b32 v134, 16, v3
    v_and_b32 v135, 0xffff0000, v3
    v_lshlrev_b32 v136, 16, v4
    v_and_b32 v137, 0xffff0000, v4
    v_lshlrev_b32 v138, 16, v5
    v_and_b32 v139, 0xffff0000, v5
    v_lshlrev_b32 v140, 16, v6
    v_and_b32 v141, 0xffff0000, v6
    v_lshlrev_b32 v142, 16, v7
    v_and_b32 v143, 0xffff0000, v7
    v_lshlrev_b32 v144, 16, v8
    v_and_b32 v145, 0xffff0000, v8
    v_lshlrev_b32 v146, 16, v9
    v_and_b32 v147, 0xffff0000, v9
    v_lshlrev_b32 v148, 16, v10
    v_and_b32 v149, 0xffff0000, v10
    v_lshlrev_b32 v150, 16, v11
    v_and_b32 v151, 0xffff0000, v11
    v_lshlrev_b32 v152, 16, v12
    v_and_b32 v153, 0xffff0000, v12
    v_lshlrev_b32 v154, 16, v13
    v_and_b32 v155, 0xffff0000, v13
    v_lshlrev_b32 v156, 16, v14
    v_and_b32 v157, 0xffff0000, v14
    v_lshlrev_b32 v158, 16, v15
    v_and_b32 v159, 0xffff0000, v15
    v_lshlrev_b32 v160, 16, v16
    v_and_b32 v161, 0xffff0000, v16
    v_lshlrev_b32 v162, 16, v17
    v_and_b32 v163, 0xffff0000, v17
    v_lshlrev_b32 v164, 16, v18
    v_and_b32 v165, 0xffff0000, v18
    v_lshlrev_b32 v166, 16, v19
    v_and_b32 v167, 0xffff0000, v19
    v_lshlrev_b32 v168, 16, v20
    v_and_b32 v169, 0xffff0000, v20
    v_lshlrev_b32 v170, 16, v21
    v_and_b32 v171, 0xffff0000, v21
    v_lshlrev_b32 v172, 16, v22
    v_and_b32 v173, 0xffff0000, v22
    v_lshlrev_b32 v174, 16, v23
    v_and_b32 v175, 0xffff0000, v23
    v_lshlrev_b32 v176, 16, v24
    v_and_b32 v177, 0xffff0000, v24
    v_lshlrev_b32 v178, 16, v25
    v_and_b32 v179, 0xffff0000, v25
    v_lshlrev_b32 v180, 16, v26
    v_and_b32 v181, 0xffff0000, v26
    v_lshlrev_b32 v182, 16, v27
    v_and_b32 v183, 0xffff0000, v27
    v_lshlrev_b32 v184, 16, v28
    v_and_b32 v185, 0xffff0000, v28
    v_lshlrev_b32 v186, 16, v29
    v_and_b32 v187, 0xffff0000, v29
    v_lshlrev_b32 v188, 16, v30
    v_and_b32 v189, 0xffff0000, v30
    v_lshlrev_b32 v190, 16, v31
    v_and_b32 v191, 0xffff0000, v31
    v_pk_add_f32 v[192:193], v[128:129], v[136:137]
    v_pk_add_f32 v[194:195], v[130:131], v[138:139]
    v_pk_add_f32 v[196:197], v[132:133], v[140:141]
    v_pk_add_f32 v[198:199], v[134:135], v[142:143]
    v_pk_add_f32 v[192:193], v[192:193], v[144:145]
    v_pk_add_f32 v[194:195], v[194:195], v[146:147]
    v_pk_add_f32 v[196:197], v[196:197], v[148:149]
    v_pk_add_f32 v[198:199], v[198:199], v[150:151]
    v_pk_add_f32 v[192:193], v[192:193], v[152:153]
    v_pk_add_f32 v[194:195], v[194:195], v[154:155]
    v_pk_add_f32 v[196:197], v[196:197], v[156:157]
    v_pk_add_f32 v[198:199], v[198:199], v[158:159]
    v_pk_add_f32 v[192:193], v[192:193], v[160:161]
    v_pk_add_f32 v[194:195], v[194:195], v[162:163]
    v_pk_add_f32 v[196:197], v[196:197], v[164:165]
    v_pk_add_f32 v[198:199], v[198:199], v[166:167]
    v_pk_add_f32 v[192:193], v[192:193], v[168:169]
    v_pk_add_f32 v[194:195], v[194:195], v[170:171]
    v_pk_add_f32 v[196:197], v[196:197], v[172:173]
    v_pk_add_f32 v[198:199], v[198:199], v[174:175]
    v_pk_add_f32 v[192:193], v[192:193], v[176:177]
    v_pk_add_f32 v[194:195], v[194:195], v[178:179]
    v_pk_add_f32 v[196:197], v[196:197], v[180:181]
    v_pk_add_f32 v[198:199], v[198:199], v[182:183]
    v_pk_add_f32 v[192:193], v[192:193], v[184:185]
    v_pk_add_f32 v[194:195], v[194:195], v[186:187]
    v_pk_add_f32 v[196:197], v[196:197], v[188:189]
    v_pk_add_f32 v[198:199], v[198:199], v[190:191]
    v_pk_add_f32 v[192:193], v[192:193], v[194:195]
    v_pk_add_f32 v[196:197], v[196:197], v[198:199]
    v_pk_add_f32 v[192:193], v[192:193], v[196:197]
    v_add_f32 v192, v192, v193
    ds_write_b32 v253, v192 offset:0
    s_waitcnt lgkmcnt(0)
    s_barrier
    ds_read_b128 v[192:195], v254 offset:0
    ds_read_b128 v[196:199], v254 offset:16
    ds_read_b128 v[200:203], v254 offset:32
    ds_read_b128 v[204:207], v254 offset:48
    s_waitcnt lgkmcnt(2)
    v_pk_add_f32 v[192:193], v[192:193], v[194:195]
    v_pk_add_f32 v[196:197], v[196:197], v[198:199]
    s_waitcnt lgkmcnt(0)
    v_pk_add_f32 v[200:201], v[200:201], v[202:203]
    v_pk_add_f32 v[204:205], v[204:205], v[206:207]
    v_pk_add_f32 v[192:193], v[192:193], v[196:197]
    v_pk_add_f32 v[200:201], v[200:201], v[204:205]
    v_pk_add_f32 v[192:193], v[192:193], v[200:201]
    v_add_f32 v192, v192, v193
    v_mul_f32 v192, 0xba800000, v192
    v_mov_b32 v193, v192
    v_pk_add_f32 v[128:129], v[128:129], v[192:193]
    v_pk_add_f32 v[130:131], v[130:131], v[192:193]
    v_pk_add_f32 v[132:133], v[132:133], v[192:193]
    v_pk_add_f32 v[134:135], v[134:135], v[192:193]
    v_pk_add_f32 v[136:137], v[136:137], v[192:193]
    v_pk_add_f32 v[138:139], v[138:139], v[192:193]
    v_pk_add_f32 v[140:141], v[140:141], v[192:193]
    v_pk_add_f32 v[142:143], v[142:143], v[192:193]
    v_pk_add_f32 v[144:145], v[144:145], v[192:193]
    v_pk_add_f32 v[146:147], v[146:147], v[192:193]
    v_pk_add_f32 v[148:149], v[148:149], v[192:193]
    v_pk_add_f32 v[150:151], v[150:151], v[192:193]
    v_pk_add_f32 v[152:153], v[152:153], v[192:193]
    v_pk_add_f32 v[154:155], v[154:155], v[192:193]
    v_pk_add_f32 v[156:157], v[156:157], v[192:193]
    v_pk_add_f32 v[158:159], v[158:159], v[192:193]
    v_pk_add_f32 v[160:161], v[160:161], v[192:193]
    v_pk_add_f32 v[162:163], v[162:163], v[192:193]
    v_pk_add_f32 v[164:165], v[164:165], v[192:193]
    v_pk_add_f32 v[166:167], v[166:167], v[192:193]
    v_pk_add_f32 v[168:169], v[168:169], v[192:193]
    v_pk_add_f32 v[170:171], v[170:171], v[192:193]
    v_pk_add_f32 v[172:173], v[172:173], v[192:193]
    v_pk_add_f32 v[174:175], v[174:175], v[192:193]
    v_pk_add_f32 v[176:177], v[176:177], v[192:193]
    v_pk_add_f32 v[178:179], v[178:179], v[192:193]
    v_pk_add_f32 v[180:181], v[180:181], v[192:193]
    v_pk_add_f32 v[182:183], v[182:183], v[192:193]
    v_pk_add_f32 v[184:185], v[184:185], v[192:193]
    v_pk_add_f32 v[186:187], v[186:187], v[192:193]
    v_pk_add_f32 v[188:189], v[188:189], v[192:193]
    v_pk_add_f32 v[190:191], v[190:191], v[192:193]
    v_pk_mul_f32 v[192:193], v[128:129], v[128:129]
    v_pk_mul_f32 v[194:195], v[130:131], v[130:131]
    v_pk_mul_f32 v[196:197], v[132:133], v[132:133]
    v_pk_mul_f32 v[198:199], v[134:135], v[134:135]
    v_pk_fma_f32 v[192:193], v[136:137], v[136:137], v[192:193]
    v_pk_fma_f32 v[194:195], v[138:139], v[138:139], v[194:195]
    v_pk_fma_f32 v[196:197], v[140:141], v[140:141], v[196:197]
    v_pk_fma_f32 v[198:199], v[142:143], v[142:143], v[198:199]
    v_pk_fma_f32 v[192:193], v[144:145], v[144:145], v[192:193]
    v_pk_fma_f32 v[194:195], v[146:147], v[146:147], v[194:195]
    v_pk_fma_f32 v[196:197], v[148:149], v[148:149], v[196:197]
    v_pk_fma_f32 v[198:199], v[150:151], v[150:151], v[198:199]
    v_pk_fma_f32 v[192:193], v[152:153], v[152:153], v[192:193]
    v_pk_fma_f32 v[194:195], v[154:155], v[154:155], v[194:195]
    v_pk_fma_f32 v[196:197], v[156:157], v[156:157], v[196:197]
    v_pk_fma_f32 v[198:199], v[158:159], v[158:159], v[198:199]
    v_pk_fma_f32 v[192:193], v[160:161], v[160:161], v[192:193]
    v_pk_fma_f32 v[194:195], v[162:163], v[162:163], v[194:195]
    v_pk_fma_f32 v[196:197], v[164:165], v[164:165], v[196:197]
    v_pk_fma_f32 v[198:199], v[166:167], v[166:167], v[198:199]
    v_pk_fma_f32 v[192:193], v[168:169], v[168:169], v[192:193]
    v_pk_fma_f32 v[194:195], v[170:171], v[170:171], v[194:195]
    v_pk_fma_f32 v[196:197], v[172:173], v[172:173], v[196:197]
    v_pk_fma_f32 v[198:199], v[174:175], v[174:175], v[198:199]
    v_pk_fma_f32 v[192:193], v[176:177], v[176:177], v[192:193]
    v_pk_fma_f32 v[194:195], v[178:179], v[178:179], v[194:195]
    v_pk_fma_f32 v[196:197], v[180:181], v[180:181], v[196:197]
    v_pk_fma_f32 v[198:199], v[182:183], v[182:183], v[198:199]
    v_pk_fma_f32 v[192:193], v[184:185], v[184:185], v[192:193]
    v_pk_fma_f32 v[194:195], v[186:187], v[186:187], v[194:195]
    v_pk_fma_f32 v[196:197], v[188:189], v[188:189], v[196:197]
    v_pk_fma_f32 v[198:199], v[190:191], v[190:191], v[198:199]
    v_pk_add_f32 v[192:193], v[192:193], v[194:195]
    v_pk_add_f32 v[196:197], v[196:197], v[198:199]
    v_pk_add_f32 v[192:193], v[192:193], v[196:197]
    v_add_f32 v192, v192, v193
    ds_write_b32 v253, v192 offset:1024
    s_waitcnt lgkmcnt(0)
    s_barrier
    ds_read_b128 v[192:195], v254 offset:1024
    ds_read_b128 v[196:199], v254 offset:1040
    ds_read_b128 v[200:203], v254 offset:1056
    ds_read_b128 v[204:207], v254 offset:1072
    s_waitcnt lgkmcnt(2)
    v_pk_add_f32 v[192:193], v[192:193], v[194:195]
    v_pk_add_f32 v[196:197], v[196:197], v[198:199]
    s_waitcnt lgkmcnt(0)
    v_pk_add_f32 v[200:201], v[200:201], v[202:203]
    v_pk_add_f32 v[204:205], v[204:205], v[206:207]
    v_pk_add_f32 v[192:193], v[192:193], v[196:197]
    v_pk_add_f32 v[200:201], v[200:201], v[204:205]
    v_pk_add_f32 v[192:193], v[192:193], v[200:201]
    v_add_f32 v192, v192, v193
    v_mov_b32 v193, 0x3727c5ac
    v_fmac_f32 v193, 0x3a800000, v192
    v_rsq_f32 v192, v193
    s_nop 0
    v_mov_b32 v193, v192
    v_pk_mul_f32 v[128:129], v[128:129], v[192:193]
    v_pk_mul_f32 v[130:131], v[130:131], v[192:193]
    v_pk_mul_f32 v[132:133], v[132:133], v[192:193]
    v_pk_mul_f32 v[134:135], v[134:135], v[192:193]
    v_pk_mul_f32 v[136:137], v[136:137], v[192:193]
    v_pk_mul_f32 v[138:139], v[138:139], v[192:193]
    v_pk_mul_f32 v[140:141], v[140:141], v[192:193]
    v_pk_mul_f32 v[142:143], v[142:143], v[192:193]
    v_pk_mul_f32 v[144:145], v[144:145], v[192:193]
    v_pk_mul_f32 v[146:147], v[146:147], v[192:193]
    v_pk_mul_f32 v[148:149], v[148:149], v[192:193]
    v_pk_mul_f32 v[150:151], v[150:151], v[192:193]
    v_pk_mul_f32 v[152:153], v[152:153], v[192:193]
    v_pk_mul_f32 v[154:155], v[154:155], v[192:193]
    v_pk_mul_f32 v[156:157], v[156:157], v[192:193]
    v_pk_mul_f32 v[158:159], v[158:159], v[192:193]
    v_pk_mul_f32 v[160:161], v[160:161], v[192:193]
    v_pk_mul_f32 v[162:163], v[162:163], v[192:193]
    v_pk_mul_f32 v[164:165], v[164:165], v[192:193]
    v_pk_mul_f32 v[166:167], v[166:167], v[192:193]
    v_pk_mul_f32 v[168:169], v[168:169], v[192:193]
    v_pk_mul_f32 v[170:171], v[170:171], v[192:193]
    v_pk_mul_f32 v[172:173], v[172:173], v[192:193]
    v_pk_mul_f32 v[174:175], v[174:175], v[192:193]
    v_pk_mul_f32 v[176:177], v[176:177], v[192:193]
    v_pk_mul_f32 v[178:179], v[178:179], v[192:193]
    v_pk_mul_f32 v[180:181], v[180:181], v[192:193]
    v_pk_mul_f32 v[182:183], v[182:183], v[192:193]
    v_pk_mul_f32 v[184:185], v[184:185], v[192:193]
    v_pk_mul_f32 v[186:187], v[186:187], v[192:193]
    v_pk_mul_f32 v[188:189], v[188:189], v[192:193]
    v_pk_mul_f32 v[190:191], v[190:191], v[192:193]
    v_cvt_pk_bf16_f32 v0, v128, v129
    v_cvt_pk_bf16_f32 v1, v130, v131
    v_cvt_pk_bf16_f32 v2, v132, v133
    v_cvt_pk_bf16_f32 v3, v134, v135
    v_cvt_pk_bf16_f32 v4, v136, v137
    v_cvt_pk_bf16_f32 v5, v138, v139
    v_cvt_pk_bf16_f32 v6, v140, v141
    v_cvt_pk_bf16_f32 v7, v142, v143
    v_cvt_pk_bf16_f32 v8, v144, v145
    v_cvt_pk_bf16_f32 v9, v146, v147
    v_cvt_pk_bf16_f32 v10, v148, v149
    v_cvt_pk_bf16_f32 v11, v150, v151
    v_cvt_pk_bf16_f32 v12, v152, v153
    v_cvt_pk_bf16_f32 v13, v154, v155
    v_cvt_pk_bf16_f32 v14, v156, v157
    v_cvt_pk_bf16_f32 v15, v158, v159
    v_cvt_pk_bf16_f32 v16, v160, v161
    v_cvt_pk_bf16_f32 v17, v162, v163
    v_cvt_pk_bf16_f32 v18, v164, v165
    v_cvt_pk_bf16_f32 v19, v166, v167
    v_cvt_pk_bf16_f32 v20, v168, v169
    v_cvt_pk_bf16_f32 v21, v170, v171
    v_cvt_pk_bf16_f32 v22, v172, v173
    v_cvt_pk_bf16_f32 v23, v174, v175
    v_cvt_pk_bf16_f32 v24, v176, v177
    v_cvt_pk_bf16_f32 v25, v178, v179
    v_cvt_pk_bf16_f32 v26, v180, v181
    v_cvt_pk_bf16_f32 v27, v182, v183
    v_cvt_pk_bf16_f32 v28, v184, v185
    v_cvt_pk_bf16_f32 v29, v186, v187
    v_cvt_pk_bf16_f32 v30, v188, v189
    v_cvt_pk_bf16_f32 v31, v190, v191
    buffer_store_dwordx4 v[0:3], v251, s[4:7], s21 offen offset:0 sc1
    buffer_store_dwordx4 v[4:7], v251, s[4:7], s21 offen offset:1024 sc1
    buffer_store_dwordx4 v[8:11], v251, s[4:7], s21 offen offset:2048 sc1
    buffer_store_dwordx4 v[12:15], v251, s[4:7], s21 offen offset:3072 sc1
    s_add_u32 s21, s21, 4096
    buffer_store_dwordx4 v[16:19], v251, s[4:7], s21 offen offset:0 sc1
    buffer_store_dwordx4 v[20:23], v251, s[4:7], s21 offen offset:1024 sc1
    buffer_store_dwordx4 v[24:27], v251, s[4:7], s21 offen offset:2048 sc1
    buffer_store_dwordx4 v[28:31], v251, s[4:7], s21 offen offset:3072 sc1
    s_add_u32 s21, s21, 28672
    s_waitcnt vmcnt(8)
    v_lshlrev_b32 v128, 16, v32
    v_and_b32 v129, 0xffff0000, v32
    v_lshlrev_b32 v130, 16, v33
    v_and_b32 v131, 0xffff0000, v33
    v_lshlrev_b32 v132, 16, v34
    v_and_b32 v133, 0xffff0000, v34
    v_lshlrev_b32 v134, 16, v35
    v_and_b32 v135, 0xffff0000, v35
    v_lshlrev_b32 v136, 16, v36
    v_and_b32 v137, 0xffff0000, v36
    v_lshlrev_b32 v138, 16, v37
    v_and_b32 v139, 0xffff0000, v37
    v_lshlrev_b32 v140, 16, v38
    v_and_b32 v141, 0xffff0000, v38
    v_lshlrev_b32 v142, 16, v39
    v_and_b32 v143, 0xffff0000, v39
    v_lshlrev_b32 v144, 16, v40
    v_and_b32 v145, 0xffff0000, v40
    v_lshlrev_b32 v146, 16, v41
    v_and_b32 v147, 0xffff0000, v41
    v_lshlrev_b32 v148, 16, v42
    v_and_b32 v149, 0xffff0000, v42
    v_lshlrev_b32 v150, 16, v43
    v_and_b32 v151, 0xffff0000, v43
    v_lshlrev_b32 v152, 16, v44
    v_and_b32 v153, 0xffff0000, v44
    v_lshlrev_b32 v154, 16, v45
    v_and_b32 v155, 0xffff0000, v45
    v_lshlrev_b32 v156, 16, v46
    v_and_b32 v157, 0xffff0000, v46
    v_lshlrev_b32 v158, 16, v47
    v_and_b32 v159, 0xffff0000, v47
    v_lshlrev_b32 v160, 16, v48
    v_and_b32 v161, 0xffff0000, v48
    v_lshlrev_b32 v162, 16, v49
    v_and_b32 v163, 0xffff0000, v49
    v_lshlrev_b32 v164, 16, v50
    v_and_b32 v165, 0xffff0000, v50
    v_lshlrev_b32 v166, 16, v51
    v_and_b32 v167, 0xffff0000, v51
    v_lshlrev_b32 v168, 16, v52
    v_and_b32 v169, 0xffff0000, v52
    v_lshlrev_b32 v170, 16, v53
    v_and_b32 v171, 0xffff0000, v53
    v_lshlrev_b32 v172, 16, v54
    v_and_b32 v173, 0xffff0000, v54
    v_lshlrev_b32 v174, 16, v55
    v_and_b32 v175, 0xffff0000, v55
    v_lshlrev_b32 v176, 16, v56
    v_and_b32 v177, 0xffff0000, v56
    v_lshlrev_b32 v178, 16, v57
    v_and_b32 v179, 0xffff0000, v57
    v_lshlrev_b32 v180, 16, v58
    v_and_b32 v181, 0xffff0000, v58
    v_lshlrev_b32 v182, 16, v59
    v_and_b32 v183, 0xffff0000, v59
    v_lshlrev_b32 v184, 16, v60
    v_and_b32 v185, 0xffff0000, v60
    v_lshlrev_b32 v186, 16, v61
    v_and_b32 v187, 0xffff0000, v61
    v_lshlrev_b32 v188, 16, v62
    v_and_b32 v189, 0xffff0000, v62
    v_lshlrev_b32 v190, 16, v63
    v_and_b32 v191, 0xffff0000, v63
    v_pk_add_f32 v[192:193], v[128:129], v[136:137]
    v_pk_add_f32 v[194:195], v[130:131], v[138:139]
    v_pk_add_f32 v[196:197], v[132:133], v[140:141]
    v_pk_add_f32 v[198:199], v[134:135], v[142:143]
    v_pk_add_f32 v[192:193], v[192:193], v[144:145]
    v_pk_add_f32 v[194:195], v[194:195], v[146:147]
    v_pk_add_f32 v[196:197], v[196:197], v[148:149]
    v_pk_add_f32 v[198:199], v[198:199], v[150:151]
    v_pk_add_f32 v[192:193], v[192:193], v[152:153]
    v_pk_add_f32 v[194:195], v[194:195], v[154:155]
    v_pk_add_f32 v[196:197], v[196:197], v[156:157]
    v_pk_add_f32 v[198:199], v[198:199], v[158:159]
    v_pk_add_f32 v[192:193], v[192:193], v[160:161]
    v_pk_add_f32 v[194:195], v[194:195], v[162:163]
    v_pk_add_f32 v[196:197], v[196:197], v[164:165]
    v_pk_add_f32 v[198:199], v[198:199], v[166:167]
    v_pk_add_f32 v[192:193], v[192:193], v[168:169]
    v_pk_add_f32 v[194:195], v[194:195], v[170:171]
    v_pk_add_f32 v[196:197], v[196:197], v[172:173]
    v_pk_add_f32 v[198:199], v[198:199], v[174:175]
    v_pk_add_f32 v[192:193], v[192:193], v[176:177]
    v_pk_add_f32 v[194:195], v[194:195], v[178:179]
    v_pk_add_f32 v[196:197], v[196:197], v[180:181]
    v_pk_add_f32 v[198:199], v[198:199], v[182:183]
    v_pk_add_f32 v[192:193], v[192:193], v[184:185]
    v_pk_add_f32 v[194:195], v[194:195], v[186:187]
    v_pk_add_f32 v[196:197], v[196:197], v[188:189]
    v_pk_add_f32 v[198:199], v[198:199], v[190:191]
    v_pk_add_f32 v[192:193], v[192:193], v[194:195]
    v_pk_add_f32 v[196:197], v[196:197], v[198:199]
    v_pk_add_f32 v[192:193], v[192:193], v[196:197]
    v_add_f32 v192, v192, v193
    ds_write_b32 v253, v192 offset:0
    s_waitcnt lgkmcnt(0)
    s_barrier
    ds_read_b128 v[192:195], v254 offset:0
    ds_read_b128 v[196:199], v254 offset:16
    ds_read_b128 v[200:203], v254 offset:32
    ds_read_b128 v[204:207], v254 offset:48
    s_waitcnt lgkmcnt(2)
    v_pk_add_f32 v[192:193], v[192:193], v[194:195]
    v_pk_add_f32 v[196:197], v[196:197], v[198:199]
    s_waitcnt lgkmcnt(0)
    v_pk_add_f32 v[200:201], v[200:201], v[202:203]
    v_pk_add_f32 v[204:205], v[204:205], v[206:207]
    v_pk_add_f32 v[192:193], v[192:193], v[196:197]
    v_pk_add_f32 v[200:201], v[200:201], v[204:205]
    v_pk_add_f32 v[192:193], v[192:193], v[200:201]
    v_add_f32 v192, v192, v193
    v_mul_f32 v192, 0xba800000, v192
    v_mov_b32 v193, v192
    v_pk_add_f32 v[128:129], v[128:129], v[192:193]
    v_pk_add_f32 v[130:131], v[130:131], v[192:193]
    v_pk_add_f32 v[132:133], v[132:133], v[192:193]
    v_pk_add_f32 v[134:135], v[134:135], v[192:193]
    v_pk_add_f32 v[136:137], v[136:137], v[192:193]
    v_pk_add_f32 v[138:139], v[138:139], v[192:193]
    v_pk_add_f32 v[140:141], v[140:141], v[192:193]
    v_pk_add_f32 v[142:143], v[142:143], v[192:193]
    v_pk_add_f32 v[144:145], v[144:145], v[192:193]
    v_pk_add_f32 v[146:147], v[146:147], v[192:193]
    v_pk_add_f32 v[148:149], v[148:149], v[192:193]
    v_pk_add_f32 v[150:151], v[150:151], v[192:193]
    v_pk_add_f32 v[152:153], v[152:153], v[192:193]
    v_pk_add_f32 v[154:155], v[154:155], v[192:193]
    v_pk_add_f32 v[156:157], v[156:157], v[192:193]
    v_pk_add_f32 v[158:159], v[158:159], v[192:193]
    v_pk_add_f32 v[160:161], v[160:161], v[192:193]
    v_pk_add_f32 v[162:163], v[162:163], v[192:193]
    v_pk_add_f32 v[164:165], v[164:165], v[192:193]
    v_pk_add_f32 v[166:167], v[166:167], v[192:193]
    v_pk_add_f32 v[168:169], v[168:169], v[192:193]
    v_pk_add_f32 v[170:171], v[170:171], v[192:193]
    v_pk_add_f32 v[172:173], v[172:173], v[192:193]
    v_pk_add_f32 v[174:175], v[174:175], v[192:193]
    v_pk_add_f32 v[176:177], v[176:177], v[192:193]
    v_pk_add_f32 v[178:179], v[178:179], v[192:193]
    v_pk_add_f32 v[180:181], v[180:181], v[192:193]
    v_pk_add_f32 v[182:183], v[182:183], v[192:193]
    v_pk_add_f32 v[184:185], v[184:185], v[192:193]
    v_pk_add_f32 v[186:187], v[186:187], v[192:193]
    v_pk_add_f32 v[188:189], v[188:189], v[192:193]
    v_pk_add_f32 v[190:191], v[190:191], v[192:193]
    v_pk_mul_f32 v[192:193], v[128:129], v[128:129]
    v_pk_mul_f32 v[194:195], v[130:131], v[130:131]
    v_pk_mul_f32 v[196:197], v[132:133], v[132:133]
    v_pk_mul_f32 v[198:199], v[134:135], v[134:135]
    v_pk_fma_f32 v[192:193], v[136:137], v[136:137], v[192:193]
    v_pk_fma_f32 v[194:195], v[138:139], v[138:139], v[194:195]
    v_pk_fma_f32 v[196:197], v[140:141], v[140:141], v[196:197]
    v_pk_fma_f32 v[198:199], v[142:143], v[142:143], v[198:199]
    v_pk_fma_f32 v[192:193], v[144:145], v[144:145], v[192:193]
    v_pk_fma_f32 v[194:195], v[146:147], v[146:147], v[194:195]
    v_pk_fma_f32 v[196:197], v[148:149], v[148:149], v[196:197]
    v_pk_fma_f32 v[198:199], v[150:151], v[150:151], v[198:199]
    v_pk_fma_f32 v[192:193], v[152:153], v[152:153], v[192:193]
    v_pk_fma_f32 v[194:195], v[154:155], v[154:155], v[194:195]
    v_pk_fma_f32 v[196:197], v[156:157], v[156:157], v[196:197]
    v_pk_fma_f32 v[198:199], v[158:159], v[158:159], v[198:199]
    v_pk_fma_f32 v[192:193], v[160:161], v[160:161], v[192:193]
    v_pk_fma_f32 v[194:195], v[162:163], v[162:163], v[194:195]
    v_pk_fma_f32 v[196:197], v[164:165], v[164:165], v[196:197]
    v_pk_fma_f32 v[198:199], v[166:167], v[166:167], v[198:199]
    v_pk_fma_f32 v[192:193], v[168:169], v[168:169], v[192:193]
    v_pk_fma_f32 v[194:195], v[170:171], v[170:171], v[194:195]
    v_pk_fma_f32 v[196:197], v[172:173], v[172:173], v[196:197]
    v_pk_fma_f32 v[198:199], v[174:175], v[174:175], v[198:199]
    v_pk_fma_f32 v[192:193], v[176:177], v[176:177], v[192:193]
    v_pk_fma_f32 v[194:195], v[178:179], v[178:179], v[194:195]
    v_pk_fma_f32 v[196:197], v[180:181], v[180:181], v[196:197]
    v_pk_fma_f32 v[198:199], v[182:183], v[182:183], v[198:199]
    v_pk_fma_f32 v[192:193], v[184:185], v[184:185], v[192:193]
    v_pk_fma_f32 v[194:195], v[186:187], v[186:187], v[194:195]
    v_pk_fma_f32 v[196:197], v[188:189], v[188:189], v[196:197]
    v_pk_fma_f32 v[198:199], v[190:191], v[190:191], v[198:199]
    v_pk_add_f32 v[192:193], v[192:193], v[194:195]
    v_pk_add_f32 v[196:197], v[196:197], v[198:199]
    v_pk_add_f32 v[192:193], v[192:193], v[196:197]
    v_add_f32 v192, v192, v193
    ds_write_b32 v253, v192 offset:1024
    s_waitcnt lgkmcnt(0)
    s_barrier
    ds_read_b128 v[192:195], v254 offset:1024
    ds_read_b128 v[196:199], v254 offset:1040
    ds_read_b128 v[200:203], v254 offset:1056
    ds_read_b128 v[204:207], v254 offset:1072
    s_waitcnt lgkmcnt(2)
    v_pk_add_f32 v[192:193], v[192:193], v[194:195]
    v_pk_add_f32 v[196:197], v[196:197], v[198:199]
    s_waitcnt lgkmcnt(0)
    v_pk_add_f32 v[200:201], v[200:201], v[202:203]
    v_pk_add_f32 v[204:205], v[204:205], v[206:207]
    v_pk_add_f32 v[192:193], v[192:193], v[196:197]
    v_pk_add_f32 v[200:201], v[200:201], v[204:205]
    v_pk_add_f32 v[192:193], v[192:193], v[200:201]
    v_add_f32 v192, v192, v193
    v_mov_b32 v193, 0x3727c5ac
    v_fmac_f32 v193, 0x3a800000, v192
    v_rsq_f32 v192, v193
    s_nop 0
    v_mov_b32 v193, v192
    v_pk_mul_f32 v[128:129], v[128:129], v[192:193]
    v_pk_mul_f32 v[130:131], v[130:131], v[192:193]
    v_pk_mul_f32 v[132:133], v[132:133], v[192:193]
    v_pk_mul_f32 v[134:135], v[134:135], v[192:193]
    v_pk_mul_f32 v[136:137], v[136:137], v[192:193]
    v_pk_mul_f32 v[138:139], v[138:139], v[192:193]
    v_pk_mul_f32 v[140:141], v[140:141], v[192:193]
    v_pk_mul_f32 v[142:143], v[142:143], v[192:193]
    v_pk_mul_f32 v[144:145], v[144:145], v[192:193]
    v_pk_mul_f32 v[146:147], v[146:147], v[192:193]
    v_pk_mul_f32 v[148:149], v[148:149], v[192:193]
    v_pk_mul_f32 v[150:151], v[150:151], v[192:193]
    v_pk_mul_f32 v[152:153], v[152:153], v[192:193]
    v_pk_mul_f32 v[154:155], v[154:155], v[192:193]
    v_pk_mul_f32 v[156:157], v[156:157], v[192:193]
    v_pk_mul_f32 v[158:159], v[158:159], v[192:193]
    v_pk_mul_f32 v[160:161], v[160:161], v[192:193]
    v_pk_mul_f32 v[162:163], v[162:163], v[192:193]
    v_pk_mul_f32 v[164:165], v[164:165], v[192:193]
    v_pk_mul_f32 v[166:167], v[166:167], v[192:193]
    v_pk_mul_f32 v[168:169], v[168:169], v[192:193]
    v_pk_mul_f32 v[170:171], v[170:171], v[192:193]
    v_pk_mul_f32 v[172:173], v[172:173], v[192:193]
    v_pk_mul_f32 v[174:175], v[174:175], v[192:193]
    v_pk_mul_f32 v[176:177], v[176:177], v[192:193]
    v_pk_mul_f32 v[178:179], v[178:179], v[192:193]
    v_pk_mul_f32 v[180:181], v[180:181], v[192:193]
    v_pk_mul_f32 v[182:183], v[182:183], v[192:193]
    v_pk_mul_f32 v[184:185], v[184:185], v[192:193]
    v_pk_mul_f32 v[186:187], v[186:187], v[192:193]
    v_pk_mul_f32 v[188:189], v[188:189], v[192:193]
    v_pk_mul_f32 v[190:191], v[190:191], v[192:193]
    v_cvt_pk_bf16_f32 v32, v128, v129
    v_cvt_pk_bf16_f32 v33, v130, v131
    v_cvt_pk_bf16_f32 v34, v132, v133
    v_cvt_pk_bf16_f32 v35, v134, v135
    v_cvt_pk_bf16_f32 v36, v136, v137
    v_cvt_pk_bf16_f32 v37, v138, v139
    v_cvt_pk_bf16_f32 v38, v140, v141
    v_cvt_pk_bf16_f32 v39, v142, v143
    v_cvt_pk_bf16_f32 v40, v144, v145
    v_cvt_pk_bf16_f32 v41, v146, v147
    v_cvt_pk_bf16_f32 v42, v148, v149
    v_cvt_pk_bf16_f32 v43, v150, v151
    v_cvt_pk_bf16_f32 v44, v152, v153
    v_cvt_pk_bf16_f32 v45, v154, v155
    v_cvt_pk_bf16_f32 v46, v156, v157
    v_cvt_pk_bf16_f32 v47, v158, v159
    v_cvt_pk_bf16_f32 v48, v160, v161
    v_cvt_pk_bf16_f32 v49, v162, v163
    v_cvt_pk_bf16_f32 v50, v164, v165
    v_cvt_pk_bf16_f32 v51, v166, v167
    v_cvt_pk_bf16_f32 v52, v168, v169
    v_cvt_pk_bf16_f32 v53, v170, v171
    v_cvt_pk_bf16_f32 v54, v172, v173
    v_cvt_pk_bf16_f32 v55, v174, v175
    v_cvt_pk_bf16_f32 v56, v176, v177
    v_cvt_pk_bf16_f32 v57, v178, v179
    v_cvt_pk_bf16_f32 v58, v180, v181
    v_cvt_pk_bf16_f32 v59, v182, v183
    v_cvt_pk_bf16_f32 v60, v184, v185
    v_cvt_pk_bf16_f32 v61, v186, v187
    v_cvt_pk_bf16_f32 v62, v188, v189
    v_cvt_pk_bf16_f32 v63, v190, v191
    buffer_store_dwordx4 v[32:35], v251, s[4:7], s21 offen offset:0 sc1
    buffer_store_dwordx4 v[36:39], v251, s[4:7], s21 offen offset:1024 sc1
    buffer_store_dwordx4 v[40:43], v251, s[4:7], s21 offen offset:2048 sc1
    buffer_store_dwordx4 v[44:47], v251, s[4:7], s21 offen offset:3072 sc1
    s_add_u32 s21, s21, 4096
    buffer_store_dwordx4 v[48:51], v251, s[4:7], s21 offen offset:0 sc1
    buffer_store_dwordx4 v[52:55], v251, s[4:7], s21 offen offset:1024 sc1
    buffer_store_dwordx4 v[56:59], v251, s[4:7], s21 offen offset:2048 sc1
    buffer_store_dwordx4 v[60:63], v251, s[4:7], s21 offen offset:3072 sc1
    s_add_u32 s21, s21, 28672
    s_mov_b32 s54, 0
main_kernel_w_done:
    s_cmp_eq_u32 s14, 0
    s_cbranch_scc1 main_kernel_w_dw0
    s_waitcnt vmcnt(0)
    s_barrier
    s_branch main_kernel_w_bar
main_kernel_w_dw0:
    s_add_u32 s32, s23, 1
    s_bitcmp0_b32 s32, 2
    s_cselect_b32 s34, 4, 9
    s_cselect_b32 s35, 8, 4
    s_lshl_b32 s32, s23, 13
    s_add_u32 s56, s32, 0x8404000
    v_lshrrev_b32 v253, 1, v250
    v_add_u32 v253, s24, v253
    v_lshlrev_b32 v253, s34, v253
    v_and_b32 v254, 1, v250
    v_add_u32 v254, s25, v254
    v_lshlrev_b32 v254, s35, v254
    v_add_u32 v249, v254, v253
    s_lshl_b32 s57, 1, s54
    s_mov_b32 s28, s55
    s_cmp_eq_u32 s55, -1
    s_cbranch_scc0 main_kernel_w_have
    s_branch main_kernel_w_try
.section .rodata,"a"
.p2align 6
.amdhsa_kernel main_kernel
  .amdhsa_next_free_vgpr 512
  .amdhsa_next_free_sgpr 102
  .amdhsa_accum_offset 256
  .amdhsa_group_segment_fixed_size 0
  .amdhsa_kernarg_size 120
  .amdhsa_user_sgpr_count 2
  .amdhsa_user_sgpr_kernarg_segment_ptr 1
  .amdhsa_system_sgpr_workgroup_id_x 1
.end_amdhsa_kernel
```

```asm
; @launch kernel=main_kernel grid=(256,1,1) block=(256,1,1) lds=163840
.amdgcn_target "amdgcn-amd-amdhsa--gfx950"
.text
.text
.globl main_kernel
.p2align 8
.type main_kernel,@function
main_kernel:
    s_load_dwordx4 s[20:23], s[0:1], 104
    s_load_dwordx8 s[40:47], s[0:1], 16
    s_load_dwordx8 s[64:71], s[0:1], 64
    s_load_dwordx2 s[72:73], s[0:1], 0
    s_load_dwordx2 s[74:75], s[0:1], 96
    s_load_dwordx2 s[76:77], s[0:1], 8
    s_cmp_ge_u32 s2, 256
    s_cbranch_scc1 main_kernel_end
    v_lshrrev_b32 v126, 6, v0
    v_and_b32 v94, 63, v0
    v_and_b32 v250, 63, v0
    v_readfirstlane_b32 s14, v126
    s_mov_b32 s29, 0x80000
    s_waitcnt lgkmcnt(0)
    s_mov_b32 s60, s20
    s_and_b32 s61, s21, 0xffff
    s_mov_b32 s62, 0x100
    s_mov_b32 s63, 0x20000
    s_mov_b32 s4, s22
    s_and_b32 s5, s23, 0xffff
    s_mov_b32 s6, 0x10000000
    s_mov_b32 s7, 0x20000
    s_cmp_lg_u32 s14, 0
    s_cbranch_scc1 main_kernel_slot_wait
    s_getreg_b32 s12, hwreg(HW_REG_XCC_ID, 0, 4)
    s_and_b32 s12, s12, 7
    s_lshl_b32 s32, s12, 5
    v_mov_b32 v126, 0
    v_mov_b32 v127, 1
    s_mov_b64 exec, 1
    buffer_atomic_add v127, v126, s[60:63], s32 offen sc0 sc1
    s_waitcnt vmcnt(0)
    s_mov_b64 exec, -1
    v_readfirstlane_b32 s13, v127
    s_nop 3
    s_cmp_lt_u32 s13, 32
    s_cbranch_scc1 main_kernel_slot_pub
    v_and_b32 v126, 7, v94
    v_lshlrev_b32 v126, 5, v126
main_kernel_ovf_cnt:
    buffer_load_dword v127, v126, s[60:63], 0 offen sc1
    s_waitcnt vmcnt(0)
    v_readlane_b32 s48, v127, 0
    v_readlane_b32 s49, v127, 1
    v_readlane_b32 s50, v127, 2
    v_readlane_b32 s51, v127, 3
    v_readlane_b32 s52, v127, 4
    v_readlane_b32 s53, v127, 5
    v_readlane_b32 s54, v127, 6
    v_readlane_b32 s55, v127, 7
    s_nop 3
    s_add_u32 s33, s48, s49
    s_add_u32 s33, s33, s50
    s_add_u32 s33, s33, s51
    s_add_u32 s33, s33, s52
    s_add_u32 s33, s33, s53
    s_add_u32 s33, s33, s54
    s_add_u32 s33, s33, s55
    s_cmp_ge_u32 s33, 256
    s_cbranch_scc1 main_kernel_ovf_cnt_ok
    s_sub_u32 s29, s29, 1
    s_cbranch_scc1 main_kernel_end
    s_sleep 4
    s_branch main_kernel_ovf_cnt
main_kernel_ovf_cnt_ok:
    v_mov_b32 v126, 0
    v_mov_b32 v127, 1
    s_mov_b64 exec, 1
    buffer_atomic_add v127, v126, s[60:63], 0 offen offset:8 sc0 sc1
    s_waitcnt vmcnt(0)
    s_mov_b64 exec, -1
    v_readfirstlane_b32 s33, v127
    s_nop 3
    s_min_u32 s34, s48, 32
    s_sub_u32 s35, 32, s34
    s_mov_b32 s12, 0
    s_add_u32 s13, s34, s33
    s_cmp_lt_u32 s33, s35
    s_cbranch_scc1 main_kernel_slot_pub
    s_sub_u32 s33, s33, s35
    s_min_u32 s34, s49, 32
    s_sub_u32 s35, 32, s34
    s_mov_b32 s12, 1
    s_add_u32 s13, s34, s33
    s_cmp_lt_u32 s33, s35
    s_cbranch_scc1 main_kernel_slot_pub
    s_sub_u32 s33, s33, s35
    s_min_u32 s34, s50, 32
    s_sub_u32 s35, 32, s34
    s_mov_b32 s12, 2
    s_add_u32 s13, s34, s33
    s_cmp_lt_u32 s33, s35
    s_cbranch_scc1 main_kernel_slot_pub
    s_sub_u32 s33, s33, s35
    s_min_u32 s34, s51, 32
    s_sub_u32 s35, 32, s34
    s_mov_b32 s12, 3
    s_add_u32 s13, s34, s33
    s_cmp_lt_u32 s33, s35
    s_cbranch_scc1 main_kernel_slot_pub
    s_sub_u32 s33, s33, s35
    s_min_u32 s34, s52, 32
    s_sub_u32 s35, 32, s34
    s_mov_b32 s12, 4
    s_add_u32 s13, s34, s33
    s_cmp_lt_u32 s33, s35
    s_cbranch_scc1 main_kernel_slot_pub
    s_sub_u32 s33, s33, s35
    s_min_u32 s34, s53, 32
    s_sub_u32 s35, 32, s34
    s_mov_b32 s12, 5
    s_add_u32 s13, s34, s33
    s_cmp_lt_u32 s33, s35
    s_cbranch_scc1 main_kernel_slot_pub
    s_sub_u32 s33, s33, s35
    s_min_u32 s34, s54, 32
    s_sub_u32 s35, 32, s34
    s_mov_b32 s12, 6
    s_add_u32 s13, s34, s33
    s_cmp_lt_u32 s33, s35
    s_cbranch_scc1 main_kernel_slot_pub
    s_sub_u32 s33, s33, s35
    s_min_u32 s34, s55, 32
    s_sub_u32 s35, 32, s34
    s_mov_b32 s12, 7
    s_add_u32 s13, s34, s33
    s_cmp_lt_u32 s33, s35
    s_cbranch_scc1 main_kernel_slot_pub
    s_sub_u32 s33, s33, s35
    s_mov_b32 s12, 8
    s_mov_b32 s13, 0
main_kernel_slot_pub:
    v_mov_b32 v126, 0
    v_mov_b32 v127, s12
    v_mov_b32 v95, s13
    ds_write_b32 v126, v127
    ds_write_b32 v126, v95 offset:4
    s_waitcnt lgkmcnt(0)
main_kernel_slot_wait:
    s_barrier
    v_mov_b32 v126, 0
    ds_read_b32 v127, v126
    ds_read_b32 v95, v126 offset:4
    s_waitcnt lgkmcnt(0)
    v_readfirstlane_b32 s12, v127
    v_readfirstlane_b32 s13, v95
    s_nop 3
    s_barrier
    s_cmp_ge_u32 s12, 8
    s_cbranch_scc1 main_kernel_end
    s_cmp_lt_u32 s12, 2
    s_cbranch_scc1 main_kernel_chain
    s_mov_b32 s96, s72
    s_and_b32 s97, s73, 0xffff
    s_mov_b32 s98, 0x400000
    s_mov_b32 s99, 0x20000
    s_mov_b32 s92, s74
    s_and_b32 s93, s75, 0xffff
    s_mov_b32 s94, 0x400000
    s_mov_b32 s95, 0x20000
    v_lshlrev_b32 v1, 4, v0
    v_lshlrev_b32 v251, 4, v250
    v_mov_b32 v4, 0
    v_mov_b32 v8, -1
    v_mov_b32 v5, 0
    v_mov_b32 v9, -1
    v_mov_b32 v6, 0
    v_mov_b32 v10, -1
    v_mov_b32 v7, 0
    v_mov_b32 v11, -1
    v_mul_u32_u24 v12, 128, v0
    s_lshl_b32 s15, s12, 4
    s_and_b32 s32, s12, 1
    s_lshl_b32 s32, s32, 5
    s_cmp_lt_u32 s12, 4
    s_cselect_b32 s15, s32, s15
    s_cselect_b32 s32, 32, 16
    s_add_u32 s15, s15, s13
    s_sub_u32 s16, s15, 80
    s_sub_u32 s27, s12, 2
    s_mov_b32 s52, 0
    s_cmp_lt_u32 s13, s32
    s_cbranch_scc1 main_kernel_s_ln
    s_cmp_lg_u32 s13, 16
    s_cbranch_scc1 main_kernel_s_fill
    s_lshl_b32 s32, s16, 11
    s_add_u32 s32, s32, 0x8400000
    buffer_store_dwordx4 v[4:7], v1, s[4:7], s32 offen sc1
    s_add_u32 s32, s32, 4096
    buffer_store_dwordx4 v[4:7], v1, s[4:7], s32 offen sc1
    s_add_u32 s32, s32, 4096
    buffer_store_dwordx4 v[4:7], v1, s[4:7], s32 offen sc1
    s_add_u32 s32, s32, 4096
    buffer_store_dwordx4 v[4:7], v1, s[4:7], s32 offen sc1
    s_add_u32 s32, s32, 4096
    buffer_store_dwordx4 v[4:7], v1, s[4:7], s32 offen sc1
    s_add_u32 s32, s32, 4096
    buffer_store_dwordx4 v[4:7], v1, s[4:7], s32 offen sc1
    s_add_u32 s32, s32, 4096
    buffer_store_dwordx4 v[4:7], v1, s[4:7], s32 offen sc1
    s_add_u32 s32, s32, 4096
    buffer_store_dwordx4 v[4:7], v1, s[4:7], s32 offen sc1
    s_add_u32 s32, s32, 4096
    v_bfe_u32 v2, v0, 2, 1
    s_lshr_b32 s32, s14, 1
    v_and_b32 v2, s32, v2
    s_bitcmp1_b32 s14, 0
    s_cselect_b32 s32, 15, 0
    s_cselect_b32 s33, 4161536, 0
    v_xor_b32 v2, s32, v2
    v_lshlrev_b32 v2, 4, v2
    v_and_b32 v3, 3, v0
    v_lshl_add_u32 v2, v3, 8, v2
    v_lshrrev_b32 v3, 3, v0
    v_lshl_add_u32 v2, v3, 10, v2
    s_add_u32 s33, s33, 0x4808000
    buffer_store_dwordx4 v[4:7], v2, s[4:7], s33 offen sc1
    s_waitcnt vmcnt(0)
    s_barrier
    s_cmp_lg_u32 s14, 0
    s_cbranch_scc1 main_kernel_s_fill
    v_mov_b32 v2, 1
    s_mov_b64 exec, 1
    buffer_atomic_add v2, v4, s[60:63], 0 offen offset:12 sc1
    s_mov_b64 exec, -1
    s_branch main_kernel_s_fill
main_kernel_s_ln:
    v_and_b32 v3, 15, v250
    v_and_b32 v2, 48, v250
    v_lshl_add_u32 v3, v3, 11, v2
    s_lshl_b32 s34, s15, 15
    s_lshl_b32 s32, s14, 9
    s_add_u32 s32, s34, s32
    buffer_load_dwordx4 v[32:35], v3, s[96:99], s32 offen offset:0
    buffer_load_dwordx4 v[36:39], v3, s[96:99], s32 offen offset:64
    buffer_load_dwordx4 v[40:43], v3, s[96:99], s32 offen offset:128
    buffer_load_dwordx4 v[44:47], v3, s[96:99], s32 offen offset:192
    buffer_load_dwordx4 v[48:51], v3, s[96:99], s32 offen offset:256
    buffer_load_dwordx4 v[52:55], v3, s[96:99], s32 offen offset:320
    buffer_load_dwordx4 v[56:59], v3, s[96:99], s32 offen offset:384
    buffer_load_dwordx4 v[60:63], v3, s[96:99], s32 offen offset:448
    v_and_b32 v255, 15, v250
    v_lshlrev_b32 v254, 6, v255
    v_add_u32 v254, 132096, v254
    v_lshrrev_b32 v255, 4, v250
    v_lshl_add_u32 v253, v255, 2, v254
    v_lshl_add_u32 v253, s14, 4, v253
    s_lshl_b32 s32, s14, 13
    s_add_u32 s34, s34, s32
    s_waitcnt vmcnt(0)
    v_permlane16_swap_b32 v32, v34
    v_permlane16_swap_b32 v33, v35
    v_permlane16_swap_b32 v36, v38
    v_permlane16_swap_b32 v37, v39
    v_permlane16_swap_b32 v40, v42
    v_permlane16_swap_b32 v41, v43
    v_permlane16_swap_b32 v44, v46
    v_permlane16_swap_b32 v45, v47
    v_permlane16_swap_b32 v48, v50
    v_permlane16_swap_b32 v49, v51
    v_permlane16_swap_b32 v52, v54
    v_permlane16_swap_b32 v53, v55
    v_permlane16_swap_b32 v56, v58
    v_permlane16_swap_b32 v57, v59
    v_permlane16_swap_b32 v60, v62
    v_permlane16_swap_b32 v61, v63
    v_permlane32_swap_b32 v32, v34
    v_permlane32_swap_b32 v33, v35
    v_permlane32_swap_b32 v36, v38
    v_permlane32_swap_b32 v37, v39
    v_permlane32_swap_b32 v40, v42
    v_permlane32_swap_b32 v41, v43
    v_permlane32_swap_b32 v44, v46
    v_permlane32_swap_b32 v45, v47
    v_permlane32_swap_b32 v48, v50
    v_permlane32_swap_b32 v49, v51
    v_permlane32_swap_b32 v52, v54
    v_permlane32_swap_b32 v53, v55
    v_permlane32_swap_b32 v56, v58
    v_permlane32_swap_b32 v57, v59
    v_permlane32_swap_b32 v60, v62
    v_permlane32_swap_b32 v61, v63
    s_lshr_b32 s32, s15, 3
    s_lshl_b32 s32, s32, 9
    s_and_b32 s33, s15, 7
    s_lshl_b32 s33, s33, 4
    s_add_u32 s32, s32, s33
    s_add_u32 s16, s32, 0x8416000
    v_lshlrev_b32 v64, 16, v32
    v_and_b32 v65, 0xffff0000, v32
    v_lshlrev_b32 v66, 16, v33
    v_and_b32 v67, 0xffff0000, v33
    v_lshlrev_b32 v68, 16, v34
    v_and_b32 v69, 0xffff0000, v34
    v_lshlrev_b32 v70, 16, v35
    v_and_b32 v71, 0xffff0000, v35
    v_lshlrev_b32 v72, 16, v36
    v_and_b32 v73, 0xffff0000, v36
    v_lshlrev_b32 v74, 16, v37
    v_and_b32 v75, 0xffff0000, v37
    v_lshlrev_b32 v76, 16, v38
    v_and_b32 v77, 0xffff0000, v38
    v_lshlrev_b32 v78, 16, v39
    v_and_b32 v79, 0xffff0000, v39
    v_lshlrev_b32 v80, 16, v40
    v_and_b32 v81, 0xffff0000, v40
    v_lshlrev_b32 v82, 16, v41
    v_and_b32 v83, 0xffff0000, v41
    v_lshlrev_b32 v84, 16, v42
    v_and_b32 v85, 0xffff0000, v42
    v_lshlrev_b32 v86, 16, v43
    v_and_b32 v87, 0xffff0000, v43
    v_lshlrev_b32 v88, 16, v44
    v_and_b32 v89, 0xffff0000, v44
    v_lshlrev_b32 v90, 16, v45
    v_and_b32 v91, 0xffff0000, v45
    v_lshlrev_b32 v92, 16, v46
    v_and_b32 v93, 0xffff0000, v46
    v_lshlrev_b32 v94, 16, v47
    v_and_b32 v95, 0xffff0000, v47
    v_lshlrev_b32 v96, 16, v48
    v_and_b32 v97, 0xffff0000, v48
    v_lshlrev_b32 v98, 16, v49
    v_and_b32 v99, 0xffff0000, v49
    v_lshlrev_b32 v100, 16, v50
    v_and_b32 v101, 0xffff0000, v50
    v_lshlrev_b32 v102, 16, v51
    v_and_b32 v103, 0xffff0000, v51
    v_lshlrev_b32 v104, 16, v52
    v_and_b32 v105, 0xffff0000, v52
    v_lshlrev_b32 v106, 16, v53
    v_and_b32 v107, 0xffff0000, v53
    v_lshlrev_b32 v108, 16, v54
    v_and_b32 v109, 0xffff0000, v54
    v_lshlrev_b32 v110, 16, v55
    v_and_b32 v111, 0xffff0000, v55
    v_lshlrev_b32 v112, 16, v56
    v_and_b32 v113, 0xffff0000, v56
    v_lshlrev_b32 v114, 16, v57
    v_and_b32 v115, 0xffff0000, v57
    v_lshlrev_b32 v116, 16, v58
    v_and_b32 v117, 0xffff0000, v58
    v_lshlrev_b32 v118, 16, v59
    v_and_b32 v119, 0xffff0000, v59
    v_lshlrev_b32 v120, 16, v60
    v_and_b32 v121, 0xffff0000, v60
    v_lshlrev_b32 v122, 16, v61
    v_and_b32 v123, 0xffff0000, v61
    v_lshlrev_b32 v124, 16, v62
    v_and_b32 v125, 0xffff0000, v62
    v_lshlrev_b32 v126, 16, v63
    v_and_b32 v127, 0xffff0000, v63
    v_pk_add_f32 v[16:17], v[64:65], v[72:73]
    v_pk_add_f32 v[18:19], v[66:67], v[74:75]
    v_pk_add_f32 v[20:21], v[68:69], v[76:77]
    v_pk_add_f32 v[22:23], v[70:71], v[78:79]
    v_pk_add_f32 v[16:17], v[16:17], v[80:81]
    v_pk_add_f32 v[18:19], v[18:19], v[82:83]
    v_pk_add_f32 v[20:21], v[20:21], v[84:85]
    v_pk_add_f32 v[22:23], v[22:23], v[86:87]
    v_pk_add_f32 v[16:17], v[16:17], v[88:89]
    v_pk_add_f32 v[18:19], v[18:19], v[90:91]
    v_pk_add_f32 v[20:21], v[20:21], v[92:93]
    v_pk_add_f32 v[22:23], v[22:23], v[94:95]
    v_pk_add_f32 v[16:17], v[16:17], v[96:97]
    v_pk_add_f32 v[18:19], v[18:19], v[98:99]
    v_pk_add_f32 v[20:21], v[20:21], v[100:101]
    v_pk_add_f32 v[22:23], v[22:23], v[102:103]
    v_pk_add_f32 v[16:17], v[16:17], v[104:105]
    v_pk_add_f32 v[18:19], v[18:19], v[106:107]
    v_pk_add_f32 v[20:21], v[20:21], v[108:109]
    v_pk_add_f32 v[22:23], v[22:23], v[110:111]
    v_pk_add_f32 v[16:17], v[16:17], v[112:113]
    v_pk_add_f32 v[18:19], v[18:19], v[114:115]
    v_pk_add_f32 v[20:21], v[20:21], v[116:117]
    v_pk_add_f32 v[22:23], v[22:23], v[118:119]
    v_pk_add_f32 v[16:17], v[16:17], v[120:121]
    v_pk_add_f32 v[18:19], v[18:19], v[122:123]
    v_pk_add_f32 v[20:21], v[20:21], v[124:125]
    v_pk_add_f32 v[22:23], v[22:23], v[126:127]
    v_pk_add_f32 v[16:17], v[16:17], v[18:19]
    v_pk_add_f32 v[20:21], v[20:21], v[22:23]
    v_pk_add_f32 v[16:17], v[16:17], v[20:21]
    v_add_f32 v16, v16, v17
    ds_write_b32 v253, v16 offset:0
    s_waitcnt lgkmcnt(0)
    s_barrier
    ds_read_b128 v[16:19], v254 offset:0
    ds_read_b128 v[20:23], v254 offset:16
    ds_read_b128 v[24:27], v254 offset:32
    ds_read_b128 v[28:31], v254 offset:48
    s_waitcnt lgkmcnt(2)
    v_pk_add_f32 v[16:17], v[16:17], v[18:19]
    v_pk_add_f32 v[20:21], v[20:21], v[22:23]
    s_waitcnt lgkmcnt(0)
    v_pk_add_f32 v[24:25], v[24:25], v[26:27]
    v_pk_add_f32 v[28:29], v[28:29], v[30:31]
    v_pk_add_f32 v[16:17], v[16:17], v[20:21]
    v_pk_add_f32 v[24:25], v[24:25], v[28:29]
    v_pk_add_f32 v[16:17], v[16:17], v[24:25]
    v_add_f32 v16, v16, v17
    v_mul_f32 v16, 0xba800000, v16
    v_mov_b32 v17, v16
    v_pk_add_f32 v[64:65], v[64:65], v[16:17]
    v_pk_add_f32 v[66:67], v[66:67], v[16:17]
    v_pk_add_f32 v[68:69], v[68:69], v[16:17]
    v_pk_add_f32 v[70:71], v[70:71], v[16:17]
    v_pk_add_f32 v[72:73], v[72:73], v[16:17]
    v_pk_add_f32 v[74:75], v[74:75], v[16:17]
    v_pk_add_f32 v[76:77], v[76:77], v[16:17]
    v_pk_add_f32 v[78:79], v[78:79], v[16:17]
    v_pk_add_f32 v[80:81], v[80:81], v[16:17]
    v_pk_add_f32 v[82:83], v[82:83], v[16:17]
    v_pk_add_f32 v[84:85], v[84:85], v[16:17]
    v_pk_add_f32 v[86:87], v[86:87], v[16:17]
    v_pk_add_f32 v[88:89], v[88:89], v[16:17]
    v_pk_add_f32 v[90:91], v[90:91], v[16:17]
    v_pk_add_f32 v[92:93], v[92:93], v[16:17]
    v_pk_add_f32 v[94:95], v[94:95], v[16:17]
    v_pk_add_f32 v[96:97], v[96:97], v[16:17]
    v_pk_add_f32 v[98:99], v[98:99], v[16:17]
    v_pk_add_f32 v[100:101], v[100:101], v[16:17]
    v_pk_add_f32 v[102:103], v[102:103], v[16:17]
    v_pk_add_f32 v[104:105], v[104:105], v[16:17]
    v_pk_add_f32 v[106:107], v[106:107], v[16:17]
    v_pk_add_f32 v[108:109], v[108:109], v[16:17]
    v_pk_add_f32 v[110:111], v[110:111], v[16:17]
    v_pk_add_f32 v[112:113], v[112:113], v[16:17]
    v_pk_add_f32 v[114:115], v[114:115], v[16:17]
    v_pk_add_f32 v[116:117], v[116:117], v[16:17]
    v_pk_add_f32 v[118:119], v[118:119], v[16:17]
    v_pk_add_f32 v[120:121], v[120:121], v[16:17]
    v_pk_add_f32 v[122:123], v[122:123], v[16:17]
    v_pk_add_f32 v[124:125], v[124:125], v[16:17]
    v_pk_add_f32 v[126:127], v[126:127], v[16:17]
    v_pk_mul_f32 v[16:17], v[64:65], v[64:65]
    v_pk_mul_f32 v[18:19], v[66:67], v[66:67]
    v_pk_mul_f32 v[20:21], v[68:69], v[68:69]
    v_pk_mul_f32 v[22:23], v[70:71], v[70:71]
    v_pk_fma_f32 v[16:17], v[72:73], v[72:73], v[16:17]
    v_pk_fma_f32 v[18:19], v[74:75], v[74:75], v[18:19]
    v_pk_fma_f32 v[20:21], v[76:77], v[76:77], v[20:21]
    v_pk_fma_f32 v[22:23], v[78:79], v[78:79], v[22:23]
    v_pk_fma_f32 v[16:17], v[80:81], v[80:81], v[16:17]
    v_pk_fma_f32 v[18:19], v[82:83], v[82:83], v[18:19]
    v_pk_fma_f32 v[20:21], v[84:85], v[84:85], v[20:21]
    v_pk_fma_f32 v[22:23], v[86:87], v[86:87], v[22:23]
    v_pk_fma_f32 v[16:17], v[88:89], v[88:89], v[16:17]
    v_pk_fma_f32 v[18:19], v[90:91], v[90:91], v[18:19]
    v_pk_fma_f32 v[20:21], v[92:93], v[92:93], v[20:21]
    v_pk_fma_f32 v[22:23], v[94:95], v[94:95], v[22:23]
    v_pk_fma_f32 v[16:17], v[96:97], v[96:97], v[16:17]
    v_pk_fma_f32 v[18:19], v[98:99], v[98:99], v[18:19]
    v_pk_fma_f32 v[20:21], v[100:101], v[100:101], v[20:21]
    v_pk_fma_f32 v[22:23], v[102:103], v[102:103], v[22:23]
    v_pk_fma_f32 v[16:17], v[104:105], v[104:105], v[16:17]
    v_pk_fma_f32 v[18:19], v[106:107], v[106:107], v[18:19]
    v_pk_fma_f32 v[20:21], v[108:109], v[108:109], v[20:21]
    v_pk_fma_f32 v[22:23], v[110:111], v[110:111], v[22:23]
    v_pk_fma_f32 v[16:17], v[112:113], v[112:113], v[16:17]
    v_pk_fma_f32 v[18:19], v[114:115], v[114:115], v[18:19]
    v_pk_fma_f32 v[20:21], v[116:117], v[116:117], v[20:21]
    v_pk_fma_f32 v[22:23], v[118:119], v[118:119], v[22:23]
    v_pk_fma_f32 v[16:17], v[120:121], v[120:121], v[16:17]
    v_pk_fma_f32 v[18:19], v[122:123], v[122:123], v[18:19]
    v_pk_fma_f32 v[20:21], v[124:125], v[124:125], v[20:21]
    v_pk_fma_f32 v[22:23], v[126:127], v[126:127], v[22:23]
    v_pk_add_f32 v[16:17], v[16:17], v[18:19]
    v_pk_add_f32 v[20:21], v[20:21], v[22:23]
    v_pk_add_f32 v[16:17], v[16:17], v[20:21]
    v_add_f32 v16, v16, v17
    ds_write_b32 v253, v16 offset:1024
    s_waitcnt lgkmcnt(0)
    s_barrier
    ds_read_b128 v[16:19], v254 offset:1024
    ds_read_b128 v[20:23], v254 offset:1040
    ds_read_b128 v[24:27], v254 offset:1056
    ds_read_b128 v[28:31], v254 offset:1072
    s_waitcnt lgkmcnt(2)
    v_pk_add_f32 v[16:17], v[16:17], v[18:19]
    v_pk_add_f32 v[20:21], v[20:21], v[22:23]
    s_waitcnt lgkmcnt(0)
    v_pk_add_f32 v[24:25], v[24:25], v[26:27]
    v_pk_add_f32 v[28:29], v[28:29], v[30:31]
    v_pk_add_f32 v[16:17], v[16:17], v[20:21]
    v_pk_add_f32 v[24:25], v[24:25], v[28:29]
    v_pk_add_f32 v[16:17], v[16:17], v[24:25]
    v_add_f32 v16, v16, v17
    v_mov_b32 v17, 0x3727c5ac
    v_fmac_f32 v17, 0x3a800000, v16
    v_rsq_f32 v16, v17
    s_nop 0
    v_mov_b32 v17, v16
    v_pk_mul_f32 v[64:65], v[64:65], v[16:17]
    v_pk_mul_f32 v[66:67], v[66:67], v[16:17]
    v_pk_mul_f32 v[68:69], v[68:69], v[16:17]
    v_pk_mul_f32 v[70:71], v[70:71], v[16:17]
    v_pk_mul_f32 v[72:73], v[72:73], v[16:17]
    v_pk_mul_f32 v[74:75], v[74:75], v[16:17]
    v_pk_mul_f32 v[76:77], v[76:77], v[16:17]
    v_pk_mul_f32 v[78:79], v[78:79], v[16:17]
    v_pk_mul_f32 v[80:81], v[80:81], v[16:17]
    v_pk_mul_f32 v[82:83], v[82:83], v[16:17]
    v_pk_mul_f32 v[84:85], v[84:85], v[16:17]
    v_pk_mul_f32 v[86:87], v[86:87], v[16:17]
    v_pk_mul_f32 v[88:89], v[88:89], v[16:17]
    v_pk_mul_f32 v[90:91], v[90:91], v[16:17]
    v_pk_mul_f32 v[92:93], v[92:93], v[16:17]
    v_pk_mul_f32 v[94:95], v[94:95], v[16:17]
    v_pk_mul_f32 v[96:97], v[96:97], v[16:17]
    v_pk_mul_f32 v[98:99], v[98:99], v[16:17]
    v_pk_mul_f32 v[100:101], v[100:101], v[16:17]
    v_pk_mul_f32 v[102:103], v[102:103], v[16:17]
    v_pk_mul_f32 v[104:105], v[104:105], v[16:17]
    v_pk_mul_f32 v[106:107], v[106:107], v[16:17]
    v_pk_mul_f32 v[108:109], v[108:109], v[16:17]
    v_pk_mul_f32 v[110:111], v[110:111], v[16:17]
    v_pk_mul_f32 v[112:113], v[112:113], v[16:17]
    v_pk_mul_f32 v[114:115], v[114:115], v[16:17]
    v_pk_mul_f32 v[116:117], v[116:117], v[16:17]
    v_pk_mul_f32 v[118:119], v[118:119], v[16:17]
    v_pk_mul_f32 v[120:121], v[120:121], v[16:17]
    v_pk_mul_f32 v[122:123], v[122:123], v[16:17]
    v_pk_mul_f32 v[124:125], v[124:125], v[16:17]
    v_pk_mul_f32 v[126:127], v[126:127], v[16:17]
    v_cvt_pk_bf16_f32 v128, v64, v65
    v_cvt_pk_bf16_f32 v129, v66, v67
    v_cvt_pk_bf16_f32 v130, v68, v69
    v_cvt_pk_bf16_f32 v131, v70, v71
    v_cvt_pk_bf16_f32 v132, v72, v73
    v_cvt_pk_bf16_f32 v133, v74, v75
    v_cvt_pk_bf16_f32 v134, v76, v77
    v_cvt_pk_bf16_f32 v135, v78, v79
    v_cvt_pk_bf16_f32 v136, v80, v81
    v_cvt_pk_bf16_f32 v137, v82, v83
    v_cvt_pk_bf16_f32 v138, v84, v85
    v_cvt_pk_bf16_f32 v139, v86, v87
    v_cvt_pk_bf16_f32 v140, v88, v89
    v_cvt_pk_bf16_f32 v141, v90, v91
    v_cvt_pk_bf16_f32 v142, v92, v93
    v_cvt_pk_bf16_f32 v143, v94, v95
    v_cvt_pk_bf16_f32 v144, v96, v97
    v_cvt_pk_bf16_f32 v145, v98, v99
    v_cvt_pk_bf16_f32 v146, v100, v101
    v_cvt_pk_bf16_f32 v147, v102, v103
    v_cvt_pk_bf16_f32 v148, v104, v105
    v_cvt_pk_bf16_f32 v149, v106, v107
    v_cvt_pk_bf16_f32 v150, v108, v109
    v_cvt_pk_bf16_f32 v151, v110, v111
    v_cvt_pk_bf16_f32 v152, v112, v113
    v_cvt_pk_bf16_f32 v153, v114, v115
    v_cvt_pk_bf16_f32 v154, v116, v117
    v_cvt_pk_bf16_f32 v155, v118, v119
    v_cvt_pk_bf16_f32 v156, v120, v121
    v_cvt_pk_bf16_f32 v157, v122, v123
    v_cvt_pk_bf16_f32 v158, v124, v125
    v_cvt_pk_bf16_f32 v159, v126, v127
    s_add_u32 s32, s34, 0x0
    s_add_u32 s33, s32, 4096
    buffer_store_dwordx4 v[128:131], v251, s[4:7], s32 offen offset:0 sc1
    buffer_store_dwordx4 v[132:135], v251, s[4:7], s32 offen offset:1024 sc1
    buffer_store_dwordx4 v[136:139], v251, s[4:7], s32 offen offset:2048 sc1
    buffer_store_dwordx4 v[140:143], v251, s[4:7], s32 offen offset:3072 sc1
    buffer_store_dwordx4 v[144:147], v251, s[4:7], s33 offen offset:0 sc1
    buffer_store_dwordx4 v[148:151], v251, s[4:7], s33 offen offset:1024 sc1
    buffer_store_dwordx4 v[152:155], v251, s[4:7], s33 offen offset:2048 sc1
    buffer_store_dwordx4 v[156:159], v251, s[4:7], s33 offen offset:3072 sc1
    buffer_load_dword v2, v4, s[60:63], 0 offen offset:12 sc1
    v_lshlrev_b32 v64, 16, v128
    v_and_b32 v65, 0xffff0000, v128
    v_lshlrev_b32 v66, 16, v129
    v_and_b32 v67, 0xffff0000, v129
    v_lshlrev_b32 v68, 16, v130
    v_and_b32 v69, 0xffff0000, v130
    v_lshlrev_b32 v70, 16, v131
    v_and_b32 v71, 0xffff0000, v131
    v_lshlrev_b32 v72, 16, v132
    v_and_b32 v73, 0xffff0000, v132
    v_lshlrev_b32 v74, 16, v133
    v_and_b32 v75, 0xffff0000, v133
    v_lshlrev_b32 v76, 16, v134
    v_and_b32 v77, 0xffff0000, v134
    v_lshlrev_b32 v78, 16, v135
    v_and_b32 v79, 0xffff0000, v135
    v_lshlrev_b32 v80, 16, v136
    v_and_b32 v81, 0xffff0000, v136
    v_lshlrev_b32 v82, 16, v137
    v_and_b32 v83, 0xffff0000, v137
    v_lshlrev_b32 v84, 16, v138
    v_and_b32 v85, 0xffff0000, v138
    v_lshlrev_b32 v86, 16, v139
    v_and_b32 v87, 0xffff0000, v139
    v_lshlrev_b32 v88, 16, v140
    v_and_b32 v89, 0xffff0000, v140
    v_lshlrev_b32 v90, 16, v141
    v_and_b32 v91, 0xffff0000, v141
    v_lshlrev_b32 v92, 16, v142
    v_and_b32 v93, 0xffff0000, v142
    v_lshlrev_b32 v94, 16, v143
    v_and_b32 v95, 0xffff0000, v143
    v_lshlrev_b32 v96, 16, v144
    v_and_b32 v97, 0xffff0000, v144
    v_lshlrev_b32 v98, 16, v145
    v_and_b32 v99, 0xffff0000, v145
    v_lshlrev_b32 v100, 16, v146
    v_and_b32 v101, 0xffff0000, v146
    v_lshlrev_b32 v102, 16, v147
    v_and_b32 v103, 0xffff0000, v147
    v_lshlrev_b32 v104, 16, v148
    v_and_b32 v105, 0xffff0000, v148
    v_lshlrev_b32 v106, 16, v149
    v_and_b32 v107, 0xffff0000, v149
    v_lshlrev_b32 v108, 16, v150
    v_and_b32 v109, 0xffff0000, v150
    v_lshlrev_b32 v110, 16, v151
    v_and_b32 v111, 0xffff0000, v151
    v_lshlrev_b32 v112, 16, v152
    v_and_b32 v113, 0xffff0000, v152
    v_lshlrev_b32 v114, 16, v153
    v_and_b32 v115, 0xffff0000, v153
    v_lshlrev_b32 v116, 16, v154
    v_and_b32 v117, 0xffff0000, v154
    v_lshlrev_b32 v118, 16, v155
    v_and_b32 v119, 0xffff0000, v155
    v_lshlrev_b32 v120, 16, v156
    v_and_b32 v121, 0xffff0000, v156
    v_lshlrev_b32 v122, 16, v157
    v_and_b32 v123, 0xffff0000, v157
    v_lshlrev_b32 v124, 16, v158
    v_and_b32 v125, 0xffff0000, v158
    v_lshlrev_b32 v126, 16, v159
    v_and_b32 v127, 0xffff0000, v159
    v_pk_add_f32 v[16:17], v[64:65], v[72:73]
    v_pk_add_f32 v[18:19], v[66:67], v[74:75]
    v_pk_add_f32 v[20:21], v[68:69], v[76:77]
    v_pk_add_f32 v[22:23], v[70:71], v[78:79]
    v_pk_add_f32 v[16:17], v[16:17], v[80:81]
    v_pk_add_f32 v[18:19], v[18:19], v[82:83]
    v_pk_add_f32 v[20:21], v[20:21], v[84:85]
    v_pk_add_f32 v[22:23], v[22:23], v[86:87]
    v_pk_add_f32 v[16:17], v[16:17], v[88:89]
    v_pk_add_f32 v[18:19], v[18:19], v[90:91]
    v_pk_add_f32 v[20:21], v[20:21], v[92:93]
    v_pk_add_f32 v[22:23], v[22:23], v[94:95]
    v_pk_add_f32 v[16:17], v[16:17], v[96:97]
    v_pk_add_f32 v[18:19], v[18:19], v[98:99]
    v_pk_add_f32 v[20:21], v[20:21], v[100:101]
    v_pk_add_f32 v[22:23], v[22:23], v[102:103]
    v_pk_add_f32 v[16:17], v[16:17], v[104:105]
    v_pk_add_f32 v[18:19], v[18:19], v[106:107]
    v_pk_add_f32 v[20:21], v[20:21], v[108:109]
    v_pk_add_f32 v[22:23], v[22:23], v[110:111]
    v_pk_add_f32 v[16:17], v[16:17], v[112:113]
    v_pk_add_f32 v[18:19], v[18:19], v[114:115]
    v_pk_add_f32 v[20:21], v[20:21], v[116:117]
    v_pk_add_f32 v[22:23], v[22:23], v[118:119]
    v_pk_add_f32 v[16:17], v[16:17], v[120:121]
    v_pk_add_f32 v[18:19], v[18:19], v[122:123]
    v_pk_add_f32 v[20:21], v[20:21], v[124:125]
    v_pk_add_f32 v[22:23], v[22:23], v[126:127]
    v_pk_add_f32 v[16:17], v[16:17], v[18:19]
    v_pk_add_f32 v[20:21], v[20:21], v[22:23]
    v_pk_add_f32 v[16:17], v[16:17], v[20:21]
    v_add_f32 v16, v16, v17
    ds_write_b32 v253, v16 offset:0
    s_waitcnt lgkmcnt(0)
    s_barrier
    ds_read_b128 v[16:19], v254 offset:0
    ds_read_b128 v[20:23], v254 offset:16
    ds_read_b128 v[24:27], v254 offset:32
    ds_read_b128 v[28:31], v254 offset:48
    s_waitcnt lgkmcnt(2)
    v_pk_add_f32 v[16:17], v[16:17], v[18:19]
    v_pk_add_f32 v[20:21], v[20:21], v[22:23]
    s_waitcnt lgkmcnt(0)
    v_pk_add_f32 v[24:25], v[24:25], v[26:27]
    v_pk_add_f32 v[28:29], v[28:29], v[30:31]
    v_pk_add_f32 v[16:17], v[16:17], v[20:21]
    v_pk_add_f32 v[24:25], v[24:25], v[28:29]
    v_pk_add_f32 v[16:17], v[16:17], v[24:25]
    v_add_f32 v16, v16, v17
    v_mul_f32 v16, 0xba800000, v16
    v_mov_b32 v17, v16
    v_pk_add_f32 v[64:65], v[64:65], v[16:17]
    v_pk_add_f32 v[66:67], v[66:67], v[16:17]
    v_pk_add_f32 v[68:69], v[68:69], v[16:17]
    v_pk_add_f32 v[70:71], v[70:71], v[16:17]
    v_pk_add_f32 v[72:73], v[72:73], v[16:17]
    v_pk_add_f32 v[74:75], v[74:75], v[16:17]
    v_pk_add_f32 v[76:77], v[76:77], v[16:17]
    v_pk_add_f32 v[78:79], v[78:79], v[16:17]
    v_pk_add_f32 v[80:81], v[80:81], v[16:17]
    v_pk_add_f32 v[82:83], v[82:83], v[16:17]
    v_pk_add_f32 v[84:85], v[84:85], v[16:17]
    v_pk_add_f32 v[86:87], v[86:87], v[16:17]
    v_pk_add_f32 v[88:89], v[88:89], v[16:17]
    v_pk_add_f32 v[90:91], v[90:91], v[16:17]
    v_pk_add_f32 v[92:93], v[92:93], v[16:17]
    v_pk_add_f32 v[94:95], v[94:95], v[16:17]
    v_pk_add_f32 v[96:97], v[96:97], v[16:17]
    v_pk_add_f32 v[98:99], v[98:99], v[16:17]
    v_pk_add_f32 v[100:101], v[100:101], v[16:17]
    v_pk_add_f32 v[102:103], v[102:103], v[16:17]
    v_pk_add_f32 v[104:105], v[104:105], v[16:17]
    v_pk_add_f32 v[106:107], v[106:107], v[16:17]
    v_pk_add_f32 v[108:109], v[108:109], v[16:17]
    v_pk_add_f32 v[110:111], v[110:111], v[16:17]
    v_pk_add_f32 v[112:113], v[112:113], v[16:17]
    v_pk_add_f32 v[114:115], v[114:115], v[16:17]
    v_pk_add_f32 v[116:117], v[116:117], v[16:17]
    v_pk_add_f32 v[118:119], v[118:119], v[16:17]
    v_pk_add_f32 v[120:121], v[120:121], v[16:17]
    v_pk_add_f32 v[122:123], v[122:123], v[16:17]
    v_pk_add_f32 v[124:125], v[124:125], v[16:17]
    v_pk_add_f32 v[126:127], v[126:127], v[16:17]
    v_pk_mul_f32 v[16:17], v[64:65], v[64:65]
    v_pk_mul_f32 v[18:19], v[66:67], v[66:67]
    v_pk_mul_f32 v[20:21], v[68:69], v[68:69]
    v_pk_mul_f32 v[22:23], v[70:71], v[70:71]
    v_pk_fma_f32 v[16:17], v[72:73], v[72:73], v[16:17]
    v_pk_fma_f32 v[18:19], v[74:75], v[74:75], v[18:19]
    v_pk_fma_f32 v[20:21], v[76:77], v[76:77], v[20:21]
    v_pk_fma_f32 v[22:23], v[78:79], v[78:79], v[22:23]
    v_pk_fma_f32 v[16:17], v[80:81], v[80:81], v[16:17]
    v_pk_fma_f32 v[18:19], v[82:83], v[82:83], v[18:19]
    v_pk_fma_f32 v[20:21], v[84:85], v[84:85], v[20:21]
    v_pk_fma_f32 v[22:23], v[86:87], v[86:87], v[22:23]
    v_pk_fma_f32 v[16:17], v[88:89], v[88:89], v[16:17]
    v_pk_fma_f32 v[18:19], v[90:91], v[90:91], v[18:19]
    v_pk_fma_f32 v[20:21], v[92:93], v[92:93], v[20:21]
    v_pk_fma_f32 v[22:23], v[94:95], v[94:95], v[22:23]
    v_pk_fma_f32 v[16:17], v[96:97], v[96:97], v[16:17]
    v_pk_fma_f32 v[18:19], v[98:99], v[98:99], v[18:19]
    v_pk_fma_f32 v[20:21], v[100:101], v[100:101], v[20:21]
    v_pk_fma_f32 v[22:23], v[102:103], v[102:103], v[22:23]
    v_pk_fma_f32 v[16:17], v[104:105], v[104:105], v[16:17]
    v_pk_fma_f32 v[18:19], v[106:107], v[106:107], v[18:19]
    v_pk_fma_f32 v[20:21], v[108:109], v[108:109], v[20:21]
    v_pk_fma_f32 v[22:23], v[110:111], v[110:111], v[22:23]
    v_pk_fma_f32 v[16:17], v[112:113], v[112:113], v[16:17]
    v_pk_fma_f32 v[18:19], v[114:115], v[114:115], v[18:19]
    v_pk_fma_f32 v[20:21], v[116:117], v[116:117], v[20:21]
    v_pk_fma_f32 v[22:23], v[118:119], v[118:119], v[22:23]
    v_pk_fma_f32 v[16:17], v[120:121], v[120:121], v[16:17]
    v_pk_fma_f32 v[18:19], v[122:123], v[122:123], v[18:19]
    v_pk_fma_f32 v[20:21], v[124:125], v[124:125], v[20:21]
    v_pk_fma_f32 v[22:23], v[126:127], v[126:127], v[22:23]
    v_pk_add_f32 v[16:17], v[16:17], v[18:19]
    v_pk_add_f32 v[20:21], v[20:21], v[22:23]
    v_pk_add_f32 v[16:17], v[16:17], v[20:21]
    v_add_f32 v16, v16, v17
    ds_write_b32 v253, v16 offset:1024
    s_waitcnt lgkmcnt(0)
    s_waitcnt vmcnt(0)
    s_barrier
    s_cmp_lg_u32 s14, 0
    s_cbranch_scc1 main_kernel_s_nf
    v_cmp_gt_u32 vcc, 4, v2
    s_cbranch_vccz main_kernel_s_wa1_ok
    v_mov_b32 v2, 0
main_kernel_s_wa1:
    buffer_load_dword v3, v2, s[60:63], 0 offen offset:12 sc1
    s_waitcnt vmcnt(0)
    v_cmp_gt_u32 vcc, 4, v3
    s_cbranch_vccz main_kernel_s_wa1_ok
    s_sleep 4
    s_sub_u32 s29, s29, 1
    s_cbranch_scc0 main_kernel_s_wa1
    s_branch main_kernel_end
main_kernel_s_wa1_ok:
    s_mov_b64 exec, 1
    buffer_store_dword v8, v4, s[4:7], s16 offen sc1
    s_mov_b64 exec, -1
main_kernel_s_nf:
    ds_read_b128 v[16:19], v254 offset:1024
    ds_read_b128 v[20:23], v254 offset:1040
    ds_read_b128 v[24:27], v254 offset:1056
    ds_read_b128 v[28:31], v254 offset:1072
    s_waitcnt lgkmcnt(2)
    v_pk_add_f32 v[16:17], v[16:17], v[18:19]
    v_pk_add_f32 v[20:21], v[20:21], v[22:23]
    s_waitcnt lgkmcnt(0)
    v_pk_add_f32 v[24:25], v[24:25], v[26:27]
    v_pk_add_f32 v[28:29], v[28:29], v[30:31]
    v_pk_add_f32 v[16:17], v[16:17], v[20:21]
    v_pk_add_f32 v[24:25], v[24:25], v[28:29]
    v_pk_add_f32 v[16:17], v[16:17], v[24:25]
    v_add_f32 v16, v16, v17
    v_mov_b32 v17, 0x3727c5ac
    v_fmac_f32 v17, 0x3a800000, v16
    v_rsq_f32 v16, v17
    s_nop 0
    v_mov_b32 v17, v16
    v_pk_mul_f32 v[64:65], v[64:65], v[16:17]
    v_pk_mul_f32 v[66:67], v[66:67], v[16:17]
    v_pk_mul_f32 v[68:69], v[68:69], v[16:17]
    v_pk_mul_f32 v[70:71], v[70:71], v[16:17]
    v_pk_mul_f32 v[72:73], v[72:73], v[16:17]
    v_pk_mul_f32 v[74:75], v[74:75], v[16:17]
    v_pk_mul_f32 v[76:77], v[76:77], v[16:17]
    v_pk_mul_f32 v[78:79], v[78:79], v[16:17]
    v_pk_mul_f32 v[80:81], v[80:81], v[16:17]
    v_pk_mul_f32 v[82:83], v[82:83], v[16:17]
    v_pk_mul_f32 v[84:85], v[84:85], v[16:17]
    v_pk_mul_f32 v[86:87], v[86:87], v[16:17]
    v_pk_mul_f32 v[88:89], v[88:89], v[16:17]
    v_pk_mul_f32 v[90:91], v[90:91], v[16:17]
    v_pk_mul_f32 v[92:93], v[92:93], v[16:17]
    v_pk_mul_f32 v[94:95], v[94:95], v[16:17]
    v_pk_mul_f32 v[96:97], v[96:97], v[16:17]
    v_pk_mul_f32 v[98:99], v[98:99], v[16:17]
    v_pk_mul_f32 v[100:101], v[100:101], v[16:17]
    v_pk_mul_f32 v[102:103], v[102:103], v[16:17]
    v_pk_mul_f32 v[104:105], v[104:105], v[16:17]
    v_pk_mul_f32 v[106:107], v[106:107], v[16:17]
    v_pk_mul_f32 v[108:109], v[108:109], v[16:17]
    v_pk_mul_f32 v[110:111], v[110:111], v[16:17]
    v_pk_mul_f32 v[112:113], v[112:113], v[16:17]
    v_pk_mul_f32 v[114:115], v[114:115], v[16:17]
    v_pk_mul_f32 v[116:117], v[116:117], v[16:17]
    v_pk_mul_f32 v[118:119], v[118:119], v[16:17]
    v_pk_mul_f32 v[120:121], v[120:121], v[16:17]
    v_pk_mul_f32 v[122:123], v[122:123], v[16:17]
    v_pk_mul_f32 v[124:125], v[124:125], v[16:17]
    v_pk_mul_f32 v[126:127], v[126:127], v[16:17]
    v_cvt_pk_bf16_f32 v32, v64, v65
    v_cvt_pk_bf16_f32 v33, v66, v67
    v_cvt_pk_bf16_f32 v34, v68, v69
    v_cvt_pk_bf16_f32 v35, v70, v71
    v_cvt_pk_bf16_f32 v36, v72, v73
    v_cvt_pk_bf16_f32 v37, v74, v75
    v_cvt_pk_bf16_f32 v38, v76, v77
    v_cvt_pk_bf16_f32 v39, v78, v79
    v_cvt_pk_bf16_f32 v40, v80, v81
    v_cvt_pk_bf16_f32 v41, v82, v83
    v_cvt_pk_bf16_f32 v42, v84, v85
    v_cvt_pk_bf16_f32 v43, v86, v87
    v_cvt_pk_bf16_f32 v44, v88, v89
    v_cvt_pk_bf16_f32 v45, v90, v91
    v_cvt_pk_bf16_f32 v46, v92, v93
    v_cvt_pk_bf16_f32 v47, v94, v95
    v_cvt_pk_bf16_f32 v48, v96, v97
    v_cvt_pk_bf16_f32 v49, v98, v99
    v_cvt_pk_bf16_f32 v50, v100, v101
    v_cvt_pk_bf16_f32 v51, v102, v103
    v_cvt_pk_bf16_f32 v52, v104, v105
    v_cvt_pk_bf16_f32 v53, v106, v107
    v_cvt_pk_bf16_f32 v54, v108, v109
    v_cvt_pk_bf16_f32 v55, v110, v111
    v_cvt_pk_bf16_f32 v56, v112, v113
    v_cvt_pk_bf16_f32 v57, v114, v115
    v_cvt_pk_bf16_f32 v58, v116, v117
    v_cvt_pk_bf16_f32 v59, v118, v119
    v_cvt_pk_bf16_f32 v60, v120, v121
    v_cvt_pk_bf16_f32 v61, v122, v123
    v_cvt_pk_bf16_f32 v62, v124, v125
    v_cvt_pk_bf16_f32 v63, v126, v127
    s_add_u32 s32, s34, 0x400000
    s_add_u32 s33, s32, 4096
    buffer_store_dwordx4 v[32:35], v251, s[4:7], s32 offen offset:0 sc1
    buffer_store_dwordx4 v[36:39], v251, s[4:7], s32 offen offset:1024 sc1
    buffer_store_dwordx4 v[40:43], v251, s[4:7], s32 offen offset:2048 sc1
    buffer_store_dwordx4 v[44:47], v251, s[4:7], s32 offen offset:3072 sc1
    buffer_store_dwordx4 v[48:51], v251, s[4:7], s33 offen offset:0 sc1
    buffer_store_dwordx4 v[52:55], v251, s[4:7], s33 offen offset:1024 sc1
    buffer_store_dwordx4 v[56:59], v251, s[4:7], s33 offen offset:2048 sc1
    buffer_store_dwordx4 v[60:63], v251, s[4:7], s33 offen offset:3072 sc1
    s_add_u32 s16, s16, 4
    s_branch main_kernel_s_wa2_ok
main_kernel_s_fill:
    s_lshl_b32 s32, s16, 14
    s_add_u32 s34, s32, 0x6c00000
    buffer_store_dwordx4 v[8:11], v1, s[4:7], s34 offen sc1
    s_add_u32 s34, s32, 0x6c01000
    buffer_store_dwordx4 v[8:11], v1, s[4:7], s34 offen sc1
    s_add_u32 s34, s32, 0x6c02000
    buffer_store_dwordx4 v[8:11], v1, s[4:7], s34 offen sc1
    s_add_u32 s34, s32, 0x6c03000
    buffer_store_dwordx4 v[8:11], v1, s[4:7], s34 offen sc1
    s_lshl_b32 s32, s16, 14
    s_add_u32 s34, s32, 0x8c00000
    buffer_store_dwordx4 v[8:11], v1, s[4:7], s34 offen sc1
    s_add_u32 s34, s32, 0x8c01000
    buffer_store_dwordx4 v[8:11], v1, s[4:7], s34 offen sc1
    s_add_u32 s34, s32, 0x8c02000
    buffer_store_dwordx4 v[8:11], v1, s[4:7], s34 offen sc1
    s_add_u32 s34, s32, 0x8c03000
    buffer_store_dwordx4 v[8:11], v1, s[4:7], s34 offen sc1
    s_add_u32 s34, s32, 0x8d00000
    buffer_store_dwordx4 v[8:11], v1, s[4:7], s34 offen sc1
    s_add_u32 s34, s32, 0x8d01000
    buffer_store_dwordx4 v[8:11], v1, s[4:7], s34 offen sc1
    s_add_u32 s34, s32, 0x8d02000
    buffer_store_dwordx4 v[8:11], v1, s[4:7], s34 offen sc1
    s_add_u32 s34, s32, 0x8d03000
    buffer_store_dwordx4 v[8:11], v1, s[4:7], s34 offen sc1
    s_lshl_b32 s32, s16, 2
    s_lshl_b32 s32, s16, 12
    s_add_u32 s33, s32, 0x8c00000
    s_add_u32 s34, s32, 0x6e00000
    buffer_store_dwordx4 v[8:11], v1, s[4:7], s34 offen sc1
    s_add_u32 s32, s32, 0x8000000
    buffer_store_dwordx4 v[8:11], v1, s[4:7], s32 offen sc1
    s_lshl_b32 s16, s16, 2
    s_add_u32 s16, s16, 0x841f000
    s_cmp_lg_u32 s16, 0x841f034
    s_cbranch_scc1 main_kernel_s_fd
    s_mov_b32 s8, s76
    s_and_b32 s9, s77, 0xffff
    s_mov_b32 s10, 0x4000
    s_mov_b32 s11, 0x20000
    v_and_b32 v2, 7, v0
    v_lshlrev_b32 v2, 11, v2
    v_lshrrev_b32 v3, 6, v0
    v_lshl_add_u32 v2, v3, 7, v2
    v_bfe_u32 v3, v0, 4, 2
    v_lshl_add_u32 v2, v3, 5, v2
    v_bfe_u32 v3, v0, 3, 1
    v_lshl_add_u32 v2, v3, 4, v2
    buffer_load_dwordx4 v[16:19], v2, s[8:11], 0 offen offset:0
    buffer_load_dwordx4 v[20:23], v2, s[8:11], 0 offen offset:512
    buffer_load_dwordx4 v[24:27], v2, s[8:11], 0 offen offset:1024
    buffer_load_dwordx4 v[28:31], v2, s[8:11], 0 offen offset:1536
    s_mov_b32 s32, 0x6d00000
    s_waitcnt vmcnt(0)
    buffer_store_dwordx4 v[16:19], v1, s[4:7], s32 offen sc1
    s_add_u32 s32, s32, 4096
    buffer_store_dwordx4 v[20:23], v1, s[4:7], s32 offen sc1
    s_add_u32 s32, s32, 4096
    buffer_store_dwordx4 v[24:27], v1, s[4:7], s32 offen sc1
    s_add_u32 s32, s32, 4096
    buffer_store_dwordx4 v[28:31], v1, s[4:7], s32 offen sc1
    s_add_u32 s32, s32, 4096
    buffer_store_dwordx4 v[8:11], v1, s[4:7], s32 offen sc1
    s_add_u32 s32, s32, 4096
    buffer_store_dwordx4 v[8:11], v1, s[4:7], s32 offen sc1
    s_add_u32 s32, s32, 4096
    buffer_store_dwordx4 v[8:11], v1, s[4:7], s32 offen sc1
    s_add_u32 s32, s32, 4096
    buffer_store_dwordx4 v[8:11], v1, s[4:7], s32 offen sc1
    s_add_u32 s32, s32, 4096
    v_xor_b32 v2, 0, v1
    v_mov_b32 v2, 0
main_kernel_s_wa3:
    buffer_load_dword v3, v2, s[60:63], 0 offen offset:12 sc1
    s_waitcnt vmcnt(0)
    v_cmp_gt_u32 vcc, 4, v3
    s_cbranch_vccz main_kernel_s_wa3_ok
    s_sleep 4
    s_sub_u32 s29, s29, 1
    s_cbranch_scc0 main_kernel_s_wa3
    s_branch main_kernel_end
main_kernel_s_wa3_ok:
    v_lshlrev_b32 v2, 8, v250
    s_mov_b32 s32, 0x8418100
    s_mov_b64 exec, 15
    buffer_store_dwordx4 v[8:11], v2, s[4:7], s32 offen sc1
    s_mov_b64 exec, -1
main_kernel_s_fd:
    s_cmp_lg_u32 s14, 0
    s_cbranch_scc1 main_kernel_s_wa2_ok
    v_mov_b32 v2, 0
main_kernel_s_wa2:
    buffer_load_dword v3, v2, s[60:63], 0 offen offset:12 sc1
    s_waitcnt vmcnt(0)
    v_cmp_gt_u32 vcc, 4, v3
    s_cbranch_vccz main_kernel_s_wa2_ok
    s_sleep 4
    s_sub_u32 s29, s29, 1
    s_cbranch_scc0 main_kernel_s_wa2
    s_branch main_kernel_end
main_kernel_s_wa2_ok:
    s_waitcnt vmcnt(0)
    s_barrier
    s_cmp_lg_u32 s14, 0
    s_cbranch_scc1 main_kernel_s_end
    s_mov_b64 exec, 1
    buffer_store_dword v8, v4, s[4:7], s16 offen sc1
    s_mov_b64 exec, -1
main_kernel_s_end:
    s_lshl_b32 s32, s12, 5
    s_add_u32 s32, s32, s13
    s_sub_u32 s32, s32, 96
    s_cmp_lt_u32 s32, 16
    s_cbranch_scc1 main_kernel_att
    s_branch main_kernel_worker
main_kernel_end:
    s_endpgm
main_kernel_chain:
    s_lshl_b32 s36, s14, 15
    s_add_u32 s36, s36, 32768
    v_lshlrev_b32 v116, 4, v94
    v_add_u32 v113, s36, v116
    v_lshrrev_b32 v126, 4, v94
    v_and_b32 v127, 15, v94
    v_lshlrev_b32 v95, 2, v126
    v_xor_b32 v127, v127, v95
    v_lshlrev_b32 v127, 4, v127
    v_and_b32 v95, 1, v126
    v_lshrrev_b32 v126, 1, v126
    v_lshl_add_u32 v127, v126, 15, v127
    v_lshl_add_u32 v65, v95, 13, v127
    v_lshl_add_u32 v66, v95, 11, v127
    s_lshr_b32 s32, s14, 1
    s_lshl_b32 s32, s32, 5
    v_xor_b32 v64, s32, v65
    v_bfe_u32 v127, v94, 2, 1
    v_bfe_u32 v95, v94, 4, 1
    v_lshl_add_u32 v78, v95, 1, v127
    v_lshl_add_u32 v126, v126, 3, v78
    v_and_b32 v127, 3, v94
    v_lshlrev_b32 v127, 3, v127
    v_lshl_add_u32 v71, v126, 8, v127
    v_bfe_u32 v95, v94, 3, 1
    v_lshl_add_u32 v71, v95, 5, v71
    v_xor_b32 v126, s14, v78
    v_lshl_add_u32 v126, v126, 6, v71
    v_add_u32 v69, 32768, v126
    v_add_u32 v70, 0x10000, v69
    v_lshl_add_u32 v126, v78, 6, v71
    v_add_u32 v80, s36, v126
    s_lshl_b32 s32, s14, 5
    s_add_u32 s32, s32, 32768
    v_xor_b32 v126, s32, v126
    v_lshl_add_u32 v67, v95, 16, v126
    v_xor_b32 v68, 0x80, v67
    v_xor_b32 v81, 64, v80
    v_xor_b32 v82, 128, v80
    v_xor_b32 v83, 192, v80
    v_and_b32 v126, 7, v94
    v_lshl_add_u32 v126, s13, 3, v126
    v_lshlrev_b32 v77, 10, v126
    s_lshl_b32 s32, s12, 22
    s_lshl_b32 s33, s13, 8
    s_add_u32 s32, s32, s33
    s_lshl_b32 s33, s14, 18
    s_add_u32 s35, s32, s33
    s_bitset0_b32 s33, 19
    s_add_u32 s34, s32, s33
    s_lshl_b32 s3, s13, 18
    s_lshl2_add_u32 s32, s12, s14
    s_lshl_b32 s32, s32, 8
    s_add_u32 s3, s3, s32
    s_cmp_lt_u32 s14, 2
    s_cbranch_scc1 main_kernel_c_pq
    s_mov_b64 s[40:41], s[42:43]
main_kernel_c_pq:
    v_min_u32 v73, 8, v94
    v_lshlrev_b32 v73, 5, v73
    v_mov_b32 v126, 12
    v_cmp_gt_u32 vcc, 8, v94
    v_lshlrev_b32 v74, 2, v94
    v_add_u32 v74, 0x841f000, v74
    v_cndmask_b32 v73, v126, v73, vcc
    v_and_b32 v75, 1, v94
    s_lshl_b32 s32, s13, 8
    s_add_u32 s32, s32, 0x8406000
    v_lshl_add_u32 v75, v75, 13, s32
    s_mov_b32 s8, s44
    s_and_b32 s9, s45, 0xffff
    s_mov_b32 s10, 0x800000
    s_mov_b32 s11, 0x20000
    s_sub_u32 s39, 511, s44
    s_and_b32 s39, s39, 0x380
    s_andn2_b32 s32, s35, 0x1fff
    s_add_u32 s39, s39, s32
    s_add_u32 s32, s39, 0x0
    buffer_load_dword v86, v77, s[8:11], s32 offen
    s_add_u32 s32, s35, 0x0
    s_add_u32 m0, s36, 0
    s_nop 0
    buffer_load_dwordx4 v65, s[8:11], s32 offen lds
    s_add_u32 s32, s35, 0x4000
    s_add_u32 m0, s36, 1024
    s_nop 0
    buffer_load_dwordx4 v65, s[8:11], s32 offen lds
    s_add_u32 s32, s35, 0x10000
    s_add_u32 m0, s36, 2048
    s_nop 0
    buffer_load_dwordx4 v65, s[8:11], s32 offen lds
    s_add_u32 s32, s35, 0x14000
    s_add_u32 m0, s36, 3072
    s_nop 0
    buffer_load_dwordx4 v65, s[8:11], s32 offen lds
    s_add_u32 s32, s35, 0x20000
    s_add_u32 m0, s36, 4096
    s_nop 0
    buffer_load_dwordx4 v65, s[8:11], s32 offen lds
    s_add_u32 s32, s35, 0x24000
    s_add_u32 m0, s36, 5120
    s_nop 0
    buffer_load_dwordx4 v65, s[8:11], s32 offen lds
    s_add_u32 s32, s35, 0x30000
    s_add_u32 m0, s36, 6144
    s_nop 0
    buffer_load_dwordx4 v65, s[8:11], s32 offen lds
    s_add_u32 s32, s35, 0x34000
    s_add_u32 m0, s36, 7168
    s_nop 0
    buffer_load_dwordx4 v65, s[8:11], s32 offen lds
    s_add_u32 s32, s39, 0x100000
    buffer_load_dword v86, v77, s[8:11], s32 offen
    s_add_u32 s32, s35, 0x100000
    s_add_u32 m0, s36, 8192
    s_nop 0
    buffer_load_dwordx4 v65, s[8:11], s32 offen lds
    s_add_u32 s32, s35, 0x104000
    s_add_u32 m0, s36, 9216
    s_nop 0
    buffer_load_dwordx4 v65, s[8:11], s32 offen lds
    s_add_u32 s32, s35, 0x110000
    s_add_u32 m0, s36, 10240
    s_nop 0
    buffer_load_dwordx4 v65, s[8:11], s32 offen lds
    s_add_u32 s32, s35, 0x114000
    s_add_u32 m0, s36, 11264
    s_nop 0
    buffer_load_dwordx4 v65, s[8:11], s32 offen lds
    s_add_u32 s32, s35, 0x120000
    s_add_u32 m0, s36, 12288
    s_nop 0
    buffer_load_dwordx4 v65, s[8:11], s32 offen lds
    s_add_u32 s32, s35, 0x124000
    s_add_u32 m0, s36, 13312
    s_nop 0
    buffer_load_dwordx4 v65, s[8:11], s32 offen lds
    s_add_u32 s32, s35, 0x130000
    s_add_u32 m0, s36, 14336
    s_nop 0
    buffer_load_dwordx4 v65, s[8:11], s32 offen lds
    s_add_u32 s32, s35, 0x134000
    s_add_u32 m0, s36, 15360
    s_nop 0
    buffer_load_dwordx4 v65, s[8:11], s32 offen lds
    s_mov_b32 s8, s40
    s_and_b32 s9, s41, 0xffff
    s_mov_b32 s10, 0x800000
    s_mov_b32 s11, 0x20000
    s_sub_u32 s39, 511, s40
    s_and_b32 s39, s39, 0x380
    s_andn2_b32 s32, s34, 0x1fff
    s_add_u32 s39, s39, s32
    s_add_u32 s32, s39, 0x0
    buffer_load_dword v86, v77, s[8:11], s32 offen
    s_add_u32 s32, s34, 0x0
    s_add_u32 m0, s36, 16384
    s_nop 0
    buffer_load_dwordx4 v64, s[8:11], s32 offen lds
    s_add_u32 s32, s34, 0x4000
    s_add_u32 m0, s36, 17408
    s_nop 0
    buffer_load_dwordx4 v64, s[8:11], s32 offen lds
    s_add_u32 s32, s34, 0x10000
    s_add_u32 m0, s36, 18432
    s_nop 0
    buffer_load_dwordx4 v64, s[8:11], s32 offen lds
    s_add_u32 s32, s34, 0x14000
    s_add_u32 m0, s36, 19456
    s_nop 0
    buffer_load_dwordx4 v64, s[8:11], s32 offen lds
    s_add_u32 s32, s34, 0x20000
    s_add_u32 m0, s36, 20480
    s_nop 0
    buffer_load_dwordx4 v64, s[8:11], s32 offen lds
    s_add_u32 s32, s34, 0x24000
    s_add_u32 m0, s36, 21504
    s_nop 0
    buffer_load_dwordx4 v64, s[8:11], s32 offen lds
    s_add_u32 s32, s34, 0x30000
    s_add_u32 m0, s36, 22528
    s_nop 0
    buffer_load_dwordx4 v64, s[8:11], s32 offen lds
    s_add_u32 s32, s34, 0x34000
    s_add_u32 m0, s36, 23552
    s_nop 0
    buffer_load_dwordx4 v64, s[8:11], s32 offen lds
    s_add_u32 s32, s39, 0x80000
    buffer_load_dword v86, v77, s[8:11], s32 offen
    s_add_u32 s32, s34, 0x80000
    s_add_u32 m0, s36, 24576
    s_nop 0
    buffer_load_dwordx4 v64, s[8:11], s32 offen lds
    s_add_u32 s32, s34, 0x84000
    s_add_u32 m0, s36, 25600
    s_nop 0
    buffer_load_dwordx4 v64, s[8:11], s32 offen lds
    s_add_u32 s32, s34, 0x90000
    s_add_u32 m0, s36, 26624
    s_nop 0
    buffer_load_dwordx4 v64, s[8:11], s32 offen lds
    s_add_u32 s32, s34, 0x94000
    s_add_u32 m0, s36, 27648
    s_nop 0
    buffer_load_dwordx4 v64, s[8:11], s32 offen lds
    s_add_u32 s32, s34, 0xa0000
    s_add_u32 m0, s36, 28672
    s_nop 0
    buffer_load_dwordx4 v64, s[8:11], s32 offen lds
    s_add_u32 s32, s34, 0xa4000
    s_add_u32 m0, s36, 29696
    s_nop 0
    buffer_load_dwordx4 v64, s[8:11], s32 offen lds
    s_add_u32 s32, s34, 0xb0000
    s_add_u32 m0, s36, 30720
    s_nop 0
    buffer_load_dwordx4 v64, s[8:11], s32 offen lds
    s_add_u32 s32, s34, 0xb4000
    s_add_u32 m0, s36, 31744
    s_nop 0
    buffer_load_dwordx4 v64, s[8:11], s32 offen lds
    s_waitcnt vmcnt(27)
    s_barrier
    ds_read_b64_tr_b16 v[128:129], v69 offset:0
    ds_read_b64_tr_b16 v[130:131], v69 offset:1024
    ds_read_b64_tr_b16 v[132:133], v69 offset:4096
    ds_read_b64_tr_b16 v[134:135], v69 offset:5120
    ds_read_b64_tr_b16 v[136:137], v69 offset:32768
    ds_read_b64_tr_b16 v[138:139], v69 offset:33792
    ds_read_b64_tr_b16 v[140:141], v69 offset:36864
    ds_read_b64_tr_b16 v[142:143], v69 offset:37888
    ds_read_b64_tr_b16 v[144:145], v70 offset:0
    ds_read_b64_tr_b16 v[146:147], v70 offset:1024
    ds_read_b64_tr_b16 v[148:149], v70 offset:4096
    ds_read_b64_tr_b16 v[150:151], v70 offset:5120
    ds_read_b64_tr_b16 v[152:153], v70 offset:32768
    ds_read_b64_tr_b16 v[154:155], v70 offset:33792
    ds_read_b64_tr_b16 v[156:157], v70 offset:36864
    ds_read_b64_tr_b16 v[158:159], v70 offset:37888
    s_waitcnt lgkmcnt(0)
    s_waitcnt vmcnt(18)
    s_barrier
    s_add_u32 s32, s39, 0x100000
    buffer_load_dword v86, v77, s[8:11], s32 offen
    s_add_u32 s32, s34, 0x100000
    s_add_u32 m0, s36, 0
    s_nop 0
    buffer_load_dwordx4 v64, s[8:11], s32 offen lds
    s_add_u32 s32, s34, 0x104000
    s_add_u32 m0, s36, 1024
    s_nop 0
    buffer_load_dwordx4 v64, s[8:11], s32 offen lds
    s_add_u32 s32, s34, 0x110000
    s_add_u32 m0, s36, 2048
    s_nop 0
    buffer_load_dwordx4 v64, s[8:11], s32 offen lds
    s_add_u32 s32, s34, 0x114000
    s_add_u32 m0, s36, 3072
    s_nop 0
    buffer_load_dwordx4 v64, s[8:11], s32 offen lds
    s_add_u32 s32, s34, 0x120000
    s_add_u32 m0, s36, 4096
    s_nop 0
    buffer_load_dwordx4 v64, s[8:11], s32 offen lds
    s_add_u32 s32, s34, 0x124000
    s_add_u32 m0, s36, 5120
    s_nop 0
    buffer_load_dwordx4 v64, s[8:11], s32 offen lds
    s_add_u32 s32, s34, 0x130000
    s_add_u32 m0, s36, 6144
    s_nop 0
    buffer_load_dwordx4 v64, s[8:11], s32 offen lds
    s_add_u32 s32, s34, 0x134000
    s_add_u32 m0, s36, 7168
    s_nop 0
    buffer_load_dwordx4 v64, s[8:11], s32 offen lds
    ds_read_b64_tr_b16 v[160:161], v69 offset:8192
    ds_read_b64_tr_b16 v[162:163], v69 offset:9216
    ds_read_b64_tr_b16 v[164:165], v69 offset:12288
    ds_read_b64_tr_b16 v[166:167], v69 offset:13312
    ds_read_b64_tr_b16 v[168:169], v69 offset:40960
    ds_read_b64_tr_b16 v[170:171], v69 offset:41984
    ds_read_b64_tr_b16 v[172:173], v69 offset:45056
    ds_read_b64_tr_b16 v[174:175], v69 offset:46080
    ds_read_b64_tr_b16 v[176:177], v70 offset:8192
    ds_read_b64_tr_b16 v[178:179], v70 offset:9216
    ds_read_b64_tr_b16 v[180:181], v70 offset:12288
    ds_read_b64_tr_b16 v[182:183], v70 offset:13312
    ds_read_b64_tr_b16 v[184:185], v70 offset:40960
    ds_read_b64_tr_b16 v[186:187], v70 offset:41984
    ds_read_b64_tr_b16 v[188:189], v70 offset:45056
    ds_read_b64_tr_b16 v[190:191], v70 offset:46080
    s_waitcnt lgkmcnt(0)
    s_waitcnt vmcnt(18)
    s_barrier
    s_add_u32 s32, s39, 0x180000
    buffer_load_dword v86, v77, s[8:11], s32 offen
    s_add_u32 s32, s34, 0x180000
    s_add_u32 m0, s36, 8192
    s_nop 0
    buffer_load_dwordx4 v64, s[8:11], s32 offen lds
    s_add_u32 s32, s34, 0x184000
    s_add_u32 m0, s36, 9216
    s_nop 0
    buffer_load_dwordx4 v64, s[8:11], s32 offen lds
    s_add_u32 s32, s34, 0x190000
    s_add_u32 m0, s36, 10240
    s_nop 0
    buffer_load_dwordx4 v64, s[8:11], s32 offen lds
    s_add_u32 s32, s34, 0x194000
    s_add_u32 m0, s36, 11264
    s_nop 0
    buffer_load_dwordx4 v64, s[8:11], s32 offen lds
    s_add_u32 s32, s34, 0x1a0000
    s_add_u32 m0, s36, 12288
    s_nop 0
    buffer_load_dwordx4 v64, s[8:11], s32 offen lds
    s_add_u32 s32, s34, 0x1a4000
    s_add_u32 m0, s36, 13312
    s_nop 0
    buffer_load_dwordx4 v64, s[8:11], s32 offen lds
    s_add_u32 s32, s34, 0x1b0000
    s_add_u32 m0, s36, 14336
    s_nop 0
    buffer_load_dwordx4 v64, s[8:11], s32 offen lds
    s_add_u32 s32, s34, 0x1b4000
    s_add_u32 m0, s36, 15360
    s_nop 0
    buffer_load_dwordx4 v64, s[8:11], s32 offen lds
    ds_read_b64_tr_b16 a[0:1], v67 offset:16384
    ds_read_b64_tr_b16 a[2:3], v67 offset:17408
    ds_read_b64_tr_b16 a[4:5], v67 offset:20480
    ds_read_b64_tr_b16 a[6:7], v67 offset:21504
    ds_read_b64_tr_b16 a[8:9], v67 offset:49152
    ds_read_b64_tr_b16 a[10:11], v67 offset:50176
    ds_read_b64_tr_b16 a[12:13], v67 offset:53248
    ds_read_b64_tr_b16 a[14:15], v67 offset:54272
    ds_read_b64_tr_b16 a[128:129], v68 offset:16384
    ds_read_b64_tr_b16 a[130:131], v68 offset:17408
    ds_read_b64_tr_b16 a[132:133], v68 offset:20480
    ds_read_b64_tr_b16 a[134:135], v68 offset:21504
    ds_read_b64_tr_b16 a[136:137], v68 offset:49152
    ds_read_b64_tr_b16 a[138:139], v68 offset:50176
    ds_read_b64_tr_b16 a[140:141], v68 offset:53248
    ds_read_b64_tr_b16 a[142:143], v68 offset:54272
    s_waitcnt lgkmcnt(0)
    s_waitcnt vmcnt(18)
    s_barrier
    s_add_u32 s32, s39, 0x200000
    buffer_load_dword v86, v77, s[8:11], s32 offen
    s_add_u32 s32, s34, 0x200000
    s_add_u32 m0, s36, 16384
    s_nop 0
    buffer_load_dwordx4 v64, s[8:11], s32 offen lds
    s_add_u32 s32, s34, 0x204000
    s_add_u32 m0, s36, 17408
    s_nop 0
    buffer_load_dwordx4 v64, s[8:11], s32 offen lds
    s_add_u32 s32, s34, 0x210000
    s_add_u32 m0, s36, 18432
    s_nop 0
    buffer_load_dwordx4 v64, s[8:11], s32 offen lds
    s_add_u32 s32, s34, 0x214000
    s_add_u32 m0, s36, 19456
    s_nop 0
    buffer_load_dwordx4 v64, s[8:11], s32 offen lds
    s_add_u32 s32, s34, 0x220000
    s_add_u32 m0, s36, 20480
    s_nop 0
    buffer_load_dwordx4 v64, s[8:11], s32 offen lds
    s_add_u32 s32, s34, 0x224000
    s_add_u32 m0, s36, 21504
    s_nop 0
    buffer_load_dwordx4 v64, s[8:11], s32 offen lds
    s_add_u32 s32, s34, 0x230000
    s_add_u32 m0, s36, 22528
    s_nop 0
    buffer_load_dwordx4 v64, s[8:11], s32 offen lds
    s_add_u32 s32, s34, 0x234000
    s_add_u32 m0, s36, 23552
    s_nop 0
    buffer_load_dwordx4 v64, s[8:11], s32 offen lds
    ds_read_b64_tr_b16 a[16:17], v67 offset:24576
    ds_read_b64_tr_b16 a[18:19], v67 offset:25600
    ds_read_b64_tr_b16 a[20:21], v67 offset:28672
    ds_read_b64_tr_b16 a[22:23], v67 offset:29696
    ds_read_b64_tr_b16 a[24:25], v67 offset:57344
    ds_read_b64_tr_b16 a[26:27], v67 offset:58368
    ds_read_b64_tr_b16 a[28:29], v67 offset:61440
    ds_read_b64_tr_b16 a[30:31], v67 offset:62464
    ds_read_b64_tr_b16 a[144:145], v68 offset:24576
    ds_read_b64_tr_b16 a[146:147], v68 offset:25600
    ds_read_b64_tr_b16 a[148:149], v68 offset:28672
    ds_read_b64_tr_b16 a[150:151], v68 offset:29696
    ds_read_b64_tr_b16 a[152:153], v68 offset:57344
    ds_read_b64_tr_b16 a[154:155], v68 offset:58368
    ds_read_b64_tr_b16 a[156:157], v68 offset:61440
    ds_read_b64_tr_b16 a[158:159], v68 offset:62464
    s_waitcnt lgkmcnt(0)
    s_waitcnt vmcnt(18)
    s_barrier
    s_add_u32 s32, s39, 0x280000
    buffer_load_dword v86, v77, s[8:11], s32 offen
    s_add_u32 s32, s34, 0x280000
    s_add_u32 m0, s36, 24576
    s_nop 0
    buffer_load_dwordx4 v64, s[8:11], s32 offen lds
    s_add_u32 s32, s34, 0x284000
    s_add_u32 m0, s36, 25600
    s_nop 0
    buffer_load_dwordx4 v64, s[8:11], s32 offen lds
    s_add_u32 s32, s34, 0x290000
    s_add_u32 m0, s36, 26624
    s_nop 0
    buffer_load_dwordx4 v64, s[8:11], s32 offen lds
    s_add_u32 s32, s34, 0x294000
    s_add_u32 m0, s36, 27648
    s_nop 0
    buffer_load_dwordx4 v64, s[8:11], s32 offen lds
    s_add_u32 s32, s34, 0x2a0000
    s_add_u32 m0, s36, 28672
    s_nop 0
    buffer_load_dwordx4 v64, s[8:11], s32 offen lds
    s_add_u32 s32, s34, 0x2a4000
    s_add_u32 m0, s36, 29696
    s_nop 0
    buffer_load_dwordx4 v64, s[8:11], s32 offen lds
    s_add_u32 s32, s34, 0x2b0000
    s_add_u32 m0, s36, 30720
    s_nop 0
    buffer_load_dwordx4 v64, s[8:11], s32 offen lds
    s_add_u32 s32, s34, 0x2b4000
    s_add_u32 m0, s36, 31744
    s_nop 0
    buffer_load_dwordx4 v64, s[8:11], s32 offen lds
    ds_read_b64_tr_b16 a[32:33], v67 offset:0
    ds_read_b64_tr_b16 a[34:35], v67 offset:1024
    ds_read_b64_tr_b16 a[36:37], v67 offset:4096
    ds_read_b64_tr_b16 a[38:39], v67 offset:5120
    ds_read_b64_tr_b16 a[40:41], v67 offset:32768
    ds_read_b64_tr_b16 a[42:43], v67 offset:33792
    ds_read_b64_tr_b16 a[44:45], v67 offset:36864
    ds_read_b64_tr_b16 a[46:47], v67 offset:37888
    ds_read_b64_tr_b16 a[160:161], v68 offset:0
    ds_read_b64_tr_b16 a[162:163], v68 offset:1024
    ds_read_b64_tr_b16 a[164:165], v68 offset:4096
    ds_read_b64_tr_b16 a[166:167], v68 offset:5120
    ds_read_b64_tr_b16 a[168:169], v68 offset:32768
    ds_read_b64_tr_b16 a[170:171], v68 offset:33792
    ds_read_b64_tr_b16 a[172:173], v68 offset:36864
    ds_read_b64_tr_b16 a[174:175], v68 offset:37888
    s_waitcnt lgkmcnt(0)
    s_waitcnt vmcnt(18)
    s_barrier
    s_add_u32 s32, s39, 0x300000
    buffer_load_dword v86, v77, s[8:11], s32 offen
    s_add_u32 s32, s34, 0x300000
    s_add_u32 m0, s36, 0
    s_nop 0
    buffer_load_dwordx4 v64, s[8:11], s32 offen lds
    s_add_u32 s32, s34, 0x304000
    s_add_u32 m0, s36, 1024
    s_nop 0
    buffer_load_dwordx4 v64, s[8:11], s32 offen lds
    s_add_u32 s32, s34, 0x310000
    s_add_u32 m0, s36, 2048
    s_nop 0
    buffer_load_dwordx4 v64, s[8:11], s32 offen lds
    s_add_u32 s32, s34, 0x314000
    s_add_u32 m0, s36, 3072
    s_nop 0
    buffer_load_dwordx4 v64, s[8:11], s32 offen lds
    s_add_u32 s32, s34, 0x320000
    s_add_u32 m0, s36, 4096
    s_nop 0
    buffer_load_dwordx4 v64, s[8:11], s32 offen lds
    s_add_u32 s32, s34, 0x324000
    s_add_u32 m0, s36, 5120
    s_nop 0
    buffer_load_dwordx4 v64, s[8:11], s32 offen lds
    s_add_u32 s32, s34, 0x330000
    s_add_u32 m0, s36, 6144
    s_nop 0
    buffer_load_dwordx4 v64, s[8:11], s32 offen lds
    s_add_u32 s32, s34, 0x334000
    s_add_u32 m0, s36, 7168
    s_nop 0
    buffer_load_dwordx4 v64, s[8:11], s32 offen lds
    ds_read_b64_tr_b16 a[48:49], v67 offset:8192
    ds_read_b64_tr_b16 a[50:51], v67 offset:9216
    ds_read_b64_tr_b16 a[52:53], v67 offset:12288
    ds_read_b64_tr_b16 a[54:55], v67 offset:13312
    ds_read_b64_tr_b16 a[56:57], v67 offset:40960
    ds_read_b64_tr_b16 a[58:59], v67 offset:41984
    ds_read_b64_tr_b16 a[60:61], v67 offset:45056
    ds_read_b64_tr_b16 a[62:63], v67 offset:46080
    ds_read_b64_tr_b16 a[176:177], v68 offset:8192
    ds_read_b64_tr_b16 a[178:179], v68 offset:9216
    ds_read_b64_tr_b16 a[180:181], v68 offset:12288
    ds_read_b64_tr_b16 a[182:183], v68 offset:13312
    ds_read_b64_tr_b16 a[184:185], v68 offset:40960
    ds_read_b64_tr_b16 a[186:187], v68 offset:41984
    ds_read_b64_tr_b16 a[188:189], v68 offset:45056
    ds_read_b64_tr_b16 a[190:191], v68 offset:46080
    s_waitcnt lgkmcnt(0)
    s_waitcnt vmcnt(18)
    s_barrier
    s_add_u32 s32, s39, 0x380000
    buffer_load_dword v86, v77, s[8:11], s32 offen
    s_add_u32 s32, s34, 0x380000
    s_add_u32 m0, s36, 8192
    s_nop 0
    buffer_load_dwordx4 v64, s[8:11], s32 offen lds
    s_add_u32 s32, s34, 0x384000
    s_add_u32 m0, s36, 9216
    s_nop 0
    buffer_load_dwordx4 v64, s[8:11], s32 offen lds
    s_add_u32 s32, s34, 0x390000
    s_add_u32 m0, s36, 10240
    s_nop 0
    buffer_load_dwordx4 v64, s[8:11], s32 offen lds
    s_add_u32 s32, s34, 0x394000
    s_add_u32 m0, s36, 11264
    s_nop 0
    buffer_load_dwordx4 v64, s[8:11], s32 offen lds
    s_add_u32 s32, s34, 0x3a0000
    s_add_u32 m0, s36, 12288
    s_nop 0
    buffer_load_dwordx4 v64, s[8:11], s32 offen lds
    s_add_u32 s32, s34, 0x3a4000
    s_add_u32 m0, s36, 13312
    s_nop 0
    buffer_load_dwordx4 v64, s[8:11], s32 offen lds
    s_add_u32 s32, s34, 0x3b0000
    s_add_u32 m0, s36, 14336
    s_nop 0
    buffer_load_dwordx4 v64, s[8:11], s32 offen lds
    s_add_u32 s32, s34, 0x3b4000
    s_add_u32 m0, s36, 15360
    s_nop 0
    buffer_load_dwordx4 v64, s[8:11], s32 offen lds
    ds_read_b64_tr_b16 a[64:65], v67 offset:16384
    ds_read_b64_tr_b16 a[66:67], v67 offset:17408
    ds_read_b64_tr_b16 a[68:69], v67 offset:20480
    ds_read_b64_tr_b16 a[70:71], v67 offset:21504
    ds_read_b64_tr_b16 a[72:73], v67 offset:49152
    ds_read_b64_tr_b16 a[74:75], v67 offset:50176
    ds_read_b64_tr_b16 a[76:77], v67 offset:53248
    ds_read_b64_tr_b16 a[78:79], v67 offset:54272
    ds_read_b64_tr_b16 a[192:193], v68 offset:16384
    ds_read_b64_tr_b16 a[194:195], v68 offset:17408
    ds_read_b64_tr_b16 a[196:197], v68 offset:20480
    ds_read_b64_tr_b16 a[198:199], v68 offset:21504
    ds_read_b64_tr_b16 a[200:201], v68 offset:49152
    ds_read_b64_tr_b16 a[202:203], v68 offset:50176
    ds_read_b64_tr_b16 a[204:205], v68 offset:53248
    ds_read_b64_tr_b16 a[206:207], v68 offset:54272
    s_waitcnt lgkmcnt(0)
    buffer_load_dword v72, v73, s[60:63], 0 offen sc1
    buffer_load_dwordx2 v[84:85], off, s[60:63], 0 offset:16 sc1
    s_waitcnt vmcnt(20)
    s_barrier
    s_mov_b32 s8, s46
    s_and_b32 s9, s47, 0xffff
    s_mov_b32 s10, 0x800000
    s_mov_b32 s11, 0x20000
    s_xor_b32 s32, s3, 0x0
    s_add_u32 m0, s36, 16384
    s_nop 0
    buffer_load_dwordx4 v66, s[8:11], s32 offen lds
    s_xor_b32 s32, s3, 0x1000
    s_add_u32 m0, s36, 17408
    s_nop 0
    buffer_load_dwordx4 v66, s[8:11], s32 offen lds
    s_xor_b32 s32, s3, 0x2000
    s_add_u32 m0, s36, 18432
    s_nop 0
    buffer_load_dwordx4 v66, s[8:11], s32 offen lds
    s_xor_b32 s32, s3, 0x3000
    s_add_u32 m0, s36, 19456
    s_nop 0
    buffer_load_dwordx4 v66, s[8:11], s32 offen lds
    s_xor_b32 s32, s3, 0x4000
    s_add_u32 m0, s36, 20480
    s_nop 0
    buffer_load_dwordx4 v66, s[8:11], s32 offen lds
    s_xor_b32 s32, s3, 0x5000
    s_add_u32 m0, s36, 21504
    s_nop 0
    buffer_load_dwordx4 v66, s[8:11], s32 offen lds
    s_xor_b32 s32, s3, 0x6000
    s_add_u32 m0, s36, 22528
    s_nop 0
    buffer_load_dwordx4 v66, s[8:11], s32 offen lds
    s_xor_b32 s32, s3, 0x7000
    s_add_u32 m0, s36, 23552
    s_nop 0
    buffer_load_dwordx4 v66, s[8:11], s32 offen lds
    ds_read_b64_tr_b16 a[80:81], v67 offset:24576
    ds_read_b64_tr_b16 a[82:83], v67 offset:25600
    ds_read_b64_tr_b16 a[84:85], v67 offset:28672
    ds_read_b64_tr_b16 a[86:87], v67 offset:29696
    ds_read_b64_tr_b16 a[88:89], v67 offset:57344
    ds_read_b64_tr_b16 a[90:91], v67 offset:58368
    ds_read_b64_tr_b16 a[92:93], v67 offset:61440
    ds_read_b64_tr_b16 a[94:95], v67 offset:62464
    ds_read_b64_tr_b16 a[208:209], v68 offset:24576
    ds_read_b64_tr_b16 a[210:211], v68 offset:25600
    ds_read_b64_tr_b16 a[212:213], v68 offset:28672
    ds_read_b64_tr_b16 a[214:215], v68 offset:29696
    ds_read_b64_tr_b16 a[216:217], v68 offset:57344
    ds_read_b64_tr_b16 a[218:219], v68 offset:58368
    ds_read_b64_tr_b16 a[220:221], v68 offset:61440
    ds_read_b64_tr_b16 a[222:223], v68 offset:62464
    s_waitcnt lgkmcnt(0)
    s_waitcnt vmcnt(19)
    s_barrier
    s_xor_b32 s32, s3, 0x10000
    s_add_u32 m0, s36, 24576
    s_nop 0
    buffer_load_dwordx4 v66, s[8:11], s32 offen lds
    s_xor_b32 s32, s3, 0x11000
    s_add_u32 m0, s36, 25600
    s_nop 0
    buffer_load_dwordx4 v66, s[8:11], s32 offen lds
    s_xor_b32 s32, s3, 0x12000
    s_add_u32 m0, s36, 26624
    s_nop 0
    buffer_load_dwordx4 v66, s[8:11], s32 offen lds
    s_xor_b32 s32, s3, 0x13000
    s_add_u32 m0, s36, 27648
    s_nop 0
    buffer_load_dwordx4 v66, s[8:11], s32 offen lds
    s_xor_b32 s32, s3, 0x14000
    s_add_u32 m0, s36, 28672
    s_nop 0
    buffer_load_dwordx4 v66, s[8:11], s32 offen lds
    s_xor_b32 s32, s3, 0x15000
    s_add_u32 m0, s36, 29696
    s_nop 0
    buffer_load_dwordx4 v66, s[8:11], s32 offen lds
    s_xor_b32 s32, s3, 0x16000
    s_add_u32 m0, s36, 30720
    s_nop 0
    buffer_load_dwordx4 v66, s[8:11], s32 offen lds
    s_xor_b32 s32, s3, 0x17000
    s_add_u32 m0, s36, 31744
    s_nop 0
    buffer_load_dwordx4 v66, s[8:11], s32 offen lds
    ds_read_b64_tr_b16 a[96:97], v67 offset:0
    ds_read_b64_tr_b16 a[98:99], v67 offset:1024
    ds_read_b64_tr_b16 a[100:101], v67 offset:4096
    ds_read_b64_tr_b16 a[102:103], v67 offset:5120
    ds_read_b64_tr_b16 a[104:105], v67 offset:32768
    ds_read_b64_tr_b16 a[106:107], v67 offset:33792
    ds_read_b64_tr_b16 a[108:109], v67 offset:36864
    ds_read_b64_tr_b16 a[110:111], v67 offset:37888
    ds_read_b64_tr_b16 a[224:225], v68 offset:0
    ds_read_b64_tr_b16 a[226:227], v68 offset:1024
    ds_read_b64_tr_b16 a[228:229], v68 offset:4096
    ds_read_b64_tr_b16 a[230:231], v68 offset:5120
    ds_read_b64_tr_b16 a[232:233], v68 offset:32768
    ds_read_b64_tr_b16 a[234:235], v68 offset:33792
    ds_read_b64_tr_b16 a[236:237], v68 offset:36864
    ds_read_b64_tr_b16 a[238:239], v68 offset:37888
    s_waitcnt lgkmcnt(0)
    s_waitcnt vmcnt(18)
    s_barrier
    s_mov_b32 s8, s44
    s_and_b32 s9, s45, 0xffff
    s_mov_b32 s10, 0x800000
    s_mov_b32 s11, 0x20000
    s_sub_u32 s39, 511, s44
    s_and_b32 s39, s39, 0x380
    s_andn2_b32 s32, s35, 0x1fff
    s_add_u32 s39, s39, s32
    s_add_u32 s32, s39, 0x200000
    buffer_load_dword v86, v77, s[8:11], s32 offen
    s_add_u32 s32, s35, 0x200000
    s_add_u32 m0, s36, 0
    s_nop 0
    buffer_load_dwordx4 v65, s[8:11], s32 offen lds
    s_add_u32 s32, s35, 0x204000
    s_add_u32 m0, s36, 1024
    s_nop 0
    buffer_load_dwordx4 v65, s[8:11], s32 offen lds
    s_add_u32 s32, s35, 0x210000
    s_add_u32 m0, s36, 2048
    s_nop 0
    buffer_load_dwordx4 v65, s[8:11], s32 offen lds
    s_add_u32 s32, s35, 0x214000
    s_add_u32 m0, s36, 3072
    s_nop 0
    buffer_load_dwordx4 v65, s[8:11], s32 offen lds
    s_add_u32 s32, s35, 0x220000
    s_add_u32 m0, s36, 4096
    s_nop 0
    buffer_load_dwordx4 v65, s[8:11], s32 offen lds
    s_add_u32 s32, s35, 0x224000
    s_add_u32 m0, s36, 5120
    s_nop 0
    buffer_load_dwordx4 v65, s[8:11], s32 offen lds
    s_add_u32 s32, s35, 0x230000
    s_add_u32 m0, s36, 6144
    s_nop 0
    buffer_load_dwordx4 v65, s[8:11], s32 offen lds
    s_add_u32 s32, s35, 0x234000
    s_add_u32 m0, s36, 7168
    s_nop 0
    buffer_load_dwordx4 v65, s[8:11], s32 offen lds
    ds_read_b64_tr_b16 a[112:113], v67 offset:8192
    ds_read_b64_tr_b16 a[114:115], v67 offset:9216
    ds_read_b64_tr_b16 a[116:117], v67 offset:12288
    ds_read_b64_tr_b16 a[118:119], v67 offset:13312
    ds_read_b64_tr_b16 a[120:121], v67 offset:40960
    ds_read_b64_tr_b16 a[122:123], v67 offset:41984
    ds_read_b64_tr_b16 a[124:125], v67 offset:45056
    ds_read_b64_tr_b16 a[126:127], v67 offset:46080
    ds_read_b64_tr_b16 a[240:241], v68 offset:8192
    ds_read_b64_tr_b16 a[242:243], v68 offset:9216
    ds_read_b64_tr_b16 a[244:245], v68 offset:12288
    ds_read_b64_tr_b16 a[246:247], v68 offset:13312
    ds_read_b64_tr_b16 a[248:249], v68 offset:40960
    ds_read_b64_tr_b16 a[250:251], v68 offset:41984
    ds_read_b64_tr_b16 a[252:253], v68 offset:45056
    ds_read_b64_tr_b16 a[254:255], v68 offset:46080
    s_waitcnt lgkmcnt(0)
    s_waitcnt vmcnt(17)
    s_barrier
    s_add_u32 s32, s39, 0x300000
    buffer_load_dword v86, v77, s[8:11], s32 offen
    s_add_u32 s32, s35, 0x300000
    s_add_u32 m0, s36, 8192
    s_nop 0
    buffer_load_dwordx4 v65, s[8:11], s32 offen lds
    s_add_u32 s32, s35, 0x304000
    s_add_u32 m0, s36, 9216
    s_nop 0
    buffer_load_dwordx4 v65, s[8:11], s32 offen lds
    s_add_u32 s32, s35, 0x310000
    s_add_u32 m0, s36, 10240
    s_nop 0
    buffer_load_dwordx4 v65, s[8:11], s32 offen lds
    s_add_u32 s32, s35, 0x314000
    s_add_u32 m0, s36, 11264
    s_nop 0
    buffer_load_dwordx4 v65, s[8:11], s32 offen lds
    s_add_u32 s32, s35, 0x320000
    s_add_u32 m0, s36, 12288
    s_nop 0
    buffer_load_dwordx4 v65, s[8:11], s32 offen lds
    s_add_u32 s32, s35, 0x324000
    s_add_u32 m0, s36, 13312
    s_nop 0
    buffer_load_dwordx4 v65, s[8:11], s32 offen lds
    s_add_u32 s32, s35, 0x330000
    s_add_u32 m0, s36, 14336
    s_nop 0
    buffer_load_dwordx4 v65, s[8:11], s32 offen lds
    s_add_u32 s32, s35, 0x334000
    s_add_u32 m0, s36, 15360
    s_nop 0
    buffer_load_dwordx4 v65, s[8:11], s32 offen lds
    v_readlane_b32 s48, v72, 0
    v_readlane_b32 s49, v72, 1
    v_readlane_b32 s50, v72, 2
    v_readlane_b32 s51, v72, 3
    v_readlane_b32 s52, v72, 4
    v_readlane_b32 s53, v72, 5
    v_readlane_b32 s54, v72, 6
    v_readlane_b32 s55, v72, 7
    v_readlane_b32 s38, v72, 8
    s_nop 3
    s_add_u32 s33, s48, s49
    s_add_u32 s33, s33, s50
    s_add_u32 s33, s33, s51
    s_add_u32 s33, s33, s52
    s_add_u32 s33, s33, s53
    s_add_u32 s33, s33, s54
    s_add_u32 s33, s33, s55
    s_cmp_ge_u32 s38, 4
    s_cselect_b32 s33, s33, 0
    s_cmp_ge_u32 s33, 256
    s_cselect_b32 s38, 0, 1
    ds_read_b64_tr_b16 v[192:193], v80 offset:16384
    ds_read_b64_tr_b16 v[194:195], v80 offset:17408
    ds_read_b64_tr_b16 v[196:197], v80 offset:20480
    ds_read_b64_tr_b16 v[198:199], v80 offset:21504
    ds_read_b64_tr_b16 v[208:209], v81 offset:16384
    ds_read_b64_tr_b16 v[210:211], v81 offset:17408
    ds_read_b64_tr_b16 v[212:213], v81 offset:20480
    ds_read_b64_tr_b16 v[214:215], v81 offset:21504
    ds_read_b64_tr_b16 v[224:225], v82 offset:16384
    ds_read_b64_tr_b16 v[226:227], v82 offset:17408
    ds_read_b64_tr_b16 v[228:229], v82 offset:20480
    ds_read_b64_tr_b16 v[230:231], v82 offset:21504
    ds_read_b64_tr_b16 v[240:241], v83 offset:16384
    ds_read_b64_tr_b16 v[242:243], v83 offset:17408
    ds_read_b64_tr_b16 v[244:245], v83 offset:20480
    ds_read_b64_tr_b16 v[246:247], v83 offset:21504
    s_waitcnt lgkmcnt(0)
    s_waitcnt vmcnt(18)
    s_barrier
    s_mov_b32 s8, s46
    s_and_b32 s9, s47, 0xffff
    s_mov_b32 s10, 0x800000
    s_mov_b32 s11, 0x20000
    s_xor_b32 s32, s3, 0x20000
    s_add_u32 m0, s36, 16384
    s_nop 0
    buffer_load_dwordx4 v66, s[8:11], s32 offen lds
    s_xor_b32 s32, s3, 0x21000
    s_add_u32 m0, s36, 17408
    s_nop 0
    buffer_load_dwordx4 v66, s[8:11], s32 offen lds
    s_xor_b32 s32, s3, 0x22000
    s_add_u32 m0, s36, 18432
    s_nop 0
    buffer_load_dwordx4 v66, s[8:11], s32 offen lds
    s_xor_b32 s32, s3, 0x23000
    s_add_u32 m0, s36, 19456
    s_nop 0
    buffer_load_dwordx4 v66, s[8:11], s32 offen lds
    s_xor_b32 s32, s3, 0x24000
    s_add_u32 m0, s36, 20480
    s_nop 0
    buffer_load_dwordx4 v66, s[8:11], s32 offen lds
    s_xor_b32 s32, s3, 0x25000
    s_add_u32 m0, s36, 21504
    s_nop 0
    buffer_load_dwordx4 v66, s[8:11], s32 offen lds
    s_xor_b32 s32, s3, 0x26000
    s_add_u32 m0, s36, 22528
    s_nop 0
    buffer_load_dwordx4 v66, s[8:11], s32 offen lds
    s_xor_b32 s32, s3, 0x27000
    s_add_u32 m0, s36, 23552
    s_nop 0
    buffer_load_dwordx4 v66, s[8:11], s32 offen lds
    ds_read_b64_tr_b16 v[200:201], v80 offset:24576
    ds_read_b64_tr_b16 v[202:203], v80 offset:25600
    ds_read_b64_tr_b16 v[204:205], v80 offset:28672
    ds_read_b64_tr_b16 v[206:207], v80 offset:29696
    ds_read_b64_tr_b16 v[216:217], v81 offset:24576
    ds_read_b64_tr_b16 v[218:219], v81 offset:25600
    ds_read_b64_tr_b16 v[220:221], v81 offset:28672
    ds_read_b64_tr_b16 v[222:223], v81 offset:29696
    ds_read_b64_tr_b16 v[232:233], v82 offset:24576
    ds_read_b64_tr_b16 v[234:235], v82 offset:25600
    ds_read_b64_tr_b16 v[236:237], v82 offset:28672
    ds_read_b64_tr_b16 v[238:239], v82 offset:29696
    ds_read_b64_tr_b16 v[248:249], v83 offset:24576
    ds_read_b64_tr_b16 v[250:251], v83 offset:25600
    ds_read_b64_tr_b16 v[252:253], v83 offset:28672
    ds_read_b64_tr_b16 v[254:255], v83 offset:29696
    s_waitcnt lgkmcnt(0)
    s_waitcnt vmcnt(17)
    s_barrier
    s_xor_b32 s32, s3, 0x30000
    s_add_u32 m0, s36, 24576
    s_nop 0
    buffer_load_dwordx4 v66, s[8:11], s32 offen lds
    s_xor_b32 s32, s3, 0x31000
    s_add_u32 m0, s36, 25600
    s_nop 0
    buffer_load_dwordx4 v66, s[8:11], s32 offen lds
    s_xor_b32 s32, s3, 0x32000
    s_add_u32 m0, s36, 26624
    s_nop 0
    buffer_load_dwordx4 v66, s[8:11], s32 offen lds
    s_xor_b32 s32, s3, 0x33000
    s_add_u32 m0, s36, 27648
    s_nop 0
    buffer_load_dwordx4 v66, s[8:11], s32 offen lds
    s_xor_b32 s32, s3, 0x34000
    s_add_u32 m0, s36, 28672
    s_nop 0
    buffer_load_dwordx4 v66, s[8:11], s32 offen lds
    s_xor_b32 s32, s3, 0x35000
    s_add_u32 m0, s36, 29696
    s_nop 0
    buffer_load_dwordx4 v66, s[8:11], s32 offen lds
    s_xor_b32 s32, s3, 0x36000
    s_add_u32 m0, s36, 30720
    s_nop 0
    buffer_load_dwordx4 v66, s[8:11], s32 offen lds
    s_xor_b32 s32, s3, 0x37000
    s_add_u32 m0, s36, 31744
    s_nop 0
    buffer_load_dwordx4 v66, s[8:11], s32 offen lds
    ds_read_b64_tr_b16 v[0:1], v69 offset:0
    ds_read_b64_tr_b16 v[2:3], v69 offset:1024
    ds_read_b64_tr_b16 v[4:5], v69 offset:4096
    ds_read_b64_tr_b16 v[6:7], v69 offset:5120
    ds_read_b64_tr_b16 v[8:9], v69 offset:32768
    ds_read_b64_tr_b16 v[10:11], v69 offset:33792
    ds_read_b64_tr_b16 v[12:13], v69 offset:36864
    ds_read_b64_tr_b16 v[14:15], v69 offset:37888
    ds_read_b64_tr_b16 v[16:17], v70 offset:0
    ds_read_b64_tr_b16 v[18:19], v70 offset:1024
    ds_read_b64_tr_b16 v[20:21], v70 offset:4096
    ds_read_b64_tr_b16 v[22:23], v70 offset:5120
    ds_read_b64_tr_b16 v[24:25], v70 offset:32768
    ds_read_b64_tr_b16 v[26:27], v70 offset:33792
    ds_read_b64_tr_b16 v[28:29], v70 offset:36864
    ds_read_b64_tr_b16 v[30:31], v70 offset:37888
    s_waitcnt lgkmcnt(0)
    v_and_b32 v64, 15, v94
    v_lshrrev_b32 v65, 4, v94
    v_mov_b32 v66, 0x3c00
    v_mov_b32 v67, 0x3c000000
    v_cmp_eq_u32 vcc, 0, v64
    s_nop 1
    v_cndmask_b32 v127, 0, v66, vcc
    v_cmp_eq_u32 vcc, 1, v64
    s_nop 1
    v_cndmask_b32 v106, v127, v67, vcc
    v_cmp_eq_u32 vcc, 2, v64
    s_nop 1
    v_cndmask_b32 v127, 0, v66, vcc
    v_cmp_eq_u32 vcc, 3, v64
    s_nop 1
    v_cndmask_b32 v107, v127, v67, vcc
    v_cmp_eq_u32 vcc, 4, v64
    s_nop 1
    v_cndmask_b32 v127, 0, v66, vcc
    v_cmp_eq_u32 vcc, 5, v64
    s_nop 1
    v_cndmask_b32 v108, v127, v67, vcc
    v_cmp_eq_u32 vcc, 6, v64
    s_nop 1
    v_cndmask_b32 v127, 0, v66, vcc
    v_cmp_eq_u32 vcc, 7, v64
    s_nop 1
    v_cndmask_b32 v109, v127, v67, vcc
    v_mov_b32 v66, 0x3f80
    v_mov_b32 v67, 0x3f800000
    v_and_b32 v126, 1, v65
    v_lshrrev_b32 v68, 1, v65
    v_lshl_add_u32 v126, v126, 2, v68
    v_sub_u32 v68, v64, v126
    v_cmp_eq_u32 vcc, 0, v68
    s_nop 1
    v_cndmask_b32 v127, 0, v66, vcc
    v_cmp_eq_u32 vcc, 2, v68
    s_nop 1
    v_cndmask_b32 v102, v127, v67, vcc
    v_cmp_eq_u32 vcc, 0, v68
    s_nop 1
    v_cndmask_b32 v127, 0, v66, vcc
    v_cmp_eq_u32 vcc, 2, v68
    s_nop 1
    v_cndmask_b32 v103, v127, v67, vcc
    v_cmp_eq_u32 vcc, 8, v68
    s_nop 1
    v_cndmask_b32 v127, 0, v66, vcc
    v_cmp_eq_u32 vcc, 10, v68
    s_nop 1
    v_cndmask_b32 v104, v127, v67, vcc
    v_cmp_eq_u32 vcc, 8, v68
    s_nop 1
    v_cndmask_b32 v127, 0, v66, vcc
    v_cmp_eq_u32 vcc, 10, v68
    s_nop 1
    v_cndmask_b32 v105, v127, v67, vcc
    v_mov_b32 v100, 0x3f003f00
    v_mov_b32 v101, 0x3f003f00
    v_and_b32 v126, 7, v64
    v_lshlrev_b32 v126, 4, v126
    v_lshl_add_u32 v114, v65, 7, v126
    v_lshrrev_b32 v126, 3, v64
    v_lshl_add_u32 v119, v126, 3, v114
    v_lshl_add_u32 v118, v126, 11, v114
    v_lshl_add_u32 v118, s14, 9, v118
    v_lshlrev_b32 v126, 4, v64
    v_lshl_add_u32 v120, v65, 13, v126
    v_lshlrev_b32 v123, 3, v94
    s_lshl_b32 s32, s14, 10
    s_add_u32 s32, s32, 16384
    v_and_b32 v126, 32, v94
    v_lshlrev_b32 v126, 1, v126
    v_xor_b32 v126, v126, v123
    v_add_u32 v124, s32, v126
    v_lshrrev_b32 v126, 2, v64
    v_lshrrev_b32 v127, 1, v65
    v_lshl_add_u32 v126, v126, 1, v127
    v_and_b32 v127, 3, v64
    v_lshl_add_u32 v126, v126, 2, v127
    v_and_b32 v127, 1, v65
    v_lshl_add_u32 v126, v126, 1, v127
    v_lshlrev_b32 v126, 3, v126
    v_mov_b32 v95, 0x7f000000
    v_mov_b32 v66, 0x4444
    v_mov_b32 v67, 0xeeee
    v_cmp_gt_u32 vcc, 8, v64
    s_nop 1
    v_cndmask_b32 v122, v95, v126, vcc
    v_cndmask_b32 v125, v114, v95, vcc
    v_cndmask_b32 v110, v67, v66, vcc
    v_lshrrev_b32 v126, 2, v94
    v_lshlrev_b32 v126, 3, v126
    v_and_b32 v127, 2, v94
    v_lshlrev_b32 v127, 5, v127
    v_xor_b32 v126, v126, v127
    v_and_b32 v127, 3, v94
    v_lshl_add_u32 v115, v127, 7, v126
    s_mov_b32 s37, 0x3f80
    s_mov_b32 s57, 0x3f800000
    s_and_b32 s32, s14, 1
    s_lshr_b32 s33, s14, 1
    s_lshl2_add_u32 s32, s32, s33
    s_lshl_b32 s59, s32, 9
    s_mov_b32 s17, 0
    s_mov_b32 s0, 0x00ff00ff
    s_mov_b32 s1, s0
    s_mov_b64 s[44:45], s[0:1]
    s_lshl_b32 s32, s12, 18
    s_lshl2_add_u32 s33, s13, s14
    s_lshl_b32 s34, s33, 11
    s_add_u32 s28, s34, 0x2800000
    s_add_u32 s21, s32, s34
    s_add_u32 s21, s21, 0x6c00000
    s_lshl_b32 s34, s13, 8
    s_add_u32 s23, s32, s34
    s_add_u32 s23, s23, 0x6c80000
    s_lshl_b32 s32, s12, 13
    s_add_u32 s25, s32, 0x6d00000
    s_add_u32 s24, s25, s34
    s_lshl_b32 s34, s33, 9
    s_add_u32 s26, s34, 0x8000000
    s_add_u32 s31, s34, 0x6e00000
    s_cmp_eq_u32 s12, 0
    s_cselect_b32 s26, s26, s31
    s_lshl_b32 s32, s12, 7
    s_add_u32 s32, s32, s33
    s_cmp_eq_u32 s32, 1
    s_mov_b32 s39, 0x7f000000
    s_cselect_b32 s39, 0x841ec04, s39
    s_lshl_b32 s27, s13, 12
    s_lshl_b32 s36, s14, 11
    s_and_b32 s33, s36, 2048
    s_add_u32 s27, s27, s33
    s_lshr_b32 s33, s14, 1
    s_lshl_b32 s33, s33, 17
    s_add_u32 s27, s27, s33
    s_add_u32 s27, s27, 0x1800000
    s_add_u32 s36, s36, 24576
    v_add_u32 v112, 24576, v116
    s_lshl_b32 s32, s12, 12
    s_add_u32 s32, s32, 0x841c000
    s_lshl2_add_u32 s46, s13, s32
    v_lshl_add_u32 v117, v123, 25, v114
    s_and_b32 s33, s13, 3
    s_lshl_b32 s33, s33, 7
    s_add_u32 s47, s32, s33
    s_cmp_eq_u32 s14, 0
    s_cselect_b32 s47, s47, 0x7f000000
    s_cselect_b32 s11, -1, 0
    s_mov_b32 s30, 0x3e0293ee
    v_mov_b32 v121, 0x7f000000
    v_and_b32 v127, 1, v94
    s_mov_b32 exec_lo, 0
    s_mov_b32 exec_hi, 0x300
    s_lshl_b32 s32, s13, 8
    s_add_u32 s32, s32, 0x8406000
    v_lshl_add_u32 v121, v127, 13, s32
    s_mov_b32 exec_hi, 0x3c00
    s_mov_b32 s32, 0x841760c
    v_lshl_add_u32 v121, v64, 8, s32
    s_mov_b64 exec, -1
    s_waitcnt vmcnt(16)
    s_barrier
    ds_write_b128 v113, v[0:3] offset:0
    ds_write_b128 v113, v[4:7] offset:1024
    ds_write_b128 v113, v[8:11] offset:2048
    ds_write_b128 v113, v[12:15] offset:3072
    ds_write_b128 v113, v[16:19] offset:4096
    ds_write_b128 v113, v[20:23] offset:5120
    ds_write_b128 v113, v[24:27] offset:6144
    ds_write_b128 v113, v[28:31] offset:7168
    ds_read_b64_tr_b16 v[32:33], v69 offset:8192
    ds_read_b64_tr_b16 v[34:35], v69 offset:9216
    ds_read_b64_tr_b16 v[36:37], v69 offset:12288
    ds_read_b64_tr_b16 v[38:39], v69 offset:13312
    ds_read_b64_tr_b16 v[40:41], v69 offset:40960
    ds_read_b64_tr_b16 v[42:43], v69 offset:41984
    ds_read_b64_tr_b16 v[44:45], v69 offset:45056
    ds_read_b64_tr_b16 v[46:47], v69 offset:46080
    ds_read_b64_tr_b16 v[48:49], v70 offset:8192
    ds_read_b64_tr_b16 v[50:51], v70 offset:9216
    ds_read_b64_tr_b16 v[52:53], v70 offset:12288
    ds_read_b64_tr_b16 v[54:55], v70 offset:13312
    ds_read_b64_tr_b16 v[56:57], v70 offset:40960
    ds_read_b64_tr_b16 v[58:59], v70 offset:41984
    ds_read_b64_tr_b16 v[60:61], v70 offset:45056
    ds_read_b64_tr_b16 v[62:63], v70 offset:46080
    s_waitcnt lgkmcnt(0)
    s_waitcnt vmcnt(8)
    s_barrier
    ds_write_b128 v113, v[32:35] offset:8192
    ds_write_b128 v113, v[36:39] offset:9216
    ds_write_b128 v113, v[40:43] offset:10240
    ds_write_b128 v113, v[44:47] offset:11264
    ds_write_b128 v113, v[48:51] offset:12288
    ds_write_b128 v113, v[52:55] offset:13312
    ds_write_b128 v113, v[56:59] offset:14336
    ds_write_b128 v113, v[60:63] offset:15360
    buffer_load_dword v76, v74, s[4:7], 0 offen sc1
    buffer_load_dword v79, v75, s[4:7], 0 offen sc1
    ds_read_b64_tr_b16 v[0:1], v80 offset:16384
    ds_read_b64_tr_b16 v[2:3], v80 offset:17408
    ds_read_b64_tr_b16 v[4:5], v80 offset:20480
    ds_read_b64_tr_b16 v[6:7], v80 offset:21504
    ds_read_b64_tr_b16 v[8:9], v81 offset:16384
    ds_read_b64_tr_b16 v[10:11], v81 offset:17408
    ds_read_b64_tr_b16 v[12:13], v81 offset:20480
    ds_read_b64_tr_b16 v[14:15], v81 offset:21504
    ds_read_b64_tr_b16 v[16:17], v82 offset:16384
    ds_read_b64_tr_b16 v[18:19], v82 offset:17408
    ds_read_b64_tr_b16 v[20:21], v82 offset:20480
    ds_read_b64_tr_b16 v[22:23], v82 offset:21504
    ds_read_b64_tr_b16 v[24:25], v83 offset:16384
    ds_read_b64_tr_b16 v[26:27], v83 offset:17408
    ds_read_b64_tr_b16 v[28:29], v83 offset:20480
    ds_read_b64_tr_b16 v[30:31], v83 offset:21504
    s_waitcnt lgkmcnt(0)
    ds_write_b128 v113, v[0:3] offset:16384
    ds_write_b128 v113, v[4:7] offset:17408
    ds_write_b128 v113, v[8:11] offset:18432
    ds_write_b128 v113, v[12:15] offset:19456
    ds_write_b128 v113, v[16:19] offset:20480
    ds_write_b128 v113, v[20:23] offset:21504
    ds_write_b128 v113, v[24:27] offset:22528
    ds_write_b128 v113, v[28:31] offset:23552
    s_waitcnt lgkmcnt(0)
    s_waitcnt vmcnt(2)
    s_waitcnt vmcnt(0)
    v_min_u32 v76, v76, v79
    v_cmp_eq_u32 vcc, 0, v76
    s_cmp_eq_u32 s38, 0
    s_cbranch_scc0 main_kernel_c_sl0
    s_cbranch_vccnz main_kernel_c_sl1
    s_branch main_kernel_c_kv0_ok
main_kernel_c_sl0:
    v_and_b32 v126, 7, v94
    v_lshlrev_b32 v126, 5, v126
main_kernel_c_mode_cnt:
    buffer_load_dword v127, v126, s[60:63], 0 offen sc1
    s_waitcnt vmcnt(0)
    v_readlane_b32 s48, v127, 0
    v_readlane_b32 s49, v127, 1
    v_readlane_b32 s50, v127, 2
    v_readlane_b32 s51, v127, 3
    v_readlane_b32 s52, v127, 4
    v_readlane_b32 s53, v127, 5
    v_readlane_b32 s54, v127, 6
    v_readlane_b32 s55, v127, 7
    s_nop 3
    s_add_u32 s33, s48, s49
    s_add_u32 s33, s33, s50
    s_add_u32 s33, s33, s51
    s_add_u32 s33, s33, s52
    s_add_u32 s33, s33, s53
    s_add_u32 s33, s33, s54
    s_add_u32 s33, s33, s55
    s_cmp_ge_u32 s33, 256
    s_cbranch_scc1 main_kernel_c_mode_cnt_ok
    s_sub_u32 s29, s29, 1
    s_cbranch_scc1 main_kernel_end
    s_sleep 4
    s_branch main_kernel_c_mode_cnt
main_kernel_c_mode_cnt_ok:
    v_mov_b32 v126, 0
main_kernel_c_wa:
    buffer_load_dword v127, v126, s[60:63], 0 offen offset:12 sc1
    s_waitcnt vmcnt(0)
    v_cmp_gt_u32 vcc, 4, v127
    s_cbranch_vccz main_kernel_c_wa_ok
    s_sleep 4
    s_sub_u32 s29, s29, 1
    s_cbranch_scc0 main_kernel_c_wa
    s_branch main_kernel_end
main_kernel_c_wa_ok:
main_kernel_c_sl1:
    v_lshlrev_b32 v126, 2, v94
    s_mov_b32 s32, 0x841f000
main_kernel_c_wf:
    buffer_load_dword v0, v126, s[4:7], s32 offen sc1
    s_waitcnt vmcnt(0)
    v_cmp_eq_u32 vcc, 0, v0
    s_cbranch_vccz main_kernel_c_wf_ok
    s_sleep 4
    s_sub_u32 s29, s29, 1
    s_cbranch_scc0 main_kernel_c_wf
    s_branch main_kernel_end
main_kernel_c_wf_ok:
    s_mov_b32 exec_lo, 0
    s_mov_b32 exec_hi, 0x300
    v_subrev_u32 v127, 0, v121
main_kernel_c_kv0:
    buffer_load_dword v126, v127, s[4:7], 0 offen sc1
    s_waitcnt vmcnt(0)
    v_cmp_eq_u32 vcc, 0, v126
    s_cbranch_vccz main_kernel_c_kv0_ok
    s_sleep 2
    s_sub_u32 s29, s29, 1
    s_cbranch_scc0 main_kernel_c_kv0
    s_branch main_kernel_end
main_kernel_c_kv0_ok:
    s_mov_b32 exec_lo, 0
    s_mov_b32 exec_hi, 0x100
    v_add_u32 v121, 4, v121
    s_mov_b64 exec, -1
    v_add_u32 v121, 4, v121
    v_lshlrev_b32 v126, 3, v116
    v_and_b32 v126, 0x780, v126
    v_bfe_u32 v127, v116, 8, 1
    v_lshl_add_u32 v126, v127, 19, v126
    s_mov_b32 m0, s36
    buffer_load_dword v111, v126, s[4:7], s21 offen sc1
    buffer_load_dwordx4 v116, s[4:7], s27 offen offset:0 sc1 lds
    buffer_load_dwordx4 v116, s[4:7], s27 offen offset:1024 sc1 lds
    s_lshl_b32 s32, s14, 11
    s_add_u32 m0, s32, 0
    s_add_u32 s32, s32, s25
    buffer_load_dwordx4 v116, s[4:7], s32 offen offset:0 sc1 lds
    buffer_load_dwordx4 v116, s[4:7], s32 offen offset:1024 sc1 lds
    s_add_u32 s27, s27, 0x40000
    ds_read_b64_tr_b16 v[32:33], v80 offset:24576
    ds_read_b64_tr_b16 v[34:35], v80 offset:25600
    ds_read_b64_tr_b16 v[36:37], v80 offset:28672
    ds_read_b64_tr_b16 v[38:39], v80 offset:29696
    ds_read_b64_tr_b16 v[40:41], v81 offset:24576
    ds_read_b64_tr_b16 v[42:43], v81 offset:25600
    ds_read_b64_tr_b16 v[44:45], v81 offset:28672
    ds_read_b64_tr_b16 v[46:47], v81 offset:29696
    ds_read_b64_tr_b16 v[48:49], v82 offset:24576
    ds_read_b64_tr_b16 v[50:51], v82 offset:25600
    ds_read_b64_tr_b16 v[52:53], v82 offset:28672
    ds_read_b64_tr_b16 v[54:55], v82 offset:29696
    ds_read_b64_tr_b16 v[56:57], v83 offset:24576
    ds_read_b64_tr_b16 v[58:59], v83 offset:25600
    ds_read_b64_tr_b16 v[60:61], v83 offset:28672
    ds_read_b64_tr_b16 v[62:63], v83 offset:29696
    s_waitcnt lgkmcnt(0)
    ds_write_b128 v113, v[32:35] offset:24576
    ds_write_b128 v113, v[36:39] offset:25600
    ds_write_b128 v113, v[40:43] offset:26624
    ds_write_b128 v113, v[44:47] offset:27648
    ds_write_b128 v113, v[48:51] offset:28672
    ds_write_b128 v113, v[52:55] offset:29696
    ds_write_b128 v113, v[56:59] offset:30720
    ds_write_b128 v113, v[60:63] offset:31744
    s_waitcnt lgkmcnt(0)
main_kernel_c_nb:
    v_readfirstlane_b32 s33, v84
    v_readfirstlane_b32 s32, v85
    s_nop 3
    s_and_b32 s34, s32, s33
    s_cbranch_scc1 main_kernel_c_nb_ok
    buffer_load_dwordx2 v[84:85], off, s[60:63], 0 offset:16 sc1
    s_sub_u32 s29, s29, 1
    s_cbranch_scc1 main_kernel_end
    s_waitcnt vmcnt(0)
    s_branch main_kernel_c_nb
main_kernel_c_nb_ok:
    s_and_b32 s33, s33, 1
    s_lshl_b32 s32, s12, 5
    s_add_u32 s32, s32, s13
    s_lshl1_add_u32 s32, s32, s33
    s_lshl2_add_u32 s32, s32, s14
    s_lshl_b32 s32, s32, 11
    s_add_u32 s18, s32, 0x8c00000
    s_xor_b32 s19, s18, 0x80000
    v_mov_b32 v64, 0
    v_mov_b32 v65, 0
    v_mov_b32 v66, 0
    v_mov_b32 v67, 0
    v_mov_b32 v68, 0
    v_mov_b32 v69, 0
    v_mov_b32 v70, 0
    v_mov_b32 v71, 0
    v_mov_b32 v96, 0
    v_mov_b32 v97, 0
    v_mov_b32 v98, 0
    v_mov_b32 v99, 0
    s_xor_b32 s36, s36, 0x4000
    s_waitcnt vmcnt(0)
    buffer_store_dword v64, off, s[4:7], s18 offset:1536 sc1
    s_mov_b32 m0, s36
    buffer_load_dwordx4 v[88:91], v116, s[4:7], s28 offen offset:0 sc1
    buffer_load_dwordx4 v116, s[4:7], s27 offen offset:0 sc1 lds
    buffer_load_dwordx4 v[92:95], v116, s[4:7], s28 offen offset:1024 sc1
    s_barrier
    s_memrealtime s[32:33]
    s_waitcnt lgkmcnt(0)
    s_mul_i32 s32, s32, 22
    s_sub_u32 s20, s32, 0x40000
    s_mov_b32 s9, 0
    s_mov_b32 s10, 0
    s_memtime s[52:53]
    s_waitcnt lgkmcnt(0)
    s_sub_u32 s38, s52, s32
    s_sub_u32 s3, s52, 0x4000
    v_mov_b32 v126, s38
    ds_write_b32 v123, v126 offset:20992
    s_waitcnt lgkmcnt(0)
    s_min_u32 s32, s48, s49
    s_cmp_ge_u32 s32, 32
    s_cbranch_scc0 main_kernel_cs_top
    .p2align 6
main_kernel_cf_top:
    s_barrier
main_kernel_cf_mrd:
    ds_read_b128 v[0:3], v114 offset:0
    ds_read_b128 v[4:7], v114 offset:512
    ds_read_b128 v[8:11], v114 offset:1024
    ds_read_b128 v[12:15], v114 offset:1536
    ds_read_b128 v[16:19], v114 offset:2048
    s_waitcnt lgkmcnt(4)
    v_smfmac_f32_16x16x64_bf16 v[96:99], v[0:3], a[0:7], v110
    ds_read_b128 v[20:23], v114 offset:2560
    s_waitcnt lgkmcnt(4)
    v_smfmac_f32_16x16x64_bf16 v[96:99], v[4:7], a[8:15], v110
    ds_read_b128 v[24:27], v114 offset:3072
    s_waitcnt lgkmcnt(4)
    s_bfe_u32 s22, s17, 0x10001
    v_smfmac_f32_16x16x64_bf16 v[96:99], v[8:11], a[16:23], v110
    ds_read_b128 v[28:31], v114 offset:3584
    s_waitcnt lgkmcnt(4)
    v_smfmac_f32_16x16x64_bf16 v[96:99], v[12:15], a[24:31], v110
    ds_read_b128 v[32:35], v114 offset:4096
    s_waitcnt lgkmcnt(4)
    v_smfmac_f32_16x16x64_bf16 v[96:99], v[16:19], a[32:39], v110
    ds_read_b128 v[36:39], v114 offset:4608
    s_waitcnt lgkmcnt(4)
    v_smfmac_f32_16x16x64_bf16 v[96:99], v[20:23], a[40:47], v110
    ds_read_b128 v[40:43], v114 offset:5120
    s_waitcnt lgkmcnt(4)
    v_smfmac_f32_16x16x64_bf16 v[96:99], v[24:27], a[48:55], v110
    ds_read_b128 v[44:47], v114 offset:5632
    s_waitcnt lgkmcnt(4)
    v_smfmac_f32_16x16x64_bf16 v[96:99], v[28:31], a[56:63], v110
    ds_read_b128 v[48:51], v114 offset:6144
    s_waitcnt lgkmcnt(4)
    v_smfmac_f32_16x16x64_bf16 v[96:99], v[32:35], a[64:71], v110
    ds_read_b128 v[52:55], v114 offset:6656
    s_waitcnt lgkmcnt(4)
    v_smfmac_f32_16x16x64_bf16 v[96:99], v[36:39], a[72:79], v110
    ds_read_b128 v[56:59], v114 offset:7168
    s_waitcnt lgkmcnt(4)
    v_smfmac_f32_16x16x64_bf16 v[96:99], v[40:43], a[80:87], v110
    ds_read_b128 v[60:63], v114 offset:7680
    s_waitcnt lgkmcnt(4)
    v_smfmac_f32_16x16x64_bf16 v[96:99], v[44:47], a[88:95], v110
    s_waitcnt lgkmcnt(3)
    buffer_load_dword v111, v121, s[4:7], 0 offen sc1
    v_smfmac_f32_16x16x64_bf16 v[96:99], v[48:51], a[96:103], v110
    s_waitcnt lgkmcnt(2)
    ds_read_b128 v[80:83], v113 offset:0
    v_smfmac_f32_16x16x64_bf16 v[96:99], v[52:55], a[104:111], v110
    s_waitcnt lgkmcnt(2)
    ds_read_b128 v[84:87], v113 offset:1024
    v_smfmac_f32_16x16x64_bf16 v[96:99], v[56:59], a[112:119], v110
    s_waitcnt lgkmcnt(2)
    v_smfmac_f32_16x16x64_bf16 v[96:99], v[60:63], a[120:127], v110
    v_smfmac_f32_16x16x64_bf16 v[68:71], v[0:3], a[128:135], v110
    ds_read_b128 v[72:75], v113 offset:2048
    v_smfmac_f32_16x16x64_bf16 v[68:71], v[4:7], a[136:143], v110
    s_nop 1
    v_pk_add_f32 v[126:127], v[96:97], v[98:99]
    ds_read_b128 v[76:79], v113 offset:3072
    v_smfmac_f32_16x16x64_bf16 v[68:71], v[8:11], a[144:151], v110
    v_cmp_u_f32 vcc, v126, v127
    v_smfmac_f32_16x16x64_bf16 v[68:71], v[12:15], a[152:159], v110
    v_cvt_pk_bf16_f32 v126, v96, v97
    v_smfmac_f32_16x16x64_bf16 v[68:71], v[16:19], a[160:167], v110
    v_cvt_pk_bf16_f32 v127, v98, v99
    s_and_b64 s[42:43], vcc, s[44:45]
    s_cbranch_scc1 main_kernel_cf_m_f
    v_smfmac_f32_16x16x64_bf16 v[68:71], v[20:23], a[168:175], v110
    v_bfi_b32 v126, 1, s22, v126
    buffer_store_dwordx2 v[126:127], v123, s[4:7], s18 offen sc1
    v_smfmac_f32_16x16x64_bf16 v[68:71], v[24:27], a[176:183], v110
    s_mov_b64 s[44:45], s[0:1]
    v_smfmac_f32_16x16x64_bf16 v[68:71], v[28:31], a[184:191], v110
    s_add_u32 s17, s17, 1
    s_bfe_u32 s40, s17, 0x10001
    v_smfmac_f32_16x16x64_bf16 v[68:71], v[32:35], a[192:199], v110
    s_add_u32 s28, s28, 0x40000
    s_mov_b32 m0, s36
    v_smfmac_f32_16x16x64_bf16 v[68:71], v[36:39], a[200:207], v110
    s_add_u32 s34, s3, 2100
    v_smfmac_f32_16x16x64_bf16 v[68:71], v[40:43], a[208:215], v110
    v_smfmac_f32_16x16x64_bf16 v[68:71], v[44:47], a[216:223], v110
    v_smfmac_f32_16x16x64_bf16 v[68:71], v[48:51], a[224:231], v110
    v_smfmac_f32_16x16x64_bf16 v[68:71], v[52:55], a[232:239], v110
    v_smfmac_f32_16x16x64_bf16 v[68:71], v[56:59], a[240:247], v110
    v_smfmac_f32_16x16x64_bf16 v[68:71], v[60:63], a[248:255], v110
    s_waitcnt lgkmcnt(2)
    v_smfmac_f32_16x16x64_bf16 v[64:67], v[32:35], v[80:87], v110
    s_waitcnt lgkmcnt(0)
    s_nop 3
    v_cvt_pk_bf16_f32 v126, v68, v69
    v_cvt_pk_bf16_f32 v127, v70, v71
    v_bfi_b32 v126, 1, s22, v126
    buffer_store_dwordx2 v[126:127], v123, s[4:7], s18 offen offset:512 sc1
    ds_read_b128 v[80:83], v113 offset:4096
    v_smfmac_f32_16x16x64_bf16 v[64:67], v[36:39], v[72:79], v110
    ds_read_b128 v[84:87], v113 offset:5120
    v_smfmac_f32_16x16x64_bf16 v[64:67], v[0:3], v[128:135], v110
    ds_read_b128 v[72:75], v113 offset:6144
    v_smfmac_f32_16x16x64_bf16 v[64:67], v[4:7], v[136:143], v110
    ds_read_b128 v[76:79], v113 offset:7168
    v_smfmac_f32_16x16x64_bf16 v[64:67], v[8:11], v[144:151], v110
    ds_read_b128 v[32:35], v113 offset:8192
    v_smfmac_f32_16x16x64_bf16 v[64:67], v[12:15], v[152:159], v110
    ds_read_b128 v[36:39], v113 offset:9216
    v_smfmac_f32_16x16x64_bf16 v[64:67], v[16:19], v[160:167], v110
    ds_read_b128 v[0:3], v113 offset:10240
    s_memtime s[52:53]
    v_smfmac_f32_16x16x64_bf16 v[64:67], v[20:23], v[168:175], v110
    ds_read_b128 v[4:7], v113 offset:11264
    s_memtime s[52:53]
    s_xor_b32 s32, s9, s22
    s_bitcmp1_b32 s32, 0
    s_cbranch_scc1 main_kernel_cf_t_p
main_kernel_cf_t_ok:
    s_sub_u32 s32, s9, s10
    v_smfmac_f32_16x16x64_bf16 v[64:67], v[24:27], v[176:183], v110
    ds_read_b128 v[8:11], v113 offset:12288
    s_memtime s[52:53]
    s_max_i32 s32, s32, 0
    s_min_i32 s32, s32, 0x4000
    v_smfmac_f32_16x16x64_bf16 v[64:67], v[28:31], v[184:191], v110
    s_waitcnt lgkmcnt(7)
    ds_read_b128 v[12:15], v113 offset:13312
    s_memtime s[52:53]
    s_add_u32 s34, s34, s32
    s_and_b32 s34, s34, s11
    v_smfmac_f32_16x16x64_bf16 v[64:67], v[40:43], v[80:87], v110
    s_waitcnt lgkmcnt(6)
    ds_read_b128 v[16:19], v113 offset:14336
    s_cmp_lt_u32 s52, s34
    s_cbranch_scc1 main_kernel_cf_t_w
main_kernel_cf_t_go:
    s_barrier
    buffer_load_dwordx2 v[126:127], v123, s[4:7], s19 offen offset:0 sc1
    v_smfmac_f32_16x16x64_bf16 v[64:67], v[44:47], v[72:79], v110
    s_waitcnt lgkmcnt(5)
    ds_read_b128 v[20:23], v113 offset:15360
    v_smfmac_f32_16x16x64_bf16 v[64:67], v[48:51], v[32:39], v110
    s_waitcnt lgkmcnt(4)
    v_smfmac_f32_16x16x64_bf16 v[64:67], v[52:55], v[0:7], v110
    s_waitcnt lgkmcnt(2)
    ds_read_b128 v[24:27], v112 offset:6144
    ds_read_b128 v[28:31], v112 offset:7168
    v_smfmac_f32_16x16x64_bf16 v[64:67], v[56:59], v[8:15], v110
    s_waitcnt lgkmcnt(2)
    ds_read_b128 v[0:3], v112 offset:0
    ds_read_b128 v[4:7], v112 offset:1024
    v_smfmac_f32_16x16x64_bf16 v[64:67], v[60:63], v[16:23], v110
    ds_read_b128 v[8:11], v112 offset:2048
    ds_read_b128 v[12:15], v112 offset:3072
    ds_read_b128 v[16:19], v112 offset:4096
    ds_read_b128 v[20:23], v112 offset:5120
    v_mov_b32 v76, 0
    v_mov_b32 v77, 0
    v_mov_b32 v78, 0
    s_nop 0
    v_permlane32_swap_b32 v64, v65
    v_permlane32_swap_b32 v66, v67
    v_cvt_pk_bf16_f32 v84, v64, v66
    v_cvt_pk_bf16_f32 v85, v65, v67
    v_bfi_b32 v84, 1, s22, v84
    buffer_load_dwordx2 v[42:43], v123, s[4:7], s19 offen offset:512 sc1
    v_mov_b32 v79, 0
    v_mov_b32 v80, 0
    v_mov_b32 v81, 0
    v_mov_b32 v82, 0
    v_mov_b32 v83, 0
    v_mov_b32 v60, 0
    v_mov_b32 v60, 0
    v_mov_b32 v60, 0
    v_mov_b32 v60, 0
    v_mov_b32 v60, 0
    v_mov_b32 v60, 0
    v_mov_b32 v60, 0
    buffer_store_dwordx2 v[84:85], v123, s[4:7], s18 offen offset:1024 sc1
    v_mov_b32 v60, 0
    v_mov_b32 v60, 0
    v_mov_b32 v60, 0
    v_mov_b32 v60, 0
    v_mov_b32 v60, 0
    v_mov_b32 v60, 0
    v_mov_b32 v60, 0
    v_mov_b32 v60, 0
    v_mov_b32 v60, 0
    v_mov_b32 v60, 0
    v_mov_b32 v60, 0
    v_mov_b32 v60, 0
    v_mov_b32 v60, 0
    v_mov_b32 v60, 0
    v_mov_b32 v60, 0
    v_mov_b32 v60, 0
    v_mov_b32 v60, 0
    v_mov_b32 v60, 0
    v_mov_b32 v60, 0
    v_mov_b32 v60, 0
    v_mov_b32 v60, 0
    v_mov_b32 v60, 0
    v_mov_b32 v60, 0
    v_mov_b32 v60, 0
    v_mov_b32 v60, 0
    v_mov_b32 v60, 0
    v_mov_b32 v60, 0
    v_mov_b32 v60, 0
    v_mov_b32 v60, 0
    v_mov_b32 v60, 0
    v_mov_b32 v60, 0
    v_mov_b32 v60, 0
    v_mov_b32 v60, 0
    v_mov_b32 v60, 0
    v_mov_b32 v60, 0
    v_mov_b32 v60, 0
    v_mov_b32 v60, 0
    v_mov_b32 v60, 0
    s_waitcnt vmcnt(2)
main_kernel_cf_z0:
    v_dot2_f32_bf16 v44, v126, s37, v96
    v_dot2_f32_bf16 v45, v126, s57, v97
    v_dot2_f32_bf16 v46, v127, s37, v98
    v_dot2_f32_bf16 v47, v127, s57, v99
    v_bitop3_b32 v60, v126, s22, 1 bitop3:0x28
    v_cvt_pk_bf16_f32 v44, v44, v45
    v_cmp_ne_u32 vcc, 0, v60
    v_cvt_pk_bf16_f32 v45, v46, v47
    ds_write_b64 v124, v[44:45] offset:0
    buffer_load_dwordx2 v[64:65], v123, s[4:7], s19 offen offset:512 sc1
    v_cmp_eq_u32 s[42:43], 0, v111
    s_cbranch_vccnz main_kernel_cf_z0_f
    v_mov_b32 v96, 0x3f803f80
    v_mov_b32 v97, 0x3f803f80
    v_mov_b32 v98, 0x3f803f80
    v_mov_b32 v99, 0x3f803f80
    s_and_b32 s32, s43, 0x3f00
    s_cbranch_scc1 main_kernel_cf_kvw
main_kernel_cf_kvok:
    s_waitcnt lgkmcnt(0)
    s_barrier
    ds_read_b64_tr_b16 v[48:49], v115 offset:16384
    ds_read_b64_tr_b16 v[50:51], v115 offset:17408
    ds_read_b64_tr_b16 v[52:53], v115 offset:18432
    ds_read_b64_tr_b16 v[54:55], v115 offset:19456
    s_waitcnt vmcnt(2)
    s_memtime s[52:53]
    v_dot2_f32_bf16 v44, v42, s37, v68
    v_dot2_f32_bf16 v45, v42, s57, v69
    v_dot2_f32_bf16 v46, v43, s37, v70
    v_dot2_f32_bf16 v47, v43, s57, v71
    v_bitop3_b32 v60, v42, s22, 1 bitop3:0x28
    v_cvt_pk_bf16_f32 v44, v44, v45
    v_cmp_ne_u32 vcc, 0, v60
    v_cvt_pk_bf16_f32 v45, v46, v47
    ds_write_b64 v124, v[44:45] offset:512
    s_waitcnt lgkmcnt(3)
    v_mfma_f32_16x16x32_bf16 v[32:35], v[0:3], v[48:51], 0
    v_mfma_f32_16x16x32_bf16 v[36:39], v[16:19], v[48:51], 0
    s_cbranch_vccnz main_kernel_cf_z1_f
main_kernel_cf_z_ok:
    v_mfma_f32_16x16x32_bf16 v[72:75], v[48:51], v[48:51], 0
    s_waitcnt lgkmcnt(1)
    s_sub_u32 s32, s52, s38
    v_mov_b32 v46, s32
    v_mfma_f32_16x16x32_bf16 v[32:35], v[4:7], v[52:55], v[32:35]
    buffer_load_dwordx2 v[86:87], v123, s[4:7], s19 offen offset:1024 sc1
    buffer_store_dword v46, v117, s[4:7], s46 offen
    s_cmp_eq_u32 s17, 64
    s_waitcnt lgkmcnt(0)
    s_barrier
    ds_read_b64_tr_b16 v[56:57], v115 offset:16896
    ds_read_b64_tr_b16 v[58:59], v115 offset:17920
    ds_read_b64_tr_b16 v[60:61], v115 offset:18944
    ds_read_b64_tr_b16 v[62:63], v115 offset:19968
    s_cbranch_scc1 main_kernel_cf_last
    v_bfe_u32 v47, v123, 1, 7
    buffer_load_dwordx2 v[126:127], v123, s[4:7], s19 offen offset:1024 sc1
    buffer_load_dwordx4 v116, s[4:7], s27 offen offset:1024 sc1 lds
    v_mfma_f32_16x16x32_bf16 v[36:39], v[20:23], v[52:55], v[36:39]
    v_mfma_f32_16x16x32_bf16 v[72:75], v[52:55], v[52:55], v[72:75]
    s_waitcnt lgkmcnt(2)
    v_mfma_f32_16x16x32_bf16 v[72:75], v[56:59], v[56:59], v[72:75]
    v_mfma_f32_16x16x32_bf16 v[32:35], v[8:11], v[56:59], v[32:35]
    s_waitcnt lgkmcnt(0)
    v_mfma_f32_16x16x32_bf16 v[72:75], v[60:63], v[60:63], v[72:75]
    ds_read_b128 v[0:3], v113 offset:16384
    v_mfma_f32_16x16x32_bf16 v[32:35], v[12:15], v[60:63], v[32:35]
    ds_read_b128 v[16:19], v113 offset:18432
    v_mfma_f32_16x16x32_bf16 v[36:39], v[24:27], v[56:59], v[36:39]
    ds_read_b128 v[4:7], v113 offset:17408
    s_nop 0
    v_permlane32_swap_b32 v72, v73
    v_permlane32_swap_b32 v74, v75
    v_mfma_f32_16x16x32_bf16 v[36:39], v[28:31], v[60:63], v[36:39]
    ds_read_b128 v[20:23], v113 offset:19456
    v_mul_f32 v73, s30, v73
    v_mul_f32 v75, s30, v75
    v_exp_f32 v32, v32
    ds_read_b128 v[8:11], v113 offset:24576
    v_exp_f32 v33, v33
    ds_read_b128 v[12:15], v113 offset:25600
    v_exp_f32 v73, v73
    ds_read_b128 v[24:27], v113 offset:26624
    v_exp_f32 v75, v75
    ds_read_b128 v[28:31], v113 offset:27648
    v_exp_f32 v34, v34
    v_cvt_pk_bf16_f32 v72, v73, v75
    v_cvt_pk_bf16_f32 v73, v73, v75
    v_exp_f32 v35, v35
    s_waitcnt vmcnt(4)
    v_mfma_f32_16x16x16_bf16 v[40:43], v[100:101], v[72:73], 0
    v_exp_f32 v36, v36
    v_cvt_pk_bf16_f32 v32, v32, v33
    v_exp_f32 v37, v37
    v_cvt_pk_bf16_f32 v33, v34, v35
    v_exp_f32 v38, v38
    v_exp_f32 v39, v39
    v_cvt_pk_bf16_f32 v34, v36, v37
    v_cvt_pk_bf16_f32 v35, v38, v39
    s_nop 1
    v_mfma_f32_16x16x32_bf16 v[40:43], v[96:99], v[32:35], v[40:43]
    v_mfma_f32_16x16x32_bf16 v[64:67], v[88:91], v[32:35], 0
    v_mfma_f32_16x16x32_bf16 v[68:71], v[92:95], v[32:35], 0
    s_waitcnt vmcnt(3)
main_kernel_cf_v_ok:
    v_bitop3_b32 v44, v86, s22, 1 bitop3:0x28
    v_swap_b32 v85, v86
    v_cmp_ne_u32 vcc, 0, v44
main_kernel_cf_d_ok:
    s_nop 0
    v_mfma_f32_16x16x16_bf16 v[64:67], v[84:85], v[72:73], v[64:67]
    v_mfma_f32_16x16x16_bf16 v[68:71], v[86:87], v[72:73], v[68:71]
    s_cbranch_vccnz main_kernel_cf_v_f
    v_rcp_f32 v42, v40
    v_subrev_u32 v41, 0x21800000, v41
    v_cmp_lt_u32 vcc, 0x3c000000, v41
    s_nop 0
    v_pk_mul_f32 v[64:65], v[64:65], v[42:43] op_sel_hi:[1,0]
    v_pk_mul_f32 v[66:67], v[66:67], v[42:43] op_sel_hi:[1,0]
    v_cvt_pk_bf16_f32 v44, v64, v65
    v_pk_mul_f32 v[68:69], v[68:69], v[42:43] op_sel_hi:[1,0]
    v_cvt_pk_bf16_f32 v45, v66, v67
    v_pk_mul_f32 v[70:71], v[70:71], v[42:43] op_sel_hi:[1,0]
    v_cvt_pk_bf16_f32 v46, v68, v69
    v_cvt_pk_bf16_f32 v47, v70, v71
    ds_write_b128 v118, v[44:47]
    s_and_b64 s[42:43], vcc, s[44:45]
    s_cbranch_scc1 main_kernel_cf_d_f
    s_mov_b64 s[44:45], s[0:1]
    v_mov_b32 v64, 0
    v_mov_b32 v65, 0
    v_mov_b32 v66, 0
    v_mov_b32 v67, 0
    v_mov_b32 v68, 0
    v_mov_b32 v69, 0
    v_mov_b32 v70, 0
    v_mov_b32 v71, 0
    v_bfe_u32 v90, v123, 1, 7
    s_xor_b32 s23, s23, 0x80000
    s_waitcnt lgkmcnt(0)
    s_barrier
    ds_read_b128 v[56:59], v114 offset:1024
    ds_read_b128 v[60:63], v114 offset:1536
    ds_read_b128 v[48:51], v114 offset:0
    ds_read_b128 v[52:55], v114 offset:512
    s_xor_b32 s18, s18, 0x100000
    s_xor_b32 s19, s18, 0x80000
    s_xor_b32 s25, s25, 0x4000
    s_add_u32 s27, s27, 0x40000
    v_add_u32 v121, 4, v121
    v_xor_b32 v112, 0x4000, v112
    s_xor_b32 s36, s36, 0x4000
    s_mov_b32 m0, 0
    s_mov_b32 s54, s24
    s_xor_b32 s24, s24, 0x4000
    s_add_u32 s55, s25, 4096
    v_mov_b32 v89, s17
    s_mov_b32 s15, 0
    s_add_u32 s56, s19, 1536
    s_xor_b32 s9, s11, s40
    s_add_u32 s16, s20, s38
    s_waitcnt lgkmcnt(3)
    v_smfmac_f32_16x16x64_bf16 v[76:79], v[56:59], v[0:7], v110
    s_waitcnt lgkmcnt(2)
    ds_read_b128 v[0:3], v113 offset:20480
    v_smfmac_f32_16x16x64_bf16 v[76:79], v[60:63], v[8:15], v110
    s_waitcnt lgkmcnt(2)
    ds_read_b128 v[4:7], v113 offset:21504
    v_smfmac_f32_16x16x64_bf16 v[76:79], v[48:51], v[192:199], v110
    s_waitcnt lgkmcnt(2)
    ds_read_b128 v[8:11], v113 offset:28672
    v_smfmac_f32_16x16x64_bf16 v[76:79], v[52:55], v[200:207], v110
    ds_read_b128 v[12:15], v113 offset:29696
    buffer_load_dword v111, v90, s[4:7], s47 offen sc1
    v_smfmac_f32_16x16x64_bf16 v[80:83], v[56:59], v[16:23], v110
    ds_read_b128 v[16:19], v113 offset:22528
    v_smfmac_f32_16x16x64_bf16 v[80:83], v[60:63], v[24:31], v110
    ds_read_b128 v[20:23], v113 offset:23552
    v_smfmac_f32_16x16x64_bf16 v[80:83], v[48:51], v[208:215], v110
    ds_read_b128 v[24:27], v113 offset:30720
    v_cvt_pk_f16_f32 v40, v76, v77
    v_smfmac_f32_16x16x64_bf16 v[80:83], v[52:55], v[216:223], v110
    ds_read_b128 v[28:31], v113 offset:31744
    v_cvt_pk_f16_f32 v41, v78, v79
    v_smfmac_f32_16x16x64_bf16 v[64:67], v[48:51], v[224:231], v110
    v_bfi_b32 v40, 1, s22, v40
    v_smfmac_f32_16x16x64_bf16 v[64:67], v[52:55], v[232:239], v110
    s_waitcnt lgkmcnt(6)
    buffer_load_dword v111, v90, s[4:7], s47 offen sc1
    v_smfmac_f32_16x16x64_bf16 v[64:67], v[56:59], v[0:7], v110
    s_waitcnt lgkmcnt(4)
    buffer_store_dwordx2 v[40:41], v119, s[4:7], s21 offen offset:0
    v_cvt_pk_f16_f32 v42, v80, v81
    v_smfmac_f32_16x16x64_bf16 v[64:67], v[60:63], v[8:15], v110
    v_cvt_pk_f16_f32 v43, v82, v83
    v_smfmac_f32_16x16x64_bf16 v[68:71], v[48:51], v[240:247], v110
    v_bfi_b32 v42, 1, s22, v42
    v_smfmac_f32_16x16x64_bf16 v[68:71], v[52:55], v[248:255], v110
    s_waitcnt lgkmcnt(2)
    v_smfmac_f32_16x16x64_bf16 v[68:71], v[56:59], v[16:23], v110
    s_waitcnt lgkmcnt(0)
    buffer_store_dwordx2 v[42:43], v119, s[4:7], s21 offen offset:512
    v_cvt_pk_f16_f32 v44, v64, v65
    v_smfmac_f32_16x16x64_bf16 v[68:71], v[60:63], v[24:31], v110
    v_cvt_pk_f16_f32 v45, v66, v67
    v_bfi_b32 v44, 1, s22, v44
    s_cmp_lg_u32 s14, 0
    buffer_store_dwordx2 v[44:45], v119, s[4:7], s21 offen offset:1024
    s_nop 3
    v_cvt_pk_f16_f32 v46, v68, v69
    v_cvt_pk_f16_f32 v47, v70, v71
    v_bfi_b32 v46, 1, s22, v46
    buffer_store_dwordx2 v[46:47], v119, s[4:7], s21 offen offset:1536
    s_cbranch_scc1 main_kernel_cf_wx
    s_waitcnt vmcnt(5)
    s_xor_b32 s21, s21, 0x80000
main_kernel_cf_rgo:
    v_subrev_u32 v32, s20, v111
    s_memtime s[52:53]
    v_cmp_lt_u32 vcc, 0x100000, v32
    v_max_u32_dpp v32, v32, v32 row_shr:1 row_mask:0xf bank_mask:0xf
    s_nop 0
    s_nop 0
    v_max_u32_dpp v32, v32, v32 row_shr:2 row_mask:0xf bank_mask:0xf
    s_nop 0
    s_cbranch_vccnz main_kernel_cf_fsp
main_kernel_cf_fok:
    s_nop 0
    v_max_u32_dpp v32, v32, v32 row_shr:4 row_mask:0xf bank_mask:0xf
    s_memtime s[52:53]
    s_nop 0
    v_max_u32_dpp v32, v32, v32 row_shr:8 row_mask:0xf bank_mask:0xf
    s_memtime s[52:53]
    s_nop 0
    v_max_u32_dpp v32, v32, v32 row_bcast:15 row_mask:0xa bank_mask:0xf
    s_memtime s[52:53]
    s_sub_u32 s33, s52, s16
    v_readlane_b32 s32, v32, 31
    s_add_u32 s33, s33, 0x400
    s_memtime s[52:53]
    s_add_u32 s34, s16, 1650
    s_memtime s[52:53]
    s_min_u32 s32, s32, s33
    s_max_u32 s32, s32, s15
    s_add_u32 s34, s34, s32
    s_mov_b32 s35, 200
main_kernel_cf_fw:
    s_memtime s[52:53]
    s_cmp_ge_u32 s52, s34
    s_cbranch_scc1 main_kernel_cf_fgo
    s_memtime s[52:53]
    s_cmp_ge_u32 s52, s34
    s_cbranch_scc1 main_kernel_cf_fgo
    s_memtime s[52:53]
    s_cmp_ge_u32 s52, s34
    s_cbranch_scc1 main_kernel_cf_fgo
    s_memtime s[52:53]
    s_cmp_ge_u32 s52, s34
    s_cbranch_scc1 main_kernel_cf_fgo
    s_memtime s[52:53]
    s_cmp_ge_u32 s52, s34
    s_cbranch_scc1 main_kernel_cf_fgo
    s_memtime s[52:53]
    s_cmp_ge_u32 s52, s34
    s_cbranch_scc1 main_kernel_cf_fgo
    s_memtime s[52:53]
    s_cmp_ge_u32 s52, s34
    s_cbranch_scc1 main_kernel_cf_fgo
    s_memtime s[52:53]
    s_cmp_ge_u32 s52, s34
    s_cbranch_scc1 main_kernel_cf_fgo
    s_sub_u32 s35, s35, 1
    s_cbranch_scc0 main_kernel_cf_fw
main_kernel_cf_fgo:
    buffer_load_dwordx4 v[0:3], v120, s[4:7], s23 offen sc1
    s_add_u32 s35, s23, 0x8000
    buffer_load_dwordx4 v[4:7], v120, s[4:7], s35 offen sc1
    s_add_u32 s35, s23, 0x10000
    buffer_load_dwordx4 v[8:11], v120, s[4:7], s35 offen sc1
    ds_read_b32 v33, v123 offset:20992
    s_add_u32 s35, s23, 0x18000
    buffer_load_dwordx4 v[12:15], v120, s[4:7], s35 offen sc1
    s_add_u32 s35, s23, 0x20000
    buffer_load_dwordx4 v[16:19], v120, s[4:7], s35 offen sc1
    s_add_u32 s35, s23, 0x28000
    buffer_load_dwordx4 v[20:23], v120, s[4:7], s35 offen sc1
    s_add_u32 s35, s23, 0x30000
    buffer_load_dwordx4 v[24:27], v120, s[4:7], s35 offen sc1
    s_add_u32 s35, s23, 0x38000
    buffer_load_dwordx4 v[28:31], v120, s[4:7], s35 offen sc1
    s_mov_b64 exec, 1
    s_waitcnt lgkmcnt(0)
    v_sub_u32 v33, s34, v33
    v_bfi_b32 v33, 1, s40, v33
    buffer_store_dword v33, off, s[4:7], s18 offset:1536 sc1
    v_readfirstlane_b32 s10, v33
    s_mov_b64 exec, -1
    s_waitcnt vmcnt(8)
    v_mfma_f32_16x16x32_f16 v[76:79], v[0:3], v[106:109], 0
    v_xor_b32 v36, s22, v0
    v_bitop3_b32 v36, v2, s22, v36 bitop3:0xbe
    s_waitcnt vmcnt(7)
    v_mfma_f32_16x16x32_f16 v[76:79], v[4:7], v[106:109], v[76:79]
    v_bitop3_b32 v36, v4, s22, v36 bitop3:0xbe
    v_bitop3_b32 v36, v6, s22, v36 bitop3:0xbe
    s_waitcnt vmcnt(6)
    v_mfma_f32_16x16x32_f16 v[76:79], v[8:11], v[106:109], v[76:79]
    v_bitop3_b32 v36, v8, s22, v36 bitop3:0xbe
    v_bitop3_b32 v36, v10, s22, v36 bitop3:0xbe
    s_waitcnt vmcnt(5)
    v_mfma_f32_16x16x32_f16 v[76:79], v[12:15], v[106:109], v[76:79]
    v_bitop3_b32 v36, v12, s22, v36 bitop3:0xbe
    v_bitop3_b32 v36, v14, s22, v36 bitop3:0xbe
    s_waitcnt vmcnt(4)
    v_mfma_f32_16x16x32_f16 v[76:79], v[16:19], v[106:109], v[76:79]
    v_bitop3_b32 v36, v16, s22, v36 bitop3:0xbe
    v_bitop3_b32 v36, v18, s22, v36 bitop3:0xbe
    s_waitcnt vmcnt(3)
    v_mfma_f32_16x16x32_f16 v[76:79], v[20:23], v[106:109], v[76:79]
    v_bitop3_b32 v36, v20, s22, v36 bitop3:0xbe
    v_bitop3_b32 v36, v22, s22, v36 bitop3:0xbe
    s_waitcnt vmcnt(2)
    v_mfma_f32_16x16x32_f16 v[76:79], v[24:27], v[106:109], v[76:79]
    v_bitop3_b32 v36, v24, s22, v36 bitop3:0xbe
    v_bitop3_b32 v36, v26, s22, v36 bitop3:0xbe
    s_waitcnt vmcnt(1)
    v_mfma_f32_16x16x32_f16 v[76:79], v[28:31], v[106:109], v[76:79]
    v_bitop3_b32 v36, v28, s22, v36 bitop3:0xbe
    v_bitop3_b32 v36, v30, s22, v36 bitop3:0xbe
    v_and_b32 v36, 1, v36
    v_cmp_ne_u32 vcc, 0, v36
    s_nop 3
    v_cvt_pk_bf16_f32 v126, v76, v77
    v_cvt_pk_bf16_f32 v127, v78, v79
    s_cbranch_vccnz main_kernel_cf_r_f
    buffer_store_dwordx2 v[126:127], v122, s[4:7], s24 offen
    s_sub_u32 s20, s34, s38
    s_mov_b32 s3, s34
    buffer_store_dword v89, v117, s[4:7], s46 offen offset:512
    v_mov_b32 v32, -1
    v_mov_b32 v33, -1
    v_mov_b32 v64, 0
    v_mov_b32 v65, 0
    v_mov_b32 v66, 0
    v_mov_b32 v67, 0
    v_mov_b32 v68, 0
    v_mov_b32 v69, 0
    v_mov_b32 v70, 0
    v_mov_b32 v71, 0
    v_mov_b32 v96, 0
    v_mov_b32 v97, 0
    v_mov_b32 v98, 0
    v_mov_b32 v99, 0
    buffer_store_dwordx2 v[32:33], v122, s[4:7], s54 offen
    s_cmp_eq_u32 s12, 0
    v_add_u32 v56, s59, v115
    s_cbranch_scc0 main_kernel_cf_vma
    ds_read_b64_tr_b16 v[80:81], v56 offset:16384
    ds_read_b64_tr_b16 v[82:83], v56 offset:17408
    s_waitcnt lgkmcnt(0)
    s_nop 15
    s_nop 15
    s_nop 5
    s_buffer_load_dword s9, s[4:7], s56 glc
    buffer_load_dword v111, v90, s[4:7], s47 offen offset:512 sc1
    buffer_load_dwordx4 v116, s[4:7], s25 offen offset:0 sc1 lds
    buffer_load_dwordx4 v116, s[4:7], s25 offen offset:1024 sc1 lds
    buffer_load_dwordx4 v116, s[4:7], s25 offen offset:2048 sc1 lds
    buffer_load_dwordx4 v116, s[4:7], s25 offen offset:3072 sc1 lds
    s_mov_b32 m0, 4096
    s_nop 0
    buffer_load_dwordx4 v116, s[4:7], s55 offen offset:0 sc1 lds
    buffer_load_dwordx4 v116, s[4:7], s55 offen offset:1024 sc1 lds
    buffer_load_dwordx4 v116, s[4:7], s55 offen offset:2048 sc1 lds
    buffer_load_dwordx4 v116, s[4:7], s55 offen offset:3072 sc1 lds
    v_mov_b32 v34, v90
    s_mov_b32 m0, s36
    s_barrier
    ds_read_b32 v35, v123 offset:20480
    buffer_load_dwordx4 v[88:91], v116, s[4:7], s28 offen offset:0 sc1
    buffer_load_dwordx4 v[92:95], v116, s[4:7], s28 offen offset:1024 sc1
    buffer_load_dwordx4 v116, s[4:7], s27 offen offset:0 sc1 lds
    buffer_store_dwordx4 v[80:83], v125, s[4:7], s26 offen sc1
    s_branch main_kernel_cf_kva
main_kernel_cf_vma:
    v_mfma_f32_16x16x32_bf16 v[56:59], v[102:105], v[84:87], 0
    s_nop 7
    v_cvt_pk_bf16_f32 v80, v56, v57
    v_cvt_pk_bf16_f32 v81, v58, v59
    s_nop 15
    s_nop 15
    s_nop 5
    s_buffer_load_dword s9, s[4:7], s56 glc
    buffer_load_dword v111, v90, s[4:7], s47 offen offset:512 sc1
    buffer_load_dwordx4 v116, s[4:7], s25 offen offset:0 sc1 lds
    buffer_load_dwordx4 v116, s[4:7], s25 offen offset:1024 sc1 lds
    buffer_load_dwordx4 v116, s[4:7], s25 offen offset:2048 sc1 lds
    buffer_load_dwordx4 v116, s[4:7], s25 offen offset:3072 sc1 lds
    s_mov_b32 m0, 4096
    s_nop 0
    buffer_load_dwordx4 v116, s[4:7], s55 offen offset:0 sc1 lds
    buffer_load_dwordx4 v116, s[4:7], s55 offen offset:1024 sc1 lds
    buffer_load_dwordx4 v116, s[4:7], s55 offen offset:2048 sc1 lds
    buffer_load_dwordx4 v116, s[4:7], s55 offen offset:3072 sc1 lds
    v_mov_b32 v34, v90
    s_mov_b32 m0, s36
    s_barrier
    ds_read_b32 v35, v123 offset:20480
    buffer_load_dwordx4 v[88:91], v116, s[4:7], s28 offen offset:0 sc1
    buffer_load_dwordx4 v[92:95], v116, s[4:7], s28 offen offset:1024 sc1
    buffer_load_dwordx4 v116, s[4:7], s27 offen offset:0 sc1 lds
    buffer_store_dwordx2 v[80:81], v123, s[4:7], s26 offen sc1
main_kernel_cf_kva:
    s_add_u32 s26, s26, 0x10000
    s_waitcnt vmcnt(12)
    v_cmp_gt_i32 vcc, s17, v111
    v_readfirstlane_b32 s38, v35
    s_cbranch_vccnz main_kernel_cf_mc_f
    s_waitcnt vmcnt(4)
    s_branch main_kernel_cf_top
main_kernel_cf_wx:
    s_cmp_lg_u32 s14, 1
    s_cbranch_scc1 main_kernel_cf_wy
    s_memrealtime s[32:33]
    s_nop 0
    s_nop 0
    s_memrealtime s[32:33]
    s_nop 0
    s_nop 0
    s_memrealtime s[32:33]
    s_nop 0
    s_nop 0
    s_memrealtime s[32:33]
    s_nop 0
    s_nop 0
    s_memrealtime s[32:33]
    s_nop 0
    s_nop 0
    s_memrealtime s[32:33]
    s_nop 0
    s_nop 0
    s_memrealtime s[32:33]
    s_nop 0
    s_nop 0
    s_memrealtime s[32:33]
    s_nop 0
    s_nop 0
    s_memrealtime s[32:33]
    s_nop 0
    s_nop 0
    s_memrealtime s[32:33]
    s_nop 0
    s_nop 0
    s_memrealtime s[32:33]
    s_nop 0
    s_nop 0
    s_memrealtime s[32:33]
    s_nop 0
    s_nop 0
    s_mov_b32 s34, s32
    s_memrealtime s[32:33]
    s_cmp_lg_u32 s32, s34
    s_cbranch_scc1 main_kernel_cf_e1
    s_memrealtime s[32:33]
    s_cmp_lg_u32 s32, s34
    s_cbranch_scc1 main_kernel_cf_e1
    s_memrealtime s[32:33]
    s_cmp_lg_u32 s32, s34
    s_cbranch_scc1 main_kernel_cf_e1
    s_memrealtime s[32:33]
    s_cmp_lg_u32 s32, s34
    s_cbranch_scc1 main_kernel_cf_e1
    s_memrealtime s[32:33]
    s_cmp_lg_u32 s32, s34
    s_cbranch_scc1 main_kernel_cf_e1
    s_memrealtime s[32:33]
    s_cmp_lg_u32 s32, s34
    s_cbranch_scc1 main_kernel_cf_e1
    s_memrealtime s[32:33]
    s_cmp_lg_u32 s32, s34
    s_cbranch_scc1 main_kernel_cf_e1
    s_memrealtime s[32:33]
    s_cmp_lg_u32 s32, s34
    s_cbranch_scc1 main_kernel_cf_e1
    s_memrealtime s[32:33]
    s_cmp_lg_u32 s32, s34
    s_cbranch_scc1 main_kernel_cf_e1
    s_memrealtime s[32:33]
    s_cmp_lg_u32 s32, s34
    s_cbranch_scc1 main_kernel_cf_e1
    s_memrealtime s[32:33]
    s_cmp_lg_u32 s32, s34
    s_cbranch_scc1 main_kernel_cf_e1
    s_memrealtime s[32:33]
    s_cmp_lg_u32 s32, s34
    s_cbranch_scc1 main_kernel_cf_e1
main_kernel_cf_e1:
    s_memtime s[52:53]
    s_mul_i32 s34, s32, 22
    s_waitcnt lgkmcnt(0)
    s_sub_u32 s32, s52, s34
    s_sub_u32 s33, s32, s38
    s_sub_u32 s33, s33, s10
    s_max_i32 s33, s33, -400
    s_min_i32 s33, s33, 400
    s_ashr_i32 s33, s33, 2
    s_add_u32 s10, s10, s33
    s_mov_b32 s33, s10
    s_ashr_i32 s34, s33, 2
    s_add_u32 s34, s34, s32
    v_mov_b32 v34, s34
    v_mov_b32 v33, s32
    ds_write2st64_b32 v123, v33, v34 offset0:80 offset1:82
    v_add_u32 v37, s33, v34
main_kernel_cf_wy:
    s_xor_b32 s21, s21, 0x80000
    v_mov_b32 v64, 0
    v_mov_b32 v65, 0
    v_mov_b32 v66, 0
    v_mov_b32 v67, 0
    v_mov_b32 v68, 0
    v_mov_b32 v69, 0
    v_mov_b32 v70, 0
    v_mov_b32 v71, 0
    v_mov_b32 v96, 0
    v_mov_b32 v97, 0
    v_mov_b32 v98, 0
    v_mov_b32 v99, 0
    s_cmp_eq_u32 s12, 0
    v_add_u32 v56, s59, v115
    s_cbranch_scc0 main_kernel_cf_vmb
    ds_read_b64_tr_b16 v[80:81], v56 offset:16384
    ds_read_b64_tr_b16 v[82:83], v56 offset:17408
    s_waitcnt lgkmcnt(0)
    s_waitcnt vmcnt(0)
    s_mov_b32 m0, s36
    s_barrier
    ds_read_b32 v35, v123 offset:20480
    ds_write_b32 v124, v37 offset:3584
    buffer_load_dwordx4 v[88:91], v116, s[4:7], s28 offen offset:0 sc1
    buffer_load_dwordx4 v[92:95], v116, s[4:7], s28 offen offset:1024 sc1
    buffer_load_dwordx4 v116, s[4:7], s27 offen offset:0 sc1 lds
    buffer_store_dwordx4 v[80:83], v125, s[4:7], s26 offen sc1
    s_branch main_kernel_cf_kvb
main_kernel_cf_vmb:
    v_mfma_f32_16x16x32_bf16 v[56:59], v[102:105], v[84:87], 0
    s_nop 7
    v_cvt_pk_bf16_f32 v80, v56, v57
    v_cvt_pk_bf16_f32 v81, v58, v59
    s_waitcnt vmcnt(0)
    s_mov_b32 m0, s36
    s_barrier
    ds_read_b32 v35, v123 offset:20480
    ds_write_b32 v124, v37 offset:3584
    buffer_load_dwordx4 v[88:91], v116, s[4:7], s28 offen offset:0 sc1
    buffer_load_dwordx4 v[92:95], v116, s[4:7], s28 offen offset:1024 sc1
    buffer_load_dwordx4 v116, s[4:7], s27 offen offset:0 sc1 lds
    buffer_store_dwordx2 v[80:81], v123, s[4:7], s26 offen sc1
main_kernel_cf_kvb:
    s_add_u32 s26, s26, 0x10000
    s_mov_b64 exec, 1
    buffer_store_dword v100, off, s[4:7], s39 sc1
    s_mov_b64 exec, -1
    s_add_u32 s39, s39, 4
    s_waitcnt lgkmcnt(0)
    v_readfirstlane_b32 s38, v35
    v_mov_b32 v35, 0
    v_mov_b32 v35, 0
    v_mov_b32 v35, 0
    v_mov_b32 v35, 0
    v_mov_b32 v35, 0
    v_mov_b32 v35, 0
main_kernel_cf_end:
    s_branch main_kernel_cf_top
main_kernel_cf_mc_f:
    s_mov_b32 m0, 0
    s_sub_u32 s29, s29, 1
    s_cbranch_scc1 main_kernel_end
    buffer_load_dword v111, v34, s[4:7], s47 offen offset:512 sc1
    buffer_load_dwordx4 v116, s[4:7], s25 offen offset:0 sc1 lds
    buffer_load_dwordx4 v116, s[4:7], s25 offen offset:1024 sc1 lds
    buffer_load_dwordx4 v116, s[4:7], s25 offen offset:2048 sc1 lds
    buffer_load_dwordx4 v116, s[4:7], s25 offen offset:3072 sc1 lds
    s_mov_b32 m0, 4096
    s_nop 0
    buffer_load_dwordx4 v116, s[4:7], s55 offen offset:0 sc1 lds
    buffer_load_dwordx4 v116, s[4:7], s55 offen offset:1024 sc1 lds
    buffer_load_dwordx4 v116, s[4:7], s55 offen offset:2048 sc1 lds
    buffer_load_dwordx4 v116, s[4:7], s55 offen offset:3072 sc1 lds
    s_waitcnt vmcnt(8)
    v_cmp_gt_i32 vcc, s17, v111
    v_readfirstlane_b32 s38, v35
    s_cbranch_vccnz main_kernel_cf_mc_f
    s_waitcnt vmcnt(0)
    s_branch main_kernel_cf_end
main_kernel_cf_t_w:
    s_mov_b32 s35, 200
main_kernel_cf_t_s:
    s_memtime s[52:53]
    s_cmp_ge_u32 s52, s34
    s_cbranch_scc1 main_kernel_cf_t_go
    s_memtime s[52:53]
    s_cmp_ge_u32 s52, s34
    s_cbranch_scc1 main_kernel_cf_t_go
    s_memtime s[52:53]
    s_cmp_ge_u32 s52, s34
    s_cbranch_scc1 main_kernel_cf_t_go
    s_memtime s[52:53]
    s_cmp_ge_u32 s52, s34
    s_cbranch_scc1 main_kernel_cf_t_go
    s_memtime s[52:53]
    s_cmp_ge_u32 s52, s34
    s_cbranch_scc1 main_kernel_cf_t_go
    s_memtime s[52:53]
    s_cmp_ge_u32 s52, s34
    s_cbranch_scc1 main_kernel_cf_t_go
    s_memtime s[52:53]
    s_cmp_ge_u32 s52, s34
    s_cbranch_scc1 main_kernel_cf_t_go
    s_memtime s[52:53]
    s_cmp_ge_u32 s52, s34
    s_cbranch_scc1 main_kernel_cf_t_go
    s_sub_u32 s35, s35, 1
    s_cbranch_scc0 main_kernel_cf_t_s
    s_branch main_kernel_cf_t_go
main_kernel_cf_t_p:
    s_waitcnt lgkmcnt(0)
    s_xor_b32 s32, s9, s22
    s_bitcmp1_b32 s32, 0
    s_cbranch_scc0 main_kernel_cf_t_ok
    s_buffer_load_dword s9, s[4:7], s56 glc
    s_sub_u32 s29, s29, 1
    s_cbranch_scc1 main_kernel_end
    s_branch main_kernel_cf_t_p
main_kernel_cf_z0_f:
    buffer_load_dwordx2 v[126:127], v123, s[4:7], s19 offen offset:0 sc1
    s_sub_u32 s29, s29, 1
    s_cbranch_scc1 main_kernel_end
    s_waitcnt vmcnt(0)
    s_branch main_kernel_cf_z0
main_kernel_cf_z2_f:
    buffer_load_dwordx2 v[64:65], v123, s[4:7], s19 offen offset:512 sc1
    s_sub_u32 s29, s29, 1
    s_cbranch_scc1 main_kernel_end
    s_waitcnt vmcnt(0)
main_kernel_cf_z1_f:
    s_waitcnt vmcnt(0)
    s_memtime s[52:53]
    v_dot2_f32_bf16 v44, v64, s37, v68
    v_dot2_f32_bf16 v45, v64, s57, v69
    v_dot2_f32_bf16 v46, v65, s37, v70
    v_dot2_f32_bf16 v47, v65, s57, v71
    v_bitop3_b32 v60, v64, s22, 1 bitop3:0x28
    v_cvt_pk_bf16_f32 v44, v44, v45
    v_cmp_ne_u32 vcc, 0, v60
    v_cvt_pk_bf16_f32 v45, v46, v47
    ds_write_b64 v124, v[44:45] offset:512
    s_cbranch_vccnz main_kernel_cf_z2_f
    s_branch main_kernel_cf_z_ok
main_kernel_cf_kvw:
    s_cmp_eq_u32 s17, 64
    s_cbranch_scc1 main_kernel_cf_kvok
    s_waitcnt vmcnt(0)
    s_mov_b32 exec_lo, 0
    s_mov_b32 exec_hi, 0x3f00
    v_subrev_u32 v127, 0, v121
main_kernel_cf_kvp:
    buffer_load_dword v126, v127, s[4:7], 0 offen sc1
    s_waitcnt vmcnt(0)
    v_cmp_eq_u32 vcc, 0, v126
    s_cbranch_vccz main_kernel_cf_kvp_ok
    s_sleep 2
    s_sub_u32 s29, s29, 1
    s_cbranch_scc0 main_kernel_cf_kvp
    s_branch main_kernel_end
main_kernel_cf_kvp_ok:
    s_mov_b64 exec, -1
    s_branch main_kernel_cf_kvok
main_kernel_cf_last:
    buffer_load_dwordx2 v[86:87], v123, s[4:7], s19 offen offset:1024 sc1
    s_sub_u32 s29, s29, 1
    s_cbranch_scc1 main_kernel_end
    s_waitcnt vmcnt(0) lgkmcnt(0)
    v_bitop3_b32 v44, v86, s22, 1 bitop3:0x28
    v_cmp_ne_u32 vcc, 0, v44
    s_cbranch_vccnz main_kernel_cf_last
    v_swap_b32 v85, v86
    s_cmp_eq_u32 s12, 0
    v_add_u32 v56, s59, v115
    s_cbranch_scc0 main_kernel_cf_vmc
    ds_read_b64_tr_b16 v[80:81], v56 offset:16384
    ds_read_b64_tr_b16 v[82:83], v56 offset:17408
    s_waitcnt lgkmcnt(0)
    buffer_store_dwordx4 v[80:83], v125, s[4:7], s26 offen sc1
    s_branch main_kernel_cf_kvc
main_kernel_cf_vmc:
    v_mfma_f32_16x16x32_bf16 v[56:59], v[102:105], v[84:87], 0
    s_nop 7
    v_cvt_pk_bf16_f32 v80, v56, v57
    v_cvt_pk_bf16_f32 v81, v58, v59
    buffer_store_dwordx2 v[80:81], v123, s[4:7], s26 offen sc1
main_kernel_cf_kvc:
    s_add_u32 s26, s26, 0x10000
    s_branch main_kernel_end
main_kernel_cf_m_f:
main_kernel_cf_m_t:
    ds_read_b128 v[0:3], v116 offset:0
    ds_read_b128 v[4:7], v116 offset:1024
    ds_read_b128 v[8:11], v116 offset:2048
    ds_read_b128 v[12:15], v116 offset:3072
    ds_read_b128 v[16:19], v116 offset:4096
    ds_read_b128 v[20:23], v116 offset:5120
    ds_read_b128 v[24:27], v116 offset:6144
    ds_read_b128 v[28:31], v116 offset:7168
    s_waitcnt lgkmcnt(0)
    v_max_u32 v126, v0, v2
    v_max3_u32 v126, v126, v4, v6
    v_max3_u32 v126, v126, v8, v10
    v_max3_u32 v126, v126, v12, v14
    v_max3_u32 v126, v126, v16, v18
    v_max3_u32 v126, v126, v20, v22
    v_max3_u32 v126, v126, v24, v26
    v_max3_u32 v126, v126, v28, v30
    v_cmp_eq_u32 vcc, -1, v126
    s_cbranch_vccz main_kernel_cf_m_g
    s_barrier
    s_lshl_b32 s32, s14, 11
    s_add_u32 m0, s32, 0
    s_add_u32 s32, s32, s25
    buffer_load_dwordx4 v116, s[4:7], s32 offen offset:0 sc1 lds
    buffer_load_dwordx4 v116, s[4:7], s32 offen offset:1024 sc1 lds
    s_sub_u32 s29, s29, 1
    s_cbranch_scc1 main_kernel_end
    s_waitcnt vmcnt(0)
    s_barrier
    s_branch main_kernel_cf_m_t
main_kernel_cf_m_g:
    s_mov_b64 s[44:45], 0
    v_mov_b32 v64, 0
    v_mov_b32 v65, 0
    v_mov_b32 v66, 0
    v_mov_b32 v67, 0
    v_mov_b32 v68, 0
    v_mov_b32 v69, 0
    v_mov_b32 v70, 0
    v_mov_b32 v71, 0
    v_mov_b32 v96, 0
    v_mov_b32 v97, 0
    v_mov_b32 v98, 0
    v_mov_b32 v99, 0
    s_branch main_kernel_cf_mrd
main_kernel_cf_v_f:
    v_swap_b32 v85, v86
    s_nop 7
    s_waitcnt vmcnt(1)
main_kernel_cf_v_t:
    s_memtime s[52:53]
    v_bitop3_b32 v44, v126, s22, 1 bitop3:0x28
    v_cmp_ne_u32 vcc, 0, v44
    s_sub_u32 s29, s29, 1
    s_cbranch_scc1 main_kernel_end
    s_cbranch_vccnz main_kernel_cf_v_g
    v_mfma_f32_16x16x32_bf16 v[64:67], v[88:91], v[32:35], 0
    v_mfma_f32_16x16x32_bf16 v[68:71], v[92:95], v[32:35], 0
    v_mov_b32 v86, v126
    v_mov_b32 v87, v127
    s_waitcnt lgkmcnt(0)
    s_sub_u32 s32, s52, s38
    s_add_u32 s32, s32, -550
    v_mov_b32 v46, s32
    buffer_store_dword v46, v117, s[4:7], s46 offen
    s_branch main_kernel_cf_v_ok
main_kernel_cf_v_g:
    buffer_load_dwordx2 v[126:127], v123, s[4:7], s19 offen offset:1024 sc1
    s_waitcnt lgkmcnt(0)
    s_sub_u32 s32, s52, s38
    s_add_u32 s32, s32, -50
    v_mov_b32 v46, s32
    buffer_store_dword v46, v117, s[4:7], s46 offen
    s_waitcnt vmcnt(0)
    s_branch main_kernel_cf_v_t
main_kernel_cf_d_f:
    s_memtime s[52:53]
    s_waitcnt vmcnt(1) lgkmcnt(0)
    s_sub_u32 s32, s52, s38
    s_add_u32 s32, s32, 300
    v_mov_b32 v46, s32
    buffer_store_dword v46, v117, s[4:7], s46 offen
    ds_read_b128 v[0:3], v112 offset:0
    ds_read_b128 v[4:7], v112 offset:1024
    ds_read_b128 v[8:11], v112 offset:2048
    ds_read_b128 v[12:15], v112 offset:3072
    ds_read_b128 v[16:19], v112 offset:4096
    ds_read_b128 v[20:23], v112 offset:5120
    ds_read_b128 v[24:27], v112 offset:6144
    ds_read_b128 v[28:31], v112 offset:7168
    s_waitcnt lgkmcnt(0)
    v_mfma_f32_16x16x32_bf16 v[32:35], v[0:3], v[48:51], 0
    v_mfma_f32_16x16x32_bf16 v[36:39], v[16:19], v[48:51], 0
    v_mfma_f32_16x16x32_bf16 v[72:75], v[48:51], v[48:51], 0
    v_mfma_f32_16x16x32_bf16 v[32:35], v[4:7], v[52:55], v[32:35]
    v_mfma_f32_16x16x32_bf16 v[36:39], v[20:23], v[52:55], v[36:39]
    v_mfma_f32_16x16x32_bf16 v[72:75], v[52:55], v[52:55], v[72:75]
    v_mfma_f32_16x16x32_bf16 v[32:35], v[8:11], v[56:59], v[32:35]
    v_mfma_f32_16x16x32_bf16 v[36:39], v[24:27], v[56:59], v[36:39]
    v_mfma_f32_16x16x32_bf16 v[72:75], v[56:59], v[56:59], v[72:75]
    v_mfma_f32_16x16x32_bf16 v[32:35], v[12:15], v[60:63], v[32:35]
    v_mfma_f32_16x16x32_bf16 v[36:39], v[28:31], v[60:63], v[36:39]
    v_mfma_f32_16x16x32_bf16 v[72:75], v[60:63], v[60:63], v[72:75]
    s_nop 7
    ds_read_b128 v[0:3], v113 offset:16384
    ds_read_b128 v[16:19], v113 offset:18432
    ds_read_b128 v[4:7], v113 offset:17408
    ds_read_b128 v[20:23], v113 offset:19456
    ds_read_b128 v[8:11], v113 offset:24576
    ds_read_b128 v[24:27], v113 offset:26624
    ds_read_b128 v[12:15], v113 offset:25600
    ds_read_b128 v[28:31], v113 offset:27648
    v_permlane32_swap_b32 v72, v73
    v_permlane32_swap_b32 v74, v75
    v_mul_f32 v73, s30, v73
    v_mul_f32 v75, s30, v75
    v_max_f32 v126, v73, v75
    v_max3_f32 v126, v126, v32, v33
    v_max3_f32 v126, v126, v34, v35
    v_max3_f32 v126, v126, v36, v37
    v_max3_f32 v126, v126, v38, v39
    v_mov_b32 v127, v126
    s_nop 1
    v_permlane32_swap_b32 v126, v127
    v_max_f32 v126, v126, v127
    v_mov_b32 v127, v126
    s_nop 1
    v_permlane16_swap_b32 v126, v127
    v_max_f32 v126, v126, v127
    v_sub_f32 v32, v32, v126
    v_sub_f32 v33, v33, v126
    v_sub_f32 v34, v34, v126
    v_sub_f32 v35, v35, v126
    v_sub_f32 v36, v36, v126
    v_sub_f32 v37, v37, v126
    v_sub_f32 v38, v38, v126
    v_sub_f32 v39, v39, v126
    v_sub_f32 v73, v73, v126
    v_sub_f32 v75, v75, v126
    v_exp_f32 v32, v32
    v_exp_f32 v33, v33
    v_exp_f32 v34, v34
    v_exp_f32 v35, v35
    v_exp_f32 v36, v36
    v_exp_f32 v37, v37
    v_exp_f32 v38, v38
    v_exp_f32 v39, v39
    v_exp_f32 v73, v73
    v_exp_f32 v75, v75
    v_cvt_pk_bf16_f32 v32, v32, v33
    v_cvt_pk_bf16_f32 v33, v34, v35
    v_cvt_pk_bf16_f32 v34, v36, v37
    v_cvt_pk_bf16_f32 v35, v38, v39
    v_cvt_pk_bf16_f32 v72, v73, v75
    v_cvt_pk_bf16_f32 v73, v73, v75
    s_nop 1
    v_mfma_f32_16x16x32_bf16 v[64:67], v[88:91], v[32:35], 0
    v_mfma_f32_16x16x32_bf16 v[68:71], v[92:95], v[32:35], 0
    v_mfma_f32_16x16x32_bf16 v[40:43], v[96:99], v[32:35], 0
    s_nop 3
    s_nop 1
    v_mfma_f32_16x16x16_bf16 v[40:43], v[100:101], v[72:73], v[40:43]
    s_mov_b64 s[44:45], 0
    s_mov_b64 vcc, 0
    s_nop 7
    s_branch main_kernel_cf_d_ok
main_kernel_cf_fsp:
    s_mov_b32 s35, 40
main_kernel_cf_fsl:
    buffer_load_dword v111, v90, s[4:7], s47 offen sc1
    s_waitcnt vmcnt(1)
    v_subrev_u32 v32, s20, v111
    v_cmp_lt_u32 vcc, 0x100000, v32
    s_cbranch_vccz main_kernel_cf_rgo
    s_sub_u32 s35, s35, 1
    s_cbranch_scc0 main_kernel_cf_fsl
    v_mov_b32 v32, 0
    s_branch main_kernel_cf_fok
main_kernel_cf_r_f:
    s_memtime s[52:53]
    buffer_load_dword v111, v90, s[4:7], s47 offen sc1
    s_waitcnt lgkmcnt(0)
    s_sub_u32 s15, s52, s16
    s_add_u32 s15, s15, -1500
    s_waitcnt vmcnt(0)
    s_sub_u32 s29, s29, 1
    s_cbranch_scc1 main_kernel_end
    s_branch main_kernel_cf_rgo
    .p2align 6
main_kernel_cs_top:
    s_barrier
main_kernel_cs_mrd:
    ds_read_b128 v[0:3], v114 offset:0
    ds_read_b128 v[4:7], v114 offset:512
    ds_read_b128 v[8:11], v114 offset:1024
    ds_read_b128 v[12:15], v114 offset:1536
    ds_read_b128 v[16:19], v114 offset:2048
    s_waitcnt lgkmcnt(4)
    v_smfmac_f32_16x16x64_bf16 v[96:99], v[0:3], a[0:7], v110
    ds_read_b128 v[20:23], v114 offset:2560
    s_waitcnt lgkmcnt(4)
    v_smfmac_f32_16x16x64_bf16 v[96:99], v[4:7], a[8:15], v110
    ds_read_b128 v[24:27], v114 offset:3072
    s_waitcnt lgkmcnt(4)
    s_bfe_u32 s22, s17, 0x10001
    v_smfmac_f32_16x16x64_bf16 v[96:99], v[8:11], a[16:23], v110
    ds_read_b128 v[28:31], v114 offset:3584
    s_waitcnt lgkmcnt(4)
    v_smfmac_f32_16x16x64_bf16 v[96:99], v[12:15], a[24:31], v110
    ds_read_b128 v[32:35], v114 offset:4096
    s_waitcnt lgkmcnt(4)
    v_smfmac_f32_16x16x64_bf16 v[96:99], v[16:19], a[32:39], v110
    ds_read_b128 v[36:39], v114 offset:4608
    s_waitcnt lgkmcnt(4)
    v_smfmac_f32_16x16x64_bf16 v[96:99], v[20:23], a[40:47], v110
    ds_read_b128 v[40:43], v114 offset:5120
    s_waitcnt lgkmcnt(4)
    v_smfmac_f32_16x16x64_bf16 v[96:99], v[24:27], a[48:55], v110
    ds_read_b128 v[44:47], v114 offset:5632
    s_waitcnt lgkmcnt(4)
    v_smfmac_f32_16x16x64_bf16 v[96:99], v[28:31], a[56:63], v110
    ds_read_b128 v[48:51], v114 offset:6144
    s_waitcnt lgkmcnt(4)
    v_smfmac_f32_16x16x64_bf16 v[96:99], v[32:35], a[64:71], v110
    ds_read_b128 v[52:55], v114 offset:6656
    s_waitcnt lgkmcnt(4)
    v_smfmac_f32_16x16x64_bf16 v[96:99], v[36:39], a[72:79], v110
    ds_read_b128 v[56:59], v114 offset:7168
    s_waitcnt lgkmcnt(4)
    v_smfmac_f32_16x16x64_bf16 v[96:99], v[40:43], a[80:87], v110
    ds_read_b128 v[60:63], v114 offset:7680
    s_waitcnt lgkmcnt(4)
    v_smfmac_f32_16x16x64_bf16 v[96:99], v[44:47], a[88:95], v110
    s_waitcnt lgkmcnt(3)
    buffer_load_dword v111, v121, s[4:7], 0 offen sc1
    v_smfmac_f32_16x16x64_bf16 v[96:99], v[48:51], a[96:103], v110
    s_waitcnt lgkmcnt(2)
    ds_read_b128 v[80:83], v113 offset:0
    v_smfmac_f32_16x16x64_bf16 v[96:99], v[52:55], a[104:111], v110
    s_waitcnt lgkmcnt(2)
    ds_read_b128 v[84:87], v113 offset:1024
    v_smfmac_f32_16x16x64_bf16 v[96:99], v[56:59], a[112:119], v110
    s_waitcnt lgkmcnt(2)
    v_smfmac_f32_16x16x64_bf16 v[96:99], v[60:63], a[120:127], v110
    v_smfmac_f32_16x16x64_bf16 v[68:71], v[0:3], a[128:135], v110
    ds_read_b128 v[72:75], v113 offset:2048
    v_smfmac_f32_16x16x64_bf16 v[68:71], v[4:7], a[136:143], v110
    s_nop 1
    v_pk_add_f32 v[126:127], v[96:97], v[98:99]
    ds_read_b128 v[76:79], v113 offset:3072
    v_smfmac_f32_16x16x64_bf16 v[68:71], v[8:11], a[144:151], v110
    v_cmp_u_f32 vcc, v126, v127
    v_smfmac_f32_16x16x64_bf16 v[68:71], v[12:15], a[152:159], v110
    v_cvt_pk_bf16_f32 v126, v96, v97
    v_smfmac_f32_16x16x64_bf16 v[68:71], v[16:19], a[160:167], v110
    v_cvt_pk_bf16_f32 v127, v98, v99
    s_and_b64 s[42:43], vcc, s[44:45]
    s_cbranch_scc1 main_kernel_cs_m_f
    v_smfmac_f32_16x16x64_bf16 v[68:71], v[20:23], a[168:175], v110
    v_bfi_b32 v126, 1, s22, v126
    buffer_store_dwordx2 v[126:127], v123, s[4:7], s18 offen sc1
    v_smfmac_f32_16x16x64_bf16 v[68:71], v[24:27], a[176:183], v110
    s_mov_b64 s[44:45], s[0:1]
    v_smfmac_f32_16x16x64_bf16 v[68:71], v[28:31], a[184:191], v110
    s_add_u32 s17, s17, 1
    s_bfe_u32 s40, s17, 0x10001
    v_smfmac_f32_16x16x64_bf16 v[68:71], v[32:35], a[192:199], v110
    s_add_u32 s28, s28, 0x40000
    s_mov_b32 m0, s36
    v_smfmac_f32_16x16x64_bf16 v[68:71], v[36:39], a[200:207], v110
    s_add_u32 s34, s3, 2100
    v_smfmac_f32_16x16x64_bf16 v[68:71], v[40:43], a[208:215], v110
    v_smfmac_f32_16x16x64_bf16 v[68:71], v[44:47], a[216:223], v110
    v_smfmac_f32_16x16x64_bf16 v[68:71], v[48:51], a[224:231], v110
    v_smfmac_f32_16x16x64_bf16 v[68:71], v[52:55], a[232:239], v110
    v_smfmac_f32_16x16x64_bf16 v[68:71], v[56:59], a[240:247], v110
    v_smfmac_f32_16x16x64_bf16 v[68:71], v[60:63], a[248:255], v110
    s_waitcnt lgkmcnt(2)
    v_smfmac_f32_16x16x64_bf16 v[64:67], v[32:35], v[80:87], v110
    s_waitcnt lgkmcnt(0)
    s_nop 3
    v_cvt_pk_bf16_f32 v126, v68, v69
    v_cvt_pk_bf16_f32 v127, v70, v71
    v_bfi_b32 v126, 1, s22, v126
    buffer_store_dwordx2 v[126:127], v123, s[4:7], s18 offen offset:512 sc1
    ds_read_b128 v[80:83], v113 offset:4096
    v_smfmac_f32_16x16x64_bf16 v[64:67], v[36:39], v[72:79], v110
    ds_read_b128 v[84:87], v113 offset:5120
    v_smfmac_f32_16x16x64_bf16 v[64:67], v[0:3], v[128:135], v110
    ds_read_b128 v[72:75], v113 offset:6144
    v_smfmac_f32_16x16x64_bf16 v[64:67], v[4:7], v[136:143], v110
    ds_read_b128 v[76:79], v113 offset:7168
    v_smfmac_f32_16x16x64_bf16 v[64:67], v[8:11], v[144:151], v110
    ds_read_b128 v[32:35], v113 offset:8192
    v_smfmac_f32_16x16x64_bf16 v[64:67], v[12:15], v[152:159], v110
    ds_read_b128 v[36:39], v113 offset:9216
    v_smfmac_f32_16x16x64_bf16 v[64:67], v[16:19], v[160:167], v110
    ds_read_b128 v[0:3], v113 offset:10240
    s_memtime s[52:53]
    v_smfmac_f32_16x16x64_bf16 v[64:67], v[20:23], v[168:175], v110
    ds_read_b128 v[4:7], v113 offset:11264
    s_memtime s[52:53]
    s_xor_b32 s32, s9, s22
    s_bitcmp1_b32 s32, 0
    s_cbranch_scc1 main_kernel_cs_t_p
main_kernel_cs_t_ok:
    s_sub_u32 s32, s9, s10
    v_smfmac_f32_16x16x64_bf16 v[64:67], v[24:27], v[176:183], v110
    ds_read_b128 v[8:11], v113 offset:12288
    s_memtime s[52:53]
    s_max_i32 s32, s32, 0
    s_min_i32 s32, s32, 0x4000
    v_smfmac_f32_16x16x64_bf16 v[64:67], v[28:31], v[184:191], v110
    s_waitcnt lgkmcnt(7)
    ds_read_b128 v[12:15], v113 offset:13312
    s_memtime s[52:53]
    s_add_u32 s34, s34, s32
    s_and_b32 s34, s34, s11
    v_smfmac_f32_16x16x64_bf16 v[64:67], v[40:43], v[80:87], v110
    s_waitcnt lgkmcnt(6)
    ds_read_b128 v[16:19], v113 offset:14336
    s_cmp_lt_u32 s52, s34
    s_cbranch_scc1 main_kernel_cs_t_w
main_kernel_cs_t_go:
    s_barrier
    buffer_load_dwordx2 v[126:127], v123, s[4:7], s19 offen offset:0 sc1
    v_smfmac_f32_16x16x64_bf16 v[64:67], v[44:47], v[72:79], v110
    s_waitcnt lgkmcnt(5)
    ds_read_b128 v[20:23], v113 offset:15360
    v_smfmac_f32_16x16x64_bf16 v[64:67], v[48:51], v[32:39], v110
    s_waitcnt lgkmcnt(4)
    v_smfmac_f32_16x16x64_bf16 v[64:67], v[52:55], v[0:7], v110
    s_waitcnt lgkmcnt(2)
    ds_read_b128 v[24:27], v112 offset:6144
    ds_read_b128 v[28:31], v112 offset:7168
    v_smfmac_f32_16x16x64_bf16 v[64:67], v[56:59], v[8:15], v110
    s_waitcnt lgkmcnt(2)
    ds_read_b128 v[0:3], v112 offset:0
    ds_read_b128 v[4:7], v112 offset:1024
    v_smfmac_f32_16x16x64_bf16 v[64:67], v[60:63], v[16:23], v110
    ds_read_b128 v[8:11], v112 offset:2048
    ds_read_b128 v[12:15], v112 offset:3072
    ds_read_b128 v[16:19], v112 offset:4096
    ds_read_b128 v[20:23], v112 offset:5120
    v_mov_b32 v76, 0
    v_mov_b32 v77, 0
    v_mov_b32 v78, 0
    s_nop 0
    v_permlane32_swap_b32 v64, v65
    v_permlane32_swap_b32 v66, v67
    v_cvt_pk_bf16_f32 v84, v64, v66
    v_cvt_pk_bf16_f32 v85, v65, v67
    v_bfi_b32 v84, 1, s22, v84
    buffer_load_dwordx2 v[42:43], v123, s[4:7], s19 offen offset:512 sc1
    v_mov_b32 v79, 0
    v_mov_b32 v80, 0
    v_mov_b32 v81, 0
    v_mov_b32 v82, 0
    v_mov_b32 v83, 0
    v_mov_b32 v60, 0
    v_mov_b32 v60, 0
    v_mov_b32 v60, 0
    v_mov_b32 v60, 0
    v_mov_b32 v60, 0
    v_mov_b32 v60, 0
    v_mov_b32 v60, 0
    buffer_store_dwordx2 v[84:85], v123, s[4:7], s18 offen offset:1024 sc1
    v_mov_b32 v60, 0
    v_mov_b32 v60, 0
    v_mov_b32 v60, 0
    v_mov_b32 v60, 0
    v_mov_b32 v60, 0
    v_mov_b32 v60, 0
    v_mov_b32 v60, 0
    v_mov_b32 v60, 0
    v_mov_b32 v60, 0
    v_mov_b32 v60, 0
    v_mov_b32 v60, 0
    v_mov_b32 v60, 0
    v_mov_b32 v60, 0
    v_mov_b32 v60, 0
    v_mov_b32 v60, 0
    v_mov_b32 v60, 0
    v_mov_b32 v60, 0
    v_mov_b32 v60, 0
    v_mov_b32 v60, 0
    v_mov_b32 v60, 0
    v_mov_b32 v60, 0
    v_mov_b32 v60, 0
    v_mov_b32 v60, 0
    v_mov_b32 v60, 0
    v_mov_b32 v60, 0
    v_mov_b32 v60, 0
    v_mov_b32 v60, 0
    v_mov_b32 v60, 0
    v_mov_b32 v60, 0
    v_mov_b32 v60, 0
    v_mov_b32 v60, 0
    v_mov_b32 v60, 0
    v_mov_b32 v60, 0
    v_mov_b32 v60, 0
    v_mov_b32 v60, 0
    v_mov_b32 v60, 0
    v_mov_b32 v60, 0
    v_mov_b32 v60, 0
    s_waitcnt vmcnt(2)
main_kernel_cs_z0:
    v_dot2_f32_bf16 v44, v126, s37, v96
    v_dot2_f32_bf16 v45, v126, s57, v97
    v_dot2_f32_bf16 v46, v127, s37, v98
    v_dot2_f32_bf16 v47, v127, s57, v99
    v_bitop3_b32 v60, v126, s22, 1 bitop3:0x28
    v_cvt_pk_bf16_f32 v44, v44, v45
    v_cmp_ne_u32 vcc, 0, v60
    v_cvt_pk_bf16_f32 v45, v46, v47
    ds_write_b64 v124, v[44:45] offset:0
    buffer_load_dwordx2 v[64:65], v123, s[4:7], s19 offen offset:512 sc1
    v_cmp_eq_u32 s[42:43], 0, v111
    s_cbranch_vccnz main_kernel_cs_z0_f
    v_mov_b32 v96, 0x3f803f80
    v_mov_b32 v97, 0x3f803f80
    v_mov_b32 v98, 0x3f803f80
    v_mov_b32 v99, 0x3f803f80
    s_and_b32 s32, s43, 0x3f00
    s_cbranch_scc1 main_kernel_cs_kvw
main_kernel_cs_kvok:
    s_waitcnt lgkmcnt(0)
    s_barrier
    ds_read_b64_tr_b16 v[48:49], v115 offset:16384
    ds_read_b64_tr_b16 v[50:51], v115 offset:17408
    ds_read_b64_tr_b16 v[52:53], v115 offset:18432
    ds_read_b64_tr_b16 v[54:55], v115 offset:19456
    s_waitcnt vmcnt(2)
    s_memtime s[52:53]
    v_dot2_f32_bf16 v44, v42, s37, v68
    v_dot2_f32_bf16 v45, v42, s57, v69
    v_dot2_f32_bf16 v46, v43, s37, v70
    v_dot2_f32_bf16 v47, v43, s57, v71
    v_bitop3_b32 v60, v42, s22, 1 bitop3:0x28
    v_cvt_pk_bf16_f32 v44, v44, v45
    v_cmp_ne_u32 vcc, 0, v60
    v_cvt_pk_bf16_f32 v45, v46, v47
    ds_write_b64 v124, v[44:45] offset:512
    s_waitcnt lgkmcnt(3)
    v_mfma_f32_16x16x32_bf16 v[32:35], v[0:3], v[48:51], 0
    v_mfma_f32_16x16x32_bf16 v[36:39], v[16:19], v[48:51], 0
    s_cbranch_vccnz main_kernel_cs_z1_f
main_kernel_cs_z_ok:
    v_mfma_f32_16x16x32_bf16 v[72:75], v[48:51], v[48:51], 0
    s_waitcnt lgkmcnt(1)
    s_sub_u32 s32, s52, s38
    v_mov_b32 v46, s32
    v_mfma_f32_16x16x32_bf16 v[32:35], v[4:7], v[52:55], v[32:35]
    buffer_load_dwordx2 v[86:87], v123, s[4:7], s19 offen offset:1024 sc1
    buffer_store_dword v46, v117, s[4:7], s46 offen sc1
    s_cmp_eq_u32 s17, 64
    s_waitcnt lgkmcnt(0)
    s_barrier
    ds_read_b64_tr_b16 v[56:57], v115 offset:16896
    ds_read_b64_tr_b16 v[58:59], v115 offset:17920
    ds_read_b64_tr_b16 v[60:61], v115 offset:18944
    ds_read_b64_tr_b16 v[62:63], v115 offset:19968
    s_cbranch_scc1 main_kernel_cs_last
    v_bfe_u32 v47, v123, 1, 7
    buffer_load_dwordx2 v[126:127], v123, s[4:7], s19 offen offset:1024 sc1
    buffer_load_dwordx4 v116, s[4:7], s27 offen offset:1024 sc1 lds
    v_mfma_f32_16x16x32_bf16 v[36:39], v[20:23], v[52:55], v[36:39]
    v_mfma_f32_16x16x32_bf16 v[72:75], v[52:55], v[52:55], v[72:75]
    s_waitcnt lgkmcnt(2)
    v_mfma_f32_16x16x32_bf16 v[72:75], v[56:59], v[56:59], v[72:75]
    v_mfma_f32_16x16x32_bf16 v[32:35], v[8:11], v[56:59], v[32:35]
    s_waitcnt lgkmcnt(0)
    v_mfma_f32_16x16x32_bf16 v[72:75], v[60:63], v[60:63], v[72:75]
    ds_read_b128 v[0:3], v113 offset:16384
    v_mfma_f32_16x16x32_bf16 v[32:35], v[12:15], v[60:63], v[32:35]
    ds_read_b128 v[16:19], v113 offset:18432
    v_mfma_f32_16x16x32_bf16 v[36:39], v[24:27], v[56:59], v[36:39]
    ds_read_b128 v[4:7], v113 offset:17408
    s_nop 0
    v_permlane32_swap_b32 v72, v73
    v_permlane32_swap_b32 v74, v75
    v_mfma_f32_16x16x32_bf16 v[36:39], v[28:31], v[60:63], v[36:39]
    ds_read_b128 v[20:23], v113 offset:19456
    v_mul_f32 v73, s30, v73
    v_mul_f32 v75, s30, v75
    v_exp_f32 v32, v32
    ds_read_b128 v[8:11], v113 offset:24576
    v_exp_f32 v33, v33
    ds_read_b128 v[12:15], v113 offset:25600
    v_exp_f32 v73, v73
    ds_read_b128 v[24:27], v113 offset:26624
    v_exp_f32 v75, v75
    ds_read_b128 v[28:31], v113 offset:27648
    v_exp_f32 v34, v34
    v_cvt_pk_bf16_f32 v72, v73, v75
    v_cvt_pk_bf16_f32 v73, v73, v75
    v_exp_f32 v35, v35
    s_waitcnt vmcnt(4)
    v_mfma_f32_16x16x16_bf16 v[40:43], v[100:101], v[72:73], 0
    v_exp_f32 v36, v36
    v_cvt_pk_bf16_f32 v32, v32, v33
    v_exp_f32 v37, v37
    v_cvt_pk_bf16_f32 v33, v34, v35
    v_exp_f32 v38, v38
    v_exp_f32 v39, v39
    v_cvt_pk_bf16_f32 v34, v36, v37
    v_cvt_pk_bf16_f32 v35, v38, v39
    s_nop 1
    v_mfma_f32_16x16x32_bf16 v[40:43], v[96:99], v[32:35], v[40:43]
    v_mfma_f32_16x16x32_bf16 v[64:67], v[88:91], v[32:35], 0
    v_mfma_f32_16x16x32_bf16 v[68:71], v[92:95], v[32:35], 0
    s_waitcnt vmcnt(3)
main_kernel_cs_v_ok:
    v_bitop3_b32 v44, v86, s22, 1 bitop3:0x28
    v_swap_b32 v85, v86
    v_cmp_ne_u32 vcc, 0, v44
main_kernel_cs_d_ok:
    s_nop 0
    v_mfma_f32_16x16x16_bf16 v[64:67], v[84:85], v[72:73], v[64:67]
    v_mfma_f32_16x16x16_bf16 v[68:71], v[86:87], v[72:73], v[68:71]
    s_cbranch_vccnz main_kernel_cs_v_f
    v_rcp_f32 v42, v40
    v_subrev_u32 v41, 0x21800000, v41
    v_cmp_lt_u32 vcc, 0x3c000000, v41
    s_nop 0
    v_pk_mul_f32 v[64:65], v[64:65], v[42:43] op_sel_hi:[1,0]
    v_pk_mul_f32 v[66:67], v[66:67], v[42:43] op_sel_hi:[1,0]
    v_cvt_pk_bf16_f32 v44, v64, v65
    v_pk_mul_f32 v[68:69], v[68:69], v[42:43] op_sel_hi:[1,0]
    v_cvt_pk_bf16_f32 v45, v66, v67
    v_pk_mul_f32 v[70:71], v[70:71], v[42:43] op_sel_hi:[1,0]
    v_cvt_pk_bf16_f32 v46, v68, v69
    v_cvt_pk_bf16_f32 v47, v70, v71
    ds_write_b128 v118, v[44:47]
    s_and_b64 s[42:43], vcc, s[44:45]
    s_cbranch_scc1 main_kernel_cs_d_f
    s_mov_b64 s[44:45], s[0:1]
    v_mov_b32 v64, 0
    v_mov_b32 v65, 0
    v_mov_b32 v66, 0
    v_mov_b32 v67, 0
    v_mov_b32 v68, 0
    v_mov_b32 v69, 0
    v_mov_b32 v70, 0
    v_mov_b32 v71, 0
    v_bfe_u32 v90, v123, 1, 7
    s_xor_b32 s23, s23, 0x80000
    s_waitcnt lgkmcnt(0)
    s_barrier
    ds_read_b128 v[56:59], v114 offset:1024
    ds_read_b128 v[60:63], v114 offset:1536
    ds_read_b128 v[48:51], v114 offset:0
    ds_read_b128 v[52:55], v114 offset:512
    s_xor_b32 s18, s18, 0x100000
    s_xor_b32 s19, s18, 0x80000
    s_xor_b32 s25, s25, 0x4000
    s_add_u32 s27, s27, 0x40000
    v_add_u32 v121, 4, v121
    v_xor_b32 v112, 0x4000, v112
    s_xor_b32 s36, s36, 0x4000
    s_mov_b32 m0, 0
    s_mov_b32 s54, s24
    s_xor_b32 s24, s24, 0x4000
    s_add_u32 s55, s25, 4096
    v_mov_b32 v89, s17
    s_mov_b32 s15, 0
    s_add_u32 s56, s19, 1536
    s_xor_b32 s9, s11, s40
    s_add_u32 s16, s20, s38
    s_waitcnt lgkmcnt(3)
    v_smfmac_f32_16x16x64_bf16 v[76:79], v[56:59], v[0:7], v110
    s_waitcnt lgkmcnt(2)
    ds_read_b128 v[0:3], v113 offset:20480
    v_smfmac_f32_16x16x64_bf16 v[76:79], v[60:63], v[8:15], v110
    s_waitcnt lgkmcnt(2)
    ds_read_b128 v[4:7], v113 offset:21504
    v_smfmac_f32_16x16x64_bf16 v[76:79], v[48:51], v[192:199], v110
    s_waitcnt lgkmcnt(2)
    ds_read_b128 v[8:11], v113 offset:28672
    v_smfmac_f32_16x16x64_bf16 v[76:79], v[52:55], v[200:207], v110
    ds_read_b128 v[12:15], v113 offset:29696
    buffer_load_dword v111, v90, s[4:7], s47 offen sc1
    v_smfmac_f32_16x16x64_bf16 v[80:83], v[56:59], v[16:23], v110
    ds_read_b128 v[16:19], v113 offset:22528
    v_smfmac_f32_16x16x64_bf16 v[80:83], v[60:63], v[24:31], v110
    ds_read_b128 v[20:23], v113 offset:23552
    v_smfmac_f32_16x16x64_bf16 v[80:83], v[48:51], v[208:215], v110
    ds_read_b128 v[24:27], v113 offset:30720
    v_cvt_pk_f16_f32 v40, v76, v77
    v_smfmac_f32_16x16x64_bf16 v[80:83], v[52:55], v[216:223], v110
    ds_read_b128 v[28:31], v113 offset:31744
    v_cvt_pk_f16_f32 v41, v78, v79
    v_smfmac_f32_16x16x64_bf16 v[64:67], v[48:51], v[224:231], v110
    v_bfi_b32 v40, 1, s22, v40
    v_smfmac_f32_16x16x64_bf16 v[64:67], v[52:55], v[232:239], v110
    s_waitcnt lgkmcnt(6)
    buffer_load_dword v111, v90, s[4:7], s47 offen sc1
    v_smfmac_f32_16x16x64_bf16 v[64:67], v[56:59], v[0:7], v110
    s_waitcnt lgkmcnt(4)
    buffer_store_dwordx2 v[40:41], v119, s[4:7], s21 offen offset:0 sc1
    v_cvt_pk_f16_f32 v42, v80, v81
    v_smfmac_f32_16x16x64_bf16 v[64:67], v[60:63], v[8:15], v110
    v_cvt_pk_f16_f32 v43, v82, v83
    v_smfmac_f32_16x16x64_bf16 v[68:71], v[48:51], v[240:247], v110
    v_bfi_b32 v42, 1, s22, v42
    v_smfmac_f32_16x16x64_bf16 v[68:71], v[52:55], v[248:255], v110
    s_waitcnt lgkmcnt(2)
    v_smfmac_f32_16x16x64_bf16 v[68:71], v[56:59], v[16:23], v110
    s_waitcnt lgkmcnt(0)
    buffer_store_dwordx2 v[42:43], v119, s[4:7], s21 offen offset:512 sc1
    v_cvt_pk_f16_f32 v44, v64, v65
    v_smfmac_f32_16x16x64_bf16 v[68:71], v[60:63], v[24:31], v110
    v_cvt_pk_f16_f32 v45, v66, v67
    v_bfi_b32 v44, 1, s22, v44
    s_cmp_lg_u32 s14, 0
    buffer_store_dwordx2 v[44:45], v119, s[4:7], s21 offen offset:1024 sc1
    s_nop 3
    v_cvt_pk_f16_f32 v46, v68, v69
    v_cvt_pk_f16_f32 v47, v70, v71
    v_bfi_b32 v46, 1, s22, v46
    buffer_store_dwordx2 v[46:47], v119, s[4:7], s21 offen offset:1536 sc1
    s_cbranch_scc1 main_kernel_cs_wx
    s_waitcnt vmcnt(5)
    s_xor_b32 s21, s21, 0x80000
main_kernel_cs_rgo:
    v_subrev_u32 v32, s20, v111
    s_memtime s[52:53]
    v_cmp_lt_u32 vcc, 0x100000, v32
    v_max_u32_dpp v32, v32, v32 row_shr:1 row_mask:0xf bank_mask:0xf
    s_nop 0
    s_nop 0
    v_max_u32_dpp v32, v32, v32 row_shr:2 row_mask:0xf bank_mask:0xf
    s_nop 0
    s_cbranch_vccnz main_kernel_cs_fsp
main_kernel_cs_fok:
    s_nop 0
    v_max_u32_dpp v32, v32, v32 row_shr:4 row_mask:0xf bank_mask:0xf
    s_memtime s[52:53]
    s_nop 0
    v_max_u32_dpp v32, v32, v32 row_shr:8 row_mask:0xf bank_mask:0xf
    s_memtime s[52:53]
    s_nop 0
    v_max_u32_dpp v32, v32, v32 row_bcast:15 row_mask:0xa bank_mask:0xf
    s_memtime s[52:53]
    s_sub_u32 s33, s52, s16
    v_readlane_b32 s32, v32, 31
    s_add_u32 s33, s33, 0x400
    s_memtime s[52:53]
    s_add_u32 s34, s16, 1650
    s_memtime s[52:53]
    s_min_u32 s32, s32, s33
    s_max_u32 s32, s32, s15
    s_add_u32 s34, s34, s32
    s_mov_b32 s35, 200
main_kernel_cs_fw:
    s_memtime s[52:53]
    s_cmp_ge_u32 s52, s34
    s_cbranch_scc1 main_kernel_cs_fgo
    s_memtime s[52:53]
    s_cmp_ge_u32 s52, s34
    s_cbranch_scc1 main_kernel_cs_fgo
    s_memtime s[52:53]
    s_cmp_ge_u32 s52, s34
    s_cbranch_scc1 main_kernel_cs_fgo
    s_memtime s[52:53]
    s_cmp_ge_u32 s52, s34
    s_cbranch_scc1 main_kernel_cs_fgo
    s_memtime s[52:53]
    s_cmp_ge_u32 s52, s34
    s_cbranch_scc1 main_kernel_cs_fgo
    s_memtime s[52:53]
    s_cmp_ge_u32 s52, s34
    s_cbranch_scc1 main_kernel_cs_fgo
    s_memtime s[52:53]
    s_cmp_ge_u32 s52, s34
    s_cbranch_scc1 main_kernel_cs_fgo
    s_memtime s[52:53]
    s_cmp_ge_u32 s52, s34
    s_cbranch_scc1 main_kernel_cs_fgo
    s_sub_u32 s35, s35, 1
    s_cbranch_scc0 main_kernel_cs_fw
main_kernel_cs_fgo:
    buffer_load_dwordx4 v[0:3], v120, s[4:7], s23 offen sc1
    s_add_u32 s35, s23, 0x8000
    buffer_load_dwordx4 v[4:7], v120, s[4:7], s35 offen sc1
    s_add_u32 s35, s23, 0x10000
    buffer_load_dwordx4 v[8:11], v120, s[4:7], s35 offen sc1
    ds_read_b32 v33, v123 offset:20992
    s_add_u32 s35, s23, 0x18000
    buffer_load_dwordx4 v[12:15], v120, s[4:7], s35 offen sc1
    s_add_u32 s35, s23, 0x20000
    buffer_load_dwordx4 v[16:19], v120, s[4:7], s35 offen sc1
    s_add_u32 s35, s23, 0x28000
    buffer_load_dwordx4 v[20:23], v120, s[4:7], s35 offen sc1
    s_add_u32 s35, s23, 0x30000
    buffer_load_dwordx4 v[24:27], v120, s[4:7], s35 offen sc1
    s_add_u32 s35, s23, 0x38000
    buffer_load_dwordx4 v[28:31], v120, s[4:7], s35 offen sc1
    s_mov_b64 exec, 1
    s_waitcnt lgkmcnt(0)
    v_sub_u32 v33, s34, v33
    v_bfi_b32 v33, 1, s40, v33
    buffer_store_dword v33, off, s[4:7], s18 offset:1536 sc1
    v_readfirstlane_b32 s10, v33
    s_mov_b64 exec, -1
    s_waitcnt vmcnt(8)
    v_mfma_f32_16x16x32_f16 v[76:79], v[0:3], v[106:109], 0
    v_xor_b32 v36, s22, v0
    v_bitop3_b32 v36, v2, s22, v36 bitop3:0xbe
    s_waitcnt vmcnt(7)
    v_mfma_f32_16x16x32_f16 v[76:79], v[4:7], v[106:109], v[76:79]
    v_bitop3_b32 v36, v4, s22, v36 bitop3:0xbe
    v_bitop3_b32 v36, v6, s22, v36 bitop3:0xbe
    s_waitcnt vmcnt(6)
    v_mfma_f32_16x16x32_f16 v[76:79], v[8:11], v[106:109], v[76:79]
    v_bitop3_b32 v36, v8, s22, v36 bitop3:0xbe
    v_bitop3_b32 v36, v10, s22, v36 bitop3:0xbe
    s_waitcnt vmcnt(5)
    v_mfma_f32_16x16x32_f16 v[76:79], v[12:15], v[106:109], v[76:79]
    v_bitop3_b32 v36, v12, s22, v36 bitop3:0xbe
    v_bitop3_b32 v36, v14, s22, v36 bitop3:0xbe
    s_waitcnt vmcnt(4)
    v_mfma_f32_16x16x32_f16 v[76:79], v[16:19], v[106:109], v[76:79]
    v_bitop3_b32 v36, v16, s22, v36 bitop3:0xbe
    v_bitop3_b32 v36, v18, s22, v36 bitop3:0xbe
    s_waitcnt vmcnt(3)
    v_mfma_f32_16x16x32_f16 v[76:79], v[20:23], v[106:109], v[76:79]
    v_bitop3_b32 v36, v20, s22, v36 bitop3:0xbe
    v_bitop3_b32 v36, v22, s22, v36 bitop3:0xbe
    s_waitcnt vmcnt(2)
    v_mfma_f32_16x16x32_f16 v[76:79], v[24:27], v[106:109], v[76:79]
    v_bitop3_b32 v36, v24, s22, v36 bitop3:0xbe
    v_bitop3_b32 v36, v26, s22, v36 bitop3:0xbe
    s_waitcnt vmcnt(1)
    v_mfma_f32_16x16x32_f16 v[76:79], v[28:31], v[106:109], v[76:79]
    v_bitop3_b32 v36, v28, s22, v36 bitop3:0xbe
    v_bitop3_b32 v36, v30, s22, v36 bitop3:0xbe
    v_and_b32 v36, 1, v36
    v_cmp_ne_u32 vcc, 0, v36
    s_nop 3
    v_cvt_pk_bf16_f32 v126, v76, v77
    v_cvt_pk_bf16_f32 v127, v78, v79
    s_cbranch_vccnz main_kernel_cs_r_f
    buffer_store_dwordx2 v[126:127], v122, s[4:7], s24 offen sc1
    s_sub_u32 s20, s34, s38
    s_mov_b32 s3, s34
    buffer_store_dword v89, v117, s[4:7], s46 offen offset:512 sc1
    v_mov_b32 v32, -1
    v_mov_b32 v33, -1
    v_mov_b32 v64, 0
    v_mov_b32 v65, 0
    v_mov_b32 v66, 0
    v_mov_b32 v67, 0
    v_mov_b32 v68, 0
    v_mov_b32 v69, 0
    v_mov_b32 v70, 0
    v_mov_b32 v71, 0
    v_mov_b32 v96, 0
    v_mov_b32 v97, 0
    v_mov_b32 v98, 0
    v_mov_b32 v99, 0
    buffer_store_dwordx2 v[32:33], v122, s[4:7], s54 offen sc1
    s_cmp_eq_u32 s12, 0
    v_add_u32 v56, s59, v115
    s_cbranch_scc0 main_kernel_cs_vma
    ds_read_b64_tr_b16 v[80:81], v56 offset:16384
    ds_read_b64_tr_b16 v[82:83], v56 offset:17408
    s_waitcnt lgkmcnt(0)
    s_nop 15
    s_nop 15
    s_nop 5
    s_buffer_load_dword s9, s[4:7], s56 glc
    buffer_load_dword v111, v90, s[4:7], s47 offen offset:512 sc1
    buffer_load_dwordx4 v116, s[4:7], s25 offen offset:0 sc1 lds
    buffer_load_dwordx4 v116, s[4:7], s25 offen offset:1024 sc1 lds
    buffer_load_dwordx4 v116, s[4:7], s25 offen offset:2048 sc1 lds
    buffer_load_dwordx4 v116, s[4:7], s25 offen offset:3072 sc1 lds
    s_mov_b32 m0, 4096
    s_nop 0
    buffer_load_dwordx4 v116, s[4:7], s55 offen offset:0 sc1 lds
    buffer_load_dwordx4 v116, s[4:7], s55 offen offset:1024 sc1 lds
    buffer_load_dwordx4 v116, s[4:7], s55 offen offset:2048 sc1 lds
    buffer_load_dwordx4 v116, s[4:7], s55 offen offset:3072 sc1 lds
    v_mov_b32 v34, v90
    s_mov_b32 m0, s36
    s_barrier
    ds_read_b32 v35, v123 offset:20480
    buffer_load_dwordx4 v[88:91], v116, s[4:7], s28 offen offset:0 sc1
    buffer_load_dwordx4 v[92:95], v116, s[4:7], s28 offen offset:1024 sc1
    buffer_load_dwordx4 v116, s[4:7], s27 offen offset:0 sc1 lds
    buffer_store_dwordx4 v[80:83], v125, s[4:7], s26 offen sc1
    s_branch main_kernel_cs_kva
main_kernel_cs_vma:
    v_mfma_f32_16x16x32_bf16 v[56:59], v[102:105], v[84:87], 0
    s_nop 7
    v_cvt_pk_bf16_f32 v80, v56, v57
    v_cvt_pk_bf16_f32 v81, v58, v59
    s_nop 15
    s_nop 15
    s_nop 5
    s_buffer_load_dword s9, s[4:7], s56 glc
    buffer_load_dword v111, v90, s[4:7], s47 offen offset:512 sc1
    buffer_load_dwordx4 v116, s[4:7], s25 offen offset:0 sc1 lds
    buffer_load_dwordx4 v116, s[4:7], s25 offen offset:1024 sc1 lds
    buffer_load_dwordx4 v116, s[4:7], s25 offen offset:2048 sc1 lds
    buffer_load_dwordx4 v116, s[4:7], s25 offen offset:3072 sc1 lds
    s_mov_b32 m0, 4096
    s_nop 0
    buffer_load_dwordx4 v116, s[4:7], s55 offen offset:0 sc1 lds
    buffer_load_dwordx4 v116, s[4:7], s55 offen offset:1024 sc1 lds
    buffer_load_dwordx4 v116, s[4:7], s55 offen offset:2048 sc1 lds
    buffer_load_dwordx4 v116, s[4:7], s55 offen offset:3072 sc1 lds
    v_mov_b32 v34, v90
    s_mov_b32 m0, s36
    s_barrier
    ds_read_b32 v35, v123 offset:20480
    buffer_load_dwordx4 v[88:91], v116, s[4:7], s28 offen offset:0 sc1
    buffer_load_dwordx4 v[92:95], v116, s[4:7], s28 offen offset:1024 sc1
    buffer_load_dwordx4 v116, s[4:7], s27 offen offset:0 sc1 lds
    buffer_store_dwordx2 v[80:81], v123, s[4:7], s26 offen sc1
main_kernel_cs_kva:
    s_add_u32 s26, s26, 0x10000
    s_waitcnt vmcnt(12)
    v_cmp_gt_i32 vcc, s17, v111
    v_readfirstlane_b32 s38, v35
    s_cbranch_vccnz main_kernel_cs_mc_f
    s_waitcnt vmcnt(4)
    s_branch main_kernel_cs_top
main_kernel_cs_wx:
    s_cmp_lg_u32 s14, 1
    s_cbranch_scc1 main_kernel_cs_wy
    s_memrealtime s[32:33]
    s_nop 0
    s_nop 0
    s_memrealtime s[32:33]
    s_nop 0
    s_nop 0
    s_memrealtime s[32:33]
    s_nop 0
    s_nop 0
    s_memrealtime s[32:33]
    s_nop 0
    s_nop 0
    s_memrealtime s[32:33]
    s_nop 0
    s_nop 0
    s_memrealtime s[32:33]
    s_nop 0
    s_nop 0
    s_memrealtime s[32:33]
    s_nop 0
    s_nop 0
    s_memrealtime s[32:33]
    s_nop 0
    s_nop 0
    s_memrealtime s[32:33]
    s_nop 0
    s_nop 0
    s_memrealtime s[32:33]
    s_nop 0
    s_nop 0
    s_memrealtime s[32:33]
    s_nop 0
    s_nop 0
    s_memrealtime s[32:33]
    s_nop 0
    s_nop 0
    s_mov_b32 s34, s32
    s_memrealtime s[32:33]
    s_cmp_lg_u32 s32, s34
    s_cbranch_scc1 main_kernel_cs_e1
    s_memrealtime s[32:33]
    s_cmp_lg_u32 s32, s34
    s_cbranch_scc1 main_kernel_cs_e1
    s_memrealtime s[32:33]
    s_cmp_lg_u32 s32, s34
    s_cbranch_scc1 main_kernel_cs_e1
    s_memrealtime s[32:33]
    s_cmp_lg_u32 s32, s34
    s_cbranch_scc1 main_kernel_cs_e1
    s_memrealtime s[32:33]
    s_cmp_lg_u32 s32, s34
    s_cbranch_scc1 main_kernel_cs_e1
    s_memrealtime s[32:33]
    s_cmp_lg_u32 s32, s34
    s_cbranch_scc1 main_kernel_cs_e1
    s_memrealtime s[32:33]
    s_cmp_lg_u32 s32, s34
    s_cbranch_scc1 main_kernel_cs_e1
    s_memrealtime s[32:33]
    s_cmp_lg_u32 s32, s34
    s_cbranch_scc1 main_kernel_cs_e1
    s_memrealtime s[32:33]
    s_cmp_lg_u32 s32, s34
    s_cbranch_scc1 main_kernel_cs_e1
    s_memrealtime s[32:33]
    s_cmp_lg_u32 s32, s34
    s_cbranch_scc1 main_kernel_cs_e1
    s_memrealtime s[32:33]
    s_cmp_lg_u32 s32, s34
    s_cbranch_scc1 main_kernel_cs_e1
    s_memrealtime s[32:33]
    s_cmp_lg_u32 s32, s34
    s_cbranch_scc1 main_kernel_cs_e1
main_kernel_cs_e1:
    s_memtime s[52:53]
    s_mul_i32 s34, s32, 22
    s_waitcnt lgkmcnt(0)
    s_sub_u32 s32, s52, s34
    s_sub_u32 s33, s32, s38
    s_sub_u32 s33, s33, s10
    s_max_i32 s33, s33, -400
    s_min_i32 s33, s33, 400
    s_ashr_i32 s33, s33, 2
    s_add_u32 s10, s10, s33
    s_mov_b32 s33, s10
    s_ashr_i32 s34, s33, 2
    s_add_u32 s34, s34, s32
    v_mov_b32 v34, s34
    v_mov_b32 v33, s32
    ds_write2st64_b32 v123, v33, v34 offset0:80 offset1:82
    v_add_u32 v37, s33, v34
main_kernel_cs_wy:
    s_xor_b32 s21, s21, 0x80000
    v_mov_b32 v64, 0
    v_mov_b32 v65, 0
    v_mov_b32 v66, 0
    v_mov_b32 v67, 0
    v_mov_b32 v68, 0
    v_mov_b32 v69, 0
    v_mov_b32 v70, 0
    v_mov_b32 v71, 0
    v_mov_b32 v96, 0
    v_mov_b32 v97, 0
    v_mov_b32 v98, 0
    v_mov_b32 v99, 0
    s_cmp_eq_u32 s12, 0
    v_add_u32 v56, s59, v115
    s_cbranch_scc0 main_kernel_cs_vmb
    ds_read_b64_tr_b16 v[80:81], v56 offset:16384
    ds_read_b64_tr_b16 v[82:83], v56 offset:17408
    s_waitcnt lgkmcnt(0)
    s_waitcnt vmcnt(0)
    s_mov_b32 m0, s36
    s_barrier
    ds_read_b32 v35, v123 offset:20480
    ds_write_b32 v124, v37 offset:3584
    buffer_load_dwordx4 v[88:91], v116, s[4:7], s28 offen offset:0 sc1
    buffer_load_dwordx4 v[92:95], v116, s[4:7], s28 offen offset:1024 sc1
    buffer_load_dwordx4 v116, s[4:7], s27 offen offset:0 sc1 lds
    buffer_store_dwordx4 v[80:83], v125, s[4:7], s26 offen sc1
    s_branch main_kernel_cs_kvb
main_kernel_cs_vmb:
    v_mfma_f32_16x16x32_bf16 v[56:59], v[102:105], v[84:87], 0
    s_nop 7
    v_cvt_pk_bf16_f32 v80, v56, v57
    v_cvt_pk_bf16_f32 v81, v58, v59
    s_waitcnt vmcnt(0)
    s_mov_b32 m0, s36
    s_barrier
    ds_read_b32 v35, v123 offset:20480
    ds_write_b32 v124, v37 offset:3584
    buffer_load_dwordx4 v[88:91], v116, s[4:7], s28 offen offset:0 sc1
    buffer_load_dwordx4 v[92:95], v116, s[4:7], s28 offen offset:1024 sc1
    buffer_load_dwordx4 v116, s[4:7], s27 offen offset:0 sc1 lds
    buffer_store_dwordx2 v[80:81], v123, s[4:7], s26 offen sc1
main_kernel_cs_kvb:
    s_add_u32 s26, s26, 0x10000
    s_mov_b64 exec, 1
    buffer_store_dword v100, off, s[4:7], s39 sc1
    s_mov_b64 exec, -1
    s_add_u32 s39, s39, 4
    s_waitcnt lgkmcnt(0)
    v_readfirstlane_b32 s38, v35
    v_mov_b32 v35, 0
    v_mov_b32 v35, 0
    v_mov_b32 v35, 0
    v_mov_b32 v35, 0
    v_mov_b32 v35, 0
    v_mov_b32 v35, 0
main_kernel_cs_end:
    s_branch main_kernel_cs_top
main_kernel_cs_mc_f:
    s_mov_b32 m0, 0
    s_sub_u32 s29, s29, 1
    s_cbranch_scc1 main_kernel_end
    buffer_load_dword v111, v34, s[4:7], s47 offen offset:512 sc1
    buffer_load_dwordx4 v116, s[4:7], s25 offen offset:0 sc1 lds
    buffer_load_dwordx4 v116, s[4:7], s25 offen offset:1024 sc1 lds
    buffer_load_dwordx4 v116, s[4:7], s25 offen offset:2048 sc1 lds
    buffer_load_dwordx4 v116, s[4:7], s25 offen offset:3072 sc1 lds
    s_mov_b32 m0, 4096
    s_nop 0
    buffer_load_dwordx4 v116, s[4:7], s55 offen offset:0 sc1 lds
    buffer_load_dwordx4 v116, s[4:7], s55 offen offset:1024 sc1 lds
    buffer_load_dwordx4 v116, s[4:7], s55 offen offset:2048 sc1 lds
    buffer_load_dwordx4 v116, s[4:7], s55 offen offset:3072 sc1 lds
    s_waitcnt vmcnt(8)
    v_cmp_gt_i32 vcc, s17, v111
    v_readfirstlane_b32 s38, v35
    s_cbranch_vccnz main_kernel_cs_mc_f
    s_waitcnt vmcnt(0)
    s_branch main_kernel_cs_end
main_kernel_cs_t_w:
    s_mov_b32 s35, 200
main_kernel_cs_t_s:
    s_memtime s[52:53]
    s_cmp_ge_u32 s52, s34
    s_cbranch_scc1 main_kernel_cs_t_go
    s_memtime s[52:53]
    s_cmp_ge_u32 s52, s34
    s_cbranch_scc1 main_kernel_cs_t_go
    s_memtime s[52:53]
    s_cmp_ge_u32 s52, s34
    s_cbranch_scc1 main_kernel_cs_t_go
    s_memtime s[52:53]
    s_cmp_ge_u32 s52, s34
    s_cbranch_scc1 main_kernel_cs_t_go
    s_memtime s[52:53]
    s_cmp_ge_u32 s52, s34
    s_cbranch_scc1 main_kernel_cs_t_go
    s_memtime s[52:53]
    s_cmp_ge_u32 s52, s34
    s_cbranch_scc1 main_kernel_cs_t_go
    s_memtime s[52:53]
    s_cmp_ge_u32 s52, s34
    s_cbranch_scc1 main_kernel_cs_t_go
    s_memtime s[52:53]
    s_cmp_ge_u32 s52, s34
    s_cbranch_scc1 main_kernel_cs_t_go
    s_sub_u32 s35, s35, 1
    s_cbranch_scc0 main_kernel_cs_t_s
    s_branch main_kernel_cs_t_go
main_kernel_cs_t_p:
    s_waitcnt lgkmcnt(0)
    s_xor_b32 s32, s9, s22
    s_bitcmp1_b32 s32, 0
    s_cbranch_scc0 main_kernel_cs_t_ok
    s_buffer_load_dword s9, s[4:7], s56 glc
    s_sub_u32 s29, s29, 1
    s_cbranch_scc1 main_kernel_end
    s_branch main_kernel_cs_t_p
main_kernel_cs_z0_f:
    buffer_load_dwordx2 v[126:127], v123, s[4:7], s19 offen offset:0 sc1
    s_sub_u32 s29, s29, 1
    s_cbranch_scc1 main_kernel_end
    s_waitcnt vmcnt(0)
    s_branch main_kernel_cs_z0
main_kernel_cs_z2_f:
    buffer_load_dwordx2 v[64:65], v123, s[4:7], s19 offen offset:512 sc1
    s_sub_u32 s29, s29, 1
    s_cbranch_scc1 main_kernel_end
    s_waitcnt vmcnt(0)
main_kernel_cs_z1_f:
    s_waitcnt vmcnt(0)
    s_memtime s[52:53]
    v_dot2_f32_bf16 v44, v64, s37, v68
    v_dot2_f32_bf16 v45, v64, s57, v69
    v_dot2_f32_bf16 v46, v65, s37, v70
    v_dot2_f32_bf16 v47, v65, s57, v71
    v_bitop3_b32 v60, v64, s22, 1 bitop3:0x28
    v_cvt_pk_bf16_f32 v44, v44, v45
    v_cmp_ne_u32 vcc, 0, v60
    v_cvt_pk_bf16_f32 v45, v46, v47
    ds_write_b64 v124, v[44:45] offset:512
    s_cbranch_vccnz main_kernel_cs_z2_f
    s_branch main_kernel_cs_z_ok
main_kernel_cs_kvw:
    s_cmp_eq_u32 s17, 64
    s_cbranch_scc1 main_kernel_cs_kvok
    s_waitcnt vmcnt(0)
    s_mov_b32 exec_lo, 0
    s_mov_b32 exec_hi, 0x3f00
    v_subrev_u32 v127, 0, v121
main_kernel_cs_kvp:
    buffer_load_dword v126, v127, s[4:7], 0 offen sc1
    s_waitcnt vmcnt(0)
    v_cmp_eq_u32 vcc, 0, v126
    s_cbranch_vccz main_kernel_cs_kvp_ok
    s_sleep 2
    s_sub_u32 s29, s29, 1
    s_cbranch_scc0 main_kernel_cs_kvp
    s_branch main_kernel_end
main_kernel_cs_kvp_ok:
    s_mov_b64 exec, -1
    s_branch main_kernel_cs_kvok
main_kernel_cs_last:
    buffer_load_dwordx2 v[86:87], v123, s[4:7], s19 offen offset:1024 sc1
    s_sub_u32 s29, s29, 1
    s_cbranch_scc1 main_kernel_end
    s_waitcnt vmcnt(0) lgkmcnt(0)
    v_bitop3_b32 v44, v86, s22, 1 bitop3:0x28
    v_cmp_ne_u32 vcc, 0, v44
    s_cbranch_vccnz main_kernel_cs_last
    v_swap_b32 v85, v86
    s_cmp_eq_u32 s12, 0
    v_add_u32 v56, s59, v115
    s_cbranch_scc0 main_kernel_cs_vmc
    ds_read_b64_tr_b16 v[80:81], v56 offset:16384
    ds_read_b64_tr_b16 v[82:83], v56 offset:17408
    s_waitcnt lgkmcnt(0)
    buffer_store_dwordx4 v[80:83], v125, s[4:7], s26 offen sc1
    s_branch main_kernel_cs_kvc
main_kernel_cs_vmc:
    v_mfma_f32_16x16x32_bf16 v[56:59], v[102:105], v[84:87], 0
    s_nop 7
    v_cvt_pk_bf16_f32 v80, v56, v57
    v_cvt_pk_bf16_f32 v81, v58, v59
    buffer_store_dwordx2 v[80:81], v123, s[4:7], s26 offen sc1
main_kernel_cs_kvc:
    s_add_u32 s26, s26, 0x10000
    s_branch main_kernel_end
main_kernel_cs_m_f:
main_kernel_cs_m_t:
    ds_read_b128 v[0:3], v116 offset:0
    ds_read_b128 v[4:7], v116 offset:1024
    ds_read_b128 v[8:11], v116 offset:2048
    ds_read_b128 v[12:15], v116 offset:3072
    ds_read_b128 v[16:19], v116 offset:4096
    ds_read_b128 v[20:23], v116 offset:5120
    ds_read_b128 v[24:27], v116 offset:6144
    ds_read_b128 v[28:31], v116 offset:7168
    s_waitcnt lgkmcnt(0)
    v_max_u32 v126, v0, v2
    v_max3_u32 v126, v126, v4, v6
    v_max3_u32 v126, v126, v8, v10
    v_max3_u32 v126, v126, v12, v14
    v_max3_u32 v126, v126, v16, v18
    v_max3_u32 v126, v126, v20, v22
    v_max3_u32 v126, v126, v24, v26
    v_max3_u32 v126, v126, v28, v30
    v_cmp_eq_u32 vcc, -1, v126
    s_cbranch_vccz main_kernel_cs_m_g
    s_barrier
    s_lshl_b32 s32, s14, 11
    s_add_u32 m0, s32, 0
    s_add_u32 s32, s32, s25
    buffer_load_dwordx4 v116, s[4:7], s32 offen offset:0 sc1 lds
    buffer_load_dwordx4 v116, s[4:7], s32 offen offset:1024 sc1 lds
    s_sub_u32 s29, s29, 1
    s_cbranch_scc1 main_kernel_end
    s_waitcnt vmcnt(0)
    s_barrier
    s_branch main_kernel_cs_m_t
main_kernel_cs_m_g:
    s_mov_b64 s[44:45], 0
    v_mov_b32 v64, 0
    v_mov_b32 v65, 0
    v_mov_b32 v66, 0
    v_mov_b32 v67, 0
    v_mov_b32 v68, 0
    v_mov_b32 v69, 0
    v_mov_b32 v70, 0
    v_mov_b32 v71, 0
    v_mov_b32 v96, 0
    v_mov_b32 v97, 0
    v_mov_b32 v98, 0
    v_mov_b32 v99, 0
    s_branch main_kernel_cs_mrd
main_kernel_cs_v_f:
    v_swap_b32 v85, v86
    s_nop 7
    s_waitcnt vmcnt(1)
main_kernel_cs_v_t:
    s_memtime s[52:53]
    v_bitop3_b32 v44, v126, s22, 1 bitop3:0x28
    v_cmp_ne_u32 vcc, 0, v44
    s_sub_u32 s29, s29, 1
    s_cbranch_scc1 main_kernel_end
    s_cbranch_vccnz main_kernel_cs_v_g
    v_mfma_f32_16x16x32_bf16 v[64:67], v[88:91], v[32:35], 0
    v_mfma_f32_16x16x32_bf16 v[68:71], v[92:95], v[32:35], 0
    v_mov_b32 v86, v126
    v_mov_b32 v87, v127
    s_waitcnt lgkmcnt(0)
    s_sub_u32 s32, s52, s38
    s_add_u32 s32, s32, -550
    v_mov_b32 v46, s32
    buffer_store_dword v46, v117, s[4:7], s46 offen sc1
    s_branch main_kernel_cs_v_ok
main_kernel_cs_v_g:
    buffer_load_dwordx2 v[126:127], v123, s[4:7], s19 offen offset:1024 sc1
    s_waitcnt lgkmcnt(0)
    s_sub_u32 s32, s52, s38
    s_add_u32 s32, s32, -50
    v_mov_b32 v46, s32
    buffer_store_dword v46, v117, s[4:7], s46 offen sc1
    s_waitcnt vmcnt(0)
    s_branch main_kernel_cs_v_t
main_kernel_cs_d_f:
    s_memtime s[52:53]
    s_waitcnt vmcnt(1) lgkmcnt(0)
    s_sub_u32 s32, s52, s38
    s_add_u32 s32, s32, 300
    v_mov_b32 v46, s32
    buffer_store_dword v46, v117, s[4:7], s46 offen sc1
    ds_read_b128 v[0:3], v112 offset:0
    ds_read_b128 v[4:7], v112 offset:1024
    ds_read_b128 v[8:11], v112 offset:2048
    ds_read_b128 v[12:15], v112 offset:3072
    ds_read_b128 v[16:19], v112 offset:4096
    ds_read_b128 v[20:23], v112 offset:5120
    ds_read_b128 v[24:27], v112 offset:6144
    ds_read_b128 v[28:31], v112 offset:7168
    s_waitcnt lgkmcnt(0)
    v_mfma_f32_16x16x32_bf16 v[32:35], v[0:3], v[48:51], 0
    v_mfma_f32_16x16x32_bf16 v[36:39], v[16:19], v[48:51], 0
    v_mfma_f32_16x16x32_bf16 v[72:75], v[48:51], v[48:51], 0
    v_mfma_f32_16x16x32_bf16 v[32:35], v[4:7], v[52:55], v[32:35]
    v_mfma_f32_16x16x32_bf16 v[36:39], v[20:23], v[52:55], v[36:39]
    v_mfma_f32_16x16x32_bf16 v[72:75], v[52:55], v[52:55], v[72:75]
    v_mfma_f32_16x16x32_bf16 v[32:35], v[8:11], v[56:59], v[32:35]
    v_mfma_f32_16x16x32_bf16 v[36:39], v[24:27], v[56:59], v[36:39]
    v_mfma_f32_16x16x32_bf16 v[72:75], v[56:59], v[56:59], v[72:75]
    v_mfma_f32_16x16x32_bf16 v[32:35], v[12:15], v[60:63], v[32:35]
    v_mfma_f32_16x16x32_bf16 v[36:39], v[28:31], v[60:63], v[36:39]
    v_mfma_f32_16x16x32_bf16 v[72:75], v[60:63], v[60:63], v[72:75]
    s_nop 7
    ds_read_b128 v[0:3], v113 offset:16384
    ds_read_b128 v[16:19], v113 offset:18432
    ds_read_b128 v[4:7], v113 offset:17408
    ds_read_b128 v[20:23], v113 offset:19456
    ds_read_b128 v[8:11], v113 offset:24576
    ds_read_b128 v[24:27], v113 offset:26624
    ds_read_b128 v[12:15], v113 offset:25600
    ds_read_b128 v[28:31], v113 offset:27648
    v_permlane32_swap_b32 v72, v73
    v_permlane32_swap_b32 v74, v75
    v_mul_f32 v73, s30, v73
    v_mul_f32 v75, s30, v75
    v_max_f32 v126, v73, v75
    v_max3_f32 v126, v126, v32, v33
    v_max3_f32 v126, v126, v34, v35
    v_max3_f32 v126, v126, v36, v37
    v_max3_f32 v126, v126, v38, v39
    v_mov_b32 v127, v126
    s_nop 1
    v_permlane32_swap_b32 v126, v127
    v_max_f32 v126, v126, v127
    v_mov_b32 v127, v126
    s_nop 1
    v_permlane16_swap_b32 v126, v127
    v_max_f32 v126, v126, v127
    v_sub_f32 v32, v32, v126
    v_sub_f32 v33, v33, v126
    v_sub_f32 v34, v34, v126
    v_sub_f32 v35, v35, v126
    v_sub_f32 v36, v36, v126
    v_sub_f32 v37, v37, v126
    v_sub_f32 v38, v38, v126
    v_sub_f32 v39, v39, v126
    v_sub_f32 v73, v73, v126
    v_sub_f32 v75, v75, v126
    v_exp_f32 v32, v32
    v_exp_f32 v33, v33
    v_exp_f32 v34, v34
    v_exp_f32 v35, v35
    v_exp_f32 v36, v36
    v_exp_f32 v37, v37
    v_exp_f32 v38, v38
    v_exp_f32 v39, v39
    v_exp_f32 v73, v73
    v_exp_f32 v75, v75
    v_cvt_pk_bf16_f32 v32, v32, v33
    v_cvt_pk_bf16_f32 v33, v34, v35
    v_cvt_pk_bf16_f32 v34, v36, v37
    v_cvt_pk_bf16_f32 v35, v38, v39
    v_cvt_pk_bf16_f32 v72, v73, v75
    v_cvt_pk_bf16_f32 v73, v73, v75
    s_nop 1
    v_mfma_f32_16x16x32_bf16 v[64:67], v[88:91], v[32:35], 0
    v_mfma_f32_16x16x32_bf16 v[68:71], v[92:95], v[32:35], 0
    v_mfma_f32_16x16x32_bf16 v[40:43], v[96:99], v[32:35], 0
    s_nop 3
    s_nop 1
    v_mfma_f32_16x16x16_bf16 v[40:43], v[100:101], v[72:73], v[40:43]
    s_mov_b64 s[44:45], 0
    s_mov_b64 vcc, 0
    s_nop 7
    s_branch main_kernel_cs_d_ok
main_kernel_cs_fsp:
    s_mov_b32 s35, 40
main_kernel_cs_fsl:
    buffer_load_dword v111, v90, s[4:7], s47 offen sc1
    s_waitcnt vmcnt(1)
    v_subrev_u32 v32, s20, v111
    v_cmp_lt_u32 vcc, 0x100000, v32
    s_cbranch_vccz main_kernel_cs_rgo
    s_sub_u32 s35, s35, 1
    s_cbranch_scc0 main_kernel_cs_fsl
    v_mov_b32 v32, 0
    s_branch main_kernel_cs_fok
main_kernel_cs_r_f:
    s_memtime s[52:53]
    buffer_load_dword v111, v90, s[4:7], s47 offen sc1
    s_waitcnt lgkmcnt(0)
    s_sub_u32 s15, s52, s16
    s_add_u32 s15, s15, -1500
    s_waitcnt vmcnt(0)
    s_sub_u32 s29, s29, 1
    s_cbranch_scc1 main_kernel_end
    s_branch main_kernel_cs_rgo
main_kernel_att:
    s_cmp_gt_u32 s13, 1
    s_cbranch_scc1 main_kernel_p_end
    s_cmp_lg_u32 s14, 0
    s_cbranch_scc1 main_kernel_p_bar
    s_lshl_b32 s32, s13, 21
    s_add_u32 s32, s32, 0x8c00000
    v_lshlrev_b32 v2, 2, v250
    v_mov_b32 v3, -1
    s_mov_b64 s[20:21], -1
    s_mov_b32 s34, 12
    s_mov_b32 exec_hi, 0
    s_waitcnt vmcnt(0)
main_kernel_p_lp:
    s_memtime s[16:17]
    s_waitcnt lgkmcnt(0)
    buffer_store_dword v3, v2, s[4:7], s32 offen sc1
    s_waitcnt vmcnt(0)
    s_memtime s[18:19]
    s_xor_b32 s32, s32, 0x2000
    s_waitcnt lgkmcnt(0)
    s_sub_u32 s33, s18, s16
    s_min_u32 s20, s20, s33
    s_memtime s[16:17]
    s_waitcnt lgkmcnt(0)
    buffer_store_dword v3, v2, s[4:7], s32 offen sc1
    s_waitcnt vmcnt(0)
    s_memtime s[18:19]
    s_xor_b32 s32, s32, 0x2000
    s_waitcnt lgkmcnt(0)
    s_sub_u32 s33, s18, s16
    s_min_u32 s21, s21, s33
    s_add_u32 s32, s32, 128
    s_sub_u32 s34, s34, 1
    s_cmp_lg_u32 s34, 0
    s_cbranch_scc1 main_kernel_p_lp
    s_cmp_lt_u32 s21, s20
    s_cselect_b32 s32, 3, 2
    s_lshl_b32 s33, s13, 2
    v_mov_b32 v3, s32
    s_mov_b64 exec, 1
    buffer_store_dword v3, off, s[60:63], s33 offset:16 sc1
    s_mov_b64 exec, -1
main_kernel_p_bar:
    s_barrier
main_kernel_p_end:
    v_lshlrev_b32 v0, 2, v250
    s_mov_b32 s32, 0x841f000
main_kernel_awf:
    buffer_load_dword v2, v0, s[4:7], s32 offen sc1
    s_waitcnt vmcnt(0)
    v_cmp_eq_u32 vcc, 0, v2
    s_cbranch_vccz main_kernel_awf_ok
    s_sleep 4
    s_sub_u32 s29, s29, 1
    s_cbranch_scc0 main_kernel_awf
    s_branch main_kernel_end
main_kernel_awf_ok:
main_kernel_att2:
    s_lshl_b32 s28, s13, 1
    s_lshr_b32 s31, s14, 1
    s_add_u32 s28, s28, s31
    s_and_b32 s30, s14, 1
    v_lshlrev_b32 v204, 4, v250
    v_and_b32 v200, 15, v250
    v_lshrrev_b32 v201, 4, v250
    v_and_b32 v202, 7, v250
    v_lshl_add_u32 v202, v201, 3, v202
    v_lshlrev_b32 v205, 4, v202
    v_bfe_u32 v206, v204, 1, 8
    v_min_u32 v207, 2, v250
    v_lshlrev_b32 v207, 13, v207
    s_lshl_b32 s31, s28, 8
    s_sub_u32 s31, 80912, s31
    s_cmp_eq_u32 s12, 7
    s_cselect_b32 s25, 61, 0
    s_cselect_b32 s32, 16, 0
    s_sub_u32 s31, s31, s32
    s_mov_b64 exec, 0xf0
    v_lshl_add_u32 v207, v250, 8, s31
    s_mov_b64 exec, -1
    v_mov_b32 v208, 1
    v_mov_b32 v209, 0
    s_lshl_b32 s31, s30, 4
    v_add_u32 v200, s31, v200
    v_lshlrev_b32 v202, 2, v201
    v_sub_u32 v200, v200, v202
    v_mov_b32 v202, 0xf149f2ca
    v_cmp_le_i32 vcc, 0, v200
    s_nop 1
    v_cndmask_b32 v124, v202, 0, vcc
    v_cmp_le_i32 vcc, 1, v200
    s_nop 1
    v_cndmask_b32 v125, v202, 0, vcc
    v_cmp_le_i32 vcc, 2, v200
    s_nop 1
    v_cndmask_b32 v126, v202, 0, vcc
    v_cmp_le_i32 vcc, 3, v200
    s_nop 1
    v_cndmask_b32 v127, v202, 0, vcc
    v_cmp_le_i32 vcc, 16, v200
    s_nop 1
    v_cndmask_b32 v128, v202, 0, vcc
    v_cmp_le_i32 vcc, 17, v200
    s_nop 1
    v_cndmask_b32 v129, v202, 0, vcc
    v_cmp_le_i32 vcc, 18, v200
    s_nop 1
    v_cndmask_b32 v130, v202, 0, vcc
    v_cmp_le_i32 vcc, 19, v200
    s_nop 1
    v_cndmask_b32 v131, v202, 0, vcc
    v_cmp_le_u32 vcc, 2, v201
    s_nop 1
    v_cndmask_b32 v132, v202, 0, vcc
    v_mov_b32 v180, 0x3f803f80
    v_cndmask_b32 v133, v202, 0, vcc
    v_mov_b32 v181, 0x3f803f80
    v_cndmask_b32 v134, v202, 0, vcc
    v_mov_b32 v182, 0x3f803f80
    v_cndmask_b32 v135, v202, 0, vcc
    v_mov_b32 v183, 0x3f803f80
    s_mov_b32 s26, 0x3e0293ee
    s_mov_b32 s27, 0xbe0293ee
    s_lshl_b32 s31, s28, 12
    s_add_u32 s16, s31, 0x1800000
    s_add_u32 s17, s16, 131072
    s_lshl_b32 s32, s30, 17
    s_add_u32 s31, s31, s32
    s_add_u32 s15, s31, 0x800000
    s_add_u32 s22, s31, 0x3800000
    s_lshl_b32 s31, s28, 13
    s_add_u32 s18, s31, 0x2800000
    s_add_u32 s19, s18, 4096
    s_lshl_b32 s31, s28, 11
    s_add_u32 s20, s31, 0x8000000
    s_add_u32 s21, s31, 0x6e00000
    s_lshl_b32 s31, s28, 8
    s_add_u32 s23, s31, 0x8404000
    s_lshl_b32 s31, s28, 3
    s_lshl_b32 s32, s30, 2
    s_add_u32 s31, s31, s32
    s_add_u32 s24, s31, 0x8400000
    v_and_b32 v210, 3, v250
    s_mov_b32 s39, 0
    v_lshlrev_b32 v210, 2, v210
    s_mov_b32 s33, 0x841ec00
    s_lshl_b32 s31, s25, 18
    s_add_u32 s15, s15, s31
    s_add_u32 s16, s16, s31
    s_add_u32 s17, s17, s31
    s_add_u32 s18, s18, s31
    s_add_u32 s19, s19, s31
    s_add_u32 s22, s22, s31
    s_lshl_b32 s31, s25, 16
    s_add_u32 s20, s20, s31
    s_add_u32 s21, s21, s31
    s_lshl_b32 s31, s25, 8
    s_add_u32 s24, s24, s31
    s_lshl_b32 s31, s25, 2
    s_add_u32 s23, s23, s31
    s_add_u32 s33, s33, s31
    s_cmp_lg_u32 s25, 0
    s_cbranch_scc1 main_kernel_a_npf
    s_cmp_lt_u32 s13, 14
    s_cbranch_scc0 main_kernel_a_pf4
    s_mov_b32 s8, s68
    s_and_b32 s9, s69, 0xffff
    s_mov_b32 s10, 0x700000
    s_mov_b32 s11, 0x20000
    s_lshl_b32 s31, s13, 19
    s_branch main_kernel_a_pfg
main_kernel_a_pf4:
    s_mov_b32 s8, s70
    s_and_b32 s9, s71, 0xffff
    s_mov_b32 s10, 0x700000
    s_mov_b32 s11, 0x20000
    s_sub_u32 s31, s13, 2
    s_lshl_b32 s31, s31, 19
main_kernel_a_pfg:
    s_lshl_b32 s32, s14, 17
    s_add_u32 s31, s31, s32
    v_lshlrev_b32 v200, 7, v250
    buffer_load_dword v0, v200, s[8:11], s31 offen
    s_add_u32 s31, s31, 8192
    buffer_load_dword v0, v200, s[8:11], s31 offen
    s_add_u32 s31, s31, 8192
    buffer_load_dword v0, v200, s[8:11], s31 offen
    s_add_u32 s31, s31, 8192
    buffer_load_dword v0, v200, s[8:11], s31 offen
    s_add_u32 s31, s31, 8192
    buffer_load_dword v0, v200, s[8:11], s31 offen
    s_add_u32 s31, s31, 8192
    buffer_load_dword v0, v200, s[8:11], s31 offen
    s_add_u32 s31, s31, 8192
    buffer_load_dword v0, v200, s[8:11], s31 offen
    s_add_u32 s31, s31, 8192
    buffer_load_dword v0, v200, s[8:11], s31 offen
    s_add_u32 s31, s31, 8192
    buffer_load_dword v0, v200, s[8:11], s31 offen
    s_add_u32 s31, s31, 8192
    buffer_load_dword v0, v200, s[8:11], s31 offen
    s_add_u32 s31, s31, 8192
    buffer_load_dword v0, v200, s[8:11], s31 offen
    s_add_u32 s31, s31, 8192
    buffer_load_dword v0, v200, s[8:11], s31 offen
    s_add_u32 s31, s31, 8192
    buffer_load_dword v0, v200, s[8:11], s31 offen
    s_add_u32 s31, s31, 8192
    buffer_load_dword v0, v200, s[8:11], s31 offen
    s_add_u32 s31, s31, 8192
    buffer_load_dword v0, v200, s[8:11], s31 offen
    s_add_u32 s31, s31, 8192
    buffer_load_dword v0, v200, s[8:11], s31 offen
    s_add_u32 s31, s31, 8192
    s_mov_b32 s8, s70
    s_and_b32 s9, s71, 0xffff
    s_mov_b32 s10, 0x700000
    s_mov_b32 s11, 0x20000
    s_sub_u32 s31, s13, 0
    s_lshl_b32 s31, s31, 19
    s_cmp_ge_u32 s13, 12
    s_cbranch_scc1 main_kernel_a_npf
    s_lshl_b32 s32, s14, 17
    s_add_u32 s31, s31, s32
    v_lshlrev_b32 v200, 7, v250
    buffer_load_dword v0, v200, s[8:11], s31 offen
    s_add_u32 s31, s31, 8192
    buffer_load_dword v0, v200, s[8:11], s31 offen
    s_add_u32 s31, s31, 8192
    buffer_load_dword v0, v200, s[8:11], s31 offen
    s_add_u32 s31, s31, 8192
    buffer_load_dword v0, v200, s[8:11], s31 offen
    s_add_u32 s31, s31, 8192
    buffer_load_dword v0, v200, s[8:11], s31 offen
    s_add_u32 s31, s31, 8192
    buffer_load_dword v0, v200, s[8:11], s31 offen
    s_add_u32 s31, s31, 8192
    buffer_load_dword v0, v200, s[8:11], s31 offen
    s_add_u32 s31, s31, 8192
    buffer_load_dword v0, v200, s[8:11], s31 offen
    s_add_u32 s31, s31, 8192
    buffer_load_dword v0, v200, s[8:11], s31 offen
    s_add_u32 s31, s31, 8192
    buffer_load_dword v0, v200, s[8:11], s31 offen
    s_add_u32 s31, s31, 8192
    buffer_load_dword v0, v200, s[8:11], s31 offen
    s_add_u32 s31, s31, 8192
    buffer_load_dword v0, v200, s[8:11], s31 offen
    s_add_u32 s31, s31, 8192
    buffer_load_dword v0, v200, s[8:11], s31 offen
    s_add_u32 s31, s31, 8192
    buffer_load_dword v0, v200, s[8:11], s31 offen
    s_add_u32 s31, s31, 8192
    buffer_load_dword v0, v200, s[8:11], s31 offen
    s_add_u32 s31, s31, 8192
    buffer_load_dword v0, v200, s[8:11], s31 offen
    s_add_u32 s31, s31, 8192
    s_waitcnt vmcnt(0)
main_kernel_a_npf:
    s_cmp_eq_u32 s25, 0
    s_cbranch_scc1 main_kernel_a_fp
    s_sub_u32 s32, s24, 1280
main_kernel_a_gp:
    buffer_load_dword v200, v209, s[4:7], s32 offen sc1
    s_waitcnt vmcnt(0)
    v_cmp_eq_u32 vcc, 0, v200
    s_and_b32 s31, vcc_lo, 1
    s_cbranch_scc0 main_kernel_a_fp
    s_sleep 32
    s_sub_u32 s29, s29, 1
    s_cbranch_scc0 main_kernel_a_gp
    s_branch main_kernel_end
main_kernel_a_fp:
    buffer_load_dword v200, v207, s[4:7], s23 offen sc1
    s_waitcnt vmcnt(0)
    v_cmp_eq_u32 vcc, 0, v200
    s_and_b32 s31, vcc_lo, -1
    s_cbranch_scc0 main_kernel_a_fok
    s_sleep 8
    s_sub_u32 s29, s29, 1
    s_cbranch_scc0 main_kernel_a_fp
    s_branch main_kernel_end
main_kernel_a_fok:
    buffer_load_dwordx4 v[0:3], v204, s[4:7], s15 offen offset:0 sc1
    buffer_load_dwordx4 v[16:19], v204, s[4:7], s16 offen offset:0 sc1
    buffer_load_dwordx4 v[32:35], v204, s[4:7], s17 offen offset:0 sc1
    buffer_load_dwordx4 v[4:7], v204, s[4:7], s15 offen offset:1024 sc1
    buffer_load_dwordx4 v[20:23], v204, s[4:7], s16 offen offset:1024 sc1
    buffer_load_dwordx4 v[36:39], v204, s[4:7], s17 offen offset:1024 sc1
    buffer_load_dwordx4 v[8:11], v204, s[4:7], s15 offen offset:2048 sc1
    buffer_load_dwordx4 v[24:27], v204, s[4:7], s16 offen offset:2048 sc1
    buffer_load_dwordx4 v[40:43], v204, s[4:7], s17 offen offset:2048 sc1
    buffer_load_dwordx4 v[12:15], v204, s[4:7], s15 offen offset:3072 sc1
    buffer_load_dwordx4 v[28:31], v204, s[4:7], s16 offen offset:3072 sc1
    buffer_load_dwordx4 v[44:47], v204, s[4:7], s17 offen offset:3072 sc1
    buffer_load_dword v211, v210, s[4:7], s33 offen sc1
    buffer_load_dwordx4 v[48:51], v204, s[4:7], s18 offen offset:0 sc1
    buffer_load_dwordx4 v[52:55], v204, s[4:7], s18 offen offset:1024 sc1
    buffer_load_dwordx4 v[56:59], v204, s[4:7], s18 offen offset:2048 sc1
    buffer_load_dwordx4 v[60:63], v204, s[4:7], s18 offen offset:3072 sc1
    buffer_load_dwordx4 v[64:67], v204, s[4:7], s19 offen offset:0 sc1
    buffer_load_dwordx4 v[68:71], v204, s[4:7], s19 offen offset:1024 sc1
    buffer_load_dwordx4 v[72:75], v204, s[4:7], s19 offen offset:2048 sc1
    buffer_load_dwordx4 v[76:79], v204, s[4:7], s19 offen offset:3072 sc1
    s_waitcnt vmcnt(0)
main_kernel_a_top:
    s_cmp_ge_u32 s25, 60
    s_cselect_b32 s38, 2, 1
    s_lshl_b32 s34, s38, 18
    s_lshl_b32 s35, s38, 16
    s_lshl_b32 s36, s38, 8
    s_lshl_b32 s37, s38, 2
    s_waitcnt vmcnt(19)
    v_mfma_f32_16x16x32_bf16 v[112:115], v[16:19], v[0:3], v[124:127]
    v_mfma_f32_16x16x32_bf16 v[116:119], v[32:35], v[0:3], v[128:131]
    s_waitcnt vmcnt(16)
    v_mfma_f32_16x16x32_bf16 v[112:115], v[20:23], v[4:7], v[112:115]
    v_mfma_f32_16x16x32_bf16 v[116:119], v[36:39], v[4:7], v[116:119]
    s_waitcnt vmcnt(13)
    v_mfma_f32_16x16x32_bf16 v[112:115], v[24:27], v[8:11], v[112:115]
    v_mfma_f32_16x16x32_bf16 v[116:119], v[40:43], v[8:11], v[116:119]
    s_waitcnt vmcnt(10)
    v_mfma_f32_16x16x32_bf16 v[112:115], v[28:31], v[12:15], v[112:115]
    v_mfma_f32_16x16x32_bf16 v[116:119], v[44:47], v[12:15], v[116:119]
    s_add_u32 s15, s15, s34
    s_add_u32 s16, s16, s34
    s_add_u32 s17, s17, s34
    s_add_u32 s18, s18, s34
    s_add_u32 s19, s19, s34
    s_add_u32 s23, s23, s37
    s_waitcnt vmcnt(9)
    v_cmp_eq_u32 vcc, 0, v211
    s_nop 0
    v_max3_f32 v202, v112, v113, v114
    s_nop 1
    v_max3_f32 v202, v202, v115, v116
    v_max3_f32 v202, v202, v117, v118
    v_max_f32 v202, v202, v119
    s_cmp_lg_u32 s39, 0
    s_cbranch_scc1 main_kernel_a_mq
    s_cmp_ge_u32 s25, 56
    s_cselect_b32 s32, 1, 2
    s_and_b32 s31, vcc_lo, s32
    s_cbranch_scc0 main_kernel_a_mp
main_kernel_a_pp:
    buffer_load_dword v200, v210, s[4:7], s33 offen sc1
    s_waitcnt vmcnt(0)
    v_cmp_eq_u32 vcc, 0, v200
    s_and_b32 s31, vcc_lo, s32
    s_cbranch_scc0 main_kernel_a_pok
    s_sleep 2
    s_sub_u32 s29, s29, 1
    s_cbranch_scc0 main_kernel_a_pp
    s_branch main_kernel_end
main_kernel_a_pok:
    s_cmp_eq_u32 s32, 2
    s_cbranch_scc1 main_kernel_a_mp
    s_sleep 2
    s_cmp_eq_u32 s25, 63
    s_cbranch_scc1 main_kernel_a_mp
    s_sleep 40
main_kernel_a_mp:
    s_mov_b32 s39, 0
    buffer_load_dwordx4 v[80:83], v205, s[4:7], s20 offen offset:0 sc1
    buffer_load_dwordx4 v[84:87], v205, s[4:7], s20 offen offset:512 sc1
    buffer_load_dwordx4 v[88:91], v205, s[4:7], s20 offen offset:1024 sc1
    buffer_load_dwordx4 v[92:95], v205, s[4:7], s20 offen offset:1536 sc1
    buffer_load_dwordx2 v[96:97], v206, s[4:7], s21 offen offset:0 sc1
    buffer_load_dwordx2 v[98:99], v206, s[4:7], s21 offen offset:256 sc1
    buffer_load_dwordx2 v[100:101], v206, s[4:7], s21 offen offset:512 sc1
    buffer_load_dwordx2 v[102:103], v206, s[4:7], s21 offen offset:768 sc1
    buffer_load_dwordx2 v[104:105], v206, s[4:7], s21 offen offset:1024 sc1
    buffer_load_dwordx2 v[106:107], v206, s[4:7], s21 offen offset:1280 sc1
    buffer_load_dwordx2 v[108:109], v206, s[4:7], s21 offen offset:1536 sc1
    buffer_load_dwordx2 v[110:111], v206, s[4:7], s21 offen offset:1792 sc1
    buffer_load_dword v212, v207, s[4:7], s23 offen offset:0 sc1
    buffer_load_dword v211, v210, s[4:7], s33 offen sc1
main_kernel_a_mq:
    s_waitcnt vmcnt(13)
    v_mfma_f32_16x16x32_bf16 v[120:123], v[80:83], v[0:3], v[132:135]
    v_max3_u32 v200, v80, v81, v82
    v_max_u32 v200, v200, v83
    s_waitcnt vmcnt(12)
    v_mfma_f32_16x16x32_bf16 v[120:123], v[84:87], v[4:7], v[120:123]
    v_max3_u32 v200, v200, v84, v85
    v_max3_u32 v200, v200, v86, v87
    s_waitcnt vmcnt(11)
    v_mfma_f32_16x16x32_bf16 v[120:123], v[88:91], v[8:11], v[120:123]
    v_max3_u32 v200, v200, v88, v89
    v_max3_u32 v200, v200, v90, v91
    s_waitcnt vmcnt(10)
    v_mfma_f32_16x16x32_bf16 v[120:123], v[92:95], v[12:15], v[120:123]
    v_max3_u32 v200, v200, v92, v93
    v_max3_u32 v200, v200, v94, v95
    s_waitcnt vmcnt(8)
    v_max3_u32 v200, v200, v96, v97
    v_max3_u32 v200, v200, v98, v99
    s_waitcnt vmcnt(6)
    v_max3_u32 v200, v200, v100, v101
    v_max3_u32 v200, v200, v102, v103
    s_waitcnt vmcnt(4)
    v_max3_u32 v200, v200, v104, v105
    v_max3_u32 v200, v200, v106, v107
    s_waitcnt vmcnt(2)
    v_max3_u32 v200, v200, v108, v109
    v_max3_u32 v200, v200, v110, v111
    v_cmp_eq_u32 vcc, -1, v200
    s_cbranch_vccz main_kernel_a_mok
    s_sleep 1
    s_sub_u32 s29, s29, 1
    s_cbranch_scc0 main_kernel_a_mp
    s_branch main_kernel_end
main_kernel_a_mok:
    v_mul_f32 v120, s26, v120
    v_mul_f32 v121, s26, v121
    v_mul_f32 v122, s26, v122
    v_mul_f32 v123, s26, v123
    v_max3_f32 v200, v202, v120, v121
    v_max3_f32 v200, v200, v122, v123
    v_mov_b32 v201, v200
    s_add_u32 s20, s20, s35
    s_add_u32 s21, s21, s35
    v_permlane32_swap_b32 v200, v201
    v_max_f32 v200, v200, v201
    v_mov_b32 v201, v200
    s_nop 1
    v_permlane16_swap_b32 v200, v201
    v_max_f32 v200, v200, v201
    v_sub_f32 v112, v112, v200
    v_sub_f32 v113, v113, v200
    v_sub_f32 v114, v114, v200
    v_sub_f32 v115, v115, v200
    v_sub_f32 v116, v116, v200
    v_sub_f32 v117, v117, v200
    v_sub_f32 v118, v118, v200
    v_sub_f32 v119, v119, v200
    v_sub_f32 v120, v120, v200
    v_sub_f32 v121, v121, v200
    v_sub_f32 v122, v122, v200
    v_sub_f32 v123, v123, v200
    v_exp_f32 v112, v112
    v_exp_f32 v113, v113
    v_exp_f32 v114, v114
    v_cvt_pk_bf16_f32 v136, v112, v113
    v_exp_f32 v115, v115
    v_exp_f32 v116, v116
    v_cvt_pk_bf16_f32 v137, v114, v115
    v_exp_f32 v117, v117
    v_exp_f32 v118, v118
    v_cvt_pk_bf16_f32 v138, v116, v117
    v_exp_f32 v119, v119
    v_exp_f32 v120, v120
    v_cvt_pk_bf16_f32 v139, v118, v119
    v_exp_f32 v121, v121
    v_exp_f32 v122, v122
    v_cvt_pk_bf16_f32 v140, v120, v121
    v_exp_f32 v123, v123
    s_nop 0
    v_cvt_pk_bf16_f32 v141, v122, v123
    s_waitcnt vmcnt(1)
    v_mfma_f32_16x16x32_bf16 v[144:147], v[180:183], v[136:139], 0
    v_mfma_f32_16x16x32_bf16 v[148:151], v[48:51], v[136:139], 0
    s_nop 0
    s_nop 0
    s_nop 0
    v_mfma_f32_16x16x16_bf16 v[144:147], v[180:181], v[140:141], v[144:147]
    v_mfma_f32_16x16x32_bf16 v[152:155], v[52:55], v[136:139], 0
    v_mfma_f32_16x16x32_bf16 v[156:159], v[56:59], v[136:139], 0
    v_mfma_f32_16x16x32_bf16 v[160:163], v[60:63], v[136:139], 0
    v_mfma_f32_16x16x32_bf16 v[164:167], v[64:67], v[136:139], 0
    v_mfma_f32_16x16x32_bf16 v[168:171], v[68:71], v[136:139], 0
    v_mfma_f32_16x16x32_bf16 v[172:175], v[72:75], v[136:139], 0
    v_mfma_f32_16x16x32_bf16 v[176:179], v[76:79], v[136:139], 0
    v_rcp_f32 v200, v144
    v_mfma_f32_16x16x16_bf16 v[148:151], v[96:97], v[140:141], v[148:151]
    v_mfma_f32_16x16x16_bf16 v[152:155], v[98:99], v[140:141], v[152:155]
    v_mfma_f32_16x16x16_bf16 v[156:159], v[100:101], v[140:141], v[156:159]
    v_mfma_f32_16x16x16_bf16 v[160:163], v[102:103], v[140:141], v[160:163]
    v_mfma_f32_16x16x16_bf16 v[164:167], v[104:105], v[140:141], v[164:167]
    v_mfma_f32_16x16x16_bf16 v[168:171], v[106:107], v[140:141], v[168:171]
    v_mfma_f32_16x16x16_bf16 v[172:175], v[108:109], v[140:141], v[172:175]
    v_mfma_f32_16x16x16_bf16 v[176:179], v[110:111], v[140:141], v[176:179]
    v_mov_b32 v201, v200
    s_cmp_lg_u32 s39, 0
    s_cbranch_scc1 main_kernel_a_nw
    s_waitcnt vmcnt(0)
main_kernel_a_nw:
    v_cmp_ne_u32 vcc, 0, v211
    s_and_b32 s39, vcc_lo, 4
    v_cmp_eq_u32 vcc, 0, v212
    v_pk_mul_f32 v[148:149], v[148:149], v[200:201]
    v_pk_mul_f32 v[150:151], v[150:151], v[200:201]
    v_pk_mul_f32 v[152:153], v[152:153], v[200:201]
    v_pk_mul_f32 v[154:155], v[154:155], v[200:201]
    v_cvt_pk_bf16_f32 v184, v148, v149
    v_cvt_pk_bf16_f32 v185, v150, v151
    v_cvt_pk_bf16_f32 v186, v152, v153
    v_cvt_pk_bf16_f32 v187, v154, v155
    buffer_store_dwordx4 v[184:187], v204, s[4:7], s22 offen offset:0 sc1
    v_pk_mul_f32 v[156:157], v[156:157], v[200:201]
    v_pk_mul_f32 v[158:159], v[158:159], v[200:201]
    v_pk_mul_f32 v[160:161], v[160:161], v[200:201]
    v_pk_mul_f32 v[162:163], v[162:163], v[200:201]
    v_cvt_pk_bf16_f32 v188, v156, v157
    v_cvt_pk_bf16_f32 v189, v158, v159
    v_cvt_pk_bf16_f32 v190, v160, v161
    v_cvt_pk_bf16_f32 v191, v162, v163
    buffer_store_dwordx4 v[188:191], v204, s[4:7], s22 offen offset:1024 sc1
    v_pk_mul_f32 v[164:165], v[164:165], v[200:201]
    v_pk_mul_f32 v[166:167], v[166:167], v[200:201]
    v_pk_mul_f32 v[168:169], v[168:169], v[200:201]
    v_pk_mul_f32 v[170:171], v[170:171], v[200:201]
    v_cvt_pk_bf16_f32 v192, v164, v165
    v_cvt_pk_bf16_f32 v193, v166, v167
    v_cvt_pk_bf16_f32 v194, v168, v169
    v_cvt_pk_bf16_f32 v195, v170, v171
    buffer_store_dwordx4 v[192:195], v204, s[4:7], s22 offen offset:2048 sc1
    s_nop 0
    v_pk_mul_f32 v[172:173], v[172:173], v[200:201]
    v_pk_mul_f32 v[174:175], v[174:175], v[200:201]
    v_pk_mul_f32 v[176:177], v[176:177], v[200:201]
    v_pk_mul_f32 v[178:179], v[178:179], v[200:201]
    v_cvt_pk_bf16_f32 v196, v172, v173
    v_cvt_pk_bf16_f32 v197, v174, v175
    v_cvt_pk_bf16_f32 v198, v176, v177
    v_cvt_pk_bf16_f32 v199, v178, v179
    buffer_store_dwordx4 v[196:199], v204, s[4:7], s22 offen offset:3072 sc1
    s_add_u32 s22, s22, s34
    s_add_u32 s33, s33, s37
    s_add_u32 s25, s25, s38
    s_cmp_ge_u32 s25, 64
    s_cbranch_scc1 main_kernel_a_last
    s_cbranch_vccnz main_kernel_a_slow
    s_cmp_gt_u32 s25, 60
    s_cbranch_scc1 main_kernel_a_slow
    s_cmp_ge_u32 s25, 56
    s_cselect_b32 s39, 0, s39
    s_cmp_lg_u32 s39, 0
    s_cbranch_scc1 main_kernel_a_pre
    buffer_load_dwordx4 v[0:3], v204, s[4:7], s15 offen offset:0 sc1
    buffer_load_dwordx4 v[16:19], v204, s[4:7], s16 offen offset:0 sc1
    buffer_load_dwordx4 v[32:35], v204, s[4:7], s17 offen offset:0 sc1
    buffer_load_dwordx4 v[4:7], v204, s[4:7], s15 offen offset:1024 sc1
    buffer_load_dwordx4 v[20:23], v204, s[4:7], s16 offen offset:1024 sc1
    buffer_load_dwordx4 v[36:39], v204, s[4:7], s17 offen offset:1024 sc1
    buffer_load_dwordx4 v[8:11], v204, s[4:7], s15 offen offset:2048 sc1
    buffer_load_dwordx4 v[24:27], v204, s[4:7], s16 offen offset:2048 sc1
    buffer_load_dwordx4 v[40:43], v204, s[4:7], s17 offen offset:2048 sc1
    buffer_load_dwordx4 v[12:15], v204, s[4:7], s15 offen offset:3072 sc1
    buffer_load_dwordx4 v[28:31], v204, s[4:7], s16 offen offset:3072 sc1
    buffer_load_dwordx4 v[44:47], v204, s[4:7], s17 offen offset:3072 sc1
    buffer_load_dword v211, v210, s[4:7], s33 offen sc1
    buffer_load_dwordx4 v[48:51], v204, s[4:7], s18 offen offset:0 sc1
    buffer_load_dwordx4 v[52:55], v204, s[4:7], s18 offen offset:1024 sc1
    buffer_load_dwordx4 v[56:59], v204, s[4:7], s18 offen offset:2048 sc1
    buffer_load_dwordx4 v[60:63], v204, s[4:7], s18 offen offset:3072 sc1
    buffer_load_dwordx4 v[64:67], v204, s[4:7], s19 offen offset:0 sc1
    buffer_load_dwordx4 v[68:71], v204, s[4:7], s19 offen offset:1024 sc1
    buffer_load_dwordx4 v[72:75], v204, s[4:7], s19 offen offset:2048 sc1
    buffer_load_dwordx4 v[76:79], v204, s[4:7], s19 offen offset:3072 sc1
    s_waitcnt vmcnt(21)
    s_mov_b64 exec, 1
    buffer_store_dword v208, v209, s[4:7], s24 offen sc1
    s_mov_b64 exec, -1
    s_add_u32 s24, s24, s36
    s_branch main_kernel_a_top
main_kernel_a_pre:
    buffer_load_dwordx4 v[80:83], v205, s[4:7], s20 offen offset:0 sc1
    buffer_load_dwordx4 v[84:87], v205, s[4:7], s20 offen offset:512 sc1
    buffer_load_dwordx4 v[88:91], v205, s[4:7], s20 offen offset:1024 sc1
    buffer_load_dwordx4 v[92:95], v205, s[4:7], s20 offen offset:1536 sc1
    buffer_load_dwordx2 v[96:97], v206, s[4:7], s21 offen offset:0 sc1
    buffer_load_dwordx2 v[98:99], v206, s[4:7], s21 offen offset:256 sc1
    buffer_load_dwordx2 v[100:101], v206, s[4:7], s21 offen offset:512 sc1
    buffer_load_dwordx2 v[102:103], v206, s[4:7], s21 offen offset:768 sc1
    buffer_load_dwordx2 v[104:105], v206, s[4:7], s21 offen offset:1024 sc1
    buffer_load_dwordx2 v[106:107], v206, s[4:7], s21 offen offset:1280 sc1
    buffer_load_dwordx2 v[108:109], v206, s[4:7], s21 offen offset:1536 sc1
    buffer_load_dwordx2 v[110:111], v206, s[4:7], s21 offen offset:1792 sc1
    buffer_load_dword v212, v207, s[4:7], s23 offen offset:4 sc1
    buffer_load_dwordx4 v[0:3], v204, s[4:7], s15 offen offset:0 sc1
    buffer_load_dwordx4 v[16:19], v204, s[4:7], s16 offen offset:0 sc1
    buffer_load_dwordx4 v[32:35], v204, s[4:7], s17 offen offset:0 sc1
    buffer_load_dwordx4 v[4:7], v204, s[4:7], s15 offen offset:1024 sc1
    buffer_load_dwordx4 v[20:23], v204, s[4:7], s16 offen offset:1024 sc1
    buffer_load_dwordx4 v[36:39], v204, s[4:7], s17 offen offset:1024 sc1
    buffer_load_dwordx4 v[8:11], v204, s[4:7], s15 offen offset:2048 sc1
    buffer_load_dwordx4 v[24:27], v204, s[4:7], s16 offen offset:2048 sc1
    buffer_load_dwordx4 v[40:43], v204, s[4:7], s17 offen offset:2048 sc1
    buffer_load_dwordx4 v[12:15], v204, s[4:7], s15 offen offset:3072 sc1
    buffer_load_dwordx4 v[28:31], v204, s[4:7], s16 offen offset:3072 sc1
    buffer_load_dwordx4 v[44:47], v204, s[4:7], s17 offen offset:3072 sc1
    buffer_load_dword v211, v210, s[4:7], s33 offen sc1
    buffer_load_dwordx4 v[48:51], v204, s[4:7], s18 offen offset:0 sc1
    buffer_load_dwordx4 v[52:55], v204, s[4:7], s18 offen offset:1024 sc1
    buffer_load_dwordx4 v[56:59], v204, s[4:7], s18 offen offset:2048 sc1
    buffer_load_dwordx4 v[60:63], v204, s[4:7], s18 offen offset:3072 sc1
    buffer_load_dwordx4 v[64:67], v204, s[4:7], s19 offen offset:0 sc1
    buffer_load_dwordx4 v[68:71], v204, s[4:7], s19 offen offset:1024 sc1
    buffer_load_dwordx4 v[72:75], v204, s[4:7], s19 offen offset:2048 sc1
    buffer_load_dwordx4 v[76:79], v204, s[4:7], s19 offen offset:3072 sc1
    s_waitcnt vmcnt(34)
    s_mov_b64 exec, 1
    buffer_store_dword v208, v209, s[4:7], s24 offen sc1
    s_mov_b64 exec, -1
    s_add_u32 s24, s24, s36
    s_branch main_kernel_a_top
main_kernel_a_slow:
    s_mov_b32 s39, 0
    s_waitcnt vmcnt(0)
    s_mov_b64 exec, 1
    buffer_store_dword v208, v209, s[4:7], s24 offen sc1
    s_mov_b64 exec, -1
    s_add_u32 s24, s24, s36
    s_branch main_kernel_a_fp
main_kernel_a_last:
    s_waitcnt vmcnt(0)
    s_mov_b64 exec, 1
    buffer_store_dword v208, v209, s[4:7], s24 offen sc1
    s_mov_b64 exec, -1
    s_add_u32 s24, s24, s36
    s_branch main_kernel_end
main_kernel_wo:
    s_mov_b32 s8, s46
    s_and_b32 s9, s47, 0xffff
    s_mov_b32 s10, 0x800000
    s_mov_b32 s11, 0x20000
    v_lshlrev_b32 v170, 4, v250
    s_lshr_b32 s23, s12, 2
    s_sub_u32 s21, s12, 5
    s_cselect_b32 s23, s23, s21
    s_cselect_b32 s18, 36, 63
    v_lshrrev_b32 v178, 2, v250
    v_and_b32 v179, 3, v250
    v_lshlrev_b32 v0, 11, v178
    v_lshl_add_u32 v0, v179, 4, v0
    s_lshl_b32 s19, s14, 15
    v_lshl_add_u32 v1, v178, 6, s19
    v_lshl_add_u32 v1, v179, 3, v1
    s_lshl_b32 s20, s14, 21
    s_lshl_b32 s21, s13, 6
    s_add_u32 s20, s20, s21
    s_add_u32 s21, s20, 0x0
    s_add_u32 m0, s19, 0
    s_nop 0
    buffer_load_dwordx4 v0, s[8:11], s21 offen lds
    s_add_u32 s21, s20, 0x8000
    s_add_u32 m0, s19, 1024
    s_nop 0
    buffer_load_dwordx4 v0, s[8:11], s21 offen lds
    s_add_u32 s21, s20, 0x10000
    s_add_u32 m0, s19, 2048
    s_nop 0
    buffer_load_dwordx4 v0, s[8:11], s21 offen lds
    s_add_u32 s21, s20, 0x18000
    s_add_u32 m0, s19, 3072
    s_nop 0
    buffer_load_dwordx4 v0, s[8:11], s21 offen lds
    s_add_u32 s21, s20, 0x20000
    s_add_u32 m0, s19, 4096
    s_nop 0
    buffer_load_dwordx4 v0, s[8:11], s21 offen lds
    s_add_u32 s21, s20, 0x28000
    s_add_u32 m0, s19, 5120
    s_nop 0
    buffer_load_dwordx4 v0, s[8:11], s21 offen lds
    s_add_u32 s21, s20, 0x30000
    s_add_u32 m0, s19, 6144
    s_nop 0
    buffer_load_dwordx4 v0, s[8:11], s21 offen lds
    s_add_u32 s21, s20, 0x38000
    s_add_u32 m0, s19, 7168
    s_nop 0
    buffer_load_dwordx4 v0, s[8:11], s21 offen lds
    s_add_u32 s21, s20, 0x40000
    s_add_u32 m0, s19, 8192
    s_nop 0
    buffer_load_dwordx4 v0, s[8:11], s21 offen lds
    s_add_u32 s21, s20, 0x48000
    s_add_u32 m0, s19, 9216
    s_nop 0
    buffer_load_dwordx4 v0, s[8:11], s21 offen lds
    s_add_u32 s21, s20, 0x50000
    s_add_u32 m0, s19, 10240
    s_nop 0
    buffer_load_dwordx4 v0, s[8:11], s21 offen lds
    s_add_u32 s21, s20, 0x58000
    s_add_u32 m0, s19, 11264
    s_nop 0
    buffer_load_dwordx4 v0, s[8:11], s21 offen lds
    s_add_u32 s21, s20, 0x60000
    s_add_u32 m0, s19, 12288
    s_nop 0
    buffer_load_dwordx4 v0, s[8:11], s21 offen lds
    s_add_u32 s21, s20, 0x68000
    s_add_u32 m0, s19, 13312
    s_nop 0
    buffer_load_dwordx4 v0, s[8:11], s21 offen lds
    s_add_u32 s21, s20, 0x70000
    s_add_u32 m0, s19, 14336
    s_nop 0
    buffer_load_dwordx4 v0, s[8:11], s21 offen lds
    s_add_u32 s21, s20, 0x78000
    s_add_u32 m0, s19, 15360
    s_nop 0
    buffer_load_dwordx4 v0, s[8:11], s21 offen lds
    s_add_u32 s21, s20, 0x80000
    s_add_u32 m0, s19, 16384
    s_nop 0
    buffer_load_dwordx4 v0, s[8:11], s21 offen lds
    s_add_u32 s21, s20, 0x88000
    s_add_u32 m0, s19, 17408
    s_nop 0
    buffer_load_dwordx4 v0, s[8:11], s21 offen lds
    s_add_u32 s21, s20, 0x90000
    s_add_u32 m0, s19, 18432
    s_nop 0
    buffer_load_dwordx4 v0, s[8:11], s21 offen lds
    s_add_u32 s21, s20, 0x98000
    s_add_u32 m0, s19, 19456
    s_nop 0
    buffer_load_dwordx4 v0, s[8:11], s21 offen lds
    s_add_u32 s21, s20, 0xa0000
    s_add_u32 m0, s19, 20480
    s_nop 0
    buffer_load_dwordx4 v0, s[8:11], s21 offen lds
    s_add_u32 s21, s20, 0xa8000
    s_add_u32 m0, s19, 21504
    s_nop 0
    buffer_load_dwordx4 v0, s[8:11], s21 offen lds
    s_add_u32 s21, s20, 0xb0000
    s_add_u32 m0, s19, 22528
    s_nop 0
    buffer_load_dwordx4 v0, s[8:11], s21 offen lds
    s_add_u32 s21, s20, 0xb8000
    s_add_u32 m0, s19, 23552
    s_nop 0
    buffer_load_dwordx4 v0, s[8:11], s21 offen lds
    s_add_u32 s21, s20, 0xc0000
    s_add_u32 m0, s19, 24576
    s_nop 0
    buffer_load_dwordx4 v0, s[8:11], s21 offen lds
    s_add_u32 s21, s20, 0xc8000
    s_add_u32 m0, s19, 25600
    s_nop 0
    buffer_load_dwordx4 v0, s[8:11], s21 offen lds
    s_add_u32 s21, s20, 0xd0000
    s_add_u32 m0, s19, 26624
    s_nop 0
    buffer_load_dwordx4 v0, s[8:11], s21 offen lds
    s_add_u32 s21, s20, 0xd8000
    s_add_u32 m0, s19, 27648
    s_nop 0
    buffer_load_dwordx4 v0, s[8:11], s21 offen lds
    s_add_u32 s21, s20, 0xe0000
    s_add_u32 m0, s19, 28672
    s_nop 0
    buffer_load_dwordx4 v0, s[8:11], s21 offen lds
    s_add_u32 s21, s20, 0xe8000
    s_add_u32 m0, s19, 29696
    s_nop 0
    buffer_load_dwordx4 v0, s[8:11], s21 offen lds
    s_add_u32 s21, s20, 0xf0000
    s_add_u32 m0, s19, 30720
    s_nop 0
    buffer_load_dwordx4 v0, s[8:11], s21 offen lds
    s_add_u32 s21, s20, 0xf8000
    s_add_u32 m0, s19, 31744
    s_nop 0
    buffer_load_dwordx4 v0, s[8:11], s21 offen lds
    v_and_b32 v178, 15, v250
    v_lshrrev_b32 v179, 4, v250
    v_lshlrev_b32 v175, 11, v178
    v_lshl_add_u32 v175, v179, 3, v175
    s_lshl_b32 s21, s14, 11
    s_add_u32 s21, s21, 131072
    v_add_u32 v176, s21, v170
    s_lshl_b32 s21, s14, 10
    s_add_u32 s21, s21, 131072
    v_add_u32 v177, s21, v170
    s_lshr_b32 s21, s13, 2
    s_lshl_b32 s21, s21, 8
    s_add_u32 s21, s21, 0x8412000
    s_lshl2_add_u32 s21, s18, s21
    v_mov_b32 v172, s21
    v_mov_b32 v173, 4
    s_lshl_b32 s21, s14, 4
    s_add_u32 s21, s21, s23
    s_lshl_b32 s21, s21, 2
    s_add_u32 s21, s21, 0x8400000
    s_lshl_b32 s22, s18, 8
    s_add_u32 s21, s21, s22
    s_mov_b64 exec, 0xff
    v_lshl_add_u32 v172, v250, 3, s21
    v_mov_b32 v173, 0x100
    s_mov_b64 exec, -1
    s_lshl_b32 s15, s14, 15
    s_lshl_b32 s21, s23, 17
    s_add_u32 s15, s15, s21
    s_add_u32 s15, s15, 0x3800000
    s_lshl_b32 s21, s18, 18
    s_add_u32 s15, s15, s21
    s_lshl_b32 s21, s23, 15
    s_lshl_b32 s22, s18, 16
    s_add_u32 s21, s21, s22
    s_and_b32 s22, s14, 1
    s_lshl_b32 s16, s13, 1
    s_add_u32 s16, s16, s22
    s_lshl_b32 s16, s16, 5
    s_add_u32 s16, s16, s21
    s_lshl_b32 s17, s13, 7
    s_add_u32 s17, s17, s22
    s_lshl_b32 s17, s17, 3
    s_add_u32 s17, s17, s21
    s_add_u32 s17, s17, 0x6400000
    s_waitcnt vmcnt(24)
    ds_read_b64_tr_b16 a[0:1], v1 offset:0
    ds_read_b64_tr_b16 a[2:3], v1 offset:1024
    ds_read_b64_tr_b16 a[128:129], v1 offset:32
    ds_read_b64_tr_b16 a[130:131], v1 offset:1056
    ds_read_b64_tr_b16 a[4:5], v1 offset:2048
    ds_read_b64_tr_b16 a[6:7], v1 offset:3072
    ds_read_b64_tr_b16 a[132:133], v1 offset:2080
    ds_read_b64_tr_b16 a[134:135], v1 offset:3104
    ds_read_b64_tr_b16 a[8:9], v1 offset:4096
    ds_read_b64_tr_b16 a[10:11], v1 offset:5120
    ds_read_b64_tr_b16 a[136:137], v1 offset:4128
    ds_read_b64_tr_b16 a[138:139], v1 offset:5152
    ds_read_b64_tr_b16 a[12:13], v1 offset:6144
    ds_read_b64_tr_b16 a[14:15], v1 offset:7168
    ds_read_b64_tr_b16 a[140:141], v1 offset:6176
    ds_read_b64_tr_b16 a[142:143], v1 offset:7200
    s_waitcnt lgkmcnt(0)
    s_add_u32 s21, s20, 0x100000
    s_add_u32 m0, s19, 0
    s_nop 0
    buffer_load_dwordx4 v0, s[8:11], s21 offen lds
    s_add_u32 s21, s20, 0x108000
    s_add_u32 m0, s19, 1024
    s_nop 0
    buffer_load_dwordx4 v0, s[8:11], s21 offen lds
    s_add_u32 s21, s20, 0x110000
    s_add_u32 m0, s19, 2048
    s_nop 0
    buffer_load_dwordx4 v0, s[8:11], s21 offen lds
    s_add_u32 s21, s20, 0x118000
    s_add_u32 m0, s19, 3072
    s_nop 0
    buffer_load_dwordx4 v0, s[8:11], s21 offen lds
    s_add_u32 s21, s20, 0x120000
    s_add_u32 m0, s19, 4096
    s_nop 0
    buffer_load_dwordx4 v0, s[8:11], s21 offen lds
    s_add_u32 s21, s20, 0x128000
    s_add_u32 m0, s19, 5120
    s_nop 0
    buffer_load_dwordx4 v0, s[8:11], s21 offen lds
    s_add_u32 s21, s20, 0x130000
    s_add_u32 m0, s19, 6144
    s_nop 0
    buffer_load_dwordx4 v0, s[8:11], s21 offen lds
    s_add_u32 s21, s20, 0x138000
    s_add_u32 m0, s19, 7168
    s_nop 0
    buffer_load_dwordx4 v0, s[8:11], s21 offen lds
    s_waitcnt vmcnt(24)
    ds_read_b64_tr_b16 a[16:17], v1 offset:8192
    ds_read_b64_tr_b16 a[18:19], v1 offset:9216
    ds_read_b64_tr_b16 a[144:145], v1 offset:8224
    ds_read_b64_tr_b16 a[146:147], v1 offset:9248
    ds_read_b64_tr_b16 a[20:21], v1 offset:10240
    ds_read_b64_tr_b16 a[22:23], v1 offset:11264
    ds_read_b64_tr_b16 a[148:149], v1 offset:10272
    ds_read_b64_tr_b16 a[150:151], v1 offset:11296
    ds_read_b64_tr_b16 a[24:25], v1 offset:12288
    ds_read_b64_tr_b16 a[26:27], v1 offset:13312
    ds_read_b64_tr_b16 a[152:153], v1 offset:12320
    ds_read_b64_tr_b16 a[154:155], v1 offset:13344
    ds_read_b64_tr_b16 a[28:29], v1 offset:14336
    ds_read_b64_tr_b16 a[30:31], v1 offset:15360
    ds_read_b64_tr_b16 a[156:157], v1 offset:14368
    ds_read_b64_tr_b16 a[158:159], v1 offset:15392
    s_waitcnt lgkmcnt(0)
    s_add_u32 s21, s20, 0x140000
    s_add_u32 m0, s19, 8192
    s_nop 0
    buffer_load_dwordx4 v0, s[8:11], s21 offen lds
    s_add_u32 s21, s20, 0x148000
    s_add_u32 m0, s19, 9216
    s_nop 0
    buffer_load_dwordx4 v0, s[8:11], s21 offen lds
    s_add_u32 s21, s20, 0x150000
    s_add_u32 m0, s19, 10240
    s_nop 0
    buffer_load_dwordx4 v0, s[8:11], s21 offen lds
    s_add_u32 s21, s20, 0x158000
    s_add_u32 m0, s19, 11264
    s_nop 0
    buffer_load_dwordx4 v0, s[8:11], s21 offen lds
    s_add_u32 s21, s20, 0x160000
    s_add_u32 m0, s19, 12288
    s_nop 0
    buffer_load_dwordx4 v0, s[8:11], s21 offen lds
    s_add_u32 s21, s20, 0x168000
    s_add_u32 m0, s19, 13312
    s_nop 0
    buffer_load_dwordx4 v0, s[8:11], s21 offen lds
    s_add_u32 s21, s20, 0x170000
    s_add_u32 m0, s19, 14336
    s_nop 0
    buffer_load_dwordx4 v0, s[8:11], s21 offen lds
    s_add_u32 s21, s20, 0x178000
    s_add_u32 m0, s19, 15360
    s_nop 0
    buffer_load_dwordx4 v0, s[8:11], s21 offen lds
    s_waitcnt vmcnt(24)
    ds_read_b64_tr_b16 a[32:33], v1 offset:16384
    ds_read_b64_tr_b16 a[34:35], v1 offset:17408
    ds_read_b64_tr_b16 a[160:161], v1 offset:16416
    ds_read_b64_tr_b16 a[162:163], v1 offset:17440
    ds_read_b64_tr_b16 a[36:37], v1 offset:18432
    ds_read_b64_tr_b16 a[38:39], v1 offset:19456
    ds_read_b64_tr_b16 a[164:165], v1 offset:18464
    ds_read_b64_tr_b16 a[166:167], v1 offset:19488
    ds_read_b64_tr_b16 a[40:41], v1 offset:20480
    ds_read_b64_tr_b16 a[42:43], v1 offset:21504
    ds_read_b64_tr_b16 a[168:169], v1 offset:20512
    ds_read_b64_tr_b16 a[170:171], v1 offset:21536
    ds_read_b64_tr_b16 a[44:45], v1 offset:22528
    ds_read_b64_tr_b16 a[46:47], v1 offset:23552
    ds_read_b64_tr_b16 a[172:173], v1 offset:22560
    ds_read_b64_tr_b16 a[174:175], v1 offset:23584
    s_waitcnt lgkmcnt(0)
    s_add_u32 s21, s20, 0x180000
    s_add_u32 m0, s19, 16384
    s_nop 0
    buffer_load_dwordx4 v0, s[8:11], s21 offen lds
    s_add_u32 s21, s20, 0x188000
    s_add_u32 m0, s19, 17408
    s_nop 0
    buffer_load_dwordx4 v0, s[8:11], s21 offen lds
    s_add_u32 s21, s20, 0x190000
    s_add_u32 m0, s19, 18432
    s_nop 0
    buffer_load_dwordx4 v0, s[8:11], s21 offen lds
    s_add_u32 s21, s20, 0x198000
    s_add_u32 m0, s19, 19456
    s_nop 0
    buffer_load_dwordx4 v0, s[8:11], s21 offen lds
    s_add_u32 s21, s20, 0x1a0000
    s_add_u32 m0, s19, 20480
    s_nop 0
    buffer_load_dwordx4 v0, s[8:11], s21 offen lds
    s_add_u32 s21, s20, 0x1a8000
    s_add_u32 m0, s19, 21504
    s_nop 0
    buffer_load_dwordx4 v0, s[8:11], s21 offen lds
    s_add_u32 s21, s20, 0x1b0000
    s_add_u32 m0, s19, 22528
    s_nop 0
    buffer_load_dwordx4 v0, s[8:11], s21 offen lds
    s_add_u32 s21, s20, 0x1b8000
    s_add_u32 m0, s19, 23552
    s_nop 0
    buffer_load_dwordx4 v0, s[8:11], s21 offen lds
    s_waitcnt vmcnt(24)
    ds_read_b64_tr_b16 a[48:49], v1 offset:24576
    ds_read_b64_tr_b16 a[50:51], v1 offset:25600
    ds_read_b64_tr_b16 a[176:177], v1 offset:24608
    ds_read_b64_tr_b16 a[178:179], v1 offset:25632
    ds_read_b64_tr_b16 a[52:53], v1 offset:26624
    ds_read_b64_tr_b16 a[54:55], v1 offset:27648
    ds_read_b64_tr_b16 a[180:181], v1 offset:26656
    ds_read_b64_tr_b16 a[182:183], v1 offset:27680
    ds_read_b64_tr_b16 a[56:57], v1 offset:28672
    ds_read_b64_tr_b16 a[58:59], v1 offset:29696
    ds_read_b64_tr_b16 a[184:185], v1 offset:28704
    ds_read_b64_tr_b16 a[186:187], v1 offset:29728
    ds_read_b64_tr_b16 a[60:61], v1 offset:30720
    ds_read_b64_tr_b16 a[62:63], v1 offset:31744
    ds_read_b64_tr_b16 a[188:189], v1 offset:30752
    ds_read_b64_tr_b16 a[190:191], v1 offset:31776
    s_waitcnt lgkmcnt(0)
    s_add_u32 s21, s20, 0x1c0000
    s_add_u32 m0, s19, 24576
    s_nop 0
    buffer_load_dwordx4 v0, s[8:11], s21 offen lds
    s_add_u32 s21, s20, 0x1c8000
    s_add_u32 m0, s19, 25600
    s_nop 0
    buffer_load_dwordx4 v0, s[8:11], s21 offen lds
    s_add_u32 s21, s20, 0x1d0000
    s_add_u32 m0, s19, 26624
    s_nop 0
    buffer_load_dwordx4 v0, s[8:11], s21 offen lds
    s_add_u32 s21, s20, 0x1d8000
    s_add_u32 m0, s19, 27648
    s_nop 0
    buffer_load_dwordx4 v0, s[8:11], s21 offen lds
    s_add_u32 s21, s20, 0x1e0000
    s_add_u32 m0, s19, 28672
    s_nop 0
    buffer_load_dwordx4 v0, s[8:11], s21 offen lds
    s_add_u32 s21, s20, 0x1e8000
    s_add_u32 m0, s19, 29696
    s_nop 0
    buffer_load_dwordx4 v0, s[8:11], s21 offen lds
    s_add_u32 s21, s20, 0x1f0000
    s_add_u32 m0, s19, 30720
    s_nop 0
    buffer_load_dwordx4 v0, s[8:11], s21 offen lds
    s_add_u32 s21, s20, 0x1f8000
    s_add_u32 m0, s19, 31744
    s_nop 0
    buffer_load_dwordx4 v0, s[8:11], s21 offen lds
    s_waitcnt vmcnt(24)
    ds_read_b64_tr_b16 a[64:65], v1 offset:0
    ds_read_b64_tr_b16 a[66:67], v1 offset:1024
    ds_read_b64_tr_b16 a[192:193], v1 offset:32
    ds_read_b64_tr_b16 a[194:195], v1 offset:1056
    ds_read_b64_tr_b16 a[68:69], v1 offset:2048
    ds_read_b64_tr_b16 a[70:71], v1 offset:3072
    ds_read_b64_tr_b16 a[196:197], v1 offset:2080
    ds_read_b64_tr_b16 a[198:199], v1 offset:3104
    ds_read_b64_tr_b16 a[72:73], v1 offset:4096
    ds_read_b64_tr_b16 a[74:75], v1 offset:5120
    ds_read_b64_tr_b16 a[200:201], v1 offset:4128
    ds_read_b64_tr_b16 a[202:203], v1 offset:5152
    ds_read_b64_tr_b16 a[76:77], v1 offset:6144
    ds_read_b64_tr_b16 a[78:79], v1 offset:7168
    ds_read_b64_tr_b16 a[204:205], v1 offset:6176
    ds_read_b64_tr_b16 a[206:207], v1 offset:7200
    s_waitcnt lgkmcnt(0)
    s_waitcnt vmcnt(16)
    ds_read_b64_tr_b16 a[80:81], v1 offset:8192
    ds_read_b64_tr_b16 a[82:83], v1 offset:9216
    ds_read_b64_tr_b16 a[208:209], v1 offset:8224
    ds_read_b64_tr_b16 a[210:211], v1 offset:9248
    ds_read_b64_tr_b16 a[84:85], v1 offset:10240
    ds_read_b64_tr_b16 a[86:87], v1 offset:11264
    ds_read_b64_tr_b16 a[212:213], v1 offset:10272
    ds_read_b64_tr_b16 a[214:215], v1 offset:11296
    ds_read_b64_tr_b16 a[88:89], v1 offset:12288
    ds_read_b64_tr_b16 a[90:91], v1 offset:13312
    ds_read_b64_tr_b16 a[216:217], v1 offset:12320
    ds_read_b64_tr_b16 a[218:219], v1 offset:13344
    ds_read_b64_tr_b16 a[92:93], v1 offset:14336
    ds_read_b64_tr_b16 a[94:95], v1 offset:15360
    ds_read_b64_tr_b16 a[220:221], v1 offset:14368
    ds_read_b64_tr_b16 a[222:223], v1 offset:15392
    s_waitcnt lgkmcnt(0)
    s_waitcnt vmcnt(8)
    ds_read_b64_tr_b16 a[96:97], v1 offset:16384
    ds_read_b64_tr_b16 a[98:99], v1 offset:17408
    ds_read_b64_tr_b16 a[224:225], v1 offset:16416
    ds_read_b64_tr_b16 a[226:227], v1 offset:17440
    ds_read_b64_tr_b16 a[100:101], v1 offset:18432
    ds_read_b64_tr_b16 a[102:103], v1 offset:19456
    ds_read_b64_tr_b16 a[228:229], v1 offset:18464
    ds_read_b64_tr_b16 a[230:231], v1 offset:19488
    ds_read_b64_tr_b16 a[104:105], v1 offset:20480
    ds_read_b64_tr_b16 a[106:107], v1 offset:21504
    ds_read_b64_tr_b16 a[232:233], v1 offset:20512
    ds_read_b64_tr_b16 a[234:235], v1 offset:21536
    ds_read_b64_tr_b16 a[108:109], v1 offset:22528
    ds_read_b64_tr_b16 a[110:111], v1 offset:23552
    ds_read_b64_tr_b16 a[236:237], v1 offset:22560
    ds_read_b64_tr_b16 a[238:239], v1 offset:23584
    s_waitcnt lgkmcnt(0)
    s_waitcnt vmcnt(0)
    ds_read_b64_tr_b16 a[112:113], v1 offset:24576
    ds_read_b64_tr_b16 a[114:115], v1 offset:25600
    ds_read_b64_tr_b16 a[240:241], v1 offset:24608
    ds_read_b64_tr_b16 a[242:243], v1 offset:25632
    ds_read_b64_tr_b16 a[116:117], v1 offset:26624
    ds_read_b64_tr_b16 a[118:119], v1 offset:27648
    ds_read_b64_tr_b16 a[244:245], v1 offset:26656
    ds_read_b64_tr_b16 a[246:247], v1 offset:27680
    ds_read_b64_tr_b16 a[120:121], v1 offset:28672
    ds_read_b64_tr_b16 a[122:123], v1 offset:29696
    ds_read_b64_tr_b16 a[248:249], v1 offset:28704
    ds_read_b64_tr_b16 a[250:251], v1 offset:29728
    ds_read_b64_tr_b16 a[124:125], v1 offset:30720
    ds_read_b64_tr_b16 a[126:127], v1 offset:31744
    ds_read_b64_tr_b16 a[252:253], v1 offset:30752
    ds_read_b64_tr_b16 a[254:255], v1 offset:31776
    s_waitcnt lgkmcnt(0)
    s_cmp_lt_u32 s12, 5
    s_cbranch_scc1 main_kernel_o_top
    v_mul_u32_u24 v178, 2, v173
    v_sub_u32 v171, v172, v178
main_kernel_o_gp:
    buffer_load_dword v174, v171, s[4:7], 0 offen sc1
    s_waitcnt vmcnt(0)
    v_cmp_eq_u32 vcc, 0, v174
    s_cbranch_vccz main_kernel_o_top
    s_sleep 32
    s_sub_u32 s29, s29, 1
    s_cbranch_scc0 main_kernel_o_gp
    s_branch main_kernel_end
main_kernel_o_top:
    buffer_load_dword v174, v172, s[4:7], 0 offen sc1
    s_waitcnt vmcnt(0)
    v_cmp_eq_u32 vcc, 0, v174
    s_cbranch_vccz main_kernel_o_go
    s_sleep 1
    s_sub_u32 s29, s29, 1
    s_cbranch_scc0 main_kernel_o_top
    s_branch main_kernel_end
main_kernel_o_go:
    v_add_u32 v172, v172, v173
    buffer_load_dword v174, v172, s[4:7], 0 offen sc1
    buffer_load_dwordx4 v[0:3], v170, s[4:7], s15 offen offset:0 sc1
    buffer_load_dwordx4 v[4:7], v170, s[4:7], s15 offen offset:1024 sc1
    buffer_load_dwordx4 v[8:11], v170, s[4:7], s15 offen offset:2048 sc1
    buffer_load_dwordx4 v[12:15], v170, s[4:7], s15 offen offset:3072 sc1
    s_add_u32 s15, s15, 4096
    buffer_load_dwordx4 v[16:19], v170, s[4:7], s15 offen offset:0 sc1
    buffer_load_dwordx4 v[20:23], v170, s[4:7], s15 offen offset:1024 sc1
    buffer_load_dwordx4 v[24:27], v170, s[4:7], s15 offen offset:2048 sc1
    buffer_load_dwordx4 v[28:31], v170, s[4:7], s15 offen offset:3072 sc1
    s_add_u32 s15, s15, 4096
    buffer_load_dwordx4 v[32:35], v170, s[4:7], s15 offen offset:0 sc1
    buffer_load_dwordx4 v[36:39], v170, s[4:7], s15 offen offset:1024 sc1
    buffer_load_dwordx4 v[40:43], v170, s[4:7], s15 offen offset:2048 sc1
    buffer_load_dwordx4 v[44:47], v170, s[4:7], s15 offen offset:3072 sc1
    s_add_u32 s15, s15, 4096
    buffer_load_dwordx4 v[48:51], v170, s[4:7], s15 offen offset:0 sc1
    buffer_load_dwordx4 v[52:55], v170, s[4:7], s15 offen offset:1024 sc1
    buffer_load_dwordx4 v[56:59], v170, s[4:7], s15 offen offset:2048 sc1
    buffer_load_dwordx4 v[60:63], v170, s[4:7], s15 offen offset:3072 sc1
    s_add_u32 s15, s15, 4096
    buffer_load_dwordx4 v[64:67], v170, s[4:7], s15 offen offset:0 sc1
    buffer_load_dwordx4 v[68:71], v170, s[4:7], s15 offen offset:1024 sc1
    buffer_load_dwordx4 v[72:75], v170, s[4:7], s15 offen offset:2048 sc1
    buffer_load_dwordx4 v[76:79], v170, s[4:7], s15 offen offset:3072 sc1
    s_add_u32 s15, s15, 4096
    buffer_load_dwordx4 v[80:83], v170, s[4:7], s15 offen offset:0 sc1
    buffer_load_dwordx4 v[84:87], v170, s[4:7], s15 offen offset:1024 sc1
    buffer_load_dwordx4 v[88:91], v170, s[4:7], s15 offen offset:2048 sc1
    buffer_load_dwordx4 v[92:95], v170, s[4:7], s15 offen offset:3072 sc1
    s_add_u32 s15, s15, 4096
    buffer_load_dwordx4 v[96:99], v170, s[4:7], s15 offen offset:0 sc1
    buffer_load_dwordx4 v[100:103], v170, s[4:7], s15 offen offset:1024 sc1
    buffer_load_dwordx4 v[104:107], v170, s[4:7], s15 offen offset:2048 sc1
    buffer_load_dwordx4 v[108:111], v170, s[4:7], s15 offen offset:3072 sc1
    s_add_u32 s15, s15, 4096
    buffer_load_dwordx4 v[112:115], v170, s[4:7], s15 offen offset:0 sc1
    buffer_load_dwordx4 v[116:119], v170, s[4:7], s15 offen offset:1024 sc1
    buffer_load_dwordx4 v[120:123], v170, s[4:7], s15 offen offset:2048 sc1
    buffer_load_dwordx4 v[124:127], v170, s[4:7], s15 offen offset:3072 sc1
    s_add_u32 s15, s15, 233472
main_kernel_o_x:
    buffer_load_dwordx2 v[160:161], v175, s[96:99], s16 offen
    buffer_load_dwordx2 v[162:163], v170, s[4:7], s17 offen sc1
    s_add_u32 s17, s17, 65536
    s_add_u32 s18, s18, 1
    s_mov_b32 s39, 0
    s_waitcnt vmcnt(34)
    v_cmp_eq_u32 vcc, 0, v174
    s_cmp_le_u32 s18, 62
    s_cbranch_scc0 main_kernel_o_n
    s_cbranch_vccnz main_kernel_o_n
    s_mov_b32 s39, 1
    v_add_u32 v172, v172, v173
    buffer_load_dword v174, v172, s[4:7], 0 offen sc1
    s_waitcnt vmcnt(34)
    v_mfma_f32_16x16x32_bf16 v[128:131], a[0:3], v[0:3], 0
    v_mfma_f32_16x16x32_bf16 v[132:135], a[128:131], v[0:3], 0
    buffer_load_dwordx4 v[0:3], v170, s[4:7], s15 offen offset:0 sc1
    s_waitcnt vmcnt(34)
    v_mfma_f32_16x16x32_bf16 v[128:131], a[4:7], v[4:7], v[128:131]
    v_mfma_f32_16x16x32_bf16 v[132:135], a[132:135], v[4:7], v[132:135]
    buffer_load_dwordx4 v[4:7], v170, s[4:7], s15 offen offset:1024 sc1
    s_waitcnt vmcnt(34)
    v_mfma_f32_16x16x32_bf16 v[128:131], a[8:11], v[8:11], v[128:131]
    v_mfma_f32_16x16x32_bf16 v[132:135], a[136:139], v[8:11], v[132:135]
    buffer_load_dwordx4 v[8:11], v170, s[4:7], s15 offen offset:2048 sc1
    s_waitcnt vmcnt(34)
    v_mfma_f32_16x16x32_bf16 v[128:131], a[12:15], v[12:15], v[128:131]
    v_mfma_f32_16x16x32_bf16 v[132:135], a[140:143], v[12:15], v[132:135]
    buffer_load_dwordx4 v[12:15], v170, s[4:7], s15 offen offset:3072 sc1
    s_add_u32 s15, s15, 4096
    s_waitcnt vmcnt(34)
    v_mfma_f32_16x16x32_bf16 v[128:131], a[16:19], v[16:19], v[128:131]
    v_mfma_f32_16x16x32_bf16 v[132:135], a[144:147], v[16:19], v[132:135]
    buffer_load_dwordx4 v[16:19], v170, s[4:7], s15 offen offset:0 sc1
    s_waitcnt vmcnt(34)
    v_mfma_f32_16x16x32_bf16 v[128:131], a[20:23], v[20:23], v[128:131]
    v_mfma_f32_16x16x32_bf16 v[132:135], a[148:151], v[20:23], v[132:135]
    buffer_load_dwordx4 v[20:23], v170, s[4:7], s15 offen offset:1024 sc1
    s_waitcnt vmcnt(34)
    v_mfma_f32_16x16x32_bf16 v[128:131], a[24:27], v[24:27], v[128:131]
    v_mfma_f32_16x16x32_bf16 v[132:135], a[152:155], v[24:27], v[132:135]
    buffer_load_dwordx4 v[24:27], v170, s[4:7], s15 offen offset:2048 sc1
    s_waitcnt vmcnt(34)
    v_mfma_f32_16x16x32_bf16 v[128:131], a[28:31], v[28:31], v[128:131]
    v_mfma_f32_16x16x32_bf16 v[132:135], a[156:159], v[28:31], v[132:135]
    buffer_load_dwordx4 v[28:31], v170, s[4:7], s15 offen offset:3072 sc1
    s_add_u32 s15, s15, 4096
    s_waitcnt vmcnt(34)
    v_mfma_f32_16x16x32_bf16 v[128:131], a[32:35], v[32:35], v[128:131]
    v_mfma_f32_16x16x32_bf16 v[132:135], a[160:163], v[32:35], v[132:135]
    buffer_load_dwordx4 v[32:35], v170, s[4:7], s15 offen offset:0 sc1
    s_waitcnt vmcnt(34)
    v_mfma_f32_16x16x32_bf16 v[128:131], a[36:39], v[36:39], v[128:131]
    v_mfma_f32_16x16x32_bf16 v[132:135], a[164:167], v[36:39], v[132:135]
    buffer_load_dwordx4 v[36:39], v170, s[4:7], s15 offen offset:1024 sc1
    s_waitcnt vmcnt(34)
    v_mfma_f32_16x16x32_bf16 v[128:131], a[40:43], v[40:43], v[128:131]
    v_mfma_f32_16x16x32_bf16 v[132:135], a[168:171], v[40:43], v[132:135]
    buffer_load_dwordx4 v[40:43], v170, s[4:7], s15 offen offset:2048 sc1
    s_waitcnt vmcnt(34)
    v_mfma_f32_16x16x32_bf16 v[128:131], a[44:47], v[44:47], v[128:131]
    v_mfma_f32_16x16x32_bf16 v[132:135], a[172:175], v[44:47], v[132:135]
    buffer_load_dwordx4 v[44:47], v170, s[4:7], s15 offen offset:3072 sc1
    s_add_u32 s15, s15, 4096
    s_waitcnt vmcnt(34)
    v_mfma_f32_16x16x32_bf16 v[128:131], a[48:51], v[48:51], v[128:131]
    v_mfma_f32_16x16x32_bf16 v[132:135], a[176:179], v[48:51], v[132:135]
    buffer_load_dwordx4 v[48:51], v170, s[4:7], s15 offen offset:0 sc1
    s_waitcnt vmcnt(34)
    v_mfma_f32_16x16x32_bf16 v[128:131], a[52:55], v[52:55], v[128:131]
    v_mfma_f32_16x16x32_bf16 v[132:135], a[180:183], v[52:55], v[132:135]
    buffer_load_dwordx4 v[52:55], v170, s[4:7], s15 offen offset:1024 sc1
    s_waitcnt vmcnt(34)
    v_mfma_f32_16x16x32_bf16 v[128:131], a[56:59], v[56:59], v[128:131]
    v_mfma_f32_16x16x32_bf16 v[132:135], a[184:187], v[56:59], v[132:135]
    buffer_load_dwordx4 v[56:59], v170, s[4:7], s15 offen offset:2048 sc1
    s_waitcnt vmcnt(34)
    v_mfma_f32_16x16x32_bf16 v[128:131], a[60:63], v[60:63], v[128:131]
    v_mfma_f32_16x16x32_bf16 v[132:135], a[188:191], v[60:63], v[132:135]
    buffer_load_dwordx4 v[60:63], v170, s[4:7], s15 offen offset:3072 sc1
    s_add_u32 s15, s15, 4096
    s_waitcnt vmcnt(34)
    v_mfma_f32_16x16x32_bf16 v[128:131], a[64:67], v[64:67], v[128:131]
    v_mfma_f32_16x16x32_bf16 v[132:135], a[192:195], v[64:67], v[132:135]
    buffer_load_dwordx4 v[64:67], v170, s[4:7], s15 offen offset:0 sc1
    s_waitcnt vmcnt(34)
    v_mfma_f32_16x16x32_bf16 v[128:131], a[68:71], v[68:71], v[128:131]
    v_mfma_f32_16x16x32_bf16 v[132:135], a[196:199], v[68:71], v[132:135]
    buffer_load_dwordx4 v[68:71], v170, s[4:7], s15 offen offset:1024 sc1
    s_waitcnt vmcnt(34)
    v_mfma_f32_16x16x32_bf16 v[128:131], a[72:75], v[72:75], v[128:131]
    v_mfma_f32_16x16x32_bf16 v[132:135], a[200:203], v[72:75], v[132:135]
    buffer_load_dwordx4 v[72:75], v170, s[4:7], s15 offen offset:2048 sc1
    s_waitcnt vmcnt(34)
    v_mfma_f32_16x16x32_bf16 v[128:131], a[76:79], v[76:79], v[128:131]
    v_mfma_f32_16x16x32_bf16 v[132:135], a[204:207], v[76:79], v[132:135]
    buffer_load_dwordx4 v[76:79], v170, s[4:7], s15 offen offset:3072 sc1
    s_add_u32 s15, s15, 4096
    s_waitcnt vmcnt(34)
    v_mfma_f32_16x16x32_bf16 v[128:131], a[80:83], v[80:83], v[128:131]
    v_mfma_f32_16x16x32_bf16 v[132:135], a[208:211], v[80:83], v[132:135]
    buffer_load_dwordx4 v[80:83], v170, s[4:7], s15 offen offset:0 sc1
    s_waitcnt vmcnt(34)
    v_mfma_f32_16x16x32_bf16 v[128:131], a[84:87], v[84:87], v[128:131]
    v_mfma_f32_16x16x32_bf16 v[132:135], a[212:215], v[84:87], v[132:135]
    buffer_load_dwordx4 v[84:87], v170, s[4:7], s15 offen offset:1024 sc1
    s_waitcnt vmcnt(34)
    v_mfma_f32_16x16x32_bf16 v[128:131], a[88:91], v[88:91], v[128:131]
    v_mfma_f32_16x16x32_bf16 v[132:135], a[216:219], v[88:91], v[132:135]
    buffer_load_dwordx4 v[88:91], v170, s[4:7], s15 offen offset:2048 sc1
    s_waitcnt vmcnt(34)
    v_mfma_f32_16x16x32_bf16 v[128:131], a[92:95], v[92:95], v[128:131]
    v_mfma_f32_16x16x32_bf16 v[132:135], a[220:223], v[92:95], v[132:135]
    buffer_load_dwordx4 v[92:95], v170, s[4:7], s15 offen offset:3072 sc1
    s_add_u32 s15, s15, 4096
    s_waitcnt vmcnt(34)
    v_mfma_f32_16x16x32_bf16 v[128:131], a[96:99], v[96:99], v[128:131]
    v_mfma_f32_16x16x32_bf16 v[132:135], a[224:227], v[96:99], v[132:135]
    buffer_load_dwordx4 v[96:99], v170, s[4:7], s15 offen offset:0 sc1
    s_waitcnt vmcnt(34)
    v_mfma_f32_16x16x32_bf16 v[128:131], a[100:103], v[100:103], v[128:131]
    v_mfma_f32_16x16x32_bf16 v[132:135], a[228:231], v[100:103], v[132:135]
    buffer_load_dwordx4 v[100:103], v170, s[4:7], s15 offen offset:1024 sc1
    s_waitcnt vmcnt(34)
    v_mfma_f32_16x16x32_bf16 v[128:131], a[104:107], v[104:107], v[128:131]
    v_mfma_f32_16x16x32_bf16 v[132:135], a[232:235], v[104:107], v[132:135]
    buffer_load_dwordx4 v[104:107], v170, s[4:7], s15 offen offset:2048 sc1
    s_waitcnt vmcnt(34)
    v_mfma_f32_16x16x32_bf16 v[128:131], a[108:111], v[108:111], v[128:131]
    v_mfma_f32_16x16x32_bf16 v[132:135], a[236:239], v[108:111], v[132:135]
    buffer_load_dwordx4 v[108:111], v170, s[4:7], s15 offen offset:3072 sc1
    s_add_u32 s15, s15, 4096
    s_waitcnt vmcnt(34)
    v_mfma_f32_16x16x32_bf16 v[128:131], a[112:115], v[112:115], v[128:131]
    v_mfma_f32_16x16x32_bf16 v[132:135], a[240:243], v[112:115], v[132:135]
    buffer_load_dwordx4 v[112:115], v170, s[4:7], s15 offen offset:0 sc1
    s_waitcnt vmcnt(34)
    v_mfma_f32_16x16x32_bf16 v[128:131], a[116:119], v[116:119], v[128:131]
    v_mfma_f32_16x16x32_bf16 v[132:135], a[244:247], v[116:119], v[132:135]
    buffer_load_dwordx4 v[116:119], v170, s[4:7], s15 offen offset:1024 sc1
    s_waitcnt vmcnt(34)
    v_mfma_f32_16x16x32_bf16 v[128:131], a[120:123], v[120:123], v[128:131]
    v_mfma_f32_16x16x32_bf16 v[132:135], a[248:251], v[120:123], v[132:135]
    buffer_load_dwordx4 v[120:123], v170, s[4:7], s15 offen offset:2048 sc1
    s_waitcnt vmcnt(34)
    v_mfma_f32_16x16x32_bf16 v[128:131], a[124:127], v[124:127], v[128:131]
    v_mfma_f32_16x16x32_bf16 v[132:135], a[252:255], v[124:127], v[132:135]
    buffer_load_dwordx4 v[124:127], v170, s[4:7], s15 offen offset:3072 sc1
    s_add_u32 s15, s15, 233472
    s_waitcnt vmcnt(33)
    s_branch main_kernel_o_e
main_kernel_o_n:
    buffer_load_dword v174, v172, s[4:7], 0 offen sc1
    s_waitcnt vmcnt(34)
    v_mfma_f32_16x16x32_bf16 v[128:131], a[0:3], v[0:3], 0
    v_mfma_f32_16x16x32_bf16 v[132:135], a[128:131], v[0:3], 0
    s_waitcnt vmcnt(33)
    v_mfma_f32_16x16x32_bf16 v[128:131], a[4:7], v[4:7], v[128:131]
    v_mfma_f32_16x16x32_bf16 v[132:135], a[132:135], v[4:7], v[132:135]
    s_waitcnt vmcnt(32)
    v_mfma_f32_16x16x32_bf16 v[128:131], a[8:11], v[8:11], v[128:131]
    v_mfma_f32_16x16x32_bf16 v[132:135], a[136:139], v[8:11], v[132:135]
    s_waitcnt vmcnt(31)
    v_mfma_f32_16x16x32_bf16 v[128:131], a[12:15], v[12:15], v[128:131]
    v_mfma_f32_16x16x32_bf16 v[132:135], a[140:143], v[12:15], v[132:135]
    s_waitcnt vmcnt(30)
    v_mfma_f32_16x16x32_bf16 v[128:131], a[16:19], v[16:19], v[128:131]
    v_mfma_f32_16x16x32_bf16 v[132:135], a[144:147], v[16:19], v[132:135]
    s_waitcnt vmcnt(29)
    v_mfma_f32_16x16x32_bf16 v[128:131], a[20:23], v[20:23], v[128:131]
    v_mfma_f32_16x16x32_bf16 v[132:135], a[148:151], v[20:23], v[132:135]
    s_waitcnt vmcnt(28)
    v_mfma_f32_16x16x32_bf16 v[128:131], a[24:27], v[24:27], v[128:131]
    v_mfma_f32_16x16x32_bf16 v[132:135], a[152:155], v[24:27], v[132:135]
    s_waitcnt vmcnt(27)
    v_mfma_f32_16x16x32_bf16 v[128:131], a[28:31], v[28:31], v[128:131]
    v_mfma_f32_16x16x32_bf16 v[132:135], a[156:159], v[28:31], v[132:135]
    s_waitcnt vmcnt(26)
    v_mfma_f32_16x16x32_bf16 v[128:131], a[32:35], v[32:35], v[128:131]
    v_mfma_f32_16x16x32_bf16 v[132:135], a[160:163], v[32:35], v[132:135]
    s_waitcnt vmcnt(25)
    v_mfma_f32_16x16x32_bf16 v[128:131], a[36:39], v[36:39], v[128:131]
    v_mfma_f32_16x16x32_bf16 v[132:135], a[164:167], v[36:39], v[132:135]
    s_waitcnt vmcnt(24)
    v_mfma_f32_16x16x32_bf16 v[128:131], a[40:43], v[40:43], v[128:131]
    v_mfma_f32_16x16x32_bf16 v[132:135], a[168:171], v[40:43], v[132:135]
    s_waitcnt vmcnt(23)
    v_mfma_f32_16x16x32_bf16 v[128:131], a[44:47], v[44:47], v[128:131]
    v_mfma_f32_16x16x32_bf16 v[132:135], a[172:175], v[44:47], v[132:135]
    s_waitcnt vmcnt(22)
    v_mfma_f32_16x16x32_bf16 v[128:131], a[48:51], v[48:51], v[128:131]
    v_mfma_f32_16x16x32_bf16 v[132:135], a[176:179], v[48:51], v[132:135]
    s_waitcnt vmcnt(21)
    v_mfma_f32_16x16x32_bf16 v[128:131], a[52:55], v[52:55], v[128:131]
    v_mfma_f32_16x16x32_bf16 v[132:135], a[180:183], v[52:55], v[132:135]
    s_waitcnt vmcnt(20)
    v_mfma_f32_16x16x32_bf16 v[128:131], a[56:59], v[56:59], v[128:131]
    v_mfma_f32_16x16x32_bf16 v[132:135], a[184:187], v[56:59], v[132:135]
    s_waitcnt vmcnt(19)
    v_mfma_f32_16x16x32_bf16 v[128:131], a[60:63], v[60:63], v[128:131]
    v_mfma_f32_16x16x32_bf16 v[132:135], a[188:191], v[60:63], v[132:135]
    s_waitcnt vmcnt(18)
    v_mfma_f32_16x16x32_bf16 v[128:131], a[64:67], v[64:67], v[128:131]
    v_mfma_f32_16x16x32_bf16 v[132:135], a[192:195], v[64:67], v[132:135]
    s_waitcnt vmcnt(17)
    v_mfma_f32_16x16x32_bf16 v[128:131], a[68:71], v[68:71], v[128:131]
    v_mfma_f32_16x16x32_bf16 v[132:135], a[196:199], v[68:71], v[132:135]
    s_waitcnt vmcnt(16)
    v_mfma_f32_16x16x32_bf16 v[128:131], a[72:75], v[72:75], v[128:131]
    v_mfma_f32_16x16x32_bf16 v[132:135], a[200:203], v[72:75], v[132:135]
    s_waitcnt vmcnt(15)
    v_mfma_f32_16x16x32_bf16 v[128:131], a[76:79], v[76:79], v[128:131]
    v_mfma_f32_16x16x32_bf16 v[132:135], a[204:207], v[76:79], v[132:135]
    s_waitcnt vmcnt(14)
    v_mfma_f32_16x16x32_bf16 v[128:131], a[80:83], v[80:83], v[128:131]
    v_mfma_f32_16x16x32_bf16 v[132:135], a[208:211], v[80:83], v[132:135]
    s_waitcnt vmcnt(13)
    v_mfma_f32_16x16x32_bf16 v[128:131], a[84:87], v[84:87], v[128:131]
    v_mfma_f32_16x16x32_bf16 v[132:135], a[212:215], v[84:87], v[132:135]
    s_waitcnt vmcnt(12)
    v_mfma_f32_16x16x32_bf16 v[128:131], a[88:91], v[88:91], v[128:131]
    v_mfma_f32_16x16x32_bf16 v[132:135], a[216:219], v[88:91], v[132:135]
    s_waitcnt vmcnt(11)
    v_mfma_f32_16x16x32_bf16 v[128:131], a[92:95], v[92:95], v[128:131]
    v_mfma_f32_16x16x32_bf16 v[132:135], a[220:223], v[92:95], v[132:135]
    s_waitcnt vmcnt(10)
    v_mfma_f32_16x16x32_bf16 v[128:131], a[96:99], v[96:99], v[128:131]
    v_mfma_f32_16x16x32_bf16 v[132:135], a[224:227], v[96:99], v[132:135]
    s_waitcnt vmcnt(9)
    v_mfma_f32_16x16x32_bf16 v[128:131], a[100:103], v[100:103], v[128:131]
    v_mfma_f32_16x16x32_bf16 v[132:135], a[228:231], v[100:103], v[132:135]
    s_waitcnt vmcnt(8)
    v_mfma_f32_16x16x32_bf16 v[128:131], a[104:107], v[104:107], v[128:131]
    v_mfma_f32_16x16x32_bf16 v[132:135], a[232:235], v[104:107], v[132:135]
    s_waitcnt vmcnt(7)
    v_mfma_f32_16x16x32_bf16 v[128:131], a[108:111], v[108:111], v[128:131]
    v_mfma_f32_16x16x32_bf16 v[132:135], a[236:239], v[108:111], v[132:135]
    s_waitcnt vmcnt(6)
    v_mfma_f32_16x16x32_bf16 v[128:131], a[112:115], v[112:115], v[128:131]
    v_mfma_f32_16x16x32_bf16 v[132:135], a[240:243], v[112:115], v[132:135]
    s_waitcnt vmcnt(5)
    v_mfma_f32_16x16x32_bf16 v[128:131], a[116:119], v[116:119], v[128:131]
    v_mfma_f32_16x16x32_bf16 v[132:135], a[244:247], v[116:119], v[132:135]
    s_waitcnt vmcnt(4)
    v_mfma_f32_16x16x32_bf16 v[128:131], a[120:123], v[120:123], v[128:131]
    v_mfma_f32_16x16x32_bf16 v[132:135], a[248:251], v[120:123], v[132:135]
    s_waitcnt vmcnt(3)
    v_mfma_f32_16x16x32_bf16 v[128:131], a[124:127], v[124:127], v[128:131]
    v_mfma_f32_16x16x32_bf16 v[132:135], a[252:255], v[124:127], v[132:135]
    s_waitcnt vmcnt(0)
    v_cmp_eq_u32 vcc, 0, v174
main_kernel_o_e:
    v_lshlrev_b32 v164, 16, v160
    v_and_b32 v165, 0xffff0000, v160
    v_lshlrev_b32 v166, 16, v161
    v_and_b32 v167, 0xffff0000, v161
    v_lshlrev_b32 v160, 16, v162
    v_and_b32 v161, 0xffff0000, v162
    v_lshlrev_b32 v162, 16, v163
    v_and_b32 v163, 0xffff0000, v163
    s_cmp_ge_u32 s14, 2
    ds_write_b128 v176, v[128:131] offset:0
    ds_write_b128 v176, v[132:135] offset:1024
    v_xor_b32 v176, 0x4000, v176
    s_waitcnt lgkmcnt(0)
    s_barrier
    s_cbranch_scc1 main_kernel_o_nx
    ds_read_b128 v[144:147], v177 offset:0
    ds_read_b128 v[148:151], v177 offset:2048
    ds_read_b128 v[152:155], v177 offset:4096
    ds_read_b128 v[156:159], v177 offset:6144
    v_xor_b32 v177, 0x4000, v177
    s_waitcnt lgkmcnt(2)
    v_pk_add_f32 v[144:145], v[144:145], v[148:149]
    v_pk_add_f32 v[146:147], v[146:147], v[150:151]
    s_waitcnt lgkmcnt(0)
    v_pk_add_f32 v[152:153], v[152:153], v[156:157]
    v_pk_add_f32 v[154:155], v[154:155], v[158:159]
    v_pk_add_f32 v[144:145], v[144:145], v[152:153]
    v_pk_add_f32 v[146:147], v[146:147], v[154:155]
    v_pk_fma_f32 v[144:145], v[144:145], v[160:161], v[164:165]
    v_pk_fma_f32 v[146:147], v[146:147], v[162:163], v[166:167]
    v_cvt_pk_bf16_f32 v148, v144, v145
    v_cvt_pk_bf16_f32 v149, v146, v147
    buffer_store_dwordx2 v[148:149], v175, s[92:95], s16 offen
main_kernel_o_nx:
    s_add_u32 s16, s16, 65536
    s_cmp_lg_u32 s39, 0
    s_cbranch_scc1 main_kernel_o_x
    s_cmp_le_u32 s18, 62
    s_cbranch_scc0 main_kernel_o_sk
    s_cbranch_vccz main_kernel_o_go
    s_branch main_kernel_o_top
main_kernel_o_sk:
    v_add_u32 v172, v172, v173
    s_add_u32 s17, s17, 65536
    s_add_u32 s16, s16, 65536
    s_add_u32 s15, s15, 262144
    s_add_u32 s18, s18, 1
    s_cmp_lt_u32 s18, 64
    s_cbranch_scc1 main_kernel_o_top
    s_branch main_kernel_end
main_kernel_end2:
    s_endpgm
main_kernel_worker:
    v_lshlrev_b32 v251, 4, v250
    v_mov_b32 v240, 0xc0135761
    v_mov_b32 v241, 0xc0135761
    v_mov_b32 v242, 0xbdd2d3e8
    v_mov_b32 v243, 0xbdd2d3e8
    v_mov_b32 v244, 0x3f800000
    v_mov_b32 v245, 0x3f800000
    v_mov_b32 v246, 0xbfb8aa3b
    v_mov_b32 v247, 0xbfb8aa3b
    s_lshr_b32 s37, s14, 1
    s_and_b32 s38, s14, 1
    v_mov_b32 v252, 0
    s_mov_b32 s8, s40
    s_and_b32 s9, s41, 0xffff
    s_mov_b32 s10, 0x0
    s_mov_b32 s11, 0x20000
    s_mov_b32 s57, 0
    s_mov_b32 s56, 0x7f000000
    v_mov_b32 v249, 0
main_kernel_w_next:
    s_cmp_lg_u32 s14, 0
    s_cbranch_scc1 main_kernel_w_bar
main_kernel_w_try:
    s_lshl_b32 s32, s27, 8
    s_add_u32 s32, s32, 0x841e000
    v_mov_b32 v254, 1
    s_mov_b64 exec, 1
    buffer_atomic_add v254, off, s[4:7], s32 sc0 sc1
    s_mov_b64 exec, -1
    s_waitcnt vmcnt(0)
    v_readfirstlane_b32 s28, v254
    s_cmp_eq_u32 s57, 0
    s_cbranch_scc1 main_kernel_w_fl1
    s_waitcnt vmcnt(0)
    s_barrier
    v_mov_b32 v4, 1
    v_mov_b32 v5, 1
    v_mov_b32 v6, 1
    v_mov_b32 v7, 1
    s_bfm_b64 exec, s57, 0
    buffer_store_dwordx4 v[4:7], v249, s[4:7], s56 offen sc1
    s_mov_b64 exec, -1
    s_mov_b32 s57, 0
main_kernel_w_fl1:
    s_nop 3
main_kernel_w_have:
    s_cmp_lg_u32 s27, 0
    s_cbranch_scc1 main_kernel_w_q1
    s_cmp_lt_u32 s28, 120
    s_cbranch_scc0 main_kernel_w_d_1
    s_cmp_lt_u32 s28, 48
    s_cbranch_scc0 main_kernel_w_d_2
    s_cmp_lt_u32 s28, 24
    s_cbranch_scc0 main_kernel_w_d_3
    s_cmp_lt_u32 s28, 8
    s_cbranch_scc0 main_kernel_w_d_4
    s_mov_b32 s36, 0x4005800
    s_branch main_kernel_w_dec
main_kernel_w_d_4:
    s_mov_b32 s36, 0x8085008
    s_branch main_kernel_w_dec
main_kernel_w_d_3:
    s_cmp_lt_u32 s28, 32
    s_cbranch_scc0 main_kernel_w_d_5
    s_mov_b32 s36, 0x64090818
    s_branch main_kernel_w_dec
main_kernel_w_d_5:
    s_mov_b32 s36, 0x48109820
    s_branch main_kernel_w_dec
main_kernel_w_d_2:
    s_cmp_lt_u32 s28, 72
    s_cbranch_scc0 main_kernel_w_d_6
    s_cmp_lt_u32 s28, 64
    s_cbranch_scc0 main_kernel_w_d_7
    s_mov_b32 s36, 0x8105030
    s_branch main_kernel_w_dec
main_kernel_w_d_7:
    s_mov_b32 s36, 0x65191040
    s_branch main_kernel_w_dec
main_kernel_w_d_6:
    s_cmp_lt_u32 s28, 88
    s_cbranch_scc0 main_kernel_w_d_8
    s_mov_b32 s36, 0x44008048
    s_branch main_kernel_w_dec
main_kernel_w_d_8:
    s_cmp_lt_u32 s28, 104
    s_cbranch_scc0 main_kernel_w_d_9
    s_mov_b32 s36, 0x41c2058
    s_branch main_kernel_w_dec
main_kernel_w_d_9:
    s_mov_b32 s36, 0x46048068
    s_branch main_kernel_w_dec
main_kernel_w_d_1:
    s_cmp_lt_u32 s28, 184
    s_cbranch_scc0 main_kernel_w_d_10
    s_cmp_lt_u32 s28, 152
    s_cbranch_scc0 main_kernel_w_d_11
    s_cmp_lt_u32 s28, 136
    s_cbranch_scc0 main_kernel_w_d_12
    s_mov_b32 s36, 0x4082078
    s_branch main_kernel_w_dec
main_kernel_w_d_12:
    s_mov_b32 s36, 0x8002888
    s_branch main_kernel_w_dec
main_kernel_w_d_11:
    s_cmp_lt_u32 s28, 160
    s_cbranch_scc0 main_kernel_w_d_13
    s_mov_b32 s36, 0x64013098
    s_branch main_kernel_w_dec
main_kernel_w_d_13:
    s_cmp_lt_u32 s28, 176
    s_cbranch_scc0 main_kernel_w_d_14
    s_mov_b32 s36, 0x4b1080a0
    s_branch main_kernel_w_dec
main_kernel_w_d_14:
    s_mov_b32 s36, 0x641130b0
    s_branch main_kernel_w_dec
main_kernel_w_d_10:
    s_cmp_lt_u32 s28, 208
    s_cbranch_scc0 main_kernel_w_d_15
    s_cmp_lt_u32 s28, 200
    s_cbranch_scc0 main_kernel_w_d_16
    s_mov_b32 s36, 0x4918b0b8
    s_branch main_kernel_w_dec
main_kernel_w_d_16:
    s_mov_b32 s36, 0x661908c8
    s_branch main_kernel_w_dec
main_kernel_w_d_15:
    s_cmp_lt_u32 s28, 224
    s_cbranch_scc0 main_kernel_w_d_17
    s_mov_b32 s36, 0x89038d0
    s_branch main_kernel_w_dec
main_kernel_w_d_17:
    s_cmp_lt_u32 s28, 232
    s_cbranch_scc0 main_kernel_w_d_18
    s_mov_b32 s36, 0x641900e0
    s_branch main_kernel_w_dec
main_kernel_w_d_18:
    s_mov_b32 s36, 0xffffffff
    s_branch main_kernel_w_dec
main_kernel_w_q1:
    s_cmp_lg_u32 s27, 1
    s_cbranch_scc1 main_kernel_w_q2
    s_cmp_lt_u32 s28, 52
    s_cbranch_scc0 main_kernel_w_d_19
    s_cmp_lt_u32 s28, 12
    s_cbranch_scc0 main_kernel_w_d_20
    s_cmp_lt_u32 s28, 4
    s_cbranch_scc0 main_kernel_w_d_21
    s_mov_b32 s36, 0x25000
    s_branch main_kernel_w_dec
main_kernel_w_d_21:
    s_mov_b32 s36, 0x42069004
    s_branch main_kernel_w_dec
main_kernel_w_d_20:
    s_cmp_lt_u32 s28, 20
    s_cbranch_scc0 main_kernel_w_d_22
    s_mov_b32 s36, 0x6709100c
    s_branch main_kernel_w_dec
main_kernel_w_d_22:
    s_cmp_lt_u32 s28, 36
    s_cbranch_scc0 main_kernel_w_d_23
    s_mov_b32 s36, 0x46008014
    s_branch main_kernel_w_dec
main_kernel_w_d_23:
    s_mov_b32 s36, 0x4042024
    s_branch main_kernel_w_dec
main_kernel_w_d_19:
    s_cmp_lt_u32 s28, 80
    s_cbranch_scc0 main_kernel_w_d_24
    s_cmp_lt_u32 s28, 68
    s_cbranch_scc0 main_kernel_w_d_25
    s_mov_b32 s36, 0x49088034
    s_branch main_kernel_w_dec
main_kernel_w_d_25:
    s_mov_b32 s36, 0x4a10b044
    s_branch main_kernel_w_dec
main_kernel_w_d_24:
    s_cmp_lt_u32 s28, 96
    s_cbranch_scc0 main_kernel_w_d_26
    s_mov_b32 s36, 0x4a108050
    s_branch main_kernel_w_dec
main_kernel_w_d_26:
    s_cmp_lt_u32 s28, 112
    s_cbranch_scc0 main_kernel_w_d_27
    s_mov_b32 s36, 0x8083860
    s_branch main_kernel_w_dec
main_kernel_w_d_27:
    s_mov_b32 s36, 0xffffffff
    s_branch main_kernel_w_dec
main_kernel_w_q2:
    s_cmp_lg_u32 s27, 2
    s_cbranch_scc1 main_kernel_w_q3
    s_cmp_lt_u32 s28, 112
    s_cbranch_scc0 main_kernel_w_d_28
    s_cmp_lt_u32 s28, 32
    s_cbranch_scc0 main_kernel_w_d_29
    s_cmp_lt_u32 s28, 16
    s_cbranch_scc0 main_kernel_w_d_30
    s_cmp_lt_u32 s28, 8
    s_cbranch_scc0 main_kernel_w_d_31
    s_mov_b32 s36, 0x800
    s_branch main_kernel_w_dec
main_kernel_w_d_31:
    s_mov_b32 s36, 0x1008
    s_branch main_kernel_w_dec
main_kernel_w_d_30:
    s_cmp_lt_u32 s28, 24
    s_cbranch_scc0 main_kernel_w_d_32
    s_mov_b32 s36, 0x44028810
    s_branch main_kernel_w_dec
main_kernel_w_d_32:
    s_mov_b32 s36, 0x44029018
    s_branch main_kernel_w_dec
main_kernel_w_d_29:
    s_cmp_lt_u32 s28, 64
    s_cbranch_scc0 main_kernel_w_d_33
    s_cmp_lt_u32 s28, 48
    s_cbranch_scc0 main_kernel_w_d_34
    s_mov_b32 s36, 0x48189820
    s_branch main_kernel_w_dec
main_kernel_w_d_34:
    s_mov_b32 s36, 0x48009830
    s_branch main_kernel_w_dec
main_kernel_w_d_33:
    s_cmp_lt_u32 s28, 80
    s_cbranch_scc0 main_kernel_w_d_35
    s_mov_b32 s36, 0x4102040
    s_branch main_kernel_w_dec
main_kernel_w_d_35:
    s_cmp_lt_u32 s28, 96
    s_cbranch_scc0 main_kernel_w_d_36
    s_mov_b32 s36, 0x4a109050
    s_branch main_kernel_w_dec
main_kernel_w_d_36:
    s_mov_b32 s36, 0x40c2060
    s_branch main_kernel_w_dec
main_kernel_w_d_28:
    s_cmp_lt_u32 s28, 162
    s_cbranch_scc0 main_kernel_w_d_37
    s_cmp_lt_u32 s28, 136
    s_cbranch_scc0 main_kernel_w_d_38
    s_cmp_lt_u32 s28, 120
    s_cbranch_scc0 main_kernel_w_d_39
    s_mov_b32 s36, 0x67111070
    s_branch main_kernel_w_dec
main_kernel_w_d_39:
    s_mov_b32 s36, 0x49108078
    s_branch main_kernel_w_dec
main_kernel_w_d_38:
    s_cmp_lt_u32 s28, 144
    s_cbranch_scc0 main_kernel_w_d_40
    s_mov_b32 s36, 0x64111088
    s_branch main_kernel_w_dec
main_kernel_w_d_40:
    s_cmp_lt_u32 s28, 150
    s_cbranch_scc0 main_kernel_w_d_41
    s_mov_b32 s36, 0x66c13090
    s_branch main_kernel_w_dec
main_kernel_w_d_41:
    s_mov_b32 s36, 0x4ad0b096
    s_branch main_kernel_w_dec
main_kernel_w_d_37:
    s_cmp_lt_u32 s28, 190
    s_cbranch_scc0 main_kernel_w_d_42
    s_cmp_lt_u32 s28, 174
    s_cbranch_scc0 main_kernel_w_d_43
    s_mov_b32 s36, 0x4ad8b0a2
    s_branch main_kernel_w_dec
main_kernel_w_d_43:
    s_mov_b32 s36, 0x81038ae
    s_branch main_kernel_w_dec
main_kernel_w_d_42:
    s_cmp_lt_u32 s28, 198
    s_cbranch_scc0 main_kernel_w_d_44
    s_mov_b32 s36, 0x671900be
    s_branch main_kernel_w_dec
main_kernel_w_d_44:
    s_cmp_lt_u32 s28, 206
    s_cbranch_scc0 main_kernel_w_d_45
    s_mov_b32 s36, 0x661900c6
    s_branch main_kernel_w_dec
main_kernel_w_d_45:
    s_mov_b32 s36, 0xffffffff
    s_branch main_kernel_w_dec
main_kernel_w_q3:
    s_cmp_lg_u32 s27, 3
    s_cbranch_scc1 main_kernel_w_q4
    s_cmp_lt_u32 s28, 112
    s_cbranch_scc0 main_kernel_w_d_46
    s_cmp_lt_u32 s28, 48
    s_cbranch_scc0 main_kernel_w_d_47
    s_cmp_lt_u32 s28, 16
    s_cbranch_scc0 main_kernel_w_d_48
    s_cmp_lt_u32 s28, 8
    s_cbranch_scc0 main_kernel_w_d_49
    s_mov_b32 s36, 0x1000800
    s_branch main_kernel_w_dec
main_kernel_w_d_49:
    s_mov_b32 s36, 0x1001008
    s_branch main_kernel_w_dec
main_kernel_w_d_48:
    s_cmp_lt_u32 s28, 24
    s_cbranch_scc0 main_kernel_w_d_50
    s_mov_b32 s36, 0x45028810
    s_branch main_kernel_w_dec
main_kernel_w_d_50:
    s_cmp_lt_u32 s28, 32
    s_cbranch_scc0 main_kernel_w_d_51
    s_mov_b32 s36, 0x45029018
    s_branch main_kernel_w_dec
main_kernel_w_d_51:
    s_mov_b32 s36, 0x48089820
    s_branch main_kernel_w_dec
main_kernel_w_d_47:
    s_cmp_lt_u32 s28, 80
    s_cbranch_scc0 main_kernel_w_d_52
    s_cmp_lt_u32 s28, 56
    s_cbranch_scc0 main_kernel_w_d_53
    s_mov_b32 s36, 0x66090830
    s_branch main_kernel_w_dec
main_kernel_w_d_53:
    s_cmp_lt_u32 s28, 64
    s_cbranch_scc0 main_kernel_w_d_54
    s_mov_b32 s36, 0x40068838
    s_branch main_kernel_w_dec
main_kernel_w_d_54:
    s_mov_b32 s36, 0x4142040
    s_branch main_kernel_w_dec
main_kernel_w_d_52:
    s_cmp_lt_u32 s28, 88
    s_cbranch_scc0 main_kernel_w_d_55
    s_mov_b32 s36, 0x67110850
    s_branch main_kernel_w_dec
main_kernel_w_d_55:
    s_cmp_lt_u32 s28, 96
    s_cbranch_scc0 main_kernel_w_d_56
    s_mov_b32 s36, 0x64110858
    s_branch main_kernel_w_dec
main_kernel_w_d_56:
    s_mov_b32 s36, 0x44048060
    s_branch main_kernel_w_dec
main_kernel_w_d_46:
    s_cmp_lt_u32 s28, 168
    s_cbranch_scc0 main_kernel_w_d_57
    s_cmp_lt_u32 s28, 142
    s_cbranch_scc0 main_kernel_w_d_58
    s_cmp_lt_u32 s28, 120
    s_cbranch_scc0 main_kernel_w_d_59
    s_mov_b32 s36, 0x67191070
    s_branch main_kernel_w_dec
main_kernel_w_d_59:
    s_cmp_lt_u32 s28, 136
    s_cbranch_scc0 main_kernel_w_d_60
    s_mov_b32 s36, 0x8082878
    s_branch main_kernel_w_dec
main_kernel_w_d_60:
    s_mov_b32 s36, 0x66013088
    s_branch main_kernel_w_dec
main_kernel_w_d_58:
    s_cmp_lt_u32 s28, 148
    s_cbranch_scc0 main_kernel_w_d_61
    s_mov_b32 s36, 0x6609308e
    s_branch main_kernel_w_dec
main_kernel_w_d_61:
    s_cmp_lt_u32 s28, 156
    s_cbranch_scc0 main_kernel_w_d_62
    s_mov_b32 s36, 0x65093094
    s_branch main_kernel_w_dec
main_kernel_w_d_62:
    s_mov_b32 s36, 0x4ac8b09c
    s_branch main_kernel_w_dec
main_kernel_w_d_57:
    s_cmp_lt_u32 s28, 208
    s_cbranch_scc0 main_kernel_w_d_63
    s_cmp_lt_u32 s28, 184
    s_cbranch_scc0 main_kernel_w_d_64
    s_mov_b32 s36, 0x89838a8
    s_branch main_kernel_w_dec
main_kernel_w_d_64:
    s_cmp_lt_u32 s28, 200
    s_cbranch_scc0 main_kernel_w_d_65
    s_mov_b32 s36, 0x88038b8
    s_branch main_kernel_w_dec
main_kernel_w_d_65:
    s_mov_b32 s36, 0x240c8
    s_branch main_kernel_w_dec
main_kernel_w_d_63:
    s_cmp_lt_u32 s28, 216
    s_cbranch_scc0 main_kernel_w_d_66
    s_mov_b32 s36, 0x840d0
    s_branch main_kernel_w_dec
main_kernel_w_d_66:
    s_cmp_lt_u32 s28, 224
    s_cbranch_scc0 main_kernel_w_d_67
    s_mov_b32 s36, 0x440d8
    s_branch main_kernel_w_dec
main_kernel_w_d_67:
    s_mov_b32 s36, 0xffffffff
    s_branch main_kernel_w_dec
main_kernel_w_q4:
    s_cmp_lg_u32 s27, 4
    s_cbranch_scc1 main_kernel_w_q5
    s_cmp_lt_u32 s28, 112
    s_cbranch_scc0 main_kernel_w_d_68
    s_cmp_lt_u32 s28, 48
    s_cbranch_scc0 main_kernel_w_d_69
    s_cmp_lt_u32 s28, 24
    s_cbranch_scc0 main_kernel_w_d_70
    s_cmp_lt_u32 s28, 8
    s_cbranch_scc0 main_kernel_w_d_71
    s_mov_b32 s36, 0x2000800
    s_branch main_kernel_w_dec
main_kernel_w_d_71:
    s_cmp_lt_u32 s28, 16
    s_cbranch_scc0 main_kernel_w_d_72
    s_mov_b32 s36, 0x2001008
    s_branch main_kernel_w_dec
main_kernel_w_d_72:
    s_mov_b32 s36, 0x46028810
    s_branch main_kernel_w_dec
main_kernel_w_d_70:
    s_cmp_lt_u32 s28, 32
    s_cbranch_scc0 main_kernel_w_d_73
    s_mov_b32 s36, 0x46029018
    s_branch main_kernel_w_dec
main_kernel_w_d_73:
    s_cmp_lt_u32 s28, 40
    s_cbranch_scc0 main_kernel_w_d_74
    s_mov_b32 s36, 0x64091020
    s_branch main_kernel_w_dec
main_kernel_w_d_74:
    s_mov_b32 s36, 0x66091028
    s_branch main_kernel_w_dec
main_kernel_w_d_69:
    s_cmp_lt_u32 s28, 72
    s_cbranch_scc0 main_kernel_w_d_75
    s_cmp_lt_u32 s28, 56
    s_cbranch_scc0 main_kernel_w_d_76
    s_mov_b32 s36, 0x67090830
    s_branch main_kernel_w_dec
main_kernel_w_d_76:
    s_cmp_lt_u32 s28, 64
    s_cbranch_scc0 main_kernel_w_d_77
    s_mov_b32 s36, 0x65090838
    s_branch main_kernel_w_dec
main_kernel_w_d_77:
    s_mov_b32 s36, 0x67090040
    s_branch main_kernel_w_dec
main_kernel_w_d_75:
    s_cmp_lt_u32 s28, 80
    s_cbranch_scc0 main_kernel_w_d_78
    s_mov_b32 s36, 0x65111048
    s_branch main_kernel_w_dec
main_kernel_w_d_78:
    s_cmp_lt_u32 s28, 96
    s_cbranch_scc0 main_kernel_w_d_79
    s_mov_b32 s36, 0x48108050
    s_branch main_kernel_w_dec
main_kernel_w_d_79:
    s_mov_b32 s36, 0x8182860
    s_branch main_kernel_w_dec
main_kernel_w_d_68:
    s_cmp_lt_u32 s28, 172
    s_cbranch_scc0 main_kernel_w_d_80
    s_cmp_lt_u32 s28, 144
    s_cbranch_scc0 main_kernel_w_d_81
    s_cmp_lt_u32 s28, 120
    s_cbranch_scc0 main_kernel_w_d_82
    s_mov_b32 s36, 0x65013070
    s_branch main_kernel_w_dec
main_kernel_w_d_82:
    s_cmp_lt_u32 s28, 136
    s_cbranch_scc0 main_kernel_w_d_83
    s_mov_b32 s36, 0x48188878
    s_branch main_kernel_w_dec
main_kernel_w_d_83:
    s_mov_b32 s36, 0x64193088
    s_branch main_kernel_w_dec
main_kernel_w_d_81:
    s_cmp_lt_u32 s28, 156
    s_cbranch_scc0 main_kernel_w_d_84
    s_mov_b32 s36, 0x4a18b090
    s_branch main_kernel_w_dec
main_kernel_w_d_84:
    s_cmp_lt_u32 s28, 164
    s_cbranch_scc0 main_kernel_w_d_85
    s_mov_b32 s36, 0x6419109c
    s_branch main_kernel_w_dec
main_kernel_w_d_85:
    s_mov_b32 s36, 0x651900a4
    s_branch main_kernel_w_dec
main_kernel_w_d_80:
    s_cmp_lt_u32 s28, 204
    s_cbranch_scc0 main_kernel_w_d_86
    s_cmp_lt_u32 s28, 188
    s_cbranch_scc0 main_kernel_w_d_87
    s_mov_b32 s36, 0x80038ac
    s_branch main_kernel_w_dec
main_kernel_w_d_87:
    s_cmp_lt_u32 s28, 196
    s_cbranch_scc0 main_kernel_w_d_88
    s_mov_b32 s36, 0x640bc
    s_branch main_kernel_w_dec
main_kernel_w_d_88:
    s_mov_b32 s36, 0xa40c4
    s_branch main_kernel_w_dec
main_kernel_w_d_86:
    s_cmp_lt_u32 s28, 212
    s_cbranch_scc0 main_kernel_w_d_89
    s_mov_b32 s36, 0xe40cc
    s_branch main_kernel_w_dec
main_kernel_w_d_89:
    s_cmp_lt_u32 s28, 220
    s_cbranch_scc0 main_kernel_w_d_90
    s_mov_b32 s36, 0x1040d4
    s_branch main_kernel_w_dec
main_kernel_w_d_90:
    s_mov_b32 s36, 0xffffffff
    s_branch main_kernel_w_dec
main_kernel_w_q5:
    s_cmp_lt_u32 s28, 128
    s_cbranch_scc0 main_kernel_w_d_91
    s_cmp_lt_u32 s28, 48
    s_cbranch_scc0 main_kernel_w_d_92
    s_cmp_lt_u32 s28, 24
    s_cbranch_scc0 main_kernel_w_d_93
    s_cmp_lt_u32 s28, 8
    s_cbranch_scc0 main_kernel_w_d_94
    s_mov_b32 s36, 0x3000800
    s_branch main_kernel_w_dec
main_kernel_w_d_94:
    s_cmp_lt_u32 s28, 16
    s_cbranch_scc0 main_kernel_w_d_95
    s_mov_b32 s36, 0x3001008
    s_branch main_kernel_w_dec
main_kernel_w_d_95:
    s_mov_b32 s36, 0x47028810
    s_branch main_kernel_w_dec
main_kernel_w_d_93:
    s_cmp_lt_u32 s28, 32
    s_cbranch_scc0 main_kernel_w_d_96
    s_mov_b32 s36, 0x47029018
    s_branch main_kernel_w_dec
main_kernel_w_d_96:
    s_cmp_lt_u32 s28, 40
    s_cbranch_scc0 main_kernel_w_d_97
    s_mov_b32 s36, 0x65091020
    s_branch main_kernel_w_dec
main_kernel_w_d_97:
    s_mov_b32 s36, 0x4045028
    s_branch main_kernel_w_dec
main_kernel_w_d_92:
    s_cmp_lt_u32 s28, 72
    s_cbranch_scc0 main_kernel_w_d_98
    s_cmp_lt_u32 s28, 56
    s_cbranch_scc0 main_kernel_w_d_99
    s_mov_b32 s36, 0x42068830
    s_branch main_kernel_w_dec
main_kernel_w_d_99:
    s_cmp_lt_u32 s28, 64
    s_cbranch_scc0 main_kernel_w_d_100
    s_mov_b32 s36, 0x66110838
    s_branch main_kernel_w_dec
main_kernel_w_d_100:
    s_mov_b32 s36, 0x40069040
    s_branch main_kernel_w_dec
main_kernel_w_d_98:
    s_cmp_lt_u32 s28, 96
    s_cbranch_scc0 main_kernel_w_d_101
    s_cmp_lt_u32 s28, 80
    s_cbranch_scc0 main_kernel_w_d_102
    s_mov_b32 s36, 0x64090048
    s_branch main_kernel_w_dec
main_kernel_w_d_102:
    s_mov_b32 s36, 0x4182050
    s_branch main_kernel_w_dec
main_kernel_w_d_101:
    s_cmp_lt_u32 s28, 112
    s_cbranch_scc0 main_kernel_w_d_103
    s_mov_b32 s36, 0x8102860
    s_branch main_kernel_w_dec
main_kernel_w_d_103:
    s_mov_b32 s36, 0x4002070
    s_branch main_kernel_w_dec
main_kernel_w_d_91:
    s_cmp_lt_u32 s28, 200
    s_cbranch_scc0 main_kernel_w_d_104
    s_cmp_lt_u32 s28, 160
    s_cbranch_scc0 main_kernel_w_d_105
    s_cmp_lt_u32 s28, 144
    s_cbranch_scc0 main_kernel_w_d_106
    s_mov_b32 s36, 0x8185080
    s_branch main_kernel_w_dec
main_kernel_w_d_106:
    s_cmp_lt_u32 s28, 152
    s_cbranch_scc0 main_kernel_w_d_107
    s_mov_b32 s36, 0x65113090
    s_branch main_kernel_w_dec
main_kernel_w_d_107:
    s_mov_b32 s36, 0x65110898
    s_branch main_kernel_w_dec
main_kernel_w_d_105:
    s_cmp_lt_u32 s28, 176
    s_cbranch_scc0 main_kernel_w_d_108
    s_mov_b32 s36, 0x4a0880a0
    s_branch main_kernel_w_dec
main_kernel_w_d_108:
    s_cmp_lt_u32 s28, 184
    s_cbranch_scc0 main_kernel_w_d_109
    s_mov_b32 s36, 0x651908b0
    s_branch main_kernel_w_dec
main_kernel_w_d_109:
    s_mov_b32 s36, 0x4808b0b8
    s_branch main_kernel_w_dec
main_kernel_w_d_104:
    s_cmp_lt_u32 s28, 232
    s_cbranch_scc0 main_kernel_w_d_110
    s_cmp_lt_u32 s28, 208
    s_cbranch_scc0 main_kernel_w_d_111
    s_mov_b32 s36, 0x671908c8
    s_branch main_kernel_w_dec
main_kernel_w_d_111:
    s_cmp_lt_u32 s28, 216
    s_cbranch_scc0 main_kernel_w_d_112
    s_mov_b32 s36, 0x661910d0
    s_branch main_kernel_w_dec
main_kernel_w_d_112:
    s_mov_b32 s36, 0x81838d8
    s_branch main_kernel_w_dec
main_kernel_w_d_110:
    s_cmp_lt_u32 s28, 256
    s_cbranch_scc0 main_kernel_w_d_113
    s_cmp_lt_u32 s28, 248
    s_cbranch_scc0 main_kernel_w_d_114
    s_mov_b32 s36, 0x88838e8
    s_branch main_kernel_w_dec
main_kernel_w_d_114:
    s_mov_b32 s36, 0x40f8
    s_branch main_kernel_w_dec
main_kernel_w_d_113:
    s_cmp_lt_u32 s28, 264
    s_cbranch_scc0 main_kernel_w_d_115
    s_mov_b32 s36, 0xc4100
    s_branch main_kernel_w_dec
main_kernel_w_d_115:
    s_mov_b32 s36, 0xffffffff
    s_branch main_kernel_w_dec
main_kernel_w_dec:
    s_cmp_lg_u32 s36, -1
    s_cbranch_scc1 main_kernel_w_got
    s_add_u32 s27, s27, 1
    s_cmp_ge_u32 s27, 6
    s_cselect_b32 s27, 0, s27
    s_add_u32 s52, s52, 1
    s_lshl_b32 s32, 1, s12
    s_and_b32 s32, s32, 116
    s_cselect_b32 s36, -2, -1
    s_cbranch_scc1 main_kernel_w_pub
    s_lshl_b32 s32, s12, 5
    s_add_u32 s32, s32, s13
    s_sub_u32 s32, s32, 224
    s_cmp_lt_u32 s32, 16
    s_cselect_b32 s52, 6, s52
    s_cmp_lt_u32 s52, 6
    s_cbranch_scc1 main_kernel_w_try
    s_lshl_b32 s32, s12, 5
    s_add_u32 s32, s32, s13
    s_sub_u32 s32, s32, 160
    s_cmp_lt_u32 s32, 80
    s_cselect_b32 s36, -3, -1
    s_cmp_lt_u32 s32, 64
    s_cselect_b32 s36, -2, s36
    s_branch main_kernel_w_pub
main_kernel_w_got:
    s_and_b32 s32, s36, 0x7ff
    s_sub_u32 s28, s28, s32
    s_bfe_u32 s32, s36, 0x3001a
    s_lshr_b32 s25, s28, s32
    s_lshl_b32 s33, s25, s32
    s_sub_u32 s24, s28, s33
    s_bfe_u32 s34, s36, 0x1001d
    s_lshl_b32 s24, s24, s34
    s_bfe_u32 s35, s36, 0x1001e
    s_lshl_b32 s25, s25, s35
    s_bfe_u32 s32, s36, 0x40011
    s_add_u32 s24, s24, s32
    s_bfe_u32 s32, s36, 0x50015
    s_add_u32 s25, s25, s32
    s_bfe_u32 s23, s36, 0x4000b
    s_bfe_u32 s36, s36, 0x6000b
    s_lshl_b32 s32, s24, 8
    s_or_b32 s36, s36, s32
    s_lshl_b32 s32, s25, 16
    s_or_b32 s36, s36, s32
    s_cmp_eq_u32 s23, 8
    s_cbranch_scc1 main_kernel_w_dwo
    s_cmp_ge_u32 s23, 10
    s_cbranch_scc1 main_kernel_w_pub
    s_mov_b32 s48, s24
    s_add_u32 s49, s24, s34
    s_mov_b32 s50, 4
    s_mov_b32 s51, 7
    s_cmp_lg_u32 s23, 4
    s_cbranch_scc1 main_kernel_w_dp1
    s_sub_u32 s48, s48, 1
    s_max_i32 s48, s48, 0
    s_add_u32 s49, s49, 1
    s_min_u32 s49, s49, 15
main_kernel_w_dp1:
    s_cmp_eq_u32 s23, 6
    s_cselect_b32 s51, 3, s51
    s_cmp_eq_u32 s23, 7
    s_cselect_b32 s51, 27, s51
    s_cselect_b32 s50, 5, s50
    v_lshrrev_b32 v253, s50, v250
    v_lshlrev_b32 v254, s50, v253
    v_sub_u32 v254, v250, v254
    v_min_u32 v254, s51, v254
    v_add_u32 v253, s48, v253
    v_min_u32 v253, s49, v253
    v_lshlrev_b32 v253, 9, v253
    v_lshl_add_u32 v253, v254, 4, v253
    s_cmp_lt_u32 s23, 4
    s_cselect_b32 s39, 10, s23
    s_lshl_b32 s39, s39, 13
    s_cmp_eq_u32 s23, 3
    s_cselect_b32 s32, 4, 0
    s_add_u32 s39, s39, s32
    s_add_u32 s39, s39, 0x8402000
main_kernel_w_poll:
    buffer_load_dword v254, v253, s[4:7], s39 offen sc1
    s_waitcnt vmcnt(0)
    v_cmp_eq_u32 vcc, 0, v254
    s_cmp_eq_u32 s57, 0
    s_cbranch_scc1 main_kernel_w_fl2
    s_waitcnt vmcnt(0)
    s_barrier
    v_mov_b32 v4, 1
    v_mov_b32 v5, 1
    v_mov_b32 v6, 1
    v_mov_b32 v7, 1
    s_bfm_b64 exec, s57, 0
    buffer_store_dwordx4 v[4:7], v249, s[4:7], s56 offen sc1
    s_mov_b64 exec, -1
    s_mov_b32 s57, 0
main_kernel_w_fl2:
    s_cbranch_vccz main_kernel_w_pub
    s_sleep 8
    s_sub_u32 s29, s29, 1
    s_cbranch_scc0 main_kernel_w_poll
    s_mov_b32 s36, -1
    s_branch main_kernel_w_pub
main_kernel_w_dwo:
    s_lshl_b32 s39, s24, 10
    s_add_u32 s39, s39, 0x8400000
main_kernel_w_pollo:
    buffer_load_dwordx4 v[0:3], v251, s[4:7], s39 offen sc1
    s_waitcnt vmcnt(0)
    v_min3_u32 v0, v0, v1, v2
    v_min_u32 v0, v0, v3
    v_cmp_eq_u32 vcc, 0, v0
    s_cmp_eq_u32 s57, 0
    s_cbranch_scc1 main_kernel_w_fl3
    s_waitcnt vmcnt(0)
    s_barrier
    v_mov_b32 v4, 1
    v_mov_b32 v5, 1
    v_mov_b32 v6, 1
    v_mov_b32 v7, 1
    s_bfm_b64 exec, s57, 0
    buffer_store_dwordx4 v[4:7], v249, s[4:7], s56 offen sc1
    s_mov_b64 exec, -1
    s_mov_b32 s57, 0
main_kernel_w_fl3:
    s_cbranch_vccz main_kernel_w_pub
    s_sleep 16
    s_sub_u32 s29, s29, 1
    s_cbranch_scc0 main_kernel_w_pollo
    s_mov_b32 s36, -1
    s_branch main_kernel_w_pub
main_kernel_w_oko:
    v_min_u32 v253, s35, v250
    v_add_u32 v253, s25, v253
    v_lshlrev_b32 v253, 8, v253
    s_lshl_b32 s39, s24, 4
    s_add_u32 s39, s39, 0x8412000
    s_branch main_kernel_w_poll
main_kernel_w_pub:
    s_cmp_eq_u32 s57, 0
    s_cbranch_scc1 main_kernel_w_fl4
    s_waitcnt vmcnt(0)
    s_barrier
    v_mov_b32 v4, 1
    v_mov_b32 v5, 1
    v_mov_b32 v6, 1
    v_mov_b32 v7, 1
    s_bfm_b64 exec, s57, 0
    buffer_store_dwordx4 v[4:7], v249, s[4:7], s56 offen sc1
    s_mov_b64 exec, -1
    s_mov_b32 s57, 0
main_kernel_w_fl4:
    v_mov_b32 v253, 131072
    v_mov_b32 v254, s36
    ds_write_b32 v253, v254
    s_waitcnt lgkmcnt(0)
main_kernel_w_bar:
    s_barrier
    v_mov_b32 v253, 131072
    ds_read_b32 v254, v253
    s_waitcnt lgkmcnt(0)
    v_readfirstlane_b32 s36, v254
    s_nop 3
    s_cmp_eq_u32 s36, -1
    s_cbranch_scc1 main_kernel_end2
    s_cmp_eq_u32 s36, -2
    s_cbranch_scc1 main_kernel_wo
    s_cmp_eq_u32 s36, -3
    s_cbranch_scc1 main_kernel_att2
    s_mov_b32 s55, -1
    s_and_b32 s23, s36, 15
    s_bfe_u32 s54, s36, 0x20004
    s_bfe_u32 s24, s36, 0x80008
    s_lshr_b32 s25, s36, 16
    s_cmp_eq_u32 s23, 5
    s_cbranch_scc1 main_kernel_w_ln2
    s_cmp_eq_u32 s23, 10
    s_cbranch_scc1 main_kernel_w_fill
    s_cmp_eq_u32 s23, 11
    s_cbranch_scc1 main_kernel_w_pref
    s_cmp_eq_u32 s54, 1
    s_cbranch_scc1 main_kernel_w_c1_task
    s_cmp_eq_u32 s54, 2
    s_cbranch_scc1 main_kernel_w_c2_task
main_kernel_w_c0_task:
    s_cmp_eq_u32 s23, 1
    s_cbranch_scc1 main_kernel_w_c0_set1
    s_cmp_eq_u32 s23, 2
    s_cbranch_scc1 main_kernel_w_c0_set2
    s_cmp_eq_u32 s23, 4
    s_cbranch_scc1 main_kernel_w_c0_set4
    s_cmp_eq_u32 s23, 7
    s_cbranch_scc1 main_kernel_w_c0_set7
    s_cmp_eq_u32 s23, 8
    s_cbranch_scc1 main_kernel_w_c0_set8
    s_branch main_kernel_w_done
main_kernel_w_c0_set1:
    s_lshl_b32 s32, s25, 8
    s_add_u32 s8, s42, s32
    s_addc_u32 s9, s43, 0
    s_and_b32 s9, s9, 0xffff
    s_sub_u32 s10, 0x800000, s32
    s_mov_b32 s11, 0x20000
    s_mov_b32 s30, 8192
    s_mov_b32 s31, 32768
    s_mul_i32 s16, s24, 262144
    s_add_u32 s16, s16, 0x0
    s_mov_b32 s18, 3
    s_lshl_b32 s32, s24, 3
    s_mul_i32 s33, s38, 4
    s_add_u32 s32, s32, s33
    s_mul_i32 s32, s32, 131072
    s_lshl_b32 s33, s25, 12
    s_add_u32 s32, s32, s33
    s_mul_i32 s33, s37, 2048
    s_add_u32 s32, s32, s33
    s_add_u32 s21, s32, 0x1800000
    s_mov_b32 s22, 131072
    s_mov_b32 s26, -1
    s_branch main_kernel_w_c0_go
main_kernel_w_c0_set2:
    s_lshl_b32 s32, s25, 8
    s_add_u32 s8, s44, s32
    s_addc_u32 s9, s45, 0
    s_and_b32 s9, s9, 0xffff
    s_sub_u32 s10, 0x800000, s32
    s_mov_b32 s11, 0x20000
    s_mov_b32 s30, 8192
    s_mov_b32 s31, 32768
    s_mul_i32 s16, s24, 262144
    s_add_u32 s16, s16, 0x0
    s_mov_b32 s18, 3
    s_lshl_b32 s32, s24, 2
    s_mul_i32 s33, s38, 2
    s_add_u32 s32, s32, s33
    s_lshl_b32 s32, s32, 18
    s_lshl_b32 s33, s25, 13
    s_add_u32 s32, s32, s33
    s_mul_i32 s33, s37, 4096
    s_add_u32 s32, s32, s33
    s_add_u32 s21, s32, 0x2800000
    s_branch main_kernel_w_c0_gov
main_kernel_w_c0_set4:
    s_lshl_b32 s32, s25, 8
    s_add_u32 s8, s66, s32
    s_addc_u32 s9, s67, 0
    s_and_b32 s9, s9, 0xffff
    s_sub_u32 s10, 0x200000, s32
    s_mov_b32 s11, 0x20000
    s_mov_b32 s30, 2048
    s_mov_b32 s31, 32768
    s_mul_i32 s16, s24, 262144
    s_add_u32 s16, s16, 0x4808000
    s_mov_b32 s18, 3
    s_lshl_b32 s32, s24, 3
    s_mul_i32 s33, s38, 4
    s_add_u32 s32, s32, s33
    s_mul_i32 s32, s32, 32768
    s_lshl_b32 s33, s25, 12
    s_add_u32 s32, s32, s33
    s_mul_i32 s33, s37, 2048
    s_add_u32 s32, s32, s33
    s_add_u32 s21, s32, 0x5000000
    s_mov_b32 s22, 32768
    s_add_u32 s26, s32, 0x0
    s_branch main_kernel_w_c0_go
main_kernel_w_c0_set7:
    s_lshl_b32 s32, s25, 8
    s_add_u32 s8, s70, s32
    s_addc_u32 s9, s71, 0
    s_and_b32 s9, s9, 0xffff
    s_sub_u32 s10, 0x700000, s32
    s_mov_b32 s11, 0x20000
    s_mov_b32 s30, 2048
    s_mov_b32 s31, 114688
    s_mul_i32 s16, s24, 917504
    s_add_u32 s16, s16, 0x5400000
    s_mov_b32 s18, 13
    s_lshl_b32 s32, s24, 3
    s_mul_i32 s33, s38, 4
    s_add_u32 s32, s32, s33
    s_mul_i32 s32, s32, 32768
    s_lshl_b32 s33, s25, 12
    s_add_u32 s32, s32, s33
    s_mul_i32 s33, s37, 2048
    s_add_u32 s32, s32, s33
    s_add_u32 s21, s32, 0x6400000
    s_mov_b32 s22, 32768
    s_add_u32 s26, s32, 0x5000000
    s_branch main_kernel_w_c0_go
main_kernel_w_c0_set8:
    s_lshl_b32 s32, s25, 8
    s_add_u32 s8, s46, s32
    s_addc_u32 s9, s47, 0
    s_and_b32 s9, s9, 0xffff
    s_sub_u32 s10, 0x800000, s32
    s_mov_b32 s11, 0x20000
    s_mov_b32 s30, 2048
    s_mov_b32 s31, 131072
    s_mul_i32 s16, s24, 1048576
    s_add_u32 s16, s16, 0x3800000
    s_mov_b32 s18, 15
    s_lshl_b32 s32, s24, 3
    s_mul_i32 s33, s38, 4
    s_add_u32 s32, s32, s33
    s_mul_i32 s32, s32, 32768
    s_lshl_b32 s33, s25, 8
    s_add_u32 s34, s32, s33
    s_mul_i32 s33, s37, 128
    s_add_u32 s34, s34, s33
    s_lshl_b32 s33, s25, 12
    s_add_u32 s32, s32, s33
    s_mul_i32 s33, s37, 2048
    s_add_u32 s32, s32, s33
    s_add_u32 s21, s32, 0x0
    s_mov_b32 s22, 32768
    s_add_u32 s26, s32, 0x6400000
    s_mov_b32 s21, s34
    v_and_b32 v253, 15, v250
    v_and_b32 v254, 48, v250
    v_lshl_add_u32 v252, v253, 11, v254
    s_branch main_kernel_w_c0_go
main_kernel_w_c0_go:
    v_lshrrev_b32 v0, 4, v250
    v_bfe_u32 v1, v250, 2, 2
    v_lshl_add_u32 v4, v0, 2, v1
    v_and_b32 v5, 7, v4
    v_mul_u32_u24 v4, 256, v4
    v_and_b32 v6, 3, v250
    v_lshl_add_u32 v4, v6, 3, v4
    s_mul_i32 s32, s37, 4
    v_xor_b32 v5, s32, v5
    v_lshl_add_u32 v128, v5, 5, v4
    v_xor_b32 v129, 32, v128
    v_xor_b32 v130, 64, v128
    v_xor_b32 v131, 96, v128
    s_mul_i32 s32, s38, 8192
    s_add_u32 s32, s32, 65536
    v_add_u32 v136, s32, v251
    v_lshrrev_b32 v2, 4, v250
    v_and_b32 v3, 15, v250
    s_mul_i32 s32, s14, 16
    v_add_u32 v4, s32, v2
    v_add_u32 v5, 0, v4
    v_and_b32 v6, 7, v5
    v_lshlrev_b32 v6, 1, v6
    v_xor_b32 v6, v6, v3
    v_mul_lo_u32 v5, v5, s30
    v_lshl_add_u32 v5, v6, 4, v5
    v_subrev_u32 v137, 0, v5
    v_add_u32 v5, 4, v4
    v_and_b32 v6, 7, v5
    v_lshlrev_b32 v6, 1, v6
    v_xor_b32 v6, v6, v3
    v_mul_lo_u32 v5, v5, s30
    v_lshl_add_u32 v5, v6, 4, v5
    v_subrev_u32 v138, 1024, v5
    v_add_u32 v5, 8, v4
    v_and_b32 v6, 7, v5
    v_lshlrev_b32 v6, 1, v6
    v_xor_b32 v6, v6, v3
    v_mul_lo_u32 v5, v5, s30
    v_lshl_add_u32 v5, v6, 4, v5
    v_subrev_u32 v139, 2048, v5
    v_add_u32 v5, 12, v4
    v_and_b32 v6, 7, v5
    v_lshlrev_b32 v6, 1, v6
    v_xor_b32 v6, v6, v3
    v_mul_lo_u32 v5, v5, s30
    v_lshl_add_u32 v5, v6, 4, v5
    v_subrev_u32 v140, 3072, v5
    s_mul_i32 s32, s14, 2
    s_mul_i32 s32, s32, s31
    v_add_u32 v141, s32, v251
    s_add_u32 s32, s32, s31
    s_sub_u32 s32, s32, 2048
    v_add_u32 v142, s32, v251
    s_mul_i32 s19, s14, 4096
    s_mul_i32 s20, s14, 4096
    s_add_u32 s20, s20, 65536
    s_mul_i32 s17, s30, 64
    s_mov_b32 s15, 0
    s_add_u32 m0, s20, 0
    s_nop 0
    buffer_load_dwordx4 v141, s[4:7], s16 offen offset:0 sc1 lds
    buffer_load_dwordx4 v141, s[4:7], s16 offen offset:1024 sc1 lds
    buffer_load_dwordx4 v142, s[4:7], s16 offen offset:2048 sc1 lds
    buffer_load_dwordx4 v142, s[4:7], s16 offen offset:3072 sc1 lds
    s_add_u32 s16, s16, 2048
    s_add_u32 m0, s19, 0
    s_nop 0
    buffer_load_dwordx4 v137, s[8:11], s15 offen offset:0 lds
    buffer_load_dwordx4 v138, s[8:11], s15 offen offset:1024 lds
    buffer_load_dwordx4 v139, s[8:11], s15 offen offset:2048 lds
    buffer_load_dwordx4 v140, s[8:11], s15 offen offset:3072 lds
    s_add_u32 s15, s15, s17
    s_add_u32 m0, s20, 16384
    s_nop 0
    buffer_load_dwordx4 v141, s[4:7], s16 offen offset:0 sc1 lds
    buffer_load_dwordx4 v141, s[4:7], s16 offen offset:1024 sc1 lds
    buffer_load_dwordx4 v142, s[4:7], s16 offen offset:2048 sc1 lds
    buffer_load_dwordx4 v142, s[4:7], s16 offen offset:3072 sc1 lds
    s_add_u32 s16, s16, 2048
    s_add_u32 m0, s19, 16384
    s_nop 0
    buffer_load_dwordx4 v137, s[8:11], s15 offen offset:0 lds
    buffer_load_dwordx4 v138, s[8:11], s15 offen offset:1024 lds
    buffer_load_dwordx4 v139, s[8:11], s15 offen offset:2048 lds
    buffer_load_dwordx4 v140, s[8:11], s15 offen offset:3072 lds
    s_add_u32 s15, s15, s17
    s_add_u32 m0, s20, 32768
    s_nop 0
    buffer_load_dwordx4 v141, s[4:7], s16 offen offset:0 sc1 lds
    buffer_load_dwordx4 v141, s[4:7], s16 offen offset:1024 sc1 lds
    buffer_load_dwordx4 v142, s[4:7], s16 offen offset:2048 sc1 lds
    buffer_load_dwordx4 v142, s[4:7], s16 offen offset:3072 sc1 lds
    s_add_u32 s16, s16, 2048
    s_add_u32 m0, s19, 32768
    s_nop 0
    buffer_load_dwordx4 v137, s[8:11], s15 offen offset:0 lds
    buffer_load_dwordx4 v138, s[8:11], s15 offen offset:1024 lds
    buffer_load_dwordx4 v139, s[8:11], s15 offen offset:2048 lds
    buffer_load_dwordx4 v140, s[8:11], s15 offen offset:3072 lds
    s_add_u32 s15, s15, s17
    s_add_u32 m0, s20, 49152
    s_nop 0
    buffer_load_dwordx4 v141, s[4:7], s16 offen offset:0 sc1 lds
    buffer_load_dwordx4 v141, s[4:7], s16 offen offset:1024 sc1 lds
    buffer_load_dwordx4 v142, s[4:7], s16 offen offset:2048 sc1 lds
    buffer_load_dwordx4 v142, s[4:7], s16 offen offset:3072 sc1 lds
    s_add_u32 s16, s16, 2048
    v_mov_b32 v64, 0
    v_mov_b32 v65, 0
    v_mov_b32 v66, 0
    v_mov_b32 v67, 0
    v_mov_b32 v68, 0
    v_mov_b32 v69, 0
    v_mov_b32 v70, 0
    v_mov_b32 v71, 0
    v_mov_b32 v72, 0
    v_mov_b32 v73, 0
    v_mov_b32 v74, 0
    v_mov_b32 v75, 0
    v_mov_b32 v76, 0
    v_mov_b32 v77, 0
    v_mov_b32 v78, 0
    v_mov_b32 v79, 0
    v_mov_b32 v80, 0
    v_mov_b32 v81, 0
    v_mov_b32 v82, 0
    v_mov_b32 v83, 0
    v_mov_b32 v84, 0
    v_mov_b32 v85, 0
    v_mov_b32 v86, 0
    v_mov_b32 v87, 0
    v_mov_b32 v88, 0
    v_mov_b32 v89, 0
    v_mov_b32 v90, 0
    v_mov_b32 v91, 0
    v_mov_b32 v92, 0
    v_mov_b32 v93, 0
    v_mov_b32 v94, 0
    v_mov_b32 v95, 0
    v_mov_b32 v96, 0
    v_mov_b32 v97, 0
    v_mov_b32 v98, 0
    v_mov_b32 v99, 0
    v_mov_b32 v100, 0
    v_mov_b32 v101, 0
    v_mov_b32 v102, 0
    v_mov_b32 v103, 0
    v_mov_b32 v104, 0
    v_mov_b32 v105, 0
    v_mov_b32 v106, 0
    v_mov_b32 v107, 0
    v_mov_b32 v108, 0
    v_mov_b32 v109, 0
    v_mov_b32 v110, 0
    v_mov_b32 v111, 0
    v_mov_b32 v112, 0
    v_mov_b32 v113, 0
    v_mov_b32 v114, 0
    v_mov_b32 v115, 0
    v_mov_b32 v116, 0
    v_mov_b32 v117, 0
    v_mov_b32 v118, 0
    v_mov_b32 v119, 0
    v_mov_b32 v120, 0
    v_mov_b32 v121, 0
    v_mov_b32 v122, 0
    v_mov_b32 v123, 0
    v_mov_b32 v124, 0
    v_mov_b32 v125, 0
    v_mov_b32 v126, 0
    v_mov_b32 v127, 0
    s_waitcnt vmcnt(20)
    s_barrier
    ds_read_b128 v[16:19], v136 offset:0
    ds_read_b64_tr_b16 v[0:1], v128 offset:0
    ds_read_b64_tr_b16 v[2:3], v128 offset:4096
    ds_read_b64_tr_b16 v[4:5], v129 offset:0
    ds_read_b64_tr_b16 v[6:7], v129 offset:4096
    ds_read_b64_tr_b16 v[8:9], v130 offset:0
    ds_read_b64_tr_b16 v[10:11], v130 offset:4096
    ds_read_b64_tr_b16 v[12:13], v131 offset:0
    ds_read_b64_tr_b16 v[14:15], v131 offset:4096
    ds_read_b128 v[20:23], v136 offset:2048
    ds_read_b128 v[24:27], v136 offset:4096
    ds_read_b128 v[28:31], v136 offset:6144
main_kernel_w_c0_n_loop:
    s_waitcnt lgkmcnt(0)
    ds_read_b128 v[48:51], v136 offset:1024
    s_add_u32 m0, s19, 49152
    s_nop 0
    v_mfma_f32_16x16x32_bf16 v[64:67], v[0:3], v[16:19], v[64:67]
    ds_read_b64_tr_b16 v[32:33], v128 offset:8192
    v_mfma_f32_16x16x32_bf16 v[68:71], v[4:7], v[16:19], v[68:71]
    ds_read_b64_tr_b16 v[34:35], v128 offset:12288
    buffer_load_dwordx4 v137, s[8:11], s15 offen offset:0 lds
    v_mfma_f32_16x16x32_bf16 v[72:75], v[8:11], v[16:19], v[72:75]
    ds_read_b64_tr_b16 v[36:37], v129 offset:8192
    v_mfma_f32_16x16x32_bf16 v[76:79], v[12:15], v[16:19], v[76:79]
    ds_read_b64_tr_b16 v[38:39], v129 offset:12288
    v_mfma_f32_16x16x32_bf16 v[80:83], v[0:3], v[20:23], v[80:83]
    ds_read_b64_tr_b16 v[40:41], v130 offset:8192
    buffer_load_dwordx4 v138, s[8:11], s15 offen offset:1024 lds
    v_mfma_f32_16x16x32_bf16 v[84:87], v[4:7], v[20:23], v[84:87]
    ds_read_b64_tr_b16 v[42:43], v130 offset:12288
    v_mfma_f32_16x16x32_bf16 v[88:91], v[8:11], v[20:23], v[88:91]
    ds_read_b64_tr_b16 v[44:45], v131 offset:8192
    v_mfma_f32_16x16x32_bf16 v[92:95], v[12:15], v[20:23], v[92:95]
    ds_read_b64_tr_b16 v[46:47], v131 offset:12288
    buffer_load_dwordx4 v139, s[8:11], s15 offen offset:2048 lds
    v_mfma_f32_16x16x32_bf16 v[96:99], v[0:3], v[24:27], v[96:99]
    ds_read_b128 v[52:55], v136 offset:3072
    v_mfma_f32_16x16x32_bf16 v[100:103], v[4:7], v[24:27], v[100:103]
    ds_read_b128 v[56:59], v136 offset:5120
    buffer_load_dwordx4 v140, s[8:11], s15 offen offset:3072 lds
    v_mfma_f32_16x16x32_bf16 v[104:107], v[8:11], v[24:27], v[104:107]
    ds_read_b128 v[60:63], v136 offset:7168
    v_mfma_f32_16x16x32_bf16 v[108:111], v[12:15], v[24:27], v[108:111]
    v_mfma_f32_16x16x32_bf16 v[112:115], v[0:3], v[28:31], v[112:115]
    s_add_u32 s15, s15, s17
    v_mfma_f32_16x16x32_bf16 v[116:119], v[4:7], v[28:31], v[116:119]
    v_mfma_f32_16x16x32_bf16 v[120:123], v[8:11], v[28:31], v[120:123]
    v_mfma_f32_16x16x32_bf16 v[124:127], v[12:15], v[28:31], v[124:127]
    s_waitcnt lgkmcnt(0)
    v_mfma_f32_16x16x32_bf16 v[64:67], v[32:35], v[48:51], v[64:67]
    s_waitcnt vmcnt(16)
    s_barrier
    ds_read_b128 v[16:19], v136 offset:16384
    s_add_u32 m0, s20, 0
    s_nop 0
    v_mfma_f32_16x16x32_bf16 v[68:71], v[36:39], v[48:51], v[68:71]
    ds_read_b64_tr_b16 v[0:1], v128 offset:16384
    v_mfma_f32_16x16x32_bf16 v[72:75], v[40:43], v[48:51], v[72:75]
    ds_read_b64_tr_b16 v[2:3], v128 offset:20480
    buffer_load_dwordx4 v141, s[4:7], s16 offen offset:0 sc1 lds
    v_mfma_f32_16x16x32_bf16 v[76:79], v[44:47], v[48:51], v[76:79]
    ds_read_b64_tr_b16 v[4:5], v129 offset:16384
    v_mfma_f32_16x16x32_bf16 v[80:83], v[32:35], v[52:55], v[80:83]
    ds_read_b64_tr_b16 v[6:7], v129 offset:20480
    v_mfma_f32_16x16x32_bf16 v[84:87], v[36:39], v[52:55], v[84:87]
    ds_read_b64_tr_b16 v[8:9], v130 offset:16384
    buffer_load_dwordx4 v141, s[4:7], s16 offen offset:1024 sc1 lds
    v_mfma_f32_16x16x32_bf16 v[88:91], v[40:43], v[52:55], v[88:91]
    ds_read_b64_tr_b16 v[10:11], v130 offset:20480
    v_mfma_f32_16x16x32_bf16 v[92:95], v[44:47], v[52:55], v[92:95]
    ds_read_b64_tr_b16 v[12:13], v131 offset:16384
    buffer_load_dwordx4 v142, s[4:7], s16 offen offset:2048 sc1 lds
    v_mfma_f32_16x16x32_bf16 v[96:99], v[32:35], v[56:59], v[96:99]
    ds_read_b64_tr_b16 v[14:15], v131 offset:20480
    v_mfma_f32_16x16x32_bf16 v[100:103], v[36:39], v[56:59], v[100:103]
    ds_read_b128 v[20:23], v136 offset:18432
    v_mfma_f32_16x16x32_bf16 v[104:107], v[40:43], v[56:59], v[104:107]
    ds_read_b128 v[24:27], v136 offset:20480
    buffer_load_dwordx4 v142, s[4:7], s16 offen offset:3072 sc1 lds
    v_mfma_f32_16x16x32_bf16 v[108:111], v[44:47], v[56:59], v[108:111]
    ds_read_b128 v[28:31], v136 offset:22528
    v_mfma_f32_16x16x32_bf16 v[112:115], v[32:35], v[60:63], v[112:115]
    s_add_u32 s16, s16, 2048
    v_mfma_f32_16x16x32_bf16 v[116:119], v[36:39], v[60:63], v[116:119]
    v_mfma_f32_16x16x32_bf16 v[120:123], v[40:43], v[60:63], v[120:123]
    v_mfma_f32_16x16x32_bf16 v[124:127], v[44:47], v[60:63], v[124:127]
    s_waitcnt lgkmcnt(0)
    ds_read_b128 v[48:51], v136 offset:17408
    s_add_u32 m0, s19, 0
    s_nop 0
    v_mfma_f32_16x16x32_bf16 v[64:67], v[0:3], v[16:19], v[64:67]
    ds_read_b64_tr_b16 v[32:33], v128 offset:24576
    v_mfma_f32_16x16x32_bf16 v[68:71], v[4:7], v[16:19], v[68:71]
    ds_read_b64_tr_b16 v[34:35], v128 offset:28672
    buffer_load_dwordx4 v137, s[8:11], s15 offen offset:0 lds
    v_mfma_f32_16x16x32_bf16 v[72:75], v[8:11], v[16:19], v[72:75]
    ds_read_b64_tr_b16 v[36:37], v129 offset:24576
    v_mfma_f32_16x16x32_bf16 v[76:79], v[12:15], v[16:19], v[76:79]
    ds_read_b64_tr_b16 v[38:39], v129 offset:28672
    v_mfma_f32_16x16x32_bf16 v[80:83], v[0:3], v[20:23], v[80:83]
    ds_read_b64_tr_b16 v[40:41], v130 offset:24576
    buffer_load_dwordx4 v138, s[8:11], s15 offen offset:1024 lds
    v_mfma_f32_16x16x32_bf16 v[84:87], v[4:7], v[20:23], v[84:87]
    ds_read_b64_tr_b16 v[42:43], v130 offset:28672
    v_mfma_f32_16x16x32_bf16 v[88:91], v[8:11], v[20:23], v[88:91]
    ds_read_b64_tr_b16 v[44:45], v131 offset:24576
    v_mfma_f32_16x16x32_bf16 v[92:95], v[12:15], v[20:23], v[92:95]
    ds_read_b64_tr_b16 v[46:47], v131 offset:28672
    buffer_load_dwordx4 v139, s[8:11], s15 offen offset:2048 lds
    v_mfma_f32_16x16x32_bf16 v[96:99], v[0:3], v[24:27], v[96:99]
    ds_read_b128 v[52:55], v136 offset:19456
    v_mfma_f32_16x16x32_bf16 v[100:103], v[4:7], v[24:27], v[100:103]
    ds_read_b128 v[56:59], v136 offset:21504
    buffer_load_dwordx4 v140, s[8:11], s15 offen offset:3072 lds
    v_mfma_f32_16x16x32_bf16 v[104:107], v[8:11], v[24:27], v[104:107]
    ds_read_b128 v[60:63], v136 offset:23552
    v_mfma_f32_16x16x32_bf16 v[108:111], v[12:15], v[24:27], v[108:111]
    v_mfma_f32_16x16x32_bf16 v[112:115], v[0:3], v[28:31], v[112:115]
    s_add_u32 s15, s15, s17
    v_mfma_f32_16x16x32_bf16 v[116:119], v[4:7], v[28:31], v[116:119]
    v_mfma_f32_16x16x32_bf16 v[120:123], v[8:11], v[28:31], v[120:123]
    v_mfma_f32_16x16x32_bf16 v[124:127], v[12:15], v[28:31], v[124:127]
    s_waitcnt lgkmcnt(0)
    v_mfma_f32_16x16x32_bf16 v[64:67], v[32:35], v[48:51], v[64:67]
    s_waitcnt vmcnt(16)
    s_barrier
    ds_read_b128 v[16:19], v136 offset:32768
    s_add_u32 m0, s20, 16384
    s_nop 0
    v_mfma_f32_16x16x32_bf16 v[68:71], v[36:39], v[48:51], v[68:71]
    ds_read_b64_tr_b16 v[0:1], v128 offset:32768
    v_mfma_f32_16x16x32_bf16 v[72:75], v[40:43], v[48:51], v[72:75]
    ds_read_b64_tr_b16 v[2:3], v128 offset:36864
    buffer_load_dwordx4 v141, s[4:7], s16 offen offset:0 sc1 lds
    v_mfma_f32_16x16x32_bf16 v[76:79], v[44:47], v[48:51], v[76:79]
    ds_read_b64_tr_b16 v[4:5], v129 offset:32768
    v_mfma_f32_16x16x32_bf16 v[80:83], v[32:35], v[52:55], v[80:83]
    ds_read_b64_tr_b16 v[6:7], v129 offset:36864
    v_mfma_f32_16x16x32_bf16 v[84:87], v[36:39], v[52:55], v[84:87]
    ds_read_b64_tr_b16 v[8:9], v130 offset:32768
    buffer_load_dwordx4 v141, s[4:7], s16 offen offset:1024 sc1 lds
    v_mfma_f32_16x16x32_bf16 v[88:91], v[40:43], v[52:55], v[88:91]
    ds_read_b64_tr_b16 v[10:11], v130 offset:36864
    v_mfma_f32_16x16x32_bf16 v[92:95], v[44:47], v[52:55], v[92:95]
    ds_read_b64_tr_b16 v[12:13], v131 offset:32768
    buffer_load_dwordx4 v142, s[4:7], s16 offen offset:2048 sc1 lds
    v_mfma_f32_16x16x32_bf16 v[96:99], v[32:35], v[56:59], v[96:99]
    ds_read_b64_tr_b16 v[14:15], v131 offset:36864
    v_mfma_f32_16x16x32_bf16 v[100:103], v[36:39], v[56:59], v[100:103]
    ds_read_b128 v[20:23], v136 offset:34816
    v_mfma_f32_16x16x32_bf16 v[104:107], v[40:43], v[56:59], v[104:107]
    ds_read_b128 v[24:27], v136 offset:36864
    buffer_load_dwordx4 v142, s[4:7], s16 offen offset:3072 sc1 lds
    v_mfma_f32_16x16x32_bf16 v[108:111], v[44:47], v[56:59], v[108:111]
    ds_read_b128 v[28:31], v136 offset:38912
    v_mfma_f32_16x16x32_bf16 v[112:115], v[32:35], v[60:63], v[112:115]
    s_add_u32 s16, s16, 2048
    v_mfma_f32_16x16x32_bf16 v[116:119], v[36:39], v[60:63], v[116:119]
    v_mfma_f32_16x16x32_bf16 v[120:123], v[40:43], v[60:63], v[120:123]
    v_mfma_f32_16x16x32_bf16 v[124:127], v[44:47], v[60:63], v[124:127]
    s_waitcnt lgkmcnt(0)
    ds_read_b128 v[48:51], v136 offset:33792
    s_add_u32 m0, s19, 16384
    s_nop 0
    v_mfma_f32_16x16x32_bf16 v[64:67], v[0:3], v[16:19], v[64:67]
    ds_read_b64_tr_b16 v[32:33], v128 offset:40960
    v_mfma_f32_16x16x32_bf16 v[68:71], v[4:7], v[16:19], v[68:71]
    ds_read_b64_tr_b16 v[34:35], v128 offset:45056
    buffer_load_dwordx4 v137, s[8:11], s15 offen offset:0 lds
    v_mfma_f32_16x16x32_bf16 v[72:75], v[8:11], v[16:19], v[72:75]
    ds_read_b64_tr_b16 v[36:37], v129 offset:40960
    v_mfma_f32_16x16x32_bf16 v[76:79], v[12:15], v[16:19], v[76:79]
    ds_read_b64_tr_b16 v[38:39], v129 offset:45056
    v_mfma_f32_16x16x32_bf16 v[80:83], v[0:3], v[20:23], v[80:83]
    ds_read_b64_tr_b16 v[40:41], v130 offset:40960
    buffer_load_dwordx4 v138, s[8:11], s15 offen offset:1024 lds
    v_mfma_f32_16x16x32_bf16 v[84:87], v[4:7], v[20:23], v[84:87]
    ds_read_b64_tr_b16 v[42:43], v130 offset:45056
    v_mfma_f32_16x16x32_bf16 v[88:91], v[8:11], v[20:23], v[88:91]
    ds_read_b64_tr_b16 v[44:45], v131 offset:40960
    v_mfma_f32_16x16x32_bf16 v[92:95], v[12:15], v[20:23], v[92:95]
    ds_read_b64_tr_b16 v[46:47], v131 offset:45056
    buffer_load_dwordx4 v139, s[8:11], s15 offen offset:2048 lds
    v_mfma_f32_16x16x32_bf16 v[96:99], v[0:3], v[24:27], v[96:99]
    ds_read_b128 v[52:55], v136 offset:35840
    v_mfma_f32_16x16x32_bf16 v[100:103], v[4:7], v[24:27], v[100:103]
    ds_read_b128 v[56:59], v136 offset:37888
    buffer_load_dwordx4 v140, s[8:11], s15 offen offset:3072 lds
    v_mfma_f32_16x16x32_bf16 v[104:107], v[8:11], v[24:27], v[104:107]
    ds_read_b128 v[60:63], v136 offset:39936
    v_mfma_f32_16x16x32_bf16 v[108:111], v[12:15], v[24:27], v[108:111]
    v_mfma_f32_16x16x32_bf16 v[112:115], v[0:3], v[28:31], v[112:115]
    s_add_u32 s15, s15, s17
    v_mfma_f32_16x16x32_bf16 v[116:119], v[4:7], v[28:31], v[116:119]
    v_mfma_f32_16x16x32_bf16 v[120:123], v[8:11], v[28:31], v[120:123]
    v_mfma_f32_16x16x32_bf16 v[124:127], v[12:15], v[28:31], v[124:127]
    s_waitcnt lgkmcnt(0)
    v_mfma_f32_16x16x32_bf16 v[64:67], v[32:35], v[48:51], v[64:67]
    s_waitcnt vmcnt(16)
    s_barrier
    ds_read_b128 v[16:19], v136 offset:49152
    s_add_u32 m0, s20, 32768
    s_nop 0
    v_mfma_f32_16x16x32_bf16 v[68:71], v[36:39], v[48:51], v[68:71]
    ds_read_b64_tr_b16 v[0:1], v128 offset:49152
    v_mfma_f32_16x16x32_bf16 v[72:75], v[40:43], v[48:51], v[72:75]
    ds_read_b64_tr_b16 v[2:3], v128 offset:53248
    buffer_load_dwordx4 v141, s[4:7], s16 offen offset:0 sc1 lds
    v_mfma_f32_16x16x32_bf16 v[76:79], v[44:47], v[48:51], v[76:79]
    ds_read_b64_tr_b16 v[4:5], v129 offset:49152
    v_mfma_f32_16x16x32_bf16 v[80:83], v[32:35], v[52:55], v[80:83]
    ds_read_b64_tr_b16 v[6:7], v129 offset:53248
    v_mfma_f32_16x16x32_bf16 v[84:87], v[36:39], v[52:55], v[84:87]
    ds_read_b64_tr_b16 v[8:9], v130 offset:49152
    buffer_load_dwordx4 v141, s[4:7], s16 offen offset:1024 sc1 lds
    v_mfma_f32_16x16x32_bf16 v[88:91], v[40:43], v[52:55], v[88:91]
    ds_read_b64_tr_b16 v[10:11], v130 offset:53248
    v_mfma_f32_16x16x32_bf16 v[92:95], v[44:47], v[52:55], v[92:95]
    ds_read_b64_tr_b16 v[12:13], v131 offset:49152
    buffer_load_dwordx4 v142, s[4:7], s16 offen offset:2048 sc1 lds
    v_mfma_f32_16x16x32_bf16 v[96:99], v[32:35], v[56:59], v[96:99]
    ds_read_b64_tr_b16 v[14:15], v131 offset:53248
    v_mfma_f32_16x16x32_bf16 v[100:103], v[36:39], v[56:59], v[100:103]
    ds_read_b128 v[20:23], v136 offset:51200
    v_mfma_f32_16x16x32_bf16 v[104:107], v[40:43], v[56:59], v[104:107]
    ds_read_b128 v[24:27], v136 offset:53248
    buffer_load_dwordx4 v142, s[4:7], s16 offen offset:3072 sc1 lds
    v_mfma_f32_16x16x32_bf16 v[108:111], v[44:47], v[56:59], v[108:111]
    ds_read_b128 v[28:31], v136 offset:55296
    v_mfma_f32_16x16x32_bf16 v[112:115], v[32:35], v[60:63], v[112:115]
    s_add_u32 s16, s16, 2048
    v_mfma_f32_16x16x32_bf16 v[116:119], v[36:39], v[60:63], v[116:119]
    v_mfma_f32_16x16x32_bf16 v[120:123], v[40:43], v[60:63], v[120:123]
    v_mfma_f32_16x16x32_bf16 v[124:127], v[44:47], v[60:63], v[124:127]
    s_waitcnt lgkmcnt(0)
    ds_read_b128 v[48:51], v136 offset:50176
    s_add_u32 m0, s19, 32768
    s_nop 0
    v_mfma_f32_16x16x32_bf16 v[64:67], v[0:3], v[16:19], v[64:67]
    ds_read_b64_tr_b16 v[32:33], v128 offset:57344
    v_mfma_f32_16x16x32_bf16 v[68:71], v[4:7], v[16:19], v[68:71]
    ds_read_b64_tr_b16 v[34:35], v128 offset:61440
    buffer_load_dwordx4 v137, s[8:11], s15 offen offset:0 lds
    v_mfma_f32_16x16x32_bf16 v[72:75], v[8:11], v[16:19], v[72:75]
    ds_read_b64_tr_b16 v[36:37], v129 offset:57344
    v_mfma_f32_16x16x32_bf16 v[76:79], v[12:15], v[16:19], v[76:79]
    ds_read_b64_tr_b16 v[38:39], v129 offset:61440
    v_mfma_f32_16x16x32_bf16 v[80:83], v[0:3], v[20:23], v[80:83]
    ds_read_b64_tr_b16 v[40:41], v130 offset:57344
    buffer_load_dwordx4 v138, s[8:11], s15 offen offset:1024 lds
    v_mfma_f32_16x16x32_bf16 v[84:87], v[4:7], v[20:23], v[84:87]
    ds_read_b64_tr_b16 v[42:43], v130 offset:61440
    v_mfma_f32_16x16x32_bf16 v[88:91], v[8:11], v[20:23], v[88:91]
    ds_read_b64_tr_b16 v[44:45], v131 offset:57344
    v_mfma_f32_16x16x32_bf16 v[92:95], v[12:15], v[20:23], v[92:95]
    ds_read_b64_tr_b16 v[46:47], v131 offset:61440
    buffer_load_dwordx4 v139, s[8:11], s15 offen offset:2048 lds
    v_mfma_f32_16x16x32_bf16 v[96:99], v[0:3], v[24:27], v[96:99]
    ds_read_b128 v[52:55], v136 offset:52224
    v_mfma_f32_16x16x32_bf16 v[100:103], v[4:7], v[24:27], v[100:103]
    ds_read_b128 v[56:59], v136 offset:54272
    buffer_load_dwordx4 v140, s[8:11], s15 offen offset:3072 lds
    v_mfma_f32_16x16x32_bf16 v[104:107], v[8:11], v[24:27], v[104:107]
    ds_read_b128 v[60:63], v136 offset:56320
    v_mfma_f32_16x16x32_bf16 v[108:111], v[12:15], v[24:27], v[108:111]
    v_mfma_f32_16x16x32_bf16 v[112:115], v[0:3], v[28:31], v[112:115]
    s_add_u32 s15, s15, s17
    v_mfma_f32_16x16x32_bf16 v[116:119], v[4:7], v[28:31], v[116:119]
    v_mfma_f32_16x16x32_bf16 v[120:123], v[8:11], v[28:31], v[120:123]
    v_mfma_f32_16x16x32_bf16 v[124:127], v[12:15], v[28:31], v[124:127]
    s_waitcnt lgkmcnt(0)
    v_mfma_f32_16x16x32_bf16 v[64:67], v[32:35], v[48:51], v[64:67]
    s_waitcnt vmcnt(16)
    s_barrier
    ds_read_b128 v[16:19], v136 offset:0
    s_add_u32 m0, s20, 49152
    s_nop 0
    v_mfma_f32_16x16x32_bf16 v[68:71], v[36:39], v[48:51], v[68:71]
    ds_read_b64_tr_b16 v[0:1], v128 offset:0
    v_mfma_f32_16x16x32_bf16 v[72:75], v[40:43], v[48:51], v[72:75]
    ds_read_b64_tr_b16 v[2:3], v128 offset:4096
    buffer_load_dwordx4 v141, s[4:7], s16 offen offset:0 sc1 lds
    v_mfma_f32_16x16x32_bf16 v[76:79], v[44:47], v[48:51], v[76:79]
    ds_read_b64_tr_b16 v[4:5], v129 offset:0
    v_mfma_f32_16x16x32_bf16 v[80:83], v[32:35], v[52:55], v[80:83]
    ds_read_b64_tr_b16 v[6:7], v129 offset:4096
    v_mfma_f32_16x16x32_bf16 v[84:87], v[36:39], v[52:55], v[84:87]
    ds_read_b64_tr_b16 v[8:9], v130 offset:0
    buffer_load_dwordx4 v141, s[4:7], s16 offen offset:1024 sc1 lds
    v_mfma_f32_16x16x32_bf16 v[88:91], v[40:43], v[52:55], v[88:91]
    ds_read_b64_tr_b16 v[10:11], v130 offset:4096
    v_mfma_f32_16x16x32_bf16 v[92:95], v[44:47], v[52:55], v[92:95]
    ds_read_b64_tr_b16 v[12:13], v131 offset:0
    buffer_load_dwordx4 v142, s[4:7], s16 offen offset:2048 sc1 lds
    v_mfma_f32_16x16x32_bf16 v[96:99], v[32:35], v[56:59], v[96:99]
    ds_read_b64_tr_b16 v[14:15], v131 offset:4096
    v_mfma_f32_16x16x32_bf16 v[100:103], v[36:39], v[56:59], v[100:103]
    ds_read_b128 v[20:23], v136 offset:2048
    v_mfma_f32_16x16x32_bf16 v[104:107], v[40:43], v[56:59], v[104:107]
    ds_read_b128 v[24:27], v136 offset:4096
    buffer_load_dwordx4 v142, s[4:7], s16 offen offset:3072 sc1 lds
    v_mfma_f32_16x16x32_bf16 v[108:111], v[44:47], v[56:59], v[108:111]
    ds_read_b128 v[28:31], v136 offset:6144
    v_mfma_f32_16x16x32_bf16 v[112:115], v[32:35], v[60:63], v[112:115]
    s_add_u32 s16, s16, 2048
    v_mfma_f32_16x16x32_bf16 v[116:119], v[36:39], v[60:63], v[116:119]
    v_mfma_f32_16x16x32_bf16 v[120:123], v[40:43], v[60:63], v[120:123]
    v_mfma_f32_16x16x32_bf16 v[124:127], v[44:47], v[60:63], v[124:127]
    s_sub_u32 s18, s18, 1
    s_cmp_lg_u32 s18, 0
    s_cbranch_scc1 main_kernel_w_c0_n_loop
    s_cmp_lg_u32 s14, 0
    s_cbranch_scc1 main_kernel_w_c0_n_nt
    s_lshl_b32 s32, s27, 8
    s_add_u32 s32, s32, 0x841e000
    v_mov_b32 v255, 1
    s_mov_b64 exec, 1
    buffer_atomic_add v255, off, s[4:7], s32 sc0 sc1
    s_mov_b64 exec, -1
main_kernel_w_c0_n_nt:
    s_cmp_lg_u32 s23, 8
    s_cbranch_scc1 main_kernel_w_c0_nlw
    s_lshl_b32 s18, s25, 4
    s_add_u32 s18, s18, s24
    s_lshl_b32 s18, s18, 4
    s_add_u32 s18, s18, 0x8412000
    buffer_load_dword v192, off, s[4:7], s18 sc1
main_kernel_w_c0_nlw:
    s_waitcnt lgkmcnt(0)
    ds_read_b128 v[48:51], v136 offset:1024
    s_add_u32 m0, s19, 49152
    s_nop 0
    v_mfma_f32_16x16x32_bf16 v[64:67], v[0:3], v[16:19], v[64:67]
    ds_read_b64_tr_b16 v[32:33], v128 offset:8192
    v_mfma_f32_16x16x32_bf16 v[68:71], v[4:7], v[16:19], v[68:71]
    ds_read_b64_tr_b16 v[34:35], v128 offset:12288
    buffer_load_dwordx4 v137, s[8:11], s15 offen offset:0 lds
    v_mfma_f32_16x16x32_bf16 v[72:75], v[8:11], v[16:19], v[72:75]
    ds_read_b64_tr_b16 v[36:37], v129 offset:8192
    v_mfma_f32_16x16x32_bf16 v[76:79], v[12:15], v[16:19], v[76:79]
    ds_read_b64_tr_b16 v[38:39], v129 offset:12288
    v_mfma_f32_16x16x32_bf16 v[80:83], v[0:3], v[20:23], v[80:83]
    ds_read_b64_tr_b16 v[40:41], v130 offset:8192
    buffer_load_dwordx4 v138, s[8:11], s15 offen offset:1024 lds
    v_mfma_f32_16x16x32_bf16 v[84:87], v[4:7], v[20:23], v[84:87]
    ds_read_b64_tr_b16 v[42:43], v130 offset:12288
    v_mfma_f32_16x16x32_bf16 v[88:91], v[8:11], v[20:23], v[88:91]
    ds_read_b64_tr_b16 v[44:45], v131 offset:8192
    v_mfma_f32_16x16x32_bf16 v[92:95], v[12:15], v[20:23], v[92:95]
    ds_read_b64_tr_b16 v[46:47], v131 offset:12288
    buffer_load_dwordx4 v139, s[8:11], s15 offen offset:2048 lds
    v_mfma_f32_16x16x32_bf16 v[96:99], v[0:3], v[24:27], v[96:99]
    ds_read_b128 v[52:55], v136 offset:3072
    v_mfma_f32_16x16x32_bf16 v[100:103], v[4:7], v[24:27], v[100:103]
    ds_read_b128 v[56:59], v136 offset:5120
    buffer_load_dwordx4 v140, s[8:11], s15 offen offset:3072 lds
    v_mfma_f32_16x16x32_bf16 v[104:107], v[8:11], v[24:27], v[104:107]
    ds_read_b128 v[60:63], v136 offset:7168
    v_mfma_f32_16x16x32_bf16 v[108:111], v[12:15], v[24:27], v[108:111]
    v_mfma_f32_16x16x32_bf16 v[112:115], v[0:3], v[28:31], v[112:115]
    s_add_u32 s15, s15, s17
    v_mfma_f32_16x16x32_bf16 v[116:119], v[4:7], v[28:31], v[116:119]
    v_mfma_f32_16x16x32_bf16 v[120:123], v[8:11], v[28:31], v[120:123]
    v_mfma_f32_16x16x32_bf16 v[124:127], v[12:15], v[28:31], v[124:127]
    s_waitcnt lgkmcnt(0)
    v_mfma_f32_16x16x32_bf16 v[64:67], v[32:35], v[48:51], v[64:67]
    s_waitcnt vmcnt(16)
    s_barrier
    ds_read_b128 v[16:19], v136 offset:16384
    v_mfma_f32_16x16x32_bf16 v[68:71], v[36:39], v[48:51], v[68:71]
    ds_read_b64_tr_b16 v[0:1], v128 offset:16384
    v_mfma_f32_16x16x32_bf16 v[72:75], v[40:43], v[48:51], v[72:75]
    ds_read_b64_tr_b16 v[2:3], v128 offset:20480
    v_mfma_f32_16x16x32_bf16 v[76:79], v[44:47], v[48:51], v[76:79]
    ds_read_b64_tr_b16 v[4:5], v129 offset:16384
    v_mfma_f32_16x16x32_bf16 v[80:83], v[32:35], v[52:55], v[80:83]
    ds_read_b64_tr_b16 v[6:7], v129 offset:20480
    v_mfma_f32_16x16x32_bf16 v[84:87], v[36:39], v[52:55], v[84:87]
    ds_read_b64_tr_b16 v[8:9], v130 offset:16384
    v_mfma_f32_16x16x32_bf16 v[88:91], v[40:43], v[52:55], v[88:91]
    ds_read_b64_tr_b16 v[10:11], v130 offset:20480
    v_mfma_f32_16x16x32_bf16 v[92:95], v[44:47], v[52:55], v[92:95]
    ds_read_b64_tr_b16 v[12:13], v131 offset:16384
    v_mfma_f32_16x16x32_bf16 v[96:99], v[32:35], v[56:59], v[96:99]
    ds_read_b64_tr_b16 v[14:15], v131 offset:20480
    v_mfma_f32_16x16x32_bf16 v[100:103], v[36:39], v[56:59], v[100:103]
    ds_read_b128 v[20:23], v136 offset:18432
    v_mfma_f32_16x16x32_bf16 v[104:107], v[40:43], v[56:59], v[104:107]
    ds_read_b128 v[24:27], v136 offset:20480
    v_mfma_f32_16x16x32_bf16 v[108:111], v[44:47], v[56:59], v[108:111]
    ds_read_b128 v[28:31], v136 offset:22528
    v_mfma_f32_16x16x32_bf16 v[112:115], v[32:35], v[60:63], v[112:115]
    v_mfma_f32_16x16x32_bf16 v[116:119], v[36:39], v[60:63], v[116:119]
    v_mfma_f32_16x16x32_bf16 v[120:123], v[40:43], v[60:63], v[120:123]
    v_mfma_f32_16x16x32_bf16 v[124:127], v[44:47], v[60:63], v[124:127]
    s_waitcnt lgkmcnt(0)
    ds_read_b128 v[48:51], v136 offset:17408
    v_mfma_f32_16x16x32_bf16 v[64:67], v[0:3], v[16:19], v[64:67]
    ds_read_b64_tr_b16 v[32:33], v128 offset:24576
    v_mfma_f32_16x16x32_bf16 v[68:71], v[4:7], v[16:19], v[68:71]
    ds_read_b64_tr_b16 v[34:35], v128 offset:28672
    v_mfma_f32_16x16x32_bf16 v[72:75], v[8:11], v[16:19], v[72:75]
    ds_read_b64_tr_b16 v[36:37], v129 offset:24576
    v_mfma_f32_16x16x32_bf16 v[76:79], v[12:15], v[16:19], v[76:79]
    ds_read_b64_tr_b16 v[38:39], v129 offset:28672
    v_mfma_f32_16x16x32_bf16 v[80:83], v[0:3], v[20:23], v[80:83]
    ds_read_b64_tr_b16 v[40:41], v130 offset:24576
    v_mfma_f32_16x16x32_bf16 v[84:87], v[4:7], v[20:23], v[84:87]
    ds_read_b64_tr_b16 v[42:43], v130 offset:28672
    v_mfma_f32_16x16x32_bf16 v[88:91], v[8:11], v[20:23], v[88:91]
    ds_read_b64_tr_b16 v[44:45], v131 offset:24576
    v_mfma_f32_16x16x32_bf16 v[92:95], v[12:15], v[20:23], v[92:95]
    ds_read_b64_tr_b16 v[46:47], v131 offset:28672
    v_mfma_f32_16x16x32_bf16 v[96:99], v[0:3], v[24:27], v[96:99]
    ds_read_b128 v[52:55], v136 offset:19456
    v_mfma_f32_16x16x32_bf16 v[100:103], v[4:7], v[24:27], v[100:103]
    ds_read_b128 v[56:59], v136 offset:21504
    v_mfma_f32_16x16x32_bf16 v[104:107], v[8:11], v[24:27], v[104:107]
    ds_read_b128 v[60:63], v136 offset:23552
    v_mfma_f32_16x16x32_bf16 v[108:111], v[12:15], v[24:27], v[108:111]
    v_mfma_f32_16x16x32_bf16 v[112:115], v[0:3], v[28:31], v[112:115]
    v_mfma_f32_16x16x32_bf16 v[116:119], v[4:7], v[28:31], v[116:119]
    v_mfma_f32_16x16x32_bf16 v[120:123], v[8:11], v[28:31], v[120:123]
    v_mfma_f32_16x16x32_bf16 v[124:127], v[12:15], v[28:31], v[124:127]
    s_waitcnt lgkmcnt(0)
    v_mfma_f32_16x16x32_bf16 v[64:67], v[32:35], v[48:51], v[64:67]
    s_waitcnt vmcnt(8)
    s_barrier
    ds_read_b128 v[16:19], v136 offset:32768
    v_mfma_f32_16x16x32_bf16 v[68:71], v[36:39], v[48:51], v[68:71]
    ds_read_b64_tr_b16 v[0:1], v128 offset:32768
    v_mfma_f32_16x16x32_bf16 v[72:75], v[40:43], v[48:51], v[72:75]
    ds_read_b64_tr_b16 v[2:3], v128 offset:36864
    v_mfma_f32_16x16x32_bf16 v[76:79], v[44:47], v[48:51], v[76:79]
    ds_read_b64_tr_b16 v[4:5], v129 offset:32768
    v_mfma_f32_16x16x32_bf16 v[80:83], v[32:35], v[52:55], v[80:83]
    ds_read_b64_tr_b16 v[6:7], v129 offset:36864
    v_mfma_f32_16x16x32_bf16 v[84:87], v[36:39], v[52:55], v[84:87]
    ds_read_b64_tr_b16 v[8:9], v130 offset:32768
    v_mfma_f32_16x16x32_bf16 v[88:91], v[40:43], v[52:55], v[88:91]
    ds_read_b64_tr_b16 v[10:11], v130 offset:36864
    v_mfma_f32_16x16x32_bf16 v[92:95], v[44:47], v[52:55], v[92:95]
    ds_read_b64_tr_b16 v[12:13], v131 offset:32768
    v_mfma_f32_16x16x32_bf16 v[96:99], v[32:35], v[56:59], v[96:99]
    ds_read_b64_tr_b16 v[14:15], v131 offset:36864
    v_mfma_f32_16x16x32_bf16 v[100:103], v[36:39], v[56:59], v[100:103]
    ds_read_b128 v[20:23], v136 offset:34816
    v_mfma_f32_16x16x32_bf16 v[104:107], v[40:43], v[56:59], v[104:107]
    ds_read_b128 v[24:27], v136 offset:36864
    v_mfma_f32_16x16x32_bf16 v[108:111], v[44:47], v[56:59], v[108:111]
    ds_read_b128 v[28:31], v136 offset:38912
    v_mfma_f32_16x16x32_bf16 v[112:115], v[32:35], v[60:63], v[112:115]
    v_mfma_f32_16x16x32_bf16 v[116:119], v[36:39], v[60:63], v[116:119]
    v_mfma_f32_16x16x32_bf16 v[120:123], v[40:43], v[60:63], v[120:123]
    v_mfma_f32_16x16x32_bf16 v[124:127], v[44:47], v[60:63], v[124:127]
    s_waitcnt lgkmcnt(0)
    ds_read_b128 v[48:51], v136 offset:33792
    v_mfma_f32_16x16x32_bf16 v[64:67], v[0:3], v[16:19], v[64:67]
    ds_read_b64_tr_b16 v[32:33], v128 offset:40960
    v_mfma_f32_16x16x32_bf16 v[68:71], v[4:7], v[16:19], v[68:71]
    ds_read_b64_tr_b16 v[34:35], v128 offset:45056
    v_mfma_f32_16x16x32_bf16 v[72:75], v[8:11], v[16:19], v[72:75]
    ds_read_b64_tr_b16 v[36:37], v129 offset:40960
    v_mfma_f32_16x16x32_bf16 v[76:79], v[12:15], v[16:19], v[76:79]
    ds_read_b64_tr_b16 v[38:39], v129 offset:45056
    v_mfma_f32_16x16x32_bf16 v[80:83], v[0:3], v[20:23], v[80:83]
    ds_read_b64_tr_b16 v[40:41], v130 offset:40960
    v_mfma_f32_16x16x32_bf16 v[84:87], v[4:7], v[20:23], v[84:87]
    ds_read_b64_tr_b16 v[42:43], v130 offset:45056
    v_mfma_f32_16x16x32_bf16 v[88:91], v[8:11], v[20:23], v[88:91]
    ds_read_b64_tr_b16 v[44:45], v131 offset:40960
    v_mfma_f32_16x16x32_bf16 v[92:95], v[12:15], v[20:23], v[92:95]
    ds_read_b64_tr_b16 v[46:47], v131 offset:45056
    v_mfma_f32_16x16x32_bf16 v[96:99], v[0:3], v[24:27], v[96:99]
    ds_read_b128 v[52:55], v136 offset:35840
    v_mfma_f32_16x16x32_bf16 v[100:103], v[4:7], v[24:27], v[100:103]
    ds_read_b128 v[56:59], v136 offset:37888
    v_mfma_f32_16x16x32_bf16 v[104:107], v[8:11], v[24:27], v[104:107]
    ds_read_b128 v[60:63], v136 offset:39936
    v_mfma_f32_16x16x32_bf16 v[108:111], v[12:15], v[24:27], v[108:111]
    v_mfma_f32_16x16x32_bf16 v[112:115], v[0:3], v[28:31], v[112:115]
    v_mfma_f32_16x16x32_bf16 v[116:119], v[4:7], v[28:31], v[116:119]
    v_mfma_f32_16x16x32_bf16 v[120:123], v[8:11], v[28:31], v[120:123]
    v_mfma_f32_16x16x32_bf16 v[124:127], v[12:15], v[28:31], v[124:127]
    s_waitcnt lgkmcnt(0)
    v_mfma_f32_16x16x32_bf16 v[64:67], v[32:35], v[48:51], v[64:67]
    s_waitcnt vmcnt(0)
    s_barrier
    ds_read_b128 v[16:19], v136 offset:49152
    v_mfma_f32_16x16x32_bf16 v[68:71], v[36:39], v[48:51], v[68:71]
    ds_read_b64_tr_b16 v[0:1], v128 offset:49152
    v_mfma_f32_16x16x32_bf16 v[72:75], v[40:43], v[48:51], v[72:75]
    ds_read_b64_tr_b16 v[2:3], v128 offset:53248
    v_mfma_f32_16x16x32_bf16 v[76:79], v[44:47], v[48:51], v[76:79]
    ds_read_b64_tr_b16 v[4:5], v129 offset:49152
    v_mfma_f32_16x16x32_bf16 v[80:83], v[32:35], v[52:55], v[80:83]
    ds_read_b64_tr_b16 v[6:7], v129 offset:53248
    v_mfma_f32_16x16x32_bf16 v[84:87], v[36:39], v[52:55], v[84:87]
    ds_read_b64_tr_b16 v[8:9], v130 offset:49152
    v_mfma_f32_16x16x32_bf16 v[88:91], v[40:43], v[52:55], v[88:91]
    ds_read_b64_tr_b16 v[10:11], v130 offset:53248
    v_mfma_f32_16x16x32_bf16 v[92:95], v[44:47], v[52:55], v[92:95]
    ds_read_b64_tr_b16 v[12:13], v131 offset:49152
    v_mfma_f32_16x16x32_bf16 v[96:99], v[32:35], v[56:59], v[96:99]
    ds_read_b64_tr_b16 v[14:15], v131 offset:53248
    v_mfma_f32_16x16x32_bf16 v[100:103], v[36:39], v[56:59], v[100:103]
    ds_read_b128 v[20:23], v136 offset:51200
    v_mfma_f32_16x16x32_bf16 v[104:107], v[40:43], v[56:59], v[104:107]
    ds_read_b128 v[24:27], v136 offset:53248
    v_mfma_f32_16x16x32_bf16 v[108:111], v[44:47], v[56:59], v[108:111]
    ds_read_b128 v[28:31], v136 offset:55296
    v_mfma_f32_16x16x32_bf16 v[112:115], v[32:35], v[60:63], v[112:115]
    v_mfma_f32_16x16x32_bf16 v[116:119], v[36:39], v[60:63], v[116:119]
    v_mfma_f32_16x16x32_bf16 v[120:123], v[40:43], v[60:63], v[120:123]
    v_mfma_f32_16x16x32_bf16 v[124:127], v[44:47], v[60:63], v[124:127]
    v_readfirstlane_b32 s55, v255
    s_cmp_lg_u32 s23, 8
    s_cbranch_scc1 main_kernel_w_c0_lwk
main_kernel_w_c0_lwp:
    v_cmp_eq_u32 vcc, 0, v192
    s_cbranch_vccz main_kernel_w_c0_lwk
    s_sleep 8
    buffer_load_dword v192, off, s[4:7], s18 sc1
    s_waitcnt vmcnt(0)
    s_sub_u32 s29, s29, 1
    s_cbranch_scc0 main_kernel_w_c0_lwp
main_kernel_w_c0_lwk:
    s_cmp_eq_u32 s26, -1
    s_cbranch_scc1 main_kernel_w_c0_nores
    s_add_u32 s32, s26, 0
    buffer_load_dwordx4 v[192:195], v251, s[4:7], s32 offen offset:0 sc1
    buffer_load_dwordx4 v[196:199], v251, s[4:7], s32 offen offset:1024 sc1
    s_add_u32 s32, s26, 32768
    buffer_load_dwordx4 v[200:203], v251, s[4:7], s32 offen offset:0 sc1
    buffer_load_dwordx4 v[204:207], v251, s[4:7], s32 offen offset:1024 sc1
    s_add_u32 s32, s26, 65536
    buffer_load_dwordx4 v[208:211], v251, s[4:7], s32 offen offset:0 sc1
    buffer_load_dwordx4 v[212:215], v251, s[4:7], s32 offen offset:1024 sc1
    s_add_u32 s32, s26, 98304
    buffer_load_dwordx4 v[216:219], v251, s[4:7], s32 offen offset:0 sc1
    buffer_load_dwordx4 v[220:223], v251, s[4:7], s32 offen offset:1024 sc1
main_kernel_w_c0_nores:
    s_waitcnt lgkmcnt(0)
    ds_read_b128 v[48:51], v136 offset:50176
    v_mfma_f32_16x16x32_bf16 v[64:67], v[0:3], v[16:19], v[64:67]
    ds_read_b64_tr_b16 v[32:33], v128 offset:57344
    v_mfma_f32_16x16x32_bf16 v[68:71], v[4:7], v[16:19], v[68:71]
    ds_read_b64_tr_b16 v[34:35], v128 offset:61440
    v_mfma_f32_16x16x32_bf16 v[72:75], v[8:11], v[16:19], v[72:75]
    ds_read_b64_tr_b16 v[36:37], v129 offset:57344
    v_mfma_f32_16x16x32_bf16 v[76:79], v[12:15], v[16:19], v[76:79]
    ds_read_b64_tr_b16 v[38:39], v129 offset:61440
    v_mfma_f32_16x16x32_bf16 v[80:83], v[0:3], v[20:23], v[80:83]
    ds_read_b64_tr_b16 v[40:41], v130 offset:57344
    v_mfma_f32_16x16x32_bf16 v[84:87], v[4:7], v[20:23], v[84:87]
    ds_read_b64_tr_b16 v[42:43], v130 offset:61440
    v_mfma_f32_16x16x32_bf16 v[88:91], v[8:11], v[20:23], v[88:91]
    ds_read_b64_tr_b16 v[44:45], v131 offset:57344
    v_mfma_f32_16x16x32_bf16 v[92:95], v[12:15], v[20:23], v[92:95]
    ds_read_b64_tr_b16 v[46:47], v131 offset:61440
    v_mfma_f32_16x16x32_bf16 v[96:99], v[0:3], v[24:27], v[96:99]
    ds_read_b128 v[52:55], v136 offset:52224
    v_mfma_f32_16x16x32_bf16 v[100:103], v[4:7], v[24:27], v[100:103]
    ds_read_b128 v[56:59], v136 offset:54272
    v_mfma_f32_16x16x32_bf16 v[104:107], v[8:11], v[24:27], v[104:107]
    ds_read_b128 v[60:63], v136 offset:56320
    v_mfma_f32_16x16x32_bf16 v[108:111], v[12:15], v[24:27], v[108:111]
    v_mfma_f32_16x16x32_bf16 v[112:115], v[0:3], v[28:31], v[112:115]
    v_mfma_f32_16x16x32_bf16 v[116:119], v[4:7], v[28:31], v[116:119]
    v_mfma_f32_16x16x32_bf16 v[120:123], v[8:11], v[28:31], v[120:123]
    v_mfma_f32_16x16x32_bf16 v[124:127], v[12:15], v[28:31], v[124:127]
    s_waitcnt lgkmcnt(0)
    v_mfma_f32_16x16x32_bf16 v[64:67], v[32:35], v[48:51], v[64:67]
    v_mfma_f32_16x16x32_bf16 v[68:71], v[36:39], v[48:51], v[68:71]
    v_mfma_f32_16x16x32_bf16 v[72:75], v[40:43], v[48:51], v[72:75]
    v_mfma_f32_16x16x32_bf16 v[76:79], v[44:47], v[48:51], v[76:79]
    v_mfma_f32_16x16x32_bf16 v[80:83], v[32:35], v[52:55], v[80:83]
    v_mfma_f32_16x16x32_bf16 v[84:87], v[36:39], v[52:55], v[84:87]
    v_mfma_f32_16x16x32_bf16 v[88:91], v[40:43], v[52:55], v[88:91]
    v_mfma_f32_16x16x32_bf16 v[92:95], v[44:47], v[52:55], v[92:95]
    v_mfma_f32_16x16x32_bf16 v[96:99], v[32:35], v[56:59], v[96:99]
    v_mfma_f32_16x16x32_bf16 v[100:103], v[36:39], v[56:59], v[100:103]
    v_mfma_f32_16x16x32_bf16 v[104:107], v[40:43], v[56:59], v[104:107]
    v_mfma_f32_16x16x32_bf16 v[108:111], v[44:47], v[56:59], v[108:111]
    v_mfma_f32_16x16x32_bf16 v[112:115], v[32:35], v[60:63], v[112:115]
    v_mfma_f32_16x16x32_bf16 v[116:119], v[36:39], v[60:63], v[116:119]
    v_mfma_f32_16x16x32_bf16 v[120:123], v[40:43], v[60:63], v[120:123]
    v_mfma_f32_16x16x32_bf16 v[124:127], v[44:47], v[60:63], v[124:127]
    s_nop 7
    s_cmp_eq_u32 s23, 4
    s_cbranch_scc1 main_kernel_w_c0_eadd
    s_cmp_eq_u32 s23, 7
    s_cbranch_scc1 main_kernel_w_c0_esilu
    s_cmp_eq_u32 s23, 8
    s_cbranch_scc1 main_kernel_w_c0_efin
main_kernel_w_c0_escl:
    s_mov_b32 s53, s21
    v_mul_f32 v64, 0x3e0293ee, v64
    v_mul_f32 v65, 0x3e0293ee, v65
    v_mul_f32 v66, 0x3e0293ee, v66
    v_mul_f32 v67, 0x3e0293ee, v67
    v_mul_f32 v68, 0x3e0293ee, v68
    v_mul_f32 v69, 0x3e0293ee, v69
    v_mul_f32 v70, 0x3e0293ee, v70
    v_mul_f32 v71, 0x3e0293ee, v71
    v_cvt_pk_bf16_f32 v16, v64, v65
    v_cvt_pk_bf16_f32 v17, v66, v67
    v_cvt_pk_bf16_f32 v18, v68, v69
    v_cvt_pk_bf16_f32 v19, v70, v71
    buffer_store_dwordx4 v[16:19], v251, s[4:7], s53 offen offset:0 sc1
    v_mul_f32 v72, 0x3e0293ee, v72
    v_mul_f32 v73, 0x3e0293ee, v73
    v_mul_f32 v74, 0x3e0293ee, v74
    v_mul_f32 v75, 0x3e0293ee, v75
    v_mul_f32 v76, 0x3e0293ee, v76
    v_mul_f32 v77, 0x3e0293ee, v77
    v_mul_f32 v78, 0x3e0293ee, v78
    v_mul_f32 v79, 0x3e0293ee, v79
    v_cvt_pk_bf16_f32 v36, v72, v73
    v_cvt_pk_bf16_f32 v37, v74, v75
    v_cvt_pk_bf16_f32 v38, v76, v77
    v_cvt_pk_bf16_f32 v39, v78, v79
    buffer_store_dwordx4 v[36:39], v251, s[4:7], s53 offen offset:1024 sc1
    s_add_u32 s53, s53, s22
    v_mul_f32 v80, 0x3e0293ee, v80
    v_mul_f32 v81, 0x3e0293ee, v81
    v_mul_f32 v82, 0x3e0293ee, v82
    v_mul_f32 v83, 0x3e0293ee, v83
    v_mul_f32 v84, 0x3e0293ee, v84
    v_mul_f32 v85, 0x3e0293ee, v85
    v_mul_f32 v86, 0x3e0293ee, v86
    v_mul_f32 v87, 0x3e0293ee, v87
    v_cvt_pk_bf16_f32 v56, v80, v81
    v_cvt_pk_bf16_f32 v57, v82, v83
    v_cvt_pk_bf16_f32 v58, v84, v85
    v_cvt_pk_bf16_f32 v59, v86, v87
    buffer_store_dwordx4 v[56:59], v251, s[4:7], s53 offen offset:0 sc1
    v_mul_f32 v88, 0x3e0293ee, v88
    v_mul_f32 v89, 0x3e0293ee, v89
    v_mul_f32 v90, 0x3e0293ee, v90
    v_mul_f32 v91, 0x3e0293ee, v91
    v_mul_f32 v92, 0x3e0293ee, v92
    v_mul_f32 v93, 0x3e0293ee, v93
    v_mul_f32 v94, 0x3e0293ee, v94
    v_mul_f32 v95, 0x3e0293ee, v95
    v_cvt_pk_bf16_f32 v16, v88, v89
    v_cvt_pk_bf16_f32 v17, v90, v91
    v_cvt_pk_bf16_f32 v18, v92, v93
    v_cvt_pk_bf16_f32 v19, v94, v95
    buffer_store_dwordx4 v[16:19], v251, s[4:7], s53 offen offset:1024 sc1
    s_add_u32 s53, s53, s22
    v_mul_f32 v96, 0x3e0293ee, v96
    v_mul_f32 v97, 0x3e0293ee, v97
    v_mul_f32 v98, 0x3e0293ee, v98
    v_mul_f32 v99, 0x3e0293ee, v99
    v_mul_f32 v100, 0x3e0293ee, v100
    v_mul_f32 v101, 0x3e0293ee, v101
    v_mul_f32 v102, 0x3e0293ee, v102
    v_mul_f32 v103, 0x3e0293ee, v103
    v_cvt_pk_bf16_f32 v36, v96, v97
    v_cvt_pk_bf16_f32 v37, v98, v99
    v_cvt_pk_bf16_f32 v38, v100, v101
    v_cvt_pk_bf16_f32 v39, v102, v103
    buffer_store_dwordx4 v[36:39], v251, s[4:7], s53 offen offset:0 sc1
    v_mul_f32 v104, 0x3e0293ee, v104
    v_mul_f32 v105, 0x3e0293ee, v105
    v_mul_f32 v106, 0x3e0293ee, v106
    v_mul_f32 v107, 0x3e0293ee, v107
    v_mul_f32 v108, 0x3e0293ee, v108
    v_mul_f32 v109, 0x3e0293ee, v109
    v_mul_f32 v110, 0x3e0293ee, v110
    v_mul_f32 v111, 0x3e0293ee, v111
    v_cvt_pk_bf16_f32 v56, v104, v105
    v_cvt_pk_bf16_f32 v57, v106, v107
    v_cvt_pk_bf16_f32 v58, v108, v109
    v_cvt_pk_bf16_f32 v59, v110, v111
    buffer_store_dwordx4 v[56:59], v251, s[4:7], s53 offen offset:1024 sc1
    s_add_u32 s53, s53, s22
    v_mul_f32 v112, 0x3e0293ee, v112
    v_mul_f32 v113, 0x3e0293ee, v113
    v_mul_f32 v114, 0x3e0293ee, v114
    v_mul_f32 v115, 0x3e0293ee, v115
    v_mul_f32 v116, 0x3e0293ee, v116
    v_mul_f32 v117, 0x3e0293ee, v117
    v_mul_f32 v118, 0x3e0293ee, v118
    v_mul_f32 v119, 0x3e0293ee, v119
    v_cvt_pk_bf16_f32 v16, v112, v113
    v_cvt_pk_bf16_f32 v17, v114, v115
    v_cvt_pk_bf16_f32 v18, v116, v117
    v_cvt_pk_bf16_f32 v19, v118, v119
    buffer_store_dwordx4 v[16:19], v251, s[4:7], s53 offen offset:0 sc1
    v_mul_f32 v120, 0x3e0293ee, v120
    v_mul_f32 v121, 0x3e0293ee, v121
    v_mul_f32 v122, 0x3e0293ee, v122
    v_mul_f32 v123, 0x3e0293ee, v123
    v_mul_f32 v124, 0x3e0293ee, v124
    v_mul_f32 v125, 0x3e0293ee, v125
    v_mul_f32 v126, 0x3e0293ee, v126
    v_mul_f32 v127, 0x3e0293ee, v127
    v_cvt_pk_bf16_f32 v36, v120, v121
    v_cvt_pk_bf16_f32 v37, v122, v123
    v_cvt_pk_bf16_f32 v38, v124, v125
    v_cvt_pk_bf16_f32 v39, v126, v127
    buffer_store_dwordx4 v[36:39], v251, s[4:7], s53 offen offset:1024 sc1
    s_branch main_kernel_w_done
main_kernel_w_c0_eadd:
    s_mov_b32 s53, s21
    s_waitcnt vmcnt(7)
    v_lshlrev_b32 v8, 16, v192
    v_and_b32 v9, 0xffff0000, v192
    v_lshlrev_b32 v10, 16, v193
    v_and_b32 v11, 0xffff0000, v193
    v_lshlrev_b32 v12, 16, v194
    v_and_b32 v13, 0xffff0000, v194
    v_lshlrev_b32 v14, 16, v195
    v_and_b32 v15, 0xffff0000, v195
    v_pk_add_f32 v[64:65], v[64:65], v[8:9]
    v_pk_add_f32 v[66:67], v[66:67], v[10:11]
    v_pk_add_f32 v[68:69], v[68:69], v[12:13]
    v_pk_add_f32 v[70:71], v[70:71], v[14:15]
    v_cvt_pk_bf16_f32 v16, v64, v65
    v_cvt_pk_bf16_f32 v17, v66, v67
    v_cvt_pk_bf16_f32 v18, v68, v69
    v_cvt_pk_bf16_f32 v19, v70, v71
    buffer_store_dwordx4 v[16:19], v251, s[4:7], s53 offen offset:0 sc1
    s_waitcnt vmcnt(7)
    v_lshlrev_b32 v28, 16, v196
    v_and_b32 v29, 0xffff0000, v196
    v_lshlrev_b32 v30, 16, v197
    v_and_b32 v31, 0xffff0000, v197
    v_lshlrev_b32 v32, 16, v198
    v_and_b32 v33, 0xffff0000, v198
    v_lshlrev_b32 v34, 16, v199
    v_and_b32 v35, 0xffff0000, v199
    v_pk_add_f32 v[72:73], v[72:73], v[28:29]
    v_pk_add_f32 v[74:75], v[74:75], v[30:31]
    v_pk_add_f32 v[76:77], v[76:77], v[32:33]
    v_pk_add_f32 v[78:79], v[78:79], v[34:35]
    v_cvt_pk_bf16_f32 v36, v72, v73
    v_cvt_pk_bf16_f32 v37, v74, v75
    v_cvt_pk_bf16_f32 v38, v76, v77
    v_cvt_pk_bf16_f32 v39, v78, v79
    buffer_store_dwordx4 v[36:39], v251, s[4:7], s53 offen offset:1024 sc1
    s_add_u32 s53, s53, s22
    s_waitcnt vmcnt(7)
    v_lshlrev_b32 v48, 16, v200
    v_and_b32 v49, 0xffff0000, v200
    v_lshlrev_b32 v50, 16, v201
    v_and_b32 v51, 0xffff0000, v201
    v_lshlrev_b32 v52, 16, v202
    v_and_b32 v53, 0xffff0000, v202
    v_lshlrev_b32 v54, 16, v203
    v_and_b32 v55, 0xffff0000, v203
    v_pk_add_f32 v[80:81], v[80:81], v[48:49]
    v_pk_add_f32 v[82:83], v[82:83], v[50:51]
    v_pk_add_f32 v[84:85], v[84:85], v[52:53]
    v_pk_add_f32 v[86:87], v[86:87], v[54:55]
    v_cvt_pk_bf16_f32 v56, v80, v81
    v_cvt_pk_bf16_f32 v57, v82, v83
    v_cvt_pk_bf16_f32 v58, v84, v85
    v_cvt_pk_bf16_f32 v59, v86, v87
    buffer_store_dwordx4 v[56:59], v251, s[4:7], s53 offen offset:0 sc1
    s_waitcnt vmcnt(7)
    v_lshlrev_b32 v8, 16, v204
    v_and_b32 v9, 0xffff0000, v204
    v_lshlrev_b32 v10, 16, v205
    v_and_b32 v11, 0xffff0000, v205
    v_lshlrev_b32 v12, 16, v206
    v_and_b32 v13, 0xffff0000, v206
    v_lshlrev_b32 v14, 16, v207
    v_and_b32 v15, 0xffff0000, v207
    v_pk_add_f32 v[88:89], v[88:89], v[8:9]
    v_pk_add_f32 v[90:91], v[90:91], v[10:11]
    v_pk_add_f32 v[92:93], v[92:93], v[12:13]
    v_pk_add_f32 v[94:95], v[94:95], v[14:15]
    v_cvt_pk_bf16_f32 v16, v88, v89
    v_cvt_pk_bf16_f32 v17, v90, v91
    v_cvt_pk_bf16_f32 v18, v92, v93
    v_cvt_pk_bf16_f32 v19, v94, v95
    buffer_store_dwordx4 v[16:19], v251, s[4:7], s53 offen offset:1024 sc1
    s_add_u32 s53, s53, s22
    s_waitcnt vmcnt(7)
    v_lshlrev_b32 v28, 16, v208
    v_and_b32 v29, 0xffff0000, v208
    v_lshlrev_b32 v30, 16, v209
    v_and_b32 v31, 0xffff0000, v209
    v_lshlrev_b32 v32, 16, v210
    v_and_b32 v33, 0xffff0000, v210
    v_lshlrev_b32 v34, 16, v211
    v_and_b32 v35, 0xffff0000, v211
    v_pk_add_f32 v[96:97], v[96:97], v[28:29]
    v_pk_add_f32 v[98:99], v[98:99], v[30:31]
    v_pk_add_f32 v[100:101], v[100:101], v[32:33]
    v_pk_add_f32 v[102:103], v[102:103], v[34:35]
    v_cvt_pk_bf16_f32 v36, v96, v97
    v_cvt_pk_bf16_f32 v37, v98, v99
    v_cvt_pk_bf16_f32 v38, v100, v101
    v_cvt_pk_bf16_f32 v39, v102, v103
    buffer_store_dwordx4 v[36:39], v251, s[4:7], s53 offen offset:0 sc1
    s_waitcnt vmcnt(7)
    v_lshlrev_b32 v48, 16, v212
    v_and_b32 v49, 0xffff0000, v212
    v_lshlrev_b32 v50, 16, v213
    v_and_b32 v51, 0xffff0000, v213
    v_lshlrev_b32 v52, 16, v214
    v_and_b32 v53, 0xffff0000, v214
    v_lshlrev_b32 v54, 16, v215
    v_and_b32 v55, 0xffff0000, v215
    v_pk_add_f32 v[104:105], v[104:105], v[48:49]
    v_pk_add_f32 v[106:107], v[106:107], v[50:51]
    v_pk_add_f32 v[108:109], v[108:109], v[52:53]
    v_pk_add_f32 v[110:111], v[110:111], v[54:55]
    v_cvt_pk_bf16_f32 v56, v104, v105
    v_cvt_pk_bf16_f32 v57, v106, v107
    v_cvt_pk_bf16_f32 v58, v108, v109
    v_cvt_pk_bf16_f32 v59, v110, v111
    buffer_store_dwordx4 v[56:59], v251, s[4:7], s53 offen offset:1024 sc1
    s_add_u32 s53, s53, s22
    s_waitcnt vmcnt(7)
    v_lshlrev_b32 v8, 16, v216
    v_and_b32 v9, 0xffff0000, v216
    v_lshlrev_b32 v10, 16, v217
    v_and_b32 v11, 0xffff0000, v217
    v_lshlrev_b32 v12, 16, v218
    v_and_b32 v13, 0xffff0000, v218
    v_lshlrev_b32 v14, 16, v219
    v_and_b32 v15, 0xffff0000, v219
    v_pk_add_f32 v[112:113], v[112:113], v[8:9]
    v_pk_add_f32 v[114:115], v[114:115], v[10:11]
    v_pk_add_f32 v[116:117], v[116:117], v[12:13]
    v_pk_add_f32 v[118:119], v[118:119], v[14:15]
    v_cvt_pk_bf16_f32 v16, v112, v113
    v_cvt_pk_bf16_f32 v17, v114, v115
    v_cvt_pk_bf16_f32 v18, v116, v117
    v_cvt_pk_bf16_f32 v19, v118, v119
    buffer_store_dwordx4 v[16:19], v251, s[4:7], s53 offen offset:0 sc1
    s_waitcnt vmcnt(7)
    v_lshlrev_b32 v28, 16, v220
    v_and_b32 v29, 0xffff0000, v220
    v_lshlrev_b32 v30, 16, v221
    v_and_b32 v31, 0xffff0000, v221
    v_lshlrev_b32 v32, 16, v222
    v_and_b32 v33, 0xffff0000, v222
    v_lshlrev_b32 v34, 16, v223
    v_and_b32 v35, 0xffff0000, v223
    v_pk_add_f32 v[120:121], v[120:121], v[28:29]
    v_pk_add_f32 v[122:123], v[122:123], v[30:31]
    v_pk_add_f32 v[124:125], v[124:125], v[32:33]
    v_pk_add_f32 v[126:127], v[126:127], v[34:35]
    v_cvt_pk_bf16_f32 v36, v120, v121
    v_cvt_pk_bf16_f32 v37, v122, v123
    v_cvt_pk_bf16_f32 v38, v124, v125
    v_cvt_pk_bf16_f32 v39, v126, v127
    buffer_store_dwordx4 v[36:39], v251, s[4:7], s53 offen offset:1024 sc1
    s_branch main_kernel_w_done
main_kernel_w_c0_esilu:
    s_mov_b32 s53, s21
    s_waitcnt vmcnt(7)
    v_lshlrev_b32 v8, 16, v192
    v_and_b32 v9, 0xffff0000, v192
    v_lshlrev_b32 v10, 16, v193
    v_and_b32 v11, 0xffff0000, v193
    v_lshlrev_b32 v12, 16, v194
    v_and_b32 v13, 0xffff0000, v194
    v_lshlrev_b32 v14, 16, v195
    v_and_b32 v15, 0xffff0000, v195
    v_pk_add_f32 v[64:65], v[64:65], v[8:9]
    v_pk_add_f32 v[66:67], v[66:67], v[10:11]
    v_pk_add_f32 v[68:69], v[68:69], v[12:13]
    v_pk_add_f32 v[70:71], v[70:71], v[14:15]
    v_pk_mul_f32 v[8:9], v[64:65], v[246:247]
    v_pk_mul_f32 v[10:11], v[66:67], v[246:247]
    v_pk_mul_f32 v[12:13], v[68:69], v[246:247]
    v_pk_mul_f32 v[14:15], v[70:71], v[246:247]
    v_exp_f32 v8, v8
    v_exp_f32 v9, v9
    v_exp_f32 v10, v10
    v_exp_f32 v11, v11
    v_exp_f32 v12, v12
    v_exp_f32 v13, v13
    v_exp_f32 v14, v14
    v_exp_f32 v15, v15
    v_pk_add_f32 v[8:9], v[8:9], v[244:245]
    v_pk_add_f32 v[10:11], v[10:11], v[244:245]
    v_pk_add_f32 v[12:13], v[12:13], v[244:245]
    v_pk_add_f32 v[14:15], v[14:15], v[244:245]
    v_rcp_f32 v8, v8
    v_rcp_f32 v9, v9
    v_rcp_f32 v10, v10
    v_rcp_f32 v11, v11
    v_rcp_f32 v12, v12
    v_rcp_f32 v13, v13
    v_rcp_f32 v14, v14
    v_rcp_f32 v15, v15
    v_pk_mul_f32 v[64:65], v[8:9], v[64:65]
    v_pk_mul_f32 v[66:67], v[10:11], v[66:67]
    v_pk_mul_f32 v[68:69], v[12:13], v[68:69]
    v_pk_mul_f32 v[70:71], v[14:15], v[70:71]
    v_cvt_pk_bf16_f32 v16, v64, v65
    v_cvt_pk_bf16_f32 v17, v66, v67
    v_cvt_pk_bf16_f32 v18, v68, v69
    v_cvt_pk_bf16_f32 v19, v70, v71
    buffer_store_dwordx4 v[16:19], v251, s[4:7], s53 offen offset:0 sc1
    s_waitcnt vmcnt(7)
    v_lshlrev_b32 v28, 16, v196
    v_and_b32 v29, 0xffff0000, v196
    v_lshlrev_b32 v30, 16, v197
    v_and_b32 v31, 0xffff0000, v197
    v_lshlrev_b32 v32, 16, v198
    v_and_b32 v33, 0xffff0000, v198
    v_lshlrev_b32 v34, 16, v199
    v_and_b32 v35, 0xffff0000, v199
    v_pk_add_f32 v[72:73], v[72:73], v[28:29]
    v_pk_add_f32 v[74:75], v[74:75], v[30:31]
    v_pk_add_f32 v[76:77], v[76:77], v[32:33]
    v_pk_add_f32 v[78:79], v[78:79], v[34:35]
    v_pk_mul_f32 v[28:29], v[72:73], v[246:247]
    v_pk_mul_f32 v[30:31], v[74:75], v[246:247]
    v_pk_mul_f32 v[32:33], v[76:77], v[246:247]
    v_pk_mul_f32 v[34:35], v[78:79], v[246:247]
    v_exp_f32 v28, v28
    v_exp_f32 v29, v29
    v_exp_f32 v30, v30
    v_exp_f32 v31, v31
    v_exp_f32 v32, v32
    v_exp_f32 v33, v33
    v_exp_f32 v34, v34
    v_exp_f32 v35, v35
    v_pk_add_f32 v[28:29], v[28:29], v[244:245]
    v_pk_add_f32 v[30:31], v[30:31], v[244:245]
    v_pk_add_f32 v[32:33], v[32:33], v[244:245]
    v_pk_add_f32 v[34:35], v[34:35], v[244:245]
    v_rcp_f32 v28, v28
    v_rcp_f32 v29, v29
    v_rcp_f32 v30, v30
    v_rcp_f32 v31, v31
    v_rcp_f32 v32, v32
    v_rcp_f32 v33, v33
    v_rcp_f32 v34, v34
    v_rcp_f32 v35, v35
    v_pk_mul_f32 v[72:73], v[28:29], v[72:73]
    v_pk_mul_f32 v[74:75], v[30:31], v[74:75]
    v_pk_mul_f32 v[76:77], v[32:33], v[76:77]
    v_pk_mul_f32 v[78:79], v[34:35], v[78:79]
    v_cvt_pk_bf16_f32 v36, v72, v73
    v_cvt_pk_bf16_f32 v37, v74, v75
    v_cvt_pk_bf16_f32 v38, v76, v77
    v_cvt_pk_bf16_f32 v39, v78, v79
    buffer_store_dwordx4 v[36:39], v251, s[4:7], s53 offen offset:1024 sc1
    s_add_u32 s53, s53, s22
    s_waitcnt vmcnt(7)
    v_lshlrev_b32 v48, 16, v200
    v_and_b32 v49, 0xffff0000, v200
    v_lshlrev_b32 v50, 16, v201
    v_and_b32 v51, 0xffff0000, v201
    v_lshlrev_b32 v52, 16, v202
    v_and_b32 v53, 0xffff0000, v202
    v_lshlrev_b32 v54, 16, v203
    v_and_b32 v55, 0xffff0000, v203
    v_pk_add_f32 v[80:81], v[80:81], v[48:49]
    v_pk_add_f32 v[82:83], v[82:83], v[50:51]
    v_pk_add_f32 v[84:85], v[84:85], v[52:53]
    v_pk_add_f32 v[86:87], v[86:87], v[54:55]
    v_pk_mul_f32 v[48:49], v[80:81], v[246:247]
    v_pk_mul_f32 v[50:51], v[82:83], v[246:247]
    v_pk_mul_f32 v[52:53], v[84:85], v[246:247]
    v_pk_mul_f32 v[54:55], v[86:87], v[246:247]
    v_exp_f32 v48, v48
    v_exp_f32 v49, v49
    v_exp_f32 v50, v50
    v_exp_f32 v51, v51
    v_exp_f32 v52, v52
    v_exp_f32 v53, v53
    v_exp_f32 v54, v54
    v_exp_f32 v55, v55
    v_pk_add_f32 v[48:49], v[48:49], v[244:245]
    v_pk_add_f32 v[50:51], v[50:51], v[244:245]
    v_pk_add_f32 v[52:53], v[52:53], v[244:245]
    v_pk_add_f32 v[54:55], v[54:55], v[244:245]
    v_rcp_f32 v48, v48
    v_rcp_f32 v49, v49
    v_rcp_f32 v50, v50
    v_rcp_f32 v51, v51
    v_rcp_f32 v52, v52
    v_rcp_f32 v53, v53
    v_rcp_f32 v54, v54
    v_rcp_f32 v55, v55
    v_pk_mul_f32 v[80:81], v[48:49], v[80:81]
    v_pk_mul_f32 v[82:83], v[50:51], v[82:83]
    v_pk_mul_f32 v[84:85], v[52:53], v[84:85]
    v_pk_mul_f32 v[86:87], v[54:55], v[86:87]
    v_cvt_pk_bf16_f32 v56, v80, v81
    v_cvt_pk_bf16_f32 v57, v82, v83
    v_cvt_pk_bf16_f32 v58, v84, v85
    v_cvt_pk_bf16_f32 v59, v86, v87
    buffer_store_dwordx4 v[56:59], v251, s[4:7], s53 offen offset:0 sc1
    s_waitcnt vmcnt(7)
    v_lshlrev_b32 v8, 16, v204
    v_and_b32 v9, 0xffff0000, v204
    v_lshlrev_b32 v10, 16, v205
    v_and_b32 v11, 0xffff0000, v205
    v_lshlrev_b32 v12, 16, v206
    v_and_b32 v13, 0xffff0000, v206
    v_lshlrev_b32 v14, 16, v207
    v_and_b32 v15, 0xffff0000, v207
    v_pk_add_f32 v[88:89], v[88:89], v[8:9]
    v_pk_add_f32 v[90:91], v[90:91], v[10:11]
    v_pk_add_f32 v[92:93], v[92:93], v[12:13]
    v_pk_add_f32 v[94:95], v[94:95], v[14:15]
    v_pk_mul_f32 v[8:9], v[88:89], v[246:247]
    v_pk_mul_f32 v[10:11], v[90:91], v[246:247]
    v_pk_mul_f32 v[12:13], v[92:93], v[246:247]
    v_pk_mul_f32 v[14:15], v[94:95], v[246:247]
    v_exp_f32 v8, v8
    v_exp_f32 v9, v9
    v_exp_f32 v10, v10
    v_exp_f32 v11, v11
    v_exp_f32 v12, v12
    v_exp_f32 v13, v13
    v_exp_f32 v14, v14
    v_exp_f32 v15, v15
    v_pk_add_f32 v[8:9], v[8:9], v[244:245]
    v_pk_add_f32 v[10:11], v[10:11], v[244:245]
    v_pk_add_f32 v[12:13], v[12:13], v[244:245]
    v_pk_add_f32 v[14:15], v[14:15], v[244:245]
    v_rcp_f32 v8, v8
    v_rcp_f32 v9, v9
    v_rcp_f32 v10, v10
    v_rcp_f32 v11, v11
    v_rcp_f32 v12, v12
    v_rcp_f32 v13, v13
    v_rcp_f32 v14, v14
    v_rcp_f32 v15, v15
    v_pk_mul_f32 v[88:89], v[8:9], v[88:89]
    v_pk_mul_f32 v[90:91], v[10:11], v[90:91]
    v_pk_mul_f32 v[92:93], v[12:13], v[92:93]
    v_pk_mul_f32 v[94:95], v[14:15], v[94:95]
    v_cvt_pk_bf16_f32 v16, v88, v89
    v_cvt_pk_bf16_f32 v17, v90, v91
    v_cvt_pk_bf16_f32 v18, v92, v93
    v_cvt_pk_bf16_f32 v19, v94, v95
    buffer_store_dwordx4 v[16:19], v251, s[4:7], s53 offen offset:1024 sc1
    s_add_u32 s53, s53, s22
    s_waitcnt vmcnt(7)
    v_lshlrev_b32 v28, 16, v208
    v_and_b32 v29, 0xffff0000, v208
    v_lshlrev_b32 v30, 16, v209
    v_and_b32 v31, 0xffff0000, v209
    v_lshlrev_b32 v32, 16, v210
    v_and_b32 v33, 0xffff0000, v210
    v_lshlrev_b32 v34, 16, v211
    v_and_b32 v35, 0xffff0000, v211
    v_pk_add_f32 v[96:97], v[96:97], v[28:29]
    v_pk_add_f32 v[98:99], v[98:99], v[30:31]
    v_pk_add_f32 v[100:101], v[100:101], v[32:33]
    v_pk_add_f32 v[102:103], v[102:103], v[34:35]
    v_pk_mul_f32 v[28:29], v[96:97], v[246:247]
    v_pk_mul_f32 v[30:31], v[98:99], v[246:247]
    v_pk_mul_f32 v[32:33], v[100:101], v[246:247]
    v_pk_mul_f32 v[34:35], v[102:103], v[246:247]
    v_exp_f32 v28, v28
    v_exp_f32 v29, v29
    v_exp_f32 v30, v30
    v_exp_f32 v31, v31
    v_exp_f32 v32, v32
    v_exp_f32 v33, v33
    v_exp_f32 v34, v34
    v_exp_f32 v35, v35
    v_pk_add_f32 v[28:29], v[28:29], v[244:245]
    v_pk_add_f32 v[30:31], v[30:31], v[244:245]
    v_pk_add_f32 v[32:33], v[32:33], v[244:245]
    v_pk_add_f32 v[34:35], v[34:35], v[244:245]
    v_rcp_f32 v28, v28
    v_rcp_f32 v29, v29
    v_rcp_f32 v30, v30
    v_rcp_f32 v31, v31
    v_rcp_f32 v32, v32
    v_rcp_f32 v33, v33
    v_rcp_f32 v34, v34
    v_rcp_f32 v35, v35
    v_pk_mul_f32 v[96:97], v[28:29], v[96:97]
    v_pk_mul_f32 v[98:99], v[30:31], v[98:99]
    v_pk_mul_f32 v[100:101], v[32:33], v[100:101]
    v_pk_mul_f32 v[102:103], v[34:35], v[102:103]
    v_cvt_pk_bf16_f32 v36, v96, v97
    v_cvt_pk_bf16_f32 v37, v98, v99
    v_cvt_pk_bf16_f32 v38, v100, v101
    v_cvt_pk_bf16_f32 v39, v102, v103
    buffer_store_dwordx4 v[36:39], v251, s[4:7], s53 offen offset:0 sc1
    s_waitcnt vmcnt(7)
    v_lshlrev_b32 v48, 16, v212
    v_and_b32 v49, 0xffff0000, v212
    v_lshlrev_b32 v50, 16, v213
    v_and_b32 v51, 0xffff0000, v213
    v_lshlrev_b32 v52, 16, v214
    v_and_b32 v53, 0xffff0000, v214
    v_lshlrev_b32 v54, 16, v215
    v_and_b32 v55, 0xffff0000, v215
    v_pk_add_f32 v[104:105], v[104:105], v[48:49]
    v_pk_add_f32 v[106:107], v[106:107], v[50:51]
    v_pk_add_f32 v[108:109], v[108:109], v[52:53]
    v_pk_add_f32 v[110:111], v[110:111], v[54:55]
    v_pk_mul_f32 v[48:49], v[104:105], v[246:247]
    v_pk_mul_f32 v[50:51], v[106:107], v[246:247]
    v_pk_mul_f32 v[52:53], v[108:109], v[246:247]
    v_pk_mul_f32 v[54:55], v[110:111], v[246:247]
    v_exp_f32 v48, v48
    v_exp_f32 v49, v49
    v_exp_f32 v50, v50
    v_exp_f32 v51, v51
    v_exp_f32 v52, v52
    v_exp_f32 v53, v53
    v_exp_f32 v54, v54
    v_exp_f32 v55, v55
    v_pk_add_f32 v[48:49], v[48:49], v[244:245]
    v_pk_add_f32 v[50:51], v[50:51], v[244:245]
    v_pk_add_f32 v[52:53], v[52:53], v[244:245]
    v_pk_add_f32 v[54:55], v[54:55], v[244:245]
    v_rcp_f32 v48, v48
    v_rcp_f32 v49, v49
    v_rcp_f32 v50, v50
    v_rcp_f32 v51, v51
    v_rcp_f32 v52, v52
    v_rcp_f32 v53, v53
    v_rcp_f32 v54, v54
    v_rcp_f32 v55, v55
    v_pk_mul_f32 v[104:105], v[48:49], v[104:105]
    v_pk_mul_f32 v[106:107], v[50:51], v[106:107]
    v_pk_mul_f32 v[108:109], v[52:53], v[108:109]
    v_pk_mul_f32 v[110:111], v[54:55], v[110:111]
    v_cvt_pk_bf16_f32 v56, v104, v105
    v_cvt_pk_bf16_f32 v57, v106, v107
    v_cvt_pk_bf16_f32 v58, v108, v109
    v_cvt_pk_bf16_f32 v59, v110, v111
    buffer_store_dwordx4 v[56:59], v251, s[4:7], s53 offen offset:1024 sc1
    s_add_u32 s53, s53, s22
    s_waitcnt vmcnt(7)
    v_lshlrev_b32 v8, 16, v216
    v_and_b32 v9, 0xffff0000, v216
    v_lshlrev_b32 v10, 16, v217
    v_and_b32 v11, 0xffff0000, v217
    v_lshlrev_b32 v12, 16, v218
    v_and_b32 v13, 0xffff0000, v218
    v_lshlrev_b32 v14, 16, v219
    v_and_b32 v15, 0xffff0000, v219
    v_pk_add_f32 v[112:113], v[112:113], v[8:9]
    v_pk_add_f32 v[114:115], v[114:115], v[10:11]
    v_pk_add_f32 v[116:117], v[116:117], v[12:13]
    v_pk_add_f32 v[118:119], v[118:119], v[14:15]
    v_pk_mul_f32 v[8:9], v[112:113], v[246:247]
    v_pk_mul_f32 v[10:11], v[114:115], v[246:247]
    v_pk_mul_f32 v[12:13], v[116:117], v[246:247]
    v_pk_mul_f32 v[14:15], v[118:119], v[246:247]
    v_exp_f32 v8, v8
    v_exp_f32 v9, v9
    v_exp_f32 v10, v10
    v_exp_f32 v11, v11
    v_exp_f32 v12, v12
    v_exp_f32 v13, v13
    v_exp_f32 v14, v14
    v_exp_f32 v15, v15
    v_pk_add_f32 v[8:9], v[8:9], v[244:245]
    v_pk_add_f32 v[10:11], v[10:11], v[244:245]
    v_pk_add_f32 v[12:13], v[12:13], v[244:245]
    v_pk_add_f32 v[14:15], v[14:15], v[244:245]
    v_rcp_f32 v8, v8
    v_rcp_f32 v9, v9
    v_rcp_f32 v10, v10
    v_rcp_f32 v11, v11
    v_rcp_f32 v12, v12
    v_rcp_f32 v13, v13
    v_rcp_f32 v14, v14
    v_rcp_f32 v15, v15
    v_pk_mul_f32 v[112:113], v[8:9], v[112:113]
    v_pk_mul_f32 v[114:115], v[10:11], v[114:115]
    v_pk_mul_f32 v[116:117], v[12:13], v[116:117]
    v_pk_mul_f32 v[118:119], v[14:15], v[118:119]
    v_cvt_pk_bf16_f32 v16, v112, v113
    v_cvt_pk_bf16_f32 v17, v114, v115
    v_cvt_pk_bf16_f32 v18, v116, v117
    v_cvt_pk_bf16_f32 v19, v118, v119
    buffer_store_dwordx4 v[16:19], v251, s[4:7], s53 offen offset:0 sc1
    s_waitcnt vmcnt(7)
    v_lshlrev_b32 v28, 16, v220
    v_and_b32 v29, 0xffff0000, v220
    v_lshlrev_b32 v30, 16, v221
    v_and_b32 v31, 0xffff0000, v221
    v_lshlrev_b32 v32, 16, v222
    v_and_b32 v33, 0xffff0000, v222
    v_lshlrev_b32 v34, 16, v223
    v_and_b32 v35, 0xffff0000, v223
    v_pk_add_f32 v[120:121], v[120:121], v[28:29]
    v_pk_add_f32 v[122:123], v[122:123], v[30:31]
    v_pk_add_f32 v[124:125], v[124:125], v[32:33]
    v_pk_add_f32 v[126:127], v[126:127], v[34:35]
    v_pk_mul_f32 v[28:29], v[120:121], v[246:247]
    v_pk_mul_f32 v[30:31], v[122:123], v[246:247]
    v_pk_mul_f32 v[32:33], v[124:125], v[246:247]
    v_pk_mul_f32 v[34:35], v[126:127], v[246:247]
    v_exp_f32 v28, v28
    v_exp_f32 v29, v29
    v_exp_f32 v30, v30
    v_exp_f32 v31, v31
    v_exp_f32 v32, v32
    v_exp_f32 v33, v33
    v_exp_f32 v34, v34
    v_exp_f32 v35, v35
    v_pk_add_f32 v[28:29], v[28:29], v[244:245]
    v_pk_add_f32 v[30:31], v[30:31], v[244:245]
    v_pk_add_f32 v[32:33], v[32:33], v[244:245]
    v_pk_add_f32 v[34:35], v[34:35], v[244:245]
    v_rcp_f32 v28, v28
    v_rcp_f32 v29, v29
    v_rcp_f32 v30, v30
    v_rcp_f32 v31, v31
    v_rcp_f32 v32, v32
    v_rcp_f32 v33, v33
    v_rcp_f32 v34, v34
    v_rcp_f32 v35, v35
    v_pk_mul_f32 v[120:121], v[28:29], v[120:121]
    v_pk_mul_f32 v[122:123], v[30:31], v[122:123]
    v_pk_mul_f32 v[124:125], v[32:33], v[124:125]
    v_pk_mul_f32 v[126:127], v[34:35], v[126:127]
    v_cvt_pk_bf16_f32 v36, v120, v121
    v_cvt_pk_bf16_f32 v37, v122, v123
    v_cvt_pk_bf16_f32 v38, v124, v125
    v_cvt_pk_bf16_f32 v39, v126, v127
    buffer_store_dwordx4 v[36:39], v251, s[4:7], s53 offen offset:1024 sc1
    s_branch main_kernel_w_done
main_kernel_w_c0_efin:
    s_mov_b32 s53, s21
    s_add_u32 s32, s21, 0
    buffer_load_dwordx4 v[160:163], v252, s[96:99], s32 offen offset:0
    buffer_load_dwordx4 v[164:167], v252, s[96:99], s32 offen offset:64
    s_add_u32 s32, s21, 32768
    buffer_load_dwordx4 v[168:171], v252, s[96:99], s32 offen offset:0
    buffer_load_dwordx4 v[172:175], v252, s[96:99], s32 offen offset:64
    s_add_u32 s32, s21, 65536
    buffer_load_dwordx4 v[176:179], v252, s[96:99], s32 offen offset:0
    buffer_load_dwordx4 v[180:183], v252, s[96:99], s32 offen offset:64
    s_add_u32 s32, s21, 98304
    buffer_load_dwordx4 v[184:187], v252, s[96:99], s32 offen offset:0
    buffer_load_dwordx4 v[188:191], v252, s[96:99], s32 offen offset:64
    s_waitcnt vmcnt(7)
    v_permlane16_swap_b32 v160, v162
    v_permlane16_swap_b32 v161, v163
    v_lshlrev_b32 v8, 16, v192
    v_and_b32 v9, 0xffff0000, v192
    v_lshlrev_b32 v10, 16, v193
    v_and_b32 v11, 0xffff0000, v193
    v_lshlrev_b32 v12, 16, v194
    v_and_b32 v13, 0xffff0000, v194
    v_lshlrev_b32 v14, 16, v195
    v_and_b32 v15, 0xffff0000, v195
    v_permlane32_swap_b32 v160, v162
    v_permlane32_swap_b32 v161, v163
    v_lshlrev_b32 v16, 16, v160
    v_and_b32 v17, 0xffff0000, v160
    v_lshlrev_b32 v18, 16, v161
    v_and_b32 v19, 0xffff0000, v161
    v_lshlrev_b32 v20, 16, v162
    v_and_b32 v21, 0xffff0000, v162
    v_lshlrev_b32 v22, 16, v163
    v_and_b32 v23, 0xffff0000, v163
    v_pk_fma_f32 v[8:9], v[64:65], v[8:9], v[16:17]
    v_pk_fma_f32 v[10:11], v[66:67], v[10:11], v[18:19]
    v_pk_fma_f32 v[12:13], v[68:69], v[12:13], v[20:21]
    v_pk_fma_f32 v[14:15], v[70:71], v[14:15], v[22:23]
    v_cvt_pk_bf16_f32 v24, v8, v9
    v_cvt_pk_bf16_f32 v25, v10, v11
    v_cvt_pk_bf16_f32 v26, v12, v13
    v_cvt_pk_bf16_f32 v27, v14, v15
    s_nop 0
    v_permlane32_swap_b32 v24, v26
    v_permlane32_swap_b32 v25, v27
    s_nop 0
    v_permlane16_swap_b32 v24, v26
    v_permlane16_swap_b32 v25, v27
    buffer_store_dwordx4 v[24:27], v252, s[92:95], s53 offen offset:0 sc1
    s_waitcnt vmcnt(7)
    v_permlane16_swap_b32 v164, v166
    v_permlane16_swap_b32 v165, v167
    v_lshlrev_b32 v36, 16, v196
    v_and_b32 v37, 0xffff0000, v196
    v_lshlrev_b32 v38, 16, v197
    v_and_b32 v39, 0xffff0000, v197
    v_lshlrev_b32 v40, 16, v198
    v_and_b32 v41, 0xffff0000, v198
    v_lshlrev_b32 v42, 16, v199
    v_and_b32 v43, 0xffff0000, v199
    v_permlane32_swap_b32 v164, v166
    v_permlane32_swap_b32 v165, v167
    v_lshlrev_b32 v44, 16, v164
    v_and_b32 v45, 0xffff0000, v164
    v_lshlrev_b32 v46, 16, v165
    v_and_b32 v47, 0xffff0000, v165
    v_lshlrev_b32 v48, 16, v166
    v_and_b32 v49, 0xffff0000, v166
    v_lshlrev_b32 v50, 16, v167
    v_and_b32 v51, 0xffff0000, v167
    v_pk_fma_f32 v[36:37], v[72:73], v[36:37], v[44:45]
    v_pk_fma_f32 v[38:39], v[74:75], v[38:39], v[46:47]
    v_pk_fma_f32 v[40:41], v[76:77], v[40:41], v[48:49]
    v_pk_fma_f32 v[42:43], v[78:79], v[42:43], v[50:51]
    v_cvt_pk_bf16_f32 v52, v36, v37
    v_cvt_pk_bf16_f32 v53, v38, v39
    v_cvt_pk_bf16_f32 v54, v40, v41
    v_cvt_pk_bf16_f32 v55, v42, v43
    s_nop 0
    v_permlane32_swap_b32 v52, v54
    v_permlane32_swap_b32 v53, v55
    s_nop 0
    v_permlane16_swap_b32 v52, v54
    v_permlane16_swap_b32 v53, v55
    buffer_store_dwordx4 v[52:55], v252, s[92:95], s53 offen offset:64 sc1
    s_add_u32 s53, s53, 32768
    s_waitcnt vmcnt(7)
    v_permlane16_swap_b32 v168, v170
    v_permlane16_swap_b32 v169, v171
    v_lshlrev_b32 v8, 16, v200
    v_and_b32 v9, 0xffff0000, v200
    v_lshlrev_b32 v10, 16, v201
    v_and_b32 v11, 0xffff0000, v201
    v_lshlrev_b32 v12, 16, v202
    v_and_b32 v13, 0xffff0000, v202
    v_lshlrev_b32 v14, 16, v203
    v_and_b32 v15, 0xffff0000, v203
    v_permlane32_swap_b32 v168, v170
    v_permlane32_swap_b32 v169, v171
    v_lshlrev_b32 v16, 16, v168
    v_and_b32 v17, 0xffff0000, v168
    v_lshlrev_b32 v18, 16, v169
    v_and_b32 v19, 0xffff0000, v169
    v_lshlrev_b32 v20, 16, v170
    v_and_b32 v21, 0xffff0000, v170
    v_lshlrev_b32 v22, 16, v171
    v_and_b32 v23, 0xffff0000, v171
    v_pk_fma_f32 v[8:9], v[80:81], v[8:9], v[16:17]
    v_pk_fma_f32 v[10:11], v[82:83], v[10:11], v[18:19]
    v_pk_fma_f32 v[12:13], v[84:85], v[12:13], v[20:21]
    v_pk_fma_f32 v[14:15], v[86:87], v[14:15], v[22:23]
    v_cvt_pk_bf16_f32 v24, v8, v9
    v_cvt_pk_bf16_f32 v25, v10, v11
    v_cvt_pk_bf16_f32 v26, v12, v13
    v_cvt_pk_bf16_f32 v27, v14, v15
    s_nop 0
    v_permlane32_swap_b32 v24, v26
    v_permlane32_swap_b32 v25, v27
    s_nop 0
    v_permlane16_swap_b32 v24, v26
    v_permlane16_swap_b32 v25, v27
    buffer_store_dwordx4 v[24:27], v252, s[92:95], s53 offen offset:0 sc1
    s_waitcnt vmcnt(7)
    v_permlane16_swap_b32 v172, v174
    v_permlane16_swap_b32 v173, v175
    v_lshlrev_b32 v36, 16, v204
    v_and_b32 v37, 0xffff0000, v204
    v_lshlrev_b32 v38, 16, v205
    v_and_b32 v39, 0xffff0000, v205
    v_lshlrev_b32 v40, 16, v206
    v_and_b32 v41, 0xffff0000, v206
    v_lshlrev_b32 v42, 16, v207
    v_and_b32 v43, 0xffff0000, v207
    v_permlane32_swap_b32 v172, v174
    v_permlane32_swap_b32 v173, v175
    v_lshlrev_b32 v44, 16, v172
    v_and_b32 v45, 0xffff0000, v172
    v_lshlrev_b32 v46, 16, v173
    v_and_b32 v47, 0xffff0000, v173
    v_lshlrev_b32 v48, 16, v174
    v_and_b32 v49, 0xffff0000, v174
    v_lshlrev_b32 v50, 16, v175
    v_and_b32 v51, 0xffff0000, v175
    v_pk_fma_f32 v[36:37], v[88:89], v[36:37], v[44:45]
    v_pk_fma_f32 v[38:39], v[90:91], v[38:39], v[46:47]
    v_pk_fma_f32 v[40:41], v[92:93], v[40:41], v[48:49]
    v_pk_fma_f32 v[42:43], v[94:95], v[42:43], v[50:51]
    v_cvt_pk_bf16_f32 v52, v36, v37
    v_cvt_pk_bf16_f32 v53, v38, v39
    v_cvt_pk_bf16_f32 v54, v40, v41
    v_cvt_pk_bf16_f32 v55, v42, v43
    s_nop 0
    v_permlane32_swap_b32 v52, v54
    v_permlane32_swap_b32 v53, v55
    s_nop 0
    v_permlane16_swap_b32 v52, v54
    v_permlane16_swap_b32 v53, v55
    buffer_store_dwordx4 v[52:55], v252, s[92:95], s53 offen offset:64 sc1
    s_add_u32 s53, s53, 32768
    s_waitcnt vmcnt(7)
    v_permlane16_swap_b32 v176, v178
    v_permlane16_swap_b32 v177, v179
    v_lshlrev_b32 v8, 16, v208
    v_and_b32 v9, 0xffff0000, v208
    v_lshlrev_b32 v10, 16, v209
    v_and_b32 v11, 0xffff0000, v209
    v_lshlrev_b32 v12, 16, v210
    v_and_b32 v13, 0xffff0000, v210
    v_lshlrev_b32 v14, 16, v211
    v_and_b32 v15, 0xffff0000, v211
    v_permlane32_swap_b32 v176, v178
    v_permlane32_swap_b32 v177, v179
    v_lshlrev_b32 v16, 16, v176
    v_and_b32 v17, 0xffff0000, v176
    v_lshlrev_b32 v18, 16, v177
    v_and_b32 v19, 0xffff0000, v177
    v_lshlrev_b32 v20, 16, v178
    v_and_b32 v21, 0xffff0000, v178
    v_lshlrev_b32 v22, 16, v179
    v_and_b32 v23, 0xffff0000, v179
    v_pk_fma_f32 v[8:9], v[96:97], v[8:9], v[16:17]
    v_pk_fma_f32 v[10:11], v[98:99], v[10:11], v[18:19]
    v_pk_fma_f32 v[12:13], v[100:101], v[12:13], v[20:21]
    v_pk_fma_f32 v[14:15], v[102:103], v[14:15], v[22:23]
    v_cvt_pk_bf16_f32 v24, v8, v9
    v_cvt_pk_bf16_f32 v25, v10, v11
    v_cvt_pk_bf16_f32 v26, v12, v13
    v_cvt_pk_bf16_f32 v27, v14, v15
    s_nop 0
    v_permlane32_swap_b32 v24, v26
    v_permlane32_swap_b32 v25, v27
    s_nop 0
    v_permlane16_swap_b32 v24, v26
    v_permlane16_swap_b32 v25, v27
    buffer_store_dwordx4 v[24:27], v252, s[92:95], s53 offen offset:0 sc1
    s_waitcnt vmcnt(7)
    v_permlane16_swap_b32 v180, v182
    v_permlane16_swap_b32 v181, v183
    v_lshlrev_b32 v36, 16, v212
    v_and_b32 v37, 0xffff0000, v212
    v_lshlrev_b32 v38, 16, v213
    v_and_b32 v39, 0xffff0000, v213
    v_lshlrev_b32 v40, 16, v214
    v_and_b32 v41, 0xffff0000, v214
    v_lshlrev_b32 v42, 16, v215
    v_and_b32 v43, 0xffff0000, v215
    v_permlane32_swap_b32 v180, v182
    v_permlane32_swap_b32 v181, v183
    v_lshlrev_b32 v44, 16, v180
    v_and_b32 v45, 0xffff0000, v180
    v_lshlrev_b32 v46, 16, v181
    v_and_b32 v47, 0xffff0000, v181
    v_lshlrev_b32 v48, 16, v182
    v_and_b32 v49, 0xffff0000, v182
    v_lshlrev_b32 v50, 16, v183
    v_and_b32 v51, 0xffff0000, v183
    v_pk_fma_f32 v[36:37], v[104:105], v[36:37], v[44:45]
    v_pk_fma_f32 v[38:39], v[106:107], v[38:39], v[46:47]
    v_pk_fma_f32 v[40:41], v[108:109], v[40:41], v[48:49]
    v_pk_fma_f32 v[42:43], v[110:111], v[42:43], v[50:51]
    v_cvt_pk_bf16_f32 v52, v36, v37
    v_cvt_pk_bf16_f32 v53, v38, v39
    v_cvt_pk_bf16_f32 v54, v40, v41
    v_cvt_pk_bf16_f32 v55, v42, v43
    s_nop 0
    v_permlane32_swap_b32 v52, v54
    v_permlane32_swap_b32 v53, v55
    s_nop 0
    v_permlane16_swap_b32 v52, v54
    v_permlane16_swap_b32 v53, v55
    buffer_store_dwordx4 v[52:55], v252, s[92:95], s53 offen offset:64 sc1
    s_add_u32 s53, s53, 32768
    s_waitcnt vmcnt(7)
    v_permlane16_swap_b32 v184, v186
    v_permlane16_swap_b32 v185, v187
    v_lshlrev_b32 v8, 16, v216
    v_and_b32 v9, 0xffff0000, v216
    v_lshlrev_b32 v10, 16, v217
    v_and_b32 v11, 0xffff0000, v217
    v_lshlrev_b32 v12, 16, v218
    v_and_b32 v13, 0xffff0000, v218
    v_lshlrev_b32 v14, 16, v219
    v_and_b32 v15, 0xffff0000, v219
    v_permlane32_swap_b32 v184, v186
    v_permlane32_swap_b32 v185, v187
    v_lshlrev_b32 v16, 16, v184
    v_and_b32 v17, 0xffff0000, v184
    v_lshlrev_b32 v18, 16, v185
    v_and_b32 v19, 0xffff0000, v185
    v_lshlrev_b32 v20, 16, v186
    v_and_b32 v21, 0xffff0000, v186
    v_lshlrev_b32 v22, 16, v187
    v_and_b32 v23, 0xffff0000, v187
    v_pk_fma_f32 v[8:9], v[112:113], v[8:9], v[16:17]
    v_pk_fma_f32 v[10:11], v[114:115], v[10:11], v[18:19]
    v_pk_fma_f32 v[12:13], v[116:117], v[12:13], v[20:21]
    v_pk_fma_f32 v[14:15], v[118:119], v[14:15], v[22:23]
    v_cvt_pk_bf16_f32 v24, v8, v9
    v_cvt_pk_bf16_f32 v25, v10, v11
    v_cvt_pk_bf16_f32 v26, v12, v13
    v_cvt_pk_bf16_f32 v27, v14, v15
    s_nop 0
    v_permlane32_swap_b32 v24, v26
    v_permlane32_swap_b32 v25, v27
    s_nop 0
    v_permlane16_swap_b32 v24, v26
    v_permlane16_swap_b32 v25, v27
    buffer_store_dwordx4 v[24:27], v252, s[92:95], s53 offen offset:0 sc1
    s_waitcnt vmcnt(7)
    v_permlane16_swap_b32 v188, v190
    v_permlane16_swap_b32 v189, v191
    v_lshlrev_b32 v36, 16, v220
    v_and_b32 v37, 0xffff0000, v220
    v_lshlrev_b32 v38, 16, v221
    v_and_b32 v39, 0xffff0000, v221
    v_lshlrev_b32 v40, 16, v222
    v_and_b32 v41, 0xffff0000, v222
    v_lshlrev_b32 v42, 16, v223
    v_and_b32 v43, 0xffff0000, v223
    v_permlane32_swap_b32 v188, v190
    v_permlane32_swap_b32 v189, v191
    v_lshlrev_b32 v44, 16, v188
    v_and_b32 v45, 0xffff0000, v188
    v_lshlrev_b32 v46, 16, v189
    v_and_b32 v47, 0xffff0000, v189
    v_lshlrev_b32 v48, 16, v190
    v_and_b32 v49, 0xffff0000, v190
    v_lshlrev_b32 v50, 16, v191
    v_and_b32 v51, 0xffff0000, v191
    v_pk_fma_f32 v[36:37], v[120:121], v[36:37], v[44:45]
    v_pk_fma_f32 v[38:39], v[122:123], v[38:39], v[46:47]
    v_pk_fma_f32 v[40:41], v[124:125], v[40:41], v[48:49]
    v_pk_fma_f32 v[42:43], v[126:127], v[42:43], v[50:51]
    v_cvt_pk_bf16_f32 v52, v36, v37
    v_cvt_pk_bf16_f32 v53, v38, v39
    v_cvt_pk_bf16_f32 v54, v40, v41
    v_cvt_pk_bf16_f32 v55, v42, v43
    s_nop 0
    v_permlane32_swap_b32 v52, v54
    v_permlane32_swap_b32 v53, v55
    s_nop 0
    v_permlane16_swap_b32 v52, v54
    v_permlane16_swap_b32 v53, v55
    buffer_store_dwordx4 v[52:55], v252, s[92:95], s53 offen offset:64 sc1
    s_branch main_kernel_w_done
main_kernel_w_c0_gov:
    v_lshrrev_b32 v0, 4, v250
    v_bfe_u32 v1, v250, 2, 2
    v_lshl_add_u32 v4, v0, 2, v1
    v_and_b32 v5, 7, v4
    v_mul_u32_u24 v4, 256, v4
    v_and_b32 v6, 3, v250
    v_lshl_add_u32 v4, v6, 3, v4
    s_mul_i32 s32, s37, 4
    v_xor_b32 v5, s32, v5
    v_lshl_add_u32 v128, v5, 5, v4
    v_xor_b32 v129, 32, v128
    v_xor_b32 v130, 64, v128
    v_xor_b32 v131, 96, v128
    s_mul_i32 s32, s38, 8192
    s_add_u32 s32, s32, 65536
    v_add_u32 v136, s32, v251
    v_lshrrev_b32 v2, 4, v250
    v_and_b32 v3, 15, v250
    s_mul_i32 s32, s14, 16
    v_add_u32 v4, s32, v2
    v_add_u32 v5, 0, v4
    v_and_b32 v6, 7, v5
    v_lshlrev_b32 v6, 1, v6
    v_xor_b32 v6, v6, v3
    v_mul_lo_u32 v5, v5, s30
    v_lshl_add_u32 v5, v6, 4, v5
    v_subrev_u32 v137, 0, v5
    v_add_u32 v5, 4, v4
    v_and_b32 v6, 7, v5
    v_lshlrev_b32 v6, 1, v6
    v_xor_b32 v6, v6, v3
    v_mul_lo_u32 v5, v5, s30
    v_lshl_add_u32 v5, v6, 4, v5
    v_subrev_u32 v138, 1024, v5
    v_add_u32 v5, 8, v4
    v_and_b32 v6, 7, v5
    v_lshlrev_b32 v6, 1, v6
    v_xor_b32 v6, v6, v3
    v_mul_lo_u32 v5, v5, s30
    v_lshl_add_u32 v5, v6, 4, v5
    v_subrev_u32 v139, 2048, v5
    v_add_u32 v5, 12, v4
    v_and_b32 v6, 7, v5
    v_lshlrev_b32 v6, 1, v6
    v_xor_b32 v6, v6, v3
    v_mul_lo_u32 v5, v5, s30
    v_lshl_add_u32 v5, v6, 4, v5
    v_subrev_u32 v140, 3072, v5
    s_mul_i32 s32, s14, 2
    s_mul_i32 s32, s32, s31
    v_add_u32 v141, s32, v251
    s_add_u32 s32, s32, s31
    s_sub_u32 s32, s32, 2048
    v_add_u32 v142, s32, v251
    s_mul_i32 s19, s14, 4096
    s_mul_i32 s20, s14, 4096
    s_add_u32 s20, s20, 65536
    s_mul_i32 s17, s30, 64
    s_mov_b32 s15, 0
    s_add_u32 m0, s20, 0
    s_nop 0
    buffer_load_dwordx4 v141, s[4:7], s16 offen offset:0 sc1 lds
    buffer_load_dwordx4 v141, s[4:7], s16 offen offset:1024 sc1 lds
    buffer_load_dwordx4 v142, s[4:7], s16 offen offset:2048 sc1 lds
    buffer_load_dwordx4 v142, s[4:7], s16 offen offset:3072 sc1 lds
    s_add_u32 s16, s16, 2048
    s_add_u32 m0, s19, 0
    s_nop 0
    buffer_load_dwordx4 v137, s[8:11], s15 offen offset:0 lds
    buffer_load_dwordx4 v138, s[8:11], s15 offen offset:1024 lds
    buffer_load_dwordx4 v139, s[8:11], s15 offen offset:2048 lds
    buffer_load_dwordx4 v140, s[8:11], s15 offen offset:3072 lds
    s_add_u32 s15, s15, s17
    s_add_u32 m0, s20, 16384
    s_nop 0
    buffer_load_dwordx4 v141, s[4:7], s16 offen offset:0 sc1 lds
    buffer_load_dwordx4 v141, s[4:7], s16 offen offset:1024 sc1 lds
    buffer_load_dwordx4 v142, s[4:7], s16 offen offset:2048 sc1 lds
    buffer_load_dwordx4 v142, s[4:7], s16 offen offset:3072 sc1 lds
    s_add_u32 s16, s16, 2048
    s_add_u32 m0, s19, 16384
    s_nop 0
    buffer_load_dwordx4 v137, s[8:11], s15 offen offset:0 lds
    buffer_load_dwordx4 v138, s[8:11], s15 offen offset:1024 lds
    buffer_load_dwordx4 v139, s[8:11], s15 offen offset:2048 lds
    buffer_load_dwordx4 v140, s[8:11], s15 offen offset:3072 lds
    s_add_u32 s15, s15, s17
    s_add_u32 m0, s20, 32768
    s_nop 0
    buffer_load_dwordx4 v141, s[4:7], s16 offen offset:0 sc1 lds
    buffer_load_dwordx4 v141, s[4:7], s16 offen offset:1024 sc1 lds
    buffer_load_dwordx4 v142, s[4:7], s16 offen offset:2048 sc1 lds
    buffer_load_dwordx4 v142, s[4:7], s16 offen offset:3072 sc1 lds
    s_add_u32 s16, s16, 2048
    s_add_u32 m0, s19, 32768
    s_nop 0
    buffer_load_dwordx4 v137, s[8:11], s15 offen offset:0 lds
    buffer_load_dwordx4 v138, s[8:11], s15 offen offset:1024 lds
    buffer_load_dwordx4 v139, s[8:11], s15 offen offset:2048 lds
    buffer_load_dwordx4 v140, s[8:11], s15 offen offset:3072 lds
    s_add_u32 s15, s15, s17
    s_add_u32 m0, s20, 49152
    s_nop 0
    buffer_load_dwordx4 v141, s[4:7], s16 offen offset:0 sc1 lds
    buffer_load_dwordx4 v141, s[4:7], s16 offen offset:1024 sc1 lds
    buffer_load_dwordx4 v142, s[4:7], s16 offen offset:2048 sc1 lds
    buffer_load_dwordx4 v142, s[4:7], s16 offen offset:3072 sc1 lds
    s_add_u32 s16, s16, 2048
    v_mov_b32 v64, 0
    v_mov_b32 v65, 0
    v_mov_b32 v66, 0
    v_mov_b32 v67, 0
    v_mov_b32 v68, 0
    v_mov_b32 v69, 0
    v_mov_b32 v70, 0
    v_mov_b32 v71, 0
    v_mov_b32 v72, 0
    v_mov_b32 v73, 0
    v_mov_b32 v74, 0
    v_mov_b32 v75, 0
    v_mov_b32 v76, 0
    v_mov_b32 v77, 0
    v_mov_b32 v78, 0
    v_mov_b32 v79, 0
    v_mov_b32 v80, 0
    v_mov_b32 v81, 0
    v_mov_b32 v82, 0
    v_mov_b32 v83, 0
    v_mov_b32 v84, 0
    v_mov_b32 v85, 0
    v_mov_b32 v86, 0
    v_mov_b32 v87, 0
    v_mov_b32 v88, 0
    v_mov_b32 v89, 0
    v_mov_b32 v90, 0
    v_mov_b32 v91, 0
    v_mov_b32 v92, 0
    v_mov_b32 v93, 0
    v_mov_b32 v94, 0
    v_mov_b32 v95, 0
    v_mov_b32 v96, 0
    v_mov_b32 v97, 0
    v_mov_b32 v98, 0
    v_mov_b32 v99, 0
    v_mov_b32 v100, 0
    v_mov_b32 v101, 0
    v_mov_b32 v102, 0
    v_mov_b32 v103, 0
    v_mov_b32 v104, 0
    v_mov_b32 v105, 0
    v_mov_b32 v106, 0
    v_mov_b32 v107, 0
    v_mov_b32 v108, 0
    v_mov_b32 v109, 0
    v_mov_b32 v110, 0
    v_mov_b32 v111, 0
    v_mov_b32 v112, 0
    v_mov_b32 v113, 0
    v_mov_b32 v114, 0
    v_mov_b32 v115, 0
    v_mov_b32 v116, 0
    v_mov_b32 v117, 0
    v_mov_b32 v118, 0
    v_mov_b32 v119, 0
    v_mov_b32 v120, 0
    v_mov_b32 v121, 0
    v_mov_b32 v122, 0
    v_mov_b32 v123, 0
    v_mov_b32 v124, 0
    v_mov_b32 v125, 0
    v_mov_b32 v126, 0
    v_mov_b32 v127, 0
    s_waitcnt vmcnt(20)
    s_barrier
    ds_read_b128 v[16:19], v136 offset:0
    ds_read_b64_tr_b16 v[0:1], v128 offset:0
    ds_read_b64_tr_b16 v[2:3], v128 offset:4096
    ds_read_b64_tr_b16 v[4:5], v129 offset:0
    ds_read_b64_tr_b16 v[6:7], v129 offset:4096
    ds_read_b64_tr_b16 v[8:9], v130 offset:0
    ds_read_b64_tr_b16 v[10:11], v130 offset:4096
    ds_read_b64_tr_b16 v[12:13], v131 offset:0
    ds_read_b64_tr_b16 v[14:15], v131 offset:4096
    ds_read_b128 v[20:23], v136 offset:2048
    ds_read_b128 v[24:27], v136 offset:4096
    ds_read_b128 v[28:31], v136 offset:6144
main_kernel_w_c0_v_loop:
    s_waitcnt lgkmcnt(0)
    ds_read_b128 v[48:51], v136 offset:1024
    s_add_u32 m0, s19, 49152
    s_nop 0
    v_mfma_f32_16x16x32_bf16 v[64:67], v[16:19], v[0:3], v[64:67]
    ds_read_b64_tr_b16 v[32:33], v128 offset:8192
    v_mfma_f32_16x16x32_bf16 v[68:71], v[16:19], v[4:7], v[68:71]
    ds_read_b64_tr_b16 v[34:35], v128 offset:12288
    buffer_load_dwordx4 v137, s[8:11], s15 offen offset:0 lds
    v_mfma_f32_16x16x32_bf16 v[72:75], v[16:19], v[8:11], v[72:75]
    ds_read_b64_tr_b16 v[36:37], v129 offset:8192
    v_mfma_f32_16x16x32_bf16 v[76:79], v[16:19], v[12:15], v[76:79]
    ds_read_b64_tr_b16 v[38:39], v129 offset:12288
    v_mfma_f32_16x16x32_bf16 v[80:83], v[20:23], v[0:3], v[80:83]
    ds_read_b64_tr_b16 v[40:41], v130 offset:8192
    buffer_load_dwordx4 v138, s[8:11], s15 offen offset:1024 lds
    v_mfma_f32_16x16x32_bf16 v[84:87], v[20:23], v[4:7], v[84:87]
    ds_read_b64_tr_b16 v[42:43], v130 offset:12288
    v_mfma_f32_16x16x32_bf16 v[88:91], v[20:23], v[8:11], v[88:91]
    ds_read_b64_tr_b16 v[44:45], v131 offset:8192
    v_mfma_f32_16x16x32_bf16 v[92:95], v[20:23], v[12:15], v[92:95]
    ds_read_b64_tr_b16 v[46:47], v131 offset:12288
    buffer_load_dwordx4 v139, s[8:11], s15 offen offset:2048 lds
    v_mfma_f32_16x16x32_bf16 v[96:99], v[24:27], v[0:3], v[96:99]
    ds_read_b128 v[52:55], v136 offset:3072
    v_mfma_f32_16x16x32_bf16 v[100:103], v[24:27], v[4:7], v[100:103]
    ds_read_b128 v[56:59], v136 offset:5120
    buffer_load_dwordx4 v140, s[8:11], s15 offen offset:3072 lds
    v_mfma_f32_16x16x32_bf16 v[104:107], v[24:27], v[8:11], v[104:107]
    ds_read_b128 v[60:63], v136 offset:7168
    v_mfma_f32_16x16x32_bf16 v[108:111], v[24:27], v[12:15], v[108:111]
    v_mfma_f32_16x16x32_bf16 v[112:115], v[28:31], v[0:3], v[112:115]
    s_add_u32 s15, s15, s17
    v_mfma_f32_16x16x32_bf16 v[116:119], v[28:31], v[4:7], v[116:119]
    v_mfma_f32_16x16x32_bf16 v[120:123], v[28:31], v[8:11], v[120:123]
    v_mfma_f32_16x16x32_bf16 v[124:127], v[28:31], v[12:15], v[124:127]
    s_waitcnt lgkmcnt(0)
    v_mfma_f32_16x16x32_bf16 v[64:67], v[48:51], v[32:35], v[64:67]
    s_waitcnt vmcnt(16)
    s_barrier
    ds_read_b128 v[16:19], v136 offset:16384
    s_add_u32 m0, s20, 0
    s_nop 0
    v_mfma_f32_16x16x32_bf16 v[68:71], v[48:51], v[36:39], v[68:71]
    ds_read_b64_tr_b16 v[0:1], v128 offset:16384
    v_mfma_f32_16x16x32_bf16 v[72:75], v[48:51], v[40:43], v[72:75]
    ds_read_b64_tr_b16 v[2:3], v128 offset:20480
    buffer_load_dwordx4 v141, s[4:7], s16 offen offset:0 sc1 lds
    v_mfma_f32_16x16x32_bf16 v[76:79], v[48:51], v[44:47], v[76:79]
    ds_read_b64_tr_b16 v[4:5], v129 offset:16384
    v_mfma_f32_16x16x32_bf16 v[80:83], v[52:55], v[32:35], v[80:83]
    ds_read_b64_tr_b16 v[6:7], v129 offset:20480
    v_mfma_f32_16x16x32_bf16 v[84:87], v[52:55], v[36:39], v[84:87]
    ds_read_b64_tr_b16 v[8:9], v130 offset:16384
    buffer_load_dwordx4 v141, s[4:7], s16 offen offset:1024 sc1 lds
    v_mfma_f32_16x16x32_bf16 v[88:91], v[52:55], v[40:43], v[88:91]
    ds_read_b64_tr_b16 v[10:11], v130 offset:20480
    v_mfma_f32_16x16x32_bf16 v[92:95], v[52:55], v[44:47], v[92:95]
    ds_read_b64_tr_b16 v[12:13], v131 offset:16384
    buffer_load_dwordx4 v142, s[4:7], s16 offen offset:2048 sc1 lds
    v_mfma_f32_16x16x32_bf16 v[96:99], v[56:59], v[32:35], v[96:99]
    ds_read_b64_tr_b16 v[14:15], v131 offset:20480
    v_mfma_f32_16x16x32_bf16 v[100:103], v[56:59], v[36:39], v[100:103]
    ds_read_b128 v[20:23], v136 offset:18432
    v_mfma_f32_16x16x32_bf16 v[104:107], v[56:59], v[40:43], v[104:107]
    ds_read_b128 v[24:27], v136 offset:20480
    buffer_load_dwordx4 v142, s[4:7], s16 offen offset:3072 sc1 lds
    v_mfma_f32_16x16x32_bf16 v[108:111], v[56:59], v[44:47], v[108:111]
    ds_read_b128 v[28:31], v136 offset:22528
    v_mfma_f32_16x16x32_bf16 v[112:115], v[60:63], v[32:35], v[112:115]
    s_add_u32 s16, s16, 2048
    v_mfma_f32_16x16x32_bf16 v[116:119], v[60:63], v[36:39], v[116:119]
    v_mfma_f32_16x16x32_bf16 v[120:123], v[60:63], v[40:43], v[120:123]
    v_mfma_f32_16x16x32_bf16 v[124:127], v[60:63], v[44:47], v[124:127]
    s_waitcnt lgkmcnt(0)
    ds_read_b128 v[48:51], v136 offset:17408
    s_add_u32 m0, s19, 0
    s_nop 0
    v_mfma_f32_16x16x32_bf16 v[64:67], v[16:19], v[0:3], v[64:67]
    ds_read_b64_tr_b16 v[32:33], v128 offset:24576
    v_mfma_f32_16x16x32_bf16 v[68:71], v[16:19], v[4:7], v[68:71]
    ds_read_b64_tr_b16 v[34:35], v128 offset:28672
    buffer_load_dwordx4 v137, s[8:11], s15 offen offset:0 lds
    v_mfma_f32_16x16x32_bf16 v[72:75], v[16:19], v[8:11], v[72:75]
    ds_read_b64_tr_b16 v[36:37], v129 offset:24576
    v_mfma_f32_16x16x32_bf16 v[76:79], v[16:19], v[12:15], v[76:79]
    ds_read_b64_tr_b16 v[38:39], v129 offset:28672
    v_mfma_f32_16x16x32_bf16 v[80:83], v[20:23], v[0:3], v[80:83]
    ds_read_b64_tr_b16 v[40:41], v130 offset:24576
    buffer_load_dwordx4 v138, s[8:11], s15 offen offset:1024 lds
    v_mfma_f32_16x16x32_bf16 v[84:87], v[20:23], v[4:7], v[84:87]
    ds_read_b64_tr_b16 v[42:43], v130 offset:28672
    v_mfma_f32_16x16x32_bf16 v[88:91], v[20:23], v[8:11], v[88:91]
    ds_read_b64_tr_b16 v[44:45], v131 offset:24576
    v_mfma_f32_16x16x32_bf16 v[92:95], v[20:23], v[12:15], v[92:95]
    ds_read_b64_tr_b16 v[46:47], v131 offset:28672
    buffer_load_dwordx4 v139, s[8:11], s15 offen offset:2048 lds
    v_mfma_f32_16x16x32_bf16 v[96:99], v[24:27], v[0:3], v[96:99]
    ds_read_b128 v[52:55], v136 offset:19456
    v_mfma_f32_16x16x32_bf16 v[100:103], v[24:27], v[4:7], v[100:103]
    ds_read_b128 v[56:59], v136 offset:21504
    buffer_load_dwordx4 v140, s[8:11], s15 offen offset:3072 lds
    v_mfma_f32_16x16x32_bf16 v[104:107], v[24:27], v[8:11], v[104:107]
    ds_read_b128 v[60:63], v136 offset:23552
    v_mfma_f32_16x16x32_bf16 v[108:111], v[24:27], v[12:15], v[108:111]
    v_mfma_f32_16x16x32_bf16 v[112:115], v[28:31], v[0:3], v[112:115]
    s_add_u32 s15, s15, s17
    v_mfma_f32_16x16x32_bf16 v[116:119], v[28:31], v[4:7], v[116:119]
    v_mfma_f32_16x16x32_bf16 v[120:123], v[28:31], v[8:11], v[120:123]
    v_mfma_f32_16x16x32_bf16 v[124:127], v[28:31], v[12:15], v[124:127]
    s_waitcnt lgkmcnt(0)
    v_mfma_f32_16x16x32_bf16 v[64:67], v[48:51], v[32:35], v[64:67]
    s_waitcnt vmcnt(16)
    s_barrier
    ds_read_b128 v[16:19], v136 offset:32768
    s_add_u32 m0, s20, 16384
    s_nop 0
    v_mfma_f32_16x16x32_bf16 v[68:71], v[48:51], v[36:39], v[68:71]
    ds_read_b64_tr_b16 v[0:1], v128 offset:32768
    v_mfma_f32_16x16x32_bf16 v[72:75], v[48:51], v[40:43], v[72:75]
    ds_read_b64_tr_b16 v[2:3], v128 offset:36864
    buffer_load_dwordx4 v141, s[4:7], s16 offen offset:0 sc1 lds
    v_mfma_f32_16x16x32_bf16 v[76:79], v[48:51], v[44:47], v[76:79]
    ds_read_b64_tr_b16 v[4:5], v129 offset:32768
    v_mfma_f32_16x16x32_bf16 v[80:83], v[52:55], v[32:35], v[80:83]
    ds_read_b64_tr_b16 v[6:7], v129 offset:36864
    v_mfma_f32_16x16x32_bf16 v[84:87], v[52:55], v[36:39], v[84:87]
    ds_read_b64_tr_b16 v[8:9], v130 offset:32768
    buffer_load_dwordx4 v141, s[4:7], s16 offen offset:1024 sc1 lds
    v_mfma_f32_16x16x32_bf16 v[88:91], v[52:55], v[40:43], v[88:91]
    ds_read_b64_tr_b16 v[10:11], v130 offset:36864
    v_mfma_f32_16x16x32_bf16 v[92:95], v[52:55], v[44:47], v[92:95]
    ds_read_b64_tr_b16 v[12:13], v131 offset:32768
    buffer_load_dwordx4 v142, s[4:7], s16 offen offset:2048 sc1 lds
    v_mfma_f32_16x16x32_bf16 v[96:99], v[56:59], v[32:35], v[96:99]
    ds_read_b64_tr_b16 v[14:15], v131 offset:36864
    v_mfma_f32_16x16x32_bf16 v[100:103], v[56:59], v[36:39], v[100:103]
    ds_read_b128 v[20:23], v136 offset:34816
    v_mfma_f32_16x16x32_bf16 v[104:107], v[56:59], v[40:43], v[104:107]
    ds_read_b128 v[24:27], v136 offset:36864
    buffer_load_dwordx4 v142, s[4:7], s16 offen offset:3072 sc1 lds
    v_mfma_f32_16x16x32_bf16 v[108:111], v[56:59], v[44:47], v[108:111]
    ds_read_b128 v[28:31], v136 offset:38912
    v_mfma_f32_16x16x32_bf16 v[112:115], v[60:63], v[32:35], v[112:115]
    s_add_u32 s16, s16, 2048
    v_mfma_f32_16x16x32_bf16 v[116:119], v[60:63], v[36:39], v[116:119]
    v_mfma_f32_16x16x32_bf16 v[120:123], v[60:63], v[40:43], v[120:123]
    v_mfma_f32_16x16x32_bf16 v[124:127], v[60:63], v[44:47], v[124:127]
    s_waitcnt lgkmcnt(0)
    ds_read_b128 v[48:51], v136 offset:33792
    s_add_u32 m0, s19, 16384
    s_nop 0
    v_mfma_f32_16x16x32_bf16 v[64:67], v[16:19], v[0:3], v[64:67]
    ds_read_b64_tr_b16 v[32:33], v128 offset:40960
    v_mfma_f32_16x16x32_bf16 v[68:71], v[16:19], v[4:7], v[68:71]
    ds_read_b64_tr_b16 v[34:35], v128 offset:45056
    buffer_load_dwordx4 v137, s[8:11], s15 offen offset:0 lds
    v_mfma_f32_16x16x32_bf16 v[72:75], v[16:19], v[8:11], v[72:75]
    ds_read_b64_tr_b16 v[36:37], v129 offset:40960
    v_mfma_f32_16x16x32_bf16 v[76:79], v[16:19], v[12:15], v[76:79]
    ds_read_b64_tr_b16 v[38:39], v129 offset:45056
    v_mfma_f32_16x16x32_bf16 v[80:83], v[20:23], v[0:3], v[80:83]
    ds_read_b64_tr_b16 v[40:41], v130 offset:40960
    buffer_load_dwordx4 v138, s[8:11], s15 offen offset:1024 lds
    v_mfma_f32_16x16x32_bf16 v[84:87], v[20:23], v[4:7], v[84:87]
    ds_read_b64_tr_b16 v[42:43], v130 offset:45056
    v_mfma_f32_16x16x32_bf16 v[88:91], v[20:23], v[8:11], v[88:91]
    ds_read_b64_tr_b16 v[44:45], v131 offset:40960
    v_mfma_f32_16x16x32_bf16 v[92:95], v[20:23], v[12:15], v[92:95]
    ds_read_b64_tr_b16 v[46:47], v131 offset:45056
    buffer_load_dwordx4 v139, s[8:11], s15 offen offset:2048 lds
    v_mfma_f32_16x16x32_bf16 v[96:99], v[24:27], v[0:3], v[96:99]
    ds_read_b128 v[52:55], v136 offset:35840
    v_mfma_f32_16x16x32_bf16 v[100:103], v[24:27], v[4:7], v[100:103]
    ds_read_b128 v[56:59], v136 offset:37888
    buffer_load_dwordx4 v140, s[8:11], s15 offen offset:3072 lds
    v_mfma_f32_16x16x32_bf16 v[104:107], v[24:27], v[8:11], v[104:107]
    ds_read_b128 v[60:63], v136 offset:39936
    v_mfma_f32_16x16x32_bf16 v[108:111], v[24:27], v[12:15], v[108:111]
    v_mfma_f32_16x16x32_bf16 v[112:115], v[28:31], v[0:3], v[112:115]
    s_add_u32 s15, s15, s17
    v_mfma_f32_16x16x32_bf16 v[116:119], v[28:31], v[4:7], v[116:119]
    v_mfma_f32_16x16x32_bf16 v[120:123], v[28:31], v[8:11], v[120:123]
    v_mfma_f32_16x16x32_bf16 v[124:127], v[28:31], v[12:15], v[124:127]
    s_waitcnt lgkmcnt(0)
    v_mfma_f32_16x16x32_bf16 v[64:67], v[48:51], v[32:35], v[64:67]
    s_waitcnt vmcnt(16)
    s_barrier
    ds_read_b128 v[16:19], v136 offset:49152
    s_add_u32 m0, s20, 32768
    s_nop 0
    v_mfma_f32_16x16x32_bf16 v[68:71], v[48:51], v[36:39], v[68:71]
    ds_read_b64_tr_b16 v[0:1], v128 offset:49152
    v_mfma_f32_16x16x32_bf16 v[72:75], v[48:51], v[40:43], v[72:75]
    ds_read_b64_tr_b16 v[2:3], v128 offset:53248
    buffer_load_dwordx4 v141, s[4:7], s16 offen offset:0 sc1 lds
    v_mfma_f32_16x16x32_bf16 v[76:79], v[48:51], v[44:47], v[76:79]
    ds_read_b64_tr_b16 v[4:5], v129 offset:49152
    v_mfma_f32_16x16x32_bf16 v[80:83], v[52:55], v[32:35], v[80:83]
    ds_read_b64_tr_b16 v[6:7], v129 offset:53248
    v_mfma_f32_16x16x32_bf16 v[84:87], v[52:55], v[36:39], v[84:87]
    ds_read_b64_tr_b16 v[8:9], v130 offset:49152
    buffer_load_dwordx4 v141, s[4:7], s16 offen offset:1024 sc1 lds
    v_mfma_f32_16x16x32_bf16 v[88:91], v[52:55], v[40:43], v[88:91]
    ds_read_b64_tr_b16 v[10:11], v130 offset:53248
    v_mfma_f32_16x16x32_bf16 v[92:95], v[52:55], v[44:47], v[92:95]
    ds_read_b64_tr_b16 v[12:13], v131 offset:49152
    buffer_load_dwordx4 v142, s[4:7], s16 offen offset:2048 sc1 lds
    v_mfma_f32_16x16x32_bf16 v[96:99], v[56:59], v[32:35], v[96:99]
    ds_read_b64_tr_b16 v[14:15], v131 offset:53248
    v_mfma_f32_16x16x32_bf16 v[100:103], v[56:59], v[36:39], v[100:103]
    ds_read_b128 v[20:23], v136 offset:51200
    v_mfma_f32_16x16x32_bf16 v[104:107], v[56:59], v[40:43], v[104:107]
    ds_read_b128 v[24:27], v136 offset:53248
    buffer_load_dwordx4 v142, s[4:7], s16 offen offset:3072 sc1 lds
    v_mfma_f32_16x16x32_bf16 v[108:111], v[56:59], v[44:47], v[108:111]
    ds_read_b128 v[28:31], v136 offset:55296
    v_mfma_f32_16x16x32_bf16 v[112:115], v[60:63], v[32:35], v[112:115]
    s_add_u32 s16, s16, 2048
    v_mfma_f32_16x16x32_bf16 v[116:119], v[60:63], v[36:39], v[116:119]
    v_mfma_f32_16x16x32_bf16 v[120:123], v[60:63], v[40:43], v[120:123]
    v_mfma_f32_16x16x32_bf16 v[124:127], v[60:63], v[44:47], v[124:127]
    s_waitcnt lgkmcnt(0)
    ds_read_b128 v[48:51], v136 offset:50176
    s_add_u32 m0, s19, 32768
    s_nop 0
    v_mfma_f32_16x16x32_bf16 v[64:67], v[16:19], v[0:3], v[64:67]
    ds_read_b64_tr_b16 v[32:33], v128 offset:57344
    v_mfma_f32_16x16x32_bf16 v[68:71], v[16:19], v[4:7], v[68:71]
    ds_read_b64_tr_b16 v[34:35], v128 offset:61440
    buffer_load_dwordx4 v137, s[8:11], s15 offen offset:0 lds
    v_mfma_f32_16x16x32_bf16 v[72:75], v[16:19], v[8:11], v[72:75]
    ds_read_b64_tr_b16 v[36:37], v129 offset:57344
    v_mfma_f32_16x16x32_bf16 v[76:79], v[16:19], v[12:15], v[76:79]
    ds_read_b64_tr_b16 v[38:39], v129 offset:61440
    v_mfma_f32_16x16x32_bf16 v[80:83], v[20:23], v[0:3], v[80:83]
    ds_read_b64_tr_b16 v[40:41], v130 offset:57344
    buffer_load_dwordx4 v138, s[8:11], s15 offen offset:1024 lds
    v_mfma_f32_16x16x32_bf16 v[84:87], v[20:23], v[4:7], v[84:87]
    ds_read_b64_tr_b16 v[42:43], v130 offset:61440
    v_mfma_f32_16x16x32_bf16 v[88:91], v[20:23], v[8:11], v[88:91]
    ds_read_b64_tr_b16 v[44:45], v131 offset:57344
    v_mfma_f32_16x16x32_bf16 v[92:95], v[20:23], v[12:15], v[92:95]
    ds_read_b64_tr_b16 v[46:47], v131 offset:61440
    buffer_load_dwordx4 v139, s[8:11], s15 offen offset:2048 lds
    v_mfma_f32_16x16x32_bf16 v[96:99], v[24:27], v[0:3], v[96:99]
    ds_read_b128 v[52:55], v136 offset:52224
    v_mfma_f32_16x16x32_bf16 v[100:103], v[24:27], v[4:7], v[100:103]
    ds_read_b128 v[56:59], v136 offset:54272
    buffer_load_dwordx4 v140, s[8:11], s15 offen offset:3072 lds
    v_mfma_f32_16x16x32_bf16 v[104:107], v[24:27], v[8:11], v[104:107]
    ds_read_b128 v[60:63], v136 offset:56320
    v_mfma_f32_16x16x32_bf16 v[108:111], v[24:27], v[12:15], v[108:111]
    v_mfma_f32_16x16x32_bf16 v[112:115], v[28:31], v[0:3], v[112:115]
    s_add_u32 s15, s15, s17
    v_mfma_f32_16x16x32_bf16 v[116:119], v[28:31], v[4:7], v[116:119]
    v_mfma_f32_16x16x32_bf16 v[120:123], v[28:31], v[8:11], v[120:123]
    v_mfma_f32_16x16x32_bf16 v[124:127], v[28:31], v[12:15], v[124:127]
    s_waitcnt lgkmcnt(0)
    v_mfma_f32_16x16x32_bf16 v[64:67], v[48:51], v[32:35], v[64:67]
    s_waitcnt vmcnt(16)
    s_barrier
    ds_read_b128 v[16:19], v136 offset:0
    s_add_u32 m0, s20, 49152
    s_nop 0
    v_mfma_f32_16x16x32_bf16 v[68:71], v[48:51], v[36:39], v[68:71]
    ds_read_b64_tr_b16 v[0:1], v128 offset:0
    v_mfma_f32_16x16x32_bf16 v[72:75], v[48:51], v[40:43], v[72:75]
    ds_read_b64_tr_b16 v[2:3], v128 offset:4096
    buffer_load_dwordx4 v141, s[4:7], s16 offen offset:0 sc1 lds
    v_mfma_f32_16x16x32_bf16 v[76:79], v[48:51], v[44:47], v[76:79]
    ds_read_b64_tr_b16 v[4:5], v129 offset:0
    v_mfma_f32_16x16x32_bf16 v[80:83], v[52:55], v[32:35], v[80:83]
    ds_read_b64_tr_b16 v[6:7], v129 offset:4096
    v_mfma_f32_16x16x32_bf16 v[84:87], v[52:55], v[36:39], v[84:87]
    ds_read_b64_tr_b16 v[8:9], v130 offset:0
    buffer_load_dwordx4 v141, s[4:7], s16 offen offset:1024 sc1 lds
    v_mfma_f32_16x16x32_bf16 v[88:91], v[52:55], v[40:43], v[88:91]
    ds_read_b64_tr_b16 v[10:11], v130 offset:4096
    v_mfma_f32_16x16x32_bf16 v[92:95], v[52:55], v[44:47], v[92:95]
    ds_read_b64_tr_b16 v[12:13], v131 offset:0
    buffer_load_dwordx4 v142, s[4:7], s16 offen offset:2048 sc1 lds
    v_mfma_f32_16x16x32_bf16 v[96:99], v[56:59], v[32:35], v[96:99]
    ds_read_b64_tr_b16 v[14:15], v131 offset:4096
    v_mfma_f32_16x16x32_bf16 v[100:103], v[56:59], v[36:39], v[100:103]
    ds_read_b128 v[20:23], v136 offset:2048
    v_mfma_f32_16x16x32_bf16 v[104:107], v[56:59], v[40:43], v[104:107]
    ds_read_b128 v[24:27], v136 offset:4096
    buffer_load_dwordx4 v142, s[4:7], s16 offen offset:3072 sc1 lds
    v_mfma_f32_16x16x32_bf16 v[108:111], v[56:59], v[44:47], v[108:111]
    ds_read_b128 v[28:31], v136 offset:6144
    v_mfma_f32_16x16x32_bf16 v[112:115], v[60:63], v[32:35], v[112:115]
    s_add_u32 s16, s16, 2048
    v_mfma_f32_16x16x32_bf16 v[116:119], v[60:63], v[36:39], v[116:119]
    v_mfma_f32_16x16x32_bf16 v[120:123], v[60:63], v[40:43], v[120:123]
    v_mfma_f32_16x16x32_bf16 v[124:127], v[60:63], v[44:47], v[124:127]
    s_sub_u32 s18, s18, 1
    s_cmp_lg_u32 s18, 0
    s_cbranch_scc1 main_kernel_w_c0_v_loop
    s_cmp_lg_u32 s14, 0
    s_cbranch_scc1 main_kernel_w_c0_v_nt
    s_lshl_b32 s32, s27, 8
    s_add_u32 s32, s32, 0x841e000
    v_mov_b32 v255, 1
    s_mov_b64 exec, 1
    buffer_atomic_add v255, off, s[4:7], s32 sc0 sc1
    s_mov_b64 exec, -1
main_kernel_w_c0_v_nt:
    s_waitcnt lgkmcnt(0)
    ds_read_b128 v[48:51], v136 offset:1024
    s_add_u32 m0, s19, 49152
    s_nop 0
    v_mfma_f32_16x16x32_bf16 v[64:67], v[16:19], v[0:3], v[64:67]
    ds_read_b64_tr_b16 v[32:33], v128 offset:8192
    v_mfma_f32_16x16x32_bf16 v[68:71], v[16:19], v[4:7], v[68:71]
    ds_read_b64_tr_b16 v[34:35], v128 offset:12288
    buffer_load_dwordx4 v137, s[8:11], s15 offen offset:0 lds
    v_mfma_f32_16x16x32_bf16 v[72:75], v[16:19], v[8:11], v[72:75]
    ds_read_b64_tr_b16 v[36:37], v129 offset:8192
    v_mfma_f32_16x16x32_bf16 v[76:79], v[16:19], v[12:15], v[76:79]
    ds_read_b64_tr_b16 v[38:39], v129 offset:12288
    v_mfma_f32_16x16x32_bf16 v[80:83], v[20:23], v[0:3], v[80:83]
    ds_read_b64_tr_b16 v[40:41], v130 offset:8192
    buffer_load_dwordx4 v138, s[8:11], s15 offen offset:1024 lds
    v_mfma_f32_16x16x32_bf16 v[84:87], v[20:23], v[4:7], v[84:87]
    ds_read_b64_tr_b16 v[42:43], v130 offset:12288
    v_mfma_f32_16x16x32_bf16 v[88:91], v[20:23], v[8:11], v[88:91]
    ds_read_b64_tr_b16 v[44:45], v131 offset:8192
    v_mfma_f32_16x16x32_bf16 v[92:95], v[20:23], v[12:15], v[92:95]
    ds_read_b64_tr_b16 v[46:47], v131 offset:12288
    buffer_load_dwordx4 v139, s[8:11], s15 offen offset:2048 lds
    v_mfma_f32_16x16x32_bf16 v[96:99], v[24:27], v[0:3], v[96:99]
    ds_read_b128 v[52:55], v136 offset:3072
    v_mfma_f32_16x16x32_bf16 v[100:103], v[24:27], v[4:7], v[100:103]
    ds_read_b128 v[56:59], v136 offset:5120
    buffer_load_dwordx4 v140, s[8:11], s15 offen offset:3072 lds
    v_mfma_f32_16x16x32_bf16 v[104:107], v[24:27], v[8:11], v[104:107]
    ds_read_b128 v[60:63], v136 offset:7168
    v_mfma_f32_16x16x32_bf16 v[108:111], v[24:27], v[12:15], v[108:111]
    v_mfma_f32_16x16x32_bf16 v[112:115], v[28:31], v[0:3], v[112:115]
    s_add_u32 s15, s15, s17
    v_mfma_f32_16x16x32_bf16 v[116:119], v[28:31], v[4:7], v[116:119]
    v_mfma_f32_16x16x32_bf16 v[120:123], v[28:31], v[8:11], v[120:123]
    v_mfma_f32_16x16x32_bf16 v[124:127], v[28:31], v[12:15], v[124:127]
    s_waitcnt lgkmcnt(0)
    v_mfma_f32_16x16x32_bf16 v[64:67], v[48:51], v[32:35], v[64:67]
    s_waitcnt vmcnt(16)
    s_barrier
    ds_read_b128 v[16:19], v136 offset:16384
    v_mfma_f32_16x16x32_bf16 v[68:71], v[48:51], v[36:39], v[68:71]
    ds_read_b64_tr_b16 v[0:1], v128 offset:16384
    v_mfma_f32_16x16x32_bf16 v[72:75], v[48:51], v[40:43], v[72:75]
    ds_read_b64_tr_b16 v[2:3], v128 offset:20480
    v_mfma_f32_16x16x32_bf16 v[76:79], v[48:51], v[44:47], v[76:79]
    ds_read_b64_tr_b16 v[4:5], v129 offset:16384
    v_mfma_f32_16x16x32_bf16 v[80:83], v[52:55], v[32:35], v[80:83]
    ds_read_b64_tr_b16 v[6:7], v129 offset:20480
    v_mfma_f32_16x16x32_bf16 v[84:87], v[52:55], v[36:39], v[84:87]
    ds_read_b64_tr_b16 v[8:9], v130 offset:16384
    v_mfma_f32_16x16x32_bf16 v[88:91], v[52:55], v[40:43], v[88:91]
    ds_read_b64_tr_b16 v[10:11], v130 offset:20480
    v_mfma_f32_16x16x32_bf16 v[92:95], v[52:55], v[44:47], v[92:95]
    ds_read_b64_tr_b16 v[12:13], v131 offset:16384
    v_mfma_f32_16x16x32_bf16 v[96:99], v[56:59], v[32:35], v[96:99]
    ds_read_b64_tr_b16 v[14:15], v131 offset:20480
    v_mfma_f32_16x16x32_bf16 v[100:103], v[56:59], v[36:39], v[100:103]
    ds_read_b128 v[20:23], v136 offset:18432
    v_mfma_f32_16x16x32_bf16 v[104:107], v[56:59], v[40:43], v[104:107]
    ds_read_b128 v[24:27], v136 offset:20480
    v_mfma_f32_16x16x32_bf16 v[108:111], v[56:59], v[44:47], v[108:111]
    ds_read_b128 v[28:31], v136 offset:22528
    v_mfma_f32_16x16x32_bf16 v[112:115], v[60:63], v[32:35], v[112:115]
    v_mfma_f32_16x16x32_bf16 v[116:119], v[60:63], v[36:39], v[116:119]
    v_mfma_f32_16x16x32_bf16 v[120:123], v[60:63], v[40:43], v[120:123]
    v_mfma_f32_16x16x32_bf16 v[124:127], v[60:63], v[44:47], v[124:127]
    s_waitcnt lgkmcnt(0)
    ds_read_b128 v[48:51], v136 offset:17408
    v_mfma_f32_16x16x32_bf16 v[64:67], v[16:19], v[0:3], v[64:67]
    ds_read_b64_tr_b16 v[32:33], v128 offset:24576
    v_mfma_f32_16x16x32_bf16 v[68:71], v[16:19], v[4:7], v[68:71]
    ds_read_b64_tr_b16 v[34:35], v128 offset:28672
    v_mfma_f32_16x16x32_bf16 v[72:75], v[16:19], v[8:11], v[72:75]
    ds_read_b64_tr_b16 v[36:37], v129 offset:24576
    v_mfma_f32_16x16x32_bf16 v[76:79], v[16:19], v[12:15], v[76:79]
    ds_read_b64_tr_b16 v[38:39], v129 offset:28672
    v_mfma_f32_16x16x32_bf16 v[80:83], v[20:23], v[0:3], v[80:83]
    ds_read_b64_tr_b16 v[40:41], v130 offset:24576
    v_mfma_f32_16x16x32_bf16 v[84:87], v[20:23], v[4:7], v[84:87]
    ds_read_b64_tr_b16 v[42:43], v130 offset:28672
    v_mfma_f32_16x16x32_bf16 v[88:91], v[20:23], v[8:11], v[88:91]
    ds_read_b64_tr_b16 v[44:45], v131 offset:24576
    v_mfma_f32_16x16x32_bf16 v[92:95], v[20:23], v[12:15], v[92:95]
    ds_read_b64_tr_b16 v[46:47], v131 offset:28672
    v_mfma_f32_16x16x32_bf16 v[96:99], v[24:27], v[0:3], v[96:99]
    ds_read_b128 v[52:55], v136 offset:19456
    v_mfma_f32_16x16x32_bf16 v[100:103], v[24:27], v[4:7], v[100:103]
    ds_read_b128 v[56:59], v136 offset:21504
    v_mfma_f32_16x16x32_bf16 v[104:107], v[24:27], v[8:11], v[104:107]
    ds_read_b128 v[60:63], v136 offset:23552
    v_mfma_f32_16x16x32_bf16 v[108:111], v[24:27], v[12:15], v[108:111]
    v_mfma_f32_16x16x32_bf16 v[112:115], v[28:31], v[0:3], v[112:115]
    v_mfma_f32_16x16x32_bf16 v[116:119], v[28:31], v[4:7], v[116:119]
    v_mfma_f32_16x16x32_bf16 v[120:123], v[28:31], v[8:11], v[120:123]
    v_mfma_f32_16x16x32_bf16 v[124:127], v[28:31], v[12:15], v[124:127]
    s_waitcnt lgkmcnt(0)
    v_mfma_f32_16x16x32_bf16 v[64:67], v[48:51], v[32:35], v[64:67]
    s_waitcnt vmcnt(8)
    s_barrier
    ds_read_b128 v[16:19], v136 offset:32768
    v_mfma_f32_16x16x32_bf16 v[68:71], v[48:51], v[36:39], v[68:71]
    ds_read_b64_tr_b16 v[0:1], v128 offset:32768
    v_mfma_f32_16x16x32_bf16 v[72:75], v[48:51], v[40:43], v[72:75]
    ds_read_b64_tr_b16 v[2:3], v128 offset:36864
    v_mfma_f32_16x16x32_bf16 v[76:79], v[48:51], v[44:47], v[76:79]
    ds_read_b64_tr_b16 v[4:5], v129 offset:32768
    v_mfma_f32_16x16x32_bf16 v[80:83], v[52:55], v[32:35], v[80:83]
    ds_read_b64_tr_b16 v[6:7], v129 offset:36864
    v_mfma_f32_16x16x32_bf16 v[84:87], v[52:55], v[36:39], v[84:87]
    ds_read_b64_tr_b16 v[8:9], v130 offset:32768
    v_mfma_f32_16x16x32_bf16 v[88:91], v[52:55], v[40:43], v[88:91]
    ds_read_b64_tr_b16 v[10:11], v130 offset:36864
    v_mfma_f32_16x16x32_bf16 v[92:95], v[52:55], v[44:47], v[92:95]
    ds_read_b64_tr_b16 v[12:13], v131 offset:32768
    v_mfma_f32_16x16x32_bf16 v[96:99], v[56:59], v[32:35], v[96:99]
    ds_read_b64_tr_b16 v[14:15], v131 offset:36864
    v_mfma_f32_16x16x32_bf16 v[100:103], v[56:59], v[36:39], v[100:103]
    ds_read_b128 v[20:23], v136 offset:34816
    v_mfma_f32_16x16x32_bf16 v[104:107], v[56:59], v[40:43], v[104:107]
    ds_read_b128 v[24:27], v136 offset:36864
    v_mfma_f32_16x16x32_bf16 v[108:111], v[56:59], v[44:47], v[108:111]
    ds_read_b128 v[28:31], v136 offset:38912
    v_mfma_f32_16x16x32_bf16 v[112:115], v[60:63], v[32:35], v[112:115]
    v_mfma_f32_16x16x32_bf16 v[116:119], v[60:63], v[36:39], v[116:119]
    v_mfma_f32_16x16x32_bf16 v[120:123], v[60:63], v[40:43], v[120:123]
    v_mfma_f32_16x16x32_bf16 v[124:127], v[60:63], v[44:47], v[124:127]
    s_waitcnt lgkmcnt(0)
    ds_read_b128 v[48:51], v136 offset:33792
    v_mfma_f32_16x16x32_bf16 v[64:67], v[16:19], v[0:3], v[64:67]
    ds_read_b64_tr_b16 v[32:33], v128 offset:40960
    v_mfma_f32_16x16x32_bf16 v[68:71], v[16:19], v[4:7], v[68:71]
    ds_read_b64_tr_b16 v[34:35], v128 offset:45056
    v_mfma_f32_16x16x32_bf16 v[72:75], v[16:19], v[8:11], v[72:75]
    ds_read_b64_tr_b16 v[36:37], v129 offset:40960
    v_mfma_f32_16x16x32_bf16 v[76:79], v[16:19], v[12:15], v[76:79]
    ds_read_b64_tr_b16 v[38:39], v129 offset:45056
    v_mfma_f32_16x16x32_bf16 v[80:83], v[20:23], v[0:3], v[80:83]
    ds_read_b64_tr_b16 v[40:41], v130 offset:40960
    v_mfma_f32_16x16x32_bf16 v[84:87], v[20:23], v[4:7], v[84:87]
    ds_read_b64_tr_b16 v[42:43], v130 offset:45056
    v_mfma_f32_16x16x32_bf16 v[88:91], v[20:23], v[8:11], v[88:91]
    ds_read_b64_tr_b16 v[44:45], v131 offset:40960
    v_mfma_f32_16x16x32_bf16 v[92:95], v[20:23], v[12:15], v[92:95]
    ds_read_b64_tr_b16 v[46:47], v131 offset:45056
    v_mfma_f32_16x16x32_bf16 v[96:99], v[24:27], v[0:3], v[96:99]
    ds_read_b128 v[52:55], v136 offset:35840
    v_mfma_f32_16x16x32_bf16 v[100:103], v[24:27], v[4:7], v[100:103]
    ds_read_b128 v[56:59], v136 offset:37888
    v_mfma_f32_16x16x32_bf16 v[104:107], v[24:27], v[8:11], v[104:107]
    ds_read_b128 v[60:63], v136 offset:39936
    v_mfma_f32_16x16x32_bf16 v[108:111], v[24:27], v[12:15], v[108:111]
    v_mfma_f32_16x16x32_bf16 v[112:115], v[28:31], v[0:3], v[112:115]
    v_mfma_f32_16x16x32_bf16 v[116:119], v[28:31], v[4:7], v[116:119]
    v_mfma_f32_16x16x32_bf16 v[120:123], v[28:31], v[8:11], v[120:123]
    v_mfma_f32_16x16x32_bf16 v[124:127], v[28:31], v[12:15], v[124:127]
    s_waitcnt lgkmcnt(0)
    v_mfma_f32_16x16x32_bf16 v[64:67], v[48:51], v[32:35], v[64:67]
    s_waitcnt vmcnt(0)
    s_barrier
    ds_read_b128 v[16:19], v136 offset:49152
    v_mfma_f32_16x16x32_bf16 v[68:71], v[48:51], v[36:39], v[68:71]
    ds_read_b64_tr_b16 v[0:1], v128 offset:49152
    v_mfma_f32_16x16x32_bf16 v[72:75], v[48:51], v[40:43], v[72:75]
    ds_read_b64_tr_b16 v[2:3], v128 offset:53248
    v_mfma_f32_16x16x32_bf16 v[76:79], v[48:51], v[44:47], v[76:79]
    ds_read_b64_tr_b16 v[4:5], v129 offset:49152
    v_mfma_f32_16x16x32_bf16 v[80:83], v[52:55], v[32:35], v[80:83]
    ds_read_b64_tr_b16 v[6:7], v129 offset:53248
    v_mfma_f32_16x16x32_bf16 v[84:87], v[52:55], v[36:39], v[84:87]
    ds_read_b64_tr_b16 v[8:9], v130 offset:49152
    v_mfma_f32_16x16x32_bf16 v[88:91], v[52:55], v[40:43], v[88:91]
    ds_read_b64_tr_b16 v[10:11], v130 offset:53248
    v_mfma_f32_16x16x32_bf16 v[92:95], v[52:55], v[44:47], v[92:95]
    ds_read_b64_tr_b16 v[12:13], v131 offset:49152
    v_mfma_f32_16x16x32_bf16 v[96:99], v[56:59], v[32:35], v[96:99]
    ds_read_b64_tr_b16 v[14:15], v131 offset:53248
    v_mfma_f32_16x16x32_bf16 v[100:103], v[56:59], v[36:39], v[100:103]
    ds_read_b128 v[20:23], v136 offset:51200
    v_mfma_f32_16x16x32_bf16 v[104:107], v[56:59], v[40:43], v[104:107]
    ds_read_b128 v[24:27], v136 offset:53248
    v_mfma_f32_16x16x32_bf16 v[108:111], v[56:59], v[44:47], v[108:111]
    ds_read_b128 v[28:31], v136 offset:55296
    v_mfma_f32_16x16x32_bf16 v[112:115], v[60:63], v[32:35], v[112:115]
    v_mfma_f32_16x16x32_bf16 v[116:119], v[60:63], v[36:39], v[116:119]
    v_mfma_f32_16x16x32_bf16 v[120:123], v[60:63], v[40:43], v[120:123]
    v_mfma_f32_16x16x32_bf16 v[124:127], v[60:63], v[44:47], v[124:127]
    v_readfirstlane_b32 s55, v255
    s_waitcnt lgkmcnt(0)
    ds_read_b128 v[48:51], v136 offset:50176
    v_mfma_f32_16x16x32_bf16 v[64:67], v[16:19], v[0:3], v[64:67]
    ds_read_b64_tr_b16 v[32:33], v128 offset:57344
    v_mfma_f32_16x16x32_bf16 v[68:71], v[16:19], v[4:7], v[68:71]
    ds_read_b64_tr_b16 v[34:35], v128 offset:61440
    v_mfma_f32_16x16x32_bf16 v[72:75], v[16:19], v[8:11], v[72:75]
    ds_read_b64_tr_b16 v[36:37], v129 offset:57344
    v_mfma_f32_16x16x32_bf16 v[76:79], v[16:19], v[12:15], v[76:79]
    ds_read_b64_tr_b16 v[38:39], v129 offset:61440
    v_mfma_f32_16x16x32_bf16 v[80:83], v[20:23], v[0:3], v[80:83]
    ds_read_b64_tr_b16 v[40:41], v130 offset:57344
    v_mfma_f32_16x16x32_bf16 v[84:87], v[20:23], v[4:7], v[84:87]
    ds_read_b64_tr_b16 v[42:43], v130 offset:61440
    v_mfma_f32_16x16x32_bf16 v[88:91], v[20:23], v[8:11], v[88:91]
    ds_read_b64_tr_b16 v[44:45], v131 offset:57344
    v_mfma_f32_16x16x32_bf16 v[92:95], v[20:23], v[12:15], v[92:95]
    ds_read_b64_tr_b16 v[46:47], v131 offset:61440
    v_mfma_f32_16x16x32_bf16 v[96:99], v[24:27], v[0:3], v[96:99]
    ds_read_b128 v[52:55], v136 offset:52224
    v_mfma_f32_16x16x32_bf16 v[100:103], v[24:27], v[4:7], v[100:103]
    ds_read_b128 v[56:59], v136 offset:54272
    v_mfma_f32_16x16x32_bf16 v[104:107], v[24:27], v[8:11], v[104:107]
    ds_read_b128 v[60:63], v136 offset:56320
    v_mfma_f32_16x16x32_bf16 v[108:111], v[24:27], v[12:15], v[108:111]
    v_mfma_f32_16x16x32_bf16 v[112:115], v[28:31], v[0:3], v[112:115]
    v_mfma_f32_16x16x32_bf16 v[116:119], v[28:31], v[4:7], v[116:119]
    v_mfma_f32_16x16x32_bf16 v[120:123], v[28:31], v[8:11], v[120:123]
    v_mfma_f32_16x16x32_bf16 v[124:127], v[28:31], v[12:15], v[124:127]
    s_waitcnt lgkmcnt(0)
    v_mfma_f32_16x16x32_bf16 v[64:67], v[48:51], v[32:35], v[64:67]
    v_mfma_f32_16x16x32_bf16 v[68:71], v[48:51], v[36:39], v[68:71]
    v_mfma_f32_16x16x32_bf16 v[72:75], v[48:51], v[40:43], v[72:75]
    v_mfma_f32_16x16x32_bf16 v[76:79], v[48:51], v[44:47], v[76:79]
    v_mfma_f32_16x16x32_bf16 v[80:83], v[52:55], v[32:35], v[80:83]
    v_mfma_f32_16x16x32_bf16 v[84:87], v[52:55], v[36:39], v[84:87]
    v_mfma_f32_16x16x32_bf16 v[88:91], v[52:55], v[40:43], v[88:91]
    v_mfma_f32_16x16x32_bf16 v[92:95], v[52:55], v[44:47], v[92:95]
    v_mfma_f32_16x16x32_bf16 v[96:99], v[56:59], v[32:35], v[96:99]
    v_mfma_f32_16x16x32_bf16 v[100:103], v[56:59], v[36:39], v[100:103]
    v_mfma_f32_16x16x32_bf16 v[104:107], v[56:59], v[40:43], v[104:107]
    v_mfma_f32_16x16x32_bf16 v[108:111], v[56:59], v[44:47], v[108:111]
    v_mfma_f32_16x16x32_bf16 v[112:115], v[60:63], v[32:35], v[112:115]
    v_mfma_f32_16x16x32_bf16 v[116:119], v[60:63], v[36:39], v[116:119]
    v_mfma_f32_16x16x32_bf16 v[120:123], v[60:63], v[40:43], v[120:123]
    v_mfma_f32_16x16x32_bf16 v[124:127], v[60:63], v[44:47], v[124:127]
    s_nop 7
    s_mov_b32 s53, s21
    v_cvt_pk_bf16_f32 v8, v64, v65
    v_cvt_pk_bf16_f32 v9, v66, v67
    v_cvt_pk_bf16_f32 v10, v80, v81
    v_cvt_pk_bf16_f32 v11, v82, v83
    buffer_store_dwordx4 v[8:11], v251, s[4:7], s53 offen offset:0 sc1
    v_cvt_pk_bf16_f32 v24, v68, v69
    v_cvt_pk_bf16_f32 v25, v70, v71
    v_cvt_pk_bf16_f32 v26, v84, v85
    v_cvt_pk_bf16_f32 v27, v86, v87
    buffer_store_dwordx4 v[24:27], v251, s[4:7], s53 offen offset:1024 sc1
    v_cvt_pk_bf16_f32 v40, v72, v73
    v_cvt_pk_bf16_f32 v41, v74, v75
    v_cvt_pk_bf16_f32 v42, v88, v89
    v_cvt_pk_bf16_f32 v43, v90, v91
    buffer_store_dwordx4 v[40:43], v251, s[4:7], s53 offen offset:2048 sc1
    v_cvt_pk_bf16_f32 v56, v76, v77
    v_cvt_pk_bf16_f32 v57, v78, v79
    v_cvt_pk_bf16_f32 v58, v92, v93
    v_cvt_pk_bf16_f32 v59, v94, v95
    buffer_store_dwordx4 v[56:59], v251, s[4:7], s53 offen offset:3072 sc1
    s_add_u32 s53, s53, 262144
    v_cvt_pk_bf16_f32 v8, v96, v97
    v_cvt_pk_bf16_f32 v9, v98, v99
    v_cvt_pk_bf16_f32 v10, v112, v113
    v_cvt_pk_bf16_f32 v11, v114, v115
    buffer_store_dwordx4 v[8:11], v251, s[4:7], s53 offen offset:0 sc1
    v_cvt_pk_bf16_f32 v24, v100, v101
    v_cvt_pk_bf16_f32 v25, v102, v103
    v_cvt_pk_bf16_f32 v26, v116, v117
    v_cvt_pk_bf16_f32 v27, v118, v119
    buffer_store_dwordx4 v[24:27], v251, s[4:7], s53 offen offset:1024 sc1
    v_cvt_pk_bf16_f32 v40, v104, v105
    v_cvt_pk_bf16_f32 v41, v106, v107
    v_cvt_pk_bf16_f32 v42, v120, v121
    v_cvt_pk_bf16_f32 v43, v122, v123
    buffer_store_dwordx4 v[40:43], v251, s[4:7], s53 offen offset:2048 sc1
    v_cvt_pk_bf16_f32 v56, v108, v109
    v_cvt_pk_bf16_f32 v57, v110, v111
    v_cvt_pk_bf16_f32 v58, v124, v125
    v_cvt_pk_bf16_f32 v59, v126, v127
    buffer_store_dwordx4 v[56:59], v251, s[4:7], s53 offen offset:3072 sc1
    s_add_u32 s53, s53, 262144
    s_branch main_kernel_w_done
main_kernel_w_c1_task:
    s_cmp_eq_u32 s23, 0
    s_cbranch_scc1 main_kernel_w_c1_set0
    s_cmp_eq_u32 s23, 1
    s_cbranch_scc1 main_kernel_w_c1_set1
    s_cmp_eq_u32 s23, 2
    s_cbranch_scc1 main_kernel_w_c1_set2
    s_cmp_eq_u32 s23, 3
    s_cbranch_scc1 main_kernel_w_c1_set3
    s_cmp_eq_u32 s23, 6
    s_cbranch_scc1 main_kernel_w_c1_set6
    s_branch main_kernel_w_done
main_kernel_w_c1_set0:
    s_lshl_b32 s32, s25, 8
    s_add_u32 s8, s40, s32
    s_addc_u32 s9, s41, 0
    s_and_b32 s9, s9, 0xffff
    s_sub_u32 s10, 0x800000, s32
    s_mov_b32 s11, 0x20000
    s_mov_b32 s30, 8192
    s_mov_b32 s31, 32768
    s_mul_i32 s16, s24, 262144
    s_add_u32 s16, s16, 0x0
    s_mov_b32 s18, 7
    s_lshl_b32 s32, s24, 3
    s_mul_i32 s33, s38, 4
    s_add_u32 s32, s32, s33
    s_mul_i32 s32, s32, 131072
    s_lshl_b32 s33, s25, 12
    s_add_u32 s32, s32, s33
    s_mul_i32 s33, s37, 4096
    s_add_u32 s32, s32, s33
    s_add_u32 s21, s32, 0x800000
    s_mov_b32 s22, 131072
    s_mov_b32 s26, -1
    s_branch main_kernel_w_c1_go
main_kernel_w_c1_set1:
    s_lshl_b32 s32, s25, 8
    s_add_u32 s8, s42, s32
    s_addc_u32 s9, s43, 0
    s_and_b32 s9, s9, 0xffff
    s_sub_u32 s10, 0x800000, s32
    s_mov_b32 s11, 0x20000
    s_mov_b32 s30, 8192
    s_mov_b32 s31, 32768
    s_mul_i32 s16, s24, 262144
    s_add_u32 s16, s16, 0x0
    s_mov_b32 s18, 7
    s_lshl_b32 s32, s24, 3
    s_mul_i32 s33, s38, 4
    s_add_u32 s32, s32, s33
    s_mul_i32 s32, s32, 131072
    s_lshl_b32 s33, s25, 12
    s_add_u32 s32, s32, s33
    s_mul_i32 s33, s37, 4096
    s_add_u32 s32, s32, s33
    s_add_u32 s21, s32, 0x1800000
    s_mov_b32 s22, 131072
    s_mov_b32 s26, -1
    s_branch main_kernel_w_c1_go
main_kernel_w_c1_set2:
    s_lshl_b32 s32, s25, 8
    s_add_u32 s8, s44, s32
    s_addc_u32 s9, s45, 0
    s_and_b32 s9, s9, 0xffff
    s_sub_u32 s10, 0x800000, s32
    s_mov_b32 s11, 0x20000
    s_mov_b32 s30, 8192
    s_mov_b32 s31, 32768
    s_mul_i32 s16, s24, 262144
    s_add_u32 s16, s16, 0x0
    s_mov_b32 s18, 7
    s_lshl_b32 s32, s24, 2
    s_mul_i32 s33, s38, 2
    s_add_u32 s32, s32, s33
    s_lshl_b32 s32, s32, 18
    s_lshl_b32 s33, s25, 13
    s_add_u32 s32, s32, s33
    s_mul_i32 s33, s37, 8192
    s_add_u32 s32, s32, s33
    s_add_u32 s21, s32, 0x2800000
    s_branch main_kernel_w_c1_gov
main_kernel_w_c1_set3:
    s_lshl_b32 s32, s25, 8
    s_add_u32 s8, s64, s32
    s_addc_u32 s9, s65, 0
    s_and_b32 s9, s9, 0xffff
    s_sub_u32 s10, 0x200000, s32
    s_mov_b32 s11, 0x20000
    s_mov_b32 s30, 2048
    s_mov_b32 s31, 32768
    s_mul_i32 s16, s24, 262144
    s_add_u32 s16, s16, 0x400000
    s_mov_b32 s18, 7
    s_lshl_b32 s32, s24, 3
    s_mul_i32 s33, s38, 4
    s_add_u32 s32, s32, s33
    s_mul_i32 s32, s32, 32768
    s_lshl_b32 s33, s25, 12
    s_add_u32 s32, s32, s33
    s_mul_i32 s33, s37, 4096
    s_add_u32 s32, s32, s33
    s_add_u32 s21, s32, 0x4800000
    s_mov_b32 s22, 32768
    s_mov_b32 s26, -1
    s_lshr_b32 s32, s25, 2
    s_add_u32 s32, s32, 1
    s_sub_u32 s33, 0, s32
    s_bitcmp1_b32 s25, 1
    s_cselect_b32 s32, s33, s32
    s_add_u32 s32, s32, 16
    v_and_b32 v253, 15, v250
    v_add_u32 v253, s32, v253
    v_lshrrev_b32 v254, 4, v253
    v_lshlrev_b32 v254, 15, v254
    v_and_b32 v253, 15, v253
    v_lshl_add_u32 v254, v253, 4, v254
    v_and_b32 v253, 0x300, v251
    v_add_u32 v252, v253, v254
    s_branch main_kernel_w_c1_go
main_kernel_w_c1_set6:
    s_lshl_b32 s32, s25, 8
    s_add_u32 s8, s68, s32
    s_addc_u32 s9, s69, 0
    s_and_b32 s9, s9, 0xffff
    s_sub_u32 s10, 0x700000, s32
    s_mov_b32 s11, 0x20000
    s_mov_b32 s30, 7168
    s_mov_b32 s31, 32768
    s_mul_i32 s16, s24, 262144
    s_add_u32 s16, s16, 0x6800000
    s_mov_b32 s18, 7
    s_lshl_b32 s32, s24, 3
    s_mul_i32 s33, s38, 4
    s_add_u32 s32, s32, s33
    s_mul_i32 s32, s32, 114688
    s_lshl_b32 s33, s25, 12
    s_add_u32 s32, s32, s33
    s_mul_i32 s33, s37, 4096
    s_add_u32 s32, s32, s33
    s_add_u32 s21, s32, 0x5400000
    s_mov_b32 s22, 114688
    s_mov_b32 s26, -1
    s_branch main_kernel_w_c1_go
main_kernel_w_c1_go:
    v_lshrrev_b32 v0, 4, v250
    v_bfe_u32 v1, v250, 2, 2
    v_lshl_add_u32 v4, v0, 2, v1
    v_and_b32 v5, 7, v4
    v_mul_u32_u24 v4, 512, v4
    v_and_b32 v6, 3, v250
    v_lshl_add_u32 v4, v6, 3, v4
    s_mul_i32 s32, s37, 8
    v_xor_b32 v5, s32, v5
    v_lshl_add_u32 v128, v5, 5, v4
    v_xor_b32 v129, 32, v128
    v_xor_b32 v130, 64, v128
    v_xor_b32 v131, 96, v128
    v_xor_b32 v132, 128, v128
    v_xor_b32 v133, 160, v128
    v_xor_b32 v134, 192, v128
    v_xor_b32 v135, 224, v128
    s_mul_i32 s32, s38, 4096
    s_add_u32 s32, s32, 65536
    v_add_u32 v136, s32, v251
    v_lshrrev_b32 v2, 5, v250
    v_and_b32 v3, 31, v250
    s_mul_i32 s32, s14, 8
    v_add_u32 v4, s32, v2
    v_add_u32 v5, 0, v4
    v_and_b32 v6, 7, v5
    v_lshlrev_b32 v6, 1, v6
    v_xor_b32 v6, v6, v3
    v_mul_lo_u32 v5, v5, s30
    v_lshl_add_u32 v5, v6, 4, v5
    v_subrev_u32 v137, 0, v5
    v_add_u32 v5, 2, v4
    v_and_b32 v6, 7, v5
    v_lshlrev_b32 v6, 1, v6
    v_xor_b32 v6, v6, v3
    v_mul_lo_u32 v5, v5, s30
    v_lshl_add_u32 v5, v6, 4, v5
    v_subrev_u32 v138, 1024, v5
    v_add_u32 v5, 4, v4
    v_and_b32 v6, 7, v5
    v_lshlrev_b32 v6, 1, v6
    v_xor_b32 v6, v6, v3
    v_mul_lo_u32 v5, v5, s30
    v_lshl_add_u32 v5, v6, 4, v5
    v_subrev_u32 v139, 2048, v5
    v_add_u32 v5, 6, v4
    v_and_b32 v6, 7, v5
    v_lshlrev_b32 v6, 1, v6
    v_xor_b32 v6, v6, v3
    v_mul_lo_u32 v5, v5, s30
    v_lshl_add_u32 v5, v6, 4, v5
    v_subrev_u32 v140, 3072, v5
    s_mul_i32 s32, s14, 2
    s_mul_i32 s32, s32, s31
    v_add_u32 v141, s32, v251
    s_add_u32 s32, s32, s31
    s_sub_u32 s32, s32, 1024
    v_add_u32 v142, s32, v251
    s_mul_i32 s19, s14, 4096
    s_mul_i32 s20, s14, 2048
    s_add_u32 s20, s20, 65536
    s_mul_i32 s17, s30, 32
    s_mov_b32 s15, 0
    s_add_u32 m0, s20, 0
    s_nop 0
    buffer_load_dwordx4 v141, s[4:7], s16 offen offset:0 sc1 lds
    buffer_load_dwordx4 v142, s[4:7], s16 offen offset:1024 sc1 lds
    s_add_u32 s16, s16, 1024
    s_add_u32 m0, s19, 0
    s_nop 0
    buffer_load_dwordx4 v137, s[8:11], s15 offen offset:0 lds
    buffer_load_dwordx4 v138, s[8:11], s15 offen offset:1024 lds
    buffer_load_dwordx4 v139, s[8:11], s15 offen offset:2048 lds
    buffer_load_dwordx4 v140, s[8:11], s15 offen offset:3072 lds
    s_add_u32 s15, s15, s17
    s_add_u32 m0, s20, 8192
    s_nop 0
    buffer_load_dwordx4 v141, s[4:7], s16 offen offset:0 sc1 lds
    buffer_load_dwordx4 v142, s[4:7], s16 offen offset:1024 sc1 lds
    s_add_u32 s16, s16, 1024
    s_add_u32 m0, s19, 16384
    s_nop 0
    buffer_load_dwordx4 v137, s[8:11], s15 offen offset:0 lds
    buffer_load_dwordx4 v138, s[8:11], s15 offen offset:1024 lds
    buffer_load_dwordx4 v139, s[8:11], s15 offen offset:2048 lds
    buffer_load_dwordx4 v140, s[8:11], s15 offen offset:3072 lds
    s_add_u32 s15, s15, s17
    s_add_u32 m0, s20, 16384
    s_nop 0
    buffer_load_dwordx4 v141, s[4:7], s16 offen offset:0 sc1 lds
    buffer_load_dwordx4 v142, s[4:7], s16 offen offset:1024 sc1 lds
    s_add_u32 s16, s16, 1024
    s_add_u32 m0, s19, 32768
    s_nop 0
    buffer_load_dwordx4 v137, s[8:11], s15 offen offset:0 lds
    buffer_load_dwordx4 v138, s[8:11], s15 offen offset:1024 lds
    buffer_load_dwordx4 v139, s[8:11], s15 offen offset:2048 lds
    buffer_load_dwordx4 v140, s[8:11], s15 offen offset:3072 lds
    s_add_u32 s15, s15, s17
    s_add_u32 m0, s20, 24576
    s_nop 0
    buffer_load_dwordx4 v141, s[4:7], s16 offen offset:0 sc1 lds
    buffer_load_dwordx4 v142, s[4:7], s16 offen offset:1024 sc1 lds
    s_add_u32 s16, s16, 1024
    s_add_u32 m0, s19, 49152
    s_nop 0
    buffer_load_dwordx4 v137, s[8:11], s15 offen offset:0 lds
    buffer_load_dwordx4 v138, s[8:11], s15 offen offset:1024 lds
    buffer_load_dwordx4 v139, s[8:11], s15 offen offset:2048 lds
    buffer_load_dwordx4 v140, s[8:11], s15 offen offset:3072 lds
    s_add_u32 s15, s15, s17
    v_accvgpr_write_b32 a0, 0
    v_accvgpr_write_b32 a1, 0
    v_accvgpr_write_b32 a2, 0
    v_accvgpr_write_b32 a3, 0
    v_accvgpr_write_b32 a4, 0
    v_accvgpr_write_b32 a5, 0
    v_accvgpr_write_b32 a6, 0
    v_accvgpr_write_b32 a7, 0
    v_accvgpr_write_b32 a8, 0
    v_accvgpr_write_b32 a9, 0
    v_accvgpr_write_b32 a10, 0
    v_accvgpr_write_b32 a11, 0
    v_accvgpr_write_b32 a12, 0
    v_accvgpr_write_b32 a13, 0
    v_accvgpr_write_b32 a14, 0
    v_accvgpr_write_b32 a15, 0
    v_accvgpr_write_b32 a16, 0
    v_accvgpr_write_b32 a17, 0
    v_accvgpr_write_b32 a18, 0
    v_accvgpr_write_b32 a19, 0
    v_accvgpr_write_b32 a20, 0
    v_accvgpr_write_b32 a21, 0
    v_accvgpr_write_b32 a22, 0
    v_accvgpr_write_b32 a23, 0
    v_accvgpr_write_b32 a24, 0
    v_accvgpr_write_b32 a25, 0
    v_accvgpr_write_b32 a26, 0
    v_accvgpr_write_b32 a27, 0
    v_accvgpr_write_b32 a28, 0
    v_accvgpr_write_b32 a29, 0
    v_accvgpr_write_b32 a30, 0
    v_accvgpr_write_b32 a31, 0
    v_accvgpr_write_b32 a32, 0
    v_accvgpr_write_b32 a33, 0
    v_accvgpr_write_b32 a34, 0
    v_accvgpr_write_b32 a35, 0
    v_accvgpr_write_b32 a36, 0
    v_accvgpr_write_b32 a37, 0
    v_accvgpr_write_b32 a38, 0
    v_accvgpr_write_b32 a39, 0
    v_accvgpr_write_b32 a40, 0
    v_accvgpr_write_b32 a41, 0
    v_accvgpr_write_b32 a42, 0
    v_accvgpr_write_b32 a43, 0
    v_accvgpr_write_b32 a44, 0
    v_accvgpr_write_b32 a45, 0
    v_accvgpr_write_b32 a46, 0
    v_accvgpr_write_b32 a47, 0
    v_accvgpr_write_b32 a48, 0
    v_accvgpr_write_b32 a49, 0
    v_accvgpr_write_b32 a50, 0
    v_accvgpr_write_b32 a51, 0
    v_accvgpr_write_b32 a52, 0
    v_accvgpr_write_b32 a53, 0
    v_accvgpr_write_b32 a54, 0
    v_accvgpr_write_b32 a55, 0
    v_accvgpr_write_b32 a56, 0
    v_accvgpr_write_b32 a57, 0
    v_accvgpr_write_b32 a58, 0
    v_accvgpr_write_b32 a59, 0
    v_accvgpr_write_b32 a60, 0
    v_accvgpr_write_b32 a61, 0
    v_accvgpr_write_b32 a62, 0
    v_accvgpr_write_b32 a63, 0
    v_accvgpr_write_b32 a64, 0
    v_accvgpr_write_b32 a65, 0
    v_accvgpr_write_b32 a66, 0
    v_accvgpr_write_b32 a67, 0
    v_accvgpr_write_b32 a68, 0
    v_accvgpr_write_b32 a69, 0
    v_accvgpr_write_b32 a70, 0
    v_accvgpr_write_b32 a71, 0
    v_accvgpr_write_b32 a72, 0
    v_accvgpr_write_b32 a73, 0
    v_accvgpr_write_b32 a74, 0
    v_accvgpr_write_b32 a75, 0
    v_accvgpr_write_b32 a76, 0
    v_accvgpr_write_b32 a77, 0
    v_accvgpr_write_b32 a78, 0
    v_accvgpr_write_b32 a79, 0
    v_accvgpr_write_b32 a80, 0
    v_accvgpr_write_b32 a81, 0
    v_accvgpr_write_b32 a82, 0
    v_accvgpr_write_b32 a83, 0
    v_accvgpr_write_b32 a84, 0
    v_accvgpr_write_b32 a85, 0
    v_accvgpr_write_b32 a86, 0
    v_accvgpr_write_b32 a87, 0
    v_accvgpr_write_b32 a88, 0
    v_accvgpr_write_b32 a89, 0
    v_accvgpr_write_b32 a90, 0
    v_accvgpr_write_b32 a91, 0
    v_accvgpr_write_b32 a92, 0
    v_accvgpr_write_b32 a93, 0
    v_accvgpr_write_b32 a94, 0
    v_accvgpr_write_b32 a95, 0
    v_accvgpr_write_b32 a96, 0
    v_accvgpr_write_b32 a97, 0
    v_accvgpr_write_b32 a98, 0
    v_accvgpr_write_b32 a99, 0
    v_accvgpr_write_b32 a100, 0
    v_accvgpr_write_b32 a101, 0
    v_accvgpr_write_b32 a102, 0
    v_accvgpr_write_b32 a103, 0
    v_accvgpr_write_b32 a104, 0
    v_accvgpr_write_b32 a105, 0
    v_accvgpr_write_b32 a106, 0
    v_accvgpr_write_b32 a107, 0
    v_accvgpr_write_b32 a108, 0
    v_accvgpr_write_b32 a109, 0
    v_accvgpr_write_b32 a110, 0
    v_accvgpr_write_b32 a111, 0
    v_accvgpr_write_b32 a112, 0
    v_accvgpr_write_b32 a113, 0
    v_accvgpr_write_b32 a114, 0
    v_accvgpr_write_b32 a115, 0
    v_accvgpr_write_b32 a116, 0
    v_accvgpr_write_b32 a117, 0
    v_accvgpr_write_b32 a118, 0
    v_accvgpr_write_b32 a119, 0
    v_accvgpr_write_b32 a120, 0
    v_accvgpr_write_b32 a121, 0
    v_accvgpr_write_b32 a122, 0
    v_accvgpr_write_b32 a123, 0
    v_accvgpr_write_b32 a124, 0
    v_accvgpr_write_b32 a125, 0
    v_accvgpr_write_b32 a126, 0
    v_accvgpr_write_b32 a127, 0
    s_waitcnt vmcnt(18)
    s_barrier
    ds_read_b128 v[32:35], v136 offset:0
    ds_read_b64_tr_b16 v[0:1], v128 offset:0
    ds_read_b64_tr_b16 v[2:3], v128 offset:8192
    ds_read_b64_tr_b16 v[4:5], v129 offset:0
    ds_read_b64_tr_b16 v[6:7], v129 offset:8192
    ds_read_b64_tr_b16 v[8:9], v130 offset:0
    ds_read_b64_tr_b16 v[10:11], v130 offset:8192
    ds_read_b64_tr_b16 v[12:13], v131 offset:0
    ds_read_b64_tr_b16 v[14:15], v131 offset:8192
    ds_read_b64_tr_b16 v[16:17], v132 offset:0
    ds_read_b64_tr_b16 v[18:19], v132 offset:8192
    ds_read_b64_tr_b16 v[20:21], v133 offset:0
    ds_read_b64_tr_b16 v[22:23], v133 offset:8192
    ds_read_b64_tr_b16 v[24:25], v134 offset:0
    ds_read_b64_tr_b16 v[26:27], v134 offset:8192
    ds_read_b64_tr_b16 v[28:29], v135 offset:0
    ds_read_b64_tr_b16 v[30:31], v135 offset:8192
    ds_read_b128 v[36:39], v136 offset:1024
    ds_read_b128 v[40:43], v136 offset:2048
    ds_read_b128 v[44:47], v136 offset:3072
main_kernel_w_c1_n_loop:
    s_waitcnt lgkmcnt(0)
    v_mfma_f32_16x16x32_bf16 a[0:3], v[0:3], v[32:35], a[0:3]
    s_waitcnt vmcnt(12)
    s_barrier
    ds_read_b128 v[80:83], v136 offset:8192
    s_add_u32 m0, s20, 0
    s_nop 0
    v_mfma_f32_16x16x32_bf16 a[4:7], v[4:7], v[32:35], a[4:7]
    ds_read_b64_tr_b16 v[48:49], v128 offset:16384
    v_mfma_f32_16x16x32_bf16 a[8:11], v[8:11], v[32:35], a[8:11]
    ds_read_b64_tr_b16 v[50:51], v128 offset:24576
    v_mfma_f32_16x16x32_bf16 a[12:15], v[12:15], v[32:35], a[12:15]
    ds_read_b64_tr_b16 v[52:53], v129 offset:16384
    buffer_load_dwordx4 v141, s[4:7], s16 offen offset:0 sc1 lds
    v_mfma_f32_16x16x32_bf16 a[16:19], v[16:19], v[32:35], a[16:19]
    ds_read_b64_tr_b16 v[54:55], v129 offset:24576
    v_mfma_f32_16x16x32_bf16 a[20:23], v[20:23], v[32:35], a[20:23]
    ds_read_b64_tr_b16 v[56:57], v130 offset:16384
    v_mfma_f32_16x16x32_bf16 a[24:27], v[24:27], v[32:35], a[24:27]
    ds_read_b64_tr_b16 v[58:59], v130 offset:24576
    buffer_load_dwordx4 v142, s[4:7], s16 offen offset:1024 sc1 lds
    v_mfma_f32_16x16x32_bf16 a[28:31], v[28:31], v[32:35], a[28:31]
    ds_read_b64_tr_b16 v[60:61], v131 offset:16384
    v_mfma_f32_16x16x32_bf16 a[32:35], v[0:3], v[36:39], a[32:35]
    ds_read_b64_tr_b16 v[62:63], v131 offset:24576
    v_mfma_f32_16x16x32_bf16 a[36:39], v[4:7], v[36:39], a[36:39]
    ds_read_b64_tr_b16 v[64:65], v132 offset:16384
    s_add_u32 s16, s16, 1024
    v_mfma_f32_16x16x32_bf16 a[40:43], v[8:11], v[36:39], a[40:43]
    ds_read_b64_tr_b16 v[66:67], v132 offset:24576
    v_mfma_f32_16x16x32_bf16 a[44:47], v[12:15], v[36:39], a[44:47]
    ds_read_b64_tr_b16 v[68:69], v133 offset:16384
    v_mfma_f32_16x16x32_bf16 a[48:51], v[16:19], v[36:39], a[48:51]
    ds_read_b64_tr_b16 v[70:71], v133 offset:24576
    s_add_u32 m0, s19, 0
    s_nop 0
    v_mfma_f32_16x16x32_bf16 a[52:55], v[20:23], v[36:39], a[52:55]
    ds_read_b64_tr_b16 v[72:73], v134 offset:16384
    v_mfma_f32_16x16x32_bf16 a[56:59], v[24:27], v[36:39], a[56:59]
    ds_read_b64_tr_b16 v[74:75], v134 offset:24576
    v_mfma_f32_16x16x32_bf16 a[60:63], v[28:31], v[36:39], a[60:63]
    ds_read_b64_tr_b16 v[76:77], v135 offset:16384
    buffer_load_dwordx4 v137, s[8:11], s15 offen offset:0 lds
    v_mfma_f32_16x16x32_bf16 a[64:67], v[0:3], v[40:43], a[64:67]
    ds_read_b64_tr_b16 v[78:79], v135 offset:24576
    v_mfma_f32_16x16x32_bf16 a[68:71], v[4:7], v[40:43], a[68:71]
    ds_read_b128 v[84:87], v136 offset:9216
    v_mfma_f32_16x16x32_bf16 a[72:75], v[8:11], v[40:43], a[72:75]
    ds_read_b128 v[88:91], v136 offset:10240
    buffer_load_dwordx4 v138, s[8:11], s15 offen offset:1024 lds
    v_mfma_f32_16x16x32_bf16 a[76:79], v[12:15], v[40:43], a[76:79]
    ds_read_b128 v[92:95], v136 offset:11264
    v_mfma_f32_16x16x32_bf16 a[80:83], v[16:19], v[40:43], a[80:83]
    v_mfma_f32_16x16x32_bf16 a[84:87], v[20:23], v[40:43], a[84:87]
    buffer_load_dwordx4 v139, s[8:11], s15 offen offset:2048 lds
    v_mfma_f32_16x16x32_bf16 a[88:91], v[24:27], v[40:43], a[88:91]
    v_mfma_f32_16x16x32_bf16 a[92:95], v[28:31], v[40:43], a[92:95]
    v_mfma_f32_16x16x32_bf16 a[96:99], v[0:3], v[44:47], a[96:99]
    buffer_load_dwordx4 v140, s[8:11], s15 offen offset:3072 lds
    v_mfma_f32_16x16x32_bf16 a[100:103], v[4:7], v[44:47], a[100:103]
    v_mfma_f32_16x16x32_bf16 a[104:107], v[8:11], v[44:47], a[104:107]
    v_mfma_f32_16x16x32_bf16 a[108:111], v[12:15], v[44:47], a[108:111]
    s_add_u32 s15, s15, s17
    v_mfma_f32_16x16x32_bf16 a[112:115], v[16:19], v[44:47], a[112:115]
    v_mfma_f32_16x16x32_bf16 a[116:119], v[20:23], v[44:47], a[116:119]
    v_mfma_f32_16x16x32_bf16 a[120:123], v[24:27], v[44:47], a[120:123]
    v_mfma_f32_16x16x32_bf16 a[124:127], v[28:31], v[44:47], a[124:127]
    s_waitcnt lgkmcnt(0)
    v_mfma_f32_16x16x32_bf16 a[0:3], v[48:51], v[80:83], a[0:3]
    s_waitcnt vmcnt(12)
    s_barrier
    ds_read_b128 v[32:35], v136 offset:16384
    s_add_u32 m0, s20, 8192
    s_nop 0
    v_mfma_f32_16x16x32_bf16 a[4:7], v[52:55], v[80:83], a[4:7]
    ds_read_b64_tr_b16 v[0:1], v128 offset:32768
    v_mfma_f32_16x16x32_bf16 a[8:11], v[56:59], v[80:83], a[8:11]
    ds_read_b64_tr_b16 v[2:3], v128 offset:40960
    v_mfma_f32_16x16x32_bf16 a[12:15], v[60:63], v[80:83], a[12:15]
    ds_read_b64_tr_b16 v[4:5], v129 offset:32768
    buffer_load_dwordx4 v141, s[4:7], s16 offen offset:0 sc1 lds
    v_mfma_f32_16x16x32_bf16 a[16:19], v[64:67], v[80:83], a[16:19]
    ds_read_b64_tr_b16 v[6:7], v129 offset:40960
    v_mfma_f32_16x16x32_bf16 a[20:23], v[68:71], v[80:83], a[20:23]
    ds_read_b64_tr_b16 v[8:9], v130 offset:32768
    v_mfma_f32_16x16x32_bf16 a[24:27], v[72:75], v[80:83], a[24:27]
    ds_read_b64_tr_b16 v[10:11], v130 offset:40960
    buffer_load_dwordx4 v142, s[4:7], s16 offen offset:1024 sc1 lds
    v_mfma_f32_16x16x32_bf16 a[28:31], v[76:79], v[80:83], a[28:31]
    ds_read_b64_tr_b16 v[12:13], v131 offset:32768
    v_mfma_f32_16x16x32_bf16 a[32:35], v[48:51], v[84:87], a[32:35]
    ds_read_b64_tr_b16 v[14:15], v131 offset:40960
    v_mfma_f32_16x16x32_bf16 a[36:39], v[52:55], v[84:87], a[36:39]
    ds_read_b64_tr_b16 v[16:17], v132 offset:32768
    s_add_u32 s16, s16, 1024
    v_mfma_f32_16x16x32_bf16 a[40:43], v[56:59], v[84:87], a[40:43]
    ds_read_b64_tr_b16 v[18:19], v132 offset:40960
    v_mfma_f32_16x16x32_bf16 a[44:47], v[60:63], v[84:87], a[44:47]
    ds_read_b64_tr_b16 v[20:21], v133 offset:32768
    v_mfma_f32_16x16x32_bf16 a[48:51], v[64:67], v[84:87], a[48:51]
    ds_read_b64_tr_b16 v[22:23], v133 offset:40960
    s_add_u32 m0, s19, 16384
    s_nop 0
    v_mfma_f32_16x16x32_bf16 a[52:55], v[68:71], v[84:87], a[52:55]
    ds_read_b64_tr_b16 v[24:25], v134 offset:32768
    v_mfma_f32_16x16x32_bf16 a[56:59], v[72:75], v[84:87], a[56:59]
    ds_read_b64_tr_b16 v[26:27], v134 offset:40960
    v_mfma_f32_16x16x32_bf16 a[60:63], v[76:79], v[84:87], a[60:63]
    ds_read_b64_tr_b16 v[28:29], v135 offset:32768
    buffer_load_dwordx4 v137, s[8:11], s15 offen offset:0 lds
    v_mfma_f32_16x16x32_bf16 a[64:67], v[48:51], v[88:91], a[64:67]
    ds_read_b64_tr_b16 v[30:31], v135 offset:40960
    v_mfma_f32_16x16x32_bf16 a[68:71], v[52:55], v[88:91], a[68:71]
    ds_read_b128 v[36:39], v136 offset:17408
    v_mfma_f32_16x16x32_bf16 a[72:75], v[56:59], v[88:91], a[72:75]
    ds_read_b128 v[40:43], v136 offset:18432
    buffer_load_dwordx4 v138, s[8:11], s15 offen offset:1024 lds
    v_mfma_f32_16x16x32_bf16 a[76:79], v[60:63], v[88:91], a[76:79]
    ds_read_b128 v[44:47], v136 offset:19456
    v_mfma_f32_16x16x32_bf16 a[80:83], v[64:67], v[88:91], a[80:83]
    v_mfma_f32_16x16x32_bf16 a[84:87], v[68:71], v[88:91], a[84:87]
    buffer_load_dwordx4 v139, s[8:11], s15 offen offset:2048 lds
    v_mfma_f32_16x16x32_bf16 a[88:91], v[72:75], v[88:91], a[88:91]
    v_mfma_f32_16x16x32_bf16 a[92:95], v[76:79], v[88:91], a[92:95]
    v_mfma_f32_16x16x32_bf16 a[96:99], v[48:51], v[92:95], a[96:99]
    buffer_load_dwordx4 v140, s[8:11], s15 offen offset:3072 lds
    v_mfma_f32_16x16x32_bf16 a[100:103], v[52:55], v[92:95], a[100:103]
    v_mfma_f32_16x16x32_bf16 a[104:107], v[56:59], v[92:95], a[104:107]
    v_mfma_f32_16x16x32_bf16 a[108:111], v[60:63], v[92:95], a[108:111]
    s_add_u32 s15, s15, s17
    v_mfma_f32_16x16x32_bf16 a[112:115], v[64:67], v[92:95], a[112:115]
    v_mfma_f32_16x16x32_bf16 a[116:119], v[68:71], v[92:95], a[116:119]
    v_mfma_f32_16x16x32_bf16 a[120:123], v[72:75], v[92:95], a[120:123]
    v_mfma_f32_16x16x32_bf16 a[124:127], v[76:79], v[92:95], a[124:127]
    s_waitcnt lgkmcnt(0)
    v_mfma_f32_16x16x32_bf16 a[0:3], v[0:3], v[32:35], a[0:3]
    s_waitcnt vmcnt(12)
    s_barrier
    ds_read_b128 v[80:83], v136 offset:24576
    s_add_u32 m0, s20, 16384
    s_nop 0
    v_mfma_f32_16x16x32_bf16 a[4:7], v[4:7], v[32:35], a[4:7]
    ds_read_b64_tr_b16 v[48:49], v128 offset:49152
    v_mfma_f32_16x16x32_bf16 a[8:11], v[8:11], v[32:35], a[8:11]
    ds_read_b64_tr_b16 v[50:51], v128 offset:57344
    v_mfma_f32_16x16x32_bf16 a[12:15], v[12:15], v[32:35], a[12:15]
    ds_read_b64_tr_b16 v[52:53], v129 offset:49152
    buffer_load_dwordx4 v141, s[4:7], s16 offen offset:0 sc1 lds
    v_mfma_f32_16x16x32_bf16 a[16:19], v[16:19], v[32:35], a[16:19]
    ds_read_b64_tr_b16 v[54:55], v129 offset:57344
    v_mfma_f32_16x16x32_bf16 a[20:23], v[20:23], v[32:35], a[20:23]
    ds_read_b64_tr_b16 v[56:57], v130 offset:49152
    v_mfma_f32_16x16x32_bf16 a[24:27], v[24:27], v[32:35], a[24:27]
    ds_read_b64_tr_b16 v[58:59], v130 offset:57344
    buffer_load_dwordx4 v142, s[4:7], s16 offen offset:1024 sc1 lds
    v_mfma_f32_16x16x32_bf16 a[28:31], v[28:31], v[32:35], a[28:31]
    ds_read_b64_tr_b16 v[60:61], v131 offset:49152
    v_mfma_f32_16x16x32_bf16 a[32:35], v[0:3], v[36:39], a[32:35]
    ds_read_b64_tr_b16 v[62:63], v131 offset:57344
    v_mfma_f32_16x16x32_bf16 a[36:39], v[4:7], v[36:39], a[36:39]
    ds_read_b64_tr_b16 v[64:65], v132 offset:49152
    s_add_u32 s16, s16, 1024
    v_mfma_f32_16x16x32_bf16 a[40:43], v[8:11], v[36:39], a[40:43]
    ds_read_b64_tr_b16 v[66:67], v132 offset:57344
    v_mfma_f32_16x16x32_bf16 a[44:47], v[12:15], v[36:39], a[44:47]
    ds_read_b64_tr_b16 v[68:69], v133 offset:49152
    v_mfma_f32_16x16x32_bf16 a[48:51], v[16:19], v[36:39], a[48:51]
    ds_read_b64_tr_b16 v[70:71], v133 offset:57344
    s_add_u32 m0, s19, 32768
    s_nop 0
    v_mfma_f32_16x16x32_bf16 a[52:55], v[20:23], v[36:39], a[52:55]
    ds_read_b64_tr_b16 v[72:73], v134 offset:49152
    v_mfma_f32_16x16x32_bf16 a[56:59], v[24:27], v[36:39], a[56:59]
    ds_read_b64_tr_b16 v[74:75], v134 offset:57344
    v_mfma_f32_16x16x32_bf16 a[60:63], v[28:31], v[36:39], a[60:63]
    ds_read_b64_tr_b16 v[76:77], v135 offset:49152
    buffer_load_dwordx4 v137, s[8:11], s15 offen offset:0 lds
    v_mfma_f32_16x16x32_bf16 a[64:67], v[0:3], v[40:43], a[64:67]
    ds_read_b64_tr_b16 v[78:79], v135 offset:57344
    v_mfma_f32_16x16x32_bf16 a[68:71], v[4:7], v[40:43], a[68:71]
    ds_read_b128 v[84:87], v136 offset:25600
    v_mfma_f32_16x16x32_bf16 a[72:75], v[8:11], v[40:43], a[72:75]
    ds_read_b128 v[88:91], v136 offset:26624
    buffer_load_dwordx4 v138, s[8:11], s15 offen offset:1024 lds
    v_mfma_f32_16x16x32_bf16 a[76:79], v[12:15], v[40:43], a[76:79]
    ds_read_b128 v[92:95], v136 offset:27648
    v_mfma_f32_16x16x32_bf16 a[80:83], v[16:19], v[40:43], a[80:83]
    v_mfma_f32_16x16x32_bf16 a[84:87], v[20:23], v[40:43], a[84:87]
    buffer_load_dwordx4 v139, s[8:11], s15 offen offset:2048 lds
    v_mfma_f32_16x16x32_bf16 a[88:91], v[24:27], v[40:43], a[88:91]
    v_mfma_f32_16x16x32_bf16 a[92:95], v[28:31], v[40:43], a[92:95]
    v_mfma_f32_16x16x32_bf16 a[96:99], v[0:3], v[44:47], a[96:99]
    buffer_load_dwordx4 v140, s[8:11], s15 offen offset:3072 lds
    v_mfma_f32_16x16x32_bf16 a[100:103], v[4:7], v[44:47], a[100:103]
    v_mfma_f32_16x16x32_bf16 a[104:107], v[8:11], v[44:47], a[104:107]
    v_mfma_f32_16x16x32_bf16 a[108:111], v[12:15], v[44:47], a[108:111]
    s_add_u32 s15, s15, s17
    v_mfma_f32_16x16x32_bf16 a[112:115], v[16:19], v[44:47], a[112:115]
    v_mfma_f32_16x16x32_bf16 a[116:119], v[20:23], v[44:47], a[116:119]
    v_mfma_f32_16x16x32_bf16 a[120:123], v[24:27], v[44:47], a[120:123]
    v_mfma_f32_16x16x32_bf16 a[124:127], v[28:31], v[44:47], a[124:127]
    s_waitcnt lgkmcnt(0)
    v_mfma_f32_16x16x32_bf16 a[0:3], v[48:51], v[80:83], a[0:3]
    s_waitcnt vmcnt(12)
    s_barrier
    ds_read_b128 v[32:35], v136 offset:0
    s_add_u32 m0, s20, 24576
    s_nop 0
    v_mfma_f32_16x16x32_bf16 a[4:7], v[52:55], v[80:83], a[4:7]
    ds_read_b64_tr_b16 v[0:1], v128 offset:0
    v_mfma_f32_16x16x32_bf16 a[8:11], v[56:59], v[80:83], a[8:11]
    ds_read_b64_tr_b16 v[2:3], v128 offset:8192
    v_mfma_f32_16x16x32_bf16 a[12:15], v[60:63], v[80:83], a[12:15]
    ds_read_b64_tr_b16 v[4:5], v129 offset:0
    buffer_load_dwordx4 v141, s[4:7], s16 offen offset:0 sc1 lds
    v_mfma_f32_16x16x32_bf16 a[16:19], v[64:67], v[80:83], a[16:19]
    ds_read_b64_tr_b16 v[6:7], v129 offset:8192
    v_mfma_f32_16x16x32_bf16 a[20:23], v[68:71], v[80:83], a[20:23]
    ds_read_b64_tr_b16 v[8:9], v130 offset:0
    v_mfma_f32_16x16x32_bf16 a[24:27], v[72:75], v[80:83], a[24:27]
    ds_read_b64_tr_b16 v[10:11], v130 offset:8192
    buffer_load_dwordx4 v142, s[4:7], s16 offen offset:1024 sc1 lds
    v_mfma_f32_16x16x32_bf16 a[28:31], v[76:79], v[80:83], a[28:31]
    ds_read_b64_tr_b16 v[12:13], v131 offset:0
    v_mfma_f32_16x16x32_bf16 a[32:35], v[48:51], v[84:87], a[32:35]
    ds_read_b64_tr_b16 v[14:15], v131 offset:8192
    v_mfma_f32_16x16x32_bf16 a[36:39], v[52:55], v[84:87], a[36:39]
    ds_read_b64_tr_b16 v[16:17], v132 offset:0
    s_add_u32 s16, s16, 1024
    v_mfma_f32_16x16x32_bf16 a[40:43], v[56:59], v[84:87], a[40:43]
    ds_read_b64_tr_b16 v[18:19], v132 offset:8192
    v_mfma_f32_16x16x32_bf16 a[44:47], v[60:63], v[84:87], a[44:47]
    ds_read_b64_tr_b16 v[20:21], v133 offset:0
    v_mfma_f32_16x16x32_bf16 a[48:51], v[64:67], v[84:87], a[48:51]
    ds_read_b64_tr_b16 v[22:23], v133 offset:8192
    s_add_u32 m0, s19, 49152
    s_nop 0
    v_mfma_f32_16x16x32_bf16 a[52:55], v[68:71], v[84:87], a[52:55]
    ds_read_b64_tr_b16 v[24:25], v134 offset:0
    v_mfma_f32_16x16x32_bf16 a[56:59], v[72:75], v[84:87], a[56:59]
    ds_read_b64_tr_b16 v[26:27], v134 offset:8192
    v_mfma_f32_16x16x32_bf16 a[60:63], v[76:79], v[84:87], a[60:63]
    ds_read_b64_tr_b16 v[28:29], v135 offset:0
    buffer_load_dwordx4 v137, s[8:11], s15 offen offset:0 lds
    v_mfma_f32_16x16x32_bf16 a[64:67], v[48:51], v[88:91], a[64:67]
    ds_read_b64_tr_b16 v[30:31], v135 offset:8192
    v_mfma_f32_16x16x32_bf16 a[68:71], v[52:55], v[88:91], a[68:71]
    ds_read_b128 v[36:39], v136 offset:1024
    v_mfma_f32_16x16x32_bf16 a[72:75], v[56:59], v[88:91], a[72:75]
    ds_read_b128 v[40:43], v136 offset:2048
    buffer_load_dwordx4 v138, s[8:11], s15 offen offset:1024 lds
    v_mfma_f32_16x16x32_bf16 a[76:79], v[60:63], v[88:91], a[76:79]
    ds_read_b128 v[44:47], v136 offset:3072
    v_mfma_f32_16x16x32_bf16 a[80:83], v[64:67], v[88:91], a[80:83]
    v_mfma_f32_16x16x32_bf16 a[84:87], v[68:71], v[88:91], a[84:87]
    buffer_load_dwordx4 v139, s[8:11], s15 offen offset:2048 lds
    v_mfma_f32_16x16x32_bf16 a[88:91], v[72:75], v[88:91], a[88:91]
    v_mfma_f32_16x16x32_bf16 a[92:95], v[76:79], v[88:91], a[92:95]
    v_mfma_f32_16x16x32_bf16 a[96:99], v[48:51], v[92:95], a[96:99]
    buffer_load_dwordx4 v140, s[8:11], s15 offen offset:3072 lds
    v_mfma_f32_16x16x32_bf16 a[100:103], v[52:55], v[92:95], a[100:103]
    v_mfma_f32_16x16x32_bf16 a[104:107], v[56:59], v[92:95], a[104:107]
    v_mfma_f32_16x16x32_bf16 a[108:111], v[60:63], v[92:95], a[108:111]
    s_add_u32 s15, s15, s17
    v_mfma_f32_16x16x32_bf16 a[112:115], v[64:67], v[92:95], a[112:115]
    v_mfma_f32_16x16x32_bf16 a[116:119], v[68:71], v[92:95], a[116:119]
    v_mfma_f32_16x16x32_bf16 a[120:123], v[72:75], v[92:95], a[120:123]
    v_mfma_f32_16x16x32_bf16 a[124:127], v[76:79], v[92:95], a[124:127]
    s_sub_u32 s18, s18, 1
    s_cmp_lg_u32 s18, 0
    s_cbranch_scc1 main_kernel_w_c1_n_loop
    s_cmp_lg_u32 s14, 0
    s_cbranch_scc1 main_kernel_w_c1_n_nt
    s_lshl_b32 s32, s27, 8
    s_add_u32 s32, s32, 0x841e000
    v_mov_b32 v255, 1
    s_mov_b64 exec, 1
    buffer_atomic_add v255, off, s[4:7], s32 sc0 sc1
    s_mov_b64 exec, -1
main_kernel_w_c1_n_nt:
    s_waitcnt lgkmcnt(0)
    v_mfma_f32_16x16x32_bf16 a[0:3], v[0:3], v[32:35], a[0:3]
    s_waitcnt vmcnt(12)
    s_barrier
    ds_read_b128 v[80:83], v136 offset:8192
    v_mfma_f32_16x16x32_bf16 a[4:7], v[4:7], v[32:35], a[4:7]
    ds_read_b64_tr_b16 v[48:49], v128 offset:16384
    v_mfma_f32_16x16x32_bf16 a[8:11], v[8:11], v[32:35], a[8:11]
    ds_read_b64_tr_b16 v[50:51], v128 offset:24576
    v_mfma_f32_16x16x32_bf16 a[12:15], v[12:15], v[32:35], a[12:15]
    ds_read_b64_tr_b16 v[52:53], v129 offset:16384
    v_mfma_f32_16x16x32_bf16 a[16:19], v[16:19], v[32:35], a[16:19]
    ds_read_b64_tr_b16 v[54:55], v129 offset:24576
    v_mfma_f32_16x16x32_bf16 a[20:23], v[20:23], v[32:35], a[20:23]
    ds_read_b64_tr_b16 v[56:57], v130 offset:16384
    v_mfma_f32_16x16x32_bf16 a[24:27], v[24:27], v[32:35], a[24:27]
    ds_read_b64_tr_b16 v[58:59], v130 offset:24576
    v_mfma_f32_16x16x32_bf16 a[28:31], v[28:31], v[32:35], a[28:31]
    ds_read_b64_tr_b16 v[60:61], v131 offset:16384
    v_mfma_f32_16x16x32_bf16 a[32:35], v[0:3], v[36:39], a[32:35]
    ds_read_b64_tr_b16 v[62:63], v131 offset:24576
    v_mfma_f32_16x16x32_bf16 a[36:39], v[4:7], v[36:39], a[36:39]
    ds_read_b64_tr_b16 v[64:65], v132 offset:16384
    v_mfma_f32_16x16x32_bf16 a[40:43], v[8:11], v[36:39], a[40:43]
    ds_read_b64_tr_b16 v[66:67], v132 offset:24576
    v_mfma_f32_16x16x32_bf16 a[44:47], v[12:15], v[36:39], a[44:47]
    ds_read_b64_tr_b16 v[68:69], v133 offset:16384
    v_mfma_f32_16x16x32_bf16 a[48:51], v[16:19], v[36:39], a[48:51]
    ds_read_b64_tr_b16 v[70:71], v133 offset:24576
    v_mfma_f32_16x16x32_bf16 a[52:55], v[20:23], v[36:39], a[52:55]
    ds_read_b64_tr_b16 v[72:73], v134 offset:16384
    v_mfma_f32_16x16x32_bf16 a[56:59], v[24:27], v[36:39], a[56:59]
    ds_read_b64_tr_b16 v[74:75], v134 offset:24576
    v_mfma_f32_16x16x32_bf16 a[60:63], v[28:31], v[36:39], a[60:63]
    ds_read_b64_tr_b16 v[76:77], v135 offset:16384
    v_mfma_f32_16x16x32_bf16 a[64:67], v[0:3], v[40:43], a[64:67]
    ds_read_b64_tr_b16 v[78:79], v135 offset:24576
    v_mfma_f32_16x16x32_bf16 a[68:71], v[4:7], v[40:43], a[68:71]
    ds_read_b128 v[84:87], v136 offset:9216
    v_mfma_f32_16x16x32_bf16 a[72:75], v[8:11], v[40:43], a[72:75]
    ds_read_b128 v[88:91], v136 offset:10240
    v_mfma_f32_16x16x32_bf16 a[76:79], v[12:15], v[40:43], a[76:79]
    ds_read_b128 v[92:95], v136 offset:11264
    v_mfma_f32_16x16x32_bf16 a[80:83], v[16:19], v[40:43], a[80:83]
    v_mfma_f32_16x16x32_bf16 a[84:87], v[20:23], v[40:43], a[84:87]
    v_mfma_f32_16x16x32_bf16 a[88:91], v[24:27], v[40:43], a[88:91]
    v_mfma_f32_16x16x32_bf16 a[92:95], v[28:31], v[40:43], a[92:95]
    v_mfma_f32_16x16x32_bf16 a[96:99], v[0:3], v[44:47], a[96:99]
    v_mfma_f32_16x16x32_bf16 a[100:103], v[4:7], v[44:47], a[100:103]
    v_mfma_f32_16x16x32_bf16 a[104:107], v[8:11], v[44:47], a[104:107]
    v_mfma_f32_16x16x32_bf16 a[108:111], v[12:15], v[44:47], a[108:111]
    v_mfma_f32_16x16x32_bf16 a[112:115], v[16:19], v[44:47], a[112:115]
    v_mfma_f32_16x16x32_bf16 a[116:119], v[20:23], v[44:47], a[116:119]
    v_mfma_f32_16x16x32_bf16 a[120:123], v[24:27], v[44:47], a[120:123]
    v_mfma_f32_16x16x32_bf16 a[124:127], v[28:31], v[44:47], a[124:127]
    s_waitcnt lgkmcnt(0)
    v_mfma_f32_16x16x32_bf16 a[0:3], v[48:51], v[80:83], a[0:3]
    s_waitcnt vmcnt(6)
    s_barrier
    ds_read_b128 v[32:35], v136 offset:16384
    v_mfma_f32_16x16x32_bf16 a[4:7], v[52:55], v[80:83], a[4:7]
    ds_read_b64_tr_b16 v[0:1], v128 offset:32768
    v_mfma_f32_16x16x32_bf16 a[8:11], v[56:59], v[80:83], a[8:11]
    ds_read_b64_tr_b16 v[2:3], v128 offset:40960
    v_mfma_f32_16x16x32_bf16 a[12:15], v[60:63], v[80:83], a[12:15]
    ds_read_b64_tr_b16 v[4:5], v129 offset:32768
    v_mfma_f32_16x16x32_bf16 a[16:19], v[64:67], v[80:83], a[16:19]
    ds_read_b64_tr_b16 v[6:7], v129 offset:40960
    v_mfma_f32_16x16x32_bf16 a[20:23], v[68:71], v[80:83], a[20:23]
    ds_read_b64_tr_b16 v[8:9], v130 offset:32768
    v_mfma_f32_16x16x32_bf16 a[24:27], v[72:75], v[80:83], a[24:27]
    ds_read_b64_tr_b16 v[10:11], v130 offset:40960
    v_mfma_f32_16x16x32_bf16 a[28:31], v[76:79], v[80:83], a[28:31]
    ds_read_b64_tr_b16 v[12:13], v131 offset:32768
    v_mfma_f32_16x16x32_bf16 a[32:35], v[48:51], v[84:87], a[32:35]
    ds_read_b64_tr_b16 v[14:15], v131 offset:40960
    v_mfma_f32_16x16x32_bf16 a[36:39], v[52:55], v[84:87], a[36:39]
    ds_read_b64_tr_b16 v[16:17], v132 offset:32768
    v_mfma_f32_16x16x32_bf16 a[40:43], v[56:59], v[84:87], a[40:43]
    ds_read_b64_tr_b16 v[18:19], v132 offset:40960
    v_mfma_f32_16x16x32_bf16 a[44:47], v[60:63], v[84:87], a[44:47]
    ds_read_b64_tr_b16 v[20:21], v133 offset:32768
    v_mfma_f32_16x16x32_bf16 a[48:51], v[64:67], v[84:87], a[48:51]
    ds_read_b64_tr_b16 v[22:23], v133 offset:40960
    v_mfma_f32_16x16x32_bf16 a[52:55], v[68:71], v[84:87], a[52:55]
    ds_read_b64_tr_b16 v[24:25], v134 offset:32768
    v_mfma_f32_16x16x32_bf16 a[56:59], v[72:75], v[84:87], a[56:59]
    ds_read_b64_tr_b16 v[26:27], v134 offset:40960
    v_mfma_f32_16x16x32_bf16 a[60:63], v[76:79], v[84:87], a[60:63]
    ds_read_b64_tr_b16 v[28:29], v135 offset:32768
    v_mfma_f32_16x16x32_bf16 a[64:67], v[48:51], v[88:91], a[64:67]
    ds_read_b64_tr_b16 v[30:31], v135 offset:40960
    v_mfma_f32_16x16x32_bf16 a[68:71], v[52:55], v[88:91], a[68:71]
    ds_read_b128 v[36:39], v136 offset:17408
    v_mfma_f32_16x16x32_bf16 a[72:75], v[56:59], v[88:91], a[72:75]
    ds_read_b128 v[40:43], v136 offset:18432
    v_mfma_f32_16x16x32_bf16 a[76:79], v[60:63], v[88:91], a[76:79]
    ds_read_b128 v[44:47], v136 offset:19456
    v_mfma_f32_16x16x32_bf16 a[80:83], v[64:67], v[88:91], a[80:83]
    v_mfma_f32_16x16x32_bf16 a[84:87], v[68:71], v[88:91], a[84:87]
    v_mfma_f32_16x16x32_bf16 a[88:91], v[72:75], v[88:91], a[88:91]
    v_mfma_f32_16x16x32_bf16 a[92:95], v[76:79], v[88:91], a[92:95]
    v_mfma_f32_16x16x32_bf16 a[96:99], v[48:51], v[92:95], a[96:99]
    v_mfma_f32_16x16x32_bf16 a[100:103], v[52:55], v[92:95], a[100:103]
    v_mfma_f32_16x16x32_bf16 a[104:107], v[56:59], v[92:95], a[104:107]
    v_mfma_f32_16x16x32_bf16 a[108:111], v[60:63], v[92:95], a[108:111]
    v_mfma_f32_16x16x32_bf16 a[112:115], v[64:67], v[92:95], a[112:115]
    v_mfma_f32_16x16x32_bf16 a[116:119], v[68:71], v[92:95], a[116:119]
    v_mfma_f32_16x16x32_bf16 a[120:123], v[72:75], v[92:95], a[120:123]
    v_mfma_f32_16x16x32_bf16 a[124:127], v[76:79], v[92:95], a[124:127]
    s_waitcnt lgkmcnt(0)
    v_mfma_f32_16x16x32_bf16 a[0:3], v[0:3], v[32:35], a[0:3]
    s_waitcnt vmcnt(0)
    s_barrier
    ds_read_b128 v[80:83], v136 offset:24576
    v_mfma_f32_16x16x32_bf16 a[4:7], v[4:7], v[32:35], a[4:7]
    ds_read_b64_tr_b16 v[48:49], v128 offset:49152
    v_mfma_f32_16x16x32_bf16 a[8:11], v[8:11], v[32:35], a[8:11]
    ds_read_b64_tr_b16 v[50:51], v128 offset:57344
    v_mfma_f32_16x16x32_bf16 a[12:15], v[12:15], v[32:35], a[12:15]
    ds_read_b64_tr_b16 v[52:53], v129 offset:49152
    v_mfma_f32_16x16x32_bf16 a[16:19], v[16:19], v[32:35], a[16:19]
    ds_read_b64_tr_b16 v[54:55], v129 offset:57344
    v_mfma_f32_16x16x32_bf16 a[20:23], v[20:23], v[32:35], a[20:23]
    ds_read_b64_tr_b16 v[56:57], v130 offset:49152
    v_mfma_f32_16x16x32_bf16 a[24:27], v[24:27], v[32:35], a[24:27]
    ds_read_b64_tr_b16 v[58:59], v130 offset:57344
    v_mfma_f32_16x16x32_bf16 a[28:31], v[28:31], v[32:35], a[28:31]
    ds_read_b64_tr_b16 v[60:61], v131 offset:49152
    v_mfma_f32_16x16x32_bf16 a[32:35], v[0:3], v[36:39], a[32:35]
    ds_read_b64_tr_b16 v[62:63], v131 offset:57344
    v_mfma_f32_16x16x32_bf16 a[36:39], v[4:7], v[36:39], a[36:39]
    ds_read_b64_tr_b16 v[64:65], v132 offset:49152
    v_mfma_f32_16x16x32_bf16 a[40:43], v[8:11], v[36:39], a[40:43]
    ds_read_b64_tr_b16 v[66:67], v132 offset:57344
    v_mfma_f32_16x16x32_bf16 a[44:47], v[12:15], v[36:39], a[44:47]
    ds_read_b64_tr_b16 v[68:69], v133 offset:49152
    v_mfma_f32_16x16x32_bf16 a[48:51], v[16:19], v[36:39], a[48:51]
    ds_read_b64_tr_b16 v[70:71], v133 offset:57344
    v_mfma_f32_16x16x32_bf16 a[52:55], v[20:23], v[36:39], a[52:55]
    ds_read_b64_tr_b16 v[72:73], v134 offset:49152
    v_mfma_f32_16x16x32_bf16 a[56:59], v[24:27], v[36:39], a[56:59]
    ds_read_b64_tr_b16 v[74:75], v134 offset:57344
    v_mfma_f32_16x16x32_bf16 a[60:63], v[28:31], v[36:39], a[60:63]
    ds_read_b64_tr_b16 v[76:77], v135 offset:49152
    v_mfma_f32_16x16x32_bf16 a[64:67], v[0:3], v[40:43], a[64:67]
    ds_read_b64_tr_b16 v[78:79], v135 offset:57344
    v_mfma_f32_16x16x32_bf16 a[68:71], v[4:7], v[40:43], a[68:71]
    ds_read_b128 v[84:87], v136 offset:25600
    v_mfma_f32_16x16x32_bf16 a[72:75], v[8:11], v[40:43], a[72:75]
    ds_read_b128 v[88:91], v136 offset:26624
    v_mfma_f32_16x16x32_bf16 a[76:79], v[12:15], v[40:43], a[76:79]
    ds_read_b128 v[92:95], v136 offset:27648
    v_mfma_f32_16x16x32_bf16 a[80:83], v[16:19], v[40:43], a[80:83]
    v_mfma_f32_16x16x32_bf16 a[84:87], v[20:23], v[40:43], a[84:87]
    v_mfma_f32_16x16x32_bf16 a[88:91], v[24:27], v[40:43], a[88:91]
    v_mfma_f32_16x16x32_bf16 a[92:95], v[28:31], v[40:43], a[92:95]
    v_mfma_f32_16x16x32_bf16 a[96:99], v[0:3], v[44:47], a[96:99]
    v_mfma_f32_16x16x32_bf16 a[100:103], v[4:7], v[44:47], a[100:103]
    v_mfma_f32_16x16x32_bf16 a[104:107], v[8:11], v[44:47], a[104:107]
    v_mfma_f32_16x16x32_bf16 a[108:111], v[12:15], v[44:47], a[108:111]
    v_mfma_f32_16x16x32_bf16 a[112:115], v[16:19], v[44:47], a[112:115]
    v_mfma_f32_16x16x32_bf16 a[116:119], v[20:23], v[44:47], a[116:119]
    v_mfma_f32_16x16x32_bf16 a[120:123], v[24:27], v[44:47], a[120:123]
    v_mfma_f32_16x16x32_bf16 a[124:127], v[28:31], v[44:47], a[124:127]
    v_readfirstlane_b32 s55, v255
    s_waitcnt lgkmcnt(0)
    v_mfma_f32_16x16x32_bf16 a[0:3], v[48:51], v[80:83], a[0:3]
    v_mfma_f32_16x16x32_bf16 a[4:7], v[52:55], v[80:83], a[4:7]
    v_mfma_f32_16x16x32_bf16 a[8:11], v[56:59], v[80:83], a[8:11]
    v_mfma_f32_16x16x32_bf16 a[12:15], v[60:63], v[80:83], a[12:15]
    v_mfma_f32_16x16x32_bf16 a[16:19], v[64:67], v[80:83], a[16:19]
    v_mfma_f32_16x16x32_bf16 a[20:23], v[68:71], v[80:83], a[20:23]
    v_mfma_f32_16x16x32_bf16 a[24:27], v[72:75], v[80:83], a[24:27]
    v_mfma_f32_16x16x32_bf16 a[28:31], v[76:79], v[80:83], a[28:31]
    v_mfma_f32_16x16x32_bf16 a[32:35], v[48:51], v[84:87], a[32:35]
    v_mfma_f32_16x16x32_bf16 a[36:39], v[52:55], v[84:87], a[36:39]
    v_mfma_f32_16x16x32_bf16 a[40:43], v[56:59], v[84:87], a[40:43]
    v_mfma_f32_16x16x32_bf16 a[44:47], v[60:63], v[84:87], a[44:47]
    v_mfma_f32_16x16x32_bf16 a[48:51], v[64:67], v[84:87], a[48:51]
    v_mfma_f32_16x16x32_bf16 a[52:55], v[68:71], v[84:87], a[52:55]
    v_mfma_f32_16x16x32_bf16 a[56:59], v[72:75], v[84:87], a[56:59]
    v_mfma_f32_16x16x32_bf16 a[60:63], v[76:79], v[84:87], a[60:63]
    v_mfma_f32_16x16x32_bf16 a[64:67], v[48:51], v[88:91], a[64:67]
    v_mfma_f32_16x16x32_bf16 a[68:71], v[52:55], v[88:91], a[68:71]
    v_mfma_f32_16x16x32_bf16 a[72:75], v[56:59], v[88:91], a[72:75]
    v_mfma_f32_16x16x32_bf16 a[76:79], v[60:63], v[88:91], a[76:79]
    v_mfma_f32_16x16x32_bf16 a[80:83], v[64:67], v[88:91], a[80:83]
    v_mfma_f32_16x16x32_bf16 a[84:87], v[68:71], v[88:91], a[84:87]
    v_mfma_f32_16x16x32_bf16 a[88:91], v[72:75], v[88:91], a[88:91]
    v_mfma_f32_16x16x32_bf16 a[92:95], v[76:79], v[88:91], a[92:95]
    v_mfma_f32_16x16x32_bf16 a[96:99], v[48:51], v[92:95], a[96:99]
    v_mfma_f32_16x16x32_bf16 a[100:103], v[52:55], v[92:95], a[100:103]
    v_mfma_f32_16x16x32_bf16 a[104:107], v[56:59], v[92:95], a[104:107]
    v_mfma_f32_16x16x32_bf16 a[108:111], v[60:63], v[92:95], a[108:111]
    v_mfma_f32_16x16x32_bf16 a[112:115], v[64:67], v[92:95], a[112:115]
    v_mfma_f32_16x16x32_bf16 a[116:119], v[68:71], v[92:95], a[116:119]
    v_mfma_f32_16x16x32_bf16 a[120:123], v[72:75], v[92:95], a[120:123]
    v_mfma_f32_16x16x32_bf16 a[124:127], v[76:79], v[92:95], a[124:127]
    s_nop 7
    s_cmp_eq_u32 s23, 1
    s_cbranch_scc1 main_kernel_w_c1_escl
    s_cmp_eq_u32 s23, 3
    s_cbranch_scc1 main_kernel_w_c1_egelus
    s_cmp_eq_u32 s23, 6
    s_cbranch_scc1 main_kernel_w_c1_egelu
main_kernel_w_c1_eplain:
    s_mov_b32 s53, s21
    v_accvgpr_read_b32 v0, a0
    v_accvgpr_read_b32 v1, a1
    v_accvgpr_read_b32 v2, a2
    v_accvgpr_read_b32 v3, a3
    v_accvgpr_read_b32 v4, a4
    v_accvgpr_read_b32 v5, a5
    v_accvgpr_read_b32 v6, a6
    v_accvgpr_read_b32 v7, a7
    v_cvt_pk_bf16_f32 v16, v0, v1
    v_cvt_pk_bf16_f32 v17, v2, v3
    v_cvt_pk_bf16_f32 v18, v4, v5
    v_cvt_pk_bf16_f32 v19, v6, v7
    buffer_store_dwordx4 v[16:19], v251, s[4:7], s53 offen offset:0 sc1
    v_accvgpr_read_b32 v20, a8
    v_accvgpr_read_b32 v21, a9
    v_accvgpr_read_b32 v22, a10
    v_accvgpr_read_b32 v23, a11
    v_accvgpr_read_b32 v24, a12
    v_accvgpr_read_b32 v25, a13
    v_accvgpr_read_b32 v26, a14
    v_accvgpr_read_b32 v27, a15
    v_cvt_pk_bf16_f32 v36, v20, v21
    v_cvt_pk_bf16_f32 v37, v22, v23
    v_cvt_pk_bf16_f32 v38, v24, v25
    v_cvt_pk_bf16_f32 v39, v26, v27
    buffer_store_dwordx4 v[36:39], v251, s[4:7], s53 offen offset:1024 sc1
    v_accvgpr_read_b32 v40, a16
    v_accvgpr_read_b32 v41, a17
    v_accvgpr_read_b32 v42, a18
    v_accvgpr_read_b32 v43, a19
    v_accvgpr_read_b32 v44, a20
    v_accvgpr_read_b32 v45, a21
    v_accvgpr_read_b32 v46, a22
    v_accvgpr_read_b32 v47, a23
    v_cvt_pk_bf16_f32 v56, v40, v41
    v_cvt_pk_bf16_f32 v57, v42, v43
    v_cvt_pk_bf16_f32 v58, v44, v45
    v_cvt_pk_bf16_f32 v59, v46, v47
    buffer_store_dwordx4 v[56:59], v251, s[4:7], s53 offen offset:2048 sc1
    v_accvgpr_read_b32 v0, a24
    v_accvgpr_read_b32 v1, a25
    v_accvgpr_read_b32 v2, a26
    v_accvgpr_read_b32 v3, a27
    v_accvgpr_read_b32 v4, a28
    v_accvgpr_read_b32 v5, a29
    v_accvgpr_read_b32 v6, a30
    v_accvgpr_read_b32 v7, a31
    v_cvt_pk_bf16_f32 v16, v0, v1
    v_cvt_pk_bf16_f32 v17, v2, v3
    v_cvt_pk_bf16_f32 v18, v4, v5
    v_cvt_pk_bf16_f32 v19, v6, v7
    buffer_store_dwordx4 v[16:19], v251, s[4:7], s53 offen offset:3072 sc1
    s_add_u32 s53, s53, s22
    v_accvgpr_read_b32 v20, a32
    v_accvgpr_read_b32 v21, a33
    v_accvgpr_read_b32 v22, a34
    v_accvgpr_read_b32 v23, a35
    v_accvgpr_read_b32 v24, a36
    v_accvgpr_read_b32 v25, a37
    v_accvgpr_read_b32 v26, a38
    v_accvgpr_read_b32 v27, a39
    v_cvt_pk_bf16_f32 v36, v20, v21
    v_cvt_pk_bf16_f32 v37, v22, v23
    v_cvt_pk_bf16_f32 v38, v24, v25
    v_cvt_pk_bf16_f32 v39, v26, v27
    buffer_store_dwordx4 v[36:39], v251, s[4:7], s53 offen offset:0 sc1
    v_accvgpr_read_b32 v40, a40
    v_accvgpr_read_b32 v41, a41
    v_accvgpr_read_b32 v42, a42
    v_accvgpr_read_b32 v43, a43
    v_accvgpr_read_b32 v44, a44
    v_accvgpr_read_b32 v45, a45
    v_accvgpr_read_b32 v46, a46
    v_accvgpr_read_b32 v47, a47
    v_cvt_pk_bf16_f32 v56, v40, v41
    v_cvt_pk_bf16_f32 v57, v42, v43
    v_cvt_pk_bf16_f32 v58, v44, v45
    v_cvt_pk_bf16_f32 v59, v46, v47
    buffer_store_dwordx4 v[56:59], v251, s[4:7], s53 offen offset:1024 sc1
    v_accvgpr_read_b32 v0, a48
    v_accvgpr_read_b32 v1, a49
    v_accvgpr_read_b32 v2, a50
    v_accvgpr_read_b32 v3, a51
    v_accvgpr_read_b32 v4, a52
    v_accvgpr_read_b32 v5, a53
    v_accvgpr_read_b32 v6, a54
    v_accvgpr_read_b32 v7, a55
    v_cvt_pk_bf16_f32 v16, v0, v1
    v_cvt_pk_bf16_f32 v17, v2, v3
    v_cvt_pk_bf16_f32 v18, v4, v5
    v_cvt_pk_bf16_f32 v19, v6, v7
    buffer_store_dwordx4 v[16:19], v251, s[4:7], s53 offen offset:2048 sc1
    v_accvgpr_read_b32 v20, a56
    v_accvgpr_read_b32 v21, a57
    v_accvgpr_read_b32 v22, a58
    v_accvgpr_read_b32 v23, a59
    v_accvgpr_read_b32 v24, a60
    v_accvgpr_read_b32 v25, a61
    v_accvgpr_read_b32 v26, a62
    v_accvgpr_read_b32 v27, a63
    v_cvt_pk_bf16_f32 v36, v20, v21
    v_cvt_pk_bf16_f32 v37, v22, v23
    v_cvt_pk_bf16_f32 v38, v24, v25
    v_cvt_pk_bf16_f32 v39, v26, v27
    buffer_store_dwordx4 v[36:39], v251, s[4:7], s53 offen offset:3072 sc1
    s_add_u32 s53, s53, s22
    v_accvgpr_read_b32 v40, a64
    v_accvgpr_read_b32 v41, a65
    v_accvgpr_read_b32 v42, a66
    v_accvgpr_read_b32 v43, a67
    v_accvgpr_read_b32 v44, a68
    v_accvgpr_read_b32 v45, a69
    v_accvgpr_read_b32 v46, a70
    v_accvgpr_read_b32 v47, a71
    v_cvt_pk_bf16_f32 v56, v40, v41
    v_cvt_pk_bf16_f32 v57, v42, v43
    v_cvt_pk_bf16_f32 v58, v44, v45
    v_cvt_pk_bf16_f32 v59, v46, v47
    buffer_store_dwordx4 v[56:59], v251, s[4:7], s53 offen offset:0 sc1
    v_accvgpr_read_b32 v0, a72
    v_accvgpr_read_b32 v1, a73
    v_accvgpr_read_b32 v2, a74
    v_accvgpr_read_b32 v3, a75
    v_accvgpr_read_b32 v4, a76
    v_accvgpr_read_b32 v5, a77
    v_accvgpr_read_b32 v6, a78
    v_accvgpr_read_b32 v7, a79
    v_cvt_pk_bf16_f32 v16, v0, v1
    v_cvt_pk_bf16_f32 v17, v2, v3
    v_cvt_pk_bf16_f32 v18, v4, v5
    v_cvt_pk_bf16_f32 v19, v6, v7
    buffer_store_dwordx4 v[16:19], v251, s[4:7], s53 offen offset:1024 sc1
    v_accvgpr_read_b32 v20, a80
    v_accvgpr_read_b32 v21, a81
    v_accvgpr_read_b32 v22, a82
    v_accvgpr_read_b32 v23, a83
    v_accvgpr_read_b32 v24, a84
    v_accvgpr_read_b32 v25, a85
    v_accvgpr_read_b32 v26, a86
    v_accvgpr_read_b32 v27, a87
    v_cvt_pk_bf16_f32 v36, v20, v21
    v_cvt_pk_bf16_f32 v37, v22, v23
    v_cvt_pk_bf16_f32 v38, v24, v25
    v_cvt_pk_bf16_f32 v39, v26, v27
    buffer_store_dwordx4 v[36:39], v251, s[4:7], s53 offen offset:2048 sc1
    v_accvgpr_read_b32 v40, a88
    v_accvgpr_read_b32 v41, a89
    v_accvgpr_read_b32 v42, a90
    v_accvgpr_read_b32 v43, a91
    v_accvgpr_read_b32 v44, a92
    v_accvgpr_read_b32 v45, a93
    v_accvgpr_read_b32 v46, a94
    v_accvgpr_read_b32 v47, a95
    v_cvt_pk_bf16_f32 v56, v40, v41
    v_cvt_pk_bf16_f32 v57, v42, v43
    v_cvt_pk_bf16_f32 v58, v44, v45
    v_cvt_pk_bf16_f32 v59, v46, v47
    buffer_store_dwordx4 v[56:59], v251, s[4:7], s53 offen offset:3072 sc1
    s_add_u32 s53, s53, s22
    v_accvgpr_read_b32 v0, a96
    v_accvgpr_read_b32 v1, a97
    v_accvgpr_read_b32 v2, a98
    v_accvgpr_read_b32 v3, a99
    v_accvgpr_read_b32 v4, a100
    v_accvgpr_read_b32 v5, a101
    v_accvgpr_read_b32 v6, a102
    v_accvgpr_read_b32 v7, a103
    v_cvt_pk_bf16_f32 v16, v0, v1
    v_cvt_pk_bf16_f32 v17, v2, v3
    v_cvt_pk_bf16_f32 v18, v4, v5
    v_cvt_pk_bf16_f32 v19, v6, v7
    buffer_store_dwordx4 v[16:19], v251, s[4:7], s53 offen offset:0 sc1
    v_accvgpr_read_b32 v20, a104
    v_accvgpr_read_b32 v21, a105
    v_accvgpr_read_b32 v22, a106
    v_accvgpr_read_b32 v23, a107
    v_accvgpr_read_b32 v24, a108
    v_accvgpr_read_b32 v25, a109
    v_accvgpr_read_b32 v26, a110
    v_accvgpr_read_b32 v27, a111
    v_cvt_pk_bf16_f32 v36, v20, v21
    v_cvt_pk_bf16_f32 v37, v22, v23
    v_cvt_pk_bf16_f32 v38, v24, v25
    v_cvt_pk_bf16_f32 v39, v26, v27
    buffer_store_dwordx4 v[36:39], v251, s[4:7], s53 offen offset:1024 sc1
    v_accvgpr_read_b32 v40, a112
    v_accvgpr_read_b32 v41, a113
    v_accvgpr_read_b32 v42, a114
    v_accvgpr_read_b32 v43, a115
    v_accvgpr_read_b32 v44, a116
    v_accvgpr_read_b32 v45, a117
    v_accvgpr_read_b32 v46, a118
    v_accvgpr_read_b32 v47, a119
    v_cvt_pk_bf16_f32 v56, v40, v41
    v_cvt_pk_bf16_f32 v57, v42, v43
    v_cvt_pk_bf16_f32 v58, v44, v45
    v_cvt_pk_bf16_f32 v59, v46, v47
    buffer_store_dwordx4 v[56:59], v251, s[4:7], s53 offen offset:2048 sc1
    v_accvgpr_read_b32 v0, a120
    v_accvgpr_read_b32 v1, a121
    v_accvgpr_read_b32 v2, a122
    v_accvgpr_read_b32 v3, a123
    v_accvgpr_read_b32 v4, a124
    v_accvgpr_read_b32 v5, a125
    v_accvgpr_read_b32 v6, a126
    v_accvgpr_read_b32 v7, a127
    v_cvt_pk_bf16_f32 v16, v0, v1
    v_cvt_pk_bf16_f32 v17, v2, v3
    v_cvt_pk_bf16_f32 v18, v4, v5
    v_cvt_pk_bf16_f32 v19, v6, v7
    buffer_store_dwordx4 v[16:19], v251, s[4:7], s53 offen offset:3072 sc1
    s_branch main_kernel_w_done
main_kernel_w_c1_escl:
    s_mov_b32 s53, s21
    v_accvgpr_read_b32 v0, a0
    v_accvgpr_read_b32 v1, a1
    v_accvgpr_read_b32 v2, a2
    v_accvgpr_read_b32 v3, a3
    v_accvgpr_read_b32 v4, a4
    v_accvgpr_read_b32 v5, a5
    v_accvgpr_read_b32 v6, a6
    v_accvgpr_read_b32 v7, a7
    v_mul_f32 v0, 0x3e0293ee, v0
    v_mul_f32 v1, 0x3e0293ee, v1
    v_mul_f32 v2, 0x3e0293ee, v2
    v_mul_f32 v3, 0x3e0293ee, v3
    v_mul_f32 v4, 0x3e0293ee, v4
    v_mul_f32 v5, 0x3e0293ee, v5
    v_mul_f32 v6, 0x3e0293ee, v6
    v_mul_f32 v7, 0x3e0293ee, v7
    v_cvt_pk_bf16_f32 v16, v0, v1
    v_cvt_pk_bf16_f32 v17, v2, v3
    v_cvt_pk_bf16_f32 v18, v4, v5
    v_cvt_pk_bf16_f32 v19, v6, v7
    buffer_store_dwordx4 v[16:19], v251, s[4:7], s53 offen offset:0 sc1
    v_accvgpr_read_b32 v20, a8
    v_accvgpr_read_b32 v21, a9
    v_accvgpr_read_b32 v22, a10
    v_accvgpr_read_b32 v23, a11
    v_accvgpr_read_b32 v24, a12
    v_accvgpr_read_b32 v25, a13
    v_accvgpr_read_b32 v26, a14
    v_accvgpr_read_b32 v27, a15
    v_mul_f32 v20, 0x3e0293ee, v20
    v_mul_f32 v21, 0x3e0293ee, v21
    v_mul_f32 v22, 0x3e0293ee, v22
    v_mul_f32 v23, 0x3e0293ee, v23
    v_mul_f32 v24, 0x3e0293ee, v24
    v_mul_f32 v25, 0x3e0293ee, v25
    v_mul_f32 v26, 0x3e0293ee, v26
    v_mul_f32 v27, 0x3e0293ee, v27
    v_cvt_pk_bf16_f32 v36, v20, v21
    v_cvt_pk_bf16_f32 v37, v22, v23
    v_cvt_pk_bf16_f32 v38, v24, v25
    v_cvt_pk_bf16_f32 v39, v26, v27
    buffer_store_dwordx4 v[36:39], v251, s[4:7], s53 offen offset:1024 sc1
    v_accvgpr_read_b32 v40, a16
    v_accvgpr_read_b32 v41, a17
    v_accvgpr_read_b32 v42, a18
    v_accvgpr_read_b32 v43, a19
    v_accvgpr_read_b32 v44, a20
    v_accvgpr_read_b32 v45, a21
    v_accvgpr_read_b32 v46, a22
    v_accvgpr_read_b32 v47, a23
    v_mul_f32 v40, 0x3e0293ee, v40
    v_mul_f32 v41, 0x3e0293ee, v41
    v_mul_f32 v42, 0x3e0293ee, v42
    v_mul_f32 v43, 0x3e0293ee, v43
    v_mul_f32 v44, 0x3e0293ee, v44
    v_mul_f32 v45, 0x3e0293ee, v45
    v_mul_f32 v46, 0x3e0293ee, v46
    v_mul_f32 v47, 0x3e0293ee, v47
    v_cvt_pk_bf16_f32 v56, v40, v41
    v_cvt_pk_bf16_f32 v57, v42, v43
    v_cvt_pk_bf16_f32 v58, v44, v45
    v_cvt_pk_bf16_f32 v59, v46, v47
    buffer_store_dwordx4 v[56:59], v251, s[4:7], s53 offen offset:2048 sc1
    v_accvgpr_read_b32 v0, a24
    v_accvgpr_read_b32 v1, a25
    v_accvgpr_read_b32 v2, a26
    v_accvgpr_read_b32 v3, a27
    v_accvgpr_read_b32 v4, a28
    v_accvgpr_read_b32 v5, a29
    v_accvgpr_read_b32 v6, a30
    v_accvgpr_read_b32 v7, a31
    v_mul_f32 v0, 0x3e0293ee, v0
    v_mul_f32 v1, 0x3e0293ee, v1
    v_mul_f32 v2, 0x3e0293ee, v2
    v_mul_f32 v3, 0x3e0293ee, v3
    v_mul_f32 v4, 0x3e0293ee, v4
    v_mul_f32 v5, 0x3e0293ee, v5
    v_mul_f32 v6, 0x3e0293ee, v6
    v_mul_f32 v7, 0x3e0293ee, v7
    v_cvt_pk_bf16_f32 v16, v0, v1
    v_cvt_pk_bf16_f32 v17, v2, v3
    v_cvt_pk_bf16_f32 v18, v4, v5
    v_cvt_pk_bf16_f32 v19, v6, v7
    buffer_store_dwordx4 v[16:19], v251, s[4:7], s53 offen offset:3072 sc1
    s_add_u32 s53, s53, s22
    v_accvgpr_read_b32 v20, a32
    v_accvgpr_read_b32 v21, a33
    v_accvgpr_read_b32 v22, a34
    v_accvgpr_read_b32 v23, a35
    v_accvgpr_read_b32 v24, a36
    v_accvgpr_read_b32 v25, a37
    v_accvgpr_read_b32 v26, a38
    v_accvgpr_read_b32 v27, a39
    v_mul_f32 v20, 0x3e0293ee, v20
    v_mul_f32 v21, 0x3e0293ee, v21
    v_mul_f32 v22, 0x3e0293ee, v22
    v_mul_f32 v23, 0x3e0293ee, v23
    v_mul_f32 v24, 0x3e0293ee, v24
    v_mul_f32 v25, 0x3e0293ee, v25
    v_mul_f32 v26, 0x3e0293ee, v26
    v_mul_f32 v27, 0x3e0293ee, v27
    v_cvt_pk_bf16_f32 v36, v20, v21
    v_cvt_pk_bf16_f32 v37, v22, v23
    v_cvt_pk_bf16_f32 v38, v24, v25
    v_cvt_pk_bf16_f32 v39, v26, v27
    buffer_store_dwordx4 v[36:39], v251, s[4:7], s53 offen offset:0 sc1
    v_accvgpr_read_b32 v40, a40
    v_accvgpr_read_b32 v41, a41
    v_accvgpr_read_b32 v42, a42
    v_accvgpr_read_b32 v43, a43
    v_accvgpr_read_b32 v44, a44
    v_accvgpr_read_b32 v45, a45
    v_accvgpr_read_b32 v46, a46
    v_accvgpr_read_b32 v47, a47
    v_mul_f32 v40, 0x3e0293ee, v40
    v_mul_f32 v41, 0x3e0293ee, v41
    v_mul_f32 v42, 0x3e0293ee, v42
    v_mul_f32 v43, 0x3e0293ee, v43
    v_mul_f32 v44, 0x3e0293ee, v44
    v_mul_f32 v45, 0x3e0293ee, v45
    v_mul_f32 v46, 0x3e0293ee, v46
    v_mul_f32 v47, 0x3e0293ee, v47
    v_cvt_pk_bf16_f32 v56, v40, v41
    v_cvt_pk_bf16_f32 v57, v42, v43
    v_cvt_pk_bf16_f32 v58, v44, v45
    v_cvt_pk_bf16_f32 v59, v46, v47
    buffer_store_dwordx4 v[56:59], v251, s[4:7], s53 offen offset:1024 sc1
    v_accvgpr_read_b32 v0, a48
    v_accvgpr_read_b32 v1, a49
    v_accvgpr_read_b32 v2, a50
    v_accvgpr_read_b32 v3, a51
    v_accvgpr_read_b32 v4, a52
    v_accvgpr_read_b32 v5, a53
    v_accvgpr_read_b32 v6, a54
    v_accvgpr_read_b32 v7, a55
    v_mul_f32 v0, 0x3e0293ee, v0
    v_mul_f32 v1, 0x3e0293ee, v1
    v_mul_f32 v2, 0x3e0293ee, v2
    v_mul_f32 v3, 0x3e0293ee, v3
    v_mul_f32 v4, 0x3e0293ee, v4
    v_mul_f32 v5, 0x3e0293ee, v5
    v_mul_f32 v6, 0x3e0293ee, v6
    v_mul_f32 v7, 0x3e0293ee, v7
    v_cvt_pk_bf16_f32 v16, v0, v1
    v_cvt_pk_bf16_f32 v17, v2, v3
    v_cvt_pk_bf16_f32 v18, v4, v5
    v_cvt_pk_bf16_f32 v19, v6, v7
    buffer_store_dwordx4 v[16:19], v251, s[4:7], s53 offen offset:2048 sc1
    v_accvgpr_read_b32 v20, a56
    v_accvgpr_read_b32 v21, a57
    v_accvgpr_read_b32 v22, a58
    v_accvgpr_read_b32 v23, a59
    v_accvgpr_read_b32 v24, a60
    v_accvgpr_read_b32 v25, a61
    v_accvgpr_read_b32 v26, a62
    v_accvgpr_read_b32 v27, a63
    v_mul_f32 v20, 0x3e0293ee, v20
    v_mul_f32 v21, 0x3e0293ee, v21
    v_mul_f32 v22, 0x3e0293ee, v22
    v_mul_f32 v23, 0x3e0293ee, v23
    v_mul_f32 v24, 0x3e0293ee, v24
    v_mul_f32 v25, 0x3e0293ee, v25
    v_mul_f32 v26, 0x3e0293ee, v26
    v_mul_f32 v27, 0x3e0293ee, v27
    v_cvt_pk_bf16_f32 v36, v20, v21
    v_cvt_pk_bf16_f32 v37, v22, v23
    v_cvt_pk_bf16_f32 v38, v24, v25
    v_cvt_pk_bf16_f32 v39, v26, v27
    buffer_store_dwordx4 v[36:39], v251, s[4:7], s53 offen offset:3072 sc1
    s_add_u32 s53, s53, s22
    v_accvgpr_read_b32 v40, a64
    v_accvgpr_read_b32 v41, a65
    v_accvgpr_read_b32 v42, a66
    v_accvgpr_read_b32 v43, a67
    v_accvgpr_read_b32 v44, a68
    v_accvgpr_read_b32 v45, a69
    v_accvgpr_read_b32 v46, a70
    v_accvgpr_read_b32 v47, a71
    v_mul_f32 v40, 0x3e0293ee, v40
    v_mul_f32 v41, 0x3e0293ee, v41
    v_mul_f32 v42, 0x3e0293ee, v42
    v_mul_f32 v43, 0x3e0293ee, v43
    v_mul_f32 v44, 0x3e0293ee, v44
    v_mul_f32 v45, 0x3e0293ee, v45
    v_mul_f32 v46, 0x3e0293ee, v46
    v_mul_f32 v47, 0x3e0293ee, v47
    v_cvt_pk_bf16_f32 v56, v40, v41
    v_cvt_pk_bf16_f32 v57, v42, v43
    v_cvt_pk_bf16_f32 v58, v44, v45
    v_cvt_pk_bf16_f32 v59, v46, v47
    buffer_store_dwordx4 v[56:59], v251, s[4:7], s53 offen offset:0 sc1
    v_accvgpr_read_b32 v0, a72
    v_accvgpr_read_b32 v1, a73
    v_accvgpr_read_b32 v2, a74
    v_accvgpr_read_b32 v3, a75
    v_accvgpr_read_b32 v4, a76
    v_accvgpr_read_b32 v5, a77
    v_accvgpr_read_b32 v6, a78
    v_accvgpr_read_b32 v7, a79
    v_mul_f32 v0, 0x3e0293ee, v0
    v_mul_f32 v1, 0x3e0293ee, v1
    v_mul_f32 v2, 0x3e0293ee, v2
    v_mul_f32 v3, 0x3e0293ee, v3
    v_mul_f32 v4, 0x3e0293ee, v4
    v_mul_f32 v5, 0x3e0293ee, v5
    v_mul_f32 v6, 0x3e0293ee, v6
    v_mul_f32 v7, 0x3e0293ee, v7
    v_cvt_pk_bf16_f32 v16, v0, v1
    v_cvt_pk_bf16_f32 v17, v2, v3
    v_cvt_pk_bf16_f32 v18, v4, v5
    v_cvt_pk_bf16_f32 v19, v6, v7
    buffer_store_dwordx4 v[16:19], v251, s[4:7], s53 offen offset:1024 sc1
    v_accvgpr_read_b32 v20, a80
    v_accvgpr_read_b32 v21, a81
    v_accvgpr_read_b32 v22, a82
    v_accvgpr_read_b32 v23, a83
    v_accvgpr_read_b32 v24, a84
    v_accvgpr_read_b32 v25, a85
    v_accvgpr_read_b32 v26, a86
    v_accvgpr_read_b32 v27, a87
    v_mul_f32 v20, 0x3e0293ee, v20
    v_mul_f32 v21, 0x3e0293ee, v21
    v_mul_f32 v22, 0x3e0293ee, v22
    v_mul_f32 v23, 0x3e0293ee, v23
    v_mul_f32 v24, 0x3e0293ee, v24
    v_mul_f32 v25, 0x3e0293ee, v25
    v_mul_f32 v26, 0x3e0293ee, v26
    v_mul_f32 v27, 0x3e0293ee, v27
    v_cvt_pk_bf16_f32 v36, v20, v21
    v_cvt_pk_bf16_f32 v37, v22, v23
    v_cvt_pk_bf16_f32 v38, v24, v25
    v_cvt_pk_bf16_f32 v39, v26, v27
    buffer_store_dwordx4 v[36:39], v251, s[4:7], s53 offen offset:2048 sc1
    v_accvgpr_read_b32 v40, a88
    v_accvgpr_read_b32 v41, a89
    v_accvgpr_read_b32 v42, a90
    v_accvgpr_read_b32 v43, a91
    v_accvgpr_read_b32 v44, a92
    v_accvgpr_read_b32 v45, a93
    v_accvgpr_read_b32 v46, a94
    v_accvgpr_read_b32 v47, a95
    v_mul_f32 v40, 0x3e0293ee, v40
    v_mul_f32 v41, 0x3e0293ee, v41
    v_mul_f32 v42, 0x3e0293ee, v42
    v_mul_f32 v43, 0x3e0293ee, v43
    v_mul_f32 v44, 0x3e0293ee, v44
    v_mul_f32 v45, 0x3e0293ee, v45
    v_mul_f32 v46, 0x3e0293ee, v46
    v_mul_f32 v47, 0x3e0293ee, v47
    v_cvt_pk_bf16_f32 v56, v40, v41
    v_cvt_pk_bf16_f32 v57, v42, v43
    v_cvt_pk_bf16_f32 v58, v44, v45
    v_cvt_pk_bf16_f32 v59, v46, v47
    buffer_store_dwordx4 v[56:59], v251, s[4:7], s53 offen offset:3072 sc1
    s_add_u32 s53, s53, s22
    v_accvgpr_read_b32 v0, a96
    v_accvgpr_read_b32 v1, a97
    v_accvgpr_read_b32 v2, a98
    v_accvgpr_read_b32 v3, a99
    v_accvgpr_read_b32 v4, a100
    v_accvgpr_read_b32 v5, a101
    v_accvgpr_read_b32 v6, a102
    v_accvgpr_read_b32 v7, a103
    v_mul_f32 v0, 0x3e0293ee, v0
    v_mul_f32 v1, 0x3e0293ee, v1
    v_mul_f32 v2, 0x3e0293ee, v2
    v_mul_f32 v3, 0x3e0293ee, v3
    v_mul_f32 v4, 0x3e0293ee, v4
    v_mul_f32 v5, 0x3e0293ee, v5
    v_mul_f32 v6, 0x3e0293ee, v6
    v_mul_f32 v7, 0x3e0293ee, v7
    v_cvt_pk_bf16_f32 v16, v0, v1
    v_cvt_pk_bf16_f32 v17, v2, v3
    v_cvt_pk_bf16_f32 v18, v4, v5
    v_cvt_pk_bf16_f32 v19, v6, v7
    buffer_store_dwordx4 v[16:19], v251, s[4:7], s53 offen offset:0 sc1
    v_accvgpr_read_b32 v20, a104
    v_accvgpr_read_b32 v21, a105
    v_accvgpr_read_b32 v22, a106
    v_accvgpr_read_b32 v23, a107
    v_accvgpr_read_b32 v24, a108
    v_accvgpr_read_b32 v25, a109
    v_accvgpr_read_b32 v26, a110
    v_accvgpr_read_b32 v27, a111
    v_mul_f32 v20, 0x3e0293ee, v20
    v_mul_f32 v21, 0x3e0293ee, v21
    v_mul_f32 v22, 0x3e0293ee, v22
    v_mul_f32 v23, 0x3e0293ee, v23
    v_mul_f32 v24, 0x3e0293ee, v24
    v_mul_f32 v25, 0x3e0293ee, v25
    v_mul_f32 v26, 0x3e0293ee, v26
    v_mul_f32 v27, 0x3e0293ee, v27
    v_cvt_pk_bf16_f32 v36, v20, v21
    v_cvt_pk_bf16_f32 v37, v22, v23
    v_cvt_pk_bf16_f32 v38, v24, v25
    v_cvt_pk_bf16_f32 v39, v26, v27
    buffer_store_dwordx4 v[36:39], v251, s[4:7], s53 offen offset:1024 sc1
    v_accvgpr_read_b32 v40, a112
    v_accvgpr_read_b32 v41, a113
    v_accvgpr_read_b32 v42, a114
    v_accvgpr_read_b32 v43, a115
    v_accvgpr_read_b32 v44, a116
    v_accvgpr_read_b32 v45, a117
    v_accvgpr_read_b32 v46, a118
    v_accvgpr_read_b32 v47, a119
    v_mul_f32 v40, 0x3e0293ee, v40
    v_mul_f32 v41, 0x3e0293ee, v41
    v_mul_f32 v42, 0x3e0293ee, v42
    v_mul_f32 v43, 0x3e0293ee, v43
    v_mul_f32 v44, 0x3e0293ee, v44
    v_mul_f32 v45, 0x3e0293ee, v45
    v_mul_f32 v46, 0x3e0293ee, v46
    v_mul_f32 v47, 0x3e0293ee, v47
    v_cvt_pk_bf16_f32 v56, v40, v41
    v_cvt_pk_bf16_f32 v57, v42, v43
    v_cvt_pk_bf16_f32 v58, v44, v45
    v_cvt_pk_bf16_f32 v59, v46, v47
    buffer_store_dwordx4 v[56:59], v251, s[4:7], s53 offen offset:2048 sc1
    v_accvgpr_read_b32 v0, a120
    v_accvgpr_read_b32 v1, a121
    v_accvgpr_read_b32 v2, a122
    v_accvgpr_read_b32 v3, a123
    v_accvgpr_read_b32 v4, a124
    v_accvgpr_read_b32 v5, a125
    v_accvgpr_read_b32 v6, a126
    v_accvgpr_read_b32 v7, a127
    v_mul_f32 v0, 0x3e0293ee, v0
    v_mul_f32 v1, 0x3e0293ee, v1
    v_mul_f32 v2, 0x3e0293ee, v2
    v_mul_f32 v3, 0x3e0293ee, v3
    v_mul_f32 v4, 0x3e0293ee, v4
    v_mul_f32 v5, 0x3e0293ee, v5
    v_mul_f32 v6, 0x3e0293ee, v6
    v_mul_f32 v7, 0x3e0293ee, v7
    v_cvt_pk_bf16_f32 v16, v0, v1
    v_cvt_pk_bf16_f32 v17, v2, v3
    v_cvt_pk_bf16_f32 v18, v4, v5
    v_cvt_pk_bf16_f32 v19, v6, v7
    buffer_store_dwordx4 v[16:19], v251, s[4:7], s53 offen offset:3072 sc1
    s_branch main_kernel_w_done
main_kernel_w_c1_egelus:
    s_mov_b32 s53, s21
    v_accvgpr_read_b32 v0, a0
    v_accvgpr_read_b32 v1, a1
    v_accvgpr_read_b32 v2, a2
    v_accvgpr_read_b32 v3, a3
    v_accvgpr_read_b32 v4, a4
    v_accvgpr_read_b32 v5, a5
    v_accvgpr_read_b32 v6, a6
    v_accvgpr_read_b32 v7, a7
    v_pk_mul_f32 v[8:9], v[0:1], v[0:1]
    v_pk_mul_f32 v[10:11], v[2:3], v[2:3]
    v_pk_mul_f32 v[12:13], v[4:5], v[4:5]
    v_pk_mul_f32 v[14:15], v[6:7], v[6:7]
    v_pk_fma_f32 v[8:9], v[8:9], v[242:243], v[240:241]
    v_pk_fma_f32 v[10:11], v[10:11], v[242:243], v[240:241]
    v_pk_fma_f32 v[12:13], v[12:13], v[242:243], v[240:241]
    v_pk_fma_f32 v[14:15], v[14:15], v[242:243], v[240:241]
    v_pk_mul_f32 v[8:9], v[8:9], v[0:1]
    v_pk_mul_f32 v[10:11], v[10:11], v[2:3]
    v_pk_mul_f32 v[12:13], v[12:13], v[4:5]
    v_pk_mul_f32 v[14:15], v[14:15], v[6:7]
    v_exp_f32 v8, v8
    v_exp_f32 v9, v9
    v_exp_f32 v10, v10
    v_exp_f32 v11, v11
    v_exp_f32 v12, v12
    v_exp_f32 v13, v13
    v_exp_f32 v14, v14
    v_exp_f32 v15, v15
    v_pk_add_f32 v[8:9], v[8:9], v[244:245]
    v_pk_add_f32 v[10:11], v[10:11], v[244:245]
    v_pk_add_f32 v[12:13], v[12:13], v[244:245]
    v_pk_add_f32 v[14:15], v[14:15], v[244:245]
    v_rcp_f32 v8, v8
    v_rcp_f32 v9, v9
    v_rcp_f32 v10, v10
    v_rcp_f32 v11, v11
    v_rcp_f32 v12, v12
    v_rcp_f32 v13, v13
    v_rcp_f32 v14, v14
    v_rcp_f32 v15, v15
    v_pk_mul_f32 v[0:1], v[8:9], v[0:1]
    v_pk_mul_f32 v[2:3], v[10:11], v[2:3]
    v_pk_mul_f32 v[4:5], v[12:13], v[4:5]
    v_pk_mul_f32 v[6:7], v[14:15], v[6:7]
    v_cvt_pk_bf16_f32 v16, v0, v1
    v_cvt_pk_bf16_f32 v17, v2, v3
    v_cvt_pk_bf16_f32 v18, v4, v5
    v_cvt_pk_bf16_f32 v19, v6, v7
    buffer_store_dwordx4 v[16:19], v252, s[4:7], s53 offen offset:0 sc1
    v_accvgpr_read_b32 v20, a8
    v_accvgpr_read_b32 v21, a9
    v_accvgpr_read_b32 v22, a10
    v_accvgpr_read_b32 v23, a11
    v_accvgpr_read_b32 v24, a12
    v_accvgpr_read_b32 v25, a13
    v_accvgpr_read_b32 v26, a14
    v_accvgpr_read_b32 v27, a15
    v_pk_mul_f32 v[28:29], v[20:21], v[20:21]
    v_pk_mul_f32 v[30:31], v[22:23], v[22:23]
    v_pk_mul_f32 v[32:33], v[24:25], v[24:25]
    v_pk_mul_f32 v[34:35], v[26:27], v[26:27]
    v_pk_fma_f32 v[28:29], v[28:29], v[242:243], v[240:241]
    v_pk_fma_f32 v[30:31], v[30:31], v[242:243], v[240:241]
    v_pk_fma_f32 v[32:33], v[32:33], v[242:243], v[240:241]
    v_pk_fma_f32 v[34:35], v[34:35], v[242:243], v[240:241]
    v_pk_mul_f32 v[28:29], v[28:29], v[20:21]
    v_pk_mul_f32 v[30:31], v[30:31], v[22:23]
    v_pk_mul_f32 v[32:33], v[32:33], v[24:25]
    v_pk_mul_f32 v[34:35], v[34:35], v[26:27]
    v_exp_f32 v28, v28
    v_exp_f32 v29, v29
    v_exp_f32 v30, v30
    v_exp_f32 v31, v31
    v_exp_f32 v32, v32
    v_exp_f32 v33, v33
    v_exp_f32 v34, v34
    v_exp_f32 v35, v35
    v_pk_add_f32 v[28:29], v[28:29], v[244:245]
    v_pk_add_f32 v[30:31], v[30:31], v[244:245]
    v_pk_add_f32 v[32:33], v[32:33], v[244:245]
    v_pk_add_f32 v[34:35], v[34:35], v[244:245]
    v_rcp_f32 v28, v28
    v_rcp_f32 v29, v29
    v_rcp_f32 v30, v30
    v_rcp_f32 v31, v31
    v_rcp_f32 v32, v32
    v_rcp_f32 v33, v33
    v_rcp_f32 v34, v34
    v_rcp_f32 v35, v35
    v_pk_mul_f32 v[20:21], v[28:29], v[20:21]
    v_pk_mul_f32 v[22:23], v[30:31], v[22:23]
    v_pk_mul_f32 v[24:25], v[32:33], v[24:25]
    v_pk_mul_f32 v[26:27], v[34:35], v[26:27]
    v_cvt_pk_bf16_f32 v36, v20, v21
    v_cvt_pk_bf16_f32 v37, v22, v23
    v_cvt_pk_bf16_f32 v38, v24, v25
    v_cvt_pk_bf16_f32 v39, v26, v27
    buffer_store_dwordx4 v[36:39], v252, s[4:7], s53 offen offset:1024 sc1
    v_accvgpr_read_b32 v40, a16
    v_accvgpr_read_b32 v41, a17
    v_accvgpr_read_b32 v42, a18
    v_accvgpr_read_b32 v43, a19
    v_accvgpr_read_b32 v44, a20
    v_accvgpr_read_b32 v45, a21
    v_accvgpr_read_b32 v46, a22
    v_accvgpr_read_b32 v47, a23
    v_pk_mul_f32 v[48:49], v[40:41], v[40:41]
    v_pk_mul_f32 v[50:51], v[42:43], v[42:43]
    v_pk_mul_f32 v[52:53], v[44:45], v[44:45]
    v_pk_mul_f32 v[54:55], v[46:47], v[46:47]
    v_pk_fma_f32 v[48:49], v[48:49], v[242:243], v[240:241]
    v_pk_fma_f32 v[50:51], v[50:51], v[242:243], v[240:241]
    v_pk_fma_f32 v[52:53], v[52:53], v[242:243], v[240:241]
    v_pk_fma_f32 v[54:55], v[54:55], v[242:243], v[240:241]
    v_pk_mul_f32 v[48:49], v[48:49], v[40:41]
    v_pk_mul_f32 v[50:51], v[50:51], v[42:43]
    v_pk_mul_f32 v[52:53], v[52:53], v[44:45]
    v_pk_mul_f32 v[54:55], v[54:55], v[46:47]
    v_exp_f32 v48, v48
    v_exp_f32 v49, v49
    v_exp_f32 v50, v50
    v_exp_f32 v51, v51
    v_exp_f32 v52, v52
    v_exp_f32 v53, v53
    v_exp_f32 v54, v54
    v_exp_f32 v55, v55
    v_pk_add_f32 v[48:49], v[48:49], v[244:245]
    v_pk_add_f32 v[50:51], v[50:51], v[244:245]
    v_pk_add_f32 v[52:53], v[52:53], v[244:245]
    v_pk_add_f32 v[54:55], v[54:55], v[244:245]
    v_rcp_f32 v48, v48
    v_rcp_f32 v49, v49
    v_rcp_f32 v50, v50
    v_rcp_f32 v51, v51
    v_rcp_f32 v52, v52
    v_rcp_f32 v53, v53
    v_rcp_f32 v54, v54
    v_rcp_f32 v55, v55
    v_pk_mul_f32 v[40:41], v[48:49], v[40:41]
    v_pk_mul_f32 v[42:43], v[50:51], v[42:43]
    v_pk_mul_f32 v[44:45], v[52:53], v[44:45]
    v_pk_mul_f32 v[46:47], v[54:55], v[46:47]
    v_cvt_pk_bf16_f32 v56, v40, v41
    v_cvt_pk_bf16_f32 v57, v42, v43
    v_cvt_pk_bf16_f32 v58, v44, v45
    v_cvt_pk_bf16_f32 v59, v46, v47
    buffer_store_dwordx4 v[56:59], v252, s[4:7], s53 offen offset:2048 sc1
    v_accvgpr_read_b32 v0, a24
    v_accvgpr_read_b32 v1, a25
    v_accvgpr_read_b32 v2, a26
    v_accvgpr_read_b32 v3, a27
    v_accvgpr_read_b32 v4, a28
    v_accvgpr_read_b32 v5, a29
    v_accvgpr_read_b32 v6, a30
    v_accvgpr_read_b32 v7, a31
    v_pk_mul_f32 v[8:9], v[0:1], v[0:1]
    v_pk_mul_f32 v[10:11], v[2:3], v[2:3]
    v_pk_mul_f32 v[12:13], v[4:5], v[4:5]
    v_pk_mul_f32 v[14:15], v[6:7], v[6:7]
    v_pk_fma_f32 v[8:9], v[8:9], v[242:243], v[240:241]
    v_pk_fma_f32 v[10:11], v[10:11], v[242:243], v[240:241]
    v_pk_fma_f32 v[12:13], v[12:13], v[242:243], v[240:241]
    v_pk_fma_f32 v[14:15], v[14:15], v[242:243], v[240:241]
    v_pk_mul_f32 v[8:9], v[8:9], v[0:1]
    v_pk_mul_f32 v[10:11], v[10:11], v[2:3]
    v_pk_mul_f32 v[12:13], v[12:13], v[4:5]
    v_pk_mul_f32 v[14:15], v[14:15], v[6:7]
    v_exp_f32 v8, v8
    v_exp_f32 v9, v9
    v_exp_f32 v10, v10
    v_exp_f32 v11, v11
    v_exp_f32 v12, v12
    v_exp_f32 v13, v13
    v_exp_f32 v14, v14
    v_exp_f32 v15, v15
    v_pk_add_f32 v[8:9], v[8:9], v[244:245]
    v_pk_add_f32 v[10:11], v[10:11], v[244:245]
    v_pk_add_f32 v[12:13], v[12:13], v[244:245]
    v_pk_add_f32 v[14:15], v[14:15], v[244:245]
    v_rcp_f32 v8, v8
    v_rcp_f32 v9, v9
    v_rcp_f32 v10, v10
    v_rcp_f32 v11, v11
    v_rcp_f32 v12, v12
    v_rcp_f32 v13, v13
    v_rcp_f32 v14, v14
    v_rcp_f32 v15, v15
    v_pk_mul_f32 v[0:1], v[8:9], v[0:1]
    v_pk_mul_f32 v[2:3], v[10:11], v[2:3]
    v_pk_mul_f32 v[4:5], v[12:13], v[4:5]
    v_pk_mul_f32 v[6:7], v[14:15], v[6:7]
    v_cvt_pk_bf16_f32 v16, v0, v1
    v_cvt_pk_bf16_f32 v17, v2, v3
    v_cvt_pk_bf16_f32 v18, v4, v5
    v_cvt_pk_bf16_f32 v19, v6, v7
    buffer_store_dwordx4 v[16:19], v252, s[4:7], s53 offen offset:3072 sc1
    s_add_u32 s53, s53, s22
    v_accvgpr_read_b32 v20, a32
    v_accvgpr_read_b32 v21, a33
    v_accvgpr_read_b32 v22, a34
    v_accvgpr_read_b32 v23, a35
    v_accvgpr_read_b32 v24, a36
    v_accvgpr_read_b32 v25, a37
    v_accvgpr_read_b32 v26, a38
    v_accvgpr_read_b32 v27, a39
    v_pk_mul_f32 v[28:29], v[20:21], v[20:21]
    v_pk_mul_f32 v[30:31], v[22:23], v[22:23]
    v_pk_mul_f32 v[32:33], v[24:25], v[24:25]
    v_pk_mul_f32 v[34:35], v[26:27], v[26:27]
    v_pk_fma_f32 v[28:29], v[28:29], v[242:243], v[240:241]
    v_pk_fma_f32 v[30:31], v[30:31], v[242:243], v[240:241]
    v_pk_fma_f32 v[32:33], v[32:33], v[242:243], v[240:241]
    v_pk_fma_f32 v[34:35], v[34:35], v[242:243], v[240:241]
    v_pk_mul_f32 v[28:29], v[28:29], v[20:21]
    v_pk_mul_f32 v[30:31], v[30:31], v[22:23]
    v_pk_mul_f32 v[32:33], v[32:33], v[24:25]
    v_pk_mul_f32 v[34:35], v[34:35], v[26:27]
    v_exp_f32 v28, v28
    v_exp_f32 v29, v29
    v_exp_f32 v30, v30
    v_exp_f32 v31, v31
    v_exp_f32 v32, v32
    v_exp_f32 v33, v33
    v_exp_f32 v34, v34
    v_exp_f32 v35, v35
    v_pk_add_f32 v[28:29], v[28:29], v[244:245]
    v_pk_add_f32 v[30:31], v[30:31], v[244:245]
    v_pk_add_f32 v[32:33], v[32:33], v[244:245]
    v_pk_add_f32 v[34:35], v[34:35], v[244:245]
    v_rcp_f32 v28, v28
    v_rcp_f32 v29, v29
    v_rcp_f32 v30, v30
    v_rcp_f32 v31, v31
    v_rcp_f32 v32, v32
    v_rcp_f32 v33, v33
    v_rcp_f32 v34, v34
    v_rcp_f32 v35, v35
    v_pk_mul_f32 v[20:21], v[28:29], v[20:21]
    v_pk_mul_f32 v[22:23], v[30:31], v[22:23]
    v_pk_mul_f32 v[24:25], v[32:33], v[24:25]
    v_pk_mul_f32 v[26:27], v[34:35], v[26:27]
    v_cvt_pk_bf16_f32 v36, v20, v21
    v_cvt_pk_bf16_f32 v37, v22, v23
    v_cvt_pk_bf16_f32 v38, v24, v25
    v_cvt_pk_bf16_f32 v39, v26, v27
    buffer_store_dwordx4 v[36:39], v252, s[4:7], s53 offen offset:0 sc1
    v_accvgpr_read_b32 v40, a40
    v_accvgpr_read_b32 v41, a41
    v_accvgpr_read_b32 v42, a42
    v_accvgpr_read_b32 v43, a43
    v_accvgpr_read_b32 v44, a44
    v_accvgpr_read_b32 v45, a45
    v_accvgpr_read_b32 v46, a46
    v_accvgpr_read_b32 v47, a47
    v_pk_mul_f32 v[48:49], v[40:41], v[40:41]
    v_pk_mul_f32 v[50:51], v[42:43], v[42:43]
    v_pk_mul_f32 v[52:53], v[44:45], v[44:45]
    v_pk_mul_f32 v[54:55], v[46:47], v[46:47]
    v_pk_fma_f32 v[48:49], v[48:49], v[242:243], v[240:241]
    v_pk_fma_f32 v[50:51], v[50:51], v[242:243], v[240:241]
    v_pk_fma_f32 v[52:53], v[52:53], v[242:243], v[240:241]
    v_pk_fma_f32 v[54:55], v[54:55], v[242:243], v[240:241]
    v_pk_mul_f32 v[48:49], v[48:49], v[40:41]
    v_pk_mul_f32 v[50:51], v[50:51], v[42:43]
    v_pk_mul_f32 v[52:53], v[52:53], v[44:45]
    v_pk_mul_f32 v[54:55], v[54:55], v[46:47]
    v_exp_f32 v48, v48
    v_exp_f32 v49, v49
    v_exp_f32 v50, v50
    v_exp_f32 v51, v51
    v_exp_f32 v52, v52
    v_exp_f32 v53, v53
    v_exp_f32 v54, v54
    v_exp_f32 v55, v55
    v_pk_add_f32 v[48:49], v[48:49], v[244:245]
    v_pk_add_f32 v[50:51], v[50:51], v[244:245]
    v_pk_add_f32 v[52:53], v[52:53], v[244:245]
    v_pk_add_f32 v[54:55], v[54:55], v[244:245]
    v_rcp_f32 v48, v48
    v_rcp_f32 v49, v49
    v_rcp_f32 v50, v50
    v_rcp_f32 v51, v51
    v_rcp_f32 v52, v52
    v_rcp_f32 v53, v53
    v_rcp_f32 v54, v54
    v_rcp_f32 v55, v55
    v_pk_mul_f32 v[40:41], v[48:49], v[40:41]
    v_pk_mul_f32 v[42:43], v[50:51], v[42:43]
    v_pk_mul_f32 v[44:45], v[52:53], v[44:45]
    v_pk_mul_f32 v[46:47], v[54:55], v[46:47]
    v_cvt_pk_bf16_f32 v56, v40, v41
    v_cvt_pk_bf16_f32 v57, v42, v43
    v_cvt_pk_bf16_f32 v58, v44, v45
    v_cvt_pk_bf16_f32 v59, v46, v47
    buffer_store_dwordx4 v[56:59], v252, s[4:7], s53 offen offset:1024 sc1
    v_accvgpr_read_b32 v0, a48
    v_accvgpr_read_b32 v1, a49
    v_accvgpr_read_b32 v2, a50
    v_accvgpr_read_b32 v3, a51
    v_accvgpr_read_b32 v4, a52
    v_accvgpr_read_b32 v5, a53
    v_accvgpr_read_b32 v6, a54
    v_accvgpr_read_b32 v7, a55
    v_pk_mul_f32 v[8:9], v[0:1], v[0:1]
    v_pk_mul_f32 v[10:11], v[2:3], v[2:3]
    v_pk_mul_f32 v[12:13], v[4:5], v[4:5]
    v_pk_mul_f32 v[14:15], v[6:7], v[6:7]
    v_pk_fma_f32 v[8:9], v[8:9], v[242:243], v[240:241]
    v_pk_fma_f32 v[10:11], v[10:11], v[242:243], v[240:241]
    v_pk_fma_f32 v[12:13], v[12:13], v[242:243], v[240:241]
    v_pk_fma_f32 v[14:15], v[14:15], v[242:243], v[240:241]
    v_pk_mul_f32 v[8:9], v[8:9], v[0:1]
    v_pk_mul_f32 v[10:11], v[10:11], v[2:3]
    v_pk_mul_f32 v[12:13], v[12:13], v[4:5]
    v_pk_mul_f32 v[14:15], v[14:15], v[6:7]
    v_exp_f32 v8, v8
    v_exp_f32 v9, v9
    v_exp_f32 v10, v10
    v_exp_f32 v11, v11
    v_exp_f32 v12, v12
    v_exp_f32 v13, v13
    v_exp_f32 v14, v14
    v_exp_f32 v15, v15
    v_pk_add_f32 v[8:9], v[8:9], v[244:245]
    v_pk_add_f32 v[10:11], v[10:11], v[244:245]
    v_pk_add_f32 v[12:13], v[12:13], v[244:245]
    v_pk_add_f32 v[14:15], v[14:15], v[244:245]
    v_rcp_f32 v8, v8
    v_rcp_f32 v9, v9
    v_rcp_f32 v10, v10
    v_rcp_f32 v11, v11
    v_rcp_f32 v12, v12
    v_rcp_f32 v13, v13
    v_rcp_f32 v14, v14
    v_rcp_f32 v15, v15
    v_pk_mul_f32 v[0:1], v[8:9], v[0:1]
    v_pk_mul_f32 v[2:3], v[10:11], v[2:3]
    v_pk_mul_f32 v[4:5], v[12:13], v[4:5]
    v_pk_mul_f32 v[6:7], v[14:15], v[6:7]
    v_cvt_pk_bf16_f32 v16, v0, v1
    v_cvt_pk_bf16_f32 v17, v2, v3
    v_cvt_pk_bf16_f32 v18, v4, v5
    v_cvt_pk_bf16_f32 v19, v6, v7
    buffer_store_dwordx4 v[16:19], v252, s[4:7], s53 offen offset:2048 sc1
    v_accvgpr_read_b32 v20, a56
    v_accvgpr_read_b32 v21, a57
    v_accvgpr_read_b32 v22, a58
    v_accvgpr_read_b32 v23, a59
    v_accvgpr_read_b32 v24, a60
    v_accvgpr_read_b32 v25, a61
    v_accvgpr_read_b32 v26, a62
    v_accvgpr_read_b32 v27, a63
    v_pk_mul_f32 v[28:29], v[20:21], v[20:21]
    v_pk_mul_f32 v[30:31], v[22:23], v[22:23]
    v_pk_mul_f32 v[32:33], v[24:25], v[24:25]
    v_pk_mul_f32 v[34:35], v[26:27], v[26:27]
    v_pk_fma_f32 v[28:29], v[28:29], v[242:243], v[240:241]
    v_pk_fma_f32 v[30:31], v[30:31], v[242:243], v[240:241]
    v_pk_fma_f32 v[32:33], v[32:33], v[242:243], v[240:241]
    v_pk_fma_f32 v[34:35], v[34:35], v[242:243], v[240:241]
    v_pk_mul_f32 v[28:29], v[28:29], v[20:21]
    v_pk_mul_f32 v[30:31], v[30:31], v[22:23]
    v_pk_mul_f32 v[32:33], v[32:33], v[24:25]
    v_pk_mul_f32 v[34:35], v[34:35], v[26:27]
    v_exp_f32 v28, v28
    v_exp_f32 v29, v29
    v_exp_f32 v30, v30
    v_exp_f32 v31, v31
    v_exp_f32 v32, v32
    v_exp_f32 v33, v33
    v_exp_f32 v34, v34
    v_exp_f32 v35, v35
    v_pk_add_f32 v[28:29], v[28:29], v[244:245]
    v_pk_add_f32 v[30:31], v[30:31], v[244:245]
    v_pk_add_f32 v[32:33], v[32:33], v[244:245]
    v_pk_add_f32 v[34:35], v[34:35], v[244:245]
    v_rcp_f32 v28, v28
    v_rcp_f32 v29, v29
    v_rcp_f32 v30, v30
    v_rcp_f32 v31, v31
    v_rcp_f32 v32, v32
    v_rcp_f32 v33, v33
    v_rcp_f32 v34, v34
    v_rcp_f32 v35, v35
    v_pk_mul_f32 v[20:21], v[28:29], v[20:21]
    v_pk_mul_f32 v[22:23], v[30:31], v[22:23]
    v_pk_mul_f32 v[24:25], v[32:33], v[24:25]
    v_pk_mul_f32 v[26:27], v[34:35], v[26:27]
    v_cvt_pk_bf16_f32 v36, v20, v21
    v_cvt_pk_bf16_f32 v37, v22, v23
    v_cvt_pk_bf16_f32 v38, v24, v25
    v_cvt_pk_bf16_f32 v39, v26, v27
    buffer_store_dwordx4 v[36:39], v252, s[4:7], s53 offen offset:3072 sc1
    s_add_u32 s53, s53, s22
    v_accvgpr_read_b32 v40, a64
    v_accvgpr_read_b32 v41, a65
    v_accvgpr_read_b32 v42, a66
    v_accvgpr_read_b32 v43, a67
    v_accvgpr_read_b32 v44, a68
    v_accvgpr_read_b32 v45, a69
    v_accvgpr_read_b32 v46, a70
    v_accvgpr_read_b32 v47, a71
    v_pk_mul_f32 v[48:49], v[40:41], v[40:41]
    v_pk_mul_f32 v[50:51], v[42:43], v[42:43]
    v_pk_mul_f32 v[52:53], v[44:45], v[44:45]
    v_pk_mul_f32 v[54:55], v[46:47], v[46:47]
    v_pk_fma_f32 v[48:49], v[48:49], v[242:243], v[240:241]
    v_pk_fma_f32 v[50:51], v[50:51], v[242:243], v[240:241]
    v_pk_fma_f32 v[52:53], v[52:53], v[242:243], v[240:241]
    v_pk_fma_f32 v[54:55], v[54:55], v[242:243], v[240:241]
    v_pk_mul_f32 v[48:49], v[48:49], v[40:41]
    v_pk_mul_f32 v[50:51], v[50:51], v[42:43]
    v_pk_mul_f32 v[52:53], v[52:53], v[44:45]
    v_pk_mul_f32 v[54:55], v[54:55], v[46:47]
    v_exp_f32 v48, v48
    v_exp_f32 v49, v49
    v_exp_f32 v50, v50
    v_exp_f32 v51, v51
    v_exp_f32 v52, v52
    v_exp_f32 v53, v53
    v_exp_f32 v54, v54
    v_exp_f32 v55, v55
    v_pk_add_f32 v[48:49], v[48:49], v[244:245]
    v_pk_add_f32 v[50:51], v[50:51], v[244:245]
    v_pk_add_f32 v[52:53], v[52:53], v[244:245]
    v_pk_add_f32 v[54:55], v[54:55], v[244:245]
    v_rcp_f32 v48, v48
    v_rcp_f32 v49, v49
    v_rcp_f32 v50, v50
    v_rcp_f32 v51, v51
    v_rcp_f32 v52, v52
    v_rcp_f32 v53, v53
    v_rcp_f32 v54, v54
    v_rcp_f32 v55, v55
    v_pk_mul_f32 v[40:41], v[48:49], v[40:41]
    v_pk_mul_f32 v[42:43], v[50:51], v[42:43]
    v_pk_mul_f32 v[44:45], v[52:53], v[44:45]
    v_pk_mul_f32 v[46:47], v[54:55], v[46:47]
    v_cvt_pk_bf16_f32 v56, v40, v41
    v_cvt_pk_bf16_f32 v57, v42, v43
    v_cvt_pk_bf16_f32 v58, v44, v45
    v_cvt_pk_bf16_f32 v59, v46, v47
    buffer_store_dwordx4 v[56:59], v252, s[4:7], s53 offen offset:0 sc1
    v_accvgpr_read_b32 v0, a72
    v_accvgpr_read_b32 v1, a73
    v_accvgpr_read_b32 v2, a74
    v_accvgpr_read_b32 v3, a75
    v_accvgpr_read_b32 v4, a76
    v_accvgpr_read_b32 v5, a77
    v_accvgpr_read_b32 v6, a78
    v_accvgpr_read_b32 v7, a79
    v_pk_mul_f32 v[8:9], v[0:1], v[0:1]
    v_pk_mul_f32 v[10:11], v[2:3], v[2:3]
    v_pk_mul_f32 v[12:13], v[4:5], v[4:5]
    v_pk_mul_f32 v[14:15], v[6:7], v[6:7]
    v_pk_fma_f32 v[8:9], v[8:9], v[242:243], v[240:241]
    v_pk_fma_f32 v[10:11], v[10:11], v[242:243], v[240:241]
    v_pk_fma_f32 v[12:13], v[12:13], v[242:243], v[240:241]
    v_pk_fma_f32 v[14:15], v[14:15], v[242:243], v[240:241]
    v_pk_mul_f32 v[8:9], v[8:9], v[0:1]
    v_pk_mul_f32 v[10:11], v[10:11], v[2:3]
    v_pk_mul_f32 v[12:13], v[12:13], v[4:5]
    v_pk_mul_f32 v[14:15], v[14:15], v[6:7]
    v_exp_f32 v8, v8
    v_exp_f32 v9, v9
    v_exp_f32 v10, v10
    v_exp_f32 v11, v11
    v_exp_f32 v12, v12
    v_exp_f32 v13, v13
    v_exp_f32 v14, v14
    v_exp_f32 v15, v15
    v_pk_add_f32 v[8:9], v[8:9], v[244:245]
    v_pk_add_f32 v[10:11], v[10:11], v[244:245]
    v_pk_add_f32 v[12:13], v[12:13], v[244:245]
    v_pk_add_f32 v[14:15], v[14:15], v[244:245]
    v_rcp_f32 v8, v8
    v_rcp_f32 v9, v9
    v_rcp_f32 v10, v10
    v_rcp_f32 v11, v11
    v_rcp_f32 v12, v12
    v_rcp_f32 v13, v13
    v_rcp_f32 v14, v14
    v_rcp_f32 v15, v15
    v_pk_mul_f32 v[0:1], v[8:9], v[0:1]
    v_pk_mul_f32 v[2:3], v[10:11], v[2:3]
    v_pk_mul_f32 v[4:5], v[12:13], v[4:5]
    v_pk_mul_f32 v[6:7], v[14:15], v[6:7]
    v_cvt_pk_bf16_f32 v16, v0, v1
    v_cvt_pk_bf16_f32 v17, v2, v3
    v_cvt_pk_bf16_f32 v18, v4, v5
    v_cvt_pk_bf16_f32 v19, v6, v7
    buffer_store_dwordx4 v[16:19], v252, s[4:7], s53 offen offset:1024 sc1
    v_accvgpr_read_b32 v20, a80
    v_accvgpr_read_b32 v21, a81
    v_accvgpr_read_b32 v22, a82
    v_accvgpr_read_b32 v23, a83
    v_accvgpr_read_b32 v24, a84
    v_accvgpr_read_b32 v25, a85
    v_accvgpr_read_b32 v26, a86
    v_accvgpr_read_b32 v27, a87
    v_pk_mul_f32 v[28:29], v[20:21], v[20:21]
    v_pk_mul_f32 v[30:31], v[22:23], v[22:23]
    v_pk_mul_f32 v[32:33], v[24:25], v[24:25]
    v_pk_mul_f32 v[34:35], v[26:27], v[26:27]
    v_pk_fma_f32 v[28:29], v[28:29], v[242:243], v[240:241]
    v_pk_fma_f32 v[30:31], v[30:31], v[242:243], v[240:241]
    v_pk_fma_f32 v[32:33], v[32:33], v[242:243], v[240:241]
    v_pk_fma_f32 v[34:35], v[34:35], v[242:243], v[240:241]
    v_pk_mul_f32 v[28:29], v[28:29], v[20:21]
    v_pk_mul_f32 v[30:31], v[30:31], v[22:23]
    v_pk_mul_f32 v[32:33], v[32:33], v[24:25]
    v_pk_mul_f32 v[34:35], v[34:35], v[26:27]
    v_exp_f32 v28, v28
    v_exp_f32 v29, v29
    v_exp_f32 v30, v30
    v_exp_f32 v31, v31
    v_exp_f32 v32, v32
    v_exp_f32 v33, v33
    v_exp_f32 v34, v34
    v_exp_f32 v35, v35
    v_pk_add_f32 v[28:29], v[28:29], v[244:245]
    v_pk_add_f32 v[30:31], v[30:31], v[244:245]
    v_pk_add_f32 v[32:33], v[32:33], v[244:245]
    v_pk_add_f32 v[34:35], v[34:35], v[244:245]
    v_rcp_f32 v28, v28
    v_rcp_f32 v29, v29
    v_rcp_f32 v30, v30
    v_rcp_f32 v31, v31
    v_rcp_f32 v32, v32
    v_rcp_f32 v33, v33
    v_rcp_f32 v34, v34
    v_rcp_f32 v35, v35
    v_pk_mul_f32 v[20:21], v[28:29], v[20:21]
    v_pk_mul_f32 v[22:23], v[30:31], v[22:23]
    v_pk_mul_f32 v[24:25], v[32:33], v[24:25]
    v_pk_mul_f32 v[26:27], v[34:35], v[26:27]
    v_cvt_pk_bf16_f32 v36, v20, v21
    v_cvt_pk_bf16_f32 v37, v22, v23
    v_cvt_pk_bf16_f32 v38, v24, v25
    v_cvt_pk_bf16_f32 v39, v26, v27
    buffer_store_dwordx4 v[36:39], v252, s[4:7], s53 offen offset:2048 sc1
    v_accvgpr_read_b32 v40, a88
    v_accvgpr_read_b32 v41, a89
    v_accvgpr_read_b32 v42, a90
    v_accvgpr_read_b32 v43, a91
    v_accvgpr_read_b32 v44, a92
    v_accvgpr_read_b32 v45, a93
    v_accvgpr_read_b32 v46, a94
    v_accvgpr_read_b32 v47, a95
    v_pk_mul_f32 v[48:49], v[40:41], v[40:41]
    v_pk_mul_f32 v[50:51], v[42:43], v[42:43]
    v_pk_mul_f32 v[52:53], v[44:45], v[44:45]
    v_pk_mul_f32 v[54:55], v[46:47], v[46:47]
    v_pk_fma_f32 v[48:49], v[48:49], v[242:243], v[240:241]
    v_pk_fma_f32 v[50:51], v[50:51], v[242:243], v[240:241]
    v_pk_fma_f32 v[52:53], v[52:53], v[242:243], v[240:241]
    v_pk_fma_f32 v[54:55], v[54:55], v[242:243], v[240:241]
    v_pk_mul_f32 v[48:49], v[48:49], v[40:41]
    v_pk_mul_f32 v[50:51], v[50:51], v[42:43]
    v_pk_mul_f32 v[52:53], v[52:53], v[44:45]
    v_pk_mul_f32 v[54:55], v[54:55], v[46:47]
    v_exp_f32 v48, v48
    v_exp_f32 v49, v49
    v_exp_f32 v50, v50
    v_exp_f32 v51, v51
    v_exp_f32 v52, v52
    v_exp_f32 v53, v53
    v_exp_f32 v54, v54
    v_exp_f32 v55, v55
    v_pk_add_f32 v[48:49], v[48:49], v[244:245]
    v_pk_add_f32 v[50:51], v[50:51], v[244:245]
    v_pk_add_f32 v[52:53], v[52:53], v[244:245]
    v_pk_add_f32 v[54:55], v[54:55], v[244:245]
    v_rcp_f32 v48, v48
    v_rcp_f32 v49, v49
    v_rcp_f32 v50, v50
    v_rcp_f32 v51, v51
    v_rcp_f32 v52, v52
    v_rcp_f32 v53, v53
    v_rcp_f32 v54, v54
    v_rcp_f32 v55, v55
    v_pk_mul_f32 v[40:41], v[48:49], v[40:41]
    v_pk_mul_f32 v[42:43], v[50:51], v[42:43]
    v_pk_mul_f32 v[44:45], v[52:53], v[44:45]
    v_pk_mul_f32 v[46:47], v[54:55], v[46:47]
    v_cvt_pk_bf16_f32 v56, v40, v41
    v_cvt_pk_bf16_f32 v57, v42, v43
    v_cvt_pk_bf16_f32 v58, v44, v45
    v_cvt_pk_bf16_f32 v59, v46, v47
    buffer_store_dwordx4 v[56:59], v252, s[4:7], s53 offen offset:3072 sc1
    s_add_u32 s53, s53, s22
    v_accvgpr_read_b32 v0, a96
    v_accvgpr_read_b32 v1, a97
    v_accvgpr_read_b32 v2, a98
    v_accvgpr_read_b32 v3, a99
    v_accvgpr_read_b32 v4, a100
    v_accvgpr_read_b32 v5, a101
    v_accvgpr_read_b32 v6, a102
    v_accvgpr_read_b32 v7, a103
    v_pk_mul_f32 v[8:9], v[0:1], v[0:1]
    v_pk_mul_f32 v[10:11], v[2:3], v[2:3]
    v_pk_mul_f32 v[12:13], v[4:5], v[4:5]
    v_pk_mul_f32 v[14:15], v[6:7], v[6:7]
    v_pk_fma_f32 v[8:9], v[8:9], v[242:243], v[240:241]
    v_pk_fma_f32 v[10:11], v[10:11], v[242:243], v[240:241]
    v_pk_fma_f32 v[12:13], v[12:13], v[242:243], v[240:241]
    v_pk_fma_f32 v[14:15], v[14:15], v[242:243], v[240:241]
    v_pk_mul_f32 v[8:9], v[8:9], v[0:1]
    v_pk_mul_f32 v[10:11], v[10:11], v[2:3]
    v_pk_mul_f32 v[12:13], v[12:13], v[4:5]
    v_pk_mul_f32 v[14:15], v[14:15], v[6:7]
    v_exp_f32 v8, v8
    v_exp_f32 v9, v9
    v_exp_f32 v10, v10
    v_exp_f32 v11, v11
    v_exp_f32 v12, v12
    v_exp_f32 v13, v13
    v_exp_f32 v14, v14
    v_exp_f32 v15, v15
    v_pk_add_f32 v[8:9], v[8:9], v[244:245]
    v_pk_add_f32 v[10:11], v[10:11], v[244:245]
    v_pk_add_f32 v[12:13], v[12:13], v[244:245]
    v_pk_add_f32 v[14:15], v[14:15], v[244:245]
    v_rcp_f32 v8, v8
    v_rcp_f32 v9, v9
    v_rcp_f32 v10, v10
    v_rcp_f32 v11, v11
    v_rcp_f32 v12, v12
    v_rcp_f32 v13, v13
    v_rcp_f32 v14, v14
    v_rcp_f32 v15, v15
    v_pk_mul_f32 v[0:1], v[8:9], v[0:1]
    v_pk_mul_f32 v[2:3], v[10:11], v[2:3]
    v_pk_mul_f32 v[4:5], v[12:13], v[4:5]
    v_pk_mul_f32 v[6:7], v[14:15], v[6:7]
    v_cvt_pk_bf16_f32 v16, v0, v1
    v_cvt_pk_bf16_f32 v17, v2, v3
    v_cvt_pk_bf16_f32 v18, v4, v5
    v_cvt_pk_bf16_f32 v19, v6, v7
    buffer_store_dwordx4 v[16:19], v252, s[4:7], s53 offen offset:0 sc1
    v_accvgpr_read_b32 v20, a104
    v_accvgpr_read_b32 v21, a105
    v_accvgpr_read_b32 v22, a106
    v_accvgpr_read_b32 v23, a107
    v_accvgpr_read_b32 v24, a108
    v_accvgpr_read_b32 v25, a109
    v_accvgpr_read_b32 v26, a110
    v_accvgpr_read_b32 v27, a111
    v_pk_mul_f32 v[28:29], v[20:21], v[20:21]
    v_pk_mul_f32 v[30:31], v[22:23], v[22:23]
    v_pk_mul_f32 v[32:33], v[24:25], v[24:25]
    v_pk_mul_f32 v[34:35], v[26:27], v[26:27]
    v_pk_fma_f32 v[28:29], v[28:29], v[242:243], v[240:241]
    v_pk_fma_f32 v[30:31], v[30:31], v[242:243], v[240:241]
    v_pk_fma_f32 v[32:33], v[32:33], v[242:243], v[240:241]
    v_pk_fma_f32 v[34:35], v[34:35], v[242:243], v[240:241]
    v_pk_mul_f32 v[28:29], v[28:29], v[20:21]
    v_pk_mul_f32 v[30:31], v[30:31], v[22:23]
    v_pk_mul_f32 v[32:33], v[32:33], v[24:25]
    v_pk_mul_f32 v[34:35], v[34:35], v[26:27]
    v_exp_f32 v28, v28
    v_exp_f32 v29, v29
    v_exp_f32 v30, v30
    v_exp_f32 v31, v31
    v_exp_f32 v32, v32
    v_exp_f32 v33, v33
    v_exp_f32 v34, v34
    v_exp_f32 v35, v35
    v_pk_add_f32 v[28:29], v[28:29], v[244:245]
    v_pk_add_f32 v[30:31], v[30:31], v[244:245]
    v_pk_add_f32 v[32:33], v[32:33], v[244:245]
    v_pk_add_f32 v[34:35], v[34:35], v[244:245]
    v_rcp_f32 v28, v28
    v_rcp_f32 v29, v29
    v_rcp_f32 v30, v30
    v_rcp_f32 v31, v31
    v_rcp_f32 v32, v32
    v_rcp_f32 v33, v33
    v_rcp_f32 v34, v34
    v_rcp_f32 v35, v35
    v_pk_mul_f32 v[20:21], v[28:29], v[20:21]
    v_pk_mul_f32 v[22:23], v[30:31], v[22:23]
    v_pk_mul_f32 v[24:25], v[32:33], v[24:25]
    v_pk_mul_f32 v[26:27], v[34:35], v[26:27]
    v_cvt_pk_bf16_f32 v36, v20, v21
    v_cvt_pk_bf16_f32 v37, v22, v23
    v_cvt_pk_bf16_f32 v38, v24, v25
    v_cvt_pk_bf16_f32 v39, v26, v27
    buffer_store_dwordx4 v[36:39], v252, s[4:7], s53 offen offset:1024 sc1
    v_accvgpr_read_b32 v40, a112
    v_accvgpr_read_b32 v41, a113
    v_accvgpr_read_b32 v42, a114
    v_accvgpr_read_b32 v43, a115
    v_accvgpr_read_b32 v44, a116
    v_accvgpr_read_b32 v45, a117
    v_accvgpr_read_b32 v46, a118
    v_accvgpr_read_b32 v47, a119
    v_pk_mul_f32 v[48:49], v[40:41], v[40:41]
    v_pk_mul_f32 v[50:51], v[42:43], v[42:43]
    v_pk_mul_f32 v[52:53], v[44:45], v[44:45]
    v_pk_mul_f32 v[54:55], v[46:47], v[46:47]
    v_pk_fma_f32 v[48:49], v[48:49], v[242:243], v[240:241]
    v_pk_fma_f32 v[50:51], v[50:51], v[242:243], v[240:241]
    v_pk_fma_f32 v[52:53], v[52:53], v[242:243], v[240:241]
    v_pk_fma_f32 v[54:55], v[54:55], v[242:243], v[240:241]
    v_pk_mul_f32 v[48:49], v[48:49], v[40:41]
    v_pk_mul_f32 v[50:51], v[50:51], v[42:43]
    v_pk_mul_f32 v[52:53], v[52:53], v[44:45]
    v_pk_mul_f32 v[54:55], v[54:55], v[46:47]
    v_exp_f32 v48, v48
    v_exp_f32 v49, v49
    v_exp_f32 v50, v50
    v_exp_f32 v51, v51
    v_exp_f32 v52, v52
    v_exp_f32 v53, v53
    v_exp_f32 v54, v54
    v_exp_f32 v55, v55
    v_pk_add_f32 v[48:49], v[48:49], v[244:245]
    v_pk_add_f32 v[50:51], v[50:51], v[244:245]
    v_pk_add_f32 v[52:53], v[52:53], v[244:245]
    v_pk_add_f32 v[54:55], v[54:55], v[244:245]
    v_rcp_f32 v48, v48
    v_rcp_f32 v49, v49
    v_rcp_f32 v50, v50
    v_rcp_f32 v51, v51
    v_rcp_f32 v52, v52
    v_rcp_f32 v53, v53
    v_rcp_f32 v54, v54
    v_rcp_f32 v55, v55
    v_pk_mul_f32 v[40:41], v[48:49], v[40:41]
    v_pk_mul_f32 v[42:43], v[50:51], v[42:43]
    v_pk_mul_f32 v[44:45], v[52:53], v[44:45]
    v_pk_mul_f32 v[46:47], v[54:55], v[46:47]
    v_cvt_pk_bf16_f32 v56, v40, v41
    v_cvt_pk_bf16_f32 v57, v42, v43
    v_cvt_pk_bf16_f32 v58, v44, v45
    v_cvt_pk_bf16_f32 v59, v46, v47
    buffer_store_dwordx4 v[56:59], v252, s[4:7], s53 offen offset:2048 sc1
    v_accvgpr_read_b32 v0, a120
    v_accvgpr_read_b32 v1, a121
    v_accvgpr_read_b32 v2, a122
    v_accvgpr_read_b32 v3, a123
    v_accvgpr_read_b32 v4, a124
    v_accvgpr_read_b32 v5, a125
    v_accvgpr_read_b32 v6, a126
    v_accvgpr_read_b32 v7, a127
    v_pk_mul_f32 v[8:9], v[0:1], v[0:1]
    v_pk_mul_f32 v[10:11], v[2:3], v[2:3]
    v_pk_mul_f32 v[12:13], v[4:5], v[4:5]
    v_pk_mul_f32 v[14:15], v[6:7], v[6:7]
    v_pk_fma_f32 v[8:9], v[8:9], v[242:243], v[240:241]
    v_pk_fma_f32 v[10:11], v[10:11], v[242:243], v[240:241]
    v_pk_fma_f32 v[12:13], v[12:13], v[242:243], v[240:241]
    v_pk_fma_f32 v[14:15], v[14:15], v[242:243], v[240:241]
    v_pk_mul_f32 v[8:9], v[8:9], v[0:1]
    v_pk_mul_f32 v[10:11], v[10:11], v[2:3]
    v_pk_mul_f32 v[12:13], v[12:13], v[4:5]
    v_pk_mul_f32 v[14:15], v[14:15], v[6:7]
    v_exp_f32 v8, v8
    v_exp_f32 v9, v9
    v_exp_f32 v10, v10
    v_exp_f32 v11, v11
    v_exp_f32 v12, v12
    v_exp_f32 v13, v13
    v_exp_f32 v14, v14
    v_exp_f32 v15, v15
    v_pk_add_f32 v[8:9], v[8:9], v[244:245]
    v_pk_add_f32 v[10:11], v[10:11], v[244:245]
    v_pk_add_f32 v[12:13], v[12:13], v[244:245]
    v_pk_add_f32 v[14:15], v[14:15], v[244:245]
    v_rcp_f32 v8, v8
    v_rcp_f32 v9, v9
    v_rcp_f32 v10, v10
    v_rcp_f32 v11, v11
    v_rcp_f32 v12, v12
    v_rcp_f32 v13, v13
    v_rcp_f32 v14, v14
    v_rcp_f32 v15, v15
    v_pk_mul_f32 v[0:1], v[8:9], v[0:1]
    v_pk_mul_f32 v[2:3], v[10:11], v[2:3]
    v_pk_mul_f32 v[4:5], v[12:13], v[4:5]
    v_pk_mul_f32 v[6:7], v[14:15], v[6:7]
    v_cvt_pk_bf16_f32 v16, v0, v1
    v_cvt_pk_bf16_f32 v17, v2, v3
    v_cvt_pk_bf16_f32 v18, v4, v5
    v_cvt_pk_bf16_f32 v19, v6, v7
    buffer_store_dwordx4 v[16:19], v252, s[4:7], s53 offen offset:3072 sc1
    s_branch main_kernel_w_done
main_kernel_w_c1_egelu:
    s_mov_b32 s53, s21
    v_accvgpr_read_b32 v0, a0
    v_accvgpr_read_b32 v1, a1
    v_accvgpr_read_b32 v2, a2
    v_accvgpr_read_b32 v3, a3
    v_accvgpr_read_b32 v4, a4
    v_accvgpr_read_b32 v5, a5
    v_accvgpr_read_b32 v6, a6
    v_accvgpr_read_b32 v7, a7
    v_pk_mul_f32 v[8:9], v[0:1], v[0:1]
    v_pk_mul_f32 v[10:11], v[2:3], v[2:3]
    v_pk_mul_f32 v[12:13], v[4:5], v[4:5]
    v_pk_mul_f32 v[14:15], v[6:7], v[6:7]
    v_pk_fma_f32 v[8:9], v[8:9], v[242:243], v[240:241]
    v_pk_fma_f32 v[10:11], v[10:11], v[242:243], v[240:241]
    v_pk_fma_f32 v[12:13], v[12:13], v[242:243], v[240:241]
    v_pk_fma_f32 v[14:15], v[14:15], v[242:243], v[240:241]
    v_pk_mul_f32 v[8:9], v[8:9], v[0:1]
    v_pk_mul_f32 v[10:11], v[10:11], v[2:3]
    v_pk_mul_f32 v[12:13], v[12:13], v[4:5]
    v_pk_mul_f32 v[14:15], v[14:15], v[6:7]
    v_exp_f32 v8, v8
    v_exp_f32 v9, v9
    v_exp_f32 v10, v10
    v_exp_f32 v11, v11
    v_exp_f32 v12, v12
    v_exp_f32 v13, v13
    v_exp_f32 v14, v14
    v_exp_f32 v15, v15
    v_pk_add_f32 v[8:9], v[8:9], v[244:245]
    v_pk_add_f32 v[10:11], v[10:11], v[244:245]
    v_pk_add_f32 v[12:13], v[12:13], v[244:245]
    v_pk_add_f32 v[14:15], v[14:15], v[244:245]
    v_rcp_f32 v8, v8
    v_rcp_f32 v9, v9
    v_rcp_f32 v10, v10
    v_rcp_f32 v11, v11
    v_rcp_f32 v12, v12
    v_rcp_f32 v13, v13
    v_rcp_f32 v14, v14
    v_rcp_f32 v15, v15
    v_pk_mul_f32 v[0:1], v[8:9], v[0:1]
    v_pk_mul_f32 v[2:3], v[10:11], v[2:3]
    v_pk_mul_f32 v[4:5], v[12:13], v[4:5]
    v_pk_mul_f32 v[6:7], v[14:15], v[6:7]
    v_cvt_pk_bf16_f32 v16, v0, v1
    v_cvt_pk_bf16_f32 v17, v2, v3
    v_cvt_pk_bf16_f32 v18, v4, v5
    v_cvt_pk_bf16_f32 v19, v6, v7
    buffer_store_dwordx4 v[16:19], v251, s[4:7], s53 offen offset:0 sc1
    v_accvgpr_read_b32 v20, a8
    v_accvgpr_read_b32 v21, a9
    v_accvgpr_read_b32 v22, a10
    v_accvgpr_read_b32 v23, a11
    v_accvgpr_read_b32 v24, a12
    v_accvgpr_read_b32 v25, a13
    v_accvgpr_read_b32 v26, a14
    v_accvgpr_read_b32 v27, a15
    v_pk_mul_f32 v[28:29], v[20:21], v[20:21]
    v_pk_mul_f32 v[30:31], v[22:23], v[22:23]
    v_pk_mul_f32 v[32:33], v[24:25], v[24:25]
    v_pk_mul_f32 v[34:35], v[26:27], v[26:27]
    v_pk_fma_f32 v[28:29], v[28:29], v[242:243], v[240:241]
    v_pk_fma_f32 v[30:31], v[30:31], v[242:243], v[240:241]
    v_pk_fma_f32 v[32:33], v[32:33], v[242:243], v[240:241]
    v_pk_fma_f32 v[34:35], v[34:35], v[242:243], v[240:241]
    v_pk_mul_f32 v[28:29], v[28:29], v[20:21]
    v_pk_mul_f32 v[30:31], v[30:31], v[22:23]
    v_pk_mul_f32 v[32:33], v[32:33], v[24:25]
    v_pk_mul_f32 v[34:35], v[34:35], v[26:27]
    v_exp_f32 v28, v28
    v_exp_f32 v29, v29
    v_exp_f32 v30, v30
    v_exp_f32 v31, v31
    v_exp_f32 v32, v32
    v_exp_f32 v33, v33
    v_exp_f32 v34, v34
    v_exp_f32 v35, v35
    v_pk_add_f32 v[28:29], v[28:29], v[244:245]
    v_pk_add_f32 v[30:31], v[30:31], v[244:245]
    v_pk_add_f32 v[32:33], v[32:33], v[244:245]
    v_pk_add_f32 v[34:35], v[34:35], v[244:245]
    v_rcp_f32 v28, v28
    v_rcp_f32 v29, v29
    v_rcp_f32 v30, v30
    v_rcp_f32 v31, v31
    v_rcp_f32 v32, v32
    v_rcp_f32 v33, v33
    v_rcp_f32 v34, v34
    v_rcp_f32 v35, v35
    v_pk_mul_f32 v[20:21], v[28:29], v[20:21]
    v_pk_mul_f32 v[22:23], v[30:31], v[22:23]
    v_pk_mul_f32 v[24:25], v[32:33], v[24:25]
    v_pk_mul_f32 v[26:27], v[34:35], v[26:27]
    v_cvt_pk_bf16_f32 v36, v20, v21
    v_cvt_pk_bf16_f32 v37, v22, v23
    v_cvt_pk_bf16_f32 v38, v24, v25
    v_cvt_pk_bf16_f32 v39, v26, v27
    buffer_store_dwordx4 v[36:39], v251, s[4:7], s53 offen offset:1024 sc1
    v_accvgpr_read_b32 v40, a16
    v_accvgpr_read_b32 v41, a17
    v_accvgpr_read_b32 v42, a18
    v_accvgpr_read_b32 v43, a19
    v_accvgpr_read_b32 v44, a20
    v_accvgpr_read_b32 v45, a21
    v_accvgpr_read_b32 v46, a22
    v_accvgpr_read_b32 v47, a23
    v_pk_mul_f32 v[48:49], v[40:41], v[40:41]
    v_pk_mul_f32 v[50:51], v[42:43], v[42:43]
    v_pk_mul_f32 v[52:53], v[44:45], v[44:45]
    v_pk_mul_f32 v[54:55], v[46:47], v[46:47]
    v_pk_fma_f32 v[48:49], v[48:49], v[242:243], v[240:241]
    v_pk_fma_f32 v[50:51], v[50:51], v[242:243], v[240:241]
    v_pk_fma_f32 v[52:53], v[52:53], v[242:243], v[240:241]
    v_pk_fma_f32 v[54:55], v[54:55], v[242:243], v[240:241]
    v_pk_mul_f32 v[48:49], v[48:49], v[40:41]
    v_pk_mul_f32 v[50:51], v[50:51], v[42:43]
    v_pk_mul_f32 v[52:53], v[52:53], v[44:45]
    v_pk_mul_f32 v[54:55], v[54:55], v[46:47]
    v_exp_f32 v48, v48
    v_exp_f32 v49, v49
    v_exp_f32 v50, v50
    v_exp_f32 v51, v51
    v_exp_f32 v52, v52
    v_exp_f32 v53, v53
    v_exp_f32 v54, v54
    v_exp_f32 v55, v55
    v_pk_add_f32 v[48:49], v[48:49], v[244:245]
    v_pk_add_f32 v[50:51], v[50:51], v[244:245]
    v_pk_add_f32 v[52:53], v[52:53], v[244:245]
    v_pk_add_f32 v[54:55], v[54:55], v[244:245]
    v_rcp_f32 v48, v48
    v_rcp_f32 v49, v49
    v_rcp_f32 v50, v50
    v_rcp_f32 v51, v51
    v_rcp_f32 v52, v52
    v_rcp_f32 v53, v53
    v_rcp_f32 v54, v54
    v_rcp_f32 v55, v55
    v_pk_mul_f32 v[40:41], v[48:49], v[40:41]
    v_pk_mul_f32 v[42:43], v[50:51], v[42:43]
    v_pk_mul_f32 v[44:45], v[52:53], v[44:45]
    v_pk_mul_f32 v[46:47], v[54:55], v[46:47]
    v_cvt_pk_bf16_f32 v56, v40, v41
    v_cvt_pk_bf16_f32 v57, v42, v43
    v_cvt_pk_bf16_f32 v58, v44, v45
    v_cvt_pk_bf16_f32 v59, v46, v47
    buffer_store_dwordx4 v[56:59], v251, s[4:7], s53 offen offset:2048 sc1
    v_accvgpr_read_b32 v0, a24
    v_accvgpr_read_b32 v1, a25
    v_accvgpr_read_b32 v2, a26
    v_accvgpr_read_b32 v3, a27
    v_accvgpr_read_b32 v4, a28
    v_accvgpr_read_b32 v5, a29
    v_accvgpr_read_b32 v6, a30
    v_accvgpr_read_b32 v7, a31
    v_pk_mul_f32 v[8:9], v[0:1], v[0:1]
    v_pk_mul_f32 v[10:11], v[2:3], v[2:3]
    v_pk_mul_f32 v[12:13], v[4:5], v[4:5]
    v_pk_mul_f32 v[14:15], v[6:7], v[6:7]
    v_pk_fma_f32 v[8:9], v[8:9], v[242:243], v[240:241]
    v_pk_fma_f32 v[10:11], v[10:11], v[242:243], v[240:241]
    v_pk_fma_f32 v[12:13], v[12:13], v[242:243], v[240:241]
    v_pk_fma_f32 v[14:15], v[14:15], v[242:243], v[240:241]
    v_pk_mul_f32 v[8:9], v[8:9], v[0:1]
    v_pk_mul_f32 v[10:11], v[10:11], v[2:3]
    v_pk_mul_f32 v[12:13], v[12:13], v[4:5]
    v_pk_mul_f32 v[14:15], v[14:15], v[6:7]
    v_exp_f32 v8, v8
    v_exp_f32 v9, v9
    v_exp_f32 v10, v10
    v_exp_f32 v11, v11
    v_exp_f32 v12, v12
    v_exp_f32 v13, v13
    v_exp_f32 v14, v14
    v_exp_f32 v15, v15
    v_pk_add_f32 v[8:9], v[8:9], v[244:245]
    v_pk_add_f32 v[10:11], v[10:11], v[244:245]
    v_pk_add_f32 v[12:13], v[12:13], v[244:245]
    v_pk_add_f32 v[14:15], v[14:15], v[244:245]
    v_rcp_f32 v8, v8
    v_rcp_f32 v9, v9
    v_rcp_f32 v10, v10
    v_rcp_f32 v11, v11
    v_rcp_f32 v12, v12
    v_rcp_f32 v13, v13
    v_rcp_f32 v14, v14
    v_rcp_f32 v15, v15
    v_pk_mul_f32 v[0:1], v[8:9], v[0:1]
    v_pk_mul_f32 v[2:3], v[10:11], v[2:3]
    v_pk_mul_f32 v[4:5], v[12:13], v[4:5]
    v_pk_mul_f32 v[6:7], v[14:15], v[6:7]
    v_cvt_pk_bf16_f32 v16, v0, v1
    v_cvt_pk_bf16_f32 v17, v2, v3
    v_cvt_pk_bf16_f32 v18, v4, v5
    v_cvt_pk_bf16_f32 v19, v6, v7
    buffer_store_dwordx4 v[16:19], v251, s[4:7], s53 offen offset:3072 sc1
    s_add_u32 s53, s53, s22
    v_accvgpr_read_b32 v20, a32
    v_accvgpr_read_b32 v21, a33
    v_accvgpr_read_b32 v22, a34
    v_accvgpr_read_b32 v23, a35
    v_accvgpr_read_b32 v24, a36
    v_accvgpr_read_b32 v25, a37
    v_accvgpr_read_b32 v26, a38
    v_accvgpr_read_b32 v27, a39
    v_pk_mul_f32 v[28:29], v[20:21], v[20:21]
    v_pk_mul_f32 v[30:31], v[22:23], v[22:23]
    v_pk_mul_f32 v[32:33], v[24:25], v[24:25]
    v_pk_mul_f32 v[34:35], v[26:27], v[26:27]
    v_pk_fma_f32 v[28:29], v[28:29], v[242:243], v[240:241]
    v_pk_fma_f32 v[30:31], v[30:31], v[242:243], v[240:241]
    v_pk_fma_f32 v[32:33], v[32:33], v[242:243], v[240:241]
    v_pk_fma_f32 v[34:35], v[34:35], v[242:243], v[240:241]
    v_pk_mul_f32 v[28:29], v[28:29], v[20:21]
    v_pk_mul_f32 v[30:31], v[30:31], v[22:23]
    v_pk_mul_f32 v[32:33], v[32:33], v[24:25]
    v_pk_mul_f32 v[34:35], v[34:35], v[26:27]
    v_exp_f32 v28, v28
    v_exp_f32 v29, v29
    v_exp_f32 v30, v30
    v_exp_f32 v31, v31
    v_exp_f32 v32, v32
    v_exp_f32 v33, v33
    v_exp_f32 v34, v34
    v_exp_f32 v35, v35
    v_pk_add_f32 v[28:29], v[28:29], v[244:245]
    v_pk_add_f32 v[30:31], v[30:31], v[244:245]
    v_pk_add_f32 v[32:33], v[32:33], v[244:245]
    v_pk_add_f32 v[34:35], v[34:35], v[244:245]
    v_rcp_f32 v28, v28
    v_rcp_f32 v29, v29
    v_rcp_f32 v30, v30
    v_rcp_f32 v31, v31
    v_rcp_f32 v32, v32
    v_rcp_f32 v33, v33
    v_rcp_f32 v34, v34
    v_rcp_f32 v35, v35
    v_pk_mul_f32 v[20:21], v[28:29], v[20:21]
    v_pk_mul_f32 v[22:23], v[30:31], v[22:23]
    v_pk_mul_f32 v[24:25], v[32:33], v[24:25]
    v_pk_mul_f32 v[26:27], v[34:35], v[26:27]
    v_cvt_pk_bf16_f32 v36, v20, v21
    v_cvt_pk_bf16_f32 v37, v22, v23
    v_cvt_pk_bf16_f32 v38, v24, v25
    v_cvt_pk_bf16_f32 v39, v26, v27
    buffer_store_dwordx4 v[36:39], v251, s[4:7], s53 offen offset:0 sc1
    v_accvgpr_read_b32 v40, a40
    v_accvgpr_read_b32 v41, a41
    v_accvgpr_read_b32 v42, a42
    v_accvgpr_read_b32 v43, a43
    v_accvgpr_read_b32 v44, a44
    v_accvgpr_read_b32 v45, a45
    v_accvgpr_read_b32 v46, a46
    v_accvgpr_read_b32 v47, a47
    v_pk_mul_f32 v[48:49], v[40:41], v[40:41]
    v_pk_mul_f32 v[50:51], v[42:43], v[42:43]
    v_pk_mul_f32 v[52:53], v[44:45], v[44:45]
    v_pk_mul_f32 v[54:55], v[46:47], v[46:47]
    v_pk_fma_f32 v[48:49], v[48:49], v[242:243], v[240:241]
    v_pk_fma_f32 v[50:51], v[50:51], v[242:243], v[240:241]
    v_pk_fma_f32 v[52:53], v[52:53], v[242:243], v[240:241]
    v_pk_fma_f32 v[54:55], v[54:55], v[242:243], v[240:241]
    v_pk_mul_f32 v[48:49], v[48:49], v[40:41]
    v_pk_mul_f32 v[50:51], v[50:51], v[42:43]
    v_pk_mul_f32 v[52:53], v[52:53], v[44:45]
    v_pk_mul_f32 v[54:55], v[54:55], v[46:47]
    v_exp_f32 v48, v48
    v_exp_f32 v49, v49
    v_exp_f32 v50, v50
    v_exp_f32 v51, v51
    v_exp_f32 v52, v52
    v_exp_f32 v53, v53
    v_exp_f32 v54, v54
    v_exp_f32 v55, v55
    v_pk_add_f32 v[48:49], v[48:49], v[244:245]
    v_pk_add_f32 v[50:51], v[50:51], v[244:245]
    v_pk_add_f32 v[52:53], v[52:53], v[244:245]
    v_pk_add_f32 v[54:55], v[54:55], v[244:245]
    v_rcp_f32 v48, v48
    v_rcp_f32 v49, v49
    v_rcp_f32 v50, v50
    v_rcp_f32 v51, v51
    v_rcp_f32 v52, v52
    v_rcp_f32 v53, v53
    v_rcp_f32 v54, v54
    v_rcp_f32 v55, v55
    v_pk_mul_f32 v[40:41], v[48:49], v[40:41]
    v_pk_mul_f32 v[42:43], v[50:51], v[42:43]
    v_pk_mul_f32 v[44:45], v[52:53], v[44:45]
    v_pk_mul_f32 v[46:47], v[54:55], v[46:47]
    v_cvt_pk_bf16_f32 v56, v40, v41
    v_cvt_pk_bf16_f32 v57, v42, v43
    v_cvt_pk_bf16_f32 v58, v44, v45
    v_cvt_pk_bf16_f32 v59, v46, v47
    buffer_store_dwordx4 v[56:59], v251, s[4:7], s53 offen offset:1024 sc1
    v_accvgpr_read_b32 v0, a48
    v_accvgpr_read_b32 v1, a49
    v_accvgpr_read_b32 v2, a50
    v_accvgpr_read_b32 v3, a51
    v_accvgpr_read_b32 v4, a52
    v_accvgpr_read_b32 v5, a53
    v_accvgpr_read_b32 v6, a54
    v_accvgpr_read_b32 v7, a55
    v_pk_mul_f32 v[8:9], v[0:1], v[0:1]
    v_pk_mul_f32 v[10:11], v[2:3], v[2:3]
    v_pk_mul_f32 v[12:13], v[4:5], v[4:5]
    v_pk_mul_f32 v[14:15], v[6:7], v[6:7]
    v_pk_fma_f32 v[8:9], v[8:9], v[242:243], v[240:241]
    v_pk_fma_f32 v[10:11], v[10:11], v[242:243], v[240:241]
    v_pk_fma_f32 v[12:13], v[12:13], v[242:243], v[240:241]
    v_pk_fma_f32 v[14:15], v[14:15], v[242:243], v[240:241]
    v_pk_mul_f32 v[8:9], v[8:9], v[0:1]
    v_pk_mul_f32 v[10:11], v[10:11], v[2:3]
    v_pk_mul_f32 v[12:13], v[12:13], v[4:5]
    v_pk_mul_f32 v[14:15], v[14:15], v[6:7]
    v_exp_f32 v8, v8
    v_exp_f32 v9, v9
    v_exp_f32 v10, v10
    v_exp_f32 v11, v11
    v_exp_f32 v12, v12
    v_exp_f32 v13, v13
    v_exp_f32 v14, v14
    v_exp_f32 v15, v15
    v_pk_add_f32 v[8:9], v[8:9], v[244:245]
    v_pk_add_f32 v[10:11], v[10:11], v[244:245]
    v_pk_add_f32 v[12:13], v[12:13], v[244:245]
    v_pk_add_f32 v[14:15], v[14:15], v[244:245]
    v_rcp_f32 v8, v8
    v_rcp_f32 v9, v9
    v_rcp_f32 v10, v10
    v_rcp_f32 v11, v11
    v_rcp_f32 v12, v12
    v_rcp_f32 v13, v13
    v_rcp_f32 v14, v14
    v_rcp_f32 v15, v15
    v_pk_mul_f32 v[0:1], v[8:9], v[0:1]
    v_pk_mul_f32 v[2:3], v[10:11], v[2:3]
    v_pk_mul_f32 v[4:5], v[12:13], v[4:5]
    v_pk_mul_f32 v[6:7], v[14:15], v[6:7]
    v_cvt_pk_bf16_f32 v16, v0, v1
    v_cvt_pk_bf16_f32 v17, v2, v3
    v_cvt_pk_bf16_f32 v18, v4, v5
    v_cvt_pk_bf16_f32 v19, v6, v7
    buffer_store_dwordx4 v[16:19], v251, s[4:7], s53 offen offset:2048 sc1
    v_accvgpr_read_b32 v20, a56
    v_accvgpr_read_b32 v21, a57
    v_accvgpr_read_b32 v22, a58
    v_accvgpr_read_b32 v23, a59
    v_accvgpr_read_b32 v24, a60
    v_accvgpr_read_b32 v25, a61
    v_accvgpr_read_b32 v26, a62
    v_accvgpr_read_b32 v27, a63
    v_pk_mul_f32 v[28:29], v[20:21], v[20:21]
    v_pk_mul_f32 v[30:31], v[22:23], v[22:23]
    v_pk_mul_f32 v[32:33], v[24:25], v[24:25]
    v_pk_mul_f32 v[34:35], v[26:27], v[26:27]
    v_pk_fma_f32 v[28:29], v[28:29], v[242:243], v[240:241]
    v_pk_fma_f32 v[30:31], v[30:31], v[242:243], v[240:241]
    v_pk_fma_f32 v[32:33], v[32:33], v[242:243], v[240:241]
    v_pk_fma_f32 v[34:35], v[34:35], v[242:243], v[240:241]
    v_pk_mul_f32 v[28:29], v[28:29], v[20:21]
    v_pk_mul_f32 v[30:31], v[30:31], v[22:23]
    v_pk_mul_f32 v[32:33], v[32:33], v[24:25]
    v_pk_mul_f32 v[34:35], v[34:35], v[26:27]
    v_exp_f32 v28, v28
    v_exp_f32 v29, v29
    v_exp_f32 v30, v30
    v_exp_f32 v31, v31
    v_exp_f32 v32, v32
    v_exp_f32 v33, v33
    v_exp_f32 v34, v34
    v_exp_f32 v35, v35
    v_pk_add_f32 v[28:29], v[28:29], v[244:245]
    v_pk_add_f32 v[30:31], v[30:31], v[244:245]
    v_pk_add_f32 v[32:33], v[32:33], v[244:245]
    v_pk_add_f32 v[34:35], v[34:35], v[244:245]
    v_rcp_f32 v28, v28
    v_rcp_f32 v29, v29
    v_rcp_f32 v30, v30
    v_rcp_f32 v31, v31
    v_rcp_f32 v32, v32
    v_rcp_f32 v33, v33
    v_rcp_f32 v34, v34
    v_rcp_f32 v35, v35
    v_pk_mul_f32 v[20:21], v[28:29], v[20:21]
    v_pk_mul_f32 v[22:23], v[30:31], v[22:23]
    v_pk_mul_f32 v[24:25], v[32:33], v[24:25]
    v_pk_mul_f32 v[26:27], v[34:35], v[26:27]
    v_cvt_pk_bf16_f32 v36, v20, v21
    v_cvt_pk_bf16_f32 v37, v22, v23
    v_cvt_pk_bf16_f32 v38, v24, v25
    v_cvt_pk_bf16_f32 v39, v26, v27
    buffer_store_dwordx4 v[36:39], v251, s[4:7], s53 offen offset:3072 sc1
    s_add_u32 s53, s53, s22
    v_accvgpr_read_b32 v40, a64
    v_accvgpr_read_b32 v41, a65
    v_accvgpr_read_b32 v42, a66
    v_accvgpr_read_b32 v43, a67
    v_accvgpr_read_b32 v44, a68
    v_accvgpr_read_b32 v45, a69
    v_accvgpr_read_b32 v46, a70
    v_accvgpr_read_b32 v47, a71
    v_pk_mul_f32 v[48:49], v[40:41], v[40:41]
    v_pk_mul_f32 v[50:51], v[42:43], v[42:43]
    v_pk_mul_f32 v[52:53], v[44:45], v[44:45]
    v_pk_mul_f32 v[54:55], v[46:47], v[46:47]
    v_pk_fma_f32 v[48:49], v[48:49], v[242:243], v[240:241]
    v_pk_fma_f32 v[50:51], v[50:51], v[242:243], v[240:241]
    v_pk_fma_f32 v[52:53], v[52:53], v[242:243], v[240:241]
    v_pk_fma_f32 v[54:55], v[54:55], v[242:243], v[240:241]
    v_pk_mul_f32 v[48:49], v[48:49], v[40:41]
    v_pk_mul_f32 v[50:51], v[50:51], v[42:43]
    v_pk_mul_f32 v[52:53], v[52:53], v[44:45]
    v_pk_mul_f32 v[54:55], v[54:55], v[46:47]
    v_exp_f32 v48, v48
    v_exp_f32 v49, v49
    v_exp_f32 v50, v50
    v_exp_f32 v51, v51
    v_exp_f32 v52, v52
    v_exp_f32 v53, v53
    v_exp_f32 v54, v54
    v_exp_f32 v55, v55
    v_pk_add_f32 v[48:49], v[48:49], v[244:245]
    v_pk_add_f32 v[50:51], v[50:51], v[244:245]
    v_pk_add_f32 v[52:53], v[52:53], v[244:245]
    v_pk_add_f32 v[54:55], v[54:55], v[244:245]
    v_rcp_f32 v48, v48
    v_rcp_f32 v49, v49
    v_rcp_f32 v50, v50
    v_rcp_f32 v51, v51
    v_rcp_f32 v52, v52
    v_rcp_f32 v53, v53
    v_rcp_f32 v54, v54
    v_rcp_f32 v55, v55
    v_pk_mul_f32 v[40:41], v[48:49], v[40:41]
    v_pk_mul_f32 v[42:43], v[50:51], v[42:43]
    v_pk_mul_f32 v[44:45], v[52:53], v[44:45]
    v_pk_mul_f32 v[46:47], v[54:55], v[46:47]
    v_cvt_pk_bf16_f32 v56, v40, v41
    v_cvt_pk_bf16_f32 v57, v42, v43
    v_cvt_pk_bf16_f32 v58, v44, v45
    v_cvt_pk_bf16_f32 v59, v46, v47
    buffer_store_dwordx4 v[56:59], v251, s[4:7], s53 offen offset:0 sc1
    v_accvgpr_read_b32 v0, a72
    v_accvgpr_read_b32 v1, a73
    v_accvgpr_read_b32 v2, a74
    v_accvgpr_read_b32 v3, a75
    v_accvgpr_read_b32 v4, a76
    v_accvgpr_read_b32 v5, a77
    v_accvgpr_read_b32 v6, a78
    v_accvgpr_read_b32 v7, a79
    v_pk_mul_f32 v[8:9], v[0:1], v[0:1]
    v_pk_mul_f32 v[10:11], v[2:3], v[2:3]
    v_pk_mul_f32 v[12:13], v[4:5], v[4:5]
    v_pk_mul_f32 v[14:15], v[6:7], v[6:7]
    v_pk_fma_f32 v[8:9], v[8:9], v[242:243], v[240:241]
    v_pk_fma_f32 v[10:11], v[10:11], v[242:243], v[240:241]
    v_pk_fma_f32 v[12:13], v[12:13], v[242:243], v[240:241]
    v_pk_fma_f32 v[14:15], v[14:15], v[242:243], v[240:241]
    v_pk_mul_f32 v[8:9], v[8:9], v[0:1]
    v_pk_mul_f32 v[10:11], v[10:11], v[2:3]
    v_pk_mul_f32 v[12:13], v[12:13], v[4:5]
    v_pk_mul_f32 v[14:15], v[14:15], v[6:7]
    v_exp_f32 v8, v8
    v_exp_f32 v9, v9
    v_exp_f32 v10, v10
    v_exp_f32 v11, v11
    v_exp_f32 v12, v12
    v_exp_f32 v13, v13
    v_exp_f32 v14, v14
    v_exp_f32 v15, v15
    v_pk_add_f32 v[8:9], v[8:9], v[244:245]
    v_pk_add_f32 v[10:11], v[10:11], v[244:245]
    v_pk_add_f32 v[12:13], v[12:13], v[244:245]
    v_pk_add_f32 v[14:15], v[14:15], v[244:245]
    v_rcp_f32 v8, v8
    v_rcp_f32 v9, v9
    v_rcp_f32 v10, v10
    v_rcp_f32 v11, v11
    v_rcp_f32 v12, v12
    v_rcp_f32 v13, v13
    v_rcp_f32 v14, v14
    v_rcp_f32 v15, v15
    v_pk_mul_f32 v[0:1], v[8:9], v[0:1]
    v_pk_mul_f32 v[2:3], v[10:11], v[2:3]
    v_pk_mul_f32 v[4:5], v[12:13], v[4:5]
    v_pk_mul_f32 v[6:7], v[14:15], v[6:7]
    v_cvt_pk_bf16_f32 v16, v0, v1
    v_cvt_pk_bf16_f32 v17, v2, v3
    v_cvt_pk_bf16_f32 v18, v4, v5
    v_cvt_pk_bf16_f32 v19, v6, v7
    buffer_store_dwordx4 v[16:19], v251, s[4:7], s53 offen offset:1024 sc1
    v_accvgpr_read_b32 v20, a80
    v_accvgpr_read_b32 v21, a81
    v_accvgpr_read_b32 v22, a82
    v_accvgpr_read_b32 v23, a83
    v_accvgpr_read_b32 v24, a84
    v_accvgpr_read_b32 v25, a85
    v_accvgpr_read_b32 v26, a86
    v_accvgpr_read_b32 v27, a87
    v_pk_mul_f32 v[28:29], v[20:21], v[20:21]
    v_pk_mul_f32 v[30:31], v[22:23], v[22:23]
    v_pk_mul_f32 v[32:33], v[24:25], v[24:25]
    v_pk_mul_f32 v[34:35], v[26:27], v[26:27]
    v_pk_fma_f32 v[28:29], v[28:29], v[242:243], v[240:241]
    v_pk_fma_f32 v[30:31], v[30:31], v[242:243], v[240:241]
    v_pk_fma_f32 v[32:33], v[32:33], v[242:243], v[240:241]
    v_pk_fma_f32 v[34:35], v[34:35], v[242:243], v[240:241]
    v_pk_mul_f32 v[28:29], v[28:29], v[20:21]
    v_pk_mul_f32 v[30:31], v[30:31], v[22:23]
    v_pk_mul_f32 v[32:33], v[32:33], v[24:25]
    v_pk_mul_f32 v[34:35], v[34:35], v[26:27]
    v_exp_f32 v28, v28
    v_exp_f32 v29, v29
    v_exp_f32 v30, v30
    v_exp_f32 v31, v31
    v_exp_f32 v32, v32
    v_exp_f32 v33, v33
    v_exp_f32 v34, v34
    v_exp_f32 v35, v35
    v_pk_add_f32 v[28:29], v[28:29], v[244:245]
    v_pk_add_f32 v[30:31], v[30:31], v[244:245]
    v_pk_add_f32 v[32:33], v[32:33], v[244:245]
    v_pk_add_f32 v[34:35], v[34:35], v[244:245]
    v_rcp_f32 v28, v28
    v_rcp_f32 v29, v29
    v_rcp_f32 v30, v30
    v_rcp_f32 v31, v31
    v_rcp_f32 v32, v32
    v_rcp_f32 v33, v33
    v_rcp_f32 v34, v34
    v_rcp_f32 v35, v35
    v_pk_mul_f32 v[20:21], v[28:29], v[20:21]
    v_pk_mul_f32 v[22:23], v[30:31], v[22:23]
    v_pk_mul_f32 v[24:25], v[32:33], v[24:25]
    v_pk_mul_f32 v[26:27], v[34:35], v[26:27]
    v_cvt_pk_bf16_f32 v36, v20, v21
    v_cvt_pk_bf16_f32 v37, v22, v23
    v_cvt_pk_bf16_f32 v38, v24, v25
    v_cvt_pk_bf16_f32 v39, v26, v27
    buffer_store_dwordx4 v[36:39], v251, s[4:7], s53 offen offset:2048 sc1
    v_accvgpr_read_b32 v40, a88
    v_accvgpr_read_b32 v41, a89
    v_accvgpr_read_b32 v42, a90
    v_accvgpr_read_b32 v43, a91
    v_accvgpr_read_b32 v44, a92
    v_accvgpr_read_b32 v45, a93
    v_accvgpr_read_b32 v46, a94
    v_accvgpr_read_b32 v47, a95
    v_pk_mul_f32 v[48:49], v[40:41], v[40:41]
    v_pk_mul_f32 v[50:51], v[42:43], v[42:43]
    v_pk_mul_f32 v[52:53], v[44:45], v[44:45]
    v_pk_mul_f32 v[54:55], v[46:47], v[46:47]
    v_pk_fma_f32 v[48:49], v[48:49], v[242:243], v[240:241]
    v_pk_fma_f32 v[50:51], v[50:51], v[242:243], v[240:241]
    v_pk_fma_f32 v[52:53], v[52:53], v[242:243], v[240:241]
    v_pk_fma_f32 v[54:55], v[54:55], v[242:243], v[240:241]
    v_pk_mul_f32 v[48:49], v[48:49], v[40:41]
    v_pk_mul_f32 v[50:51], v[50:51], v[42:43]
    v_pk_mul_f32 v[52:53], v[52:53], v[44:45]
    v_pk_mul_f32 v[54:55], v[54:55], v[46:47]
    v_exp_f32 v48, v48
    v_exp_f32 v49, v49
    v_exp_f32 v50, v50
    v_exp_f32 v51, v51
    v_exp_f32 v52, v52
    v_exp_f32 v53, v53
    v_exp_f32 v54, v54
    v_exp_f32 v55, v55
    v_pk_add_f32 v[48:49], v[48:49], v[244:245]
    v_pk_add_f32 v[50:51], v[50:51], v[244:245]
    v_pk_add_f32 v[52:53], v[52:53], v[244:245]
    v_pk_add_f32 v[54:55], v[54:55], v[244:245]
    v_rcp_f32 v48, v48
    v_rcp_f32 v49, v49
    v_rcp_f32 v50, v50
    v_rcp_f32 v51, v51
    v_rcp_f32 v52, v52
    v_rcp_f32 v53, v53
    v_rcp_f32 v54, v54
    v_rcp_f32 v55, v55
    v_pk_mul_f32 v[40:41], v[48:49], v[40:41]
    v_pk_mul_f32 v[42:43], v[50:51], v[42:43]
    v_pk_mul_f32 v[44:45], v[52:53], v[44:45]
    v_pk_mul_f32 v[46:47], v[54:55], v[46:47]
    v_cvt_pk_bf16_f32 v56, v40, v41
    v_cvt_pk_bf16_f32 v57, v42, v43
    v_cvt_pk_bf16_f32 v58, v44, v45
    v_cvt_pk_bf16_f32 v59, v46, v47
    buffer_store_dwordx4 v[56:59], v251, s[4:7], s53 offen offset:3072 sc1
    s_add_u32 s53, s53, s22
    v_accvgpr_read_b32 v0, a96
    v_accvgpr_read_b32 v1, a97
    v_accvgpr_read_b32 v2, a98
    v_accvgpr_read_b32 v3, a99
    v_accvgpr_read_b32 v4, a100
    v_accvgpr_read_b32 v5, a101
    v_accvgpr_read_b32 v6, a102
    v_accvgpr_read_b32 v7, a103
    v_pk_mul_f32 v[8:9], v[0:1], v[0:1]
    v_pk_mul_f32 v[10:11], v[2:3], v[2:3]
    v_pk_mul_f32 v[12:13], v[4:5], v[4:5]
    v_pk_mul_f32 v[14:15], v[6:7], v[6:7]
    v_pk_fma_f32 v[8:9], v[8:9], v[242:243], v[240:241]
    v_pk_fma_f32 v[10:11], v[10:11], v[242:243], v[240:241]
    v_pk_fma_f32 v[12:13], v[12:13], v[242:243], v[240:241]
    v_pk_fma_f32 v[14:15], v[14:15], v[242:243], v[240:241]
    v_pk_mul_f32 v[8:9], v[8:9], v[0:1]
    v_pk_mul_f32 v[10:11], v[10:11], v[2:3]
    v_pk_mul_f32 v[12:13], v[12:13], v[4:5]
    v_pk_mul_f32 v[14:15], v[14:15], v[6:7]
    v_exp_f32 v8, v8
    v_exp_f32 v9, v9
    v_exp_f32 v10, v10
    v_exp_f32 v11, v11
    v_exp_f32 v12, v12
    v_exp_f32 v13, v13
    v_exp_f32 v14, v14
    v_exp_f32 v15, v15
    v_pk_add_f32 v[8:9], v[8:9], v[244:245]
    v_pk_add_f32 v[10:11], v[10:11], v[244:245]
    v_pk_add_f32 v[12:13], v[12:13], v[244:245]
    v_pk_add_f32 v[14:15], v[14:15], v[244:245]
    v_rcp_f32 v8, v8
    v_rcp_f32 v9, v9
    v_rcp_f32 v10, v10
    v_rcp_f32 v11, v11
    v_rcp_f32 v12, v12
    v_rcp_f32 v13, v13
    v_rcp_f32 v14, v14
    v_rcp_f32 v15, v15
    v_pk_mul_f32 v[0:1], v[8:9], v[0:1]
    v_pk_mul_f32 v[2:3], v[10:11], v[2:3]
    v_pk_mul_f32 v[4:5], v[12:13], v[4:5]
    v_pk_mul_f32 v[6:7], v[14:15], v[6:7]
    v_cvt_pk_bf16_f32 v16, v0, v1
    v_cvt_pk_bf16_f32 v17, v2, v3
    v_cvt_pk_bf16_f32 v18, v4, v5
    v_cvt_pk_bf16_f32 v19, v6, v7
    buffer_store_dwordx4 v[16:19], v251, s[4:7], s53 offen offset:0 sc1
    v_accvgpr_read_b32 v20, a104
    v_accvgpr_read_b32 v21, a105
    v_accvgpr_read_b32 v22, a106
    v_accvgpr_read_b32 v23, a107
    v_accvgpr_read_b32 v24, a108
    v_accvgpr_read_b32 v25, a109
    v_accvgpr_read_b32 v26, a110
    v_accvgpr_read_b32 v27, a111
    v_pk_mul_f32 v[28:29], v[20:21], v[20:21]
    v_pk_mul_f32 v[30:31], v[22:23], v[22:23]
    v_pk_mul_f32 v[32:33], v[24:25], v[24:25]
    v_pk_mul_f32 v[34:35], v[26:27], v[26:27]
    v_pk_fma_f32 v[28:29], v[28:29], v[242:243], v[240:241]
    v_pk_fma_f32 v[30:31], v[30:31], v[242:243], v[240:241]
    v_pk_fma_f32 v[32:33], v[32:33], v[242:243], v[240:241]
    v_pk_fma_f32 v[34:35], v[34:35], v[242:243], v[240:241]
    v_pk_mul_f32 v[28:29], v[28:29], v[20:21]
    v_pk_mul_f32 v[30:31], v[30:31], v[22:23]
    v_pk_mul_f32 v[32:33], v[32:33], v[24:25]
    v_pk_mul_f32 v[34:35], v[34:35], v[26:27]
    v_exp_f32 v28, v28
    v_exp_f32 v29, v29
    v_exp_f32 v30, v30
    v_exp_f32 v31, v31
    v_exp_f32 v32, v32
    v_exp_f32 v33, v33
    v_exp_f32 v34, v34
    v_exp_f32 v35, v35
    v_pk_add_f32 v[28:29], v[28:29], v[244:245]
    v_pk_add_f32 v[30:31], v[30:31], v[244:245]
    v_pk_add_f32 v[32:33], v[32:33], v[244:245]
    v_pk_add_f32 v[34:35], v[34:35], v[244:245]
    v_rcp_f32 v28, v28
    v_rcp_f32 v29, v29
    v_rcp_f32 v30, v30
    v_rcp_f32 v31, v31
    v_rcp_f32 v32, v32
    v_rcp_f32 v33, v33
    v_rcp_f32 v34, v34
    v_rcp_f32 v35, v35
    v_pk_mul_f32 v[20:21], v[28:29], v[20:21]
    v_pk_mul_f32 v[22:23], v[30:31], v[22:23]
    v_pk_mul_f32 v[24:25], v[32:33], v[24:25]
    v_pk_mul_f32 v[26:27], v[34:35], v[26:27]
    v_cvt_pk_bf16_f32 v36, v20, v21
    v_cvt_pk_bf16_f32 v37, v22, v23
    v_cvt_pk_bf16_f32 v38, v24, v25
    v_cvt_pk_bf16_f32 v39, v26, v27
    buffer_store_dwordx4 v[36:39], v251, s[4:7], s53 offen offset:1024 sc1
    v_accvgpr_read_b32 v40, a112
    v_accvgpr_read_b32 v41, a113
    v_accvgpr_read_b32 v42, a114
    v_accvgpr_read_b32 v43, a115
    v_accvgpr_read_b32 v44, a116
    v_accvgpr_read_b32 v45, a117
    v_accvgpr_read_b32 v46, a118
    v_accvgpr_read_b32 v47, a119
    v_pk_mul_f32 v[48:49], v[40:41], v[40:41]
    v_pk_mul_f32 v[50:51], v[42:43], v[42:43]
    v_pk_mul_f32 v[52:53], v[44:45], v[44:45]
    v_pk_mul_f32 v[54:55], v[46:47], v[46:47]
    v_pk_fma_f32 v[48:49], v[48:49], v[242:243], v[240:241]
    v_pk_fma_f32 v[50:51], v[50:51], v[242:243], v[240:241]
    v_pk_fma_f32 v[52:53], v[52:53], v[242:243], v[240:241]
    v_pk_fma_f32 v[54:55], v[54:55], v[242:243], v[240:241]
    v_pk_mul_f32 v[48:49], v[48:49], v[40:41]
    v_pk_mul_f32 v[50:51], v[50:51], v[42:43]
    v_pk_mul_f32 v[52:53], v[52:53], v[44:45]
    v_pk_mul_f32 v[54:55], v[54:55], v[46:47]
    v_exp_f32 v48, v48
    v_exp_f32 v49, v49
    v_exp_f32 v50, v50
    v_exp_f32 v51, v51
    v_exp_f32 v52, v52
    v_exp_f32 v53, v53
    v_exp_f32 v54, v54
    v_exp_f32 v55, v55
    v_pk_add_f32 v[48:49], v[48:49], v[244:245]
    v_pk_add_f32 v[50:51], v[50:51], v[244:245]
    v_pk_add_f32 v[52:53], v[52:53], v[244:245]
    v_pk_add_f32 v[54:55], v[54:55], v[244:245]
    v_rcp_f32 v48, v48
    v_rcp_f32 v49, v49
    v_rcp_f32 v50, v50
    v_rcp_f32 v51, v51
    v_rcp_f32 v52, v52
    v_rcp_f32 v53, v53
    v_rcp_f32 v54, v54
    v_rcp_f32 v55, v55
    v_pk_mul_f32 v[40:41], v[48:49], v[40:41]
    v_pk_mul_f32 v[42:43], v[50:51], v[42:43]
    v_pk_mul_f32 v[44:45], v[52:53], v[44:45]
    v_pk_mul_f32 v[46:47], v[54:55], v[46:47]
    v_cvt_pk_bf16_f32 v56, v40, v41
    v_cvt_pk_bf16_f32 v57, v42, v43
    v_cvt_pk_bf16_f32 v58, v44, v45
    v_cvt_pk_bf16_f32 v59, v46, v47
    buffer_store_dwordx4 v[56:59], v251, s[4:7], s53 offen offset:2048 sc1
    v_accvgpr_read_b32 v0, a120
    v_accvgpr_read_b32 v1, a121
    v_accvgpr_read_b32 v2, a122
    v_accvgpr_read_b32 v3, a123
    v_accvgpr_read_b32 v4, a124
    v_accvgpr_read_b32 v5, a125
    v_accvgpr_read_b32 v6, a126
    v_accvgpr_read_b32 v7, a127
    v_pk_mul_f32 v[8:9], v[0:1], v[0:1]
    v_pk_mul_f32 v[10:11], v[2:3], v[2:3]
    v_pk_mul_f32 v[12:13], v[4:5], v[4:5]
    v_pk_mul_f32 v[14:15], v[6:7], v[6:7]
    v_pk_fma_f32 v[8:9], v[8:9], v[242:243], v[240:241]
    v_pk_fma_f32 v[10:11], v[10:11], v[242:243], v[240:241]
    v_pk_fma_f32 v[12:13], v[12:13], v[242:243], v[240:241]
    v_pk_fma_f32 v[14:15], v[14:15], v[242:243], v[240:241]
    v_pk_mul_f32 v[8:9], v[8:9], v[0:1]
    v_pk_mul_f32 v[10:11], v[10:11], v[2:3]
    v_pk_mul_f32 v[12:13], v[12:13], v[4:5]
    v_pk_mul_f32 v[14:15], v[14:15], v[6:7]
    v_exp_f32 v8, v8
    v_exp_f32 v9, v9
    v_exp_f32 v10, v10
    v_exp_f32 v11, v11
    v_exp_f32 v12, v12
    v_exp_f32 v13, v13
    v_exp_f32 v14, v14
    v_exp_f32 v15, v15
    v_pk_add_f32 v[8:9], v[8:9], v[244:245]
    v_pk_add_f32 v[10:11], v[10:11], v[244:245]
    v_pk_add_f32 v[12:13], v[12:13], v[244:245]
    v_pk_add_f32 v[14:15], v[14:15], v[244:245]
    v_rcp_f32 v8, v8
    v_rcp_f32 v9, v9
    v_rcp_f32 v10, v10
    v_rcp_f32 v11, v11
    v_rcp_f32 v12, v12
    v_rcp_f32 v13, v13
    v_rcp_f32 v14, v14
    v_rcp_f32 v15, v15
    v_pk_mul_f32 v[0:1], v[8:9], v[0:1]
    v_pk_mul_f32 v[2:3], v[10:11], v[2:3]
    v_pk_mul_f32 v[4:5], v[12:13], v[4:5]
    v_pk_mul_f32 v[6:7], v[14:15], v[6:7]
    v_cvt_pk_bf16_f32 v16, v0, v1
    v_cvt_pk_bf16_f32 v17, v2, v3
    v_cvt_pk_bf16_f32 v18, v4, v5
    v_cvt_pk_bf16_f32 v19, v6, v7
    buffer_store_dwordx4 v[16:19], v251, s[4:7], s53 offen offset:3072 sc1
    s_branch main_kernel_w_done
main_kernel_w_c1_gov:
    v_lshrrev_b32 v0, 4, v250
    v_bfe_u32 v1, v250, 2, 2
    v_lshl_add_u32 v4, v0, 2, v1
    v_and_b32 v5, 7, v4
    v_mul_u32_u24 v4, 512, v4
    v_and_b32 v6, 3, v250
    v_lshl_add_u32 v4, v6, 3, v4
    s_mul_i32 s32, s37, 8
    v_xor_b32 v5, s32, v5
    v_lshl_add_u32 v128, v5, 5, v4
    v_xor_b32 v129, 32, v128
    v_xor_b32 v130, 64, v128
    v_xor_b32 v131, 96, v128
    v_xor_b32 v132, 128, v128
    v_xor_b32 v133, 160, v128
    v_xor_b32 v134, 192, v128
    v_xor_b32 v135, 224, v128
    s_mul_i32 s32, s38, 4096
    s_add_u32 s32, s32, 65536
    v_add_u32 v136, s32, v251
    v_lshrrev_b32 v2, 5, v250
    v_and_b32 v3, 31, v250
    s_mul_i32 s32, s14, 8
    v_add_u32 v4, s32, v2
    v_add_u32 v5, 0, v4
    v_and_b32 v6, 7, v5
    v_lshlrev_b32 v6, 1, v6
    v_xor_b32 v6, v6, v3
    v_mul_lo_u32 v5, v5, s30
    v_lshl_add_u32 v5, v6, 4, v5
    v_subrev_u32 v137, 0, v5
    v_add_u32 v5, 2, v4
    v_and_b32 v6, 7, v5
    v_lshlrev_b32 v6, 1, v6
    v_xor_b32 v6, v6, v3
    v_mul_lo_u32 v5, v5, s30
    v_lshl_add_u32 v5, v6, 4, v5
    v_subrev_u32 v138, 1024, v5
    v_add_u32 v5, 4, v4
    v_and_b32 v6, 7, v5
    v_lshlrev_b32 v6, 1, v6
    v_xor_b32 v6, v6, v3
    v_mul_lo_u32 v5, v5, s30
    v_lshl_add_u32 v5, v6, 4, v5
    v_subrev_u32 v139, 2048, v5
    v_add_u32 v5, 6, v4
    v_and_b32 v6, 7, v5
    v_lshlrev_b32 v6, 1, v6
    v_xor_b32 v6, v6, v3
    v_mul_lo_u32 v5, v5, s30
    v_lshl_add_u32 v5, v6, 4, v5
    v_subrev_u32 v140, 3072, v5
    s_mul_i32 s32, s14, 2
    s_mul_i32 s32, s32, s31
    v_add_u32 v141, s32, v251
    s_add_u32 s32, s32, s31
    s_sub_u32 s32, s32, 1024
    v_add_u32 v142, s32, v251
    s_mul_i32 s19, s14, 4096
    s_mul_i32 s20, s14, 2048
    s_add_u32 s20, s20, 65536
    s_mul_i32 s17, s30, 32
    s_mov_b32 s15, 0
    s_add_u32 m0, s20, 0
    s_nop 0
    buffer_load_dwordx4 v141, s[4:7], s16 offen offset:0 sc1 lds
    buffer_load_dwordx4 v142, s[4:7], s16 offen offset:1024 sc1 lds
    s_add_u32 s16, s16, 1024
    s_add_u32 m0, s19, 0
    s_nop 0
    buffer_load_dwordx4 v137, s[8:11], s15 offen offset:0 lds
    buffer_load_dwordx4 v138, s[8:11], s15 offen offset:1024 lds
    buffer_load_dwordx4 v139, s[8:11], s15 offen offset:2048 lds
    buffer_load_dwordx4 v140, s[8:11], s15 offen offset:3072 lds
    s_add_u32 s15, s15, s17
    s_add_u32 m0, s20, 8192
    s_nop 0
    buffer_load_dwordx4 v141, s[4:7], s16 offen offset:0 sc1 lds
    buffer_load_dwordx4 v142, s[4:7], s16 offen offset:1024 sc1 lds
    s_add_u32 s16, s16, 1024
    s_add_u32 m0, s19, 16384
    s_nop 0
    buffer_load_dwordx4 v137, s[8:11], s15 offen offset:0 lds
    buffer_load_dwordx4 v138, s[8:11], s15 offen offset:1024 lds
    buffer_load_dwordx4 v139, s[8:11], s15 offen offset:2048 lds
    buffer_load_dwordx4 v140, s[8:11], s15 offen offset:3072 lds
    s_add_u32 s15, s15, s17
    s_add_u32 m0, s20, 16384
    s_nop 0
    buffer_load_dwordx4 v141, s[4:7], s16 offen offset:0 sc1 lds
    buffer_load_dwordx4 v142, s[4:7], s16 offen offset:1024 sc1 lds
    s_add_u32 s16, s16, 1024
    s_add_u32 m0, s19, 32768
    s_nop 0
    buffer_load_dwordx4 v137, s[8:11], s15 offen offset:0 lds
    buffer_load_dwordx4 v138, s[8:11], s15 offen offset:1024 lds
    buffer_load_dwordx4 v139, s[8:11], s15 offen offset:2048 lds
    buffer_load_dwordx4 v140, s[8:11], s15 offen offset:3072 lds
    s_add_u32 s15, s15, s17
    s_add_u32 m0, s20, 24576
    s_nop 0
    buffer_load_dwordx4 v141, s[4:7], s16 offen offset:0 sc1 lds
    buffer_load_dwordx4 v142, s[4:7], s16 offen offset:1024 sc1 lds
    s_add_u32 s16, s16, 1024
    s_add_u32 m0, s19, 49152
    s_nop 0
    buffer_load_dwordx4 v137, s[8:11], s15 offen offset:0 lds
    buffer_load_dwordx4 v138, s[8:11], s15 offen offset:1024 lds
    buffer_load_dwordx4 v139, s[8:11], s15 offen offset:2048 lds
    buffer_load_dwordx4 v140, s[8:11], s15 offen offset:3072 lds
    s_add_u32 s15, s15, s17
    v_accvgpr_write_b32 a0, 0
    v_accvgpr_write_b32 a1, 0
    v_accvgpr_write_b32 a2, 0
    v_accvgpr_write_b32 a3, 0
    v_accvgpr_write_b32 a4, 0
    v_accvgpr_write_b32 a5, 0
    v_accvgpr_write_b32 a6, 0
    v_accvgpr_write_b32 a7, 0
    v_accvgpr_write_b32 a8, 0
    v_accvgpr_write_b32 a9, 0
    v_accvgpr_write_b32 a10, 0
    v_accvgpr_write_b32 a11, 0
    v_accvgpr_write_b32 a12, 0
    v_accvgpr_write_b32 a13, 0
    v_accvgpr_write_b32 a14, 0
    v_accvgpr_write_b32 a15, 0
    v_accvgpr_write_b32 a16, 0
    v_accvgpr_write_b32 a17, 0
    v_accvgpr_write_b32 a18, 0
    v_accvgpr_write_b32 a19, 0
    v_accvgpr_write_b32 a20, 0
    v_accvgpr_write_b32 a21, 0
    v_accvgpr_write_b32 a22, 0
    v_accvgpr_write_b32 a23, 0
    v_accvgpr_write_b32 a24, 0
    v_accvgpr_write_b32 a25, 0
    v_accvgpr_write_b32 a26, 0
    v_accvgpr_write_b32 a27, 0
    v_accvgpr_write_b32 a28, 0
    v_accvgpr_write_b32 a29, 0
    v_accvgpr_write_b32 a30, 0
    v_accvgpr_write_b32 a31, 0
    v_accvgpr_write_b32 a32, 0
    v_accvgpr_write_b32 a33, 0
    v_accvgpr_write_b32 a34, 0
    v_accvgpr_write_b32 a35, 0
    v_accvgpr_write_b32 a36, 0
    v_accvgpr_write_b32 a37, 0
    v_accvgpr_write_b32 a38, 0
    v_accvgpr_write_b32 a39, 0
    v_accvgpr_write_b32 a40, 0
    v_accvgpr_write_b32 a41, 0
    v_accvgpr_write_b32 a42, 0
    v_accvgpr_write_b32 a43, 0
    v_accvgpr_write_b32 a44, 0
    v_accvgpr_write_b32 a45, 0
    v_accvgpr_write_b32 a46, 0
    v_accvgpr_write_b32 a47, 0
    v_accvgpr_write_b32 a48, 0
    v_accvgpr_write_b32 a49, 0
    v_accvgpr_write_b32 a50, 0
    v_accvgpr_write_b32 a51, 0
    v_accvgpr_write_b32 a52, 0
    v_accvgpr_write_b32 a53, 0
    v_accvgpr_write_b32 a54, 0
    v_accvgpr_write_b32 a55, 0
    v_accvgpr_write_b32 a56, 0
    v_accvgpr_write_b32 a57, 0
    v_accvgpr_write_b32 a58, 0
    v_accvgpr_write_b32 a59, 0
    v_accvgpr_write_b32 a60, 0
    v_accvgpr_write_b32 a61, 0
    v_accvgpr_write_b32 a62, 0
    v_accvgpr_write_b32 a63, 0
    v_accvgpr_write_b32 a64, 0
    v_accvgpr_write_b32 a65, 0
    v_accvgpr_write_b32 a66, 0
    v_accvgpr_write_b32 a67, 0
    v_accvgpr_write_b32 a68, 0
    v_accvgpr_write_b32 a69, 0
    v_accvgpr_write_b32 a70, 0
    v_accvgpr_write_b32 a71, 0
    v_accvgpr_write_b32 a72, 0
    v_accvgpr_write_b32 a73, 0
    v_accvgpr_write_b32 a74, 0
    v_accvgpr_write_b32 a75, 0
    v_accvgpr_write_b32 a76, 0
    v_accvgpr_write_b32 a77, 0
    v_accvgpr_write_b32 a78, 0
    v_accvgpr_write_b32 a79, 0
    v_accvgpr_write_b32 a80, 0
    v_accvgpr_write_b32 a81, 0
    v_accvgpr_write_b32 a82, 0
    v_accvgpr_write_b32 a83, 0
    v_accvgpr_write_b32 a84, 0
    v_accvgpr_write_b32 a85, 0
    v_accvgpr_write_b32 a86, 0
    v_accvgpr_write_b32 a87, 0
    v_accvgpr_write_b32 a88, 0
    v_accvgpr_write_b32 a89, 0
    v_accvgpr_write_b32 a90, 0
    v_accvgpr_write_b32 a91, 0
    v_accvgpr_write_b32 a92, 0
    v_accvgpr_write_b32 a93, 0
    v_accvgpr_write_b32 a94, 0
    v_accvgpr_write_b32 a95, 0
    v_accvgpr_write_b32 a96, 0
    v_accvgpr_write_b32 a97, 0
    v_accvgpr_write_b32 a98, 0
    v_accvgpr_write_b32 a99, 0
    v_accvgpr_write_b32 a100, 0
    v_accvgpr_write_b32 a101, 0
    v_accvgpr_write_b32 a102, 0
    v_accvgpr_write_b32 a103, 0
    v_accvgpr_write_b32 a104, 0
    v_accvgpr_write_b32 a105, 0
    v_accvgpr_write_b32 a106, 0
    v_accvgpr_write_b32 a107, 0
    v_accvgpr_write_b32 a108, 0
    v_accvgpr_write_b32 a109, 0
    v_accvgpr_write_b32 a110, 0
    v_accvgpr_write_b32 a111, 0
    v_accvgpr_write_b32 a112, 0
    v_accvgpr_write_b32 a113, 0
    v_accvgpr_write_b32 a114, 0
    v_accvgpr_write_b32 a115, 0
    v_accvgpr_write_b32 a116, 0
    v_accvgpr_write_b32 a117, 0
    v_accvgpr_write_b32 a118, 0
    v_accvgpr_write_b32 a119, 0
    v_accvgpr_write_b32 a120, 0
    v_accvgpr_write_b32 a121, 0
    v_accvgpr_write_b32 a122, 0
    v_accvgpr_write_b32 a123, 0
    v_accvgpr_write_b32 a124, 0
    v_accvgpr_write_b32 a125, 0
    v_accvgpr_write_b32 a126, 0
    v_accvgpr_write_b32 a127, 0
    s_waitcnt vmcnt(18)
    s_barrier
    ds_read_b128 v[32:35], v136 offset:0
    ds_read_b64_tr_b16 v[0:1], v128 offset:0
    ds_read_b64_tr_b16 v[2:3], v128 offset:8192
    ds_read_b64_tr_b16 v[4:5], v129 offset:0
    ds_read_b64_tr_b16 v[6:7], v129 offset:8192
    ds_read_b64_tr_b16 v[8:9], v130 offset:0
    ds_read_b64_tr_b16 v[10:11], v130 offset:8192
    ds_read_b64_tr_b16 v[12:13], v131 offset:0
    ds_read_b64_tr_b16 v[14:15], v131 offset:8192
    ds_read_b64_tr_b16 v[16:17], v132 offset:0
    ds_read_b64_tr_b16 v[18:19], v132 offset:8192
    ds_read_b64_tr_b16 v[20:21], v133 offset:0
    ds_read_b64_tr_b16 v[22:23], v133 offset:8192
    ds_read_b64_tr_b16 v[24:25], v134 offset:0
    ds_read_b64_tr_b16 v[26:27], v134 offset:8192
    ds_read_b64_tr_b16 v[28:29], v135 offset:0
    ds_read_b64_tr_b16 v[30:31], v135 offset:8192
    ds_read_b128 v[36:39], v136 offset:1024
    ds_read_b128 v[40:43], v136 offset:2048
    ds_read_b128 v[44:47], v136 offset:3072
main_kernel_w_c1_v_loop:
    s_waitcnt lgkmcnt(0)
    v_mfma_f32_16x16x32_bf16 a[0:3], v[32:35], v[0:3], a[0:3]
    s_waitcnt vmcnt(12)
    s_barrier
    ds_read_b128 v[80:83], v136 offset:8192
    s_add_u32 m0, s20, 0
    s_nop 0
    v_mfma_f32_16x16x32_bf16 a[4:7], v[32:35], v[4:7], a[4:7]
    ds_read_b64_tr_b16 v[48:49], v128 offset:16384
    v_mfma_f32_16x16x32_bf16 a[8:11], v[32:35], v[8:11], a[8:11]
    ds_read_b64_tr_b16 v[50:51], v128 offset:24576
    v_mfma_f32_16x16x32_bf16 a[12:15], v[32:35], v[12:15], a[12:15]
    ds_read_b64_tr_b16 v[52:53], v129 offset:16384
    buffer_load_dwordx4 v141, s[4:7], s16 offen offset:0 sc1 lds
    v_mfma_f32_16x16x32_bf16 a[16:19], v[32:35], v[16:19], a[16:19]
    ds_read_b64_tr_b16 v[54:55], v129 offset:24576
    v_mfma_f32_16x16x32_bf16 a[20:23], v[32:35], v[20:23], a[20:23]
    ds_read_b64_tr_b16 v[56:57], v130 offset:16384
    v_mfma_f32_16x16x32_bf16 a[24:27], v[32:35], v[24:27], a[24:27]
    ds_read_b64_tr_b16 v[58:59], v130 offset:24576
    buffer_load_dwordx4 v142, s[4:7], s16 offen offset:1024 sc1 lds
    v_mfma_f32_16x16x32_bf16 a[28:31], v[32:35], v[28:31], a[28:31]
    ds_read_b64_tr_b16 v[60:61], v131 offset:16384
    v_mfma_f32_16x16x32_bf16 a[32:35], v[36:39], v[0:3], a[32:35]
    ds_read_b64_tr_b16 v[62:63], v131 offset:24576
    v_mfma_f32_16x16x32_bf16 a[36:39], v[36:39], v[4:7], a[36:39]
    ds_read_b64_tr_b16 v[64:65], v132 offset:16384
    s_add_u32 s16, s16, 1024
    v_mfma_f32_16x16x32_bf16 a[40:43], v[36:39], v[8:11], a[40:43]
    ds_read_b64_tr_b16 v[66:67], v132 offset:24576
    v_mfma_f32_16x16x32_bf16 a[44:47], v[36:39], v[12:15], a[44:47]
    ds_read_b64_tr_b16 v[68:69], v133 offset:16384
    v_mfma_f32_16x16x32_bf16 a[48:51], v[36:39], v[16:19], a[48:51]
    ds_read_b64_tr_b16 v[70:71], v133 offset:24576
    s_add_u32 m0, s19, 0
    s_nop 0
    v_mfma_f32_16x16x32_bf16 a[52:55], v[36:39], v[20:23], a[52:55]
    ds_read_b64_tr_b16 v[72:73], v134 offset:16384
    v_mfma_f32_16x16x32_bf16 a[56:59], v[36:39], v[24:27], a[56:59]
    ds_read_b64_tr_b16 v[74:75], v134 offset:24576
    v_mfma_f32_16x16x32_bf16 a[60:63], v[36:39], v[28:31], a[60:63]
    ds_read_b64_tr_b16 v[76:77], v135 offset:16384
    buffer_load_dwordx4 v137, s[8:11], s15 offen offset:0 lds
    v_mfma_f32_16x16x32_bf16 a[64:67], v[40:43], v[0:3], a[64:67]
    ds_read_b64_tr_b16 v[78:79], v135 offset:24576
    v_mfma_f32_16x16x32_bf16 a[68:71], v[40:43], v[4:7], a[68:71]
    ds_read_b128 v[84:87], v136 offset:9216
    v_mfma_f32_16x16x32_bf16 a[72:75], v[40:43], v[8:11], a[72:75]
    ds_read_b128 v[88:91], v136 offset:10240
    buffer_load_dwordx4 v138, s[8:11], s15 offen offset:1024 lds
    v_mfma_f32_16x16x32_bf16 a[76:79], v[40:43], v[12:15], a[76:79]
    ds_read_b128 v[92:95], v136 offset:11264
    v_mfma_f32_16x16x32_bf16 a[80:83], v[40:43], v[16:19], a[80:83]
    v_mfma_f32_16x16x32_bf16 a[84:87], v[40:43], v[20:23], a[84:87]
    buffer_load_dwordx4 v139, s[8:11], s15 offen offset:2048 lds
    v_mfma_f32_16x16x32_bf16 a[88:91], v[40:43], v[24:27], a[88:91]
    v_mfma_f32_16x16x32_bf16 a[92:95], v[40:43], v[28:31], a[92:95]
    v_mfma_f32_16x16x32_bf16 a[96:99], v[44:47], v[0:3], a[96:99]
    buffer_load_dwordx4 v140, s[8:11], s15 offen offset:3072 lds
    v_mfma_f32_16x16x32_bf16 a[100:103], v[44:47], v[4:7], a[100:103]
    v_mfma_f32_16x16x32_bf16 a[104:107], v[44:47], v[8:11], a[104:107]
    v_mfma_f32_16x16x32_bf16 a[108:111], v[44:47], v[12:15], a[108:111]
    s_add_u32 s15, s15, s17
    v_mfma_f32_16x16x32_bf16 a[112:115], v[44:47], v[16:19], a[112:115]
    v_mfma_f32_16x16x32_bf16 a[116:119], v[44:47], v[20:23], a[116:119]
    v_mfma_f32_16x16x32_bf16 a[120:123], v[44:47], v[24:27], a[120:123]
    v_mfma_f32_16x16x32_bf16 a[124:127], v[44:47], v[28:31], a[124:127]
    s_waitcnt lgkmcnt(0)
    v_mfma_f32_16x16x32_bf16 a[0:3], v[80:83], v[48:51], a[0:3]
    s_waitcnt vmcnt(12)
    s_barrier
    ds_read_b128 v[32:35], v136 offset:16384
    s_add_u32 m0, s20, 8192
    s_nop 0
    v_mfma_f32_16x16x32_bf16 a[4:7], v[80:83], v[52:55], a[4:7]
    ds_read_b64_tr_b16 v[0:1], v128 offset:32768
    v_mfma_f32_16x16x32_bf16 a[8:11], v[80:83], v[56:59], a[8:11]
    ds_read_b64_tr_b16 v[2:3], v128 offset:40960
    v_mfma_f32_16x16x32_bf16 a[12:15], v[80:83], v[60:63], a[12:15]
    ds_read_b64_tr_b16 v[4:5], v129 offset:32768
    buffer_load_dwordx4 v141, s[4:7], s16 offen offset:0 sc1 lds
    v_mfma_f32_16x16x32_bf16 a[16:19], v[80:83], v[64:67], a[16:19]
    ds_read_b64_tr_b16 v[6:7], v129 offset:40960
    v_mfma_f32_16x16x32_bf16 a[20:23], v[80:83], v[68:71], a[20:23]
    ds_read_b64_tr_b16 v[8:9], v130 offset:32768
    v_mfma_f32_16x16x32_bf16 a[24:27], v[80:83], v[72:75], a[24:27]
    ds_read_b64_tr_b16 v[10:11], v130 offset:40960
    buffer_load_dwordx4 v142, s[4:7], s16 offen offset:1024 sc1 lds
    v_mfma_f32_16x16x32_bf16 a[28:31], v[80:83], v[76:79], a[28:31]
    ds_read_b64_tr_b16 v[12:13], v131 offset:32768
    v_mfma_f32_16x16x32_bf16 a[32:35], v[84:87], v[48:51], a[32:35]
    ds_read_b64_tr_b16 v[14:15], v131 offset:40960
    v_mfma_f32_16x16x32_bf16 a[36:39], v[84:87], v[52:55], a[36:39]
    ds_read_b64_tr_b16 v[16:17], v132 offset:32768
    s_add_u32 s16, s16, 1024
    v_mfma_f32_16x16x32_bf16 a[40:43], v[84:87], v[56:59], a[40:43]
    ds_read_b64_tr_b16 v[18:19], v132 offset:40960
    v_mfma_f32_16x16x32_bf16 a[44:47], v[84:87], v[60:63], a[44:47]
    ds_read_b64_tr_b16 v[20:21], v133 offset:32768
    v_mfma_f32_16x16x32_bf16 a[48:51], v[84:87], v[64:67], a[48:51]
    ds_read_b64_tr_b16 v[22:23], v133 offset:40960
    s_add_u32 m0, s19, 16384
    s_nop 0
    v_mfma_f32_16x16x32_bf16 a[52:55], v[84:87], v[68:71], a[52:55]
    ds_read_b64_tr_b16 v[24:25], v134 offset:32768
    v_mfma_f32_16x16x32_bf16 a[56:59], v[84:87], v[72:75], a[56:59]
    ds_read_b64_tr_b16 v[26:27], v134 offset:40960
    v_mfma_f32_16x16x32_bf16 a[60:63], v[84:87], v[76:79], a[60:63]
    ds_read_b64_tr_b16 v[28:29], v135 offset:32768
    buffer_load_dwordx4 v137, s[8:11], s15 offen offset:0 lds
    v_mfma_f32_16x16x32_bf16 a[64:67], v[88:91], v[48:51], a[64:67]
    ds_read_b64_tr_b16 v[30:31], v135 offset:40960
    v_mfma_f32_16x16x32_bf16 a[68:71], v[88:91], v[52:55], a[68:71]
    ds_read_b128 v[36:39], v136 offset:17408
    v_mfma_f32_16x16x32_bf16 a[72:75], v[88:91], v[56:59], a[72:75]
    ds_read_b128 v[40:43], v136 offset:18432
    buffer_load_dwordx4 v138, s[8:11], s15 offen offset:1024 lds
    v_mfma_f32_16x16x32_bf16 a[76:79], v[88:91], v[60:63], a[76:79]
    ds_read_b128 v[44:47], v136 offset:19456
    v_mfma_f32_16x16x32_bf16 a[80:83], v[88:91], v[64:67], a[80:83]
    v_mfma_f32_16x16x32_bf16 a[84:87], v[88:91], v[68:71], a[84:87]
    buffer_load_dwordx4 v139, s[8:11], s15 offen offset:2048 lds
    v_mfma_f32_16x16x32_bf16 a[88:91], v[88:91], v[72:75], a[88:91]
    v_mfma_f32_16x16x32_bf16 a[92:95], v[88:91], v[76:79], a[92:95]
    v_mfma_f32_16x16x32_bf16 a[96:99], v[92:95], v[48:51], a[96:99]
    buffer_load_dwordx4 v140, s[8:11], s15 offen offset:3072 lds
    v_mfma_f32_16x16x32_bf16 a[100:103], v[92:95], v[52:55], a[100:103]
    v_mfma_f32_16x16x32_bf16 a[104:107], v[92:95], v[56:59], a[104:107]
    v_mfma_f32_16x16x32_bf16 a[108:111], v[92:95], v[60:63], a[108:111]
    s_add_u32 s15, s15, s17
    v_mfma_f32_16x16x32_bf16 a[112:115], v[92:95], v[64:67], a[112:115]
    v_mfma_f32_16x16x32_bf16 a[116:119], v[92:95], v[68:71], a[116:119]
    v_mfma_f32_16x16x32_bf16 a[120:123], v[92:95], v[72:75], a[120:123]
    v_mfma_f32_16x16x32_bf16 a[124:127], v[92:95], v[76:79], a[124:127]
    s_waitcnt lgkmcnt(0)
    v_mfma_f32_16x16x32_bf16 a[0:3], v[32:35], v[0:3], a[0:3]
    s_waitcnt vmcnt(12)
    s_barrier
    ds_read_b128 v[80:83], v136 offset:24576
    s_add_u32 m0, s20, 16384
    s_nop 0
    v_mfma_f32_16x16x32_bf16 a[4:7], v[32:35], v[4:7], a[4:7]
    ds_read_b64_tr_b16 v[48:49], v128 offset:49152
    v_mfma_f32_16x16x32_bf16 a[8:11], v[32:35], v[8:11], a[8:11]
    ds_read_b64_tr_b16 v[50:51], v128 offset:57344
    v_mfma_f32_16x16x32_bf16 a[12:15], v[32:35], v[12:15], a[12:15]
    ds_read_b64_tr_b16 v[52:53], v129 offset:49152
    buffer_load_dwordx4 v141, s[4:7], s16 offen offset:0 sc1 lds
    v_mfma_f32_16x16x32_bf16 a[16:19], v[32:35], v[16:19], a[16:19]
    ds_read_b64_tr_b16 v[54:55], v129 offset:57344
    v_mfma_f32_16x16x32_bf16 a[20:23], v[32:35], v[20:23], a[20:23]
    ds_read_b64_tr_b16 v[56:57], v130 offset:49152
    v_mfma_f32_16x16x32_bf16 a[24:27], v[32:35], v[24:27], a[24:27]
    ds_read_b64_tr_b16 v[58:59], v130 offset:57344
    buffer_load_dwordx4 v142, s[4:7], s16 offen offset:1024 sc1 lds
    v_mfma_f32_16x16x32_bf16 a[28:31], v[32:35], v[28:31], a[28:31]
    ds_read_b64_tr_b16 v[60:61], v131 offset:49152
    v_mfma_f32_16x16x32_bf16 a[32:35], v[36:39], v[0:3], a[32:35]
    ds_read_b64_tr_b16 v[62:63], v131 offset:57344
    v_mfma_f32_16x16x32_bf16 a[36:39], v[36:39], v[4:7], a[36:39]
    ds_read_b64_tr_b16 v[64:65], v132 offset:49152
    s_add_u32 s16, s16, 1024
    v_mfma_f32_16x16x32_bf16 a[40:43], v[36:39], v[8:11], a[40:43]
    ds_read_b64_tr_b16 v[66:67], v132 offset:57344
    v_mfma_f32_16x16x32_bf16 a[44:47], v[36:39], v[12:15], a[44:47]
    ds_read_b64_tr_b16 v[68:69], v133 offset:49152
    v_mfma_f32_16x16x32_bf16 a[48:51], v[36:39], v[16:19], a[48:51]
    ds_read_b64_tr_b16 v[70:71], v133 offset:57344
    s_add_u32 m0, s19, 32768
    s_nop 0
    v_mfma_f32_16x16x32_bf16 a[52:55], v[36:39], v[20:23], a[52:55]
    ds_read_b64_tr_b16 v[72:73], v134 offset:49152
    v_mfma_f32_16x16x32_bf16 a[56:59], v[36:39], v[24:27], a[56:59]
    ds_read_b64_tr_b16 v[74:75], v134 offset:57344
    v_mfma_f32_16x16x32_bf16 a[60:63], v[36:39], v[28:31], a[60:63]
    ds_read_b64_tr_b16 v[76:77], v135 offset:49152
    buffer_load_dwordx4 v137, s[8:11], s15 offen offset:0 lds
    v_mfma_f32_16x16x32_bf16 a[64:67], v[40:43], v[0:3], a[64:67]
    ds_read_b64_tr_b16 v[78:79], v135 offset:57344
    v_mfma_f32_16x16x32_bf16 a[68:71], v[40:43], v[4:7], a[68:71]
    ds_read_b128 v[84:87], v136 offset:25600
    v_mfma_f32_16x16x32_bf16 a[72:75], v[40:43], v[8:11], a[72:75]
    ds_read_b128 v[88:91], v136 offset:26624
    buffer_load_dwordx4 v138, s[8:11], s15 offen offset:1024 lds
    v_mfma_f32_16x16x32_bf16 a[76:79], v[40:43], v[12:15], a[76:79]
    ds_read_b128 v[92:95], v136 offset:27648
    v_mfma_f32_16x16x32_bf16 a[80:83], v[40:43], v[16:19], a[80:83]
    v_mfma_f32_16x16x32_bf16 a[84:87], v[40:43], v[20:23], a[84:87]
    buffer_load_dwordx4 v139, s[8:11], s15 offen offset:2048 lds
    v_mfma_f32_16x16x32_bf16 a[88:91], v[40:43], v[24:27], a[88:91]
    v_mfma_f32_16x16x32_bf16 a[92:95], v[40:43], v[28:31], a[92:95]
    v_mfma_f32_16x16x32_bf16 a[96:99], v[44:47], v[0:3], a[96:99]
    buffer_load_dwordx4 v140, s[8:11], s15 offen offset:3072 lds
    v_mfma_f32_16x16x32_bf16 a[100:103], v[44:47], v[4:7], a[100:103]
    v_mfma_f32_16x16x32_bf16 a[104:107], v[44:47], v[8:11], a[104:107]
    v_mfma_f32_16x16x32_bf16 a[108:111], v[44:47], v[12:15], a[108:111]
    s_add_u32 s15, s15, s17
    v_mfma_f32_16x16x32_bf16 a[112:115], v[44:47], v[16:19], a[112:115]
    v_mfma_f32_16x16x32_bf16 a[116:119], v[44:47], v[20:23], a[116:119]
    v_mfma_f32_16x16x32_bf16 a[120:123], v[44:47], v[24:27], a[120:123]
    v_mfma_f32_16x16x32_bf16 a[124:127], v[44:47], v[28:31], a[124:127]
    s_waitcnt lgkmcnt(0)
    v_mfma_f32_16x16x32_bf16 a[0:3], v[80:83], v[48:51], a[0:3]
    s_waitcnt vmcnt(12)
    s_barrier
    ds_read_b128 v[32:35], v136 offset:0
    s_add_u32 m0, s20, 24576
    s_nop 0
    v_mfma_f32_16x16x32_bf16 a[4:7], v[80:83], v[52:55], a[4:7]
    ds_read_b64_tr_b16 v[0:1], v128 offset:0
    v_mfma_f32_16x16x32_bf16 a[8:11], v[80:83], v[56:59], a[8:11]
    ds_read_b64_tr_b16 v[2:3], v128 offset:8192
    v_mfma_f32_16x16x32_bf16 a[12:15], v[80:83], v[60:63], a[12:15]
    ds_read_b64_tr_b16 v[4:5], v129 offset:0
    buffer_load_dwordx4 v141, s[4:7], s16 offen offset:0 sc1 lds
    v_mfma_f32_16x16x32_bf16 a[16:19], v[80:83], v[64:67], a[16:19]
    ds_read_b64_tr_b16 v[6:7], v129 offset:8192
    v_mfma_f32_16x16x32_bf16 a[20:23], v[80:83], v[68:71], a[20:23]
    ds_read_b64_tr_b16 v[8:9], v130 offset:0
    v_mfma_f32_16x16x32_bf16 a[24:27], v[80:83], v[72:75], a[24:27]
    ds_read_b64_tr_b16 v[10:11], v130 offset:8192
    buffer_load_dwordx4 v142, s[4:7], s16 offen offset:1024 sc1 lds
    v_mfma_f32_16x16x32_bf16 a[28:31], v[80:83], v[76:79], a[28:31]
    ds_read_b64_tr_b16 v[12:13], v131 offset:0
    v_mfma_f32_16x16x32_bf16 a[32:35], v[84:87], v[48:51], a[32:35]
    ds_read_b64_tr_b16 v[14:15], v131 offset:8192
    v_mfma_f32_16x16x32_bf16 a[36:39], v[84:87], v[52:55], a[36:39]
    ds_read_b64_tr_b16 v[16:17], v132 offset:0
    s_add_u32 s16, s16, 1024
    v_mfma_f32_16x16x32_bf16 a[40:43], v[84:87], v[56:59], a[40:43]
    ds_read_b64_tr_b16 v[18:19], v132 offset:8192
    v_mfma_f32_16x16x32_bf16 a[44:47], v[84:87], v[60:63], a[44:47]
    ds_read_b64_tr_b16 v[20:21], v133 offset:0
    v_mfma_f32_16x16x32_bf16 a[48:51], v[84:87], v[64:67], a[48:51]
    ds_read_b64_tr_b16 v[22:23], v133 offset:8192
    s_add_u32 m0, s19, 49152
    s_nop 0
    v_mfma_f32_16x16x32_bf16 a[52:55], v[84:87], v[68:71], a[52:55]
    ds_read_b64_tr_b16 v[24:25], v134 offset:0
    v_mfma_f32_16x16x32_bf16 a[56:59], v[84:87], v[72:75], a[56:59]
    ds_read_b64_tr_b16 v[26:27], v134 offset:8192
    v_mfma_f32_16x16x32_bf16 a[60:63], v[84:87], v[76:79], a[60:63]
    ds_read_b64_tr_b16 v[28:29], v135 offset:0
    buffer_load_dwordx4 v137, s[8:11], s15 offen offset:0 lds
    v_mfma_f32_16x16x32_bf16 a[64:67], v[88:91], v[48:51], a[64:67]
    ds_read_b64_tr_b16 v[30:31], v135 offset:8192
    v_mfma_f32_16x16x32_bf16 a[68:71], v[88:91], v[52:55], a[68:71]
    ds_read_b128 v[36:39], v136 offset:1024
    v_mfma_f32_16x16x32_bf16 a[72:75], v[88:91], v[56:59], a[72:75]
    ds_read_b128 v[40:43], v136 offset:2048
    buffer_load_dwordx4 v138, s[8:11], s15 offen offset:1024 lds
    v_mfma_f32_16x16x32_bf16 a[76:79], v[88:91], v[60:63], a[76:79]
    ds_read_b128 v[44:47], v136 offset:3072
    v_mfma_f32_16x16x32_bf16 a[80:83], v[88:91], v[64:67], a[80:83]
    v_mfma_f32_16x16x32_bf16 a[84:87], v[88:91], v[68:71], a[84:87]
    buffer_load_dwordx4 v139, s[8:11], s15 offen offset:2048 lds
    v_mfma_f32_16x16x32_bf16 a[88:91], v[88:91], v[72:75], a[88:91]
    v_mfma_f32_16x16x32_bf16 a[92:95], v[88:91], v[76:79], a[92:95]
    v_mfma_f32_16x16x32_bf16 a[96:99], v[92:95], v[48:51], a[96:99]
    buffer_load_dwordx4 v140, s[8:11], s15 offen offset:3072 lds
    v_mfma_f32_16x16x32_bf16 a[100:103], v[92:95], v[52:55], a[100:103]
    v_mfma_f32_16x16x32_bf16 a[104:107], v[92:95], v[56:59], a[104:107]
    v_mfma_f32_16x16x32_bf16 a[108:111], v[92:95], v[60:63], a[108:111]
    s_add_u32 s15, s15, s17
    v_mfma_f32_16x16x32_bf16 a[112:115], v[92:95], v[64:67], a[112:115]
    v_mfma_f32_16x16x32_bf16 a[116:119], v[92:95], v[68:71], a[116:119]
    v_mfma_f32_16x16x32_bf16 a[120:123], v[92:95], v[72:75], a[120:123]
    v_mfma_f32_16x16x32_bf16 a[124:127], v[92:95], v[76:79], a[124:127]
    s_sub_u32 s18, s18, 1
    s_cmp_lg_u32 s18, 0
    s_cbranch_scc1 main_kernel_w_c1_v_loop
    s_cmp_lg_u32 s14, 0
    s_cbranch_scc1 main_kernel_w_c1_v_nt
    s_lshl_b32 s32, s27, 8
    s_add_u32 s32, s32, 0x841e000
    v_mov_b32 v255, 1
    s_mov_b64 exec, 1
    buffer_atomic_add v255, off, s[4:7], s32 sc0 sc1
    s_mov_b64 exec, -1
main_kernel_w_c1_v_nt:
    s_waitcnt lgkmcnt(0)
    v_mfma_f32_16x16x32_bf16 a[0:3], v[32:35], v[0:3], a[0:3]
    s_waitcnt vmcnt(12)
    s_barrier
    ds_read_b128 v[80:83], v136 offset:8192
    v_mfma_f32_16x16x32_bf16 a[4:7], v[32:35], v[4:7], a[4:7]
    ds_read_b64_tr_b16 v[48:49], v128 offset:16384
    v_mfma_f32_16x16x32_bf16 a[8:11], v[32:35], v[8:11], a[8:11]
    ds_read_b64_tr_b16 v[50:51], v128 offset:24576
    v_mfma_f32_16x16x32_bf16 a[12:15], v[32:35], v[12:15], a[12:15]
    ds_read_b64_tr_b16 v[52:53], v129 offset:16384
    v_mfma_f32_16x16x32_bf16 a[16:19], v[32:35], v[16:19], a[16:19]
    ds_read_b64_tr_b16 v[54:55], v129 offset:24576
    v_mfma_f32_16x16x32_bf16 a[20:23], v[32:35], v[20:23], a[20:23]
    ds_read_b64_tr_b16 v[56:57], v130 offset:16384
    v_mfma_f32_16x16x32_bf16 a[24:27], v[32:35], v[24:27], a[24:27]
    ds_read_b64_tr_b16 v[58:59], v130 offset:24576
    v_mfma_f32_16x16x32_bf16 a[28:31], v[32:35], v[28:31], a[28:31]
    ds_read_b64_tr_b16 v[60:61], v131 offset:16384
    v_mfma_f32_16x16x32_bf16 a[32:35], v[36:39], v[0:3], a[32:35]
    ds_read_b64_tr_b16 v[62:63], v131 offset:24576
    v_mfma_f32_16x16x32_bf16 a[36:39], v[36:39], v[4:7], a[36:39]
    ds_read_b64_tr_b16 v[64:65], v132 offset:16384
    v_mfma_f32_16x16x32_bf16 a[40:43], v[36:39], v[8:11], a[40:43]
    ds_read_b64_tr_b16 v[66:67], v132 offset:24576
    v_mfma_f32_16x16x32_bf16 a[44:47], v[36:39], v[12:15], a[44:47]
    ds_read_b64_tr_b16 v[68:69], v133 offset:16384
    v_mfma_f32_16x16x32_bf16 a[48:51], v[36:39], v[16:19], a[48:51]
    ds_read_b64_tr_b16 v[70:71], v133 offset:24576
    v_mfma_f32_16x16x32_bf16 a[52:55], v[36:39], v[20:23], a[52:55]
    ds_read_b64_tr_b16 v[72:73], v134 offset:16384
    v_mfma_f32_16x16x32_bf16 a[56:59], v[36:39], v[24:27], a[56:59]
    ds_read_b64_tr_b16 v[74:75], v134 offset:24576
    v_mfma_f32_16x16x32_bf16 a[60:63], v[36:39], v[28:31], a[60:63]
    ds_read_b64_tr_b16 v[76:77], v135 offset:16384
    v_mfma_f32_16x16x32_bf16 a[64:67], v[40:43], v[0:3], a[64:67]
    ds_read_b64_tr_b16 v[78:79], v135 offset:24576
    v_mfma_f32_16x16x32_bf16 a[68:71], v[40:43], v[4:7], a[68:71]
    ds_read_b128 v[84:87], v136 offset:9216
    v_mfma_f32_16x16x32_bf16 a[72:75], v[40:43], v[8:11], a[72:75]
    ds_read_b128 v[88:91], v136 offset:10240
    v_mfma_f32_16x16x32_bf16 a[76:79], v[40:43], v[12:15], a[76:79]
    ds_read_b128 v[92:95], v136 offset:11264
    v_mfma_f32_16x16x32_bf16 a[80:83], v[40:43], v[16:19], a[80:83]
    v_mfma_f32_16x16x32_bf16 a[84:87], v[40:43], v[20:23], a[84:87]
    v_mfma_f32_16x16x32_bf16 a[88:91], v[40:43], v[24:27], a[88:91]
    v_mfma_f32_16x16x32_bf16 a[92:95], v[40:43], v[28:31], a[92:95]
    v_mfma_f32_16x16x32_bf16 a[96:99], v[44:47], v[0:3], a[96:99]
    v_mfma_f32_16x16x32_bf16 a[100:103], v[44:47], v[4:7], a[100:103]
    v_mfma_f32_16x16x32_bf16 a[104:107], v[44:47], v[8:11], a[104:107]
    v_mfma_f32_16x16x32_bf16 a[108:111], v[44:47], v[12:15], a[108:111]
    v_mfma_f32_16x16x32_bf16 a[112:115], v[44:47], v[16:19], a[112:115]
    v_mfma_f32_16x16x32_bf16 a[116:119], v[44:47], v[20:23], a[116:119]
    v_mfma_f32_16x16x32_bf16 a[120:123], v[44:47], v[24:27], a[120:123]
    v_mfma_f32_16x16x32_bf16 a[124:127], v[44:47], v[28:31], a[124:127]
    s_waitcnt lgkmcnt(0)
    v_mfma_f32_16x16x32_bf16 a[0:3], v[80:83], v[48:51], a[0:3]
    s_waitcnt vmcnt(6)
    s_barrier
    ds_read_b128 v[32:35], v136 offset:16384
    v_mfma_f32_16x16x32_bf16 a[4:7], v[80:83], v[52:55], a[4:7]
    ds_read_b64_tr_b16 v[0:1], v128 offset:32768
    v_mfma_f32_16x16x32_bf16 a[8:11], v[80:83], v[56:59], a[8:11]
    ds_read_b64_tr_b16 v[2:3], v128 offset:40960
    v_mfma_f32_16x16x32_bf16 a[12:15], v[80:83], v[60:63], a[12:15]
    ds_read_b64_tr_b16 v[4:5], v129 offset:32768
    v_mfma_f32_16x16x32_bf16 a[16:19], v[80:83], v[64:67], a[16:19]
    ds_read_b64_tr_b16 v[6:7], v129 offset:40960
    v_mfma_f32_16x16x32_bf16 a[20:23], v[80:83], v[68:71], a[20:23]
    ds_read_b64_tr_b16 v[8:9], v130 offset:32768
    v_mfma_f32_16x16x32_bf16 a[24:27], v[80:83], v[72:75], a[24:27]
    ds_read_b64_tr_b16 v[10:11], v130 offset:40960
    v_mfma_f32_16x16x32_bf16 a[28:31], v[80:83], v[76:79], a[28:31]
    ds_read_b64_tr_b16 v[12:13], v131 offset:32768
    v_mfma_f32_16x16x32_bf16 a[32:35], v[84:87], v[48:51], a[32:35]
    ds_read_b64_tr_b16 v[14:15], v131 offset:40960
    v_mfma_f32_16x16x32_bf16 a[36:39], v[84:87], v[52:55], a[36:39]
    ds_read_b64_tr_b16 v[16:17], v132 offset:32768
    v_mfma_f32_16x16x32_bf16 a[40:43], v[84:87], v[56:59], a[40:43]
    ds_read_b64_tr_b16 v[18:19], v132 offset:40960
    v_mfma_f32_16x16x32_bf16 a[44:47], v[84:87], v[60:63], a[44:47]
    ds_read_b64_tr_b16 v[20:21], v133 offset:32768
    v_mfma_f32_16x16x32_bf16 a[48:51], v[84:87], v[64:67], a[48:51]
    ds_read_b64_tr_b16 v[22:23], v133 offset:40960
    v_mfma_f32_16x16x32_bf16 a[52:55], v[84:87], v[68:71], a[52:55]
    ds_read_b64_tr_b16 v[24:25], v134 offset:32768
    v_mfma_f32_16x16x32_bf16 a[56:59], v[84:87], v[72:75], a[56:59]
    ds_read_b64_tr_b16 v[26:27], v134 offset:40960
    v_mfma_f32_16x16x32_bf16 a[60:63], v[84:87], v[76:79], a[60:63]
    ds_read_b64_tr_b16 v[28:29], v135 offset:32768
    v_mfma_f32_16x16x32_bf16 a[64:67], v[88:91], v[48:51], a[64:67]
    ds_read_b64_tr_b16 v[30:31], v135 offset:40960
    v_mfma_f32_16x16x32_bf16 a[68:71], v[88:91], v[52:55], a[68:71]
    ds_read_b128 v[36:39], v136 offset:17408
    v_mfma_f32_16x16x32_bf16 a[72:75], v[88:91], v[56:59], a[72:75]
    ds_read_b128 v[40:43], v136 offset:18432
    v_mfma_f32_16x16x32_bf16 a[76:79], v[88:91], v[60:63], a[76:79]
    ds_read_b128 v[44:47], v136 offset:19456
    v_mfma_f32_16x16x32_bf16 a[80:83], v[88:91], v[64:67], a[80:83]
    v_mfma_f32_16x16x32_bf16 a[84:87], v[88:91], v[68:71], a[84:87]
    v_mfma_f32_16x16x32_bf16 a[88:91], v[88:91], v[72:75], a[88:91]
    v_mfma_f32_16x16x32_bf16 a[92:95], v[88:91], v[76:79], a[92:95]
    v_mfma_f32_16x16x32_bf16 a[96:99], v[92:95], v[48:51], a[96:99]
    v_mfma_f32_16x16x32_bf16 a[100:103], v[92:95], v[52:55], a[100:103]
    v_mfma_f32_16x16x32_bf16 a[104:107], v[92:95], v[56:59], a[104:107]
    v_mfma_f32_16x16x32_bf16 a[108:111], v[92:95], v[60:63], a[108:111]
    v_mfma_f32_16x16x32_bf16 a[112:115], v[92:95], v[64:67], a[112:115]
    v_mfma_f32_16x16x32_bf16 a[116:119], v[92:95], v[68:71], a[116:119]
    v_mfma_f32_16x16x32_bf16 a[120:123], v[92:95], v[72:75], a[120:123]
    v_mfma_f32_16x16x32_bf16 a[124:127], v[92:95], v[76:79], a[124:127]
    s_waitcnt lgkmcnt(0)
    v_mfma_f32_16x16x32_bf16 a[0:3], v[32:35], v[0:3], a[0:3]
    s_waitcnt vmcnt(0)
    s_barrier
    ds_read_b128 v[80:83], v136 offset:24576
    v_mfma_f32_16x16x32_bf16 a[4:7], v[32:35], v[4:7], a[4:7]
    ds_read_b64_tr_b16 v[48:49], v128 offset:49152
    v_mfma_f32_16x16x32_bf16 a[8:11], v[32:35], v[8:11], a[8:11]
    ds_read_b64_tr_b16 v[50:51], v128 offset:57344
    v_mfma_f32_16x16x32_bf16 a[12:15], v[32:35], v[12:15], a[12:15]
    ds_read_b64_tr_b16 v[52:53], v129 offset:49152
    v_mfma_f32_16x16x32_bf16 a[16:19], v[32:35], v[16:19], a[16:19]
    ds_read_b64_tr_b16 v[54:55], v129 offset:57344
    v_mfma_f32_16x16x32_bf16 a[20:23], v[32:35], v[20:23], a[20:23]
    ds_read_b64_tr_b16 v[56:57], v130 offset:49152
    v_mfma_f32_16x16x32_bf16 a[24:27], v[32:35], v[24:27], a[24:27]
    ds_read_b64_tr_b16 v[58:59], v130 offset:57344
    v_mfma_f32_16x16x32_bf16 a[28:31], v[32:35], v[28:31], a[28:31]
    ds_read_b64_tr_b16 v[60:61], v131 offset:49152
    v_mfma_f32_16x16x32_bf16 a[32:35], v[36:39], v[0:3], a[32:35]
    ds_read_b64_tr_b16 v[62:63], v131 offset:57344
    v_mfma_f32_16x16x32_bf16 a[36:39], v[36:39], v[4:7], a[36:39]
    ds_read_b64_tr_b16 v[64:65], v132 offset:49152
    v_mfma_f32_16x16x32_bf16 a[40:43], v[36:39], v[8:11], a[40:43]
    ds_read_b64_tr_b16 v[66:67], v132 offset:57344
    v_mfma_f32_16x16x32_bf16 a[44:47], v[36:39], v[12:15], a[44:47]
    ds_read_b64_tr_b16 v[68:69], v133 offset:49152
    v_mfma_f32_16x16x32_bf16 a[48:51], v[36:39], v[16:19], a[48:51]
    ds_read_b64_tr_b16 v[70:71], v133 offset:57344
    v_mfma_f32_16x16x32_bf16 a[52:55], v[36:39], v[20:23], a[52:55]
    ds_read_b64_tr_b16 v[72:73], v134 offset:49152
    v_mfma_f32_16x16x32_bf16 a[56:59], v[36:39], v[24:27], a[56:59]
    ds_read_b64_tr_b16 v[74:75], v134 offset:57344
    v_mfma_f32_16x16x32_bf16 a[60:63], v[36:39], v[28:31], a[60:63]
    ds_read_b64_tr_b16 v[76:77], v135 offset:49152
    v_mfma_f32_16x16x32_bf16 a[64:67], v[40:43], v[0:3], a[64:67]
    ds_read_b64_tr_b16 v[78:79], v135 offset:57344
    v_mfma_f32_16x16x32_bf16 a[68:71], v[40:43], v[4:7], a[68:71]
    ds_read_b128 v[84:87], v136 offset:25600
    v_mfma_f32_16x16x32_bf16 a[72:75], v[40:43], v[8:11], a[72:75]
    ds_read_b128 v[88:91], v136 offset:26624
    v_mfma_f32_16x16x32_bf16 a[76:79], v[40:43], v[12:15], a[76:79]
    ds_read_b128 v[92:95], v136 offset:27648
    v_mfma_f32_16x16x32_bf16 a[80:83], v[40:43], v[16:19], a[80:83]
    v_mfma_f32_16x16x32_bf16 a[84:87], v[40:43], v[20:23], a[84:87]
    v_mfma_f32_16x16x32_bf16 a[88:91], v[40:43], v[24:27], a[88:91]
    v_mfma_f32_16x16x32_bf16 a[92:95], v[40:43], v[28:31], a[92:95]
    v_mfma_f32_16x16x32_bf16 a[96:99], v[44:47], v[0:3], a[96:99]
    v_mfma_f32_16x16x32_bf16 a[100:103], v[44:47], v[4:7], a[100:103]
    v_mfma_f32_16x16x32_bf16 a[104:107], v[44:47], v[8:11], a[104:107]
    v_mfma_f32_16x16x32_bf16 a[108:111], v[44:47], v[12:15], a[108:111]
    v_mfma_f32_16x16x32_bf16 a[112:115], v[44:47], v[16:19], a[112:115]
    v_mfma_f32_16x16x32_bf16 a[116:119], v[44:47], v[20:23], a[116:119]
    v_mfma_f32_16x16x32_bf16 a[120:123], v[44:47], v[24:27], a[120:123]
    v_mfma_f32_16x16x32_bf16 a[124:127], v[44:47], v[28:31], a[124:127]
    v_readfirstlane_b32 s55, v255
    s_waitcnt lgkmcnt(0)
    v_mfma_f32_16x16x32_bf16 a[0:3], v[80:83], v[48:51], a[0:3]
    v_mfma_f32_16x16x32_bf16 a[4:7], v[80:83], v[52:55], a[4:7]
    v_mfma_f32_16x16x32_bf16 a[8:11], v[80:83], v[56:59], a[8:11]
    v_mfma_f32_16x16x32_bf16 a[12:15], v[80:83], v[60:63], a[12:15]
    v_mfma_f32_16x16x32_bf16 a[16:19], v[80:83], v[64:67], a[16:19]
    v_mfma_f32_16x16x32_bf16 a[20:23], v[80:83], v[68:71], a[20:23]
    v_mfma_f32_16x16x32_bf16 a[24:27], v[80:83], v[72:75], a[24:27]
    v_mfma_f32_16x16x32_bf16 a[28:31], v[80:83], v[76:79], a[28:31]
    v_mfma_f32_16x16x32_bf16 a[32:35], v[84:87], v[48:51], a[32:35]
    v_mfma_f32_16x16x32_bf16 a[36:39], v[84:87], v[52:55], a[36:39]
    v_mfma_f32_16x16x32_bf16 a[40:43], v[84:87], v[56:59], a[40:43]
    v_mfma_f32_16x16x32_bf16 a[44:47], v[84:87], v[60:63], a[44:47]
    v_mfma_f32_16x16x32_bf16 a[48:51], v[84:87], v[64:67], a[48:51]
    v_mfma_f32_16x16x32_bf16 a[52:55], v[84:87], v[68:71], a[52:55]
    v_mfma_f32_16x16x32_bf16 a[56:59], v[84:87], v[72:75], a[56:59]
    v_mfma_f32_16x16x32_bf16 a[60:63], v[84:87], v[76:79], a[60:63]
    v_mfma_f32_16x16x32_bf16 a[64:67], v[88:91], v[48:51], a[64:67]
    v_mfma_f32_16x16x32_bf16 a[68:71], v[88:91], v[52:55], a[68:71]
    v_mfma_f32_16x16x32_bf16 a[72:75], v[88:91], v[56:59], a[72:75]
    v_mfma_f32_16x16x32_bf16 a[76:79], v[88:91], v[60:63], a[76:79]
    v_mfma_f32_16x16x32_bf16 a[80:83], v[88:91], v[64:67], a[80:83]
    v_mfma_f32_16x16x32_bf16 a[84:87], v[88:91], v[68:71], a[84:87]
    v_mfma_f32_16x16x32_bf16 a[88:91], v[88:91], v[72:75], a[88:91]
    v_mfma_f32_16x16x32_bf16 a[92:95], v[88:91], v[76:79], a[92:95]
    v_mfma_f32_16x16x32_bf16 a[96:99], v[92:95], v[48:51], a[96:99]
    v_mfma_f32_16x16x32_bf16 a[100:103], v[92:95], v[52:55], a[100:103]
    v_mfma_f32_16x16x32_bf16 a[104:107], v[92:95], v[56:59], a[104:107]
    v_mfma_f32_16x16x32_bf16 a[108:111], v[92:95], v[60:63], a[108:111]
    v_mfma_f32_16x16x32_bf16 a[112:115], v[92:95], v[64:67], a[112:115]
    v_mfma_f32_16x16x32_bf16 a[116:119], v[92:95], v[68:71], a[116:119]
    v_mfma_f32_16x16x32_bf16 a[120:123], v[92:95], v[72:75], a[120:123]
    v_mfma_f32_16x16x32_bf16 a[124:127], v[92:95], v[76:79], a[124:127]
    s_nop 7
    s_mov_b32 s53, s21
    v_accvgpr_read_b32 v0, a0
    v_accvgpr_read_b32 v1, a1
    v_accvgpr_read_b32 v2, a2
    v_accvgpr_read_b32 v3, a3
    v_accvgpr_read_b32 v4, a32
    v_accvgpr_read_b32 v5, a33
    v_accvgpr_read_b32 v6, a34
    v_accvgpr_read_b32 v7, a35
    v_cvt_pk_bf16_f32 v8, v0, v1
    v_cvt_pk_bf16_f32 v9, v2, v3
    v_cvt_pk_bf16_f32 v10, v4, v5
    v_cvt_pk_bf16_f32 v11, v6, v7
    buffer_store_dwordx4 v[8:11], v251, s[4:7], s53 offen offset:0 sc1
    v_accvgpr_read_b32 v16, a4
    v_accvgpr_read_b32 v17, a5
    v_accvgpr_read_b32 v18, a6
    v_accvgpr_read_b32 v19, a7
    v_accvgpr_read_b32 v20, a36
    v_accvgpr_read_b32 v21, a37
    v_accvgpr_read_b32 v22, a38
    v_accvgpr_read_b32 v23, a39
    v_cvt_pk_bf16_f32 v24, v16, v17
    v_cvt_pk_bf16_f32 v25, v18, v19
    v_cvt_pk_bf16_f32 v26, v20, v21
    v_cvt_pk_bf16_f32 v27, v22, v23
    buffer_store_dwordx4 v[24:27], v251, s[4:7], s53 offen offset:1024 sc1
    v_accvgpr_read_b32 v32, a8
    v_accvgpr_read_b32 v33, a9
    v_accvgpr_read_b32 v34, a10
    v_accvgpr_read_b32 v35, a11
    v_accvgpr_read_b32 v36, a40
    v_accvgpr_read_b32 v37, a41
    v_accvgpr_read_b32 v38, a42
    v_accvgpr_read_b32 v39, a43
    v_cvt_pk_bf16_f32 v40, v32, v33
    v_cvt_pk_bf16_f32 v41, v34, v35
    v_cvt_pk_bf16_f32 v42, v36, v37
    v_cvt_pk_bf16_f32 v43, v38, v39
    buffer_store_dwordx4 v[40:43], v251, s[4:7], s53 offen offset:2048 sc1
    v_accvgpr_read_b32 v48, a12
    v_accvgpr_read_b32 v49, a13
    v_accvgpr_read_b32 v50, a14
    v_accvgpr_read_b32 v51, a15
    v_accvgpr_read_b32 v52, a44
    v_accvgpr_read_b32 v53, a45
    v_accvgpr_read_b32 v54, a46
    v_accvgpr_read_b32 v55, a47
    v_cvt_pk_bf16_f32 v56, v48, v49
    v_cvt_pk_bf16_f32 v57, v50, v51
    v_cvt_pk_bf16_f32 v58, v52, v53
    v_cvt_pk_bf16_f32 v59, v54, v55
    buffer_store_dwordx4 v[56:59], v251, s[4:7], s53 offen offset:3072 sc1
    s_add_u32 s53, s53, 4096
    v_accvgpr_read_b32 v0, a16
    v_accvgpr_read_b32 v1, a17
    v_accvgpr_read_b32 v2, a18
    v_accvgpr_read_b32 v3, a19
    v_accvgpr_read_b32 v4, a48
    v_accvgpr_read_b32 v5, a49
    v_accvgpr_read_b32 v6, a50
    v_accvgpr_read_b32 v7, a51
    v_cvt_pk_bf16_f32 v8, v0, v1
    v_cvt_pk_bf16_f32 v9, v2, v3
    v_cvt_pk_bf16_f32 v10, v4, v5
    v_cvt_pk_bf16_f32 v11, v6, v7
    buffer_store_dwordx4 v[8:11], v251, s[4:7], s53 offen offset:0 sc1
    v_accvgpr_read_b32 v16, a20
    v_accvgpr_read_b32 v17, a21
    v_accvgpr_read_b32 v18, a22
    v_accvgpr_read_b32 v19, a23
    v_accvgpr_read_b32 v20, a52
    v_accvgpr_read_b32 v21, a53
    v_accvgpr_read_b32 v22, a54
    v_accvgpr_read_b32 v23, a55
    v_cvt_pk_bf16_f32 v24, v16, v17
    v_cvt_pk_bf16_f32 v25, v18, v19
    v_cvt_pk_bf16_f32 v26, v20, v21
    v_cvt_pk_bf16_f32 v27, v22, v23
    buffer_store_dwordx4 v[24:27], v251, s[4:7], s53 offen offset:1024 sc1
    v_accvgpr_read_b32 v32, a24
    v_accvgpr_read_b32 v33, a25
    v_accvgpr_read_b32 v34, a26
    v_accvgpr_read_b32 v35, a27
    v_accvgpr_read_b32 v36, a56
    v_accvgpr_read_b32 v37, a57
    v_accvgpr_read_b32 v38, a58
    v_accvgpr_read_b32 v39, a59
    v_cvt_pk_bf16_f32 v40, v32, v33
    v_cvt_pk_bf16_f32 v41, v34, v35
    v_cvt_pk_bf16_f32 v42, v36, v37
    v_cvt_pk_bf16_f32 v43, v38, v39
    buffer_store_dwordx4 v[40:43], v251, s[4:7], s53 offen offset:2048 sc1
    v_accvgpr_read_b32 v48, a28
    v_accvgpr_read_b32 v49, a29
    v_accvgpr_read_b32 v50, a30
    v_accvgpr_read_b32 v51, a31
    v_accvgpr_read_b32 v52, a60
    v_accvgpr_read_b32 v53, a61
    v_accvgpr_read_b32 v54, a62
    v_accvgpr_read_b32 v55, a63
    v_cvt_pk_bf16_f32 v56, v48, v49
    v_cvt_pk_bf16_f32 v57, v50, v51
    v_cvt_pk_bf16_f32 v58, v52, v53
    v_cvt_pk_bf16_f32 v59, v54, v55
    buffer_store_dwordx4 v[56:59], v251, s[4:7], s53 offen offset:3072 sc1
    s_add_u32 s53, s53, 258048
    v_accvgpr_read_b32 v0, a64
    v_accvgpr_read_b32 v1, a65
    v_accvgpr_read_b32 v2, a66
    v_accvgpr_read_b32 v3, a67
    v_accvgpr_read_b32 v4, a96
    v_accvgpr_read_b32 v5, a97
    v_accvgpr_read_b32 v6, a98
    v_accvgpr_read_b32 v7, a99
    v_cvt_pk_bf16_f32 v8, v0, v1
    v_cvt_pk_bf16_f32 v9, v2, v3
    v_cvt_pk_bf16_f32 v10, v4, v5
    v_cvt_pk_bf16_f32 v11, v6, v7
    buffer_store_dwordx4 v[8:11], v251, s[4:7], s53 offen offset:0 sc1
    v_accvgpr_read_b32 v16, a68
    v_accvgpr_read_b32 v17, a69
    v_accvgpr_read_b32 v18, a70
    v_accvgpr_read_b32 v19, a71
    v_accvgpr_read_b32 v20, a100
    v_accvgpr_read_b32 v21, a101
    v_accvgpr_read_b32 v22, a102
    v_accvgpr_read_b32 v23, a103
    v_cvt_pk_bf16_f32 v24, v16, v17
    v_cvt_pk_bf16_f32 v25, v18, v19
    v_cvt_pk_bf16_f32 v26, v20, v21
    v_cvt_pk_bf16_f32 v27, v22, v23
    buffer_store_dwordx4 v[24:27], v251, s[4:7], s53 offen offset:1024 sc1
    v_accvgpr_read_b32 v32, a72
    v_accvgpr_read_b32 v33, a73
    v_accvgpr_read_b32 v34, a74
    v_accvgpr_read_b32 v35, a75
    v_accvgpr_read_b32 v36, a104
    v_accvgpr_read_b32 v37, a105
    v_accvgpr_read_b32 v38, a106
    v_accvgpr_read_b32 v39, a107
    v_cvt_pk_bf16_f32 v40, v32, v33
    v_cvt_pk_bf16_f32 v41, v34, v35
    v_cvt_pk_bf16_f32 v42, v36, v37
    v_cvt_pk_bf16_f32 v43, v38, v39
    buffer_store_dwordx4 v[40:43], v251, s[4:7], s53 offen offset:2048 sc1
    v_accvgpr_read_b32 v48, a76
    v_accvgpr_read_b32 v49, a77
    v_accvgpr_read_b32 v50, a78
    v_accvgpr_read_b32 v51, a79
    v_accvgpr_read_b32 v52, a108
    v_accvgpr_read_b32 v53, a109
    v_accvgpr_read_b32 v54, a110
    v_accvgpr_read_b32 v55, a111
    v_cvt_pk_bf16_f32 v56, v48, v49
    v_cvt_pk_bf16_f32 v57, v50, v51
    v_cvt_pk_bf16_f32 v58, v52, v53
    v_cvt_pk_bf16_f32 v59, v54, v55
    buffer_store_dwordx4 v[56:59], v251, s[4:7], s53 offen offset:3072 sc1
    s_add_u32 s53, s53, 4096
    v_accvgpr_read_b32 v0, a80
    v_accvgpr_read_b32 v1, a81
    v_accvgpr_read_b32 v2, a82
    v_accvgpr_read_b32 v3, a83
    v_accvgpr_read_b32 v4, a112
    v_accvgpr_read_b32 v5, a113
    v_accvgpr_read_b32 v6, a114
    v_accvgpr_read_b32 v7, a115
    v_cvt_pk_bf16_f32 v8, v0, v1
    v_cvt_pk_bf16_f32 v9, v2, v3
    v_cvt_pk_bf16_f32 v10, v4, v5
    v_cvt_pk_bf16_f32 v11, v6, v7
    buffer_store_dwordx4 v[8:11], v251, s[4:7], s53 offen offset:0 sc1
    v_accvgpr_read_b32 v16, a84
    v_accvgpr_read_b32 v17, a85
    v_accvgpr_read_b32 v18, a86
    v_accvgpr_read_b32 v19, a87
    v_accvgpr_read_b32 v20, a116
    v_accvgpr_read_b32 v21, a117
    v_accvgpr_read_b32 v22, a118
    v_accvgpr_read_b32 v23, a119
    v_cvt_pk_bf16_f32 v24, v16, v17
    v_cvt_pk_bf16_f32 v25, v18, v19
    v_cvt_pk_bf16_f32 v26, v20, v21
    v_cvt_pk_bf16_f32 v27, v22, v23
    buffer_store_dwordx4 v[24:27], v251, s[4:7], s53 offen offset:1024 sc1
    v_accvgpr_read_b32 v32, a88
    v_accvgpr_read_b32 v33, a89
    v_accvgpr_read_b32 v34, a90
    v_accvgpr_read_b32 v35, a91
    v_accvgpr_read_b32 v36, a120
    v_accvgpr_read_b32 v37, a121
    v_accvgpr_read_b32 v38, a122
    v_accvgpr_read_b32 v39, a123
    v_cvt_pk_bf16_f32 v40, v32, v33
    v_cvt_pk_bf16_f32 v41, v34, v35
    v_cvt_pk_bf16_f32 v42, v36, v37
    v_cvt_pk_bf16_f32 v43, v38, v39
    buffer_store_dwordx4 v[40:43], v251, s[4:7], s53 offen offset:2048 sc1
    v_accvgpr_read_b32 v48, a92
    v_accvgpr_read_b32 v49, a93
    v_accvgpr_read_b32 v50, a94
    v_accvgpr_read_b32 v51, a95
    v_accvgpr_read_b32 v52, a124
    v_accvgpr_read_b32 v53, a125
    v_accvgpr_read_b32 v54, a126
    v_accvgpr_read_b32 v55, a127
    v_cvt_pk_bf16_f32 v56, v48, v49
    v_cvt_pk_bf16_f32 v57, v50, v51
    v_cvt_pk_bf16_f32 v58, v52, v53
    v_cvt_pk_bf16_f32 v59, v54, v55
    buffer_store_dwordx4 v[56:59], v251, s[4:7], s53 offen offset:3072 sc1
    s_add_u32 s53, s53, 258048
    s_branch main_kernel_w_done
main_kernel_w_c2_task:
    s_cmp_eq_u32 s23, 0
    s_cbranch_scc1 main_kernel_w_c2_set0
    s_cmp_eq_u32 s23, 1
    s_cbranch_scc1 main_kernel_w_c2_set1
    s_cmp_eq_u32 s23, 2
    s_cbranch_scc1 main_kernel_w_c2_set2
    s_cmp_eq_u32 s23, 6
    s_cbranch_scc1 main_kernel_w_c2_set6
    s_branch main_kernel_w_done
main_kernel_w_c2_set0:
    s_lshl_b32 s32, s25, 8
    s_add_u32 s8, s40, s32
    s_addc_u32 s9, s41, 0
    s_and_b32 s9, s9, 0xffff
    s_sub_u32 s10, 0x800000, s32
    s_mov_b32 s11, 0x20000
    s_mov_b32 s30, 8192
    s_mov_b32 s31, 32768
    s_mul_i32 s16, s24, 262144
    s_add_u32 s16, s16, 0x0
    s_mov_b32 s18, 7
    s_lshl_b32 s32, s24, 3
    s_mul_i32 s33, s38, 8
    s_add_u32 s32, s32, s33
    s_mul_i32 s32, s32, 131072
    s_lshl_b32 s33, s25, 12
    s_add_u32 s32, s32, s33
    s_mul_i32 s33, s37, 4096
    s_add_u32 s32, s32, s33
    s_add_u32 s21, s32, 0x800000
    s_mov_b32 s22, 131072
    s_mov_b32 s26, -1
    s_branch main_kernel_w_c2_go
main_kernel_w_c2_set1:
    s_lshl_b32 s32, s25, 8
    s_add_u32 s8, s42, s32
    s_addc_u32 s9, s43, 0
    s_and_b32 s9, s9, 0xffff
    s_sub_u32 s10, 0x800000, s32
    s_mov_b32 s11, 0x20000
    s_mov_b32 s30, 8192
    s_mov_b32 s31, 32768
    s_mul_i32 s16, s24, 262144
    s_add_u32 s16, s16, 0x0
    s_mov_b32 s18, 7
    s_lshl_b32 s32, s24, 3
    s_mul_i32 s33, s38, 8
    s_add_u32 s32, s32, s33
    s_mul_i32 s32, s32, 131072
    s_lshl_b32 s33, s25, 12
    s_add_u32 s32, s32, s33
    s_mul_i32 s33, s37, 4096
    s_add_u32 s32, s32, s33
    s_add_u32 s21, s32, 0x1800000
    s_mov_b32 s22, 131072
    s_mov_b32 s26, -1
    s_branch main_kernel_w_c2_go
main_kernel_w_c2_set2:
    s_lshl_b32 s32, s25, 8
    s_add_u32 s8, s44, s32
    s_addc_u32 s9, s45, 0
    s_and_b32 s9, s9, 0xffff
    s_sub_u32 s10, 0x800000, s32
    s_mov_b32 s11, 0x20000
    s_mov_b32 s30, 8192
    s_mov_b32 s31, 32768
    s_mul_i32 s16, s24, 262144
    s_add_u32 s16, s16, 0x0
    s_mov_b32 s18, 7
    s_lshl_b32 s32, s24, 2
    s_mul_i32 s33, s38, 4
    s_add_u32 s32, s32, s33
    s_lshl_b32 s32, s32, 18
    s_lshl_b32 s33, s25, 13
    s_add_u32 s32, s32, s33
    s_mul_i32 s33, s37, 8192
    s_add_u32 s32, s32, s33
    s_add_u32 s21, s32, 0x2800000
    s_branch main_kernel_w_c2_gov
main_kernel_w_c2_set6:
    s_lshl_b32 s32, s25, 8
    s_add_u32 s8, s68, s32
    s_addc_u32 s9, s69, 0
    s_and_b32 s9, s9, 0xffff
    s_sub_u32 s10, 0x700000, s32
    s_mov_b32 s11, 0x20000
    s_mov_b32 s30, 7168
    s_mov_b32 s31, 32768
    s_mul_i32 s16, s24, 262144
    s_add_u32 s16, s16, 0x6800000
    s_mov_b32 s18, 7
    s_lshl_b32 s32, s24, 3
    s_mul_i32 s33, s38, 8
    s_add_u32 s32, s32, s33
    s_mul_i32 s32, s32, 114688
    s_lshl_b32 s33, s25, 12
    s_add_u32 s32, s32, s33
    s_mul_i32 s33, s37, 4096
    s_add_u32 s32, s32, s33
    s_add_u32 s21, s32, 0x5400000
    s_mov_b32 s22, 114688
    s_mov_b32 s26, -1
    s_branch main_kernel_w_c2_go
main_kernel_w_c2_go:
    v_lshrrev_b32 v0, 4, v250
    v_bfe_u32 v1, v250, 2, 2
    v_lshl_add_u32 v4, v0, 2, v1
    v_and_b32 v5, 7, v4
    v_mul_u32_u24 v4, 512, v4
    v_and_b32 v6, 3, v250
    v_lshl_add_u32 v4, v6, 3, v4
    s_mul_i32 s32, s37, 8
    v_xor_b32 v5, s32, v5
    v_lshl_add_u32 v128, v5, 5, v4
    v_xor_b32 v129, 32, v128
    v_xor_b32 v130, 64, v128
    v_xor_b32 v131, 96, v128
    v_xor_b32 v132, 128, v128
    v_xor_b32 v133, 160, v128
    v_xor_b32 v134, 192, v128
    v_xor_b32 v135, 224, v128
    s_mul_i32 s32, s38, 8192
    s_add_u32 s32, s32, 65536
    v_add_u32 v136, s32, v251
    v_lshrrev_b32 v2, 5, v250
    v_and_b32 v3, 31, v250
    s_mul_i32 s32, s14, 8
    v_add_u32 v4, s32, v2
    v_add_u32 v5, 0, v4
    v_and_b32 v6, 7, v5
    v_lshlrev_b32 v6, 1, v6
    v_xor_b32 v6, v6, v3
    v_mul_lo_u32 v5, v5, s30
    v_lshl_add_u32 v5, v6, 4, v5
    v_subrev_u32 v137, 0, v5
    v_add_u32 v5, 2, v4
    v_and_b32 v6, 7, v5
    v_lshlrev_b32 v6, 1, v6
    v_xor_b32 v6, v6, v3
    v_mul_lo_u32 v5, v5, s30
    v_lshl_add_u32 v5, v6, 4, v5
    v_subrev_u32 v138, 1024, v5
    v_add_u32 v5, 4, v4
    v_and_b32 v6, 7, v5
    v_lshlrev_b32 v6, 1, v6
    v_xor_b32 v6, v6, v3
    v_mul_lo_u32 v5, v5, s30
    v_lshl_add_u32 v5, v6, 4, v5
    v_subrev_u32 v139, 2048, v5
    v_add_u32 v5, 6, v4
    v_and_b32 v6, 7, v5
    v_lshlrev_b32 v6, 1, v6
    v_xor_b32 v6, v6, v3
    v_mul_lo_u32 v5, v5, s30
    v_lshl_add_u32 v5, v6, 4, v5
    v_subrev_u32 v140, 3072, v5
    s_mul_i32 s32, s14, 4
    s_mul_i32 s32, s32, s31
    v_add_u32 v141, s32, v251
    s_add_u32 s32, s32, s31
    s_sub_u32 s32, s32, 1024
    v_add_u32 v142, s32, v251
    s_add_u32 s32, s32, s31
    s_sub_u32 s32, s32, 1024
    v_add_u32 v143, s32, v251
    s_add_u32 s32, s32, s31
    s_sub_u32 s32, s32, 1024
    v_add_u32 v144, s32, v251
    s_mul_i32 s19, s14, 4096
    s_mul_i32 s20, s14, 4096
    s_add_u32 s20, s20, 65536
    s_mul_i32 s17, s30, 32
    s_mov_b32 s15, 0
    s_add_u32 m0, s20, 0
    s_nop 0
    buffer_load_dwordx4 v141, s[4:7], s16 offen offset:0 sc1 lds
    buffer_load_dwordx4 v142, s[4:7], s16 offen offset:1024 sc1 lds
    buffer_load_dwordx4 v143, s[4:7], s16 offen offset:2048 sc1 lds
    buffer_load_dwordx4 v144, s[4:7], s16 offen offset:3072 sc1 lds
    s_add_u32 s16, s16, 1024
    s_add_u32 m0, s19, 0
    s_nop 0
    buffer_load_dwordx4 v137, s[8:11], s15 offen offset:0 lds
    buffer_load_dwordx4 v138, s[8:11], s15 offen offset:1024 lds
    buffer_load_dwordx4 v139, s[8:11], s15 offen offset:2048 lds
    buffer_load_dwordx4 v140, s[8:11], s15 offen offset:3072 lds
    s_add_u32 s15, s15, s17
    s_add_u32 m0, s20, 16384
    s_nop 0
    buffer_load_dwordx4 v141, s[4:7], s16 offen offset:0 sc1 lds
    buffer_load_dwordx4 v142, s[4:7], s16 offen offset:1024 sc1 lds
    buffer_load_dwordx4 v143, s[4:7], s16 offen offset:2048 sc1 lds
    buffer_load_dwordx4 v144, s[4:7], s16 offen offset:3072 sc1 lds
    s_add_u32 s16, s16, 1024
    s_add_u32 m0, s19, 16384
    s_nop 0
    buffer_load_dwordx4 v137, s[8:11], s15 offen offset:0 lds
    buffer_load_dwordx4 v138, s[8:11], s15 offen offset:1024 lds
    buffer_load_dwordx4 v139, s[8:11], s15 offen offset:2048 lds
    buffer_load_dwordx4 v140, s[8:11], s15 offen offset:3072 lds
    s_add_u32 s15, s15, s17
    s_add_u32 m0, s20, 32768
    s_nop 0
    buffer_load_dwordx4 v141, s[4:7], s16 offen offset:0 sc1 lds
    buffer_load_dwordx4 v142, s[4:7], s16 offen offset:1024 sc1 lds
    buffer_load_dwordx4 v143, s[4:7], s16 offen offset:2048 sc1 lds
    buffer_load_dwordx4 v144, s[4:7], s16 offen offset:3072 sc1 lds
    s_add_u32 s16, s16, 1024
    s_add_u32 m0, s19, 32768
    s_nop 0
    buffer_load_dwordx4 v137, s[8:11], s15 offen offset:0 lds
    buffer_load_dwordx4 v138, s[8:11], s15 offen offset:1024 lds
    buffer_load_dwordx4 v139, s[8:11], s15 offen offset:2048 lds
    buffer_load_dwordx4 v140, s[8:11], s15 offen offset:3072 lds
    s_add_u32 s15, s15, s17
    s_add_u32 m0, s20, 49152
    s_nop 0
    buffer_load_dwordx4 v141, s[4:7], s16 offen offset:0 sc1 lds
    buffer_load_dwordx4 v142, s[4:7], s16 offen offset:1024 sc1 lds
    buffer_load_dwordx4 v143, s[4:7], s16 offen offset:2048 sc1 lds
    buffer_load_dwordx4 v144, s[4:7], s16 offen offset:3072 sc1 lds
    s_add_u32 s16, s16, 1024
    s_add_u32 m0, s19, 49152
    s_nop 0
    buffer_load_dwordx4 v137, s[8:11], s15 offen offset:0 lds
    buffer_load_dwordx4 v138, s[8:11], s15 offen offset:1024 lds
    buffer_load_dwordx4 v139, s[8:11], s15 offen offset:2048 lds
    buffer_load_dwordx4 v140, s[8:11], s15 offen offset:3072 lds
    s_add_u32 s15, s15, s17
    v_accvgpr_write_b32 a0, 0
    v_accvgpr_write_b32 a1, 0
    v_accvgpr_write_b32 a2, 0
    v_accvgpr_write_b32 a3, 0
    v_accvgpr_write_b32 a4, 0
    v_accvgpr_write_b32 a5, 0
    v_accvgpr_write_b32 a6, 0
    v_accvgpr_write_b32 a7, 0
    v_accvgpr_write_b32 a8, 0
    v_accvgpr_write_b32 a9, 0
    v_accvgpr_write_b32 a10, 0
    v_accvgpr_write_b32 a11, 0
    v_accvgpr_write_b32 a12, 0
    v_accvgpr_write_b32 a13, 0
    v_accvgpr_write_b32 a14, 0
    v_accvgpr_write_b32 a15, 0
    v_accvgpr_write_b32 a16, 0
    v_accvgpr_write_b32 a17, 0
    v_accvgpr_write_b32 a18, 0
    v_accvgpr_write_b32 a19, 0
    v_accvgpr_write_b32 a20, 0
    v_accvgpr_write_b32 a21, 0
    v_accvgpr_write_b32 a22, 0
    v_accvgpr_write_b32 a23, 0
    v_accvgpr_write_b32 a24, 0
    v_accvgpr_write_b32 a25, 0
    v_accvgpr_write_b32 a26, 0
    v_accvgpr_write_b32 a27, 0
    v_accvgpr_write_b32 a28, 0
    v_accvgpr_write_b32 a29, 0
    v_accvgpr_write_b32 a30, 0
    v_accvgpr_write_b32 a31, 0
    v_accvgpr_write_b32 a32, 0
    v_accvgpr_write_b32 a33, 0
    v_accvgpr_write_b32 a34, 0
    v_accvgpr_write_b32 a35, 0
    v_accvgpr_write_b32 a36, 0
    v_accvgpr_write_b32 a37, 0
    v_accvgpr_write_b32 a38, 0
    v_accvgpr_write_b32 a39, 0
    v_accvgpr_write_b32 a40, 0
    v_accvgpr_write_b32 a41, 0
    v_accvgpr_write_b32 a42, 0
    v_accvgpr_write_b32 a43, 0
    v_accvgpr_write_b32 a44, 0
    v_accvgpr_write_b32 a45, 0
    v_accvgpr_write_b32 a46, 0
    v_accvgpr_write_b32 a47, 0
    v_accvgpr_write_b32 a48, 0
    v_accvgpr_write_b32 a49, 0
    v_accvgpr_write_b32 a50, 0
    v_accvgpr_write_b32 a51, 0
    v_accvgpr_write_b32 a52, 0
    v_accvgpr_write_b32 a53, 0
    v_accvgpr_write_b32 a54, 0
    v_accvgpr_write_b32 a55, 0
    v_accvgpr_write_b32 a56, 0
    v_accvgpr_write_b32 a57, 0
    v_accvgpr_write_b32 a58, 0
    v_accvgpr_write_b32 a59, 0
    v_accvgpr_write_b32 a60, 0
    v_accvgpr_write_b32 a61, 0
    v_accvgpr_write_b32 a62, 0
    v_accvgpr_write_b32 a63, 0
    v_accvgpr_write_b32 a64, 0
    v_accvgpr_write_b32 a65, 0
    v_accvgpr_write_b32 a66, 0
    v_accvgpr_write_b32 a67, 0
    v_accvgpr_write_b32 a68, 0
    v_accvgpr_write_b32 a69, 0
    v_accvgpr_write_b32 a70, 0
    v_accvgpr_write_b32 a71, 0
    v_accvgpr_write_b32 a72, 0
    v_accvgpr_write_b32 a73, 0
    v_accvgpr_write_b32 a74, 0
    v_accvgpr_write_b32 a75, 0
    v_accvgpr_write_b32 a76, 0
    v_accvgpr_write_b32 a77, 0
    v_accvgpr_write_b32 a78, 0
    v_accvgpr_write_b32 a79, 0
    v_accvgpr_write_b32 a80, 0
    v_accvgpr_write_b32 a81, 0
    v_accvgpr_write_b32 a82, 0
    v_accvgpr_write_b32 a83, 0
    v_accvgpr_write_b32 a84, 0
    v_accvgpr_write_b32 a85, 0
    v_accvgpr_write_b32 a86, 0
    v_accvgpr_write_b32 a87, 0
    v_accvgpr_write_b32 a88, 0
    v_accvgpr_write_b32 a89, 0
    v_accvgpr_write_b32 a90, 0
    v_accvgpr_write_b32 a91, 0
    v_accvgpr_write_b32 a92, 0
    v_accvgpr_write_b32 a93, 0
    v_accvgpr_write_b32 a94, 0
    v_accvgpr_write_b32 a95, 0
    v_accvgpr_write_b32 a96, 0
    v_accvgpr_write_b32 a97, 0
    v_accvgpr_write_b32 a98, 0
    v_accvgpr_write_b32 a99, 0
    v_accvgpr_write_b32 a100, 0
    v_accvgpr_write_b32 a101, 0
    v_accvgpr_write_b32 a102, 0
    v_accvgpr_write_b32 a103, 0
    v_accvgpr_write_b32 a104, 0
    v_accvgpr_write_b32 a105, 0
    v_accvgpr_write_b32 a106, 0
    v_accvgpr_write_b32 a107, 0
    v_accvgpr_write_b32 a108, 0
    v_accvgpr_write_b32 a109, 0
    v_accvgpr_write_b32 a110, 0
    v_accvgpr_write_b32 a111, 0
    v_accvgpr_write_b32 a112, 0
    v_accvgpr_write_b32 a113, 0
    v_accvgpr_write_b32 a114, 0
    v_accvgpr_write_b32 a115, 0
    v_accvgpr_write_b32 a116, 0
    v_accvgpr_write_b32 a117, 0
    v_accvgpr_write_b32 a118, 0
    v_accvgpr_write_b32 a119, 0
    v_accvgpr_write_b32 a120, 0
    v_accvgpr_write_b32 a121, 0
    v_accvgpr_write_b32 a122, 0
    v_accvgpr_write_b32 a123, 0
    v_accvgpr_write_b32 a124, 0
    v_accvgpr_write_b32 a125, 0
    v_accvgpr_write_b32 a126, 0
    v_accvgpr_write_b32 a127, 0
    v_accvgpr_write_b32 a128, 0
    v_accvgpr_write_b32 a129, 0
    v_accvgpr_write_b32 a130, 0
    v_accvgpr_write_b32 a131, 0
    v_accvgpr_write_b32 a132, 0
    v_accvgpr_write_b32 a133, 0
    v_accvgpr_write_b32 a134, 0
    v_accvgpr_write_b32 a135, 0
    v_accvgpr_write_b32 a136, 0
    v_accvgpr_write_b32 a137, 0
    v_accvgpr_write_b32 a138, 0
    v_accvgpr_write_b32 a139, 0
    v_accvgpr_write_b32 a140, 0
    v_accvgpr_write_b32 a141, 0
    v_accvgpr_write_b32 a142, 0
    v_accvgpr_write_b32 a143, 0
    v_accvgpr_write_b32 a144, 0
    v_accvgpr_write_b32 a145, 0
    v_accvgpr_write_b32 a146, 0
    v_accvgpr_write_b32 a147, 0
    v_accvgpr_write_b32 a148, 0
    v_accvgpr_write_b32 a149, 0
    v_accvgpr_write_b32 a150, 0
    v_accvgpr_write_b32 a151, 0
    v_accvgpr_write_b32 a152, 0
    v_accvgpr_write_b32 a153, 0
    v_accvgpr_write_b32 a154, 0
    v_accvgpr_write_b32 a155, 0
    v_accvgpr_write_b32 a156, 0
    v_accvgpr_write_b32 a157, 0
    v_accvgpr_write_b32 a158, 0
    v_accvgpr_write_b32 a159, 0
    v_accvgpr_write_b32 a160, 0
    v_accvgpr_write_b32 a161, 0
    v_accvgpr_write_b32 a162, 0
    v_accvgpr_write_b32 a163, 0
    v_accvgpr_write_b32 a164, 0
    v_accvgpr_write_b32 a165, 0
    v_accvgpr_write_b32 a166, 0
    v_accvgpr_write_b32 a167, 0
    v_accvgpr_write_b32 a168, 0
    v_accvgpr_write_b32 a169, 0
    v_accvgpr_write_b32 a170, 0
    v_accvgpr_write_b32 a171, 0
    v_accvgpr_write_b32 a172, 0
    v_accvgpr_write_b32 a173, 0
    v_accvgpr_write_b32 a174, 0
    v_accvgpr_write_b32 a175, 0
    v_accvgpr_write_b32 a176, 0
    v_accvgpr_write_b32 a177, 0
    v_accvgpr_write_b32 a178, 0
    v_accvgpr_write_b32 a179, 0
    v_accvgpr_write_b32 a180, 0
    v_accvgpr_write_b32 a181, 0
    v_accvgpr_write_b32 a182, 0
    v_accvgpr_write_b32 a183, 0
    v_accvgpr_write_b32 a184, 0
    v_accvgpr_write_b32 a185, 0
    v_accvgpr_write_b32 a186, 0
    v_accvgpr_write_b32 a187, 0
    v_accvgpr_write_b32 a188, 0
    v_accvgpr_write_b32 a189, 0
    v_accvgpr_write_b32 a190, 0
    v_accvgpr_write_b32 a191, 0
    v_accvgpr_write_b32 a192, 0
    v_accvgpr_write_b32 a193, 0
    v_accvgpr_write_b32 a194, 0
    v_accvgpr_write_b32 a195, 0
    v_accvgpr_write_b32 a196, 0
    v_accvgpr_write_b32 a197, 0
    v_accvgpr_write_b32 a198, 0
    v_accvgpr_write_b32 a199, 0
    v_accvgpr_write_b32 a200, 0
    v_accvgpr_write_b32 a201, 0
    v_accvgpr_write_b32 a202, 0
    v_accvgpr_write_b32 a203, 0
    v_accvgpr_write_b32 a204, 0
    v_accvgpr_write_b32 a205, 0
    v_accvgpr_write_b32 a206, 0
    v_accvgpr_write_b32 a207, 0
    v_accvgpr_write_b32 a208, 0
    v_accvgpr_write_b32 a209, 0
    v_accvgpr_write_b32 a210, 0
    v_accvgpr_write_b32 a211, 0
    v_accvgpr_write_b32 a212, 0
    v_accvgpr_write_b32 a213, 0
    v_accvgpr_write_b32 a214, 0
    v_accvgpr_write_b32 a215, 0
    v_accvgpr_write_b32 a216, 0
    v_accvgpr_write_b32 a217, 0
    v_accvgpr_write_b32 a218, 0
    v_accvgpr_write_b32 a219, 0
    v_accvgpr_write_b32 a220, 0
    v_accvgpr_write_b32 a221, 0
    v_accvgpr_write_b32 a222, 0
    v_accvgpr_write_b32 a223, 0
    v_accvgpr_write_b32 a224, 0
    v_accvgpr_write_b32 a225, 0
    v_accvgpr_write_b32 a226, 0
    v_accvgpr_write_b32 a227, 0
    v_accvgpr_write_b32 a228, 0
    v_accvgpr_write_b32 a229, 0
    v_accvgpr_write_b32 a230, 0
    v_accvgpr_write_b32 a231, 0
    v_accvgpr_write_b32 a232, 0
    v_accvgpr_write_b32 a233, 0
    v_accvgpr_write_b32 a234, 0
    v_accvgpr_write_b32 a235, 0
    v_accvgpr_write_b32 a236, 0
    v_accvgpr_write_b32 a237, 0
    v_accvgpr_write_b32 a238, 0
    v_accvgpr_write_b32 a239, 0
    v_accvgpr_write_b32 a240, 0
    v_accvgpr_write_b32 a241, 0
    v_accvgpr_write_b32 a242, 0
    v_accvgpr_write_b32 a243, 0
    v_accvgpr_write_b32 a244, 0
    v_accvgpr_write_b32 a245, 0
    v_accvgpr_write_b32 a246, 0
    v_accvgpr_write_b32 a247, 0
    v_accvgpr_write_b32 a248, 0
    v_accvgpr_write_b32 a249, 0
    v_accvgpr_write_b32 a250, 0
    v_accvgpr_write_b32 a251, 0
    v_accvgpr_write_b32 a252, 0
    v_accvgpr_write_b32 a253, 0
    v_accvgpr_write_b32 a254, 0
    v_accvgpr_write_b32 a255, 0
    s_waitcnt vmcnt(24)
    s_barrier
    ds_read_b128 v[32:35], v136 offset:0
    ds_read_b64_tr_b16 v[0:1], v128 offset:0
    ds_read_b64_tr_b16 v[2:3], v128 offset:8192
    ds_read_b64_tr_b16 v[4:5], v129 offset:0
    ds_read_b64_tr_b16 v[6:7], v129 offset:8192
    ds_read_b64_tr_b16 v[8:9], v130 offset:0
    ds_read_b64_tr_b16 v[10:11], v130 offset:8192
    ds_read_b64_tr_b16 v[12:13], v131 offset:0
    ds_read_b64_tr_b16 v[14:15], v131 offset:8192
    ds_read_b64_tr_b16 v[16:17], v132 offset:0
    ds_read_b64_tr_b16 v[18:19], v132 offset:8192
    ds_read_b64_tr_b16 v[20:21], v133 offset:0
    ds_read_b64_tr_b16 v[22:23], v133 offset:8192
    ds_read_b64_tr_b16 v[24:25], v134 offset:0
    ds_read_b64_tr_b16 v[26:27], v134 offset:8192
    ds_read_b64_tr_b16 v[28:29], v135 offset:0
    ds_read_b64_tr_b16 v[30:31], v135 offset:8192
    ds_read_b128 v[36:39], v136 offset:1024
    ds_read_b128 v[40:43], v136 offset:2048
    ds_read_b128 v[44:47], v136 offset:3072
    ds_read_b128 v[48:51], v136 offset:4096
    ds_read_b128 v[52:55], v136 offset:5120
    ds_read_b128 v[56:59], v136 offset:6144
    ds_read_b128 v[60:63], v136 offset:7168
main_kernel_w_c2_n_loop:
    s_waitcnt lgkmcnt(0)
    v_mfma_f32_16x16x32_bf16 a[0:3], v[0:3], v[32:35], a[0:3]
    s_waitcnt vmcnt(16)
    s_barrier
    ds_read_b128 v[96:99], v136 offset:16384
    s_add_u32 m0, s20, 0
    s_nop 0
    v_mfma_f32_16x16x32_bf16 a[4:7], v[4:7], v[32:35], a[4:7]
    ds_read_b64_tr_b16 v[64:65], v128 offset:16384
    v_mfma_f32_16x16x32_bf16 a[8:11], v[8:11], v[32:35], a[8:11]
    ds_read_b64_tr_b16 v[66:67], v128 offset:24576
    v_mfma_f32_16x16x32_bf16 a[12:15], v[12:15], v[32:35], a[12:15]
    ds_read_b64_tr_b16 v[68:69], v129 offset:16384
    v_mfma_f32_16x16x32_bf16 a[16:19], v[16:19], v[32:35], a[16:19]
    ds_read_b64_tr_b16 v[70:71], v129 offset:24576
    v_mfma_f32_16x16x32_bf16 a[20:23], v[20:23], v[32:35], a[20:23]
    ds_read_b64_tr_b16 v[72:73], v130 offset:16384
    buffer_load_dwordx4 v141, s[4:7], s16 offen offset:0 sc1 lds
    v_mfma_f32_16x16x32_bf16 a[24:27], v[24:27], v[32:35], a[24:27]
    ds_read_b64_tr_b16 v[74:75], v130 offset:24576
    v_mfma_f32_16x16x32_bf16 a[28:31], v[28:31], v[32:35], a[28:31]
    ds_read_b64_tr_b16 v[76:77], v131 offset:16384
    v_mfma_f32_16x16x32_bf16 a[32:35], v[0:3], v[36:39], a[32:35]
    ds_read_b64_tr_b16 v[78:79], v131 offset:24576
    v_mfma_f32_16x16x32_bf16 a[36:39], v[4:7], v[36:39], a[36:39]
    ds_read_b64_tr_b16 v[80:81], v132 offset:16384
    v_mfma_f32_16x16x32_bf16 a[40:43], v[8:11], v[36:39], a[40:43]
    ds_read_b64_tr_b16 v[82:83], v132 offset:24576
    buffer_load_dwordx4 v142, s[4:7], s16 offen offset:1024 sc1 lds
    v_mfma_f32_16x16x32_bf16 a[44:47], v[12:15], v[36:39], a[44:47]
    ds_read_b64_tr_b16 v[84:85], v133 offset:16384
    v_mfma_f32_16x16x32_bf16 a[48:51], v[16:19], v[36:39], a[48:51]
    ds_read_b64_tr_b16 v[86:87], v133 offset:24576
    v_mfma_f32_16x16x32_bf16 a[52:55], v[20:23], v[36:39], a[52:55]
    ds_read_b64_tr_b16 v[88:89], v134 offset:16384
    v_mfma_f32_16x16x32_bf16 a[56:59], v[24:27], v[36:39], a[56:59]
    ds_read_b64_tr_b16 v[90:91], v134 offset:24576
    v_mfma_f32_16x16x32_bf16 a[60:63], v[28:31], v[36:39], a[60:63]
    ds_read_b64_tr_b16 v[92:93], v135 offset:16384
    buffer_load_dwordx4 v143, s[4:7], s16 offen offset:2048 sc1 lds
    v_mfma_f32_16x16x32_bf16 a[64:67], v[0:3], v[40:43], a[64:67]
    ds_read_b64_tr_b16 v[94:95], v135 offset:24576
    v_mfma_f32_16x16x32_bf16 a[68:71], v[4:7], v[40:43], a[68:71]
    ds_read_b128 v[100:103], v136 offset:17408
    v_mfma_f32_16x16x32_bf16 a[72:75], v[8:11], v[40:43], a[72:75]
    ds_read_b128 v[104:107], v136 offset:18432
    v_mfma_f32_16x16x32_bf16 a[76:79], v[12:15], v[40:43], a[76:79]
    ds_read_b128 v[108:111], v136 offset:19456
    v_mfma_f32_16x16x32_bf16 a[80:83], v[16:19], v[40:43], a[80:83]
    ds_read_b128 v[112:115], v136 offset:20480
    v_mfma_f32_16x16x32_bf16 a[84:87], v[20:23], v[40:43], a[84:87]
    ds_read_b128 v[116:119], v136 offset:21504
    buffer_load_dwordx4 v144, s[4:7], s16 offen offset:3072 sc1 lds
    v_mfma_f32_16x16x32_bf16 a[88:91], v[24:27], v[40:43], a[88:91]
    ds_read_b128 v[120:123], v136 offset:22528
    v_mfma_f32_16x16x32_bf16 a[92:95], v[28:31], v[40:43], a[92:95]
    ds_read_b128 v[124:127], v136 offset:23552
    v_mfma_f32_16x16x32_bf16 a[96:99], v[0:3], v[44:47], a[96:99]
    v_mfma_f32_16x16x32_bf16 a[100:103], v[4:7], v[44:47], a[100:103]
    v_mfma_f32_16x16x32_bf16 a[104:107], v[8:11], v[44:47], a[104:107]
    s_add_u32 s16, s16, 1024
    v_mfma_f32_16x16x32_bf16 a[108:111], v[12:15], v[44:47], a[108:111]
    v_mfma_f32_16x16x32_bf16 a[112:115], v[16:19], v[44:47], a[112:115]
    v_mfma_f32_16x16x32_bf16 a[116:119], v[20:23], v[44:47], a[116:119]
    v_mfma_f32_16x16x32_bf16 a[120:123], v[24:27], v[44:47], a[120:123]
    v_mfma_f32_16x16x32_bf16 a[124:127], v[28:31], v[44:47], a[124:127]
    s_add_u32 m0, s19, 0
    s_nop 0
    v_mfma_f32_16x16x32_bf16 a[128:131], v[0:3], v[48:51], a[128:131]
    v_mfma_f32_16x16x32_bf16 a[132:135], v[4:7], v[48:51], a[132:135]
    v_mfma_f32_16x16x32_bf16 a[136:139], v[8:11], v[48:51], a[136:139]
    v_mfma_f32_16x16x32_bf16 a[140:143], v[12:15], v[48:51], a[140:143]
    v_mfma_f32_16x16x32_bf16 a[144:147], v[16:19], v[48:51], a[144:147]
    buffer_load_dwordx4 v137, s[8:11], s15 offen offset:0 lds
    v_mfma_f32_16x16x32_bf16 a[148:151], v[20:23], v[48:51], a[148:151]
    v_mfma_f32_16x16x32_bf16 a[152:155], v[24:27], v[48:51], a[152:155]
    v_mfma_f32_16x16x32_bf16 a[156:159], v[28:31], v[48:51], a[156:159]
    v_mfma_f32_16x16x32_bf16 a[160:163], v[0:3], v[52:55], a[160:163]
    v_mfma_f32_16x16x32_bf16 a[164:167], v[4:7], v[52:55], a[164:167]
    v_mfma_f32_16x16x32_bf16 a[168:171], v[8:11], v[52:55], a[168:171]
    buffer_load_dwordx4 v138, s[8:11], s15 offen offset:1024 lds
    v_mfma_f32_16x16x32_bf16 a[172:175], v[12:15], v[52:55], a[172:175]
    v_mfma_f32_16x16x32_bf16 a[176:179], v[16:19], v[52:55], a[176:179]
    v_mfma_f32_16x16x32_bf16 a[180:183], v[20:23], v[52:55], a[180:183]
    v_mfma_f32_16x16x32_bf16 a[184:187], v[24:27], v[52:55], a[184:187]
    v_mfma_f32_16x16x32_bf16 a[188:191], v[28:31], v[52:55], a[188:191]
    buffer_load_dwordx4 v139, s[8:11], s15 offen offset:2048 lds
    v_mfma_f32_16x16x32_bf16 a[192:195], v[0:3], v[56:59], a[192:195]
    v_mfma_f32_16x16x32_bf16 a[196:199], v[4:7], v[56:59], a[196:199]
    v_mfma_f32_16x16x32_bf16 a[200:203], v[8:11], v[56:59], a[200:203]
    v_mfma_f32_16x16x32_bf16 a[204:207], v[12:15], v[56:59], a[204:207]
    v_mfma_f32_16x16x32_bf16 a[208:211], v[16:19], v[56:59], a[208:211]
    buffer_load_dwordx4 v140, s[8:11], s15 offen offset:3072 lds
    v_mfma_f32_16x16x32_bf16 a[212:215], v[20:23], v[56:59], a[212:215]
    v_mfma_f32_16x16x32_bf16 a[216:219], v[24:27], v[56:59], a[216:219]
    v_mfma_f32_16x16x32_bf16 a[220:223], v[28:31], v[56:59], a[220:223]
    v_mfma_f32_16x16x32_bf16 a[224:227], v[0:3], v[60:63], a[224:227]
    v_mfma_f32_16x16x32_bf16 a[228:231], v[4:7], v[60:63], a[228:231]
    s_add_u32 s15, s15, s17
    v_mfma_f32_16x16x32_bf16 a[232:235], v[8:11], v[60:63], a[232:235]
    v_mfma_f32_16x16x32_bf16 a[236:239], v[12:15], v[60:63], a[236:239]
    v_mfma_f32_16x16x32_bf16 a[240:243], v[16:19], v[60:63], a[240:243]
    v_mfma_f32_16x16x32_bf16 a[244:247], v[20:23], v[60:63], a[244:247]
    v_mfma_f32_16x16x32_bf16 a[248:251], v[24:27], v[60:63], a[248:251]
    v_mfma_f32_16x16x32_bf16 a[252:255], v[28:31], v[60:63], a[252:255]
    s_waitcnt lgkmcnt(0)
    v_mfma_f32_16x16x32_bf16 a[0:3], v[64:67], v[96:99], a[0:3]
    s_waitcnt vmcnt(16)
    s_barrier
    ds_read_b128 v[32:35], v136 offset:32768
    s_add_u32 m0, s20, 16384
    s_nop 0
    v_mfma_f32_16x16x32_bf16 a[4:7], v[68:71], v[96:99], a[4:7]
    ds_read_b64_tr_b16 v[0:1], v128 offset:32768
    v_mfma_f32_16x16x32_bf16 a[8:11], v[72:75], v[96:99], a[8:11]
    ds_read_b64_tr_b16 v[2:3], v128 offset:40960
    v_mfma_f32_16x16x32_bf16 a[12:15], v[76:79], v[96:99], a[12:15]
    ds_read_b64_tr_b16 v[4:5], v129 offset:32768
    v_mfma_f32_16x16x32_bf16 a[16:19], v[80:83], v[96:99], a[16:19]
    ds_read_b64_tr_b16 v[6:7], v129 offset:40960
    v_mfma_f32_16x16x32_bf16 a[20:23], v[84:87], v[96:99], a[20:23]
    ds_read_b64_tr_b16 v[8:9], v130 offset:32768
    buffer_load_dwordx4 v141, s[4:7], s16 offen offset:0 sc1 lds
    v_mfma_f32_16x16x32_bf16 a[24:27], v[88:91], v[96:99], a[24:27]
    ds_read_b64_tr_b16 v[10:11], v130 offset:40960
    v_mfma_f32_16x16x32_bf16 a[28:31], v[92:95], v[96:99], a[28:31]
    ds_read_b64_tr_b16 v[12:13], v131 offset:32768
    v_mfma_f32_16x16x32_bf16 a[32:35], v[64:67], v[100:103], a[32:35]
    ds_read_b64_tr_b16 v[14:15], v131 offset:40960
    v_mfma_f32_16x16x32_bf16 a[36:39], v[68:71], v[100:103], a[36:39]
    ds_read_b64_tr_b16 v[16:17], v132 offset:32768
    v_mfma_f32_16x16x32_bf16 a[40:43], v[72:75], v[100:103], a[40:43]
    ds_read_b64_tr_b16 v[18:19], v132 offset:40960
    buffer_load_dwordx4 v142, s[4:7], s16 offen offset:1024 sc1 lds
    v_mfma_f32_16x16x32_bf16 a[44:47], v[76:79], v[100:103], a[44:47]
    ds_read_b64_tr_b16 v[20:21], v133 offset:32768
    v_mfma_f32_16x16x32_bf16 a[48:51], v[80:83], v[100:103], a[48:51]
    ds_read_b64_tr_b16 v[22:23], v133 offset:40960
    v_mfma_f32_16x16x32_bf16 a[52:55], v[84:87], v[100:103], a[52:55]
    ds_read_b64_tr_b16 v[24:25], v134 offset:32768
    v_mfma_f32_16x16x32_bf16 a[56:59], v[88:91], v[100:103], a[56:59]
    ds_read_b64_tr_b16 v[26:27], v134 offset:40960
    v_mfma_f32_16x16x32_bf16 a[60:63], v[92:95], v[100:103], a[60:63]
    ds_read_b64_tr_b16 v[28:29], v135 offset:32768
    buffer_load_dwordx4 v143, s[4:7], s16 offen offset:2048 sc1 lds
    v_mfma_f32_16x16x32_bf16 a[64:67], v[64:67], v[104:107], a[64:67]
    ds_read_b64_tr_b16 v[30:31], v135 offset:40960
    v_mfma_f32_16x16x32_bf16 a[68:71], v[68:71], v[104:107], a[68:71]
    ds_read_b128 v[36:39], v136 offset:33792
    v_mfma_f32_16x16x32_bf16 a[72:75], v[72:75], v[104:107], a[72:75]
    ds_read_b128 v[40:43], v136 offset:34816
    v_mfma_f32_16x16x32_bf16 a[76:79], v[76:79], v[104:107], a[76:79]
    ds_read_b128 v[44:47], v136 offset:35840
    v_mfma_f32_16x16x32_bf16 a[80:83], v[80:83], v[104:107], a[80:83]
    ds_read_b128 v[48:51], v136 offset:36864
    v_mfma_f32_16x16x32_bf16 a[84:87], v[84:87], v[104:107], a[84:87]
    ds_read_b128 v[52:55], v136 offset:37888
    buffer_load_dwordx4 v144, s[4:7], s16 offen offset:3072 sc1 lds
    v_mfma_f32_16x16x32_bf16 a[88:91], v[88:91], v[104:107], a[88:91]
    ds_read_b128 v[56:59], v136 offset:38912
    v_mfma_f32_16x16x32_bf16 a[92:95], v[92:95], v[104:107], a[92:95]
    ds_read_b128 v[60:63], v136 offset:39936
    v_mfma_f32_16x16x32_bf16 a[96:99], v[64:67], v[108:111], a[96:99]
    v_mfma_f32_16x16x32_bf16 a[100:103], v[68:71], v[108:111], a[100:103]
    v_mfma_f32_16x16x32_bf16 a[104:107], v[72:75], v[108:111], a[104:107]
    s_add_u32 s16, s16, 1024
    v_mfma_f32_16x16x32_bf16 a[108:111], v[76:79], v[108:111], a[108:111]
    v_mfma_f32_16x16x32_bf16 a[112:115], v[80:83], v[108:111], a[112:115]
    v_mfma_f32_16x16x32_bf16 a[116:119], v[84:87], v[108:111], a[116:119]
    v_mfma_f32_16x16x32_bf16 a[120:123], v[88:91], v[108:111], a[120:123]
    v_mfma_f32_16x16x32_bf16 a[124:127], v[92:95], v[108:111], a[124:127]
    s_add_u32 m0, s19, 16384
    s_nop 0
    v_mfma_f32_16x16x32_bf16 a[128:131], v[64:67], v[112:115], a[128:131]
    v_mfma_f32_16x16x32_bf16 a[132:135], v[68:71], v[112:115], a[132:135]
    v_mfma_f32_16x16x32_bf16 a[136:139], v[72:75], v[112:115], a[136:139]
    v_mfma_f32_16x16x32_bf16 a[140:143], v[76:79], v[112:115], a[140:143]
    v_mfma_f32_16x16x32_bf16 a[144:147], v[80:83], v[112:115], a[144:147]
    buffer_load_dwordx4 v137, s[8:11], s15 offen offset:0 lds
    v_mfma_f32_16x16x32_bf16 a[148:151], v[84:87], v[112:115], a[148:151]
    v_mfma_f32_16x16x32_bf16 a[152:155], v[88:91], v[112:115], a[152:155]
    v_mfma_f32_16x16x32_bf16 a[156:159], v[92:95], v[112:115], a[156:159]
    v_mfma_f32_16x16x32_bf16 a[160:163], v[64:67], v[116:119], a[160:163]
    v_mfma_f32_16x16x32_bf16 a[164:167], v[68:71], v[116:119], a[164:167]
    v_mfma_f32_16x16x32_bf16 a[168:171], v[72:75], v[116:119], a[168:171]
    buffer_load_dwordx4 v138, s[8:11], s15 offen offset:1024 lds
    v_mfma_f32_16x16x32_bf16 a[172:175], v[76:79], v[116:119], a[172:175]
    v_mfma_f32_16x16x32_bf16 a[176:179], v[80:83], v[116:119], a[176:179]
    v_mfma_f32_16x16x32_bf16 a[180:183], v[84:87], v[116:119], a[180:183]
    v_mfma_f32_16x16x32_bf16 a[184:187], v[88:91], v[116:119], a[184:187]
    v_mfma_f32_16x16x32_bf16 a[188:191], v[92:95], v[116:119], a[188:191]
    buffer_load_dwordx4 v139, s[8:11], s15 offen offset:2048 lds
    v_mfma_f32_16x16x32_bf16 a[192:195], v[64:67], v[120:123], a[192:195]
    v_mfma_f32_16x16x32_bf16 a[196:199], v[68:71], v[120:123], a[196:199]
    v_mfma_f32_16x16x32_bf16 a[200:203], v[72:75], v[120:123], a[200:203]
    v_mfma_f32_16x16x32_bf16 a[204:207], v[76:79], v[120:123], a[204:207]
    v_mfma_f32_16x16x32_bf16 a[208:211], v[80:83], v[120:123], a[208:211]
    buffer_load_dwordx4 v140, s[8:11], s15 offen offset:3072 lds
    v_mfma_f32_16x16x32_bf16 a[212:215], v[84:87], v[120:123], a[212:215]
    v_mfma_f32_16x16x32_bf16 a[216:219], v[88:91], v[120:123], a[216:219]
    v_mfma_f32_16x16x32_bf16 a[220:223], v[92:95], v[120:123], a[220:223]
    v_mfma_f32_16x16x32_bf16 a[224:227], v[64:67], v[124:127], a[224:227]
    v_mfma_f32_16x16x32_bf16 a[228:231], v[68:71], v[124:127], a[228:231]
    s_add_u32 s15, s15, s17
    v_mfma_f32_16x16x32_bf16 a[232:235], v[72:75], v[124:127], a[232:235]
    v_mfma_f32_16x16x32_bf16 a[236:239], v[76:79], v[124:127], a[236:239]
    v_mfma_f32_16x16x32_bf16 a[240:243], v[80:83], v[124:127], a[240:243]
    v_mfma_f32_16x16x32_bf16 a[244:247], v[84:87], v[124:127], a[244:247]
    v_mfma_f32_16x16x32_bf16 a[248:251], v[88:91], v[124:127], a[248:251]
    v_mfma_f32_16x16x32_bf16 a[252:255], v[92:95], v[124:127], a[252:255]
    s_waitcnt lgkmcnt(0)
    v_mfma_f32_16x16x32_bf16 a[0:3], v[0:3], v[32:35], a[0:3]
    s_waitcnt vmcnt(16)
    s_barrier
    ds_read_b128 v[96:99], v136 offset:49152
    s_add_u32 m0, s20, 32768
    s_nop 0
    v_mfma_f32_16x16x32_bf16 a[4:7], v[4:7], v[32:35], a[4:7]
    ds_read_b64_tr_b16 v[64:65], v128 offset:49152
    v_mfma_f32_16x16x32_bf16 a[8:11], v[8:11], v[32:35], a[8:11]
    ds_read_b64_tr_b16 v[66:67], v128 offset:57344
    v_mfma_f32_16x16x32_bf16 a[12:15], v[12:15], v[32:35], a[12:15]
    ds_read_b64_tr_b16 v[68:69], v129 offset:49152
    v_mfma_f32_16x16x32_bf16 a[16:19], v[16:19], v[32:35], a[16:19]
    ds_read_b64_tr_b16 v[70:71], v129 offset:57344
    v_mfma_f32_16x16x32_bf16 a[20:23], v[20:23], v[32:35], a[20:23]
    ds_read_b64_tr_b16 v[72:73], v130 offset:49152
    buffer_load_dwordx4 v141, s[4:7], s16 offen offset:0 sc1 lds
    v_mfma_f32_16x16x32_bf16 a[24:27], v[24:27], v[32:35], a[24:27]
    ds_read_b64_tr_b16 v[74:75], v130 offset:57344
    v_mfma_f32_16x16x32_bf16 a[28:31], v[28:31], v[32:35], a[28:31]
    ds_read_b64_tr_b16 v[76:77], v131 offset:49152
    v_mfma_f32_16x16x32_bf16 a[32:35], v[0:3], v[36:39], a[32:35]
    ds_read_b64_tr_b16 v[78:79], v131 offset:57344
    v_mfma_f32_16x16x32_bf16 a[36:39], v[4:7], v[36:39], a[36:39]
    ds_read_b64_tr_b16 v[80:81], v132 offset:49152
    v_mfma_f32_16x16x32_bf16 a[40:43], v[8:11], v[36:39], a[40:43]
    ds_read_b64_tr_b16 v[82:83], v132 offset:57344
    buffer_load_dwordx4 v142, s[4:7], s16 offen offset:1024 sc1 lds
    v_mfma_f32_16x16x32_bf16 a[44:47], v[12:15], v[36:39], a[44:47]
    ds_read_b64_tr_b16 v[84:85], v133 offset:49152
    v_mfma_f32_16x16x32_bf16 a[48:51], v[16:19], v[36:39], a[48:51]
    ds_read_b64_tr_b16 v[86:87], v133 offset:57344
    v_mfma_f32_16x16x32_bf16 a[52:55], v[20:23], v[36:39], a[52:55]
    ds_read_b64_tr_b16 v[88:89], v134 offset:49152
    v_mfma_f32_16x16x32_bf16 a[56:59], v[24:27], v[36:39], a[56:59]
    ds_read_b64_tr_b16 v[90:91], v134 offset:57344
    v_mfma_f32_16x16x32_bf16 a[60:63], v[28:31], v[36:39], a[60:63]
    ds_read_b64_tr_b16 v[92:93], v135 offset:49152
    buffer_load_dwordx4 v143, s[4:7], s16 offen offset:2048 sc1 lds
    v_mfma_f32_16x16x32_bf16 a[64:67], v[0:3], v[40:43], a[64:67]
    ds_read_b64_tr_b16 v[94:95], v135 offset:57344
    v_mfma_f32_16x16x32_bf16 a[68:71], v[4:7], v[40:43], a[68:71]
    ds_read_b128 v[100:103], v136 offset:50176
    v_mfma_f32_16x16x32_bf16 a[72:75], v[8:11], v[40:43], a[72:75]
    ds_read_b128 v[104:107], v136 offset:51200
    v_mfma_f32_16x16x32_bf16 a[76:79], v[12:15], v[40:43], a[76:79]
    ds_read_b128 v[108:111], v136 offset:52224
    v_mfma_f32_16x16x32_bf16 a[80:83], v[16:19], v[40:43], a[80:83]
    ds_read_b128 v[112:115], v136 offset:53248
    v_mfma_f32_16x16x32_bf16 a[84:87], v[20:23], v[40:43], a[84:87]
    ds_read_b128 v[116:119], v136 offset:54272
    buffer_load_dwordx4 v144, s[4:7], s16 offen offset:3072 sc1 lds
    v_mfma_f32_16x16x32_bf16 a[88:91], v[24:27], v[40:43], a[88:91]
    ds_read_b128 v[120:123], v136 offset:55296
    v_mfma_f32_16x16x32_bf16 a[92:95], v[28:31], v[40:43], a[92:95]
    ds_read_b128 v[124:127], v136 offset:56320
    v_mfma_f32_16x16x32_bf16 a[96:99], v[0:3], v[44:47], a[96:99]
    v_mfma_f32_16x16x32_bf16 a[100:103], v[4:7], v[44:47], a[100:103]
    v_mfma_f32_16x16x32_bf16 a[104:107], v[8:11], v[44:47], a[104:107]
    s_add_u32 s16, s16, 1024
    v_mfma_f32_16x16x32_bf16 a[108:111], v[12:15], v[44:47], a[108:111]
    v_mfma_f32_16x16x32_bf16 a[112:115], v[16:19], v[44:47], a[112:115]
    v_mfma_f32_16x16x32_bf16 a[116:119], v[20:23], v[44:47], a[116:119]
    v_mfma_f32_16x16x32_bf16 a[120:123], v[24:27], v[44:47], a[120:123]
    v_mfma_f32_16x16x32_bf16 a[124:127], v[28:31], v[44:47], a[124:127]
    s_add_u32 m0, s19, 32768
    s_nop 0
    v_mfma_f32_16x16x32_bf16 a[128:131], v[0:3], v[48:51], a[128:131]
    v_mfma_f32_16x16x32_bf16 a[132:135], v[4:7], v[48:51], a[132:135]
    v_mfma_f32_16x16x32_bf16 a[136:139], v[8:11], v[48:51], a[136:139]
    v_mfma_f32_16x16x32_bf16 a[140:143], v[12:15], v[48:51], a[140:143]
    v_mfma_f32_16x16x32_bf16 a[144:147], v[16:19], v[48:51], a[144:147]
    buffer_load_dwordx4 v137, s[8:11], s15 offen offset:0 lds
    v_mfma_f32_16x16x32_bf16 a[148:151], v[20:23], v[48:51], a[148:151]
    v_mfma_f32_16x16x32_bf16 a[152:155], v[24:27], v[48:51], a[152:155]
    v_mfma_f32_16x16x32_bf16 a[156:159], v[28:31], v[48:51], a[156:159]
    v_mfma_f32_16x16x32_bf16 a[160:163], v[0:3], v[52:55], a[160:163]
    v_mfma_f32_16x16x32_bf16 a[164:167], v[4:7], v[52:55], a[164:167]
    v_mfma_f32_16x16x32_bf16 a[168:171], v[8:11], v[52:55], a[168:171]
    buffer_load_dwordx4 v138, s[8:11], s15 offen offset:1024 lds
    v_mfma_f32_16x16x32_bf16 a[172:175], v[12:15], v[52:55], a[172:175]
    v_mfma_f32_16x16x32_bf16 a[176:179], v[16:19], v[52:55], a[176:179]
    v_mfma_f32_16x16x32_bf16 a[180:183], v[20:23], v[52:55], a[180:183]
    v_mfma_f32_16x16x32_bf16 a[184:187], v[24:27], v[52:55], a[184:187]
    v_mfma_f32_16x16x32_bf16 a[188:191], v[28:31], v[52:55], a[188:191]
    buffer_load_dwordx4 v139, s[8:11], s15 offen offset:2048 lds
    v_mfma_f32_16x16x32_bf16 a[192:195], v[0:3], v[56:59], a[192:195]
    v_mfma_f32_16x16x32_bf16 a[196:199], v[4:7], v[56:59], a[196:199]
    v_mfma_f32_16x16x32_bf16 a[200:203], v[8:11], v[56:59], a[200:203]
    v_mfma_f32_16x16x32_bf16 a[204:207], v[12:15], v[56:59], a[204:207]
    v_mfma_f32_16x16x32_bf16 a[208:211], v[16:19], v[56:59], a[208:211]
    buffer_load_dwordx4 v140, s[8:11], s15 offen offset:3072 lds
    v_mfma_f32_16x16x32_bf16 a[212:215], v[20:23], v[56:59], a[212:215]
    v_mfma_f32_16x16x32_bf16 a[216:219], v[24:27], v[56:59], a[216:219]
    v_mfma_f32_16x16x32_bf16 a[220:223], v[28:31], v[56:59], a[220:223]
    v_mfma_f32_16x16x32_bf16 a[224:227], v[0:3], v[60:63], a[224:227]
    v_mfma_f32_16x16x32_bf16 a[228:231], v[4:7], v[60:63], a[228:231]
    s_add_u32 s15, s15, s17
    v_mfma_f32_16x16x32_bf16 a[232:235], v[8:11], v[60:63], a[232:235]
    v_mfma_f32_16x16x32_bf16 a[236:239], v[12:15], v[60:63], a[236:239]
    v_mfma_f32_16x16x32_bf16 a[240:243], v[16:19], v[60:63], a[240:243]
    v_mfma_f32_16x16x32_bf16 a[244:247], v[20:23], v[60:63], a[244:247]
    v_mfma_f32_16x16x32_bf16 a[248:251], v[24:27], v[60:63], a[248:251]
    v_mfma_f32_16x16x32_bf16 a[252:255], v[28:31], v[60:63], a[252:255]
    s_waitcnt lgkmcnt(0)
    v_mfma_f32_16x16x32_bf16 a[0:3], v[64:67], v[96:99], a[0:3]
    s_waitcnt vmcnt(16)
    s_barrier
    ds_read_b128 v[32:35], v136 offset:0
    s_add_u32 m0, s20, 49152
    s_nop 0
    v_mfma_f32_16x16x32_bf16 a[4:7], v[68:71], v[96:99], a[4:7]
    ds_read_b64_tr_b16 v[0:1], v128 offset:0
    v_mfma_f32_16x16x32_bf16 a[8:11], v[72:75], v[96:99], a[8:11]
    ds_read_b64_tr_b16 v[2:3], v128 offset:8192
    v_mfma_f32_16x16x32_bf16 a[12:15], v[76:79], v[96:99], a[12:15]
    ds_read_b64_tr_b16 v[4:5], v129 offset:0
    v_mfma_f32_16x16x32_bf16 a[16:19], v[80:83], v[96:99], a[16:19]
    ds_read_b64_tr_b16 v[6:7], v129 offset:8192
    v_mfma_f32_16x16x32_bf16 a[20:23], v[84:87], v[96:99], a[20:23]
    ds_read_b64_tr_b16 v[8:9], v130 offset:0
    buffer_load_dwordx4 v141, s[4:7], s16 offen offset:0 sc1 lds
    v_mfma_f32_16x16x32_bf16 a[24:27], v[88:91], v[96:99], a[24:27]
    ds_read_b64_tr_b16 v[10:11], v130 offset:8192
    v_mfma_f32_16x16x32_bf16 a[28:31], v[92:95], v[96:99], a[28:31]
    ds_read_b64_tr_b16 v[12:13], v131 offset:0
    v_mfma_f32_16x16x32_bf16 a[32:35], v[64:67], v[100:103], a[32:35]
    ds_read_b64_tr_b16 v[14:15], v131 offset:8192
    v_mfma_f32_16x16x32_bf16 a[36:39], v[68:71], v[100:103], a[36:39]
    ds_read_b64_tr_b16 v[16:17], v132 offset:0
    v_mfma_f32_16x16x32_bf16 a[40:43], v[72:75], v[100:103], a[40:43]
    ds_read_b64_tr_b16 v[18:19], v132 offset:8192
    buffer_load_dwordx4 v142, s[4:7], s16 offen offset:1024 sc1 lds
    v_mfma_f32_16x16x32_bf16 a[44:47], v[76:79], v[100:103], a[44:47]
    ds_read_b64_tr_b16 v[20:21], v133 offset:0
    v_mfma_f32_16x16x32_bf16 a[48:51], v[80:83], v[100:103], a[48:51]
    ds_read_b64_tr_b16 v[22:23], v133 offset:8192
    v_mfma_f32_16x16x32_bf16 a[52:55], v[84:87], v[100:103], a[52:55]
    ds_read_b64_tr_b16 v[24:25], v134 offset:0
    v_mfma_f32_16x16x32_bf16 a[56:59], v[88:91], v[100:103], a[56:59]
    ds_read_b64_tr_b16 v[26:27], v134 offset:8192
    v_mfma_f32_16x16x32_bf16 a[60:63], v[92:95], v[100:103], a[60:63]
    ds_read_b64_tr_b16 v[28:29], v135 offset:0
    buffer_load_dwordx4 v143, s[4:7], s16 offen offset:2048 sc1 lds
    v_mfma_f32_16x16x32_bf16 a[64:67], v[64:67], v[104:107], a[64:67]
    ds_read_b64_tr_b16 v[30:31], v135 offset:8192
    v_mfma_f32_16x16x32_bf16 a[68:71], v[68:71], v[104:107], a[68:71]
    ds_read_b128 v[36:39], v136 offset:1024
    v_mfma_f32_16x16x32_bf16 a[72:75], v[72:75], v[104:107], a[72:75]
    ds_read_b128 v[40:43], v136 offset:2048
    v_mfma_f32_16x16x32_bf16 a[76:79], v[76:79], v[104:107], a[76:79]
    ds_read_b128 v[44:47], v136 offset:3072
    v_mfma_f32_16x16x32_bf16 a[80:83], v[80:83], v[104:107], a[80:83]
    ds_read_b128 v[48:51], v136 offset:4096
    v_mfma_f32_16x16x32_bf16 a[84:87], v[84:87], v[104:107], a[84:87]
    ds_read_b128 v[52:55], v136 offset:5120
    buffer_load_dwordx4 v144, s[4:7], s16 offen offset:3072 sc1 lds
    v_mfma_f32_16x16x32_bf16 a[88:91], v[88:91], v[104:107], a[88:91]
    ds_read_b128 v[56:59], v136 offset:6144
    v_mfma_f32_16x16x32_bf16 a[92:95], v[92:95], v[104:107], a[92:95]
    ds_read_b128 v[60:63], v136 offset:7168
    v_mfma_f32_16x16x32_bf16 a[96:99], v[64:67], v[108:111], a[96:99]
    v_mfma_f32_16x16x32_bf16 a[100:103], v[68:71], v[108:111], a[100:103]
    v_mfma_f32_16x16x32_bf16 a[104:107], v[72:75], v[108:111], a[104:107]
    s_add_u32 s16, s16, 1024
    v_mfma_f32_16x16x32_bf16 a[108:111], v[76:79], v[108:111], a[108:111]
    v_mfma_f32_16x16x32_bf16 a[112:115], v[80:83], v[108:111], a[112:115]
    v_mfma_f32_16x16x32_bf16 a[116:119], v[84:87], v[108:111], a[116:119]
    v_mfma_f32_16x16x32_bf16 a[120:123], v[88:91], v[108:111], a[120:123]
    v_mfma_f32_16x16x32_bf16 a[124:127], v[92:95], v[108:111], a[124:127]
    s_add_u32 m0, s19, 49152
    s_nop 0
    v_mfma_f32_16x16x32_bf16 a[128:131], v[64:67], v[112:115], a[128:131]
    v_mfma_f32_16x16x32_bf16 a[132:135], v[68:71], v[112:115], a[132:135]
    v_mfma_f32_16x16x32_bf16 a[136:139], v[72:75], v[112:115], a[136:139]
    v_mfma_f32_16x16x32_bf16 a[140:143], v[76:79], v[112:115], a[140:143]
    v_mfma_f32_16x16x32_bf16 a[144:147], v[80:83], v[112:115], a[144:147]
    buffer_load_dwordx4 v137, s[8:11], s15 offen offset:0 lds
    v_mfma_f32_16x16x32_bf16 a[148:151], v[84:87], v[112:115], a[148:151]
    v_mfma_f32_16x16x32_bf16 a[152:155], v[88:91], v[112:115], a[152:155]
    v_mfma_f32_16x16x32_bf16 a[156:159], v[92:95], v[112:115], a[156:159]
    v_mfma_f32_16x16x32_bf16 a[160:163], v[64:67], v[116:119], a[160:163]
    v_mfma_f32_16x16x32_bf16 a[164:167], v[68:71], v[116:119], a[164:167]
    v_mfma_f32_16x16x32_bf16 a[168:171], v[72:75], v[116:119], a[168:171]
    buffer_load_dwordx4 v138, s[8:11], s15 offen offset:1024 lds
    v_mfma_f32_16x16x32_bf16 a[172:175], v[76:79], v[116:119], a[172:175]
    v_mfma_f32_16x16x32_bf16 a[176:179], v[80:83], v[116:119], a[176:179]
    v_mfma_f32_16x16x32_bf16 a[180:183], v[84:87], v[116:119], a[180:183]
    v_mfma_f32_16x16x32_bf16 a[184:187], v[88:91], v[116:119], a[184:187]
    v_mfma_f32_16x16x32_bf16 a[188:191], v[92:95], v[116:119], a[188:191]
    buffer_load_dwordx4 v139, s[8:11], s15 offen offset:2048 lds
    v_mfma_f32_16x16x32_bf16 a[192:195], v[64:67], v[120:123], a[192:195]
    v_mfma_f32_16x16x32_bf16 a[196:199], v[68:71], v[120:123], a[196:199]
    v_mfma_f32_16x16x32_bf16 a[200:203], v[72:75], v[120:123], a[200:203]
    v_mfma_f32_16x16x32_bf16 a[204:207], v[76:79], v[120:123], a[204:207]
    v_mfma_f32_16x16x32_bf16 a[208:211], v[80:83], v[120:123], a[208:211]
    buffer_load_dwordx4 v140, s[8:11], s15 offen offset:3072 lds
    v_mfma_f32_16x16x32_bf16 a[212:215], v[84:87], v[120:123], a[212:215]
    v_mfma_f32_16x16x32_bf16 a[216:219], v[88:91], v[120:123], a[216:219]
    v_mfma_f32_16x16x32_bf16 a[220:223], v[92:95], v[120:123], a[220:223]
    v_mfma_f32_16x16x32_bf16 a[224:227], v[64:67], v[124:127], a[224:227]
    v_mfma_f32_16x16x32_bf16 a[228:231], v[68:71], v[124:127], a[228:231]
    s_add_u32 s15, s15, s17
    v_mfma_f32_16x16x32_bf16 a[232:235], v[72:75], v[124:127], a[232:235]
    v_mfma_f32_16x16x32_bf16 a[236:239], v[76:79], v[124:127], a[236:239]
    v_mfma_f32_16x16x32_bf16 a[240:243], v[80:83], v[124:127], a[240:243]
    v_mfma_f32_16x16x32_bf16 a[244:247], v[84:87], v[124:127], a[244:247]
    v_mfma_f32_16x16x32_bf16 a[248:251], v[88:91], v[124:127], a[248:251]
    v_mfma_f32_16x16x32_bf16 a[252:255], v[92:95], v[124:127], a[252:255]
    s_sub_u32 s18, s18, 1
    s_cmp_lg_u32 s18, 0
    s_cbranch_scc1 main_kernel_w_c2_n_loop
    s_cmp_lg_u32 s14, 0
    s_cbranch_scc1 main_kernel_w_c2_n_nt
    s_lshl_b32 s32, s27, 8
    s_add_u32 s32, s32, 0x841e000
    v_mov_b32 v255, 1
    s_mov_b64 exec, 1
    buffer_atomic_add v255, off, s[4:7], s32 sc0 sc1
    s_mov_b64 exec, -1
main_kernel_w_c2_n_nt:
    s_waitcnt lgkmcnt(0)
    v_mfma_f32_16x16x32_bf16 a[0:3], v[0:3], v[32:35], a[0:3]
    s_waitcnt vmcnt(16)
    s_barrier
    ds_read_b128 v[96:99], v136 offset:16384
    v_mfma_f32_16x16x32_bf16 a[4:7], v[4:7], v[32:35], a[4:7]
    ds_read_b64_tr_b16 v[64:65], v128 offset:16384
    v_mfma_f32_16x16x32_bf16 a[8:11], v[8:11], v[32:35], a[8:11]
    ds_read_b64_tr_b16 v[66:67], v128 offset:24576
    v_mfma_f32_16x16x32_bf16 a[12:15], v[12:15], v[32:35], a[12:15]
    ds_read_b64_tr_b16 v[68:69], v129 offset:16384
    v_mfma_f32_16x16x32_bf16 a[16:19], v[16:19], v[32:35], a[16:19]
    ds_read_b64_tr_b16 v[70:71], v129 offset:24576
    v_mfma_f32_16x16x32_bf16 a[20:23], v[20:23], v[32:35], a[20:23]
    ds_read_b64_tr_b16 v[72:73], v130 offset:16384
    v_mfma_f32_16x16x32_bf16 a[24:27], v[24:27], v[32:35], a[24:27]
    ds_read_b64_tr_b16 v[74:75], v130 offset:24576
    v_mfma_f32_16x16x32_bf16 a[28:31], v[28:31], v[32:35], a[28:31]
    ds_read_b64_tr_b16 v[76:77], v131 offset:16384
    v_mfma_f32_16x16x32_bf16 a[32:35], v[0:3], v[36:39], a[32:35]
    ds_read_b64_tr_b16 v[78:79], v131 offset:24576
    v_mfma_f32_16x16x32_bf16 a[36:39], v[4:7], v[36:39], a[36:39]
    ds_read_b64_tr_b16 v[80:81], v132 offset:16384
    v_mfma_f32_16x16x32_bf16 a[40:43], v[8:11], v[36:39], a[40:43]
    ds_read_b64_tr_b16 v[82:83], v132 offset:24576
    v_mfma_f32_16x16x32_bf16 a[44:47], v[12:15], v[36:39], a[44:47]
    ds_read_b64_tr_b16 v[84:85], v133 offset:16384
    v_mfma_f32_16x16x32_bf16 a[48:51], v[16:19], v[36:39], a[48:51]
    ds_read_b64_tr_b16 v[86:87], v133 offset:24576
    v_mfma_f32_16x16x32_bf16 a[52:55], v[20:23], v[36:39], a[52:55]
    ds_read_b64_tr_b16 v[88:89], v134 offset:16384
    v_mfma_f32_16x16x32_bf16 a[56:59], v[24:27], v[36:39], a[56:59]
    ds_read_b64_tr_b16 v[90:91], v134 offset:24576
    v_mfma_f32_16x16x32_bf16 a[60:63], v[28:31], v[36:39], a[60:63]
    ds_read_b64_tr_b16 v[92:93], v135 offset:16384
    v_mfma_f32_16x16x32_bf16 a[64:67], v[0:3], v[40:43], a[64:67]
    ds_read_b64_tr_b16 v[94:95], v135 offset:24576
    v_mfma_f32_16x16x32_bf16 a[68:71], v[4:7], v[40:43], a[68:71]
    ds_read_b128 v[100:103], v136 offset:17408
    v_mfma_f32_16x16x32_bf16 a[72:75], v[8:11], v[40:43], a[72:75]
    ds_read_b128 v[104:107], v136 offset:18432
    v_mfma_f32_16x16x32_bf16 a[76:79], v[12:15], v[40:43], a[76:79]
    ds_read_b128 v[108:111], v136 offset:19456
    v_mfma_f32_16x16x32_bf16 a[80:83], v[16:19], v[40:43], a[80:83]
    ds_read_b128 v[112:115], v136 offset:20480
    v_mfma_f32_16x16x32_bf16 a[84:87], v[20:23], v[40:43], a[84:87]
    ds_read_b128 v[116:119], v136 offset:21504
    v_mfma_f32_16x16x32_bf16 a[88:91], v[24:27], v[40:43], a[88:91]
    ds_read_b128 v[120:123], v136 offset:22528
    v_mfma_f32_16x16x32_bf16 a[92:95], v[28:31], v[40:43], a[92:95]
    ds_read_b128 v[124:127], v136 offset:23552
    v_mfma_f32_16x16x32_bf16 a[96:99], v[0:3], v[44:47], a[96:99]
    v_mfma_f32_16x16x32_bf16 a[100:103], v[4:7], v[44:47], a[100:103]
    v_mfma_f32_16x16x32_bf16 a[104:107], v[8:11], v[44:47], a[104:107]
    v_mfma_f32_16x16x32_bf16 a[108:111], v[12:15], v[44:47], a[108:111]
    v_mfma_f32_16x16x32_bf16 a[112:115], v[16:19], v[44:47], a[112:115]
    v_mfma_f32_16x16x32_bf16 a[116:119], v[20:23], v[44:47], a[116:119]
    v_mfma_f32_16x16x32_bf16 a[120:123], v[24:27], v[44:47], a[120:123]
    v_mfma_f32_16x16x32_bf16 a[124:127], v[28:31], v[44:47], a[124:127]
    v_mfma_f32_16x16x32_bf16 a[128:131], v[0:3], v[48:51], a[128:131]
    v_mfma_f32_16x16x32_bf16 a[132:135], v[4:7], v[48:51], a[132:135]
    v_mfma_f32_16x16x32_bf16 a[136:139], v[8:11], v[48:51], a[136:139]
    v_mfma_f32_16x16x32_bf16 a[140:143], v[12:15], v[48:51], a[140:143]
    v_mfma_f32_16x16x32_bf16 a[144:147], v[16:19], v[48:51], a[144:147]
    v_mfma_f32_16x16x32_bf16 a[148:151], v[20:23], v[48:51], a[148:151]
    v_mfma_f32_16x16x32_bf16 a[152:155], v[24:27], v[48:51], a[152:155]
    v_mfma_f32_16x16x32_bf16 a[156:159], v[28:31], v[48:51], a[156:159]
    v_mfma_f32_16x16x32_bf16 a[160:163], v[0:3], v[52:55], a[160:163]
    v_mfma_f32_16x16x32_bf16 a[164:167], v[4:7], v[52:55], a[164:167]
    v_mfma_f32_16x16x32_bf16 a[168:171], v[8:11], v[52:55], a[168:171]
    v_mfma_f32_16x16x32_bf16 a[172:175], v[12:15], v[52:55], a[172:175]
    v_mfma_f32_16x16x32_bf16 a[176:179], v[16:19], v[52:55], a[176:179]
    v_mfma_f32_16x16x32_bf16 a[180:183], v[20:23], v[52:55], a[180:183]
    v_mfma_f32_16x16x32_bf16 a[184:187], v[24:27], v[52:55], a[184:187]
    v_mfma_f32_16x16x32_bf16 a[188:191], v[28:31], v[52:55], a[188:191]
    v_mfma_f32_16x16x32_bf16 a[192:195], v[0:3], v[56:59], a[192:195]
    v_mfma_f32_16x16x32_bf16 a[196:199], v[4:7], v[56:59], a[196:199]
    v_mfma_f32_16x16x32_bf16 a[200:203], v[8:11], v[56:59], a[200:203]
    v_mfma_f32_16x16x32_bf16 a[204:207], v[12:15], v[56:59], a[204:207]
    v_mfma_f32_16x16x32_bf16 a[208:211], v[16:19], v[56:59], a[208:211]
    v_mfma_f32_16x16x32_bf16 a[212:215], v[20:23], v[56:59], a[212:215]
    v_mfma_f32_16x16x32_bf16 a[216:219], v[24:27], v[56:59], a[216:219]
    v_mfma_f32_16x16x32_bf16 a[220:223], v[28:31], v[56:59], a[220:223]
    v_mfma_f32_16x16x32_bf16 a[224:227], v[0:3], v[60:63], a[224:227]
    v_mfma_f32_16x16x32_bf16 a[228:231], v[4:7], v[60:63], a[228:231]
    v_mfma_f32_16x16x32_bf16 a[232:235], v[8:11], v[60:63], a[232:235]
    v_mfma_f32_16x16x32_bf16 a[236:239], v[12:15], v[60:63], a[236:239]
    v_mfma_f32_16x16x32_bf16 a[240:243], v[16:19], v[60:63], a[240:243]
    v_mfma_f32_16x16x32_bf16 a[244:247], v[20:23], v[60:63], a[244:247]
    v_mfma_f32_16x16x32_bf16 a[248:251], v[24:27], v[60:63], a[248:251]
    v_mfma_f32_16x16x32_bf16 a[252:255], v[28:31], v[60:63], a[252:255]
    s_waitcnt lgkmcnt(0)
    v_mfma_f32_16x16x32_bf16 a[0:3], v[64:67], v[96:99], a[0:3]
    s_waitcnt vmcnt(8)
    s_barrier
    ds_read_b128 v[32:35], v136 offset:32768
    v_mfma_f32_16x16x32_bf16 a[4:7], v[68:71], v[96:99], a[4:7]
    ds_read_b64_tr_b16 v[0:1], v128 offset:32768
    v_mfma_f32_16x16x32_bf16 a[8:11], v[72:75], v[96:99], a[8:11]
    ds_read_b64_tr_b16 v[2:3], v128 offset:40960
    v_mfma_f32_16x16x32_bf16 a[12:15], v[76:79], v[96:99], a[12:15]
    ds_read_b64_tr_b16 v[4:5], v129 offset:32768
    v_mfma_f32_16x16x32_bf16 a[16:19], v[80:83], v[96:99], a[16:19]
    ds_read_b64_tr_b16 v[6:7], v129 offset:40960
    v_mfma_f32_16x16x32_bf16 a[20:23], v[84:87], v[96:99], a[20:23]
    ds_read_b64_tr_b16 v[8:9], v130 offset:32768
    v_mfma_f32_16x16x32_bf16 a[24:27], v[88:91], v[96:99], a[24:27]
    ds_read_b64_tr_b16 v[10:11], v130 offset:40960
    v_mfma_f32_16x16x32_bf16 a[28:31], v[92:95], v[96:99], a[28:31]
    ds_read_b64_tr_b16 v[12:13], v131 offset:32768
    v_mfma_f32_16x16x32_bf16 a[32:35], v[64:67], v[100:103], a[32:35]
    ds_read_b64_tr_b16 v[14:15], v131 offset:40960
    v_mfma_f32_16x16x32_bf16 a[36:39], v[68:71], v[100:103], a[36:39]
    ds_read_b64_tr_b16 v[16:17], v132 offset:32768
    v_mfma_f32_16x16x32_bf16 a[40:43], v[72:75], v[100:103], a[40:43]
    ds_read_b64_tr_b16 v[18:19], v132 offset:40960
    v_mfma_f32_16x16x32_bf16 a[44:47], v[76:79], v[100:103], a[44:47]
    ds_read_b64_tr_b16 v[20:21], v133 offset:32768
    v_mfma_f32_16x16x32_bf16 a[48:51], v[80:83], v[100:103], a[48:51]
    ds_read_b64_tr_b16 v[22:23], v133 offset:40960
    v_mfma_f32_16x16x32_bf16 a[52:55], v[84:87], v[100:103], a[52:55]
    ds_read_b64_tr_b16 v[24:25], v134 offset:32768
    v_mfma_f32_16x16x32_bf16 a[56:59], v[88:91], v[100:103], a[56:59]
    ds_read_b64_tr_b16 v[26:27], v134 offset:40960
    v_mfma_f32_16x16x32_bf16 a[60:63], v[92:95], v[100:103], a[60:63]
    ds_read_b64_tr_b16 v[28:29], v135 offset:32768
    v_mfma_f32_16x16x32_bf16 a[64:67], v[64:67], v[104:107], a[64:67]
    ds_read_b64_tr_b16 v[30:31], v135 offset:40960
    v_mfma_f32_16x16x32_bf16 a[68:71], v[68:71], v[104:107], a[68:71]
    ds_read_b128 v[36:39], v136 offset:33792
    v_mfma_f32_16x16x32_bf16 a[72:75], v[72:75], v[104:107], a[72:75]
    ds_read_b128 v[40:43], v136 offset:34816
    v_mfma_f32_16x16x32_bf16 a[76:79], v[76:79], v[104:107], a[76:79]
    ds_read_b128 v[44:47], v136 offset:35840
    v_mfma_f32_16x16x32_bf16 a[80:83], v[80:83], v[104:107], a[80:83]
    ds_read_b128 v[48:51], v136 offset:36864
    v_mfma_f32_16x16x32_bf16 a[84:87], v[84:87], v[104:107], a[84:87]
    ds_read_b128 v[52:55], v136 offset:37888
    v_mfma_f32_16x16x32_bf16 a[88:91], v[88:91], v[104:107], a[88:91]
    ds_read_b128 v[56:59], v136 offset:38912
    v_mfma_f32_16x16x32_bf16 a[92:95], v[92:95], v[104:107], a[92:95]
    ds_read_b128 v[60:63], v136 offset:39936
    v_mfma_f32_16x16x32_bf16 a[96:99], v[64:67], v[108:111], a[96:99]
    v_mfma_f32_16x16x32_bf16 a[100:103], v[68:71], v[108:111], a[100:103]
    v_mfma_f32_16x16x32_bf16 a[104:107], v[72:75], v[108:111], a[104:107]
    v_mfma_f32_16x16x32_bf16 a[108:111], v[76:79], v[108:111], a[108:111]
    v_mfma_f32_16x16x32_bf16 a[112:115], v[80:83], v[108:111], a[112:115]
    v_mfma_f32_16x16x32_bf16 a[116:119], v[84:87], v[108:111], a[116:119]
    v_mfma_f32_16x16x32_bf16 a[120:123], v[88:91], v[108:111], a[120:123]
    v_mfma_f32_16x16x32_bf16 a[124:127], v[92:95], v[108:111], a[124:127]
    v_mfma_f32_16x16x32_bf16 a[128:131], v[64:67], v[112:115], a[128:131]
    v_mfma_f32_16x16x32_bf16 a[132:135], v[68:71], v[112:115], a[132:135]
    v_mfma_f32_16x16x32_bf16 a[136:139], v[72:75], v[112:115], a[136:139]
    v_mfma_f32_16x16x32_bf16 a[140:143], v[76:79], v[112:115], a[140:143]
    v_mfma_f32_16x16x32_bf16 a[144:147], v[80:83], v[112:115], a[144:147]
    v_mfma_f32_16x16x32_bf16 a[148:151], v[84:87], v[112:115], a[148:151]
    v_mfma_f32_16x16x32_bf16 a[152:155], v[88:91], v[112:115], a[152:155]
    v_mfma_f32_16x16x32_bf16 a[156:159], v[92:95], v[112:115], a[156:159]
    v_mfma_f32_16x16x32_bf16 a[160:163], v[64:67], v[116:119], a[160:163]
    v_mfma_f32_16x16x32_bf16 a[164:167], v[68:71], v[116:119], a[164:167]
    v_mfma_f32_16x16x32_bf16 a[168:171], v[72:75], v[116:119], a[168:171]
    v_mfma_f32_16x16x32_bf16 a[172:175], v[76:79], v[116:119], a[172:175]
    v_mfma_f32_16x16x32_bf16 a[176:179], v[80:83], v[116:119], a[176:179]
    v_mfma_f32_16x16x32_bf16 a[180:183], v[84:87], v[116:119], a[180:183]
    v_mfma_f32_16x16x32_bf16 a[184:187], v[88:91], v[116:119], a[184:187]
    v_mfma_f32_16x16x32_bf16 a[188:191], v[92:95], v[116:119], a[188:191]
    v_mfma_f32_16x16x32_bf16 a[192:195], v[64:67], v[120:123], a[192:195]
    v_mfma_f32_16x16x32_bf16 a[196:199], v[68:71], v[120:123], a[196:199]
    v_mfma_f32_16x16x32_bf16 a[200:203], v[72:75], v[120:123], a[200:203]
    v_mfma_f32_16x16x32_bf16 a[204:207], v[76:79], v[120:123], a[204:207]
    v_mfma_f32_16x16x32_bf16 a[208:211], v[80:83], v[120:123], a[208:211]
    v_mfma_f32_16x16x32_bf16 a[212:215], v[84:87], v[120:123], a[212:215]
    v_mfma_f32_16x16x32_bf16 a[216:219], v[88:91], v[120:123], a[216:219]
    v_mfma_f32_16x16x32_bf16 a[220:223], v[92:95], v[120:123], a[220:223]
    v_mfma_f32_16x16x32_bf16 a[224:227], v[64:67], v[124:127], a[224:227]
    v_mfma_f32_16x16x32_bf16 a[228:231], v[68:71], v[124:127], a[228:231]
    v_mfma_f32_16x16x32_bf16 a[232:235], v[72:75], v[124:127], a[232:235]
    v_mfma_f32_16x16x32_bf16 a[236:239], v[76:79], v[124:127], a[236:239]
    v_mfma_f32_16x16x32_bf16 a[240:243], v[80:83], v[124:127], a[240:243]
    v_mfma_f32_16x16x32_bf16 a[244:247], v[84:87], v[124:127], a[244:247]
    v_mfma_f32_16x16x32_bf16 a[248:251], v[88:91], v[124:127], a[248:251]
    v_mfma_f32_16x16x32_bf16 a[252:255], v[92:95], v[124:127], a[252:255]
    s_waitcnt lgkmcnt(0)
    v_mfma_f32_16x16x32_bf16 a[0:3], v[0:3], v[32:35], a[0:3]
    s_waitcnt vmcnt(0)
    s_barrier
    ds_read_b128 v[96:99], v136 offset:49152
    v_mfma_f32_16x16x32_bf16 a[4:7], v[4:7], v[32:35], a[4:7]
    ds_read_b64_tr_b16 v[64:65], v128 offset:49152
    v_mfma_f32_16x16x32_bf16 a[8:11], v[8:11], v[32:35], a[8:11]
    ds_read_b64_tr_b16 v[66:67], v128 offset:57344
    v_mfma_f32_16x16x32_bf16 a[12:15], v[12:15], v[32:35], a[12:15]
    ds_read_b64_tr_b16 v[68:69], v129 offset:49152
    v_mfma_f32_16x16x32_bf16 a[16:19], v[16:19], v[32:35], a[16:19]
    ds_read_b64_tr_b16 v[70:71], v129 offset:57344
    v_mfma_f32_16x16x32_bf16 a[20:23], v[20:23], v[32:35], a[20:23]
    ds_read_b64_tr_b16 v[72:73], v130 offset:49152
    v_mfma_f32_16x16x32_bf16 a[24:27], v[24:27], v[32:35], a[24:27]
    ds_read_b64_tr_b16 v[74:75], v130 offset:57344
    v_mfma_f32_16x16x32_bf16 a[28:31], v[28:31], v[32:35], a[28:31]
    ds_read_b64_tr_b16 v[76:77], v131 offset:49152
    v_mfma_f32_16x16x32_bf16 a[32:35], v[0:3], v[36:39], a[32:35]
    ds_read_b64_tr_b16 v[78:79], v131 offset:57344
    v_mfma_f32_16x16x32_bf16 a[36:39], v[4:7], v[36:39], a[36:39]
    ds_read_b64_tr_b16 v[80:81], v132 offset:49152
    v_mfma_f32_16x16x32_bf16 a[40:43], v[8:11], v[36:39], a[40:43]
    ds_read_b64_tr_b16 v[82:83], v132 offset:57344
    v_mfma_f32_16x16x32_bf16 a[44:47], v[12:15], v[36:39], a[44:47]
    ds_read_b64_tr_b16 v[84:85], v133 offset:49152
    v_mfma_f32_16x16x32_bf16 a[48:51], v[16:19], v[36:39], a[48:51]
    ds_read_b64_tr_b16 v[86:87], v133 offset:57344
    v_mfma_f32_16x16x32_bf16 a[52:55], v[20:23], v[36:39], a[52:55]
    ds_read_b64_tr_b16 v[88:89], v134 offset:49152
    v_mfma_f32_16x16x32_bf16 a[56:59], v[24:27], v[36:39], a[56:59]
    ds_read_b64_tr_b16 v[90:91], v134 offset:57344
    v_mfma_f32_16x16x32_bf16 a[60:63], v[28:31], v[36:39], a[60:63]
    ds_read_b64_tr_b16 v[92:93], v135 offset:49152
    v_mfma_f32_16x16x32_bf16 a[64:67], v[0:3], v[40:43], a[64:67]
    ds_read_b64_tr_b16 v[94:95], v135 offset:57344
    v_mfma_f32_16x16x32_bf16 a[68:71], v[4:7], v[40:43], a[68:71]
    ds_read_b128 v[100:103], v136 offset:50176
    v_mfma_f32_16x16x32_bf16 a[72:75], v[8:11], v[40:43], a[72:75]
    ds_read_b128 v[104:107], v136 offset:51200
    v_mfma_f32_16x16x32_bf16 a[76:79], v[12:15], v[40:43], a[76:79]
    ds_read_b128 v[108:111], v136 offset:52224
    v_mfma_f32_16x16x32_bf16 a[80:83], v[16:19], v[40:43], a[80:83]
    ds_read_b128 v[112:115], v136 offset:53248
    v_mfma_f32_16x16x32_bf16 a[84:87], v[20:23], v[40:43], a[84:87]
    ds_read_b128 v[116:119], v136 offset:54272
    v_mfma_f32_16x16x32_bf16 a[88:91], v[24:27], v[40:43], a[88:91]
    ds_read_b128 v[120:123], v136 offset:55296
    v_mfma_f32_16x16x32_bf16 a[92:95], v[28:31], v[40:43], a[92:95]
    ds_read_b128 v[124:127], v136 offset:56320
    v_mfma_f32_16x16x32_bf16 a[96:99], v[0:3], v[44:47], a[96:99]
    v_mfma_f32_16x16x32_bf16 a[100:103], v[4:7], v[44:47], a[100:103]
    v_mfma_f32_16x16x32_bf16 a[104:107], v[8:11], v[44:47], a[104:107]
    v_mfma_f32_16x16x32_bf16 a[108:111], v[12:15], v[44:47], a[108:111]
    v_mfma_f32_16x16x32_bf16 a[112:115], v[16:19], v[44:47], a[112:115]
    v_mfma_f32_16x16x32_bf16 a[116:119], v[20:23], v[44:47], a[116:119]
    v_mfma_f32_16x16x32_bf16 a[120:123], v[24:27], v[44:47], a[120:123]
    v_mfma_f32_16x16x32_bf16 a[124:127], v[28:31], v[44:47], a[124:127]
    v_mfma_f32_16x16x32_bf16 a[128:131], v[0:3], v[48:51], a[128:131]
    v_mfma_f32_16x16x32_bf16 a[132:135], v[4:7], v[48:51], a[132:135]
    v_mfma_f32_16x16x32_bf16 a[136:139], v[8:11], v[48:51], a[136:139]
    v_mfma_f32_16x16x32_bf16 a[140:143], v[12:15], v[48:51], a[140:143]
    v_mfma_f32_16x16x32_bf16 a[144:147], v[16:19], v[48:51], a[144:147]
    v_mfma_f32_16x16x32_bf16 a[148:151], v[20:23], v[48:51], a[148:151]
    v_mfma_f32_16x16x32_bf16 a[152:155], v[24:27], v[48:51], a[152:155]
    v_mfma_f32_16x16x32_bf16 a[156:159], v[28:31], v[48:51], a[156:159]
    v_mfma_f32_16x16x32_bf16 a[160:163], v[0:3], v[52:55], a[160:163]
    v_mfma_f32_16x16x32_bf16 a[164:167], v[4:7], v[52:55], a[164:167]
    v_mfma_f32_16x16x32_bf16 a[168:171], v[8:11], v[52:55], a[168:171]
    v_mfma_f32_16x16x32_bf16 a[172:175], v[12:15], v[52:55], a[172:175]
    v_mfma_f32_16x16x32_bf16 a[176:179], v[16:19], v[52:55], a[176:179]
    v_mfma_f32_16x16x32_bf16 a[180:183], v[20:23], v[52:55], a[180:183]
    v_mfma_f32_16x16x32_bf16 a[184:187], v[24:27], v[52:55], a[184:187]
    v_mfma_f32_16x16x32_bf16 a[188:191], v[28:31], v[52:55], a[188:191]
    v_mfma_f32_16x16x32_bf16 a[192:195], v[0:3], v[56:59], a[192:195]
    v_mfma_f32_16x16x32_bf16 a[196:199], v[4:7], v[56:59], a[196:199]
    v_mfma_f32_16x16x32_bf16 a[200:203], v[8:11], v[56:59], a[200:203]
    v_mfma_f32_16x16x32_bf16 a[204:207], v[12:15], v[56:59], a[204:207]
    v_mfma_f32_16x16x32_bf16 a[208:211], v[16:19], v[56:59], a[208:211]
    v_mfma_f32_16x16x32_bf16 a[212:215], v[20:23], v[56:59], a[212:215]
    v_mfma_f32_16x16x32_bf16 a[216:219], v[24:27], v[56:59], a[216:219]
    v_mfma_f32_16x16x32_bf16 a[220:223], v[28:31], v[56:59], a[220:223]
    v_mfma_f32_16x16x32_bf16 a[224:227], v[0:3], v[60:63], a[224:227]
    v_mfma_f32_16x16x32_bf16 a[228:231], v[4:7], v[60:63], a[228:231]
    v_mfma_f32_16x16x32_bf16 a[232:235], v[8:11], v[60:63], a[232:235]
    v_mfma_f32_16x16x32_bf16 a[236:239], v[12:15], v[60:63], a[236:239]
    v_mfma_f32_16x16x32_bf16 a[240:243], v[16:19], v[60:63], a[240:243]
    v_mfma_f32_16x16x32_bf16 a[244:247], v[20:23], v[60:63], a[244:247]
    v_mfma_f32_16x16x32_bf16 a[248:251], v[24:27], v[60:63], a[248:251]
    v_mfma_f32_16x16x32_bf16 a[252:255], v[28:31], v[60:63], a[252:255]
    v_readfirstlane_b32 s55, v255
    s_waitcnt lgkmcnt(0)
    v_mfma_f32_16x16x32_bf16 a[0:3], v[64:67], v[96:99], a[0:3]
    v_mfma_f32_16x16x32_bf16 a[4:7], v[68:71], v[96:99], a[4:7]
    v_mfma_f32_16x16x32_bf16 a[8:11], v[72:75], v[96:99], a[8:11]
    v_mfma_f32_16x16x32_bf16 a[12:15], v[76:79], v[96:99], a[12:15]
    v_mfma_f32_16x16x32_bf16 a[16:19], v[80:83], v[96:99], a[16:19]
    v_mfma_f32_16x16x32_bf16 a[20:23], v[84:87], v[96:99], a[20:23]
    v_mfma_f32_16x16x32_bf16 a[24:27], v[88:91], v[96:99], a[24:27]
    v_mfma_f32_16x16x32_bf16 a[28:31], v[92:95], v[96:99], a[28:31]
    v_mfma_f32_16x16x32_bf16 a[32:35], v[64:67], v[100:103], a[32:35]
    v_mfma_f32_16x16x32_bf16 a[36:39], v[68:71], v[100:103], a[36:39]
    v_mfma_f32_16x16x32_bf16 a[40:43], v[72:75], v[100:103], a[40:43]
    v_mfma_f32_16x16x32_bf16 a[44:47], v[76:79], v[100:103], a[44:47]
    v_mfma_f32_16x16x32_bf16 a[48:51], v[80:83], v[100:103], a[48:51]
    v_mfma_f32_16x16x32_bf16 a[52:55], v[84:87], v[100:103], a[52:55]
    v_mfma_f32_16x16x32_bf16 a[56:59], v[88:91], v[100:103], a[56:59]
    v_mfma_f32_16x16x32_bf16 a[60:63], v[92:95], v[100:103], a[60:63]
    v_mfma_f32_16x16x32_bf16 a[64:67], v[64:67], v[104:107], a[64:67]
    v_mfma_f32_16x16x32_bf16 a[68:71], v[68:71], v[104:107], a[68:71]
    v_mfma_f32_16x16x32_bf16 a[72:75], v[72:75], v[104:107], a[72:75]
    v_mfma_f32_16x16x32_bf16 a[76:79], v[76:79], v[104:107], a[76:79]
    v_mfma_f32_16x16x32_bf16 a[80:83], v[80:83], v[104:107], a[80:83]
    v_mfma_f32_16x16x32_bf16 a[84:87], v[84:87], v[104:107], a[84:87]
    v_mfma_f32_16x16x32_bf16 a[88:91], v[88:91], v[104:107], a[88:91]
    v_mfma_f32_16x16x32_bf16 a[92:95], v[92:95], v[104:107], a[92:95]
    v_mfma_f32_16x16x32_bf16 a[96:99], v[64:67], v[108:111], a[96:99]
    v_mfma_f32_16x16x32_bf16 a[100:103], v[68:71], v[108:111], a[100:103]
    v_mfma_f32_16x16x32_bf16 a[104:107], v[72:75], v[108:111], a[104:107]
    v_mfma_f32_16x16x32_bf16 a[108:111], v[76:79], v[108:111], a[108:111]
    v_mfma_f32_16x16x32_bf16 a[112:115], v[80:83], v[108:111], a[112:115]
    v_mfma_f32_16x16x32_bf16 a[116:119], v[84:87], v[108:111], a[116:119]
    v_mfma_f32_16x16x32_bf16 a[120:123], v[88:91], v[108:111], a[120:123]
    v_mfma_f32_16x16x32_bf16 a[124:127], v[92:95], v[108:111], a[124:127]
    v_mfma_f32_16x16x32_bf16 a[128:131], v[64:67], v[112:115], a[128:131]
    v_mfma_f32_16x16x32_bf16 a[132:135], v[68:71], v[112:115], a[132:135]
    v_mfma_f32_16x16x32_bf16 a[136:139], v[72:75], v[112:115], a[136:139]
    v_mfma_f32_16x16x32_bf16 a[140:143], v[76:79], v[112:115], a[140:143]
    v_mfma_f32_16x16x32_bf16 a[144:147], v[80:83], v[112:115], a[144:147]
    v_mfma_f32_16x16x32_bf16 a[148:151], v[84:87], v[112:115], a[148:151]
    v_mfma_f32_16x16x32_bf16 a[152:155], v[88:91], v[112:115], a[152:155]
    v_mfma_f32_16x16x32_bf16 a[156:159], v[92:95], v[112:115], a[156:159]
    v_mfma_f32_16x16x32_bf16 a[160:163], v[64:67], v[116:119], a[160:163]
    v_mfma_f32_16x16x32_bf16 a[164:167], v[68:71], v[116:119], a[164:167]
    v_mfma_f32_16x16x32_bf16 a[168:171], v[72:75], v[116:119], a[168:171]
    v_mfma_f32_16x16x32_bf16 a[172:175], v[76:79], v[116:119], a[172:175]
    v_mfma_f32_16x16x32_bf16 a[176:179], v[80:83], v[116:119], a[176:179]
    v_mfma_f32_16x16x32_bf16 a[180:183], v[84:87], v[116:119], a[180:183]
    v_mfma_f32_16x16x32_bf16 a[184:187], v[88:91], v[116:119], a[184:187]
    v_mfma_f32_16x16x32_bf16 a[188:191], v[92:95], v[116:119], a[188:191]
    v_mfma_f32_16x16x32_bf16 a[192:195], v[64:67], v[120:123], a[192:195]
    v_mfma_f32_16x16x32_bf16 a[196:199], v[68:71], v[120:123], a[196:199]
    v_mfma_f32_16x16x32_bf16 a[200:203], v[72:75], v[120:123], a[200:203]
    v_mfma_f32_16x16x32_bf16 a[204:207], v[76:79], v[120:123], a[204:207]
    v_mfma_f32_16x16x32_bf16 a[208:211], v[80:83], v[120:123], a[208:211]
    v_mfma_f32_16x16x32_bf16 a[212:215], v[84:87], v[120:123], a[212:215]
    v_mfma_f32_16x16x32_bf16 a[216:219], v[88:91], v[120:123], a[216:219]
    v_mfma_f32_16x16x32_bf16 a[220:223], v[92:95], v[120:123], a[220:223]
    v_mfma_f32_16x16x32_bf16 a[224:227], v[64:67], v[124:127], a[224:227]
    v_mfma_f32_16x16x32_bf16 a[228:231], v[68:71], v[124:127], a[228:231]
    v_mfma_f32_16x16x32_bf16 a[232:235], v[72:75], v[124:127], a[232:235]
    v_mfma_f32_16x16x32_bf16 a[236:239], v[76:79], v[124:127], a[236:239]
    v_mfma_f32_16x16x32_bf16 a[240:243], v[80:83], v[124:127], a[240:243]
    v_mfma_f32_16x16x32_bf16 a[244:247], v[84:87], v[124:127], a[244:247]
    v_mfma_f32_16x16x32_bf16 a[248:251], v[88:91], v[124:127], a[248:251]
    v_mfma_f32_16x16x32_bf16 a[252:255], v[92:95], v[124:127], a[252:255]
    s_nop 7
    s_cmp_eq_u32 s23, 1
    s_cbranch_scc1 main_kernel_w_c2_escl
    s_cmp_eq_u32 s23, 6
    s_cbranch_scc1 main_kernel_w_c2_egelu
main_kernel_w_c2_eplain:
    s_mov_b32 s53, s21
    v_accvgpr_read_b32 v0, a0
    v_accvgpr_read_b32 v1, a1
    v_accvgpr_read_b32 v2, a2
    v_accvgpr_read_b32 v3, a3
    v_accvgpr_read_b32 v4, a4
    v_accvgpr_read_b32 v5, a5
    v_accvgpr_read_b32 v6, a6
    v_accvgpr_read_b32 v7, a7
    v_cvt_pk_bf16_f32 v16, v0, v1
    v_cvt_pk_bf16_f32 v17, v2, v3
    v_cvt_pk_bf16_f32 v18, v4, v5
    v_cvt_pk_bf16_f32 v19, v6, v7
    buffer_store_dwordx4 v[16:19], v251, s[4:7], s53 offen offset:0 sc1
    v_accvgpr_read_b32 v20, a8
    v_accvgpr_read_b32 v21, a9
    v_accvgpr_read_b32 v22, a10
    v_accvgpr_read_b32 v23, a11
    v_accvgpr_read_b32 v24, a12
    v_accvgpr_read_b32 v25, a13
    v_accvgpr_read_b32 v26, a14
    v_accvgpr_read_b32 v27, a15
    v_cvt_pk_bf16_f32 v36, v20, v21
    v_cvt_pk_bf16_f32 v37, v22, v23
    v_cvt_pk_bf16_f32 v38, v24, v25
    v_cvt_pk_bf16_f32 v39, v26, v27
    buffer_store_dwordx4 v[36:39], v251, s[4:7], s53 offen offset:1024 sc1
    v_accvgpr_read_b32 v40, a16
    v_accvgpr_read_b32 v41, a17
    v_accvgpr_read_b32 v42, a18
    v_accvgpr_read_b32 v43, a19
    v_accvgpr_read_b32 v44, a20
    v_accvgpr_read_b32 v45, a21
    v_accvgpr_read_b32 v46, a22
    v_accvgpr_read_b32 v47, a23
    v_cvt_pk_bf16_f32 v56, v40, v41
    v_cvt_pk_bf16_f32 v57, v42, v43
    v_cvt_pk_bf16_f32 v58, v44, v45
    v_cvt_pk_bf16_f32 v59, v46, v47
    buffer_store_dwordx4 v[56:59], v251, s[4:7], s53 offen offset:2048 sc1
    v_accvgpr_read_b32 v0, a24
    v_accvgpr_read_b32 v1, a25
    v_accvgpr_read_b32 v2, a26
    v_accvgpr_read_b32 v3, a27
    v_accvgpr_read_b32 v4, a28
    v_accvgpr_read_b32 v5, a29
    v_accvgpr_read_b32 v6, a30
    v_accvgpr_read_b32 v7, a31
    v_cvt_pk_bf16_f32 v16, v0, v1
    v_cvt_pk_bf16_f32 v17, v2, v3
    v_cvt_pk_bf16_f32 v18, v4, v5
    v_cvt_pk_bf16_f32 v19, v6, v7
    buffer_store_dwordx4 v[16:19], v251, s[4:7], s53 offen offset:3072 sc1
    s_add_u32 s53, s53, s22
    v_accvgpr_read_b32 v20, a32
    v_accvgpr_read_b32 v21, a33
    v_accvgpr_read_b32 v22, a34
    v_accvgpr_read_b32 v23, a35
    v_accvgpr_read_b32 v24, a36
    v_accvgpr_read_b32 v25, a37
    v_accvgpr_read_b32 v26, a38
    v_accvgpr_read_b32 v27, a39
    v_cvt_pk_bf16_f32 v36, v20, v21
    v_cvt_pk_bf16_f32 v37, v22, v23
    v_cvt_pk_bf16_f32 v38, v24, v25
    v_cvt_pk_bf16_f32 v39, v26, v27
    buffer_store_dwordx4 v[36:39], v251, s[4:7], s53 offen offset:0 sc1
    v_accvgpr_read_b32 v40, a40
    v_accvgpr_read_b32 v41, a41
    v_accvgpr_read_b32 v42, a42
    v_accvgpr_read_b32 v43, a43
    v_accvgpr_read_b32 v44, a44
    v_accvgpr_read_b32 v45, a45
    v_accvgpr_read_b32 v46, a46
    v_accvgpr_read_b32 v47, a47
    v_cvt_pk_bf16_f32 v56, v40, v41
    v_cvt_pk_bf16_f32 v57, v42, v43
    v_cvt_pk_bf16_f32 v58, v44, v45
    v_cvt_pk_bf16_f32 v59, v46, v47
    buffer_store_dwordx4 v[56:59], v251, s[4:7], s53 offen offset:1024 sc1
    v_accvgpr_read_b32 v0, a48
    v_accvgpr_read_b32 v1, a49
    v_accvgpr_read_b32 v2, a50
    v_accvgpr_read_b32 v3, a51
    v_accvgpr_read_b32 v4, a52
    v_accvgpr_read_b32 v5, a53
    v_accvgpr_read_b32 v6, a54
    v_accvgpr_read_b32 v7, a55
    v_cvt_pk_bf16_f32 v16, v0, v1
    v_cvt_pk_bf16_f32 v17, v2, v3
    v_cvt_pk_bf16_f32 v18, v4, v5
    v_cvt_pk_bf16_f32 v19, v6, v7
    buffer_store_dwordx4 v[16:19], v251, s[4:7], s53 offen offset:2048 sc1
    v_accvgpr_read_b32 v20, a56
    v_accvgpr_read_b32 v21, a57
    v_accvgpr_read_b32 v22, a58
    v_accvgpr_read_b32 v23, a59
    v_accvgpr_read_b32 v24, a60
    v_accvgpr_read_b32 v25, a61
    v_accvgpr_read_b32 v26, a62
    v_accvgpr_read_b32 v27, a63
    v_cvt_pk_bf16_f32 v36, v20, v21
    v_cvt_pk_bf16_f32 v37, v22, v23
    v_cvt_pk_bf16_f32 v38, v24, v25
    v_cvt_pk_bf16_f32 v39, v26, v27
    buffer_store_dwordx4 v[36:39], v251, s[4:7], s53 offen offset:3072 sc1
    s_add_u32 s53, s53, s22
    v_accvgpr_read_b32 v40, a64
    v_accvgpr_read_b32 v41, a65
    v_accvgpr_read_b32 v42, a66
    v_accvgpr_read_b32 v43, a67
    v_accvgpr_read_b32 v44, a68
    v_accvgpr_read_b32 v45, a69
    v_accvgpr_read_b32 v46, a70
    v_accvgpr_read_b32 v47, a71
    v_cvt_pk_bf16_f32 v56, v40, v41
    v_cvt_pk_bf16_f32 v57, v42, v43
    v_cvt_pk_bf16_f32 v58, v44, v45
    v_cvt_pk_bf16_f32 v59, v46, v47
    buffer_store_dwordx4 v[56:59], v251, s[4:7], s53 offen offset:0 sc1
    v_accvgpr_read_b32 v0, a72
    v_accvgpr_read_b32 v1, a73
    v_accvgpr_read_b32 v2, a74
    v_accvgpr_read_b32 v3, a75
    v_accvgpr_read_b32 v4, a76
    v_accvgpr_read_b32 v5, a77
    v_accvgpr_read_b32 v6, a78
    v_accvgpr_read_b32 v7, a79
    v_cvt_pk_bf16_f32 v16, v0, v1
    v_cvt_pk_bf16_f32 v17, v2, v3
    v_cvt_pk_bf16_f32 v18, v4, v5
    v_cvt_pk_bf16_f32 v19, v6, v7
    buffer_store_dwordx4 v[16:19], v251, s[4:7], s53 offen offset:1024 sc1
    v_accvgpr_read_b32 v20, a80
    v_accvgpr_read_b32 v21, a81
    v_accvgpr_read_b32 v22, a82
    v_accvgpr_read_b32 v23, a83
    v_accvgpr_read_b32 v24, a84
    v_accvgpr_read_b32 v25, a85
    v_accvgpr_read_b32 v26, a86
    v_accvgpr_read_b32 v27, a87
    v_cvt_pk_bf16_f32 v36, v20, v21
    v_cvt_pk_bf16_f32 v37, v22, v23
    v_cvt_pk_bf16_f32 v38, v24, v25
    v_cvt_pk_bf16_f32 v39, v26, v27
    buffer_store_dwordx4 v[36:39], v251, s[4:7], s53 offen offset:2048 sc1
    v_accvgpr_read_b32 v40, a88
    v_accvgpr_read_b32 v41, a89
    v_accvgpr_read_b32 v42, a90
    v_accvgpr_read_b32 v43, a91
    v_accvgpr_read_b32 v44, a92
    v_accvgpr_read_b32 v45, a93
    v_accvgpr_read_b32 v46, a94
    v_accvgpr_read_b32 v47, a95
    v_cvt_pk_bf16_f32 v56, v40, v41
    v_cvt_pk_bf16_f32 v57, v42, v43
    v_cvt_pk_bf16_f32 v58, v44, v45
    v_cvt_pk_bf16_f32 v59, v46, v47
    buffer_store_dwordx4 v[56:59], v251, s[4:7], s53 offen offset:3072 sc1
    s_add_u32 s53, s53, s22
    v_accvgpr_read_b32 v0, a96
    v_accvgpr_read_b32 v1, a97
    v_accvgpr_read_b32 v2, a98
    v_accvgpr_read_b32 v3, a99
    v_accvgpr_read_b32 v4, a100
    v_accvgpr_read_b32 v5, a101
    v_accvgpr_read_b32 v6, a102
    v_accvgpr_read_b32 v7, a103
    v_cvt_pk_bf16_f32 v16, v0, v1
    v_cvt_pk_bf16_f32 v17, v2, v3
    v_cvt_pk_bf16_f32 v18, v4, v5
    v_cvt_pk_bf16_f32 v19, v6, v7
    buffer_store_dwordx4 v[16:19], v251, s[4:7], s53 offen offset:0 sc1
    v_accvgpr_read_b32 v20, a104
    v_accvgpr_read_b32 v21, a105
    v_accvgpr_read_b32 v22, a106
    v_accvgpr_read_b32 v23, a107
    v_accvgpr_read_b32 v24, a108
    v_accvgpr_read_b32 v25, a109
    v_accvgpr_read_b32 v26, a110
    v_accvgpr_read_b32 v27, a111
    v_cvt_pk_bf16_f32 v36, v20, v21
    v_cvt_pk_bf16_f32 v37, v22, v23
    v_cvt_pk_bf16_f32 v38, v24, v25
    v_cvt_pk_bf16_f32 v39, v26, v27
    buffer_store_dwordx4 v[36:39], v251, s[4:7], s53 offen offset:1024 sc1
    v_accvgpr_read_b32 v40, a112
    v_accvgpr_read_b32 v41, a113
    v_accvgpr_read_b32 v42, a114
    v_accvgpr_read_b32 v43, a115
    v_accvgpr_read_b32 v44, a116
    v_accvgpr_read_b32 v45, a117
    v_accvgpr_read_b32 v46, a118
    v_accvgpr_read_b32 v47, a119
    v_cvt_pk_bf16_f32 v56, v40, v41
    v_cvt_pk_bf16_f32 v57, v42, v43
    v_cvt_pk_bf16_f32 v58, v44, v45
    v_cvt_pk_bf16_f32 v59, v46, v47
    buffer_store_dwordx4 v[56:59], v251, s[4:7], s53 offen offset:2048 sc1
    v_accvgpr_read_b32 v0, a120
    v_accvgpr_read_b32 v1, a121
    v_accvgpr_read_b32 v2, a122
    v_accvgpr_read_b32 v3, a123
    v_accvgpr_read_b32 v4, a124
    v_accvgpr_read_b32 v5, a125
    v_accvgpr_read_b32 v6, a126
    v_accvgpr_read_b32 v7, a127
    v_cvt_pk_bf16_f32 v16, v0, v1
    v_cvt_pk_bf16_f32 v17, v2, v3
    v_cvt_pk_bf16_f32 v18, v4, v5
    v_cvt_pk_bf16_f32 v19, v6, v7
    buffer_store_dwordx4 v[16:19], v251, s[4:7], s53 offen offset:3072 sc1
    s_add_u32 s53, s53, s22
    v_accvgpr_read_b32 v20, a128
    v_accvgpr_read_b32 v21, a129
    v_accvgpr_read_b32 v22, a130
    v_accvgpr_read_b32 v23, a131
    v_accvgpr_read_b32 v24, a132
    v_accvgpr_read_b32 v25, a133
    v_accvgpr_read_b32 v26, a134
    v_accvgpr_read_b32 v27, a135
    v_cvt_pk_bf16_f32 v36, v20, v21
    v_cvt_pk_bf16_f32 v37, v22, v23
    v_cvt_pk_bf16_f32 v38, v24, v25
    v_cvt_pk_bf16_f32 v39, v26, v27
    buffer_store_dwordx4 v[36:39], v251, s[4:7], s53 offen offset:0 sc1
    v_accvgpr_read_b32 v40, a136
    v_accvgpr_read_b32 v41, a137
    v_accvgpr_read_b32 v42, a138
    v_accvgpr_read_b32 v43, a139
    v_accvgpr_read_b32 v44, a140
    v_accvgpr_read_b32 v45, a141
    v_accvgpr_read_b32 v46, a142
    v_accvgpr_read_b32 v47, a143
    v_cvt_pk_bf16_f32 v56, v40, v41
    v_cvt_pk_bf16_f32 v57, v42, v43
    v_cvt_pk_bf16_f32 v58, v44, v45
    v_cvt_pk_bf16_f32 v59, v46, v47
    buffer_store_dwordx4 v[56:59], v251, s[4:7], s53 offen offset:1024 sc1
    v_accvgpr_read_b32 v0, a144
    v_accvgpr_read_b32 v1, a145
    v_accvgpr_read_b32 v2, a146
    v_accvgpr_read_b32 v3, a147
    v_accvgpr_read_b32 v4, a148
    v_accvgpr_read_b32 v5, a149
    v_accvgpr_read_b32 v6, a150
    v_accvgpr_read_b32 v7, a151
    v_cvt_pk_bf16_f32 v16, v0, v1
    v_cvt_pk_bf16_f32 v17, v2, v3
    v_cvt_pk_bf16_f32 v18, v4, v5
    v_cvt_pk_bf16_f32 v19, v6, v7
    buffer_store_dwordx4 v[16:19], v251, s[4:7], s53 offen offset:2048 sc1
    v_accvgpr_read_b32 v20, a152
    v_accvgpr_read_b32 v21, a153
    v_accvgpr_read_b32 v22, a154
    v_accvgpr_read_b32 v23, a155
    v_accvgpr_read_b32 v24, a156
    v_accvgpr_read_b32 v25, a157
    v_accvgpr_read_b32 v26, a158
    v_accvgpr_read_b32 v27, a159
    v_cvt_pk_bf16_f32 v36, v20, v21
    v_cvt_pk_bf16_f32 v37, v22, v23
    v_cvt_pk_bf16_f32 v38, v24, v25
    v_cvt_pk_bf16_f32 v39, v26, v27
    buffer_store_dwordx4 v[36:39], v251, s[4:7], s53 offen offset:3072 sc1
    s_add_u32 s53, s53, s22
    v_accvgpr_read_b32 v40, a160
    v_accvgpr_read_b32 v41, a161
    v_accvgpr_read_b32 v42, a162
    v_accvgpr_read_b32 v43, a163
    v_accvgpr_read_b32 v44, a164
    v_accvgpr_read_b32 v45, a165
    v_accvgpr_read_b32 v46, a166
    v_accvgpr_read_b32 v47, a167
    v_cvt_pk_bf16_f32 v56, v40, v41
    v_cvt_pk_bf16_f32 v57, v42, v43
    v_cvt_pk_bf16_f32 v58, v44, v45
    v_cvt_pk_bf16_f32 v59, v46, v47
    buffer_store_dwordx4 v[56:59], v251, s[4:7], s53 offen offset:0 sc1
    v_accvgpr_read_b32 v0, a168
    v_accvgpr_read_b32 v1, a169
    v_accvgpr_read_b32 v2, a170
    v_accvgpr_read_b32 v3, a171
    v_accvgpr_read_b32 v4, a172
    v_accvgpr_read_b32 v5, a173
    v_accvgpr_read_b32 v6, a174
    v_accvgpr_read_b32 v7, a175
    v_cvt_pk_bf16_f32 v16, v0, v1
    v_cvt_pk_bf16_f32 v17, v2, v3
    v_cvt_pk_bf16_f32 v18, v4, v5
    v_cvt_pk_bf16_f32 v19, v6, v7
    buffer_store_dwordx4 v[16:19], v251, s[4:7], s53 offen offset:1024 sc1
    v_accvgpr_read_b32 v20, a176
    v_accvgpr_read_b32 v21, a177
    v_accvgpr_read_b32 v22, a178
    v_accvgpr_read_b32 v23, a179
    v_accvgpr_read_b32 v24, a180
    v_accvgpr_read_b32 v25, a181
    v_accvgpr_read_b32 v26, a182
    v_accvgpr_read_b32 v27, a183
    v_cvt_pk_bf16_f32 v36, v20, v21
    v_cvt_pk_bf16_f32 v37, v22, v23
    v_cvt_pk_bf16_f32 v38, v24, v25
    v_cvt_pk_bf16_f32 v39, v26, v27
    buffer_store_dwordx4 v[36:39], v251, s[4:7], s53 offen offset:2048 sc1
    v_accvgpr_read_b32 v40, a184
    v_accvgpr_read_b32 v41, a185
    v_accvgpr_read_b32 v42, a186
    v_accvgpr_read_b32 v43, a187
    v_accvgpr_read_b32 v44, a188
    v_accvgpr_read_b32 v45, a189
    v_accvgpr_read_b32 v46, a190
    v_accvgpr_read_b32 v47, a191
    v_cvt_pk_bf16_f32 v56, v40, v41
    v_cvt_pk_bf16_f32 v57, v42, v43
    v_cvt_pk_bf16_f32 v58, v44, v45
    v_cvt_pk_bf16_f32 v59, v46, v47
    buffer_store_dwordx4 v[56:59], v251, s[4:7], s53 offen offset:3072 sc1
    s_add_u32 s53, s53, s22
    v_accvgpr_read_b32 v0, a192
    v_accvgpr_read_b32 v1, a193
    v_accvgpr_read_b32 v2, a194
    v_accvgpr_read_b32 v3, a195
    v_accvgpr_read_b32 v4, a196
    v_accvgpr_read_b32 v5, a197
    v_accvgpr_read_b32 v6, a198
    v_accvgpr_read_b32 v7, a199
    v_cvt_pk_bf16_f32 v16, v0, v1
    v_cvt_pk_bf16_f32 v17, v2, v3
    v_cvt_pk_bf16_f32 v18, v4, v5
    v_cvt_pk_bf16_f32 v19, v6, v7
    buffer_store_dwordx4 v[16:19], v251, s[4:7], s53 offen offset:0 sc1
    v_accvgpr_read_b32 v20, a200
    v_accvgpr_read_b32 v21, a201
    v_accvgpr_read_b32 v22, a202
    v_accvgpr_read_b32 v23, a203
    v_accvgpr_read_b32 v24, a204
    v_accvgpr_read_b32 v25, a205
    v_accvgpr_read_b32 v26, a206
    v_accvgpr_read_b32 v27, a207
    v_cvt_pk_bf16_f32 v36, v20, v21
    v_cvt_pk_bf16_f32 v37, v22, v23
    v_cvt_pk_bf16_f32 v38, v24, v25
    v_cvt_pk_bf16_f32 v39, v26, v27
    buffer_store_dwordx4 v[36:39], v251, s[4:7], s53 offen offset:1024 sc1
    v_accvgpr_read_b32 v40, a208
    v_accvgpr_read_b32 v41, a209
    v_accvgpr_read_b32 v42, a210
    v_accvgpr_read_b32 v43, a211
    v_accvgpr_read_b32 v44, a212
    v_accvgpr_read_b32 v45, a213
    v_accvgpr_read_b32 v46, a214
    v_accvgpr_read_b32 v47, a215
    v_cvt_pk_bf16_f32 v56, v40, v41
    v_cvt_pk_bf16_f32 v57, v42, v43
    v_cvt_pk_bf16_f32 v58, v44, v45
    v_cvt_pk_bf16_f32 v59, v46, v47
    buffer_store_dwordx4 v[56:59], v251, s[4:7], s53 offen offset:2048 sc1
    v_accvgpr_read_b32 v0, a216
    v_accvgpr_read_b32 v1, a217
    v_accvgpr_read_b32 v2, a218
    v_accvgpr_read_b32 v3, a219
    v_accvgpr_read_b32 v4, a220
    v_accvgpr_read_b32 v5, a221
    v_accvgpr_read_b32 v6, a222
    v_accvgpr_read_b32 v7, a223
    v_cvt_pk_bf16_f32 v16, v0, v1
    v_cvt_pk_bf16_f32 v17, v2, v3
    v_cvt_pk_bf16_f32 v18, v4, v5
    v_cvt_pk_bf16_f32 v19, v6, v7
    buffer_store_dwordx4 v[16:19], v251, s[4:7], s53 offen offset:3072 sc1
    s_add_u32 s53, s53, s22
    v_accvgpr_read_b32 v20, a224
    v_accvgpr_read_b32 v21, a225
    v_accvgpr_read_b32 v22, a226
    v_accvgpr_read_b32 v23, a227
    v_accvgpr_read_b32 v24, a228
    v_accvgpr_read_b32 v25, a229
    v_accvgpr_read_b32 v26, a230
    v_accvgpr_read_b32 v27, a231
    v_cvt_pk_bf16_f32 v36, v20, v21
    v_cvt_pk_bf16_f32 v37, v22, v23
    v_cvt_pk_bf16_f32 v38, v24, v25
    v_cvt_pk_bf16_f32 v39, v26, v27
    buffer_store_dwordx4 v[36:39], v251, s[4:7], s53 offen offset:0 sc1
    v_accvgpr_read_b32 v40, a232
    v_accvgpr_read_b32 v41, a233
    v_accvgpr_read_b32 v42, a234
    v_accvgpr_read_b32 v43, a235
    v_accvgpr_read_b32 v44, a236
    v_accvgpr_read_b32 v45, a237
    v_accvgpr_read_b32 v46, a238
    v_accvgpr_read_b32 v47, a239
    v_cvt_pk_bf16_f32 v56, v40, v41
    v_cvt_pk_bf16_f32 v57, v42, v43
    v_cvt_pk_bf16_f32 v58, v44, v45
    v_cvt_pk_bf16_f32 v59, v46, v47
    buffer_store_dwordx4 v[56:59], v251, s[4:7], s53 offen offset:1024 sc1
    v_accvgpr_read_b32 v0, a240
    v_accvgpr_read_b32 v1, a241
    v_accvgpr_read_b32 v2, a242
    v_accvgpr_read_b32 v3, a243
    v_accvgpr_read_b32 v4, a244
    v_accvgpr_read_b32 v5, a245
    v_accvgpr_read_b32 v6, a246
    v_accvgpr_read_b32 v7, a247
    v_cvt_pk_bf16_f32 v16, v0, v1
    v_cvt_pk_bf16_f32 v17, v2, v3
    v_cvt_pk_bf16_f32 v18, v4, v5
    v_cvt_pk_bf16_f32 v19, v6, v7
    buffer_store_dwordx4 v[16:19], v251, s[4:7], s53 offen offset:2048 sc1
    v_accvgpr_read_b32 v20, a248
    v_accvgpr_read_b32 v21, a249
    v_accvgpr_read_b32 v22, a250
    v_accvgpr_read_b32 v23, a251
    v_accvgpr_read_b32 v24, a252
    v_accvgpr_read_b32 v25, a253
    v_accvgpr_read_b32 v26, a254
    v_accvgpr_read_b32 v27, a255
    v_cvt_pk_bf16_f32 v36, v20, v21
    v_cvt_pk_bf16_f32 v37, v22, v23
    v_cvt_pk_bf16_f32 v38, v24, v25
    v_cvt_pk_bf16_f32 v39, v26, v27
    buffer_store_dwordx4 v[36:39], v251, s[4:7], s53 offen offset:3072 sc1
    s_branch main_kernel_w_done
main_kernel_w_c2_escl:
    s_mov_b32 s53, s21
    v_accvgpr_read_b32 v0, a0
    v_accvgpr_read_b32 v1, a1
    v_accvgpr_read_b32 v2, a2
    v_accvgpr_read_b32 v3, a3
    v_accvgpr_read_b32 v4, a4
    v_accvgpr_read_b32 v5, a5
    v_accvgpr_read_b32 v6, a6
    v_accvgpr_read_b32 v7, a7
    v_mul_f32 v0, 0x3e0293ee, v0
    v_mul_f32 v1, 0x3e0293ee, v1
    v_mul_f32 v2, 0x3e0293ee, v2
    v_mul_f32 v3, 0x3e0293ee, v3
    v_mul_f32 v4, 0x3e0293ee, v4
    v_mul_f32 v5, 0x3e0293ee, v5
    v_mul_f32 v6, 0x3e0293ee, v6
    v_mul_f32 v7, 0x3e0293ee, v7
    v_cvt_pk_bf16_f32 v16, v0, v1
    v_cvt_pk_bf16_f32 v17, v2, v3
    v_cvt_pk_bf16_f32 v18, v4, v5
    v_cvt_pk_bf16_f32 v19, v6, v7
    buffer_store_dwordx4 v[16:19], v251, s[4:7], s53 offen offset:0 sc1
    v_accvgpr_read_b32 v20, a8
    v_accvgpr_read_b32 v21, a9
    v_accvgpr_read_b32 v22, a10
    v_accvgpr_read_b32 v23, a11
    v_accvgpr_read_b32 v24, a12
    v_accvgpr_read_b32 v25, a13
    v_accvgpr_read_b32 v26, a14
    v_accvgpr_read_b32 v27, a15
    v_mul_f32 v20, 0x3e0293ee, v20
    v_mul_f32 v21, 0x3e0293ee, v21
    v_mul_f32 v22, 0x3e0293ee, v22
    v_mul_f32 v23, 0x3e0293ee, v23
    v_mul_f32 v24, 0x3e0293ee, v24
    v_mul_f32 v25, 0x3e0293ee, v25
    v_mul_f32 v26, 0x3e0293ee, v26
    v_mul_f32 v27, 0x3e0293ee, v27
    v_cvt_pk_bf16_f32 v36, v20, v21
    v_cvt_pk_bf16_f32 v37, v22, v23
    v_cvt_pk_bf16_f32 v38, v24, v25
    v_cvt_pk_bf16_f32 v39, v26, v27
    buffer_store_dwordx4 v[36:39], v251, s[4:7], s53 offen offset:1024 sc1
    v_accvgpr_read_b32 v40, a16
    v_accvgpr_read_b32 v41, a17
    v_accvgpr_read_b32 v42, a18
    v_accvgpr_read_b32 v43, a19
    v_accvgpr_read_b32 v44, a20
    v_accvgpr_read_b32 v45, a21
    v_accvgpr_read_b32 v46, a22
    v_accvgpr_read_b32 v47, a23
    v_mul_f32 v40, 0x3e0293ee, v40
    v_mul_f32 v41, 0x3e0293ee, v41
    v_mul_f32 v42, 0x3e0293ee, v42
    v_mul_f32 v43, 0x3e0293ee, v43
    v_mul_f32 v44, 0x3e0293ee, v44
    v_mul_f32 v45, 0x3e0293ee, v45
    v_mul_f32 v46, 0x3e0293ee, v46
    v_mul_f32 v47, 0x3e0293ee, v47
    v_cvt_pk_bf16_f32 v56, v40, v41
    v_cvt_pk_bf16_f32 v57, v42, v43
    v_cvt_pk_bf16_f32 v58, v44, v45
    v_cvt_pk_bf16_f32 v59, v46, v47
    buffer_store_dwordx4 v[56:59], v251, s[4:7], s53 offen offset:2048 sc1
    v_accvgpr_read_b32 v0, a24
    v_accvgpr_read_b32 v1, a25
    v_accvgpr_read_b32 v2, a26
    v_accvgpr_read_b32 v3, a27
    v_accvgpr_read_b32 v4, a28
    v_accvgpr_read_b32 v5, a29
    v_accvgpr_read_b32 v6, a30
    v_accvgpr_read_b32 v7, a31
    v_mul_f32 v0, 0x3e0293ee, v0
    v_mul_f32 v1, 0x3e0293ee, v1
    v_mul_f32 v2, 0x3e0293ee, v2
    v_mul_f32 v3, 0x3e0293ee, v3
    v_mul_f32 v4, 0x3e0293ee, v4
    v_mul_f32 v5, 0x3e0293ee, v5
    v_mul_f32 v6, 0x3e0293ee, v6
    v_mul_f32 v7, 0x3e0293ee, v7
    v_cvt_pk_bf16_f32 v16, v0, v1
    v_cvt_pk_bf16_f32 v17, v2, v3
    v_cvt_pk_bf16_f32 v18, v4, v5
    v_cvt_pk_bf16_f32 v19, v6, v7
    buffer_store_dwordx4 v[16:19], v251, s[4:7], s53 offen offset:3072 sc1
    s_add_u32 s53, s53, s22
    v_accvgpr_read_b32 v20, a32
    v_accvgpr_read_b32 v21, a33
    v_accvgpr_read_b32 v22, a34
    v_accvgpr_read_b32 v23, a35
    v_accvgpr_read_b32 v24, a36
    v_accvgpr_read_b32 v25, a37
    v_accvgpr_read_b32 v26, a38
    v_accvgpr_read_b32 v27, a39
    v_mul_f32 v20, 0x3e0293ee, v20
    v_mul_f32 v21, 0x3e0293ee, v21
    v_mul_f32 v22, 0x3e0293ee, v22
    v_mul_f32 v23, 0x3e0293ee, v23
    v_mul_f32 v24, 0x3e0293ee, v24
    v_mul_f32 v25, 0x3e0293ee, v25
    v_mul_f32 v26, 0x3e0293ee, v26
    v_mul_f32 v27, 0x3e0293ee, v27
    v_cvt_pk_bf16_f32 v36, v20, v21
    v_cvt_pk_bf16_f32 v37, v22, v23
    v_cvt_pk_bf16_f32 v38, v24, v25
    v_cvt_pk_bf16_f32 v39, v26, v27
    buffer_store_dwordx4 v[36:39], v251, s[4:7], s53 offen offset:0 sc1
    v_accvgpr_read_b32 v40, a40
    v_accvgpr_read_b32 v41, a41
    v_accvgpr_read_b32 v42, a42
    v_accvgpr_read_b32 v43, a43
    v_accvgpr_read_b32 v44, a44
    v_accvgpr_read_b32 v45, a45
    v_accvgpr_read_b32 v46, a46
    v_accvgpr_read_b32 v47, a47
    v_mul_f32 v40, 0x3e0293ee, v40
    v_mul_f32 v41, 0x3e0293ee, v41
    v_mul_f32 v42, 0x3e0293ee, v42
    v_mul_f32 v43, 0x3e0293ee, v43
    v_mul_f32 v44, 0x3e0293ee, v44
    v_mul_f32 v45, 0x3e0293ee, v45
    v_mul_f32 v46, 0x3e0293ee, v46
    v_mul_f32 v47, 0x3e0293ee, v47
    v_cvt_pk_bf16_f32 v56, v40, v41
    v_cvt_pk_bf16_f32 v57, v42, v43
    v_cvt_pk_bf16_f32 v58, v44, v45
    v_cvt_pk_bf16_f32 v59, v46, v47
    buffer_store_dwordx4 v[56:59], v251, s[4:7], s53 offen offset:1024 sc1
    v_accvgpr_read_b32 v0, a48
    v_accvgpr_read_b32 v1, a49
    v_accvgpr_read_b32 v2, a50
    v_accvgpr_read_b32 v3, a51
    v_accvgpr_read_b32 v4, a52
    v_accvgpr_read_b32 v5, a53
    v_accvgpr_read_b32 v6, a54
    v_accvgpr_read_b32 v7, a55
    v_mul_f32 v0, 0x3e0293ee, v0
    v_mul_f32 v1, 0x3e0293ee, v1
    v_mul_f32 v2, 0x3e0293ee, v2
    v_mul_f32 v3, 0x3e0293ee, v3
    v_mul_f32 v4, 0x3e0293ee, v4
    v_mul_f32 v5, 0x3e0293ee, v5
    v_mul_f32 v6, 0x3e0293ee, v6
    v_mul_f32 v7, 0x3e0293ee, v7
    v_cvt_pk_bf16_f32 v16, v0, v1
    v_cvt_pk_bf16_f32 v17, v2, v3
    v_cvt_pk_bf16_f32 v18, v4, v5
    v_cvt_pk_bf16_f32 v19, v6, v7
    buffer_store_dwordx4 v[16:19], v251, s[4:7], s53 offen offset:2048 sc1
    v_accvgpr_read_b32 v20, a56
    v_accvgpr_read_b32 v21, a57
    v_accvgpr_read_b32 v22, a58
    v_accvgpr_read_b32 v23, a59
    v_accvgpr_read_b32 v24, a60
    v_accvgpr_read_b32 v25, a61
    v_accvgpr_read_b32 v26, a62
    v_accvgpr_read_b32 v27, a63
    v_mul_f32 v20, 0x3e0293ee, v20
    v_mul_f32 v21, 0x3e0293ee, v21
    v_mul_f32 v22, 0x3e0293ee, v22
    v_mul_f32 v23, 0x3e0293ee, v23
    v_mul_f32 v24, 0x3e0293ee, v24
    v_mul_f32 v25, 0x3e0293ee, v25
    v_mul_f32 v26, 0x3e0293ee, v26
    v_mul_f32 v27, 0x3e0293ee, v27
    v_cvt_pk_bf16_f32 v36, v20, v21
    v_cvt_pk_bf16_f32 v37, v22, v23
    v_cvt_pk_bf16_f32 v38, v24, v25
    v_cvt_pk_bf16_f32 v39, v26, v27
    buffer_store_dwordx4 v[36:39], v251, s[4:7], s53 offen offset:3072 sc1
    s_add_u32 s53, s53, s22
    v_accvgpr_read_b32 v40, a64
    v_accvgpr_read_b32 v41, a65
    v_accvgpr_read_b32 v42, a66
    v_accvgpr_read_b32 v43, a67
    v_accvgpr_read_b32 v44, a68
    v_accvgpr_read_b32 v45, a69
    v_accvgpr_read_b32 v46, a70
    v_accvgpr_read_b32 v47, a71
    v_mul_f32 v40, 0x3e0293ee, v40
    v_mul_f32 v41, 0x3e0293ee, v41
    v_mul_f32 v42, 0x3e0293ee, v42
    v_mul_f32 v43, 0x3e0293ee, v43
    v_mul_f32 v44, 0x3e0293ee, v44
    v_mul_f32 v45, 0x3e0293ee, v45
    v_mul_f32 v46, 0x3e0293ee, v46
    v_mul_f32 v47, 0x3e0293ee, v47
    v_cvt_pk_bf16_f32 v56, v40, v41
    v_cvt_pk_bf16_f32 v57, v42, v43
    v_cvt_pk_bf16_f32 v58, v44, v45
    v_cvt_pk_bf16_f32 v59, v46, v47
    buffer_store_dwordx4 v[56:59], v251, s[4:7], s53 offen offset:0 sc1
    v_accvgpr_read_b32 v0, a72
    v_accvgpr_read_b32 v1, a73
    v_accvgpr_read_b32 v2, a74
    v_accvgpr_read_b32 v3, a75
    v_accvgpr_read_b32 v4, a76
    v_accvgpr_read_b32 v5, a77
    v_accvgpr_read_b32 v6, a78
    v_accvgpr_read_b32 v7, a79
    v_mul_f32 v0, 0x3e0293ee, v0
    v_mul_f32 v1, 0x3e0293ee, v1
    v_mul_f32 v2, 0x3e0293ee, v2
    v_mul_f32 v3, 0x3e0293ee, v3
    v_mul_f32 v4, 0x3e0293ee, v4
    v_mul_f32 v5, 0x3e0293ee, v5
    v_mul_f32 v6, 0x3e0293ee, v6
    v_mul_f32 v7, 0x3e0293ee, v7
    v_cvt_pk_bf16_f32 v16, v0, v1
    v_cvt_pk_bf16_f32 v17, v2, v3
    v_cvt_pk_bf16_f32 v18, v4, v5
    v_cvt_pk_bf16_f32 v19, v6, v7
    buffer_store_dwordx4 v[16:19], v251, s[4:7], s53 offen offset:1024 sc1
    v_accvgpr_read_b32 v20, a80
    v_accvgpr_read_b32 v21, a81
    v_accvgpr_read_b32 v22, a82
    v_accvgpr_read_b32 v23, a83
    v_accvgpr_read_b32 v24, a84
    v_accvgpr_read_b32 v25, a85
    v_accvgpr_read_b32 v26, a86
    v_accvgpr_read_b32 v27, a87
    v_mul_f32 v20, 0x3e0293ee, v20
    v_mul_f32 v21, 0x3e0293ee, v21
    v_mul_f32 v22, 0x3e0293ee, v22
    v_mul_f32 v23, 0x3e0293ee, v23
    v_mul_f32 v24, 0x3e0293ee, v24
    v_mul_f32 v25, 0x3e0293ee, v25
    v_mul_f32 v26, 0x3e0293ee, v26
    v_mul_f32 v27, 0x3e0293ee, v27
    v_cvt_pk_bf16_f32 v36, v20, v21
    v_cvt_pk_bf16_f32 v37, v22, v23
    v_cvt_pk_bf16_f32 v38, v24, v25
    v_cvt_pk_bf16_f32 v39, v26, v27
    buffer_store_dwordx4 v[36:39], v251, s[4:7], s53 offen offset:2048 sc1
    v_accvgpr_read_b32 v40, a88
    v_accvgpr_read_b32 v41, a89
    v_accvgpr_read_b32 v42, a90
    v_accvgpr_read_b32 v43, a91
    v_accvgpr_read_b32 v44, a92
    v_accvgpr_read_b32 v45, a93
    v_accvgpr_read_b32 v46, a94
    v_accvgpr_read_b32 v47, a95
    v_mul_f32 v40, 0x3e0293ee, v40
    v_mul_f32 v41, 0x3e0293ee, v41
    v_mul_f32 v42, 0x3e0293ee, v42
    v_mul_f32 v43, 0x3e0293ee, v43
    v_mul_f32 v44, 0x3e0293ee, v44
    v_mul_f32 v45, 0x3e0293ee, v45
    v_mul_f32 v46, 0x3e0293ee, v46
    v_mul_f32 v47, 0x3e0293ee, v47
    v_cvt_pk_bf16_f32 v56, v40, v41
    v_cvt_pk_bf16_f32 v57, v42, v43
    v_cvt_pk_bf16_f32 v58, v44, v45
    v_cvt_pk_bf16_f32 v59, v46, v47
    buffer_store_dwordx4 v[56:59], v251, s[4:7], s53 offen offset:3072 sc1
    s_add_u32 s53, s53, s22
    v_accvgpr_read_b32 v0, a96
    v_accvgpr_read_b32 v1, a97
    v_accvgpr_read_b32 v2, a98
    v_accvgpr_read_b32 v3, a99
    v_accvgpr_read_b32 v4, a100
    v_accvgpr_read_b32 v5, a101
    v_accvgpr_read_b32 v6, a102
    v_accvgpr_read_b32 v7, a103
    v_mul_f32 v0, 0x3e0293ee, v0
    v_mul_f32 v1, 0x3e0293ee, v1
    v_mul_f32 v2, 0x3e0293ee, v2
    v_mul_f32 v3, 0x3e0293ee, v3
    v_mul_f32 v4, 0x3e0293ee, v4
    v_mul_f32 v5, 0x3e0293ee, v5
    v_mul_f32 v6, 0x3e0293ee, v6
    v_mul_f32 v7, 0x3e0293ee, v7
    v_cvt_pk_bf16_f32 v16, v0, v1
    v_cvt_pk_bf16_f32 v17, v2, v3
    v_cvt_pk_bf16_f32 v18, v4, v5
    v_cvt_pk_bf16_f32 v19, v6, v7
    buffer_store_dwordx4 v[16:19], v251, s[4:7], s53 offen offset:0 sc1
    v_accvgpr_read_b32 v20, a104
    v_accvgpr_read_b32 v21, a105
    v_accvgpr_read_b32 v22, a106
    v_accvgpr_read_b32 v23, a107
    v_accvgpr_read_b32 v24, a108
    v_accvgpr_read_b32 v25, a109
    v_accvgpr_read_b32 v26, a110
    v_accvgpr_read_b32 v27, a111
    v_mul_f32 v20, 0x3e0293ee, v20
    v_mul_f32 v21, 0x3e0293ee, v21
    v_mul_f32 v22, 0x3e0293ee, v22
    v_mul_f32 v23, 0x3e0293ee, v23
    v_mul_f32 v24, 0x3e0293ee, v24
    v_mul_f32 v25, 0x3e0293ee, v25
    v_mul_f32 v26, 0x3e0293ee, v26
    v_mul_f32 v27, 0x3e0293ee, v27
    v_cvt_pk_bf16_f32 v36, v20, v21
    v_cvt_pk_bf16_f32 v37, v22, v23
    v_cvt_pk_bf16_f32 v38, v24, v25
    v_cvt_pk_bf16_f32 v39, v26, v27
    buffer_store_dwordx4 v[36:39], v251, s[4:7], s53 offen offset:1024 sc1
    v_accvgpr_read_b32 v40, a112
    v_accvgpr_read_b32 v41, a113
    v_accvgpr_read_b32 v42, a114
    v_accvgpr_read_b32 v43, a115
    v_accvgpr_read_b32 v44, a116
    v_accvgpr_read_b32 v45, a117
    v_accvgpr_read_b32 v46, a118
    v_accvgpr_read_b32 v47, a119
    v_mul_f32 v40, 0x3e0293ee, v40
    v_mul_f32 v41, 0x3e0293ee, v41
    v_mul_f32 v42, 0x3e0293ee, v42
    v_mul_f32 v43, 0x3e0293ee, v43
    v_mul_f32 v44, 0x3e0293ee, v44
    v_mul_f32 v45, 0x3e0293ee, v45
    v_mul_f32 v46, 0x3e0293ee, v46
    v_mul_f32 v47, 0x3e0293ee, v47
    v_cvt_pk_bf16_f32 v56, v40, v41
    v_cvt_pk_bf16_f32 v57, v42, v43
    v_cvt_pk_bf16_f32 v58, v44, v45
    v_cvt_pk_bf16_f32 v59, v46, v47
    buffer_store_dwordx4 v[56:59], v251, s[4:7], s53 offen offset:2048 sc1
    v_accvgpr_read_b32 v0, a120
    v_accvgpr_read_b32 v1, a121
    v_accvgpr_read_b32 v2, a122
    v_accvgpr_read_b32 v3, a123
    v_accvgpr_read_b32 v4, a124
    v_accvgpr_read_b32 v5, a125
    v_accvgpr_read_b32 v6, a126
    v_accvgpr_read_b32 v7, a127
    v_mul_f32 v0, 0x3e0293ee, v0
    v_mul_f32 v1, 0x3e0293ee, v1
    v_mul_f32 v2, 0x3e0293ee, v2
    v_mul_f32 v3, 0x3e0293ee, v3
    v_mul_f32 v4, 0x3e0293ee, v4
    v_mul_f32 v5, 0x3e0293ee, v5
    v_mul_f32 v6, 0x3e0293ee, v6
    v_mul_f32 v7, 0x3e0293ee, v7
    v_cvt_pk_bf16_f32 v16, v0, v1
    v_cvt_pk_bf16_f32 v17, v2, v3
    v_cvt_pk_bf16_f32 v18, v4, v5
    v_cvt_pk_bf16_f32 v19, v6, v7
    buffer_store_dwordx4 v[16:19], v251, s[4:7], s53 offen offset:3072 sc1
    s_add_u32 s53, s53, s22
    v_accvgpr_read_b32 v20, a128
    v_accvgpr_read_b32 v21, a129
    v_accvgpr_read_b32 v22, a130
    v_accvgpr_read_b32 v23, a131
    v_accvgpr_read_b32 v24, a132
    v_accvgpr_read_b32 v25, a133
    v_accvgpr_read_b32 v26, a134
    v_accvgpr_read_b32 v27, a135
    v_mul_f32 v20, 0x3e0293ee, v20
    v_mul_f32 v21, 0x3e0293ee, v21
    v_mul_f32 v22, 0x3e0293ee, v22
    v_mul_f32 v23, 0x3e0293ee, v23
    v_mul_f32 v24, 0x3e0293ee, v24
    v_mul_f32 v25, 0x3e0293ee, v25
    v_mul_f32 v26, 0x3e0293ee, v26
    v_mul_f32 v27, 0x3e0293ee, v27
    v_cvt_pk_bf16_f32 v36, v20, v21
    v_cvt_pk_bf16_f32 v37, v22, v23
    v_cvt_pk_bf16_f32 v38, v24, v25
    v_cvt_pk_bf16_f32 v39, v26, v27
    buffer_store_dwordx4 v[36:39], v251, s[4:7], s53 offen offset:0 sc1
    v_accvgpr_read_b32 v40, a136
    v_accvgpr_read_b32 v41, a137
    v_accvgpr_read_b32 v42, a138
    v_accvgpr_read_b32 v43, a139
    v_accvgpr_read_b32 v44, a140
    v_accvgpr_read_b32 v45, a141
    v_accvgpr_read_b32 v46, a142
    v_accvgpr_read_b32 v47, a143
    v_mul_f32 v40, 0x3e0293ee, v40
    v_mul_f32 v41, 0x3e0293ee, v41
    v_mul_f32 v42, 0x3e0293ee, v42
    v_mul_f32 v43, 0x3e0293ee, v43
    v_mul_f32 v44, 0x3e0293ee, v44
    v_mul_f32 v45, 0x3e0293ee, v45
    v_mul_f32 v46, 0x3e0293ee, v46
    v_mul_f32 v47, 0x3e0293ee, v47
    v_cvt_pk_bf16_f32 v56, v40, v41
    v_cvt_pk_bf16_f32 v57, v42, v43
    v_cvt_pk_bf16_f32 v58, v44, v45
    v_cvt_pk_bf16_f32 v59, v46, v47
    buffer_store_dwordx4 v[56:59], v251, s[4:7], s53 offen offset:1024 sc1
    v_accvgpr_read_b32 v0, a144
    v_accvgpr_read_b32 v1, a145
    v_accvgpr_read_b32 v2, a146
    v_accvgpr_read_b32 v3, a147
    v_accvgpr_read_b32 v4, a148
    v_accvgpr_read_b32 v5, a149
    v_accvgpr_read_b32 v6, a150
    v_accvgpr_read_b32 v7, a151
    v_mul_f32 v0, 0x3e0293ee, v0
    v_mul_f32 v1, 0x3e0293ee, v1
    v_mul_f32 v2, 0x3e0293ee, v2
    v_mul_f32 v3, 0x3e0293ee, v3
    v_mul_f32 v4, 0x3e0293ee, v4
    v_mul_f32 v5, 0x3e0293ee, v5
    v_mul_f32 v6, 0x3e0293ee, v6
    v_mul_f32 v7, 0x3e0293ee, v7
    v_cvt_pk_bf16_f32 v16, v0, v1
    v_cvt_pk_bf16_f32 v17, v2, v3
    v_cvt_pk_bf16_f32 v18, v4, v5
    v_cvt_pk_bf16_f32 v19, v6, v7
    buffer_store_dwordx4 v[16:19], v251, s[4:7], s53 offen offset:2048 sc1
    v_accvgpr_read_b32 v20, a152
    v_accvgpr_read_b32 v21, a153
    v_accvgpr_read_b32 v22, a154
    v_accvgpr_read_b32 v23, a155
    v_accvgpr_read_b32 v24, a156
    v_accvgpr_read_b32 v25, a157
    v_accvgpr_read_b32 v26, a158
    v_accvgpr_read_b32 v27, a159
    v_mul_f32 v20, 0x3e0293ee, v20
    v_mul_f32 v21, 0x3e0293ee, v21
    v_mul_f32 v22, 0x3e0293ee, v22
    v_mul_f32 v23, 0x3e0293ee, v23
    v_mul_f32 v24, 0x3e0293ee, v24
    v_mul_f32 v25, 0x3e0293ee, v25
    v_mul_f32 v26, 0x3e0293ee, v26
    v_mul_f32 v27, 0x3e0293ee, v27
    v_cvt_pk_bf16_f32 v36, v20, v21
    v_cvt_pk_bf16_f32 v37, v22, v23
    v_cvt_pk_bf16_f32 v38, v24, v25
    v_cvt_pk_bf16_f32 v39, v26, v27
    buffer_store_dwordx4 v[36:39], v251, s[4:7], s53 offen offset:3072 sc1
    s_add_u32 s53, s53, s22
    v_accvgpr_read_b32 v40, a160
    v_accvgpr_read_b32 v41, a161
    v_accvgpr_read_b32 v42, a162
    v_accvgpr_read_b32 v43, a163
    v_accvgpr_read_b32 v44, a164
    v_accvgpr_read_b32 v45, a165
    v_accvgpr_read_b32 v46, a166
    v_accvgpr_read_b32 v47, a167
    v_mul_f32 v40, 0x3e0293ee, v40
    v_mul_f32 v41, 0x3e0293ee, v41
    v_mul_f32 v42, 0x3e0293ee, v42
    v_mul_f32 v43, 0x3e0293ee, v43
    v_mul_f32 v44, 0x3e0293ee, v44
    v_mul_f32 v45, 0x3e0293ee, v45
    v_mul_f32 v46, 0x3e0293ee, v46
    v_mul_f32 v47, 0x3e0293ee, v47
    v_cvt_pk_bf16_f32 v56, v40, v41
    v_cvt_pk_bf16_f32 v57, v42, v43
    v_cvt_pk_bf16_f32 v58, v44, v45
    v_cvt_pk_bf16_f32 v59, v46, v47
    buffer_store_dwordx4 v[56:59], v251, s[4:7], s53 offen offset:0 sc1
    v_accvgpr_read_b32 v0, a168
    v_accvgpr_read_b32 v1, a169
    v_accvgpr_read_b32 v2, a170
    v_accvgpr_read_b32 v3, a171
    v_accvgpr_read_b32 v4, a172
    v_accvgpr_read_b32 v5, a173
    v_accvgpr_read_b32 v6, a174
    v_accvgpr_read_b32 v7, a175
    v_mul_f32 v0, 0x3e0293ee, v0
    v_mul_f32 v1, 0x3e0293ee, v1
    v_mul_f32 v2, 0x3e0293ee, v2
    v_mul_f32 v3, 0x3e0293ee, v3
    v_mul_f32 v4, 0x3e0293ee, v4
    v_mul_f32 v5, 0x3e0293ee, v5
    v_mul_f32 v6, 0x3e0293ee, v6
    v_mul_f32 v7, 0x3e0293ee, v7
    v_cvt_pk_bf16_f32 v16, v0, v1
    v_cvt_pk_bf16_f32 v17, v2, v3
    v_cvt_pk_bf16_f32 v18, v4, v5
    v_cvt_pk_bf16_f32 v19, v6, v7
    buffer_store_dwordx4 v[16:19], v251, s[4:7], s53 offen offset:1024 sc1
    v_accvgpr_read_b32 v20, a176
    v_accvgpr_read_b32 v21, a177
    v_accvgpr_read_b32 v22, a178
    v_accvgpr_read_b32 v23, a179
    v_accvgpr_read_b32 v24, a180
    v_accvgpr_read_b32 v25, a181
    v_accvgpr_read_b32 v26, a182
    v_accvgpr_read_b32 v27, a183
    v_mul_f32 v20, 0x3e0293ee, v20
    v_mul_f32 v21, 0x3e0293ee, v21
    v_mul_f32 v22, 0x3e0293ee, v22
    v_mul_f32 v23, 0x3e0293ee, v23
    v_mul_f32 v24, 0x3e0293ee, v24
    v_mul_f32 v25, 0x3e0293ee, v25
    v_mul_f32 v26, 0x3e0293ee, v26
    v_mul_f32 v27, 0x3e0293ee, v27
    v_cvt_pk_bf16_f32 v36, v20, v21
    v_cvt_pk_bf16_f32 v37, v22, v23
    v_cvt_pk_bf16_f32 v38, v24, v25
    v_cvt_pk_bf16_f32 v39, v26, v27
    buffer_store_dwordx4 v[36:39], v251, s[4:7], s53 offen offset:2048 sc1
    v_accvgpr_read_b32 v40, a184
    v_accvgpr_read_b32 v41, a185
    v_accvgpr_read_b32 v42, a186
    v_accvgpr_read_b32 v43, a187
    v_accvgpr_read_b32 v44, a188
    v_accvgpr_read_b32 v45, a189
    v_accvgpr_read_b32 v46, a190
    v_accvgpr_read_b32 v47, a191
    v_mul_f32 v40, 0x3e0293ee, v40
    v_mul_f32 v41, 0x3e0293ee, v41
    v_mul_f32 v42, 0x3e0293ee, v42
    v_mul_f32 v43, 0x3e0293ee, v43
    v_mul_f32 v44, 0x3e0293ee, v44
    v_mul_f32 v45, 0x3e0293ee, v45
    v_mul_f32 v46, 0x3e0293ee, v46
    v_mul_f32 v47, 0x3e0293ee, v47
    v_cvt_pk_bf16_f32 v56, v40, v41
    v_cvt_pk_bf16_f32 v57, v42, v43
    v_cvt_pk_bf16_f32 v58, v44, v45
    v_cvt_pk_bf16_f32 v59, v46, v47
    buffer_store_dwordx4 v[56:59], v251, s[4:7], s53 offen offset:3072 sc1
    s_add_u32 s53, s53, s22
    v_accvgpr_read_b32 v0, a192
    v_accvgpr_read_b32 v1, a193
    v_accvgpr_read_b32 v2, a194
    v_accvgpr_read_b32 v3, a195
    v_accvgpr_read_b32 v4, a196
    v_accvgpr_read_b32 v5, a197
    v_accvgpr_read_b32 v6, a198
    v_accvgpr_read_b32 v7, a199
    v_mul_f32 v0, 0x3e0293ee, v0
    v_mul_f32 v1, 0x3e0293ee, v1
    v_mul_f32 v2, 0x3e0293ee, v2
    v_mul_f32 v3, 0x3e0293ee, v3
    v_mul_f32 v4, 0x3e0293ee, v4
    v_mul_f32 v5, 0x3e0293ee, v5
    v_mul_f32 v6, 0x3e0293ee, v6
    v_mul_f32 v7, 0x3e0293ee, v7
    v_cvt_pk_bf16_f32 v16, v0, v1
    v_cvt_pk_bf16_f32 v17, v2, v3
    v_cvt_pk_bf16_f32 v18, v4, v5
    v_cvt_pk_bf16_f32 v19, v6, v7
    buffer_store_dwordx4 v[16:19], v251, s[4:7], s53 offen offset:0 sc1
    v_accvgpr_read_b32 v20, a200
    v_accvgpr_read_b32 v21, a201
    v_accvgpr_read_b32 v22, a202
    v_accvgpr_read_b32 v23, a203
    v_accvgpr_read_b32 v24, a204
    v_accvgpr_read_b32 v25, a205
    v_accvgpr_read_b32 v26, a206
    v_accvgpr_read_b32 v27, a207
    v_mul_f32 v20, 0x3e0293ee, v20
    v_mul_f32 v21, 0x3e0293ee, v21
    v_mul_f32 v22, 0x3e0293ee, v22
    v_mul_f32 v23, 0x3e0293ee, v23
    v_mul_f32 v24, 0x3e0293ee, v24
    v_mul_f32 v25, 0x3e0293ee, v25
    v_mul_f32 v26, 0x3e0293ee, v26
    v_mul_f32 v27, 0x3e0293ee, v27
    v_cvt_pk_bf16_f32 v36, v20, v21
    v_cvt_pk_bf16_f32 v37, v22, v23
    v_cvt_pk_bf16_f32 v38, v24, v25
    v_cvt_pk_bf16_f32 v39, v26, v27
    buffer_store_dwordx4 v[36:39], v251, s[4:7], s53 offen offset:1024 sc1
    v_accvgpr_read_b32 v40, a208
    v_accvgpr_read_b32 v41, a209
    v_accvgpr_read_b32 v42, a210
    v_accvgpr_read_b32 v43, a211
    v_accvgpr_read_b32 v44, a212
    v_accvgpr_read_b32 v45, a213
    v_accvgpr_read_b32 v46, a214
    v_accvgpr_read_b32 v47, a215
    v_mul_f32 v40, 0x3e0293ee, v40
    v_mul_f32 v41, 0x3e0293ee, v41
    v_mul_f32 v42, 0x3e0293ee, v42
    v_mul_f32 v43, 0x3e0293ee, v43
    v_mul_f32 v44, 0x3e0293ee, v44
    v_mul_f32 v45, 0x3e0293ee, v45
    v_mul_f32 v46, 0x3e0293ee, v46
    v_mul_f32 v47, 0x3e0293ee, v47
    v_cvt_pk_bf16_f32 v56, v40, v41
    v_cvt_pk_bf16_f32 v57, v42, v43
    v_cvt_pk_bf16_f32 v58, v44, v45
    v_cvt_pk_bf16_f32 v59, v46, v47
    buffer_store_dwordx4 v[56:59], v251, s[4:7], s53 offen offset:2048 sc1
    v_accvgpr_read_b32 v0, a216
    v_accvgpr_read_b32 v1, a217
    v_accvgpr_read_b32 v2, a218
    v_accvgpr_read_b32 v3, a219
    v_accvgpr_read_b32 v4, a220
    v_accvgpr_read_b32 v5, a221
    v_accvgpr_read_b32 v6, a222
    v_accvgpr_read_b32 v7, a223
    v_mul_f32 v0, 0x3e0293ee, v0
    v_mul_f32 v1, 0x3e0293ee, v1
    v_mul_f32 v2, 0x3e0293ee, v2
    v_mul_f32 v3, 0x3e0293ee, v3
    v_mul_f32 v4, 0x3e0293ee, v4
    v_mul_f32 v5, 0x3e0293ee, v5
    v_mul_f32 v6, 0x3e0293ee, v6
    v_mul_f32 v7, 0x3e0293ee, v7
    v_cvt_pk_bf16_f32 v16, v0, v1
    v_cvt_pk_bf16_f32 v17, v2, v3
    v_cvt_pk_bf16_f32 v18, v4, v5
    v_cvt_pk_bf16_f32 v19, v6, v7
    buffer_store_dwordx4 v[16:19], v251, s[4:7], s53 offen offset:3072 sc1
    s_add_u32 s53, s53, s22
    v_accvgpr_read_b32 v20, a224
    v_accvgpr_read_b32 v21, a225
    v_accvgpr_read_b32 v22, a226
    v_accvgpr_read_b32 v23, a227
    v_accvgpr_read_b32 v24, a228
    v_accvgpr_read_b32 v25, a229
    v_accvgpr_read_b32 v26, a230
    v_accvgpr_read_b32 v27, a231
    v_mul_f32 v20, 0x3e0293ee, v20
    v_mul_f32 v21, 0x3e0293ee, v21
    v_mul_f32 v22, 0x3e0293ee, v22
    v_mul_f32 v23, 0x3e0293ee, v23
    v_mul_f32 v24, 0x3e0293ee, v24
    v_mul_f32 v25, 0x3e0293ee, v25
    v_mul_f32 v26, 0x3e0293ee, v26
    v_mul_f32 v27, 0x3e0293ee, v27
    v_cvt_pk_bf16_f32 v36, v20, v21
    v_cvt_pk_bf16_f32 v37, v22, v23
    v_cvt_pk_bf16_f32 v38, v24, v25
    v_cvt_pk_bf16_f32 v39, v26, v27
    buffer_store_dwordx4 v[36:39], v251, s[4:7], s53 offen offset:0 sc1
    v_accvgpr_read_b32 v40, a232
    v_accvgpr_read_b32 v41, a233
    v_accvgpr_read_b32 v42, a234
    v_accvgpr_read_b32 v43, a235
    v_accvgpr_read_b32 v44, a236
    v_accvgpr_read_b32 v45, a237
    v_accvgpr_read_b32 v46, a238
    v_accvgpr_read_b32 v47, a239
    v_mul_f32 v40, 0x3e0293ee, v40
    v_mul_f32 v41, 0x3e0293ee, v41
    v_mul_f32 v42, 0x3e0293ee, v42
    v_mul_f32 v43, 0x3e0293ee, v43
    v_mul_f32 v44, 0x3e0293ee, v44
    v_mul_f32 v45, 0x3e0293ee, v45
    v_mul_f32 v46, 0x3e0293ee, v46
    v_mul_f32 v47, 0x3e0293ee, v47
    v_cvt_pk_bf16_f32 v56, v40, v41
    v_cvt_pk_bf16_f32 v57, v42, v43
    v_cvt_pk_bf16_f32 v58, v44, v45
    v_cvt_pk_bf16_f32 v59, v46, v47
    buffer_store_dwordx4 v[56:59], v251, s[4:7], s53 offen offset:1024 sc1
    v_accvgpr_read_b32 v0, a240
    v_accvgpr_read_b32 v1, a241
    v_accvgpr_read_b32 v2, a242
    v_accvgpr_read_b32 v3, a243
    v_accvgpr_read_b32 v4, a244
    v_accvgpr_read_b32 v5, a245
    v_accvgpr_read_b32 v6, a246
    v_accvgpr_read_b32 v7, a247
    v_mul_f32 v0, 0x3e0293ee, v0
    v_mul_f32 v1, 0x3e0293ee, v1
    v_mul_f32 v2, 0x3e0293ee, v2
    v_mul_f32 v3, 0x3e0293ee, v3
    v_mul_f32 v4, 0x3e0293ee, v4
    v_mul_f32 v5, 0x3e0293ee, v5
    v_mul_f32 v6, 0x3e0293ee, v6
    v_mul_f32 v7, 0x3e0293ee, v7
    v_cvt_pk_bf16_f32 v16, v0, v1
    v_cvt_pk_bf16_f32 v17, v2, v3
    v_cvt_pk_bf16_f32 v18, v4, v5
    v_cvt_pk_bf16_f32 v19, v6, v7
    buffer_store_dwordx4 v[16:19], v251, s[4:7], s53 offen offset:2048 sc1
    v_accvgpr_read_b32 v20, a248
    v_accvgpr_read_b32 v21, a249
    v_accvgpr_read_b32 v22, a250
    v_accvgpr_read_b32 v23, a251
    v_accvgpr_read_b32 v24, a252
    v_accvgpr_read_b32 v25, a253
    v_accvgpr_read_b32 v26, a254
    v_accvgpr_read_b32 v27, a255
    v_mul_f32 v20, 0x3e0293ee, v20
    v_mul_f32 v21, 0x3e0293ee, v21
    v_mul_f32 v22, 0x3e0293ee, v22
    v_mul_f32 v23, 0x3e0293ee, v23
    v_mul_f32 v24, 0x3e0293ee, v24
    v_mul_f32 v25, 0x3e0293ee, v25
    v_mul_f32 v26, 0x3e0293ee, v26
    v_mul_f32 v27, 0x3e0293ee, v27
    v_cvt_pk_bf16_f32 v36, v20, v21
    v_cvt_pk_bf16_f32 v37, v22, v23
    v_cvt_pk_bf16_f32 v38, v24, v25
    v_cvt_pk_bf16_f32 v39, v26, v27
    buffer_store_dwordx4 v[36:39], v251, s[4:7], s53 offen offset:3072 sc1
    s_branch main_kernel_w_done
main_kernel_w_c2_egelu:
    s_mov_b32 s53, s21
    v_accvgpr_read_b32 v0, a0
    v_accvgpr_read_b32 v1, a1
    v_accvgpr_read_b32 v2, a2
    v_accvgpr_read_b32 v3, a3
    v_accvgpr_read_b32 v4, a4
    v_accvgpr_read_b32 v5, a5
    v_accvgpr_read_b32 v6, a6
    v_accvgpr_read_b32 v7, a7
    v_pk_mul_f32 v[8:9], v[0:1], v[0:1]
    v_pk_mul_f32 v[10:11], v[2:3], v[2:3]
    v_pk_mul_f32 v[12:13], v[4:5], v[4:5]
    v_pk_mul_f32 v[14:15], v[6:7], v[6:7]
    v_pk_fma_f32 v[8:9], v[8:9], v[242:243], v[240:241]
    v_pk_fma_f32 v[10:11], v[10:11], v[242:243], v[240:241]
    v_pk_fma_f32 v[12:13], v[12:13], v[242:243], v[240:241]
    v_pk_fma_f32 v[14:15], v[14:15], v[242:243], v[240:241]
    v_pk_mul_f32 v[8:9], v[8:9], v[0:1]
    v_pk_mul_f32 v[10:11], v[10:11], v[2:3]
    v_pk_mul_f32 v[12:13], v[12:13], v[4:5]
    v_pk_mul_f32 v[14:15], v[14:15], v[6:7]
    v_exp_f32 v8, v8
    v_exp_f32 v9, v9
    v_exp_f32 v10, v10
    v_exp_f32 v11, v11
    v_exp_f32 v12, v12
    v_exp_f32 v13, v13
    v_exp_f32 v14, v14
    v_exp_f32 v15, v15
    v_pk_add_f32 v[8:9], v[8:9], v[244:245]
    v_pk_add_f32 v[10:11], v[10:11], v[244:245]
    v_pk_add_f32 v[12:13], v[12:13], v[244:245]
    v_pk_add_f32 v[14:15], v[14:15], v[244:245]
    v_rcp_f32 v8, v8
    v_rcp_f32 v9, v9
    v_rcp_f32 v10, v10
    v_rcp_f32 v11, v11
    v_rcp_f32 v12, v12
    v_rcp_f32 v13, v13
    v_rcp_f32 v14, v14
    v_rcp_f32 v15, v15
    v_pk_mul_f32 v[0:1], v[8:9], v[0:1]
    v_pk_mul_f32 v[2:3], v[10:11], v[2:3]
    v_pk_mul_f32 v[4:5], v[12:13], v[4:5]
    v_pk_mul_f32 v[6:7], v[14:15], v[6:7]
    v_cvt_pk_bf16_f32 v16, v0, v1
    v_cvt_pk_bf16_f32 v17, v2, v3
    v_cvt_pk_bf16_f32 v18, v4, v5
    v_cvt_pk_bf16_f32 v19, v6, v7
    buffer_store_dwordx4 v[16:19], v251, s[4:7], s53 offen offset:0 sc1
    v_accvgpr_read_b32 v20, a8
    v_accvgpr_read_b32 v21, a9
    v_accvgpr_read_b32 v22, a10
    v_accvgpr_read_b32 v23, a11
    v_accvgpr_read_b32 v24, a12
    v_accvgpr_read_b32 v25, a13
    v_accvgpr_read_b32 v26, a14
    v_accvgpr_read_b32 v27, a15
    v_pk_mul_f32 v[28:29], v[20:21], v[20:21]
    v_pk_mul_f32 v[30:31], v[22:23], v[22:23]
    v_pk_mul_f32 v[32:33], v[24:25], v[24:25]
    v_pk_mul_f32 v[34:35], v[26:27], v[26:27]
    v_pk_fma_f32 v[28:29], v[28:29], v[242:243], v[240:241]
    v_pk_fma_f32 v[30:31], v[30:31], v[242:243], v[240:241]
    v_pk_fma_f32 v[32:33], v[32:33], v[242:243], v[240:241]
    v_pk_fma_f32 v[34:35], v[34:35], v[242:243], v[240:241]
    v_pk_mul_f32 v[28:29], v[28:29], v[20:21]
    v_pk_mul_f32 v[30:31], v[30:31], v[22:23]
    v_pk_mul_f32 v[32:33], v[32:33], v[24:25]
    v_pk_mul_f32 v[34:35], v[34:35], v[26:27]
    v_exp_f32 v28, v28
    v_exp_f32 v29, v29
    v_exp_f32 v30, v30
    v_exp_f32 v31, v31
    v_exp_f32 v32, v32
    v_exp_f32 v33, v33
    v_exp_f32 v34, v34
    v_exp_f32 v35, v35
    v_pk_add_f32 v[28:29], v[28:29], v[244:245]
    v_pk_add_f32 v[30:31], v[30:31], v[244:245]
    v_pk_add_f32 v[32:33], v[32:33], v[244:245]
    v_pk_add_f32 v[34:35], v[34:35], v[244:245]
    v_rcp_f32 v28, v28
    v_rcp_f32 v29, v29
    v_rcp_f32 v30, v30
    v_rcp_f32 v31, v31
    v_rcp_f32 v32, v32
    v_rcp_f32 v33, v33
    v_rcp_f32 v34, v34
    v_rcp_f32 v35, v35
    v_pk_mul_f32 v[20:21], v[28:29], v[20:21]
    v_pk_mul_f32 v[22:23], v[30:31], v[22:23]
    v_pk_mul_f32 v[24:25], v[32:33], v[24:25]
    v_pk_mul_f32 v[26:27], v[34:35], v[26:27]
    v_cvt_pk_bf16_f32 v36, v20, v21
    v_cvt_pk_bf16_f32 v37, v22, v23
    v_cvt_pk_bf16_f32 v38, v24, v25
    v_cvt_pk_bf16_f32 v39, v26, v27
    buffer_store_dwordx4 v[36:39], v251, s[4:7], s53 offen offset:1024 sc1
    v_accvgpr_read_b32 v40, a16
    v_accvgpr_read_b32 v41, a17
    v_accvgpr_read_b32 v42, a18
    v_accvgpr_read_b32 v43, a19
    v_accvgpr_read_b32 v44, a20
    v_accvgpr_read_b32 v45, a21
    v_accvgpr_read_b32 v46, a22
    v_accvgpr_read_b32 v47, a23
    v_pk_mul_f32 v[48:49], v[40:41], v[40:41]
    v_pk_mul_f32 v[50:51], v[42:43], v[42:43]
    v_pk_mul_f32 v[52:53], v[44:45], v[44:45]
    v_pk_mul_f32 v[54:55], v[46:47], v[46:47]
    v_pk_fma_f32 v[48:49], v[48:49], v[242:243], v[240:241]
    v_pk_fma_f32 v[50:51], v[50:51], v[242:243], v[240:241]
    v_pk_fma_f32 v[52:53], v[52:53], v[242:243], v[240:241]
    v_pk_fma_f32 v[54:55], v[54:55], v[242:243], v[240:241]
    v_pk_mul_f32 v[48:49], v[48:49], v[40:41]
    v_pk_mul_f32 v[50:51], v[50:51], v[42:43]
    v_pk_mul_f32 v[52:53], v[52:53], v[44:45]
    v_pk_mul_f32 v[54:55], v[54:55], v[46:47]
    v_exp_f32 v48, v48
    v_exp_f32 v49, v49
    v_exp_f32 v50, v50
    v_exp_f32 v51, v51
    v_exp_f32 v52, v52
    v_exp_f32 v53, v53
    v_exp_f32 v54, v54
    v_exp_f32 v55, v55
    v_pk_add_f32 v[48:49], v[48:49], v[244:245]
    v_pk_add_f32 v[50:51], v[50:51], v[244:245]
    v_pk_add_f32 v[52:53], v[52:53], v[244:245]
    v_pk_add_f32 v[54:55], v[54:55], v[244:245]
    v_rcp_f32 v48, v48
    v_rcp_f32 v49, v49
    v_rcp_f32 v50, v50
    v_rcp_f32 v51, v51
    v_rcp_f32 v52, v52
    v_rcp_f32 v53, v53
    v_rcp_f32 v54, v54
    v_rcp_f32 v55, v55
    v_pk_mul_f32 v[40:41], v[48:49], v[40:41]
    v_pk_mul_f32 v[42:43], v[50:51], v[42:43]
    v_pk_mul_f32 v[44:45], v[52:53], v[44:45]
    v_pk_mul_f32 v[46:47], v[54:55], v[46:47]
    v_cvt_pk_bf16_f32 v56, v40, v41
    v_cvt_pk_bf16_f32 v57, v42, v43
    v_cvt_pk_bf16_f32 v58, v44, v45
    v_cvt_pk_bf16_f32 v59, v46, v47
    buffer_store_dwordx4 v[56:59], v251, s[4:7], s53 offen offset:2048 sc1
    v_accvgpr_read_b32 v0, a24
    v_accvgpr_read_b32 v1, a25
    v_accvgpr_read_b32 v2, a26
    v_accvgpr_read_b32 v3, a27
    v_accvgpr_read_b32 v4, a28
    v_accvgpr_read_b32 v5, a29
    v_accvgpr_read_b32 v6, a30
    v_accvgpr_read_b32 v7, a31
    v_pk_mul_f32 v[8:9], v[0:1], v[0:1]
    v_pk_mul_f32 v[10:11], v[2:3], v[2:3]
    v_pk_mul_f32 v[12:13], v[4:5], v[4:5]
    v_pk_mul_f32 v[14:15], v[6:7], v[6:7]
    v_pk_fma_f32 v[8:9], v[8:9], v[242:243], v[240:241]
    v_pk_fma_f32 v[10:11], v[10:11], v[242:243], v[240:241]
    v_pk_fma_f32 v[12:13], v[12:13], v[242:243], v[240:241]
    v_pk_fma_f32 v[14:15], v[14:15], v[242:243], v[240:241]
    v_pk_mul_f32 v[8:9], v[8:9], v[0:1]
    v_pk_mul_f32 v[10:11], v[10:11], v[2:3]
    v_pk_mul_f32 v[12:13], v[12:13], v[4:5]
    v_pk_mul_f32 v[14:15], v[14:15], v[6:7]
    v_exp_f32 v8, v8
    v_exp_f32 v9, v9
    v_exp_f32 v10, v10
    v_exp_f32 v11, v11
    v_exp_f32 v12, v12
    v_exp_f32 v13, v13
    v_exp_f32 v14, v14
    v_exp_f32 v15, v15
    v_pk_add_f32 v[8:9], v[8:9], v[244:245]
    v_pk_add_f32 v[10:11], v[10:11], v[244:245]
    v_pk_add_f32 v[12:13], v[12:13], v[244:245]
    v_pk_add_f32 v[14:15], v[14:15], v[244:245]
    v_rcp_f32 v8, v8
    v_rcp_f32 v9, v9
    v_rcp_f32 v10, v10
    v_rcp_f32 v11, v11
    v_rcp_f32 v12, v12
    v_rcp_f32 v13, v13
    v_rcp_f32 v14, v14
    v_rcp_f32 v15, v15
    v_pk_mul_f32 v[0:1], v[8:9], v[0:1]
    v_pk_mul_f32 v[2:3], v[10:11], v[2:3]
    v_pk_mul_f32 v[4:5], v[12:13], v[4:5]
    v_pk_mul_f32 v[6:7], v[14:15], v[6:7]
    v_cvt_pk_bf16_f32 v16, v0, v1
    v_cvt_pk_bf16_f32 v17, v2, v3
    v_cvt_pk_bf16_f32 v18, v4, v5
    v_cvt_pk_bf16_f32 v19, v6, v7
    buffer_store_dwordx4 v[16:19], v251, s[4:7], s53 offen offset:3072 sc1
    s_add_u32 s53, s53, s22
    v_accvgpr_read_b32 v20, a32
    v_accvgpr_read_b32 v21, a33
    v_accvgpr_read_b32 v22, a34
    v_accvgpr_read_b32 v23, a35
    v_accvgpr_read_b32 v24, a36
    v_accvgpr_read_b32 v25, a37
    v_accvgpr_read_b32 v26, a38
    v_accvgpr_read_b32 v27, a39
    v_pk_mul_f32 v[28:29], v[20:21], v[20:21]
    v_pk_mul_f32 v[30:31], v[22:23], v[22:23]
    v_pk_mul_f32 v[32:33], v[24:25], v[24:25]
    v_pk_mul_f32 v[34:35], v[26:27], v[26:27]
    v_pk_fma_f32 v[28:29], v[28:29], v[242:243], v[240:241]
    v_pk_fma_f32 v[30:31], v[30:31], v[242:243], v[240:241]
    v_pk_fma_f32 v[32:33], v[32:33], v[242:243], v[240:241]
    v_pk_fma_f32 v[34:35], v[34:35], v[242:243], v[240:241]
    v_pk_mul_f32 v[28:29], v[28:29], v[20:21]
    v_pk_mul_f32 v[30:31], v[30:31], v[22:23]
    v_pk_mul_f32 v[32:33], v[32:33], v[24:25]
    v_pk_mul_f32 v[34:35], v[34:35], v[26:27]
    v_exp_f32 v28, v28
    v_exp_f32 v29, v29
    v_exp_f32 v30, v30
    v_exp_f32 v31, v31
    v_exp_f32 v32, v32
    v_exp_f32 v33, v33
    v_exp_f32 v34, v34
    v_exp_f32 v35, v35
    v_pk_add_f32 v[28:29], v[28:29], v[244:245]
    v_pk_add_f32 v[30:31], v[30:31], v[244:245]
    v_pk_add_f32 v[32:33], v[32:33], v[244:245]
    v_pk_add_f32 v[34:35], v[34:35], v[244:245]
    v_rcp_f32 v28, v28
    v_rcp_f32 v29, v29
    v_rcp_f32 v30, v30
    v_rcp_f32 v31, v31
    v_rcp_f32 v32, v32
    v_rcp_f32 v33, v33
    v_rcp_f32 v34, v34
    v_rcp_f32 v35, v35
    v_pk_mul_f32 v[20:21], v[28:29], v[20:21]
    v_pk_mul_f32 v[22:23], v[30:31], v[22:23]
    v_pk_mul_f32 v[24:25], v[32:33], v[24:25]
    v_pk_mul_f32 v[26:27], v[34:35], v[26:27]
    v_cvt_pk_bf16_f32 v36, v20, v21
    v_cvt_pk_bf16_f32 v37, v22, v23
    v_cvt_pk_bf16_f32 v38, v24, v25
    v_cvt_pk_bf16_f32 v39, v26, v27
    buffer_store_dwordx4 v[36:39], v251, s[4:7], s53 offen offset:0 sc1
    v_accvgpr_read_b32 v40, a40
    v_accvgpr_read_b32 v41, a41
    v_accvgpr_read_b32 v42, a42
    v_accvgpr_read_b32 v43, a43
    v_accvgpr_read_b32 v44, a44
    v_accvgpr_read_b32 v45, a45
    v_accvgpr_read_b32 v46, a46
    v_accvgpr_read_b32 v47, a47
    v_pk_mul_f32 v[48:49], v[40:41], v[40:41]
    v_pk_mul_f32 v[50:51], v[42:43], v[42:43]
    v_pk_mul_f32 v[52:53], v[44:45], v[44:45]
    v_pk_mul_f32 v[54:55], v[46:47], v[46:47]
    v_pk_fma_f32 v[48:49], v[48:49], v[242:243], v[240:241]
    v_pk_fma_f32 v[50:51], v[50:51], v[242:243], v[240:241]
    v_pk_fma_f32 v[52:53], v[52:53], v[242:243], v[240:241]
    v_pk_fma_f32 v[54:55], v[54:55], v[242:243], v[240:241]
    v_pk_mul_f32 v[48:49], v[48:49], v[40:41]
    v_pk_mul_f32 v[50:51], v[50:51], v[42:43]
    v_pk_mul_f32 v[52:53], v[52:53], v[44:45]
    v_pk_mul_f32 v[54:55], v[54:55], v[46:47]
    v_exp_f32 v48, v48
    v_exp_f32 v49, v49
    v_exp_f32 v50, v50
    v_exp_f32 v51, v51
    v_exp_f32 v52, v52
    v_exp_f32 v53, v53
    v_exp_f32 v54, v54
    v_exp_f32 v55, v55
    v_pk_add_f32 v[48:49], v[48:49], v[244:245]
    v_pk_add_f32 v[50:51], v[50:51], v[244:245]
    v_pk_add_f32 v[52:53], v[52:53], v[244:245]
    v_pk_add_f32 v[54:55], v[54:55], v[244:245]
    v_rcp_f32 v48, v48
    v_rcp_f32 v49, v49
    v_rcp_f32 v50, v50
    v_rcp_f32 v51, v51
    v_rcp_f32 v52, v52
    v_rcp_f32 v53, v53
    v_rcp_f32 v54, v54
    v_rcp_f32 v55, v55
    v_pk_mul_f32 v[40:41], v[48:49], v[40:41]
    v_pk_mul_f32 v[42:43], v[50:51], v[42:43]
    v_pk_mul_f32 v[44:45], v[52:53], v[44:45]
    v_pk_mul_f32 v[46:47], v[54:55], v[46:47]
    v_cvt_pk_bf16_f32 v56, v40, v41
    v_cvt_pk_bf16_f32 v57, v42, v43
    v_cvt_pk_bf16_f32 v58, v44, v45
    v_cvt_pk_bf16_f32 v59, v46, v47
    buffer_store_dwordx4 v[56:59], v251, s[4:7], s53 offen offset:1024 sc1
    v_accvgpr_read_b32 v0, a48
    v_accvgpr_read_b32 v1, a49
    v_accvgpr_read_b32 v2, a50
    v_accvgpr_read_b32 v3, a51
    v_accvgpr_read_b32 v4, a52
    v_accvgpr_read_b32 v5, a53
    v_accvgpr_read_b32 v6, a54
    v_accvgpr_read_b32 v7, a55
    v_pk_mul_f32 v[8:9], v[0:1], v[0:1]
    v_pk_mul_f32 v[10:11], v[2:3], v[2:3]
    v_pk_mul_f32 v[12:13], v[4:5], v[4:5]
    v_pk_mul_f32 v[14:15], v[6:7], v[6:7]
    v_pk_fma_f32 v[8:9], v[8:9], v[242:243], v[240:241]
    v_pk_fma_f32 v[10:11], v[10:11], v[242:243], v[240:241]
    v_pk_fma_f32 v[12:13], v[12:13], v[242:243], v[240:241]
    v_pk_fma_f32 v[14:15], v[14:15], v[242:243], v[240:241]
    v_pk_mul_f32 v[8:9], v[8:9], v[0:1]
    v_pk_mul_f32 v[10:11], v[10:11], v[2:3]
    v_pk_mul_f32 v[12:13], v[12:13], v[4:5]
    v_pk_mul_f32 v[14:15], v[14:15], v[6:7]
    v_exp_f32 v8, v8
    v_exp_f32 v9, v9
    v_exp_f32 v10, v10
    v_exp_f32 v11, v11
    v_exp_f32 v12, v12
    v_exp_f32 v13, v13
    v_exp_f32 v14, v14
    v_exp_f32 v15, v15
    v_pk_add_f32 v[8:9], v[8:9], v[244:245]
    v_pk_add_f32 v[10:11], v[10:11], v[244:245]
    v_pk_add_f32 v[12:13], v[12:13], v[244:245]
    v_pk_add_f32 v[14:15], v[14:15], v[244:245]
    v_rcp_f32 v8, v8
    v_rcp_f32 v9, v9
    v_rcp_f32 v10, v10
    v_rcp_f32 v11, v11
    v_rcp_f32 v12, v12
    v_rcp_f32 v13, v13
    v_rcp_f32 v14, v14
    v_rcp_f32 v15, v15
    v_pk_mul_f32 v[0:1], v[8:9], v[0:1]
    v_pk_mul_f32 v[2:3], v[10:11], v[2:3]
    v_pk_mul_f32 v[4:5], v[12:13], v[4:5]
    v_pk_mul_f32 v[6:7], v[14:15], v[6:7]
    v_cvt_pk_bf16_f32 v16, v0, v1
    v_cvt_pk_bf16_f32 v17, v2, v3
    v_cvt_pk_bf16_f32 v18, v4, v5
    v_cvt_pk_bf16_f32 v19, v6, v7
    buffer_store_dwordx4 v[16:19], v251, s[4:7], s53 offen offset:2048 sc1
    v_accvgpr_read_b32 v20, a56
    v_accvgpr_read_b32 v21, a57
    v_accvgpr_read_b32 v22, a58
    v_accvgpr_read_b32 v23, a59
    v_accvgpr_read_b32 v24, a60
    v_accvgpr_read_b32 v25, a61
    v_accvgpr_read_b32 v26, a62
    v_accvgpr_read_b32 v27, a63
    v_pk_mul_f32 v[28:29], v[20:21], v[20:21]
    v_pk_mul_f32 v[30:31], v[22:23], v[22:23]
    v_pk_mul_f32 v[32:33], v[24:25], v[24:25]
    v_pk_mul_f32 v[34:35], v[26:27], v[26:27]
    v_pk_fma_f32 v[28:29], v[28:29], v[242:243], v[240:241]
    v_pk_fma_f32 v[30:31], v[30:31], v[242:243], v[240:241]
    v_pk_fma_f32 v[32:33], v[32:33], v[242:243], v[240:241]
    v_pk_fma_f32 v[34:35], v[34:35], v[242:243], v[240:241]
    v_pk_mul_f32 v[28:29], v[28:29], v[20:21]
    v_pk_mul_f32 v[30:31], v[30:31], v[22:23]
    v_pk_mul_f32 v[32:33], v[32:33], v[24:25]
    v_pk_mul_f32 v[34:35], v[34:35], v[26:27]
    v_exp_f32 v28, v28
    v_exp_f32 v29, v29
    v_exp_f32 v30, v30
    v_exp_f32 v31, v31
    v_exp_f32 v32, v32
    v_exp_f32 v33, v33
    v_exp_f32 v34, v34
    v_exp_f32 v35, v35
    v_pk_add_f32 v[28:29], v[28:29], v[244:245]
    v_pk_add_f32 v[30:31], v[30:31], v[244:245]
    v_pk_add_f32 v[32:33], v[32:33], v[244:245]
    v_pk_add_f32 v[34:35], v[34:35], v[244:245]
    v_rcp_f32 v28, v28
    v_rcp_f32 v29, v29
    v_rcp_f32 v30, v30
    v_rcp_f32 v31, v31
    v_rcp_f32 v32, v32
    v_rcp_f32 v33, v33
    v_rcp_f32 v34, v34
    v_rcp_f32 v35, v35
    v_pk_mul_f32 v[20:21], v[28:29], v[20:21]
    v_pk_mul_f32 v[22:23], v[30:31], v[22:23]
    v_pk_mul_f32 v[24:25], v[32:33], v[24:25]
    v_pk_mul_f32 v[26:27], v[34:35], v[26:27]
    v_cvt_pk_bf16_f32 v36, v20, v21
    v_cvt_pk_bf16_f32 v37, v22, v23
    v_cvt_pk_bf16_f32 v38, v24, v25
    v_cvt_pk_bf16_f32 v39, v26, v27
    buffer_store_dwordx4 v[36:39], v251, s[4:7], s53 offen offset:3072 sc1
    s_add_u32 s53, s53, s22
    v_accvgpr_read_b32 v40, a64
    v_accvgpr_read_b32 v41, a65
    v_accvgpr_read_b32 v42, a66
    v_accvgpr_read_b32 v43, a67
    v_accvgpr_read_b32 v44, a68
    v_accvgpr_read_b32 v45, a69
    v_accvgpr_read_b32 v46, a70
    v_accvgpr_read_b32 v47, a71
    v_pk_mul_f32 v[48:49], v[40:41], v[40:41]
    v_pk_mul_f32 v[50:51], v[42:43], v[42:43]
    v_pk_mul_f32 v[52:53], v[44:45], v[44:45]
    v_pk_mul_f32 v[54:55], v[46:47], v[46:47]
    v_pk_fma_f32 v[48:49], v[48:49], v[242:243], v[240:241]
    v_pk_fma_f32 v[50:51], v[50:51], v[242:243], v[240:241]
    v_pk_fma_f32 v[52:53], v[52:53], v[242:243], v[240:241]
    v_pk_fma_f32 v[54:55], v[54:55], v[242:243], v[240:241]
    v_pk_mul_f32 v[48:49], v[48:49], v[40:41]
    v_pk_mul_f32 v[50:51], v[50:51], v[42:43]
    v_pk_mul_f32 v[52:53], v[52:53], v[44:45]
    v_pk_mul_f32 v[54:55], v[54:55], v[46:47]
    v_exp_f32 v48, v48
    v_exp_f32 v49, v49
    v_exp_f32 v50, v50
    v_exp_f32 v51, v51
    v_exp_f32 v52, v52
    v_exp_f32 v53, v53
    v_exp_f32 v54, v54
    v_exp_f32 v55, v55
    v_pk_add_f32 v[48:49], v[48:49], v[244:245]
    v_pk_add_f32 v[50:51], v[50:51], v[244:245]
    v_pk_add_f32 v[52:53], v[52:53], v[244:245]
    v_pk_add_f32 v[54:55], v[54:55], v[244:245]
    v_rcp_f32 v48, v48
    v_rcp_f32 v49, v49
    v_rcp_f32 v50, v50
    v_rcp_f32 v51, v51
    v_rcp_f32 v52, v52
    v_rcp_f32 v53, v53
    v_rcp_f32 v54, v54
    v_rcp_f32 v55, v55
    v_pk_mul_f32 v[40:41], v[48:49], v[40:41]
    v_pk_mul_f32 v[42:43], v[50:51], v[42:43]
    v_pk_mul_f32 v[44:45], v[52:53], v[44:45]
    v_pk_mul_f32 v[46:47], v[54:55], v[46:47]
    v_cvt_pk_bf16_f32 v56, v40, v41
    v_cvt_pk_bf16_f32 v57, v42, v43
    v_cvt_pk_bf16_f32 v58, v44, v45
    v_cvt_pk_bf16_f32 v59, v46, v47
    buffer_store_dwordx4 v[56:59], v251, s[4:7], s53 offen offset:0 sc1
    v_accvgpr_read_b32 v0, a72
    v_accvgpr_read_b32 v1, a73
    v_accvgpr_read_b32 v2, a74
    v_accvgpr_read_b32 v3, a75
    v_accvgpr_read_b32 v4, a76
    v_accvgpr_read_b32 v5, a77
    v_accvgpr_read_b32 v6, a78
    v_accvgpr_read_b32 v7, a79
    v_pk_mul_f32 v[8:9], v[0:1], v[0:1]
    v_pk_mul_f32 v[10:11], v[2:3], v[2:3]
    v_pk_mul_f32 v[12:13], v[4:5], v[4:5]
    v_pk_mul_f32 v[14:15], v[6:7], v[6:7]
    v_pk_fma_f32 v[8:9], v[8:9], v[242:243], v[240:241]
    v_pk_fma_f32 v[10:11], v[10:11], v[242:243], v[240:241]
    v_pk_fma_f32 v[12:13], v[12:13], v[242:243], v[240:241]
    v_pk_fma_f32 v[14:15], v[14:15], v[242:243], v[240:241]
    v_pk_mul_f32 v[8:9], v[8:9], v[0:1]
    v_pk_mul_f32 v[10:11], v[10:11], v[2:3]
    v_pk_mul_f32 v[12:13], v[12:13], v[4:5]
    v_pk_mul_f32 v[14:15], v[14:15], v[6:7]
    v_exp_f32 v8, v8
    v_exp_f32 v9, v9
    v_exp_f32 v10, v10
    v_exp_f32 v11, v11
    v_exp_f32 v12, v12
    v_exp_f32 v13, v13
    v_exp_f32 v14, v14
    v_exp_f32 v15, v15
    v_pk_add_f32 v[8:9], v[8:9], v[244:245]
    v_pk_add_f32 v[10:11], v[10:11], v[244:245]
    v_pk_add_f32 v[12:13], v[12:13], v[244:245]
    v_pk_add_f32 v[14:15], v[14:15], v[244:245]
    v_rcp_f32 v8, v8
    v_rcp_f32 v9, v9
    v_rcp_f32 v10, v10
    v_rcp_f32 v11, v11
    v_rcp_f32 v12, v12
    v_rcp_f32 v13, v13
    v_rcp_f32 v14, v14
    v_rcp_f32 v15, v15
    v_pk_mul_f32 v[0:1], v[8:9], v[0:1]
    v_pk_mul_f32 v[2:3], v[10:11], v[2:3]
    v_pk_mul_f32 v[4:5], v[12:13], v[4:5]
    v_pk_mul_f32 v[6:7], v[14:15], v[6:7]
    v_cvt_pk_bf16_f32 v16, v0, v1
    v_cvt_pk_bf16_f32 v17, v2, v3
    v_cvt_pk_bf16_f32 v18, v4, v5
    v_cvt_pk_bf16_f32 v19, v6, v7
    buffer_store_dwordx4 v[16:19], v251, s[4:7], s53 offen offset:1024 sc1
    v_accvgpr_read_b32 v20, a80
    v_accvgpr_read_b32 v21, a81
    v_accvgpr_read_b32 v22, a82
    v_accvgpr_read_b32 v23, a83
    v_accvgpr_read_b32 v24, a84
    v_accvgpr_read_b32 v25, a85
    v_accvgpr_read_b32 v26, a86
    v_accvgpr_read_b32 v27, a87
    v_pk_mul_f32 v[28:29], v[20:21], v[20:21]
    v_pk_mul_f32 v[30:31], v[22:23], v[22:23]
    v_pk_mul_f32 v[32:33], v[24:25], v[24:25]
    v_pk_mul_f32 v[34:35], v[26:27], v[26:27]
    v_pk_fma_f32 v[28:29], v[28:29], v[242:243], v[240:241]
    v_pk_fma_f32 v[30:31], v[30:31], v[242:243], v[240:241]
    v_pk_fma_f32 v[32:33], v[32:33], v[242:243], v[240:241]
    v_pk_fma_f32 v[34:35], v[34:35], v[242:243], v[240:241]
    v_pk_mul_f32 v[28:29], v[28:29], v[20:21]
    v_pk_mul_f32 v[30:31], v[30:31], v[22:23]
    v_pk_mul_f32 v[32:33], v[32:33], v[24:25]
    v_pk_mul_f32 v[34:35], v[34:35], v[26:27]
    v_exp_f32 v28, v28
    v_exp_f32 v29, v29
    v_exp_f32 v30, v30
    v_exp_f32 v31, v31
    v_exp_f32 v32, v32
    v_exp_f32 v33, v33
    v_exp_f32 v34, v34
    v_exp_f32 v35, v35
    v_pk_add_f32 v[28:29], v[28:29], v[244:245]
    v_pk_add_f32 v[30:31], v[30:31], v[244:245]
    v_pk_add_f32 v[32:33], v[32:33], v[244:245]
    v_pk_add_f32 v[34:35], v[34:35], v[244:245]
    v_rcp_f32 v28, v28
    v_rcp_f32 v29, v29
    v_rcp_f32 v30, v30
    v_rcp_f32 v31, v31
    v_rcp_f32 v32, v32
    v_rcp_f32 v33, v33
    v_rcp_f32 v34, v34
    v_rcp_f32 v35, v35
    v_pk_mul_f32 v[20:21], v[28:29], v[20:21]
    v_pk_mul_f32 v[22:23], v[30:31], v[22:23]
    v_pk_mul_f32 v[24:25], v[32:33], v[24:25]
    v_pk_mul_f32 v[26:27], v[34:35], v[26:27]
    v_cvt_pk_bf16_f32 v36, v20, v21
    v_cvt_pk_bf16_f32 v37, v22, v23
    v_cvt_pk_bf16_f32 v38, v24, v25
    v_cvt_pk_bf16_f32 v39, v26, v27
    buffer_store_dwordx4 v[36:39], v251, s[4:7], s53 offen offset:2048 sc1
    v_accvgpr_read_b32 v40, a88
    v_accvgpr_read_b32 v41, a89
    v_accvgpr_read_b32 v42, a90
    v_accvgpr_read_b32 v43, a91
    v_accvgpr_read_b32 v44, a92
    v_accvgpr_read_b32 v45, a93
    v_accvgpr_read_b32 v46, a94
    v_accvgpr_read_b32 v47, a95
    v_pk_mul_f32 v[48:49], v[40:41], v[40:41]
    v_pk_mul_f32 v[50:51], v[42:43], v[42:43]
    v_pk_mul_f32 v[52:53], v[44:45], v[44:45]
    v_pk_mul_f32 v[54:55], v[46:47], v[46:47]
    v_pk_fma_f32 v[48:49], v[48:49], v[242:243], v[240:241]
    v_pk_fma_f32 v[50:51], v[50:51], v[242:243], v[240:241]
    v_pk_fma_f32 v[52:53], v[52:53], v[242:243], v[240:241]
    v_pk_fma_f32 v[54:55], v[54:55], v[242:243], v[240:241]
    v_pk_mul_f32 v[48:49], v[48:49], v[40:41]
    v_pk_mul_f32 v[50:51], v[50:51], v[42:43]
    v_pk_mul_f32 v[52:53], v[52:53], v[44:45]
    v_pk_mul_f32 v[54:55], v[54:55], v[46:47]
    v_exp_f32 v48, v48
    v_exp_f32 v49, v49
    v_exp_f32 v50, v50
    v_exp_f32 v51, v51
    v_exp_f32 v52, v52
    v_exp_f32 v53, v53
    v_exp_f32 v54, v54
    v_exp_f32 v55, v55
    v_pk_add_f32 v[48:49], v[48:49], v[244:245]
    v_pk_add_f32 v[50:51], v[50:51], v[244:245]
    v_pk_add_f32 v[52:53], v[52:53], v[244:245]
    v_pk_add_f32 v[54:55], v[54:55], v[244:245]
    v_rcp_f32 v48, v48
    v_rcp_f32 v49, v49
    v_rcp_f32 v50, v50
    v_rcp_f32 v51, v51
    v_rcp_f32 v52, v52
    v_rcp_f32 v53, v53
    v_rcp_f32 v54, v54
    v_rcp_f32 v55, v55
    v_pk_mul_f32 v[40:41], v[48:49], v[40:41]
    v_pk_mul_f32 v[42:43], v[50:51], v[42:43]
    v_pk_mul_f32 v[44:45], v[52:53], v[44:45]
    v_pk_mul_f32 v[46:47], v[54:55], v[46:47]
    v_cvt_pk_bf16_f32 v56, v40, v41
    v_cvt_pk_bf16_f32 v57, v42, v43
    v_cvt_pk_bf16_f32 v58, v44, v45
    v_cvt_pk_bf16_f32 v59, v46, v47
    buffer_store_dwordx4 v[56:59], v251, s[4:7], s53 offen offset:3072 sc1
    s_add_u32 s53, s53, s22
    v_accvgpr_read_b32 v0, a96
    v_accvgpr_read_b32 v1, a97
    v_accvgpr_read_b32 v2, a98
    v_accvgpr_read_b32 v3, a99
    v_accvgpr_read_b32 v4, a100
    v_accvgpr_read_b32 v5, a101
    v_accvgpr_read_b32 v6, a102
    v_accvgpr_read_b32 v7, a103
    v_pk_mul_f32 v[8:9], v[0:1], v[0:1]
    v_pk_mul_f32 v[10:11], v[2:3], v[2:3]
    v_pk_mul_f32 v[12:13], v[4:5], v[4:5]
    v_pk_mul_f32 v[14:15], v[6:7], v[6:7]
    v_pk_fma_f32 v[8:9], v[8:9], v[242:243], v[240:241]
    v_pk_fma_f32 v[10:11], v[10:11], v[242:243], v[240:241]
    v_pk_fma_f32 v[12:13], v[12:13], v[242:243], v[240:241]
    v_pk_fma_f32 v[14:15], v[14:15], v[242:243], v[240:241]
    v_pk_mul_f32 v[8:9], v[8:9], v[0:1]
    v_pk_mul_f32 v[10:11], v[10:11], v[2:3]
    v_pk_mul_f32 v[12:13], v[12:13], v[4:5]
    v_pk_mul_f32 v[14:15], v[14:15], v[6:7]
    v_exp_f32 v8, v8
    v_exp_f32 v9, v9
    v_exp_f32 v10, v10
    v_exp_f32 v11, v11
    v_exp_f32 v12, v12
    v_exp_f32 v13, v13
    v_exp_f32 v14, v14
    v_exp_f32 v15, v15
    v_pk_add_f32 v[8:9], v[8:9], v[244:245]
    v_pk_add_f32 v[10:11], v[10:11], v[244:245]
    v_pk_add_f32 v[12:13], v[12:13], v[244:245]
    v_pk_add_f32 v[14:15], v[14:15], v[244:245]
    v_rcp_f32 v8, v8
    v_rcp_f32 v9, v9
    v_rcp_f32 v10, v10
    v_rcp_f32 v11, v11
    v_rcp_f32 v12, v12
    v_rcp_f32 v13, v13
    v_rcp_f32 v14, v14
    v_rcp_f32 v15, v15
    v_pk_mul_f32 v[0:1], v[8:9], v[0:1]
    v_pk_mul_f32 v[2:3], v[10:11], v[2:3]
    v_pk_mul_f32 v[4:5], v[12:13], v[4:5]
    v_pk_mul_f32 v[6:7], v[14:15], v[6:7]
    v_cvt_pk_bf16_f32 v16, v0, v1
    v_cvt_pk_bf16_f32 v17, v2, v3
    v_cvt_pk_bf16_f32 v18, v4, v5
    v_cvt_pk_bf16_f32 v19, v6, v7
    buffer_store_dwordx4 v[16:19], v251, s[4:7], s53 offen offset:0 sc1
    v_accvgpr_read_b32 v20, a104
    v_accvgpr_read_b32 v21, a105
    v_accvgpr_read_b32 v22, a106
    v_accvgpr_read_b32 v23, a107
    v_accvgpr_read_b32 v24, a108
    v_accvgpr_read_b32 v25, a109
    v_accvgpr_read_b32 v26, a110
    v_accvgpr_read_b32 v27, a111
    v_pk_mul_f32 v[28:29], v[20:21], v[20:21]
    v_pk_mul_f32 v[30:31], v[22:23], v[22:23]
    v_pk_mul_f32 v[32:33], v[24:25], v[24:25]
    v_pk_mul_f32 v[34:35], v[26:27], v[26:27]
    v_pk_fma_f32 v[28:29], v[28:29], v[242:243], v[240:241]
    v_pk_fma_f32 v[30:31], v[30:31], v[242:243], v[240:241]
    v_pk_fma_f32 v[32:33], v[32:33], v[242:243], v[240:241]
    v_pk_fma_f32 v[34:35], v[34:35], v[242:243], v[240:241]
    v_pk_mul_f32 v[28:29], v[28:29], v[20:21]
    v_pk_mul_f32 v[30:31], v[30:31], v[22:23]
    v_pk_mul_f32 v[32:33], v[32:33], v[24:25]
    v_pk_mul_f32 v[34:35], v[34:35], v[26:27]
    v_exp_f32 v28, v28
    v_exp_f32 v29, v29
    v_exp_f32 v30, v30
    v_exp_f32 v31, v31
    v_exp_f32 v32, v32
    v_exp_f32 v33, v33
    v_exp_f32 v34, v34
    v_exp_f32 v35, v35
    v_pk_add_f32 v[28:29], v[28:29], v[244:245]
    v_pk_add_f32 v[30:31], v[30:31], v[244:245]
    v_pk_add_f32 v[32:33], v[32:33], v[244:245]
    v_pk_add_f32 v[34:35], v[34:35], v[244:245]
    v_rcp_f32 v28, v28
    v_rcp_f32 v29, v29
    v_rcp_f32 v30, v30
    v_rcp_f32 v31, v31
    v_rcp_f32 v32, v32
    v_rcp_f32 v33, v33
    v_rcp_f32 v34, v34
    v_rcp_f32 v35, v35
    v_pk_mul_f32 v[20:21], v[28:29], v[20:21]
    v_pk_mul_f32 v[22:23], v[30:31], v[22:23]
    v_pk_mul_f32 v[24:25], v[32:33], v[24:25]
    v_pk_mul_f32 v[26:27], v[34:35], v[26:27]
    v_cvt_pk_bf16_f32 v36, v20, v21
    v_cvt_pk_bf16_f32 v37, v22, v23
    v_cvt_pk_bf16_f32 v38, v24, v25
    v_cvt_pk_bf16_f32 v39, v26, v27
    buffer_store_dwordx4 v[36:39], v251, s[4:7], s53 offen offset:1024 sc1
    v_accvgpr_read_b32 v40, a112
    v_accvgpr_read_b32 v41, a113
    v_accvgpr_read_b32 v42, a114
    v_accvgpr_read_b32 v43, a115
    v_accvgpr_read_b32 v44, a116
    v_accvgpr_read_b32 v45, a117
    v_accvgpr_read_b32 v46, a118
    v_accvgpr_read_b32 v47, a119
    v_pk_mul_f32 v[48:49], v[40:41], v[40:41]
    v_pk_mul_f32 v[50:51], v[42:43], v[42:43]
    v_pk_mul_f32 v[52:53], v[44:45], v[44:45]
    v_pk_mul_f32 v[54:55], v[46:47], v[46:47]
    v_pk_fma_f32 v[48:49], v[48:49], v[242:243], v[240:241]
    v_pk_fma_f32 v[50:51], v[50:51], v[242:243], v[240:241]
    v_pk_fma_f32 v[52:53], v[52:53], v[242:243], v[240:241]
    v_pk_fma_f32 v[54:55], v[54:55], v[242:243], v[240:241]
    v_pk_mul_f32 v[48:49], v[48:49], v[40:41]
    v_pk_mul_f32 v[50:51], v[50:51], v[42:43]
    v_pk_mul_f32 v[52:53], v[52:53], v[44:45]
    v_pk_mul_f32 v[54:55], v[54:55], v[46:47]
    v_exp_f32 v48, v48
    v_exp_f32 v49, v49
    v_exp_f32 v50, v50
    v_exp_f32 v51, v51
    v_exp_f32 v52, v52
    v_exp_f32 v53, v53
    v_exp_f32 v54, v54
    v_exp_f32 v55, v55
    v_pk_add_f32 v[48:49], v[48:49], v[244:245]
    v_pk_add_f32 v[50:51], v[50:51], v[244:245]
    v_pk_add_f32 v[52:53], v[52:53], v[244:245]
    v_pk_add_f32 v[54:55], v[54:55], v[244:245]
    v_rcp_f32 v48, v48
    v_rcp_f32 v49, v49
    v_rcp_f32 v50, v50
    v_rcp_f32 v51, v51
    v_rcp_f32 v52, v52
    v_rcp_f32 v53, v53
    v_rcp_f32 v54, v54
    v_rcp_f32 v55, v55
    v_pk_mul_f32 v[40:41], v[48:49], v[40:41]
    v_pk_mul_f32 v[42:43], v[50:51], v[42:43]
    v_pk_mul_f32 v[44:45], v[52:53], v[44:45]
    v_pk_mul_f32 v[46:47], v[54:55], v[46:47]
    v_cvt_pk_bf16_f32 v56, v40, v41
    v_cvt_pk_bf16_f32 v57, v42, v43
    v_cvt_pk_bf16_f32 v58, v44, v45
    v_cvt_pk_bf16_f32 v59, v46, v47
    buffer_store_dwordx4 v[56:59], v251, s[4:7], s53 offen offset:2048 sc1
    v_accvgpr_read_b32 v0, a120
    v_accvgpr_read_b32 v1, a121
    v_accvgpr_read_b32 v2, a122
    v_accvgpr_read_b32 v3, a123
    v_accvgpr_read_b32 v4, a124
    v_accvgpr_read_b32 v5, a125
    v_accvgpr_read_b32 v6, a126
    v_accvgpr_read_b32 v7, a127
    v_pk_mul_f32 v[8:9], v[0:1], v[0:1]
    v_pk_mul_f32 v[10:11], v[2:3], v[2:3]
    v_pk_mul_f32 v[12:13], v[4:5], v[4:5]
    v_pk_mul_f32 v[14:15], v[6:7], v[6:7]
    v_pk_fma_f32 v[8:9], v[8:9], v[242:243], v[240:241]
    v_pk_fma_f32 v[10:11], v[10:11], v[242:243], v[240:241]
    v_pk_fma_f32 v[12:13], v[12:13], v[242:243], v[240:241]
    v_pk_fma_f32 v[14:15], v[14:15], v[242:243], v[240:241]
    v_pk_mul_f32 v[8:9], v[8:9], v[0:1]
    v_pk_mul_f32 v[10:11], v[10:11], v[2:3]
    v_pk_mul_f32 v[12:13], v[12:13], v[4:5]
    v_pk_mul_f32 v[14:15], v[14:15], v[6:7]
    v_exp_f32 v8, v8
    v_exp_f32 v9, v9
    v_exp_f32 v10, v10
    v_exp_f32 v11, v11
    v_exp_f32 v12, v12
    v_exp_f32 v13, v13
    v_exp_f32 v14, v14
    v_exp_f32 v15, v15
    v_pk_add_f32 v[8:9], v[8:9], v[244:245]
    v_pk_add_f32 v[10:11], v[10:11], v[244:245]
    v_pk_add_f32 v[12:13], v[12:13], v[244:245]
    v_pk_add_f32 v[14:15], v[14:15], v[244:245]
    v_rcp_f32 v8, v8
    v_rcp_f32 v9, v9
    v_rcp_f32 v10, v10
    v_rcp_f32 v11, v11
    v_rcp_f32 v12, v12
    v_rcp_f32 v13, v13
    v_rcp_f32 v14, v14
    v_rcp_f32 v15, v15
    v_pk_mul_f32 v[0:1], v[8:9], v[0:1]
    v_pk_mul_f32 v[2:3], v[10:11], v[2:3]
    v_pk_mul_f32 v[4:5], v[12:13], v[4:5]
    v_pk_mul_f32 v[6:7], v[14:15], v[6:7]
    v_cvt_pk_bf16_f32 v16, v0, v1
    v_cvt_pk_bf16_f32 v17, v2, v3
    v_cvt_pk_bf16_f32 v18, v4, v5
    v_cvt_pk_bf16_f32 v19, v6, v7
    buffer_store_dwordx4 v[16:19], v251, s[4:7], s53 offen offset:3072 sc1
    s_add_u32 s53, s53, s22
    v_accvgpr_read_b32 v20, a128
    v_accvgpr_read_b32 v21, a129
    v_accvgpr_read_b32 v22, a130
    v_accvgpr_read_b32 v23, a131
    v_accvgpr_read_b32 v24, a132
    v_accvgpr_read_b32 v25, a133
    v_accvgpr_read_b32 v26, a134
    v_accvgpr_read_b32 v27, a135
    v_pk_mul_f32 v[28:29], v[20:21], v[20:21]
    v_pk_mul_f32 v[30:31], v[22:23], v[22:23]
    v_pk_mul_f32 v[32:33], v[24:25], v[24:25]
    v_pk_mul_f32 v[34:35], v[26:27], v[26:27]
    v_pk_fma_f32 v[28:29], v[28:29], v[242:243], v[240:241]
    v_pk_fma_f32 v[30:31], v[30:31], v[242:243], v[240:241]
    v_pk_fma_f32 v[32:33], v[32:33], v[242:243], v[240:241]
    v_pk_fma_f32 v[34:35], v[34:35], v[242:243], v[240:241]
    v_pk_mul_f32 v[28:29], v[28:29], v[20:21]
    v_pk_mul_f32 v[30:31], v[30:31], v[22:23]
    v_pk_mul_f32 v[32:33], v[32:33], v[24:25]
    v_pk_mul_f32 v[34:35], v[34:35], v[26:27]
    v_exp_f32 v28, v28
    v_exp_f32 v29, v29
    v_exp_f32 v30, v30
    v_exp_f32 v31, v31
    v_exp_f32 v32, v32
    v_exp_f32 v33, v33
    v_exp_f32 v34, v34
    v_exp_f32 v35, v35
    v_pk_add_f32 v[28:29], v[28:29], v[244:245]
    v_pk_add_f32 v[30:31], v[30:31], v[244:245]
    v_pk_add_f32 v[32:33], v[32:33], v[244:245]
    v_pk_add_f32 v[34:35], v[34:35], v[244:245]
    v_rcp_f32 v28, v28
    v_rcp_f32 v29, v29
    v_rcp_f32 v30, v30
    v_rcp_f32 v31, v31
    v_rcp_f32 v32, v32
    v_rcp_f32 v33, v33
    v_rcp_f32 v34, v34
    v_rcp_f32 v35, v35
    v_pk_mul_f32 v[20:21], v[28:29], v[20:21]
    v_pk_mul_f32 v[22:23], v[30:31], v[22:23]
    v_pk_mul_f32 v[24:25], v[32:33], v[24:25]
    v_pk_mul_f32 v[26:27], v[34:35], v[26:27]
    v_cvt_pk_bf16_f32 v36, v20, v21
    v_cvt_pk_bf16_f32 v37, v22, v23
    v_cvt_pk_bf16_f32 v38, v24, v25
    v_cvt_pk_bf16_f32 v39, v26, v27
    buffer_store_dwordx4 v[36:39], v251, s[4:7], s53 offen offset:0 sc1
    v_accvgpr_read_b32 v40, a136
    v_accvgpr_read_b32 v41, a137
    v_accvgpr_read_b32 v42, a138
    v_accvgpr_read_b32 v43, a139
    v_accvgpr_read_b32 v44, a140
    v_accvgpr_read_b32 v45, a141
    v_accvgpr_read_b32 v46, a142
    v_accvgpr_read_b32 v47, a143
    v_pk_mul_f32 v[48:49], v[40:41], v[40:41]
    v_pk_mul_f32 v[50:51], v[42:43], v[42:43]
    v_pk_mul_f32 v[52:53], v[44:45], v[44:45]
    v_pk_mul_f32 v[54:55], v[46:47], v[46:47]
    v_pk_fma_f32 v[48:49], v[48:49], v[242:243], v[240:241]
    v_pk_fma_f32 v[50:51], v[50:51], v[242:243], v[240:241]
    v_pk_fma_f32 v[52:53], v[52:53], v[242:243], v[240:241]
    v_pk_fma_f32 v[54:55], v[54:55], v[242:243], v[240:241]
    v_pk_mul_f32 v[48:49], v[48:49], v[40:41]
    v_pk_mul_f32 v[50:51], v[50:51], v[42:43]
    v_pk_mul_f32 v[52:53], v[52:53], v[44:45]
    v_pk_mul_f32 v[54:55], v[54:55], v[46:47]
    v_exp_f32 v48, v48
    v_exp_f32 v49, v49
    v_exp_f32 v50, v50
    v_exp_f32 v51, v51
    v_exp_f32 v52, v52
    v_exp_f32 v53, v53
    v_exp_f32 v54, v54
    v_exp_f32 v55, v55
    v_pk_add_f32 v[48:49], v[48:49], v[244:245]
    v_pk_add_f32 v[50:51], v[50:51], v[244:245]
    v_pk_add_f32 v[52:53], v[52:53], v[244:245]
    v_pk_add_f32 v[54:55], v[54:55], v[244:245]
    v_rcp_f32 v48, v48
    v_rcp_f32 v49, v49
    v_rcp_f32 v50, v50
    v_rcp_f32 v51, v51
    v_rcp_f32 v52, v52
    v_rcp_f32 v53, v53
    v_rcp_f32 v54, v54
    v_rcp_f32 v55, v55
    v_pk_mul_f32 v[40:41], v[48:49], v[40:41]
    v_pk_mul_f32 v[42:43], v[50:51], v[42:43]
    v_pk_mul_f32 v[44:45], v[52:53], v[44:45]
    v_pk_mul_f32 v[46:47], v[54:55], v[46:47]
    v_cvt_pk_bf16_f32 v56, v40, v41
    v_cvt_pk_bf16_f32 v57, v42, v43
    v_cvt_pk_bf16_f32 v58, v44, v45
    v_cvt_pk_bf16_f32 v59, v46, v47
    buffer_store_dwordx4 v[56:59], v251, s[4:7], s53 offen offset:1024 sc1
    v_accvgpr_read_b32 v0, a144
    v_accvgpr_read_b32 v1, a145
    v_accvgpr_read_b32 v2, a146
    v_accvgpr_read_b32 v3, a147
    v_accvgpr_read_b32 v4, a148
    v_accvgpr_read_b32 v5, a149
    v_accvgpr_read_b32 v6, a150
    v_accvgpr_read_b32 v7, a151
    v_pk_mul_f32 v[8:9], v[0:1], v[0:1]
    v_pk_mul_f32 v[10:11], v[2:3], v[2:3]
    v_pk_mul_f32 v[12:13], v[4:5], v[4:5]
    v_pk_mul_f32 v[14:15], v[6:7], v[6:7]
    v_pk_fma_f32 v[8:9], v[8:9], v[242:243], v[240:241]
    v_pk_fma_f32 v[10:11], v[10:11], v[242:243], v[240:241]
    v_pk_fma_f32 v[12:13], v[12:13], v[242:243], v[240:241]
    v_pk_fma_f32 v[14:15], v[14:15], v[242:243], v[240:241]
    v_pk_mul_f32 v[8:9], v[8:9], v[0:1]
    v_pk_mul_f32 v[10:11], v[10:11], v[2:3]
    v_pk_mul_f32 v[12:13], v[12:13], v[4:5]
    v_pk_mul_f32 v[14:15], v[14:15], v[6:7]
    v_exp_f32 v8, v8
    v_exp_f32 v9, v9
    v_exp_f32 v10, v10
    v_exp_f32 v11, v11
    v_exp_f32 v12, v12
    v_exp_f32 v13, v13
    v_exp_f32 v14, v14
    v_exp_f32 v15, v15
    v_pk_add_f32 v[8:9], v[8:9], v[244:245]
    v_pk_add_f32 v[10:11], v[10:11], v[244:245]
    v_pk_add_f32 v[12:13], v[12:13], v[244:245]
    v_pk_add_f32 v[14:15], v[14:15], v[244:245]
    v_rcp_f32 v8, v8
    v_rcp_f32 v9, v9
    v_rcp_f32 v10, v10
    v_rcp_f32 v11, v11
    v_rcp_f32 v12, v12
    v_rcp_f32 v13, v13
    v_rcp_f32 v14, v14
    v_rcp_f32 v15, v15
    v_pk_mul_f32 v[0:1], v[8:9], v[0:1]
    v_pk_mul_f32 v[2:3], v[10:11], v[2:3]
    v_pk_mul_f32 v[4:5], v[12:13], v[4:5]
    v_pk_mul_f32 v[6:7], v[14:15], v[6:7]
    v_cvt_pk_bf16_f32 v16, v0, v1
    v_cvt_pk_bf16_f32 v17, v2, v3
    v_cvt_pk_bf16_f32 v18, v4, v5
    v_cvt_pk_bf16_f32 v19, v6, v7
    buffer_store_dwordx4 v[16:19], v251, s[4:7], s53 offen offset:2048 sc1
    v_accvgpr_read_b32 v20, a152
    v_accvgpr_read_b32 v21, a153
    v_accvgpr_read_b32 v22, a154
    v_accvgpr_read_b32 v23, a155
    v_accvgpr_read_b32 v24, a156
    v_accvgpr_read_b32 v25, a157
    v_accvgpr_read_b32 v26, a158
    v_accvgpr_read_b32 v27, a159
    v_pk_mul_f32 v[28:29], v[20:21], v[20:21]
    v_pk_mul_f32 v[30:31], v[22:23], v[22:23]
    v_pk_mul_f32 v[32:33], v[24:25], v[24:25]
    v_pk_mul_f32 v[34:35], v[26:27], v[26:27]
    v_pk_fma_f32 v[28:29], v[28:29], v[242:243], v[240:241]
    v_pk_fma_f32 v[30:31], v[30:31], v[242:243], v[240:241]
    v_pk_fma_f32 v[32:33], v[32:33], v[242:243], v[240:241]
    v_pk_fma_f32 v[34:35], v[34:35], v[242:243], v[240:241]
    v_pk_mul_f32 v[28:29], v[28:29], v[20:21]
    v_pk_mul_f32 v[30:31], v[30:31], v[22:23]
    v_pk_mul_f32 v[32:33], v[32:33], v[24:25]
    v_pk_mul_f32 v[34:35], v[34:35], v[26:27]
    v_exp_f32 v28, v28
    v_exp_f32 v29, v29
    v_exp_f32 v30, v30
    v_exp_f32 v31, v31
    v_exp_f32 v32, v32
    v_exp_f32 v33, v33
    v_exp_f32 v34, v34
    v_exp_f32 v35, v35
    v_pk_add_f32 v[28:29], v[28:29], v[244:245]
    v_pk_add_f32 v[30:31], v[30:31], v[244:245]
    v_pk_add_f32 v[32:33], v[32:33], v[244:245]
    v_pk_add_f32 v[34:35], v[34:35], v[244:245]
    v_rcp_f32 v28, v28
    v_rcp_f32 v29, v29
    v_rcp_f32 v30, v30
    v_rcp_f32 v31, v31
    v_rcp_f32 v32, v32
    v_rcp_f32 v33, v33
    v_rcp_f32 v34, v34
    v_rcp_f32 v35, v35
    v_pk_mul_f32 v[20:21], v[28:29], v[20:21]
    v_pk_mul_f32 v[22:23], v[30:31], v[22:23]
    v_pk_mul_f32 v[24:25], v[32:33], v[24:25]
    v_pk_mul_f32 v[26:27], v[34:35], v[26:27]
    v_cvt_pk_bf16_f32 v36, v20, v21
    v_cvt_pk_bf16_f32 v37, v22, v23
    v_cvt_pk_bf16_f32 v38, v24, v25
    v_cvt_pk_bf16_f32 v39, v26, v27
    buffer_store_dwordx4 v[36:39], v251, s[4:7], s53 offen offset:3072 sc1
    s_add_u32 s53, s53, s22
    v_accvgpr_read_b32 v40, a160
    v_accvgpr_read_b32 v41, a161
    v_accvgpr_read_b32 v42, a162
    v_accvgpr_read_b32 v43, a163
    v_accvgpr_read_b32 v44, a164
    v_accvgpr_read_b32 v45, a165
    v_accvgpr_read_b32 v46, a166
    v_accvgpr_read_b32 v47, a167
    v_pk_mul_f32 v[48:49], v[40:41], v[40:41]
    v_pk_mul_f32 v[50:51], v[42:43], v[42:43]
    v_pk_mul_f32 v[52:53], v[44:45], v[44:45]
    v_pk_mul_f32 v[54:55], v[46:47], v[46:47]
    v_pk_fma_f32 v[48:49], v[48:49], v[242:243], v[240:241]
    v_pk_fma_f32 v[50:51], v[50:51], v[242:243], v[240:241]
    v_pk_fma_f32 v[52:53], v[52:53], v[242:243], v[240:241]
    v_pk_fma_f32 v[54:55], v[54:55], v[242:243], v[240:241]
    v_pk_mul_f32 v[48:49], v[48:49], v[40:41]
    v_pk_mul_f32 v[50:51], v[50:51], v[42:43]
    v_pk_mul_f32 v[52:53], v[52:53], v[44:45]
    v_pk_mul_f32 v[54:55], v[54:55], v[46:47]
    v_exp_f32 v48, v48
    v_exp_f32 v49, v49
    v_exp_f32 v50, v50
    v_exp_f32 v51, v51
    v_exp_f32 v52, v52
    v_exp_f32 v53, v53
    v_exp_f32 v54, v54
    v_exp_f32 v55, v55
    v_pk_add_f32 v[48:49], v[48:49], v[244:245]
    v_pk_add_f32 v[50:51], v[50:51], v[244:245]
    v_pk_add_f32 v[52:53], v[52:53], v[244:245]
    v_pk_add_f32 v[54:55], v[54:55], v[244:245]
    v_rcp_f32 v48, v48
    v_rcp_f32 v49, v49
    v_rcp_f32 v50, v50
    v_rcp_f32 v51, v51
    v_rcp_f32 v52, v52
    v_rcp_f32 v53, v53
    v_rcp_f32 v54, v54
    v_rcp_f32 v55, v55
    v_pk_mul_f32 v[40:41], v[48:49], v[40:41]
    v_pk_mul_f32 v[42:43], v[50:51], v[42:43]
    v_pk_mul_f32 v[44:45], v[52:53], v[44:45]
    v_pk_mul_f32 v[46:47], v[54:55], v[46:47]
    v_cvt_pk_bf16_f32 v56, v40, v41
    v_cvt_pk_bf16_f32 v57, v42, v43
    v_cvt_pk_bf16_f32 v58, v44, v45
    v_cvt_pk_bf16_f32 v59, v46, v47
    buffer_store_dwordx4 v[56:59], v251, s[4:7], s53 offen offset:0 sc1
    v_accvgpr_read_b32 v0, a168
    v_accvgpr_read_b32 v1, a169
    v_accvgpr_read_b32 v2, a170
    v_accvgpr_read_b32 v3, a171
    v_accvgpr_read_b32 v4, a172
    v_accvgpr_read_b32 v5, a173
    v_accvgpr_read_b32 v6, a174
    v_accvgpr_read_b32 v7, a175
    v_pk_mul_f32 v[8:9], v[0:1], v[0:1]
    v_pk_mul_f32 v[10:11], v[2:3], v[2:3]
    v_pk_mul_f32 v[12:13], v[4:5], v[4:5]
    v_pk_mul_f32 v[14:15], v[6:7], v[6:7]
    v_pk_fma_f32 v[8:9], v[8:9], v[242:243], v[240:241]
    v_pk_fma_f32 v[10:11], v[10:11], v[242:243], v[240:241]
    v_pk_fma_f32 v[12:13], v[12:13], v[242:243], v[240:241]
    v_pk_fma_f32 v[14:15], v[14:15], v[242:243], v[240:241]
    v_pk_mul_f32 v[8:9], v[8:9], v[0:1]
    v_pk_mul_f32 v[10:11], v[10:11], v[2:3]
    v_pk_mul_f32 v[12:13], v[12:13], v[4:5]
    v_pk_mul_f32 v[14:15], v[14:15], v[6:7]
    v_exp_f32 v8, v8
    v_exp_f32 v9, v9
    v_exp_f32 v10, v10
    v_exp_f32 v11, v11
    v_exp_f32 v12, v12
    v_exp_f32 v13, v13
    v_exp_f32 v14, v14
    v_exp_f32 v15, v15
    v_pk_add_f32 v[8:9], v[8:9], v[244:245]
    v_pk_add_f32 v[10:11], v[10:11], v[244:245]
    v_pk_add_f32 v[12:13], v[12:13], v[244:245]
    v_pk_add_f32 v[14:15], v[14:15], v[244:245]
    v_rcp_f32 v8, v8
    v_rcp_f32 v9, v9
    v_rcp_f32 v10, v10
    v_rcp_f32 v11, v11
    v_rcp_f32 v12, v12
    v_rcp_f32 v13, v13
    v_rcp_f32 v14, v14
    v_rcp_f32 v15, v15
    v_pk_mul_f32 v[0:1], v[8:9], v[0:1]
    v_pk_mul_f32 v[2:3], v[10:11], v[2:3]
    v_pk_mul_f32 v[4:5], v[12:13], v[4:5]
    v_pk_mul_f32 v[6:7], v[14:15], v[6:7]
    v_cvt_pk_bf16_f32 v16, v0, v1
    v_cvt_pk_bf16_f32 v17, v2, v3
    v_cvt_pk_bf16_f32 v18, v4, v5
    v_cvt_pk_bf16_f32 v19, v6, v7
    buffer_store_dwordx4 v[16:19], v251, s[4:7], s53 offen offset:1024 sc1
    v_accvgpr_read_b32 v20, a176
    v_accvgpr_read_b32 v21, a177
    v_accvgpr_read_b32 v22, a178
    v_accvgpr_read_b32 v23, a179
    v_accvgpr_read_b32 v24, a180
    v_accvgpr_read_b32 v25, a181
    v_accvgpr_read_b32 v26, a182
    v_accvgpr_read_b32 v27, a183
    v_pk_mul_f32 v[28:29], v[20:21], v[20:21]
    v_pk_mul_f32 v[30:31], v[22:23], v[22:23]
    v_pk_mul_f32 v[32:33], v[24:25], v[24:25]
    v_pk_mul_f32 v[34:35], v[26:27], v[26:27]
    v_pk_fma_f32 v[28:29], v[28:29], v[242:243], v[240:241]
    v_pk_fma_f32 v[30:31], v[30:31], v[242:243], v[240:241]
    v_pk_fma_f32 v[32:33], v[32:33], v[242:243], v[240:241]
    v_pk_fma_f32 v[34:35], v[34:35], v[242:243], v[240:241]
    v_pk_mul_f32 v[28:29], v[28:29], v[20:21]
    v_pk_mul_f32 v[30:31], v[30:31], v[22:23]
    v_pk_mul_f32 v[32:33], v[32:33], v[24:25]
    v_pk_mul_f32 v[34:35], v[34:35], v[26:27]
    v_exp_f32 v28, v28
    v_exp_f32 v29, v29
    v_exp_f32 v30, v30
    v_exp_f32 v31, v31
    v_exp_f32 v32, v32
    v_exp_f32 v33, v33
    v_exp_f32 v34, v34
    v_exp_f32 v35, v35
    v_pk_add_f32 v[28:29], v[28:29], v[244:245]
    v_pk_add_f32 v[30:31], v[30:31], v[244:245]
    v_pk_add_f32 v[32:33], v[32:33], v[244:245]
    v_pk_add_f32 v[34:35], v[34:35], v[244:245]
    v_rcp_f32 v28, v28
    v_rcp_f32 v29, v29
    v_rcp_f32 v30, v30
    v_rcp_f32 v31, v31
    v_rcp_f32 v32, v32
    v_rcp_f32 v33, v33
    v_rcp_f32 v34, v34
    v_rcp_f32 v35, v35
    v_pk_mul_f32 v[20:21], v[28:29], v[20:21]
    v_pk_mul_f32 v[22:23], v[30:31], v[22:23]
    v_pk_mul_f32 v[24:25], v[32:33], v[24:25]
    v_pk_mul_f32 v[26:27], v[34:35], v[26:27]
    v_cvt_pk_bf16_f32 v36, v20, v21
    v_cvt_pk_bf16_f32 v37, v22, v23
    v_cvt_pk_bf16_f32 v38, v24, v25
    v_cvt_pk_bf16_f32 v39, v26, v27
    buffer_store_dwordx4 v[36:39], v251, s[4:7], s53 offen offset:2048 sc1
    v_accvgpr_read_b32 v40, a184
    v_accvgpr_read_b32 v41, a185
    v_accvgpr_read_b32 v42, a186
    v_accvgpr_read_b32 v43, a187
    v_accvgpr_read_b32 v44, a188
    v_accvgpr_read_b32 v45, a189
    v_accvgpr_read_b32 v46, a190
    v_accvgpr_read_b32 v47, a191
    v_pk_mul_f32 v[48:49], v[40:41], v[40:41]
    v_pk_mul_f32 v[50:51], v[42:43], v[42:43]
    v_pk_mul_f32 v[52:53], v[44:45], v[44:45]
    v_pk_mul_f32 v[54:55], v[46:47], v[46:47]
    v_pk_fma_f32 v[48:49], v[48:49], v[242:243], v[240:241]
    v_pk_fma_f32 v[50:51], v[50:51], v[242:243], v[240:241]
    v_pk_fma_f32 v[52:53], v[52:53], v[242:243], v[240:241]
    v_pk_fma_f32 v[54:55], v[54:55], v[242:243], v[240:241]
    v_pk_mul_f32 v[48:49], v[48:49], v[40:41]
    v_pk_mul_f32 v[50:51], v[50:51], v[42:43]
    v_pk_mul_f32 v[52:53], v[52:53], v[44:45]
    v_pk_mul_f32 v[54:55], v[54:55], v[46:47]
    v_exp_f32 v48, v48
    v_exp_f32 v49, v49
    v_exp_f32 v50, v50
    v_exp_f32 v51, v51
    v_exp_f32 v52, v52
    v_exp_f32 v53, v53
    v_exp_f32 v54, v54
    v_exp_f32 v55, v55
    v_pk_add_f32 v[48:49], v[48:49], v[244:245]
    v_pk_add_f32 v[50:51], v[50:51], v[244:245]
    v_pk_add_f32 v[52:53], v[52:53], v[244:245]
    v_pk_add_f32 v[54:55], v[54:55], v[244:245]
    v_rcp_f32 v48, v48
    v_rcp_f32 v49, v49
    v_rcp_f32 v50, v50
    v_rcp_f32 v51, v51
    v_rcp_f32 v52, v52
    v_rcp_f32 v53, v53
    v_rcp_f32 v54, v54
    v_rcp_f32 v55, v55
    v_pk_mul_f32 v[40:41], v[48:49], v[40:41]
    v_pk_mul_f32 v[42:43], v[50:51], v[42:43]
    v_pk_mul_f32 v[44:45], v[52:53], v[44:45]
    v_pk_mul_f32 v[46:47], v[54:55], v[46:47]
    v_cvt_pk_bf16_f32 v56, v40, v41
    v_cvt_pk_bf16_f32 v57, v42, v43
    v_cvt_pk_bf16_f32 v58, v44, v45
    v_cvt_pk_bf16_f32 v59, v46, v47
    buffer_store_dwordx4 v[56:59], v251, s[4:7], s53 offen offset:3072 sc1
    s_add_u32 s53, s53, s22
    v_accvgpr_read_b32 v0, a192
    v_accvgpr_read_b32 v1, a193
    v_accvgpr_read_b32 v2, a194
    v_accvgpr_read_b32 v3, a195
    v_accvgpr_read_b32 v4, a196
    v_accvgpr_read_b32 v5, a197
    v_accvgpr_read_b32 v6, a198
    v_accvgpr_read_b32 v7, a199
    v_pk_mul_f32 v[8:9], v[0:1], v[0:1]
    v_pk_mul_f32 v[10:11], v[2:3], v[2:3]
    v_pk_mul_f32 v[12:13], v[4:5], v[4:5]
    v_pk_mul_f32 v[14:15], v[6:7], v[6:7]
    v_pk_fma_f32 v[8:9], v[8:9], v[242:243], v[240:241]
    v_pk_fma_f32 v[10:11], v[10:11], v[242:243], v[240:241]
    v_pk_fma_f32 v[12:13], v[12:13], v[242:243], v[240:241]
    v_pk_fma_f32 v[14:15], v[14:15], v[242:243], v[240:241]
    v_pk_mul_f32 v[8:9], v[8:9], v[0:1]
    v_pk_mul_f32 v[10:11], v[10:11], v[2:3]
    v_pk_mul_f32 v[12:13], v[12:13], v[4:5]
    v_pk_mul_f32 v[14:15], v[14:15], v[6:7]
    v_exp_f32 v8, v8
    v_exp_f32 v9, v9
    v_exp_f32 v10, v10
    v_exp_f32 v11, v11
    v_exp_f32 v12, v12
    v_exp_f32 v13, v13
    v_exp_f32 v14, v14
    v_exp_f32 v15, v15
    v_pk_add_f32 v[8:9], v[8:9], v[244:245]
    v_pk_add_f32 v[10:11], v[10:11], v[244:245]
    v_pk_add_f32 v[12:13], v[12:13], v[244:245]
    v_pk_add_f32 v[14:15], v[14:15], v[244:245]
    v_rcp_f32 v8, v8
    v_rcp_f32 v9, v9
    v_rcp_f32 v10, v10
    v_rcp_f32 v11, v11
    v_rcp_f32 v12, v12
    v_rcp_f32 v13, v13
    v_rcp_f32 v14, v14
    v_rcp_f32 v15, v15
    v_pk_mul_f32 v[0:1], v[8:9], v[0:1]
    v_pk_mul_f32 v[2:3], v[10:11], v[2:3]
    v_pk_mul_f32 v[4:5], v[12:13], v[4:5]
    v_pk_mul_f32 v[6:7], v[14:15], v[6:7]
    v_cvt_pk_bf16_f32 v16, v0, v1
    v_cvt_pk_bf16_f32 v17, v2, v3
    v_cvt_pk_bf16_f32 v18, v4, v5
    v_cvt_pk_bf16_f32 v19, v6, v7
    buffer_store_dwordx4 v[16:19], v251, s[4:7], s53 offen offset:0 sc1
    v_accvgpr_read_b32 v20, a200
    v_accvgpr_read_b32 v21, a201
    v_accvgpr_read_b32 v22, a202
    v_accvgpr_read_b32 v23, a203
    v_accvgpr_read_b32 v24, a204
    v_accvgpr_read_b32 v25, a205
    v_accvgpr_read_b32 v26, a206
    v_accvgpr_read_b32 v27, a207
    v_pk_mul_f32 v[28:29], v[20:21], v[20:21]
    v_pk_mul_f32 v[30:31], v[22:23], v[22:23]
    v_pk_mul_f32 v[32:33], v[24:25], v[24:25]
    v_pk_mul_f32 v[34:35], v[26:27], v[26:27]
    v_pk_fma_f32 v[28:29], v[28:29], v[242:243], v[240:241]
    v_pk_fma_f32 v[30:31], v[30:31], v[242:243], v[240:241]
    v_pk_fma_f32 v[32:33], v[32:33], v[242:243], v[240:241]
    v_pk_fma_f32 v[34:35], v[34:35], v[242:243], v[240:241]
    v_pk_mul_f32 v[28:29], v[28:29], v[20:21]
    v_pk_mul_f32 v[30:31], v[30:31], v[22:23]
    v_pk_mul_f32 v[32:33], v[32:33], v[24:25]
    v_pk_mul_f32 v[34:35], v[34:35], v[26:27]
    v_exp_f32 v28, v28
    v_exp_f32 v29, v29
    v_exp_f32 v30, v30
    v_exp_f32 v31, v31
    v_exp_f32 v32, v32
    v_exp_f32 v33, v33
    v_exp_f32 v34, v34
    v_exp_f32 v35, v35
    v_pk_add_f32 v[28:29], v[28:29], v[244:245]
    v_pk_add_f32 v[30:31], v[30:31], v[244:245]
    v_pk_add_f32 v[32:33], v[32:33], v[244:245]
    v_pk_add_f32 v[34:35], v[34:35], v[244:245]
    v_rcp_f32 v28, v28
    v_rcp_f32 v29, v29
    v_rcp_f32 v30, v30
    v_rcp_f32 v31, v31
    v_rcp_f32 v32, v32
    v_rcp_f32 v33, v33
    v_rcp_f32 v34, v34
    v_rcp_f32 v35, v35
    v_pk_mul_f32 v[20:21], v[28:29], v[20:21]
    v_pk_mul_f32 v[22:23], v[30:31], v[22:23]
    v_pk_mul_f32 v[24:25], v[32:33], v[24:25]
    v_pk_mul_f32 v[26:27], v[34:35], v[26:27]
    v_cvt_pk_bf16_f32 v36, v20, v21
    v_cvt_pk_bf16_f32 v37, v22, v23
    v_cvt_pk_bf16_f32 v38, v24, v25
    v_cvt_pk_bf16_f32 v39, v26, v27
    buffer_store_dwordx4 v[36:39], v251, s[4:7], s53 offen offset:1024 sc1
    v_accvgpr_read_b32 v40, a208
    v_accvgpr_read_b32 v41, a209
    v_accvgpr_read_b32 v42, a210
    v_accvgpr_read_b32 v43, a211
    v_accvgpr_read_b32 v44, a212
    v_accvgpr_read_b32 v45, a213
    v_accvgpr_read_b32 v46, a214
    v_accvgpr_read_b32 v47, a215
    v_pk_mul_f32 v[48:49], v[40:41], v[40:41]
    v_pk_mul_f32 v[50:51], v[42:43], v[42:43]
    v_pk_mul_f32 v[52:53], v[44:45], v[44:45]
    v_pk_mul_f32 v[54:55], v[46:47], v[46:47]
    v_pk_fma_f32 v[48:49], v[48:49], v[242:243], v[240:241]
    v_pk_fma_f32 v[50:51], v[50:51], v[242:243], v[240:241]
    v_pk_fma_f32 v[52:53], v[52:53], v[242:243], v[240:241]
    v_pk_fma_f32 v[54:55], v[54:55], v[242:243], v[240:241]
    v_pk_mul_f32 v[48:49], v[48:49], v[40:41]
    v_pk_mul_f32 v[50:51], v[50:51], v[42:43]
    v_pk_mul_f32 v[52:53], v[52:53], v[44:45]
    v_pk_mul_f32 v[54:55], v[54:55], v[46:47]
    v_exp_f32 v48, v48
    v_exp_f32 v49, v49
    v_exp_f32 v50, v50
    v_exp_f32 v51, v51
    v_exp_f32 v52, v52
    v_exp_f32 v53, v53
    v_exp_f32 v54, v54
    v_exp_f32 v55, v55
    v_pk_add_f32 v[48:49], v[48:49], v[244:245]
    v_pk_add_f32 v[50:51], v[50:51], v[244:245]
    v_pk_add_f32 v[52:53], v[52:53], v[244:245]
    v_pk_add_f32 v[54:55], v[54:55], v[244:245]
    v_rcp_f32 v48, v48
    v_rcp_f32 v49, v49
    v_rcp_f32 v50, v50
    v_rcp_f32 v51, v51
    v_rcp_f32 v52, v52
    v_rcp_f32 v53, v53
    v_rcp_f32 v54, v54
    v_rcp_f32 v55, v55
    v_pk_mul_f32 v[40:41], v[48:49], v[40:41]
    v_pk_mul_f32 v[42:43], v[50:51], v[42:43]
    v_pk_mul_f32 v[44:45], v[52:53], v[44:45]
    v_pk_mul_f32 v[46:47], v[54:55], v[46:47]
    v_cvt_pk_bf16_f32 v56, v40, v41
    v_cvt_pk_bf16_f32 v57, v42, v43
    v_cvt_pk_bf16_f32 v58, v44, v45
    v_cvt_pk_bf16_f32 v59, v46, v47
    buffer_store_dwordx4 v[56:59], v251, s[4:7], s53 offen offset:2048 sc1
    v_accvgpr_read_b32 v0, a216
    v_accvgpr_read_b32 v1, a217
    v_accvgpr_read_b32 v2, a218
    v_accvgpr_read_b32 v3, a219
    v_accvgpr_read_b32 v4, a220
    v_accvgpr_read_b32 v5, a221
    v_accvgpr_read_b32 v6, a222
    v_accvgpr_read_b32 v7, a223
    v_pk_mul_f32 v[8:9], v[0:1], v[0:1]
    v_pk_mul_f32 v[10:11], v[2:3], v[2:3]
    v_pk_mul_f32 v[12:13], v[4:5], v[4:5]
    v_pk_mul_f32 v[14:15], v[6:7], v[6:7]
    v_pk_fma_f32 v[8:9], v[8:9], v[242:243], v[240:241]
    v_pk_fma_f32 v[10:11], v[10:11], v[242:243], v[240:241]
    v_pk_fma_f32 v[12:13], v[12:13], v[242:243], v[240:241]
    v_pk_fma_f32 v[14:15], v[14:15], v[242:243], v[240:241]
    v_pk_mul_f32 v[8:9], v[8:9], v[0:1]
    v_pk_mul_f32 v[10:11], v[10:11], v[2:3]
    v_pk_mul_f32 v[12:13], v[12:13], v[4:5]
    v_pk_mul_f32 v[14:15], v[14:15], v[6:7]
    v_exp_f32 v8, v8
    v_exp_f32 v9, v9
    v_exp_f32 v10, v10
    v_exp_f32 v11, v11
    v_exp_f32 v12, v12
    v_exp_f32 v13, v13
    v_exp_f32 v14, v14
    v_exp_f32 v15, v15
    v_pk_add_f32 v[8:9], v[8:9], v[244:245]
    v_pk_add_f32 v[10:11], v[10:11], v[244:245]
    v_pk_add_f32 v[12:13], v[12:13], v[244:245]
    v_pk_add_f32 v[14:15], v[14:15], v[244:245]
    v_rcp_f32 v8, v8
    v_rcp_f32 v9, v9
    v_rcp_f32 v10, v10
    v_rcp_f32 v11, v11
    v_rcp_f32 v12, v12
    v_rcp_f32 v13, v13
    v_rcp_f32 v14, v14
    v_rcp_f32 v15, v15
    v_pk_mul_f32 v[0:1], v[8:9], v[0:1]
    v_pk_mul_f32 v[2:3], v[10:11], v[2:3]
    v_pk_mul_f32 v[4:5], v[12:13], v[4:5]
    v_pk_mul_f32 v[6:7], v[14:15], v[6:7]
    v_cvt_pk_bf16_f32 v16, v0, v1
    v_cvt_pk_bf16_f32 v17, v2, v3
    v_cvt_pk_bf16_f32 v18, v4, v5
    v_cvt_pk_bf16_f32 v19, v6, v7
    buffer_store_dwordx4 v[16:19], v251, s[4:7], s53 offen offset:3072 sc1
    s_add_u32 s53, s53, s22
    v_accvgpr_read_b32 v20, a224
    v_accvgpr_read_b32 v21, a225
    v_accvgpr_read_b32 v22, a226
    v_accvgpr_read_b32 v23, a227
    v_accvgpr_read_b32 v24, a228
    v_accvgpr_read_b32 v25, a229
    v_accvgpr_read_b32 v26, a230
    v_accvgpr_read_b32 v27, a231
    v_pk_mul_f32 v[28:29], v[20:21], v[20:21]
    v_pk_mul_f32 v[30:31], v[22:23], v[22:23]
    v_pk_mul_f32 v[32:33], v[24:25], v[24:25]
    v_pk_mul_f32 v[34:35], v[26:27], v[26:27]
    v_pk_fma_f32 v[28:29], v[28:29], v[242:243], v[240:241]
    v_pk_fma_f32 v[30:31], v[30:31], v[242:243], v[240:241]
    v_pk_fma_f32 v[32:33], v[32:33], v[242:243], v[240:241]
    v_pk_fma_f32 v[34:35], v[34:35], v[242:243], v[240:241]
    v_pk_mul_f32 v[28:29], v[28:29], v[20:21]
    v_pk_mul_f32 v[30:31], v[30:31], v[22:23]
    v_pk_mul_f32 v[32:33], v[32:33], v[24:25]
    v_pk_mul_f32 v[34:35], v[34:35], v[26:27]
    v_exp_f32 v28, v28
    v_exp_f32 v29, v29
    v_exp_f32 v30, v30
    v_exp_f32 v31, v31
    v_exp_f32 v32, v32
    v_exp_f32 v33, v33
    v_exp_f32 v34, v34
    v_exp_f32 v35, v35
    v_pk_add_f32 v[28:29], v[28:29], v[244:245]
    v_pk_add_f32 v[30:31], v[30:31], v[244:245]
    v_pk_add_f32 v[32:33], v[32:33], v[244:245]
    v_pk_add_f32 v[34:35], v[34:35], v[244:245]
    v_rcp_f32 v28, v28
    v_rcp_f32 v29, v29
    v_rcp_f32 v30, v30
    v_rcp_f32 v31, v31
    v_rcp_f32 v32, v32
    v_rcp_f32 v33, v33
    v_rcp_f32 v34, v34
    v_rcp_f32 v35, v35
    v_pk_mul_f32 v[20:21], v[28:29], v[20:21]
    v_pk_mul_f32 v[22:23], v[30:31], v[22:23]
    v_pk_mul_f32 v[24:25], v[32:33], v[24:25]
    v_pk_mul_f32 v[26:27], v[34:35], v[26:27]
    v_cvt_pk_bf16_f32 v36, v20, v21
    v_cvt_pk_bf16_f32 v37, v22, v23
    v_cvt_pk_bf16_f32 v38, v24, v25
    v_cvt_pk_bf16_f32 v39, v26, v27
    buffer_store_dwordx4 v[36:39], v251, s[4:7], s53 offen offset:0 sc1
    v_accvgpr_read_b32 v40, a232
    v_accvgpr_read_b32 v41, a233
    v_accvgpr_read_b32 v42, a234
    v_accvgpr_read_b32 v43, a235
    v_accvgpr_read_b32 v44, a236
    v_accvgpr_read_b32 v45, a237
    v_accvgpr_read_b32 v46, a238
    v_accvgpr_read_b32 v47, a239
    v_pk_mul_f32 v[48:49], v[40:41], v[40:41]
    v_pk_mul_f32 v[50:51], v[42:43], v[42:43]
    v_pk_mul_f32 v[52:53], v[44:45], v[44:45]
    v_pk_mul_f32 v[54:55], v[46:47], v[46:47]
    v_pk_fma_f32 v[48:49], v[48:49], v[242:243], v[240:241]
    v_pk_fma_f32 v[50:51], v[50:51], v[242:243], v[240:241]
    v_pk_fma_f32 v[52:53], v[52:53], v[242:243], v[240:241]
    v_pk_fma_f32 v[54:55], v[54:55], v[242:243], v[240:241]
    v_pk_mul_f32 v[48:49], v[48:49], v[40:41]
    v_pk_mul_f32 v[50:51], v[50:51], v[42:43]
    v_pk_mul_f32 v[52:53], v[52:53], v[44:45]
    v_pk_mul_f32 v[54:55], v[54:55], v[46:47]
    v_exp_f32 v48, v48
    v_exp_f32 v49, v49
    v_exp_f32 v50, v50
    v_exp_f32 v51, v51
    v_exp_f32 v52, v52
    v_exp_f32 v53, v53
    v_exp_f32 v54, v54
    v_exp_f32 v55, v55
    v_pk_add_f32 v[48:49], v[48:49], v[244:245]
    v_pk_add_f32 v[50:51], v[50:51], v[244:245]
    v_pk_add_f32 v[52:53], v[52:53], v[244:245]
    v_pk_add_f32 v[54:55], v[54:55], v[244:245]
    v_rcp_f32 v48, v48
    v_rcp_f32 v49, v49
    v_rcp_f32 v50, v50
    v_rcp_f32 v51, v51
    v_rcp_f32 v52, v52
    v_rcp_f32 v53, v53
    v_rcp_f32 v54, v54
    v_rcp_f32 v55, v55
    v_pk_mul_f32 v[40:41], v[48:49], v[40:41]
    v_pk_mul_f32 v[42:43], v[50:51], v[42:43]
    v_pk_mul_f32 v[44:45], v[52:53], v[44:45]
    v_pk_mul_f32 v[46:47], v[54:55], v[46:47]
    v_cvt_pk_bf16_f32 v56, v40, v41
    v_cvt_pk_bf16_f32 v57, v42, v43
    v_cvt_pk_bf16_f32 v58, v44, v45
    v_cvt_pk_bf16_f32 v59, v46, v47
    buffer_store_dwordx4 v[56:59], v251, s[4:7], s53 offen offset:1024 sc1
    v_accvgpr_read_b32 v0, a240
    v_accvgpr_read_b32 v1, a241
    v_accvgpr_read_b32 v2, a242
    v_accvgpr_read_b32 v3, a243
    v_accvgpr_read_b32 v4, a244
    v_accvgpr_read_b32 v5, a245
    v_accvgpr_read_b32 v6, a246
    v_accvgpr_read_b32 v7, a247
    v_pk_mul_f32 v[8:9], v[0:1], v[0:1]
    v_pk_mul_f32 v[10:11], v[2:3], v[2:3]
    v_pk_mul_f32 v[12:13], v[4:5], v[4:5]
    v_pk_mul_f32 v[14:15], v[6:7], v[6:7]
    v_pk_fma_f32 v[8:9], v[8:9], v[242:243], v[240:241]
    v_pk_fma_f32 v[10:11], v[10:11], v[242:243], v[240:241]
    v_pk_fma_f32 v[12:13], v[12:13], v[242:243], v[240:241]
    v_pk_fma_f32 v[14:15], v[14:15], v[242:243], v[240:241]
    v_pk_mul_f32 v[8:9], v[8:9], v[0:1]
    v_pk_mul_f32 v[10:11], v[10:11], v[2:3]
    v_pk_mul_f32 v[12:13], v[12:13], v[4:5]
    v_pk_mul_f32 v[14:15], v[14:15], v[6:7]
    v_exp_f32 v8, v8
    v_exp_f32 v9, v9
    v_exp_f32 v10, v10
    v_exp_f32 v11, v11
    v_exp_f32 v12, v12
    v_exp_f32 v13, v13
    v_exp_f32 v14, v14
    v_exp_f32 v15, v15
    v_pk_add_f32 v[8:9], v[8:9], v[244:245]
    v_pk_add_f32 v[10:11], v[10:11], v[244:245]
    v_pk_add_f32 v[12:13], v[12:13], v[244:245]
    v_pk_add_f32 v[14:15], v[14:15], v[244:245]
    v_rcp_f32 v8, v8
    v_rcp_f32 v9, v9
    v_rcp_f32 v10, v10
    v_rcp_f32 v11, v11
    v_rcp_f32 v12, v12
    v_rcp_f32 v13, v13
    v_rcp_f32 v14, v14
    v_rcp_f32 v15, v15
    v_pk_mul_f32 v[0:1], v[8:9], v[0:1]
    v_pk_mul_f32 v[2:3], v[10:11], v[2:3]
    v_pk_mul_f32 v[4:5], v[12:13], v[4:5]
    v_pk_mul_f32 v[6:7], v[14:15], v[6:7]
    v_cvt_pk_bf16_f32 v16, v0, v1
    v_cvt_pk_bf16_f32 v17, v2, v3
    v_cvt_pk_bf16_f32 v18, v4, v5
    v_cvt_pk_bf16_f32 v19, v6, v7
    buffer_store_dwordx4 v[16:19], v251, s[4:7], s53 offen offset:2048 sc1
    v_accvgpr_read_b32 v20, a248
    v_accvgpr_read_b32 v21, a249
    v_accvgpr_read_b32 v22, a250
    v_accvgpr_read_b32 v23, a251
    v_accvgpr_read_b32 v24, a252
    v_accvgpr_read_b32 v25, a253
    v_accvgpr_read_b32 v26, a254
    v_accvgpr_read_b32 v27, a255
    v_pk_mul_f32 v[28:29], v[20:21], v[20:21]
    v_pk_mul_f32 v[30:31], v[22:23], v[22:23]
    v_pk_mul_f32 v[32:33], v[24:25], v[24:25]
    v_pk_mul_f32 v[34:35], v[26:27], v[26:27]
    v_pk_fma_f32 v[28:29], v[28:29], v[242:243], v[240:241]
    v_pk_fma_f32 v[30:31], v[30:31], v[242:243], v[240:241]
    v_pk_fma_f32 v[32:33], v[32:33], v[242:243], v[240:241]
    v_pk_fma_f32 v[34:35], v[34:35], v[242:243], v[240:241]
    v_pk_mul_f32 v[28:29], v[28:29], v[20:21]
    v_pk_mul_f32 v[30:31], v[30:31], v[22:23]
    v_pk_mul_f32 v[32:33], v[32:33], v[24:25]
    v_pk_mul_f32 v[34:35], v[34:35], v[26:27]
    v_exp_f32 v28, v28
    v_exp_f32 v29, v29
    v_exp_f32 v30, v30
    v_exp_f32 v31, v31
    v_exp_f32 v32, v32
    v_exp_f32 v33, v33
    v_exp_f32 v34, v34
    v_exp_f32 v35, v35
    v_pk_add_f32 v[28:29], v[28:29], v[244:245]
    v_pk_add_f32 v[30:31], v[30:31], v[244:245]
    v_pk_add_f32 v[32:33], v[32:33], v[244:245]
    v_pk_add_f32 v[34:35], v[34:35], v[244:245]
    v_rcp_f32 v28, v28
    v_rcp_f32 v29, v29
    v_rcp_f32 v30, v30
    v_rcp_f32 v31, v31
    v_rcp_f32 v32, v32
    v_rcp_f32 v33, v33
    v_rcp_f32 v34, v34
    v_rcp_f32 v35, v35
    v_pk_mul_f32 v[20:21], v[28:29], v[20:21]
    v_pk_mul_f32 v[22:23], v[30:31], v[22:23]
    v_pk_mul_f32 v[24:25], v[32:33], v[24:25]
    v_pk_mul_f32 v[26:27], v[34:35], v[26:27]
    v_cvt_pk_bf16_f32 v36, v20, v21
    v_cvt_pk_bf16_f32 v37, v22, v23
    v_cvt_pk_bf16_f32 v38, v24, v25
    v_cvt_pk_bf16_f32 v39, v26, v27
    buffer_store_dwordx4 v[36:39], v251, s[4:7], s53 offen offset:3072 sc1
    s_branch main_kernel_w_done
main_kernel_w_c2_gov:
    v_lshrrev_b32 v0, 4, v250
    v_bfe_u32 v1, v250, 2, 2
    v_lshl_add_u32 v4, v0, 2, v1
    v_and_b32 v5, 7, v4
    v_mul_u32_u24 v4, 512, v4
    v_and_b32 v6, 3, v250
    v_lshl_add_u32 v4, v6, 3, v4
    s_mul_i32 s32, s37, 8
    v_xor_b32 v5, s32, v5
    v_lshl_add_u32 v128, v5, 5, v4
    v_xor_b32 v129, 32, v128
    v_xor_b32 v130, 64, v128
    v_xor_b32 v131, 96, v128
    v_xor_b32 v132, 128, v128
    v_xor_b32 v133, 160, v128
    v_xor_b32 v134, 192, v128
    v_xor_b32 v135, 224, v128
    s_mul_i32 s32, s38, 8192
    s_add_u32 s32, s32, 65536
    v_add_u32 v136, s32, v251
    v_lshrrev_b32 v2, 5, v250
    v_and_b32 v3, 31, v250
    s_mul_i32 s32, s14, 8
    v_add_u32 v4, s32, v2
    v_add_u32 v5, 0, v4
    v_and_b32 v6, 7, v5
    v_lshlrev_b32 v6, 1, v6
    v_xor_b32 v6, v6, v3
    v_mul_lo_u32 v5, v5, s30
    v_lshl_add_u32 v5, v6, 4, v5
    v_subrev_u32 v137, 0, v5
    v_add_u32 v5, 2, v4
    v_and_b32 v6, 7, v5
    v_lshlrev_b32 v6, 1, v6
    v_xor_b32 v6, v6, v3
    v_mul_lo_u32 v5, v5, s30
    v_lshl_add_u32 v5, v6, 4, v5
    v_subrev_u32 v138, 1024, v5
    v_add_u32 v5, 4, v4
    v_and_b32 v6, 7, v5
    v_lshlrev_b32 v6, 1, v6
    v_xor_b32 v6, v6, v3
    v_mul_lo_u32 v5, v5, s30
    v_lshl_add_u32 v5, v6, 4, v5
    v_subrev_u32 v139, 2048, v5
    v_add_u32 v5, 6, v4
    v_and_b32 v6, 7, v5
    v_lshlrev_b32 v6, 1, v6
    v_xor_b32 v6, v6, v3
    v_mul_lo_u32 v5, v5, s30
    v_lshl_add_u32 v5, v6, 4, v5
    v_subrev_u32 v140, 3072, v5
    s_mul_i32 s32, s14, 4
    s_mul_i32 s32, s32, s31
    v_add_u32 v141, s32, v251
    s_add_u32 s32, s32, s31
    s_sub_u32 s32, s32, 1024
    v_add_u32 v142, s32, v251
    s_add_u32 s32, s32, s31
    s_sub_u32 s32, s32, 1024
    v_add_u32 v143, s32, v251
    s_add_u32 s32, s32, s31
    s_sub_u32 s32, s32, 1024
    v_add_u32 v144, s32, v251
    s_mul_i32 s19, s14, 4096
    s_mul_i32 s20, s14, 4096
    s_add_u32 s20, s20, 65536
    s_mul_i32 s17, s30, 32
    s_mov_b32 s15, 0
    s_add_u32 m0, s20, 0
    s_nop 0
    buffer_load_dwordx4 v141, s[4:7], s16 offen offset:0 sc1 lds
    buffer_load_dwordx4 v142, s[4:7], s16 offen offset:1024 sc1 lds
    buffer_load_dwordx4 v143, s[4:7], s16 offen offset:2048 sc1 lds
    buffer_load_dwordx4 v144, s[4:7], s16 offen offset:3072 sc1 lds
    s_add_u32 s16, s16, 1024
    s_add_u32 m0, s19, 0
    s_nop 0
    buffer_load_dwordx4 v137, s[8:11], s15 offen offset:0 lds
    buffer_load_dwordx4 v138, s[8:11], s15 offen offset:1024 lds
    buffer_load_dwordx4 v139, s[8:11], s15 offen offset:2048 lds
    buffer_load_dwordx4 v140, s[8:11], s15 offen offset:3072 lds
    s_add_u32 s15, s15, s17
    s_add_u32 m0, s20, 16384
    s_nop 0
    buffer_load_dwordx4 v141, s[4:7], s16 offen offset:0 sc1 lds
    buffer_load_dwordx4 v142, s[4:7], s16 offen offset:1024 sc1 lds
    buffer_load_dwordx4 v143, s[4:7], s16 offen offset:2048 sc1 lds
    buffer_load_dwordx4 v144, s[4:7], s16 offen offset:3072 sc1 lds
    s_add_u32 s16, s16, 1024
    s_add_u32 m0, s19, 16384
    s_nop 0
    buffer_load_dwordx4 v137, s[8:11], s15 offen offset:0 lds
    buffer_load_dwordx4 v138, s[8:11], s15 offen offset:1024 lds
    buffer_load_dwordx4 v139, s[8:11], s15 offen offset:2048 lds
    buffer_load_dwordx4 v140, s[8:11], s15 offen offset:3072 lds
    s_add_u32 s15, s15, s17
    s_add_u32 m0, s20, 32768
    s_nop 0
    buffer_load_dwordx4 v141, s[4:7], s16 offen offset:0 sc1 lds
    buffer_load_dwordx4 v142, s[4:7], s16 offen offset:1024 sc1 lds
    buffer_load_dwordx4 v143, s[4:7], s16 offen offset:2048 sc1 lds
    buffer_load_dwordx4 v144, s[4:7], s16 offen offset:3072 sc1 lds
    s_add_u32 s16, s16, 1024
    s_add_u32 m0, s19, 32768
    s_nop 0
    buffer_load_dwordx4 v137, s[8:11], s15 offen offset:0 lds
    buffer_load_dwordx4 v138, s[8:11], s15 offen offset:1024 lds
    buffer_load_dwordx4 v139, s[8:11], s15 offen offset:2048 lds
    buffer_load_dwordx4 v140, s[8:11], s15 offen offset:3072 lds
    s_add_u32 s15, s15, s17
    s_add_u32 m0, s20, 49152
    s_nop 0
    buffer_load_dwordx4 v141, s[4:7], s16 offen offset:0 sc1 lds
    buffer_load_dwordx4 v142, s[4:7], s16 offen offset:1024 sc1 lds
    buffer_load_dwordx4 v143, s[4:7], s16 offen offset:2048 sc1 lds
    buffer_load_dwordx4 v144, s[4:7], s16 offen offset:3072 sc1 lds
    s_add_u32 s16, s16, 1024
    s_add_u32 m0, s19, 49152
    s_nop 0
    buffer_load_dwordx4 v137, s[8:11], s15 offen offset:0 lds
    buffer_load_dwordx4 v138, s[8:11], s15 offen offset:1024 lds
    buffer_load_dwordx4 v139, s[8:11], s15 offen offset:2048 lds
    buffer_load_dwordx4 v140, s[8:11], s15 offen offset:3072 lds
    s_add_u32 s15, s15, s17
    v_accvgpr_write_b32 a0, 0
    v_accvgpr_write_b32 a1, 0
    v_accvgpr_write_b32 a2, 0
    v_accvgpr_write_b32 a3, 0
    v_accvgpr_write_b32 a4, 0
    v_accvgpr_write_b32 a5, 0
    v_accvgpr_write_b32 a6, 0
    v_accvgpr_write_b32 a7, 0
    v_accvgpr_write_b32 a8, 0
    v_accvgpr_write_b32 a9, 0
    v_accvgpr_write_b32 a10, 0
    v_accvgpr_write_b32 a11, 0
    v_accvgpr_write_b32 a12, 0
    v_accvgpr_write_b32 a13, 0
    v_accvgpr_write_b32 a14, 0
    v_accvgpr_write_b32 a15, 0
    v_accvgpr_write_b32 a16, 0
    v_accvgpr_write_b32 a17, 0
    v_accvgpr_write_b32 a18, 0
    v_accvgpr_write_b32 a19, 0
    v_accvgpr_write_b32 a20, 0
    v_accvgpr_write_b32 a21, 0
    v_accvgpr_write_b32 a22, 0
    v_accvgpr_write_b32 a23, 0
    v_accvgpr_write_b32 a24, 0
    v_accvgpr_write_b32 a25, 0
    v_accvgpr_write_b32 a26, 0
    v_accvgpr_write_b32 a27, 0
    v_accvgpr_write_b32 a28, 0
    v_accvgpr_write_b32 a29, 0
    v_accvgpr_write_b32 a30, 0
    v_accvgpr_write_b32 a31, 0
    v_accvgpr_write_b32 a32, 0
    v_accvgpr_write_b32 a33, 0
    v_accvgpr_write_b32 a34, 0
    v_accvgpr_write_b32 a35, 0
    v_accvgpr_write_b32 a36, 0
    v_accvgpr_write_b32 a37, 0
    v_accvgpr_write_b32 a38, 0
    v_accvgpr_write_b32 a39, 0
    v_accvgpr_write_b32 a40, 0
    v_accvgpr_write_b32 a41, 0
    v_accvgpr_write_b32 a42, 0
    v_accvgpr_write_b32 a43, 0
    v_accvgpr_write_b32 a44, 0
    v_accvgpr_write_b32 a45, 0
    v_accvgpr_write_b32 a46, 0
    v_accvgpr_write_b32 a47, 0
    v_accvgpr_write_b32 a48, 0
    v_accvgpr_write_b32 a49, 0
    v_accvgpr_write_b32 a50, 0
    v_accvgpr_write_b32 a51, 0
    v_accvgpr_write_b32 a52, 0
    v_accvgpr_write_b32 a53, 0
    v_accvgpr_write_b32 a54, 0
    v_accvgpr_write_b32 a55, 0
    v_accvgpr_write_b32 a56, 0
    v_accvgpr_write_b32 a57, 0
    v_accvgpr_write_b32 a58, 0
    v_accvgpr_write_b32 a59, 0
    v_accvgpr_write_b32 a60, 0
    v_accvgpr_write_b32 a61, 0
    v_accvgpr_write_b32 a62, 0
    v_accvgpr_write_b32 a63, 0
    v_accvgpr_write_b32 a64, 0
    v_accvgpr_write_b32 a65, 0
    v_accvgpr_write_b32 a66, 0
    v_accvgpr_write_b32 a67, 0
    v_accvgpr_write_b32 a68, 0
    v_accvgpr_write_b32 a69, 0
    v_accvgpr_write_b32 a70, 0
    v_accvgpr_write_b32 a71, 0
    v_accvgpr_write_b32 a72, 0
    v_accvgpr_write_b32 a73, 0
    v_accvgpr_write_b32 a74, 0
    v_accvgpr_write_b32 a75, 0
    v_accvgpr_write_b32 a76, 0
    v_accvgpr_write_b32 a77, 0
    v_accvgpr_write_b32 a78, 0
    v_accvgpr_write_b32 a79, 0
    v_accvgpr_write_b32 a80, 0
    v_accvgpr_write_b32 a81, 0
    v_accvgpr_write_b32 a82, 0
    v_accvgpr_write_b32 a83, 0
    v_accvgpr_write_b32 a84, 0
    v_accvgpr_write_b32 a85, 0
    v_accvgpr_write_b32 a86, 0
    v_accvgpr_write_b32 a87, 0
    v_accvgpr_write_b32 a88, 0
    v_accvgpr_write_b32 a89, 0
    v_accvgpr_write_b32 a90, 0
    v_accvgpr_write_b32 a91, 0
    v_accvgpr_write_b32 a92, 0
    v_accvgpr_write_b32 a93, 0
    v_accvgpr_write_b32 a94, 0
    v_accvgpr_write_b32 a95, 0
    v_accvgpr_write_b32 a96, 0
    v_accvgpr_write_b32 a97, 0
    v_accvgpr_write_b32 a98, 0
    v_accvgpr_write_b32 a99, 0
    v_accvgpr_write_b32 a100, 0
    v_accvgpr_write_b32 a101, 0
    v_accvgpr_write_b32 a102, 0
    v_accvgpr_write_b32 a103, 0
    v_accvgpr_write_b32 a104, 0
    v_accvgpr_write_b32 a105, 0
    v_accvgpr_write_b32 a106, 0
    v_accvgpr_write_b32 a107, 0
    v_accvgpr_write_b32 a108, 0
    v_accvgpr_write_b32 a109, 0
    v_accvgpr_write_b32 a110, 0
    v_accvgpr_write_b32 a111, 0
    v_accvgpr_write_b32 a112, 0
    v_accvgpr_write_b32 a113, 0
    v_accvgpr_write_b32 a114, 0
    v_accvgpr_write_b32 a115, 0
    v_accvgpr_write_b32 a116, 0
    v_accvgpr_write_b32 a117, 0
    v_accvgpr_write_b32 a118, 0
    v_accvgpr_write_b32 a119, 0
    v_accvgpr_write_b32 a120, 0
    v_accvgpr_write_b32 a121, 0
    v_accvgpr_write_b32 a122, 0
    v_accvgpr_write_b32 a123, 0
    v_accvgpr_write_b32 a124, 0
    v_accvgpr_write_b32 a125, 0
    v_accvgpr_write_b32 a126, 0
    v_accvgpr_write_b32 a127, 0
    v_accvgpr_write_b32 a128, 0
    v_accvgpr_write_b32 a129, 0
    v_accvgpr_write_b32 a130, 0
    v_accvgpr_write_b32 a131, 0
    v_accvgpr_write_b32 a132, 0
    v_accvgpr_write_b32 a133, 0
    v_accvgpr_write_b32 a134, 0
    v_accvgpr_write_b32 a135, 0
    v_accvgpr_write_b32 a136, 0
    v_accvgpr_write_b32 a137, 0
    v_accvgpr_write_b32 a138, 0
    v_accvgpr_write_b32 a139, 0
    v_accvgpr_write_b32 a140, 0
    v_accvgpr_write_b32 a141, 0
    v_accvgpr_write_b32 a142, 0
    v_accvgpr_write_b32 a143, 0
    v_accvgpr_write_b32 a144, 0
    v_accvgpr_write_b32 a145, 0
    v_accvgpr_write_b32 a146, 0
    v_accvgpr_write_b32 a147, 0
    v_accvgpr_write_b32 a148, 0
    v_accvgpr_write_b32 a149, 0
    v_accvgpr_write_b32 a150, 0
    v_accvgpr_write_b32 a151, 0
    v_accvgpr_write_b32 a152, 0
    v_accvgpr_write_b32 a153, 0
    v_accvgpr_write_b32 a154, 0
    v_accvgpr_write_b32 a155, 0
    v_accvgpr_write_b32 a156, 0
    v_accvgpr_write_b32 a157, 0
    v_accvgpr_write_b32 a158, 0
    v_accvgpr_write_b32 a159, 0
    v_accvgpr_write_b32 a160, 0
    v_accvgpr_write_b32 a161, 0
    v_accvgpr_write_b32 a162, 0
    v_accvgpr_write_b32 a163, 0
    v_accvgpr_write_b32 a164, 0
    v_accvgpr_write_b32 a165, 0
    v_accvgpr_write_b32 a166, 0
    v_accvgpr_write_b32 a167, 0
    v_accvgpr_write_b32 a168, 0
    v_accvgpr_write_b32 a169, 0
    v_accvgpr_write_b32 a170, 0
    v_accvgpr_write_b32 a171, 0
    v_accvgpr_write_b32 a172, 0
    v_accvgpr_write_b32 a173, 0
    v_accvgpr_write_b32 a174, 0
    v_accvgpr_write_b32 a175, 0
    v_accvgpr_write_b32 a176, 0
    v_accvgpr_write_b32 a177, 0
    v_accvgpr_write_b32 a178, 0
    v_accvgpr_write_b32 a179, 0
    v_accvgpr_write_b32 a180, 0
    v_accvgpr_write_b32 a181, 0
    v_accvgpr_write_b32 a182, 0
    v_accvgpr_write_b32 a183, 0
    v_accvgpr_write_b32 a184, 0
    v_accvgpr_write_b32 a185, 0
    v_accvgpr_write_b32 a186, 0
    v_accvgpr_write_b32 a187, 0
    v_accvgpr_write_b32 a188, 0
    v_accvgpr_write_b32 a189, 0
    v_accvgpr_write_b32 a190, 0
    v_accvgpr_write_b32 a191, 0
    v_accvgpr_write_b32 a192, 0
    v_accvgpr_write_b32 a193, 0
    v_accvgpr_write_b32 a194, 0
    v_accvgpr_write_b32 a195, 0
    v_accvgpr_write_b32 a196, 0
    v_accvgpr_write_b32 a197, 0
    v_accvgpr_write_b32 a198, 0
    v_accvgpr_write_b32 a199, 0
    v_accvgpr_write_b32 a200, 0
    v_accvgpr_write_b32 a201, 0
    v_accvgpr_write_b32 a202, 0
    v_accvgpr_write_b32 a203, 0
    v_accvgpr_write_b32 a204, 0
    v_accvgpr_write_b32 a205, 0
    v_accvgpr_write_b32 a206, 0
    v_accvgpr_write_b32 a207, 0
    v_accvgpr_write_b32 a208, 0
    v_accvgpr_write_b32 a209, 0
    v_accvgpr_write_b32 a210, 0
    v_accvgpr_write_b32 a211, 0
    v_accvgpr_write_b32 a212, 0
    v_accvgpr_write_b32 a213, 0
    v_accvgpr_write_b32 a214, 0
    v_accvgpr_write_b32 a215, 0
    v_accvgpr_write_b32 a216, 0
    v_accvgpr_write_b32 a217, 0
    v_accvgpr_write_b32 a218, 0
    v_accvgpr_write_b32 a219, 0
    v_accvgpr_write_b32 a220, 0
    v_accvgpr_write_b32 a221, 0
    v_accvgpr_write_b32 a222, 0
    v_accvgpr_write_b32 a223, 0
    v_accvgpr_write_b32 a224, 0
    v_accvgpr_write_b32 a225, 0
    v_accvgpr_write_b32 a226, 0
    v_accvgpr_write_b32 a227, 0
    v_accvgpr_write_b32 a228, 0
    v_accvgpr_write_b32 a229, 0
    v_accvgpr_write_b32 a230, 0
    v_accvgpr_write_b32 a231, 0
    v_accvgpr_write_b32 a232, 0
    v_accvgpr_write_b32 a233, 0
    v_accvgpr_write_b32 a234, 0
    v_accvgpr_write_b32 a235, 0
    v_accvgpr_write_b32 a236, 0
    v_accvgpr_write_b32 a237, 0
    v_accvgpr_write_b32 a238, 0
    v_accvgpr_write_b32 a239, 0
    v_accvgpr_write_b32 a240, 0
    v_accvgpr_write_b32 a241, 0
    v_accvgpr_write_b32 a242, 0
    v_accvgpr_write_b32 a243, 0
    v_accvgpr_write_b32 a244, 0
    v_accvgpr_write_b32 a245, 0
    v_accvgpr_write_b32 a246, 0
    v_accvgpr_write_b32 a247, 0
    v_accvgpr_write_b32 a248, 0
    v_accvgpr_write_b32 a249, 0
    v_accvgpr_write_b32 a250, 0
    v_accvgpr_write_b32 a251, 0
    v_accvgpr_write_b32 a252, 0
    v_accvgpr_write_b32 a253, 0
    v_accvgpr_write_b32 a254, 0
    v_accvgpr_write_b32 a255, 0
    s_waitcnt vmcnt(24)
    s_barrier
    ds_read_b128 v[32:35], v136 offset:0
    ds_read_b64_tr_b16 v[0:1], v128 offset:0
    ds_read_b64_tr_b16 v[2:3], v128 offset:8192
    ds_read_b64_tr_b16 v[4:5], v129 offset:0
    ds_read_b64_tr_b16 v[6:7], v129 offset:8192
    ds_read_b64_tr_b16 v[8:9], v130 offset:0
    ds_read_b64_tr_b16 v[10:11], v130 offset:8192
    ds_read_b64_tr_b16 v[12:13], v131 offset:0
    ds_read_b64_tr_b16 v[14:15], v131 offset:8192
    ds_read_b64_tr_b16 v[16:17], v132 offset:0
    ds_read_b64_tr_b16 v[18:19], v132 offset:8192
    ds_read_b64_tr_b16 v[20:21], v133 offset:0
    ds_read_b64_tr_b16 v[22:23], v133 offset:8192
    ds_read_b64_tr_b16 v[24:25], v134 offset:0
    ds_read_b64_tr_b16 v[26:27], v134 offset:8192
    ds_read_b64_tr_b16 v[28:29], v135 offset:0
    ds_read_b64_tr_b16 v[30:31], v135 offset:8192
    ds_read_b128 v[36:39], v136 offset:1024
    ds_read_b128 v[40:43], v136 offset:2048
    ds_read_b128 v[44:47], v136 offset:3072
    ds_read_b128 v[48:51], v136 offset:4096
    ds_read_b128 v[52:55], v136 offset:5120
    ds_read_b128 v[56:59], v136 offset:6144
    ds_read_b128 v[60:63], v136 offset:7168
main_kernel_w_c2_v_loop:
    s_waitcnt lgkmcnt(0)
    v_mfma_f32_16x16x32_bf16 a[0:3], v[32:35], v[0:3], a[0:3]
    s_waitcnt vmcnt(16)
    s_barrier
    ds_read_b128 v[96:99], v136 offset:16384
    s_add_u32 m0, s20, 0
    s_nop 0
    v_mfma_f32_16x16x32_bf16 a[4:7], v[32:35], v[4:7], a[4:7]
    ds_read_b64_tr_b16 v[64:65], v128 offset:16384
    v_mfma_f32_16x16x32_bf16 a[8:11], v[32:35], v[8:11], a[8:11]
    ds_read_b64_tr_b16 v[66:67], v128 offset:24576
    v_mfma_f32_16x16x32_bf16 a[12:15], v[32:35], v[12:15], a[12:15]
    ds_read_b64_tr_b16 v[68:69], v129 offset:16384
    v_mfma_f32_16x16x32_bf16 a[16:19], v[32:35], v[16:19], a[16:19]
    ds_read_b64_tr_b16 v[70:71], v129 offset:24576
    v_mfma_f32_16x16x32_bf16 a[20:23], v[32:35], v[20:23], a[20:23]
    ds_read_b64_tr_b16 v[72:73], v130 offset:16384
    buffer_load_dwordx4 v141, s[4:7], s16 offen offset:0 sc1 lds
    v_mfma_f32_16x16x32_bf16 a[24:27], v[32:35], v[24:27], a[24:27]
    ds_read_b64_tr_b16 v[74:75], v130 offset:24576
    v_mfma_f32_16x16x32_bf16 a[28:31], v[32:35], v[28:31], a[28:31]
    ds_read_b64_tr_b16 v[76:77], v131 offset:16384
    v_mfma_f32_16x16x32_bf16 a[32:35], v[36:39], v[0:3], a[32:35]
    ds_read_b64_tr_b16 v[78:79], v131 offset:24576
    v_mfma_f32_16x16x32_bf16 a[36:39], v[36:39], v[4:7], a[36:39]
    ds_read_b64_tr_b16 v[80:81], v132 offset:16384
    v_mfma_f32_16x16x32_bf16 a[40:43], v[36:39], v[8:11], a[40:43]
    ds_read_b64_tr_b16 v[82:83], v132 offset:24576
    buffer_load_dwordx4 v142, s[4:7], s16 offen offset:1024 sc1 lds
    v_mfma_f32_16x16x32_bf16 a[44:47], v[36:39], v[12:15], a[44:47]
    ds_read_b64_tr_b16 v[84:85], v133 offset:16384
    v_mfma_f32_16x16x32_bf16 a[48:51], v[36:39], v[16:19], a[48:51]
    ds_read_b64_tr_b16 v[86:87], v133 offset:24576
    v_mfma_f32_16x16x32_bf16 a[52:55], v[36:39], v[20:23], a[52:55]
    ds_read_b64_tr_b16 v[88:89], v134 offset:16384
    v_mfma_f32_16x16x32_bf16 a[56:59], v[36:39], v[24:27], a[56:59]
    ds_read_b64_tr_b16 v[90:91], v134 offset:24576
    v_mfma_f32_16x16x32_bf16 a[60:63], v[36:39], v[28:31], a[60:63]
    ds_read_b64_tr_b16 v[92:93], v135 offset:16384
    buffer_load_dwordx4 v143, s[4:7], s16 offen offset:2048 sc1 lds
    v_mfma_f32_16x16x32_bf16 a[64:67], v[40:43], v[0:3], a[64:67]
    ds_read_b64_tr_b16 v[94:95], v135 offset:24576
    v_mfma_f32_16x16x32_bf16 a[68:71], v[40:43], v[4:7], a[68:71]
    ds_read_b128 v[100:103], v136 offset:17408
    v_mfma_f32_16x16x32_bf16 a[72:75], v[40:43], v[8:11], a[72:75]
    ds_read_b128 v[104:107], v136 offset:18432
    v_mfma_f32_16x16x32_bf16 a[76:79], v[40:43], v[12:15], a[76:79]
    ds_read_b128 v[108:111], v136 offset:19456
    v_mfma_f32_16x16x32_bf16 a[80:83], v[40:43], v[16:19], a[80:83]
    ds_read_b128 v[112:115], v136 offset:20480
    v_mfma_f32_16x16x32_bf16 a[84:87], v[40:43], v[20:23], a[84:87]
    ds_read_b128 v[116:119], v136 offset:21504
    buffer_load_dwordx4 v144, s[4:7], s16 offen offset:3072 sc1 lds
    v_mfma_f32_16x16x32_bf16 a[88:91], v[40:43], v[24:27], a[88:91]
    ds_read_b128 v[120:123], v136 offset:22528
    v_mfma_f32_16x16x32_bf16 a[92:95], v[40:43], v[28:31], a[92:95]
    ds_read_b128 v[124:127], v136 offset:23552
    v_mfma_f32_16x16x32_bf16 a[96:99], v[44:47], v[0:3], a[96:99]
    v_mfma_f32_16x16x32_bf16 a[100:103], v[44:47], v[4:7], a[100:103]
    v_mfma_f32_16x16x32_bf16 a[104:107], v[44:47], v[8:11], a[104:107]
    s_add_u32 s16, s16, 1024
    v_mfma_f32_16x16x32_bf16 a[108:111], v[44:47], v[12:15], a[108:111]
    v_mfma_f32_16x16x32_bf16 a[112:115], v[44:47], v[16:19], a[112:115]
    v_mfma_f32_16x16x32_bf16 a[116:119], v[44:47], v[20:23], a[116:119]
    v_mfma_f32_16x16x32_bf16 a[120:123], v[44:47], v[24:27], a[120:123]
    v_mfma_f32_16x16x32_bf16 a[124:127], v[44:47], v[28:31], a[124:127]
    s_add_u32 m0, s19, 0
    s_nop 0
    v_mfma_f32_16x16x32_bf16 a[128:131], v[48:51], v[0:3], a[128:131]
    v_mfma_f32_16x16x32_bf16 a[132:135], v[48:51], v[4:7], a[132:135]
    v_mfma_f32_16x16x32_bf16 a[136:139], v[48:51], v[8:11], a[136:139]
    v_mfma_f32_16x16x32_bf16 a[140:143], v[48:51], v[12:15], a[140:143]
    v_mfma_f32_16x16x32_bf16 a[144:147], v[48:51], v[16:19], a[144:147]
    buffer_load_dwordx4 v137, s[8:11], s15 offen offset:0 lds
    v_mfma_f32_16x16x32_bf16 a[148:151], v[48:51], v[20:23], a[148:151]
    v_mfma_f32_16x16x32_bf16 a[152:155], v[48:51], v[24:27], a[152:155]
    v_mfma_f32_16x16x32_bf16 a[156:159], v[48:51], v[28:31], a[156:159]
    v_mfma_f32_16x16x32_bf16 a[160:163], v[52:55], v[0:3], a[160:163]
    v_mfma_f32_16x16x32_bf16 a[164:167], v[52:55], v[4:7], a[164:167]
    v_mfma_f32_16x16x32_bf16 a[168:171], v[52:55], v[8:11], a[168:171]
    buffer_load_dwordx4 v138, s[8:11], s15 offen offset:1024 lds
    v_mfma_f32_16x16x32_bf16 a[172:175], v[52:55], v[12:15], a[172:175]
    v_mfma_f32_16x16x32_bf16 a[176:179], v[52:55], v[16:19], a[176:179]
    v_mfma_f32_16x16x32_bf16 a[180:183], v[52:55], v[20:23], a[180:183]
    v_mfma_f32_16x16x32_bf16 a[184:187], v[52:55], v[24:27], a[184:187]
    v_mfma_f32_16x16x32_bf16 a[188:191], v[52:55], v[28:31], a[188:191]
    buffer_load_dwordx4 v139, s[8:11], s15 offen offset:2048 lds
    v_mfma_f32_16x16x32_bf16 a[192:195], v[56:59], v[0:3], a[192:195]
    v_mfma_f32_16x16x32_bf16 a[196:199], v[56:59], v[4:7], a[196:199]
    v_mfma_f32_16x16x32_bf16 a[200:203], v[56:59], v[8:11], a[200:203]
    v_mfma_f32_16x16x32_bf16 a[204:207], v[56:59], v[12:15], a[204:207]
    v_mfma_f32_16x16x32_bf16 a[208:211], v[56:59], v[16:19], a[208:211]
    buffer_load_dwordx4 v140, s[8:11], s15 offen offset:3072 lds
    v_mfma_f32_16x16x32_bf16 a[212:215], v[56:59], v[20:23], a[212:215]
    v_mfma_f32_16x16x32_bf16 a[216:219], v[56:59], v[24:27], a[216:219]
    v_mfma_f32_16x16x32_bf16 a[220:223], v[56:59], v[28:31], a[220:223]
    v_mfma_f32_16x16x32_bf16 a[224:227], v[60:63], v[0:3], a[224:227]
    v_mfma_f32_16x16x32_bf16 a[228:231], v[60:63], v[4:7], a[228:231]
    s_add_u32 s15, s15, s17
    v_mfma_f32_16x16x32_bf16 a[232:235], v[60:63], v[8:11], a[232:235]
    v_mfma_f32_16x16x32_bf16 a[236:239], v[60:63], v[12:15], a[236:239]
    v_mfma_f32_16x16x32_bf16 a[240:243], v[60:63], v[16:19], a[240:243]
    v_mfma_f32_16x16x32_bf16 a[244:247], v[60:63], v[20:23], a[244:247]
    v_mfma_f32_16x16x32_bf16 a[248:251], v[60:63], v[24:27], a[248:251]
    v_mfma_f32_16x16x32_bf16 a[252:255], v[60:63], v[28:31], a[252:255]
    s_waitcnt lgkmcnt(0)
    v_mfma_f32_16x16x32_bf16 a[0:3], v[96:99], v[64:67], a[0:3]
    s_waitcnt vmcnt(16)
    s_barrier
    ds_read_b128 v[32:35], v136 offset:32768
    s_add_u32 m0, s20, 16384
    s_nop 0
    v_mfma_f32_16x16x32_bf16 a[4:7], v[96:99], v[68:71], a[4:7]
    ds_read_b64_tr_b16 v[0:1], v128 offset:32768
    v_mfma_f32_16x16x32_bf16 a[8:11], v[96:99], v[72:75], a[8:11]
    ds_read_b64_tr_b16 v[2:3], v128 offset:40960
    v_mfma_f32_16x16x32_bf16 a[12:15], v[96:99], v[76:79], a[12:15]
    ds_read_b64_tr_b16 v[4:5], v129 offset:32768
    v_mfma_f32_16x16x32_bf16 a[16:19], v[96:99], v[80:83], a[16:19]
    ds_read_b64_tr_b16 v[6:7], v129 offset:40960
    v_mfma_f32_16x16x32_bf16 a[20:23], v[96:99], v[84:87], a[20:23]
    ds_read_b64_tr_b16 v[8:9], v130 offset:32768
    buffer_load_dwordx4 v141, s[4:7], s16 offen offset:0 sc1 lds
    v_mfma_f32_16x16x32_bf16 a[24:27], v[96:99], v[88:91], a[24:27]
    ds_read_b64_tr_b16 v[10:11], v130 offset:40960
    v_mfma_f32_16x16x32_bf16 a[28:31], v[96:99], v[92:95], a[28:31]
    ds_read_b64_tr_b16 v[12:13], v131 offset:32768
    v_mfma_f32_16x16x32_bf16 a[32:35], v[100:103], v[64:67], a[32:35]
    ds_read_b64_tr_b16 v[14:15], v131 offset:40960
    v_mfma_f32_16x16x32_bf16 a[36:39], v[100:103], v[68:71], a[36:39]
    ds_read_b64_tr_b16 v[16:17], v132 offset:32768
    v_mfma_f32_16x16x32_bf16 a[40:43], v[100:103], v[72:75], a[40:43]
    ds_read_b64_tr_b16 v[18:19], v132 offset:40960
    buffer_load_dwordx4 v142, s[4:7], s16 offen offset:1024 sc1 lds
    v_mfma_f32_16x16x32_bf16 a[44:47], v[100:103], v[76:79], a[44:47]
    ds_read_b64_tr_b16 v[20:21], v133 offset:32768
    v_mfma_f32_16x16x32_bf16 a[48:51], v[100:103], v[80:83], a[48:51]
    ds_read_b64_tr_b16 v[22:23], v133 offset:40960
    v_mfma_f32_16x16x32_bf16 a[52:55], v[100:103], v[84:87], a[52:55]
    ds_read_b64_tr_b16 v[24:25], v134 offset:32768
    v_mfma_f32_16x16x32_bf16 a[56:59], v[100:103], v[88:91], a[56:59]
    ds_read_b64_tr_b16 v[26:27], v134 offset:40960
    v_mfma_f32_16x16x32_bf16 a[60:63], v[100:103], v[92:95], a[60:63]
    ds_read_b64_tr_b16 v[28:29], v135 offset:32768
    buffer_load_dwordx4 v143, s[4:7], s16 offen offset:2048 sc1 lds
    v_mfma_f32_16x16x32_bf16 a[64:67], v[104:107], v[64:67], a[64:67]
    ds_read_b64_tr_b16 v[30:31], v135 offset:40960
    v_mfma_f32_16x16x32_bf16 a[68:71], v[104:107], v[68:71], a[68:71]
    ds_read_b128 v[36:39], v136 offset:33792
    v_mfma_f32_16x16x32_bf16 a[72:75], v[104:107], v[72:75], a[72:75]
    ds_read_b128 v[40:43], v136 offset:34816
    v_mfma_f32_16x16x32_bf16 a[76:79], v[104:107], v[76:79], a[76:79]
    ds_read_b128 v[44:47], v136 offset:35840
    v_mfma_f32_16x16x32_bf16 a[80:83], v[104:107], v[80:83], a[80:83]
    ds_read_b128 v[48:51], v136 offset:36864
    v_mfma_f32_16x16x32_bf16 a[84:87], v[104:107], v[84:87], a[84:87]
    ds_read_b128 v[52:55], v136 offset:37888
    buffer_load_dwordx4 v144, s[4:7], s16 offen offset:3072 sc1 lds
    v_mfma_f32_16x16x32_bf16 a[88:91], v[104:107], v[88:91], a[88:91]
    ds_read_b128 v[56:59], v136 offset:38912
    v_mfma_f32_16x16x32_bf16 a[92:95], v[104:107], v[92:95], a[92:95]
    ds_read_b128 v[60:63], v136 offset:39936
    v_mfma_f32_16x16x32_bf16 a[96:99], v[108:111], v[64:67], a[96:99]
    v_mfma_f32_16x16x32_bf16 a[100:103], v[108:111], v[68:71], a[100:103]
    v_mfma_f32_16x16x32_bf16 a[104:107], v[108:111], v[72:75], a[104:107]
    s_add_u32 s16, s16, 1024
    v_mfma_f32_16x16x32_bf16 a[108:111], v[108:111], v[76:79], a[108:111]
    v_mfma_f32_16x16x32_bf16 a[112:115], v[108:111], v[80:83], a[112:115]
    v_mfma_f32_16x16x32_bf16 a[116:119], v[108:111], v[84:87], a[116:119]
    v_mfma_f32_16x16x32_bf16 a[120:123], v[108:111], v[88:91], a[120:123]
    v_mfma_f32_16x16x32_bf16 a[124:127], v[108:111], v[92:95], a[124:127]
    s_add_u32 m0, s19, 16384
    s_nop 0
    v_mfma_f32_16x16x32_bf16 a[128:131], v[112:115], v[64:67], a[128:131]
    v_mfma_f32_16x16x32_bf16 a[132:135], v[112:115], v[68:71], a[132:135]
    v_mfma_f32_16x16x32_bf16 a[136:139], v[112:115], v[72:75], a[136:139]
    v_mfma_f32_16x16x32_bf16 a[140:143], v[112:115], v[76:79], a[140:143]
    v_mfma_f32_16x16x32_bf16 a[144:147], v[112:115], v[80:83], a[144:147]
    buffer_load_dwordx4 v137, s[8:11], s15 offen offset:0 lds
    v_mfma_f32_16x16x32_bf16 a[148:151], v[112:115], v[84:87], a[148:151]
    v_mfma_f32_16x16x32_bf16 a[152:155], v[112:115], v[88:91], a[152:155]
    v_mfma_f32_16x16x32_bf16 a[156:159], v[112:115], v[92:95], a[156:159]
    v_mfma_f32_16x16x32_bf16 a[160:163], v[116:119], v[64:67], a[160:163]
    v_mfma_f32_16x16x32_bf16 a[164:167], v[116:119], v[68:71], a[164:167]
    v_mfma_f32_16x16x32_bf16 a[168:171], v[116:119], v[72:75], a[168:171]
    buffer_load_dwordx4 v138, s[8:11], s15 offen offset:1024 lds
    v_mfma_f32_16x16x32_bf16 a[172:175], v[116:119], v[76:79], a[172:175]
    v_mfma_f32_16x16x32_bf16 a[176:179], v[116:119], v[80:83], a[176:179]
    v_mfma_f32_16x16x32_bf16 a[180:183], v[116:119], v[84:87], a[180:183]
    v_mfma_f32_16x16x32_bf16 a[184:187], v[116:119], v[88:91], a[184:187]
    v_mfma_f32_16x16x32_bf16 a[188:191], v[116:119], v[92:95], a[188:191]
    buffer_load_dwordx4 v139, s[8:11], s15 offen offset:2048 lds
    v_mfma_f32_16x16x32_bf16 a[192:195], v[120:123], v[64:67], a[192:195]
    v_mfma_f32_16x16x32_bf16 a[196:199], v[120:123], v[68:71], a[196:199]
    v_mfma_f32_16x16x32_bf16 a[200:203], v[120:123], v[72:75], a[200:203]
    v_mfma_f32_16x16x32_bf16 a[204:207], v[120:123], v[76:79], a[204:207]
    v_mfma_f32_16x16x32_bf16 a[208:211], v[120:123], v[80:83], a[208:211]
    buffer_load_dwordx4 v140, s[8:11], s15 offen offset:3072 lds
    v_mfma_f32_16x16x32_bf16 a[212:215], v[120:123], v[84:87], a[212:215]
    v_mfma_f32_16x16x32_bf16 a[216:219], v[120:123], v[88:91], a[216:219]
    v_mfma_f32_16x16x32_bf16 a[220:223], v[120:123], v[92:95], a[220:223]
    v_mfma_f32_16x16x32_bf16 a[224:227], v[124:127], v[64:67], a[224:227]
    v_mfma_f32_16x16x32_bf16 a[228:231], v[124:127], v[68:71], a[228:231]
    s_add_u32 s15, s15, s17
    v_mfma_f32_16x16x32_bf16 a[232:235], v[124:127], v[72:75], a[232:235]
    v_mfma_f32_16x16x32_bf16 a[236:239], v[124:127], v[76:79], a[236:239]
    v_mfma_f32_16x16x32_bf16 a[240:243], v[124:127], v[80:83], a[240:243]
    v_mfma_f32_16x16x32_bf16 a[244:247], v[124:127], v[84:87], a[244:247]
    v_mfma_f32_16x16x32_bf16 a[248:251], v[124:127], v[88:91], a[248:251]
    v_mfma_f32_16x16x32_bf16 a[252:255], v[124:127], v[92:95], a[252:255]
    s_waitcnt lgkmcnt(0)
    v_mfma_f32_16x16x32_bf16 a[0:3], v[32:35], v[0:3], a[0:3]
    s_waitcnt vmcnt(16)
    s_barrier
    ds_read_b128 v[96:99], v136 offset:49152
    s_add_u32 m0, s20, 32768
    s_nop 0
    v_mfma_f32_16x16x32_bf16 a[4:7], v[32:35], v[4:7], a[4:7]
    ds_read_b64_tr_b16 v[64:65], v128 offset:49152
    v_mfma_f32_16x16x32_bf16 a[8:11], v[32:35], v[8:11], a[8:11]
    ds_read_b64_tr_b16 v[66:67], v128 offset:57344
    v_mfma_f32_16x16x32_bf16 a[12:15], v[32:35], v[12:15], a[12:15]
    ds_read_b64_tr_b16 v[68:69], v129 offset:49152
    v_mfma_f32_16x16x32_bf16 a[16:19], v[32:35], v[16:19], a[16:19]
    ds_read_b64_tr_b16 v[70:71], v129 offset:57344
    v_mfma_f32_16x16x32_bf16 a[20:23], v[32:35], v[20:23], a[20:23]
    ds_read_b64_tr_b16 v[72:73], v130 offset:49152
    buffer_load_dwordx4 v141, s[4:7], s16 offen offset:0 sc1 lds
    v_mfma_f32_16x16x32_bf16 a[24:27], v[32:35], v[24:27], a[24:27]
    ds_read_b64_tr_b16 v[74:75], v130 offset:57344
    v_mfma_f32_16x16x32_bf16 a[28:31], v[32:35], v[28:31], a[28:31]
    ds_read_b64_tr_b16 v[76:77], v131 offset:49152
    v_mfma_f32_16x16x32_bf16 a[32:35], v[36:39], v[0:3], a[32:35]
    ds_read_b64_tr_b16 v[78:79], v131 offset:57344
    v_mfma_f32_16x16x32_bf16 a[36:39], v[36:39], v[4:7], a[36:39]
    ds_read_b64_tr_b16 v[80:81], v132 offset:49152
    v_mfma_f32_16x16x32_bf16 a[40:43], v[36:39], v[8:11], a[40:43]
    ds_read_b64_tr_b16 v[82:83], v132 offset:57344
    buffer_load_dwordx4 v142, s[4:7], s16 offen offset:1024 sc1 lds
    v_mfma_f32_16x16x32_bf16 a[44:47], v[36:39], v[12:15], a[44:47]
    ds_read_b64_tr_b16 v[84:85], v133 offset:49152
    v_mfma_f32_16x16x32_bf16 a[48:51], v[36:39], v[16:19], a[48:51]
    ds_read_b64_tr_b16 v[86:87], v133 offset:57344
    v_mfma_f32_16x16x32_bf16 a[52:55], v[36:39], v[20:23], a[52:55]
    ds_read_b64_tr_b16 v[88:89], v134 offset:49152
    v_mfma_f32_16x16x32_bf16 a[56:59], v[36:39], v[24:27], a[56:59]
    ds_read_b64_tr_b16 v[90:91], v134 offset:57344
    v_mfma_f32_16x16x32_bf16 a[60:63], v[36:39], v[28:31], a[60:63]
    ds_read_b64_tr_b16 v[92:93], v135 offset:49152
    buffer_load_dwordx4 v143, s[4:7], s16 offen offset:2048 sc1 lds
    v_mfma_f32_16x16x32_bf16 a[64:67], v[40:43], v[0:3], a[64:67]
    ds_read_b64_tr_b16 v[94:95], v135 offset:57344
    v_mfma_f32_16x16x32_bf16 a[68:71], v[40:43], v[4:7], a[68:71]
    ds_read_b128 v[100:103], v136 offset:50176
    v_mfma_f32_16x16x32_bf16 a[72:75], v[40:43], v[8:11], a[72:75]
    ds_read_b128 v[104:107], v136 offset:51200
    v_mfma_f32_16x16x32_bf16 a[76:79], v[40:43], v[12:15], a[76:79]
    ds_read_b128 v[108:111], v136 offset:52224
    v_mfma_f32_16x16x32_bf16 a[80:83], v[40:43], v[16:19], a[80:83]
    ds_read_b128 v[112:115], v136 offset:53248
    v_mfma_f32_16x16x32_bf16 a[84:87], v[40:43], v[20:23], a[84:87]
    ds_read_b128 v[116:119], v136 offset:54272
    buffer_load_dwordx4 v144, s[4:7], s16 offen offset:3072 sc1 lds
    v_mfma_f32_16x16x32_bf16 a[88:91], v[40:43], v[24:27], a[88:91]
    ds_read_b128 v[120:123], v136 offset:55296
    v_mfma_f32_16x16x32_bf16 a[92:95], v[40:43], v[28:31], a[92:95]
    ds_read_b128 v[124:127], v136 offset:56320
    v_mfma_f32_16x16x32_bf16 a[96:99], v[44:47], v[0:3], a[96:99]
    v_mfma_f32_16x16x32_bf16 a[100:103], v[44:47], v[4:7], a[100:103]
    v_mfma_f32_16x16x32_bf16 a[104:107], v[44:47], v[8:11], a[104:107]
    s_add_u32 s16, s16, 1024
    v_mfma_f32_16x16x32_bf16 a[108:111], v[44:47], v[12:15], a[108:111]
    v_mfma_f32_16x16x32_bf16 a[112:115], v[44:47], v[16:19], a[112:115]
    v_mfma_f32_16x16x32_bf16 a[116:119], v[44:47], v[20:23], a[116:119]
    v_mfma_f32_16x16x32_bf16 a[120:123], v[44:47], v[24:27], a[120:123]
    v_mfma_f32_16x16x32_bf16 a[124:127], v[44:47], v[28:31], a[124:127]
    s_add_u32 m0, s19, 32768
    s_nop 0
    v_mfma_f32_16x16x32_bf16 a[128:131], v[48:51], v[0:3], a[128:131]
    v_mfma_f32_16x16x32_bf16 a[132:135], v[48:51], v[4:7], a[132:135]
    v_mfma_f32_16x16x32_bf16 a[136:139], v[48:51], v[8:11], a[136:139]
    v_mfma_f32_16x16x32_bf16 a[140:143], v[48:51], v[12:15], a[140:143]
    v_mfma_f32_16x16x32_bf16 a[144:147], v[48:51], v[16:19], a[144:147]
    buffer_load_dwordx4 v137, s[8:11], s15 offen offset:0 lds
    v_mfma_f32_16x16x32_bf16 a[148:151], v[48:51], v[20:23], a[148:151]
    v_mfma_f32_16x16x32_bf16 a[152:155], v[48:51], v[24:27], a[152:155]
    v_mfma_f32_16x16x32_bf16 a[156:159], v[48:51], v[28:31], a[156:159]
    v_mfma_f32_16x16x32_bf16 a[160:163], v[52:55], v[0:3], a[160:163]
    v_mfma_f32_16x16x32_bf16 a[164:167], v[52:55], v[4:7], a[164:167]
    v_mfma_f32_16x16x32_bf16 a[168:171], v[52:55], v[8:11], a[168:171]
    buffer_load_dwordx4 v138, s[8:11], s15 offen offset:1024 lds
    v_mfma_f32_16x16x32_bf16 a[172:175], v[52:55], v[12:15], a[172:175]
    v_mfma_f32_16x16x32_bf16 a[176:179], v[52:55], v[16:19], a[176:179]
    v_mfma_f32_16x16x32_bf16 a[180:183], v[52:55], v[20:23], a[180:183]
    v_mfma_f32_16x16x32_bf16 a[184:187], v[52:55], v[24:27], a[184:187]
    v_mfma_f32_16x16x32_bf16 a[188:191], v[52:55], v[28:31], a[188:191]
    buffer_load_dwordx4 v139, s[8:11], s15 offen offset:2048 lds
    v_mfma_f32_16x16x32_bf16 a[192:195], v[56:59], v[0:3], a[192:195]
    v_mfma_f32_16x16x32_bf16 a[196:199], v[56:59], v[4:7], a[196:199]
    v_mfma_f32_16x16x32_bf16 a[200:203], v[56:59], v[8:11], a[200:203]
    v_mfma_f32_16x16x32_bf16 a[204:207], v[56:59], v[12:15], a[204:207]
    v_mfma_f32_16x16x32_bf16 a[208:211], v[56:59], v[16:19], a[208:211]
    buffer_load_dwordx4 v140, s[8:11], s15 offen offset:3072 lds
    v_mfma_f32_16x16x32_bf16 a[212:215], v[56:59], v[20:23], a[212:215]
    v_mfma_f32_16x16x32_bf16 a[216:219], v[56:59], v[24:27], a[216:219]
    v_mfma_f32_16x16x32_bf16 a[220:223], v[56:59], v[28:31], a[220:223]
    v_mfma_f32_16x16x32_bf16 a[224:227], v[60:63], v[0:3], a[224:227]
    v_mfma_f32_16x16x32_bf16 a[228:231], v[60:63], v[4:7], a[228:231]
    s_add_u32 s15, s15, s17
    v_mfma_f32_16x16x32_bf16 a[232:235], v[60:63], v[8:11], a[232:235]
    v_mfma_f32_16x16x32_bf16 a[236:239], v[60:63], v[12:15], a[236:239]
    v_mfma_f32_16x16x32_bf16 a[240:243], v[60:63], v[16:19], a[240:243]
    v_mfma_f32_16x16x32_bf16 a[244:247], v[60:63], v[20:23], a[244:247]
    v_mfma_f32_16x16x32_bf16 a[248:251], v[60:63], v[24:27], a[248:251]
    v_mfma_f32_16x16x32_bf16 a[252:255], v[60:63], v[28:31], a[252:255]
    s_waitcnt lgkmcnt(0)
    v_mfma_f32_16x16x32_bf16 a[0:3], v[96:99], v[64:67], a[0:3]
    s_waitcnt vmcnt(16)
    s_barrier
    ds_read_b128 v[32:35], v136 offset:0
    s_add_u32 m0, s20, 49152
    s_nop 0
    v_mfma_f32_16x16x32_bf16 a[4:7], v[96:99], v[68:71], a[4:7]
    ds_read_b64_tr_b16 v[0:1], v128 offset:0
    v_mfma_f32_16x16x32_bf16 a[8:11], v[96:99], v[72:75], a[8:11]
    ds_read_b64_tr_b16 v[2:3], v128 offset:8192
    v_mfma_f32_16x16x32_bf16 a[12:15], v[96:99], v[76:79], a[12:15]
    ds_read_b64_tr_b16 v[4:5], v129 offset:0
    v_mfma_f32_16x16x32_bf16 a[16:19], v[96:99], v[80:83], a[16:19]
    ds_read_b64_tr_b16 v[6:7], v129 offset:8192
    v_mfma_f32_16x16x32_bf16 a[20:23], v[96:99], v[84:87], a[20:23]
    ds_read_b64_tr_b16 v[8:9], v130 offset:0
    buffer_load_dwordx4 v141, s[4:7], s16 offen offset:0 sc1 lds
    v_mfma_f32_16x16x32_bf16 a[24:27], v[96:99], v[88:91], a[24:27]
    ds_read_b64_tr_b16 v[10:11], v130 offset:8192
    v_mfma_f32_16x16x32_bf16 a[28:31], v[96:99], v[92:95], a[28:31]
    ds_read_b64_tr_b16 v[12:13], v131 offset:0
    v_mfma_f32_16x16x32_bf16 a[32:35], v[100:103], v[64:67], a[32:35]
    ds_read_b64_tr_b16 v[14:15], v131 offset:8192
    v_mfma_f32_16x16x32_bf16 a[36:39], v[100:103], v[68:71], a[36:39]
    ds_read_b64_tr_b16 v[16:17], v132 offset:0
    v_mfma_f32_16x16x32_bf16 a[40:43], v[100:103], v[72:75], a[40:43]
    ds_read_b64_tr_b16 v[18:19], v132 offset:8192
    buffer_load_dwordx4 v142, s[4:7], s16 offen offset:1024 sc1 lds
    v_mfma_f32_16x16x32_bf16 a[44:47], v[100:103], v[76:79], a[44:47]
    ds_read_b64_tr_b16 v[20:21], v133 offset:0
    v_mfma_f32_16x16x32_bf16 a[48:51], v[100:103], v[80:83], a[48:51]
    ds_read_b64_tr_b16 v[22:23], v133 offset:8192
    v_mfma_f32_16x16x32_bf16 a[52:55], v[100:103], v[84:87], a[52:55]
    ds_read_b64_tr_b16 v[24:25], v134 offset:0
    v_mfma_f32_16x16x32_bf16 a[56:59], v[100:103], v[88:91], a[56:59]
    ds_read_b64_tr_b16 v[26:27], v134 offset:8192
    v_mfma_f32_16x16x32_bf16 a[60:63], v[100:103], v[92:95], a[60:63]
    ds_read_b64_tr_b16 v[28:29], v135 offset:0
    buffer_load_dwordx4 v143, s[4:7], s16 offen offset:2048 sc1 lds
    v_mfma_f32_16x16x32_bf16 a[64:67], v[104:107], v[64:67], a[64:67]
    ds_read_b64_tr_b16 v[30:31], v135 offset:8192
    v_mfma_f32_16x16x32_bf16 a[68:71], v[104:107], v[68:71], a[68:71]
    ds_read_b128 v[36:39], v136 offset:1024
    v_mfma_f32_16x16x32_bf16 a[72:75], v[104:107], v[72:75], a[72:75]
    ds_read_b128 v[40:43], v136 offset:2048
    v_mfma_f32_16x16x32_bf16 a[76:79], v[104:107], v[76:79], a[76:79]
    ds_read_b128 v[44:47], v136 offset:3072
    v_mfma_f32_16x16x32_bf16 a[80:83], v[104:107], v[80:83], a[80:83]
    ds_read_b128 v[48:51], v136 offset:4096
    v_mfma_f32_16x16x32_bf16 a[84:87], v[104:107], v[84:87], a[84:87]
    ds_read_b128 v[52:55], v136 offset:5120
    buffer_load_dwordx4 v144, s[4:7], s16 offen offset:3072 sc1 lds
    v_mfma_f32_16x16x32_bf16 a[88:91], v[104:107], v[88:91], a[88:91]
    ds_read_b128 v[56:59], v136 offset:6144
    v_mfma_f32_16x16x32_bf16 a[92:95], v[104:107], v[92:95], a[92:95]
    ds_read_b128 v[60:63], v136 offset:7168
    v_mfma_f32_16x16x32_bf16 a[96:99], v[108:111], v[64:67], a[96:99]
    v_mfma_f32_16x16x32_bf16 a[100:103], v[108:111], v[68:71], a[100:103]
    v_mfma_f32_16x16x32_bf16 a[104:107], v[108:111], v[72:75], a[104:107]
    s_add_u32 s16, s16, 1024
    v_mfma_f32_16x16x32_bf16 a[108:111], v[108:111], v[76:79], a[108:111]
    v_mfma_f32_16x16x32_bf16 a[112:115], v[108:111], v[80:83], a[112:115]
    v_mfma_f32_16x16x32_bf16 a[116:119], v[108:111], v[84:87], a[116:119]
    v_mfma_f32_16x16x32_bf16 a[120:123], v[108:111], v[88:91], a[120:123]
    v_mfma_f32_16x16x32_bf16 a[124:127], v[108:111], v[92:95], a[124:127]
    s_add_u32 m0, s19, 49152
    s_nop 0
    v_mfma_f32_16x16x32_bf16 a[128:131], v[112:115], v[64:67], a[128:131]
    v_mfma_f32_16x16x32_bf16 a[132:135], v[112:115], v[68:71], a[132:135]
    v_mfma_f32_16x16x32_bf16 a[136:139], v[112:115], v[72:75], a[136:139]
    v_mfma_f32_16x16x32_bf16 a[140:143], v[112:115], v[76:79], a[140:143]
    v_mfma_f32_16x16x32_bf16 a[144:147], v[112:115], v[80:83], a[144:147]
    buffer_load_dwordx4 v137, s[8:11], s15 offen offset:0 lds
    v_mfma_f32_16x16x32_bf16 a[148:151], v[112:115], v[84:87], a[148:151]
    v_mfma_f32_16x16x32_bf16 a[152:155], v[112:115], v[88:91], a[152:155]
    v_mfma_f32_16x16x32_bf16 a[156:159], v[112:115], v[92:95], a[156:159]
    v_mfma_f32_16x16x32_bf16 a[160:163], v[116:119], v[64:67], a[160:163]
    v_mfma_f32_16x16x32_bf16 a[164:167], v[116:119], v[68:71], a[164:167]
    v_mfma_f32_16x16x32_bf16 a[168:171], v[116:119], v[72:75], a[168:171]
    buffer_load_dwordx4 v138, s[8:11], s15 offen offset:1024 lds
    v_mfma_f32_16x16x32_bf16 a[172:175], v[116:119], v[76:79], a[172:175]
    v_mfma_f32_16x16x32_bf16 a[176:179], v[116:119], v[80:83], a[176:179]
    v_mfma_f32_16x16x32_bf16 a[180:183], v[116:119], v[84:87], a[180:183]
    v_mfma_f32_16x16x32_bf16 a[184:187], v[116:119], v[88:91], a[184:187]
    v_mfma_f32_16x16x32_bf16 a[188:191], v[116:119], v[92:95], a[188:191]
    buffer_load_dwordx4 v139, s[8:11], s15 offen offset:2048 lds
    v_mfma_f32_16x16x32_bf16 a[192:195], v[120:123], v[64:67], a[192:195]
    v_mfma_f32_16x16x32_bf16 a[196:199], v[120:123], v[68:71], a[196:199]
    v_mfma_f32_16x16x32_bf16 a[200:203], v[120:123], v[72:75], a[200:203]
    v_mfma_f32_16x16x32_bf16 a[204:207], v[120:123], v[76:79], a[204:207]
    v_mfma_f32_16x16x32_bf16 a[208:211], v[120:123], v[80:83], a[208:211]
    buffer_load_dwordx4 v140, s[8:11], s15 offen offset:3072 lds
    v_mfma_f32_16x16x32_bf16 a[212:215], v[120:123], v[84:87], a[212:215]
    v_mfma_f32_16x16x32_bf16 a[216:219], v[120:123], v[88:91], a[216:219]
    v_mfma_f32_16x16x32_bf16 a[220:223], v[120:123], v[92:95], a[220:223]
    v_mfma_f32_16x16x32_bf16 a[224:227], v[124:127], v[64:67], a[224:227]
    v_mfma_f32_16x16x32_bf16 a[228:231], v[124:127], v[68:71], a[228:231]
    s_add_u32 s15, s15, s17
    v_mfma_f32_16x16x32_bf16 a[232:235], v[124:127], v[72:75], a[232:235]
    v_mfma_f32_16x16x32_bf16 a[236:239], v[124:127], v[76:79], a[236:239]
    v_mfma_f32_16x16x32_bf16 a[240:243], v[124:127], v[80:83], a[240:243]
    v_mfma_f32_16x16x32_bf16 a[244:247], v[124:127], v[84:87], a[244:247]
    v_mfma_f32_16x16x32_bf16 a[248:251], v[124:127], v[88:91], a[248:251]
    v_mfma_f32_16x16x32_bf16 a[252:255], v[124:127], v[92:95], a[252:255]
    s_sub_u32 s18, s18, 1
    s_cmp_lg_u32 s18, 0
    s_cbranch_scc1 main_kernel_w_c2_v_loop
    s_cmp_lg_u32 s14, 0
    s_cbranch_scc1 main_kernel_w_c2_v_nt
    s_lshl_b32 s32, s27, 8
    s_add_u32 s32, s32, 0x841e000
    v_mov_b32 v255, 1
    s_mov_b64 exec, 1
    buffer_atomic_add v255, off, s[4:7], s32 sc0 sc1
    s_mov_b64 exec, -1
main_kernel_w_c2_v_nt:
    s_waitcnt lgkmcnt(0)
    v_mfma_f32_16x16x32_bf16 a[0:3], v[32:35], v[0:3], a[0:3]
    s_waitcnt vmcnt(16)
    s_barrier
    ds_read_b128 v[96:99], v136 offset:16384
    v_mfma_f32_16x16x32_bf16 a[4:7], v[32:35], v[4:7], a[4:7]
    ds_read_b64_tr_b16 v[64:65], v128 offset:16384
    v_mfma_f32_16x16x32_bf16 a[8:11], v[32:35], v[8:11], a[8:11]
    ds_read_b64_tr_b16 v[66:67], v128 offset:24576
    v_mfma_f32_16x16x32_bf16 a[12:15], v[32:35], v[12:15], a[12:15]
    ds_read_b64_tr_b16 v[68:69], v129 offset:16384
    v_mfma_f32_16x16x32_bf16 a[16:19], v[32:35], v[16:19], a[16:19]
    ds_read_b64_tr_b16 v[70:71], v129 offset:24576
    v_mfma_f32_16x16x32_bf16 a[20:23], v[32:35], v[20:23], a[20:23]
    ds_read_b64_tr_b16 v[72:73], v130 offset:16384
    v_mfma_f32_16x16x32_bf16 a[24:27], v[32:35], v[24:27], a[24:27]
    ds_read_b64_tr_b16 v[74:75], v130 offset:24576
    v_mfma_f32_16x16x32_bf16 a[28:31], v[32:35], v[28:31], a[28:31]
    ds_read_b64_tr_b16 v[76:77], v131 offset:16384
    v_mfma_f32_16x16x32_bf16 a[32:35], v[36:39], v[0:3], a[32:35]
    ds_read_b64_tr_b16 v[78:79], v131 offset:24576
    v_mfma_f32_16x16x32_bf16 a[36:39], v[36:39], v[4:7], a[36:39]
    ds_read_b64_tr_b16 v[80:81], v132 offset:16384
    v_mfma_f32_16x16x32_bf16 a[40:43], v[36:39], v[8:11], a[40:43]
    ds_read_b64_tr_b16 v[82:83], v132 offset:24576
    v_mfma_f32_16x16x32_bf16 a[44:47], v[36:39], v[12:15], a[44:47]
    ds_read_b64_tr_b16 v[84:85], v133 offset:16384
    v_mfma_f32_16x16x32_bf16 a[48:51], v[36:39], v[16:19], a[48:51]
    ds_read_b64_tr_b16 v[86:87], v133 offset:24576
    v_mfma_f32_16x16x32_bf16 a[52:55], v[36:39], v[20:23], a[52:55]
    ds_read_b64_tr_b16 v[88:89], v134 offset:16384
    v_mfma_f32_16x16x32_bf16 a[56:59], v[36:39], v[24:27], a[56:59]
    ds_read_b64_tr_b16 v[90:91], v134 offset:24576
    v_mfma_f32_16x16x32_bf16 a[60:63], v[36:39], v[28:31], a[60:63]
    ds_read_b64_tr_b16 v[92:93], v135 offset:16384
    v_mfma_f32_16x16x32_bf16 a[64:67], v[40:43], v[0:3], a[64:67]
    ds_read_b64_tr_b16 v[94:95], v135 offset:24576
    v_mfma_f32_16x16x32_bf16 a[68:71], v[40:43], v[4:7], a[68:71]
    ds_read_b128 v[100:103], v136 offset:17408
    v_mfma_f32_16x16x32_bf16 a[72:75], v[40:43], v[8:11], a[72:75]
    ds_read_b128 v[104:107], v136 offset:18432
    v_mfma_f32_16x16x32_bf16 a[76:79], v[40:43], v[12:15], a[76:79]
    ds_read_b128 v[108:111], v136 offset:19456
    v_mfma_f32_16x16x32_bf16 a[80:83], v[40:43], v[16:19], a[80:83]
    ds_read_b128 v[112:115], v136 offset:20480
    v_mfma_f32_16x16x32_bf16 a[84:87], v[40:43], v[20:23], a[84:87]
    ds_read_b128 v[116:119], v136 offset:21504
    v_mfma_f32_16x16x32_bf16 a[88:91], v[40:43], v[24:27], a[88:91]
    ds_read_b128 v[120:123], v136 offset:22528
    v_mfma_f32_16x16x32_bf16 a[92:95], v[40:43], v[28:31], a[92:95]
    ds_read_b128 v[124:127], v136 offset:23552
    v_mfma_f32_16x16x32_bf16 a[96:99], v[44:47], v[0:3], a[96:99]
    v_mfma_f32_16x16x32_bf16 a[100:103], v[44:47], v[4:7], a[100:103]
    v_mfma_f32_16x16x32_bf16 a[104:107], v[44:47], v[8:11], a[104:107]
    v_mfma_f32_16x16x32_bf16 a[108:111], v[44:47], v[12:15], a[108:111]
    v_mfma_f32_16x16x32_bf16 a[112:115], v[44:47], v[16:19], a[112:115]
    v_mfma_f32_16x16x32_bf16 a[116:119], v[44:47], v[20:23], a[116:119]
    v_mfma_f32_16x16x32_bf16 a[120:123], v[44:47], v[24:27], a[120:123]
    v_mfma_f32_16x16x32_bf16 a[124:127], v[44:47], v[28:31], a[124:127]
    v_mfma_f32_16x16x32_bf16 a[128:131], v[48:51], v[0:3], a[128:131]
    v_mfma_f32_16x16x32_bf16 a[132:135], v[48:51], v[4:7], a[132:135]
    v_mfma_f32_16x16x32_bf16 a[136:139], v[48:51], v[8:11], a[136:139]
    v_mfma_f32_16x16x32_bf16 a[140:143], v[48:51], v[12:15], a[140:143]
    v_mfma_f32_16x16x32_bf16 a[144:147], v[48:51], v[16:19], a[144:147]
    v_mfma_f32_16x16x32_bf16 a[148:151], v[48:51], v[20:23], a[148:151]
    v_mfma_f32_16x16x32_bf16 a[152:155], v[48:51], v[24:27], a[152:155]
    v_mfma_f32_16x16x32_bf16 a[156:159], v[48:51], v[28:31], a[156:159]
    v_mfma_f32_16x16x32_bf16 a[160:163], v[52:55], v[0:3], a[160:163]
    v_mfma_f32_16x16x32_bf16 a[164:167], v[52:55], v[4:7], a[164:167]
    v_mfma_f32_16x16x32_bf16 a[168:171], v[52:55], v[8:11], a[168:171]
    v_mfma_f32_16x16x32_bf16 a[172:175], v[52:55], v[12:15], a[172:175]
    v_mfma_f32_16x16x32_bf16 a[176:179], v[52:55], v[16:19], a[176:179]
    v_mfma_f32_16x16x32_bf16 a[180:183], v[52:55], v[20:23], a[180:183]
    v_mfma_f32_16x16x32_bf16 a[184:187], v[52:55], v[24:27], a[184:187]
    v_mfma_f32_16x16x32_bf16 a[188:191], v[52:55], v[28:31], a[188:191]
    v_mfma_f32_16x16x32_bf16 a[192:195], v[56:59], v[0:3], a[192:195]
    v_mfma_f32_16x16x32_bf16 a[196:199], v[56:59], v[4:7], a[196:199]
    v_mfma_f32_16x16x32_bf16 a[200:203], v[56:59], v[8:11], a[200:203]
    v_mfma_f32_16x16x32_bf16 a[204:207], v[56:59], v[12:15], a[204:207]
    v_mfma_f32_16x16x32_bf16 a[208:211], v[56:59], v[16:19], a[208:211]
    v_mfma_f32_16x16x32_bf16 a[212:215], v[56:59], v[20:23], a[212:215]
    v_mfma_f32_16x16x32_bf16 a[216:219], v[56:59], v[24:27], a[216:219]
    v_mfma_f32_16x16x32_bf16 a[220:223], v[56:59], v[28:31], a[220:223]
    v_mfma_f32_16x16x32_bf16 a[224:227], v[60:63], v[0:3], a[224:227]
    v_mfma_f32_16x16x32_bf16 a[228:231], v[60:63], v[4:7], a[228:231]
    v_mfma_f32_16x16x32_bf16 a[232:235], v[60:63], v[8:11], a[232:235]
    v_mfma_f32_16x16x32_bf16 a[236:239], v[60:63], v[12:15], a[236:239]
    v_mfma_f32_16x16x32_bf16 a[240:243], v[60:63], v[16:19], a[240:243]
    v_mfma_f32_16x16x32_bf16 a[244:247], v[60:63], v[20:23], a[244:247]
    v_mfma_f32_16x16x32_bf16 a[248:251], v[60:63], v[24:27], a[248:251]
    v_mfma_f32_16x16x32_bf16 a[252:255], v[60:63], v[28:31], a[252:255]
    s_waitcnt lgkmcnt(0)
    v_mfma_f32_16x16x32_bf16 a[0:3], v[96:99], v[64:67], a[0:3]
    s_waitcnt vmcnt(8)
    s_barrier
    ds_read_b128 v[32:35], v136 offset:32768
    v_mfma_f32_16x16x32_bf16 a[4:7], v[96:99], v[68:71], a[4:7]
    ds_read_b64_tr_b16 v[0:1], v128 offset:32768
    v_mfma_f32_16x16x32_bf16 a[8:11], v[96:99], v[72:75], a[8:11]
    ds_read_b64_tr_b16 v[2:3], v128 offset:40960
    v_mfma_f32_16x16x32_bf16 a[12:15], v[96:99], v[76:79], a[12:15]
    ds_read_b64_tr_b16 v[4:5], v129 offset:32768
    v_mfma_f32_16x16x32_bf16 a[16:19], v[96:99], v[80:83], a[16:19]
    ds_read_b64_tr_b16 v[6:7], v129 offset:40960
    v_mfma_f32_16x16x32_bf16 a[20:23], v[96:99], v[84:87], a[20:23]
    ds_read_b64_tr_b16 v[8:9], v130 offset:32768
    v_mfma_f32_16x16x32_bf16 a[24:27], v[96:99], v[88:91], a[24:27]
    ds_read_b64_tr_b16 v[10:11], v130 offset:40960
    v_mfma_f32_16x16x32_bf16 a[28:31], v[96:99], v[92:95], a[28:31]
    ds_read_b64_tr_b16 v[12:13], v131 offset:32768
    v_mfma_f32_16x16x32_bf16 a[32:35], v[100:103], v[64:67], a[32:35]
    ds_read_b64_tr_b16 v[14:15], v131 offset:40960
    v_mfma_f32_16x16x32_bf16 a[36:39], v[100:103], v[68:71], a[36:39]
    ds_read_b64_tr_b16 v[16:17], v132 offset:32768
    v_mfma_f32_16x16x32_bf16 a[40:43], v[100:103], v[72:75], a[40:43]
    ds_read_b64_tr_b16 v[18:19], v132 offset:40960
    v_mfma_f32_16x16x32_bf16 a[44:47], v[100:103], v[76:79], a[44:47]
    ds_read_b64_tr_b16 v[20:21], v133 offset:32768
    v_mfma_f32_16x16x32_bf16 a[48:51], v[100:103], v[80:83], a[48:51]
    ds_read_b64_tr_b16 v[22:23], v133 offset:40960
    v_mfma_f32_16x16x32_bf16 a[52:55], v[100:103], v[84:87], a[52:55]
    ds_read_b64_tr_b16 v[24:25], v134 offset:32768
    v_mfma_f32_16x16x32_bf16 a[56:59], v[100:103], v[88:91], a[56:59]
    ds_read_b64_tr_b16 v[26:27], v134 offset:40960
    v_mfma_f32_16x16x32_bf16 a[60:63], v[100:103], v[92:95], a[60:63]
    ds_read_b64_tr_b16 v[28:29], v135 offset:32768
    v_mfma_f32_16x16x32_bf16 a[64:67], v[104:107], v[64:67], a[64:67]
    ds_read_b64_tr_b16 v[30:31], v135 offset:40960
    v_mfma_f32_16x16x32_bf16 a[68:71], v[104:107], v[68:71], a[68:71]
    ds_read_b128 v[36:39], v136 offset:33792
    v_mfma_f32_16x16x32_bf16 a[72:75], v[104:107], v[72:75], a[72:75]
    ds_read_b128 v[40:43], v136 offset:34816
    v_mfma_f32_16x16x32_bf16 a[76:79], v[104:107], v[76:79], a[76:79]
    ds_read_b128 v[44:47], v136 offset:35840
    v_mfma_f32_16x16x32_bf16 a[80:83], v[104:107], v[80:83], a[80:83]
    ds_read_b128 v[48:51], v136 offset:36864
    v_mfma_f32_16x16x32_bf16 a[84:87], v[104:107], v[84:87], a[84:87]
    ds_read_b128 v[52:55], v136 offset:37888
    v_mfma_f32_16x16x32_bf16 a[88:91], v[104:107], v[88:91], a[88:91]
    ds_read_b128 v[56:59], v136 offset:38912
    v_mfma_f32_16x16x32_bf16 a[92:95], v[104:107], v[92:95], a[92:95]
    ds_read_b128 v[60:63], v136 offset:39936
    v_mfma_f32_16x16x32_bf16 a[96:99], v[108:111], v[64:67], a[96:99]
    v_mfma_f32_16x16x32_bf16 a[100:103], v[108:111], v[68:71], a[100:103]
    v_mfma_f32_16x16x32_bf16 a[104:107], v[108:111], v[72:75], a[104:107]
    v_mfma_f32_16x16x32_bf16 a[108:111], v[108:111], v[76:79], a[108:111]
    v_mfma_f32_16x16x32_bf16 a[112:115], v[108:111], v[80:83], a[112:115]
    v_mfma_f32_16x16x32_bf16 a[116:119], v[108:111], v[84:87], a[116:119]
    v_mfma_f32_16x16x32_bf16 a[120:123], v[108:111], v[88:91], a[120:123]
    v_mfma_f32_16x16x32_bf16 a[124:127], v[108:111], v[92:95], a[124:127]
    v_mfma_f32_16x16x32_bf16 a[128:131], v[112:115], v[64:67], a[128:131]
    v_mfma_f32_16x16x32_bf16 a[132:135], v[112:115], v[68:71], a[132:135]
    v_mfma_f32_16x16x32_bf16 a[136:139], v[112:115], v[72:75], a[136:139]
    v_mfma_f32_16x16x32_bf16 a[140:143], v[112:115], v[76:79], a[140:143]
    v_mfma_f32_16x16x32_bf16 a[144:147], v[112:115], v[80:83], a[144:147]
    v_mfma_f32_16x16x32_bf16 a[148:151], v[112:115], v[84:87], a[148:151]
    v_mfma_f32_16x16x32_bf16 a[152:155], v[112:115], v[88:91], a[152:155]
    v_mfma_f32_16x16x32_bf16 a[156:159], v[112:115], v[92:95], a[156:159]
    v_mfma_f32_16x16x32_bf16 a[160:163], v[116:119], v[64:67], a[160:163]
    v_mfma_f32_16x16x32_bf16 a[164:167], v[116:119], v[68:71], a[164:167]
    v_mfma_f32_16x16x32_bf16 a[168:171], v[116:119], v[72:75], a[168:171]
    v_mfma_f32_16x16x32_bf16 a[172:175], v[116:119], v[76:79], a[172:175]
    v_mfma_f32_16x16x32_bf16 a[176:179], v[116:119], v[80:83], a[176:179]
    v_mfma_f32_16x16x32_bf16 a[180:183], v[116:119], v[84:87], a[180:183]
    v_mfma_f32_16x16x32_bf16 a[184:187], v[116:119], v[88:91], a[184:187]
    v_mfma_f32_16x16x32_bf16 a[188:191], v[116:119], v[92:95], a[188:191]
    v_mfma_f32_16x16x32_bf16 a[192:195], v[120:123], v[64:67], a[192:195]
    v_mfma_f32_16x16x32_bf16 a[196:199], v[120:123], v[68:71], a[196:199]
    v_mfma_f32_16x16x32_bf16 a[200:203], v[120:123], v[72:75], a[200:203]
    v_mfma_f32_16x16x32_bf16 a[204:207], v[120:123], v[76:79], a[204:207]
    v_mfma_f32_16x16x32_bf16 a[208:211], v[120:123], v[80:83], a[208:211]
    v_mfma_f32_16x16x32_bf16 a[212:215], v[120:123], v[84:87], a[212:215]
    v_mfma_f32_16x16x32_bf16 a[216:219], v[120:123], v[88:91], a[216:219]
    v_mfma_f32_16x16x32_bf16 a[220:223], v[120:123], v[92:95], a[220:223]
    v_mfma_f32_16x16x32_bf16 a[224:227], v[124:127], v[64:67], a[224:227]
    v_mfma_f32_16x16x32_bf16 a[228:231], v[124:127], v[68:71], a[228:231]
    v_mfma_f32_16x16x32_bf16 a[232:235], v[124:127], v[72:75], a[232:235]
    v_mfma_f32_16x16x32_bf16 a[236:239], v[124:127], v[76:79], a[236:239]
    v_mfma_f32_16x16x32_bf16 a[240:243], v[124:127], v[80:83], a[240:243]
    v_mfma_f32_16x16x32_bf16 a[244:247], v[124:127], v[84:87], a[244:247]
    v_mfma_f32_16x16x32_bf16 a[248:251], v[124:127], v[88:91], a[248:251]
    v_mfma_f32_16x16x32_bf16 a[252:255], v[124:127], v[92:95], a[252:255]
    s_waitcnt lgkmcnt(0)
    v_mfma_f32_16x16x32_bf16 a[0:3], v[32:35], v[0:3], a[0:3]
    s_waitcnt vmcnt(0)
    s_barrier
    ds_read_b128 v[96:99], v136 offset:49152
    v_mfma_f32_16x16x32_bf16 a[4:7], v[32:35], v[4:7], a[4:7]
    ds_read_b64_tr_b16 v[64:65], v128 offset:49152
    v_mfma_f32_16x16x32_bf16 a[8:11], v[32:35], v[8:11], a[8:11]
    ds_read_b64_tr_b16 v[66:67], v128 offset:57344
    v_mfma_f32_16x16x32_bf16 a[12:15], v[32:35], v[12:15], a[12:15]
    ds_read_b64_tr_b16 v[68:69], v129 offset:49152
    v_mfma_f32_16x16x32_bf16 a[16:19], v[32:35], v[16:19], a[16:19]
    ds_read_b64_tr_b16 v[70:71], v129 offset:57344
    v_mfma_f32_16x16x32_bf16 a[20:23], v[32:35], v[20:23], a[20:23]
    ds_read_b64_tr_b16 v[72:73], v130 offset:49152
    v_mfma_f32_16x16x32_bf16 a[24:27], v[32:35], v[24:27], a[24:27]
    ds_read_b64_tr_b16 v[74:75], v130 offset:57344
    v_mfma_f32_16x16x32_bf16 a[28:31], v[32:35], v[28:31], a[28:31]
    ds_read_b64_tr_b16 v[76:77], v131 offset:49152
    v_mfma_f32_16x16x32_bf16 a[32:35], v[36:39], v[0:3], a[32:35]
    ds_read_b64_tr_b16 v[78:79], v131 offset:57344
    v_mfma_f32_16x16x32_bf16 a[36:39], v[36:39], v[4:7], a[36:39]
    ds_read_b64_tr_b16 v[80:81], v132 offset:49152
    v_mfma_f32_16x16x32_bf16 a[40:43], v[36:39], v[8:11], a[40:43]
    ds_read_b64_tr_b16 v[82:83], v132 offset:57344
    v_mfma_f32_16x16x32_bf16 a[44:47], v[36:39], v[12:15], a[44:47]
    ds_read_b64_tr_b16 v[84:85], v133 offset:49152
    v_mfma_f32_16x16x32_bf16 a[48:51], v[36:39], v[16:19], a[48:51]
    ds_read_b64_tr_b16 v[86:87], v133 offset:57344
    v_mfma_f32_16x16x32_bf16 a[52:55], v[36:39], v[20:23], a[52:55]
    ds_read_b64_tr_b16 v[88:89], v134 offset:49152
    v_mfma_f32_16x16x32_bf16 a[56:59], v[36:39], v[24:27], a[56:59]
    ds_read_b64_tr_b16 v[90:91], v134 offset:57344
    v_mfma_f32_16x16x32_bf16 a[60:63], v[36:39], v[28:31], a[60:63]
    ds_read_b64_tr_b16 v[92:93], v135 offset:49152
    v_mfma_f32_16x16x32_bf16 a[64:67], v[40:43], v[0:3], a[64:67]
    ds_read_b64_tr_b16 v[94:95], v135 offset:57344
    v_mfma_f32_16x16x32_bf16 a[68:71], v[40:43], v[4:7], a[68:71]
    ds_read_b128 v[100:103], v136 offset:50176
    v_mfma_f32_16x16x32_bf16 a[72:75], v[40:43], v[8:11], a[72:75]
    ds_read_b128 v[104:107], v136 offset:51200
    v_mfma_f32_16x16x32_bf16 a[76:79], v[40:43], v[12:15], a[76:79]
    ds_read_b128 v[108:111], v136 offset:52224
    v_mfma_f32_16x16x32_bf16 a[80:83], v[40:43], v[16:19], a[80:83]
    ds_read_b128 v[112:115], v136 offset:53248
    v_mfma_f32_16x16x32_bf16 a[84:87], v[40:43], v[20:23], a[84:87]
    ds_read_b128 v[116:119], v136 offset:54272
    v_mfma_f32_16x16x32_bf16 a[88:91], v[40:43], v[24:27], a[88:91]
    ds_read_b128 v[120:123], v136 offset:55296
    v_mfma_f32_16x16x32_bf16 a[92:95], v[40:43], v[28:31], a[92:95]
    ds_read_b128 v[124:127], v136 offset:56320
    v_mfma_f32_16x16x32_bf16 a[96:99], v[44:47], v[0:3], a[96:99]
    v_mfma_f32_16x16x32_bf16 a[100:103], v[44:47], v[4:7], a[100:103]
    v_mfma_f32_16x16x32_bf16 a[104:107], v[44:47], v[8:11], a[104:107]
    v_mfma_f32_16x16x32_bf16 a[108:111], v[44:47], v[12:15], a[108:111]
    v_mfma_f32_16x16x32_bf16 a[112:115], v[44:47], v[16:19], a[112:115]
    v_mfma_f32_16x16x32_bf16 a[116:119], v[44:47], v[20:23], a[116:119]
    v_mfma_f32_16x16x32_bf16 a[120:123], v[44:47], v[24:27], a[120:123]
    v_mfma_f32_16x16x32_bf16 a[124:127], v[44:47], v[28:31], a[124:127]
    v_mfma_f32_16x16x32_bf16 a[128:131], v[48:51], v[0:3], a[128:131]
    v_mfma_f32_16x16x32_bf16 a[132:135], v[48:51], v[4:7], a[132:135]
    v_mfma_f32_16x16x32_bf16 a[136:139], v[48:51], v[8:11], a[136:139]
    v_mfma_f32_16x16x32_bf16 a[140:143], v[48:51], v[12:15], a[140:143]
    v_mfma_f32_16x16x32_bf16 a[144:147], v[48:51], v[16:19], a[144:147]
    v_mfma_f32_16x16x32_bf16 a[148:151], v[48:51], v[20:23], a[148:151]
    v_mfma_f32_16x16x32_bf16 a[152:155], v[48:51], v[24:27], a[152:155]
    v_mfma_f32_16x16x32_bf16 a[156:159], v[48:51], v[28:31], a[156:159]
    v_mfma_f32_16x16x32_bf16 a[160:163], v[52:55], v[0:3], a[160:163]
    v_mfma_f32_16x16x32_bf16 a[164:167], v[52:55], v[4:7], a[164:167]
    v_mfma_f32_16x16x32_bf16 a[168:171], v[52:55], v[8:11], a[168:171]
    v_mfma_f32_16x16x32_bf16 a[172:175], v[52:55], v[12:15], a[172:175]
    v_mfma_f32_16x16x32_bf16 a[176:179], v[52:55], v[16:19], a[176:179]
    v_mfma_f32_16x16x32_bf16 a[180:183], v[52:55], v[20:23], a[180:183]
    v_mfma_f32_16x16x32_bf16 a[184:187], v[52:55], v[24:27], a[184:187]
    v_mfma_f32_16x16x32_bf16 a[188:191], v[52:55], v[28:31], a[188:191]
    v_mfma_f32_16x16x32_bf16 a[192:195], v[56:59], v[0:3], a[192:195]
    v_mfma_f32_16x16x32_bf16 a[196:199], v[56:59], v[4:7], a[196:199]
    v_mfma_f32_16x16x32_bf16 a[200:203], v[56:59], v[8:11], a[200:203]
    v_mfma_f32_16x16x32_bf16 a[204:207], v[56:59], v[12:15], a[204:207]
    v_mfma_f32_16x16x32_bf16 a[208:211], v[56:59], v[16:19], a[208:211]
    v_mfma_f32_16x16x32_bf16 a[212:215], v[56:59], v[20:23], a[212:215]
    v_mfma_f32_16x16x32_bf16 a[216:219], v[56:59], v[24:27], a[216:219]
    v_mfma_f32_16x16x32_bf16 a[220:223], v[56:59], v[28:31], a[220:223]
    v_mfma_f32_16x16x32_bf16 a[224:227], v[60:63], v[0:3], a[224:227]
    v_mfma_f32_16x16x32_bf16 a[228:231], v[60:63], v[4:7], a[228:231]
    v_mfma_f32_16x16x32_bf16 a[232:235], v[60:63], v[8:11], a[232:235]
    v_mfma_f32_16x16x32_bf16 a[236:239], v[60:63], v[12:15], a[236:239]
    v_mfma_f32_16x16x32_bf16 a[240:243], v[60:63], v[16:19], a[240:243]
    v_mfma_f32_16x16x32_bf16 a[244:247], v[60:63], v[20:23], a[244:247]
    v_mfma_f32_16x16x32_bf16 a[248:251], v[60:63], v[24:27], a[248:251]
    v_mfma_f32_16x16x32_bf16 a[252:255], v[60:63], v[28:31], a[252:255]
    v_readfirstlane_b32 s55, v255
    s_waitcnt lgkmcnt(0)
    v_mfma_f32_16x16x32_bf16 a[0:3], v[96:99], v[64:67], a[0:3]
    v_mfma_f32_16x16x32_bf16 a[4:7], v[96:99], v[68:71], a[4:7]
    v_mfma_f32_16x16x32_bf16 a[8:11], v[96:99], v[72:75], a[8:11]
    v_mfma_f32_16x16x32_bf16 a[12:15], v[96:99], v[76:79], a[12:15]
    v_mfma_f32_16x16x32_bf16 a[16:19], v[96:99], v[80:83], a[16:19]
    v_mfma_f32_16x16x32_bf16 a[20:23], v[96:99], v[84:87], a[20:23]
    v_mfma_f32_16x16x32_bf16 a[24:27], v[96:99], v[88:91], a[24:27]
    v_mfma_f32_16x16x32_bf16 a[28:31], v[96:99], v[92:95], a[28:31]
    v_mfma_f32_16x16x32_bf16 a[32:35], v[100:103], v[64:67], a[32:35]
    v_mfma_f32_16x16x32_bf16 a[36:39], v[100:103], v[68:71], a[36:39]
    v_mfma_f32_16x16x32_bf16 a[40:43], v[100:103], v[72:75], a[40:43]
    v_mfma_f32_16x16x32_bf16 a[44:47], v[100:103], v[76:79], a[44:47]
    v_mfma_f32_16x16x32_bf16 a[48:51], v[100:103], v[80:83], a[48:51]
    v_mfma_f32_16x16x32_bf16 a[52:55], v[100:103], v[84:87], a[52:55]
    v_mfma_f32_16x16x32_bf16 a[56:59], v[100:103], v[88:91], a[56:59]
    v_mfma_f32_16x16x32_bf16 a[60:63], v[100:103], v[92:95], a[60:63]
    v_mfma_f32_16x16x32_bf16 a[64:67], v[104:107], v[64:67], a[64:67]
    v_mfma_f32_16x16x32_bf16 a[68:71], v[104:107], v[68:71], a[68:71]
    v_mfma_f32_16x16x32_bf16 a[72:75], v[104:107], v[72:75], a[72:75]
    v_mfma_f32_16x16x32_bf16 a[76:79], v[104:107], v[76:79], a[76:79]
    v_mfma_f32_16x16x32_bf16 a[80:83], v[104:107], v[80:83], a[80:83]
    v_mfma_f32_16x16x32_bf16 a[84:87], v[104:107], v[84:87], a[84:87]
    v_mfma_f32_16x16x32_bf16 a[88:91], v[104:107], v[88:91], a[88:91]
    v_mfma_f32_16x16x32_bf16 a[92:95], v[104:107], v[92:95], a[92:95]
    v_mfma_f32_16x16x32_bf16 a[96:99], v[108:111], v[64:67], a[96:99]
    v_mfma_f32_16x16x32_bf16 a[100:103], v[108:111], v[68:71], a[100:103]
    v_mfma_f32_16x16x32_bf16 a[104:107], v[108:111], v[72:75], a[104:107]
    v_mfma_f32_16x16x32_bf16 a[108:111], v[108:111], v[76:79], a[108:111]
    v_mfma_f32_16x16x32_bf16 a[112:115], v[108:111], v[80:83], a[112:115]
    v_mfma_f32_16x16x32_bf16 a[116:119], v[108:111], v[84:87], a[116:119]
    v_mfma_f32_16x16x32_bf16 a[120:123], v[108:111], v[88:91], a[120:123]
    v_mfma_f32_16x16x32_bf16 a[124:127], v[108:111], v[92:95], a[124:127]
    v_mfma_f32_16x16x32_bf16 a[128:131], v[112:115], v[64:67], a[128:131]
    v_mfma_f32_16x16x32_bf16 a[132:135], v[112:115], v[68:71], a[132:135]
    v_mfma_f32_16x16x32_bf16 a[136:139], v[112:115], v[72:75], a[136:139]
    v_mfma_f32_16x16x32_bf16 a[140:143], v[112:115], v[76:79], a[140:143]
    v_mfma_f32_16x16x32_bf16 a[144:147], v[112:115], v[80:83], a[144:147]
    v_mfma_f32_16x16x32_bf16 a[148:151], v[112:115], v[84:87], a[148:151]
    v_mfma_f32_16x16x32_bf16 a[152:155], v[112:115], v[88:91], a[152:155]
    v_mfma_f32_16x16x32_bf16 a[156:159], v[112:115], v[92:95], a[156:159]
    v_mfma_f32_16x16x32_bf16 a[160:163], v[116:119], v[64:67], a[160:163]
    v_mfma_f32_16x16x32_bf16 a[164:167], v[116:119], v[68:71], a[164:167]
    v_mfma_f32_16x16x32_bf16 a[168:171], v[116:119], v[72:75], a[168:171]
    v_mfma_f32_16x16x32_bf16 a[172:175], v[116:119], v[76:79], a[172:175]
    v_mfma_f32_16x16x32_bf16 a[176:179], v[116:119], v[80:83], a[176:179]
    v_mfma_f32_16x16x32_bf16 a[180:183], v[116:119], v[84:87], a[180:183]
    v_mfma_f32_16x16x32_bf16 a[184:187], v[116:119], v[88:91], a[184:187]
    v_mfma_f32_16x16x32_bf16 a[188:191], v[116:119], v[92:95], a[188:191]
    v_mfma_f32_16x16x32_bf16 a[192:195], v[120:123], v[64:67], a[192:195]
    v_mfma_f32_16x16x32_bf16 a[196:199], v[120:123], v[68:71], a[196:199]
    v_mfma_f32_16x16x32_bf16 a[200:203], v[120:123], v[72:75], a[200:203]
    v_mfma_f32_16x16x32_bf16 a[204:207], v[120:123], v[76:79], a[204:207]
    v_mfma_f32_16x16x32_bf16 a[208:211], v[120:123], v[80:83], a[208:211]
    v_mfma_f32_16x16x32_bf16 a[212:215], v[120:123], v[84:87], a[212:215]
    v_mfma_f32_16x16x32_bf16 a[216:219], v[120:123], v[88:91], a[216:219]
    v_mfma_f32_16x16x32_bf16 a[220:223], v[120:123], v[92:95], a[220:223]
    v_mfma_f32_16x16x32_bf16 a[224:227], v[124:127], v[64:67], a[224:227]
    v_mfma_f32_16x16x32_bf16 a[228:231], v[124:127], v[68:71], a[228:231]
    v_mfma_f32_16x16x32_bf16 a[232:235], v[124:127], v[72:75], a[232:235]
    v_mfma_f32_16x16x32_bf16 a[236:239], v[124:127], v[76:79], a[236:239]
    v_mfma_f32_16x16x32_bf16 a[240:243], v[124:127], v[80:83], a[240:243]
    v_mfma_f32_16x16x32_bf16 a[244:247], v[124:127], v[84:87], a[244:247]
    v_mfma_f32_16x16x32_bf16 a[248:251], v[124:127], v[88:91], a[248:251]
    v_mfma_f32_16x16x32_bf16 a[252:255], v[124:127], v[92:95], a[252:255]
    s_nop 7
    s_mov_b32 s53, s21
    v_accvgpr_read_b32 v0, a0
    v_accvgpr_read_b32 v1, a1
    v_accvgpr_read_b32 v2, a2
    v_accvgpr_read_b32 v3, a3
    v_accvgpr_read_b32 v4, a32
    v_accvgpr_read_b32 v5, a33
    v_accvgpr_read_b32 v6, a34
    v_accvgpr_read_b32 v7, a35
    v_cvt_pk_bf16_f32 v8, v0, v1
    v_cvt_pk_bf16_f32 v9, v2, v3
    v_cvt_pk_bf16_f32 v10, v4, v5
    v_cvt_pk_bf16_f32 v11, v6, v7
    buffer_store_dwordx4 v[8:11], v251, s[4:7], s53 offen offset:0 sc1
    v_accvgpr_read_b32 v16, a4
    v_accvgpr_read_b32 v17, a5
    v_accvgpr_read_b32 v18, a6
    v_accvgpr_read_b32 v19, a7
    v_accvgpr_read_b32 v20, a36
    v_accvgpr_read_b32 v21, a37
    v_accvgpr_read_b32 v22, a38
    v_accvgpr_read_b32 v23, a39
    v_cvt_pk_bf16_f32 v24, v16, v17
    v_cvt_pk_bf16_f32 v25, v18, v19
    v_cvt_pk_bf16_f32 v26, v20, v21
    v_cvt_pk_bf16_f32 v27, v22, v23
    buffer_store_dwordx4 v[24:27], v251, s[4:7], s53 offen offset:1024 sc1
    v_accvgpr_read_b32 v32, a8
    v_accvgpr_read_b32 v33, a9
    v_accvgpr_read_b32 v34, a10
    v_accvgpr_read_b32 v35, a11
    v_accvgpr_read_b32 v36, a40
    v_accvgpr_read_b32 v37, a41
    v_accvgpr_read_b32 v38, a42
    v_accvgpr_read_b32 v39, a43
    v_cvt_pk_bf16_f32 v40, v32, v33
    v_cvt_pk_bf16_f32 v41, v34, v35
    v_cvt_pk_bf16_f32 v42, v36, v37
    v_cvt_pk_bf16_f32 v43, v38, v39
    buffer_store_dwordx4 v[40:43], v251, s[4:7], s53 offen offset:2048 sc1
    v_accvgpr_read_b32 v48, a12
    v_accvgpr_read_b32 v49, a13
    v_accvgpr_read_b32 v50, a14
    v_accvgpr_read_b32 v51, a15
    v_accvgpr_read_b32 v52, a44
    v_accvgpr_read_b32 v53, a45
    v_accvgpr_read_b32 v54, a46
    v_accvgpr_read_b32 v55, a47
    v_cvt_pk_bf16_f32 v56, v48, v49
    v_cvt_pk_bf16_f32 v57, v50, v51
    v_cvt_pk_bf16_f32 v58, v52, v53
    v_cvt_pk_bf16_f32 v59, v54, v55
    buffer_store_dwordx4 v[56:59], v251, s[4:7], s53 offen offset:3072 sc1
    s_add_u32 s53, s53, 4096
    v_accvgpr_read_b32 v0, a16
    v_accvgpr_read_b32 v1, a17
    v_accvgpr_read_b32 v2, a18
    v_accvgpr_read_b32 v3, a19
    v_accvgpr_read_b32 v4, a48
    v_accvgpr_read_b32 v5, a49
    v_accvgpr_read_b32 v6, a50
    v_accvgpr_read_b32 v7, a51
    v_cvt_pk_bf16_f32 v8, v0, v1
    v_cvt_pk_bf16_f32 v9, v2, v3
    v_cvt_pk_bf16_f32 v10, v4, v5
    v_cvt_pk_bf16_f32 v11, v6, v7
    buffer_store_dwordx4 v[8:11], v251, s[4:7], s53 offen offset:0 sc1
    v_accvgpr_read_b32 v16, a20
    v_accvgpr_read_b32 v17, a21
    v_accvgpr_read_b32 v18, a22
    v_accvgpr_read_b32 v19, a23
    v_accvgpr_read_b32 v20, a52
    v_accvgpr_read_b32 v21, a53
    v_accvgpr_read_b32 v22, a54
    v_accvgpr_read_b32 v23, a55
    v_cvt_pk_bf16_f32 v24, v16, v17
    v_cvt_pk_bf16_f32 v25, v18, v19
    v_cvt_pk_bf16_f32 v26, v20, v21
    v_cvt_pk_bf16_f32 v27, v22, v23
    buffer_store_dwordx4 v[24:27], v251, s[4:7], s53 offen offset:1024 sc1
    v_accvgpr_read_b32 v32, a24
    v_accvgpr_read_b32 v33, a25
    v_accvgpr_read_b32 v34, a26
    v_accvgpr_read_b32 v35, a27
    v_accvgpr_read_b32 v36, a56
    v_accvgpr_read_b32 v37, a57
    v_accvgpr_read_b32 v38, a58
    v_accvgpr_read_b32 v39, a59
    v_cvt_pk_bf16_f32 v40, v32, v33
    v_cvt_pk_bf16_f32 v41, v34, v35
    v_cvt_pk_bf16_f32 v42, v36, v37
    v_cvt_pk_bf16_f32 v43, v38, v39
    buffer_store_dwordx4 v[40:43], v251, s[4:7], s53 offen offset:2048 sc1
    v_accvgpr_read_b32 v48, a28
    v_accvgpr_read_b32 v49, a29
    v_accvgpr_read_b32 v50, a30
    v_accvgpr_read_b32 v51, a31
    v_accvgpr_read_b32 v52, a60
    v_accvgpr_read_b32 v53, a61
    v_accvgpr_read_b32 v54, a62
    v_accvgpr_read_b32 v55, a63
    v_cvt_pk_bf16_f32 v56, v48, v49
    v_cvt_pk_bf16_f32 v57, v50, v51
    v_cvt_pk_bf16_f32 v58, v52, v53
    v_cvt_pk_bf16_f32 v59, v54, v55
    buffer_store_dwordx4 v[56:59], v251, s[4:7], s53 offen offset:3072 sc1
    s_add_u32 s53, s53, 258048
    v_accvgpr_read_b32 v0, a64
    v_accvgpr_read_b32 v1, a65
    v_accvgpr_read_b32 v2, a66
    v_accvgpr_read_b32 v3, a67
    v_accvgpr_read_b32 v4, a96
    v_accvgpr_read_b32 v5, a97
    v_accvgpr_read_b32 v6, a98
    v_accvgpr_read_b32 v7, a99
    v_cvt_pk_bf16_f32 v8, v0, v1
    v_cvt_pk_bf16_f32 v9, v2, v3
    v_cvt_pk_bf16_f32 v10, v4, v5
    v_cvt_pk_bf16_f32 v11, v6, v7
    buffer_store_dwordx4 v[8:11], v251, s[4:7], s53 offen offset:0 sc1
    v_accvgpr_read_b32 v16, a68
    v_accvgpr_read_b32 v17, a69
    v_accvgpr_read_b32 v18, a70
    v_accvgpr_read_b32 v19, a71
    v_accvgpr_read_b32 v20, a100
    v_accvgpr_read_b32 v21, a101
    v_accvgpr_read_b32 v22, a102
    v_accvgpr_read_b32 v23, a103
    v_cvt_pk_bf16_f32 v24, v16, v17
    v_cvt_pk_bf16_f32 v25, v18, v19
    v_cvt_pk_bf16_f32 v26, v20, v21
    v_cvt_pk_bf16_f32 v27, v22, v23
    buffer_store_dwordx4 v[24:27], v251, s[4:7], s53 offen offset:1024 sc1
    v_accvgpr_read_b32 v32, a72
    v_accvgpr_read_b32 v33, a73
    v_accvgpr_read_b32 v34, a74
    v_accvgpr_read_b32 v35, a75
    v_accvgpr_read_b32 v36, a104
    v_accvgpr_read_b32 v37, a105
    v_accvgpr_read_b32 v38, a106
    v_accvgpr_read_b32 v39, a107
    v_cvt_pk_bf16_f32 v40, v32, v33
    v_cvt_pk_bf16_f32 v41, v34, v35
    v_cvt_pk_bf16_f32 v42, v36, v37
    v_cvt_pk_bf16_f32 v43, v38, v39
    buffer_store_dwordx4 v[40:43], v251, s[4:7], s53 offen offset:2048 sc1
    v_accvgpr_read_b32 v48, a76
    v_accvgpr_read_b32 v49, a77
    v_accvgpr_read_b32 v50, a78
    v_accvgpr_read_b32 v51, a79
    v_accvgpr_read_b32 v52, a108
    v_accvgpr_read_b32 v53, a109
    v_accvgpr_read_b32 v54, a110
    v_accvgpr_read_b32 v55, a111
    v_cvt_pk_bf16_f32 v56, v48, v49
    v_cvt_pk_bf16_f32 v57, v50, v51
    v_cvt_pk_bf16_f32 v58, v52, v53
    v_cvt_pk_bf16_f32 v59, v54, v55
    buffer_store_dwordx4 v[56:59], v251, s[4:7], s53 offen offset:3072 sc1
    s_add_u32 s53, s53, 4096
    v_accvgpr_read_b32 v0, a80
    v_accvgpr_read_b32 v1, a81
    v_accvgpr_read_b32 v2, a82
    v_accvgpr_read_b32 v3, a83
    v_accvgpr_read_b32 v4, a112
    v_accvgpr_read_b32 v5, a113
    v_accvgpr_read_b32 v6, a114
    v_accvgpr_read_b32 v7, a115
    v_cvt_pk_bf16_f32 v8, v0, v1
    v_cvt_pk_bf16_f32 v9, v2, v3
    v_cvt_pk_bf16_f32 v10, v4, v5
    v_cvt_pk_bf16_f32 v11, v6, v7
    buffer_store_dwordx4 v[8:11], v251, s[4:7], s53 offen offset:0 sc1
    v_accvgpr_read_b32 v16, a84
    v_accvgpr_read_b32 v17, a85
    v_accvgpr_read_b32 v18, a86
    v_accvgpr_read_b32 v19, a87
    v_accvgpr_read_b32 v20, a116
    v_accvgpr_read_b32 v21, a117
    v_accvgpr_read_b32 v22, a118
    v_accvgpr_read_b32 v23, a119
    v_cvt_pk_bf16_f32 v24, v16, v17
    v_cvt_pk_bf16_f32 v25, v18, v19
    v_cvt_pk_bf16_f32 v26, v20, v21
    v_cvt_pk_bf16_f32 v27, v22, v23
    buffer_store_dwordx4 v[24:27], v251, s[4:7], s53 offen offset:1024 sc1
    v_accvgpr_read_b32 v32, a88
    v_accvgpr_read_b32 v33, a89
    v_accvgpr_read_b32 v34, a90
    v_accvgpr_read_b32 v35, a91
    v_accvgpr_read_b32 v36, a120
    v_accvgpr_read_b32 v37, a121
    v_accvgpr_read_b32 v38, a122
    v_accvgpr_read_b32 v39, a123
    v_cvt_pk_bf16_f32 v40, v32, v33
    v_cvt_pk_bf16_f32 v41, v34, v35
    v_cvt_pk_bf16_f32 v42, v36, v37
    v_cvt_pk_bf16_f32 v43, v38, v39
    buffer_store_dwordx4 v[40:43], v251, s[4:7], s53 offen offset:2048 sc1
    v_accvgpr_read_b32 v48, a92
    v_accvgpr_read_b32 v49, a93
    v_accvgpr_read_b32 v50, a94
    v_accvgpr_read_b32 v51, a95
    v_accvgpr_read_b32 v52, a124
    v_accvgpr_read_b32 v53, a125
    v_accvgpr_read_b32 v54, a126
    v_accvgpr_read_b32 v55, a127
    v_cvt_pk_bf16_f32 v56, v48, v49
    v_cvt_pk_bf16_f32 v57, v50, v51
    v_cvt_pk_bf16_f32 v58, v52, v53
    v_cvt_pk_bf16_f32 v59, v54, v55
    buffer_store_dwordx4 v[56:59], v251, s[4:7], s53 offen offset:3072 sc1
    s_add_u32 s53, s53, 258048
    v_accvgpr_read_b32 v0, a128
    v_accvgpr_read_b32 v1, a129
    v_accvgpr_read_b32 v2, a130
    v_accvgpr_read_b32 v3, a131
    v_accvgpr_read_b32 v4, a160
    v_accvgpr_read_b32 v5, a161
    v_accvgpr_read_b32 v6, a162
    v_accvgpr_read_b32 v7, a163
    v_cvt_pk_bf16_f32 v8, v0, v1
    v_cvt_pk_bf16_f32 v9, v2, v3
    v_cvt_pk_bf16_f32 v10, v4, v5
    v_cvt_pk_bf16_f32 v11, v6, v7
    buffer_store_dwordx4 v[8:11], v251, s[4:7], s53 offen offset:0 sc1
    v_accvgpr_read_b32 v16, a132
    v_accvgpr_read_b32 v17, a133
    v_accvgpr_read_b32 v18, a134
    v_accvgpr_read_b32 v19, a135
    v_accvgpr_read_b32 v20, a164
    v_accvgpr_read_b32 v21, a165
    v_accvgpr_read_b32 v22, a166
    v_accvgpr_read_b32 v23, a167
    v_cvt_pk_bf16_f32 v24, v16, v17
    v_cvt_pk_bf16_f32 v25, v18, v19
    v_cvt_pk_bf16_f32 v26, v20, v21
    v_cvt_pk_bf16_f32 v27, v22, v23
    buffer_store_dwordx4 v[24:27], v251, s[4:7], s53 offen offset:1024 sc1
    v_accvgpr_read_b32 v32, a136
    v_accvgpr_read_b32 v33, a137
    v_accvgpr_read_b32 v34, a138
    v_accvgpr_read_b32 v35, a139
    v_accvgpr_read_b32 v36, a168
    v_accvgpr_read_b32 v37, a169
    v_accvgpr_read_b32 v38, a170
    v_accvgpr_read_b32 v39, a171
    v_cvt_pk_bf16_f32 v40, v32, v33
    v_cvt_pk_bf16_f32 v41, v34, v35
    v_cvt_pk_bf16_f32 v42, v36, v37
    v_cvt_pk_bf16_f32 v43, v38, v39
    buffer_store_dwordx4 v[40:43], v251, s[4:7], s53 offen offset:2048 sc1
    v_accvgpr_read_b32 v48, a140
    v_accvgpr_read_b32 v49, a141
    v_accvgpr_read_b32 v50, a142
    v_accvgpr_read_b32 v51, a143
    v_accvgpr_read_b32 v52, a172
    v_accvgpr_read_b32 v53, a173
    v_accvgpr_read_b32 v54, a174
    v_accvgpr_read_b32 v55, a175
    v_cvt_pk_bf16_f32 v56, v48, v49
    v_cvt_pk_bf16_f32 v57, v50, v51
    v_cvt_pk_bf16_f32 v58, v52, v53
    v_cvt_pk_bf16_f32 v59, v54, v55
    buffer_store_dwordx4 v[56:59], v251, s[4:7], s53 offen offset:3072 sc1
    s_add_u32 s53, s53, 4096
    v_accvgpr_read_b32 v0, a144
    v_accvgpr_read_b32 v1, a145
    v_accvgpr_read_b32 v2, a146
    v_accvgpr_read_b32 v3, a147
    v_accvgpr_read_b32 v4, a176
    v_accvgpr_read_b32 v5, a177
    v_accvgpr_read_b32 v6, a178
    v_accvgpr_read_b32 v7, a179
    v_cvt_pk_bf16_f32 v8, v0, v1
    v_cvt_pk_bf16_f32 v9, v2, v3
    v_cvt_pk_bf16_f32 v10, v4, v5
    v_cvt_pk_bf16_f32 v11, v6, v7
    buffer_store_dwordx4 v[8:11], v251, s[4:7], s53 offen offset:0 sc1
    v_accvgpr_read_b32 v16, a148
    v_accvgpr_read_b32 v17, a149
    v_accvgpr_read_b32 v18, a150
    v_accvgpr_read_b32 v19, a151
    v_accvgpr_read_b32 v20, a180
    v_accvgpr_read_b32 v21, a181
    v_accvgpr_read_b32 v22, a182
    v_accvgpr_read_b32 v23, a183
    v_cvt_pk_bf16_f32 v24, v16, v17
    v_cvt_pk_bf16_f32 v25, v18, v19
    v_cvt_pk_bf16_f32 v26, v20, v21
    v_cvt_pk_bf16_f32 v27, v22, v23
    buffer_store_dwordx4 v[24:27], v251, s[4:7], s53 offen offset:1024 sc1
    v_accvgpr_read_b32 v32, a152
    v_accvgpr_read_b32 v33, a153
    v_accvgpr_read_b32 v34, a154
    v_accvgpr_read_b32 v35, a155
    v_accvgpr_read_b32 v36, a184
    v_accvgpr_read_b32 v37, a185
    v_accvgpr_read_b32 v38, a186
    v_accvgpr_read_b32 v39, a187
    v_cvt_pk_bf16_f32 v40, v32, v33
    v_cvt_pk_bf16_f32 v41, v34, v35
    v_cvt_pk_bf16_f32 v42, v36, v37
    v_cvt_pk_bf16_f32 v43, v38, v39
    buffer_store_dwordx4 v[40:43], v251, s[4:7], s53 offen offset:2048 sc1
    v_accvgpr_read_b32 v48, a156
    v_accvgpr_read_b32 v49, a157
    v_accvgpr_read_b32 v50, a158
    v_accvgpr_read_b32 v51, a159
    v_accvgpr_read_b32 v52, a188
    v_accvgpr_read_b32 v53, a189
    v_accvgpr_read_b32 v54, a190
    v_accvgpr_read_b32 v55, a191
    v_cvt_pk_bf16_f32 v56, v48, v49
    v_cvt_pk_bf16_f32 v57, v50, v51
    v_cvt_pk_bf16_f32 v58, v52, v53
    v_cvt_pk_bf16_f32 v59, v54, v55
    buffer_store_dwordx4 v[56:59], v251, s[4:7], s53 offen offset:3072 sc1
    s_add_u32 s53, s53, 258048
    v_accvgpr_read_b32 v0, a192
    v_accvgpr_read_b32 v1, a193
    v_accvgpr_read_b32 v2, a194
    v_accvgpr_read_b32 v3, a195
    v_accvgpr_read_b32 v4, a224
    v_accvgpr_read_b32 v5, a225
    v_accvgpr_read_b32 v6, a226
    v_accvgpr_read_b32 v7, a227
    v_cvt_pk_bf16_f32 v8, v0, v1
    v_cvt_pk_bf16_f32 v9, v2, v3
    v_cvt_pk_bf16_f32 v10, v4, v5
    v_cvt_pk_bf16_f32 v11, v6, v7
    buffer_store_dwordx4 v[8:11], v251, s[4:7], s53 offen offset:0 sc1
    v_accvgpr_read_b32 v16, a196
    v_accvgpr_read_b32 v17, a197
    v_accvgpr_read_b32 v18, a198
    v_accvgpr_read_b32 v19, a199
    v_accvgpr_read_b32 v20, a228
    v_accvgpr_read_b32 v21, a229
    v_accvgpr_read_b32 v22, a230
    v_accvgpr_read_b32 v23, a231
    v_cvt_pk_bf16_f32 v24, v16, v17
    v_cvt_pk_bf16_f32 v25, v18, v19
    v_cvt_pk_bf16_f32 v26, v20, v21
    v_cvt_pk_bf16_f32 v27, v22, v23
    buffer_store_dwordx4 v[24:27], v251, s[4:7], s53 offen offset:1024 sc1
    v_accvgpr_read_b32 v32, a200
    v_accvgpr_read_b32 v33, a201
    v_accvgpr_read_b32 v34, a202
    v_accvgpr_read_b32 v35, a203
    v_accvgpr_read_b32 v36, a232
    v_accvgpr_read_b32 v37, a233
    v_accvgpr_read_b32 v38, a234
    v_accvgpr_read_b32 v39, a235
    v_cvt_pk_bf16_f32 v40, v32, v33
    v_cvt_pk_bf16_f32 v41, v34, v35
    v_cvt_pk_bf16_f32 v42, v36, v37
    v_cvt_pk_bf16_f32 v43, v38, v39
    buffer_store_dwordx4 v[40:43], v251, s[4:7], s53 offen offset:2048 sc1
    v_accvgpr_read_b32 v48, a204
    v_accvgpr_read_b32 v49, a205
    v_accvgpr_read_b32 v50, a206
    v_accvgpr_read_b32 v51, a207
    v_accvgpr_read_b32 v52, a236
    v_accvgpr_read_b32 v53, a237
    v_accvgpr_read_b32 v54, a238
    v_accvgpr_read_b32 v55, a239
    v_cvt_pk_bf16_f32 v56, v48, v49
    v_cvt_pk_bf16_f32 v57, v50, v51
    v_cvt_pk_bf16_f32 v58, v52, v53
    v_cvt_pk_bf16_f32 v59, v54, v55
    buffer_store_dwordx4 v[56:59], v251, s[4:7], s53 offen offset:3072 sc1
    s_add_u32 s53, s53, 4096
    v_accvgpr_read_b32 v0, a208
    v_accvgpr_read_b32 v1, a209
    v_accvgpr_read_b32 v2, a210
    v_accvgpr_read_b32 v3, a211
    v_accvgpr_read_b32 v4, a240
    v_accvgpr_read_b32 v5, a241
    v_accvgpr_read_b32 v6, a242
    v_accvgpr_read_b32 v7, a243
    v_cvt_pk_bf16_f32 v8, v0, v1
    v_cvt_pk_bf16_f32 v9, v2, v3
    v_cvt_pk_bf16_f32 v10, v4, v5
    v_cvt_pk_bf16_f32 v11, v6, v7
    buffer_store_dwordx4 v[8:11], v251, s[4:7], s53 offen offset:0 sc1
    v_accvgpr_read_b32 v16, a212
    v_accvgpr_read_b32 v17, a213
    v_accvgpr_read_b32 v18, a214
    v_accvgpr_read_b32 v19, a215
    v_accvgpr_read_b32 v20, a244
    v_accvgpr_read_b32 v21, a245
    v_accvgpr_read_b32 v22, a246
    v_accvgpr_read_b32 v23, a247
    v_cvt_pk_bf16_f32 v24, v16, v17
    v_cvt_pk_bf16_f32 v25, v18, v19
    v_cvt_pk_bf16_f32 v26, v20, v21
    v_cvt_pk_bf16_f32 v27, v22, v23
    buffer_store_dwordx4 v[24:27], v251, s[4:7], s53 offen offset:1024 sc1
    v_accvgpr_read_b32 v32, a216
    v_accvgpr_read_b32 v33, a217
    v_accvgpr_read_b32 v34, a218
    v_accvgpr_read_b32 v35, a219
    v_accvgpr_read_b32 v36, a248
    v_accvgpr_read_b32 v37, a249
    v_accvgpr_read_b32 v38, a250
    v_accvgpr_read_b32 v39, a251
    v_cvt_pk_bf16_f32 v40, v32, v33
    v_cvt_pk_bf16_f32 v41, v34, v35
    v_cvt_pk_bf16_f32 v42, v36, v37
    v_cvt_pk_bf16_f32 v43, v38, v39
    buffer_store_dwordx4 v[40:43], v251, s[4:7], s53 offen offset:2048 sc1
    v_accvgpr_read_b32 v48, a220
    v_accvgpr_read_b32 v49, a221
    v_accvgpr_read_b32 v50, a222
    v_accvgpr_read_b32 v51, a223
    v_accvgpr_read_b32 v52, a252
    v_accvgpr_read_b32 v53, a253
    v_accvgpr_read_b32 v54, a254
    v_accvgpr_read_b32 v55, a255
    v_cvt_pk_bf16_f32 v56, v48, v49
    v_cvt_pk_bf16_f32 v57, v50, v51
    v_cvt_pk_bf16_f32 v58, v52, v53
    v_cvt_pk_bf16_f32 v59, v54, v55
    buffer_store_dwordx4 v[56:59], v251, s[4:7], s53 offen offset:3072 sc1
    s_add_u32 s53, s53, 258048
    s_branch main_kernel_w_done
main_kernel_w_pref:
    s_cmp_lg_u32 s24, 0
    s_cbranch_scc1 main_kernel_w_pf0
    s_mov_b32 s8, s64
    s_and_b32 s9, s65, 0xffff
    s_mov_b32 s10, 0x200000
    s_mov_b32 s11, 0x20000
    s_branch main_kernel_w_pfg
main_kernel_w_pf0:
    s_cmp_lg_u32 s24, 1
    s_cbranch_scc1 main_kernel_w_pf1
    s_mov_b32 s8, s66
    s_and_b32 s9, s67, 0xffff
    s_mov_b32 s10, 0x200000
    s_mov_b32 s11, 0x20000
    s_branch main_kernel_w_pfg
main_kernel_w_pf1:
    s_cmp_lg_u32 s24, 2
    s_cbranch_scc1 main_kernel_w_pf2
    s_mov_b32 s8, s68
    s_and_b32 s9, s69, 0xffff
    s_mov_b32 s10, 0x700000
    s_mov_b32 s11, 0x20000
    s_branch main_kernel_w_pfg
main_kernel_w_pf2:
    s_mov_b32 s8, s70
    s_and_b32 s9, s71, 0xffff
    s_mov_b32 s10, 0x700000
    s_mov_b32 s11, 0x20000
main_kernel_w_pfg:
    s_lshl_b32 s32, s25, 19
    s_lshl_b32 s33, s14, 17
    s_add_u32 s32, s32, s33
    v_lshlrev_b32 v253, 7, v250
    buffer_load_dword v0, v253, s[8:11], s32 offen
    s_add_u32 s32, s32, 8192
    buffer_load_dword v0, v253, s[8:11], s32 offen
    s_add_u32 s32, s32, 8192
    buffer_load_dword v0, v253, s[8:11], s32 offen
    s_add_u32 s32, s32, 8192
    buffer_load_dword v0, v253, s[8:11], s32 offen
    s_add_u32 s32, s32, 8192
    buffer_load_dword v0, v253, s[8:11], s32 offen
    s_add_u32 s32, s32, 8192
    buffer_load_dword v0, v253, s[8:11], s32 offen
    s_add_u32 s32, s32, 8192
    buffer_load_dword v0, v253, s[8:11], s32 offen
    s_add_u32 s32, s32, 8192
    buffer_load_dword v0, v253, s[8:11], s32 offen
    s_add_u32 s32, s32, 8192
    buffer_load_dword v0, v253, s[8:11], s32 offen
    s_add_u32 s32, s32, 8192
    buffer_load_dword v0, v253, s[8:11], s32 offen
    s_add_u32 s32, s32, 8192
    buffer_load_dword v0, v253, s[8:11], s32 offen
    s_add_u32 s32, s32, 8192
    buffer_load_dword v0, v253, s[8:11], s32 offen
    s_add_u32 s32, s32, 8192
    buffer_load_dword v0, v253, s[8:11], s32 offen
    s_add_u32 s32, s32, 8192
    buffer_load_dword v0, v253, s[8:11], s32 offen
    s_add_u32 s32, s32, 8192
    buffer_load_dword v0, v253, s[8:11], s32 offen
    s_add_u32 s32, s32, 8192
    buffer_load_dword v0, v253, s[8:11], s32 offen
    s_add_u32 s32, s32, 8192
    s_branch main_kernel_w_done
main_kernel_w_fill:
    s_lshl_b32 s32, s24, 2
    s_add_u32 s32, s32, s25
    s_lshl_b32 s33, s32, 16
    s_add_u32 s32, s33, 0x6e00000
    s_add_u32 s35, s33, 0x8c00000
    s_add_u32 s33, s33, 0x8000000
    s_lshl_b32 s34, s14, 12
    v_add_u32 v253, s34, v251
    v_mov_b32 v0, -1
    v_mov_b32 v1, -1
    v_mov_b32 v2, -1
    v_mov_b32 v3, -1
    s_mov_b32 s18, 4
main_kernel_w_fl:
    buffer_store_dwordx4 v[0:3], v253, s[4:7], s32 offen offset:0 sc1
    buffer_store_dwordx4 v[0:3], v253, s[4:7], s32 offen offset:1024 sc1
    buffer_store_dwordx4 v[0:3], v253, s[4:7], s32 offen offset:2048 sc1
    buffer_store_dwordx4 v[0:3], v253, s[4:7], s32 offen offset:3072 sc1
    s_add_u32 s32, s32, 16384
    buffer_store_dwordx4 v[0:3], v253, s[4:7], s33 offen offset:0 sc1
    buffer_store_dwordx4 v[0:3], v253, s[4:7], s33 offen offset:1024 sc1
    buffer_store_dwordx4 v[0:3], v253, s[4:7], s33 offen offset:2048 sc1
    buffer_store_dwordx4 v[0:3], v253, s[4:7], s33 offen offset:3072 sc1
    s_add_u32 s33, s33, 16384
    s_sub_u32 s18, s18, 1
    s_cmp_lg_u32 s18, 0
    s_cbranch_scc1 main_kernel_w_fl
    s_branch main_kernel_w_done
main_kernel_w_ln2:
    s_lshl_b32 s32, s24, 3
    s_mul_i32 s33, s25, 2
    s_add_u32 s32, s32, s33
    s_lshl_b32 s32, s32, 15
    s_lshl_b32 s33, s14, 13
    s_add_u32 s32, s32, s33
    s_add_u32 s21, s32, 0x6800000
    s_add_u32 s32, s32, 0x5000000
    buffer_load_dwordx4 v[0:3], v251, s[4:7], s32 offen offset:0 sc1
    buffer_load_dwordx4 v[4:7], v251, s[4:7], s32 offen offset:1024 sc1
    buffer_load_dwordx4 v[8:11], v251, s[4:7], s32 offen offset:2048 sc1
    buffer_load_dwordx4 v[12:15], v251, s[4:7], s32 offen offset:3072 sc1
    s_add_u32 s32, s32, 4096
    buffer_load_dwordx4 v[16:19], v251, s[4:7], s32 offen offset:0 sc1
    buffer_load_dwordx4 v[20:23], v251, s[4:7], s32 offen offset:1024 sc1
    buffer_load_dwordx4 v[24:27], v251, s[4:7], s32 offen offset:2048 sc1
    buffer_load_dwordx4 v[28:31], v251, s[4:7], s32 offen offset:3072 sc1
    s_add_u32 s32, s32, 28672
    buffer_load_dwordx4 v[32:35], v251, s[4:7], s32 offen offset:0 sc1
    buffer_load_dwordx4 v[36:39], v251, s[4:7], s32 offen offset:1024 sc1
    buffer_load_dwordx4 v[40:43], v251, s[4:7], s32 offen offset:2048 sc1
    buffer_load_dwordx4 v[44:47], v251, s[4:7], s32 offen offset:3072 sc1
    s_add_u32 s32, s32, 4096
    buffer_load_dwordx4 v[48:51], v251, s[4:7], s32 offen offset:0 sc1
    buffer_load_dwordx4 v[52:55], v251, s[4:7], s32 offen offset:1024 sc1
    buffer_load_dwordx4 v[56:59], v251, s[4:7], s32 offen offset:2048 sc1
    buffer_load_dwordx4 v[60:63], v251, s[4:7], s32 offen offset:3072 sc1
    s_add_u32 s32, s32, 28672
    v_and_b32 v255, 15, v250
    v_lshlrev_b32 v254, 6, v255
    v_add_u32 v254, 132096, v254
    v_lshrrev_b32 v255, 4, v250
    v_lshl_add_u32 v253, v255, 2, v254
    v_lshl_add_u32 v253, s14, 4, v253
    s_waitcnt vmcnt(8)
    v_lshlrev_b32 v128, 16, v0
    v_and_b32 v129, 0xffff0000, v0
    v_lshlrev_b32 v130, 16, v1
    v_and_b32 v131, 0xffff0000, v1
    v_lshlrev_b32 v132, 16, v2
    v_and_b32 v133, 0xffff0000, v2
    v_lshlrev_b32 v134, 16, v3
    v_and_b32 v135, 0xffff0000, v3
    v_lshlrev_b32 v136, 16, v4
    v_and_b32 v137, 0xffff0000, v4
    v_lshlrev_b32 v138, 16, v5
    v_and_b32 v139, 0xffff0000, v5
    v_lshlrev_b32 v140, 16, v6
    v_and_b32 v141, 0xffff0000, v6
    v_lshlrev_b32 v142, 16, v7
    v_and_b32 v143, 0xffff0000, v7
    v_lshlrev_b32 v144, 16, v8
    v_and_b32 v145, 0xffff0000, v8
    v_lshlrev_b32 v146, 16, v9
    v_and_b32 v147, 0xffff0000, v9
    v_lshlrev_b32 v148, 16, v10
    v_and_b32 v149, 0xffff0000, v10
    v_lshlrev_b32 v150, 16, v11
    v_and_b32 v151, 0xffff0000, v11
    v_lshlrev_b32 v152, 16, v12
    v_and_b32 v153, 0xffff0000, v12
    v_lshlrev_b32 v154, 16, v13
    v_and_b32 v155, 0xffff0000, v13
    v_lshlrev_b32 v156, 16, v14
    v_and_b32 v157, 0xffff0000, v14
    v_lshlrev_b32 v158, 16, v15
    v_and_b32 v159, 0xffff0000, v15
    v_lshlrev_b32 v160, 16, v16
    v_and_b32 v161, 0xffff0000, v16
    v_lshlrev_b32 v162, 16, v17
    v_and_b32 v163, 0xffff0000, v17
    v_lshlrev_b32 v164, 16, v18
    v_and_b32 v165, 0xffff0000, v18
    v_lshlrev_b32 v166, 16, v19
    v_and_b32 v167, 0xffff0000, v19
    v_lshlrev_b32 v168, 16, v20
    v_and_b32 v169, 0xffff0000, v20
    v_lshlrev_b32 v170, 16, v21
    v_and_b32 v171, 0xffff0000, v21
    v_lshlrev_b32 v172, 16, v22
    v_and_b32 v173, 0xffff0000, v22
    v_lshlrev_b32 v174, 16, v23
    v_and_b32 v175, 0xffff0000, v23
    v_lshlrev_b32 v176, 16, v24
    v_and_b32 v177, 0xffff0000, v24
    v_lshlrev_b32 v178, 16, v25
    v_and_b32 v179, 0xffff0000, v25
    v_lshlrev_b32 v180, 16, v26
    v_and_b32 v181, 0xffff0000, v26
    v_lshlrev_b32 v182, 16, v27
    v_and_b32 v183, 0xffff0000, v27
    v_lshlrev_b32 v184, 16, v28
    v_and_b32 v185, 0xffff0000, v28
    v_lshlrev_b32 v186, 16, v29
    v_and_b32 v187, 0xffff0000, v29
    v_lshlrev_b32 v188, 16, v30
    v_and_b32 v189, 0xffff0000, v30
    v_lshlrev_b32 v190, 16, v31
    v_and_b32 v191, 0xffff0000, v31
    v_pk_add_f32 v[192:193], v[128:129], v[136:137]
    v_pk_add_f32 v[194:195], v[130:131], v[138:139]
    v_pk_add_f32 v[196:197], v[132:133], v[140:141]
    v_pk_add_f32 v[198:199], v[134:135], v[142:143]
    v_pk_add_f32 v[192:193], v[192:193], v[144:145]
    v_pk_add_f32 v[194:195], v[194:195], v[146:147]
    v_pk_add_f32 v[196:197], v[196:197], v[148:149]
    v_pk_add_f32 v[198:199], v[198:199], v[150:151]
    v_pk_add_f32 v[192:193], v[192:193], v[152:153]
    v_pk_add_f32 v[194:195], v[194:195], v[154:155]
    v_pk_add_f32 v[196:197], v[196:197], v[156:157]
    v_pk_add_f32 v[198:199], v[198:199], v[158:159]
    v_pk_add_f32 v[192:193], v[192:193], v[160:161]
    v_pk_add_f32 v[194:195], v[194:195], v[162:163]
    v_pk_add_f32 v[196:197], v[196:197], v[164:165]
    v_pk_add_f32 v[198:199], v[198:199], v[166:167]
    v_pk_add_f32 v[192:193], v[192:193], v[168:169]
    v_pk_add_f32 v[194:195], v[194:195], v[170:171]
    v_pk_add_f32 v[196:197], v[196:197], v[172:173]
    v_pk_add_f32 v[198:199], v[198:199], v[174:175]
    v_pk_add_f32 v[192:193], v[192:193], v[176:177]
    v_pk_add_f32 v[194:195], v[194:195], v[178:179]
    v_pk_add_f32 v[196:197], v[196:197], v[180:181]
    v_pk_add_f32 v[198:199], v[198:199], v[182:183]
    v_pk_add_f32 v[192:193], v[192:193], v[184:185]
    v_pk_add_f32 v[194:195], v[194:195], v[186:187]
    v_pk_add_f32 v[196:197], v[196:197], v[188:189]
    v_pk_add_f32 v[198:199], v[198:199], v[190:191]
    v_pk_add_f32 v[192:193], v[192:193], v[194:195]
    v_pk_add_f32 v[196:197], v[196:197], v[198:199]
    v_pk_add_f32 v[192:193], v[192:193], v[196:197]
    v_add_f32 v192, v192, v193
    ds_write_b32 v253, v192 offset:0
    s_waitcnt lgkmcnt(0)
    s_barrier
    ds_read_b128 v[192:195], v254 offset:0
    ds_read_b128 v[196:199], v254 offset:16
    ds_read_b128 v[200:203], v254 offset:32
    ds_read_b128 v[204:207], v254 offset:48
    s_waitcnt lgkmcnt(2)
    v_pk_add_f32 v[192:193], v[192:193], v[194:195]
    v_pk_add_f32 v[196:197], v[196:197], v[198:199]
    s_waitcnt lgkmcnt(0)
    v_pk_add_f32 v[200:201], v[200:201], v[202:203]
    v_pk_add_f32 v[204:205], v[204:205], v[206:207]
    v_pk_add_f32 v[192:193], v[192:193], v[196:197]
    v_pk_add_f32 v[200:201], v[200:201], v[204:205]
    v_pk_add_f32 v[192:193], v[192:193], v[200:201]
    v_add_f32 v192, v192, v193
    v_mul_f32 v192, 0xba800000, v192
    v_mov_b32 v193, v192
    v_pk_add_f32 v[128:129], v[128:129], v[192:193]
    v_pk_add_f32 v[130:131], v[130:131], v[192:193]
    v_pk_add_f32 v[132:133], v[132:133], v[192:193]
    v_pk_add_f32 v[134:135], v[134:135], v[192:193]
    v_pk_add_f32 v[136:137], v[136:137], v[192:193]
    v_pk_add_f32 v[138:139], v[138:139], v[192:193]
    v_pk_add_f32 v[140:141], v[140:141], v[192:193]
    v_pk_add_f32 v[142:143], v[142:143], v[192:193]
    v_pk_add_f32 v[144:145], v[144:145], v[192:193]
    v_pk_add_f32 v[146:147], v[146:147], v[192:193]
    v_pk_add_f32 v[148:149], v[148:149], v[192:193]
    v_pk_add_f32 v[150:151], v[150:151], v[192:193]
    v_pk_add_f32 v[152:153], v[152:153], v[192:193]
    v_pk_add_f32 v[154:155], v[154:155], v[192:193]
    v_pk_add_f32 v[156:157], v[156:157], v[192:193]
    v_pk_add_f32 v[158:159], v[158:159], v[192:193]
    v_pk_add_f32 v[160:161], v[160:161], v[192:193]
    v_pk_add_f32 v[162:163], v[162:163], v[192:193]
    v_pk_add_f32 v[164:165], v[164:165], v[192:193]
    v_pk_add_f32 v[166:167], v[166:167], v[192:193]
    v_pk_add_f32 v[168:169], v[168:169], v[192:193]
    v_pk_add_f32 v[170:171], v[170:171], v[192:193]
    v_pk_add_f32 v[172:173], v[172:173], v[192:193]
    v_pk_add_f32 v[174:175], v[174:175], v[192:193]
    v_pk_add_f32 v[176:177], v[176:177], v[192:193]
    v_pk_add_f32 v[178:179], v[178:179], v[192:193]
    v_pk_add_f32 v[180:181], v[180:181], v[192:193]
    v_pk_add_f32 v[182:183], v[182:183], v[192:193]
    v_pk_add_f32 v[184:185], v[184:185], v[192:193]
    v_pk_add_f32 v[186:187], v[186:187], v[192:193]
    v_pk_add_f32 v[188:189], v[188:189], v[192:193]
    v_pk_add_f32 v[190:191], v[190:191], v[192:193]
    v_pk_mul_f32 v[192:193], v[128:129], v[128:129]
    v_pk_mul_f32 v[194:195], v[130:131], v[130:131]
    v_pk_mul_f32 v[196:197], v[132:133], v[132:133]
    v_pk_mul_f32 v[198:199], v[134:135], v[134:135]
    v_pk_fma_f32 v[192:193], v[136:137], v[136:137], v[192:193]
    v_pk_fma_f32 v[194:195], v[138:139], v[138:139], v[194:195]
    v_pk_fma_f32 v[196:197], v[140:141], v[140:141], v[196:197]
    v_pk_fma_f32 v[198:199], v[142:143], v[142:143], v[198:199]
    v_pk_fma_f32 v[192:193], v[144:145], v[144:145], v[192:193]
    v_pk_fma_f32 v[194:195], v[146:147], v[146:147], v[194:195]
    v_pk_fma_f32 v[196:197], v[148:149], v[148:149], v[196:197]
    v_pk_fma_f32 v[198:199], v[150:151], v[150:151], v[198:199]
    v_pk_fma_f32 v[192:193], v[152:153], v[152:153], v[192:193]
    v_pk_fma_f32 v[194:195], v[154:155], v[154:155], v[194:195]
    v_pk_fma_f32 v[196:197], v[156:157], v[156:157], v[196:197]
    v_pk_fma_f32 v[198:199], v[158:159], v[158:159], v[198:199]
    v_pk_fma_f32 v[192:193], v[160:161], v[160:161], v[192:193]
    v_pk_fma_f32 v[194:195], v[162:163], v[162:163], v[194:195]
    v_pk_fma_f32 v[196:197], v[164:165], v[164:165], v[196:197]
    v_pk_fma_f32 v[198:199], v[166:167], v[166:167], v[198:199]
    v_pk_fma_f32 v[192:193], v[168:169], v[168:169], v[192:193]
    v_pk_fma_f32 v[194:195], v[170:171], v[170:171], v[194:195]
    v_pk_fma_f32 v[196:197], v[172:173], v[172:173], v[196:197]
    v_pk_fma_f32 v[198:199], v[174:175], v[174:175], v[198:199]
    v_pk_fma_f32 v[192:193], v[176:177], v[176:177], v[192:193]
    v_pk_fma_f32 v[194:195], v[178:179], v[178:179], v[194:195]
    v_pk_fma_f32 v[196:197], v[180:181], v[180:181], v[196:197]
    v_pk_fma_f32 v[198:199], v[182:183], v[182:183], v[198:199]
    v_pk_fma_f32 v[192:193], v[184:185], v[184:185], v[192:193]
    v_pk_fma_f32 v[194:195], v[186:187], v[186:187], v[194:195]
    v_pk_fma_f32 v[196:197], v[188:189], v[188:189], v[196:197]
    v_pk_fma_f32 v[198:199], v[190:191], v[190:191], v[198:199]
    v_pk_add_f32 v[192:193], v[192:193], v[194:195]
    v_pk_add_f32 v[196:197], v[196:197], v[198:199]
    v_pk_add_f32 v[192:193], v[192:193], v[196:197]
    v_add_f32 v192, v192, v193
    ds_write_b32 v253, v192 offset:1024
    s_waitcnt lgkmcnt(0)
    s_barrier
    ds_read_b128 v[192:195], v254 offset:1024
    ds_read_b128 v[196:199], v254 offset:1040
    ds_read_b128 v[200:203], v254 offset:1056
    ds_read_b128 v[204:207], v254 offset:1072
    s_waitcnt lgkmcnt(2)
    v_pk_add_f32 v[192:193], v[192:193], v[194:195]
    v_pk_add_f32 v[196:197], v[196:197], v[198:199]
    s_waitcnt lgkmcnt(0)
    v_pk_add_f32 v[200:201], v[200:201], v[202:203]
    v_pk_add_f32 v[204:205], v[204:205], v[206:207]
    v_pk_add_f32 v[192:193], v[192:193], v[196:197]
    v_pk_add_f32 v[200:201], v[200:201], v[204:205]
    v_pk_add_f32 v[192:193], v[192:193], v[200:201]
    v_add_f32 v192, v192, v193
    v_mov_b32 v193, 0x3727c5ac
    v_fmac_f32 v193, 0x3a800000, v192
    v_rsq_f32 v192, v193
    s_nop 0
    v_mov_b32 v193, v192
    v_pk_mul_f32 v[128:129], v[128:129], v[192:193]
    v_pk_mul_f32 v[130:131], v[130:131], v[192:193]
    v_pk_mul_f32 v[132:133], v[132:133], v[192:193]
    v_pk_mul_f32 v[134:135], v[134:135], v[192:193]
    v_pk_mul_f32 v[136:137], v[136:137], v[192:193]
    v_pk_mul_f32 v[138:139], v[138:139], v[192:193]
    v_pk_mul_f32 v[140:141], v[140:141], v[192:193]
    v_pk_mul_f32 v[142:143], v[142:143], v[192:193]
    v_pk_mul_f32 v[144:145], v[144:145], v[192:193]
    v_pk_mul_f32 v[146:147], v[146:147], v[192:193]
    v_pk_mul_f32 v[148:149], v[148:149], v[192:193]
    v_pk_mul_f32 v[150:151], v[150:151], v[192:193]
    v_pk_mul_f32 v[152:153], v[152:153], v[192:193]
    v_pk_mul_f32 v[154:155], v[154:155], v[192:193]
    v_pk_mul_f32 v[156:157], v[156:157], v[192:193]
    v_pk_mul_f32 v[158:159], v[158:159], v[192:193]
    v_pk_mul_f32 v[160:161], v[160:161], v[192:193]
    v_pk_mul_f32 v[162:163], v[162:163], v[192:193]
    v_pk_mul_f32 v[164:165], v[164:165], v[192:193]
    v_pk_mul_f32 v[166:167], v[166:167], v[192:193]
    v_pk_mul_f32 v[168:169], v[168:169], v[192:193]
    v_pk_mul_f32 v[170:171], v[170:171], v[192:193]
    v_pk_mul_f32 v[172:173], v[172:173], v[192:193]
    v_pk_mul_f32 v[174:175], v[174:175], v[192:193]
    v_pk_mul_f32 v[176:177], v[176:177], v[192:193]
    v_pk_mul_f32 v[178:179], v[178:179], v[192:193]
    v_pk_mul_f32 v[180:181], v[180:181], v[192:193]
    v_pk_mul_f32 v[182:183], v[182:183], v[192:193]
    v_pk_mul_f32 v[184:185], v[184:185], v[192:193]
    v_pk_mul_f32 v[186:187], v[186:187], v[192:193]
    v_pk_mul_f32 v[188:189], v[188:189], v[192:193]
    v_pk_mul_f32 v[190:191], v[190:191], v[192:193]
    v_cvt_pk_bf16_f32 v0, v128, v129
    v_cvt_pk_bf16_f32 v1, v130, v131
    v_cvt_pk_bf16_f32 v2, v132, v133
    v_cvt_pk_bf16_f32 v3, v134, v135
    v_cvt_pk_bf16_f32 v4, v136, v137
    v_cvt_pk_bf16_f32 v5, v138, v139
    v_cvt_pk_bf16_f32 v6, v140, v141
    v_cvt_pk_bf16_f32 v7, v142, v143
    v_cvt_pk_bf16_f32 v8, v144, v145
    v_cvt_pk_bf16_f32 v9, v146, v147
    v_cvt_pk_bf16_f32 v10, v148, v149
    v_cvt_pk_bf16_f32 v11, v150, v151
    v_cvt_pk_bf16_f32 v12, v152, v153
    v_cvt_pk_bf16_f32 v13, v154, v155
    v_cvt_pk_bf16_f32 v14, v156, v157
    v_cvt_pk_bf16_f32 v15, v158, v159
    v_cvt_pk_bf16_f32 v16, v160, v161
    v_cvt_pk_bf16_f32 v17, v162, v163
    v_cvt_pk_bf16_f32 v18, v164, v165
    v_cvt_pk_bf16_f32 v19, v166, v167
    v_cvt_pk_bf16_f32 v20, v168, v169
    v_cvt_pk_bf16_f32 v21, v170, v171
    v_cvt_pk_bf16_f32 v22, v172, v173
    v_cvt_pk_bf16_f32 v23, v174, v175
    v_cvt_pk_bf16_f32 v24, v176, v177
    v_cvt_pk_bf16_f32 v25, v178, v179
    v_cvt_pk_bf16_f32 v26, v180, v181
    v_cvt_pk_bf16_f32 v27, v182, v183
    v_cvt_pk_bf16_f32 v28, v184, v185
    v_cvt_pk_bf16_f32 v29, v186, v187
    v_cvt_pk_bf16_f32 v30, v188, v189
    v_cvt_pk_bf16_f32 v31, v190, v191
    buffer_store_dwordx4 v[0:3], v251, s[4:7], s21 offen offset:0 sc1
    buffer_store_dwordx4 v[4:7], v251, s[4:7], s21 offen offset:1024 sc1
    buffer_store_dwordx4 v[8:11], v251, s[4:7], s21 offen offset:2048 sc1
    buffer_store_dwordx4 v[12:15], v251, s[4:7], s21 offen offset:3072 sc1
    s_add_u32 s21, s21, 4096
    buffer_store_dwordx4 v[16:19], v251, s[4:7], s21 offen offset:0 sc1
    buffer_store_dwordx4 v[20:23], v251, s[4:7], s21 offen offset:1024 sc1
    buffer_store_dwordx4 v[24:27], v251, s[4:7], s21 offen offset:2048 sc1
    buffer_store_dwordx4 v[28:31], v251, s[4:7], s21 offen offset:3072 sc1
    s_add_u32 s21, s21, 28672
    s_waitcnt vmcnt(8)
    v_lshlrev_b32 v128, 16, v32
    v_and_b32 v129, 0xffff0000, v32
    v_lshlrev_b32 v130, 16, v33
    v_and_b32 v131, 0xffff0000, v33
    v_lshlrev_b32 v132, 16, v34
    v_and_b32 v133, 0xffff0000, v34
    v_lshlrev_b32 v134, 16, v35
    v_and_b32 v135, 0xffff0000, v35
    v_lshlrev_b32 v136, 16, v36
    v_and_b32 v137, 0xffff0000, v36
    v_lshlrev_b32 v138, 16, v37
    v_and_b32 v139, 0xffff0000, v37
    v_lshlrev_b32 v140, 16, v38
    v_and_b32 v141, 0xffff0000, v38
    v_lshlrev_b32 v142, 16, v39
    v_and_b32 v143, 0xffff0000, v39
    v_lshlrev_b32 v144, 16, v40
    v_and_b32 v145, 0xffff0000, v40
    v_lshlrev_b32 v146, 16, v41
    v_and_b32 v147, 0xffff0000, v41
    v_lshlrev_b32 v148, 16, v42
    v_and_b32 v149, 0xffff0000, v42
    v_lshlrev_b32 v150, 16, v43
    v_and_b32 v151, 0xffff0000, v43
    v_lshlrev_b32 v152, 16, v44
    v_and_b32 v153, 0xffff0000, v44
    v_lshlrev_b32 v154, 16, v45
    v_and_b32 v155, 0xffff0000, v45
    v_lshlrev_b32 v156, 16, v46
    v_and_b32 v157, 0xffff0000, v46
    v_lshlrev_b32 v158, 16, v47
    v_and_b32 v159, 0xffff0000, v47
    v_lshlrev_b32 v160, 16, v48
    v_and_b32 v161, 0xffff0000, v48
    v_lshlrev_b32 v162, 16, v49
    v_and_b32 v163, 0xffff0000, v49
    v_lshlrev_b32 v164, 16, v50
    v_and_b32 v165, 0xffff0000, v50
    v_lshlrev_b32 v166, 16, v51
    v_and_b32 v167, 0xffff0000, v51
    v_lshlrev_b32 v168, 16, v52
    v_and_b32 v169, 0xffff0000, v52
    v_lshlrev_b32 v170, 16, v53
    v_and_b32 v171, 0xffff0000, v53
    v_lshlrev_b32 v172, 16, v54
    v_and_b32 v173, 0xffff0000, v54
    v_lshlrev_b32 v174, 16, v55
    v_and_b32 v175, 0xffff0000, v55
    v_lshlrev_b32 v176, 16, v56
    v_and_b32 v177, 0xffff0000, v56
    v_lshlrev_b32 v178, 16, v57
    v_and_b32 v179, 0xffff0000, v57
    v_lshlrev_b32 v180, 16, v58
    v_and_b32 v181, 0xffff0000, v58
    v_lshlrev_b32 v182, 16, v59
    v_and_b32 v183, 0xffff0000, v59
    v_lshlrev_b32 v184, 16, v60
    v_and_b32 v185, 0xffff0000, v60
    v_lshlrev_b32 v186, 16, v61
    v_and_b32 v187, 0xffff0000, v61
    v_lshlrev_b32 v188, 16, v62
    v_and_b32 v189, 0xffff0000, v62
    v_lshlrev_b32 v190, 16, v63
    v_and_b32 v191, 0xffff0000, v63
    v_pk_add_f32 v[192:193], v[128:129], v[136:137]
    v_pk_add_f32 v[194:195], v[130:131], v[138:139]
    v_pk_add_f32 v[196:197], v[132:133], v[140:141]
    v_pk_add_f32 v[198:199], v[134:135], v[142:143]
    v_pk_add_f32 v[192:193], v[192:193], v[144:145]
    v_pk_add_f32 v[194:195], v[194:195], v[146:147]
    v_pk_add_f32 v[196:197], v[196:197], v[148:149]
    v_pk_add_f32 v[198:199], v[198:199], v[150:151]
    v_pk_add_f32 v[192:193], v[192:193], v[152:153]
    v_pk_add_f32 v[194:195], v[194:195], v[154:155]
    v_pk_add_f32 v[196:197], v[196:197], v[156:157]
    v_pk_add_f32 v[198:199], v[198:199], v[158:159]
    v_pk_add_f32 v[192:193], v[192:193], v[160:161]
    v_pk_add_f32 v[194:195], v[194:195], v[162:163]
    v_pk_add_f32 v[196:197], v[196:197], v[164:165]
    v_pk_add_f32 v[198:199], v[198:199], v[166:167]
    v_pk_add_f32 v[192:193], v[192:193], v[168:169]
    v_pk_add_f32 v[194:195], v[194:195], v[170:171]
    v_pk_add_f32 v[196:197], v[196:197], v[172:173]
    v_pk_add_f32 v[198:199], v[198:199], v[174:175]
    v_pk_add_f32 v[192:193], v[192:193], v[176:177]
    v_pk_add_f32 v[194:195], v[194:195], v[178:179]
    v_pk_add_f32 v[196:197], v[196:197], v[180:181]
    v_pk_add_f32 v[198:199], v[198:199], v[182:183]
    v_pk_add_f32 v[192:193], v[192:193], v[184:185]
    v_pk_add_f32 v[194:195], v[194:195], v[186:187]
    v_pk_add_f32 v[196:197], v[196:197], v[188:189]
    v_pk_add_f32 v[198:199], v[198:199], v[190:191]
    v_pk_add_f32 v[192:193], v[192:193], v[194:195]
    v_pk_add_f32 v[196:197], v[196:197], v[198:199]
    v_pk_add_f32 v[192:193], v[192:193], v[196:197]
    v_add_f32 v192, v192, v193
    ds_write_b32 v253, v192 offset:0
    s_waitcnt lgkmcnt(0)
    s_barrier
    ds_read_b128 v[192:195], v254 offset:0
    ds_read_b128 v[196:199], v254 offset:16
    ds_read_b128 v[200:203], v254 offset:32
    ds_read_b128 v[204:207], v254 offset:48
    s_waitcnt lgkmcnt(2)
    v_pk_add_f32 v[192:193], v[192:193], v[194:195]
    v_pk_add_f32 v[196:197], v[196:197], v[198:199]
    s_waitcnt lgkmcnt(0)
    v_pk_add_f32 v[200:201], v[200:201], v[202:203]
    v_pk_add_f32 v[204:205], v[204:205], v[206:207]
    v_pk_add_f32 v[192:193], v[192:193], v[196:197]
    v_pk_add_f32 v[200:201], v[200:201], v[204:205]
    v_pk_add_f32 v[192:193], v[192:193], v[200:201]
    v_add_f32 v192, v192, v193
    v_mul_f32 v192, 0xba800000, v192
    v_mov_b32 v193, v192
    v_pk_add_f32 v[128:129], v[128:129], v[192:193]
    v_pk_add_f32 v[130:131], v[130:131], v[192:193]
    v_pk_add_f32 v[132:133], v[132:133], v[192:193]
    v_pk_add_f32 v[134:135], v[134:135], v[192:193]
    v_pk_add_f32 v[136:137], v[136:137], v[192:193]
    v_pk_add_f32 v[138:139], v[138:139], v[192:193]
    v_pk_add_f32 v[140:141], v[140:141], v[192:193]
    v_pk_add_f32 v[142:143], v[142:143], v[192:193]
    v_pk_add_f32 v[144:145], v[144:145], v[192:193]
    v_pk_add_f32 v[146:147], v[146:147], v[192:193]
    v_pk_add_f32 v[148:149], v[148:149], v[192:193]
    v_pk_add_f32 v[150:151], v[150:151], v[192:193]
    v_pk_add_f32 v[152:153], v[152:153], v[192:193]
    v_pk_add_f32 v[154:155], v[154:155], v[192:193]
    v_pk_add_f32 v[156:157], v[156:157], v[192:193]
    v_pk_add_f32 v[158:159], v[158:159], v[192:193]
    v_pk_add_f32 v[160:161], v[160:161], v[192:193]
    v_pk_add_f32 v[162:163], v[162:163], v[192:193]
    v_pk_add_f32 v[164:165], v[164:165], v[192:193]
    v_pk_add_f32 v[166:167], v[166:167], v[192:193]
    v_pk_add_f32 v[168:169], v[168:169], v[192:193]
    v_pk_add_f32 v[170:171], v[170:171], v[192:193]
    v_pk_add_f32 v[172:173], v[172:173], v[192:193]
    v_pk_add_f32 v[174:175], v[174:175], v[192:193]
    v_pk_add_f32 v[176:177], v[176:177], v[192:193]
    v_pk_add_f32 v[178:179], v[178:179], v[192:193]
    v_pk_add_f32 v[180:181], v[180:181], v[192:193]
    v_pk_add_f32 v[182:183], v[182:183], v[192:193]
    v_pk_add_f32 v[184:185], v[184:185], v[192:193]
    v_pk_add_f32 v[186:187], v[186:187], v[192:193]
    v_pk_add_f32 v[188:189], v[188:189], v[192:193]
    v_pk_add_f32 v[190:191], v[190:191], v[192:193]
    v_pk_mul_f32 v[192:193], v[128:129], v[128:129]
    v_pk_mul_f32 v[194:195], v[130:131], v[130:131]
    v_pk_mul_f32 v[196:197], v[132:133], v[132:133]
    v_pk_mul_f32 v[198:199], v[134:135], v[134:135]
    v_pk_fma_f32 v[192:193], v[136:137], v[136:137], v[192:193]
    v_pk_fma_f32 v[194:195], v[138:139], v[138:139], v[194:195]
    v_pk_fma_f32 v[196:197], v[140:141], v[140:141], v[196:197]
    v_pk_fma_f32 v[198:199], v[142:143], v[142:143], v[198:199]
    v_pk_fma_f32 v[192:193], v[144:145], v[144:145], v[192:193]
    v_pk_fma_f32 v[194:195], v[146:147], v[146:147], v[194:195]
    v_pk_fma_f32 v[196:197], v[148:149], v[148:149], v[196:197]
    v_pk_fma_f32 v[198:199], v[150:151], v[150:151], v[198:199]
    v_pk_fma_f32 v[192:193], v[152:153], v[152:153], v[192:193]
    v_pk_fma_f32 v[194:195], v[154:155], v[154:155], v[194:195]
    v_pk_fma_f32 v[196:197], v[156:157], v[156:157], v[196:197]
    v_pk_fma_f32 v[198:199], v[158:159], v[158:159], v[198:199]
    v_pk_fma_f32 v[192:193], v[160:161], v[160:161], v[192:193]
    v_pk_fma_f32 v[194:195], v[162:163], v[162:163], v[194:195]
    v_pk_fma_f32 v[196:197], v[164:165], v[164:165], v[196:197]
    v_pk_fma_f32 v[198:199], v[166:167], v[166:167], v[198:199]
    v_pk_fma_f32 v[192:193], v[168:169], v[168:169], v[192:193]
    v_pk_fma_f32 v[194:195], v[170:171], v[170:171], v[194:195]
    v_pk_fma_f32 v[196:197], v[172:173], v[172:173], v[196:197]
    v_pk_fma_f32 v[198:199], v[174:175], v[174:175], v[198:199]
    v_pk_fma_f32 v[192:193], v[176:177], v[176:177], v[192:193]
    v_pk_fma_f32 v[194:195], v[178:179], v[178:179], v[194:195]
    v_pk_fma_f32 v[196:197], v[180:181], v[180:181], v[196:197]
    v_pk_fma_f32 v[198:199], v[182:183], v[182:183], v[198:199]
    v_pk_fma_f32 v[192:193], v[184:185], v[184:185], v[192:193]
    v_pk_fma_f32 v[194:195], v[186:187], v[186:187], v[194:195]
    v_pk_fma_f32 v[196:197], v[188:189], v[188:189], v[196:197]
    v_pk_fma_f32 v[198:199], v[190:191], v[190:191], v[198:199]
    v_pk_add_f32 v[192:193], v[192:193], v[194:195]
    v_pk_add_f32 v[196:197], v[196:197], v[198:199]
    v_pk_add_f32 v[192:193], v[192:193], v[196:197]
    v_add_f32 v192, v192, v193
    ds_write_b32 v253, v192 offset:1024
    s_waitcnt lgkmcnt(0)
    s_barrier
    ds_read_b128 v[192:195], v254 offset:1024
    ds_read_b128 v[196:199], v254 offset:1040
    ds_read_b128 v[200:203], v254 offset:1056
    ds_read_b128 v[204:207], v254 offset:1072
    s_waitcnt lgkmcnt(2)
    v_pk_add_f32 v[192:193], v[192:193], v[194:195]
    v_pk_add_f32 v[196:197], v[196:197], v[198:199]
    s_waitcnt lgkmcnt(0)
    v_pk_add_f32 v[200:201], v[200:201], v[202:203]
    v_pk_add_f32 v[204:205], v[204:205], v[206:207]
    v_pk_add_f32 v[192:193], v[192:193], v[196:197]
    v_pk_add_f32 v[200:201], v[200:201], v[204:205]
    v_pk_add_f32 v[192:193], v[192:193], v[200:201]
    v_add_f32 v192, v192, v193
    v_mov_b32 v193, 0x3727c5ac
    v_fmac_f32 v193, 0x3a800000, v192
    v_rsq_f32 v192, v193
    s_nop 0
    v_mov_b32 v193, v192
    v_pk_mul_f32 v[128:129], v[128:129], v[192:193]
    v_pk_mul_f32 v[130:131], v[130:131], v[192:193]
    v_pk_mul_f32 v[132:133], v[132:133], v[192:193]
    v_pk_mul_f32 v[134:135], v[134:135], v[192:193]
    v_pk_mul_f32 v[136:137], v[136:137], v[192:193]
    v_pk_mul_f32 v[138:139], v[138:139], v[192:193]
    v_pk_mul_f32 v[140:141], v[140:141], v[192:193]
    v_pk_mul_f32 v[142:143], v[142:143], v[192:193]
    v_pk_mul_f32 v[144:145], v[144:145], v[192:193]
    v_pk_mul_f32 v[146:147], v[146:147], v[192:193]
    v_pk_mul_f32 v[148:149], v[148:149], v[192:193]
    v_pk_mul_f32 v[150:151], v[150:151], v[192:193]
    v_pk_mul_f32 v[152:153], v[152:153], v[192:193]
    v_pk_mul_f32 v[154:155], v[154:155], v[192:193]
    v_pk_mul_f32 v[156:157], v[156:157], v[192:193]
    v_pk_mul_f32 v[158:159], v[158:159], v[192:193]
    v_pk_mul_f32 v[160:161], v[160:161], v[192:193]
    v_pk_mul_f32 v[162:163], v[162:163], v[192:193]
    v_pk_mul_f32 v[164:165], v[164:165], v[192:193]
    v_pk_mul_f32 v[166:167], v[166:167], v[192:193]
    v_pk_mul_f32 v[168:169], v[168:169], v[192:193]
    v_pk_mul_f32 v[170:171], v[170:171], v[192:193]
    v_pk_mul_f32 v[172:173], v[172:173], v[192:193]
    v_pk_mul_f32 v[174:175], v[174:175], v[192:193]
    v_pk_mul_f32 v[176:177], v[176:177], v[192:193]
    v_pk_mul_f32 v[178:179], v[178:179], v[192:193]
    v_pk_mul_f32 v[180:181], v[180:181], v[192:193]
    v_pk_mul_f32 v[182:183], v[182:183], v[192:193]
    v_pk_mul_f32 v[184:185], v[184:185], v[192:193]
    v_pk_mul_f32 v[186:187], v[186:187], v[192:193]
    v_pk_mul_f32 v[188:189], v[188:189], v[192:193]
    v_pk_mul_f32 v[190:191], v[190:191], v[192:193]
    v_cvt_pk_bf16_f32 v32, v128, v129
    v_cvt_pk_bf16_f32 v33, v130, v131
    v_cvt_pk_bf16_f32 v34, v132, v133
    v_cvt_pk_bf16_f32 v35, v134, v135
    v_cvt_pk_bf16_f32 v36, v136, v137
    v_cvt_pk_bf16_f32 v37, v138, v139
    v_cvt_pk_bf16_f32 v38, v140, v141
    v_cvt_pk_bf16_f32 v39, v142, v143
    v_cvt_pk_bf16_f32 v40, v144, v145
    v_cvt_pk_bf16_f32 v41, v146, v147
    v_cvt_pk_bf16_f32 v42, v148, v149
    v_cvt_pk_bf16_f32 v43, v150, v151
    v_cvt_pk_bf16_f32 v44, v152, v153
    v_cvt_pk_bf16_f32 v45, v154, v155
    v_cvt_pk_bf16_f32 v46, v156, v157
    v_cvt_pk_bf16_f32 v47, v158, v159
    v_cvt_pk_bf16_f32 v48, v160, v161
    v_cvt_pk_bf16_f32 v49, v162, v163
    v_cvt_pk_bf16_f32 v50, v164, v165
    v_cvt_pk_bf16_f32 v51, v166, v167
    v_cvt_pk_bf16_f32 v52, v168, v169
    v_cvt_pk_bf16_f32 v53, v170, v171
    v_cvt_pk_bf16_f32 v54, v172, v173
    v_cvt_pk_bf16_f32 v55, v174, v175
    v_cvt_pk_bf16_f32 v56, v176, v177
    v_cvt_pk_bf16_f32 v57, v178, v179
    v_cvt_pk_bf16_f32 v58, v180, v181
    v_cvt_pk_bf16_f32 v59, v182, v183
    v_cvt_pk_bf16_f32 v60, v184, v185
    v_cvt_pk_bf16_f32 v61, v186, v187
    v_cvt_pk_bf16_f32 v62, v188, v189
    v_cvt_pk_bf16_f32 v63, v190, v191
    buffer_store_dwordx4 v[32:35], v251, s[4:7], s21 offen offset:0 sc1
    buffer_store_dwordx4 v[36:39], v251, s[4:7], s21 offen offset:1024 sc1
    buffer_store_dwordx4 v[40:43], v251, s[4:7], s21 offen offset:2048 sc1
    buffer_store_dwordx4 v[44:47], v251, s[4:7], s21 offen offset:3072 sc1
    s_add_u32 s21, s21, 4096
    buffer_store_dwordx4 v[48:51], v251, s[4:7], s21 offen offset:0 sc1
    buffer_store_dwordx4 v[52:55], v251, s[4:7], s21 offen offset:1024 sc1
    buffer_store_dwordx4 v[56:59], v251, s[4:7], s21 offen offset:2048 sc1
    buffer_store_dwordx4 v[60:63], v251, s[4:7], s21 offen offset:3072 sc1
    s_add_u32 s21, s21, 28672
    s_mov_b32 s54, 0
main_kernel_w_done:
    s_cmp_eq_u32 s14, 0
    s_cbranch_scc1 main_kernel_w_dw0
    s_waitcnt vmcnt(0)
    s_barrier
    s_branch main_kernel_w_bar
main_kernel_w_dw0:
    s_add_u32 s32, s23, 1
    s_bitcmp0_b32 s32, 2
    s_cselect_b32 s34, 4, 9
    s_cselect_b32 s35, 8, 4
    s_lshl_b32 s32, s23, 13
    s_add_u32 s56, s32, 0x8404000
    v_lshrrev_b32 v253, 1, v250
    v_add_u32 v253, s24, v253
    v_lshlrev_b32 v253, s34, v253
    v_and_b32 v254, 1, v250
    v_add_u32 v254, s25, v254
    v_lshlrev_b32 v254, s35, v254
    v_add_u32 v249, v254, v253
    s_lshl_b32 s57, 1, s54
    s_mov_b32 s28, s55
    s_cmp_eq_u32 s55, -1
    s_cbranch_scc0 main_kernel_w_have
    s_branch main_kernel_w_try
.section .rodata,"a"
.p2align 6
.amdhsa_kernel main_kernel
  .amdhsa_next_free_vgpr 512
  .amdhsa_next_free_sgpr 102
  .amdhsa_accum_offset 256
  .amdhsa_group_segment_fixed_size 0
  .amdhsa_kernarg_size 120
  .amdhsa_user_sgpr_count 2
  .amdhsa_user_sgpr_kernarg_segment_ptr 1
  .amdhsa_system_sgpr_workgroup_id_x 1
.end_amdhsa_kernel
```

```asm
; @launch kernel=main_kernel grid=(256,1,1) block=(256,1,1) lds=163840
.amdgcn_target "amdgcn-amd-amdhsa--gfx950"
.text
.text
.globl main_kernel
.p2align 8
.type main_kernel,@function
main_kernel:
    s_load_dwordx4 s[20:23], s[0:1], 104
    s_load_dwordx8 s[40:47], s[0:1], 16
    s_load_dwordx8 s[64:71], s[0:1], 64
    s_load_dwordx2 s[72:73], s[0:1], 0
    s_load_dwordx2 s[74:75], s[0:1], 96
    s_load_dwordx2 s[76:77], s[0:1], 8
    s_cmp_ge_u32 s2, 256
    s_cbranch_scc1 main_kernel_end
    v_lshrrev_b32 v126, 6, v0
    v_and_b32 v94, 63, v0
    v_and_b32 v250, 63, v0
    v_readfirstlane_b32 s14, v126
    s_mov_b32 s29, 0x80000
    s_waitcnt lgkmcnt(0)
    s_mov_b32 s60, s20
    s_and_b32 s61, s21, 0xffff
    s_mov_b32 s62, 0x100
    s_mov_b32 s63, 0x20000
    s_mov_b32 s4, s22
    s_and_b32 s5, s23, 0xffff
    s_mov_b32 s6, 0x10000000
    s_mov_b32 s7, 0x20000
    s_cmp_lg_u32 s14, 0
    s_cbranch_scc1 main_kernel_slot_wait
    s_getreg_b32 s12, hwreg(HW_REG_XCC_ID, 0, 4)
    s_and_b32 s12, s12, 7
    s_lshl_b32 s32, s12, 5
    v_mov_b32 v126, 0
    v_mov_b32 v127, 1
    s_mov_b64 exec, 1
    buffer_atomic_add v127, v126, s[60:63], s32 offen sc0 sc1
    s_waitcnt vmcnt(0)
    s_mov_b64 exec, -1
    v_readfirstlane_b32 s13, v127
    s_nop 3
    s_cmp_lt_u32 s13, 32
    s_cbranch_scc1 main_kernel_slot_pub
    v_and_b32 v126, 7, v94
    v_lshlrev_b32 v126, 5, v126
main_kernel_ovf_cnt:
    buffer_load_dword v127, v126, s[60:63], 0 offen sc1
    s_waitcnt vmcnt(0)
    v_readlane_b32 s48, v127, 0
    v_readlane_b32 s49, v127, 1
    v_readlane_b32 s50, v127, 2
    v_readlane_b32 s51, v127, 3
    v_readlane_b32 s52, v127, 4
    v_readlane_b32 s53, v127, 5
    v_readlane_b32 s54, v127, 6
    v_readlane_b32 s55, v127, 7
    s_nop 3
    s_add_u32 s33, s48, s49
    s_add_u32 s33, s33, s50
    s_add_u32 s33, s33, s51
    s_add_u32 s33, s33, s52
    s_add_u32 s33, s33, s53
    s_add_u32 s33, s33, s54
    s_add_u32 s33, s33, s55
    s_cmp_ge_u32 s33, 256
    s_cbranch_scc1 main_kernel_ovf_cnt_ok
    s_sub_u32 s29, s29, 1
    s_cbranch_scc1 main_kernel_end
    s_sleep 4
    s_branch main_kernel_ovf_cnt
main_kernel_ovf_cnt_ok:
    v_mov_b32 v126, 0
    v_mov_b32 v127, 1
    s_mov_b64 exec, 1
    buffer_atomic_add v127, v126, s[60:63], 0 offen offset:8 sc0 sc1
    s_waitcnt vmcnt(0)
    s_mov_b64 exec, -1
    v_readfirstlane_b32 s33, v127
    s_nop 3
    s_min_u32 s34, s48, 32
    s_sub_u32 s35, 32, s34
    s_mov_b32 s12, 0
    s_add_u32 s13, s34, s33
    s_cmp_lt_u32 s33, s35
    s_cbranch_scc1 main_kernel_slot_pub
    s_sub_u32 s33, s33, s35
    s_min_u32 s34, s49, 32
    s_sub_u32 s35, 32, s34
    s_mov_b32 s12, 1
    s_add_u32 s13, s34, s33
    s_cmp_lt_u32 s33, s35
    s_cbranch_scc1 main_kernel_slot_pub
    s_sub_u32 s33, s33, s35
    s_min_u32 s34, s50, 32
    s_sub_u32 s35, 32, s34
    s_mov_b32 s12, 2
    s_add_u32 s13, s34, s33
    s_cmp_lt_u32 s33, s35
    s_cbranch_scc1 main_kernel_slot_pub
    s_sub_u32 s33, s33, s35
    s_min_u32 s34, s51, 32
    s_sub_u32 s35, 32, s34
    s_mov_b32 s12, 3
    s_add_u32 s13, s34, s33
    s_cmp_lt_u32 s33, s35
    s_cbranch_scc1 main_kernel_slot_pub
    s_sub_u32 s33, s33, s35
    s_min_u32 s34, s52, 32
    s_sub_u32 s35, 32, s34
    s_mov_b32 s12, 4
    s_add_u32 s13, s34, s33
    s_cmp_lt_u32 s33, s35
    s_cbranch_scc1 main_kernel_slot_pub
    s_sub_u32 s33, s33, s35
    s_min_u32 s34, s53, 32
    s_sub_u32 s35, 32, s34
    s_mov_b32 s12, 5
    s_add_u32 s13, s34, s33
    s_cmp_lt_u32 s33, s35
    s_cbranch_scc1 main_kernel_slot_pub
    s_sub_u32 s33, s33, s35
    s_min_u32 s34, s54, 32
    s_sub_u32 s35, 32, s34
    s_mov_b32 s12, 6
    s_add_u32 s13, s34, s33
    s_cmp_lt_u32 s33, s35
    s_cbranch_scc1 main_kernel_slot_pub
    s_sub_u32 s33, s33, s35
    s_min_u32 s34, s55, 32
    s_sub_u32 s35, 32, s34
    s_mov_b32 s12, 7
    s_add_u32 s13, s34, s33
    s_cmp_lt_u32 s33, s35
    s_cbranch_scc1 main_kernel_slot_pub
    s_sub_u32 s33, s33, s35
    s_mov_b32 s12, 8
    s_mov_b32 s13, 0
main_kernel_slot_pub:
    v_mov_b32 v126, 0
    v_mov_b32 v127, s12
    v_mov_b32 v95, s13
    ds_write_b32 v126, v127
    ds_write_b32 v126, v95 offset:4
    s_waitcnt lgkmcnt(0)
main_kernel_slot_wait:
    s_barrier
    v_mov_b32 v126, 0
    ds_read_b32 v127, v126
    ds_read_b32 v95, v126 offset:4
    s_waitcnt lgkmcnt(0)
    v_readfirstlane_b32 s12, v127
    v_readfirstlane_b32 s13, v95
    s_nop 3
    s_barrier
    s_cmp_ge_u32 s12, 8
    s_cbranch_scc1 main_kernel_end
    s_cmp_lt_u32 s12, 2
    s_cbranch_scc1 main_kernel_chain
    s_mov_b32 s96, s72
    s_and_b32 s97, s73, 0xffff
    s_mov_b32 s98, 0x400000
    s_mov_b32 s99, 0x20000
    s_mov_b32 s92, s74
    s_and_b32 s93, s75, 0xffff
    s_mov_b32 s94, 0x400000
    s_mov_b32 s95, 0x20000
    v_lshlrev_b32 v1, 4, v0
    v_lshlrev_b32 v251, 4, v250
    v_mov_b32 v4, 0
    v_mov_b32 v8, -1
    v_mov_b32 v5, 0
    v_mov_b32 v9, -1
    v_mov_b32 v6, 0
    v_mov_b32 v10, -1
    v_mov_b32 v7, 0
    v_mov_b32 v11, -1
    v_mul_u32_u24 v12, 128, v0
    s_lshl_b32 s15, s12, 4
    s_and_b32 s32, s12, 1
    s_lshl_b32 s32, s32, 5
    s_cmp_lt_u32 s12, 4
    s_cselect_b32 s15, s32, s15
    s_cselect_b32 s32, 32, 16
    s_add_u32 s15, s15, s13
    s_sub_u32 s16, s15, 80
    s_sub_u32 s27, s12, 2
    s_mov_b32 s52, 0
    s_cmp_lt_u32 s13, s32
    s_cbranch_scc1 main_kernel_s_ln
    s_cmp_lg_u32 s13, 16
    s_cbranch_scc1 main_kernel_s_fill
    s_lshl_b32 s32, s16, 11
    s_add_u32 s32, s32, 0x8400000
    buffer_store_dwordx4 v[4:7], v1, s[4:7], s32 offen sc1
    s_add_u32 s32, s32, 4096
    buffer_store_dwordx4 v[4:7], v1, s[4:7], s32 offen sc1
    s_add_u32 s32, s32, 4096
    buffer_store_dwordx4 v[4:7], v1, s[4:7], s32 offen sc1
    s_add_u32 s32, s32, 4096
    buffer_store_dwordx4 v[4:7], v1, s[4:7], s32 offen sc1
    s_add_u32 s32, s32, 4096
    buffer_store_dwordx4 v[4:7], v1, s[4:7], s32 offen sc1
    s_add_u32 s32, s32, 4096
    buffer_store_dwordx4 v[4:7], v1, s[4:7], s32 offen sc1
    s_add_u32 s32, s32, 4096
    buffer_store_dwordx4 v[4:7], v1, s[4:7], s32 offen sc1
    s_add_u32 s32, s32, 4096
    buffer_store_dwordx4 v[4:7], v1, s[4:7], s32 offen sc1
    s_add_u32 s32, s32, 4096
    v_bfe_u32 v2, v0, 2, 1
    s_lshr_b32 s32, s14, 1
    v_and_b32 v2, s32, v2
    s_bitcmp1_b32 s14, 0
    s_cselect_b32 s32, 15, 0
    s_cselect_b32 s33, 4161536, 0
    v_xor_b32 v2, s32, v2
    v_lshlrev_b32 v2, 4, v2
    v_and_b32 v3, 3, v0
    v_lshl_add_u32 v2, v3, 8, v2
    v_lshrrev_b32 v3, 3, v0
    v_lshl_add_u32 v2, v3, 10, v2
    s_add_u32 s33, s33, 0x4808000
    buffer_store_dwordx4 v[4:7], v2, s[4:7], s33 offen sc1
    s_waitcnt vmcnt(0)
    s_barrier
    s_cmp_lg_u32 s14, 0
    s_cbranch_scc1 main_kernel_s_fill
    v_mov_b32 v2, 1
    s_mov_b64 exec, 1
    buffer_atomic_add v2, v4, s[60:63], 0 offen offset:12 sc1
    s_mov_b64 exec, -1
    s_branch main_kernel_s_fill
main_kernel_s_ln:
    v_and_b32 v3, 15, v250
    v_and_b32 v2, 48, v250
    v_lshl_add_u32 v3, v3, 11, v2
    s_lshl_b32 s34, s15, 15
    s_lshl_b32 s32, s14, 9
    s_add_u32 s32, s34, s32
    buffer_load_dwordx4 v[32:35], v3, s[96:99], s32 offen offset:0
    buffer_load_dwordx4 v[36:39], v3, s[96:99], s32 offen offset:64
    buffer_load_dwordx4 v[40:43], v3, s[96:99], s32 offen offset:128
    buffer_load_dwordx4 v[44:47], v3, s[96:99], s32 offen offset:192
    buffer_load_dwordx4 v[48:51], v3, s[96:99], s32 offen offset:256
    buffer_load_dwordx4 v[52:55], v3, s[96:99], s32 offen offset:320
    buffer_load_dwordx4 v[56:59], v3, s[96:99], s32 offen offset:384
    buffer_load_dwordx4 v[60:63], v3, s[96:99], s32 offen offset:448
    v_and_b32 v255, 15, v250
    v_lshlrev_b32 v254, 6, v255
    v_add_u32 v254, 132096, v254
    v_lshrrev_b32 v255, 4, v250
    v_lshl_add_u32 v253, v255, 2, v254
    v_lshl_add_u32 v253, s14, 4, v253
    s_lshl_b32 s32, s14, 13
    s_add_u32 s34, s34, s32
    s_waitcnt vmcnt(0)
    v_permlane16_swap_b32 v32, v34
    v_permlane16_swap_b32 v33, v35
    v_permlane16_swap_b32 v36, v38
    v_permlane16_swap_b32 v37, v39
    v_permlane16_swap_b32 v40, v42
    v_permlane16_swap_b32 v41, v43
    v_permlane16_swap_b32 v44, v46
    v_permlane16_swap_b32 v45, v47
    v_permlane16_swap_b32 v48, v50
    v_permlane16_swap_b32 v49, v51
    v_permlane16_swap_b32 v52, v54
    v_permlane16_swap_b32 v53, v55
    v_permlane16_swap_b32 v56, v58
    v_permlane16_swap_b32 v57, v59
    v_permlane16_swap_b32 v60, v62
    v_permlane16_swap_b32 v61, v63
    v_permlane32_swap_b32 v32, v34
    v_permlane32_swap_b32 v33, v35
    v_permlane32_swap_b32 v36, v38
    v_permlane32_swap_b32 v37, v39
    v_permlane32_swap_b32 v40, v42
    v_permlane32_swap_b32 v41, v43
    v_permlane32_swap_b32 v44, v46
    v_permlane32_swap_b32 v45, v47
    v_permlane32_swap_b32 v48, v50
    v_permlane32_swap_b32 v49, v51
    v_permlane32_swap_b32 v52, v54
    v_permlane32_swap_b32 v53, v55
    v_permlane32_swap_b32 v56, v58
    v_permlane32_swap_b32 v57, v59
    v_permlane32_swap_b32 v60, v62
    v_permlane32_swap_b32 v61, v63
    s_lshr_b32 s32, s15, 3
    s_lshl_b32 s32, s32, 9
    s_and_b32 s33, s15, 7
    s_lshl_b32 s33, s33, 4
    s_add_u32 s32, s32, s33
    s_add_u32 s16, s32, 0x8416000
    v_lshlrev_b32 v64, 16, v32
    v_and_b32 v65, 0xffff0000, v32
    v_lshlrev_b32 v66, 16, v33
    v_and_b32 v67, 0xffff0000, v33
    v_lshlrev_b32 v68, 16, v34
    v_and_b32 v69, 0xffff0000, v34
    v_lshlrev_b32 v70, 16, v35
    v_and_b32 v71, 0xffff0000, v35
    v_lshlrev_b32 v72, 16, v36
    v_and_b32 v73, 0xffff0000, v36
    v_lshlrev_b32 v74, 16, v37
    v_and_b32 v75, 0xffff0000, v37
    v_lshlrev_b32 v76, 16, v38
    v_and_b32 v77, 0xffff0000, v38
    v_lshlrev_b32 v78, 16, v39
    v_and_b32 v79, 0xffff0000, v39
    v_lshlrev_b32 v80, 16, v40
    v_and_b32 v81, 0xffff0000, v40
    v_lshlrev_b32 v82, 16, v41
    v_and_b32 v83, 0xffff0000, v41
    v_lshlrev_b32 v84, 16, v42
    v_and_b32 v85, 0xffff0000, v42
    v_lshlrev_b32 v86, 16, v43
    v_and_b32 v87, 0xffff0000, v43
    v_lshlrev_b32 v88, 16, v44
    v_and_b32 v89, 0xffff0000, v44
    v_lshlrev_b32 v90, 16, v45
    v_and_b32 v91, 0xffff0000, v45
    v_lshlrev_b32 v92, 16, v46
    v_and_b32 v93, 0xffff0000, v46
    v_lshlrev_b32 v94, 16, v47
    v_and_b32 v95, 0xffff0000, v47
    v_lshlrev_b32 v96, 16, v48
    v_and_b32 v97, 0xffff0000, v48
    v_lshlrev_b32 v98, 16, v49
    v_and_b32 v99, 0xffff0000, v49
    v_lshlrev_b32 v100, 16, v50
    v_and_b32 v101, 0xffff0000, v50
    v_lshlrev_b32 v102, 16, v51
    v_and_b32 v103, 0xffff0000, v51
    v_lshlrev_b32 v104, 16, v52
    v_and_b32 v105, 0xffff0000, v52
    v_lshlrev_b32 v106, 16, v53
    v_and_b32 v107, 0xffff0000, v53
    v_lshlrev_b32 v108, 16, v54
    v_and_b32 v109, 0xffff0000, v54
    v_lshlrev_b32 v110, 16, v55
    v_and_b32 v111, 0xffff0000, v55
    v_lshlrev_b32 v112, 16, v56
    v_and_b32 v113, 0xffff0000, v56
    v_lshlrev_b32 v114, 16, v57
    v_and_b32 v115, 0xffff0000, v57
    v_lshlrev_b32 v116, 16, v58
    v_and_b32 v117, 0xffff0000, v58
    v_lshlrev_b32 v118, 16, v59
    v_and_b32 v119, 0xffff0000, v59
    v_lshlrev_b32 v120, 16, v60
    v_and_b32 v121, 0xffff0000, v60
    v_lshlrev_b32 v122, 16, v61
    v_and_b32 v123, 0xffff0000, v61
    v_lshlrev_b32 v124, 16, v62
    v_and_b32 v125, 0xffff0000, v62
    v_lshlrev_b32 v126, 16, v63
    v_and_b32 v127, 0xffff0000, v63
    v_pk_add_f32 v[16:17], v[64:65], v[72:73]
    v_pk_add_f32 v[18:19], v[66:67], v[74:75]
    v_pk_add_f32 v[20:21], v[68:69], v[76:77]
    v_pk_add_f32 v[22:23], v[70:71], v[78:79]
    v_pk_add_f32 v[16:17], v[16:17], v[80:81]
    v_pk_add_f32 v[18:19], v[18:19], v[82:83]
    v_pk_add_f32 v[20:21], v[20:21], v[84:85]
    v_pk_add_f32 v[22:23], v[22:23], v[86:87]
    v_pk_add_f32 v[16:17], v[16:17], v[88:89]
    v_pk_add_f32 v[18:19], v[18:19], v[90:91]
    v_pk_add_f32 v[20:21], v[20:21], v[92:93]
    v_pk_add_f32 v[22:23], v[22:23], v[94:95]
    v_pk_add_f32 v[16:17], v[16:17], v[96:97]
    v_pk_add_f32 v[18:19], v[18:19], v[98:99]
    v_pk_add_f32 v[20:21], v[20:21], v[100:101]
    v_pk_add_f32 v[22:23], v[22:23], v[102:103]
    v_pk_add_f32 v[16:17], v[16:17], v[104:105]
    v_pk_add_f32 v[18:19], v[18:19], v[106:107]
    v_pk_add_f32 v[20:21], v[20:21], v[108:109]
    v_pk_add_f32 v[22:23], v[22:23], v[110:111]
    v_pk_add_f32 v[16:17], v[16:17], v[112:113]
    v_pk_add_f32 v[18:19], v[18:19], v[114:115]
    v_pk_add_f32 v[20:21], v[20:21], v[116:117]
    v_pk_add_f32 v[22:23], v[22:23], v[118:119]
    v_pk_add_f32 v[16:17], v[16:17], v[120:121]
    v_pk_add_f32 v[18:19], v[18:19], v[122:123]
    v_pk_add_f32 v[20:21], v[20:21], v[124:125]
    v_pk_add_f32 v[22:23], v[22:23], v[126:127]
    v_pk_add_f32 v[16:17], v[16:17], v[18:19]
    v_pk_add_f32 v[20:21], v[20:21], v[22:23]
    v_pk_add_f32 v[16:17], v[16:17], v[20:21]
    v_add_f32 v16, v16, v17
    ds_write_b32 v253, v16 offset:0
    s_waitcnt lgkmcnt(0)
    s_barrier
    ds_read_b128 v[16:19], v254 offset:0
    ds_read_b128 v[20:23], v254 offset:16
    ds_read_b128 v[24:27], v254 offset:32
    ds_read_b128 v[28:31], v254 offset:48
    s_waitcnt lgkmcnt(2)
    v_pk_add_f32 v[16:17], v[16:17], v[18:19]
    v_pk_add_f32 v[20:21], v[20:21], v[22:23]
    s_waitcnt lgkmcnt(0)
    v_pk_add_f32 v[24:25], v[24:25], v[26:27]
    v_pk_add_f32 v[28:29], v[28:29], v[30:31]
    v_pk_add_f32 v[16:17], v[16:17], v[20:21]
    v_pk_add_f32 v[24:25], v[24:25], v[28:29]
    v_pk_add_f32 v[16:17], v[16:17], v[24:25]
    v_add_f32 v16, v16, v17
    v_mul_f32 v16, 0xba800000, v16
    v_mov_b32 v17, v16
    v_pk_add_f32 v[64:65], v[64:65], v[16:17]
    v_pk_add_f32 v[66:67], v[66:67], v[16:17]
    v_pk_add_f32 v[68:69], v[68:69], v[16:17]
    v_pk_add_f32 v[70:71], v[70:71], v[16:17]
    v_pk_add_f32 v[72:73], v[72:73], v[16:17]
    v_pk_add_f32 v[74:75], v[74:75], v[16:17]
    v_pk_add_f32 v[76:77], v[76:77], v[16:17]
    v_pk_add_f32 v[78:79], v[78:79], v[16:17]
    v_pk_add_f32 v[80:81], v[80:81], v[16:17]
    v_pk_add_f32 v[82:83], v[82:83], v[16:17]
    v_pk_add_f32 v[84:85], v[84:85], v[16:17]
    v_pk_add_f32 v[86:87], v[86:87], v[16:17]
    v_pk_add_f32 v[88:89], v[88:89], v[16:17]
    v_pk_add_f32 v[90:91], v[90:91], v[16:17]
    v_pk_add_f32 v[92:93], v[92:93], v[16:17]
    v_pk_add_f32 v[94:95], v[94:95], v[16:17]
    v_pk_add_f32 v[96:97], v[96:97], v[16:17]
    v_pk_add_f32 v[98:99], v[98:99], v[16:17]
    v_pk_add_f32 v[100:101], v[100:101], v[16:17]
    v_pk_add_f32 v[102:103], v[102:103], v[16:17]
    v_pk_add_f32 v[104:105], v[104:105], v[16:17]
    v_pk_add_f32 v[106:107], v[106:107], v[16:17]
    v_pk_add_f32 v[108:109], v[108:109], v[16:17]
    v_pk_add_f32 v[110:111], v[110:111], v[16:17]
    v_pk_add_f32 v[112:113], v[112:113], v[16:17]
    v_pk_add_f32 v[114:115], v[114:115], v[16:17]
    v_pk_add_f32 v[116:117], v[116:117], v[16:17]
    v_pk_add_f32 v[118:119], v[118:119], v[16:17]
    v_pk_add_f32 v[120:121], v[120:121], v[16:17]
    v_pk_add_f32 v[122:123], v[122:123], v[16:17]
    v_pk_add_f32 v[124:125], v[124:125], v[16:17]
    v_pk_add_f32 v[126:127], v[126:127], v[16:17]
    v_pk_mul_f32 v[16:17], v[64:65], v[64:65]
    v_pk_mul_f32 v[18:19], v[66:67], v[66:67]
    v_pk_mul_f32 v[20:21], v[68:69], v[68:69]
    v_pk_mul_f32 v[22:23], v[70:71], v[70:71]
    v_pk_fma_f32 v[16:17], v[72:73], v[72:73], v[16:17]
    v_pk_fma_f32 v[18:19], v[74:75], v[74:75], v[18:19]
    v_pk_fma_f32 v[20:21], v[76:77], v[76:77], v[20:21]
    v_pk_fma_f32 v[22:23], v[78:79], v[78:79], v[22:23]
    v_pk_fma_f32 v[16:17], v[80:81], v[80:81], v[16:17]
    v_pk_fma_f32 v[18:19], v[82:83], v[82:83], v[18:19]
    v_pk_fma_f32 v[20:21], v[84:85], v[84:85], v[20:21]
    v_pk_fma_f32 v[22:23], v[86:87], v[86:87], v[22:23]
    v_pk_fma_f32 v[16:17], v[88:89], v[88:89], v[16:17]
    v_pk_fma_f32 v[18:19], v[90:91], v[90:91], v[18:19]
    v_pk_fma_f32 v[20:21], v[92:93], v[92:93], v[20:21]
    v_pk_fma_f32 v[22:23], v[94:95], v[94:95], v[22:23]
    v_pk_fma_f32 v[16:17], v[96:97], v[96:97], v[16:17]
    v_pk_fma_f32 v[18:19], v[98:99], v[98:99], v[18:19]
    v_pk_fma_f32 v[20:21], v[100:101], v[100:101], v[20:21]
    v_pk_fma_f32 v[22:23], v[102:103], v[102:103], v[22:23]
    v_pk_fma_f32 v[16:17], v[104:105], v[104:105], v[16:17]
    v_pk_fma_f32 v[18:19], v[106:107], v[106:107], v[18:19]
    v_pk_fma_f32 v[20:21], v[108:109], v[108:109], v[20:21]
    v_pk_fma_f32 v[22:23], v[110:111], v[110:111], v[22:23]
    v_pk_fma_f32 v[16:17], v[112:113], v[112:113], v[16:17]
    v_pk_fma_f32 v[18:19], v[114:115], v[114:115], v[18:19]
    v_pk_fma_f32 v[20:21], v[116:117], v[116:117], v[20:21]
    v_pk_fma_f32 v[22:23], v[118:119], v[118:119], v[22:23]
    v_pk_fma_f32 v[16:17], v[120:121], v[120:121], v[16:17]
    v_pk_fma_f32 v[18:19], v[122:123], v[122:123], v[18:19]
    v_pk_fma_f32 v[20:21], v[124:125], v[124:125], v[20:21]
    v_pk_fma_f32 v[22:23], v[126:127], v[126:127], v[22:23]
    v_pk_add_f32 v[16:17], v[16:17], v[18:19]
    v_pk_add_f32 v[20:21], v[20:21], v[22:23]
    v_pk_add_f32 v[16:17], v[16:17], v[20:21]
    v_add_f32 v16, v16, v17
    ds_write_b32 v253, v16 offset:1024
    s_waitcnt lgkmcnt(0)
    s_barrier
    ds_read_b128 v[16:19], v254 offset:1024
    ds_read_b128 v[20:23], v254 offset:1040
    ds_read_b128 v[24:27], v254 offset:1056
    ds_read_b128 v[28:31], v254 offset:1072
    s_waitcnt lgkmcnt(2)
    v_pk_add_f32 v[16:17], v[16:17], v[18:19]
    v_pk_add_f32 v[20:21], v[20:21], v[22:23]
    s_waitcnt lgkmcnt(0)
    v_pk_add_f32 v[24:25], v[24:25], v[26:27]
    v_pk_add_f32 v[28:29], v[28:29], v[30:31]
    v_pk_add_f32 v[16:17], v[16:17], v[20:21]
    v_pk_add_f32 v[24:25], v[24:25], v[28:29]
    v_pk_add_f32 v[16:17], v[16:17], v[24:25]
    v_add_f32 v16, v16, v17
    v_mov_b32 v17, 0x3727c5ac
    v_fmac_f32 v17, 0x3a800000, v16
    v_rsq_f32 v16, v17
    s_nop 0
    v_mov_b32 v17, v16
    v_pk_mul_f32 v[64:65], v[64:65], v[16:17]
    v_pk_mul_f32 v[66:67], v[66:67], v[16:17]
    v_pk_mul_f32 v[68:69], v[68:69], v[16:17]
    v_pk_mul_f32 v[70:71], v[70:71], v[16:17]
    v_pk_mul_f32 v[72:73], v[72:73], v[16:17]
    v_pk_mul_f32 v[74:75], v[74:75], v[16:17]
    v_pk_mul_f32 v[76:77], v[76:77], v[16:17]
    v_pk_mul_f32 v[78:79], v[78:79], v[16:17]
    v_pk_mul_f32 v[80:81], v[80:81], v[16:17]
    v_pk_mul_f32 v[82:83], v[82:83], v[16:17]
    v_pk_mul_f32 v[84:85], v[84:85], v[16:17]
    v_pk_mul_f32 v[86:87], v[86:87], v[16:17]
    v_pk_mul_f32 v[88:89], v[88:89], v[16:17]
    v_pk_mul_f32 v[90:91], v[90:91], v[16:17]
    v_pk_mul_f32 v[92:93], v[92:93], v[16:17]
    v_pk_mul_f32 v[94:95], v[94:95], v[16:17]
    v_pk_mul_f32 v[96:97], v[96:97], v[16:17]
    v_pk_mul_f32 v[98:99], v[98:99], v[16:17]
    v_pk_mul_f32 v[100:101], v[100:101], v[16:17]
    v_pk_mul_f32 v[102:103], v[102:103], v[16:17]
    v_pk_mul_f32 v[104:105], v[104:105], v[16:17]
    v_pk_mul_f32 v[106:107], v[106:107], v[16:17]
    v_pk_mul_f32 v[108:109], v[108:109], v[16:17]
    v_pk_mul_f32 v[110:111], v[110:111], v[16:17]
    v_pk_mul_f32 v[112:113], v[112:113], v[16:17]
    v_pk_mul_f32 v[114:115], v[114:115], v[16:17]
    v_pk_mul_f32 v[116:117], v[116:117], v[16:17]
    v_pk_mul_f32 v[118:119], v[118:119], v[16:17]
    v_pk_mul_f32 v[120:121], v[120:121], v[16:17]
    v_pk_mul_f32 v[122:123], v[122:123], v[16:17]
    v_pk_mul_f32 v[124:125], v[124:125], v[16:17]
    v_pk_mul_f32 v[126:127], v[126:127], v[16:17]
    v_cvt_pk_bf16_f32 v128, v64, v65
    v_cvt_pk_bf16_f32 v129, v66, v67
    v_cvt_pk_bf16_f32 v130, v68, v69
    v_cvt_pk_bf16_f32 v131, v70, v71
    v_cvt_pk_bf16_f32 v132, v72, v73
    v_cvt_pk_bf16_f32 v133, v74, v75
    v_cvt_pk_bf16_f32 v134, v76, v77
    v_cvt_pk_bf16_f32 v135, v78, v79
    v_cvt_pk_bf16_f32 v136, v80, v81
    v_cvt_pk_bf16_f32 v137, v82, v83
    v_cvt_pk_bf16_f32 v138, v84, v85
    v_cvt_pk_bf16_f32 v139, v86, v87
    v_cvt_pk_bf16_f32 v140, v88, v89
    v_cvt_pk_bf16_f32 v141, v90, v91
    v_cvt_pk_bf16_f32 v142, v92, v93
    v_cvt_pk_bf16_f32 v143, v94, v95
    v_cvt_pk_bf16_f32 v144, v96, v97
    v_cvt_pk_bf16_f32 v145, v98, v99
    v_cvt_pk_bf16_f32 v146, v100, v101
    v_cvt_pk_bf16_f32 v147, v102, v103
    v_cvt_pk_bf16_f32 v148, v104, v105
    v_cvt_pk_bf16_f32 v149, v106, v107
    v_cvt_pk_bf16_f32 v150, v108, v109
    v_cvt_pk_bf16_f32 v151, v110, v111
    v_cvt_pk_bf16_f32 v152, v112, v113
    v_cvt_pk_bf16_f32 v153, v114, v115
    v_cvt_pk_bf16_f32 v154, v116, v117
    v_cvt_pk_bf16_f32 v155, v118, v119
    v_cvt_pk_bf16_f32 v156, v120, v121
    v_cvt_pk_bf16_f32 v157, v122, v123
    v_cvt_pk_bf16_f32 v158, v124, v125
    v_cvt_pk_bf16_f32 v159, v126, v127
    s_add_u32 s32, s34, 0x0
    s_add_u32 s33, s32, 4096
    buffer_store_dwordx4 v[128:131], v251, s[4:7], s32 offen offset:0 sc1
    buffer_store_dwordx4 v[132:135], v251, s[4:7], s32 offen offset:1024 sc1
    buffer_store_dwordx4 v[136:139], v251, s[4:7], s32 offen offset:2048 sc1
    buffer_store_dwordx4 v[140:143], v251, s[4:7], s32 offen offset:3072 sc1
    buffer_store_dwordx4 v[144:147], v251, s[4:7], s33 offen offset:0 sc1
    buffer_store_dwordx4 v[148:151], v251, s[4:7], s33 offen offset:1024 sc1
    buffer_store_dwordx4 v[152:155], v251, s[4:7], s33 offen offset:2048 sc1
    buffer_store_dwordx4 v[156:159], v251, s[4:7], s33 offen offset:3072 sc1
    buffer_load_dword v2, v4, s[60:63], 0 offen offset:12 sc1
    v_lshlrev_b32 v64, 16, v128
    v_and_b32 v65, 0xffff0000, v128
    v_lshlrev_b32 v66, 16, v129
    v_and_b32 v67, 0xffff0000, v129
    v_lshlrev_b32 v68, 16, v130
    v_and_b32 v69, 0xffff0000, v130
    v_lshlrev_b32 v70, 16, v131
    v_and_b32 v71, 0xffff0000, v131
    v_lshlrev_b32 v72, 16, v132
    v_and_b32 v73, 0xffff0000, v132
    v_lshlrev_b32 v74, 16, v133
    v_and_b32 v75, 0xffff0000, v133
    v_lshlrev_b32 v76, 16, v134
    v_and_b32 v77, 0xffff0000, v134
    v_lshlrev_b32 v78, 16, v135
    v_and_b32 v79, 0xffff0000, v135
    v_lshlrev_b32 v80, 16, v136
    v_and_b32 v81, 0xffff0000, v136
    v_lshlrev_b32 v82, 16, v137
    v_and_b32 v83, 0xffff0000, v137
    v_lshlrev_b32 v84, 16, v138
    v_and_b32 v85, 0xffff0000, v138
    v_lshlrev_b32 v86, 16, v139
    v_and_b32 v87, 0xffff0000, v139
    v_lshlrev_b32 v88, 16, v140
    v_and_b32 v89, 0xffff0000, v140
    v_lshlrev_b32 v90, 16, v141
    v_and_b32 v91, 0xffff0000, v141
    v_lshlrev_b32 v92, 16, v142
    v_and_b32 v93, 0xffff0000, v142
    v_lshlrev_b32 v94, 16, v143
    v_and_b32 v95, 0xffff0000, v143
    v_lshlrev_b32 v96, 16, v144
    v_and_b32 v97, 0xffff0000, v144
    v_lshlrev_b32 v98, 16, v145
    v_and_b32 v99, 0xffff0000, v145
    v_lshlrev_b32 v100, 16, v146
    v_and_b32 v101, 0xffff0000, v146
    v_lshlrev_b32 v102, 16, v147
    v_and_b32 v103, 0xffff0000, v147
    v_lshlrev_b32 v104, 16, v148
    v_and_b32 v105, 0xffff0000, v148
    v_lshlrev_b32 v106, 16, v149
    v_and_b32 v107, 0xffff0000, v149
    v_lshlrev_b32 v108, 16, v150
    v_and_b32 v109, 0xffff0000, v150
    v_lshlrev_b32 v110, 16, v151
    v_and_b32 v111, 0xffff0000, v151
    v_lshlrev_b32 v112, 16, v152
    v_and_b32 v113, 0xffff0000, v152
    v_lshlrev_b32 v114, 16, v153
    v_and_b32 v115, 0xffff0000, v153
    v_lshlrev_b32 v116, 16, v154
    v_and_b32 v117, 0xffff0000, v154
    v_lshlrev_b32 v118, 16, v155
    v_and_b32 v119, 0xffff0000, v155
    v_lshlrev_b32 v120, 16, v156
    v_and_b32 v121, 0xffff0000, v156
    v_lshlrev_b32 v122, 16, v157
    v_and_b32 v123, 0xffff0000, v157
    v_lshlrev_b32 v124, 16, v158
    v_and_b32 v125, 0xffff0000, v158
    v_lshlrev_b32 v126, 16, v159
    v_and_b32 v127, 0xffff0000, v159
    v_pk_add_f32 v[16:17], v[64:65], v[72:73]
    v_pk_add_f32 v[18:19], v[66:67], v[74:75]
    v_pk_add_f32 v[20:21], v[68:69], v[76:77]
    v_pk_add_f32 v[22:23], v[70:71], v[78:79]
    v_pk_add_f32 v[16:17], v[16:17], v[80:81]
    v_pk_add_f32 v[18:19], v[18:19], v[82:83]
    v_pk_add_f32 v[20:21], v[20:21], v[84:85]
    v_pk_add_f32 v[22:23], v[22:23], v[86:87]
    v_pk_add_f32 v[16:17], v[16:17], v[88:89]
    v_pk_add_f32 v[18:19], v[18:19], v[90:91]
    v_pk_add_f32 v[20:21], v[20:21], v[92:93]
    v_pk_add_f32 v[22:23], v[22:23], v[94:95]
    v_pk_add_f32 v[16:17], v[16:17], v[96:97]
    v_pk_add_f32 v[18:19], v[18:19], v[98:99]
    v_pk_add_f32 v[20:21], v[20:21], v[100:101]
    v_pk_add_f32 v[22:23], v[22:23], v[102:103]
    v_pk_add_f32 v[16:17], v[16:17], v[104:105]
    v_pk_add_f32 v[18:19], v[18:19], v[106:107]
    v_pk_add_f32 v[20:21], v[20:21], v[108:109]
    v_pk_add_f32 v[22:23], v[22:23], v[110:111]
    v_pk_add_f32 v[16:17], v[16:17], v[112:113]
    v_pk_add_f32 v[18:19], v[18:19], v[114:115]
    v_pk_add_f32 v[20:21], v[20:21], v[116:117]
    v_pk_add_f32 v[22:23], v[22:23], v[118:119]
    v_pk_add_f32 v[16:17], v[16:17], v[120:121]
    v_pk_add_f32 v[18:19], v[18:19], v[122:123]
    v_pk_add_f32 v[20:21], v[20:21], v[124:125]
    v_pk_add_f32 v[22:23], v[22:23], v[126:127]
    v_pk_add_f32 v[16:17], v[16:17], v[18:19]
    v_pk_add_f32 v[20:21], v[20:21], v[22:23]
    v_pk_add_f32 v[16:17], v[16:17], v[20:21]
    v_add_f32 v16, v16, v17
    ds_write_b32 v253, v16 offset:0
    s_waitcnt lgkmcnt(0)
    s_barrier
    ds_read_b128 v[16:19], v254 offset:0
    ds_read_b128 v[20:23], v254 offset:16
    ds_read_b128 v[24:27], v254 offset:32
    ds_read_b128 v[28:31], v254 offset:48
    s_waitcnt lgkmcnt(2)
    v_pk_add_f32 v[16:17], v[16:17], v[18:19]
    v_pk_add_f32 v[20:21], v[20:21], v[22:23]
    s_waitcnt lgkmcnt(0)
    v_pk_add_f32 v[24:25], v[24:25], v[26:27]
    v_pk_add_f32 v[28:29], v[28:29], v[30:31]
    v_pk_add_f32 v[16:17], v[16:17], v[20:21]
    v_pk_add_f32 v[24:25], v[24:25], v[28:29]
    v_pk_add_f32 v[16:17], v[16:17], v[24:25]
    v_add_f32 v16, v16, v17
    v_mul_f32 v16, 0xba800000, v16
    v_mov_b32 v17, v16
    v_pk_add_f32 v[64:65], v[64:65], v[16:17]
    v_pk_add_f32 v[66:67], v[66:67], v[16:17]
    v_pk_add_f32 v[68:69], v[68:69], v[16:17]
    v_pk_add_f32 v[70:71], v[70:71], v[16:17]
    v_pk_add_f32 v[72:73], v[72:73], v[16:17]
    v_pk_add_f32 v[74:75], v[74:75], v[16:17]
    v_pk_add_f32 v[76:77], v[76:77], v[16:17]
    v_pk_add_f32 v[78:79], v[78:79], v[16:17]
    v_pk_add_f32 v[80:81], v[80:81], v[16:17]
    v_pk_add_f32 v[82:83], v[82:83], v[16:17]
    v_pk_add_f32 v[84:85], v[84:85], v[16:17]
    v_pk_add_f32 v[86:87], v[86:87], v[16:17]
    v_pk_add_f32 v[88:89], v[88:89], v[16:17]
    v_pk_add_f32 v[90:91], v[90:91], v[16:17]
    v_pk_add_f32 v[92:93], v[92:93], v[16:17]
    v_pk_add_f32 v[94:95], v[94:95], v[16:17]
    v_pk_add_f32 v[96:97], v[96:97], v[16:17]
    v_pk_add_f32 v[98:99], v[98:99], v[16:17]
    v_pk_add_f32 v[100:101], v[100:101], v[16:17]
    v_pk_add_f32 v[102:103], v[102:103], v[16:17]
    v_pk_add_f32 v[104:105], v[104:105], v[16:17]
    v_pk_add_f32 v[106:107], v[106:107], v[16:17]
    v_pk_add_f32 v[108:109], v[108:109], v[16:17]
    v_pk_add_f32 v[110:111], v[110:111], v[16:17]
    v_pk_add_f32 v[112:113], v[112:113], v[16:17]
    v_pk_add_f32 v[114:115], v[114:115], v[16:17]
    v_pk_add_f32 v[116:117], v[116:117], v[16:17]
    v_pk_add_f32 v[118:119], v[118:119], v[16:17]
    v_pk_add_f32 v[120:121], v[120:121], v[16:17]
    v_pk_add_f32 v[122:123], v[122:123], v[16:17]
    v_pk_add_f32 v[124:125], v[124:125], v[16:17]
    v_pk_add_f32 v[126:127], v[126:127], v[16:17]
    v_pk_mul_f32 v[16:17], v[64:65], v[64:65]
    v_pk_mul_f32 v[18:19], v[66:67], v[66:67]
    v_pk_mul_f32 v[20:21], v[68:69], v[68:69]
    v_pk_mul_f32 v[22:23], v[70:71], v[70:71]
    v_pk_fma_f32 v[16:17], v[72:73], v[72:73], v[16:17]
    v_pk_fma_f32 v[18:19], v[74:75], v[74:75], v[18:19]
    v_pk_fma_f32 v[20:21], v[76:77], v[76:77], v[20:21]
    v_pk_fma_f32 v[22:23], v[78:79], v[78:79], v[22:23]
    v_pk_fma_f32 v[16:17], v[80:81], v[80:81], v[16:17]
    v_pk_fma_f32 v[18:19], v[82:83], v[82:83], v[18:19]
    v_pk_fma_f32 v[20:21], v[84:85], v[84:85], v[20:21]
    v_pk_fma_f32 v[22:23], v[86:87], v[86:87], v[22:23]
    v_pk_fma_f32 v[16:17], v[88:89], v[88:89], v[16:17]
    v_pk_fma_f32 v[18:19], v[90:91], v[90:91], v[18:19]
    v_pk_fma_f32 v[20:21], v[92:93], v[92:93], v[20:21]
    v_pk_fma_f32 v[22:23], v[94:95], v[94:95], v[22:23]
    v_pk_fma_f32 v[16:17], v[96:97], v[96:97], v[16:17]
    v_pk_fma_f32 v[18:19], v[98:99], v[98:99], v[18:19]
    v_pk_fma_f32 v[20:21], v[100:101], v[100:101], v[20:21]
    v_pk_fma_f32 v[22:23], v[102:103], v[102:103], v[22:23]
    v_pk_fma_f32 v[16:17], v[104:105], v[104:105], v[16:17]
    v_pk_fma_f32 v[18:19], v[106:107], v[106:107], v[18:19]
    v_pk_fma_f32 v[20:21], v[108:109], v[108:109], v[20:21]
    v_pk_fma_f32 v[22:23], v[110:111], v[110:111], v[22:23]
    v_pk_fma_f32 v[16:17], v[112:113], v[112:113], v[16:17]
    v_pk_fma_f32 v[18:19], v[114:115], v[114:115], v[18:19]
    v_pk_fma_f32 v[20:21], v[116:117], v[116:117], v[20:21]
    v_pk_fma_f32 v[22:23], v[118:119], v[118:119], v[22:23]
    v_pk_fma_f32 v[16:17], v[120:121], v[120:121], v[16:17]
    v_pk_fma_f32 v[18:19], v[122:123], v[122:123], v[18:19]
    v_pk_fma_f32 v[20:21], v[124:125], v[124:125], v[20:21]
    v_pk_fma_f32 v[22:23], v[126:127], v[126:127], v[22:23]
    v_pk_add_f32 v[16:17], v[16:17], v[18:19]
    v_pk_add_f32 v[20:21], v[20:21], v[22:23]
    v_pk_add_f32 v[16:17], v[16:17], v[20:21]
    v_add_f32 v16, v16, v17
    ds_write_b32 v253, v16 offset:1024
    s_waitcnt lgkmcnt(0)
    s_waitcnt vmcnt(0)
    s_barrier
    s_cmp_lg_u32 s14, 0
    s_cbranch_scc1 main_kernel_s_nf
    v_cmp_gt_u32 vcc, 4, v2
    s_cbranch_vccz main_kernel_s_wa1_ok
    v_mov_b32 v2, 0
main_kernel_s_wa1:
    buffer_load_dword v3, v2, s[60:63], 0 offen offset:12 sc1
    s_waitcnt vmcnt(0)
    v_cmp_gt_u32 vcc, 4, v3
    s_cbranch_vccz main_kernel_s_wa1_ok
    s_sleep 4
    s_sub_u32 s29, s29, 1
    s_cbranch_scc0 main_kernel_s_wa1
    s_branch main_kernel_end
main_kernel_s_wa1_ok:
    s_mov_b64 exec, 1
    buffer_store_dword v8, v4, s[4:7], s16 offen sc1
    s_mov_b64 exec, -1
main_kernel_s_nf:
    ds_read_b128 v[16:19], v254 offset:1024
    ds_read_b128 v[20:23], v254 offset:1040
    ds_read_b128 v[24:27], v254 offset:1056
    ds_read_b128 v[28:31], v254 offset:1072
    s_waitcnt lgkmcnt(2)
    v_pk_add_f32 v[16:17], v[16:17], v[18:19]
    v_pk_add_f32 v[20:21], v[20:21], v[22:23]
    s_waitcnt lgkmcnt(0)
    v_pk_add_f32 v[24:25], v[24:25], v[26:27]
    v_pk_add_f32 v[28:29], v[28:29], v[30:31]
    v_pk_add_f32 v[16:17], v[16:17], v[20:21]
    v_pk_add_f32 v[24:25], v[24:25], v[28:29]
    v_pk_add_f32 v[16:17], v[16:17], v[24:25]
    v_add_f32 v16, v16, v17
    v_mov_b32 v17, 0x3727c5ac
    v_fmac_f32 v17, 0x3a800000, v16
    v_rsq_f32 v16, v17
    s_nop 0
    v_mov_b32 v17, v16
    v_pk_mul_f32 v[64:65], v[64:65], v[16:17]
    v_pk_mul_f32 v[66:67], v[66:67], v[16:17]
    v_pk_mul_f32 v[68:69], v[68:69], v[16:17]
    v_pk_mul_f32 v[70:71], v[70:71], v[16:17]
    v_pk_mul_f32 v[72:73], v[72:73], v[16:17]
    v_pk_mul_f32 v[74:75], v[74:75], v[16:17]
    v_pk_mul_f32 v[76:77], v[76:77], v[16:17]
    v_pk_mul_f32 v[78:79], v[78:79], v[16:17]
    v_pk_mul_f32 v[80:81], v[80:81], v[16:17]
    v_pk_mul_f32 v[82:83], v[82:83], v[16:17]
    v_pk_mul_f32 v[84:85], v[84:85], v[16:17]
    v_pk_mul_f32 v[86:87], v[86:87], v[16:17]
    v_pk_mul_f32 v[88:89], v[88:89], v[16:17]
    v_pk_mul_f32 v[90:91], v[90:91], v[16:17]
    v_pk_mul_f32 v[92:93], v[92:93], v[16:17]
    v_pk_mul_f32 v[94:95], v[94:95], v[16:17]
    v_pk_mul_f32 v[96:97], v[96:97], v[16:17]
    v_pk_mul_f32 v[98:99], v[98:99], v[16:17]
    v_pk_mul_f32 v[100:101], v[100:101], v[16:17]
    v_pk_mul_f32 v[102:103], v[102:103], v[16:17]
    v_pk_mul_f32 v[104:105], v[104:105], v[16:17]
    v_pk_mul_f32 v[106:107], v[106:107], v[16:17]
    v_pk_mul_f32 v[108:109], v[108:109], v[16:17]
    v_pk_mul_f32 v[110:111], v[110:111], v[16:17]
    v_pk_mul_f32 v[112:113], v[112:113], v[16:17]
    v_pk_mul_f32 v[114:115], v[114:115], v[16:17]
    v_pk_mul_f32 v[116:117], v[116:117], v[16:17]
    v_pk_mul_f32 v[118:119], v[118:119], v[16:17]
    v_pk_mul_f32 v[120:121], v[120:121], v[16:17]
    v_pk_mul_f32 v[122:123], v[122:123], v[16:17]
    v_pk_mul_f32 v[124:125], v[124:125], v[16:17]
    v_pk_mul_f32 v[126:127], v[126:127], v[16:17]
    v_cvt_pk_bf16_f32 v32, v64, v65
    v_cvt_pk_bf16_f32 v33, v66, v67
    v_cvt_pk_bf16_f32 v34, v68, v69
    v_cvt_pk_bf16_f32 v35, v70, v71
    v_cvt_pk_bf16_f32 v36, v72, v73
    v_cvt_pk_bf16_f32 v37, v74, v75
    v_cvt_pk_bf16_f32 v38, v76, v77
    v_cvt_pk_bf16_f32 v39, v78, v79
    v_cvt_pk_bf16_f32 v40, v80, v81
    v_cvt_pk_bf16_f32 v41, v82, v83
    v_cvt_pk_bf16_f32 v42, v84, v85
    v_cvt_pk_bf16_f32 v43, v86, v87
    v_cvt_pk_bf16_f32 v44, v88, v89
    v_cvt_pk_bf16_f32 v45, v90, v91
    v_cvt_pk_bf16_f32 v46, v92, v93
    v_cvt_pk_bf16_f32 v47, v94, v95
    v_cvt_pk_bf16_f32 v48, v96, v97
    v_cvt_pk_bf16_f32 v49, v98, v99
    v_cvt_pk_bf16_f32 v50, v100, v101
    v_cvt_pk_bf16_f32 v51, v102, v103
    v_cvt_pk_bf16_f32 v52, v104, v105
    v_cvt_pk_bf16_f32 v53, v106, v107
    v_cvt_pk_bf16_f32 v54, v108, v109
    v_cvt_pk_bf16_f32 v55, v110, v111
    v_cvt_pk_bf16_f32 v56, v112, v113
    v_cvt_pk_bf16_f32 v57, v114, v115
    v_cvt_pk_bf16_f32 v58, v116, v117
    v_cvt_pk_bf16_f32 v59, v118, v119
    v_cvt_pk_bf16_f32 v60, v120, v121
    v_cvt_pk_bf16_f32 v61, v122, v123
    v_cvt_pk_bf16_f32 v62, v124, v125
    v_cvt_pk_bf16_f32 v63, v126, v127
    s_add_u32 s32, s34, 0x400000
    s_add_u32 s33, s32, 4096
    buffer_store_dwordx4 v[32:35], v251, s[4:7], s32 offen offset:0 sc1
    buffer_store_dwordx4 v[36:39], v251, s[4:7], s32 offen offset:1024 sc1
    buffer_store_dwordx4 v[40:43], v251, s[4:7], s32 offen offset:2048 sc1
    buffer_store_dwordx4 v[44:47], v251, s[4:7], s32 offen offset:3072 sc1
    buffer_store_dwordx4 v[48:51], v251, s[4:7], s33 offen offset:0 sc1
    buffer_store_dwordx4 v[52:55], v251, s[4:7], s33 offen offset:1024 sc1
    buffer_store_dwordx4 v[56:59], v251, s[4:7], s33 offen offset:2048 sc1
    buffer_store_dwordx4 v[60:63], v251, s[4:7], s33 offen offset:3072 sc1
    s_add_u32 s16, s16, 4
    s_branch main_kernel_s_wa2_ok
main_kernel_s_fill:
    s_lshl_b32 s32, s16, 14
    s_add_u32 s34, s32, 0x6c00000
    buffer_store_dwordx4 v[8:11], v1, s[4:7], s34 offen sc1
    s_add_u32 s34, s32, 0x6c01000
    buffer_store_dwordx4 v[8:11], v1, s[4:7], s34 offen sc1
    s_add_u32 s34, s32, 0x6c02000
    buffer_store_dwordx4 v[8:11], v1, s[4:7], s34 offen sc1
    s_add_u32 s34, s32, 0x6c03000
    buffer_store_dwordx4 v[8:11], v1, s[4:7], s34 offen sc1
    s_lshl_b32 s32, s16, 14
    s_add_u32 s34, s32, 0x8c00000
    buffer_store_dwordx4 v[8:11], v1, s[4:7], s34 offen sc1
    s_add_u32 s34, s32, 0x8c01000
    buffer_store_dwordx4 v[8:11], v1, s[4:7], s34 offen sc1
    s_add_u32 s34, s32, 0x8c02000
    buffer_store_dwordx4 v[8:11], v1, s[4:7], s34 offen sc1
    s_add_u32 s34, s32, 0x8c03000
    buffer_store_dwordx4 v[8:11], v1, s[4:7], s34 offen sc1
    s_add_u32 s34, s32, 0x8d00000
    buffer_store_dwordx4 v[8:11], v1, s[4:7], s34 offen sc1
    s_add_u32 s34, s32, 0x8d01000
    buffer_store_dwordx4 v[8:11], v1, s[4:7], s34 offen sc1
    s_add_u32 s34, s32, 0x8d02000
    buffer_store_dwordx4 v[8:11], v1, s[4:7], s34 offen sc1
    s_add_u32 s34, s32, 0x8d03000
    buffer_store_dwordx4 v[8:11], v1, s[4:7], s34 offen sc1
    s_lshl_b32 s32, s16, 2
    s_lshl_b32 s32, s16, 12
    s_add_u32 s33, s32, 0x8c00000
    s_add_u32 s34, s32, 0x6e00000
    buffer_store_dwordx4 v[8:11], v1, s[4:7], s34 offen sc1
    s_add_u32 s32, s32, 0x8000000
    buffer_store_dwordx4 v[8:11], v1, s[4:7], s32 offen sc1
    s_lshl_b32 s16, s16, 2
    s_add_u32 s16, s16, 0x841f000
    s_cmp_lg_u32 s16, 0x841f034
    s_cbranch_scc1 main_kernel_s_fd
    s_mov_b32 s8, s76
    s_and_b32 s9, s77, 0xffff
    s_mov_b32 s10, 0x4000
    s_mov_b32 s11, 0x20000
    v_and_b32 v2, 7, v0
    v_lshlrev_b32 v2, 11, v2
    v_lshrrev_b32 v3, 6, v0
    v_lshl_add_u32 v2, v3, 7, v2
    v_bfe_u32 v3, v0, 4, 2
    v_lshl_add_u32 v2, v3, 5, v2
    v_bfe_u32 v3, v0, 3, 1
    v_lshl_add_u32 v2, v3, 4, v2
    buffer_load_dwordx4 v[16:19], v2, s[8:11], 0 offen offset:0
    buffer_load_dwordx4 v[20:23], v2, s[8:11], 0 offen offset:512
    buffer_load_dwordx4 v[24:27], v2, s[8:11], 0 offen offset:1024
    buffer_load_dwordx4 v[28:31], v2, s[8:11], 0 offen offset:1536
    s_mov_b32 s32, 0x6d00000
    s_waitcnt vmcnt(0)
    buffer_store_dwordx4 v[16:19], v1, s[4:7], s32 offen sc1
    s_add_u32 s32, s32, 4096
    buffer_store_dwordx4 v[20:23], v1, s[4:7], s32 offen sc1
    s_add_u32 s32, s32, 4096
    buffer_store_dwordx4 v[24:27], v1, s[4:7], s32 offen sc1
    s_add_u32 s32, s32, 4096
    buffer_store_dwordx4 v[28:31], v1, s[4:7], s32 offen sc1
    s_add_u32 s32, s32, 4096
    buffer_store_dwordx4 v[8:11], v1, s[4:7], s32 offen sc1
    s_add_u32 s32, s32, 4096
    buffer_store_dwordx4 v[8:11], v1, s[4:7], s32 offen sc1
    s_add_u32 s32, s32, 4096
    buffer_store_dwordx4 v[8:11], v1, s[4:7], s32 offen sc1
    s_add_u32 s32, s32, 4096
    buffer_store_dwordx4 v[8:11], v1, s[4:7], s32 offen sc1
    s_add_u32 s32, s32, 4096
    v_xor_b32 v2, 0, v1
    v_mov_b32 v2, 0
main_kernel_s_wa3:
    buffer_load_dword v3, v2, s[60:63], 0 offen offset:12 sc1
    s_waitcnt vmcnt(0)
    v_cmp_gt_u32 vcc, 4, v3
    s_cbranch_vccz main_kernel_s_wa3_ok
    s_sleep 4
    s_sub_u32 s29, s29, 1
    s_cbranch_scc0 main_kernel_s_wa3
    s_branch main_kernel_end
main_kernel_s_wa3_ok:
    v_lshlrev_b32 v2, 8, v250
    s_mov_b32 s32, 0x8418100
    s_mov_b64 exec, 15
    buffer_store_dwordx4 v[8:11], v2, s[4:7], s32 offen sc1
    s_mov_b64 exec, -1
main_kernel_s_fd:
    s_cmp_lg_u32 s14, 0
    s_cbranch_scc1 main_kernel_s_wa2_ok
    v_mov_b32 v2, 0
main_kernel_s_wa2:
    buffer_load_dword v3, v2, s[60:63], 0 offen offset:12 sc1
    s_waitcnt vmcnt(0)
    v_cmp_gt_u32 vcc, 4, v3
    s_cbranch_vccz main_kernel_s_wa2_ok
    s_sleep 4
    s_sub_u32 s29, s29, 1
    s_cbranch_scc0 main_kernel_s_wa2
    s_branch main_kernel_end
main_kernel_s_wa2_ok:
    s_waitcnt vmcnt(0)
    s_barrier
    s_cmp_lg_u32 s14, 0
    s_cbranch_scc1 main_kernel_s_end
    s_mov_b64 exec, 1
    buffer_store_dword v8, v4, s[4:7], s16 offen sc1
    s_mov_b64 exec, -1
main_kernel_s_end:
    s_lshl_b32 s32, s12, 5
    s_add_u32 s32, s32, s13
    s_sub_u32 s32, s32, 96
    s_cmp_lt_u32 s32, 16
    s_cbranch_scc1 main_kernel_att
    s_branch main_kernel_worker
main_kernel_end:
    s_endpgm
main_kernel_chain:
    s_lshl_b32 s36, s14, 15
    s_add_u32 s36, s36, 32768
    v_lshlrev_b32 v116, 4, v94
    v_add_u32 v113, s36, v116
    v_lshrrev_b32 v126, 4, v94
    v_and_b32 v127, 15, v94
    v_lshlrev_b32 v95, 2, v126
    v_xor_b32 v127, v127, v95
    v_lshlrev_b32 v127, 4, v127
    v_and_b32 v95, 1, v126
    v_lshrrev_b32 v126, 1, v126
    v_lshl_add_u32 v127, v126, 15, v127
    v_lshl_add_u32 v65, v95, 13, v127
    v_lshl_add_u32 v66, v95, 11, v127
    s_lshr_b32 s32, s14, 1
    s_lshl_b32 s32, s32, 5
    v_xor_b32 v64, s32, v65
    v_bfe_u32 v127, v94, 2, 1
    v_bfe_u32 v95, v94, 4, 1
    v_lshl_add_u32 v78, v95, 1, v127
    v_lshl_add_u32 v126, v126, 3, v78
    v_and_b32 v127, 3, v94
    v_lshlrev_b32 v127, 3, v127
    v_lshl_add_u32 v71, v126, 8, v127
    v_bfe_u32 v95, v94, 3, 1
    v_lshl_add_u32 v71, v95, 5, v71
    v_xor_b32 v126, s14, v78
    v_lshl_add_u32 v126, v126, 6, v71
    v_add_u32 v69, 32768, v126
    v_add_u32 v70, 0x10000, v69
    v_lshl_add_u32 v126, v78, 6, v71
    v_add_u32 v80, s36, v126
    s_lshl_b32 s32, s14, 5
    s_add_u32 s32, s32, 32768
    v_xor_b32 v126, s32, v126
    v_lshl_add_u32 v67, v95, 16, v126
    v_xor_b32 v68, 0x80, v67
    v_xor_b32 v81, 64, v80
    v_xor_b32 v82, 128, v80
    v_xor_b32 v83, 192, v80
    v_and_b32 v126, 7, v94
    v_lshl_add_u32 v126, s13, 3, v126
    v_lshlrev_b32 v77, 10, v126
    s_lshl_b32 s32, s12, 22
    s_lshl_b32 s33, s13, 8
    s_add_u32 s32, s32, s33
    s_lshl_b32 s33, s14, 18
    s_add_u32 s35, s32, s33
    s_bitset0_b32 s33, 19
    s_add_u32 s34, s32, s33
    s_lshl_b32 s3, s13, 18
    s_lshl2_add_u32 s32, s12, s14
    s_lshl_b32 s32, s32, 8
    s_add_u32 s3, s3, s32
    s_cmp_lt_u32 s14, 2
    s_cbranch_scc1 main_kernel_c_pq
    s_mov_b64 s[40:41], s[42:43]
main_kernel_c_pq:
    v_min_u32 v73, 8, v94
    v_lshlrev_b32 v73, 5, v73
    v_mov_b32 v126, 12
    v_cmp_gt_u32 vcc, 8, v94
    v_lshlrev_b32 v74, 2, v94
    v_add_u32 v74, 0x841f000, v74
    v_cndmask_b32 v73, v126, v73, vcc
    v_and_b32 v75, 1, v94
    s_lshl_b32 s32, s13, 8
    s_add_u32 s32, s32, 0x8406000
    v_lshl_add_u32 v75, v75, 13, s32
    s_mov_b32 s8, s44
    s_and_b32 s9, s45, 0xffff
    s_mov_b32 s10, 0x800000
    s_mov_b32 s11, 0x20000
    s_sub_u32 s39, 511, s44
    s_and_b32 s39, s39, 0x380
    s_andn2_b32 s32, s35, 0x1fff
    s_add_u32 s39, s39, s32
    s_add_u32 s32, s39, 0x0
    buffer_load_dword v86, v77, s[8:11], s32 offen
    s_add_u32 s32, s35, 0x0
    s_add_u32 m0, s36, 0
    s_nop 0
    buffer_load_dwordx4 v65, s[8:11], s32 offen lds
    s_add_u32 s32, s35, 0x4000
    s_add_u32 m0, s36, 1024
    s_nop 0
    buffer_load_dwordx4 v65, s[8:11], s32 offen lds
    s_add_u32 s32, s35, 0x10000
    s_add_u32 m0, s36, 2048
    s_nop 0
    buffer_load_dwordx4 v65, s[8:11], s32 offen lds
    s_add_u32 s32, s35, 0x14000
    s_add_u32 m0, s36, 3072
    s_nop 0
    buffer_load_dwordx4 v65, s[8:11], s32 offen lds
    s_add_u32 s32, s35, 0x20000
    s_add_u32 m0, s36, 4096
    s_nop 0
    buffer_load_dwordx4 v65, s[8:11], s32 offen lds
    s_add_u32 s32, s35, 0x24000
    s_add_u32 m0, s36, 5120
    s_nop 0
    buffer_load_dwordx4 v65, s[8:11], s32 offen lds
    s_add_u32 s32, s35, 0x30000
    s_add_u32 m0, s36, 6144
    s_nop 0
    buffer_load_dwordx4 v65, s[8:11], s32 offen lds
    s_add_u32 s32, s35, 0x34000
    s_add_u32 m0, s36, 7168
    s_nop 0
    buffer_load_dwordx4 v65, s[8:11], s32 offen lds
    s_add_u32 s32, s39, 0x100000
    buffer_load_dword v86, v77, s[8:11], s32 offen
    s_add_u32 s32, s35, 0x100000
    s_add_u32 m0, s36, 8192
    s_nop 0
    buffer_load_dwordx4 v65, s[8:11], s32 offen lds
    s_add_u32 s32, s35, 0x104000
    s_add_u32 m0, s36, 9216
    s_nop 0
    buffer_load_dwordx4 v65, s[8:11], s32 offen lds
    s_add_u32 s32, s35, 0x110000
    s_add_u32 m0, s36, 10240
    s_nop 0
    buffer_load_dwordx4 v65, s[8:11], s32 offen lds
    s_add_u32 s32, s35, 0x114000
    s_add_u32 m0, s36, 11264
    s_nop 0
    buffer_load_dwordx4 v65, s[8:11], s32 offen lds
    s_add_u32 s32, s35, 0x120000
    s_add_u32 m0, s36, 12288
    s_nop 0
    buffer_load_dwordx4 v65, s[8:11], s32 offen lds
    s_add_u32 s32, s35, 0x124000
    s_add_u32 m0, s36, 13312
    s_nop 0
    buffer_load_dwordx4 v65, s[8:11], s32 offen lds
    s_add_u32 s32, s35, 0x130000
    s_add_u32 m0, s36, 14336
    s_nop 0
    buffer_load_dwordx4 v65, s[8:11], s32 offen lds
    s_add_u32 s32, s35, 0x134000
    s_add_u32 m0, s36, 15360
    s_nop 0
    buffer_load_dwordx4 v65, s[8:11], s32 offen lds
    s_mov_b32 s8, s40
    s_and_b32 s9, s41, 0xffff
    s_mov_b32 s10, 0x800000
    s_mov_b32 s11, 0x20000
    s_sub_u32 s39, 511, s40
    s_and_b32 s39, s39, 0x380
    s_andn2_b32 s32, s34, 0x1fff
    s_add_u32 s39, s39, s32
    s_add_u32 s32, s39, 0x0
    buffer_load_dword v86, v77, s[8:11], s32 offen
    s_add_u32 s32, s34, 0x0
    s_add_u32 m0, s36, 16384
    s_nop 0
    buffer_load_dwordx4 v64, s[8:11], s32 offen lds
    s_add_u32 s32, s34, 0x4000
    s_add_u32 m0, s36, 17408
    s_nop 0
    buffer_load_dwordx4 v64, s[8:11], s32 offen lds
    s_add_u32 s32, s34, 0x10000
    s_add_u32 m0, s36, 18432
    s_nop 0
    buffer_load_dwordx4 v64, s[8:11], s32 offen lds
    s_add_u32 s32, s34, 0x14000
    s_add_u32 m0, s36, 19456
    s_nop 0
    buffer_load_dwordx4 v64, s[8:11], s32 offen lds
    s_add_u32 s32, s34, 0x20000
    s_add_u32 m0, s36, 20480
    s_nop 0
    buffer_load_dwordx4 v64, s[8:11], s32 offen lds
    s_add_u32 s32, s34, 0x24000
    s_add_u32 m0, s36, 21504
    s_nop 0
    buffer_load_dwordx4 v64, s[8:11], s32 offen lds
    s_add_u32 s32, s34, 0x30000
    s_add_u32 m0, s36, 22528
    s_nop 0
    buffer_load_dwordx4 v64, s[8:11], s32 offen lds
    s_add_u32 s32, s34, 0x34000
    s_add_u32 m0, s36, 23552
    s_nop 0
    buffer_load_dwordx4 v64, s[8:11], s32 offen lds
    s_add_u32 s32, s39, 0x80000
    buffer_load_dword v86, v77, s[8:11], s32 offen
    s_add_u32 s32, s34, 0x80000
    s_add_u32 m0, s36, 24576
    s_nop 0
    buffer_load_dwordx4 v64, s[8:11], s32 offen lds
    s_add_u32 s32, s34, 0x84000
    s_add_u32 m0, s36, 25600
    s_nop 0
    buffer_load_dwordx4 v64, s[8:11], s32 offen lds
    s_add_u32 s32, s34, 0x90000
    s_add_u32 m0, s36, 26624
    s_nop 0
    buffer_load_dwordx4 v64, s[8:11], s32 offen lds
    s_add_u32 s32, s34, 0x94000
    s_add_u32 m0, s36, 27648
    s_nop 0
    buffer_load_dwordx4 v64, s[8:11], s32 offen lds
    s_add_u32 s32, s34, 0xa0000
    s_add_u32 m0, s36, 28672
    s_nop 0
    buffer_load_dwordx4 v64, s[8:11], s32 offen lds
    s_add_u32 s32, s34, 0xa4000
    s_add_u32 m0, s36, 29696
    s_nop 0
    buffer_load_dwordx4 v64, s[8:11], s32 offen lds
    s_add_u32 s32, s34, 0xb0000
    s_add_u32 m0, s36, 30720
    s_nop 0
    buffer_load_dwordx4 v64, s[8:11], s32 offen lds
    s_add_u32 s32, s34, 0xb4000
    s_add_u32 m0, s36, 31744
    s_nop 0
    buffer_load_dwordx4 v64, s[8:11], s32 offen lds
    s_waitcnt vmcnt(27)
    s_barrier
    ds_read_b64_tr_b16 v[128:129], v69 offset:0
    ds_read_b64_tr_b16 v[130:131], v69 offset:1024
    ds_read_b64_tr_b16 v[132:133], v69 offset:4096
    ds_read_b64_tr_b16 v[134:135], v69 offset:5120
    ds_read_b64_tr_b16 v[136:137], v69 offset:32768
    ds_read_b64_tr_b16 v[138:139], v69 offset:33792
    ds_read_b64_tr_b16 v[140:141], v69 offset:36864
    ds_read_b64_tr_b16 v[142:143], v69 offset:37888
    ds_read_b64_tr_b16 v[144:145], v70 offset:0
    ds_read_b64_tr_b16 v[146:147], v70 offset:1024
    ds_read_b64_tr_b16 v[148:149], v70 offset:4096
    ds_read_b64_tr_b16 v[150:151], v70 offset:5120
    ds_read_b64_tr_b16 v[152:153], v70 offset:32768
    ds_read_b64_tr_b16 v[154:155], v70 offset:33792
    ds_read_b64_tr_b16 v[156:157], v70 offset:36864
    ds_read_b64_tr_b16 v[158:159], v70 offset:37888
    s_waitcnt lgkmcnt(0)
    s_waitcnt vmcnt(18)
    s_barrier
    s_add_u32 s32, s39, 0x100000
    buffer_load_dword v86, v77, s[8:11], s32 offen
    s_add_u32 s32, s34, 0x100000
    s_add_u32 m0, s36, 0
    s_nop 0
    buffer_load_dwordx4 v64, s[8:11], s32 offen lds
    s_add_u32 s32, s34, 0x104000
    s_add_u32 m0, s36, 1024
    s_nop 0
    buffer_load_dwordx4 v64, s[8:11], s32 offen lds
    s_add_u32 s32, s34, 0x110000
    s_add_u32 m0, s36, 2048
    s_nop 0
    buffer_load_dwordx4 v64, s[8:11], s32 offen lds
    s_add_u32 s32, s34, 0x114000
    s_add_u32 m0, s36, 3072
    s_nop 0
    buffer_load_dwordx4 v64, s[8:11], s32 offen lds
    s_add_u32 s32, s34, 0x120000
    s_add_u32 m0, s36, 4096
    s_nop 0
    buffer_load_dwordx4 v64, s[8:11], s32 offen lds
    s_add_u32 s32, s34, 0x124000
    s_add_u32 m0, s36, 5120
    s_nop 0
    buffer_load_dwordx4 v64, s[8:11], s32 offen lds
    s_add_u32 s32, s34, 0x130000
    s_add_u32 m0, s36, 6144
    s_nop 0
    buffer_load_dwordx4 v64, s[8:11], s32 offen lds
    s_add_u32 s32, s34, 0x134000
    s_add_u32 m0, s36, 7168
    s_nop 0
    buffer_load_dwordx4 v64, s[8:11], s32 offen lds
    ds_read_b64_tr_b16 v[160:161], v69 offset:8192
    ds_read_b64_tr_b16 v[162:163], v69 offset:9216
    ds_read_b64_tr_b16 v[164:165], v69 offset:12288
    ds_read_b64_tr_b16 v[166:167], v69 offset:13312
    ds_read_b64_tr_b16 v[168:169], v69 offset:40960
    ds_read_b64_tr_b16 v[170:171], v69 offset:41984
    ds_read_b64_tr_b16 v[172:173], v69 offset:45056
    ds_read_b64_tr_b16 v[174:175], v69 offset:46080
    ds_read_b64_tr_b16 v[176:177], v70 offset:8192
    ds_read_b64_tr_b16 v[178:179], v70 offset:9216
    ds_read_b64_tr_b16 v[180:181], v70 offset:12288
    ds_read_b64_tr_b16 v[182:183], v70 offset:13312
    ds_read_b64_tr_b16 v[184:185], v70 offset:40960
    ds_read_b64_tr_b16 v[186:187], v70 offset:41984
    ds_read_b64_tr_b16 v[188:189], v70 offset:45056
    ds_read_b64_tr_b16 v[190:191], v70 offset:46080
    s_waitcnt lgkmcnt(0)
    s_waitcnt vmcnt(18)
    s_barrier
    s_add_u32 s32, s39, 0x180000
    buffer_load_dword v86, v77, s[8:11], s32 offen
    s_add_u32 s32, s34, 0x180000
    s_add_u32 m0, s36, 8192
    s_nop 0
    buffer_load_dwordx4 v64, s[8:11], s32 offen lds
    s_add_u32 s32, s34, 0x184000
    s_add_u32 m0, s36, 9216
    s_nop 0
    buffer_load_dwordx4 v64, s[8:11], s32 offen lds
    s_add_u32 s32, s34, 0x190000
    s_add_u32 m0, s36, 10240
    s_nop 0
    buffer_load_dwordx4 v64, s[8:11], s32 offen lds
    s_add_u32 s32, s34, 0x194000
    s_add_u32 m0, s36, 11264
    s_nop 0
    buffer_load_dwordx4 v64, s[8:11], s32 offen lds
    s_add_u32 s32, s34, 0x1a0000
    s_add_u32 m0, s36, 12288
    s_nop 0
    buffer_load_dwordx4 v64, s[8:11], s32 offen lds
    s_add_u32 s32, s34, 0x1a4000
    s_add_u32 m0, s36, 13312
    s_nop 0
    buffer_load_dwordx4 v64, s[8:11], s32 offen lds
    s_add_u32 s32, s34, 0x1b0000
    s_add_u32 m0, s36, 14336
    s_nop 0
    buffer_load_dwordx4 v64, s[8:11], s32 offen lds
    s_add_u32 s32, s34, 0x1b4000
    s_add_u32 m0, s36, 15360
    s_nop 0
    buffer_load_dwordx4 v64, s[8:11], s32 offen lds
    ds_read_b64_tr_b16 a[0:1], v67 offset:16384
    ds_read_b64_tr_b16 a[2:3], v67 offset:17408
    ds_read_b64_tr_b16 a[4:5], v67 offset:20480
    ds_read_b64_tr_b16 a[6:7], v67 offset:21504
    ds_read_b64_tr_b16 a[8:9], v67 offset:49152
    ds_read_b64_tr_b16 a[10:11], v67 offset:50176
    ds_read_b64_tr_b16 a[12:13], v67 offset:53248
    ds_read_b64_tr_b16 a[14:15], v67 offset:54272
    ds_read_b64_tr_b16 a[128:129], v68 offset:16384
    ds_read_b64_tr_b16 a[130:131], v68 offset:17408
    ds_read_b64_tr_b16 a[132:133], v68 offset:20480
    ds_read_b64_tr_b16 a[134:135], v68 offset:21504
    ds_read_b64_tr_b16 a[136:137], v68 offset:49152
    ds_read_b64_tr_b16 a[138:139], v68 offset:50176
    ds_read_b64_tr_b16 a[140:141], v68 offset:53248
    ds_read_b64_tr_b16 a[142:143], v68 offset:54272
    s_waitcnt lgkmcnt(0)
    s_waitcnt vmcnt(18)
    s_barrier
    s_add_u32 s32, s39, 0x200000
    buffer_load_dword v86, v77, s[8:11], s32 offen
    s_add_u32 s32, s34, 0x200000
    s_add_u32 m0, s36, 16384
    s_nop 0
    buffer_load_dwordx4 v64, s[8:11], s32 offen lds
    s_add_u32 s32, s34, 0x204000
    s_add_u32 m0, s36, 17408
    s_nop 0
    buffer_load_dwordx4 v64, s[8:11], s32 offen lds
    s_add_u32 s32, s34, 0x210000
    s_add_u32 m0, s36, 18432
    s_nop 0
    buffer_load_dwordx4 v64, s[8:11], s32 offen lds
    s_add_u32 s32, s34, 0x214000
    s_add_u32 m0, s36, 19456
    s_nop 0
    buffer_load_dwordx4 v64, s[8:11], s32 offen lds
    s_add_u32 s32, s34, 0x220000
    s_add_u32 m0, s36, 20480
    s_nop 0
    buffer_load_dwordx4 v64, s[8:11], s32 offen lds
    s_add_u32 s32, s34, 0x224000
    s_add_u32 m0, s36, 21504
    s_nop 0
    buffer_load_dwordx4 v64, s[8:11], s32 offen lds
    s_add_u32 s32, s34, 0x230000
    s_add_u32 m0, s36, 22528
    s_nop 0
    buffer_load_dwordx4 v64, s[8:11], s32 offen lds
    s_add_u32 s32, s34, 0x234000
    s_add_u32 m0, s36, 23552
    s_nop 0
    buffer_load_dwordx4 v64, s[8:11], s32 offen lds
    ds_read_b64_tr_b16 a[16:17], v67 offset:24576
    ds_read_b64_tr_b16 a[18:19], v67 offset:25600
    ds_read_b64_tr_b16 a[20:21], v67 offset:28672
    ds_read_b64_tr_b16 a[22:23], v67 offset:29696
    ds_read_b64_tr_b16 a[24:25], v67 offset:57344
    ds_read_b64_tr_b16 a[26:27], v67 offset:58368
    ds_read_b64_tr_b16 a[28:29], v67 offset:61440
    ds_read_b64_tr_b16 a[30:31], v67 offset:62464
    ds_read_b64_tr_b16 a[144:145], v68 offset:24576
    ds_read_b64_tr_b16 a[146:147], v68 offset:25600
    ds_read_b64_tr_b16 a[148:149], v68 offset:28672
    ds_read_b64_tr_b16 a[150:151], v68 offset:29696
    ds_read_b64_tr_b16 a[152:153], v68 offset:57344
    ds_read_b64_tr_b16 a[154:155], v68 offset:58368
    ds_read_b64_tr_b16 a[156:157], v68 offset:61440
    ds_read_b64_tr_b16 a[158:159], v68 offset:62464
    s_waitcnt lgkmcnt(0)
    s_waitcnt vmcnt(18)
    s_barrier
    s_add_u32 s32, s39, 0x280000
    buffer_load_dword v86, v77, s[8:11], s32 offen
    s_add_u32 s32, s34, 0x280000
    s_add_u32 m0, s36, 24576
    s_nop 0
    buffer_load_dwordx4 v64, s[8:11], s32 offen lds
    s_add_u32 s32, s34, 0x284000
    s_add_u32 m0, s36, 25600
    s_nop 0
    buffer_load_dwordx4 v64, s[8:11], s32 offen lds
    s_add_u32 s32, s34, 0x290000
    s_add_u32 m0, s36, 26624
    s_nop 0
    buffer_load_dwordx4 v64, s[8:11], s32 offen lds
    s_add_u32 s32, s34, 0x294000
    s_add_u32 m0, s36, 27648
    s_nop 0
    buffer_load_dwordx4 v64, s[8:11], s32 offen lds
    s_add_u32 s32, s34, 0x2a0000
    s_add_u32 m0, s36, 28672
    s_nop 0
    buffer_load_dwordx4 v64, s[8:11], s32 offen lds
    s_add_u32 s32, s34, 0x2a4000
    s_add_u32 m0, s36, 29696
    s_nop 0
    buffer_load_dwordx4 v64, s[8:11], s32 offen lds
    s_add_u32 s32, s34, 0x2b0000
    s_add_u32 m0, s36, 30720
    s_nop 0
    buffer_load_dwordx4 v64, s[8:11], s32 offen lds
    s_add_u32 s32, s34, 0x2b4000
    s_add_u32 m0, s36, 31744
    s_nop 0
    buffer_load_dwordx4 v64, s[8:11], s32 offen lds
    ds_read_b64_tr_b16 a[32:33], v67 offset:0
    ds_read_b64_tr_b16 a[34:35], v67 offset:1024
    ds_read_b64_tr_b16 a[36:37], v67 offset:4096
    ds_read_b64_tr_b16 a[38:39], v67 offset:5120
    ds_read_b64_tr_b16 a[40:41], v67 offset:32768
    ds_read_b64_tr_b16 a[42:43], v67 offset:33792
    ds_read_b64_tr_b16 a[44:45], v67 offset:36864
    ds_read_b64_tr_b16 a[46:47], v67 offset:37888
    ds_read_b64_tr_b16 a[160:161], v68 offset:0
    ds_read_b64_tr_b16 a[162:163], v68 offset:1024
    ds_read_b64_tr_b16 a[164:165], v68 offset:4096
    ds_read_b64_tr_b16 a[166:167], v68 offset:5120
    ds_read_b64_tr_b16 a[168:169], v68 offset:32768
    ds_read_b64_tr_b16 a[170:171], v68 offset:33792
    ds_read_b64_tr_b16 a[172:173], v68 offset:36864
    ds_read_b64_tr_b16 a[174:175], v68 offset:37888
    s_waitcnt lgkmcnt(0)
    s_waitcnt vmcnt(18)
    s_barrier
    s_add_u32 s32, s39, 0x300000
    buffer_load_dword v86, v77, s[8:11], s32 offen
    s_add_u32 s32, s34, 0x300000
    s_add_u32 m0, s36, 0
    s_nop 0
    buffer_load_dwordx4 v64, s[8:11], s32 offen lds
    s_add_u32 s32, s34, 0x304000
    s_add_u32 m0, s36, 1024
    s_nop 0
    buffer_load_dwordx4 v64, s[8:11], s32 offen lds
    s_add_u32 s32, s34, 0x310000
    s_add_u32 m0, s36, 2048
    s_nop 0
    buffer_load_dwordx4 v64, s[8:11], s32 offen lds
    s_add_u32 s32, s34, 0x314000
    s_add_u32 m0, s36, 3072
    s_nop 0
    buffer_load_dwordx4 v64, s[8:11], s32 offen lds
    s_add_u32 s32, s34, 0x320000
    s_add_u32 m0, s36, 4096
    s_nop 0
    buffer_load_dwordx4 v64, s[8:11], s32 offen lds
    s_add_u32 s32, s34, 0x324000
    s_add_u32 m0, s36, 5120
    s_nop 0
    buffer_load_dwordx4 v64, s[8:11], s32 offen lds
    s_add_u32 s32, s34, 0x330000
    s_add_u32 m0, s36, 6144
    s_nop 0
    buffer_load_dwordx4 v64, s[8:11], s32 offen lds
    s_add_u32 s32, s34, 0x334000
    s_add_u32 m0, s36, 7168
    s_nop 0
    buffer_load_dwordx4 v64, s[8:11], s32 offen lds
    ds_read_b64_tr_b16 a[48:49], v67 offset:8192
    ds_read_b64_tr_b16 a[50:51], v67 offset:9216
    ds_read_b64_tr_b16 a[52:53], v67 offset:12288
    ds_read_b64_tr_b16 a[54:55], v67 offset:13312
    ds_read_b64_tr_b16 a[56:57], v67 offset:40960
    ds_read_b64_tr_b16 a[58:59], v67 offset:41984
    ds_read_b64_tr_b16 a[60:61], v67 offset:45056
    ds_read_b64_tr_b16 a[62:63], v67 offset:46080
    ds_read_b64_tr_b16 a[176:177], v68 offset:8192
    ds_read_b64_tr_b16 a[178:179], v68 offset:9216
    ds_read_b64_tr_b16 a[180:181], v68 offset:12288
    ds_read_b64_tr_b16 a[182:183], v68 offset:13312
    ds_read_b64_tr_b16 a[184:185], v68 offset:40960
    ds_read_b64_tr_b16 a[186:187], v68 offset:41984
    ds_read_b64_tr_b16 a[188:189], v68 offset:45056
    ds_read_b64_tr_b16 a[190:191], v68 offset:46080
    s_waitcnt lgkmcnt(0)
    s_waitcnt vmcnt(18)
    s_barrier
    s_add_u32 s32, s39, 0x380000
    buffer_load_dword v86, v77, s[8:11], s32 offen
    s_add_u32 s32, s34, 0x380000
    s_add_u32 m0, s36, 8192
    s_nop 0
    buffer_load_dwordx4 v64, s[8:11], s32 offen lds
    s_add_u32 s32, s34, 0x384000
    s_add_u32 m0, s36, 9216
    s_nop 0
    buffer_load_dwordx4 v64, s[8:11], s32 offen lds
    s_add_u32 s32, s34, 0x390000
    s_add_u32 m0, s36, 10240
    s_nop 0
    buffer_load_dwordx4 v64, s[8:11], s32 offen lds
    s_add_u32 s32, s34, 0x394000
    s_add_u32 m0, s36, 11264
    s_nop 0
    buffer_load_dwordx4 v64, s[8:11], s32 offen lds
    s_add_u32 s32, s34, 0x3a0000
    s_add_u32 m0, s36, 12288
    s_nop 0
    buffer_load_dwordx4 v64, s[8:11], s32 offen lds
    s_add_u32 s32, s34, 0x3a4000
    s_add_u32 m0, s36, 13312
    s_nop 0
    buffer_load_dwordx4 v64, s[8:11], s32 offen lds
    s_add_u32 s32, s34, 0x3b0000
    s_add_u32 m0, s36, 14336
    s_nop 0
    buffer_load_dwordx4 v64, s[8:11], s32 offen lds
    s_add_u32 s32, s34, 0x3b4000
    s_add_u32 m0, s36, 15360
    s_nop 0
    buffer_load_dwordx4 v64, s[8:11], s32 offen lds
    ds_read_b64_tr_b16 a[64:65], v67 offset:16384
    ds_read_b64_tr_b16 a[66:67], v67 offset:17408
    ds_read_b64_tr_b16 a[68:69], v67 offset:20480
    ds_read_b64_tr_b16 a[70:71], v67 offset:21504
    ds_read_b64_tr_b16 a[72:73], v67 offset:49152
    ds_read_b64_tr_b16 a[74:75], v67 offset:50176
    ds_read_b64_tr_b16 a[76:77], v67 offset:53248
    ds_read_b64_tr_b16 a[78:79], v67 offset:54272
    ds_read_b64_tr_b16 a[192:193], v68 offset:16384
    ds_read_b64_tr_b16 a[194:195], v68 offset:17408
    ds_read_b64_tr_b16 a[196:197], v68 offset:20480
    ds_read_b64_tr_b16 a[198:199], v68 offset:21504
    ds_read_b64_tr_b16 a[200:201], v68 offset:49152
    ds_read_b64_tr_b16 a[202:203], v68 offset:50176
    ds_read_b64_tr_b16 a[204:205], v68 offset:53248
    ds_read_b64_tr_b16 a[206:207], v68 offset:54272
    s_waitcnt lgkmcnt(0)
    buffer_load_dword v72, v73, s[60:63], 0 offen sc1
    buffer_load_dwordx2 v[84:85], off, s[60:63], 0 offset:16 sc1
    s_waitcnt vmcnt(20)
    s_barrier
    s_mov_b32 s8, s46
    s_and_b32 s9, s47, 0xffff
    s_mov_b32 s10, 0x800000
    s_mov_b32 s11, 0x20000
    s_xor_b32 s32, s3, 0x0
    s_add_u32 m0, s36, 16384
    s_nop 0
    buffer_load_dwordx4 v66, s[8:11], s32 offen lds
    s_xor_b32 s32, s3, 0x1000
    s_add_u32 m0, s36, 17408
    s_nop 0
    buffer_load_dwordx4 v66, s[8:11], s32 offen lds
    s_xor_b32 s32, s3, 0x2000
    s_add_u32 m0, s36, 18432
    s_nop 0
    buffer_load_dwordx4 v66, s[8:11], s32 offen lds
    s_xor_b32 s32, s3, 0x3000
    s_add_u32 m0, s36, 19456
    s_nop 0
    buffer_load_dwordx4 v66, s[8:11], s32 offen lds
    s_xor_b32 s32, s3, 0x4000
    s_add_u32 m0, s36, 20480
    s_nop 0
    buffer_load_dwordx4 v66, s[8:11], s32 offen lds
    s_xor_b32 s32, s3, 0x5000
    s_add_u32 m0, s36, 21504
    s_nop 0
    buffer_load_dwordx4 v66, s[8:11], s32 offen lds
    s_xor_b32 s32, s3, 0x6000
    s_add_u32 m0, s36, 22528
    s_nop 0
    buffer_load_dwordx4 v66, s[8:11], s32 offen lds
    s_xor_b32 s32, s3, 0x7000
    s_add_u32 m0, s36, 23552
    s_nop 0
    buffer_load_dwordx4 v66, s[8:11], s32 offen lds
    ds_read_b64_tr_b16 a[80:81], v67 offset:24576
    ds_read_b64_tr_b16 a[82:83], v67 offset:25600
    ds_read_b64_tr_b16 a[84:85], v67 offset:28672
    ds_read_b64_tr_b16 a[86:87], v67 offset:29696
    ds_read_b64_tr_b16 a[88:89], v67 offset:57344
    ds_read_b64_tr_b16 a[90:91], v67 offset:58368
    ds_read_b64_tr_b16 a[92:93], v67 offset:61440
    ds_read_b64_tr_b16 a[94:95], v67 offset:62464
    ds_read_b64_tr_b16 a[208:209], v68 offset:24576
    ds_read_b64_tr_b16 a[210:211], v68 offset:25600
    ds_read_b64_tr_b16 a[212:213], v68 offset:28672
    ds_read_b64_tr_b16 a[214:215], v68 offset:29696
    ds_read_b64_tr_b16 a[216:217], v68 offset:57344
    ds_read_b64_tr_b16 a[218:219], v68 offset:58368
    ds_read_b64_tr_b16 a[220:221], v68 offset:61440
    ds_read_b64_tr_b16 a[222:223], v68 offset:62464
    s_waitcnt lgkmcnt(0)
    s_waitcnt vmcnt(19)
    s_barrier
    s_xor_b32 s32, s3, 0x10000
    s_add_u32 m0, s36, 24576
    s_nop 0
    buffer_load_dwordx4 v66, s[8:11], s32 offen lds
    s_xor_b32 s32, s3, 0x11000
    s_add_u32 m0, s36, 25600
    s_nop 0
    buffer_load_dwordx4 v66, s[8:11], s32 offen lds
    s_xor_b32 s32, s3, 0x12000
    s_add_u32 m0, s36, 26624
    s_nop 0
    buffer_load_dwordx4 v66, s[8:11], s32 offen lds
    s_xor_b32 s32, s3, 0x13000
    s_add_u32 m0, s36, 27648
    s_nop 0
    buffer_load_dwordx4 v66, s[8:11], s32 offen lds
    s_xor_b32 s32, s3, 0x14000
    s_add_u32 m0, s36, 28672
    s_nop 0
    buffer_load_dwordx4 v66, s[8:11], s32 offen lds
    s_xor_b32 s32, s3, 0x15000
    s_add_u32 m0, s36, 29696
    s_nop 0
    buffer_load_dwordx4 v66, s[8:11], s32 offen lds
    s_xor_b32 s32, s3, 0x16000
    s_add_u32 m0, s36, 30720
    s_nop 0
    buffer_load_dwordx4 v66, s[8:11], s32 offen lds
    s_xor_b32 s32, s3, 0x17000
    s_add_u32 m0, s36, 31744
    s_nop 0
    buffer_load_dwordx4 v66, s[8:11], s32 offen lds
    ds_read_b64_tr_b16 a[96:97], v67 offset:0
    ds_read_b64_tr_b16 a[98:99], v67 offset:1024
    ds_read_b64_tr_b16 a[100:101], v67 offset:4096
    ds_read_b64_tr_b16 a[102:103], v67 offset:5120
    ds_read_b64_tr_b16 a[104:105], v67 offset:32768
    ds_read_b64_tr_b16 a[106:107], v67 offset:33792
    ds_read_b64_tr_b16 a[108:109], v67 offset:36864
    ds_read_b64_tr_b16 a[110:111], v67 offset:37888
    ds_read_b64_tr_b16 a[224:225], v68 offset:0
    ds_read_b64_tr_b16 a[226:227], v68 offset:1024
    ds_read_b64_tr_b16 a[228:229], v68 offset:4096
    ds_read_b64_tr_b16 a[230:231], v68 offset:5120
    ds_read_b64_tr_b16 a[232:233], v68 offset:32768
    ds_read_b64_tr_b16 a[234:235], v68 offset:33792
    ds_read_b64_tr_b16 a[236:237], v68 offset:36864
    ds_read_b64_tr_b16 a[238:239], v68 offset:37888
    s_waitcnt lgkmcnt(0)
    s_waitcnt vmcnt(18)
    s_barrier
    s_mov_b32 s8, s44
    s_and_b32 s9, s45, 0xffff
    s_mov_b32 s10, 0x800000
    s_mov_b32 s11, 0x20000
    s_sub_u32 s39, 511, s44
    s_and_b32 s39, s39, 0x380
    s_andn2_b32 s32, s35, 0x1fff
    s_add_u32 s39, s39, s32
    s_add_u32 s32, s39, 0x200000
    buffer_load_dword v86, v77, s[8:11], s32 offen
    s_add_u32 s32, s35, 0x200000
    s_add_u32 m0, s36, 0
    s_nop 0
    buffer_load_dwordx4 v65, s[8:11], s32 offen lds
    s_add_u32 s32, s35, 0x204000
    s_add_u32 m0, s36, 1024
    s_nop 0
    buffer_load_dwordx4 v65, s[8:11], s32 offen lds
    s_add_u32 s32, s35, 0x210000
    s_add_u32 m0, s36, 2048
    s_nop 0
    buffer_load_dwordx4 v65, s[8:11], s32 offen lds
    s_add_u32 s32, s35, 0x214000
    s_add_u32 m0, s36, 3072
    s_nop 0
    buffer_load_dwordx4 v65, s[8:11], s32 offen lds
    s_add_u32 s32, s35, 0x220000
    s_add_u32 m0, s36, 4096
    s_nop 0
    buffer_load_dwordx4 v65, s[8:11], s32 offen lds
    s_add_u32 s32, s35, 0x224000
    s_add_u32 m0, s36, 5120
    s_nop 0
    buffer_load_dwordx4 v65, s[8:11], s32 offen lds
    s_add_u32 s32, s35, 0x230000
    s_add_u32 m0, s36, 6144
    s_nop 0
    buffer_load_dwordx4 v65, s[8:11], s32 offen lds
    s_add_u32 s32, s35, 0x234000
    s_add_u32 m0, s36, 7168
    s_nop 0
    buffer_load_dwordx4 v65, s[8:11], s32 offen lds
    ds_read_b64_tr_b16 a[112:113], v67 offset:8192
    ds_read_b64_tr_b16 a[114:115], v67 offset:9216
    ds_read_b64_tr_b16 a[116:117], v67 offset:12288
    ds_read_b64_tr_b16 a[118:119], v67 offset:13312
    ds_read_b64_tr_b16 a[120:121], v67 offset:40960
    ds_read_b64_tr_b16 a[122:123], v67 offset:41984
    ds_read_b64_tr_b16 a[124:125], v67 offset:45056
    ds_read_b64_tr_b16 a[126:127], v67 offset:46080
    ds_read_b64_tr_b16 a[240:241], v68 offset:8192
    ds_read_b64_tr_b16 a[242:243], v68 offset:9216
    ds_read_b64_tr_b16 a[244:245], v68 offset:12288
    ds_read_b64_tr_b16 a[246:247], v68 offset:13312
    ds_read_b64_tr_b16 a[248:249], v68 offset:40960
    ds_read_b64_tr_b16 a[250:251], v68 offset:41984
    ds_read_b64_tr_b16 a[252:253], v68 offset:45056
    ds_read_b64_tr_b16 a[254:255], v68 offset:46080
    s_waitcnt lgkmcnt(0)
    s_waitcnt vmcnt(17)
    s_barrier
    s_add_u32 s32, s39, 0x300000
    buffer_load_dword v86, v77, s[8:11], s32 offen
    s_add_u32 s32, s35, 0x300000
    s_add_u32 m0, s36, 8192
    s_nop 0
    buffer_load_dwordx4 v65, s[8:11], s32 offen lds
    s_add_u32 s32, s35, 0x304000
    s_add_u32 m0, s36, 9216
    s_nop 0
    buffer_load_dwordx4 v65, s[8:11], s32 offen lds
    s_add_u32 s32, s35, 0x310000
    s_add_u32 m0, s36, 10240
    s_nop 0
    buffer_load_dwordx4 v65, s[8:11], s32 offen lds
    s_add_u32 s32, s35, 0x314000
    s_add_u32 m0, s36, 11264
    s_nop 0
    buffer_load_dwordx4 v65, s[8:11], s32 offen lds
    s_add_u32 s32, s35, 0x320000
    s_add_u32 m0, s36, 12288
    s_nop 0
    buffer_load_dwordx4 v65, s[8:11], s32 offen lds
    s_add_u32 s32, s35, 0x324000
    s_add_u32 m0, s36, 13312
    s_nop 0
    buffer_load_dwordx4 v65, s[8:11], s32 offen lds
    s_add_u32 s32, s35, 0x330000
    s_add_u32 m0, s36, 14336
    s_nop 0
    buffer_load_dwordx4 v65, s[8:11], s32 offen lds
    s_add_u32 s32, s35, 0x334000
    s_add_u32 m0, s36, 15360
    s_nop 0
    buffer_load_dwordx4 v65, s[8:11], s32 offen lds
    v_readlane_b32 s48, v72, 0
    v_readlane_b32 s49, v72, 1
    v_readlane_b32 s50, v72, 2
    v_readlane_b32 s51, v72, 3
    v_readlane_b32 s52, v72, 4
    v_readlane_b32 s53, v72, 5
    v_readlane_b32 s54, v72, 6
    v_readlane_b32 s55, v72, 7
    v_readlane_b32 s38, v72, 8
    s_nop 3
    s_add_u32 s33, s48, s49
    s_add_u32 s33, s33, s50
    s_add_u32 s33, s33, s51
    s_add_u32 s33, s33, s52
    s_add_u32 s33, s33, s53
    s_add_u32 s33, s33, s54
    s_add_u32 s33, s33, s55
    s_cmp_ge_u32 s38, 4
    s_cselect_b32 s33, s33, 0
    s_cmp_ge_u32 s33, 256
    s_cselect_b32 s38, 0, 1
    ds_read_b64_tr_b16 v[192:193], v80 offset:16384
    ds_read_b64_tr_b16 v[194:195], v80 offset:17408
    ds_read_b64_tr_b16 v[196:197], v80 offset:20480
    ds_read_b64_tr_b16 v[198:199], v80 offset:21504
    ds_read_b64_tr_b16 v[208:209], v81 offset:16384
    ds_read_b64_tr_b16 v[210:211], v81 offset:17408
    ds_read_b64_tr_b16 v[212:213], v81 offset:20480
    ds_read_b64_tr_b16 v[214:215], v81 offset:21504
    ds_read_b64_tr_b16 v[224:225], v82 offset:16384
    ds_read_b64_tr_b16 v[226:227], v82 offset:17408
    ds_read_b64_tr_b16 v[228:229], v82 offset:20480
    ds_read_b64_tr_b16 v[230:231], v82 offset:21504
    ds_read_b64_tr_b16 v[240:241], v83 offset:16384
    ds_read_b64_tr_b16 v[242:243], v83 offset:17408
    ds_read_b64_tr_b16 v[244:245], v83 offset:20480
    ds_read_b64_tr_b16 v[246:247], v83 offset:21504
    s_waitcnt lgkmcnt(0)
    s_waitcnt vmcnt(18)
    s_barrier
    s_mov_b32 s8, s46
    s_and_b32 s9, s47, 0xffff
    s_mov_b32 s10, 0x800000
    s_mov_b32 s11, 0x20000
    s_xor_b32 s32, s3, 0x20000
    s_add_u32 m0, s36, 16384
    s_nop 0
    buffer_load_dwordx4 v66, s[8:11], s32 offen lds
    s_xor_b32 s32, s3, 0x21000
    s_add_u32 m0, s36, 17408
    s_nop 0
    buffer_load_dwordx4 v66, s[8:11], s32 offen lds
    s_xor_b32 s32, s3, 0x22000
    s_add_u32 m0, s36, 18432
    s_nop 0
    buffer_load_dwordx4 v66, s[8:11], s32 offen lds
    s_xor_b32 s32, s3, 0x23000
    s_add_u32 m0, s36, 19456
    s_nop 0
    buffer_load_dwordx4 v66, s[8:11], s32 offen lds
    s_xor_b32 s32, s3, 0x24000
    s_add_u32 m0, s36, 20480
    s_nop 0
    buffer_load_dwordx4 v66, s[8:11], s32 offen lds
    s_xor_b32 s32, s3, 0x25000
    s_add_u32 m0, s36, 21504
    s_nop 0
    buffer_load_dwordx4 v66, s[8:11], s32 offen lds
    s_xor_b32 s32, s3, 0x26000
    s_add_u32 m0, s36, 22528
    s_nop 0
    buffer_load_dwordx4 v66, s[8:11], s32 offen lds
    s_xor_b32 s32, s3, 0x27000
    s_add_u32 m0, s36, 23552
    s_nop 0
    buffer_load_dwordx4 v66, s[8:11], s32 offen lds
    ds_read_b64_tr_b16 v[200:201], v80 offset:24576
    ds_read_b64_tr_b16 v[202:203], v80 offset:25600
    ds_read_b64_tr_b16 v[204:205], v80 offset:28672
    ds_read_b64_tr_b16 v[206:207], v80 offset:29696
    ds_read_b64_tr_b16 v[216:217], v81 offset:24576
    ds_read_b64_tr_b16 v[218:219], v81 offset:25600
    ds_read_b64_tr_b16 v[220:221], v81 offset:28672
    ds_read_b64_tr_b16 v[222:223], v81 offset:29696
    ds_read_b64_tr_b16 v[232:233], v82 offset:24576
    ds_read_b64_tr_b16 v[234:235], v82 offset:25600
    ds_read_b64_tr_b16 v[236:237], v82 offset:28672
    ds_read_b64_tr_b16 v[238:239], v82 offset:29696
    ds_read_b64_tr_b16 v[248:249], v83 offset:24576
    ds_read_b64_tr_b16 v[250:251], v83 offset:25600
    ds_read_b64_tr_b16 v[252:253], v83 offset:28672
    ds_read_b64_tr_b16 v[254:255], v83 offset:29696
    s_waitcnt lgkmcnt(0)
    s_waitcnt vmcnt(17)
    s_barrier
    s_xor_b32 s32, s3, 0x30000
    s_add_u32 m0, s36, 24576
    s_nop 0
    buffer_load_dwordx4 v66, s[8:11], s32 offen lds
    s_xor_b32 s32, s3, 0x31000
    s_add_u32 m0, s36, 25600
    s_nop 0
    buffer_load_dwordx4 v66, s[8:11], s32 offen lds
    s_xor_b32 s32, s3, 0x32000
    s_add_u32 m0, s36, 26624
    s_nop 0
    buffer_load_dwordx4 v66, s[8:11], s32 offen lds
    s_xor_b32 s32, s3, 0x33000
    s_add_u32 m0, s36, 27648
    s_nop 0
    buffer_load_dwordx4 v66, s[8:11], s32 offen lds
    s_xor_b32 s32, s3, 0x34000
    s_add_u32 m0, s36, 28672
    s_nop 0
    buffer_load_dwordx4 v66, s[8:11], s32 offen lds
    s_xor_b32 s32, s3, 0x35000
    s_add_u32 m0, s36, 29696
    s_nop 0
    buffer_load_dwordx4 v66, s[8:11], s32 offen lds
    s_xor_b32 s32, s3, 0x36000
    s_add_u32 m0, s36, 30720
    s_nop 0
    buffer_load_dwordx4 v66, s[8:11], s32 offen lds
    s_xor_b32 s32, s3, 0x37000
    s_add_u32 m0, s36, 31744
    s_nop 0
    buffer_load_dwordx4 v66, s[8:11], s32 offen lds
    ds_read_b64_tr_b16 v[0:1], v69 offset:0
    ds_read_b64_tr_b16 v[2:3], v69 offset:1024
    ds_read_b64_tr_b16 v[4:5], v69 offset:4096
    ds_read_b64_tr_b16 v[6:7], v69 offset:5120
    ds_read_b64_tr_b16 v[8:9], v69 offset:32768
    ds_read_b64_tr_b16 v[10:11], v69 offset:33792
    ds_read_b64_tr_b16 v[12:13], v69 offset:36864
    ds_read_b64_tr_b16 v[14:15], v69 offset:37888
    ds_read_b64_tr_b16 v[16:17], v70 offset:0
    ds_read_b64_tr_b16 v[18:19], v70 offset:1024
    ds_read_b64_tr_b16 v[20:21], v70 offset:4096
    ds_read_b64_tr_b16 v[22:23], v70 offset:5120
    ds_read_b64_tr_b16 v[24:25], v70 offset:32768
    ds_read_b64_tr_b16 v[26:27], v70 offset:33792
    ds_read_b64_tr_b16 v[28:29], v70 offset:36864
    ds_read_b64_tr_b16 v[30:31], v70 offset:37888
    s_waitcnt lgkmcnt(0)
    v_and_b32 v64, 15, v94
    v_lshrrev_b32 v65, 4, v94
    v_mov_b32 v66, 0x3c00
    v_mov_b32 v67, 0x3c000000
    v_cmp_eq_u32 vcc, 0, v64
    s_nop 1
    v_cndmask_b32 v127, 0, v66, vcc
    v_cmp_eq_u32 vcc, 1, v64
    s_nop 1
    v_cndmask_b32 v106, v127, v67, vcc
    v_cmp_eq_u32 vcc, 2, v64
    s_nop 1
    v_cndmask_b32 v127, 0, v66, vcc
    v_cmp_eq_u32 vcc, 3, v64
    s_nop 1
    v_cndmask_b32 v107, v127, v67, vcc
    v_cmp_eq_u32 vcc, 4, v64
    s_nop 1
    v_cndmask_b32 v127, 0, v66, vcc
    v_cmp_eq_u32 vcc, 5, v64
    s_nop 1
    v_cndmask_b32 v108, v127, v67, vcc
    v_cmp_eq_u32 vcc, 6, v64
    s_nop 1
    v_cndmask_b32 v127, 0, v66, vcc
    v_cmp_eq_u32 vcc, 7, v64
    s_nop 1
    v_cndmask_b32 v109, v127, v67, vcc
    v_mov_b32 v66, 0x3f80
    v_mov_b32 v67, 0x3f800000
    v_and_b32 v126, 1, v65
    v_lshrrev_b32 v68, 1, v65
    v_lshl_add_u32 v126, v126, 2, v68
    v_sub_u32 v68, v64, v126
    v_cmp_eq_u32 vcc, 0, v68
    s_nop 1
    v_cndmask_b32 v127, 0, v66, vcc
    v_cmp_eq_u32 vcc, 2, v68
    s_nop 1
    v_cndmask_b32 v102, v127, v67, vcc
    v_cmp_eq_u32 vcc, 0, v68
    s_nop 1
    v_cndmask_b32 v127, 0, v66, vcc
    v_cmp_eq_u32 vcc, 2, v68
    s_nop 1
    v_cndmask_b32 v103, v127, v67, vcc
    v_cmp_eq_u32 vcc, 8, v68
    s_nop 1
    v_cndmask_b32 v127, 0, v66, vcc
    v_cmp_eq_u32 vcc, 10, v68
    s_nop 1
    v_cndmask_b32 v104, v127, v67, vcc
    v_cmp_eq_u32 vcc, 8, v68
    s_nop 1
    v_cndmask_b32 v127, 0, v66, vcc
    v_cmp_eq_u32 vcc, 10, v68
    s_nop 1
    v_cndmask_b32 v105, v127, v67, vcc
    v_mov_b32 v100, 0x3f003f00
    v_mov_b32 v101, 0x3f003f00
    v_and_b32 v126, 7, v64
    v_lshlrev_b32 v126, 4, v126
    v_lshl_add_u32 v114, v65, 7, v126
    v_lshrrev_b32 v126, 3, v64
    v_lshl_add_u32 v119, v126, 3, v114
    v_lshl_add_u32 v118, v126, 11, v114
    v_lshl_add_u32 v118, s14, 9, v118
    v_lshlrev_b32 v126, 4, v64
    v_lshl_add_u32 v120, v65, 13, v126
    v_lshlrev_b32 v123, 3, v94
    s_lshl_b32 s32, s14, 10
    s_add_u32 s32, s32, 16384
    v_and_b32 v126, 32, v94
    v_lshlrev_b32 v126, 1, v126
    v_xor_b32 v126, v126, v123
    v_add_u32 v124, s32, v126
    v_lshrrev_b32 v126, 2, v64
    v_lshrrev_b32 v127, 1, v65
    v_lshl_add_u32 v126, v126, 1, v127
    v_and_b32 v127, 3, v64
    v_lshl_add_u32 v126, v126, 2, v127
    v_and_b32 v127, 1, v65
    v_lshl_add_u32 v126, v126, 1, v127
    v_lshlrev_b32 v126, 3, v126
    v_mov_b32 v95, 0x7f000000
    v_mov_b32 v66, 0x4444
    v_mov_b32 v67, 0xeeee
    v_cmp_gt_u32 vcc, 8, v64
    s_nop 1
    v_cndmask_b32 v122, v95, v126, vcc
    v_cndmask_b32 v125, v114, v95, vcc
    v_cndmask_b32 v110, v67, v66, vcc
    v_lshrrev_b32 v126, 2, v94
    v_lshlrev_b32 v126, 3, v126
    v_and_b32 v127, 2, v94
    v_lshlrev_b32 v127, 5, v127
    v_xor_b32 v126, v126, v127
    v_and_b32 v127, 3, v94
    v_lshl_add_u32 v115, v127, 7, v126
    s_mov_b32 s37, 0x3f80
    s_mov_b32 s57, 0x3f800000
    s_and_b32 s32, s14, 1
    s_lshr_b32 s33, s14, 1
    s_lshl2_add_u32 s32, s32, s33
    s_lshl_b32 s59, s32, 9
    s_mov_b32 s17, 0
    s_mov_b32 s0, 0x00ff00ff
    s_mov_b32 s1, s0
    s_mov_b64 s[44:45], s[0:1]
    s_lshl_b32 s32, s12, 18
    s_lshl2_add_u32 s33, s13, s14
    s_lshl_b32 s34, s33, 11
    s_add_u32 s28, s34, 0x2800000
    s_add_u32 s21, s32, s34
    s_add_u32 s21, s21, 0x6c00000
    s_lshl_b32 s34, s13, 8
    s_add_u32 s23, s32, s34
    s_add_u32 s23, s23, 0x6c80000
    s_lshl_b32 s32, s12, 13
    s_add_u32 s25, s32, 0x6d00000
    s_add_u32 s24, s25, s34
    s_lshl_b32 s34, s33, 9
    s_add_u32 s26, s34, 0x8000000
    s_add_u32 s31, s34, 0x6e00000
    s_cmp_eq_u32 s12, 0
    s_cselect_b32 s26, s26, s31
    s_lshl_b32 s32, s12, 7
    s_add_u32 s32, s32, s33
    s_cmp_eq_u32 s32, 1
    s_mov_b32 s39, 0x7f000000
    s_cselect_b32 s39, 0x841ec04, s39
    s_lshl_b32 s27, s13, 12
    s_lshl_b32 s36, s14, 11
    s_and_b32 s33, s36, 2048
    s_add_u32 s27, s27, s33
    s_lshr_b32 s33, s14, 1
    s_lshl_b32 s33, s33, 17
    s_add_u32 s27, s27, s33
    s_add_u32 s27, s27, 0x1800000
    s_add_u32 s36, s36, 24576
    v_add_u32 v112, 24576, v116
    s_lshl_b32 s32, s12, 12
    s_add_u32 s32, s32, 0x841c000
    s_lshl2_add_u32 s46, s13, s32
    v_lshl_add_u32 v117, v123, 25, v114
    s_and_b32 s33, s13, 3
    s_lshl_b32 s33, s33, 7
    s_add_u32 s47, s32, s33
    s_cmp_eq_u32 s14, 0
    s_cselect_b32 s47, s47, 0x7f000000
    s_cselect_b32 s11, -1, 0
    s_mov_b32 s30, 0x3e0293ee
    v_mov_b32 v121, 0x7f000000
    v_and_b32 v127, 1, v94
    s_mov_b32 exec_lo, 0
    s_mov_b32 exec_hi, 0x300
    s_lshl_b32 s32, s13, 8
    s_add_u32 s32, s32, 0x8406000
    v_lshl_add_u32 v121, v127, 13, s32
    s_mov_b32 exec_hi, 0x3c00
    s_mov_b32 s32, 0x841760c
    v_lshl_add_u32 v121, v64, 8, s32
    s_mov_b64 exec, -1
    s_waitcnt vmcnt(16)
    s_barrier
    ds_write_b128 v113, v[0:3] offset:0
    ds_write_b128 v113, v[4:7] offset:1024
    ds_write_b128 v113, v[8:11] offset:2048
    ds_write_b128 v113, v[12:15] offset:3072
    ds_write_b128 v113, v[16:19] offset:4096
    ds_write_b128 v113, v[20:23] offset:5120
    ds_write_b128 v113, v[24:27] offset:6144
    ds_write_b128 v113, v[28:31] offset:7168
    ds_read_b64_tr_b16 v[32:33], v69 offset:8192
    ds_read_b64_tr_b16 v[34:35], v69 offset:9216
    ds_read_b64_tr_b16 v[36:37], v69 offset:12288
    ds_read_b64_tr_b16 v[38:39], v69 offset:13312
    ds_read_b64_tr_b16 v[40:41], v69 offset:40960
    ds_read_b64_tr_b16 v[42:43], v69 offset:41984
    ds_read_b64_tr_b16 v[44:45], v69 offset:45056
    ds_read_b64_tr_b16 v[46:47], v69 offset:46080
    ds_read_b64_tr_b16 v[48:49], v70 offset:8192
    ds_read_b64_tr_b16 v[50:51], v70 offset:9216
    ds_read_b64_tr_b16 v[52:53], v70 offset:12288
    ds_read_b64_tr_b16 v[54:55], v70 offset:13312
    ds_read_b64_tr_b16 v[56:57], v70 offset:40960
    ds_read_b64_tr_b16 v[58:59], v70 offset:41984
    ds_read_b64_tr_b16 v[60:61], v70 offset:45056
    ds_read_b64_tr_b16 v[62:63], v70 offset:46080
    s_waitcnt lgkmcnt(0)
    s_waitcnt vmcnt(8)
    s_barrier
    ds_write_b128 v113, v[32:35] offset:8192
    ds_write_b128 v113, v[36:39] offset:9216
    ds_write_b128 v113, v[40:43] offset:10240
    ds_write_b128 v113, v[44:47] offset:11264
    ds_write_b128 v113, v[48:51] offset:12288
    ds_write_b128 v113, v[52:55] offset:13312
    ds_write_b128 v113, v[56:59] offset:14336
    ds_write_b128 v113, v[60:63] offset:15360
    buffer_load_dword v76, v74, s[4:7], 0 offen sc1
    buffer_load_dword v79, v75, s[4:7], 0 offen sc1
    ds_read_b64_tr_b16 v[0:1], v80 offset:16384
    ds_read_b64_tr_b16 v[2:3], v80 offset:17408
    ds_read_b64_tr_b16 v[4:5], v80 offset:20480
    ds_read_b64_tr_b16 v[6:7], v80 offset:21504
    ds_read_b64_tr_b16 v[8:9], v81 offset:16384
    ds_read_b64_tr_b16 v[10:11], v81 offset:17408
    ds_read_b64_tr_b16 v[12:13], v81 offset:20480
    ds_read_b64_tr_b16 v[14:15], v81 offset:21504
    ds_read_b64_tr_b16 v[16:17], v82 offset:16384
    ds_read_b64_tr_b16 v[18:19], v82 offset:17408
    ds_read_b64_tr_b16 v[20:21], v82 offset:20480
    ds_read_b64_tr_b16 v[22:23], v82 offset:21504
    ds_read_b64_tr_b16 v[24:25], v83 offset:16384
    ds_read_b64_tr_b16 v[26:27], v83 offset:17408
    ds_read_b64_tr_b16 v[28:29], v83 offset:20480
    ds_read_b64_tr_b16 v[30:31], v83 offset:21504
    s_waitcnt lgkmcnt(0)
    ds_write_b128 v113, v[0:3] offset:16384
    ds_write_b128 v113, v[4:7] offset:17408
    ds_write_b128 v113, v[8:11] offset:18432
    ds_write_b128 v113, v[12:15] offset:19456
    ds_write_b128 v113, v[16:19] offset:20480
    ds_write_b128 v113, v[20:23] offset:21504
    ds_write_b128 v113, v[24:27] offset:22528
    ds_write_b128 v113, v[28:31] offset:23552
    s_waitcnt lgkmcnt(0)
    s_waitcnt vmcnt(2)
    s_waitcnt vmcnt(0)
    v_min_u32 v76, v76, v79
    v_cmp_eq_u32 vcc, 0, v76
    s_cmp_eq_u32 s38, 0
    s_cbranch_scc0 main_kernel_c_sl0
    s_cbranch_vccnz main_kernel_c_sl1
    s_branch main_kernel_c_kv0_ok
main_kernel_c_sl0:
    v_and_b32 v126, 7, v94
    v_lshlrev_b32 v126, 5, v126
main_kernel_c_mode_cnt:
    buffer_load_dword v127, v126, s[60:63], 0 offen sc1
    s_waitcnt vmcnt(0)
    v_readlane_b32 s48, v127, 0
    v_readlane_b32 s49, v127, 1
    v_readlane_b32 s50, v127, 2
    v_readlane_b32 s51, v127, 3
    v_readlane_b32 s52, v127, 4
    v_readlane_b32 s53, v127, 5
    v_readlane_b32 s54, v127, 6
    v_readlane_b32 s55, v127, 7
    s_nop 3
    s_add_u32 s33, s48, s49
    s_add_u32 s33, s33, s50
    s_add_u32 s33, s33, s51
    s_add_u32 s33, s33, s52
    s_add_u32 s33, s33, s53
    s_add_u32 s33, s33, s54
    s_add_u32 s33, s33, s55
    s_cmp_ge_u32 s33, 256
    s_cbranch_scc1 main_kernel_c_mode_cnt_ok
    s_sub_u32 s29, s29, 1
    s_cbranch_scc1 main_kernel_end
    s_sleep 4
    s_branch main_kernel_c_mode_cnt
main_kernel_c_mode_cnt_ok:
    v_mov_b32 v126, 0
main_kernel_c_wa:
    buffer_load_dword v127, v126, s[60:63], 0 offen offset:12 sc1
    s_waitcnt vmcnt(0)
    v_cmp_gt_u32 vcc, 4, v127
    s_cbranch_vccz main_kernel_c_wa_ok
    s_sleep 4
    s_sub_u32 s29, s29, 1
    s_cbranch_scc0 main_kernel_c_wa
    s_branch main_kernel_end
main_kernel_c_wa_ok:
main_kernel_c_sl1:
    v_lshlrev_b32 v126, 2, v94
    s_mov_b32 s32, 0x841f000
main_kernel_c_wf:
    buffer_load_dword v0, v126, s[4:7], s32 offen sc1
    s_waitcnt vmcnt(0)
    v_cmp_eq_u32 vcc, 0, v0
    s_cbranch_vccz main_kernel_c_wf_ok
    s_sleep 4
    s_sub_u32 s29, s29, 1
    s_cbranch_scc0 main_kernel_c_wf
    s_branch main_kernel_end
main_kernel_c_wf_ok:
    s_mov_b32 exec_lo, 0
    s_mov_b32 exec_hi, 0x300
    v_subrev_u32 v127, 0, v121
main_kernel_c_kv0:
    buffer_load_dword v126, v127, s[4:7], 0 offen sc1
    s_waitcnt vmcnt(0)
    v_cmp_eq_u32 vcc, 0, v126
    s_cbranch_vccz main_kernel_c_kv0_ok
    s_sleep 2
    s_sub_u32 s29, s29, 1
    s_cbranch_scc0 main_kernel_c_kv0
    s_branch main_kernel_end
main_kernel_c_kv0_ok:
    s_mov_b32 exec_lo, 0
    s_mov_b32 exec_hi, 0x100
    v_add_u32 v121, 4, v121
    s_mov_b64 exec, -1
    v_add_u32 v121, 4, v121
    v_lshlrev_b32 v126, 3, v116
    v_and_b32 v126, 0x780, v126
    v_bfe_u32 v127, v116, 8, 1
    v_lshl_add_u32 v126, v127, 19, v126
    s_mov_b32 m0, s36
    buffer_load_dword v111, v126, s[4:7], s21 offen sc1
    buffer_load_dwordx4 v116, s[4:7], s27 offen offset:0 sc1 lds
    buffer_load_dwordx4 v116, s[4:7], s27 offen offset:1024 sc1 lds
    s_lshl_b32 s32, s14, 11
    s_add_u32 m0, s32, 0
    s_add_u32 s32, s32, s25
    buffer_load_dwordx4 v116, s[4:7], s32 offen offset:0 sc1 lds
    buffer_load_dwordx4 v116, s[4:7], s32 offen offset:1024 sc1 lds
    s_add_u32 s27, s27, 0x40000
    ds_read_b64_tr_b16 v[32:33], v80 offset:24576
    ds_read_b64_tr_b16 v[34:35], v80 offset:25600
    ds_read_b64_tr_b16 v[36:37], v80 offset:28672
    ds_read_b64_tr_b16 v[38:39], v80 offset:29696
    ds_read_b64_tr_b16 v[40:41], v81 offset:24576
    ds_read_b64_tr_b16 v[42:43], v81 offset:25600
    ds_read_b64_tr_b16 v[44:45], v81 offset:28672
    ds_read_b64_tr_b16 v[46:47], v81 offset:29696
    ds_read_b64_tr_b16 v[48:49], v82 offset:24576
    ds_read_b64_tr_b16 v[50:51], v82 offset:25600
    ds_read_b64_tr_b16 v[52:53], v82 offset:28672
    ds_read_b64_tr_b16 v[54:55], v82 offset:29696
    ds_read_b64_tr_b16 v[56:57], v83 offset:24576
    ds_read_b64_tr_b16 v[58:59], v83 offset:25600
    ds_read_b64_tr_b16 v[60:61], v83 offset:28672
    ds_read_b64_tr_b16 v[62:63], v83 offset:29696
    s_waitcnt lgkmcnt(0)
    ds_write_b128 v113, v[32:35] offset:24576
    ds_write_b128 v113, v[36:39] offset:25600
    ds_write_b128 v113, v[40:43] offset:26624
    ds_write_b128 v113, v[44:47] offset:27648
    ds_write_b128 v113, v[48:51] offset:28672
    ds_write_b128 v113, v[52:55] offset:29696
    ds_write_b128 v113, v[56:59] offset:30720
    ds_write_b128 v113, v[60:63] offset:31744
    s_waitcnt lgkmcnt(0)
main_kernel_c_nb:
    v_readfirstlane_b32 s33, v84
    v_readfirstlane_b32 s32, v85
    s_nop 3
    s_and_b32 s34, s32, s33
    s_cbranch_scc1 main_kernel_c_nb_ok
    buffer_load_dwordx2 v[84:85], off, s[60:63], 0 offset:16 sc1
    s_sub_u32 s29, s29, 1
    s_cbranch_scc1 main_kernel_end
    s_waitcnt vmcnt(0)
    s_branch main_kernel_c_nb
main_kernel_c_nb_ok:
    s_and_b32 s33, s33, 1
    s_lshl_b32 s32, s12, 5
    s_add_u32 s32, s32, s13
    s_lshl1_add_u32 s32, s32, s33
    s_lshl2_add_u32 s32, s32, s14
    s_lshl_b32 s32, s32, 11
    s_add_u32 s18, s32, 0x8c00000
    s_xor_b32 s19, s18, 0x80000
    v_mov_b32 v64, 0
    v_mov_b32 v65, 0
    v_mov_b32 v66, 0
    v_mov_b32 v67, 0
    v_mov_b32 v68, 0
    v_mov_b32 v69, 0
    v_mov_b32 v70, 0
    v_mov_b32 v71, 0
    v_mov_b32 v96, 0
    v_mov_b32 v97, 0
    v_mov_b32 v98, 0
    v_mov_b32 v99, 0
    s_xor_b32 s36, s36, 0x4000
    s_waitcnt vmcnt(0)
    buffer_store_dword v64, off, s[4:7], s18 offset:1536 sc1
    s_mov_b32 m0, s36
    buffer_load_dwordx4 v[88:91], v116, s[4:7], s28 offen offset:0 sc1
    buffer_load_dwordx4 v116, s[4:7], s27 offen offset:0 sc1 lds
    buffer_load_dwordx4 v[92:95], v116, s[4:7], s28 offen offset:1024 sc1
    s_barrier
    s_memrealtime s[32:33]
    s_waitcnt lgkmcnt(0)
    s_mul_i32 s32, s32, 22
    s_sub_u32 s20, s32, 0x40000
    s_mov_b32 s9, 0
    s_mov_b32 s10, 0
    s_memtime s[52:53]
    s_waitcnt lgkmcnt(0)
    s_sub_u32 s38, s52, s32
    s_sub_u32 s3, s52, 0x4000
    v_mov_b32 v126, s38
    ds_write_b32 v123, v126 offset:20992
    s_waitcnt lgkmcnt(0)
    s_min_u32 s32, s48, s49
    s_cmp_ge_u32 s32, 32
    s_cbranch_scc0 main_kernel_cs_top
    .p2align 6
main_kernel_cf_top:
    s_barrier
main_kernel_cf_mrd:
    ds_read_b128 v[0:3], v114 offset:0
    ds_read_b128 v[4:7], v114 offset:512
    ds_read_b128 v[8:11], v114 offset:1024
    ds_read_b128 v[12:15], v114 offset:1536
    ds_read_b128 v[16:19], v114 offset:2048
    s_waitcnt lgkmcnt(4)
    v_smfmac_f32_16x16x64_bf16 v[96:99], v[0:3], a[0:7], v110
    ds_read_b128 v[20:23], v114 offset:2560
    s_waitcnt lgkmcnt(4)
    v_smfmac_f32_16x16x64_bf16 v[96:99], v[4:7], a[8:15], v110
    ds_read_b128 v[24:27], v114 offset:3072
    s_waitcnt lgkmcnt(4)
    s_bfe_u32 s22, s17, 0x10001
    v_smfmac_f32_16x16x64_bf16 v[96:99], v[8:11], a[16:23], v110
    ds_read_b128 v[28:31], v114 offset:3584
    s_waitcnt lgkmcnt(4)
    v_smfmac_f32_16x16x64_bf16 v[96:99], v[12:15], a[24:31], v110
    ds_read_b128 v[32:35], v114 offset:4096
    s_waitcnt lgkmcnt(4)
    v_smfmac_f32_16x16x64_bf16 v[96:99], v[16:19], a[32:39], v110
    ds_read_b128 v[36:39], v114 offset:4608
    s_waitcnt lgkmcnt(4)
    v_smfmac_f32_16x16x64_bf16 v[96:99], v[20:23], a[40:47], v110
    ds_read_b128 v[40:43], v114 offset:5120
    s_waitcnt lgkmcnt(4)
    v_smfmac_f32_16x16x64_bf16 v[96:99], v[24:27], a[48:55], v110
    ds_read_b128 v[44:47], v114 offset:5632
    s_waitcnt lgkmcnt(4)
    v_smfmac_f32_16x16x64_bf16 v[96:99], v[28:31], a[56:63], v110
    ds_read_b128 v[48:51], v114 offset:6144
    s_waitcnt lgkmcnt(4)
    v_smfmac_f32_16x16x64_bf16 v[96:99], v[32:35], a[64:71], v110
    ds_read_b128 v[52:55], v114 offset:6656
    s_waitcnt lgkmcnt(4)
    v_smfmac_f32_16x16x64_bf16 v[96:99], v[36:39], a[72:79], v110
    ds_read_b128 v[56:59], v114 offset:7168
    s_waitcnt lgkmcnt(4)
    v_smfmac_f32_16x16x64_bf16 v[96:99], v[40:43], a[80:87], v110
    ds_read_b128 v[60:63], v114 offset:7680
    s_waitcnt lgkmcnt(4)
    v_smfmac_f32_16x16x64_bf16 v[96:99], v[44:47], a[88:95], v110
    s_waitcnt lgkmcnt(3)
    buffer_load_dword v111, v121, s[4:7], 0 offen sc1
    v_smfmac_f32_16x16x64_bf16 v[96:99], v[48:51], a[96:103], v110
    s_waitcnt lgkmcnt(2)
    ds_read_b128 v[80:83], v113 offset:0
    v_smfmac_f32_16x16x64_bf16 v[96:99], v[52:55], a[104:111], v110
    s_waitcnt lgkmcnt(2)
    ds_read_b128 v[84:87], v113 offset:1024
    v_smfmac_f32_16x16x64_bf16 v[96:99], v[56:59], a[112:119], v110
    s_waitcnt lgkmcnt(2)
    v_smfmac_f32_16x16x64_bf16 v[96:99], v[60:63], a[120:127], v110
    v_smfmac_f32_16x16x64_bf16 v[68:71], v[0:3], a[128:135], v110
    ds_read_b128 v[72:75], v113 offset:2048
    v_smfmac_f32_16x16x64_bf16 v[68:71], v[4:7], a[136:143], v110
    s_nop 1
    v_pk_add_f32 v[126:127], v[96:97], v[98:99]
    ds_read_b128 v[76:79], v113 offset:3072
    v_smfmac_f32_16x16x64_bf16 v[68:71], v[8:11], a[144:151], v110
    v_cmp_u_f32 vcc, v126, v127
    v_smfmac_f32_16x16x64_bf16 v[68:71], v[12:15], a[152:159], v110
    v_cvt_pk_bf16_f32 v126, v96, v97
    v_smfmac_f32_16x16x64_bf16 v[68:71], v[16:19], a[160:167], v110
    v_cvt_pk_bf16_f32 v127, v98, v99
    s_and_b64 s[42:43], vcc, s[44:45]
    s_cbranch_scc1 main_kernel_cf_m_f
    v_smfmac_f32_16x16x64_bf16 v[68:71], v[20:23], a[168:175], v110
    v_bfi_b32 v126, 1, s22, v126
    buffer_store_dwordx2 v[126:127], v123, s[4:7], s18 offen sc1
    v_smfmac_f32_16x16x64_bf16 v[68:71], v[24:27], a[176:183], v110
    s_mov_b64 s[44:45], s[0:1]
    v_smfmac_f32_16x16x64_bf16 v[68:71], v[28:31], a[184:191], v110
    s_add_u32 s17, s17, 1
    s_bfe_u32 s40, s17, 0x10001
    v_smfmac_f32_16x16x64_bf16 v[68:71], v[32:35], a[192:199], v110
    s_add_u32 s28, s28, 0x40000
    s_mov_b32 m0, s36
    v_smfmac_f32_16x16x64_bf16 v[68:71], v[36:39], a[200:207], v110
    s_add_u32 s34, s3, 2100
    v_smfmac_f32_16x16x64_bf16 v[68:71], v[40:43], a[208:215], v110
    v_smfmac_f32_16x16x64_bf16 v[68:71], v[44:47], a[216:223], v110
    v_smfmac_f32_16x16x64_bf16 v[68:71], v[48:51], a[224:231], v110
    v_smfmac_f32_16x16x64_bf16 v[68:71], v[52:55], a[232:239], v110
    v_smfmac_f32_16x16x64_bf16 v[68:71], v[56:59], a[240:247], v110
    v_smfmac_f32_16x16x64_bf16 v[68:71], v[60:63], a[248:255], v110
    s_waitcnt lgkmcnt(2)
    v_smfmac_f32_16x16x64_bf16 v[64:67], v[32:35], v[80:87], v110
    s_waitcnt lgkmcnt(0)
    s_nop 3
    v_cvt_pk_bf16_f32 v126, v68, v69
    v_cvt_pk_bf16_f32 v127, v70, v71
    v_bfi_b32 v126, 1, s22, v126
    buffer_store_dwordx2 v[126:127], v123, s[4:7], s18 offen offset:512 sc1
    ds_read_b128 v[80:83], v113 offset:4096
    v_smfmac_f32_16x16x64_bf16 v[64:67], v[36:39], v[72:79], v110
    ds_read_b128 v[84:87], v113 offset:5120
    v_smfmac_f32_16x16x64_bf16 v[64:67], v[0:3], v[128:135], v110
    ds_read_b128 v[72:75], v113 offset:6144
    v_smfmac_f32_16x16x64_bf16 v[64:67], v[4:7], v[136:143], v110
    ds_read_b128 v[76:79], v113 offset:7168
    v_smfmac_f32_16x16x64_bf16 v[64:67], v[8:11], v[144:151], v110
    ds_read_b128 v[32:35], v113 offset:8192
    v_smfmac_f32_16x16x64_bf16 v[64:67], v[12:15], v[152:159], v110
    ds_read_b128 v[36:39], v113 offset:9216
    v_smfmac_f32_16x16x64_bf16 v[64:67], v[16:19], v[160:167], v110
    ds_read_b128 v[0:3], v113 offset:10240
    s_memtime s[52:53]
    v_smfmac_f32_16x16x64_bf16 v[64:67], v[20:23], v[168:175], v110
    ds_read_b128 v[4:7], v113 offset:11264
    s_memtime s[52:53]
    s_xor_b32 s32, s9, s22
    s_bitcmp1_b32 s32, 0
    s_cbranch_scc1 main_kernel_cf_t_p
main_kernel_cf_t_ok:
    s_sub_u32 s32, s9, s10
    v_smfmac_f32_16x16x64_bf16 v[64:67], v[24:27], v[176:183], v110
    ds_read_b128 v[8:11], v113 offset:12288
    s_memtime s[52:53]
    s_max_i32 s32, s32, 0
    s_min_i32 s32, s32, 0x4000
    v_smfmac_f32_16x16x64_bf16 v[64:67], v[28:31], v[184:191], v110
    s_waitcnt lgkmcnt(7)
    ds_read_b128 v[12:15], v113 offset:13312
    s_memtime s[52:53]
    s_add_u32 s34, s34, s32
    s_and_b32 s34, s34, s11
    v_smfmac_f32_16x16x64_bf16 v[64:67], v[40:43], v[80:87], v110
    s_waitcnt lgkmcnt(6)
    ds_read_b128 v[16:19], v113 offset:14336
    s_cmp_lt_u32 s52, s34
    s_cbranch_scc1 main_kernel_cf_t_w
main_kernel_cf_t_go:
    s_barrier
    buffer_load_dwordx2 v[126:127], v123, s[4:7], s19 offen offset:0 sc1
    v_smfmac_f32_16x16x64_bf16 v[64:67], v[44:47], v[72:79], v110
    s_waitcnt lgkmcnt(5)
    ds_read_b128 v[20:23], v113 offset:15360
    v_smfmac_f32_16x16x64_bf16 v[64:67], v[48:51], v[32:39], v110
    s_waitcnt lgkmcnt(4)
    v_smfmac_f32_16x16x64_bf16 v[64:67], v[52:55], v[0:7], v110
    s_waitcnt lgkmcnt(2)
    ds_read_b128 v[24:27], v112 offset:6144
    ds_read_b128 v[28:31], v112 offset:7168
    v_smfmac_f32_16x16x64_bf16 v[64:67], v[56:59], v[8:15], v110
    s_waitcnt lgkmcnt(2)
    ds_read_b128 v[0:3], v112 offset:0
    ds_read_b128 v[4:7], v112 offset:1024
    v_smfmac_f32_16x16x64_bf16 v[64:67], v[60:63], v[16:23], v110
    ds_read_b128 v[8:11], v112 offset:2048
    ds_read_b128 v[12:15], v112 offset:3072
    ds_read_b128 v[16:19], v112 offset:4096
    ds_read_b128 v[20:23], v112 offset:5120
    v_mov_b32 v76, 0
    v_mov_b32 v77, 0
    v_mov_b32 v78, 0
    s_nop 0
    v_permlane32_swap_b32 v64, v65
    v_permlane32_swap_b32 v66, v67
    v_cvt_pk_bf16_f32 v84, v64, v66
    v_cvt_pk_bf16_f32 v85, v65, v67
    v_bfi_b32 v84, 1, s22, v84
    buffer_load_dwordx2 v[42:43], v123, s[4:7], s19 offen offset:512 sc1
    v_mov_b32 v79, 0
    v_mov_b32 v80, 0
    v_mov_b32 v81, 0
    v_mov_b32 v82, 0
    v_mov_b32 v83, 0
    v_mov_b32 v60, 0
    v_mov_b32 v60, 0
    v_mov_b32 v60, 0
    v_mov_b32 v60, 0
    v_mov_b32 v60, 0
    v_mov_b32 v60, 0
    v_mov_b32 v60, 0
    buffer_store_dwordx2 v[84:85], v123, s[4:7], s18 offen offset:1024 sc1
    v_mov_b32 v60, 0
    v_mov_b32 v60, 0
    v_mov_b32 v60, 0
    v_mov_b32 v60, 0
    v_mov_b32 v60, 0
    v_mov_b32 v60, 0
    v_mov_b32 v60, 0
    v_mov_b32 v60, 0
    v_mov_b32 v60, 0
    v_mov_b32 v60, 0
    v_mov_b32 v60, 0
    v_mov_b32 v60, 0
    v_mov_b32 v60, 0
    v_mov_b32 v60, 0
    v_mov_b32 v60, 0
    v_mov_b32 v60, 0
    v_mov_b32 v60, 0
    v_mov_b32 v60, 0
    v_mov_b32 v60, 0
    v_mov_b32 v60, 0
    v_mov_b32 v60, 0
    v_mov_b32 v60, 0
    v_mov_b32 v60, 0
    v_mov_b32 v60, 0
    v_mov_b32 v60, 0
    v_mov_b32 v60, 0
    v_mov_b32 v60, 0
    v_mov_b32 v60, 0
    v_mov_b32 v60, 0
    v_mov_b32 v60, 0
    v_mov_b32 v60, 0
    v_mov_b32 v60, 0
    v_mov_b32 v60, 0
    v_mov_b32 v60, 0
    v_mov_b32 v60, 0
    v_mov_b32 v60, 0
    v_mov_b32 v60, 0
    v_mov_b32 v60, 0
    s_waitcnt vmcnt(2)
main_kernel_cf_z0:
    v_dot2_f32_bf16 v44, v126, s37, v96
    v_dot2_f32_bf16 v45, v126, s57, v97
    v_dot2_f32_bf16 v46, v127, s37, v98
    v_dot2_f32_bf16 v47, v127, s57, v99
    v_bitop3_b32 v60, v126, s22, 1 bitop3:0x28
    v_cvt_pk_bf16_f32 v44, v44, v45
    v_cmp_ne_u32 vcc, 0, v60
    v_cvt_pk_bf16_f32 v45, v46, v47
    ds_write_b64 v124, v[44:45] offset:0
    buffer_load_dwordx2 v[64:65], v123, s[4:7], s19 offen offset:512 sc1
    v_cmp_eq_u32 s[42:43], 0, v111
    s_cbranch_vccnz main_kernel_cf_z0_f
    v_mov_b32 v96, 0x3f803f80
    v_mov_b32 v97, 0x3f803f80
    v_mov_b32 v98, 0x3f803f80
    v_mov_b32 v99, 0x3f803f80
    s_and_b32 s32, s43, 0x3f00
    s_cbranch_scc1 main_kernel_cf_kvw
main_kernel_cf_kvok:
    s_waitcnt lgkmcnt(0)
    s_barrier
    ds_read_b64_tr_b16 v[48:49], v115 offset:16384
    ds_read_b64_tr_b16 v[50:51], v115 offset:17408
    ds_read_b64_tr_b16 v[52:53], v115 offset:18432
    ds_read_b64_tr_b16 v[54:55], v115 offset:19456
    s_waitcnt vmcnt(2)
    s_memtime s[52:53]
    v_dot2_f32_bf16 v44, v42, s37, v68
    v_dot2_f32_bf16 v45, v42, s57, v69
    v_dot2_f32_bf16 v46, v43, s37, v70
    v_dot2_f32_bf16 v47, v43, s57, v71
    v_bitop3_b32 v60, v42, s22, 1 bitop3:0x28
    v_cvt_pk_bf16_f32 v44, v44, v45
    v_cmp_ne_u32 vcc, 0, v60
    v_cvt_pk_bf16_f32 v45, v46, v47
    ds_write_b64 v124, v[44:45] offset:512
    s_waitcnt lgkmcnt(3)
    v_mfma_f32_16x16x32_bf16 v[32:35], v[0:3], v[48:51], 0
    v_mfma_f32_16x16x32_bf16 v[36:39], v[16:19], v[48:51], 0
    s_cbranch_vccnz main_kernel_cf_z1_f
main_kernel_cf_z_ok:
    v_mfma_f32_16x16x32_bf16 v[72:75], v[48:51], v[48:51], 0
    s_waitcnt lgkmcnt(1)
    s_sub_u32 s32, s52, s38
    v_mov_b32 v46, s32
    v_mfma_f32_16x16x32_bf16 v[32:35], v[4:7], v[52:55], v[32:35]
    buffer_load_dwordx2 v[86:87], v123, s[4:7], s19 offen offset:1024 sc1
    buffer_store_dword v46, v117, s[4:7], s46 offen
    s_cmp_eq_u32 s17, 64
    s_waitcnt lgkmcnt(0)
    s_barrier
    ds_read_b64_tr_b16 v[56:57], v115 offset:16896
    ds_read_b64_tr_b16 v[58:59], v115 offset:17920
    ds_read_b64_tr_b16 v[60:61], v115 offset:18944
    ds_read_b64_tr_b16 v[62:63], v115 offset:19968
    s_cbranch_scc1 main_kernel_cf_last
    v_bfe_u32 v47, v123, 1, 7
    buffer_load_dwordx2 v[126:127], v123, s[4:7], s19 offen offset:1024 sc1
    buffer_load_dwordx4 v116, s[4:7], s27 offen offset:1024 sc1 lds
    v_mfma_f32_16x16x32_bf16 v[36:39], v[20:23], v[52:55], v[36:39]
    v_mfma_f32_16x16x32_bf16 v[72:75], v[52:55], v[52:55], v[72:75]
    s_waitcnt lgkmcnt(2)
    v_mfma_f32_16x16x32_bf16 v[72:75], v[56:59], v[56:59], v[72:75]
    v_mfma_f32_16x16x32_bf16 v[32:35], v[8:11], v[56:59], v[32:35]
    s_waitcnt lgkmcnt(0)
    v_mfma_f32_16x16x32_bf16 v[72:75], v[60:63], v[60:63], v[72:75]
    ds_read_b128 v[0:3], v113 offset:16384
    v_mfma_f32_16x16x32_bf16 v[32:35], v[12:15], v[60:63], v[32:35]
    ds_read_b128 v[16:19], v113 offset:18432
    v_mfma_f32_16x16x32_bf16 v[36:39], v[24:27], v[56:59], v[36:39]
    ds_read_b128 v[4:7], v113 offset:17408
    s_nop 0
    v_permlane32_swap_b32 v72, v73
    v_permlane32_swap_b32 v74, v75
    v_mfma_f32_16x16x32_bf16 v[36:39], v[28:31], v[60:63], v[36:39]
    ds_read_b128 v[20:23], v113 offset:19456
    v_mul_f32 v73, s30, v73
    v_mul_f32 v75, s30, v75
    v_exp_f32 v32, v32
    ds_read_b128 v[8:11], v113 offset:24576
    v_exp_f32 v33, v33
    ds_read_b128 v[12:15], v113 offset:25600
    v_exp_f32 v73, v73
    ds_read_b128 v[24:27], v113 offset:26624
    v_exp_f32 v75, v75
    ds_read_b128 v[28:31], v113 offset:27648
    v_exp_f32 v34, v34
    v_cvt_pk_bf16_f32 v72, v73, v75
    v_cvt_pk_bf16_f32 v73, v73, v75
    v_exp_f32 v35, v35
    s_waitcnt vmcnt(4)
    v_mfma_f32_16x16x16_bf16 v[40:43], v[100:101], v[72:73], 0
    v_exp_f32 v36, v36
    v_cvt_pk_bf16_f32 v32, v32, v33
    v_exp_f32 v37, v37
    v_cvt_pk_bf16_f32 v33, v34, v35
    v_exp_f32 v38, v38
    v_exp_f32 v39, v39
    v_cvt_pk_bf16_f32 v34, v36, v37
    v_cvt_pk_bf16_f32 v35, v38, v39
    s_nop 1
    v_mfma_f32_16x16x32_bf16 v[40:43], v[96:99], v[32:35], v[40:43]
    v_mfma_f32_16x16x32_bf16 v[64:67], v[88:91], v[32:35], 0
    v_mfma_f32_16x16x32_bf16 v[68:71], v[92:95], v[32:35], 0
    s_waitcnt vmcnt(3)
main_kernel_cf_v_ok:
    v_bitop3_b32 v44, v86, s22, 1 bitop3:0x28
    v_swap_b32 v85, v86
    v_cmp_ne_u32 vcc, 0, v44
main_kernel_cf_d_ok:
    s_nop 0
    v_mfma_f32_16x16x16_bf16 v[64:67], v[84:85], v[72:73], v[64:67]
    v_mfma_f32_16x16x16_bf16 v[68:71], v[86:87], v[72:73], v[68:71]
    s_cbranch_vccnz main_kernel_cf_v_f
    v_rcp_f32 v42, v40
    v_subrev_u32 v41, 0x21800000, v41
    v_cmp_lt_u32 vcc, 0x3c000000, v41
    s_nop 0
    v_pk_mul_f32 v[64:65], v[64:65], v[42:43] op_sel_hi:[1,0]
    v_pk_mul_f32 v[66:67], v[66:67], v[42:43] op_sel_hi:[1,0]
    v_cvt_pk_bf16_f32 v44, v64, v65
    v_pk_mul_f32 v[68:69], v[68:69], v[42:43] op_sel_hi:[1,0]
    v_cvt_pk_bf16_f32 v45, v66, v67
    v_pk_mul_f32 v[70:71], v[70:71], v[42:43] op_sel_hi:[1,0]
    v_cvt_pk_bf16_f32 v46, v68, v69
    v_cvt_pk_bf16_f32 v47, v70, v71
    ds_write_b128 v118, v[44:47]
    s_and_b64 s[42:43], vcc, s[44:45]
    s_cbranch_scc1 main_kernel_cf_d_f
    s_mov_b64 s[44:45], s[0:1]
    v_mov_b32 v64, 0
    v_mov_b32 v65, 0
    v_mov_b32 v66, 0
    v_mov_b32 v67, 0
    v_mov_b32 v68, 0
    v_mov_b32 v69, 0
    v_mov_b32 v70, 0
    v_mov_b32 v71, 0
    v_bfe_u32 v90, v123, 1, 7
    s_xor_b32 s23, s23, 0x80000
    s_waitcnt lgkmcnt(0)
    s_barrier
    ds_read_b128 v[56:59], v114 offset:1024
    ds_read_b128 v[60:63], v114 offset:1536
    ds_read_b128 v[48:51], v114 offset:0
    ds_read_b128 v[52:55], v114 offset:512
    s_xor_b32 s18, s18, 0x100000
    s_xor_b32 s19, s18, 0x80000
    s_xor_b32 s25, s25, 0x4000
    s_add_u32 s27, s27, 0x40000
    v_add_u32 v121, 4, v121
    v_xor_b32 v112, 0x4000, v112
    s_xor_b32 s36, s36, 0x4000
    s_mov_b32 m0, 0
    s_mov_b32 s54, s24
    s_xor_b32 s24, s24, 0x4000
    s_add_u32 s55, s25, 4096
    v_mov_b32 v89, s17
    s_mov_b32 s15, 0
    s_add_u32 s56, s19, 1536
    s_xor_b32 s9, s11, s40
    s_add_u32 s16, s20, s38
    s_waitcnt lgkmcnt(3)
    v_smfmac_f32_16x16x64_bf16 v[76:79], v[56:59], v[0:7], v110
    s_waitcnt lgkmcnt(2)
    ds_read_b128 v[0:3], v113 offset:20480
    v_smfmac_f32_16x16x64_bf16 v[76:79], v[60:63], v[8:15], v110
    s_waitcnt lgkmcnt(2)
    ds_read_b128 v[4:7], v113 offset:21504
    v_smfmac_f32_16x16x64_bf16 v[76:79], v[48:51], v[192:199], v110
    s_waitcnt lgkmcnt(2)
    ds_read_b128 v[8:11], v113 offset:28672
    v_smfmac_f32_16x16x64_bf16 v[76:79], v[52:55], v[200:207], v110
    ds_read_b128 v[12:15], v113 offset:29696
    buffer_load_dword v111, v90, s[4:7], s47 offen sc1
    v_smfmac_f32_16x16x64_bf16 v[80:83], v[56:59], v[16:23], v110
    ds_read_b128 v[16:19], v113 offset:22528
    v_smfmac_f32_16x16x64_bf16 v[80:83], v[60:63], v[24:31], v110
    ds_read_b128 v[20:23], v113 offset:23552
    v_smfmac_f32_16x16x64_bf16 v[80:83], v[48:51], v[208:215], v110
    ds_read_b128 v[24:27], v113 offset:30720
    v_cvt_pk_f16_f32 v40, v76, v77
    v_smfmac_f32_16x16x64_bf16 v[80:83], v[52:55], v[216:223], v110
    ds_read_b128 v[28:31], v113 offset:31744
    v_cvt_pk_f16_f32 v41, v78, v79
    v_smfmac_f32_16x16x64_bf16 v[64:67], v[48:51], v[224:231], v110
    v_bfi_b32 v40, 1, s22, v40
    v_smfmac_f32_16x16x64_bf16 v[64:67], v[52:55], v[232:239], v110
    s_waitcnt lgkmcnt(6)
    buffer_load_dword v111, v90, s[4:7], s47 offen sc1
    v_smfmac_f32_16x16x64_bf16 v[64:67], v[56:59], v[0:7], v110
    s_waitcnt lgkmcnt(4)
    buffer_store_dwordx2 v[40:41], v119, s[4:7], s21 offen offset:0
    v_cvt_pk_f16_f32 v42, v80, v81
    v_smfmac_f32_16x16x64_bf16 v[64:67], v[60:63], v[8:15], v110
    v_cvt_pk_f16_f32 v43, v82, v83
    v_smfmac_f32_16x16x64_bf16 v[68:71], v[48:51], v[240:247], v110
    v_bfi_b32 v42, 1, s22, v42
    v_smfmac_f32_16x16x64_bf16 v[68:71], v[52:55], v[248:255], v110
    s_waitcnt lgkmcnt(2)
    v_smfmac_f32_16x16x64_bf16 v[68:71], v[56:59], v[16:23], v110
    s_waitcnt lgkmcnt(0)
    buffer_store_dwordx2 v[42:43], v119, s[4:7], s21 offen offset:512
    v_cvt_pk_f16_f32 v44, v64, v65
    v_smfmac_f32_16x16x64_bf16 v[68:71], v[60:63], v[24:31], v110
    v_cvt_pk_f16_f32 v45, v66, v67
    v_bfi_b32 v44, 1, s22, v44
    s_cmp_lg_u32 s14, 0
    buffer_store_dwordx2 v[44:45], v119, s[4:7], s21 offen offset:1024
    s_nop 3
    v_cvt_pk_f16_f32 v46, v68, v69
    v_cvt_pk_f16_f32 v47, v70, v71
    v_bfi_b32 v46, 1, s22, v46
    buffer_store_dwordx2 v[46:47], v119, s[4:7], s21 offen offset:1536
    s_cbranch_scc1 main_kernel_cf_wx
    s_waitcnt vmcnt(5)
    s_xor_b32 s21, s21, 0x80000
main_kernel_cf_rgo:
    v_subrev_u32 v32, s20, v111
    s_memtime s[52:53]
    v_cmp_lt_u32 vcc, 0x100000, v32
    v_max_u32_dpp v32, v32, v32 row_shr:1 row_mask:0xf bank_mask:0xf
    s_nop 0
    s_nop 0
    v_max_u32_dpp v32, v32, v32 row_shr:2 row_mask:0xf bank_mask:0xf
    s_nop 0
    s_cbranch_vccnz main_kernel_cf_fsp
main_kernel_cf_fok:
    s_nop 0
    v_max_u32_dpp v32, v32, v32 row_shr:4 row_mask:0xf bank_mask:0xf
    s_memtime s[52:53]
    s_nop 0
    v_max_u32_dpp v32, v32, v32 row_shr:8 row_mask:0xf bank_mask:0xf
    s_memtime s[52:53]
    s_nop 0
    v_max_u32_dpp v32, v32, v32 row_bcast:15 row_mask:0xa bank_mask:0xf
    s_memtime s[52:53]
    s_sub_u32 s33, s52, s16
    v_readlane_b32 s32, v32, 31
    s_add_u32 s33, s33, 0x400
    s_memtime s[52:53]
    s_add_u32 s34, s16, 1650
    s_memtime s[52:53]
    s_min_u32 s32, s32, s33
    s_max_u32 s32, s32, s15
    s_add_u32 s34, s34, s32
    s_mov_b32 s35, 200
main_kernel_cf_fw:
    s_memtime s[52:53]
    s_cmp_ge_u32 s52, s34
    s_cbranch_scc1 main_kernel_cf_fgo
    s_memtime s[52:53]
    s_cmp_ge_u32 s52, s34
    s_cbranch_scc1 main_kernel_cf_fgo
    s_memtime s[52:53]
    s_cmp_ge_u32 s52, s34
    s_cbranch_scc1 main_kernel_cf_fgo
    s_memtime s[52:53]
    s_cmp_ge_u32 s52, s34
    s_cbranch_scc1 main_kernel_cf_fgo
    s_memtime s[52:53]
    s_cmp_ge_u32 s52, s34
    s_cbranch_scc1 main_kernel_cf_fgo
    s_memtime s[52:53]
    s_cmp_ge_u32 s52, s34
    s_cbranch_scc1 main_kernel_cf_fgo
    s_memtime s[52:53]
    s_cmp_ge_u32 s52, s34
    s_cbranch_scc1 main_kernel_cf_fgo
    s_memtime s[52:53]
    s_cmp_ge_u32 s52, s34
    s_cbranch_scc1 main_kernel_cf_fgo
    s_sub_u32 s35, s35, 1
    s_cbranch_scc0 main_kernel_cf_fw
main_kernel_cf_fgo:
    buffer_load_dwordx4 v[0:3], v120, s[4:7], s23 offen sc1
    s_add_u32 s35, s23, 0x8000
    buffer_load_dwordx4 v[4:7], v120, s[4:7], s35 offen sc1
    s_add_u32 s35, s23, 0x10000
    buffer_load_dwordx4 v[8:11], v120, s[4:7], s35 offen sc1
    ds_read_b32 v33, v123 offset:20992
    s_add_u32 s35, s23, 0x18000
    buffer_load_dwordx4 v[12:15], v120, s[4:7], s35 offen sc1
    s_add_u32 s35, s23, 0x20000
    buffer_load_dwordx4 v[16:19], v120, s[4:7], s35 offen sc1
    s_add_u32 s35, s23, 0x28000
    buffer_load_dwordx4 v[20:23], v120, s[4:7], s35 offen sc1
    s_add_u32 s35, s23, 0x30000
    buffer_load_dwordx4 v[24:27], v120, s[4:7], s35 offen sc1
    s_add_u32 s35, s23, 0x38000
    buffer_load_dwordx4 v[28:31], v120, s[4:7], s35 offen sc1
    s_mov_b64 exec, 1
    s_waitcnt lgkmcnt(0)
    v_sub_u32 v33, s34, v33
    v_bfi_b32 v33, 1, s40, v33
    buffer_store_dword v33, off, s[4:7], s18 offset:1536 sc1
    v_readfirstlane_b32 s10, v33
    s_mov_b64 exec, -1
    s_waitcnt vmcnt(8)
    v_mfma_f32_16x16x32_f16 v[76:79], v[0:3], v[106:109], 0
    v_xor_b32 v36, s22, v0
    v_bitop3_b32 v36, v2, s22, v36 bitop3:0xbe
    s_waitcnt vmcnt(7)
    v_mfma_f32_16x16x32_f16 v[76:79], v[4:7], v[106:109], v[76:79]
    v_bitop3_b32 v36, v4, s22, v36 bitop3:0xbe
    v_bitop3_b32 v36, v6, s22, v36 bitop3:0xbe
    s_waitcnt vmcnt(6)
    v_mfma_f32_16x16x32_f16 v[76:79], v[8:11], v[106:109], v[76:79]
    v_bitop3_b32 v36, v8, s22, v36 bitop3:0xbe
    v_bitop3_b32 v36, v10, s22, v36 bitop3:0xbe
    s_waitcnt vmcnt(5)
    v_mfma_f32_16x16x32_f16 v[76:79], v[12:15], v[106:109], v[76:79]
    v_bitop3_b32 v36, v12, s22, v36 bitop3:0xbe
    v_bitop3_b32 v36, v14, s22, v36 bitop3:0xbe
    s_waitcnt vmcnt(4)
    v_mfma_f32_16x16x32_f16 v[76:79], v[16:19], v[106:109], v[76:79]
    v_bitop3_b32 v36, v16, s22, v36 bitop3:0xbe
    v_bitop3_b32 v36, v18, s22, v36 bitop3:0xbe
    s_waitcnt vmcnt(3)
    v_mfma_f32_16x16x32_f16 v[76:79], v[20:23], v[106:109], v[76:79]
    v_bitop3_b32 v36, v20, s22, v36 bitop3:0xbe
    v_bitop3_b32 v36, v22, s22, v36 bitop3:0xbe
    s_waitcnt vmcnt(2)
    v_mfma_f32_16x16x32_f16 v[76:79], v[24:27], v[106:109], v[76:79]
    v_bitop3_b32 v36, v24, s22, v36 bitop3:0xbe
    v_bitop3_b32 v36, v26, s22, v36 bitop3:0xbe
    s_waitcnt vmcnt(1)
    v_mfma_f32_16x16x32_f16 v[76:79], v[28:31], v[106:109], v[76:79]
    v_bitop3_b32 v36, v28, s22, v36 bitop3:0xbe
    v_bitop3_b32 v36, v30, s22, v36 bitop3:0xbe
    v_and_b32 v36, 1, v36
    v_cmp_ne_u32 vcc, 0, v36
    s_nop 3
    v_cvt_pk_bf16_f32 v126, v76, v77
    v_cvt_pk_bf16_f32 v127, v78, v79
    s_cbranch_vccnz main_kernel_cf_r_f
    buffer_store_dwordx2 v[126:127], v122, s[4:7], s24 offen
    s_sub_u32 s20, s34, s38
    s_mov_b32 s3, s34
    buffer_store_dword v89, v117, s[4:7], s46 offen offset:512
    v_mov_b32 v32, -1
    v_mov_b32 v33, -1
    v_mov_b32 v64, 0
    v_mov_b32 v65, 0
    v_mov_b32 v66, 0
    v_mov_b32 v67, 0
    v_mov_b32 v68, 0
    v_mov_b32 v69, 0
    v_mov_b32 v70, 0
    v_mov_b32 v71, 0
    v_mov_b32 v96, 0
    v_mov_b32 v97, 0
    v_mov_b32 v98, 0
    v_mov_b32 v99, 0
    buffer_store_dwordx2 v[32:33], v122, s[4:7], s54 offen
    s_cmp_eq_u32 s12, 0
    v_add_u32 v56, s59, v115
    s_cbranch_scc0 main_kernel_cf_vma
    ds_read_b64_tr_b16 v[80:81], v56 offset:16384
    ds_read_b64_tr_b16 v[82:83], v56 offset:17408
    s_waitcnt lgkmcnt(0)
    s_nop 15
    s_nop 15
    s_nop 5
    s_buffer_load_dword s9, s[4:7], s56 glc
    buffer_load_dword v111, v90, s[4:7], s47 offen offset:512 sc1
    buffer_load_dwordx4 v116, s[4:7], s25 offen offset:0 sc1 lds
    buffer_load_dwordx4 v116, s[4:7], s25 offen offset:1024 sc1 lds
    buffer_load_dwordx4 v116, s[4:7], s25 offen offset:2048 sc1 lds
    buffer_load_dwordx4 v116, s[4:7], s25 offen offset:3072 sc1 lds
    s_mov_b32 m0, 4096
    s_nop 0
    buffer_load_dwordx4 v116, s[4:7], s55 offen offset:0 sc1 lds
    buffer_load_dwordx4 v116, s[4:7], s55 offen offset:1024 sc1 lds
    buffer_load_dwordx4 v116, s[4:7], s55 offen offset:2048 sc1 lds
    buffer_load_dwordx4 v116, s[4:7], s55 offen offset:3072 sc1 lds
    v_mov_b32 v34, v90
    s_mov_b32 m0, s36
    s_barrier
    ds_read_b32 v35, v123 offset:20480
    buffer_load_dwordx4 v[88:91], v116, s[4:7], s28 offen offset:0 sc1
    buffer_load_dwordx4 v[92:95], v116, s[4:7], s28 offen offset:1024 sc1
    buffer_load_dwordx4 v116, s[4:7], s27 offen offset:0 sc1 lds
    buffer_store_dwordx4 v[80:83], v125, s[4:7], s26 offen sc1
    s_branch main_kernel_cf_kva
main_kernel_cf_vma:
    v_mfma_f32_16x16x32_bf16 v[56:59], v[102:105], v[84:87], 0
    s_nop 7
    v_cvt_pk_bf16_f32 v80, v56, v57
    v_cvt_pk_bf16_f32 v81, v58, v59
    s_nop 15
    s_nop 15
    s_nop 5
    s_buffer_load_dword s9, s[4:7], s56 glc
    buffer_load_dword v111, v90, s[4:7], s47 offen offset:512 sc1
    buffer_load_dwordx4 v116, s[4:7], s25 offen offset:0 sc1 lds
    buffer_load_dwordx4 v116, s[4:7], s25 offen offset:1024 sc1 lds
    buffer_load_dwordx4 v116, s[4:7], s25 offen offset:2048 sc1 lds
    buffer_load_dwordx4 v116, s[4:7], s25 offen offset:3072 sc1 lds
    s_mov_b32 m0, 4096
    s_nop 0
    buffer_load_dwordx4 v116, s[4:7], s55 offen offset:0 sc1 lds
    buffer_load_dwordx4 v116, s[4:7], s55 offen offset:1024 sc1 lds
    buffer_load_dwordx4 v116, s[4:7], s55 offen offset:2048 sc1 lds
    buffer_load_dwordx4 v116, s[4:7], s55 offen offset:3072 sc1 lds
    v_mov_b32 v34, v90
    s_mov_b32 m0, s36
    s_barrier
    ds_read_b32 v35, v123 offset:20480
    buffer_load_dwordx4 v[88:91], v116, s[4:7], s28 offen offset:0 sc1
    buffer_load_dwordx4 v[92:95], v116, s[4:7], s28 offen offset:1024 sc1
    buffer_load_dwordx4 v116, s[4:7], s27 offen offset:0 sc1 lds
    buffer_store_dwordx2 v[80:81], v123, s[4:7], s26 offen sc1
main_kernel_cf_kva:
    s_add_u32 s26, s26, 0x10000
    s_waitcnt vmcnt(12)
    v_cmp_gt_i32 vcc, s17, v111
    v_readfirstlane_b32 s38, v35
    s_cbranch_vccnz main_kernel_cf_mc_f
    s_waitcnt vmcnt(4)
    s_branch main_kernel_cf_top
main_kernel_cf_wx:
    s_cmp_lg_u32 s14, 1
    s_cbranch_scc1 main_kernel_cf_wy
    s_memrealtime s[32:33]
    s_nop 0
    s_nop 0
    s_memrealtime s[32:33]
    s_nop 0
    s_nop 0
    s_memrealtime s[32:33]
    s_nop 0
    s_nop 0
    s_memrealtime s[32:33]
    s_nop 0
    s_nop 0
    s_memrealtime s[32:33]
    s_nop 0
    s_nop 0
    s_memrealtime s[32:33]
    s_nop 0
    s_nop 0
    s_memrealtime s[32:33]
    s_nop 0
    s_nop 0
    s_memrealtime s[32:33]
    s_nop 0
    s_nop 0
    s_memrealtime s[32:33]
    s_nop 0
    s_nop 0
    s_memrealtime s[32:33]
    s_nop 0
    s_nop 0
    s_memrealtime s[32:33]
    s_nop 0
    s_nop 0
    s_memrealtime s[32:33]
    s_nop 0
    s_nop 0
    s_mov_b32 s34, s32
    s_memrealtime s[32:33]
    s_cmp_lg_u32 s32, s34
    s_cbranch_scc1 main_kernel_cf_e1
    s_memrealtime s[32:33]
    s_cmp_lg_u32 s32, s34
    s_cbranch_scc1 main_kernel_cf_e1
    s_memrealtime s[32:33]
    s_cmp_lg_u32 s32, s34
    s_cbranch_scc1 main_kernel_cf_e1
    s_memrealtime s[32:33]
    s_cmp_lg_u32 s32, s34
    s_cbranch_scc1 main_kernel_cf_e1
    s_memrealtime s[32:33]
    s_cmp_lg_u32 s32, s34
    s_cbranch_scc1 main_kernel_cf_e1
    s_memrealtime s[32:33]
    s_cmp_lg_u32 s32, s34
    s_cbranch_scc1 main_kernel_cf_e1
    s_memrealtime s[32:33]
    s_cmp_lg_u32 s32, s34
    s_cbranch_scc1 main_kernel_cf_e1
    s_memrealtime s[32:33]
    s_cmp_lg_u32 s32, s34
    s_cbranch_scc1 main_kernel_cf_e1
    s_memrealtime s[32:33]
    s_cmp_lg_u32 s32, s34
    s_cbranch_scc1 main_kernel_cf_e1
    s_memrealtime s[32:33]
    s_cmp_lg_u32 s32, s34
    s_cbranch_scc1 main_kernel_cf_e1
    s_memrealtime s[32:33]
    s_cmp_lg_u32 s32, s34
    s_cbranch_scc1 main_kernel_cf_e1
    s_memrealtime s[32:33]
    s_cmp_lg_u32 s32, s34
    s_cbranch_scc1 main_kernel_cf_e1
main_kernel_cf_e1:
    s_memtime s[52:53]
    s_mul_i32 s34, s32, 22
    s_waitcnt lgkmcnt(0)
    s_sub_u32 s32, s52, s34
    s_sub_u32 s33, s32, s38
    s_sub_u32 s33, s33, s10
    s_max_i32 s33, s33, -400
    s_min_i32 s33, s33, 400
    s_ashr_i32 s33, s33, 2
    s_add_u32 s10, s10, s33
    s_mov_b32 s33, s10
    s_ashr_i32 s34, s33, 2
    s_add_u32 s34, s34, s32
    v_mov_b32 v34, s34
    v_mov_b32 v33, s32
    ds_write2st64_b32 v123, v33, v34 offset0:80 offset1:82
    v_add_u32 v37, s33, v34
main_kernel_cf_wy:
    s_xor_b32 s21, s21, 0x80000
    v_mov_b32 v64, 0
    v_mov_b32 v65, 0
    v_mov_b32 v66, 0
    v_mov_b32 v67, 0
    v_mov_b32 v68, 0
    v_mov_b32 v69, 0
    v_mov_b32 v70, 0
    v_mov_b32 v71, 0
    v_mov_b32 v96, 0
    v_mov_b32 v97, 0
    v_mov_b32 v98, 0
    v_mov_b32 v99, 0
    s_cmp_eq_u32 s12, 0
    v_add_u32 v56, s59, v115
    s_cbranch_scc0 main_kernel_cf_vmb
    ds_read_b64_tr_b16 v[80:81], v56 offset:16384
    ds_read_b64_tr_b16 v[82:83], v56 offset:17408
    s_waitcnt lgkmcnt(0)
    s_waitcnt vmcnt(0)
    s_mov_b32 m0, s36
    s_barrier
    ds_read_b32 v35, v123 offset:20480
    ds_write_b32 v124, v37 offset:3584
    buffer_load_dwordx4 v[88:91], v116, s[4:7], s28 offen offset:0 sc1
    buffer_load_dwordx4 v[92:95], v116, s[4:7], s28 offen offset:1024 sc1
    buffer_load_dwordx4 v116, s[4:7], s27 offen offset:0 sc1 lds
    buffer_store_dwordx4 v[80:83], v125, s[4:7], s26 offen sc1
    s_branch main_kernel_cf_kvb
main_kernel_cf_vmb:
    v_mfma_f32_16x16x32_bf16 v[56:59], v[102:105], v[84:87], 0
    s_nop 7
    v_cvt_pk_bf16_f32 v80, v56, v57
    v_cvt_pk_bf16_f32 v81, v58, v59
    s_waitcnt vmcnt(0)
    s_mov_b32 m0, s36
    s_barrier
    ds_read_b32 v35, v123 offset:20480
    ds_write_b32 v124, v37 offset:3584
    buffer_load_dwordx4 v[88:91], v116, s[4:7], s28 offen offset:0 sc1
    buffer_load_dwordx4 v[92:95], v116, s[4:7], s28 offen offset:1024 sc1
    buffer_load_dwordx4 v116, s[4:7], s27 offen offset:0 sc1 lds
    buffer_store_dwordx2 v[80:81], v123, s[4:7], s26 offen sc1
main_kernel_cf_kvb:
    s_add_u32 s26, s26, 0x10000
    s_mov_b64 exec, 1
    buffer_store_dword v100, off, s[4:7], s39 sc1
    s_mov_b64 exec, -1
    s_add_u32 s39, s39, 4
    s_waitcnt lgkmcnt(0)
    v_readfirstlane_b32 s38, v35
    v_mov_b32 v35, 0
    v_mov_b32 v35, 0
    v_mov_b32 v35, 0
    v_mov_b32 v35, 0
    v_mov_b32 v35, 0
    v_mov_b32 v35, 0
main_kernel_cf_end:
    s_branch main_kernel_cf_top
main_kernel_cf_mc_f:
    s_mov_b32 m0, 0
    s_sub_u32 s29, s29, 1
    s_cbranch_scc1 main_kernel_end
    buffer_load_dword v111, v34, s[4:7], s47 offen offset:512 sc1
    buffer_load_dwordx4 v116, s[4:7], s25 offen offset:0 sc1 lds
    buffer_load_dwordx4 v116, s[4:7], s25 offen offset:1024 sc1 lds
    buffer_load_dwordx4 v116, s[4:7], s25 offen offset:2048 sc1 lds
    buffer_load_dwordx4 v116, s[4:7], s25 offen offset:3072 sc1 lds
    s_mov_b32 m0, 4096
    s_nop 0
    buffer_load_dwordx4 v116, s[4:7], s55 offen offset:0 sc1 lds
    buffer_load_dwordx4 v116, s[4:7], s55 offen offset:1024 sc1 lds
    buffer_load_dwordx4 v116, s[4:7], s55 offen offset:2048 sc1 lds
    buffer_load_dwordx4 v116, s[4:7], s55 offen offset:3072 sc1 lds
    s_waitcnt vmcnt(8)
    v_cmp_gt_i32 vcc, s17, v111
    v_readfirstlane_b32 s38, v35
    s_cbranch_vccnz main_kernel_cf_mc_f
    s_waitcnt vmcnt(0)
    s_branch main_kernel_cf_end
main_kernel_cf_t_w:
    s_mov_b32 s35, 200
main_kernel_cf_t_s:
    s_memtime s[52:53]
    s_cmp_ge_u32 s52, s34
    s_cbranch_scc1 main_kernel_cf_t_go
    s_memtime s[52:53]
    s_cmp_ge_u32 s52, s34
    s_cbranch_scc1 main_kernel_cf_t_go
    s_memtime s[52:53]
    s_cmp_ge_u32 s52, s34
    s_cbranch_scc1 main_kernel_cf_t_go
    s_memtime s[52:53]
    s_cmp_ge_u32 s52, s34
    s_cbranch_scc1 main_kernel_cf_t_go
    s_memtime s[52:53]
    s_cmp_ge_u32 s52, s34
    s_cbranch_scc1 main_kernel_cf_t_go
    s_memtime s[52:53]
    s_cmp_ge_u32 s52, s34
    s_cbranch_scc1 main_kernel_cf_t_go
    s_memtime s[52:53]
    s_cmp_ge_u32 s52, s34
    s_cbranch_scc1 main_kernel_cf_t_go
    s_memtime s[52:53]
    s_cmp_ge_u32 s52, s34
    s_cbranch_scc1 main_kernel_cf_t_go
    s_sub_u32 s35, s35, 1
    s_cbranch_scc0 main_kernel_cf_t_s
    s_branch main_kernel_cf_t_go
main_kernel_cf_t_p:
    s_waitcnt lgkmcnt(0)
    s_xor_b32 s32, s9, s22
    s_bitcmp1_b32 s32, 0
    s_cbranch_scc0 main_kernel_cf_t_ok
    s_buffer_load_dword s9, s[4:7], s56 glc
    s_sub_u32 s29, s29, 1
    s_cbranch_scc1 main_kernel_end
    s_branch main_kernel_cf_t_p
main_kernel_cf_z0_f:
    buffer_load_dwordx2 v[126:127], v123, s[4:7], s19 offen offset:0 sc1
    s_sub_u32 s29, s29, 1
    s_cbranch_scc1 main_kernel_end
    s_waitcnt vmcnt(0)
    s_branch main_kernel_cf_z0
main_kernel_cf_z2_f:
    buffer_load_dwordx2 v[64:65], v123, s[4:7], s19 offen offset:512 sc1
    s_sub_u32 s29, s29, 1
    s_cbranch_scc1 main_kernel_end
    s_waitcnt vmcnt(0)
main_kernel_cf_z1_f:
    s_waitcnt vmcnt(0)
    s_memtime s[52:53]
    v_dot2_f32_bf16 v44, v64, s37, v68
    v_dot2_f32_bf16 v45, v64, s57, v69
    v_dot2_f32_bf16 v46, v65, s37, v70
    v_dot2_f32_bf16 v47, v65, s57, v71
    v_bitop3_b32 v60, v64, s22, 1 bitop3:0x28
    v_cvt_pk_bf16_f32 v44, v44, v45
    v_cmp_ne_u32 vcc, 0, v60
    v_cvt_pk_bf16_f32 v45, v46, v47
    ds_write_b64 v124, v[44:45] offset:512
    s_cbranch_vccnz main_kernel_cf_z2_f
    s_branch main_kernel_cf_z_ok
main_kernel_cf_kvw:
    s_cmp_eq_u32 s17, 64
    s_cbranch_scc1 main_kernel_cf_kvok
    s_waitcnt vmcnt(0)
    s_mov_b32 exec_lo, 0
    s_mov_b32 exec_hi, 0x3f00
    v_subrev_u32 v127, 0, v121
main_kernel_cf_kvp:
    buffer_load_dword v126, v127, s[4:7], 0 offen sc1
    s_waitcnt vmcnt(0)
    v_cmp_eq_u32 vcc, 0, v126
    s_cbranch_vccz main_kernel_cf_kvp_ok
    s_sleep 2
    s_sub_u32 s29, s29, 1
    s_cbranch_scc0 main_kernel_cf_kvp
    s_branch main_kernel_end
main_kernel_cf_kvp_ok:
    s_mov_b64 exec, -1
    s_branch main_kernel_cf_kvok
main_kernel_cf_las2:
    buffer_load_dwordx2 v[86:87], v123, s[4:7], s19 offen offset:1024 sc1
    s_sub_u32 s29, s29, 1
    s_cbranch_scc1 main_kernel_end
main_kernel_cf_last:
    s_cmp_eq_u32 s12, 0
    s_cbranch_scc1 main_kernel_cf_las3
    s_waitcnt vmcnt(0) lgkmcnt(0)
    v_bitop3_b32 v44, v86, s22, 1 bitop3:0x28
    v_cmp_ne_u32 vcc, 0, v44
    s_cbranch_vccnz main_kernel_cf_las2
    v_swap_b32 v85, v86
main_kernel_cf_las3:
    s_waitcnt lgkmcnt(0)
    s_cmp_eq_u32 s12, 0
    v_add_u32 v56, s59, v115
    s_cbranch_scc0 main_kernel_cf_vmc
    ds_read_b64_tr_b16 v[80:81], v56 offset:16384
    ds_read_b64_tr_b16 v[82:83], v56 offset:17408
    s_waitcnt lgkmcnt(0)
    buffer_store_dwordx4 v[80:83], v125, s[4:7], s26 offen sc1
    s_branch main_kernel_cf_kvc
main_kernel_cf_vmc:
    v_mfma_f32_16x16x32_bf16 v[56:59], v[102:105], v[84:87], 0
    s_nop 7
    v_cvt_pk_bf16_f32 v80, v56, v57
    v_cvt_pk_bf16_f32 v81, v58, v59
    buffer_store_dwordx2 v[80:81], v123, s[4:7], s26 offen sc1
main_kernel_cf_kvc:
    s_add_u32 s26, s26, 0x10000
    s_branch main_kernel_end
main_kernel_cf_m_f:
main_kernel_cf_m_t:
    ds_read_b128 v[0:3], v116 offset:0
    ds_read_b128 v[4:7], v116 offset:1024
    ds_read_b128 v[8:11], v116 offset:2048
    ds_read_b128 v[12:15], v116 offset:3072
    ds_read_b128 v[16:19], v116 offset:4096
    ds_read_b128 v[20:23], v116 offset:5120
    ds_read_b128 v[24:27], v116 offset:6144
    ds_read_b128 v[28:31], v116 offset:7168
    s_waitcnt lgkmcnt(0)
    v_max_u32 v126, v0, v2
    v_max3_u32 v126, v126, v4, v6
    v_max3_u32 v126, v126, v8, v10
    v_max3_u32 v126, v126, v12, v14
    v_max3_u32 v126, v126, v16, v18
    v_max3_u32 v126, v126, v20, v22
    v_max3_u32 v126, v126, v24, v26
    v_max3_u32 v126, v126, v28, v30
    v_cmp_eq_u32 vcc, -1, v126
    s_cbranch_vccz main_kernel_cf_m_g
    s_barrier
    s_lshl_b32 s32, s14, 11
    s_add_u32 m0, s32, 0
    s_add_u32 s32, s32, s25
    buffer_load_dwordx4 v116, s[4:7], s32 offen offset:0 sc1 lds
    buffer_load_dwordx4 v116, s[4:7], s32 offen offset:1024 sc1 lds
    s_sub_u32 s29, s29, 1
    s_cbranch_scc1 main_kernel_end
    s_waitcnt vmcnt(0)
    s_barrier
    s_branch main_kernel_cf_m_t
main_kernel_cf_m_g:
    s_mov_b64 s[44:45], 0
    v_mov_b32 v64, 0
    v_mov_b32 v65, 0
    v_mov_b32 v66, 0
    v_mov_b32 v67, 0
    v_mov_b32 v68, 0
    v_mov_b32 v69, 0
    v_mov_b32 v70, 0
    v_mov_b32 v71, 0
    v_mov_b32 v96, 0
    v_mov_b32 v97, 0
    v_mov_b32 v98, 0
    v_mov_b32 v99, 0
    s_branch main_kernel_cf_mrd
main_kernel_cf_v_f:
    v_swap_b32 v85, v86
    s_nop 7
    s_waitcnt vmcnt(1)
main_kernel_cf_v_t:
    s_memtime s[52:53]
    v_bitop3_b32 v44, v126, s22, 1 bitop3:0x28
    v_cmp_ne_u32 vcc, 0, v44
    s_sub_u32 s29, s29, 1
    s_cbranch_scc1 main_kernel_end
    s_cbranch_vccnz main_kernel_cf_v_g
    v_mfma_f32_16x16x32_bf16 v[64:67], v[88:91], v[32:35], 0
    v_mfma_f32_16x16x32_bf16 v[68:71], v[92:95], v[32:35], 0
    v_mov_b32 v86, v126
    v_mov_b32 v87, v127
    s_waitcnt lgkmcnt(0)
    s_sub_u32 s32, s52, s38
    s_add_u32 s32, s32, -550
    v_mov_b32 v46, s32
    buffer_store_dword v46, v117, s[4:7], s46 offen
    s_branch main_kernel_cf_v_ok
main_kernel_cf_v_g:
    buffer_load_dwordx2 v[126:127], v123, s[4:7], s19 offen offset:1024 sc1
    s_waitcnt lgkmcnt(0)
    s_sub_u32 s32, s52, s38
    s_add_u32 s32, s32, -50
    v_mov_b32 v46, s32
    buffer_store_dword v46, v117, s[4:7], s46 offen
    s_waitcnt vmcnt(0)
    s_branch main_kernel_cf_v_t
main_kernel_cf_d_f:
    s_memtime s[52:53]
    s_waitcnt vmcnt(1) lgkmcnt(0)
    s_sub_u32 s32, s52, s38
    s_add_u32 s32, s32, 300
    v_mov_b32 v46, s32
    buffer_store_dword v46, v117, s[4:7], s46 offen
    ds_read_b128 v[0:3], v112 offset:0
    ds_read_b128 v[4:7], v112 offset:1024
    ds_read_b128 v[8:11], v112 offset:2048
    ds_read_b128 v[12:15], v112 offset:3072
    ds_read_b128 v[16:19], v112 offset:4096
    ds_read_b128 v[20:23], v112 offset:5120
    ds_read_b128 v[24:27], v112 offset:6144
    ds_read_b128 v[28:31], v112 offset:7168
    s_waitcnt lgkmcnt(0)
    v_mfma_f32_16x16x32_bf16 v[32:35], v[0:3], v[48:51], 0
    v_mfma_f32_16x16x32_bf16 v[36:39], v[16:19], v[48:51], 0
    v_mfma_f32_16x16x32_bf16 v[72:75], v[48:51], v[48:51], 0
    v_mfma_f32_16x16x32_bf16 v[32:35], v[4:7], v[52:55], v[32:35]
    v_mfma_f32_16x16x32_bf16 v[36:39], v[20:23], v[52:55], v[36:39]
    v_mfma_f32_16x16x32_bf16 v[72:75], v[52:55], v[52:55], v[72:75]
    v_mfma_f32_16x16x32_bf16 v[32:35], v[8:11], v[56:59], v[32:35]
    v_mfma_f32_16x16x32_bf16 v[36:39], v[24:27], v[56:59], v[36:39]
    v_mfma_f32_16x16x32_bf16 v[72:75], v[56:59], v[56:59], v[72:75]
    v_mfma_f32_16x16x32_bf16 v[32:35], v[12:15], v[60:63], v[32:35]
    v_mfma_f32_16x16x32_bf16 v[36:39], v[28:31], v[60:63], v[36:39]
    v_mfma_f32_16x16x32_bf16 v[72:75], v[60:63], v[60:63], v[72:75]
    s_nop 7
    ds_read_b128 v[0:3], v113 offset:16384
    ds_read_b128 v[16:19], v113 offset:18432
    ds_read_b128 v[4:7], v113 offset:17408
    ds_read_b128 v[20:23], v113 offset:19456
    ds_read_b128 v[8:11], v113 offset:24576
    ds_read_b128 v[24:27], v113 offset:26624
    ds_read_b128 v[12:15], v113 offset:25600
    ds_read_b128 v[28:31], v113 offset:27648
    v_permlane32_swap_b32 v72, v73
    v_permlane32_swap_b32 v74, v75
    v_mul_f32 v73, s30, v73
    v_mul_f32 v75, s30, v75
    v_max_f32 v126, v73, v75
    v_max3_f32 v126, v126, v32, v33
    v_max3_f32 v126, v126, v34, v35
    v_max3_f32 v126, v126, v36, v37
    v_max3_f32 v126, v126, v38, v39
    v_mov_b32 v127, v126
    s_nop 1
    v_permlane32_swap_b32 v126, v127
    v_max_f32 v126, v126, v127
    v_mov_b32 v127, v126
    s_nop 1
    v_permlane16_swap_b32 v126, v127
    v_max_f32 v126, v126, v127
    v_sub_f32 v32, v32, v126
    v_sub_f32 v33, v33, v126
    v_sub_f32 v34, v34, v126
    v_sub_f32 v35, v35, v126
    v_sub_f32 v36, v36, v126
    v_sub_f32 v37, v37, v126
    v_sub_f32 v38, v38, v126
    v_sub_f32 v39, v39, v126
    v_sub_f32 v73, v73, v126
    v_sub_f32 v75, v75, v126
    v_exp_f32 v32, v32
    v_exp_f32 v33, v33
    v_exp_f32 v34, v34
    v_exp_f32 v35, v35
    v_exp_f32 v36, v36
    v_exp_f32 v37, v37
    v_exp_f32 v38, v38
    v_exp_f32 v39, v39
    v_exp_f32 v73, v73
    v_exp_f32 v75, v75
    v_cvt_pk_bf16_f32 v32, v32, v33
    v_cvt_pk_bf16_f32 v33, v34, v35
    v_cvt_pk_bf16_f32 v34, v36, v37
    v_cvt_pk_bf16_f32 v35, v38, v39
    v_cvt_pk_bf16_f32 v72, v73, v75
    v_cvt_pk_bf16_f32 v73, v73, v75
    s_nop 1
    v_mfma_f32_16x16x32_bf16 v[64:67], v[88:91], v[32:35], 0
    v_mfma_f32_16x16x32_bf16 v[68:71], v[92:95], v[32:35], 0
    v_mfma_f32_16x16x32_bf16 v[40:43], v[96:99], v[32:35], 0
    s_nop 3
    s_nop 1
    v_mfma_f32_16x16x16_bf16 v[40:43], v[100:101], v[72:73], v[40:43]
    s_mov_b64 s[44:45], 0
    s_mov_b64 vcc, 0
    s_nop 7
    s_branch main_kernel_cf_d_ok
main_kernel_cf_fsp:
    s_mov_b32 s35, 40
main_kernel_cf_fsl:
    buffer_load_dword v111, v90, s[4:7], s47 offen sc1
    s_waitcnt vmcnt(1)
    v_subrev_u32 v32, s20, v111
    v_cmp_lt_u32 vcc, 0x100000, v32
    s_cbranch_vccz main_kernel_cf_rgo
    s_sub_u32 s35, s35, 1
    s_cbranch_scc0 main_kernel_cf_fsl
    v_mov_b32 v32, 0
    s_branch main_kernel_cf_fok
main_kernel_cf_r_f:
    s_memtime s[52:53]
    buffer_load_dword v111, v90, s[4:7], s47 offen sc1
    s_waitcnt lgkmcnt(0)
    s_sub_u32 s15, s52, s16
    s_add_u32 s15, s15, -1500
    s_waitcnt vmcnt(0)
    s_sub_u32 s29, s29, 1
    s_cbranch_scc1 main_kernel_end
    s_branch main_kernel_cf_rgo
    .p2align 6
main_kernel_cs_top:
    s_barrier
main_kernel_cs_mrd:
    ds_read_b128 v[0:3], v114 offset:0
    ds_read_b128 v[4:7], v114 offset:512
    ds_read_b128 v[8:11], v114 offset:1024
    ds_read_b128 v[12:15], v114 offset:1536
    ds_read_b128 v[16:19], v114 offset:2048
    s_waitcnt lgkmcnt(4)
    v_smfmac_f32_16x16x64_bf16 v[96:99], v[0:3], a[0:7], v110
    ds_read_b128 v[20:23], v114 offset:2560
    s_waitcnt lgkmcnt(4)
    v_smfmac_f32_16x16x64_bf16 v[96:99], v[4:7], a[8:15], v110
    ds_read_b128 v[24:27], v114 offset:3072
    s_waitcnt lgkmcnt(4)
    s_bfe_u32 s22, s17, 0x10001
    v_smfmac_f32_16x16x64_bf16 v[96:99], v[8:11], a[16:23], v110
    ds_read_b128 v[28:31], v114 offset:3584
    s_waitcnt lgkmcnt(4)
    v_smfmac_f32_16x16x64_bf16 v[96:99], v[12:15], a[24:31], v110
    ds_read_b128 v[32:35], v114 offset:4096
    s_waitcnt lgkmcnt(4)
    v_smfmac_f32_16x16x64_bf16 v[96:99], v[16:19], a[32:39], v110
    ds_read_b128 v[36:39], v114 offset:4608
    s_waitcnt lgkmcnt(4)
    v_smfmac_f32_16x16x64_bf16 v[96:99], v[20:23], a[40:47], v110
    ds_read_b128 v[40:43], v114 offset:5120
    s_waitcnt lgkmcnt(4)
    v_smfmac_f32_16x16x64_bf16 v[96:99], v[24:27], a[48:55], v110
    ds_read_b128 v[44:47], v114 offset:5632
    s_waitcnt lgkmcnt(4)
    v_smfmac_f32_16x16x64_bf16 v[96:99], v[28:31], a[56:63], v110
    ds_read_b128 v[48:51], v114 offset:6144
    s_waitcnt lgkmcnt(4)
    v_smfmac_f32_16x16x64_bf16 v[96:99], v[32:35], a[64:71], v110
    ds_read_b128 v[52:55], v114 offset:6656
    s_waitcnt lgkmcnt(4)
    v_smfmac_f32_16x16x64_bf16 v[96:99], v[36:39], a[72:79], v110
    ds_read_b128 v[56:59], v114 offset:7168
    s_waitcnt lgkmcnt(4)
    v_smfmac_f32_16x16x64_bf16 v[96:99], v[40:43], a[80:87], v110
    ds_read_b128 v[60:63], v114 offset:7680
    s_waitcnt lgkmcnt(4)
    v_smfmac_f32_16x16x64_bf16 v[96:99], v[44:47], a[88:95], v110
    s_waitcnt lgkmcnt(3)
    buffer_load_dword v111, v121, s[4:7], 0 offen sc1
    v_smfmac_f32_16x16x64_bf16 v[96:99], v[48:51], a[96:103], v110
    s_waitcnt lgkmcnt(2)
    ds_read_b128 v[80:83], v113 offset:0
    v_smfmac_f32_16x16x64_bf16 v[96:99], v[52:55], a[104:111], v110
    s_waitcnt lgkmcnt(2)
    ds_read_b128 v[84:87], v113 offset:1024
    v_smfmac_f32_16x16x64_bf16 v[96:99], v[56:59], a[112:119], v110
    s_waitcnt lgkmcnt(2)
    v_smfmac_f32_16x16x64_bf16 v[96:99], v[60:63], a[120:127], v110
    v_smfmac_f32_16x16x64_bf16 v[68:71], v[0:3], a[128:135], v110
    ds_read_b128 v[72:75], v113 offset:2048
    v_smfmac_f32_16x16x64_bf16 v[68:71], v[4:7], a[136:143], v110
    s_nop 1
    v_pk_add_f32 v[126:127], v[96:97], v[98:99]
    ds_read_b128 v[76:79], v113 offset:3072
    v_smfmac_f32_16x16x64_bf16 v[68:71], v[8:11], a[144:151], v110
    v_cmp_u_f32 vcc, v126, v127
    v_smfmac_f32_16x16x64_bf16 v[68:71], v[12:15], a[152:159], v110
    v_cvt_pk_bf16_f32 v126, v96, v97
    v_smfmac_f32_16x16x64_bf16 v[68:71], v[16:19], a[160:167], v110
    v_cvt_pk_bf16_f32 v127, v98, v99
    s_and_b64 s[42:43], vcc, s[44:45]
    s_cbranch_scc1 main_kernel_cs_m_f
    v_smfmac_f32_16x16x64_bf16 v[68:71], v[20:23], a[168:175], v110
    v_bfi_b32 v126, 1, s22, v126
    buffer_store_dwordx2 v[126:127], v123, s[4:7], s18 offen sc1
    v_smfmac_f32_16x16x64_bf16 v[68:71], v[24:27], a[176:183], v110
    s_mov_b64 s[44:45], s[0:1]
    v_smfmac_f32_16x16x64_bf16 v[68:71], v[28:31], a[184:191], v110
    s_add_u32 s17, s17, 1
    s_bfe_u32 s40, s17, 0x10001
    v_smfmac_f32_16x16x64_bf16 v[68:71], v[32:35], a[192:199], v110
    s_add_u32 s28, s28, 0x40000
    s_mov_b32 m0, s36
    v_smfmac_f32_16x16x64_bf16 v[68:71], v[36:39], a[200:207], v110
    s_add_u32 s34, s3, 2100
    v_smfmac_f32_16x16x64_bf16 v[68:71], v[40:43], a[208:215], v110
    v_smfmac_f32_16x16x64_bf16 v[68:71], v[44:47], a[216:223], v110
    v_smfmac_f32_16x16x64_bf16 v[68:71], v[48:51], a[224:231], v110
    v_smfmac_f32_16x16x64_bf16 v[68:71], v[52:55], a[232:239], v110
    v_smfmac_f32_16x16x64_bf16 v[68:71], v[56:59], a[240:247], v110
    v_smfmac_f32_16x16x64_bf16 v[68:71], v[60:63], a[248:255], v110
    s_waitcnt lgkmcnt(2)
    v_smfmac_f32_16x16x64_bf16 v[64:67], v[32:35], v[80:87], v110
    s_waitcnt lgkmcnt(0)
    s_nop 3
    v_cvt_pk_bf16_f32 v126, v68, v69
    v_cvt_pk_bf16_f32 v127, v70, v71
    v_bfi_b32 v126, 1, s22, v126
    buffer_store_dwordx2 v[126:127], v123, s[4:7], s18 offen offset:512 sc1
    ds_read_b128 v[80:83], v113 offset:4096
    v_smfmac_f32_16x16x64_bf16 v[64:67], v[36:39], v[72:79], v110
    ds_read_b128 v[84:87], v113 offset:5120
    v_smfmac_f32_16x16x64_bf16 v[64:67], v[0:3], v[128:135], v110
    ds_read_b128 v[72:75], v113 offset:6144
    v_smfmac_f32_16x16x64_bf16 v[64:67], v[4:7], v[136:143], v110
    ds_read_b128 v[76:79], v113 offset:7168
    v_smfmac_f32_16x16x64_bf16 v[64:67], v[8:11], v[144:151], v110
    ds_read_b128 v[32:35], v113 offset:8192
    v_smfmac_f32_16x16x64_bf16 v[64:67], v[12:15], v[152:159], v110
    ds_read_b128 v[36:39], v113 offset:9216
    v_smfmac_f32_16x16x64_bf16 v[64:67], v[16:19], v[160:167], v110
    ds_read_b128 v[0:3], v113 offset:10240
    s_memtime s[52:53]
    v_smfmac_f32_16x16x64_bf16 v[64:67], v[20:23], v[168:175], v110
    ds_read_b128 v[4:7], v113 offset:11264
    s_memtime s[52:53]
    s_xor_b32 s32, s9, s22
    s_bitcmp1_b32 s32, 0
    s_cbranch_scc1 main_kernel_cs_t_p
main_kernel_cs_t_ok:
    s_sub_u32 s32, s9, s10
    v_smfmac_f32_16x16x64_bf16 v[64:67], v[24:27], v[176:183], v110
    ds_read_b128 v[8:11], v113 offset:12288
    s_memtime s[52:53]
    s_max_i32 s32, s32, 0
    s_min_i32 s32, s32, 0x4000
    v_smfmac_f32_16x16x64_bf16 v[64:67], v[28:31], v[184:191], v110
    s_waitcnt lgkmcnt(7)
    ds_read_b128 v[12:15], v113 offset:13312
    s_memtime s[52:53]
    s_add_u32 s34, s34, s32
    s_and_b32 s34, s34, s11
    v_smfmac_f32_16x16x64_bf16 v[64:67], v[40:43], v[80:87], v110
    s_waitcnt lgkmcnt(6)
    ds_read_b128 v[16:19], v113 offset:14336
    s_cmp_lt_u32 s52, s34
    s_cbranch_scc1 main_kernel_cs_t_w
main_kernel_cs_t_go:
    s_barrier
    buffer_load_dwordx2 v[126:127], v123, s[4:7], s19 offen offset:0 sc1
    v_smfmac_f32_16x16x64_bf16 v[64:67], v[44:47], v[72:79], v110
    s_waitcnt lgkmcnt(5)
    ds_read_b128 v[20:23], v113 offset:15360
    v_smfmac_f32_16x16x64_bf16 v[64:67], v[48:51], v[32:39], v110
    s_waitcnt lgkmcnt(4)
    v_smfmac_f32_16x16x64_bf16 v[64:67], v[52:55], v[0:7], v110
    s_waitcnt lgkmcnt(2)
    ds_read_b128 v[24:27], v112 offset:6144
    ds_read_b128 v[28:31], v112 offset:7168
    v_smfmac_f32_16x16x64_bf16 v[64:67], v[56:59], v[8:15], v110
    s_waitcnt lgkmcnt(2)
    ds_read_b128 v[0:3], v112 offset:0
    ds_read_b128 v[4:7], v112 offset:1024
    v_smfmac_f32_16x16x64_bf16 v[64:67], v[60:63], v[16:23], v110
    ds_read_b128 v[8:11], v112 offset:2048
    ds_read_b128 v[12:15], v112 offset:3072
    ds_read_b128 v[16:19], v112 offset:4096
    ds_read_b128 v[20:23], v112 offset:5120
    v_mov_b32 v76, 0
    v_mov_b32 v77, 0
    v_mov_b32 v78, 0
    s_nop 0
    v_permlane32_swap_b32 v64, v65
    v_permlane32_swap_b32 v66, v67
    v_cvt_pk_bf16_f32 v84, v64, v66
    v_cvt_pk_bf16_f32 v85, v65, v67
    v_bfi_b32 v84, 1, s22, v84
    buffer_load_dwordx2 v[42:43], v123, s[4:7], s19 offen offset:512 sc1
    v_mov_b32 v79, 0
    v_mov_b32 v80, 0
    v_mov_b32 v81, 0
    v_mov_b32 v82, 0
    v_mov_b32 v83, 0
    v_mov_b32 v60, 0
    v_mov_b32 v60, 0
    v_mov_b32 v60, 0
    v_mov_b32 v60, 0
    v_mov_b32 v60, 0
    v_mov_b32 v60, 0
    v_mov_b32 v60, 0
    buffer_store_dwordx2 v[84:85], v123, s[4:7], s18 offen offset:1024 sc1
    v_mov_b32 v60, 0
    v_mov_b32 v60, 0
    v_mov_b32 v60, 0
    v_mov_b32 v60, 0
    v_mov_b32 v60, 0
    v_mov_b32 v60, 0
    v_mov_b32 v60, 0
    v_mov_b32 v60, 0
    v_mov_b32 v60, 0
    v_mov_b32 v60, 0
    v_mov_b32 v60, 0
    v_mov_b32 v60, 0
    v_mov_b32 v60, 0
    v_mov_b32 v60, 0
    v_mov_b32 v60, 0
    v_mov_b32 v60, 0
    v_mov_b32 v60, 0
    v_mov_b32 v60, 0
    v_mov_b32 v60, 0
    v_mov_b32 v60, 0
    v_mov_b32 v60, 0
    v_mov_b32 v60, 0
    v_mov_b32 v60, 0
    v_mov_b32 v60, 0
    v_mov_b32 v60, 0
    v_mov_b32 v60, 0
    v_mov_b32 v60, 0
    v_mov_b32 v60, 0
    v_mov_b32 v60, 0
    v_mov_b32 v60, 0
    v_mov_b32 v60, 0
    v_mov_b32 v60, 0
    v_mov_b32 v60, 0
    v_mov_b32 v60, 0
    v_mov_b32 v60, 0
    v_mov_b32 v60, 0
    v_mov_b32 v60, 0
    v_mov_b32 v60, 0
    s_waitcnt vmcnt(2)
main_kernel_cs_z0:
    v_dot2_f32_bf16 v44, v126, s37, v96
    v_dot2_f32_bf16 v45, v126, s57, v97
    v_dot2_f32_bf16 v46, v127, s37, v98
    v_dot2_f32_bf16 v47, v127, s57, v99
    v_bitop3_b32 v60, v126, s22, 1 bitop3:0x28
    v_cvt_pk_bf16_f32 v44, v44, v45
    v_cmp_ne_u32 vcc, 0, v60
    v_cvt_pk_bf16_f32 v45, v46, v47
    ds_write_b64 v124, v[44:45] offset:0
    buffer_load_dwordx2 v[64:65], v123, s[4:7], s19 offen offset:512 sc1
    v_cmp_eq_u32 s[42:43], 0, v111
    s_cbranch_vccnz main_kernel_cs_z0_f
    v_mov_b32 v96, 0x3f803f80
    v_mov_b32 v97, 0x3f803f80
    v_mov_b32 v98, 0x3f803f80
    v_mov_b32 v99, 0x3f803f80
    s_and_b32 s32, s43, 0x3f00
    s_cbranch_scc1 main_kernel_cs_kvw
main_kernel_cs_kvok:
    s_waitcnt lgkmcnt(0)
    s_barrier
    ds_read_b64_tr_b16 v[48:49], v115 offset:16384
    ds_read_b64_tr_b16 v[50:51], v115 offset:17408
    ds_read_b64_tr_b16 v[52:53], v115 offset:18432
    ds_read_b64_tr_b16 v[54:55], v115 offset:19456
    s_waitcnt vmcnt(2)
    s_memtime s[52:53]
    v_dot2_f32_bf16 v44, v42, s37, v68
    v_dot2_f32_bf16 v45, v42, s57, v69
    v_dot2_f32_bf16 v46, v43, s37, v70
    v_dot2_f32_bf16 v47, v43, s57, v71
    v_bitop3_b32 v60, v42, s22, 1 bitop3:0x28
    v_cvt_pk_bf16_f32 v44, v44, v45
    v_cmp_ne_u32 vcc, 0, v60
    v_cvt_pk_bf16_f32 v45, v46, v47
    ds_write_b64 v124, v[44:45] offset:512
    s_waitcnt lgkmcnt(3)
    v_mfma_f32_16x16x32_bf16 v[32:35], v[0:3], v[48:51], 0
    v_mfma_f32_16x16x32_bf16 v[36:39], v[16:19], v[48:51], 0
    s_cbranch_vccnz main_kernel_cs_z1_f
main_kernel_cs_z_ok:
    v_mfma_f32_16x16x32_bf16 v[72:75], v[48:51], v[48:51], 0
    s_waitcnt lgkmcnt(1)
    s_sub_u32 s32, s52, s38
    v_mov_b32 v46, s32
    v_mfma_f32_16x16x32_bf16 v[32:35], v[4:7], v[52:55], v[32:35]
    buffer_load_dwordx2 v[86:87], v123, s[4:7], s19 offen offset:1024 sc1
    buffer_store_dword v46, v117, s[4:7], s46 offen sc1
    s_cmp_eq_u32 s17, 64
    s_waitcnt lgkmcnt(0)
    s_barrier
    ds_read_b64_tr_b16 v[56:57], v115 offset:16896
    ds_read_b64_tr_b16 v[58:59], v115 offset:17920
    ds_read_b64_tr_b16 v[60:61], v115 offset:18944
    ds_read_b64_tr_b16 v[62:63], v115 offset:19968
    s_cbranch_scc1 main_kernel_cs_last
    v_bfe_u32 v47, v123, 1, 7
    buffer_load_dwordx2 v[126:127], v123, s[4:7], s19 offen offset:1024 sc1
    buffer_load_dwordx4 v116, s[4:7], s27 offen offset:1024 sc1 lds
    v_mfma_f32_16x16x32_bf16 v[36:39], v[20:23], v[52:55], v[36:39]
    v_mfma_f32_16x16x32_bf16 v[72:75], v[52:55], v[52:55], v[72:75]
    s_waitcnt lgkmcnt(2)
    v_mfma_f32_16x16x32_bf16 v[72:75], v[56:59], v[56:59], v[72:75]
    v_mfma_f32_16x16x32_bf16 v[32:35], v[8:11], v[56:59], v[32:35]
    s_waitcnt lgkmcnt(0)
    v_mfma_f32_16x16x32_bf16 v[72:75], v[60:63], v[60:63], v[72:75]
    ds_read_b128 v[0:3], v113 offset:16384
    v_mfma_f32_16x16x32_bf16 v[32:35], v[12:15], v[60:63], v[32:35]
    ds_read_b128 v[16:19], v113 offset:18432
    v_mfma_f32_16x16x32_bf16 v[36:39], v[24:27], v[56:59], v[36:39]
    ds_read_b128 v[4:7], v113 offset:17408
    s_nop 0
    v_permlane32_swap_b32 v72, v73
    v_permlane32_swap_b32 v74, v75
    v_mfma_f32_16x16x32_bf16 v[36:39], v[28:31], v[60:63], v[36:39]
    ds_read_b128 v[20:23], v113 offset:19456
    v_mul_f32 v73, s30, v73
    v_mul_f32 v75, s30, v75
    v_exp_f32 v32, v32
    ds_read_b128 v[8:11], v113 offset:24576
    v_exp_f32 v33, v33
    ds_read_b128 v[12:15], v113 offset:25600
    v_exp_f32 v73, v73
    ds_read_b128 v[24:27], v113 offset:26624
    v_exp_f32 v75, v75
    ds_read_b128 v[28:31], v113 offset:27648
    v_exp_f32 v34, v34
    v_cvt_pk_bf16_f32 v72, v73, v75
    v_cvt_pk_bf16_f32 v73, v73, v75
    v_exp_f32 v35, v35
    s_waitcnt vmcnt(4)
    v_mfma_f32_16x16x16_bf16 v[40:43], v[100:101], v[72:73], 0
    v_exp_f32 v36, v36
    v_cvt_pk_bf16_f32 v32, v32, v33
    v_exp_f32 v37, v37
    v_cvt_pk_bf16_f32 v33, v34, v35
    v_exp_f32 v38, v38
    v_exp_f32 v39, v39
    v_cvt_pk_bf16_f32 v34, v36, v37
    v_cvt_pk_bf16_f32 v35, v38, v39
    s_nop 1
    v_mfma_f32_16x16x32_bf16 v[40:43], v[96:99], v[32:35], v[40:43]
    v_mfma_f32_16x16x32_bf16 v[64:67], v[88:91], v[32:35], 0
    v_mfma_f32_16x16x32_bf16 v[68:71], v[92:95], v[32:35], 0
    s_waitcnt vmcnt(3)
main_kernel_cs_v_ok:
    v_bitop3_b32 v44, v86, s22, 1 bitop3:0x28
    v_swap_b32 v85, v86
    v_cmp_ne_u32 vcc, 0, v44
main_kernel_cs_d_ok:
    s_nop 0
    v_mfma_f32_16x16x16_bf16 v[64:67], v[84:85], v[72:73], v[64:67]
    v_mfma_f32_16x16x16_bf16 v[68:71], v[86:87], v[72:73], v[68:71]
    s_cbranch_vccnz main_kernel_cs_v_f
    v_rcp_f32 v42, v40
    v_subrev_u32 v41, 0x21800000, v41
    v_cmp_lt_u32 vcc, 0x3c000000, v41
    s_nop 0
    v_pk_mul_f32 v[64:65], v[64:65], v[42:43] op_sel_hi:[1,0]
    v_pk_mul_f32 v[66:67], v[66:67], v[42:43] op_sel_hi:[1,0]
    v_cvt_pk_bf16_f32 v44, v64, v65
    v_pk_mul_f32 v[68:69], v[68:69], v[42:43] op_sel_hi:[1,0]
    v_cvt_pk_bf16_f32 v45, v66, v67
    v_pk_mul_f32 v[70:71], v[70:71], v[42:43] op_sel_hi:[1,0]
    v_cvt_pk_bf16_f32 v46, v68, v69
    v_cvt_pk_bf16_f32 v47, v70, v71
    ds_write_b128 v118, v[44:47]
    s_and_b64 s[42:43], vcc, s[44:45]
    s_cbranch_scc1 main_kernel_cs_d_f
    s_mov_b64 s[44:45], s[0:1]
    v_mov_b32 v64, 0
    v_mov_b32 v65, 0
    v_mov_b32 v66, 0
    v_mov_b32 v67, 0
    v_mov_b32 v68, 0
    v_mov_b32 v69, 0
    v_mov_b32 v70, 0
    v_mov_b32 v71, 0
    v_bfe_u32 v90, v123, 1, 7
    s_xor_b32 s23, s23, 0x80000
    s_waitcnt lgkmcnt(0)
    s_barrier
    ds_read_b128 v[56:59], v114 offset:1024
    ds_read_b128 v[60:63], v114 offset:1536
    ds_read_b128 v[48:51], v114 offset:0
    ds_read_b128 v[52:55], v114 offset:512
    s_xor_b32 s18, s18, 0x100000
    s_xor_b32 s19, s18, 0x80000
    s_xor_b32 s25, s25, 0x4000
    s_add_u32 s27, s27, 0x40000
    v_add_u32 v121, 4, v121
    v_xor_b32 v112, 0x4000, v112
    s_xor_b32 s36, s36, 0x4000
    s_mov_b32 m0, 0
    s_mov_b32 s54, s24
    s_xor_b32 s24, s24, 0x4000
    s_add_u32 s55, s25, 4096
    v_mov_b32 v89, s17
    s_mov_b32 s15, 0
    s_add_u32 s56, s19, 1536
    s_xor_b32 s9, s11, s40
    s_add_u32 s16, s20, s38
    s_waitcnt lgkmcnt(3)
    v_smfmac_f32_16x16x64_bf16 v[76:79], v[56:59], v[0:7], v110
    s_waitcnt lgkmcnt(2)
    ds_read_b128 v[0:3], v113 offset:20480
    v_smfmac_f32_16x16x64_bf16 v[76:79], v[60:63], v[8:15], v110
    s_waitcnt lgkmcnt(2)
    ds_read_b128 v[4:7], v113 offset:21504
    v_smfmac_f32_16x16x64_bf16 v[76:79], v[48:51], v[192:199], v110
    s_waitcnt lgkmcnt(2)
    ds_read_b128 v[8:11], v113 offset:28672
    v_smfmac_f32_16x16x64_bf16 v[76:79], v[52:55], v[200:207], v110
    ds_read_b128 v[12:15], v113 offset:29696
    buffer_load_dword v111, v90, s[4:7], s47 offen sc1
    v_smfmac_f32_16x16x64_bf16 v[80:83], v[56:59], v[16:23], v110
    ds_read_b128 v[16:19], v113 offset:22528
    v_smfmac_f32_16x16x64_bf16 v[80:83], v[60:63], v[24:31], v110
    ds_read_b128 v[20:23], v113 offset:23552
    v_smfmac_f32_16x16x64_bf16 v[80:83], v[48:51], v[208:215], v110
    ds_read_b128 v[24:27], v113 offset:30720
    v_cvt_pk_f16_f32 v40, v76, v77
    v_smfmac_f32_16x16x64_bf16 v[80:83], v[52:55], v[216:223], v110
    ds_read_b128 v[28:31], v113 offset:31744
    v_cvt_pk_f16_f32 v41, v78, v79
    v_smfmac_f32_16x16x64_bf16 v[64:67], v[48:51], v[224:231], v110
    v_bfi_b32 v40, 1, s22, v40
    v_smfmac_f32_16x16x64_bf16 v[64:67], v[52:55], v[232:239], v110
    s_waitcnt lgkmcnt(6)
    buffer_load_dword v111, v90, s[4:7], s47 offen sc1
    v_smfmac_f32_16x16x64_bf16 v[64:67], v[56:59], v[0:7], v110
    s_waitcnt lgkmcnt(4)
    buffer_store_dwordx2 v[40:41], v119, s[4:7], s21 offen offset:0 sc1
    v_cvt_pk_f16_f32 v42, v80, v81
    v_smfmac_f32_16x16x64_bf16 v[64:67], v[60:63], v[8:15], v110
    v_cvt_pk_f16_f32 v43, v82, v83
    v_smfmac_f32_16x16x64_bf16 v[68:71], v[48:51], v[240:247], v110
    v_bfi_b32 v42, 1, s22, v42
    v_smfmac_f32_16x16x64_bf16 v[68:71], v[52:55], v[248:255], v110
    s_waitcnt lgkmcnt(2)
    v_smfmac_f32_16x16x64_bf16 v[68:71], v[56:59], v[16:23], v110
    s_waitcnt lgkmcnt(0)
    buffer_store_dwordx2 v[42:43], v119, s[4:7], s21 offen offset:512 sc1
    v_cvt_pk_f16_f32 v44, v64, v65
    v_smfmac_f32_16x16x64_bf16 v[68:71], v[60:63], v[24:31], v110
    v_cvt_pk_f16_f32 v45, v66, v67
    v_bfi_b32 v44, 1, s22, v44
    s_cmp_lg_u32 s14, 0
    buffer_store_dwordx2 v[44:45], v119, s[4:7], s21 offen offset:1024 sc1
    s_nop 3
    v_cvt_pk_f16_f32 v46, v68, v69
    v_cvt_pk_f16_f32 v47, v70, v71
    v_bfi_b32 v46, 1, s22, v46
    buffer_store_dwordx2 v[46:47], v119, s[4:7], s21 offen offset:1536 sc1
    s_cbranch_scc1 main_kernel_cs_wx
    s_waitcnt vmcnt(5)
    s_xor_b32 s21, s21, 0x80000
main_kernel_cs_rgo:
    v_subrev_u32 v32, s20, v111
    s_memtime s[52:53]
    v_cmp_lt_u32 vcc, 0x100000, v32
    v_max_u32_dpp v32, v32, v32 row_shr:1 row_mask:0xf bank_mask:0xf
    s_nop 0
    s_nop 0
    v_max_u32_dpp v32, v32, v32 row_shr:2 row_mask:0xf bank_mask:0xf
    s_nop 0
    s_cbranch_vccnz main_kernel_cs_fsp
main_kernel_cs_fok:
    s_nop 0
    v_max_u32_dpp v32, v32, v32 row_shr:4 row_mask:0xf bank_mask:0xf
    s_memtime s[52:53]
    s_nop 0
    v_max_u32_dpp v32, v32, v32 row_shr:8 row_mask:0xf bank_mask:0xf
    s_memtime s[52:53]
    s_nop 0
    v_max_u32_dpp v32, v32, v32 row_bcast:15 row_mask:0xa bank_mask:0xf
    s_memtime s[52:53]
    s_sub_u32 s33, s52, s16
    v_readlane_b32 s32, v32, 31
    s_add_u32 s33, s33, 0x400
    s_memtime s[52:53]
    s_add_u32 s34, s16, 1650
    s_memtime s[52:53]
    s_min_u32 s32, s32, s33
    s_max_u32 s32, s32, s15
    s_add_u32 s34, s34, s32
    s_mov_b32 s35, 200
main_kernel_cs_fw:
    s_memtime s[52:53]
    s_cmp_ge_u32 s52, s34
    s_cbranch_scc1 main_kernel_cs_fgo
    s_memtime s[52:53]
    s_cmp_ge_u32 s52, s34
    s_cbranch_scc1 main_kernel_cs_fgo
    s_memtime s[52:53]
    s_cmp_ge_u32 s52, s34
    s_cbranch_scc1 main_kernel_cs_fgo
    s_memtime s[52:53]
    s_cmp_ge_u32 s52, s34
    s_cbranch_scc1 main_kernel_cs_fgo
    s_memtime s[52:53]
    s_cmp_ge_u32 s52, s34
    s_cbranch_scc1 main_kernel_cs_fgo
    s_memtime s[52:53]
    s_cmp_ge_u32 s52, s34
    s_cbranch_scc1 main_kernel_cs_fgo
    s_memtime s[52:53]
    s_cmp_ge_u32 s52, s34
    s_cbranch_scc1 main_kernel_cs_fgo
    s_memtime s[52:53]
    s_cmp_ge_u32 s52, s34
    s_cbranch_scc1 main_kernel_cs_fgo
    s_sub_u32 s35, s35, 1
    s_cbranch_scc0 main_kernel_cs_fw
main_kernel_cs_fgo:
    buffer_load_dwordx4 v[0:3], v120, s[4:7], s23 offen sc1
    s_add_u32 s35, s23, 0x8000
    buffer_load_dwordx4 v[4:7], v120, s[4:7], s35 offen sc1
    s_add_u32 s35, s23, 0x10000
    buffer_load_dwordx4 v[8:11], v120, s[4:7], s35 offen sc1
    ds_read_b32 v33, v123 offset:20992
    s_add_u32 s35, s23, 0x18000
    buffer_load_dwordx4 v[12:15], v120, s[4:7], s35 offen sc1
    s_add_u32 s35, s23, 0x20000
    buffer_load_dwordx4 v[16:19], v120, s[4:7], s35 offen sc1
    s_add_u32 s35, s23, 0x28000
    buffer_load_dwordx4 v[20:23], v120, s[4:7], s35 offen sc1
    s_add_u32 s35, s23, 0x30000
    buffer_load_dwordx4 v[24:27], v120, s[4:7], s35 offen sc1
    s_add_u32 s35, s23, 0x38000
    buffer_load_dwordx4 v[28:31], v120, s[4:7], s35 offen sc1
    s_mov_b64 exec, 1
    s_waitcnt lgkmcnt(0)
    v_sub_u32 v33, s34, v33
    v_bfi_b32 v33, 1, s40, v33
    buffer_store_dword v33, off, s[4:7], s18 offset:1536 sc1
    v_readfirstlane_b32 s10, v33
    s_mov_b64 exec, -1
    s_waitcnt vmcnt(8)
    v_mfma_f32_16x16x32_f16 v[76:79], v[0:3], v[106:109], 0
    v_xor_b32 v36, s22, v0
    v_bitop3_b32 v36, v2, s22, v36 bitop3:0xbe
    s_waitcnt vmcnt(7)
    v_mfma_f32_16x16x32_f16 v[76:79], v[4:7], v[106:109], v[76:79]
    v_bitop3_b32 v36, v4, s22, v36 bitop3:0xbe
    v_bitop3_b32 v36, v6, s22, v36 bitop3:0xbe
    s_waitcnt vmcnt(6)
    v_mfma_f32_16x16x32_f16 v[76:79], v[8:11], v[106:109], v[76:79]
    v_bitop3_b32 v36, v8, s22, v36 bitop3:0xbe
    v_bitop3_b32 v36, v10, s22, v36 bitop3:0xbe
    s_waitcnt vmcnt(5)
    v_mfma_f32_16x16x32_f16 v[76:79], v[12:15], v[106:109], v[76:79]
    v_bitop3_b32 v36, v12, s22, v36 bitop3:0xbe
    v_bitop3_b32 v36, v14, s22, v36 bitop3:0xbe
    s_waitcnt vmcnt(4)
    v_mfma_f32_16x16x32_f16 v[76:79], v[16:19], v[106:109], v[76:79]
    v_bitop3_b32 v36, v16, s22, v36 bitop3:0xbe
    v_bitop3_b32 v36, v18, s22, v36 bitop3:0xbe
    s_waitcnt vmcnt(3)
    v_mfma_f32_16x16x32_f16 v[76:79], v[20:23], v[106:109], v[76:79]
    v_bitop3_b32 v36, v20, s22, v36 bitop3:0xbe
    v_bitop3_b32 v36, v22, s22, v36 bitop3:0xbe
    s_waitcnt vmcnt(2)
    v_mfma_f32_16x16x32_f16 v[76:79], v[24:27], v[106:109], v[76:79]
    v_bitop3_b32 v36, v24, s22, v36 bitop3:0xbe
    v_bitop3_b32 v36, v26, s22, v36 bitop3:0xbe
    s_waitcnt vmcnt(1)
    v_mfma_f32_16x16x32_f16 v[76:79], v[28:31], v[106:109], v[76:79]
    v_bitop3_b32 v36, v28, s22, v36 bitop3:0xbe
    v_bitop3_b32 v36, v30, s22, v36 bitop3:0xbe
    v_and_b32 v36, 1, v36
    v_cmp_ne_u32 vcc, 0, v36
    s_nop 3
    v_cvt_pk_bf16_f32 v126, v76, v77
    v_cvt_pk_bf16_f32 v127, v78, v79
    s_cbranch_vccnz main_kernel_cs_r_f
    buffer_store_dwordx2 v[126:127], v122, s[4:7], s24 offen sc1
    s_sub_u32 s20, s34, s38
    s_mov_b32 s3, s34
    buffer_store_dword v89, v117, s[4:7], s46 offen offset:512 sc1
    v_mov_b32 v32, -1
    v_mov_b32 v33, -1
    v_mov_b32 v64, 0
    v_mov_b32 v65, 0
    v_mov_b32 v66, 0
    v_mov_b32 v67, 0
    v_mov_b32 v68, 0
    v_mov_b32 v69, 0
    v_mov_b32 v70, 0
    v_mov_b32 v71, 0
    v_mov_b32 v96, 0
    v_mov_b32 v97, 0
    v_mov_b32 v98, 0
    v_mov_b32 v99, 0
    buffer_store_dwordx2 v[32:33], v122, s[4:7], s54 offen sc1
    s_cmp_eq_u32 s12, 0
    v_add_u32 v56, s59, v115
    s_cbranch_scc0 main_kernel_cs_vma
    ds_read_b64_tr_b16 v[80:81], v56 offset:16384
    ds_read_b64_tr_b16 v[82:83], v56 offset:17408
    s_waitcnt lgkmcnt(0)
    s_nop 15
    s_nop 15
    s_nop 5
    s_buffer_load_dword s9, s[4:7], s56 glc
    buffer_load_dword v111, v90, s[4:7], s47 offen offset:512 sc1
    buffer_load_dwordx4 v116, s[4:7], s25 offen offset:0 sc1 lds
    buffer_load_dwordx4 v116, s[4:7], s25 offen offset:1024 sc1 lds
    buffer_load_dwordx4 v116, s[4:7], s25 offen offset:2048 sc1 lds
    buffer_load_dwordx4 v116, s[4:7], s25 offen offset:3072 sc1 lds
    s_mov_b32 m0, 4096
    s_nop 0
    buffer_load_dwordx4 v116, s[4:7], s55 offen offset:0 sc1 lds
    buffer_load_dwordx4 v116, s[4:7], s55 offen offset:1024 sc1 lds
    buffer_load_dwordx4 v116, s[4:7], s55 offen offset:2048 sc1 lds
    buffer_load_dwordx4 v116, s[4:7], s55 offen offset:3072 sc1 lds
    v_mov_b32 v34, v90
    s_mov_b32 m0, s36
    s_barrier
    ds_read_b32 v35, v123 offset:20480
    buffer_load_dwordx4 v[88:91], v116, s[4:7], s28 offen offset:0 sc1
    buffer_load_dwordx4 v[92:95], v116, s[4:7], s28 offen offset:1024 sc1
    buffer_load_dwordx4 v116, s[4:7], s27 offen offset:0 sc1 lds
    buffer_store_dwordx4 v[80:83], v125, s[4:7], s26 offen sc1
    s_branch main_kernel_cs_kva
main_kernel_cs_vma:
    v_mfma_f32_16x16x32_bf16 v[56:59], v[102:105], v[84:87], 0
    s_nop 7
    v_cvt_pk_bf16_f32 v80, v56, v57
    v_cvt_pk_bf16_f32 v81, v58, v59
    s_nop 15
    s_nop 15
    s_nop 5
    s_buffer_load_dword s9, s[4:7], s56 glc
    buffer_load_dword v111, v90, s[4:7], s47 offen offset:512 sc1
    buffer_load_dwordx4 v116, s[4:7], s25 offen offset:0 sc1 lds
    buffer_load_dwordx4 v116, s[4:7], s25 offen offset:1024 sc1 lds
    buffer_load_dwordx4 v116, s[4:7], s25 offen offset:2048 sc1 lds
    buffer_load_dwordx4 v116, s[4:7], s25 offen offset:3072 sc1 lds
    s_mov_b32 m0, 4096
    s_nop 0
    buffer_load_dwordx4 v116, s[4:7], s55 offen offset:0 sc1 lds
    buffer_load_dwordx4 v116, s[4:7], s55 offen offset:1024 sc1 lds
    buffer_load_dwordx4 v116, s[4:7], s55 offen offset:2048 sc1 lds
    buffer_load_dwordx4 v116, s[4:7], s55 offen offset:3072 sc1 lds
    v_mov_b32 v34, v90
    s_mov_b32 m0, s36
    s_barrier
    ds_read_b32 v35, v123 offset:20480
    buffer_load_dwordx4 v[88:91], v116, s[4:7], s28 offen offset:0 sc1
    buffer_load_dwordx4 v[92:95], v116, s[4:7], s28 offen offset:1024 sc1
    buffer_load_dwordx4 v116, s[4:7], s27 offen offset:0 sc1 lds
    buffer_store_dwordx2 v[80:81], v123, s[4:7], s26 offen sc1
main_kernel_cs_kva:
    s_add_u32 s26, s26, 0x10000
    s_waitcnt vmcnt(12)
    v_cmp_gt_i32 vcc, s17, v111
    v_readfirstlane_b32 s38, v35
    s_cbranch_vccnz main_kernel_cs_mc_f
    s_waitcnt vmcnt(4)
    s_branch main_kernel_cs_top
main_kernel_cs_wx:
    s_cmp_lg_u32 s14, 1
    s_cbranch_scc1 main_kernel_cs_wy
    s_memrealtime s[32:33]
    s_nop 0
    s_nop 0
    s_memrealtime s[32:33]
    s_nop 0
    s_nop 0
    s_memrealtime s[32:33]
    s_nop 0
    s_nop 0
    s_memrealtime s[32:33]
    s_nop 0
    s_nop 0
    s_memrealtime s[32:33]
    s_nop 0
    s_nop 0
    s_memrealtime s[32:33]
    s_nop 0
    s_nop 0
    s_memrealtime s[32:33]
    s_nop 0
    s_nop 0
    s_memrealtime s[32:33]
    s_nop 0
    s_nop 0
    s_memrealtime s[32:33]
    s_nop 0
    s_nop 0
    s_memrealtime s[32:33]
    s_nop 0
    s_nop 0
    s_memrealtime s[32:33]
    s_nop 0
    s_nop 0
    s_memrealtime s[32:33]
    s_nop 0
    s_nop 0
    s_mov_b32 s34, s32
    s_memrealtime s[32:33]
    s_cmp_lg_u32 s32, s34
    s_cbranch_scc1 main_kernel_cs_e1
    s_memrealtime s[32:33]
    s_cmp_lg_u32 s32, s34
    s_cbranch_scc1 main_kernel_cs_e1
    s_memrealtime s[32:33]
    s_cmp_lg_u32 s32, s34
    s_cbranch_scc1 main_kernel_cs_e1
    s_memrealtime s[32:33]
    s_cmp_lg_u32 s32, s34
    s_cbranch_scc1 main_kernel_cs_e1
    s_memrealtime s[32:33]
    s_cmp_lg_u32 s32, s34
    s_cbranch_scc1 main_kernel_cs_e1
    s_memrealtime s[32:33]
    s_cmp_lg_u32 s32, s34
    s_cbranch_scc1 main_kernel_cs_e1
    s_memrealtime s[32:33]
    s_cmp_lg_u32 s32, s34
    s_cbranch_scc1 main_kernel_cs_e1
    s_memrealtime s[32:33]
    s_cmp_lg_u32 s32, s34
    s_cbranch_scc1 main_kernel_cs_e1
    s_memrealtime s[32:33]
    s_cmp_lg_u32 s32, s34
    s_cbranch_scc1 main_kernel_cs_e1
    s_memrealtime s[32:33]
    s_cmp_lg_u32 s32, s34
    s_cbranch_scc1 main_kernel_cs_e1
    s_memrealtime s[32:33]
    s_cmp_lg_u32 s32, s34
    s_cbranch_scc1 main_kernel_cs_e1
    s_memrealtime s[32:33]
    s_cmp_lg_u32 s32, s34
    s_cbranch_scc1 main_kernel_cs_e1
main_kernel_cs_e1:
    s_memtime s[52:53]
    s_mul_i32 s34, s32, 22
    s_waitcnt lgkmcnt(0)
    s_sub_u32 s32, s52, s34
    s_sub_u32 s33, s32, s38
    s_sub_u32 s33, s33, s10
    s_max_i32 s33, s33, -400
    s_min_i32 s33, s33, 400
    s_ashr_i32 s33, s33, 2
    s_add_u32 s10, s10, s33
    s_mov_b32 s33, s10
    s_ashr_i32 s34, s33, 2
    s_add_u32 s34, s34, s32
    v_mov_b32 v34, s34
    v_mov_b32 v33, s32
    ds_write2st64_b32 v123, v33, v34 offset0:80 offset1:82
    v_add_u32 v37, s33, v34
main_kernel_cs_wy:
    s_xor_b32 s21, s21, 0x80000
    v_mov_b32 v64, 0
    v_mov_b32 v65, 0
    v_mov_b32 v66, 0
    v_mov_b32 v67, 0
    v_mov_b32 v68, 0
    v_mov_b32 v69, 0
    v_mov_b32 v70, 0
    v_mov_b32 v71, 0
    v_mov_b32 v96, 0
    v_mov_b32 v97, 0
    v_mov_b32 v98, 0
    v_mov_b32 v99, 0
    s_cmp_eq_u32 s12, 0
    v_add_u32 v56, s59, v115
    s_cbranch_scc0 main_kernel_cs_vmb
    ds_read_b64_tr_b16 v[80:81], v56 offset:16384
    ds_read_b64_tr_b16 v[82:83], v56 offset:17408
    s_waitcnt lgkmcnt(0)
    s_waitcnt vmcnt(0)
    s_mov_b32 m0, s36
    s_barrier
    ds_read_b32 v35, v123 offset:20480
    ds_write_b32 v124, v37 offset:3584
    buffer_load_dwordx4 v[88:91], v116, s[4:7], s28 offen offset:0 sc1
    buffer_load_dwordx4 v[92:95], v116, s[4:7], s28 offen offset:1024 sc1
    buffer_load_dwordx4 v116, s[4:7], s27 offen offset:0 sc1 lds
    buffer_store_dwordx4 v[80:83], v125, s[4:7], s26 offen sc1
    s_branch main_kernel_cs_kvb
main_kernel_cs_vmb:
    v_mfma_f32_16x16x32_bf16 v[56:59], v[102:105], v[84:87], 0
    s_nop 7
    v_cvt_pk_bf16_f32 v80, v56, v57
    v_cvt_pk_bf16_f32 v81, v58, v59
    s_waitcnt vmcnt(0)
    s_mov_b32 m0, s36
    s_barrier
    ds_read_b32 v35, v123 offset:20480
    ds_write_b32 v124, v37 offset:3584
    buffer_load_dwordx4 v[88:91], v116, s[4:7], s28 offen offset:0 sc1
    buffer_load_dwordx4 v[92:95], v116, s[4:7], s28 offen offset:1024 sc1
    buffer_load_dwordx4 v116, s[4:7], s27 offen offset:0 sc1 lds
    buffer_store_dwordx2 v[80:81], v123, s[4:7], s26 offen sc1
main_kernel_cs_kvb:
    s_add_u32 s26, s26, 0x10000
    s_mov_b64 exec, 1
    buffer_store_dword v100, off, s[4:7], s39 sc1
    s_mov_b64 exec, -1
    s_add_u32 s39, s39, 4
    s_waitcnt lgkmcnt(0)
    v_readfirstlane_b32 s38, v35
    v_mov_b32 v35, 0
    v_mov_b32 v35, 0
    v_mov_b32 v35, 0
    v_mov_b32 v35, 0
    v_mov_b32 v35, 0
    v_mov_b32 v35, 0
main_kernel_cs_end:
    s_branch main_kernel_cs_top
main_kernel_cs_mc_f:
    s_mov_b32 m0, 0
    s_sub_u32 s29, s29, 1
    s_cbranch_scc1 main_kernel_end
    buffer_load_dword v111, v34, s[4:7], s47 offen offset:512 sc1
    buffer_load_dwordx4 v116, s[4:7], s25 offen offset:0 sc1 lds
    buffer_load_dwordx4 v116, s[4:7], s25 offen offset:1024 sc1 lds
    buffer_load_dwordx4 v116, s[4:7], s25 offen offset:2048 sc1 lds
    buffer_load_dwordx4 v116, s[4:7], s25 offen offset:3072 sc1 lds
    s_mov_b32 m0, 4096
    s_nop 0
    buffer_load_dwordx4 v116, s[4:7], s55 offen offset:0 sc1 lds
    buffer_load_dwordx4 v116, s[4:7], s55 offen offset:1024 sc1 lds
    buffer_load_dwordx4 v116, s[4:7], s55 offen offset:2048 sc1 lds
    buffer_load_dwordx4 v116, s[4:7], s55 offen offset:3072 sc1 lds
    s_waitcnt vmcnt(8)
    v_cmp_gt_i32 vcc, s17, v111
    v_readfirstlane_b32 s38, v35
    s_cbranch_vccnz main_kernel_cs_mc_f
    s_waitcnt vmcnt(0)
    s_branch main_kernel_cs_end
main_kernel_cs_t_w:
    s_mov_b32 s35, 200
main_kernel_cs_t_s:
    s_memtime s[52:53]
    s_cmp_ge_u32 s52, s34
    s_cbranch_scc1 main_kernel_cs_t_go
    s_memtime s[52:53]
    s_cmp_ge_u32 s52, s34
    s_cbranch_scc1 main_kernel_cs_t_go
    s_memtime s[52:53]
    s_cmp_ge_u32 s52, s34
    s_cbranch_scc1 main_kernel_cs_t_go
    s_memtime s[52:53]
    s_cmp_ge_u32 s52, s34
    s_cbranch_scc1 main_kernel_cs_t_go
    s_memtime s[52:53]
    s_cmp_ge_u32 s52, s34
    s_cbranch_scc1 main_kernel_cs_t_go
    s_memtime s[52:53]
    s_cmp_ge_u32 s52, s34
    s_cbranch_scc1 main_kernel_cs_t_go
    s_memtime s[52:53]
    s_cmp_ge_u32 s52, s34
    s_cbranch_scc1 main_kernel_cs_t_go
    s_memtime s[52:53]
    s_cmp_ge_u32 s52, s34
    s_cbranch_scc1 main_kernel_cs_t_go
    s_sub_u32 s35, s35, 1
    s_cbranch_scc0 main_kernel_cs_t_s
    s_branch main_kernel_cs_t_go
main_kernel_cs_t_p:
    s_waitcnt lgkmcnt(0)
    s_xor_b32 s32, s9, s22
    s_bitcmp1_b32 s32, 0
    s_cbranch_scc0 main_kernel_cs_t_ok
    s_buffer_load_dword s9, s[4:7], s56 glc
    s_sub_u32 s29, s29, 1
    s_cbranch_scc1 main_kernel_end
    s_branch main_kernel_cs_t_p
main_kernel_cs_z0_f:
    buffer_load_dwordx2 v[126:127], v123, s[4:7], s19 offen offset:0 sc1
    s_sub_u32 s29, s29, 1
    s_cbranch_scc1 main_kernel_end
    s_waitcnt vmcnt(0)
    s_branch main_kernel_cs_z0
main_kernel_cs_z2_f:
    buffer_load_dwordx2 v[64:65], v123, s[4:7], s19 offen offset:512 sc1
    s_sub_u32 s29, s29, 1
    s_cbranch_scc1 main_kernel_end
    s_waitcnt vmcnt(0)
main_kernel_cs_z1_f:
    s_waitcnt vmcnt(0)
    s_memtime s[52:53]
    v_dot2_f32_bf16 v44, v64, s37, v68
    v_dot2_f32_bf16 v45, v64, s57, v69
    v_dot2_f32_bf16 v46, v65, s37, v70
    v_dot2_f32_bf16 v47, v65, s57, v71
    v_bitop3_b32 v60, v64, s22, 1 bitop3:0x28
    v_cvt_pk_bf16_f32 v44, v44, v45
    v_cmp_ne_u32 vcc, 0, v60
    v_cvt_pk_bf16_f32 v45, v46, v47
    ds_write_b64 v124, v[44:45] offset:512
    s_cbranch_vccnz main_kernel_cs_z2_f
    s_branch main_kernel_cs_z_ok
main_kernel_cs_kvw:
    s_cmp_eq_u32 s17, 64
    s_cbranch_scc1 main_kernel_cs_kvok
    s_waitcnt vmcnt(0)
    s_mov_b32 exec_lo, 0
    s_mov_b32 exec_hi, 0x3f00
    v_subrev_u32 v127, 0, v121
main_kernel_cs_kvp:
    buffer_load_dword v126, v127, s[4:7], 0 offen sc1
    s_waitcnt vmcnt(0)
    v_cmp_eq_u32 vcc, 0, v126
    s_cbranch_vccz main_kernel_cs_kvp_ok
    s_sleep 2
    s_sub_u32 s29, s29, 1
    s_cbranch_scc0 main_kernel_cs_kvp
    s_branch main_kernel_end
main_kernel_cs_kvp_ok:
    s_mov_b64 exec, -1
    s_branch main_kernel_cs_kvok
main_kernel_cs_las2:
    buffer_load_dwordx2 v[86:87], v123, s[4:7], s19 offen offset:1024 sc1
    s_sub_u32 s29, s29, 1
    s_cbranch_scc1 main_kernel_end
main_kernel_cs_last:
    s_cmp_eq_u32 s12, 0
    s_cbranch_scc1 main_kernel_cs_las3
    s_waitcnt vmcnt(0) lgkmcnt(0)
    v_bitop3_b32 v44, v86, s22, 1 bitop3:0x28
    v_cmp_ne_u32 vcc, 0, v44
    s_cbranch_vccnz main_kernel_cs_las2
    v_swap_b32 v85, v86
main_kernel_cs_las3:
    s_waitcnt lgkmcnt(0)
    s_cmp_eq_u32 s12, 0
    v_add_u32 v56, s59, v115
    s_cbranch_scc0 main_kernel_cs_vmc
    ds_read_b64_tr_b16 v[80:81], v56 offset:16384
    ds_read_b64_tr_b16 v[82:83], v56 offset:17408
    s_waitcnt lgkmcnt(0)
    buffer_store_dwordx4 v[80:83], v125, s[4:7], s26 offen sc1
    s_branch main_kernel_cs_kvc
main_kernel_cs_vmc:
    v_mfma_f32_16x16x32_bf16 v[56:59], v[102:105], v[84:87], 0
    s_nop 7
    v_cvt_pk_bf16_f32 v80, v56, v57
    v_cvt_pk_bf16_f32 v81, v58, v59
    buffer_store_dwordx2 v[80:81], v123, s[4:7], s26 offen sc1
main_kernel_cs_kvc:
    s_add_u32 s26, s26, 0x10000
    s_branch main_kernel_end
main_kernel_cs_m_f:
main_kernel_cs_m_t:
    ds_read_b128 v[0:3], v116 offset:0
    ds_read_b128 v[4:7], v116 offset:1024
    ds_read_b128 v[8:11], v116 offset:2048
    ds_read_b128 v[12:15], v116 offset:3072
    ds_read_b128 v[16:19], v116 offset:4096
    ds_read_b128 v[20:23], v116 offset:5120
    ds_read_b128 v[24:27], v116 offset:6144
    ds_read_b128 v[28:31], v116 offset:7168
    s_waitcnt lgkmcnt(0)
    v_max_u32 v126, v0, v2
    v_max3_u32 v126, v126, v4, v6
    v_max3_u32 v126, v126, v8, v10
    v_max3_u32 v126, v126, v12, v14
    v_max3_u32 v126, v126, v16, v18
    v_max3_u32 v126, v126, v20, v22
    v_max3_u32 v126, v126, v24, v26
    v_max3_u32 v126, v126, v28, v30
    v_cmp_eq_u32 vcc, -1, v126
    s_cbranch_vccz main_kernel_cs_m_g
    s_barrier
    s_lshl_b32 s32, s14, 11
    s_add_u32 m0, s32, 0
    s_add_u32 s32, s32, s25
    buffer_load_dwordx4 v116, s[4:7], s32 offen offset:0 sc1 lds
    buffer_load_dwordx4 v116, s[4:7], s32 offen offset:1024 sc1 lds
    s_sub_u32 s29, s29, 1
    s_cbranch_scc1 main_kernel_end
    s_waitcnt vmcnt(0)
    s_barrier
    s_branch main_kernel_cs_m_t
main_kernel_cs_m_g:
    s_mov_b64 s[44:45], 0
    v_mov_b32 v64, 0
    v_mov_b32 v65, 0
    v_mov_b32 v66, 0
    v_mov_b32 v67, 0
    v_mov_b32 v68, 0
    v_mov_b32 v69, 0
    v_mov_b32 v70, 0
    v_mov_b32 v71, 0
    v_mov_b32 v96, 0
    v_mov_b32 v97, 0
    v_mov_b32 v98, 0
    v_mov_b32 v99, 0
    s_branch main_kernel_cs_mrd
main_kernel_cs_v_f:
    v_swap_b32 v85, v86
    s_nop 7
    s_waitcnt vmcnt(1)
main_kernel_cs_v_t:
    s_memtime s[52:53]
    v_bitop3_b32 v44, v126, s22, 1 bitop3:0x28
    v_cmp_ne_u32 vcc, 0, v44
    s_sub_u32 s29, s29, 1
    s_cbranch_scc1 main_kernel_end
    s_cbranch_vccnz main_kernel_cs_v_g
    v_mfma_f32_16x16x32_bf16 v[64:67], v[88:91], v[32:35], 0
    v_mfma_f32_16x16x32_bf16 v[68:71], v[92:95], v[32:35], 0
    v_mov_b32 v86, v126
    v_mov_b32 v87, v127
    s_waitcnt lgkmcnt(0)
    s_sub_u32 s32, s52, s38
    s_add_u32 s32, s32, -550
    v_mov_b32 v46, s32
    buffer_store_dword v46, v117, s[4:7], s46 offen sc1
    s_branch main_kernel_cs_v_ok
main_kernel_cs_v_g:
    buffer_load_dwordx2 v[126:127], v123, s[4:7], s19 offen offset:1024 sc1
    s_waitcnt lgkmcnt(0)
    s_sub_u32 s32, s52, s38
    s_add_u32 s32, s32, -50
    v_mov_b32 v46, s32
    buffer_store_dword v46, v117, s[4:7], s46 offen sc1
    s_waitcnt vmcnt(0)
    s_branch main_kernel_cs_v_t
main_kernel_cs_d_f:
    s_memtime s[52:53]
    s_waitcnt vmcnt(1) lgkmcnt(0)
    s_sub_u32 s32, s52, s38
    s_add_u32 s32, s32, 300
    v_mov_b32 v46, s32
    buffer_store_dword v46, v117, s[4:7], s46 offen sc1
    ds_read_b128 v[0:3], v112 offset:0
    ds_read_b128 v[4:7], v112 offset:1024
    ds_read_b128 v[8:11], v112 offset:2048
    ds_read_b128 v[12:15], v112 offset:3072
    ds_read_b128 v[16:19], v112 offset:4096
    ds_read_b128 v[20:23], v112 offset:5120
    ds_read_b128 v[24:27], v112 offset:6144
    ds_read_b128 v[28:31], v112 offset:7168
    s_waitcnt lgkmcnt(0)
    v_mfma_f32_16x16x32_bf16 v[32:35], v[0:3], v[48:51], 0
    v_mfma_f32_16x16x32_bf16 v[36:39], v[16:19], v[48:51], 0
    v_mfma_f32_16x16x32_bf16 v[72:75], v[48:51], v[48:51], 0
    v_mfma_f32_16x16x32_bf16 v[32:35], v[4:7], v[52:55], v[32:35]
    v_mfma_f32_16x16x32_bf16 v[36:39], v[20:23], v[52:55], v[36:39]
    v_mfma_f32_16x16x32_bf16 v[72:75], v[52:55], v[52:55], v[72:75]
    v_mfma_f32_16x16x32_bf16 v[32:35], v[8:11], v[56:59], v[32:35]
    v_mfma_f32_16x16x32_bf16 v[36:39], v[24:27], v[56:59], v[36:39]
    v_mfma_f32_16x16x32_bf16 v[72:75], v[56:59], v[56:59], v[72:75]
    v_mfma_f32_16x16x32_bf16 v[32:35], v[12:15], v[60:63], v[32:35]
    v_mfma_f32_16x16x32_bf16 v[36:39], v[28:31], v[60:63], v[36:39]
    v_mfma_f32_16x16x32_bf16 v[72:75], v[60:63], v[60:63], v[72:75]
    s_nop 7
    ds_read_b128 v[0:3], v113 offset:16384
    ds_read_b128 v[16:19], v113 offset:18432
    ds_read_b128 v[4:7], v113 offset:17408
    ds_read_b128 v[20:23], v113 offset:19456
    ds_read_b128 v[8:11], v113 offset:24576
    ds_read_b128 v[24:27], v113 offset:26624
    ds_read_b128 v[12:15], v113 offset:25600
    ds_read_b128 v[28:31], v113 offset:27648
    v_permlane32_swap_b32 v72, v73
    v_permlane32_swap_b32 v74, v75
    v_mul_f32 v73, s30, v73
    v_mul_f32 v75, s30, v75
    v_max_f32 v126, v73, v75
    v_max3_f32 v126, v126, v32, v33
    v_max3_f32 v126, v126, v34, v35
    v_max3_f32 v126, v126, v36, v37
    v_max3_f32 v126, v126, v38, v39
    v_mov_b32 v127, v126
    s_nop 1
    v_permlane32_swap_b32 v126, v127
    v_max_f32 v126, v126, v127
    v_mov_b32 v127, v126
    s_nop 1
    v_permlane16_swap_b32 v126, v127
    v_max_f32 v126, v126, v127
    v_sub_f32 v32, v32, v126
    v_sub_f32 v33, v33, v126
    v_sub_f32 v34, v34, v126
    v_sub_f32 v35, v35, v126
    v_sub_f32 v36, v36, v126
    v_sub_f32 v37, v37, v126
    v_sub_f32 v38, v38, v126
    v_sub_f32 v39, v39, v126
    v_sub_f32 v73, v73, v126
    v_sub_f32 v75, v75, v126
    v_exp_f32 v32, v32
    v_exp_f32 v33, v33
    v_exp_f32 v34, v34
    v_exp_f32 v35, v35
    v_exp_f32 v36, v36
    v_exp_f32 v37, v37
    v_exp_f32 v38, v38
    v_exp_f32 v39, v39
    v_exp_f32 v73, v73
    v_exp_f32 v75, v75
    v_cvt_pk_bf16_f32 v32, v32, v33
    v_cvt_pk_bf16_f32 v33, v34, v35
    v_cvt_pk_bf16_f32 v34, v36, v37
    v_cvt_pk_bf16_f32 v35, v38, v39
    v_cvt_pk_bf16_f32 v72, v73, v75
    v_cvt_pk_bf16_f32 v73, v73, v75
    s_nop 1
    v_mfma_f32_16x16x32_bf16 v[64:67], v[88:91], v[32:35], 0
    v_mfma_f32_16x16x32_bf16 v[68:71], v[92:95], v[32:35], 0
    v_mfma_f32_16x16x32_bf16 v[40:43], v[96:99], v[32:35], 0
    s_nop 3
    s_nop 1
    v_mfma_f32_16x16x16_bf16 v[40:43], v[100:101], v[72:73], v[40:43]
    s_mov_b64 s[44:45], 0
    s_mov_b64 vcc, 0
    s_nop 7
    s_branch main_kernel_cs_d_ok
main_kernel_cs_fsp:
    s_mov_b32 s35, 40
main_kernel_cs_fsl:
    buffer_load_dword v111, v90, s[4:7], s47 offen sc1
    s_waitcnt vmcnt(1)
    v_subrev_u32 v32, s20, v111
    v_cmp_lt_u32 vcc, 0x100000, v32
    s_cbranch_vccz main_kernel_cs_rgo
    s_sub_u32 s35, s35, 1
    s_cbranch_scc0 main_kernel_cs_fsl
    v_mov_b32 v32, 0
    s_branch main_kernel_cs_fok
main_kernel_cs_r_f:
    s_memtime s[52:53]
    buffer_load_dword v111, v90, s[4:7], s47 offen sc1
    s_waitcnt lgkmcnt(0)
    s_sub_u32 s15, s52, s16
    s_add_u32 s15, s15, -1500
    s_waitcnt vmcnt(0)
    s_sub_u32 s29, s29, 1
    s_cbranch_scc1 main_kernel_end
    s_branch main_kernel_cs_rgo
main_kernel_att:
    s_cmp_gt_u32 s13, 1
    s_cbranch_scc1 main_kernel_p_end
    s_cmp_lg_u32 s14, 0
    s_cbranch_scc1 main_kernel_p_bar
    s_lshl_b32 s32, s13, 21
    s_add_u32 s32, s32, 0x8c00000
    v_lshlrev_b32 v2, 2, v250
    v_mov_b32 v3, -1
    s_mov_b64 s[20:21], -1
    s_mov_b32 s34, 12
    s_mov_b32 exec_hi, 0
    s_waitcnt vmcnt(0)
main_kernel_p_lp:
    s_memtime s[16:17]
    s_waitcnt lgkmcnt(0)
    buffer_store_dword v3, v2, s[4:7], s32 offen sc1
    s_waitcnt vmcnt(0)
    s_memtime s[18:19]
    s_xor_b32 s32, s32, 0x2000
    s_waitcnt lgkmcnt(0)
    s_sub_u32 s33, s18, s16
    s_min_u32 s20, s20, s33
    s_memtime s[16:17]
    s_waitcnt lgkmcnt(0)
    buffer_store_dword v3, v2, s[4:7], s32 offen sc1
    s_waitcnt vmcnt(0)
    s_memtime s[18:19]
    s_xor_b32 s32, s32, 0x2000
    s_waitcnt lgkmcnt(0)
    s_sub_u32 s33, s18, s16
    s_min_u32 s21, s21, s33
    s_add_u32 s32, s32, 128
    s_sub_u32 s34, s34, 1
    s_cmp_lg_u32 s34, 0
    s_cbranch_scc1 main_kernel_p_lp
    s_cmp_lt_u32 s21, s20
    s_cselect_b32 s32, 3, 2
    s_lshl_b32 s33, s13, 2
    v_mov_b32 v3, s32
    s_mov_b64 exec, 1
    buffer_store_dword v3, off, s[60:63], s33 offset:16 sc1
    s_mov_b64 exec, -1
main_kernel_p_bar:
    s_barrier
main_kernel_p_end:
    v_lshlrev_b32 v0, 2, v250
    s_mov_b32 s32, 0x841f000
main_kernel_awf:
    buffer_load_dword v2, v0, s[4:7], s32 offen sc1
    s_waitcnt vmcnt(0)
    v_cmp_eq_u32 vcc, 0, v2
    s_cbranch_vccz main_kernel_awf_ok
    s_sleep 4
    s_sub_u32 s29, s29, 1
    s_cbranch_scc0 main_kernel_awf
    s_branch main_kernel_end
main_kernel_awf_ok:
main_kernel_att2:
    s_lshl_b32 s28, s13, 1
    s_lshr_b32 s31, s14, 1
    s_add_u32 s28, s28, s31
    s_and_b32 s30, s14, 1
    v_lshlrev_b32 v204, 4, v250
    v_and_b32 v200, 15, v250
    v_lshrrev_b32 v201, 4, v250
    v_and_b32 v202, 7, v250
    v_lshl_add_u32 v202, v201, 3, v202
    v_lshlrev_b32 v205, 4, v202
    v_bfe_u32 v206, v204, 1, 8
    v_min_u32 v207, 2, v250
    v_lshlrev_b32 v207, 13, v207
    s_lshl_b32 s31, s28, 8
    s_sub_u32 s31, 80912, s31
    s_cmp_eq_u32 s12, 7
    s_cselect_b32 s25, 61, 0
    s_cselect_b32 s32, 16, 0
    s_sub_u32 s31, s31, s32
    s_mov_b64 exec, 0xf0
    v_lshl_add_u32 v207, v250, 8, s31
    s_mov_b64 exec, -1
    v_mov_b32 v208, 1
    v_mov_b32 v209, 0
    s_lshl_b32 s31, s30, 4
    v_add_u32 v200, s31, v200
    v_lshlrev_b32 v202, 2, v201
    v_sub_u32 v200, v200, v202
    v_mov_b32 v202, 0xf149f2ca
    v_cmp_le_i32 vcc, 0, v200
    s_nop 1
    v_cndmask_b32 v124, v202, 0, vcc
    v_cmp_le_i32 vcc, 1, v200
    s_nop 1
    v_cndmask_b32 v125, v202, 0, vcc
    v_cmp_le_i32 vcc, 2, v200
    s_nop 1
    v_cndmask_b32 v126, v202, 0, vcc
    v_cmp_le_i32 vcc, 3, v200
    s_nop 1
    v_cndmask_b32 v127, v202, 0, vcc
    v_cmp_le_i32 vcc, 16, v200
    s_nop 1
    v_cndmask_b32 v128, v202, 0, vcc
    v_cmp_le_i32 vcc, 17, v200
    s_nop 1
    v_cndmask_b32 v129, v202, 0, vcc
    v_cmp_le_i32 vcc, 18, v200
    s_nop 1
    v_cndmask_b32 v130, v202, 0, vcc
    v_cmp_le_i32 vcc, 19, v200
    s_nop 1
    v_cndmask_b32 v131, v202, 0, vcc
    v_cmp_le_u32 vcc, 2, v201
    s_nop 1
    v_cndmask_b32 v132, v202, 0, vcc
    v_mov_b32 v180, 0x3f803f80
    v_cndmask_b32 v133, v202, 0, vcc
    v_mov_b32 v181, 0x3f803f80
    v_cndmask_b32 v134, v202, 0, vcc
    v_mov_b32 v182, 0x3f803f80
    v_cndmask_b32 v135, v202, 0, vcc
    v_mov_b32 v183, 0x3f803f80
    s_mov_b32 s26, 0x3e0293ee
    s_mov_b32 s27, 0xbe0293ee
    s_lshl_b32 s31, s28, 12
    s_add_u32 s16, s31, 0x1800000
    s_add_u32 s17, s16, 131072
    s_lshl_b32 s32, s30, 17
    s_add_u32 s31, s31, s32
    s_add_u32 s15, s31, 0x800000
    s_add_u32 s22, s31, 0x3800000
    s_lshl_b32 s31, s28, 13
    s_add_u32 s18, s31, 0x2800000
    s_add_u32 s19, s18, 4096
    s_lshl_b32 s31, s28, 11
    s_add_u32 s20, s31, 0x8000000
    s_add_u32 s21, s31, 0x6e00000
    s_lshl_b32 s31, s28, 8
    s_add_u32 s23, s31, 0x8404000
    s_lshl_b32 s31, s28, 3
    s_lshl_b32 s32, s30, 2
    s_add_u32 s31, s31, s32
    s_add_u32 s24, s31, 0x8400000
    v_and_b32 v210, 3, v250
    s_mov_b32 s39, 0
    v_lshlrev_b32 v210, 2, v210
    s_mov_b32 s33, 0x841ec00
    s_lshl_b32 s31, s25, 18
    s_add_u32 s15, s15, s31
    s_add_u32 s16, s16, s31
    s_add_u32 s17, s17, s31
    s_add_u32 s18, s18, s31
    s_add_u32 s19, s19, s31
    s_add_u32 s22, s22, s31
    s_lshl_b32 s31, s25, 16
    s_add_u32 s20, s20, s31
    s_add_u32 s21, s21, s31
    s_lshl_b32 s31, s25, 8
    s_add_u32 s24, s24, s31
    s_lshl_b32 s31, s25, 2
    s_add_u32 s23, s23, s31
    s_add_u32 s33, s33, s31
    s_cmp_lg_u32 s25, 0
    s_cbranch_scc1 main_kernel_a_npf
    s_cmp_lt_u32 s13, 14
    s_cbranch_scc0 main_kernel_a_pf4
    s_mov_b32 s8, s68
    s_and_b32 s9, s69, 0xffff
    s_mov_b32 s10, 0x700000
    s_mov_b32 s11, 0x20000
    s_lshl_b32 s31, s13, 19
    s_branch main_kernel_a_pfg
main_kernel_a_pf4:
    s_mov_b32 s8, s70
    s_and_b32 s9, s71, 0xffff
    s_mov_b32 s10, 0x700000
    s_mov_b32 s11, 0x20000
    s_sub_u32 s31, s13, 2
    s_lshl_b32 s31, s31, 19
main_kernel_a_pfg:
    s_lshl_b32 s32, s14, 17
    s_add_u32 s31, s31, s32
    v_lshlrev_b32 v200, 7, v250
    buffer_load_dword v0, v200, s[8:11], s31 offen
    s_add_u32 s31, s31, 8192
    buffer_load_dword v0, v200, s[8:11], s31 offen
    s_add_u32 s31, s31, 8192
    buffer_load_dword v0, v200, s[8:11], s31 offen
    s_add_u32 s31, s31, 8192
    buffer_load_dword v0, v200, s[8:11], s31 offen
    s_add_u32 s31, s31, 8192
    buffer_load_dword v0, v200, s[8:11], s31 offen
    s_add_u32 s31, s31, 8192
    buffer_load_dword v0, v200, s[8:11], s31 offen
    s_add_u32 s31, s31, 8192
    buffer_load_dword v0, v200, s[8:11], s31 offen
    s_add_u32 s31, s31, 8192
    buffer_load_dword v0, v200, s[8:11], s31 offen
    s_add_u32 s31, s31, 8192
    buffer_load_dword v0, v200, s[8:11], s31 offen
    s_add_u32 s31, s31, 8192
    buffer_load_dword v0, v200, s[8:11], s31 offen
    s_add_u32 s31, s31, 8192
    buffer_load_dword v0, v200, s[8:11], s31 offen
    s_add_u32 s31, s31, 8192
    buffer_load_dword v0, v200, s[8:11], s31 offen
    s_add_u32 s31, s31, 8192
    buffer_load_dword v0, v200, s[8:11], s31 offen
    s_add_u32 s31, s31, 8192
    buffer_load_dword v0, v200, s[8:11], s31 offen
    s_add_u32 s31, s31, 8192
    buffer_load_dword v0, v200, s[8:11], s31 offen
    s_add_u32 s31, s31, 8192
    buffer_load_dword v0, v200, s[8:11], s31 offen
    s_add_u32 s31, s31, 8192
    s_mov_b32 s8, s70
    s_and_b32 s9, s71, 0xffff
    s_mov_b32 s10, 0x700000
    s_mov_b32 s11, 0x20000
    s_sub_u32 s31, s13, 0
    s_lshl_b32 s31, s31, 19
    s_cmp_ge_u32 s13, 12
    s_cbranch_scc1 main_kernel_a_npf
    s_lshl_b32 s32, s14, 17
    s_add_u32 s31, s31, s32
    v_lshlrev_b32 v200, 7, v250
    buffer_load_dword v0, v200, s[8:11], s31 offen
    s_add_u32 s31, s31, 8192
    buffer_load_dword v0, v200, s[8:11], s31 offen
    s_add_u32 s31, s31, 8192
    buffer_load_dword v0, v200, s[8:11], s31 offen
    s_add_u32 s31, s31, 8192
    buffer_load_dword v0, v200, s[8:11], s31 offen
    s_add_u32 s31, s31, 8192
    buffer_load_dword v0, v200, s[8:11], s31 offen
    s_add_u32 s31, s31, 8192
    buffer_load_dword v0, v200, s[8:11], s31 offen
    s_add_u32 s31, s31, 8192
    buffer_load_dword v0, v200, s[8:11], s31 offen
    s_add_u32 s31, s31, 8192
    buffer_load_dword v0, v200, s[8:11], s31 offen
    s_add_u32 s31, s31, 8192
    buffer_load_dword v0, v200, s[8:11], s31 offen
    s_add_u32 s31, s31, 8192
    buffer_load_dword v0, v200, s[8:11], s31 offen
    s_add_u32 s31, s31, 8192
    buffer_load_dword v0, v200, s[8:11], s31 offen
    s_add_u32 s31, s31, 8192
    buffer_load_dword v0, v200, s[8:11], s31 offen
    s_add_u32 s31, s31, 8192
    buffer_load_dword v0, v200, s[8:11], s31 offen
    s_add_u32 s31, s31, 8192
    buffer_load_dword v0, v200, s[8:11], s31 offen
    s_add_u32 s31, s31, 8192
    buffer_load_dword v0, v200, s[8:11], s31 offen
    s_add_u32 s31, s31, 8192
    buffer_load_dword v0, v200, s[8:11], s31 offen
    s_add_u32 s31, s31, 8192
    s_waitcnt vmcnt(0)
main_kernel_a_npf:
    s_cmp_eq_u32 s25, 0
    s_cbranch_scc1 main_kernel_a_fp
    s_sub_u32 s32, s24, 1280
main_kernel_a_gp:
    buffer_load_dword v200, v209, s[4:7], s32 offen sc1
    s_waitcnt vmcnt(0)
    v_cmp_eq_u32 vcc, 0, v200
    s_and_b32 s31, vcc_lo, 1
    s_cbranch_scc0 main_kernel_a_fp
    s_sleep 32
    s_sub_u32 s29, s29, 1
    s_cbranch_scc0 main_kernel_a_gp
    s_branch main_kernel_end
main_kernel_a_fp:
    buffer_load_dword v200, v207, s[4:7], s23 offen sc1
    s_waitcnt vmcnt(0)
    v_cmp_eq_u32 vcc, 0, v200
    s_and_b32 s31, vcc_lo, -1
    s_cbranch_scc0 main_kernel_a_fok
    s_sleep 8
    s_sub_u32 s29, s29, 1
    s_cbranch_scc0 main_kernel_a_fp
    s_branch main_kernel_end
main_kernel_a_fok:
    buffer_load_dwordx4 v[0:3], v204, s[4:7], s15 offen offset:0 sc1
    buffer_load_dwordx4 v[16:19], v204, s[4:7], s16 offen offset:0 sc1
    buffer_load_dwordx4 v[32:35], v204, s[4:7], s17 offen offset:0 sc1
    buffer_load_dwordx4 v[4:7], v204, s[4:7], s15 offen offset:1024 sc1
    buffer_load_dwordx4 v[20:23], v204, s[4:7], s16 offen offset:1024 sc1
    buffer_load_dwordx4 v[36:39], v204, s[4:7], s17 offen offset:1024 sc1
    buffer_load_dwordx4 v[8:11], v204, s[4:7], s15 offen offset:2048 sc1
    buffer_load_dwordx4 v[24:27], v204, s[4:7], s16 offen offset:2048 sc1
    buffer_load_dwordx4 v[40:43], v204, s[4:7], s17 offen offset:2048 sc1
    buffer_load_dwordx4 v[12:15], v204, s[4:7], s15 offen offset:3072 sc1
    buffer_load_dwordx4 v[28:31], v204, s[4:7], s16 offen offset:3072 sc1
    buffer_load_dwordx4 v[44:47], v204, s[4:7], s17 offen offset:3072 sc1
    buffer_load_dword v211, v210, s[4:7], s33 offen sc1
    buffer_load_dwordx4 v[48:51], v204, s[4:7], s18 offen offset:0 sc1
    buffer_load_dwordx4 v[52:55], v204, s[4:7], s18 offen offset:1024 sc1
    buffer_load_dwordx4 v[56:59], v204, s[4:7], s18 offen offset:2048 sc1
    buffer_load_dwordx4 v[60:63], v204, s[4:7], s18 offen offset:3072 sc1
    buffer_load_dwordx4 v[64:67], v204, s[4:7], s19 offen offset:0 sc1
    buffer_load_dwordx4 v[68:71], v204, s[4:7], s19 offen offset:1024 sc1
    buffer_load_dwordx4 v[72:75], v204, s[4:7], s19 offen offset:2048 sc1
    buffer_load_dwordx4 v[76:79], v204, s[4:7], s19 offen offset:3072 sc1
    s_waitcnt vmcnt(0)
main_kernel_a_top:
    s_cmp_ge_u32 s25, 60
    s_cselect_b32 s38, 2, 1
    s_lshl_b32 s34, s38, 18
    s_lshl_b32 s35, s38, 16
    s_lshl_b32 s36, s38, 8
    s_lshl_b32 s37, s38, 2
    s_waitcnt vmcnt(19)
    v_mfma_f32_16x16x32_bf16 v[112:115], v[16:19], v[0:3], v[124:127]
    v_mfma_f32_16x16x32_bf16 v[116:119], v[32:35], v[0:3], v[128:131]
    s_waitcnt vmcnt(16)
    v_mfma_f32_16x16x32_bf16 v[112:115], v[20:23], v[4:7], v[112:115]
    v_mfma_f32_16x16x32_bf16 v[116:119], v[36:39], v[4:7], v[116:119]
    s_waitcnt vmcnt(13)
    v_mfma_f32_16x16x32_bf16 v[112:115], v[24:27], v[8:11], v[112:115]
    v_mfma_f32_16x16x32_bf16 v[116:119], v[40:43], v[8:11], v[116:119]
    s_waitcnt vmcnt(10)
    v_mfma_f32_16x16x32_bf16 v[112:115], v[28:31], v[12:15], v[112:115]
    v_mfma_f32_16x16x32_bf16 v[116:119], v[44:47], v[12:15], v[116:119]
    s_add_u32 s15, s15, s34
    s_add_u32 s16, s16, s34
    s_add_u32 s17, s17, s34
    s_add_u32 s18, s18, s34
    s_add_u32 s19, s19, s34
    s_add_u32 s23, s23, s37
    s_waitcnt vmcnt(9)
    v_cmp_eq_u32 vcc, 0, v211
    s_nop 0
    v_max3_f32 v202, v112, v113, v114
    s_nop 1
    v_max3_f32 v202, v202, v115, v116
    v_max3_f32 v202, v202, v117, v118
    v_max_f32 v202, v202, v119
    s_cmp_lg_u32 s39, 0
    s_cbranch_scc1 main_kernel_a_mq
    s_cmp_ge_u32 s25, 56
    s_cselect_b32 s32, 1, 2
    s_and_b32 s31, vcc_lo, s32
    s_cbranch_scc0 main_kernel_a_mp
main_kernel_a_pp:
    buffer_load_dword v200, v210, s[4:7], s33 offen sc1
    s_waitcnt vmcnt(0)
    v_cmp_eq_u32 vcc, 0, v200
    s_and_b32 s31, vcc_lo, s32
    s_cbranch_scc0 main_kernel_a_pok
    s_sleep 2
    s_sub_u32 s29, s29, 1
    s_cbranch_scc0 main_kernel_a_pp
    s_branch main_kernel_end
main_kernel_a_pok:
    s_cmp_eq_u32 s32, 2
    s_cbranch_scc1 main_kernel_a_mp
    s_sleep 2
    s_cmp_eq_u32 s25, 63
    s_cbranch_scc1 main_kernel_a_mp
    s_sleep 40
main_kernel_a_mp:
    s_mov_b32 s39, 0
    buffer_load_dwordx4 v[80:83], v205, s[4:7], s20 offen offset:0 sc1
    buffer_load_dwordx4 v[84:87], v205, s[4:7], s20 offen offset:512 sc1
    buffer_load_dwordx4 v[88:91], v205, s[4:7], s20 offen offset:1024 sc1
    buffer_load_dwordx4 v[92:95], v205, s[4:7], s20 offen offset:1536 sc1
    buffer_load_dwordx2 v[96:97], v206, s[4:7], s21 offen offset:0 sc1
    buffer_load_dwordx2 v[98:99], v206, s[4:7], s21 offen offset:256 sc1
    buffer_load_dwordx2 v[100:101], v206, s[4:7], s21 offen offset:512 sc1
    buffer_load_dwordx2 v[102:103], v206, s[4:7], s21 offen offset:768 sc1
    buffer_load_dwordx2 v[104:105], v206, s[4:7], s21 offen offset:1024 sc1
    buffer_load_dwordx2 v[106:107], v206, s[4:7], s21 offen offset:1280 sc1
    buffer_load_dwordx2 v[108:109], v206, s[4:7], s21 offen offset:1536 sc1
    buffer_load_dwordx2 v[110:111], v206, s[4:7], s21 offen offset:1792 sc1
    buffer_load_dword v212, v207, s[4:7], s23 offen offset:0 sc1
    buffer_load_dword v211, v210, s[4:7], s33 offen sc1
main_kernel_a_mq:
    s_waitcnt vmcnt(13)
    v_mfma_f32_16x16x32_bf16 v[120:123], v[80:83], v[0:3], v[132:135]
    v_max3_u32 v200, v80, v81, v82
    v_max_u32 v200, v200, v83
    s_waitcnt vmcnt(12)
    v_mfma_f32_16x16x32_bf16 v[120:123], v[84:87], v[4:7], v[120:123]
    v_max3_u32 v200, v200, v84, v85
    v_max3_u32 v200, v200, v86, v87
    s_waitcnt vmcnt(11)
    v_mfma_f32_16x16x32_bf16 v[120:123], v[88:91], v[8:11], v[120:123]
    v_max3_u32 v200, v200, v88, v89
    v_max3_u32 v200, v200, v90, v91
    s_waitcnt vmcnt(10)
    v_mfma_f32_16x16x32_bf16 v[120:123], v[92:95], v[12:15], v[120:123]
    v_max3_u32 v200, v200, v92, v93
    v_max3_u32 v200, v200, v94, v95
    s_waitcnt vmcnt(8)
    v_max3_u32 v200, v200, v96, v97
    v_max3_u32 v200, v200, v98, v99
    s_waitcnt vmcnt(6)
    v_max3_u32 v200, v200, v100, v101
    v_max3_u32 v200, v200, v102, v103
    s_waitcnt vmcnt(4)
    v_max3_u32 v200, v200, v104, v105
    v_max3_u32 v200, v200, v106, v107
    s_waitcnt vmcnt(2)
    v_max3_u32 v200, v200, v108, v109
    v_max3_u32 v200, v200, v110, v111
    v_cmp_eq_u32 vcc, -1, v200
    s_cbranch_vccz main_kernel_a_mok
    s_sleep 1
    s_sub_u32 s29, s29, 1
    s_cbranch_scc0 main_kernel_a_mp
    s_branch main_kernel_end
main_kernel_a_mok:
    v_mul_f32 v120, s26, v120
    v_mul_f32 v121, s26, v121
    v_mul_f32 v122, s26, v122
    v_mul_f32 v123, s26, v123
    v_max3_f32 v200, v202, v120, v121
    v_max3_f32 v200, v200, v122, v123
    v_mov_b32 v201, v200
    s_add_u32 s20, s20, s35
    s_add_u32 s21, s21, s35
    v_permlane32_swap_b32 v200, v201
    v_max_f32 v200, v200, v201
    v_mov_b32 v201, v200
    s_nop 1
    v_permlane16_swap_b32 v200, v201
    v_max_f32 v200, v200, v201
    v_sub_f32 v112, v112, v200
    v_sub_f32 v113, v113, v200
    v_sub_f32 v114, v114, v200
    v_sub_f32 v115, v115, v200
    v_sub_f32 v116, v116, v200
    v_sub_f32 v117, v117, v200
    v_sub_f32 v118, v118, v200
    v_sub_f32 v119, v119, v200
    v_sub_f32 v120, v120, v200
    v_sub_f32 v121, v121, v200
    v_sub_f32 v122, v122, v200
    v_sub_f32 v123, v123, v200
    v_exp_f32 v112, v112
    v_exp_f32 v113, v113
    v_exp_f32 v114, v114
    v_cvt_pk_bf16_f32 v136, v112, v113
    v_exp_f32 v115, v115
    v_exp_f32 v116, v116
    v_cvt_pk_bf16_f32 v137, v114, v115
    v_exp_f32 v117, v117
    v_exp_f32 v118, v118
    v_cvt_pk_bf16_f32 v138, v116, v117
    v_exp_f32 v119, v119
    v_exp_f32 v120, v120
    v_cvt_pk_bf16_f32 v139, v118, v119
    v_exp_f32 v121, v121
    v_exp_f32 v122, v122
    v_cvt_pk_bf16_f32 v140, v120, v121
    v_exp_f32 v123, v123
    s_nop 0
    v_cvt_pk_bf16_f32 v141, v122, v123
    s_waitcnt vmcnt(1)
    v_mfma_f32_16x16x32_bf16 v[144:147], v[180:183], v[136:139], 0
    v_mfma_f32_16x16x32_bf16 v[148:151], v[48:51], v[136:139], 0
    s_nop 0
    s_nop 0
    s_nop 0
    v_mfma_f32_16x16x16_bf16 v[144:147], v[180:181], v[140:141], v[144:147]
    v_mfma_f32_16x16x32_bf16 v[152:155], v[52:55], v[136:139], 0
    v_mfma_f32_16x16x32_bf16 v[156:159], v[56:59], v[136:139], 0
    v_mfma_f32_16x16x32_bf16 v[160:163], v[60:63], v[136:139], 0
    v_mfma_f32_16x16x32_bf16 v[164:167], v[64:67], v[136:139], 0
    v_mfma_f32_16x16x32_bf16 v[168:171], v[68:71], v[136:139], 0
    v_mfma_f32_16x16x32_bf16 v[172:175], v[72:75], v[136:139], 0
    v_mfma_f32_16x16x32_bf16 v[176:179], v[76:79], v[136:139], 0
    v_rcp_f32 v200, v144
    v_mfma_f32_16x16x16_bf16 v[148:151], v[96:97], v[140:141], v[148:151]
    v_mfma_f32_16x16x16_bf16 v[152:155], v[98:99], v[140:141], v[152:155]
    v_mfma_f32_16x16x16_bf16 v[156:159], v[100:101], v[140:141], v[156:159]
    v_mfma_f32_16x16x16_bf16 v[160:163], v[102:103], v[140:141], v[160:163]
    v_mfma_f32_16x16x16_bf16 v[164:167], v[104:105], v[140:141], v[164:167]
    v_mfma_f32_16x16x16_bf16 v[168:171], v[106:107], v[140:141], v[168:171]
    v_mfma_f32_16x16x16_bf16 v[172:175], v[108:109], v[140:141], v[172:175]
    v_mfma_f32_16x16x16_bf16 v[176:179], v[110:111], v[140:141], v[176:179]
    v_mov_b32 v201, v200
    s_cmp_lg_u32 s39, 0
    s_cbranch_scc1 main_kernel_a_nw
    s_waitcnt vmcnt(0)
main_kernel_a_nw:
    v_cmp_ne_u32 vcc, 0, v211
    s_and_b32 s39, vcc_lo, 4
    v_cmp_eq_u32 vcc, 0, v212
    v_pk_mul_f32 v[148:149], v[148:149], v[200:201]
    v_pk_mul_f32 v[150:151], v[150:151], v[200:201]
    v_pk_mul_f32 v[152:153], v[152:153], v[200:201]
    v_pk_mul_f32 v[154:155], v[154:155], v[200:201]
    v_cvt_pk_bf16_f32 v184, v148, v149
    v_cvt_pk_bf16_f32 v185, v150, v151
    v_cvt_pk_bf16_f32 v186, v152, v153
    v_cvt_pk_bf16_f32 v187, v154, v155
    buffer_store_dwordx4 v[184:187], v204, s[4:7], s22 offen offset:0 sc1
    v_pk_mul_f32 v[156:157], v[156:157], v[200:201]
    v_pk_mul_f32 v[158:159], v[158:159], v[200:201]
    v_pk_mul_f32 v[160:161], v[160:161], v[200:201]
    v_pk_mul_f32 v[162:163], v[162:163], v[200:201]
    v_cvt_pk_bf16_f32 v188, v156, v157
    v_cvt_pk_bf16_f32 v189, v158, v159
    v_cvt_pk_bf16_f32 v190, v160, v161
    v_cvt_pk_bf16_f32 v191, v162, v163
    buffer_store_dwordx4 v[188:191], v204, s[4:7], s22 offen offset:1024 sc1
    v_pk_mul_f32 v[164:165], v[164:165], v[200:201]
    v_pk_mul_f32 v[166:167], v[166:167], v[200:201]
    v_pk_mul_f32 v[168:169], v[168:169], v[200:201]
    v_pk_mul_f32 v[170:171], v[170:171], v[200:201]
    v_cvt_pk_bf16_f32 v192, v164, v165
    v_cvt_pk_bf16_f32 v193, v166, v167
    v_cvt_pk_bf16_f32 v194, v168, v169
    v_cvt_pk_bf16_f32 v195, v170, v171
    buffer_store_dwordx4 v[192:195], v204, s[4:7], s22 offen offset:2048 sc1
    s_nop 0
    v_pk_mul_f32 v[172:173], v[172:173], v[200:201]
    v_pk_mul_f32 v[174:175], v[174:175], v[200:201]
    v_pk_mul_f32 v[176:177], v[176:177], v[200:201]
    v_pk_mul_f32 v[178:179], v[178:179], v[200:201]
    v_cvt_pk_bf16_f32 v196, v172, v173
    v_cvt_pk_bf16_f32 v197, v174, v175
    v_cvt_pk_bf16_f32 v198, v176, v177
    v_cvt_pk_bf16_f32 v199, v178, v179
    buffer_store_dwordx4 v[196:199], v204, s[4:7], s22 offen offset:3072 sc1
    s_add_u32 s22, s22, s34
    s_add_u32 s33, s33, s37
    s_add_u32 s25, s25, s38
    s_cmp_ge_u32 s25, 64
    s_cbranch_scc1 main_kernel_a_last
    s_cbranch_vccnz main_kernel_a_slow
    s_cmp_gt_u32 s25, 60
    s_cbranch_scc1 main_kernel_a_slow
    s_cmp_ge_u32 s25, 56
    s_cselect_b32 s39, 0, s39
    s_cmp_lg_u32 s39, 0
    s_cbranch_scc1 main_kernel_a_pre
    buffer_load_dwordx4 v[0:3], v204, s[4:7], s15 offen offset:0 sc1
    buffer_load_dwordx4 v[16:19], v204, s[4:7], s16 offen offset:0 sc1
    buffer_load_dwordx4 v[32:35], v204, s[4:7], s17 offen offset:0 sc1
    buffer_load_dwordx4 v[4:7], v204, s[4:7], s15 offen offset:1024 sc1
    buffer_load_dwordx4 v[20:23], v204, s[4:7], s16 offen offset:1024 sc1
    buffer_load_dwordx4 v[36:39], v204, s[4:7], s17 offen offset:1024 sc1
    buffer_load_dwordx4 v[8:11], v204, s[4:7], s15 offen offset:2048 sc1
    buffer_load_dwordx4 v[24:27], v204, s[4:7], s16 offen offset:2048 sc1
    buffer_load_dwordx4 v[40:43], v204, s[4:7], s17 offen offset:2048 sc1
    buffer_load_dwordx4 v[12:15], v204, s[4:7], s15 offen offset:3072 sc1
    buffer_load_dwordx4 v[28:31], v204, s[4:7], s16 offen offset:3072 sc1
    buffer_load_dwordx4 v[44:47], v204, s[4:7], s17 offen offset:3072 sc1
    buffer_load_dword v211, v210, s[4:7], s33 offen sc1
    buffer_load_dwordx4 v[48:51], v204, s[4:7], s18 offen offset:0 sc1
    buffer_load_dwordx4 v[52:55], v204, s[4:7], s18 offen offset:1024 sc1
    buffer_load_dwordx4 v[56:59], v204, s[4:7], s18 offen offset:2048 sc1
    buffer_load_dwordx4 v[60:63], v204, s[4:7], s18 offen offset:3072 sc1
    buffer_load_dwordx4 v[64:67], v204, s[4:7], s19 offen offset:0 sc1
    buffer_load_dwordx4 v[68:71], v204, s[4:7], s19 offen offset:1024 sc1
    buffer_load_dwordx4 v[72:75], v204, s[4:7], s19 offen offset:2048 sc1
    buffer_load_dwordx4 v[76:79], v204, s[4:7], s19 offen offset:3072 sc1
    s_waitcnt vmcnt(21)
    s_mov_b64 exec, 1
    buffer_store_dword v208, v209, s[4:7], s24 offen sc1
    s_mov_b64 exec, -1
    s_add_u32 s24, s24, s36
    s_branch main_kernel_a_top
main_kernel_a_pre:
    buffer_load_dwordx4 v[80:83], v205, s[4:7], s20 offen offset:0 sc1
    buffer_load_dwordx4 v[84:87], v205, s[4:7], s20 offen offset:512 sc1
    buffer_load_dwordx4 v[88:91], v205, s[4:7], s20 offen offset:1024 sc1
    buffer_load_dwordx4 v[92:95], v205, s[4:7], s20 offen offset:1536 sc1
    buffer_load_dwordx2 v[96:97], v206, s[4:7], s21 offen offset:0 sc1
    buffer_load_dwordx2 v[98:99], v206, s[4:7], s21 offen offset:256 sc1
    buffer_load_dwordx2 v[100:101], v206, s[4:7], s21 offen offset:512 sc1
    buffer_load_dwordx2 v[102:103], v206, s[4:7], s21 offen offset:768 sc1
    buffer_load_dwordx2 v[104:105], v206, s[4:7], s21 offen offset:1024 sc1
    buffer_load_dwordx2 v[106:107], v206, s[4:7], s21 offen offset:1280 sc1
    buffer_load_dwordx2 v[108:109], v206, s[4:7], s21 offen offset:1536 sc1
    buffer_load_dwordx2 v[110:111], v206, s[4:7], s21 offen offset:1792 sc1
    buffer_load_dword v212, v207, s[4:7], s23 offen offset:4 sc1
    buffer_load_dwordx4 v[0:3], v204, s[4:7], s15 offen offset:0 sc1
    buffer_load_dwordx4 v[16:19], v204, s[4:7], s16 offen offset:0 sc1
    buffer_load_dwordx4 v[32:35], v204, s[4:7], s17 offen offset:0 sc1
    buffer_load_dwordx4 v[4:7], v204, s[4:7], s15 offen offset:1024 sc1
    buffer_load_dwordx4 v[20:23], v204, s[4:7], s16 offen offset:1024 sc1
    buffer_load_dwordx4 v[36:39], v204, s[4:7], s17 offen offset:1024 sc1
    buffer_load_dwordx4 v[8:11], v204, s[4:7], s15 offen offset:2048 sc1
    buffer_load_dwordx4 v[24:27], v204, s[4:7], s16 offen offset:2048 sc1
    buffer_load_dwordx4 v[40:43], v204, s[4:7], s17 offen offset:2048 sc1
    buffer_load_dwordx4 v[12:15], v204, s[4:7], s15 offen offset:3072 sc1
    buffer_load_dwordx4 v[28:31], v204, s[4:7], s16 offen offset:3072 sc1
    buffer_load_dwordx4 v[44:47], v204, s[4:7], s17 offen offset:3072 sc1
    buffer_load_dword v211, v210, s[4:7], s33 offen sc1
    buffer_load_dwordx4 v[48:51], v204, s[4:7], s18 offen offset:0 sc1
    buffer_load_dwordx4 v[52:55], v204, s[4:7], s18 offen offset:1024 sc1
    buffer_load_dwordx4 v[56:59], v204, s[4:7], s18 offen offset:2048 sc1
    buffer_load_dwordx4 v[60:63], v204, s[4:7], s18 offen offset:3072 sc1
    buffer_load_dwordx4 v[64:67], v204, s[4:7], s19 offen offset:0 sc1
    buffer_load_dwordx4 v[68:71], v204, s[4:7], s19 offen offset:1024 sc1
    buffer_load_dwordx4 v[72:75], v204, s[4:7], s19 offen offset:2048 sc1
    buffer_load_dwordx4 v[76:79], v204, s[4:7], s19 offen offset:3072 sc1
    s_waitcnt vmcnt(34)
    s_mov_b64 exec, 1
    buffer_store_dword v208, v209, s[4:7], s24 offen sc1
    s_mov_b64 exec, -1
    s_add_u32 s24, s24, s36
    s_branch main_kernel_a_top
main_kernel_a_slow:
    s_mov_b32 s39, 0
    s_waitcnt vmcnt(0)
    s_mov_b64 exec, 1
    buffer_store_dword v208, v209, s[4:7], s24 offen sc1
    s_mov_b64 exec, -1
    s_add_u32 s24, s24, s36
    s_branch main_kernel_a_fp
main_kernel_a_last:
    s_waitcnt vmcnt(0)
    s_mov_b64 exec, 1
    buffer_store_dword v208, v209, s[4:7], s24 offen sc1
    s_mov_b64 exec, -1
    s_add_u32 s24, s24, s36
    s_branch main_kernel_end
main_kernel_wo:
    s_mov_b32 s8, s46
    s_and_b32 s9, s47, 0xffff
    s_mov_b32 s10, 0x800000
    s_mov_b32 s11, 0x20000
    v_lshlrev_b32 v170, 4, v250
    s_lshr_b32 s23, s12, 2
    s_sub_u32 s21, s12, 5
    s_cselect_b32 s23, s23, s21
    s_cselect_b32 s18, 40, 63
    v_lshrrev_b32 v178, 2, v250
    v_and_b32 v179, 3, v250
    v_lshlrev_b32 v0, 11, v178
    v_lshl_add_u32 v0, v179, 4, v0
    s_lshl_b32 s19, s14, 15
    v_lshl_add_u32 v1, v178, 6, s19
    v_lshl_add_u32 v1, v179, 3, v1
    s_lshl_b32 s20, s14, 21
    s_lshl_b32 s21, s13, 6
    s_add_u32 s20, s20, s21
    s_add_u32 s21, s20, 0x0
    s_add_u32 m0, s19, 0
    s_nop 0
    buffer_load_dwordx4 v0, s[8:11], s21 offen lds
    s_add_u32 s21, s20, 0x8000
    s_add_u32 m0, s19, 1024
    s_nop 0
    buffer_load_dwordx4 v0, s[8:11], s21 offen lds
    s_add_u32 s21, s20, 0x10000
    s_add_u32 m0, s19, 2048
    s_nop 0
    buffer_load_dwordx4 v0, s[8:11], s21 offen lds
    s_add_u32 s21, s20, 0x18000
    s_add_u32 m0, s19, 3072
    s_nop 0
    buffer_load_dwordx4 v0, s[8:11], s21 offen lds
    s_add_u32 s21, s20, 0x20000
    s_add_u32 m0, s19, 4096
    s_nop 0
    buffer_load_dwordx4 v0, s[8:11], s21 offen lds
    s_add_u32 s21, s20, 0x28000
    s_add_u32 m0, s19, 5120
    s_nop 0
    buffer_load_dwordx4 v0, s[8:11], s21 offen lds
    s_add_u32 s21, s20, 0x30000
    s_add_u32 m0, s19, 6144
    s_nop 0
    buffer_load_dwordx4 v0, s[8:11], s21 offen lds
    s_add_u32 s21, s20, 0x38000
    s_add_u32 m0, s19, 7168
    s_nop 0
    buffer_load_dwordx4 v0, s[8:11], s21 offen lds
    s_add_u32 s21, s20, 0x40000
    s_add_u32 m0, s19, 8192
    s_nop 0
    buffer_load_dwordx4 v0, s[8:11], s21 offen lds
    s_add_u32 s21, s20, 0x48000
    s_add_u32 m0, s19, 9216
    s_nop 0
    buffer_load_dwordx4 v0, s[8:11], s21 offen lds
    s_add_u32 s21, s20, 0x50000
    s_add_u32 m0, s19, 10240
    s_nop 0
    buffer_load_dwordx4 v0, s[8:11], s21 offen lds
    s_add_u32 s21, s20, 0x58000
    s_add_u32 m0, s19, 11264
    s_nop 0
    buffer_load_dwordx4 v0, s[8:11], s21 offen lds
    s_add_u32 s21, s20, 0x60000
    s_add_u32 m0, s19, 12288
    s_nop 0
    buffer_load_dwordx4 v0, s[8:11], s21 offen lds
    s_add_u32 s21, s20, 0x68000
    s_add_u32 m0, s19, 13312
    s_nop 0
    buffer_load_dwordx4 v0, s[8:11], s21 offen lds
    s_add_u32 s21, s20, 0x70000
    s_add_u32 m0, s19, 14336
    s_nop 0
    buffer_load_dwordx4 v0, s[8:11], s21 offen lds
    s_add_u32 s21, s20, 0x78000
    s_add_u32 m0, s19, 15360
    s_nop 0
    buffer_load_dwordx4 v0, s[8:11], s21 offen lds
    s_add_u32 s21, s20, 0x80000
    s_add_u32 m0, s19, 16384
    s_nop 0
    buffer_load_dwordx4 v0, s[8:11], s21 offen lds
    s_add_u32 s21, s20, 0x88000
    s_add_u32 m0, s19, 17408
    s_nop 0
    buffer_load_dwordx4 v0, s[8:11], s21 offen lds
    s_add_u32 s21, s20, 0x90000
    s_add_u32 m0, s19, 18432
    s_nop 0
    buffer_load_dwordx4 v0, s[8:11], s21 offen lds
    s_add_u32 s21, s20, 0x98000
    s_add_u32 m0, s19, 19456
    s_nop 0
    buffer_load_dwordx4 v0, s[8:11], s21 offen lds
    s_add_u32 s21, s20, 0xa0000
    s_add_u32 m0, s19, 20480
    s_nop 0
    buffer_load_dwordx4 v0, s[8:11], s21 offen lds
    s_add_u32 s21, s20, 0xa8000
    s_add_u32 m0, s19, 21504
    s_nop 0
    buffer_load_dwordx4 v0, s[8:11], s21 offen lds
    s_add_u32 s21, s20, 0xb0000
    s_add_u32 m0, s19, 22528
    s_nop 0
    buffer_load_dwordx4 v0, s[8:11], s21 offen lds
    s_add_u32 s21, s20, 0xb8000
    s_add_u32 m0, s19, 23552
    s_nop 0
    buffer_load_dwordx4 v0, s[8:11], s21 offen lds
    s_add_u32 s21, s20, 0xc0000
    s_add_u32 m0, s19, 24576
    s_nop 0
    buffer_load_dwordx4 v0, s[8:11], s21 offen lds
    s_add_u32 s21, s20, 0xc8000
    s_add_u32 m0, s19, 25600
    s_nop 0
    buffer_load_dwordx4 v0, s[8:11], s21 offen lds
    s_add_u32 s21, s20, 0xd0000
    s_add_u32 m0, s19, 26624
    s_nop 0
    buffer_load_dwordx4 v0, s[8:11], s21 offen lds
    s_add_u32 s21, s20, 0xd8000
    s_add_u32 m0, s19, 27648
    s_nop 0
    buffer_load_dwordx4 v0, s[8:11], s21 offen lds
    s_add_u32 s21, s20, 0xe0000
    s_add_u32 m0, s19, 28672
    s_nop 0
    buffer_load_dwordx4 v0, s[8:11], s21 offen lds
    s_add_u32 s21, s20, 0xe8000
    s_add_u32 m0, s19, 29696
    s_nop 0
    buffer_load_dwordx4 v0, s[8:11], s21 offen lds
    s_add_u32 s21, s20, 0xf0000
    s_add_u32 m0, s19, 30720
    s_nop 0
    buffer_load_dwordx4 v0, s[8:11], s21 offen lds
    s_add_u32 s21, s20, 0xf8000
    s_add_u32 m0, s19, 31744
    s_nop 0
    buffer_load_dwordx4 v0, s[8:11], s21 offen lds
    v_and_b32 v178, 15, v250
    v_lshrrev_b32 v179, 4, v250
    v_lshlrev_b32 v175, 11, v178
    v_lshl_add_u32 v175, v179, 3, v175
    s_lshl_b32 s21, s14, 11
    s_add_u32 s21, s21, 131072
    v_add_u32 v176, s21, v170
    s_lshl_b32 s21, s14, 10
    s_add_u32 s21, s21, 131072
    v_add_u32 v177, s21, v170
    s_lshr_b32 s21, s13, 2
    s_lshl_b32 s21, s21, 8
    s_add_u32 s21, s21, 0x8412000
    s_lshl2_add_u32 s21, s18, s21
    v_mov_b32 v172, s21
    v_mov_b32 v173, 4
    s_lshl_b32 s21, s14, 4
    s_add_u32 s21, s21, s23
    s_lshl_b32 s21, s21, 2
    s_add_u32 s21, s21, 0x8400000
    s_lshl_b32 s22, s18, 8
    s_add_u32 s21, s21, s22
    s_mov_b64 exec, 0xff
    v_lshl_add_u32 v172, v250, 3, s21
    v_mov_b32 v173, 0x100
    s_mov_b64 exec, -1
    s_lshl_b32 s15, s14, 15
    s_lshl_b32 s21, s23, 17
    s_add_u32 s15, s15, s21
    s_add_u32 s15, s15, 0x3800000
    s_lshl_b32 s21, s18, 18
    s_add_u32 s15, s15, s21
    s_lshl_b32 s21, s23, 15
    s_lshl_b32 s22, s18, 16
    s_add_u32 s21, s21, s22
    s_and_b32 s22, s14, 1
    s_lshl_b32 s16, s13, 1
    s_add_u32 s16, s16, s22
    s_lshl_b32 s16, s16, 5
    s_add_u32 s16, s16, s21
    s_lshl_b32 s17, s13, 7
    s_add_u32 s17, s17, s22
    s_lshl_b32 s17, s17, 3
    s_add_u32 s17, s17, s21
    s_add_u32 s17, s17, 0x6400000
    s_waitcnt vmcnt(24)
    ds_read_b64_tr_b16 a[0:1], v1 offset:0
    ds_read_b64_tr_b16 a[2:3], v1 offset:1024
    ds_read_b64_tr_b16 a[128:129], v1 offset:32
    ds_read_b64_tr_b16 a[130:131], v1 offset:1056
    ds_read_b64_tr_b16 a[4:5], v1 offset:2048
    ds_read_b64_tr_b16 a[6:7], v1 offset:3072
    ds_read_b64_tr_b16 a[132:133], v1 offset:2080
    ds_read_b64_tr_b16 a[134:135], v1 offset:3104
    ds_read_b64_tr_b16 a[8:9], v1 offset:4096
    ds_read_b64_tr_b16 a[10:11], v1 offset:5120
    ds_read_b64_tr_b16 a[136:137], v1 offset:4128
    ds_read_b64_tr_b16 a[138:139], v1 offset:5152
    ds_read_b64_tr_b16 a[12:13], v1 offset:6144
    ds_read_b64_tr_b16 a[14:15], v1 offset:7168
    ds_read_b64_tr_b16 a[140:141], v1 offset:6176
    ds_read_b64_tr_b16 a[142:143], v1 offset:7200
    s_waitcnt lgkmcnt(0)
    s_add_u32 s21, s20, 0x100000
    s_add_u32 m0, s19, 0
    s_nop 0
    buffer_load_dwordx4 v0, s[8:11], s21 offen lds
    s_add_u32 s21, s20, 0x108000
    s_add_u32 m0, s19, 1024
    s_nop 0
    buffer_load_dwordx4 v0, s[8:11], s21 offen lds
    s_add_u32 s21, s20, 0x110000
    s_add_u32 m0, s19, 2048
    s_nop 0
    buffer_load_dwordx4 v0, s[8:11], s21 offen lds
    s_add_u32 s21, s20, 0x118000
    s_add_u32 m0, s19, 3072
    s_nop 0
    buffer_load_dwordx4 v0, s[8:11], s21 offen lds
    s_add_u32 s21, s20, 0x120000
    s_add_u32 m0, s19, 4096
    s_nop 0
    buffer_load_dwordx4 v0, s[8:11], s21 offen lds
    s_add_u32 s21, s20, 0x128000
    s_add_u32 m0, s19, 5120
    s_nop 0
    buffer_load_dwordx4 v0, s[8:11], s21 offen lds
    s_add_u32 s21, s20, 0x130000
    s_add_u32 m0, s19, 6144
    s_nop 0
    buffer_load_dwordx4 v0, s[8:11], s21 offen lds
    s_add_u32 s21, s20, 0x138000
    s_add_u32 m0, s19, 7168
    s_nop 0
    buffer_load_dwordx4 v0, s[8:11], s21 offen lds
    s_waitcnt vmcnt(24)
    ds_read_b64_tr_b16 a[16:17], v1 offset:8192
    ds_read_b64_tr_b16 a[18:19], v1 offset:9216
    ds_read_b64_tr_b16 a[144:145], v1 offset:8224
    ds_read_b64_tr_b16 a[146:147], v1 offset:9248
    ds_read_b64_tr_b16 a[20:21], v1 offset:10240
    ds_read_b64_tr_b16 a[22:23], v1 offset:11264
    ds_read_b64_tr_b16 a[148:149], v1 offset:10272
    ds_read_b64_tr_b16 a[150:151], v1 offset:11296
    ds_read_b64_tr_b16 a[24:25], v1 offset:12288
    ds_read_b64_tr_b16 a[26:27], v1 offset:13312
    ds_read_b64_tr_b16 a[152:153], v1 offset:12320
    ds_read_b64_tr_b16 a[154:155], v1 offset:13344
    ds_read_b64_tr_b16 a[28:29], v1 offset:14336
    ds_read_b64_tr_b16 a[30:31], v1 offset:15360
    ds_read_b64_tr_b16 a[156:157], v1 offset:14368
    ds_read_b64_tr_b16 a[158:159], v1 offset:15392
    s_waitcnt lgkmcnt(0)
    s_add_u32 s21, s20, 0x140000
    s_add_u32 m0, s19, 8192
    s_nop 0
    buffer_load_dwordx4 v0, s[8:11], s21 offen lds
    s_add_u32 s21, s20, 0x148000
    s_add_u32 m0, s19, 9216
    s_nop 0
    buffer_load_dwordx4 v0, s[8:11], s21 offen lds
    s_add_u32 s21, s20, 0x150000
    s_add_u32 m0, s19, 10240
    s_nop 0
    buffer_load_dwordx4 v0, s[8:11], s21 offen lds
    s_add_u32 s21, s20, 0x158000
    s_add_u32 m0, s19, 11264
    s_nop 0
    buffer_load_dwordx4 v0, s[8:11], s21 offen lds
    s_add_u32 s21, s20, 0x160000
    s_add_u32 m0, s19, 12288
    s_nop 0
    buffer_load_dwordx4 v0, s[8:11], s21 offen lds
    s_add_u32 s21, s20, 0x168000
    s_add_u32 m0, s19, 13312
    s_nop 0
    buffer_load_dwordx4 v0, s[8:11], s21 offen lds
    s_add_u32 s21, s20, 0x170000
    s_add_u32 m0, s19, 14336
    s_nop 0
    buffer_load_dwordx4 v0, s[8:11], s21 offen lds
    s_add_u32 s21, s20, 0x178000
    s_add_u32 m0, s19, 15360
    s_nop 0
    buffer_load_dwordx4 v0, s[8:11], s21 offen lds
    s_waitcnt vmcnt(24)
    ds_read_b64_tr_b16 a[32:33], v1 offset:16384
    ds_read_b64_tr_b16 a[34:35], v1 offset:17408
    ds_read_b64_tr_b16 a[160:161], v1 offset:16416
    ds_read_b64_tr_b16 a[162:163], v1 offset:17440
    ds_read_b64_tr_b16 a[36:37], v1 offset:18432
    ds_read_b64_tr_b16 a[38:39], v1 offset:19456
    ds_read_b64_tr_b16 a[164:165], v1 offset:18464
    ds_read_b64_tr_b16 a[166:167], v1 offset:19488
    ds_read_b64_tr_b16 a[40:41], v1 offset:20480
    ds_read_b64_tr_b16 a[42:43], v1 offset:21504
    ds_read_b64_tr_b16 a[168:169], v1 offset:20512
    ds_read_b64_tr_b16 a[170:171], v1 offset:21536
    ds_read_b64_tr_b16 a[44:45], v1 offset:22528
    ds_read_b64_tr_b16 a[46:47], v1 offset:23552
    ds_read_b64_tr_b16 a[172:173], v1 offset:22560
    ds_read_b64_tr_b16 a[174:175], v1 offset:23584
    s_waitcnt lgkmcnt(0)
    s_add_u32 s21, s20, 0x180000
    s_add_u32 m0, s19, 16384
    s_nop 0
    buffer_load_dwordx4 v0, s[8:11], s21 offen lds
    s_add_u32 s21, s20, 0x188000
    s_add_u32 m0, s19, 17408
    s_nop 0
    buffer_load_dwordx4 v0, s[8:11], s21 offen lds
    s_add_u32 s21, s20, 0x190000
    s_add_u32 m0, s19, 18432
    s_nop 0
    buffer_load_dwordx4 v0, s[8:11], s21 offen lds
    s_add_u32 s21, s20, 0x198000
    s_add_u32 m0, s19, 19456
    s_nop 0
    buffer_load_dwordx4 v0, s[8:11], s21 offen lds
    s_add_u32 s21, s20, 0x1a0000
    s_add_u32 m0, s19, 20480
    s_nop 0
    buffer_load_dwordx4 v0, s[8:11], s21 offen lds
    s_add_u32 s21, s20, 0x1a8000
    s_add_u32 m0, s19, 21504
    s_nop 0
    buffer_load_dwordx4 v0, s[8:11], s21 offen lds
    s_add_u32 s21, s20, 0x1b0000
    s_add_u32 m0, s19, 22528
    s_nop 0
    buffer_load_dwordx4 v0, s[8:11], s21 offen lds
    s_add_u32 s21, s20, 0x1b8000
    s_add_u32 m0, s19, 23552
    s_nop 0
    buffer_load_dwordx4 v0, s[8:11], s21 offen lds
    s_waitcnt vmcnt(24)
    ds_read_b64_tr_b16 a[48:49], v1 offset:24576
    ds_read_b64_tr_b16 a[50:51], v1 offset:25600
    ds_read_b64_tr_b16 a[176:177], v1 offset:24608
    ds_read_b64_tr_b16 a[178:179], v1 offset:25632
    ds_read_b64_tr_b16 a[52:53], v1 offset:26624
    ds_read_b64_tr_b16 a[54:55], v1 offset:27648
    ds_read_b64_tr_b16 a[180:181], v1 offset:26656
    ds_read_b64_tr_b16 a[182:183], v1 offset:27680
    ds_read_b64_tr_b16 a[56:57], v1 offset:28672
    ds_read_b64_tr_b16 a[58:59], v1 offset:29696
    ds_read_b64_tr_b16 a[184:185], v1 offset:28704
    ds_read_b64_tr_b16 a[186:187], v1 offset:29728
    ds_read_b64_tr_b16 a[60:61], v1 offset:30720
    ds_read_b64_tr_b16 a[62:63], v1 offset:31744
    ds_read_b64_tr_b16 a[188:189], v1 offset:30752
    ds_read_b64_tr_b16 a[190:191], v1 offset:31776
    s_waitcnt lgkmcnt(0)
    s_add_u32 s21, s20, 0x1c0000
    s_add_u32 m0, s19, 24576
    s_nop 0
    buffer_load_dwordx4 v0, s[8:11], s21 offen lds
    s_add_u32 s21, s20, 0x1c8000
    s_add_u32 m0, s19, 25600
    s_nop 0
    buffer_load_dwordx4 v0, s[8:11], s21 offen lds
    s_add_u32 s21, s20, 0x1d0000
    s_add_u32 m0, s19, 26624
    s_nop 0
    buffer_load_dwordx4 v0, s[8:11], s21 offen lds
    s_add_u32 s21, s20, 0x1d8000
    s_add_u32 m0, s19, 27648
    s_nop 0
    buffer_load_dwordx4 v0, s[8:11], s21 offen lds
    s_add_u32 s21, s20, 0x1e0000
    s_add_u32 m0, s19, 28672
    s_nop 0
    buffer_load_dwordx4 v0, s[8:11], s21 offen lds
    s_add_u32 s21, s20, 0x1e8000
    s_add_u32 m0, s19, 29696
    s_nop 0
    buffer_load_dwordx4 v0, s[8:11], s21 offen lds
    s_add_u32 s21, s20, 0x1f0000
    s_add_u32 m0, s19, 30720
    s_nop 0
    buffer_load_dwordx4 v0, s[8:11], s21 offen lds
    s_add_u32 s21, s20, 0x1f8000
    s_add_u32 m0, s19, 31744
    s_nop 0
    buffer_load_dwordx4 v0, s[8:11], s21 offen lds
    s_waitcnt vmcnt(24)
    ds_read_b64_tr_b16 a[64:65], v1 offset:0
    ds_read_b64_tr_b16 a[66:67], v1 offset:1024
    ds_read_b64_tr_b16 a[192:193], v1 offset:32
    ds_read_b64_tr_b16 a[194:195], v1 offset:1056
    ds_read_b64_tr_b16 a[68:69], v1 offset:2048
    ds_read_b64_tr_b16 a[70:71], v1 offset:3072
    ds_read_b64_tr_b16 a[196:197], v1 offset:2080
    ds_read_b64_tr_b16 a[198:199], v1 offset:3104
    ds_read_b64_tr_b16 a[72:73], v1 offset:4096
    ds_read_b64_tr_b16 a[74:75], v1 offset:5120
    ds_read_b64_tr_b16 a[200:201], v1 offset:4128
    ds_read_b64_tr_b16 a[202:203], v1 offset:5152
    ds_read_b64_tr_b16 a[76:77], v1 offset:6144
    ds_read_b64_tr_b16 a[78:79], v1 offset:7168
    ds_read_b64_tr_b16 a[204:205], v1 offset:6176
    ds_read_b64_tr_b16 a[206:207], v1 offset:7200
    s_waitcnt lgkmcnt(0)
    s_waitcnt vmcnt(16)
    ds_read_b64_tr_b16 a[80:81], v1 offset:8192
    ds_read_b64_tr_b16 a[82:83], v1 offset:9216
    ds_read_b64_tr_b16 a[208:209], v1 offset:8224
    ds_read_b64_tr_b16 a[210:211], v1 offset:9248
    ds_read_b64_tr_b16 a[84:85], v1 offset:10240
    ds_read_b64_tr_b16 a[86:87], v1 offset:11264
    ds_read_b64_tr_b16 a[212:213], v1 offset:10272
    ds_read_b64_tr_b16 a[214:215], v1 offset:11296
    ds_read_b64_tr_b16 a[88:89], v1 offset:12288
    ds_read_b64_tr_b16 a[90:91], v1 offset:13312
    ds_read_b64_tr_b16 a[216:217], v1 offset:12320
    ds_read_b64_tr_b16 a[218:219], v1 offset:13344
    ds_read_b64_tr_b16 a[92:93], v1 offset:14336
    ds_read_b64_tr_b16 a[94:95], v1 offset:15360
    ds_read_b64_tr_b16 a[220:221], v1 offset:14368
    ds_read_b64_tr_b16 a[222:223], v1 offset:15392
    s_waitcnt lgkmcnt(0)
    s_waitcnt vmcnt(8)
    ds_read_b64_tr_b16 a[96:97], v1 offset:16384
    ds_read_b64_tr_b16 a[98:99], v1 offset:17408
    ds_read_b64_tr_b16 a[224:225], v1 offset:16416
    ds_read_b64_tr_b16 a[226:227], v1 offset:17440
    ds_read_b64_tr_b16 a[100:101], v1 offset:18432
    ds_read_b64_tr_b16 a[102:103], v1 offset:19456
    ds_read_b64_tr_b16 a[228:229], v1 offset:18464
    ds_read_b64_tr_b16 a[230:231], v1 offset:19488
    ds_read_b64_tr_b16 a[104:105], v1 offset:20480
    ds_read_b64_tr_b16 a[106:107], v1 offset:21504
    ds_read_b64_tr_b16 a[232:233], v1 offset:20512
    ds_read_b64_tr_b16 a[234:235], v1 offset:21536
    ds_read_b64_tr_b16 a[108:109], v1 offset:22528
    ds_read_b64_tr_b16 a[110:111], v1 offset:23552
    ds_read_b64_tr_b16 a[236:237], v1 offset:22560
    ds_read_b64_tr_b16 a[238:239], v1 offset:23584
    s_waitcnt lgkmcnt(0)
    s_waitcnt vmcnt(0)
    ds_read_b64_tr_b16 a[112:113], v1 offset:24576
    ds_read_b64_tr_b16 a[114:115], v1 offset:25600
    ds_read_b64_tr_b16 a[240:241], v1 offset:24608
    ds_read_b64_tr_b16 a[242:243], v1 offset:25632
    ds_read_b64_tr_b16 a[116:117], v1 offset:26624
    ds_read_b64_tr_b16 a[118:119], v1 offset:27648
    ds_read_b64_tr_b16 a[244:245], v1 offset:26656
    ds_read_b64_tr_b16 a[246:247], v1 offset:27680
    ds_read_b64_tr_b16 a[120:121], v1 offset:28672
    ds_read_b64_tr_b16 a[122:123], v1 offset:29696
    ds_read_b64_tr_b16 a[248:249], v1 offset:28704
    ds_read_b64_tr_b16 a[250:251], v1 offset:29728
    ds_read_b64_tr_b16 a[124:125], v1 offset:30720
    ds_read_b64_tr_b16 a[126:127], v1 offset:31744
    ds_read_b64_tr_b16 a[252:253], v1 offset:30752
    ds_read_b64_tr_b16 a[254:255], v1 offset:31776
    s_waitcnt lgkmcnt(0)
    s_cmp_lt_u32 s12, 5
    s_cbranch_scc1 main_kernel_o_top
    v_mul_u32_u24 v178, 2, v173
    v_sub_u32 v171, v172, v178
main_kernel_o_gp:
    buffer_load_dword v174, v171, s[4:7], 0 offen sc1
    s_waitcnt vmcnt(0)
    v_cmp_eq_u32 vcc, 0, v174
    s_cbranch_vccz main_kernel_o_top
    s_sleep 32
    s_sub_u32 s29, s29, 1
    s_cbranch_scc0 main_kernel_o_gp
    s_branch main_kernel_end
main_kernel_o_top:
    buffer_load_dword v174, v172, s[4:7], 0 offen sc1
    s_waitcnt vmcnt(0)
    v_cmp_eq_u32 vcc, 0, v174
    s_cbranch_vccz main_kernel_o_go
    s_sleep 1
    s_sub_u32 s29, s29, 1
    s_cbranch_scc0 main_kernel_o_top
    s_branch main_kernel_end
main_kernel_o_go:
    s_cmp_ge_u32 s18, 54
    s_cselect_b32 s33, 0x7f000000, 0
    v_add_u32 v172, v172, v173
    buffer_load_dword v174, v172, s[4:7], s33 offen sc1
    buffer_load_dwordx4 v[0:3], v170, s[4:7], s15 offen offset:0 sc1
    buffer_load_dwordx4 v[4:7], v170, s[4:7], s15 offen offset:1024 sc1
    buffer_load_dwordx4 v[8:11], v170, s[4:7], s15 offen offset:2048 sc1
    buffer_load_dwordx4 v[12:15], v170, s[4:7], s15 offen offset:3072 sc1
    s_add_u32 s15, s15, 4096
    buffer_load_dwordx4 v[16:19], v170, s[4:7], s15 offen offset:0 sc1
    buffer_load_dwordx4 v[20:23], v170, s[4:7], s15 offen offset:1024 sc1
    buffer_load_dwordx4 v[24:27], v170, s[4:7], s15 offen offset:2048 sc1
    buffer_load_dwordx4 v[28:31], v170, s[4:7], s15 offen offset:3072 sc1
    s_add_u32 s15, s15, 4096
    buffer_load_dwordx4 v[32:35], v170, s[4:7], s15 offen offset:0 sc1
    buffer_load_dwordx4 v[36:39], v170, s[4:7], s15 offen offset:1024 sc1
    buffer_load_dwordx4 v[40:43], v170, s[4:7], s15 offen offset:2048 sc1
    buffer_load_dwordx4 v[44:47], v170, s[4:7], s15 offen offset:3072 sc1
    s_add_u32 s15, s15, 4096
    buffer_load_dwordx4 v[48:51], v170, s[4:7], s15 offen offset:0 sc1
    buffer_load_dwordx4 v[52:55], v170, s[4:7], s15 offen offset:1024 sc1
    buffer_load_dwordx4 v[56:59], v170, s[4:7], s15 offen offset:2048 sc1
    buffer_load_dwordx4 v[60:63], v170, s[4:7], s15 offen offset:3072 sc1
    s_add_u32 s15, s15, 4096
    buffer_load_dwordx2 v[160:161], v175, s[96:99], s16 offen
    buffer_load_dwordx2 v[162:163], v170, s[4:7], s17 offen sc1
    buffer_load_dwordx4 v[64:67], v170, s[4:7], s15 offen offset:0 sc1
    buffer_load_dwordx4 v[68:71], v170, s[4:7], s15 offen offset:1024 sc1
    buffer_load_dwordx4 v[72:75], v170, s[4:7], s15 offen offset:2048 sc1
    buffer_load_dwordx4 v[76:79], v170, s[4:7], s15 offen offset:3072 sc1
    s_add_u32 s15, s15, 4096
    buffer_load_dwordx4 v[80:83], v170, s[4:7], s15 offen offset:0 sc1
    buffer_load_dwordx4 v[84:87], v170, s[4:7], s15 offen offset:1024 sc1
    buffer_load_dwordx4 v[88:91], v170, s[4:7], s15 offen offset:2048 sc1
    buffer_load_dwordx4 v[92:95], v170, s[4:7], s15 offen offset:3072 sc1
    s_add_u32 s15, s15, 4096
    buffer_load_dwordx4 v[96:99], v170, s[4:7], s15 offen offset:0 sc1
    buffer_load_dwordx4 v[100:103], v170, s[4:7], s15 offen offset:1024 sc1
    buffer_load_dwordx4 v[104:107], v170, s[4:7], s15 offen offset:2048 sc1
    buffer_load_dwordx4 v[108:111], v170, s[4:7], s15 offen offset:3072 sc1
    s_add_u32 s15, s15, 4096
    buffer_load_dwordx4 v[112:115], v170, s[4:7], s15 offen offset:0 sc1
    buffer_load_dwordx4 v[116:119], v170, s[4:7], s15 offen offset:1024 sc1
    buffer_load_dwordx4 v[120:123], v170, s[4:7], s15 offen offset:2048 sc1
    buffer_load_dwordx4 v[124:127], v170, s[4:7], s15 offen offset:3072 sc1
    s_add_u32 s15, s15, 233472
    s_mov_b64 exec, -1
    buffer_load_dword v171, v175, s[96:99], s16 offen
    buffer_load_dword v171, v175, s[96:99], s16 offen
    s_branch main_kernel_o_x2
main_kernel_o_x:
    s_cmp_ge_u32 s18, 54
    s_cselect_b32 s33, 0x7f000000, 0
    buffer_load_dwordx2 v[160:161], v175, s[96:99], s16 offen
    buffer_load_dwordx2 v[162:163], v170, s[4:7], s17 offen sc1
main_kernel_o_x2:
    s_add_u32 s17, s17, 65536
    s_add_u32 s18, s18, 1
    s_mov_b32 s39, 0
    s_waitcnt vmcnt(34)
    v_cmp_eq_u32 vcc, 0, v174
    s_cmp_le_u32 s18, 62
    s_cbranch_scc0 main_kernel_o_n
    s_cbranch_vccnz main_kernel_o_n
    s_mov_b32 s39, 1
    v_add_u32 v172, v172, v173
    buffer_load_dword v174, v172, s[4:7], s33 offen sc1
    s_waitcnt vmcnt(34)
    v_mfma_f32_16x16x32_bf16 v[128:131], a[0:3], v[0:3], 0
    v_mfma_f32_16x16x32_bf16 v[132:135], a[128:131], v[0:3], 0
    buffer_load_dwordx4 v[0:3], v170, s[4:7], s15 offen offset:0 sc1
    s_waitcnt vmcnt(34)
    v_mfma_f32_16x16x32_bf16 v[128:131], a[4:7], v[4:7], v[128:131]
    v_mfma_f32_16x16x32_bf16 v[132:135], a[132:135], v[4:7], v[132:135]
    buffer_load_dwordx4 v[4:7], v170, s[4:7], s15 offen offset:1024 sc1
    s_waitcnt vmcnt(34)
    v_mfma_f32_16x16x32_bf16 v[128:131], a[8:11], v[8:11], v[128:131]
    v_mfma_f32_16x16x32_bf16 v[132:135], a[136:139], v[8:11], v[132:135]
    buffer_load_dwordx4 v[8:11], v170, s[4:7], s15 offen offset:2048 sc1
    s_waitcnt vmcnt(34)
    v_mfma_f32_16x16x32_bf16 v[128:131], a[12:15], v[12:15], v[128:131]
    v_mfma_f32_16x16x32_bf16 v[132:135], a[140:143], v[12:15], v[132:135]
    buffer_load_dwordx4 v[12:15], v170, s[4:7], s15 offen offset:3072 sc1
    s_add_u32 s15, s15, 4096
    s_waitcnt vmcnt(34)
    v_mfma_f32_16x16x32_bf16 v[128:131], a[16:19], v[16:19], v[128:131]
    v_mfma_f32_16x16x32_bf16 v[132:135], a[144:147], v[16:19], v[132:135]
    buffer_load_dwordx4 v[16:19], v170, s[4:7], s15 offen offset:0 sc1
    s_waitcnt vmcnt(34)
    v_mfma_f32_16x16x32_bf16 v[128:131], a[20:23], v[20:23], v[128:131]
    v_mfma_f32_16x16x32_bf16 v[132:135], a[148:151], v[20:23], v[132:135]
    buffer_load_dwordx4 v[20:23], v170, s[4:7], s15 offen offset:1024 sc1
    s_waitcnt vmcnt(34)
    v_mfma_f32_16x16x32_bf16 v[128:131], a[24:27], v[24:27], v[128:131]
    v_mfma_f32_16x16x32_bf16 v[132:135], a[152:155], v[24:27], v[132:135]
    buffer_load_dwordx4 v[24:27], v170, s[4:7], s15 offen offset:2048 sc1
    s_waitcnt vmcnt(34)
    v_mfma_f32_16x16x32_bf16 v[128:131], a[28:31], v[28:31], v[128:131]
    v_mfma_f32_16x16x32_bf16 v[132:135], a[156:159], v[28:31], v[132:135]
    buffer_load_dwordx4 v[28:31], v170, s[4:7], s15 offen offset:3072 sc1
    s_add_u32 s15, s15, 4096
    s_waitcnt vmcnt(34)
    v_mfma_f32_16x16x32_bf16 v[128:131], a[32:35], v[32:35], v[128:131]
    v_mfma_f32_16x16x32_bf16 v[132:135], a[160:163], v[32:35], v[132:135]
    buffer_load_dwordx4 v[32:35], v170, s[4:7], s15 offen offset:0 sc1
    s_waitcnt vmcnt(34)
    v_mfma_f32_16x16x32_bf16 v[128:131], a[36:39], v[36:39], v[128:131]
    v_mfma_f32_16x16x32_bf16 v[132:135], a[164:167], v[36:39], v[132:135]
    buffer_load_dwordx4 v[36:39], v170, s[4:7], s15 offen offset:1024 sc1
    s_waitcnt vmcnt(34)
    v_mfma_f32_16x16x32_bf16 v[128:131], a[40:43], v[40:43], v[128:131]
    v_mfma_f32_16x16x32_bf16 v[132:135], a[168:171], v[40:43], v[132:135]
    buffer_load_dwordx4 v[40:43], v170, s[4:7], s15 offen offset:2048 sc1
    s_waitcnt vmcnt(34)
    v_mfma_f32_16x16x32_bf16 v[128:131], a[44:47], v[44:47], v[128:131]
    v_mfma_f32_16x16x32_bf16 v[132:135], a[172:175], v[44:47], v[132:135]
    buffer_load_dwordx4 v[44:47], v170, s[4:7], s15 offen offset:3072 sc1
    s_add_u32 s15, s15, 4096
    s_waitcnt vmcnt(34)
    v_mfma_f32_16x16x32_bf16 v[128:131], a[48:51], v[48:51], v[128:131]
    v_mfma_f32_16x16x32_bf16 v[132:135], a[176:179], v[48:51], v[132:135]
    buffer_load_dwordx4 v[48:51], v170, s[4:7], s15 offen offset:0 sc1
    s_waitcnt vmcnt(34)
    v_mfma_f32_16x16x32_bf16 v[128:131], a[52:55], v[52:55], v[128:131]
    v_mfma_f32_16x16x32_bf16 v[132:135], a[180:183], v[52:55], v[132:135]
    buffer_load_dwordx4 v[52:55], v170, s[4:7], s15 offen offset:1024 sc1
    s_waitcnt vmcnt(34)
    v_mfma_f32_16x16x32_bf16 v[128:131], a[56:59], v[56:59], v[128:131]
    v_mfma_f32_16x16x32_bf16 v[132:135], a[184:187], v[56:59], v[132:135]
    buffer_load_dwordx4 v[56:59], v170, s[4:7], s15 offen offset:2048 sc1
    s_waitcnt vmcnt(34)
    v_mfma_f32_16x16x32_bf16 v[128:131], a[60:63], v[60:63], v[128:131]
    v_mfma_f32_16x16x32_bf16 v[132:135], a[188:191], v[60:63], v[132:135]
    buffer_load_dwordx4 v[60:63], v170, s[4:7], s15 offen offset:3072 sc1
    s_add_u32 s15, s15, 4096
    s_waitcnt vmcnt(34)
    v_mfma_f32_16x16x32_bf16 v[128:131], a[64:67], v[64:67], v[128:131]
    v_mfma_f32_16x16x32_bf16 v[132:135], a[192:195], v[64:67], v[132:135]
    buffer_load_dwordx4 v[64:67], v170, s[4:7], s15 offen offset:0 sc1
    s_waitcnt vmcnt(34)
    v_mfma_f32_16x16x32_bf16 v[128:131], a[68:71], v[68:71], v[128:131]
    v_mfma_f32_16x16x32_bf16 v[132:135], a[196:199], v[68:71], v[132:135]
    buffer_load_dwordx4 v[68:71], v170, s[4:7], s15 offen offset:1024 sc1
    s_waitcnt vmcnt(34)
    v_mfma_f32_16x16x32_bf16 v[128:131], a[72:75], v[72:75], v[128:131]
    v_mfma_f32_16x16x32_bf16 v[132:135], a[200:203], v[72:75], v[132:135]
    buffer_load_dwordx4 v[72:75], v170, s[4:7], s15 offen offset:2048 sc1
    s_waitcnt vmcnt(34)
    v_mfma_f32_16x16x32_bf16 v[128:131], a[76:79], v[76:79], v[128:131]
    v_mfma_f32_16x16x32_bf16 v[132:135], a[204:207], v[76:79], v[132:135]
    buffer_load_dwordx4 v[76:79], v170, s[4:7], s15 offen offset:3072 sc1
    s_add_u32 s15, s15, 4096
    s_waitcnt vmcnt(34)
    v_mfma_f32_16x16x32_bf16 v[128:131], a[80:83], v[80:83], v[128:131]
    v_mfma_f32_16x16x32_bf16 v[132:135], a[208:211], v[80:83], v[132:135]
    buffer_load_dwordx4 v[80:83], v170, s[4:7], s15 offen offset:0 sc1
    s_waitcnt vmcnt(34)
    v_mfma_f32_16x16x32_bf16 v[128:131], a[84:87], v[84:87], v[128:131]
    v_mfma_f32_16x16x32_bf16 v[132:135], a[212:215], v[84:87], v[132:135]
    buffer_load_dwordx4 v[84:87], v170, s[4:7], s15 offen offset:1024 sc1
    s_waitcnt vmcnt(34)
    v_mfma_f32_16x16x32_bf16 v[128:131], a[88:91], v[88:91], v[128:131]
    v_mfma_f32_16x16x32_bf16 v[132:135], a[216:219], v[88:91], v[132:135]
    buffer_load_dwordx4 v[88:91], v170, s[4:7], s15 offen offset:2048 sc1
    s_waitcnt vmcnt(34)
    v_mfma_f32_16x16x32_bf16 v[128:131], a[92:95], v[92:95], v[128:131]
    v_mfma_f32_16x16x32_bf16 v[132:135], a[220:223], v[92:95], v[132:135]
    buffer_load_dwordx4 v[92:95], v170, s[4:7], s15 offen offset:3072 sc1
    s_add_u32 s15, s15, 4096
    s_waitcnt vmcnt(34)
    v_mfma_f32_16x16x32_bf16 v[128:131], a[96:99], v[96:99], v[128:131]
    v_mfma_f32_16x16x32_bf16 v[132:135], a[224:227], v[96:99], v[132:135]
    buffer_load_dwordx4 v[96:99], v170, s[4:7], s15 offen offset:0 sc1
    s_waitcnt vmcnt(34)
    v_mfma_f32_16x16x32_bf16 v[128:131], a[100:103], v[100:103], v[128:131]
    v_mfma_f32_16x16x32_bf16 v[132:135], a[228:231], v[100:103], v[132:135]
    buffer_load_dwordx4 v[100:103], v170, s[4:7], s15 offen offset:1024 sc1
    s_waitcnt vmcnt(34)
    v_mfma_f32_16x16x32_bf16 v[128:131], a[104:107], v[104:107], v[128:131]
    v_mfma_f32_16x16x32_bf16 v[132:135], a[232:235], v[104:107], v[132:135]
    buffer_load_dwordx4 v[104:107], v170, s[4:7], s15 offen offset:2048 sc1
    s_waitcnt vmcnt(34)
    v_mfma_f32_16x16x32_bf16 v[128:131], a[108:111], v[108:111], v[128:131]
    v_mfma_f32_16x16x32_bf16 v[132:135], a[236:239], v[108:111], v[132:135]
    buffer_load_dwordx4 v[108:111], v170, s[4:7], s15 offen offset:3072 sc1
    s_add_u32 s15, s15, 4096
    s_waitcnt vmcnt(34)
    v_mfma_f32_16x16x32_bf16 v[128:131], a[112:115], v[112:115], v[128:131]
    v_mfma_f32_16x16x32_bf16 v[132:135], a[240:243], v[112:115], v[132:135]
    buffer_load_dwordx4 v[112:115], v170, s[4:7], s15 offen offset:0 sc1
    s_waitcnt vmcnt(34)
    v_mfma_f32_16x16x32_bf16 v[128:131], a[116:119], v[116:119], v[128:131]
    v_mfma_f32_16x16x32_bf16 v[132:135], a[244:247], v[116:119], v[132:135]
    buffer_load_dwordx4 v[116:119], v170, s[4:7], s15 offen offset:1024 sc1
    s_waitcnt vmcnt(34)
    v_mfma_f32_16x16x32_bf16 v[128:131], a[120:123], v[120:123], v[128:131]
    v_mfma_f32_16x16x32_bf16 v[132:135], a[248:251], v[120:123], v[132:135]
    buffer_load_dwordx4 v[120:123], v170, s[4:7], s15 offen offset:2048 sc1
    s_waitcnt vmcnt(34)
    v_mfma_f32_16x16x32_bf16 v[128:131], a[124:127], v[124:127], v[128:131]
    v_mfma_f32_16x16x32_bf16 v[132:135], a[252:255], v[124:127], v[132:135]
    buffer_load_dwordx4 v[124:127], v170, s[4:7], s15 offen offset:3072 sc1
    s_add_u32 s15, s15, 233472
    s_waitcnt vmcnt(33)
    s_branch main_kernel_o_e
main_kernel_o_n:
    buffer_load_dword v174, v172, s[4:7], s33 offen sc1
    s_waitcnt vmcnt(34)
    v_mfma_f32_16x16x32_bf16 v[128:131], a[0:3], v[0:3], 0
    v_mfma_f32_16x16x32_bf16 v[132:135], a[128:131], v[0:3], 0
    s_waitcnt vmcnt(33)
    v_mfma_f32_16x16x32_bf16 v[128:131], a[4:7], v[4:7], v[128:131]
    v_mfma_f32_16x16x32_bf16 v[132:135], a[132:135], v[4:7], v[132:135]
    s_waitcnt vmcnt(32)
    v_mfma_f32_16x16x32_bf16 v[128:131], a[8:11], v[8:11], v[128:131]
    v_mfma_f32_16x16x32_bf16 v[132:135], a[136:139], v[8:11], v[132:135]
    s_waitcnt vmcnt(31)
    v_mfma_f32_16x16x32_bf16 v[128:131], a[12:15], v[12:15], v[128:131]
    v_mfma_f32_16x16x32_bf16 v[132:135], a[140:143], v[12:15], v[132:135]
    s_waitcnt vmcnt(30)
    v_mfma_f32_16x16x32_bf16 v[128:131], a[16:19], v[16:19], v[128:131]
    v_mfma_f32_16x16x32_bf16 v[132:135], a[144:147], v[16:19], v[132:135]
    s_waitcnt vmcnt(29)
    v_mfma_f32_16x16x32_bf16 v[128:131], a[20:23], v[20:23], v[128:131]
    v_mfma_f32_16x16x32_bf16 v[132:135], a[148:151], v[20:23], v[132:135]
    s_waitcnt vmcnt(28)
    v_mfma_f32_16x16x32_bf16 v[128:131], a[24:27], v[24:27], v[128:131]
    v_mfma_f32_16x16x32_bf16 v[132:135], a[152:155], v[24:27], v[132:135]
    s_waitcnt vmcnt(27)
    v_mfma_f32_16x16x32_bf16 v[128:131], a[28:31], v[28:31], v[128:131]
    v_mfma_f32_16x16x32_bf16 v[132:135], a[156:159], v[28:31], v[132:135]
    s_waitcnt vmcnt(26)
    v_mfma_f32_16x16x32_bf16 v[128:131], a[32:35], v[32:35], v[128:131]
    v_mfma_f32_16x16x32_bf16 v[132:135], a[160:163], v[32:35], v[132:135]
    s_waitcnt vmcnt(25)
    v_mfma_f32_16x16x32_bf16 v[128:131], a[36:39], v[36:39], v[128:131]
    v_mfma_f32_16x16x32_bf16 v[132:135], a[164:167], v[36:39], v[132:135]
    s_waitcnt vmcnt(24)
    v_mfma_f32_16x16x32_bf16 v[128:131], a[40:43], v[40:43], v[128:131]
    v_mfma_f32_16x16x32_bf16 v[132:135], a[168:171], v[40:43], v[132:135]
    s_waitcnt vmcnt(23)
    v_mfma_f32_16x16x32_bf16 v[128:131], a[44:47], v[44:47], v[128:131]
    v_mfma_f32_16x16x32_bf16 v[132:135], a[172:175], v[44:47], v[132:135]
    s_waitcnt vmcnt(22)
    v_mfma_f32_16x16x32_bf16 v[128:131], a[48:51], v[48:51], v[128:131]
    v_mfma_f32_16x16x32_bf16 v[132:135], a[176:179], v[48:51], v[132:135]
    s_waitcnt vmcnt(21)
    v_mfma_f32_16x16x32_bf16 v[128:131], a[52:55], v[52:55], v[128:131]
    v_mfma_f32_16x16x32_bf16 v[132:135], a[180:183], v[52:55], v[132:135]
    s_waitcnt vmcnt(20)
    v_mfma_f32_16x16x32_bf16 v[128:131], a[56:59], v[56:59], v[128:131]
    v_mfma_f32_16x16x32_bf16 v[132:135], a[184:187], v[56:59], v[132:135]
    s_waitcnt vmcnt(19)
    v_mfma_f32_16x16x32_bf16 v[128:131], a[60:63], v[60:63], v[128:131]
    v_mfma_f32_16x16x32_bf16 v[132:135], a[188:191], v[60:63], v[132:135]
    s_waitcnt vmcnt(18)
    v_mfma_f32_16x16x32_bf16 v[128:131], a[64:67], v[64:67], v[128:131]
    v_mfma_f32_16x16x32_bf16 v[132:135], a[192:195], v[64:67], v[132:135]
    s_waitcnt vmcnt(17)
    v_mfma_f32_16x16x32_bf16 v[128:131], a[68:71], v[68:71], v[128:131]
    v_mfma_f32_16x16x32_bf16 v[132:135], a[196:199], v[68:71], v[132:135]
    s_waitcnt vmcnt(16)
    v_mfma_f32_16x16x32_bf16 v[128:131], a[72:75], v[72:75], v[128:131]
    v_mfma_f32_16x16x32_bf16 v[132:135], a[200:203], v[72:75], v[132:135]
    s_waitcnt vmcnt(15)
    v_mfma_f32_16x16x32_bf16 v[128:131], a[76:79], v[76:79], v[128:131]
    v_mfma_f32_16x16x32_bf16 v[132:135], a[204:207], v[76:79], v[132:135]
    s_waitcnt vmcnt(14)
    v_mfma_f32_16x16x32_bf16 v[128:131], a[80:83], v[80:83], v[128:131]
    v_mfma_f32_16x16x32_bf16 v[132:135], a[208:211], v[80:83], v[132:135]
    s_waitcnt vmcnt(13)
    v_mfma_f32_16x16x32_bf16 v[128:131], a[84:87], v[84:87], v[128:131]
    v_mfma_f32_16x16x32_bf16 v[132:135], a[212:215], v[84:87], v[132:135]
    s_waitcnt vmcnt(12)
    v_mfma_f32_16x16x32_bf16 v[128:131], a[88:91], v[88:91], v[128:131]
    v_mfma_f32_16x16x32_bf16 v[132:135], a[216:219], v[88:91], v[132:135]
    s_waitcnt vmcnt(11)
    v_mfma_f32_16x16x32_bf16 v[128:131], a[92:95], v[92:95], v[128:131]
    v_mfma_f32_16x16x32_bf16 v[132:135], a[220:223], v[92:95], v[132:135]
    s_waitcnt vmcnt(10)
    v_mfma_f32_16x16x32_bf16 v[128:131], a[96:99], v[96:99], v[128:131]
    v_mfma_f32_16x16x32_bf16 v[132:135], a[224:227], v[96:99], v[132:135]
    s_waitcnt vmcnt(9)
    v_mfma_f32_16x16x32_bf16 v[128:131], a[100:103], v[100:103], v[128:131]
    v_mfma_f32_16x16x32_bf16 v[132:135], a[228:231], v[100:103], v[132:135]
    s_waitcnt vmcnt(8)
    v_mfma_f32_16x16x32_bf16 v[128:131], a[104:107], v[104:107], v[128:131]
    v_mfma_f32_16x16x32_bf16 v[132:135], a[232:235], v[104:107], v[132:135]
    s_waitcnt vmcnt(7)
    v_mfma_f32_16x16x32_bf16 v[128:131], a[108:111], v[108:111], v[128:131]
    v_mfma_f32_16x16x32_bf16 v[132:135], a[236:239], v[108:111], v[132:135]
    s_waitcnt vmcnt(6)
    v_mfma_f32_16x16x32_bf16 v[128:131], a[112:115], v[112:115], v[128:131]
    v_mfma_f32_16x16x32_bf16 v[132:135], a[240:243], v[112:115], v[132:135]
    s_waitcnt vmcnt(5)
    v_mfma_f32_16x16x32_bf16 v[128:131], a[116:119], v[116:119], v[128:131]
    v_mfma_f32_16x16x32_bf16 v[132:135], a[244:247], v[116:119], v[132:135]
    s_waitcnt vmcnt(4)
    v_mfma_f32_16x16x32_bf16 v[128:131], a[120:123], v[120:123], v[128:131]
    v_mfma_f32_16x16x32_bf16 v[132:135], a[248:251], v[120:123], v[132:135]
    s_waitcnt vmcnt(3)
    v_mfma_f32_16x16x32_bf16 v[128:131], a[124:127], v[124:127], v[128:131]
    v_mfma_f32_16x16x32_bf16 v[132:135], a[252:255], v[124:127], v[132:135]
    s_waitcnt vmcnt(0)
    v_cmp_eq_u32 vcc, 0, v174
main_kernel_o_e:
    v_lshlrev_b32 v164, 16, v160
    v_and_b32 v165, 0xffff0000, v160
    v_lshlrev_b32 v166, 16, v161
    v_and_b32 v167, 0xffff0000, v161
    v_lshlrev_b32 v160, 16, v162
    v_and_b32 v161, 0xffff0000, v162
    v_lshlrev_b32 v162, 16, v163
    v_and_b32 v163, 0xffff0000, v163
    s_cmp_ge_u32 s14, 2
    ds_write_b128 v176, v[128:131] offset:0
    ds_write_b128 v176, v[132:135] offset:1024
    v_xor_b32 v176, 0x4000, v176
    s_waitcnt lgkmcnt(0)
    s_barrier
    s_cbranch_scc1 main_kernel_o_nx
    ds_read_b128 v[144:147], v177 offset:0
    ds_read_b128 v[148:151], v177 offset:2048
    ds_read_b128 v[152:155], v177 offset:4096
    ds_read_b128 v[156:159], v177 offset:6144
    v_xor_b32 v177, 0x4000, v177
    s_waitcnt lgkmcnt(2)
    v_pk_add_f32 v[144:145], v[144:145], v[148:149]
    v_pk_add_f32 v[146:147], v[146:147], v[150:151]
    s_waitcnt lgkmcnt(0)
    v_pk_add_f32 v[152:153], v[152:153], v[156:157]
    v_pk_add_f32 v[154:155], v[154:155], v[158:159]
    v_pk_add_f32 v[144:145], v[144:145], v[152:153]
    v_pk_add_f32 v[146:147], v[146:147], v[154:155]
    v_pk_fma_f32 v[144:145], v[144:145], v[160:161], v[164:165]
    v_pk_fma_f32 v[146:147], v[146:147], v[162:163], v[166:167]
    v_cvt_pk_bf16_f32 v148, v144, v145
    v_cvt_pk_bf16_f32 v149, v146, v147
    buffer_store_dwordx2 v[148:149], v175, s[92:95], s16 offen
main_kernel_o_nx:
    s_add_u32 s16, s16, 65536
    s_cmp_lg_u32 s39, 0
    s_cbranch_scc1 main_kernel_o_x
    s_cmp_le_u32 s18, 62
    s_cbranch_scc0 main_kernel_o_sk
    s_cbranch_vccz main_kernel_o_go
    s_branch main_kernel_o_top
main_kernel_o_sk:
    v_add_u32 v172, v172, v173
    s_add_u32 s17, s17, 65536
    s_add_u32 s16, s16, 65536
    s_add_u32 s15, s15, 262144
    s_add_u32 s18, s18, 1
    s_cmp_lt_u32 s18, 64
    s_cbranch_scc1 main_kernel_o_top
    s_branch main_kernel_end
main_kernel_end2:
    s_endpgm
main_kernel_worker:
    v_lshlrev_b32 v251, 4, v250
    v_mov_b32 v240, 0xc0135761
    v_mov_b32 v241, 0xc0135761
    v_mov_b32 v242, 0xbdd2d3e8
    v_mov_b32 v243, 0xbdd2d3e8
    v_mov_b32 v244, 0x3f800000
    v_mov_b32 v245, 0x3f800000
    v_mov_b32 v246, 0xbfb8aa3b
    v_mov_b32 v247, 0xbfb8aa3b
    s_lshr_b32 s37, s14, 1
    s_and_b32 s38, s14, 1
    v_mov_b32 v252, 0
    s_mov_b32 s8, s40
    s_and_b32 s9, s41, 0xffff
    s_mov_b32 s10, 0x0
    s_mov_b32 s11, 0x20000
    s_mov_b32 s57, 0
    s_mov_b32 s56, 0x7f000000
    v_mov_b32 v249, 0
main_kernel_w_next:
    s_cmp_lg_u32 s14, 0
    s_cbranch_scc1 main_kernel_w_bar
main_kernel_w_try:
    s_lshl_b32 s32, s27, 8
    s_add_u32 s32, s32, 0x841e000
    v_mov_b32 v254, 1
    s_mov_b64 exec, 1
    buffer_atomic_add v254, off, s[4:7], s32 sc0 sc1
    s_mov_b64 exec, -1
    s_waitcnt vmcnt(0)
    v_readfirstlane_b32 s28, v254
    s_cmp_eq_u32 s57, 0
    s_cbranch_scc1 main_kernel_w_fl1
    s_waitcnt vmcnt(0)
    s_barrier
    v_mov_b32 v4, 1
    v_mov_b32 v5, 1
    v_mov_b32 v6, 1
    v_mov_b32 v7, 1
    s_bfm_b64 exec, s57, 0
    buffer_store_dwordx4 v[4:7], v249, s[4:7], s56 offen sc1
    s_mov_b64 exec, -1
    s_mov_b32 s57, 0
main_kernel_w_fl1:
    s_nop 3
main_kernel_w_have:
    s_cmp_lg_u32 s27, 0
    s_cbranch_scc1 main_kernel_w_q1
    s_cmp_lt_u32 s28, 120
    s_cbranch_scc0 main_kernel_w_d_1
    s_cmp_lt_u32 s28, 48
    s_cbranch_scc0 main_kernel_w_d_2
    s_cmp_lt_u32 s28, 24
    s_cbranch_scc0 main_kernel_w_d_3
    s_cmp_lt_u32 s28, 8
    s_cbranch_scc0 main_kernel_w_d_4
    s_mov_b32 s36, 0x4005800
    s_branch main_kernel_w_dec
main_kernel_w_d_4:
    s_mov_b32 s36, 0x8085008
    s_branch main_kernel_w_dec
main_kernel_w_d_3:
    s_cmp_lt_u32 s28, 32
    s_cbranch_scc0 main_kernel_w_d_5
    s_mov_b32 s36, 0x64090818
    s_branch main_kernel_w_dec
main_kernel_w_d_5:
    s_mov_b32 s36, 0x48109820
    s_branch main_kernel_w_dec
main_kernel_w_d_2:
    s_cmp_lt_u32 s28, 72
    s_cbranch_scc0 main_kernel_w_d_6
    s_cmp_lt_u32 s28, 64
    s_cbranch_scc0 main_kernel_w_d_7
    s_mov_b32 s36, 0x8105030
    s_branch main_kernel_w_dec
main_kernel_w_d_7:
    s_mov_b32 s36, 0x65191040
    s_branch main_kernel_w_dec
main_kernel_w_d_6:
    s_cmp_lt_u32 s28, 88
    s_cbranch_scc0 main_kernel_w_d_8
    s_mov_b32 s36, 0x44008048
    s_branch main_kernel_w_dec
main_kernel_w_d_8:
    s_cmp_lt_u32 s28, 104
    s_cbranch_scc0 main_kernel_w_d_9
    s_mov_b32 s36, 0x41c2058
    s_branch main_kernel_w_dec
main_kernel_w_d_9:
    s_mov_b32 s36, 0x46048068
    s_branch main_kernel_w_dec
main_kernel_w_d_1:
    s_cmp_lt_u32 s28, 184
    s_cbranch_scc0 main_kernel_w_d_10
    s_cmp_lt_u32 s28, 152
    s_cbranch_scc0 main_kernel_w_d_11
    s_cmp_lt_u32 s28, 136
    s_cbranch_scc0 main_kernel_w_d_12
    s_mov_b32 s36, 0x4082078
    s_branch main_kernel_w_dec
main_kernel_w_d_12:
    s_mov_b32 s36, 0x8002888
    s_branch main_kernel_w_dec
main_kernel_w_d_11:
    s_cmp_lt_u32 s28, 160
    s_cbranch_scc0 main_kernel_w_d_13
    s_mov_b32 s36, 0x64013098
    s_branch main_kernel_w_dec
main_kernel_w_d_13:
    s_cmp_lt_u32 s28, 176
    s_cbranch_scc0 main_kernel_w_d_14
    s_mov_b32 s36, 0x4b1080a0
    s_branch main_kernel_w_dec
main_kernel_w_d_14:
    s_mov_b32 s36, 0x641130b0
    s_branch main_kernel_w_dec
main_kernel_w_d_10:
    s_cmp_lt_u32 s28, 208
    s_cbranch_scc0 main_kernel_w_d_15
    s_cmp_lt_u32 s28, 200
    s_cbranch_scc0 main_kernel_w_d_16
    s_mov_b32 s36, 0x4918b0b8
    s_branch main_kernel_w_dec
main_kernel_w_d_16:
    s_mov_b32 s36, 0x661908c8
    s_branch main_kernel_w_dec
main_kernel_w_d_15:
    s_cmp_lt_u32 s28, 224
    s_cbranch_scc0 main_kernel_w_d_17
    s_mov_b32 s36, 0x89038d0
    s_branch main_kernel_w_dec
main_kernel_w_d_17:
    s_cmp_lt_u32 s28, 232
    s_cbranch_scc0 main_kernel_w_d_18
    s_mov_b32 s36, 0x641900e0
    s_branch main_kernel_w_dec
main_kernel_w_d_18:
    s_mov_b32 s36, 0xffffffff
    s_branch main_kernel_w_dec
main_kernel_w_q1:
    s_cmp_lg_u32 s27, 1
    s_cbranch_scc1 main_kernel_w_q2
    s_cmp_lt_u32 s28, 52
    s_cbranch_scc0 main_kernel_w_d_19
    s_cmp_lt_u32 s28, 12
    s_cbranch_scc0 main_kernel_w_d_20
    s_cmp_lt_u32 s28, 4
    s_cbranch_scc0 main_kernel_w_d_21
    s_mov_b32 s36, 0x25000
    s_branch main_kernel_w_dec
main_kernel_w_d_21:
    s_mov_b32 s36, 0x42069004
    s_branch main_kernel_w_dec
main_kernel_w_d_20:
    s_cmp_lt_u32 s28, 20
    s_cbranch_scc0 main_kernel_w_d_22
    s_mov_b32 s36, 0x6709100c
    s_branch main_kernel_w_dec
main_kernel_w_d_22:
    s_cmp_lt_u32 s28, 36
    s_cbranch_scc0 main_kernel_w_d_23
    s_mov_b32 s36, 0x46008014
    s_branch main_kernel_w_dec
main_kernel_w_d_23:
    s_mov_b32 s36, 0x4042024
    s_branch main_kernel_w_dec
main_kernel_w_d_19:
    s_cmp_lt_u32 s28, 96
    s_cbranch_scc0 main_kernel_w_d_24
    s_cmp_lt_u32 s28, 68
    s_cbranch_scc0 main_kernel_w_d_25
    s_mov_b32 s36, 0x49088034
    s_branch main_kernel_w_dec
main_kernel_w_d_25:
    s_cmp_lt_u32 s28, 80
    s_cbranch_scc0 main_kernel_w_d_26
    s_mov_b32 s36, 0x4a10b044
    s_branch main_kernel_w_dec
main_kernel_w_d_26:
    s_mov_b32 s36, 0x4a108050
    s_branch main_kernel_w_dec
main_kernel_w_d_24:
    s_cmp_lt_u32 s28, 112
    s_cbranch_scc0 main_kernel_w_d_27
    s_mov_b32 s36, 0x8083860
    s_branch main_kernel_w_dec
main_kernel_w_d_27:
    s_cmp_lt_u32 s28, 120
    s_cbranch_scc0 main_kernel_w_d_28
    s_mov_b32 s36, 0x124070
    s_branch main_kernel_w_dec
main_kernel_w_d_28:
    s_mov_b32 s36, 0xffffffff
    s_branch main_kernel_w_dec
main_kernel_w_q2:
    s_cmp_lg_u32 s27, 2
    s_cbranch_scc1 main_kernel_w_q3
    s_cmp_lt_u32 s28, 112
    s_cbranch_scc0 main_kernel_w_d_29
    s_cmp_lt_u32 s28, 32
    s_cbranch_scc0 main_kernel_w_d_30
    s_cmp_lt_u32 s28, 16
    s_cbranch_scc0 main_kernel_w_d_31
    s_cmp_lt_u32 s28, 8
    s_cbranch_scc0 main_kernel_w_d_32
    s_mov_b32 s36, 0x800
    s_branch main_kernel_w_dec
main_kernel_w_d_32:
    s_mov_b32 s36, 0x1008
    s_branch main_kernel_w_dec
main_kernel_w_d_31:
    s_cmp_lt_u32 s28, 24
    s_cbranch_scc0 main_kernel_w_d_33
    s_mov_b32 s36, 0x44028810
    s_branch main_kernel_w_dec
main_kernel_w_d_33:
    s_mov_b32 s36, 0x44029018
    s_branch main_kernel_w_dec
main_kernel_w_d_30:
    s_cmp_lt_u32 s28, 64
    s_cbranch_scc0 main_kernel_w_d_34
    s_cmp_lt_u32 s28, 48
    s_cbranch_scc0 main_kernel_w_d_35
    s_mov_b32 s36, 0x48189820
    s_branch main_kernel_w_dec
main_kernel_w_d_35:
    s_mov_b32 s36, 0x48009830
    s_branch main_kernel_w_dec
main_kernel_w_d_34:
    s_cmp_lt_u32 s28, 80
    s_cbranch_scc0 main_kernel_w_d_36
    s_mov_b32 s36, 0x4102040
    s_branch main_kernel_w_dec
main_kernel_w_d_36:
    s_cmp_lt_u32 s28, 96
    s_cbranch_scc0 main_kernel_w_d_37
    s_mov_b32 s36, 0x4a109050
    s_branch main_kernel_w_dec
main_kernel_w_d_37:
    s_mov_b32 s36, 0x40c2060
    s_branch main_kernel_w_dec
main_kernel_w_d_29:
    s_cmp_lt_u32 s28, 162
    s_cbranch_scc0 main_kernel_w_d_38
    s_cmp_lt_u32 s28, 136
    s_cbranch_scc0 main_kernel_w_d_39
    s_cmp_lt_u32 s28, 120
    s_cbranch_scc0 main_kernel_w_d_40
    s_mov_b32 s36, 0x67111070
    s_branch main_kernel_w_dec
main_kernel_w_d_40:
    s_mov_b32 s36, 0x49108078
    s_branch main_kernel_w_dec
main_kernel_w_d_39:
    s_cmp_lt_u32 s28, 144
    s_cbranch_scc0 main_kernel_w_d_41
    s_mov_b32 s36, 0x64111088
    s_branch main_kernel_w_dec
main_kernel_w_d_41:
    s_cmp_lt_u32 s28, 150
    s_cbranch_scc0 main_kernel_w_d_42
    s_mov_b32 s36, 0x66c13090
    s_branch main_kernel_w_dec
main_kernel_w_d_42:
    s_mov_b32 s36, 0x4ad0b096
    s_branch main_kernel_w_dec
main_kernel_w_d_38:
    s_cmp_lt_u32 s28, 190
    s_cbranch_scc0 main_kernel_w_d_43
    s_cmp_lt_u32 s28, 174
    s_cbranch_scc0 main_kernel_w_d_44
    s_mov_b32 s36, 0x4ad8b0a2
    s_branch main_kernel_w_dec
main_kernel_w_d_44:
    s_mov_b32 s36, 0x81038ae
    s_branch main_kernel_w_dec
main_kernel_w_d_43:
    s_cmp_lt_u32 s28, 198
    s_cbranch_scc0 main_kernel_w_d_45
    s_mov_b32 s36, 0x671900be
    s_branch main_kernel_w_dec
main_kernel_w_d_45:
    s_cmp_lt_u32 s28, 206
    s_cbranch_scc0 main_kernel_w_d_46
    s_mov_b32 s36, 0x661900c6
    s_branch main_kernel_w_dec
main_kernel_w_d_46:
    s_mov_b32 s36, 0xffffffff
    s_branch main_kernel_w_dec
main_kernel_w_q3:
    s_cmp_lg_u32 s27, 3
    s_cbranch_scc1 main_kernel_w_q4
    s_cmp_lt_u32 s28, 112
    s_cbranch_scc0 main_kernel_w_d_47
    s_cmp_lt_u32 s28, 48
    s_cbranch_scc0 main_kernel_w_d_48
    s_cmp_lt_u32 s28, 16
    s_cbranch_scc0 main_kernel_w_d_49
    s_cmp_lt_u32 s28, 8
    s_cbranch_scc0 main_kernel_w_d_50
    s_mov_b32 s36, 0x1000800
    s_branch main_kernel_w_dec
main_kernel_w_d_50:
    s_mov_b32 s36, 0x1001008
    s_branch main_kernel_w_dec
main_kernel_w_d_49:
    s_cmp_lt_u32 s28, 24
    s_cbranch_scc0 main_kernel_w_d_51
    s_mov_b32 s36, 0x45028810
    s_branch main_kernel_w_dec
main_kernel_w_d_51:
    s_cmp_lt_u32 s28, 32
    s_cbranch_scc0 main_kernel_w_d_52
    s_mov_b32 s36, 0x45029018
    s_branch main_kernel_w_dec
main_kernel_w_d_52:
    s_mov_b32 s36, 0x48089820
    s_branch main_kernel_w_dec
main_kernel_w_d_48:
    s_cmp_lt_u32 s28, 80
    s_cbranch_scc0 main_kernel_w_d_53
    s_cmp_lt_u32 s28, 56
    s_cbranch_scc0 main_kernel_w_d_54
    s_mov_b32 s36, 0x66090830
    s_branch main_kernel_w_dec
main_kernel_w_d_54:
    s_cmp_lt_u32 s28, 64
    s_cbranch_scc0 main_kernel_w_d_55
    s_mov_b32 s36, 0x40068838
    s_branch main_kernel_w_dec
main_kernel_w_d_55:
    s_mov_b32 s36, 0x4142040
    s_branch main_kernel_w_dec
main_kernel_w_d_53:
    s_cmp_lt_u32 s28, 88
    s_cbranch_scc0 main_kernel_w_d_56
    s_mov_b32 s36, 0x67110850
    s_branch main_kernel_w_dec
main_kernel_w_d_56:
    s_cmp_lt_u32 s28, 96
    s_cbranch_scc0 main_kernel_w_d_57
    s_mov_b32 s36, 0x64110858
    s_branch main_kernel_w_dec
main_kernel_w_d_57:
    s_mov_b32 s36, 0x44048060
    s_branch main_kernel_w_dec
main_kernel_w_d_47:
    s_cmp_lt_u32 s28, 168
    s_cbranch_scc0 main_kernel_w_d_58
    s_cmp_lt_u32 s28, 142
    s_cbranch_scc0 main_kernel_w_d_59
    s_cmp_lt_u32 s28, 120
    s_cbranch_scc0 main_kernel_w_d_60
    s_mov_b32 s36, 0x67191070
    s_branch main_kernel_w_dec
main_kernel_w_d_60:
    s_cmp_lt_u32 s28, 136
    s_cbranch_scc0 main_kernel_w_d_61
    s_mov_b32 s36, 0x8082878
    s_branch main_kernel_w_dec
main_kernel_w_d_61:
    s_mov_b32 s36, 0x66013088
    s_branch main_kernel_w_dec
main_kernel_w_d_59:
    s_cmp_lt_u32 s28, 148
    s_cbranch_scc0 main_kernel_w_d_62
    s_mov_b32 s36, 0x6609308e
    s_branch main_kernel_w_dec
main_kernel_w_d_62:
    s_cmp_lt_u32 s28, 156
    s_cbranch_scc0 main_kernel_w_d_63
    s_mov_b32 s36, 0x65093094
    s_branch main_kernel_w_dec
main_kernel_w_d_63:
    s_mov_b32 s36, 0x4ac8b09c
    s_branch main_kernel_w_dec
main_kernel_w_d_58:
    s_cmp_lt_u32 s28, 208
    s_cbranch_scc0 main_kernel_w_d_64
    s_cmp_lt_u32 s28, 184
    s_cbranch_scc0 main_kernel_w_d_65
    s_mov_b32 s36, 0x89838a8
    s_branch main_kernel_w_dec
main_kernel_w_d_65:
    s_cmp_lt_u32 s28, 200
    s_cbranch_scc0 main_kernel_w_d_66
    s_mov_b32 s36, 0x88038b8
    s_branch main_kernel_w_dec
main_kernel_w_d_66:
    s_mov_b32 s36, 0x240c8
    s_branch main_kernel_w_dec
main_kernel_w_d_64:
    s_cmp_lt_u32 s28, 216
    s_cbranch_scc0 main_kernel_w_d_67
    s_mov_b32 s36, 0x840d0
    s_branch main_kernel_w_dec
main_kernel_w_d_67:
    s_cmp_lt_u32 s28, 224
    s_cbranch_scc0 main_kernel_w_d_68
    s_mov_b32 s36, 0x440d8
    s_branch main_kernel_w_dec
main_kernel_w_d_68:
    s_mov_b32 s36, 0xffffffff
    s_branch main_kernel_w_dec
main_kernel_w_q4:
    s_cmp_lg_u32 s27, 4
    s_cbranch_scc1 main_kernel_w_q5
    s_cmp_lt_u32 s28, 112
    s_cbranch_scc0 main_kernel_w_d_69
    s_cmp_lt_u32 s28, 48
    s_cbranch_scc0 main_kernel_w_d_70
    s_cmp_lt_u32 s28, 24
    s_cbranch_scc0 main_kernel_w_d_71
    s_cmp_lt_u32 s28, 8
    s_cbranch_scc0 main_kernel_w_d_72
    s_mov_b32 s36, 0x2000800
    s_branch main_kernel_w_dec
main_kernel_w_d_72:
    s_cmp_lt_u32 s28, 16
    s_cbranch_scc0 main_kernel_w_d_73
    s_mov_b32 s36, 0x2001008
    s_branch main_kernel_w_dec
main_kernel_w_d_73:
    s_mov_b32 s36, 0x46028810
    s_branch main_kernel_w_dec
main_kernel_w_d_71:
    s_cmp_lt_u32 s28, 32
    s_cbranch_scc0 main_kernel_w_d_74
    s_mov_b32 s36, 0x46029018
    s_branch main_kernel_w_dec
main_kernel_w_d_74:
    s_cmp_lt_u32 s28, 40
    s_cbranch_scc0 main_kernel_w_d_75
    s_mov_b32 s36, 0x64091020
    s_branch main_kernel_w_dec
main_kernel_w_d_75:
    s_mov_b32 s36, 0x66091028
    s_branch main_kernel_w_dec
main_kernel_w_d_70:
    s_cmp_lt_u32 s28, 72
    s_cbranch_scc0 main_kernel_w_d_76
    s_cmp_lt_u32 s28, 56
    s_cbranch_scc0 main_kernel_w_d_77
    s_mov_b32 s36, 0x67090830
    s_branch main_kernel_w_dec
main_kernel_w_d_77:
    s_cmp_lt_u32 s28, 64
    s_cbranch_scc0 main_kernel_w_d_78
    s_mov_b32 s36, 0x65090838
    s_branch main_kernel_w_dec
main_kernel_w_d_78:
    s_mov_b32 s36, 0x67090040
    s_branch main_kernel_w_dec
main_kernel_w_d_76:
    s_cmp_lt_u32 s28, 80
    s_cbranch_scc0 main_kernel_w_d_79
    s_mov_b32 s36, 0x65111048
    s_branch main_kernel_w_dec
main_kernel_w_d_79:
    s_cmp_lt_u32 s28, 96
    s_cbranch_scc0 main_kernel_w_d_80
    s_mov_b32 s36, 0x48108050
    s_branch main_kernel_w_dec
main_kernel_w_d_80:
    s_mov_b32 s36, 0x8182860
    s_branch main_kernel_w_dec
main_kernel_w_d_69:
    s_cmp_lt_u32 s28, 172
    s_cbranch_scc0 main_kernel_w_d_81
    s_cmp_lt_u32 s28, 144
    s_cbranch_scc0 main_kernel_w_d_82
    s_cmp_lt_u32 s28, 120
    s_cbranch_scc0 main_kernel_w_d_83
    s_mov_b32 s36, 0x65013070
    s_branch main_kernel_w_dec
main_kernel_w_d_83:
    s_cmp_lt_u32 s28, 136
    s_cbranch_scc0 main_kernel_w_d_84
    s_mov_b32 s36, 0x48188878
    s_branch main_kernel_w_dec
main_kernel_w_d_84:
    s_mov_b32 s36, 0x64193088
    s_branch main_kernel_w_dec
main_kernel_w_d_82:
    s_cmp_lt_u32 s28, 156
    s_cbranch_scc0 main_kernel_w_d_85
    s_mov_b32 s36, 0x4a18b090
    s_branch main_kernel_w_dec
main_kernel_w_d_85:
    s_cmp_lt_u32 s28, 164
    s_cbranch_scc0 main_kernel_w_d_86
    s_mov_b32 s36, 0x6419109c
    s_branch main_kernel_w_dec
main_kernel_w_d_86:
    s_mov_b32 s36, 0x651900a4
    s_branch main_kernel_w_dec
main_kernel_w_d_81:
    s_cmp_lt_u32 s28, 204
    s_cbranch_scc0 main_kernel_w_d_87
    s_cmp_lt_u32 s28, 188
    s_cbranch_scc0 main_kernel_w_d_88
    s_mov_b32 s36, 0x80038ac
    s_branch main_kernel_w_dec
main_kernel_w_d_88:
    s_cmp_lt_u32 s28, 196
    s_cbranch_scc0 main_kernel_w_d_89
    s_mov_b32 s36, 0x640bc
    s_branch main_kernel_w_dec
main_kernel_w_d_89:
    s_mov_b32 s36, 0xa40c4
    s_branch main_kernel_w_dec
main_kernel_w_d_87:
    s_cmp_lt_u32 s28, 212
    s_cbranch_scc0 main_kernel_w_d_90
    s_mov_b32 s36, 0xe40cc
    s_branch main_kernel_w_dec
main_kernel_w_d_90:
    s_cmp_lt_u32 s28, 220
    s_cbranch_scc0 main_kernel_w_d_91
    s_mov_b32 s36, 0x1040d4
    s_branch main_kernel_w_dec
main_kernel_w_d_91:
    s_mov_b32 s36, 0xffffffff
    s_branch main_kernel_w_dec
main_kernel_w_q5:
    s_cmp_lt_u32 s28, 128
    s_cbranch_scc0 main_kernel_w_d_92
    s_cmp_lt_u32 s28, 48
    s_cbranch_scc0 main_kernel_w_d_93
    s_cmp_lt_u32 s28, 24
    s_cbranch_scc0 main_kernel_w_d_94
    s_cmp_lt_u32 s28, 8
    s_cbranch_scc0 main_kernel_w_d_95
    s_mov_b32 s36, 0x3000800
    s_branch main_kernel_w_dec
main_kernel_w_d_95:
    s_cmp_lt_u32 s28, 16
    s_cbranch_scc0 main_kernel_w_d_96
    s_mov_b32 s36, 0x3001008
    s_branch main_kernel_w_dec
main_kernel_w_d_96:
    s_mov_b32 s36, 0x47028810
    s_branch main_kernel_w_dec
main_kernel_w_d_94:
    s_cmp_lt_u32 s28, 32
    s_cbranch_scc0 main_kernel_w_d_97
    s_mov_b32 s36, 0x47029018
    s_branch main_kernel_w_dec
main_kernel_w_d_97:
    s_cmp_lt_u32 s28, 40
    s_cbranch_scc0 main_kernel_w_d_98
    s_mov_b32 s36, 0x65091020
    s_branch main_kernel_w_dec
main_kernel_w_d_98:
    s_mov_b32 s36, 0x4045028
    s_branch main_kernel_w_dec
main_kernel_w_d_93:
    s_cmp_lt_u32 s28, 72
    s_cbranch_scc0 main_kernel_w_d_99
    s_cmp_lt_u32 s28, 56
    s_cbranch_scc0 main_kernel_w_d_100
    s_mov_b32 s36, 0x42068830
    s_branch main_kernel_w_dec
main_kernel_w_d_100:
    s_cmp_lt_u32 s28, 64
    s_cbranch_scc0 main_kernel_w_d_101
    s_mov_b32 s36, 0x66110838
    s_branch main_kernel_w_dec
main_kernel_w_d_101:
    s_mov_b32 s36, 0x40069040
    s_branch main_kernel_w_dec
main_kernel_w_d_99:
    s_cmp_lt_u32 s28, 96
    s_cbranch_scc0 main_kernel_w_d_102
    s_cmp_lt_u32 s28, 80
    s_cbranch_scc0 main_kernel_w_d_103
    s_mov_b32 s36, 0x64090048
    s_branch main_kernel_w_dec
main_kernel_w_d_103:
    s_mov_b32 s36, 0x4182050
    s_branch main_kernel_w_dec
main_kernel_w_d_102:
    s_cmp_lt_u32 s28, 112
    s_cbranch_scc0 main_kernel_w_d_104
    s_mov_b32 s36, 0x8102860
    s_branch main_kernel_w_dec
main_kernel_w_d_104:
    s_mov_b32 s36, 0x4002070
    s_branch main_kernel_w_dec
main_kernel_w_d_92:
    s_cmp_lt_u32 s28, 200
    s_cbranch_scc0 main_kernel_w_d_105
    s_cmp_lt_u32 s28, 160
    s_cbranch_scc0 main_kernel_w_d_106
    s_cmp_lt_u32 s28, 144
    s_cbranch_scc0 main_kernel_w_d_107
    s_mov_b32 s36, 0x8185080
    s_branch main_kernel_w_dec
main_kernel_w_d_107:
    s_cmp_lt_u32 s28, 152
    s_cbranch_scc0 main_kernel_w_d_108
    s_mov_b32 s36, 0x65113090
    s_branch main_kernel_w_dec
main_kernel_w_d_108:
    s_mov_b32 s36, 0x65110898
    s_branch main_kernel_w_dec
main_kernel_w_d_106:
    s_cmp_lt_u32 s28, 176
    s_cbranch_scc0 main_kernel_w_d_109
    s_mov_b32 s36, 0x4a0880a0
    s_branch main_kernel_w_dec
main_kernel_w_d_109:
    s_cmp_lt_u32 s28, 184
    s_cbranch_scc0 main_kernel_w_d_110
    s_mov_b32 s36, 0x651908b0
    s_branch main_kernel_w_dec
main_kernel_w_d_110:
    s_mov_b32 s36, 0x4808b0b8
    s_branch main_kernel_w_dec
main_kernel_w_d_105:
    s_cmp_lt_u32 s28, 232
    s_cbranch_scc0 main_kernel_w_d_111
    s_cmp_lt_u32 s28, 208
    s_cbranch_scc0 main_kernel_w_d_112
    s_mov_b32 s36, 0x671908c8
    s_branch main_kernel_w_dec
main_kernel_w_d_112:
    s_cmp_lt_u32 s28, 216
    s_cbranch_scc0 main_kernel_w_d_113
    s_mov_b32 s36, 0x661910d0
    s_branch main_kernel_w_dec
main_kernel_w_d_113:
    s_mov_b32 s36, 0x81838d8
    s_branch main_kernel_w_dec
main_kernel_w_d_111:
    s_cmp_lt_u32 s28, 256
    s_cbranch_scc0 main_kernel_w_d_114
    s_cmp_lt_u32 s28, 248
    s_cbranch_scc0 main_kernel_w_d_115
    s_mov_b32 s36, 0x88838e8
    s_branch main_kernel_w_dec
main_kernel_w_d_115:
    s_mov_b32 s36, 0x40f8
    s_branch main_kernel_w_dec
main_kernel_w_d_114:
    s_cmp_lt_u32 s28, 264
    s_cbranch_scc0 main_kernel_w_d_116
    s_mov_b32 s36, 0xc4100
    s_branch main_kernel_w_dec
main_kernel_w_d_116:
    s_mov_b32 s36, 0xffffffff
    s_branch main_kernel_w_dec
main_kernel_w_dec:
    s_cmp_lg_u32 s36, -1
    s_cbranch_scc1 main_kernel_w_got
    s_add_u32 s27, s27, 1
    s_cmp_ge_u32 s27, 6
    s_cselect_b32 s27, 0, s27
    s_add_u32 s52, s52, 1
    s_lshl_b32 s32, 1, s12
    s_and_b32 s32, s32, 116
    s_cselect_b32 s36, -2, -1
    s_cbranch_scc1 main_kernel_w_pub
    s_lshl_b32 s32, s12, 5
    s_add_u32 s32, s32, s13
    s_sub_u32 s32, s32, 224
    s_cmp_lt_u32 s32, 16
    s_cselect_b32 s52, 6, s52
    s_cmp_lt_u32 s52, 6
    s_cbranch_scc1 main_kernel_w_try
    s_lshl_b32 s32, s12, 5
    s_add_u32 s32, s32, s13
    s_sub_u32 s32, s32, 160
    s_cmp_lt_u32 s32, 80
    s_cselect_b32 s36, -3, -1
    s_cmp_lt_u32 s32, 64
    s_cselect_b32 s36, -2, s36
    s_branch main_kernel_w_pub
main_kernel_w_got:
    s_and_b32 s32, s36, 0x7ff
    s_sub_u32 s28, s28, s32
    s_bfe_u32 s32, s36, 0x3001a
    s_lshr_b32 s25, s28, s32
    s_lshl_b32 s33, s25, s32
    s_sub_u32 s24, s28, s33
    s_bfe_u32 s34, s36, 0x1001d
    s_lshl_b32 s24, s24, s34
    s_bfe_u32 s35, s36, 0x1001e
    s_lshl_b32 s25, s25, s35
    s_bfe_u32 s32, s36, 0x40011
    s_add_u32 s24, s24, s32
    s_bfe_u32 s32, s36, 0x50015
    s_add_u32 s25, s25, s32
    s_bfe_u32 s23, s36, 0x4000b
    s_bfe_u32 s36, s36, 0x6000b
    s_lshl_b32 s32, s24, 8
    s_or_b32 s36, s36, s32
    s_lshl_b32 s32, s25, 16
    s_or_b32 s36, s36, s32
    s_cmp_eq_u32 s23, 8
    s_cbranch_scc1 main_kernel_w_dwo
    s_cmp_ge_u32 s23, 10
    s_cbranch_scc1 main_kernel_w_pub
    s_mov_b32 s48, s24
    s_add_u32 s49, s24, s34
    s_mov_b32 s50, 4
    s_mov_b32 s51, 7
    s_cmp_lg_u32 s23, 4
    s_cbranch_scc1 main_kernel_w_dp1
    s_sub_u32 s48, s48, 1
    s_max_i32 s48, s48, 0
    s_add_u32 s49, s49, 1
    s_min_u32 s49, s49, 15
main_kernel_w_dp1:
    s_cmp_eq_u32 s23, 6
    s_cselect_b32 s51, 3, s51
    s_cmp_eq_u32 s23, 7
    s_cselect_b32 s51, 27, s51
    s_cselect_b32 s50, 5, s50
    v_lshrrev_b32 v253, s50, v250
    v_lshlrev_b32 v254, s50, v253
    v_sub_u32 v254, v250, v254
    v_min_u32 v254, s51, v254
    v_add_u32 v253, s48, v253
    v_min_u32 v253, s49, v253
    v_lshlrev_b32 v253, 9, v253
    v_lshl_add_u32 v253, v254, 4, v253
    s_cmp_lt_u32 s23, 4
    s_cselect_b32 s39, 10, s23
    s_lshl_b32 s39, s39, 13
    s_cmp_eq_u32 s23, 3
    s_cselect_b32 s32, 4, 0
    s_add_u32 s39, s39, s32
    s_add_u32 s39, s39, 0x8402000
main_kernel_w_poll:
    buffer_load_dword v254, v253, s[4:7], s39 offen sc1
    s_waitcnt vmcnt(0)
    v_cmp_eq_u32 vcc, 0, v254
    s_cmp_eq_u32 s57, 0
    s_cbranch_scc1 main_kernel_w_fl2
    s_waitcnt vmcnt(0)
    s_barrier
    v_mov_b32 v4, 1
    v_mov_b32 v5, 1
    v_mov_b32 v6, 1
    v_mov_b32 v7, 1
    s_bfm_b64 exec, s57, 0
    buffer_store_dwordx4 v[4:7], v249, s[4:7], s56 offen sc1
    s_mov_b64 exec, -1
    s_mov_b32 s57, 0
main_kernel_w_fl2:
    s_cbranch_vccz main_kernel_w_pub
    s_sleep 8
    s_sub_u32 s29, s29, 1
    s_cbranch_scc0 main_kernel_w_poll
    s_mov_b32 s36, -1
    s_branch main_kernel_w_pub
main_kernel_w_dwo:
    s_lshl_b32 s39, s24, 10
    s_add_u32 s39, s39, 0x8400000
main_kernel_w_pollo:
    buffer_load_dwordx4 v[0:3], v251, s[4:7], s39 offen sc1
    s_waitcnt vmcnt(0)
    v_min3_u32 v0, v0, v1, v2
    v_min_u32 v0, v0, v3
    v_cmp_eq_u32 vcc, 0, v0
    s_cmp_eq_u32 s57, 0
    s_cbranch_scc1 main_kernel_w_fl3
    s_waitcnt vmcnt(0)
    s_barrier
    v_mov_b32 v4, 1
    v_mov_b32 v5, 1
    v_mov_b32 v6, 1
    v_mov_b32 v7, 1
    s_bfm_b64 exec, s57, 0
    buffer_store_dwordx4 v[4:7], v249, s[4:7], s56 offen sc1
    s_mov_b64 exec, -1
    s_mov_b32 s57, 0
main_kernel_w_fl3:
    s_cbranch_vccz main_kernel_w_pub
    s_sleep 16
    s_sub_u32 s29, s29, 1
    s_cbranch_scc0 main_kernel_w_pollo
    s_mov_b32 s36, -1
    s_branch main_kernel_w_pub
main_kernel_w_oko:
    v_min_u32 v253, s35, v250
    v_add_u32 v253, s25, v253
    v_lshlrev_b32 v253, 8, v253
    s_lshl_b32 s39, s24, 4
    s_add_u32 s39, s39, 0x8412000
    s_branch main_kernel_w_poll
main_kernel_w_pub:
    s_cmp_eq_u32 s57, 0
    s_cbranch_scc1 main_kernel_w_fl4
    s_waitcnt vmcnt(0)
    s_barrier
    v_mov_b32 v4, 1
    v_mov_b32 v5, 1
    v_mov_b32 v6, 1
    v_mov_b32 v7, 1
    s_bfm_b64 exec, s57, 0
    buffer_store_dwordx4 v[4:7], v249, s[4:7], s56 offen sc1
    s_mov_b64 exec, -1
    s_mov_b32 s57, 0
main_kernel_w_fl4:
    v_mov_b32 v253, 131072
    v_mov_b32 v254, s36
    ds_write_b32 v253, v254
    s_waitcnt lgkmcnt(0)
main_kernel_w_bar:
    s_barrier
    v_mov_b32 v253, 131072
    ds_read_b32 v254, v253
    s_waitcnt lgkmcnt(0)
    v_readfirstlane_b32 s36, v254
    s_nop 3
    s_cmp_eq_u32 s36, -1
    s_cbranch_scc1 main_kernel_end2
    s_cmp_eq_u32 s36, -2
    s_cbranch_scc1 main_kernel_wo
    s_cmp_eq_u32 s36, -3
    s_cbranch_scc1 main_kernel_att2
    s_mov_b32 s55, -1
    s_and_b32 s23, s36, 15
    s_bfe_u32 s54, s36, 0x20004
    s_bfe_u32 s24, s36, 0x80008
    s_lshr_b32 s25, s36, 16
    s_cmp_eq_u32 s23, 5
    s_cbranch_scc1 main_kernel_w_ln2
    s_cmp_eq_u32 s23, 10
    s_cbranch_scc1 main_kernel_w_fill
    s_cmp_eq_u32 s23, 11
    s_cbranch_scc1 main_kernel_w_pref
    s_cmp_eq_u32 s54, 1
    s_cbranch_scc1 main_kernel_w_c1_task
    s_cmp_eq_u32 s54, 2
    s_cbranch_scc1 main_kernel_w_c2_task
main_kernel_w_c0_task:
    s_cmp_eq_u32 s23, 1
    s_cbranch_scc1 main_kernel_w_c0_set1
    s_cmp_eq_u32 s23, 2
    s_cbranch_scc1 main_kernel_w_c0_set2
    s_cmp_eq_u32 s23, 4
    s_cbranch_scc1 main_kernel_w_c0_set4
    s_cmp_eq_u32 s23, 7
    s_cbranch_scc1 main_kernel_w_c0_set7
    s_cmp_eq_u32 s23, 8
    s_cbranch_scc1 main_kernel_w_c0_set8
    s_branch main_kernel_w_done
main_kernel_w_c0_set1:
    s_lshl_b32 s32, s25, 8
    s_add_u32 s8, s42, s32
    s_addc_u32 s9, s43, 0
    s_and_b32 s9, s9, 0xffff
    s_sub_u32 s10, 0x800000, s32
    s_mov_b32 s11, 0x20000
    s_mov_b32 s30, 8192
    s_mov_b32 s31, 32768
    s_mul_i32 s16, s24, 262144
    s_add_u32 s16, s16, 0x0
    s_mov_b32 s18, 3
    s_lshl_b32 s32, s24, 3
    s_mul_i32 s33, s38, 4
    s_add_u32 s32, s32, s33
    s_mul_i32 s32, s32, 131072
    s_lshl_b32 s33, s25, 12
    s_add_u32 s32, s32, s33
    s_mul_i32 s33, s37, 2048
    s_add_u32 s32, s32, s33
    s_add_u32 s21, s32, 0x1800000
    s_mov_b32 s22, 131072
    s_mov_b32 s26, -1
    s_branch main_kernel_w_c0_go
main_kernel_w_c0_set2:
    s_lshl_b32 s32, s25, 8
    s_add_u32 s8, s44, s32
    s_addc_u32 s9, s45, 0
    s_and_b32 s9, s9, 0xffff
    s_sub_u32 s10, 0x800000, s32
    s_mov_b32 s11, 0x20000
    s_mov_b32 s30, 8192
    s_mov_b32 s31, 32768
    s_mul_i32 s16, s24, 262144
    s_add_u32 s16, s16, 0x0
    s_mov_b32 s18, 3
    s_lshl_b32 s32, s24, 2
    s_mul_i32 s33, s38, 2
    s_add_u32 s32, s32, s33
    s_lshl_b32 s32, s32, 18
    s_lshl_b32 s33, s25, 13
    s_add_u32 s32, s32, s33
    s_mul_i32 s33, s37, 4096
    s_add_u32 s32, s32, s33
    s_add_u32 s21, s32, 0x2800000
    s_branch main_kernel_w_c0_gov
main_kernel_w_c0_set4:
    s_lshl_b32 s32, s25, 8
    s_add_u32 s8, s66, s32
    s_addc_u32 s9, s67, 0
    s_and_b32 s9, s9, 0xffff
    s_sub_u32 s10, 0x200000, s32
    s_mov_b32 s11, 0x20000
    s_mov_b32 s30, 2048
    s_mov_b32 s31, 32768
    s_mul_i32 s16, s24, 262144
    s_add_u32 s16, s16, 0x4808000
    s_mov_b32 s18, 3
    s_lshl_b32 s32, s24, 3
    s_mul_i32 s33, s38, 4
    s_add_u32 s32, s32, s33
    s_mul_i32 s32, s32, 32768
    s_lshl_b32 s33, s25, 12
    s_add_u32 s32, s32, s33
    s_mul_i32 s33, s37, 2048
    s_add_u32 s32, s32, s33
    s_add_u32 s21, s32, 0x5000000
    s_mov_b32 s22, 32768
    s_add_u32 s26, s32, 0x0
    s_branch main_kernel_w_c0_go
main_kernel_w_c0_set7:
    s_lshl_b32 s32, s25, 8
    s_add_u32 s8, s70, s32
    s_addc_u32 s9, s71, 0
    s_and_b32 s9, s9, 0xffff
    s_sub_u32 s10, 0x700000, s32
    s_mov_b32 s11, 0x20000
    s_mov_b32 s30, 2048
    s_mov_b32 s31, 114688
    s_mul_i32 s16, s24, 917504
    s_add_u32 s16, s16, 0x5400000
    s_mov_b32 s18, 13
    s_lshl_b32 s32, s24, 3
    s_mul_i32 s33, s38, 4
    s_add_u32 s32, s32, s33
    s_mul_i32 s32, s32, 32768
    s_lshl_b32 s33, s25, 12
    s_add_u32 s32, s32, s33
    s_mul_i32 s33, s37, 2048
    s_add_u32 s32, s32, s33
    s_add_u32 s21, s32, 0x6400000
    s_mov_b32 s22, 32768
    s_add_u32 s26, s32, 0x5000000
    s_branch main_kernel_w_c0_go
main_kernel_w_c0_set8:
    s_lshl_b32 s32, s25, 8
    s_add_u32 s8, s46, s32
    s_addc_u32 s9, s47, 0
    s_and_b32 s9, s9, 0xffff
    s_sub_u32 s10, 0x800000, s32
    s_mov_b32 s11, 0x20000
    s_mov_b32 s30, 2048
    s_mov_b32 s31, 131072
    s_mul_i32 s16, s24, 1048576
    s_add_u32 s16, s16, 0x3800000
    s_mov_b32 s18, 15
    s_lshl_b32 s32, s24, 3
    s_mul_i32 s33, s38, 4
    s_add_u32 s32, s32, s33
    s_mul_i32 s32, s32, 32768
    s_lshl_b32 s33, s25, 8
    s_add_u32 s34, s32, s33
    s_mul_i32 s33, s37, 128
    s_add_u32 s34, s34, s33
    s_lshl_b32 s33, s25, 12
    s_add_u32 s32, s32, s33
    s_mul_i32 s33, s37, 2048
    s_add_u32 s32, s32, s33
    s_add_u32 s21, s32, 0x0
    s_mov_b32 s22, 32768
    s_add_u32 s26, s32, 0x6400000
    s_mov_b32 s21, s34
    v_and_b32 v253, 15, v250
    v_and_b32 v254, 48, v250
    v_lshl_add_u32 v252, v253, 11, v254
    s_branch main_kernel_w_c0_go
main_kernel_w_c0_go:
    v_lshrrev_b32 v0, 4, v250
    v_bfe_u32 v1, v250, 2, 2
    v_lshl_add_u32 v4, v0, 2, v1
    v_and_b32 v5, 7, v4
    v_mul_u32_u24 v4, 256, v4
    v_and_b32 v6, 3, v250
    v_lshl_add_u32 v4, v6, 3, v4
    s_mul_i32 s32, s37, 4
    v_xor_b32 v5, s32, v5
    v_lshl_add_u32 v128, v5, 5, v4
    v_xor_b32 v129, 32, v128
    v_xor_b32 v130, 64, v128
    v_xor_b32 v131, 96, v128
    s_mul_i32 s32, s38, 8192
    s_add_u32 s32, s32, 65536
    v_add_u32 v136, s32, v251
    v_lshrrev_b32 v2, 4, v250
    v_and_b32 v3, 15, v250
    s_mul_i32 s32, s14, 16
    v_add_u32 v4, s32, v2
    v_add_u32 v5, 0, v4
    v_and_b32 v6, 7, v5
    v_lshlrev_b32 v6, 1, v6
    v_xor_b32 v6, v6, v3
    v_mul_lo_u32 v5, v5, s30
    v_lshl_add_u32 v5, v6, 4, v5
    v_subrev_u32 v137, 0, v5
    v_add_u32 v5, 4, v4
    v_and_b32 v6, 7, v5
    v_lshlrev_b32 v6, 1, v6
    v_xor_b32 v6, v6, v3
    v_mul_lo_u32 v5, v5, s30
    v_lshl_add_u32 v5, v6, 4, v5
    v_subrev_u32 v138, 1024, v5
    v_add_u32 v5, 8, v4
    v_and_b32 v6, 7, v5
    v_lshlrev_b32 v6, 1, v6
    v_xor_b32 v6, v6, v3
    v_mul_lo_u32 v5, v5, s30
    v_lshl_add_u32 v5, v6, 4, v5
    v_subrev_u32 v139, 2048, v5
    v_add_u32 v5, 12, v4
    v_and_b32 v6, 7, v5
    v_lshlrev_b32 v6, 1, v6
    v_xor_b32 v6, v6, v3
    v_mul_lo_u32 v5, v5, s30
    v_lshl_add_u32 v5, v6, 4, v5
    v_subrev_u32 v140, 3072, v5
    s_mul_i32 s32, s14, 2
    s_mul_i32 s32, s32, s31
    v_add_u32 v141, s32, v251
    s_add_u32 s32, s32, s31
    s_sub_u32 s32, s32, 2048
    v_add_u32 v142, s32, v251
    s_mul_i32 s19, s14, 4096
    s_mul_i32 s20, s14, 4096
    s_add_u32 s20, s20, 65536
    s_mul_i32 s17, s30, 64
    s_mov_b32 s15, 0
    s_add_u32 m0, s20, 0
    s_nop 0
    buffer_load_dwordx4 v141, s[4:7], s16 offen offset:0 sc1 lds
    buffer_load_dwordx4 v141, s[4:7], s16 offen offset:1024 sc1 lds
    buffer_load_dwordx4 v142, s[4:7], s16 offen offset:2048 sc1 lds
    buffer_load_dwordx4 v142, s[4:7], s16 offen offset:3072 sc1 lds
    s_add_u32 s16, s16, 2048
    s_add_u32 m0, s19, 0
    s_nop 0
    buffer_load_dwordx4 v137, s[8:11], s15 offen offset:0 lds
    buffer_load_dwordx4 v138, s[8:11], s15 offen offset:1024 lds
    buffer_load_dwordx4 v139, s[8:11], s15 offen offset:2048 lds
    buffer_load_dwordx4 v140, s[8:11], s15 offen offset:3072 lds
    s_add_u32 s15, s15, s17
    s_add_u32 m0, s20, 16384
    s_nop 0
    buffer_load_dwordx4 v141, s[4:7], s16 offen offset:0 sc1 lds
    buffer_load_dwordx4 v141, s[4:7], s16 offen offset:1024 sc1 lds
    buffer_load_dwordx4 v142, s[4:7], s16 offen offset:2048 sc1 lds
    buffer_load_dwordx4 v142, s[4:7], s16 offen offset:3072 sc1 lds
    s_add_u32 s16, s16, 2048
    s_add_u32 m0, s19, 16384
    s_nop 0
    buffer_load_dwordx4 v137, s[8:11], s15 offen offset:0 lds
    buffer_load_dwordx4 v138, s[8:11], s15 offen offset:1024 lds
    buffer_load_dwordx4 v139, s[8:11], s15 offen offset:2048 lds
    buffer_load_dwordx4 v140, s[8:11], s15 offen offset:3072 lds
    s_add_u32 s15, s15, s17
    s_add_u32 m0, s20, 32768
    s_nop 0
    buffer_load_dwordx4 v141, s[4:7], s16 offen offset:0 sc1 lds
    buffer_load_dwordx4 v141, s[4:7], s16 offen offset:1024 sc1 lds
    buffer_load_dwordx4 v142, s[4:7], s16 offen offset:2048 sc1 lds
    buffer_load_dwordx4 v142, s[4:7], s16 offen offset:3072 sc1 lds
    s_add_u32 s16, s16, 2048
    s_add_u32 m0, s19, 32768
    s_nop 0
    buffer_load_dwordx4 v137, s[8:11], s15 offen offset:0 lds
    buffer_load_dwordx4 v138, s[8:11], s15 offen offset:1024 lds
    buffer_load_dwordx4 v139, s[8:11], s15 offen offset:2048 lds
    buffer_load_dwordx4 v140, s[8:11], s15 offen offset:3072 lds
    s_add_u32 s15, s15, s17
    s_add_u32 m0, s20, 49152
    s_nop 0
    buffer_load_dwordx4 v141, s[4:7], s16 offen offset:0 sc1 lds
    buffer_load_dwordx4 v141, s[4:7], s16 offen offset:1024 sc1 lds
    buffer_load_dwordx4 v142, s[4:7], s16 offen offset:2048 sc1 lds
    buffer_load_dwordx4 v142, s[4:7], s16 offen offset:3072 sc1 lds
    s_add_u32 s16, s16, 2048
    v_mov_b32 v64, 0
    v_mov_b32 v65, 0
    v_mov_b32 v66, 0
    v_mov_b32 v67, 0
    v_mov_b32 v68, 0
    v_mov_b32 v69, 0
    v_mov_b32 v70, 0
    v_mov_b32 v71, 0
    v_mov_b32 v72, 0
    v_mov_b32 v73, 0
    v_mov_b32 v74, 0
    v_mov_b32 v75, 0
    v_mov_b32 v76, 0
    v_mov_b32 v77, 0
    v_mov_b32 v78, 0
    v_mov_b32 v79, 0
    v_mov_b32 v80, 0
    v_mov_b32 v81, 0
    v_mov_b32 v82, 0
    v_mov_b32 v83, 0
    v_mov_b32 v84, 0
    v_mov_b32 v85, 0
    v_mov_b32 v86, 0
    v_mov_b32 v87, 0
    v_mov_b32 v88, 0
    v_mov_b32 v89, 0
    v_mov_b32 v90, 0
    v_mov_b32 v91, 0
    v_mov_b32 v92, 0
    v_mov_b32 v93, 0
    v_mov_b32 v94, 0
    v_mov_b32 v95, 0
    v_mov_b32 v96, 0
    v_mov_b32 v97, 0
    v_mov_b32 v98, 0
    v_mov_b32 v99, 0
    v_mov_b32 v100, 0
    v_mov_b32 v101, 0
    v_mov_b32 v102, 0
    v_mov_b32 v103, 0
    v_mov_b32 v104, 0
    v_mov_b32 v105, 0
    v_mov_b32 v106, 0
    v_mov_b32 v107, 0
    v_mov_b32 v108, 0
    v_mov_b32 v109, 0
    v_mov_b32 v110, 0
    v_mov_b32 v111, 0
    v_mov_b32 v112, 0
    v_mov_b32 v113, 0
    v_mov_b32 v114, 0
    v_mov_b32 v115, 0
    v_mov_b32 v116, 0
    v_mov_b32 v117, 0
    v_mov_b32 v118, 0
    v_mov_b32 v119, 0
    v_mov_b32 v120, 0
    v_mov_b32 v121, 0
    v_mov_b32 v122, 0
    v_mov_b32 v123, 0
    v_mov_b32 v124, 0
    v_mov_b32 v125, 0
    v_mov_b32 v126, 0
    v_mov_b32 v127, 0
    s_waitcnt vmcnt(20)
    s_barrier
    ds_read_b128 v[16:19], v136 offset:0
    ds_read_b64_tr_b16 v[0:1], v128 offset:0
    ds_read_b64_tr_b16 v[2:3], v128 offset:4096
    ds_read_b64_tr_b16 v[4:5], v129 offset:0
    ds_read_b64_tr_b16 v[6:7], v129 offset:4096
    ds_read_b64_tr_b16 v[8:9], v130 offset:0
    ds_read_b64_tr_b16 v[10:11], v130 offset:4096
    ds_read_b64_tr_b16 v[12:13], v131 offset:0
    ds_read_b64_tr_b16 v[14:15], v131 offset:4096
    ds_read_b128 v[20:23], v136 offset:2048
    ds_read_b128 v[24:27], v136 offset:4096
    ds_read_b128 v[28:31], v136 offset:6144
main_kernel_w_c0_n_loop:
    s_waitcnt lgkmcnt(0)
    ds_read_b128 v[48:51], v136 offset:1024
    s_add_u32 m0, s19, 49152
    s_nop 0
    v_mfma_f32_16x16x32_bf16 v[64:67], v[0:3], v[16:19], v[64:67]
    ds_read_b64_tr_b16 v[32:33], v128 offset:8192
    v_mfma_f32_16x16x32_bf16 v[68:71], v[4:7], v[16:19], v[68:71]
    ds_read_b64_tr_b16 v[34:35], v128 offset:12288
    buffer_load_dwordx4 v137, s[8:11], s15 offen offset:0 lds
    v_mfma_f32_16x16x32_bf16 v[72:75], v[8:11], v[16:19], v[72:75]
    ds_read_b64_tr_b16 v[36:37], v129 offset:8192
    v_mfma_f32_16x16x32_bf16 v[76:79], v[12:15], v[16:19], v[76:79]
    ds_read_b64_tr_b16 v[38:39], v129 offset:12288
    v_mfma_f32_16x16x32_bf16 v[80:83], v[0:3], v[20:23], v[80:83]
    ds_read_b64_tr_b16 v[40:41], v130 offset:8192
    buffer_load_dwordx4 v138, s[8:11], s15 offen offset:1024 lds
    v_mfma_f32_16x16x32_bf16 v[84:87], v[4:7], v[20:23], v[84:87]
    ds_read_b64_tr_b16 v[42:43], v130 offset:12288
    v_mfma_f32_16x16x32_bf16 v[88:91], v[8:11], v[20:23], v[88:91]
    ds_read_b64_tr_b16 v[44:45], v131 offset:8192
    v_mfma_f32_16x16x32_bf16 v[92:95], v[12:15], v[20:23], v[92:95]
    ds_read_b64_tr_b16 v[46:47], v131 offset:12288
    buffer_load_dwordx4 v139, s[8:11], s15 offen offset:2048 lds
    v_mfma_f32_16x16x32_bf16 v[96:99], v[0:3], v[24:27], v[96:99]
    ds_read_b128 v[52:55], v136 offset:3072
    v_mfma_f32_16x16x32_bf16 v[100:103], v[4:7], v[24:27], v[100:103]
    ds_read_b128 v[56:59], v136 offset:5120
    buffer_load_dwordx4 v140, s[8:11], s15 offen offset:3072 lds
    v_mfma_f32_16x16x32_bf16 v[104:107], v[8:11], v[24:27], v[104:107]
    ds_read_b128 v[60:63], v136 offset:7168
    v_mfma_f32_16x16x32_bf16 v[108:111], v[12:15], v[24:27], v[108:111]
    v_mfma_f32_16x16x32_bf16 v[112:115], v[0:3], v[28:31], v[112:115]
    s_add_u32 s15, s15, s17
    v_mfma_f32_16x16x32_bf16 v[116:119], v[4:7], v[28:31], v[116:119]
    v_mfma_f32_16x16x32_bf16 v[120:123], v[8:11], v[28:31], v[120:123]
    v_mfma_f32_16x16x32_bf16 v[124:127], v[12:15], v[28:31], v[124:127]
    s_waitcnt lgkmcnt(0)
    v_mfma_f32_16x16x32_bf16 v[64:67], v[32:35], v[48:51], v[64:67]
    s_waitcnt vmcnt(16)
    s_barrier
    ds_read_b128 v[16:19], v136 offset:16384
    s_add_u32 m0, s20, 0
    s_nop 0
    v_mfma_f32_16x16x32_bf16 v[68:71], v[36:39], v[48:51], v[68:71]
    ds_read_b64_tr_b16 v[0:1], v128 offset:16384
    v_mfma_f32_16x16x32_bf16 v[72:75], v[40:43], v[48:51], v[72:75]
    ds_read_b64_tr_b16 v[2:3], v128 offset:20480
    buffer_load_dwordx4 v141, s[4:7], s16 offen offset:0 sc1 lds
    v_mfma_f32_16x16x32_bf16 v[76:79], v[44:47], v[48:51], v[76:79]
    ds_read_b64_tr_b16 v[4:5], v129 offset:16384
    v_mfma_f32_16x16x32_bf16 v[80:83], v[32:35], v[52:55], v[80:83]
    ds_read_b64_tr_b16 v[6:7], v129 offset:20480
    v_mfma_f32_16x16x32_bf16 v[84:87], v[36:39], v[52:55], v[84:87]
    ds_read_b64_tr_b16 v[8:9], v130 offset:16384
    buffer_load_dwordx4 v141, s[4:7], s16 offen offset:1024 sc1 lds
    v_mfma_f32_16x16x32_bf16 v[88:91], v[40:43], v[52:55], v[88:91]
    ds_read_b64_tr_b16 v[10:11], v130 offset:20480
    v_mfma_f32_16x16x32_bf16 v[92:95], v[44:47], v[52:55], v[92:95]
    ds_read_b64_tr_b16 v[12:13], v131 offset:16384
    buffer_load_dwordx4 v142, s[4:7], s16 offen offset:2048 sc1 lds
    v_mfma_f32_16x16x32_bf16 v[96:99], v[32:35], v[56:59], v[96:99]
    ds_read_b64_tr_b16 v[14:15], v131 offset:20480
    v_mfma_f32_16x16x32_bf16 v[100:103], v[36:39], v[56:59], v[100:103]
    ds_read_b128 v[20:23], v136 offset:18432
    v_mfma_f32_16x16x32_bf16 v[104:107], v[40:43], v[56:59], v[104:107]
    ds_read_b128 v[24:27], v136 offset:20480
    buffer_load_dwordx4 v142, s[4:7], s16 offen offset:3072 sc1 lds
    v_mfma_f32_16x16x32_bf16 v[108:111], v[44:47], v[56:59], v[108:111]
    ds_read_b128 v[28:31], v136 offset:22528
    v_mfma_f32_16x16x32_bf16 v[112:115], v[32:35], v[60:63], v[112:115]
    s_add_u32 s16, s16, 2048
    v_mfma_f32_16x16x32_bf16 v[116:119], v[36:39], v[60:63], v[116:119]
    v_mfma_f32_16x16x32_bf16 v[120:123], v[40:43], v[60:63], v[120:123]
    v_mfma_f32_16x16x32_bf16 v[124:127], v[44:47], v[60:63], v[124:127]
    s_waitcnt lgkmcnt(0)
    ds_read_b128 v[48:51], v136 offset:17408
    s_add_u32 m0, s19, 0
    s_nop 0
    v_mfma_f32_16x16x32_bf16 v[64:67], v[0:3], v[16:19], v[64:67]
    ds_read_b64_tr_b16 v[32:33], v128 offset:24576
    v_mfma_f32_16x16x32_bf16 v[68:71], v[4:7], v[16:19], v[68:71]
    ds_read_b64_tr_b16 v[34:35], v128 offset:28672
    buffer_load_dwordx4 v137, s[8:11], s15 offen offset:0 lds
    v_mfma_f32_16x16x32_bf16 v[72:75], v[8:11], v[16:19], v[72:75]
    ds_read_b64_tr_b16 v[36:37], v129 offset:24576
    v_mfma_f32_16x16x32_bf16 v[76:79], v[12:15], v[16:19], v[76:79]
    ds_read_b64_tr_b16 v[38:39], v129 offset:28672
    v_mfma_f32_16x16x32_bf16 v[80:83], v[0:3], v[20:23], v[80:83]
    ds_read_b64_tr_b16 v[40:41], v130 offset:24576
    buffer_load_dwordx4 v138, s[8:11], s15 offen offset:1024 lds
    v_mfma_f32_16x16x32_bf16 v[84:87], v[4:7], v[20:23], v[84:87]
    ds_read_b64_tr_b16 v[42:43], v130 offset:28672
    v_mfma_f32_16x16x32_bf16 v[88:91], v[8:11], v[20:23], v[88:91]
    ds_read_b64_tr_b16 v[44:45], v131 offset:24576
    v_mfma_f32_16x16x32_bf16 v[92:95], v[12:15], v[20:23], v[92:95]
    ds_read_b64_tr_b16 v[46:47], v131 offset:28672
    buffer_load_dwordx4 v139, s[8:11], s15 offen offset:2048 lds
    v_mfma_f32_16x16x32_bf16 v[96:99], v[0:3], v[24:27], v[96:99]
    ds_read_b128 v[52:55], v136 offset:19456
    v_mfma_f32_16x16x32_bf16 v[100:103], v[4:7], v[24:27], v[100:103]
    ds_read_b128 v[56:59], v136 offset:21504
    buffer_load_dwordx4 v140, s[8:11], s15 offen offset:3072 lds
    v_mfma_f32_16x16x32_bf16 v[104:107], v[8:11], v[24:27], v[104:107]
    ds_read_b128 v[60:63], v136 offset:23552
    v_mfma_f32_16x16x32_bf16 v[108:111], v[12:15], v[24:27], v[108:111]
    v_mfma_f32_16x16x32_bf16 v[112:115], v[0:3], v[28:31], v[112:115]
    s_add_u32 s15, s15, s17
    v_mfma_f32_16x16x32_bf16 v[116:119], v[4:7], v[28:31], v[116:119]
    v_mfma_f32_16x16x32_bf16 v[120:123], v[8:11], v[28:31], v[120:123]
    v_mfma_f32_16x16x32_bf16 v[124:127], v[12:15], v[28:31], v[124:127]
    s_waitcnt lgkmcnt(0)
    v_mfma_f32_16x16x32_bf16 v[64:67], v[32:35], v[48:51], v[64:67]
    s_waitcnt vmcnt(16)
    s_barrier
    ds_read_b128 v[16:19], v136 offset:32768
    s_add_u32 m0, s20, 16384
    s_nop 0
    v_mfma_f32_16x16x32_bf16 v[68:71], v[36:39], v[48:51], v[68:71]
    ds_read_b64_tr_b16 v[0:1], v128 offset:32768
    v_mfma_f32_16x16x32_bf16 v[72:75], v[40:43], v[48:51], v[72:75]
    ds_read_b64_tr_b16 v[2:3], v128 offset:36864
    buffer_load_dwordx4 v141, s[4:7], s16 offen offset:0 sc1 lds
    v_mfma_f32_16x16x32_bf16 v[76:79], v[44:47], v[48:51], v[76:79]
    ds_read_b64_tr_b16 v[4:5], v129 offset:32768
    v_mfma_f32_16x16x32_bf16 v[80:83], v[32:35], v[52:55], v[80:83]
    ds_read_b64_tr_b16 v[6:7], v129 offset:36864
    v_mfma_f32_16x16x32_bf16 v[84:87], v[36:39], v[52:55], v[84:87]
    ds_read_b64_tr_b16 v[8:9], v130 offset:32768
    buffer_load_dwordx4 v141, s[4:7], s16 offen offset:1024 sc1 lds
    v_mfma_f32_16x16x32_bf16 v[88:91], v[40:43], v[52:55], v[88:91]
    ds_read_b64_tr_b16 v[10:11], v130 offset:36864
    v_mfma_f32_16x16x32_bf16 v[92:95], v[44:47], v[52:55], v[92:95]
    ds_read_b64_tr_b16 v[12:13], v131 offset:32768
    buffer_load_dwordx4 v142, s[4:7], s16 offen offset:2048 sc1 lds
    v_mfma_f32_16x16x32_bf16 v[96:99], v[32:35], v[56:59], v[96:99]
    ds_read_b64_tr_b16 v[14:15], v131 offset:36864
    v_mfma_f32_16x16x32_bf16 v[100:103], v[36:39], v[56:59], v[100:103]
    ds_read_b128 v[20:23], v136 offset:34816
    v_mfma_f32_16x16x32_bf16 v[104:107], v[40:43], v[56:59], v[104:107]
    ds_read_b128 v[24:27], v136 offset:36864
    buffer_load_dwordx4 v142, s[4:7], s16 offen offset:3072 sc1 lds
    v_mfma_f32_16x16x32_bf16 v[108:111], v[44:47], v[56:59], v[108:111]
    ds_read_b128 v[28:31], v136 offset:38912
    v_mfma_f32_16x16x32_bf16 v[112:115], v[32:35], v[60:63], v[112:115]
    s_add_u32 s16, s16, 2048
    v_mfma_f32_16x16x32_bf16 v[116:119], v[36:39], v[60:63], v[116:119]
    v_mfma_f32_16x16x32_bf16 v[120:123], v[40:43], v[60:63], v[120:123]
    v_mfma_f32_16x16x32_bf16 v[124:127], v[44:47], v[60:63], v[124:127]
    s_waitcnt lgkmcnt(0)
    ds_read_b128 v[48:51], v136 offset:33792
    s_add_u32 m0, s19, 16384
    s_nop 0
    v_mfma_f32_16x16x32_bf16 v[64:67], v[0:3], v[16:19], v[64:67]
    ds_read_b64_tr_b16 v[32:33], v128 offset:40960
    v_mfma_f32_16x16x32_bf16 v[68:71], v[4:7], v[16:19], v[68:71]
    ds_read_b64_tr_b16 v[34:35], v128 offset:45056
    buffer_load_dwordx4 v137, s[8:11], s15 offen offset:0 lds
    v_mfma_f32_16x16x32_bf16 v[72:75], v[8:11], v[16:19], v[72:75]
    ds_read_b64_tr_b16 v[36:37], v129 offset:40960
    v_mfma_f32_16x16x32_bf16 v[76:79], v[12:15], v[16:19], v[76:79]
    ds_read_b64_tr_b16 v[38:39], v129 offset:45056
    v_mfma_f32_16x16x32_bf16 v[80:83], v[0:3], v[20:23], v[80:83]
    ds_read_b64_tr_b16 v[40:41], v130 offset:40960
    buffer_load_dwordx4 v138, s[8:11], s15 offen offset:1024 lds
    v_mfma_f32_16x16x32_bf16 v[84:87], v[4:7], v[20:23], v[84:87]
    ds_read_b64_tr_b16 v[42:43], v130 offset:45056
    v_mfma_f32_16x16x32_bf16 v[88:91], v[8:11], v[20:23], v[88:91]
    ds_read_b64_tr_b16 v[44:45], v131 offset:40960
    v_mfma_f32_16x16x32_bf16 v[92:95], v[12:15], v[20:23], v[92:95]
    ds_read_b64_tr_b16 v[46:47], v131 offset:45056
    buffer_load_dwordx4 v139, s[8:11], s15 offen offset:2048 lds
    v_mfma_f32_16x16x32_bf16 v[96:99], v[0:3], v[24:27], v[96:99]
    ds_read_b128 v[52:55], v136 offset:35840
    v_mfma_f32_16x16x32_bf16 v[100:103], v[4:7], v[24:27], v[100:103]
    ds_read_b128 v[56:59], v136 offset:37888
    buffer_load_dwordx4 v140, s[8:11], s15 offen offset:3072 lds
    v_mfma_f32_16x16x32_bf16 v[104:107], v[8:11], v[24:27], v[104:107]
    ds_read_b128 v[60:63], v136 offset:39936
    v_mfma_f32_16x16x32_bf16 v[108:111], v[12:15], v[24:27], v[108:111]
    v_mfma_f32_16x16x32_bf16 v[112:115], v[0:3], v[28:31], v[112:115]
    s_add_u32 s15, s15, s17
    v_mfma_f32_16x16x32_bf16 v[116:119], v[4:7], v[28:31], v[116:119]
    v_mfma_f32_16x16x32_bf16 v[120:123], v[8:11], v[28:31], v[120:123]
    v_mfma_f32_16x16x32_bf16 v[124:127], v[12:15], v[28:31], v[124:127]
    s_waitcnt lgkmcnt(0)
    v_mfma_f32_16x16x32_bf16 v[64:67], v[32:35], v[48:51], v[64:67]
    s_waitcnt vmcnt(16)
    s_barrier
    ds_read_b128 v[16:19], v136 offset:49152
    s_add_u32 m0, s20, 32768
    s_nop 0
    v_mfma_f32_16x16x32_bf16 v[68:71], v[36:39], v[48:51], v[68:71]
    ds_read_b64_tr_b16 v[0:1], v128 offset:49152
    v_mfma_f32_16x16x32_bf16 v[72:75], v[40:43], v[48:51], v[72:75]
    ds_read_b64_tr_b16 v[2:3], v128 offset:53248
    buffer_load_dwordx4 v141, s[4:7], s16 offen offset:0 sc1 lds
    v_mfma_f32_16x16x32_bf16 v[76:79], v[44:47], v[48:51], v[76:79]
    ds_read_b64_tr_b16 v[4:5], v129 offset:49152
    v_mfma_f32_16x16x32_bf16 v[80:83], v[32:35], v[52:55], v[80:83]
    ds_read_b64_tr_b16 v[6:7], v129 offset:53248
    v_mfma_f32_16x16x32_bf16 v[84:87], v[36:39], v[52:55], v[84:87]
    ds_read_b64_tr_b16 v[8:9], v130 offset:49152
    buffer_load_dwordx4 v141, s[4:7], s16 offen offset:1024 sc1 lds
    v_mfma_f32_16x16x32_bf16 v[88:91], v[40:43], v[52:55], v[88:91]
    ds_read_b64_tr_b16 v[10:11], v130 offset:53248
    v_mfma_f32_16x16x32_bf16 v[92:95], v[44:47], v[52:55], v[92:95]
    ds_read_b64_tr_b16 v[12:13], v131 offset:49152
    buffer_load_dwordx4 v142, s[4:7], s16 offen offset:2048 sc1 lds
    v_mfma_f32_16x16x32_bf16 v[96:99], v[32:35], v[56:59], v[96:99]
    ds_read_b64_tr_b16 v[14:15], v131 offset:53248
    v_mfma_f32_16x16x32_bf16 v[100:103], v[36:39], v[56:59], v[100:103]
    ds_read_b128 v[20:23], v136 offset:51200
    v_mfma_f32_16x16x32_bf16 v[104:107], v[40:43], v[56:59], v[104:107]
    ds_read_b128 v[24:27], v136 offset:53248
    buffer_load_dwordx4 v142, s[4:7], s16 offen offset:3072 sc1 lds
    v_mfma_f32_16x16x32_bf16 v[108:111], v[44:47], v[56:59], v[108:111]
    ds_read_b128 v[28:31], v136 offset:55296
    v_mfma_f32_16x16x32_bf16 v[112:115], v[32:35], v[60:63], v[112:115]
    s_add_u32 s16, s16, 2048
    v_mfma_f32_16x16x32_bf16 v[116:119], v[36:39], v[60:63], v[116:119]
    v_mfma_f32_16x16x32_bf16 v[120:123], v[40:43], v[60:63], v[120:123]
    v_mfma_f32_16x16x32_bf16 v[124:127], v[44:47], v[60:63], v[124:127]
    s_waitcnt lgkmcnt(0)
    ds_read_b128 v[48:51], v136 offset:50176
    s_add_u32 m0, s19, 32768
    s_nop 0
    v_mfma_f32_16x16x32_bf16 v[64:67], v[0:3], v[16:19], v[64:67]
    ds_read_b64_tr_b16 v[32:33], v128 offset:57344
    v_mfma_f32_16x16x32_bf16 v[68:71], v[4:7], v[16:19], v[68:71]
    ds_read_b64_tr_b16 v[34:35], v128 offset:61440
    buffer_load_dwordx4 v137, s[8:11], s15 offen offset:0 lds
    v_mfma_f32_16x16x32_bf16 v[72:75], v[8:11], v[16:19], v[72:75]
    ds_read_b64_tr_b16 v[36:37], v129 offset:57344
    v_mfma_f32_16x16x32_bf16 v[76:79], v[12:15], v[16:19], v[76:79]
    ds_read_b64_tr_b16 v[38:39], v129 offset:61440
    v_mfma_f32_16x16x32_bf16 v[80:83], v[0:3], v[20:23], v[80:83]
    ds_read_b64_tr_b16 v[40:41], v130 offset:57344
    buffer_load_dwordx4 v138, s[8:11], s15 offen offset:1024 lds
    v_mfma_f32_16x16x32_bf16 v[84:87], v[4:7], v[20:23], v[84:87]
    ds_read_b64_tr_b16 v[42:43], v130 offset:61440
    v_mfma_f32_16x16x32_bf16 v[88:91], v[8:11], v[20:23], v[88:91]
    ds_read_b64_tr_b16 v[44:45], v131 offset:57344
    v_mfma_f32_16x16x32_bf16 v[92:95], v[12:15], v[20:23], v[92:95]
    ds_read_b64_tr_b16 v[46:47], v131 offset:61440
    buffer_load_dwordx4 v139, s[8:11], s15 offen offset:2048 lds
    v_mfma_f32_16x16x32_bf16 v[96:99], v[0:3], v[24:27], v[96:99]
    ds_read_b128 v[52:55], v136 offset:52224
    v_mfma_f32_16x16x32_bf16 v[100:103], v[4:7], v[24:27], v[100:103]
    ds_read_b128 v[56:59], v136 offset:54272
    buffer_load_dwordx4 v140, s[8:11], s15 offen offset:3072 lds
    v_mfma_f32_16x16x32_bf16 v[104:107], v[8:11], v[24:27], v[104:107]
    ds_read_b128 v[60:63], v136 offset:56320
    v_mfma_f32_16x16x32_bf16 v[108:111], v[12:15], v[24:27], v[108:111]
    v_mfma_f32_16x16x32_bf16 v[112:115], v[0:3], v[28:31], v[112:115]
    s_add_u32 s15, s15, s17
    v_mfma_f32_16x16x32_bf16 v[116:119], v[4:7], v[28:31], v[116:119]
    v_mfma_f32_16x16x32_bf16 v[120:123], v[8:11], v[28:31], v[120:123]
    v_mfma_f32_16x16x32_bf16 v[124:127], v[12:15], v[28:31], v[124:127]
    s_waitcnt lgkmcnt(0)
    v_mfma_f32_16x16x32_bf16 v[64:67], v[32:35], v[48:51], v[64:67]
    s_waitcnt vmcnt(16)
    s_barrier
    ds_read_b128 v[16:19], v136 offset:0
    s_add_u32 m0, s20, 49152
    s_nop 0
    v_mfma_f32_16x16x32_bf16 v[68:71], v[36:39], v[48:51], v[68:71]
    ds_read_b64_tr_b16 v[0:1], v128 offset:0
    v_mfma_f32_16x16x32_bf16 v[72:75], v[40:43], v[48:51], v[72:75]
    ds_read_b64_tr_b16 v[2:3], v128 offset:4096
    buffer_load_dwordx4 v141, s[4:7], s16 offen offset:0 sc1 lds
    v_mfma_f32_16x16x32_bf16 v[76:79], v[44:47], v[48:51], v[76:79]
    ds_read_b64_tr_b16 v[4:5], v129 offset:0
    v_mfma_f32_16x16x32_bf16 v[80:83], v[32:35], v[52:55], v[80:83]
    ds_read_b64_tr_b16 v[6:7], v129 offset:4096
    v_mfma_f32_16x16x32_bf16 v[84:87], v[36:39], v[52:55], v[84:87]
    ds_read_b64_tr_b16 v[8:9], v130 offset:0
    buffer_load_dwordx4 v141, s[4:7], s16 offen offset:1024 sc1 lds
    v_mfma_f32_16x16x32_bf16 v[88:91], v[40:43], v[52:55], v[88:91]
    ds_read_b64_tr_b16 v[10:11], v130 offset:4096
    v_mfma_f32_16x16x32_bf16 v[92:95], v[44:47], v[52:55], v[92:95]
    ds_read_b64_tr_b16 v[12:13], v131 offset:0
    buffer_load_dwordx4 v142, s[4:7], s16 offen offset:2048 sc1 lds
    v_mfma_f32_16x16x32_bf16 v[96:99], v[32:35], v[56:59], v[96:99]
    ds_read_b64_tr_b16 v[14:15], v131 offset:4096
    v_mfma_f32_16x16x32_bf16 v[100:103], v[36:39], v[56:59], v[100:103]
    ds_read_b128 v[20:23], v136 offset:2048
    v_mfma_f32_16x16x32_bf16 v[104:107], v[40:43], v[56:59], v[104:107]
    ds_read_b128 v[24:27], v136 offset:4096
    buffer_load_dwordx4 v142, s[4:7], s16 offen offset:3072 sc1 lds
    v_mfma_f32_16x16x32_bf16 v[108:111], v[44:47], v[56:59], v[108:111]
    ds_read_b128 v[28:31], v136 offset:6144
    v_mfma_f32_16x16x32_bf16 v[112:115], v[32:35], v[60:63], v[112:115]
    s_add_u32 s16, s16, 2048
    v_mfma_f32_16x16x32_bf16 v[116:119], v[36:39], v[60:63], v[116:119]
    v_mfma_f32_16x16x32_bf16 v[120:123], v[40:43], v[60:63], v[120:123]
    v_mfma_f32_16x16x32_bf16 v[124:127], v[44:47], v[60:63], v[124:127]
    s_sub_u32 s18, s18, 1
    s_cmp_lg_u32 s18, 0
    s_cbranch_scc1 main_kernel_w_c0_n_loop
    s_cmp_lg_u32 s14, 0
    s_cbranch_scc1 main_kernel_w_c0_n_nt
    s_lshl_b32 s32, s27, 8
    s_add_u32 s32, s32, 0x841e000
    v_mov_b32 v255, 1
    s_mov_b64 exec, 1
    buffer_atomic_add v255, off, s[4:7], s32 sc0 sc1
    s_mov_b64 exec, -1
main_kernel_w_c0_n_nt:
    s_cmp_lg_u32 s23, 8
    s_cbranch_scc1 main_kernel_w_c0_nlw
    s_lshl_b32 s18, s25, 4
    s_add_u32 s18, s18, s24
    s_lshl_b32 s18, s18, 4
    s_add_u32 s18, s18, 0x8412000
    buffer_load_dword v192, off, s[4:7], s18 sc1
main_kernel_w_c0_nlw:
    s_waitcnt lgkmcnt(0)
    ds_read_b128 v[48:51], v136 offset:1024
    s_add_u32 m0, s19, 49152
    s_nop 0
    v_mfma_f32_16x16x32_bf16 v[64:67], v[0:3], v[16:19], v[64:67]
    ds_read_b64_tr_b16 v[32:33], v128 offset:8192
    v_mfma_f32_16x16x32_bf16 v[68:71], v[4:7], v[16:19], v[68:71]
    ds_read_b64_tr_b16 v[34:35], v128 offset:12288
    buffer_load_dwordx4 v137, s[8:11], s15 offen offset:0 lds
    v_mfma_f32_16x16x32_bf16 v[72:75], v[8:11], v[16:19], v[72:75]
    ds_read_b64_tr_b16 v[36:37], v129 offset:8192
    v_mfma_f32_16x16x32_bf16 v[76:79], v[12:15], v[16:19], v[76:79]
    ds_read_b64_tr_b16 v[38:39], v129 offset:12288
    v_mfma_f32_16x16x32_bf16 v[80:83], v[0:3], v[20:23], v[80:83]
    ds_read_b64_tr_b16 v[40:41], v130 offset:8192
    buffer_load_dwordx4 v138, s[8:11], s15 offen offset:1024 lds
    v_mfma_f32_16x16x32_bf16 v[84:87], v[4:7], v[20:23], v[84:87]
    ds_read_b64_tr_b16 v[42:43], v130 offset:12288
    v_mfma_f32_16x16x32_bf16 v[88:91], v[8:11], v[20:23], v[88:91]
    ds_read_b64_tr_b16 v[44:45], v131 offset:8192
    v_mfma_f32_16x16x32_bf16 v[92:95], v[12:15], v[20:23], v[92:95]
    ds_read_b64_tr_b16 v[46:47], v131 offset:12288
    buffer_load_dwordx4 v139, s[8:11], s15 offen offset:2048 lds
    v_mfma_f32_16x16x32_bf16 v[96:99], v[0:3], v[24:27], v[96:99]
    ds_read_b128 v[52:55], v136 offset:3072
    v_mfma_f32_16x16x32_bf16 v[100:103], v[4:7], v[24:27], v[100:103]
    ds_read_b128 v[56:59], v136 offset:5120
    buffer_load_dwordx4 v140, s[8:11], s15 offen offset:3072 lds
    v_mfma_f32_16x16x32_bf16 v[104:107], v[8:11], v[24:27], v[104:107]
    ds_read_b128 v[60:63], v136 offset:7168
    v_mfma_f32_16x16x32_bf16 v[108:111], v[12:15], v[24:27], v[108:111]
    v_mfma_f32_16x16x32_bf16 v[112:115], v[0:3], v[28:31], v[112:115]
    s_add_u32 s15, s15, s17
    v_mfma_f32_16x16x32_bf16 v[116:119], v[4:7], v[28:31], v[116:119]
    v_mfma_f32_16x16x32_bf16 v[120:123], v[8:11], v[28:31], v[120:123]
    v_mfma_f32_16x16x32_bf16 v[124:127], v[12:15], v[28:31], v[124:127]
    s_waitcnt lgkmcnt(0)
    v_mfma_f32_16x16x32_bf16 v[64:67], v[32:35], v[48:51], v[64:67]
    s_waitcnt vmcnt(16)
    s_barrier
    ds_read_b128 v[16:19], v136 offset:16384
    v_mfma_f32_16x16x32_bf16 v[68:71], v[36:39], v[48:51], v[68:71]
    ds_read_b64_tr_b16 v[0:1], v128 offset:16384
    v_mfma_f32_16x16x32_bf16 v[72:75], v[40:43], v[48:51], v[72:75]
    ds_read_b64_tr_b16 v[2:3], v128 offset:20480
    v_mfma_f32_16x16x32_bf16 v[76:79], v[44:47], v[48:51], v[76:79]
    ds_read_b64_tr_b16 v[4:5], v129 offset:16384
    v_mfma_f32_16x16x32_bf16 v[80:83], v[32:35], v[52:55], v[80:83]
    ds_read_b64_tr_b16 v[6:7], v129 offset:20480
    v_mfma_f32_16x16x32_bf16 v[84:87], v[36:39], v[52:55], v[84:87]
    ds_read_b64_tr_b16 v[8:9], v130 offset:16384
    v_mfma_f32_16x16x32_bf16 v[88:91], v[40:43], v[52:55], v[88:91]
    ds_read_b64_tr_b16 v[10:11], v130 offset:20480
    v_mfma_f32_16x16x32_bf16 v[92:95], v[44:47], v[52:55], v[92:95]
    ds_read_b64_tr_b16 v[12:13], v131 offset:16384
    v_mfma_f32_16x16x32_bf16 v[96:99], v[32:35], v[56:59], v[96:99]
    ds_read_b64_tr_b16 v[14:15], v131 offset:20480
    v_mfma_f32_16x16x32_bf16 v[100:103], v[36:39], v[56:59], v[100:103]
    ds_read_b128 v[20:23], v136 offset:18432
    v_mfma_f32_16x16x32_bf16 v[104:107], v[40:43], v[56:59], v[104:107]
    ds_read_b128 v[24:27], v136 offset:20480
    v_mfma_f32_16x16x32_bf16 v[108:111], v[44:47], v[56:59], v[108:111]
    ds_read_b128 v[28:31], v136 offset:22528
    v_mfma_f32_16x16x32_bf16 v[112:115], v[32:35], v[60:63], v[112:115]
    v_mfma_f32_16x16x32_bf16 v[116:119], v[36:39], v[60:63], v[116:119]
    v_mfma_f32_16x16x32_bf16 v[120:123], v[40:43], v[60:63], v[120:123]
    v_mfma_f32_16x16x32_bf16 v[124:127], v[44:47], v[60:63], v[124:127]
    s_waitcnt lgkmcnt(0)
    ds_read_b128 v[48:51], v136 offset:17408
    v_mfma_f32_16x16x32_bf16 v[64:67], v[0:3], v[16:19], v[64:67]
    ds_read_b64_tr_b16 v[32:33], v128 offset:24576
    v_mfma_f32_16x16x32_bf16 v[68:71], v[4:7], v[16:19], v[68:71]
    ds_read_b64_tr_b16 v[34:35], v128 offset:28672
    v_mfma_f32_16x16x32_bf16 v[72:75], v[8:11], v[16:19], v[72:75]
    ds_read_b64_tr_b16 v[36:37], v129 offset:24576
    v_mfma_f32_16x16x32_bf16 v[76:79], v[12:15], v[16:19], v[76:79]
    ds_read_b64_tr_b16 v[38:39], v129 offset:28672
    v_mfma_f32_16x16x32_bf16 v[80:83], v[0:3], v[20:23], v[80:83]
    ds_read_b64_tr_b16 v[40:41], v130 offset:24576
    v_mfma_f32_16x16x32_bf16 v[84:87], v[4:7], v[20:23], v[84:87]
    ds_read_b64_tr_b16 v[42:43], v130 offset:28672
    v_mfma_f32_16x16x32_bf16 v[88:91], v[8:11], v[20:23], v[88:91]
    ds_read_b64_tr_b16 v[44:45], v131 offset:24576
    v_mfma_f32_16x16x32_bf16 v[92:95], v[12:15], v[20:23], v[92:95]
    ds_read_b64_tr_b16 v[46:47], v131 offset:28672
    v_mfma_f32_16x16x32_bf16 v[96:99], v[0:3], v[24:27], v[96:99]
    ds_read_b128 v[52:55], v136 offset:19456
    v_mfma_f32_16x16x32_bf16 v[100:103], v[4:7], v[24:27], v[100:103]
    ds_read_b128 v[56:59], v136 offset:21504
    v_mfma_f32_16x16x32_bf16 v[104:107], v[8:11], v[24:27], v[104:107]
    ds_read_b128 v[60:63], v136 offset:23552
    v_mfma_f32_16x16x32_bf16 v[108:111], v[12:15], v[24:27], v[108:111]
    v_mfma_f32_16x16x32_bf16 v[112:115], v[0:3], v[28:31], v[112:115]
    v_mfma_f32_16x16x32_bf16 v[116:119], v[4:7], v[28:31], v[116:119]
    v_mfma_f32_16x16x32_bf16 v[120:123], v[8:11], v[28:31], v[120:123]
    v_mfma_f32_16x16x32_bf16 v[124:127], v[12:15], v[28:31], v[124:127]
    s_waitcnt lgkmcnt(0)
    v_mfma_f32_16x16x32_bf16 v[64:67], v[32:35], v[48:51], v[64:67]
    s_waitcnt vmcnt(8)
    s_barrier
    ds_read_b128 v[16:19], v136 offset:32768
    v_mfma_f32_16x16x32_bf16 v[68:71], v[36:39], v[48:51], v[68:71]
    ds_read_b64_tr_b16 v[0:1], v128 offset:32768
    v_mfma_f32_16x16x32_bf16 v[72:75], v[40:43], v[48:51], v[72:75]
    ds_read_b64_tr_b16 v[2:3], v128 offset:36864
    v_mfma_f32_16x16x32_bf16 v[76:79], v[44:47], v[48:51], v[76:79]
    ds_read_b64_tr_b16 v[4:5], v129 offset:32768
    v_mfma_f32_16x16x32_bf16 v[80:83], v[32:35], v[52:55], v[80:83]
    ds_read_b64_tr_b16 v[6:7], v129 offset:36864
    v_mfma_f32_16x16x32_bf16 v[84:87], v[36:39], v[52:55], v[84:87]
    ds_read_b64_tr_b16 v[8:9], v130 offset:32768
    v_mfma_f32_16x16x32_bf16 v[88:91], v[40:43], v[52:55], v[88:91]
    ds_read_b64_tr_b16 v[10:11], v130 offset:36864
    v_mfma_f32_16x16x32_bf16 v[92:95], v[44:47], v[52:55], v[92:95]
    ds_read_b64_tr_b16 v[12:13], v131 offset:32768
    v_mfma_f32_16x16x32_bf16 v[96:99], v[32:35], v[56:59], v[96:99]
    ds_read_b64_tr_b16 v[14:15], v131 offset:36864
    v_mfma_f32_16x16x32_bf16 v[100:103], v[36:39], v[56:59], v[100:103]
    ds_read_b128 v[20:23], v136 offset:34816
    v_mfma_f32_16x16x32_bf16 v[104:107], v[40:43], v[56:59], v[104:107]
    ds_read_b128 v[24:27], v136 offset:36864
    v_mfma_f32_16x16x32_bf16 v[108:111], v[44:47], v[56:59], v[108:111]
    ds_read_b128 v[28:31], v136 offset:38912
    v_mfma_f32_16x16x32_bf16 v[112:115], v[32:35], v[60:63], v[112:115]
    v_mfma_f32_16x16x32_bf16 v[116:119], v[36:39], v[60:63], v[116:119]
    v_mfma_f32_16x16x32_bf16 v[120:123], v[40:43], v[60:63], v[120:123]
    v_mfma_f32_16x16x32_bf16 v[124:127], v[44:47], v[60:63], v[124:127]
    s_waitcnt lgkmcnt(0)
    ds_read_b128 v[48:51], v136 offset:33792
    v_mfma_f32_16x16x32_bf16 v[64:67], v[0:3], v[16:19], v[64:67]
    ds_read_b64_tr_b16 v[32:33], v128 offset:40960
    v_mfma_f32_16x16x32_bf16 v[68:71], v[4:7], v[16:19], v[68:71]
    ds_read_b64_tr_b16 v[34:35], v128 offset:45056
    v_mfma_f32_16x16x32_bf16 v[72:75], v[8:11], v[16:19], v[72:75]
    ds_read_b64_tr_b16 v[36:37], v129 offset:40960
    v_mfma_f32_16x16x32_bf16 v[76:79], v[12:15], v[16:19], v[76:79]
    ds_read_b64_tr_b16 v[38:39], v129 offset:45056
    v_mfma_f32_16x16x32_bf16 v[80:83], v[0:3], v[20:23], v[80:83]
    ds_read_b64_tr_b16 v[40:41], v130 offset:40960
    v_mfma_f32_16x16x32_bf16 v[84:87], v[4:7], v[20:23], v[84:87]
    ds_read_b64_tr_b16 v[42:43], v130 offset:45056
    v_mfma_f32_16x16x32_bf16 v[88:91], v[8:11], v[20:23], v[88:91]
    ds_read_b64_tr_b16 v[44:45], v131 offset:40960
    v_mfma_f32_16x16x32_bf16 v[92:95], v[12:15], v[20:23], v[92:95]
    ds_read_b64_tr_b16 v[46:47], v131 offset:45056
    v_mfma_f32_16x16x32_bf16 v[96:99], v[0:3], v[24:27], v[96:99]
    ds_read_b128 v[52:55], v136 offset:35840
    v_mfma_f32_16x16x32_bf16 v[100:103], v[4:7], v[24:27], v[100:103]
    ds_read_b128 v[56:59], v136 offset:37888
    v_mfma_f32_16x16x32_bf16 v[104:107], v[8:11], v[24:27], v[104:107]
    ds_read_b128 v[60:63], v136 offset:39936
    v_mfma_f32_16x16x32_bf16 v[108:111], v[12:15], v[24:27], v[108:111]
    v_mfma_f32_16x16x32_bf16 v[112:115], v[0:3], v[28:31], v[112:115]
    v_mfma_f32_16x16x32_bf16 v[116:119], v[4:7], v[28:31], v[116:119]
    v_mfma_f32_16x16x32_bf16 v[120:123], v[8:11], v[28:31], v[120:123]
    v_mfma_f32_16x16x32_bf16 v[124:127], v[12:15], v[28:31], v[124:127]
    s_waitcnt lgkmcnt(0)
    v_mfma_f32_16x16x32_bf16 v[64:67], v[32:35], v[48:51], v[64:67]
    s_waitcnt vmcnt(0)
    s_barrier
    ds_read_b128 v[16:19], v136 offset:49152
    v_mfma_f32_16x16x32_bf16 v[68:71], v[36:39], v[48:51], v[68:71]
    ds_read_b64_tr_b16 v[0:1], v128 offset:49152
    v_mfma_f32_16x16x32_bf16 v[72:75], v[40:43], v[48:51], v[72:75]
    ds_read_b64_tr_b16 v[2:3], v128 offset:53248
    v_mfma_f32_16x16x32_bf16 v[76:79], v[44:47], v[48:51], v[76:79]
    ds_read_b64_tr_b16 v[4:5], v129 offset:49152
    v_mfma_f32_16x16x32_bf16 v[80:83], v[32:35], v[52:55], v[80:83]
    ds_read_b64_tr_b16 v[6:7], v129 offset:53248
    v_mfma_f32_16x16x32_bf16 v[84:87], v[36:39], v[52:55], v[84:87]
    ds_read_b64_tr_b16 v[8:9], v130 offset:49152
    v_mfma_f32_16x16x32_bf16 v[88:91], v[40:43], v[52:55], v[88:91]
    ds_read_b64_tr_b16 v[10:11], v130 offset:53248
    v_mfma_f32_16x16x32_bf16 v[92:95], v[44:47], v[52:55], v[92:95]
    ds_read_b64_tr_b16 v[12:13], v131 offset:49152
    v_mfma_f32_16x16x32_bf16 v[96:99], v[32:35], v[56:59], v[96:99]
    ds_read_b64_tr_b16 v[14:15], v131 offset:53248
    v_mfma_f32_16x16x32_bf16 v[100:103], v[36:39], v[56:59], v[100:103]
    ds_read_b128 v[20:23], v136 offset:51200
    v_mfma_f32_16x16x32_bf16 v[104:107], v[40:43], v[56:59], v[104:107]
    ds_read_b128 v[24:27], v136 offset:53248
    v_mfma_f32_16x16x32_bf16 v[108:111], v[44:47], v[56:59], v[108:111]
    ds_read_b128 v[28:31], v136 offset:55296
    v_mfma_f32_16x16x32_bf16 v[112:115], v[32:35], v[60:63], v[112:115]
    v_mfma_f32_16x16x32_bf16 v[116:119], v[36:39], v[60:63], v[116:119]
    v_mfma_f32_16x16x32_bf16 v[120:123], v[40:43], v[60:63], v[120:123]
    v_mfma_f32_16x16x32_bf16 v[124:127], v[44:47], v[60:63], v[124:127]
    v_readfirstlane_b32 s55, v255
    s_cmp_lg_u32 s23, 8
    s_cbranch_scc1 main_kernel_w_c0_lwk
main_kernel_w_c0_lwp:
    v_cmp_eq_u32 vcc, 0, v192
    s_cbranch_vccz main_kernel_w_c0_lwk
    s_sleep 8
    buffer_load_dword v192, off, s[4:7], s18 sc1
    s_waitcnt vmcnt(0)
    s_sub_u32 s29, s29, 1
    s_cbranch_scc0 main_kernel_w_c0_lwp
main_kernel_w_c0_lwk:
    s_cmp_eq_u32 s26, -1
    s_cbranch_scc1 main_kernel_w_c0_nores
    s_add_u32 s32, s26, 0
    buffer_load_dwordx4 v[192:195], v251, s[4:7], s32 offen offset:0 sc1
    buffer_load_dwordx4 v[196:199], v251, s[4:7], s32 offen offset:1024 sc1
    s_add_u32 s32, s26, 32768
    buffer_load_dwordx4 v[200:203], v251, s[4:7], s32 offen offset:0 sc1
    buffer_load_dwordx4 v[204:207], v251, s[4:7], s32 offen offset:1024 sc1
    s_add_u32 s32, s26, 65536
    buffer_load_dwordx4 v[208:211], v251, s[4:7], s32 offen offset:0 sc1
    buffer_load_dwordx4 v[212:215], v251, s[4:7], s32 offen offset:1024 sc1
    s_add_u32 s32, s26, 98304
    buffer_load_dwordx4 v[216:219], v251, s[4:7], s32 offen offset:0 sc1
    buffer_load_dwordx4 v[220:223], v251, s[4:7], s32 offen offset:1024 sc1
main_kernel_w_c0_nores:
    s_waitcnt lgkmcnt(0)
    ds_read_b128 v[48:51], v136 offset:50176
    v_mfma_f32_16x16x32_bf16 v[64:67], v[0:3], v[16:19], v[64:67]
    ds_read_b64_tr_b16 v[32:33], v128 offset:57344
    v_mfma_f32_16x16x32_bf16 v[68:71], v[4:7], v[16:19], v[68:71]
    ds_read_b64_tr_b16 v[34:35], v128 offset:61440
    v_mfma_f32_16x16x32_bf16 v[72:75], v[8:11], v[16:19], v[72:75]
    ds_read_b64_tr_b16 v[36:37], v129 offset:57344
    v_mfma_f32_16x16x32_bf16 v[76:79], v[12:15], v[16:19], v[76:79]
    ds_read_b64_tr_b16 v[38:39], v129 offset:61440
    v_mfma_f32_16x16x32_bf16 v[80:83], v[0:3], v[20:23], v[80:83]
    ds_read_b64_tr_b16 v[40:41], v130 offset:57344
    v_mfma_f32_16x16x32_bf16 v[84:87], v[4:7], v[20:23], v[84:87]
    ds_read_b64_tr_b16 v[42:43], v130 offset:61440
    v_mfma_f32_16x16x32_bf16 v[88:91], v[8:11], v[20:23], v[88:91]
    ds_read_b64_tr_b16 v[44:45], v131 offset:57344
    v_mfma_f32_16x16x32_bf16 v[92:95], v[12:15], v[20:23], v[92:95]
    ds_read_b64_tr_b16 v[46:47], v131 offset:61440
    v_mfma_f32_16x16x32_bf16 v[96:99], v[0:3], v[24:27], v[96:99]
    ds_read_b128 v[52:55], v136 offset:52224
    v_mfma_f32_16x16x32_bf16 v[100:103], v[4:7], v[24:27], v[100:103]
    ds_read_b128 v[56:59], v136 offset:54272
    v_mfma_f32_16x16x32_bf16 v[104:107], v[8:11], v[24:27], v[104:107]
    ds_read_b128 v[60:63], v136 offset:56320
    v_mfma_f32_16x16x32_bf16 v[108:111], v[12:15], v[24:27], v[108:111]
    v_mfma_f32_16x16x32_bf16 v[112:115], v[0:3], v[28:31], v[112:115]
    v_mfma_f32_16x16x32_bf16 v[116:119], v[4:7], v[28:31], v[116:119]
    v_mfma_f32_16x16x32_bf16 v[120:123], v[8:11], v[28:31], v[120:123]
    v_mfma_f32_16x16x32_bf16 v[124:127], v[12:15], v[28:31], v[124:127]
    s_waitcnt lgkmcnt(0)
    v_mfma_f32_16x16x32_bf16 v[64:67], v[32:35], v[48:51], v[64:67]
    v_mfma_f32_16x16x32_bf16 v[68:71], v[36:39], v[48:51], v[68:71]
    v_mfma_f32_16x16x32_bf16 v[72:75], v[40:43], v[48:51], v[72:75]
    v_mfma_f32_16x16x32_bf16 v[76:79], v[44:47], v[48:51], v[76:79]
    v_mfma_f32_16x16x32_bf16 v[80:83], v[32:35], v[52:55], v[80:83]
    v_mfma_f32_16x16x32_bf16 v[84:87], v[36:39], v[52:55], v[84:87]
    v_mfma_f32_16x16x32_bf16 v[88:91], v[40:43], v[52:55], v[88:91]
    v_mfma_f32_16x16x32_bf16 v[92:95], v[44:47], v[52:55], v[92:95]
    v_mfma_f32_16x16x32_bf16 v[96:99], v[32:35], v[56:59], v[96:99]
    v_mfma_f32_16x16x32_bf16 v[100:103], v[36:39], v[56:59], v[100:103]
    v_mfma_f32_16x16x32_bf16 v[104:107], v[40:43], v[56:59], v[104:107]
    v_mfma_f32_16x16x32_bf16 v[108:111], v[44:47], v[56:59], v[108:111]
    v_mfma_f32_16x16x32_bf16 v[112:115], v[32:35], v[60:63], v[112:115]
    v_mfma_f32_16x16x32_bf16 v[116:119], v[36:39], v[60:63], v[116:119]
    v_mfma_f32_16x16x32_bf16 v[120:123], v[40:43], v[60:63], v[120:123]
    v_mfma_f32_16x16x32_bf16 v[124:127], v[44:47], v[60:63], v[124:127]
    s_nop 7
    s_cmp_eq_u32 s23, 4
    s_cbranch_scc1 main_kernel_w_c0_eadd
    s_cmp_eq_u32 s23, 7
    s_cbranch_scc1 main_kernel_w_c0_esilu
    s_cmp_eq_u32 s23, 8
    s_cbranch_scc1 main_kernel_w_c0_efin
main_kernel_w_c0_escl:
    s_mov_b32 s53, s21
    v_mul_f32 v64, 0x3e0293ee, v64
    v_mul_f32 v65, 0x3e0293ee, v65
    v_mul_f32 v66, 0x3e0293ee, v66
    v_mul_f32 v67, 0x3e0293ee, v67
    v_mul_f32 v68, 0x3e0293ee, v68
    v_mul_f32 v69, 0x3e0293ee, v69
    v_mul_f32 v70, 0x3e0293ee, v70
    v_mul_f32 v71, 0x3e0293ee, v71
    v_cvt_pk_bf16_f32 v16, v64, v65
    v_cvt_pk_bf16_f32 v17, v66, v67
    v_cvt_pk_bf16_f32 v18, v68, v69
    v_cvt_pk_bf16_f32 v19, v70, v71
    buffer_store_dwordx4 v[16:19], v251, s[4:7], s53 offen offset:0 sc1
    v_mul_f32 v72, 0x3e0293ee, v72
    v_mul_f32 v73, 0x3e0293ee, v73
    v_mul_f32 v74, 0x3e0293ee, v74
    v_mul_f32 v75, 0x3e0293ee, v75
    v_mul_f32 v76, 0x3e0293ee, v76
    v_mul_f32 v77, 0x3e0293ee, v77
    v_mul_f32 v78, 0x3e0293ee, v78
    v_mul_f32 v79, 0x3e0293ee, v79
    v_cvt_pk_bf16_f32 v36, v72, v73
    v_cvt_pk_bf16_f32 v37, v74, v75
    v_cvt_pk_bf16_f32 v38, v76, v77
    v_cvt_pk_bf16_f32 v39, v78, v79
    buffer_store_dwordx4 v[36:39], v251, s[4:7], s53 offen offset:1024 sc1
    s_add_u32 s53, s53, s22
    v_mul_f32 v80, 0x3e0293ee, v80
    v_mul_f32 v81, 0x3e0293ee, v81
    v_mul_f32 v82, 0x3e0293ee, v82
    v_mul_f32 v83, 0x3e0293ee, v83
    v_mul_f32 v84, 0x3e0293ee, v84
    v_mul_f32 v85, 0x3e0293ee, v85
    v_mul_f32 v86, 0x3e0293ee, v86
    v_mul_f32 v87, 0x3e0293ee, v87
    v_cvt_pk_bf16_f32 v56, v80, v81
    v_cvt_pk_bf16_f32 v57, v82, v83
    v_cvt_pk_bf16_f32 v58, v84, v85
    v_cvt_pk_bf16_f32 v59, v86, v87
    buffer_store_dwordx4 v[56:59], v251, s[4:7], s53 offen offset:0 sc1
    v_mul_f32 v88, 0x3e0293ee, v88
    v_mul_f32 v89, 0x3e0293ee, v89
    v_mul_f32 v90, 0x3e0293ee, v90
    v_mul_f32 v91, 0x3e0293ee, v91
    v_mul_f32 v92, 0x3e0293ee, v92
    v_mul_f32 v93, 0x3e0293ee, v93
    v_mul_f32 v94, 0x3e0293ee, v94
    v_mul_f32 v95, 0x3e0293ee, v95
    v_cvt_pk_bf16_f32 v16, v88, v89
    v_cvt_pk_bf16_f32 v17, v90, v91
    v_cvt_pk_bf16_f32 v18, v92, v93
    v_cvt_pk_bf16_f32 v19, v94, v95
    buffer_store_dwordx4 v[16:19], v251, s[4:7], s53 offen offset:1024 sc1
    s_add_u32 s53, s53, s22
    v_mul_f32 v96, 0x3e0293ee, v96
    v_mul_f32 v97, 0x3e0293ee, v97
    v_mul_f32 v98, 0x3e0293ee, v98
    v_mul_f32 v99, 0x3e0293ee, v99
    v_mul_f32 v100, 0x3e0293ee, v100
    v_mul_f32 v101, 0x3e0293ee, v101
    v_mul_f32 v102, 0x3e0293ee, v102
    v_mul_f32 v103, 0x3e0293ee, v103
    v_cvt_pk_bf16_f32 v36, v96, v97
    v_cvt_pk_bf16_f32 v37, v98, v99
    v_cvt_pk_bf16_f32 v38, v100, v101
    v_cvt_pk_bf16_f32 v39, v102, v103
    buffer_store_dwordx4 v[36:39], v251, s[4:7], s53 offen offset:0 sc1
    v_mul_f32 v104, 0x3e0293ee, v104
    v_mul_f32 v105, 0x3e0293ee, v105
    v_mul_f32 v106, 0x3e0293ee, v106
    v_mul_f32 v107, 0x3e0293ee, v107
    v_mul_f32 v108, 0x3e0293ee, v108
    v_mul_f32 v109, 0x3e0293ee, v109
    v_mul_f32 v110, 0x3e0293ee, v110
    v_mul_f32 v111, 0x3e0293ee, v111
    v_cvt_pk_bf16_f32 v56, v104, v105
    v_cvt_pk_bf16_f32 v57, v106, v107
    v_cvt_pk_bf16_f32 v58, v108, v109
    v_cvt_pk_bf16_f32 v59, v110, v111
    buffer_store_dwordx4 v[56:59], v251, s[4:7], s53 offen offset:1024 sc1
    s_add_u32 s53, s53, s22
    v_mul_f32 v112, 0x3e0293ee, v112
    v_mul_f32 v113, 0x3e0293ee, v113
    v_mul_f32 v114, 0x3e0293ee, v114
    v_mul_f32 v115, 0x3e0293ee, v115
    v_mul_f32 v116, 0x3e0293ee, v116
    v_mul_f32 v117, 0x3e0293ee, v117
    v_mul_f32 v118, 0x3e0293ee, v118
    v_mul_f32 v119, 0x3e0293ee, v119
    v_cvt_pk_bf16_f32 v16, v112, v113
    v_cvt_pk_bf16_f32 v17, v114, v115
    v_cvt_pk_bf16_f32 v18, v116, v117
    v_cvt_pk_bf16_f32 v19, v118, v119
    buffer_store_dwordx4 v[16:19], v251, s[4:7], s53 offen offset:0 sc1
    v_mul_f32 v120, 0x3e0293ee, v120
    v_mul_f32 v121, 0x3e0293ee, v121
    v_mul_f32 v122, 0x3e0293ee, v122
    v_mul_f32 v123, 0x3e0293ee, v123
    v_mul_f32 v124, 0x3e0293ee, v124
    v_mul_f32 v125, 0x3e0293ee, v125
    v_mul_f32 v126, 0x3e0293ee, v126
    v_mul_f32 v127, 0x3e0293ee, v127
    v_cvt_pk_bf16_f32 v36, v120, v121
    v_cvt_pk_bf16_f32 v37, v122, v123
    v_cvt_pk_bf16_f32 v38, v124, v125
    v_cvt_pk_bf16_f32 v39, v126, v127
    buffer_store_dwordx4 v[36:39], v251, s[4:7], s53 offen offset:1024 sc1
    s_branch main_kernel_w_done
main_kernel_w_c0_eadd:
    s_mov_b32 s53, s21
    s_waitcnt vmcnt(7)
    v_lshlrev_b32 v8, 16, v192
    v_and_b32 v9, 0xffff0000, v192
    v_lshlrev_b32 v10, 16, v193
    v_and_b32 v11, 0xffff0000, v193
    v_lshlrev_b32 v12, 16, v194
    v_and_b32 v13, 0xffff0000, v194
    v_lshlrev_b32 v14, 16, v195
    v_and_b32 v15, 0xffff0000, v195
    v_pk_add_f32 v[64:65], v[64:65], v[8:9]
    v_pk_add_f32 v[66:67], v[66:67], v[10:11]
    v_pk_add_f32 v[68:69], v[68:69], v[12:13]
    v_pk_add_f32 v[70:71], v[70:71], v[14:15]
    v_cvt_pk_bf16_f32 v16, v64, v65
    v_cvt_pk_bf16_f32 v17, v66, v67
    v_cvt_pk_bf16_f32 v18, v68, v69
    v_cvt_pk_bf16_f32 v19, v70, v71
    buffer_store_dwordx4 v[16:19], v251, s[4:7], s53 offen offset:0 sc1
    s_waitcnt vmcnt(7)
    v_lshlrev_b32 v28, 16, v196
    v_and_b32 v29, 0xffff0000, v196
    v_lshlrev_b32 v30, 16, v197
    v_and_b32 v31, 0xffff0000, v197
    v_lshlrev_b32 v32, 16, v198
    v_and_b32 v33, 0xffff0000, v198
    v_lshlrev_b32 v34, 16, v199
    v_and_b32 v35, 0xffff0000, v199
    v_pk_add_f32 v[72:73], v[72:73], v[28:29]
    v_pk_add_f32 v[74:75], v[74:75], v[30:31]
    v_pk_add_f32 v[76:77], v[76:77], v[32:33]
    v_pk_add_f32 v[78:79], v[78:79], v[34:35]
    v_cvt_pk_bf16_f32 v36, v72, v73
    v_cvt_pk_bf16_f32 v37, v74, v75
    v_cvt_pk_bf16_f32 v38, v76, v77
    v_cvt_pk_bf16_f32 v39, v78, v79
    buffer_store_dwordx4 v[36:39], v251, s[4:7], s53 offen offset:1024 sc1
    s_add_u32 s53, s53, s22
    s_waitcnt vmcnt(7)
    v_lshlrev_b32 v48, 16, v200
    v_and_b32 v49, 0xffff0000, v200
    v_lshlrev_b32 v50, 16, v201
    v_and_b32 v51, 0xffff0000, v201
    v_lshlrev_b32 v52, 16, v202
    v_and_b32 v53, 0xffff0000, v202
    v_lshlrev_b32 v54, 16, v203
    v_and_b32 v55, 0xffff0000, v203
    v_pk_add_f32 v[80:81], v[80:81], v[48:49]
    v_pk_add_f32 v[82:83], v[82:83], v[50:51]
    v_pk_add_f32 v[84:85], v[84:85], v[52:53]
    v_pk_add_f32 v[86:87], v[86:87], v[54:55]
    v_cvt_pk_bf16_f32 v56, v80, v81
    v_cvt_pk_bf16_f32 v57, v82, v83
    v_cvt_pk_bf16_f32 v58, v84, v85
    v_cvt_pk_bf16_f32 v59, v86, v87
    buffer_store_dwordx4 v[56:59], v251, s[4:7], s53 offen offset:0 sc1
    s_waitcnt vmcnt(7)
    v_lshlrev_b32 v8, 16, v204
    v_and_b32 v9, 0xffff0000, v204
    v_lshlrev_b32 v10, 16, v205
    v_and_b32 v11, 0xffff0000, v205
    v_lshlrev_b32 v12, 16, v206
    v_and_b32 v13, 0xffff0000, v206
    v_lshlrev_b32 v14, 16, v207
    v_and_b32 v15, 0xffff0000, v207
    v_pk_add_f32 v[88:89], v[88:89], v[8:9]
    v_pk_add_f32 v[90:91], v[90:91], v[10:11]
    v_pk_add_f32 v[92:93], v[92:93], v[12:13]
    v_pk_add_f32 v[94:95], v[94:95], v[14:15]
    v_cvt_pk_bf16_f32 v16, v88, v89
    v_cvt_pk_bf16_f32 v17, v90, v91
    v_cvt_pk_bf16_f32 v18, v92, v93
    v_cvt_pk_bf16_f32 v19, v94, v95
    buffer_store_dwordx4 v[16:19], v251, s[4:7], s53 offen offset:1024 sc1
    s_add_u32 s53, s53, s22
    s_waitcnt vmcnt(7)
    v_lshlrev_b32 v28, 16, v208
    v_and_b32 v29, 0xffff0000, v208
    v_lshlrev_b32 v30, 16, v209
    v_and_b32 v31, 0xffff0000, v209
    v_lshlrev_b32 v32, 16, v210
    v_and_b32 v33, 0xffff0000, v210
    v_lshlrev_b32 v34, 16, v211
    v_and_b32 v35, 0xffff0000, v211
    v_pk_add_f32 v[96:97], v[96:97], v[28:29]
    v_pk_add_f32 v[98:99], v[98:99], v[30:31]
    v_pk_add_f32 v[100:101], v[100:101], v[32:33]
    v_pk_add_f32 v[102:103], v[102:103], v[34:35]
    v_cvt_pk_bf16_f32 v36, v96, v97
    v_cvt_pk_bf16_f32 v37, v98, v99
    v_cvt_pk_bf16_f32 v38, v100, v101
    v_cvt_pk_bf16_f32 v39, v102, v103
    buffer_store_dwordx4 v[36:39], v251, s[4:7], s53 offen offset:0 sc1
    s_waitcnt vmcnt(7)
    v_lshlrev_b32 v48, 16, v212
    v_and_b32 v49, 0xffff0000, v212
    v_lshlrev_b32 v50, 16, v213
    v_and_b32 v51, 0xffff0000, v213
    v_lshlrev_b32 v52, 16, v214
    v_and_b32 v53, 0xffff0000, v214
    v_lshlrev_b32 v54, 16, v215
    v_and_b32 v55, 0xffff0000, v215
    v_pk_add_f32 v[104:105], v[104:105], v[48:49]
    v_pk_add_f32 v[106:107], v[106:107], v[50:51]
    v_pk_add_f32 v[108:109], v[108:109], v[52:53]
    v_pk_add_f32 v[110:111], v[110:111], v[54:55]
    v_cvt_pk_bf16_f32 v56, v104, v105
    v_cvt_pk_bf16_f32 v57, v106, v107
    v_cvt_pk_bf16_f32 v58, v108, v109
    v_cvt_pk_bf16_f32 v59, v110, v111
    buffer_store_dwordx4 v[56:59], v251, s[4:7], s53 offen offset:1024 sc1
    s_add_u32 s53, s53, s22
    s_waitcnt vmcnt(7)
    v_lshlrev_b32 v8, 16, v216
    v_and_b32 v9, 0xffff0000, v216
    v_lshlrev_b32 v10, 16, v217
    v_and_b32 v11, 0xffff0000, v217
    v_lshlrev_b32 v12, 16, v218
    v_and_b32 v13, 0xffff0000, v218
    v_lshlrev_b32 v14, 16, v219
    v_and_b32 v15, 0xffff0000, v219
    v_pk_add_f32 v[112:113], v[112:113], v[8:9]
    v_pk_add_f32 v[114:115], v[114:115], v[10:11]
    v_pk_add_f32 v[116:117], v[116:117], v[12:13]
    v_pk_add_f32 v[118:119], v[118:119], v[14:15]
    v_cvt_pk_bf16_f32 v16, v112, v113
    v_cvt_pk_bf16_f32 v17, v114, v115
    v_cvt_pk_bf16_f32 v18, v116, v117
    v_cvt_pk_bf16_f32 v19, v118, v119
    buffer_store_dwordx4 v[16:19], v251, s[4:7], s53 offen offset:0 sc1
    s_waitcnt vmcnt(7)
    v_lshlrev_b32 v28, 16, v220
    v_and_b32 v29, 0xffff0000, v220
    v_lshlrev_b32 v30, 16, v221
    v_and_b32 v31, 0xffff0000, v221
    v_lshlrev_b32 v32, 16, v222
    v_and_b32 v33, 0xffff0000, v222
    v_lshlrev_b32 v34, 16, v223
    v_and_b32 v35, 0xffff0000, v223
    v_pk_add_f32 v[120:121], v[120:121], v[28:29]
    v_pk_add_f32 v[122:123], v[122:123], v[30:31]
    v_pk_add_f32 v[124:125], v[124:125], v[32:33]
    v_pk_add_f32 v[126:127], v[126:127], v[34:35]
    v_cvt_pk_bf16_f32 v36, v120, v121
    v_cvt_pk_bf16_f32 v37, v122, v123
    v_cvt_pk_bf16_f32 v38, v124, v125
    v_cvt_pk_bf16_f32 v39, v126, v127
    buffer_store_dwordx4 v[36:39], v251, s[4:7], s53 offen offset:1024 sc1
    s_branch main_kernel_w_done
main_kernel_w_c0_esilu:
    s_mov_b32 s53, s21
    s_waitcnt vmcnt(7)
    v_lshlrev_b32 v8, 16, v192
    v_and_b32 v9, 0xffff0000, v192
    v_lshlrev_b32 v10, 16, v193
    v_and_b32 v11, 0xffff0000, v193
    v_lshlrev_b32 v12, 16, v194
    v_and_b32 v13, 0xffff0000, v194
    v_lshlrev_b32 v14, 16, v195
    v_and_b32 v15, 0xffff0000, v195
    v_pk_add_f32 v[64:65], v[64:65], v[8:9]
    v_pk_add_f32 v[66:67], v[66:67], v[10:11]
    v_pk_add_f32 v[68:69], v[68:69], v[12:13]
    v_pk_add_f32 v[70:71], v[70:71], v[14:15]
    v_pk_mul_f32 v[8:9], v[64:65], v[246:247]
    v_pk_mul_f32 v[10:11], v[66:67], v[246:247]
    v_pk_mul_f32 v[12:13], v[68:69], v[246:247]
    v_pk_mul_f32 v[14:15], v[70:71], v[246:247]
    v_exp_f32 v8, v8
    v_exp_f32 v9, v9
    v_exp_f32 v10, v10
    v_exp_f32 v11, v11
    v_exp_f32 v12, v12
    v_exp_f32 v13, v13
    v_exp_f32 v14, v14
    v_exp_f32 v15, v15
    v_pk_add_f32 v[8:9], v[8:9], v[244:245]
    v_pk_add_f32 v[10:11], v[10:11], v[244:245]
    v_pk_add_f32 v[12:13], v[12:13], v[244:245]
    v_pk_add_f32 v[14:15], v[14:15], v[244:245]
    v_rcp_f32 v8, v8
    v_rcp_f32 v9, v9
    v_rcp_f32 v10, v10
    v_rcp_f32 v11, v11
    v_rcp_f32 v12, v12
    v_rcp_f32 v13, v13
    v_rcp_f32 v14, v14
    v_rcp_f32 v15, v15
    v_pk_mul_f32 v[64:65], v[8:9], v[64:65]
    v_pk_mul_f32 v[66:67], v[10:11], v[66:67]
    v_pk_mul_f32 v[68:69], v[12:13], v[68:69]
    v_pk_mul_f32 v[70:71], v[14:15], v[70:71]
    v_cvt_pk_bf16_f32 v16, v64, v65
    v_cvt_pk_bf16_f32 v17, v66, v67
    v_cvt_pk_bf16_f32 v18, v68, v69
    v_cvt_pk_bf16_f32 v19, v70, v71
    buffer_store_dwordx4 v[16:19], v251, s[4:7], s53 offen offset:0 sc1
    s_waitcnt vmcnt(7)
    v_lshlrev_b32 v28, 16, v196
    v_and_b32 v29, 0xffff0000, v196
    v_lshlrev_b32 v30, 16, v197
    v_and_b32 v31, 0xffff0000, v197
    v_lshlrev_b32 v32, 16, v198
    v_and_b32 v33, 0xffff0000, v198
    v_lshlrev_b32 v34, 16, v199
    v_and_b32 v35, 0xffff0000, v199
    v_pk_add_f32 v[72:73], v[72:73], v[28:29]
    v_pk_add_f32 v[74:75], v[74:75], v[30:31]
    v_pk_add_f32 v[76:77], v[76:77], v[32:33]
    v_pk_add_f32 v[78:79], v[78:79], v[34:35]
    v_pk_mul_f32 v[28:29], v[72:73], v[246:247]
    v_pk_mul_f32 v[30:31], v[74:75], v[246:247]
    v_pk_mul_f32 v[32:33], v[76:77], v[246:247]
    v_pk_mul_f32 v[34:35], v[78:79], v[246:247]
    v_exp_f32 v28, v28
    v_exp_f32 v29, v29
    v_exp_f32 v30, v30
    v_exp_f32 v31, v31
    v_exp_f32 v32, v32
    v_exp_f32 v33, v33
    v_exp_f32 v34, v34
    v_exp_f32 v35, v35
    v_pk_add_f32 v[28:29], v[28:29], v[244:245]
    v_pk_add_f32 v[30:31], v[30:31], v[244:245]
    v_pk_add_f32 v[32:33], v[32:33], v[244:245]
    v_pk_add_f32 v[34:35], v[34:35], v[244:245]
    v_rcp_f32 v28, v28
    v_rcp_f32 v29, v29
    v_rcp_f32 v30, v30
    v_rcp_f32 v31, v31
    v_rcp_f32 v32, v32
    v_rcp_f32 v33, v33
    v_rcp_f32 v34, v34
    v_rcp_f32 v35, v35
    v_pk_mul_f32 v[72:73], v[28:29], v[72:73]
    v_pk_mul_f32 v[74:75], v[30:31], v[74:75]
    v_pk_mul_f32 v[76:77], v[32:33], v[76:77]
    v_pk_mul_f32 v[78:79], v[34:35], v[78:79]
    v_cvt_pk_bf16_f32 v36, v72, v73
    v_cvt_pk_bf16_f32 v37, v74, v75
    v_cvt_pk_bf16_f32 v38, v76, v77
    v_cvt_pk_bf16_f32 v39, v78, v79
    buffer_store_dwordx4 v[36:39], v251, s[4:7], s53 offen offset:1024 sc1
    s_add_u32 s53, s53, s22
    s_waitcnt vmcnt(7)
    v_lshlrev_b32 v48, 16, v200
    v_and_b32 v49, 0xffff0000, v200
    v_lshlrev_b32 v50, 16, v201
    v_and_b32 v51, 0xffff0000, v201
    v_lshlrev_b32 v52, 16, v202
    v_and_b32 v53, 0xffff0000, v202
    v_lshlrev_b32 v54, 16, v203
    v_and_b32 v55, 0xffff0000, v203
    v_pk_add_f32 v[80:81], v[80:81], v[48:49]
    v_pk_add_f32 v[82:83], v[82:83], v[50:51]
    v_pk_add_f32 v[84:85], v[84:85], v[52:53]
    v_pk_add_f32 v[86:87], v[86:87], v[54:55]
    v_pk_mul_f32 v[48:49], v[80:81], v[246:247]
    v_pk_mul_f32 v[50:51], v[82:83], v[246:247]
    v_pk_mul_f32 v[52:53], v[84:85], v[246:247]
    v_pk_mul_f32 v[54:55], v[86:87], v[246:247]
    v_exp_f32 v48, v48
    v_exp_f32 v49, v49
    v_exp_f32 v50, v50
    v_exp_f32 v51, v51
    v_exp_f32 v52, v52
    v_exp_f32 v53, v53
    v_exp_f32 v54, v54
    v_exp_f32 v55, v55
    v_pk_add_f32 v[48:49], v[48:49], v[244:245]
    v_pk_add_f32 v[50:51], v[50:51], v[244:245]
    v_pk_add_f32 v[52:53], v[52:53], v[244:245]
    v_pk_add_f32 v[54:55], v[54:55], v[244:245]
    v_rcp_f32 v48, v48
    v_rcp_f32 v49, v49
    v_rcp_f32 v50, v50
    v_rcp_f32 v51, v51
    v_rcp_f32 v52, v52
    v_rcp_f32 v53, v53
    v_rcp_f32 v54, v54
    v_rcp_f32 v55, v55
    v_pk_mul_f32 v[80:81], v[48:49], v[80:81]
    v_pk_mul_f32 v[82:83], v[50:51], v[82:83]
    v_pk_mul_f32 v[84:85], v[52:53], v[84:85]
    v_pk_mul_f32 v[86:87], v[54:55], v[86:87]
    v_cvt_pk_bf16_f32 v56, v80, v81
    v_cvt_pk_bf16_f32 v57, v82, v83
    v_cvt_pk_bf16_f32 v58, v84, v85
    v_cvt_pk_bf16_f32 v59, v86, v87
    buffer_store_dwordx4 v[56:59], v251, s[4:7], s53 offen offset:0 sc1
    s_waitcnt vmcnt(7)
    v_lshlrev_b32 v8, 16, v204
    v_and_b32 v9, 0xffff0000, v204
    v_lshlrev_b32 v10, 16, v205
    v_and_b32 v11, 0xffff0000, v205
    v_lshlrev_b32 v12, 16, v206
    v_and_b32 v13, 0xffff0000, v206
    v_lshlrev_b32 v14, 16, v207
    v_and_b32 v15, 0xffff0000, v207
    v_pk_add_f32 v[88:89], v[88:89], v[8:9]
    v_pk_add_f32 v[90:91], v[90:91], v[10:11]
    v_pk_add_f32 v[92:93], v[92:93], v[12:13]
    v_pk_add_f32 v[94:95], v[94:95], v[14:15]
    v_pk_mul_f32 v[8:9], v[88:89], v[246:247]
    v_pk_mul_f32 v[10:11], v[90:91], v[246:247]
    v_pk_mul_f32 v[12:13], v[92:93], v[246:247]
    v_pk_mul_f32 v[14:15], v[94:95], v[246:247]
    v_exp_f32 v8, v8
    v_exp_f32 v9, v9
    v_exp_f32 v10, v10
    v_exp_f32 v11, v11
    v_exp_f32 v12, v12
    v_exp_f32 v13, v13
    v_exp_f32 v14, v14
    v_exp_f32 v15, v15
    v_pk_add_f32 v[8:9], v[8:9], v[244:245]
    v_pk_add_f32 v[10:11], v[10:11], v[244:245]
    v_pk_add_f32 v[12:13], v[12:13], v[244:245]
    v_pk_add_f32 v[14:15], v[14:15], v[244:245]
    v_rcp_f32 v8, v8
    v_rcp_f32 v9, v9
    v_rcp_f32 v10, v10
    v_rcp_f32 v11, v11
    v_rcp_f32 v12, v12
    v_rcp_f32 v13, v13
    v_rcp_f32 v14, v14
    v_rcp_f32 v15, v15
    v_pk_mul_f32 v[88:89], v[8:9], v[88:89]
    v_pk_mul_f32 v[90:91], v[10:11], v[90:91]
    v_pk_mul_f32 v[92:93], v[12:13], v[92:93]
    v_pk_mul_f32 v[94:95], v[14:15], v[94:95]
    v_cvt_pk_bf16_f32 v16, v88, v89
    v_cvt_pk_bf16_f32 v17, v90, v91
    v_cvt_pk_bf16_f32 v18, v92, v93
    v_cvt_pk_bf16_f32 v19, v94, v95
    buffer_store_dwordx4 v[16:19], v251, s[4:7], s53 offen offset:1024 sc1
    s_add_u32 s53, s53, s22
    s_waitcnt vmcnt(7)
    v_lshlrev_b32 v28, 16, v208
    v_and_b32 v29, 0xffff0000, v208
    v_lshlrev_b32 v30, 16, v209
    v_and_b32 v31, 0xffff0000, v209
    v_lshlrev_b32 v32, 16, v210
    v_and_b32 v33, 0xffff0000, v210
    v_lshlrev_b32 v34, 16, v211
    v_and_b32 v35, 0xffff0000, v211
    v_pk_add_f32 v[96:97], v[96:97], v[28:29]
    v_pk_add_f32 v[98:99], v[98:99], v[30:31]
    v_pk_add_f32 v[100:101], v[100:101], v[32:33]
    v_pk_add_f32 v[102:103], v[102:103], v[34:35]
    v_pk_mul_f32 v[28:29], v[96:97], v[246:247]
    v_pk_mul_f32 v[30:31], v[98:99], v[246:247]
    v_pk_mul_f32 v[32:33], v[100:101], v[246:247]
    v_pk_mul_f32 v[34:35], v[102:103], v[246:247]
    v_exp_f32 v28, v28
    v_exp_f32 v29, v29
    v_exp_f32 v30, v30
    v_exp_f32 v31, v31
    v_exp_f32 v32, v32
    v_exp_f32 v33, v33
    v_exp_f32 v34, v34
    v_exp_f32 v35, v35
    v_pk_add_f32 v[28:29], v[28:29], v[244:245]
    v_pk_add_f32 v[30:31], v[30:31], v[244:245]
    v_pk_add_f32 v[32:33], v[32:33], v[244:245]
    v_pk_add_f32 v[34:35], v[34:35], v[244:245]
    v_rcp_f32 v28, v28
    v_rcp_f32 v29, v29
    v_rcp_f32 v30, v30
    v_rcp_f32 v31, v31
    v_rcp_f32 v32, v32
    v_rcp_f32 v33, v33
    v_rcp_f32 v34, v34
    v_rcp_f32 v35, v35
    v_pk_mul_f32 v[96:97], v[28:29], v[96:97]
    v_pk_mul_f32 v[98:99], v[30:31], v[98:99]
    v_pk_mul_f32 v[100:101], v[32:33], v[100:101]
    v_pk_mul_f32 v[102:103], v[34:35], v[102:103]
    v_cvt_pk_bf16_f32 v36, v96, v97
    v_cvt_pk_bf16_f32 v37, v98, v99
    v_cvt_pk_bf16_f32 v38, v100, v101
    v_cvt_pk_bf16_f32 v39, v102, v103
    buffer_store_dwordx4 v[36:39], v251, s[4:7], s53 offen offset:0 sc1
    s_waitcnt vmcnt(7)
    v_lshlrev_b32 v48, 16, v212
    v_and_b32 v49, 0xffff0000, v212
    v_lshlrev_b32 v50, 16, v213
    v_and_b32 v51, 0xffff0000, v213
    v_lshlrev_b32 v52, 16, v214
    v_and_b32 v53, 0xffff0000, v214
    v_lshlrev_b32 v54, 16, v215
    v_and_b32 v55, 0xffff0000, v215
    v_pk_add_f32 v[104:105], v[104:105], v[48:49]
    v_pk_add_f32 v[106:107], v[106:107], v[50:51]
    v_pk_add_f32 v[108:109], v[108:109], v[52:53]
    v_pk_add_f32 v[110:111], v[110:111], v[54:55]
    v_pk_mul_f32 v[48:49], v[104:105], v[246:247]
    v_pk_mul_f32 v[50:51], v[106:107], v[246:247]
    v_pk_mul_f32 v[52:53], v[108:109], v[246:247]
    v_pk_mul_f32 v[54:55], v[110:111], v[246:247]
    v_exp_f32 v48, v48
    v_exp_f32 v49, v49
    v_exp_f32 v50, v50
    v_exp_f32 v51, v51
    v_exp_f32 v52, v52
    v_exp_f32 v53, v53
    v_exp_f32 v54, v54
    v_exp_f32 v55, v55
    v_pk_add_f32 v[48:49], v[48:49], v[244:245]
    v_pk_add_f32 v[50:51], v[50:51], v[244:245]
    v_pk_add_f32 v[52:53], v[52:53], v[244:245]
    v_pk_add_f32 v[54:55], v[54:55], v[244:245]
    v_rcp_f32 v48, v48
    v_rcp_f32 v49, v49
    v_rcp_f32 v50, v50
    v_rcp_f32 v51, v51
    v_rcp_f32 v52, v52
    v_rcp_f32 v53, v53
    v_rcp_f32 v54, v54
    v_rcp_f32 v55, v55
    v_pk_mul_f32 v[104:105], v[48:49], v[104:105]
    v_pk_mul_f32 v[106:107], v[50:51], v[106:107]
    v_pk_mul_f32 v[108:109], v[52:53], v[108:109]
    v_pk_mul_f32 v[110:111], v[54:55], v[110:111]
    v_cvt_pk_bf16_f32 v56, v104, v105
    v_cvt_pk_bf16_f32 v57, v106, v107
    v_cvt_pk_bf16_f32 v58, v108, v109
    v_cvt_pk_bf16_f32 v59, v110, v111
    buffer_store_dwordx4 v[56:59], v251, s[4:7], s53 offen offset:1024 sc1
    s_add_u32 s53, s53, s22
    s_waitcnt vmcnt(7)
    v_lshlrev_b32 v8, 16, v216
    v_and_b32 v9, 0xffff0000, v216
    v_lshlrev_b32 v10, 16, v217
    v_and_b32 v11, 0xffff0000, v217
    v_lshlrev_b32 v12, 16, v218
    v_and_b32 v13, 0xffff0000, v218
    v_lshlrev_b32 v14, 16, v219
    v_and_b32 v15, 0xffff0000, v219
    v_pk_add_f32 v[112:113], v[112:113], v[8:9]
    v_pk_add_f32 v[114:115], v[114:115], v[10:11]
    v_pk_add_f32 v[116:117], v[116:117], v[12:13]
    v_pk_add_f32 v[118:119], v[118:119], v[14:15]
    v_pk_mul_f32 v[8:9], v[112:113], v[246:247]
    v_pk_mul_f32 v[10:11], v[114:115], v[246:247]
    v_pk_mul_f32 v[12:13], v[116:117], v[246:247]
    v_pk_mul_f32 v[14:15], v[118:119], v[246:247]
    v_exp_f32 v8, v8
    v_exp_f32 v9, v9
    v_exp_f32 v10, v10
    v_exp_f32 v11, v11
    v_exp_f32 v12, v12
    v_exp_f32 v13, v13
    v_exp_f32 v14, v14
    v_exp_f32 v15, v15
    v_pk_add_f32 v[8:9], v[8:9], v[244:245]
    v_pk_add_f32 v[10:11], v[10:11], v[244:245]
    v_pk_add_f32 v[12:13], v[12:13], v[244:245]
    v_pk_add_f32 v[14:15], v[14:15], v[244:245]
    v_rcp_f32 v8, v8
    v_rcp_f32 v9, v9
    v_rcp_f32 v10, v10
    v_rcp_f32 v11, v11
    v_rcp_f32 v12, v12
    v_rcp_f32 v13, v13
    v_rcp_f32 v14, v14
    v_rcp_f32 v15, v15
    v_pk_mul_f32 v[112:113], v[8:9], v[112:113]
    v_pk_mul_f32 v[114:115], v[10:11], v[114:115]
    v_pk_mul_f32 v[116:117], v[12:13], v[116:117]
    v_pk_mul_f32 v[118:119], v[14:15], v[118:119]
    v_cvt_pk_bf16_f32 v16, v112, v113
    v_cvt_pk_bf16_f32 v17, v114, v115
    v_cvt_pk_bf16_f32 v18, v116, v117
    v_cvt_pk_bf16_f32 v19, v118, v119
    buffer_store_dwordx4 v[16:19], v251, s[4:7], s53 offen offset:0 sc1
    s_waitcnt vmcnt(7)
    v_lshlrev_b32 v28, 16, v220
    v_and_b32 v29, 0xffff0000, v220
    v_lshlrev_b32 v30, 16, v221
    v_and_b32 v31, 0xffff0000, v221
    v_lshlrev_b32 v32, 16, v222
    v_and_b32 v33, 0xffff0000, v222
    v_lshlrev_b32 v34, 16, v223
    v_and_b32 v35, 0xffff0000, v223
    v_pk_add_f32 v[120:121], v[120:121], v[28:29]
    v_pk_add_f32 v[122:123], v[122:123], v[30:31]
    v_pk_add_f32 v[124:125], v[124:125], v[32:33]
    v_pk_add_f32 v[126:127], v[126:127], v[34:35]
    v_pk_mul_f32 v[28:29], v[120:121], v[246:247]
    v_pk_mul_f32 v[30:31], v[122:123], v[246:247]
    v_pk_mul_f32 v[32:33], v[124:125], v[246:247]
    v_pk_mul_f32 v[34:35], v[126:127], v[246:247]
    v_exp_f32 v28, v28
    v_exp_f32 v29, v29
    v_exp_f32 v30, v30
    v_exp_f32 v31, v31
    v_exp_f32 v32, v32
    v_exp_f32 v33, v33
    v_exp_f32 v34, v34
    v_exp_f32 v35, v35
    v_pk_add_f32 v[28:29], v[28:29], v[244:245]
    v_pk_add_f32 v[30:31], v[30:31], v[244:245]
    v_pk_add_f32 v[32:33], v[32:33], v[244:245]
    v_pk_add_f32 v[34:35], v[34:35], v[244:245]
    v_rcp_f32 v28, v28
    v_rcp_f32 v29, v29
    v_rcp_f32 v30, v30
    v_rcp_f32 v31, v31
    v_rcp_f32 v32, v32
    v_rcp_f32 v33, v33
    v_rcp_f32 v34, v34
    v_rcp_f32 v35, v35
    v_pk_mul_f32 v[120:121], v[28:29], v[120:121]
    v_pk_mul_f32 v[122:123], v[30:31], v[122:123]
    v_pk_mul_f32 v[124:125], v[32:33], v[124:125]
    v_pk_mul_f32 v[126:127], v[34:35], v[126:127]
    v_cvt_pk_bf16_f32 v36, v120, v121
    v_cvt_pk_bf16_f32 v37, v122, v123
    v_cvt_pk_bf16_f32 v38, v124, v125
    v_cvt_pk_bf16_f32 v39, v126, v127
    buffer_store_dwordx4 v[36:39], v251, s[4:7], s53 offen offset:1024 sc1
    s_branch main_kernel_w_done
main_kernel_w_c0_efin:
    s_mov_b32 s53, s21
    s_add_u32 s32, s21, 0
    buffer_load_dwordx4 v[160:163], v252, s[96:99], s32 offen offset:0
    buffer_load_dwordx4 v[164:167], v252, s[96:99], s32 offen offset:64
    s_add_u32 s32, s21, 32768
    buffer_load_dwordx4 v[168:171], v252, s[96:99], s32 offen offset:0
    buffer_load_dwordx4 v[172:175], v252, s[96:99], s32 offen offset:64
    s_add_u32 s32, s21, 65536
    buffer_load_dwordx4 v[176:179], v252, s[96:99], s32 offen offset:0
    buffer_load_dwordx4 v[180:183], v252, s[96:99], s32 offen offset:64
    s_add_u32 s32, s21, 98304
    buffer_load_dwordx4 v[184:187], v252, s[96:99], s32 offen offset:0
    buffer_load_dwordx4 v[188:191], v252, s[96:99], s32 offen offset:64
    s_waitcnt vmcnt(7)
    v_permlane16_swap_b32 v160, v162
    v_permlane16_swap_b32 v161, v163
    v_lshlrev_b32 v8, 16, v192
    v_and_b32 v9, 0xffff0000, v192
    v_lshlrev_b32 v10, 16, v193
    v_and_b32 v11, 0xffff0000, v193
    v_lshlrev_b32 v12, 16, v194
    v_and_b32 v13, 0xffff0000, v194
    v_lshlrev_b32 v14, 16, v195
    v_and_b32 v15, 0xffff0000, v195
    v_permlane32_swap_b32 v160, v162
    v_permlane32_swap_b32 v161, v163
    v_lshlrev_b32 v16, 16, v160
    v_and_b32 v17, 0xffff0000, v160
    v_lshlrev_b32 v18, 16, v161
    v_and_b32 v19, 0xffff0000, v161
    v_lshlrev_b32 v20, 16, v162
    v_and_b32 v21, 0xffff0000, v162
    v_lshlrev_b32 v22, 16, v163
    v_and_b32 v23, 0xffff0000, v163
    v_pk_fma_f32 v[8:9], v[64:65], v[8:9], v[16:17]
    v_pk_fma_f32 v[10:11], v[66:67], v[10:11], v[18:19]
    v_pk_fma_f32 v[12:13], v[68:69], v[12:13], v[20:21]
    v_pk_fma_f32 v[14:15], v[70:71], v[14:15], v[22:23]
    v_cvt_pk_bf16_f32 v24, v8, v9
    v_cvt_pk_bf16_f32 v25, v10, v11
    v_cvt_pk_bf16_f32 v26, v12, v13
    v_cvt_pk_bf16_f32 v27, v14, v15
    s_nop 0
    v_permlane32_swap_b32 v24, v26
    v_permlane32_swap_b32 v25, v27
    s_nop 0
    v_permlane16_swap_b32 v24, v26
    v_permlane16_swap_b32 v25, v27
    buffer_store_dwordx4 v[24:27], v252, s[92:95], s53 offen offset:0 sc1
    s_waitcnt vmcnt(7)
    v_permlane16_swap_b32 v164, v166
    v_permlane16_swap_b32 v165, v167
    v_lshlrev_b32 v36, 16, v196
    v_and_b32 v37, 0xffff0000, v196
    v_lshlrev_b32 v38, 16, v197
    v_and_b32 v39, 0xffff0000, v197
    v_lshlrev_b32 v40, 16, v198
    v_and_b32 v41, 0xffff0000, v198
    v_lshlrev_b32 v42, 16, v199
    v_and_b32 v43, 0xffff0000, v199
    v_permlane32_swap_b32 v164, v166
    v_permlane32_swap_b32 v165, v167
    v_lshlrev_b32 v44, 16, v164
    v_and_b32 v45, 0xffff0000, v164
    v_lshlrev_b32 v46, 16, v165
    v_and_b32 v47, 0xffff0000, v165
    v_lshlrev_b32 v48, 16, v166
    v_and_b32 v49, 0xffff0000, v166
    v_lshlrev_b32 v50, 16, v167
    v_and_b32 v51, 0xffff0000, v167
    v_pk_fma_f32 v[36:37], v[72:73], v[36:37], v[44:45]
    v_pk_fma_f32 v[38:39], v[74:75], v[38:39], v[46:47]
    v_pk_fma_f32 v[40:41], v[76:77], v[40:41], v[48:49]
    v_pk_fma_f32 v[42:43], v[78:79], v[42:43], v[50:51]
    v_cvt_pk_bf16_f32 v52, v36, v37
    v_cvt_pk_bf16_f32 v53, v38, v39
    v_cvt_pk_bf16_f32 v54, v40, v41
    v_cvt_pk_bf16_f32 v55, v42, v43
    s_nop 0
    v_permlane32_swap_b32 v52, v54
    v_permlane32_swap_b32 v53, v55
    s_nop 0
    v_permlane16_swap_b32 v52, v54
    v_permlane16_swap_b32 v53, v55
    buffer_store_dwordx4 v[52:55], v252, s[92:95], s53 offen offset:64 sc1
    s_add_u32 s53, s53, 32768
    s_waitcnt vmcnt(7)
    v_permlane16_swap_b32 v168, v170
    v_permlane16_swap_b32 v169, v171
    v_lshlrev_b32 v8, 16, v200
    v_and_b32 v9, 0xffff0000, v200
    v_lshlrev_b32 v10, 16, v201
    v_and_b32 v11, 0xffff0000, v201
    v_lshlrev_b32 v12, 16, v202
    v_and_b32 v13, 0xffff0000, v202
    v_lshlrev_b32 v14, 16, v203
    v_and_b32 v15, 0xffff0000, v203
    v_permlane32_swap_b32 v168, v170
    v_permlane32_swap_b32 v169, v171
    v_lshlrev_b32 v16, 16, v168
    v_and_b32 v17, 0xffff0000, v168
    v_lshlrev_b32 v18, 16, v169
    v_and_b32 v19, 0xffff0000, v169
    v_lshlrev_b32 v20, 16, v170
    v_and_b32 v21, 0xffff0000, v170
    v_lshlrev_b32 v22, 16, v171
    v_and_b32 v23, 0xffff0000, v171
    v_pk_fma_f32 v[8:9], v[80:81], v[8:9], v[16:17]
    v_pk_fma_f32 v[10:11], v[82:83], v[10:11], v[18:19]
    v_pk_fma_f32 v[12:13], v[84:85], v[12:13], v[20:21]
    v_pk_fma_f32 v[14:15], v[86:87], v[14:15], v[22:23]
    v_cvt_pk_bf16_f32 v24, v8, v9
    v_cvt_pk_bf16_f32 v25, v10, v11
    v_cvt_pk_bf16_f32 v26, v12, v13
    v_cvt_pk_bf16_f32 v27, v14, v15
    s_nop 0
    v_permlane32_swap_b32 v24, v26
    v_permlane32_swap_b32 v25, v27
    s_nop 0
    v_permlane16_swap_b32 v24, v26
    v_permlane16_swap_b32 v25, v27
    buffer_store_dwordx4 v[24:27], v252, s[92:95], s53 offen offset:0 sc1
    s_waitcnt vmcnt(7)
    v_permlane16_swap_b32 v172, v174
    v_permlane16_swap_b32 v173, v175
    v_lshlrev_b32 v36, 16, v204
    v_and_b32 v37, 0xffff0000, v204
    v_lshlrev_b32 v38, 16, v205
    v_and_b32 v39, 0xffff0000, v205
    v_lshlrev_b32 v40, 16, v206
    v_and_b32 v41, 0xffff0000, v206
    v_lshlrev_b32 v42, 16, v207
    v_and_b32 v43, 0xffff0000, v207
    v_permlane32_swap_b32 v172, v174
    v_permlane32_swap_b32 v173, v175
    v_lshlrev_b32 v44, 16, v172
    v_and_b32 v45, 0xffff0000, v172
    v_lshlrev_b32 v46, 16, v173
    v_and_b32 v47, 0xffff0000, v173
    v_lshlrev_b32 v48, 16, v174
    v_and_b32 v49, 0xffff0000, v174
    v_lshlrev_b32 v50, 16, v175
    v_and_b32 v51, 0xffff0000, v175
    v_pk_fma_f32 v[36:37], v[88:89], v[36:37], v[44:45]
    v_pk_fma_f32 v[38:39], v[90:91], v[38:39], v[46:47]
    v_pk_fma_f32 v[40:41], v[92:93], v[40:41], v[48:49]
    v_pk_fma_f32 v[42:43], v[94:95], v[42:43], v[50:51]
    v_cvt_pk_bf16_f32 v52, v36, v37
    v_cvt_pk_bf16_f32 v53, v38, v39
    v_cvt_pk_bf16_f32 v54, v40, v41
    v_cvt_pk_bf16_f32 v55, v42, v43
    s_nop 0
    v_permlane32_swap_b32 v52, v54
    v_permlane32_swap_b32 v53, v55
    s_nop 0
    v_permlane16_swap_b32 v52, v54
    v_permlane16_swap_b32 v53, v55
    buffer_store_dwordx4 v[52:55], v252, s[92:95], s53 offen offset:64 sc1
    s_add_u32 s53, s53, 32768
    s_waitcnt vmcnt(7)
    v_permlane16_swap_b32 v176, v178
    v_permlane16_swap_b32 v177, v179
    v_lshlrev_b32 v8, 16, v208
    v_and_b32 v9, 0xffff0000, v208
    v_lshlrev_b32 v10, 16, v209
    v_and_b32 v11, 0xffff0000, v209
    v_lshlrev_b32 v12, 16, v210
    v_and_b32 v13, 0xffff0000, v210
    v_lshlrev_b32 v14, 16, v211
    v_and_b32 v15, 0xffff0000, v211
    v_permlane32_swap_b32 v176, v178
    v_permlane32_swap_b32 v177, v179
    v_lshlrev_b32 v16, 16, v176
    v_and_b32 v17, 0xffff0000, v176
    v_lshlrev_b32 v18, 16, v177
    v_and_b32 v19, 0xffff0000, v177
    v_lshlrev_b32 v20, 16, v178
    v_and_b32 v21, 0xffff0000, v178
    v_lshlrev_b32 v22, 16, v179
    v_and_b32 v23, 0xffff0000, v179
    v_pk_fma_f32 v[8:9], v[96:97], v[8:9], v[16:17]
    v_pk_fma_f32 v[10:11], v[98:99], v[10:11], v[18:19]
    v_pk_fma_f32 v[12:13], v[100:101], v[12:13], v[20:21]
    v_pk_fma_f32 v[14:15], v[102:103], v[14:15], v[22:23]
    v_cvt_pk_bf16_f32 v24, v8, v9
    v_cvt_pk_bf16_f32 v25, v10, v11
    v_cvt_pk_bf16_f32 v26, v12, v13
    v_cvt_pk_bf16_f32 v27, v14, v15
    s_nop 0
    v_permlane32_swap_b32 v24, v26
    v_permlane32_swap_b32 v25, v27
    s_nop 0
    v_permlane16_swap_b32 v24, v26
    v_permlane16_swap_b32 v25, v27
    buffer_store_dwordx4 v[24:27], v252, s[92:95], s53 offen offset:0 sc1
    s_waitcnt vmcnt(7)
    v_permlane16_swap_b32 v180, v182
    v_permlane16_swap_b32 v181, v183
    v_lshlrev_b32 v36, 16, v212
    v_and_b32 v37, 0xffff0000, v212
    v_lshlrev_b32 v38, 16, v213
    v_and_b32 v39, 0xffff0000, v213
    v_lshlrev_b32 v40, 16, v214
    v_and_b32 v41, 0xffff0000, v214
    v_lshlrev_b32 v42, 16, v215
    v_and_b32 v43, 0xffff0000, v215
    v_permlane32_swap_b32 v180, v182
    v_permlane32_swap_b32 v181, v183
    v_lshlrev_b32 v44, 16, v180
    v_and_b32 v45, 0xffff0000, v180
    v_lshlrev_b32 v46, 16, v181
    v_and_b32 v47, 0xffff0000, v181
    v_lshlrev_b32 v48, 16, v182
    v_and_b32 v49, 0xffff0000, v182
    v_lshlrev_b32 v50, 16, v183
    v_and_b32 v51, 0xffff0000, v183
    v_pk_fma_f32 v[36:37], v[104:105], v[36:37], v[44:45]
    v_pk_fma_f32 v[38:39], v[106:107], v[38:39], v[46:47]
    v_pk_fma_f32 v[40:41], v[108:109], v[40:41], v[48:49]
    v_pk_fma_f32 v[42:43], v[110:111], v[42:43], v[50:51]
    v_cvt_pk_bf16_f32 v52, v36, v37
    v_cvt_pk_bf16_f32 v53, v38, v39
    v_cvt_pk_bf16_f32 v54, v40, v41
    v_cvt_pk_bf16_f32 v55, v42, v43
    s_nop 0
    v_permlane32_swap_b32 v52, v54
    v_permlane32_swap_b32 v53, v55
    s_nop 0
    v_permlane16_swap_b32 v52, v54
    v_permlane16_swap_b32 v53, v55
    buffer_store_dwordx4 v[52:55], v252, s[92:95], s53 offen offset:64 sc1
    s_add_u32 s53, s53, 32768
    s_waitcnt vmcnt(7)
    v_permlane16_swap_b32 v184, v186
    v_permlane16_swap_b32 v185, v187
    v_lshlrev_b32 v8, 16, v216
    v_and_b32 v9, 0xffff0000, v216
    v_lshlrev_b32 v10, 16, v217
    v_and_b32 v11, 0xffff0000, v217
    v_lshlrev_b32 v12, 16, v218
    v_and_b32 v13, 0xffff0000, v218
    v_lshlrev_b32 v14, 16, v219
    v_and_b32 v15, 0xffff0000, v219
    v_permlane32_swap_b32 v184, v186
    v_permlane32_swap_b32 v185, v187
    v_lshlrev_b32 v16, 16, v184
    v_and_b32 v17, 0xffff0000, v184
    v_lshlrev_b32 v18, 16, v185
    v_and_b32 v19, 0xffff0000, v185
    v_lshlrev_b32 v20, 16, v186
    v_and_b32 v21, 0xffff0000, v186
    v_lshlrev_b32 v22, 16, v187
    v_and_b32 v23, 0xffff0000, v187
    v_pk_fma_f32 v[8:9], v[112:113], v[8:9], v[16:17]
    v_pk_fma_f32 v[10:11], v[114:115], v[10:11], v[18:19]
    v_pk_fma_f32 v[12:13], v[116:117], v[12:13], v[20:21]
    v_pk_fma_f32 v[14:15], v[118:119], v[14:15], v[22:23]
    v_cvt_pk_bf16_f32 v24, v8, v9
    v_cvt_pk_bf16_f32 v25, v10, v11
    v_cvt_pk_bf16_f32 v26, v12, v13
    v_cvt_pk_bf16_f32 v27, v14, v15
    s_nop 0
    v_permlane32_swap_b32 v24, v26
    v_permlane32_swap_b32 v25, v27
    s_nop 0
    v_permlane16_swap_b32 v24, v26
    v_permlane16_swap_b32 v25, v27
    buffer_store_dwordx4 v[24:27], v252, s[92:95], s53 offen offset:0 sc1
    s_waitcnt vmcnt(7)
    v_permlane16_swap_b32 v188, v190
    v_permlane16_swap_b32 v189, v191
    v_lshlrev_b32 v36, 16, v220
    v_and_b32 v37, 0xffff0000, v220
    v_lshlrev_b32 v38, 16, v221
    v_and_b32 v39, 0xffff0000, v221
    v_lshlrev_b32 v40, 16, v222
    v_and_b32 v41, 0xffff0000, v222
    v_lshlrev_b32 v42, 16, v223
    v_and_b32 v43, 0xffff0000, v223
    v_permlane32_swap_b32 v188, v190
    v_permlane32_swap_b32 v189, v191
    v_lshlrev_b32 v44, 16, v188
    v_and_b32 v45, 0xffff0000, v188
    v_lshlrev_b32 v46, 16, v189
    v_and_b32 v47, 0xffff0000, v189
    v_lshlrev_b32 v48, 16, v190
    v_and_b32 v49, 0xffff0000, v190
    v_lshlrev_b32 v50, 16, v191
    v_and_b32 v51, 0xffff0000, v191
    v_pk_fma_f32 v[36:37], v[120:121], v[36:37], v[44:45]
    v_pk_fma_f32 v[38:39], v[122:123], v[38:39], v[46:47]
    v_pk_fma_f32 v[40:41], v[124:125], v[40:41], v[48:49]
    v_pk_fma_f32 v[42:43], v[126:127], v[42:43], v[50:51]
    v_cvt_pk_bf16_f32 v52, v36, v37
    v_cvt_pk_bf16_f32 v53, v38, v39
    v_cvt_pk_bf16_f32 v54, v40, v41
    v_cvt_pk_bf16_f32 v55, v42, v43
    s_nop 0
    v_permlane32_swap_b32 v52, v54
    v_permlane32_swap_b32 v53, v55
    s_nop 0
    v_permlane16_swap_b32 v52, v54
    v_permlane16_swap_b32 v53, v55
    buffer_store_dwordx4 v[52:55], v252, s[92:95], s53 offen offset:64 sc1
    s_branch main_kernel_w_done
main_kernel_w_c0_gov:
    v_lshrrev_b32 v0, 4, v250
    v_bfe_u32 v1, v250, 2, 2
    v_lshl_add_u32 v4, v0, 2, v1
    v_and_b32 v5, 7, v4
    v_mul_u32_u24 v4, 256, v4
    v_and_b32 v6, 3, v250
    v_lshl_add_u32 v4, v6, 3, v4
    s_mul_i32 s32, s37, 4
    v_xor_b32 v5, s32, v5
    v_lshl_add_u32 v128, v5, 5, v4
    v_xor_b32 v129, 32, v128
    v_xor_b32 v130, 64, v128
    v_xor_b32 v131, 96, v128
    s_mul_i32 s32, s38, 8192
    s_add_u32 s32, s32, 65536
    v_add_u32 v136, s32, v251
    v_lshrrev_b32 v2, 4, v250
    v_and_b32 v3, 15, v250
    s_mul_i32 s32, s14, 16
    v_add_u32 v4, s32, v2
    v_add_u32 v5, 0, v4
    v_and_b32 v6, 7, v5
    v_lshlrev_b32 v6, 1, v6
    v_xor_b32 v6, v6, v3
    v_mul_lo_u32 v5, v5, s30
    v_lshl_add_u32 v5, v6, 4, v5
    v_subrev_u32 v137, 0, v5
    v_add_u32 v5, 4, v4
    v_and_b32 v6, 7, v5
    v_lshlrev_b32 v6, 1, v6
    v_xor_b32 v6, v6, v3
    v_mul_lo_u32 v5, v5, s30
    v_lshl_add_u32 v5, v6, 4, v5
    v_subrev_u32 v138, 1024, v5
    v_add_u32 v5, 8, v4
    v_and_b32 v6, 7, v5
    v_lshlrev_b32 v6, 1, v6
    v_xor_b32 v6, v6, v3
    v_mul_lo_u32 v5, v5, s30
    v_lshl_add_u32 v5, v6, 4, v5
    v_subrev_u32 v139, 2048, v5
    v_add_u32 v5, 12, v4
    v_and_b32 v6, 7, v5
    v_lshlrev_b32 v6, 1, v6
    v_xor_b32 v6, v6, v3
    v_mul_lo_u32 v5, v5, s30
    v_lshl_add_u32 v5, v6, 4, v5
    v_subrev_u32 v140, 3072, v5
    s_mul_i32 s32, s14, 2
    s_mul_i32 s32, s32, s31
    v_add_u32 v141, s32, v251
    s_add_u32 s32, s32, s31
    s_sub_u32 s32, s32, 2048
    v_add_u32 v142, s32, v251
    s_mul_i32 s19, s14, 4096
    s_mul_i32 s20, s14, 4096
    s_add_u32 s20, s20, 65536
    s_mul_i32 s17, s30, 64
    s_mov_b32 s15, 0
    s_add_u32 m0, s20, 0
    s_nop 0
    buffer_load_dwordx4 v141, s[4:7], s16 offen offset:0 sc1 lds
    buffer_load_dwordx4 v141, s[4:7], s16 offen offset:1024 sc1 lds
    buffer_load_dwordx4 v142, s[4:7], s16 offen offset:2048 sc1 lds
    buffer_load_dwordx4 v142, s[4:7], s16 offen offset:3072 sc1 lds
    s_add_u32 s16, s16, 2048
    s_add_u32 m0, s19, 0
    s_nop 0
    buffer_load_dwordx4 v137, s[8:11], s15 offen offset:0 lds
    buffer_load_dwordx4 v138, s[8:11], s15 offen offset:1024 lds
    buffer_load_dwordx4 v139, s[8:11], s15 offen offset:2048 lds
    buffer_load_dwordx4 v140, s[8:11], s15 offen offset:3072 lds
    s_add_u32 s15, s15, s17
    s_add_u32 m0, s20, 16384
    s_nop 0
    buffer_load_dwordx4 v141, s[4:7], s16 offen offset:0 sc1 lds
    buffer_load_dwordx4 v141, s[4:7], s16 offen offset:1024 sc1 lds
    buffer_load_dwordx4 v142, s[4:7], s16 offen offset:2048 sc1 lds
    buffer_load_dwordx4 v142, s[4:7], s16 offen offset:3072 sc1 lds
    s_add_u32 s16, s16, 2048
    s_add_u32 m0, s19, 16384
    s_nop 0
    buffer_load_dwordx4 v137, s[8:11], s15 offen offset:0 lds
    buffer_load_dwordx4 v138, s[8:11], s15 offen offset:1024 lds
    buffer_load_dwordx4 v139, s[8:11], s15 offen offset:2048 lds
    buffer_load_dwordx4 v140, s[8:11], s15 offen offset:3072 lds
    s_add_u32 s15, s15, s17
    s_add_u32 m0, s20, 32768
    s_nop 0
    buffer_load_dwordx4 v141, s[4:7], s16 offen offset:0 sc1 lds
    buffer_load_dwordx4 v141, s[4:7], s16 offen offset:1024 sc1 lds
    buffer_load_dwordx4 v142, s[4:7], s16 offen offset:2048 sc1 lds
    buffer_load_dwordx4 v142, s[4:7], s16 offen offset:3072 sc1 lds
    s_add_u32 s16, s16, 2048
    s_add_u32 m0, s19, 32768
    s_nop 0
    buffer_load_dwordx4 v137, s[8:11], s15 offen offset:0 lds
    buffer_load_dwordx4 v138, s[8:11], s15 offen offset:1024 lds
    buffer_load_dwordx4 v139, s[8:11], s15 offen offset:2048 lds
    buffer_load_dwordx4 v140, s[8:11], s15 offen offset:3072 lds
    s_add_u32 s15, s15, s17
    s_add_u32 m0, s20, 49152
    s_nop 0
    buffer_load_dwordx4 v141, s[4:7], s16 offen offset:0 sc1 lds
    buffer_load_dwordx4 v141, s[4:7], s16 offen offset:1024 sc1 lds
    buffer_load_dwordx4 v142, s[4:7], s16 offen offset:2048 sc1 lds
    buffer_load_dwordx4 v142, s[4:7], s16 offen offset:3072 sc1 lds
    s_add_u32 s16, s16, 2048
    v_mov_b32 v64, 0
    v_mov_b32 v65, 0
    v_mov_b32 v66, 0
    v_mov_b32 v67, 0
    v_mov_b32 v68, 0
    v_mov_b32 v69, 0
    v_mov_b32 v70, 0
    v_mov_b32 v71, 0
    v_mov_b32 v72, 0
    v_mov_b32 v73, 0
    v_mov_b32 v74, 0
    v_mov_b32 v75, 0
    v_mov_b32 v76, 0
    v_mov_b32 v77, 0
    v_mov_b32 v78, 0
    v_mov_b32 v79, 0
    v_mov_b32 v80, 0
    v_mov_b32 v81, 0
    v_mov_b32 v82, 0
    v_mov_b32 v83, 0
    v_mov_b32 v84, 0
    v_mov_b32 v85, 0
    v_mov_b32 v86, 0
    v_mov_b32 v87, 0
    v_mov_b32 v88, 0
    v_mov_b32 v89, 0
    v_mov_b32 v90, 0
    v_mov_b32 v91, 0
    v_mov_b32 v92, 0
    v_mov_b32 v93, 0
    v_mov_b32 v94, 0
    v_mov_b32 v95, 0
    v_mov_b32 v96, 0
    v_mov_b32 v97, 0
    v_mov_b32 v98, 0
    v_mov_b32 v99, 0
    v_mov_b32 v100, 0
    v_mov_b32 v101, 0
    v_mov_b32 v102, 0
    v_mov_b32 v103, 0
    v_mov_b32 v104, 0
    v_mov_b32 v105, 0
    v_mov_b32 v106, 0
    v_mov_b32 v107, 0
    v_mov_b32 v108, 0
    v_mov_b32 v109, 0
    v_mov_b32 v110, 0
    v_mov_b32 v111, 0
    v_mov_b32 v112, 0
    v_mov_b32 v113, 0
    v_mov_b32 v114, 0
    v_mov_b32 v115, 0
    v_mov_b32 v116, 0
    v_mov_b32 v117, 0
    v_mov_b32 v118, 0
    v_mov_b32 v119, 0
    v_mov_b32 v120, 0
    v_mov_b32 v121, 0
    v_mov_b32 v122, 0
    v_mov_b32 v123, 0
    v_mov_b32 v124, 0
    v_mov_b32 v125, 0
    v_mov_b32 v126, 0
    v_mov_b32 v127, 0
    s_waitcnt vmcnt(20)
    s_barrier
    ds_read_b128 v[16:19], v136 offset:0
    ds_read_b64_tr_b16 v[0:1], v128 offset:0
    ds_read_b64_tr_b16 v[2:3], v128 offset:4096
    ds_read_b64_tr_b16 v[4:5], v129 offset:0
    ds_read_b64_tr_b16 v[6:7], v129 offset:4096
    ds_read_b64_tr_b16 v[8:9], v130 offset:0
    ds_read_b64_tr_b16 v[10:11], v130 offset:4096
    ds_read_b64_tr_b16 v[12:13], v131 offset:0
    ds_read_b64_tr_b16 v[14:15], v131 offset:4096
    ds_read_b128 v[20:23], v136 offset:2048
    ds_read_b128 v[24:27], v136 offset:4096
    ds_read_b128 v[28:31], v136 offset:6144
main_kernel_w_c0_v_loop:
    s_waitcnt lgkmcnt(0)
    ds_read_b128 v[48:51], v136 offset:1024
    s_add_u32 m0, s19, 49152
    s_nop 0
    v_mfma_f32_16x16x32_bf16 v[64:67], v[16:19], v[0:3], v[64:67]
    ds_read_b64_tr_b16 v[32:33], v128 offset:8192
    v_mfma_f32_16x16x32_bf16 v[68:71], v[16:19], v[4:7], v[68:71]
    ds_read_b64_tr_b16 v[34:35], v128 offset:12288
    buffer_load_dwordx4 v137, s[8:11], s15 offen offset:0 lds
    v_mfma_f32_16x16x32_bf16 v[72:75], v[16:19], v[8:11], v[72:75]
    ds_read_b64_tr_b16 v[36:37], v129 offset:8192
    v_mfma_f32_16x16x32_bf16 v[76:79], v[16:19], v[12:15], v[76:79]
    ds_read_b64_tr_b16 v[38:39], v129 offset:12288
    v_mfma_f32_16x16x32_bf16 v[80:83], v[20:23], v[0:3], v[80:83]
    ds_read_b64_tr_b16 v[40:41], v130 offset:8192
    buffer_load_dwordx4 v138, s[8:11], s15 offen offset:1024 lds
    v_mfma_f32_16x16x32_bf16 v[84:87], v[20:23], v[4:7], v[84:87]
    ds_read_b64_tr_b16 v[42:43], v130 offset:12288
    v_mfma_f32_16x16x32_bf16 v[88:91], v[20:23], v[8:11], v[88:91]
    ds_read_b64_tr_b16 v[44:45], v131 offset:8192
    v_mfma_f32_16x16x32_bf16 v[92:95], v[20:23], v[12:15], v[92:95]
    ds_read_b64_tr_b16 v[46:47], v131 offset:12288
    buffer_load_dwordx4 v139, s[8:11], s15 offen offset:2048 lds
    v_mfma_f32_16x16x32_bf16 v[96:99], v[24:27], v[0:3], v[96:99]
    ds_read_b128 v[52:55], v136 offset:3072
    v_mfma_f32_16x16x32_bf16 v[100:103], v[24:27], v[4:7], v[100:103]
    ds_read_b128 v[56:59], v136 offset:5120
    buffer_load_dwordx4 v140, s[8:11], s15 offen offset:3072 lds
    v_mfma_f32_16x16x32_bf16 v[104:107], v[24:27], v[8:11], v[104:107]
    ds_read_b128 v[60:63], v136 offset:7168
    v_mfma_f32_16x16x32_bf16 v[108:111], v[24:27], v[12:15], v[108:111]
    v_mfma_f32_16x16x32_bf16 v[112:115], v[28:31], v[0:3], v[112:115]
    s_add_u32 s15, s15, s17
    v_mfma_f32_16x16x32_bf16 v[116:119], v[28:31], v[4:7], v[116:119]
    v_mfma_f32_16x16x32_bf16 v[120:123], v[28:31], v[8:11], v[120:123]
    v_mfma_f32_16x16x32_bf16 v[124:127], v[28:31], v[12:15], v[124:127]
    s_waitcnt lgkmcnt(0)
    v_mfma_f32_16x16x32_bf16 v[64:67], v[48:51], v[32:35], v[64:67]
    s_waitcnt vmcnt(16)
    s_barrier
    ds_read_b128 v[16:19], v136 offset:16384
    s_add_u32 m0, s20, 0
    s_nop 0
    v_mfma_f32_16x16x32_bf16 v[68:71], v[48:51], v[36:39], v[68:71]
    ds_read_b64_tr_b16 v[0:1], v128 offset:16384
    v_mfma_f32_16x16x32_bf16 v[72:75], v[48:51], v[40:43], v[72:75]
    ds_read_b64_tr_b16 v[2:3], v128 offset:20480
    buffer_load_dwordx4 v141, s[4:7], s16 offen offset:0 sc1 lds
    v_mfma_f32_16x16x32_bf16 v[76:79], v[48:51], v[44:47], v[76:79]
    ds_read_b64_tr_b16 v[4:5], v129 offset:16384
    v_mfma_f32_16x16x32_bf16 v[80:83], v[52:55], v[32:35], v[80:83]
    ds_read_b64_tr_b16 v[6:7], v129 offset:20480
    v_mfma_f32_16x16x32_bf16 v[84:87], v[52:55], v[36:39], v[84:87]
    ds_read_b64_tr_b16 v[8:9], v130 offset:16384
    buffer_load_dwordx4 v141, s[4:7], s16 offen offset:1024 sc1 lds
    v_mfma_f32_16x16x32_bf16 v[88:91], v[52:55], v[40:43], v[88:91]
    ds_read_b64_tr_b16 v[10:11], v130 offset:20480
    v_mfma_f32_16x16x32_bf16 v[92:95], v[52:55], v[44:47], v[92:95]
    ds_read_b64_tr_b16 v[12:13], v131 offset:16384
    buffer_load_dwordx4 v142, s[4:7], s16 offen offset:2048 sc1 lds
    v_mfma_f32_16x16x32_bf16 v[96:99], v[56:59], v[32:35], v[96:99]
    ds_read_b64_tr_b16 v[14:15], v131 offset:20480
    v_mfma_f32_16x16x32_bf16 v[100:103], v[56:59], v[36:39], v[100:103]
    ds_read_b128 v[20:23], v136 offset:18432
    v_mfma_f32_16x16x32_bf16 v[104:107], v[56:59], v[40:43], v[104:107]
    ds_read_b128 v[24:27], v136 offset:20480
    buffer_load_dwordx4 v142, s[4:7], s16 offen offset:3072 sc1 lds
    v_mfma_f32_16x16x32_bf16 v[108:111], v[56:59], v[44:47], v[108:111]
    ds_read_b128 v[28:31], v136 offset:22528
    v_mfma_f32_16x16x32_bf16 v[112:115], v[60:63], v[32:35], v[112:115]
    s_add_u32 s16, s16, 2048
    v_mfma_f32_16x16x32_bf16 v[116:119], v[60:63], v[36:39], v[116:119]
    v_mfma_f32_16x16x32_bf16 v[120:123], v[60:63], v[40:43], v[120:123]
    v_mfma_f32_16x16x32_bf16 v[124:127], v[60:63], v[44:47], v[124:127]
    s_waitcnt lgkmcnt(0)
    ds_read_b128 v[48:51], v136 offset:17408
    s_add_u32 m0, s19, 0
    s_nop 0
    v_mfma_f32_16x16x32_bf16 v[64:67], v[16:19], v[0:3], v[64:67]
    ds_read_b64_tr_b16 v[32:33], v128 offset:24576
    v_mfma_f32_16x16x32_bf16 v[68:71], v[16:19], v[4:7], v[68:71]
    ds_read_b64_tr_b16 v[34:35], v128 offset:28672
    buffer_load_dwordx4 v137, s[8:11], s15 offen offset:0 lds
    v_mfma_f32_16x16x32_bf16 v[72:75], v[16:19], v[8:11], v[72:75]
    ds_read_b64_tr_b16 v[36:37], v129 offset:24576
    v_mfma_f32_16x16x32_bf16 v[76:79], v[16:19], v[12:15], v[76:79]
    ds_read_b64_tr_b16 v[38:39], v129 offset:28672
    v_mfma_f32_16x16x32_bf16 v[80:83], v[20:23], v[0:3], v[80:83]
    ds_read_b64_tr_b16 v[40:41], v130 offset:24576
    buffer_load_dwordx4 v138, s[8:11], s15 offen offset:1024 lds
    v_mfma_f32_16x16x32_bf16 v[84:87], v[20:23], v[4:7], v[84:87]
    ds_read_b64_tr_b16 v[42:43], v130 offset:28672
    v_mfma_f32_16x16x32_bf16 v[88:91], v[20:23], v[8:11], v[88:91]
    ds_read_b64_tr_b16 v[44:45], v131 offset:24576
    v_mfma_f32_16x16x32_bf16 v[92:95], v[20:23], v[12:15], v[92:95]
    ds_read_b64_tr_b16 v[46:47], v131 offset:28672
    buffer_load_dwordx4 v139, s[8:11], s15 offen offset:2048 lds
    v_mfma_f32_16x16x32_bf16 v[96:99], v[24:27], v[0:3], v[96:99]
    ds_read_b128 v[52:55], v136 offset:19456
    v_mfma_f32_16x16x32_bf16 v[100:103], v[24:27], v[4:7], v[100:103]
    ds_read_b128 v[56:59], v136 offset:21504
    buffer_load_dwordx4 v140, s[8:11], s15 offen offset:3072 lds
    v_mfma_f32_16x16x32_bf16 v[104:107], v[24:27], v[8:11], v[104:107]
    ds_read_b128 v[60:63], v136 offset:23552
    v_mfma_f32_16x16x32_bf16 v[108:111], v[24:27], v[12:15], v[108:111]
    v_mfma_f32_16x16x32_bf16 v[112:115], v[28:31], v[0:3], v[112:115]
    s_add_u32 s15, s15, s17
    v_mfma_f32_16x16x32_bf16 v[116:119], v[28:31], v[4:7], v[116:119]
    v_mfma_f32_16x16x32_bf16 v[120:123], v[28:31], v[8:11], v[120:123]
    v_mfma_f32_16x16x32_bf16 v[124:127], v[28:31], v[12:15], v[124:127]
    s_waitcnt lgkmcnt(0)
    v_mfma_f32_16x16x32_bf16 v[64:67], v[48:51], v[32:35], v[64:67]
    s_waitcnt vmcnt(16)
    s_barrier
    ds_read_b128 v[16:19], v136 offset:32768
    s_add_u32 m0, s20, 16384
    s_nop 0
    v_mfma_f32_16x16x32_bf16 v[68:71], v[48:51], v[36:39], v[68:71]
    ds_read_b64_tr_b16 v[0:1], v128 offset:32768
    v_mfma_f32_16x16x32_bf16 v[72:75], v[48:51], v[40:43], v[72:75]
    ds_read_b64_tr_b16 v[2:3], v128 offset:36864
    buffer_load_dwordx4 v141, s[4:7], s16 offen offset:0 sc1 lds
    v_mfma_f32_16x16x32_bf16 v[76:79], v[48:51], v[44:47], v[76:79]
    ds_read_b64_tr_b16 v[4:5], v129 offset:32768
    v_mfma_f32_16x16x32_bf16 v[80:83], v[52:55], v[32:35], v[80:83]
    ds_read_b64_tr_b16 v[6:7], v129 offset:36864
    v_mfma_f32_16x16x32_bf16 v[84:87], v[52:55], v[36:39], v[84:87]
    ds_read_b64_tr_b16 v[8:9], v130 offset:32768
    buffer_load_dwordx4 v141, s[4:7], s16 offen offset:1024 sc1 lds
    v_mfma_f32_16x16x32_bf16 v[88:91], v[52:55], v[40:43], v[88:91]
    ds_read_b64_tr_b16 v[10:11], v130 offset:36864
    v_mfma_f32_16x16x32_bf16 v[92:95], v[52:55], v[44:47], v[92:95]
    ds_read_b64_tr_b16 v[12:13], v131 offset:32768
    buffer_load_dwordx4 v142, s[4:7], s16 offen offset:2048 sc1 lds
    v_mfma_f32_16x16x32_bf16 v[96:99], v[56:59], v[32:35], v[96:99]
    ds_read_b64_tr_b16 v[14:15], v131 offset:36864
    v_mfma_f32_16x16x32_bf16 v[100:103], v[56:59], v[36:39], v[100:103]
    ds_read_b128 v[20:23], v136 offset:34816
    v_mfma_f32_16x16x32_bf16 v[104:107], v[56:59], v[40:43], v[104:107]
    ds_read_b128 v[24:27], v136 offset:36864
    buffer_load_dwordx4 v142, s[4:7], s16 offen offset:3072 sc1 lds
    v_mfma_f32_16x16x32_bf16 v[108:111], v[56:59], v[44:47], v[108:111]
    ds_read_b128 v[28:31], v136 offset:38912
    v_mfma_f32_16x16x32_bf16 v[112:115], v[60:63], v[32:35], v[112:115]
    s_add_u32 s16, s16, 2048
    v_mfma_f32_16x16x32_bf16 v[116:119], v[60:63], v[36:39], v[116:119]
    v_mfma_f32_16x16x32_bf16 v[120:123], v[60:63], v[40:43], v[120:123]
    v_mfma_f32_16x16x32_bf16 v[124:127], v[60:63], v[44:47], v[124:127]
    s_waitcnt lgkmcnt(0)
    ds_read_b128 v[48:51], v136 offset:33792
    s_add_u32 m0, s19, 16384
    s_nop 0
    v_mfma_f32_16x16x32_bf16 v[64:67], v[16:19], v[0:3], v[64:67]
    ds_read_b64_tr_b16 v[32:33], v128 offset:40960
    v_mfma_f32_16x16x32_bf16 v[68:71], v[16:19], v[4:7], v[68:71]
    ds_read_b64_tr_b16 v[34:35], v128 offset:45056
    buffer_load_dwordx4 v137, s[8:11], s15 offen offset:0 lds
    v_mfma_f32_16x16x32_bf16 v[72:75], v[16:19], v[8:11], v[72:75]
    ds_read_b64_tr_b16 v[36:37], v129 offset:40960
    v_mfma_f32_16x16x32_bf16 v[76:79], v[16:19], v[12:15], v[76:79]
    ds_read_b64_tr_b16 v[38:39], v129 offset:45056
    v_mfma_f32_16x16x32_bf16 v[80:83], v[20:23], v[0:3], v[80:83]
    ds_read_b64_tr_b16 v[40:41], v130 offset:40960
    buffer_load_dwordx4 v138, s[8:11], s15 offen offset:1024 lds
    v_mfma_f32_16x16x32_bf16 v[84:87], v[20:23], v[4:7], v[84:87]
    ds_read_b64_tr_b16 v[42:43], v130 offset:45056
    v_mfma_f32_16x16x32_bf16 v[88:91], v[20:23], v[8:11], v[88:91]
    ds_read_b64_tr_b16 v[44:45], v131 offset:40960
    v_mfma_f32_16x16x32_bf16 v[92:95], v[20:23], v[12:15], v[92:95]
    ds_read_b64_tr_b16 v[46:47], v131 offset:45056
    buffer_load_dwordx4 v139, s[8:11], s15 offen offset:2048 lds
    v_mfma_f32_16x16x32_bf16 v[96:99], v[24:27], v[0:3], v[96:99]
    ds_read_b128 v[52:55], v136 offset:35840
    v_mfma_f32_16x16x32_bf16 v[100:103], v[24:27], v[4:7], v[100:103]
    ds_read_b128 v[56:59], v136 offset:37888
    buffer_load_dwordx4 v140, s[8:11], s15 offen offset:3072 lds
    v_mfma_f32_16x16x32_bf16 v[104:107], v[24:27], v[8:11], v[104:107]
    ds_read_b128 v[60:63], v136 offset:39936
    v_mfma_f32_16x16x32_bf16 v[108:111], v[24:27], v[12:15], v[108:111]
    v_mfma_f32_16x16x32_bf16 v[112:115], v[28:31], v[0:3], v[112:115]
    s_add_u32 s15, s15, s17
    v_mfma_f32_16x16x32_bf16 v[116:119], v[28:31], v[4:7], v[116:119]
    v_mfma_f32_16x16x32_bf16 v[120:123], v[28:31], v[8:11], v[120:123]
    v_mfma_f32_16x16x32_bf16 v[124:127], v[28:31], v[12:15], v[124:127]
    s_waitcnt lgkmcnt(0)
    v_mfma_f32_16x16x32_bf16 v[64:67], v[48:51], v[32:35], v[64:67]
    s_waitcnt vmcnt(16)
    s_barrier
    ds_read_b128 v[16:19], v136 offset:49152
    s_add_u32 m0, s20, 32768
    s_nop 0
    v_mfma_f32_16x16x32_bf16 v[68:71], v[48:51], v[36:39], v[68:71]
    ds_read_b64_tr_b16 v[0:1], v128 offset:49152
    v_mfma_f32_16x16x32_bf16 v[72:75], v[48:51], v[40:43], v[72:75]
    ds_read_b64_tr_b16 v[2:3], v128 offset:53248
    buffer_load_dwordx4 v141, s[4:7], s16 offen offset:0 sc1 lds
    v_mfma_f32_16x16x32_bf16 v[76:79], v[48:51], v[44:47], v[76:79]
    ds_read_b64_tr_b16 v[4:5], v129 offset:49152
    v_mfma_f32_16x16x32_bf16 v[80:83], v[52:55], v[32:35], v[80:83]
    ds_read_b64_tr_b16 v[6:7], v129 offset:53248
    v_mfma_f32_16x16x32_bf16 v[84:87], v[52:55], v[36:39], v[84:87]
    ds_read_b64_tr_b16 v[8:9], v130 offset:49152
    buffer_load_dwordx4 v141, s[4:7], s16 offen offset:1024 sc1 lds
    v_mfma_f32_16x16x32_bf16 v[88:91], v[52:55], v[40:43], v[88:91]
    ds_read_b64_tr_b16 v[10:11], v130 offset:53248
    v_mfma_f32_16x16x32_bf16 v[92:95], v[52:55], v[44:47], v[92:95]
    ds_read_b64_tr_b16 v[12:13], v131 offset:49152
    buffer_load_dwordx4 v142, s[4:7], s16 offen offset:2048 sc1 lds
    v_mfma_f32_16x16x32_bf16 v[96:99], v[56:59], v[32:35], v[96:99]
    ds_read_b64_tr_b16 v[14:15], v131 offset:53248
    v_mfma_f32_16x16x32_bf16 v[100:103], v[56:59], v[36:39], v[100:103]
    ds_read_b128 v[20:23], v136 offset:51200
    v_mfma_f32_16x16x32_bf16 v[104:107], v[56:59], v[40:43], v[104:107]
    ds_read_b128 v[24:27], v136 offset:53248
    buffer_load_dwordx4 v142, s[4:7], s16 offen offset:3072 sc1 lds
    v_mfma_f32_16x16x32_bf16 v[108:111], v[56:59], v[44:47], v[108:111]
    ds_read_b128 v[28:31], v136 offset:55296
    v_mfma_f32_16x16x32_bf16 v[112:115], v[60:63], v[32:35], v[112:115]
    s_add_u32 s16, s16, 2048
    v_mfma_f32_16x16x32_bf16 v[116:119], v[60:63], v[36:39], v[116:119]
    v_mfma_f32_16x16x32_bf16 v[120:123], v[60:63], v[40:43], v[120:123]
    v_mfma_f32_16x16x32_bf16 v[124:127], v[60:63], v[44:47], v[124:127]
    s_waitcnt lgkmcnt(0)
    ds_read_b128 v[48:51], v136 offset:50176
    s_add_u32 m0, s19, 32768
    s_nop 0
    v_mfma_f32_16x16x32_bf16 v[64:67], v[16:19], v[0:3], v[64:67]
    ds_read_b64_tr_b16 v[32:33], v128 offset:57344
    v_mfma_f32_16x16x32_bf16 v[68:71], v[16:19], v[4:7], v[68:71]
    ds_read_b64_tr_b16 v[34:35], v128 offset:61440
    buffer_load_dwordx4 v137, s[8:11], s15 offen offset:0 lds
    v_mfma_f32_16x16x32_bf16 v[72:75], v[16:19], v[8:11], v[72:75]
    ds_read_b64_tr_b16 v[36:37], v129 offset:57344
    v_mfma_f32_16x16x32_bf16 v[76:79], v[16:19], v[12:15], v[76:79]
    ds_read_b64_tr_b16 v[38:39], v129 offset:61440
    v_mfma_f32_16x16x32_bf16 v[80:83], v[20:23], v[0:3], v[80:83]
    ds_read_b64_tr_b16 v[40:41], v130 offset:57344
    buffer_load_dwordx4 v138, s[8:11], s15 offen offset:1024 lds
    v_mfma_f32_16x16x32_bf16 v[84:87], v[20:23], v[4:7], v[84:87]
    ds_read_b64_tr_b16 v[42:43], v130 offset:61440
    v_mfma_f32_16x16x32_bf16 v[88:91], v[20:23], v[8:11], v[88:91]
    ds_read_b64_tr_b16 v[44:45], v131 offset:57344
    v_mfma_f32_16x16x32_bf16 v[92:95], v[20:23], v[12:15], v[92:95]
    ds_read_b64_tr_b16 v[46:47], v131 offset:61440
    buffer_load_dwordx4 v139, s[8:11], s15 offen offset:2048 lds
    v_mfma_f32_16x16x32_bf16 v[96:99], v[24:27], v[0:3], v[96:99]
    ds_read_b128 v[52:55], v136 offset:52224
    v_mfma_f32_16x16x32_bf16 v[100:103], v[24:27], v[4:7], v[100:103]
    ds_read_b128 v[56:59], v136 offset:54272
    buffer_load_dwordx4 v140, s[8:11], s15 offen offset:3072 lds
    v_mfma_f32_16x16x32_bf16 v[104:107], v[24:27], v[8:11], v[104:107]
    ds_read_b128 v[60:63], v136 offset:56320
    v_mfma_f32_16x16x32_bf16 v[108:111], v[24:27], v[12:15], v[108:111]
    v_mfma_f32_16x16x32_bf16 v[112:115], v[28:31], v[0:3], v[112:115]
    s_add_u32 s15, s15, s17
    v_mfma_f32_16x16x32_bf16 v[116:119], v[28:31], v[4:7], v[116:119]
    v_mfma_f32_16x16x32_bf16 v[120:123], v[28:31], v[8:11], v[120:123]
    v_mfma_f32_16x16x32_bf16 v[124:127], v[28:31], v[12:15], v[124:127]
    s_waitcnt lgkmcnt(0)
    v_mfma_f32_16x16x32_bf16 v[64:67], v[48:51], v[32:35], v[64:67]
    s_waitcnt vmcnt(16)
    s_barrier
    ds_read_b128 v[16:19], v136 offset:0
    s_add_u32 m0, s20, 49152
    s_nop 0
    v_mfma_f32_16x16x32_bf16 v[68:71], v[48:51], v[36:39], v[68:71]
    ds_read_b64_tr_b16 v[0:1], v128 offset:0
    v_mfma_f32_16x16x32_bf16 v[72:75], v[48:51], v[40:43], v[72:75]
    ds_read_b64_tr_b16 v[2:3], v128 offset:4096
    buffer_load_dwordx4 v141, s[4:7], s16 offen offset:0 sc1 lds
    v_mfma_f32_16x16x32_bf16 v[76:79], v[48:51], v[44:47], v[76:79]
    ds_read_b64_tr_b16 v[4:5], v129 offset:0
    v_mfma_f32_16x16x32_bf16 v[80:83], v[52:55], v[32:35], v[80:83]
    ds_read_b64_tr_b16 v[6:7], v129 offset:4096
    v_mfma_f32_16x16x32_bf16 v[84:87], v[52:55], v[36:39], v[84:87]
    ds_read_b64_tr_b16 v[8:9], v130 offset:0
    buffer_load_dwordx4 v141, s[4:7], s16 offen offset:1024 sc1 lds
    v_mfma_f32_16x16x32_bf16 v[88:91], v[52:55], v[40:43], v[88:91]
    ds_read_b64_tr_b16 v[10:11], v130 offset:4096
    v_mfma_f32_16x16x32_bf16 v[92:95], v[52:55], v[44:47], v[92:95]
    ds_read_b64_tr_b16 v[12:13], v131 offset:0
    buffer_load_dwordx4 v142, s[4:7], s16 offen offset:2048 sc1 lds
    v_mfma_f32_16x16x32_bf16 v[96:99], v[56:59], v[32:35], v[96:99]
    ds_read_b64_tr_b16 v[14:15], v131 offset:4096
    v_mfma_f32_16x16x32_bf16 v[100:103], v[56:59], v[36:39], v[100:103]
    ds_read_b128 v[20:23], v136 offset:2048
    v_mfma_f32_16x16x32_bf16 v[104:107], v[56:59], v[40:43], v[104:107]
    ds_read_b128 v[24:27], v136 offset:4096
    buffer_load_dwordx4 v142, s[4:7], s16 offen offset:3072 sc1 lds
    v_mfma_f32_16x16x32_bf16 v[108:111], v[56:59], v[44:47], v[108:111]
    ds_read_b128 v[28:31], v136 offset:6144
    v_mfma_f32_16x16x32_bf16 v[112:115], v[60:63], v[32:35], v[112:115]
    s_add_u32 s16, s16, 2048
    v_mfma_f32_16x16x32_bf16 v[116:119], v[60:63], v[36:39], v[116:119]
    v_mfma_f32_16x16x32_bf16 v[120:123], v[60:63], v[40:43], v[120:123]
    v_mfma_f32_16x16x32_bf16 v[124:127], v[60:63], v[44:47], v[124:127]
    s_sub_u32 s18, s18, 1
    s_cmp_lg_u32 s18, 0
    s_cbranch_scc1 main_kernel_w_c0_v_loop
    s_cmp_lg_u32 s14, 0
    s_cbranch_scc1 main_kernel_w_c0_v_nt
    s_lshl_b32 s32, s27, 8
    s_add_u32 s32, s32, 0x841e000
    v_mov_b32 v255, 1
    s_mov_b64 exec, 1
    buffer_atomic_add v255, off, s[4:7], s32 sc0 sc1
    s_mov_b64 exec, -1
main_kernel_w_c0_v_nt:
    s_waitcnt lgkmcnt(0)
    ds_read_b128 v[48:51], v136 offset:1024
    s_add_u32 m0, s19, 49152
    s_nop 0
    v_mfma_f32_16x16x32_bf16 v[64:67], v[16:19], v[0:3], v[64:67]
    ds_read_b64_tr_b16 v[32:33], v128 offset:8192
    v_mfma_f32_16x16x32_bf16 v[68:71], v[16:19], v[4:7], v[68:71]
    ds_read_b64_tr_b16 v[34:35], v128 offset:12288
    buffer_load_dwordx4 v137, s[8:11], s15 offen offset:0 lds
    v_mfma_f32_16x16x32_bf16 v[72:75], v[16:19], v[8:11], v[72:75]
    ds_read_b64_tr_b16 v[36:37], v129 offset:8192
    v_mfma_f32_16x16x32_bf16 v[76:79], v[16:19], v[12:15], v[76:79]
    ds_read_b64_tr_b16 v[38:39], v129 offset:12288
    v_mfma_f32_16x16x32_bf16 v[80:83], v[20:23], v[0:3], v[80:83]
    ds_read_b64_tr_b16 v[40:41], v130 offset:8192
    buffer_load_dwordx4 v138, s[8:11], s15 offen offset:1024 lds
    v_mfma_f32_16x16x32_bf16 v[84:87], v[20:23], v[4:7], v[84:87]
    ds_read_b64_tr_b16 v[42:43], v130 offset:12288
    v_mfma_f32_16x16x32_bf16 v[88:91], v[20:23], v[8:11], v[88:91]
    ds_read_b64_tr_b16 v[44:45], v131 offset:8192
    v_mfma_f32_16x16x32_bf16 v[92:95], v[20:23], v[12:15], v[92:95]
    ds_read_b64_tr_b16 v[46:47], v131 offset:12288
    buffer_load_dwordx4 v139, s[8:11], s15 offen offset:2048 lds
    v_mfma_f32_16x16x32_bf16 v[96:99], v[24:27], v[0:3], v[96:99]
    ds_read_b128 v[52:55], v136 offset:3072
    v_mfma_f32_16x16x32_bf16 v[100:103], v[24:27], v[4:7], v[100:103]
    ds_read_b128 v[56:59], v136 offset:5120
    buffer_load_dwordx4 v140, s[8:11], s15 offen offset:3072 lds
    v_mfma_f32_16x16x32_bf16 v[104:107], v[24:27], v[8:11], v[104:107]
    ds_read_b128 v[60:63], v136 offset:7168
    v_mfma_f32_16x16x32_bf16 v[108:111], v[24:27], v[12:15], v[108:111]
    v_mfma_f32_16x16x32_bf16 v[112:115], v[28:31], v[0:3], v[112:115]
    s_add_u32 s15, s15, s17
    v_mfma_f32_16x16x32_bf16 v[116:119], v[28:31], v[4:7], v[116:119]
    v_mfma_f32_16x16x32_bf16 v[120:123], v[28:31], v[8:11], v[120:123]
    v_mfma_f32_16x16x32_bf16 v[124:127], v[28:31], v[12:15], v[124:127]
    s_waitcnt lgkmcnt(0)
    v_mfma_f32_16x16x32_bf16 v[64:67], v[48:51], v[32:35], v[64:67]
    s_waitcnt vmcnt(16)
    s_barrier
    ds_read_b128 v[16:19], v136 offset:16384
    v_mfma_f32_16x16x32_bf16 v[68:71], v[48:51], v[36:39], v[68:71]
    ds_read_b64_tr_b16 v[0:1], v128 offset:16384
    v_mfma_f32_16x16x32_bf16 v[72:75], v[48:51], v[40:43], v[72:75]
    ds_read_b64_tr_b16 v[2:3], v128 offset:20480
    v_mfma_f32_16x16x32_bf16 v[76:79], v[48:51], v[44:47], v[76:79]
    ds_read_b64_tr_b16 v[4:5], v129 offset:16384
    v_mfma_f32_16x16x32_bf16 v[80:83], v[52:55], v[32:35], v[80:83]
    ds_read_b64_tr_b16 v[6:7], v129 offset:20480
    v_mfma_f32_16x16x32_bf16 v[84:87], v[52:55], v[36:39], v[84:87]
    ds_read_b64_tr_b16 v[8:9], v130 offset:16384
    v_mfma_f32_16x16x32_bf16 v[88:91], v[52:55], v[40:43], v[88:91]
    ds_read_b64_tr_b16 v[10:11], v130 offset:20480
    v_mfma_f32_16x16x32_bf16 v[92:95], v[52:55], v[44:47], v[92:95]
    ds_read_b64_tr_b16 v[12:13], v131 offset:16384
    v_mfma_f32_16x16x32_bf16 v[96:99], v[56:59], v[32:35], v[96:99]
    ds_read_b64_tr_b16 v[14:15], v131 offset:20480
    v_mfma_f32_16x16x32_bf16 v[100:103], v[56:59], v[36:39], v[100:103]
    ds_read_b128 v[20:23], v136 offset:18432
    v_mfma_f32_16x16x32_bf16 v[104:107], v[56:59], v[40:43], v[104:107]
    ds_read_b128 v[24:27], v136 offset:20480
    v_mfma_f32_16x16x32_bf16 v[108:111], v[56:59], v[44:47], v[108:111]
    ds_read_b128 v[28:31], v136 offset:22528
    v_mfma_f32_16x16x32_bf16 v[112:115], v[60:63], v[32:35], v[112:115]
    v_mfma_f32_16x16x32_bf16 v[116:119], v[60:63], v[36:39], v[116:119]
    v_mfma_f32_16x16x32_bf16 v[120:123], v[60:63], v[40:43], v[120:123]
    v_mfma_f32_16x16x32_bf16 v[124:127], v[60:63], v[44:47], v[124:127]
    s_waitcnt lgkmcnt(0)
    ds_read_b128 v[48:51], v136 offset:17408
    v_mfma_f32_16x16x32_bf16 v[64:67], v[16:19], v[0:3], v[64:67]
    ds_read_b64_tr_b16 v[32:33], v128 offset:24576
    v_mfma_f32_16x16x32_bf16 v[68:71], v[16:19], v[4:7], v[68:71]
    ds_read_b64_tr_b16 v[34:35], v128 offset:28672
    v_mfma_f32_16x16x32_bf16 v[72:75], v[16:19], v[8:11], v[72:75]
    ds_read_b64_tr_b16 v[36:37], v129 offset:24576
    v_mfma_f32_16x16x32_bf16 v[76:79], v[16:19], v[12:15], v[76:79]
    ds_read_b64_tr_b16 v[38:39], v129 offset:28672
    v_mfma_f32_16x16x32_bf16 v[80:83], v[20:23], v[0:3], v[80:83]
    ds_read_b64_tr_b16 v[40:41], v130 offset:24576
    v_mfma_f32_16x16x32_bf16 v[84:87], v[20:23], v[4:7], v[84:87]
    ds_read_b64_tr_b16 v[42:43], v130 offset:28672
    v_mfma_f32_16x16x32_bf16 v[88:91], v[20:23], v[8:11], v[88:91]
    ds_read_b64_tr_b16 v[44:45], v131 offset:24576
    v_mfma_f32_16x16x32_bf16 v[92:95], v[20:23], v[12:15], v[92:95]
    ds_read_b64_tr_b16 v[46:47], v131 offset:28672
    v_mfma_f32_16x16x32_bf16 v[96:99], v[24:27], v[0:3], v[96:99]
    ds_read_b128 v[52:55], v136 offset:19456
    v_mfma_f32_16x16x32_bf16 v[100:103], v[24:27], v[4:7], v[100:103]
    ds_read_b128 v[56:59], v136 offset:21504
    v_mfma_f32_16x16x32_bf16 v[104:107], v[24:27], v[8:11], v[104:107]
    ds_read_b128 v[60:63], v136 offset:23552
    v_mfma_f32_16x16x32_bf16 v[108:111], v[24:27], v[12:15], v[108:111]
    v_mfma_f32_16x16x32_bf16 v[112:115], v[28:31], v[0:3], v[112:115]
    v_mfma_f32_16x16x32_bf16 v[116:119], v[28:31], v[4:7], v[116:119]
    v_mfma_f32_16x16x32_bf16 v[120:123], v[28:31], v[8:11], v[120:123]
    v_mfma_f32_16x16x32_bf16 v[124:127], v[28:31], v[12:15], v[124:127]
    s_waitcnt lgkmcnt(0)
    v_mfma_f32_16x16x32_bf16 v[64:67], v[48:51], v[32:35], v[64:67]
    s_waitcnt vmcnt(8)
    s_barrier
    ds_read_b128 v[16:19], v136 offset:32768
    v_mfma_f32_16x16x32_bf16 v[68:71], v[48:51], v[36:39], v[68:71]
    ds_read_b64_tr_b16 v[0:1], v128 offset:32768
    v_mfma_f32_16x16x32_bf16 v[72:75], v[48:51], v[40:43], v[72:75]
    ds_read_b64_tr_b16 v[2:3], v128 offset:36864
    v_mfma_f32_16x16x32_bf16 v[76:79], v[48:51], v[44:47], v[76:79]
    ds_read_b64_tr_b16 v[4:5], v129 offset:32768
    v_mfma_f32_16x16x32_bf16 v[80:83], v[52:55], v[32:35], v[80:83]
    ds_read_b64_tr_b16 v[6:7], v129 offset:36864
    v_mfma_f32_16x16x32_bf16 v[84:87], v[52:55], v[36:39], v[84:87]
    ds_read_b64_tr_b16 v[8:9], v130 offset:32768
    v_mfma_f32_16x16x32_bf16 v[88:91], v[52:55], v[40:43], v[88:91]
    ds_read_b64_tr_b16 v[10:11], v130 offset:36864
    v_mfma_f32_16x16x32_bf16 v[92:95], v[52:55], v[44:47], v[92:95]
    ds_read_b64_tr_b16 v[12:13], v131 offset:32768
    v_mfma_f32_16x16x32_bf16 v[96:99], v[56:59], v[32:35], v[96:99]
    ds_read_b64_tr_b16 v[14:15], v131 offset:36864
    v_mfma_f32_16x16x32_bf16 v[100:103], v[56:59], v[36:39], v[100:103]
    ds_read_b128 v[20:23], v136 offset:34816
    v_mfma_f32_16x16x32_bf16 v[104:107], v[56:59], v[40:43], v[104:107]
    ds_read_b128 v[24:27], v136 offset:36864
    v_mfma_f32_16x16x32_bf16 v[108:111], v[56:59], v[44:47], v[108:111]
    ds_read_b128 v[28:31], v136 offset:38912
    v_mfma_f32_16x16x32_bf16 v[112:115], v[60:63], v[32:35], v[112:115]
    v_mfma_f32_16x16x32_bf16 v[116:119], v[60:63], v[36:39], v[116:119]
    v_mfma_f32_16x16x32_bf16 v[120:123], v[60:63], v[40:43], v[120:123]
    v_mfma_f32_16x16x32_bf16 v[124:127], v[60:63], v[44:47], v[124:127]
    s_waitcnt lgkmcnt(0)
    ds_read_b128 v[48:51], v136 offset:33792
    v_mfma_f32_16x16x32_bf16 v[64:67], v[16:19], v[0:3], v[64:67]
    ds_read_b64_tr_b16 v[32:33], v128 offset:40960
    v_mfma_f32_16x16x32_bf16 v[68:71], v[16:19], v[4:7], v[68:71]
    ds_read_b64_tr_b16 v[34:35], v128 offset:45056
    v_mfma_f32_16x16x32_bf16 v[72:75], v[16:19], v[8:11], v[72:75]
    ds_read_b64_tr_b16 v[36:37], v129 offset:40960
    v_mfma_f32_16x16x32_bf16 v[76:79], v[16:19], v[12:15], v[76:79]
    ds_read_b64_tr_b16 v[38:39], v129 offset:45056
    v_mfma_f32_16x16x32_bf16 v[80:83], v[20:23], v[0:3], v[80:83]
    ds_read_b64_tr_b16 v[40:41], v130 offset:40960
    v_mfma_f32_16x16x32_bf16 v[84:87], v[20:23], v[4:7], v[84:87]
    ds_read_b64_tr_b16 v[42:43], v130 offset:45056
    v_mfma_f32_16x16x32_bf16 v[88:91], v[20:23], v[8:11], v[88:91]
    ds_read_b64_tr_b16 v[44:45], v131 offset:40960
    v_mfma_f32_16x16x32_bf16 v[92:95], v[20:23], v[12:15], v[92:95]
    ds_read_b64_tr_b16 v[46:47], v131 offset:45056
    v_mfma_f32_16x16x32_bf16 v[96:99], v[24:27], v[0:3], v[96:99]
    ds_read_b128 v[52:55], v136 offset:35840
    v_mfma_f32_16x16x32_bf16 v[100:103], v[24:27], v[4:7], v[100:103]
    ds_read_b128 v[56:59], v136 offset:37888
    v_mfma_f32_16x16x32_bf16 v[104:107], v[24:27], v[8:11], v[104:107]
    ds_read_b128 v[60:63], v136 offset:39936
    v_mfma_f32_16x16x32_bf16 v[108:111], v[24:27], v[12:15], v[108:111]
    v_mfma_f32_16x16x32_bf16 v[112:115], v[28:31], v[0:3], v[112:115]
    v_mfma_f32_16x16x32_bf16 v[116:119], v[28:31], v[4:7], v[116:119]
    v_mfma_f32_16x16x32_bf16 v[120:123], v[28:31], v[8:11], v[120:123]
    v_mfma_f32_16x16x32_bf16 v[124:127], v[28:31], v[12:15], v[124:127]
    s_waitcnt lgkmcnt(0)
    v_mfma_f32_16x16x32_bf16 v[64:67], v[48:51], v[32:35], v[64:67]
    s_waitcnt vmcnt(0)
    s_barrier
    ds_read_b128 v[16:19], v136 offset:49152
    v_mfma_f32_16x16x32_bf16 v[68:71], v[48:51], v[36:39], v[68:71]
    ds_read_b64_tr_b16 v[0:1], v128 offset:49152
    v_mfma_f32_16x16x32_bf16 v[72:75], v[48:51], v[40:43], v[72:75]
    ds_read_b64_tr_b16 v[2:3], v128 offset:53248
    v_mfma_f32_16x16x32_bf16 v[76:79], v[48:51], v[44:47], v[76:79]
    ds_read_b64_tr_b16 v[4:5], v129 offset:49152
    v_mfma_f32_16x16x32_bf16 v[80:83], v[52:55], v[32:35], v[80:83]
    ds_read_b64_tr_b16 v[6:7], v129 offset:53248
    v_mfma_f32_16x16x32_bf16 v[84:87], v[52:55], v[36:39], v[84:87]
    ds_read_b64_tr_b16 v[8:9], v130 offset:49152
    v_mfma_f32_16x16x32_bf16 v[88:91], v[52:55], v[40:43], v[88:91]
    ds_read_b64_tr_b16 v[10:11], v130 offset:53248
    v_mfma_f32_16x16x32_bf16 v[92:95], v[52:55], v[44:47], v[92:95]
    ds_read_b64_tr_b16 v[12:13], v131 offset:49152
    v_mfma_f32_16x16x32_bf16 v[96:99], v[56:59], v[32:35], v[96:99]
    ds_read_b64_tr_b16 v[14:15], v131 offset:53248
    v_mfma_f32_16x16x32_bf16 v[100:103], v[56:59], v[36:39], v[100:103]
    ds_read_b128 v[20:23], v136 offset:51200
    v_mfma_f32_16x16x32_bf16 v[104:107], v[56:59], v[40:43], v[104:107]
    ds_read_b128 v[24:27], v136 offset:53248
    v_mfma_f32_16x16x32_bf16 v[108:111], v[56:59], v[44:47], v[108:111]
    ds_read_b128 v[28:31], v136 offset:55296
    v_mfma_f32_16x16x32_bf16 v[112:115], v[60:63], v[32:35], v[112:115]
    v_mfma_f32_16x16x32_bf16 v[116:119], v[60:63], v[36:39], v[116:119]
    v_mfma_f32_16x16x32_bf16 v[120:123], v[60:63], v[40:43], v[120:123]
    v_mfma_f32_16x16x32_bf16 v[124:127], v[60:63], v[44:47], v[124:127]
    v_readfirstlane_b32 s55, v255
    s_waitcnt lgkmcnt(0)
    ds_read_b128 v[48:51], v136 offset:50176
    v_mfma_f32_16x16x32_bf16 v[64:67], v[16:19], v[0:3], v[64:67]
    ds_read_b64_tr_b16 v[32:33], v128 offset:57344
    v_mfma_f32_16x16x32_bf16 v[68:71], v[16:19], v[4:7], v[68:71]
    ds_read_b64_tr_b16 v[34:35], v128 offset:61440
    v_mfma_f32_16x16x32_bf16 v[72:75], v[16:19], v[8:11], v[72:75]
    ds_read_b64_tr_b16 v[36:37], v129 offset:57344
    v_mfma_f32_16x16x32_bf16 v[76:79], v[16:19], v[12:15], v[76:79]
    ds_read_b64_tr_b16 v[38:39], v129 offset:61440
    v_mfma_f32_16x16x32_bf16 v[80:83], v[20:23], v[0:3], v[80:83]
    ds_read_b64_tr_b16 v[40:41], v130 offset:57344
    v_mfma_f32_16x16x32_bf16 v[84:87], v[20:23], v[4:7], v[84:87]
    ds_read_b64_tr_b16 v[42:43], v130 offset:61440
    v_mfma_f32_16x16x32_bf16 v[88:91], v[20:23], v[8:11], v[88:91]
    ds_read_b64_tr_b16 v[44:45], v131 offset:57344
    v_mfma_f32_16x16x32_bf16 v[92:95], v[20:23], v[12:15], v[92:95]
    ds_read_b64_tr_b16 v[46:47], v131 offset:61440
    v_mfma_f32_16x16x32_bf16 v[96:99], v[24:27], v[0:3], v[96:99]
    ds_read_b128 v[52:55], v136 offset:52224
    v_mfma_f32_16x16x32_bf16 v[100:103], v[24:27], v[4:7], v[100:103]
    ds_read_b128 v[56:59], v136 offset:54272
    v_mfma_f32_16x16x32_bf16 v[104:107], v[24:27], v[8:11], v[104:107]
    ds_read_b128 v[60:63], v136 offset:56320
    v_mfma_f32_16x16x32_bf16 v[108:111], v[24:27], v[12:15], v[108:111]
    v_mfma_f32_16x16x32_bf16 v[112:115], v[28:31], v[0:3], v[112:115]
    v_mfma_f32_16x16x32_bf16 v[116:119], v[28:31], v[4:7], v[116:119]
    v_mfma_f32_16x16x32_bf16 v[120:123], v[28:31], v[8:11], v[120:123]
    v_mfma_f32_16x16x32_bf16 v[124:127], v[28:31], v[12:15], v[124:127]
    s_waitcnt lgkmcnt(0)
    v_mfma_f32_16x16x32_bf16 v[64:67], v[48:51], v[32:35], v[64:67]
    v_mfma_f32_16x16x32_bf16 v[68:71], v[48:51], v[36:39], v[68:71]
    v_mfma_f32_16x16x32_bf16 v[72:75], v[48:51], v[40:43], v[72:75]
    v_mfma_f32_16x16x32_bf16 v[76:79], v[48:51], v[44:47], v[76:79]
    v_mfma_f32_16x16x32_bf16 v[80:83], v[52:55], v[32:35], v[80:83]
    v_mfma_f32_16x16x32_bf16 v[84:87], v[52:55], v[36:39], v[84:87]
    v_mfma_f32_16x16x32_bf16 v[88:91], v[52:55], v[40:43], v[88:91]
    v_mfma_f32_16x16x32_bf16 v[92:95], v[52:55], v[44:47], v[92:95]
    v_mfma_f32_16x16x32_bf16 v[96:99], v[56:59], v[32:35], v[96:99]
    v_mfma_f32_16x16x32_bf16 v[100:103], v[56:59], v[36:39], v[100:103]
    v_mfma_f32_16x16x32_bf16 v[104:107], v[56:59], v[40:43], v[104:107]
    v_mfma_f32_16x16x32_bf16 v[108:111], v[56:59], v[44:47], v[108:111]
    v_mfma_f32_16x16x32_bf16 v[112:115], v[60:63], v[32:35], v[112:115]
    v_mfma_f32_16x16x32_bf16 v[116:119], v[60:63], v[36:39], v[116:119]
    v_mfma_f32_16x16x32_bf16 v[120:123], v[60:63], v[40:43], v[120:123]
    v_mfma_f32_16x16x32_bf16 v[124:127], v[60:63], v[44:47], v[124:127]
    s_nop 7
    s_mov_b32 s53, s21
    v_cvt_pk_bf16_f32 v8, v64, v65
    v_cvt_pk_bf16_f32 v9, v66, v67
    v_cvt_pk_bf16_f32 v10, v80, v81
    v_cvt_pk_bf16_f32 v11, v82, v83
    buffer_store_dwordx4 v[8:11], v251, s[4:7], s53 offen offset:0 sc1
    v_cvt_pk_bf16_f32 v24, v68, v69
    v_cvt_pk_bf16_f32 v25, v70, v71
    v_cvt_pk_bf16_f32 v26, v84, v85
    v_cvt_pk_bf16_f32 v27, v86, v87
    buffer_store_dwordx4 v[24:27], v251, s[4:7], s53 offen offset:1024 sc1
    v_cvt_pk_bf16_f32 v40, v72, v73
    v_cvt_pk_bf16_f32 v41, v74, v75
    v_cvt_pk_bf16_f32 v42, v88, v89
    v_cvt_pk_bf16_f32 v43, v90, v91
    buffer_store_dwordx4 v[40:43], v251, s[4:7], s53 offen offset:2048 sc1
    v_cvt_pk_bf16_f32 v56, v76, v77
    v_cvt_pk_bf16_f32 v57, v78, v79
    v_cvt_pk_bf16_f32 v58, v92, v93
    v_cvt_pk_bf16_f32 v59, v94, v95
    buffer_store_dwordx4 v[56:59], v251, s[4:7], s53 offen offset:3072 sc1
    s_add_u32 s53, s53, 262144
    v_cvt_pk_bf16_f32 v8, v96, v97
    v_cvt_pk_bf16_f32 v9, v98, v99
    v_cvt_pk_bf16_f32 v10, v112, v113
    v_cvt_pk_bf16_f32 v11, v114, v115
    buffer_store_dwordx4 v[8:11], v251, s[4:7], s53 offen offset:0 sc1
    v_cvt_pk_bf16_f32 v24, v100, v101
    v_cvt_pk_bf16_f32 v25, v102, v103
    v_cvt_pk_bf16_f32 v26, v116, v117
    v_cvt_pk_bf16_f32 v27, v118, v119
    buffer_store_dwordx4 v[24:27], v251, s[4:7], s53 offen offset:1024 sc1
    v_cvt_pk_bf16_f32 v40, v104, v105
    v_cvt_pk_bf16_f32 v41, v106, v107
    v_cvt_pk_bf16_f32 v42, v120, v121
    v_cvt_pk_bf16_f32 v43, v122, v123
    buffer_store_dwordx4 v[40:43], v251, s[4:7], s53 offen offset:2048 sc1
    v_cvt_pk_bf16_f32 v56, v108, v109
    v_cvt_pk_bf16_f32 v57, v110, v111
    v_cvt_pk_bf16_f32 v58, v124, v125
    v_cvt_pk_bf16_f32 v59, v126, v127
    buffer_store_dwordx4 v[56:59], v251, s[4:7], s53 offen offset:3072 sc1
    s_add_u32 s53, s53, 262144
    s_branch main_kernel_w_done
main_kernel_w_c1_task:
    s_cmp_eq_u32 s23, 0
    s_cbranch_scc1 main_kernel_w_c1_set0
    s_cmp_eq_u32 s23, 1
    s_cbranch_scc1 main_kernel_w_c1_set1
    s_cmp_eq_u32 s23, 2
    s_cbranch_scc1 main_kernel_w_c1_set2
    s_cmp_eq_u32 s23, 3
    s_cbranch_scc1 main_kernel_w_c1_set3
    s_cmp_eq_u32 s23, 6
    s_cbranch_scc1 main_kernel_w_c1_set6
    s_branch main_kernel_w_done
main_kernel_w_c1_set0:
    s_lshl_b32 s32, s25, 8
    s_add_u32 s8, s40, s32
    s_addc_u32 s9, s41, 0
    s_and_b32 s9, s9, 0xffff
    s_sub_u32 s10, 0x800000, s32
    s_mov_b32 s11, 0x20000
    s_mov_b32 s30, 8192
    s_mov_b32 s31, 32768
    s_mul_i32 s16, s24, 262144
    s_add_u32 s16, s16, 0x0
    s_mov_b32 s18, 7
    s_lshl_b32 s32, s24, 3
    s_mul_i32 s33, s38, 4
    s_add_u32 s32, s32, s33
    s_mul_i32 s32, s32, 131072
    s_lshl_b32 s33, s25, 12
    s_add_u32 s32, s32, s33
    s_mul_i32 s33, s37, 4096
    s_add_u32 s32, s32, s33
    s_add_u32 s21, s32, 0x800000
    s_mov_b32 s22, 131072
    s_mov_b32 s26, -1
    s_branch main_kernel_w_c1_go
main_kernel_w_c1_set1:
    s_lshl_b32 s32, s25, 8
    s_add_u32 s8, s42, s32
    s_addc_u32 s9, s43, 0
    s_and_b32 s9, s9, 0xffff
    s_sub_u32 s10, 0x800000, s32
    s_mov_b32 s11, 0x20000
    s_mov_b32 s30, 8192
    s_mov_b32 s31, 32768
    s_mul_i32 s16, s24, 262144
    s_add_u32 s16, s16, 0x0
    s_mov_b32 s18, 7
    s_lshl_b32 s32, s24, 3
    s_mul_i32 s33, s38, 4
    s_add_u32 s32, s32, s33
    s_mul_i32 s32, s32, 131072
    s_lshl_b32 s33, s25, 12
    s_add_u32 s32, s32, s33
    s_mul_i32 s33, s37, 4096
    s_add_u32 s32, s32, s33
    s_add_u32 s21, s32, 0x1800000
    s_mov_b32 s22, 131072
    s_mov_b32 s26, -1
    s_branch main_kernel_w_c1_go
main_kernel_w_c1_set2:
    s_lshl_b32 s32, s25, 8
    s_add_u32 s8, s44, s32
    s_addc_u32 s9, s45, 0
    s_and_b32 s9, s9, 0xffff
    s_sub_u32 s10, 0x800000, s32
    s_mov_b32 s11, 0x20000
    s_mov_b32 s30, 8192
    s_mov_b32 s31, 32768
    s_mul_i32 s16, s24, 262144
    s_add_u32 s16, s16, 0x0
    s_mov_b32 s18, 7
    s_lshl_b32 s32, s24, 2
    s_mul_i32 s33, s38, 2
    s_add_u32 s32, s32, s33
    s_lshl_b32 s32, s32, 18
    s_lshl_b32 s33, s25, 13
    s_add_u32 s32, s32, s33
    s_mul_i32 s33, s37, 8192
    s_add_u32 s32, s32, s33
    s_add_u32 s21, s32, 0x2800000
    s_branch main_kernel_w_c1_gov
main_kernel_w_c1_set3:
    s_lshl_b32 s32, s25, 8
    s_add_u32 s8, s64, s32
    s_addc_u32 s9, s65, 0
    s_and_b32 s9, s9, 0xffff
    s_sub_u32 s10, 0x200000, s32
    s_mov_b32 s11, 0x20000
    s_mov_b32 s30, 2048
    s_mov_b32 s31, 32768
    s_mul_i32 s16, s24, 262144
    s_add_u32 s16, s16, 0x400000
    s_mov_b32 s18, 7
    s_lshl_b32 s32, s24, 3
    s_mul_i32 s33, s38, 4
    s_add_u32 s32, s32, s33
    s_mul_i32 s32, s32, 32768
    s_lshl_b32 s33, s25, 12
    s_add_u32 s32, s32, s33
    s_mul_i32 s33, s37, 4096
    s_add_u32 s32, s32, s33
    s_add_u32 s21, s32, 0x4800000
    s_mov_b32 s22, 32768
    s_mov_b32 s26, -1
    s_lshr_b32 s32, s25, 2
    s_add_u32 s32, s32, 1
    s_sub_u32 s33, 0, s32
    s_bitcmp1_b32 s25, 1
    s_cselect_b32 s32, s33, s32
    s_add_u32 s32, s32, 16
    v_and_b32 v253, 15, v250
    v_add_u32 v253, s32, v253
    v_lshrrev_b32 v254, 4, v253
    v_lshlrev_b32 v254, 15, v254
    v_and_b32 v253, 15, v253
    v_lshl_add_u32 v254, v253, 4, v254
    v_and_b32 v253, 0x300, v251
    v_add_u32 v252, v253, v254
    s_branch main_kernel_w_c1_go
main_kernel_w_c1_set6:
    s_lshl_b32 s32, s25, 8
    s_add_u32 s8, s68, s32
    s_addc_u32 s9, s69, 0
    s_and_b32 s9, s9, 0xffff
    s_sub_u32 s10, 0x700000, s32
    s_mov_b32 s11, 0x20000
    s_mov_b32 s30, 7168
    s_mov_b32 s31, 32768
    s_mul_i32 s16, s24, 262144
    s_add_u32 s16, s16, 0x6800000
    s_mov_b32 s18, 7
    s_lshl_b32 s32, s24, 3
    s_mul_i32 s33, s38, 4
    s_add_u32 s32, s32, s33
    s_mul_i32 s32, s32, 114688
    s_lshl_b32 s33, s25, 12
    s_add_u32 s32, s32, s33
    s_mul_i32 s33, s37, 4096
    s_add_u32 s32, s32, s33
    s_add_u32 s21, s32, 0x5400000
    s_mov_b32 s22, 114688
    s_mov_b32 s26, -1
    s_branch main_kernel_w_c1_go
main_kernel_w_c1_go:
    v_lshrrev_b32 v0, 4, v250
    v_bfe_u32 v1, v250, 2, 2
    v_lshl_add_u32 v4, v0, 2, v1
    v_and_b32 v5, 7, v4
    v_mul_u32_u24 v4, 512, v4
    v_and_b32 v6, 3, v250
    v_lshl_add_u32 v4, v6, 3, v4
    s_mul_i32 s32, s37, 8
    v_xor_b32 v5, s32, v5
    v_lshl_add_u32 v128, v5, 5, v4
    v_xor_b32 v129, 32, v128
    v_xor_b32 v130, 64, v128
    v_xor_b32 v131, 96, v128
    v_xor_b32 v132, 128, v128
    v_xor_b32 v133, 160, v128
    v_xor_b32 v134, 192, v128
    v_xor_b32 v135, 224, v128
    s_mul_i32 s32, s38, 4096
    s_add_u32 s32, s32, 65536
    v_add_u32 v136, s32, v251
    v_lshrrev_b32 v2, 5, v250
    v_and_b32 v3, 31, v250
    s_mul_i32 s32, s14, 8
    v_add_u32 v4, s32, v2
    v_add_u32 v5, 0, v4
    v_and_b32 v6, 7, v5
    v_lshlrev_b32 v6, 1, v6
    v_xor_b32 v6, v6, v3
    v_mul_lo_u32 v5, v5, s30
    v_lshl_add_u32 v5, v6, 4, v5
    v_subrev_u32 v137, 0, v5
    v_add_u32 v5, 2, v4
    v_and_b32 v6, 7, v5
    v_lshlrev_b32 v6, 1, v6
    v_xor_b32 v6, v6, v3
    v_mul_lo_u32 v5, v5, s30
    v_lshl_add_u32 v5, v6, 4, v5
    v_subrev_u32 v138, 1024, v5
    v_add_u32 v5, 4, v4
    v_and_b32 v6, 7, v5
    v_lshlrev_b32 v6, 1, v6
    v_xor_b32 v6, v6, v3
    v_mul_lo_u32 v5, v5, s30
    v_lshl_add_u32 v5, v6, 4, v5
    v_subrev_u32 v139, 2048, v5
    v_add_u32 v5, 6, v4
    v_and_b32 v6, 7, v5
    v_lshlrev_b32 v6, 1, v6
    v_xor_b32 v6, v6, v3
    v_mul_lo_u32 v5, v5, s30
    v_lshl_add_u32 v5, v6, 4, v5
    v_subrev_u32 v140, 3072, v5
    s_mul_i32 s32, s14, 2
    s_mul_i32 s32, s32, s31
    v_add_u32 v141, s32, v251
    s_add_u32 s32, s32, s31
    s_sub_u32 s32, s32, 1024
    v_add_u32 v142, s32, v251
    s_mul_i32 s19, s14, 4096
    s_mul_i32 s20, s14, 2048
    s_add_u32 s20, s20, 65536
    s_mul_i32 s17, s30, 32
    s_mov_b32 s15, 0
    s_add_u32 m0, s20, 0
    s_nop 0
    buffer_load_dwordx4 v141, s[4:7], s16 offen offset:0 sc1 lds
    buffer_load_dwordx4 v142, s[4:7], s16 offen offset:1024 sc1 lds
    s_add_u32 s16, s16, 1024
    s_add_u32 m0, s19, 0
    s_nop 0
    buffer_load_dwordx4 v137, s[8:11], s15 offen offset:0 lds
    buffer_load_dwordx4 v138, s[8:11], s15 offen offset:1024 lds
    buffer_load_dwordx4 v139, s[8:11], s15 offen offset:2048 lds
    buffer_load_dwordx4 v140, s[8:11], s15 offen offset:3072 lds
    s_add_u32 s15, s15, s17
    s_add_u32 m0, s20, 8192
    s_nop 0
    buffer_load_dwordx4 v141, s[4:7], s16 offen offset:0 sc1 lds
    buffer_load_dwordx4 v142, s[4:7], s16 offen offset:1024 sc1 lds
    s_add_u32 s16, s16, 1024
    s_add_u32 m0, s19, 16384
    s_nop 0
    buffer_load_dwordx4 v137, s[8:11], s15 offen offset:0 lds
    buffer_load_dwordx4 v138, s[8:11], s15 offen offset:1024 lds
    buffer_load_dwordx4 v139, s[8:11], s15 offen offset:2048 lds
    buffer_load_dwordx4 v140, s[8:11], s15 offen offset:3072 lds
    s_add_u32 s15, s15, s17
    s_add_u32 m0, s20, 16384
    s_nop 0
    buffer_load_dwordx4 v141, s[4:7], s16 offen offset:0 sc1 lds
    buffer_load_dwordx4 v142, s[4:7], s16 offen offset:1024 sc1 lds
    s_add_u32 s16, s16, 1024
    s_add_u32 m0, s19, 32768
    s_nop 0
    buffer_load_dwordx4 v137, s[8:11], s15 offen offset:0 lds
    buffer_load_dwordx4 v138, s[8:11], s15 offen offset:1024 lds
    buffer_load_dwordx4 v139, s[8:11], s15 offen offset:2048 lds
    buffer_load_dwordx4 v140, s[8:11], s15 offen offset:3072 lds
    s_add_u32 s15, s15, s17
    s_add_u32 m0, s20, 24576
    s_nop 0
    buffer_load_dwordx4 v141, s[4:7], s16 offen offset:0 sc1 lds
    buffer_load_dwordx4 v142, s[4:7], s16 offen offset:1024 sc1 lds
    s_add_u32 s16, s16, 1024
    s_add_u32 m0, s19, 49152
    s_nop 0
    buffer_load_dwordx4 v137, s[8:11], s15 offen offset:0 lds
    buffer_load_dwordx4 v138, s[8:11], s15 offen offset:1024 lds
    buffer_load_dwordx4 v139, s[8:11], s15 offen offset:2048 lds
    buffer_load_dwordx4 v140, s[8:11], s15 offen offset:3072 lds
    s_add_u32 s15, s15, s17
    v_accvgpr_write_b32 a0, 0
    v_accvgpr_write_b32 a1, 0
    v_accvgpr_write_b32 a2, 0
    v_accvgpr_write_b32 a3, 0
    v_accvgpr_write_b32 a4, 0
    v_accvgpr_write_b32 a5, 0
    v_accvgpr_write_b32 a6, 0
    v_accvgpr_write_b32 a7, 0
    v_accvgpr_write_b32 a8, 0
    v_accvgpr_write_b32 a9, 0
    v_accvgpr_write_b32 a10, 0
    v_accvgpr_write_b32 a11, 0
    v_accvgpr_write_b32 a12, 0
    v_accvgpr_write_b32 a13, 0
    v_accvgpr_write_b32 a14, 0
    v_accvgpr_write_b32 a15, 0
    v_accvgpr_write_b32 a16, 0
    v_accvgpr_write_b32 a17, 0
    v_accvgpr_write_b32 a18, 0
    v_accvgpr_write_b32 a19, 0
    v_accvgpr_write_b32 a20, 0
    v_accvgpr_write_b32 a21, 0
    v_accvgpr_write_b32 a22, 0
    v_accvgpr_write_b32 a23, 0
    v_accvgpr_write_b32 a24, 0
    v_accvgpr_write_b32 a25, 0
    v_accvgpr_write_b32 a26, 0
    v_accvgpr_write_b32 a27, 0
    v_accvgpr_write_b32 a28, 0
    v_accvgpr_write_b32 a29, 0
    v_accvgpr_write_b32 a30, 0
    v_accvgpr_write_b32 a31, 0
    v_accvgpr_write_b32 a32, 0
    v_accvgpr_write_b32 a33, 0
    v_accvgpr_write_b32 a34, 0
    v_accvgpr_write_b32 a35, 0
    v_accvgpr_write_b32 a36, 0
    v_accvgpr_write_b32 a37, 0
    v_accvgpr_write_b32 a38, 0
    v_accvgpr_write_b32 a39, 0
    v_accvgpr_write_b32 a40, 0
    v_accvgpr_write_b32 a41, 0
    v_accvgpr_write_b32 a42, 0
    v_accvgpr_write_b32 a43, 0
    v_accvgpr_write_b32 a44, 0
    v_accvgpr_write_b32 a45, 0
    v_accvgpr_write_b32 a46, 0
    v_accvgpr_write_b32 a47, 0
    v_accvgpr_write_b32 a48, 0
    v_accvgpr_write_b32 a49, 0
    v_accvgpr_write_b32 a50, 0
    v_accvgpr_write_b32 a51, 0
    v_accvgpr_write_b32 a52, 0
    v_accvgpr_write_b32 a53, 0
    v_accvgpr_write_b32 a54, 0
    v_accvgpr_write_b32 a55, 0
    v_accvgpr_write_b32 a56, 0
    v_accvgpr_write_b32 a57, 0
    v_accvgpr_write_b32 a58, 0
    v_accvgpr_write_b32 a59, 0
    v_accvgpr_write_b32 a60, 0
    v_accvgpr_write_b32 a61, 0
    v_accvgpr_write_b32 a62, 0
    v_accvgpr_write_b32 a63, 0
    v_accvgpr_write_b32 a64, 0
    v_accvgpr_write_b32 a65, 0
    v_accvgpr_write_b32 a66, 0
    v_accvgpr_write_b32 a67, 0
    v_accvgpr_write_b32 a68, 0
    v_accvgpr_write_b32 a69, 0
    v_accvgpr_write_b32 a70, 0
    v_accvgpr_write_b32 a71, 0
    v_accvgpr_write_b32 a72, 0
    v_accvgpr_write_b32 a73, 0
    v_accvgpr_write_b32 a74, 0
    v_accvgpr_write_b32 a75, 0
    v_accvgpr_write_b32 a76, 0
    v_accvgpr_write_b32 a77, 0
    v_accvgpr_write_b32 a78, 0
    v_accvgpr_write_b32 a79, 0
    v_accvgpr_write_b32 a80, 0
    v_accvgpr_write_b32 a81, 0
    v_accvgpr_write_b32 a82, 0
    v_accvgpr_write_b32 a83, 0
    v_accvgpr_write_b32 a84, 0
    v_accvgpr_write_b32 a85, 0
    v_accvgpr_write_b32 a86, 0
    v_accvgpr_write_b32 a87, 0
    v_accvgpr_write_b32 a88, 0
    v_accvgpr_write_b32 a89, 0
    v_accvgpr_write_b32 a90, 0
    v_accvgpr_write_b32 a91, 0
    v_accvgpr_write_b32 a92, 0
    v_accvgpr_write_b32 a93, 0
    v_accvgpr_write_b32 a94, 0
    v_accvgpr_write_b32 a95, 0
    v_accvgpr_write_b32 a96, 0
    v_accvgpr_write_b32 a97, 0
    v_accvgpr_write_b32 a98, 0
    v_accvgpr_write_b32 a99, 0
    v_accvgpr_write_b32 a100, 0
    v_accvgpr_write_b32 a101, 0
    v_accvgpr_write_b32 a102, 0
    v_accvgpr_write_b32 a103, 0
    v_accvgpr_write_b32 a104, 0
    v_accvgpr_write_b32 a105, 0
    v_accvgpr_write_b32 a106, 0
    v_accvgpr_write_b32 a107, 0
    v_accvgpr_write_b32 a108, 0
    v_accvgpr_write_b32 a109, 0
    v_accvgpr_write_b32 a110, 0
    v_accvgpr_write_b32 a111, 0
    v_accvgpr_write_b32 a112, 0
    v_accvgpr_write_b32 a113, 0
    v_accvgpr_write_b32 a114, 0
    v_accvgpr_write_b32 a115, 0
    v_accvgpr_write_b32 a116, 0
    v_accvgpr_write_b32 a117, 0
    v_accvgpr_write_b32 a118, 0
    v_accvgpr_write_b32 a119, 0
    v_accvgpr_write_b32 a120, 0
    v_accvgpr_write_b32 a121, 0
    v_accvgpr_write_b32 a122, 0
    v_accvgpr_write_b32 a123, 0
    v_accvgpr_write_b32 a124, 0
    v_accvgpr_write_b32 a125, 0
    v_accvgpr_write_b32 a126, 0
    v_accvgpr_write_b32 a127, 0
    s_waitcnt vmcnt(18)
    s_barrier
    ds_read_b128 v[32:35], v136 offset:0
    ds_read_b64_tr_b16 v[0:1], v128 offset:0
    ds_read_b64_tr_b16 v[2:3], v128 offset:8192
    ds_read_b64_tr_b16 v[4:5], v129 offset:0
    ds_read_b64_tr_b16 v[6:7], v129 offset:8192
    ds_read_b64_tr_b16 v[8:9], v130 offset:0
    ds_read_b64_tr_b16 v[10:11], v130 offset:8192
    ds_read_b64_tr_b16 v[12:13], v131 offset:0
    ds_read_b64_tr_b16 v[14:15], v131 offset:8192
    ds_read_b64_tr_b16 v[16:17], v132 offset:0
    ds_read_b64_tr_b16 v[18:19], v132 offset:8192
    ds_read_b64_tr_b16 v[20:21], v133 offset:0
    ds_read_b64_tr_b16 v[22:23], v133 offset:8192
    ds_read_b64_tr_b16 v[24:25], v134 offset:0
    ds_read_b64_tr_b16 v[26:27], v134 offset:8192
    ds_read_b64_tr_b16 v[28:29], v135 offset:0
    ds_read_b64_tr_b16 v[30:31], v135 offset:8192
    ds_read_b128 v[36:39], v136 offset:1024
    ds_read_b128 v[40:43], v136 offset:2048
    ds_read_b128 v[44:47], v136 offset:3072
main_kernel_w_c1_n_loop:
    s_waitcnt lgkmcnt(0)
    v_mfma_f32_16x16x32_bf16 a[0:3], v[0:3], v[32:35], a[0:3]
    s_waitcnt vmcnt(12)
    s_barrier
    ds_read_b128 v[80:83], v136 offset:8192
    s_add_u32 m0, s20, 0
    s_nop 0
    v_mfma_f32_16x16x32_bf16 a[4:7], v[4:7], v[32:35], a[4:7]
    ds_read_b64_tr_b16 v[48:49], v128 offset:16384
    v_mfma_f32_16x16x32_bf16 a[8:11], v[8:11], v[32:35], a[8:11]
    ds_read_b64_tr_b16 v[50:51], v128 offset:24576
    v_mfma_f32_16x16x32_bf16 a[12:15], v[12:15], v[32:35], a[12:15]
    ds_read_b64_tr_b16 v[52:53], v129 offset:16384
    buffer_load_dwordx4 v141, s[4:7], s16 offen offset:0 sc1 lds
    v_mfma_f32_16x16x32_bf16 a[16:19], v[16:19], v[32:35], a[16:19]
    ds_read_b64_tr_b16 v[54:55], v129 offset:24576
    v_mfma_f32_16x16x32_bf16 a[20:23], v[20:23], v[32:35], a[20:23]
    ds_read_b64_tr_b16 v[56:57], v130 offset:16384
    v_mfma_f32_16x16x32_bf16 a[24:27], v[24:27], v[32:35], a[24:27]
    ds_read_b64_tr_b16 v[58:59], v130 offset:24576
    buffer_load_dwordx4 v142, s[4:7], s16 offen offset:1024 sc1 lds
    v_mfma_f32_16x16x32_bf16 a[28:31], v[28:31], v[32:35], a[28:31]
    ds_read_b64_tr_b16 v[60:61], v131 offset:16384
    v_mfma_f32_16x16x32_bf16 a[32:35], v[0:3], v[36:39], a[32:35]
    ds_read_b64_tr_b16 v[62:63], v131 offset:24576
    v_mfma_f32_16x16x32_bf16 a[36:39], v[4:7], v[36:39], a[36:39]
    ds_read_b64_tr_b16 v[64:65], v132 offset:16384
    s_add_u32 s16, s16, 1024
    v_mfma_f32_16x16x32_bf16 a[40:43], v[8:11], v[36:39], a[40:43]
    ds_read_b64_tr_b16 v[66:67], v132 offset:24576
    v_mfma_f32_16x16x32_bf16 a[44:47], v[12:15], v[36:39], a[44:47]
    ds_read_b64_tr_b16 v[68:69], v133 offset:16384
    v_mfma_f32_16x16x32_bf16 a[48:51], v[16:19], v[36:39], a[48:51]
    ds_read_b64_tr_b16 v[70:71], v133 offset:24576
    s_add_u32 m0, s19, 0
    s_nop 0
    v_mfma_f32_16x16x32_bf16 a[52:55], v[20:23], v[36:39], a[52:55]
    ds_read_b64_tr_b16 v[72:73], v134 offset:16384
    v_mfma_f32_16x16x32_bf16 a[56:59], v[24:27], v[36:39], a[56:59]
    ds_read_b64_tr_b16 v[74:75], v134 offset:24576
    v_mfma_f32_16x16x32_bf16 a[60:63], v[28:31], v[36:39], a[60:63]
    ds_read_b64_tr_b16 v[76:77], v135 offset:16384
    buffer_load_dwordx4 v137, s[8:11], s15 offen offset:0 lds
    v_mfma_f32_16x16x32_bf16 a[64:67], v[0:3], v[40:43], a[64:67]
    ds_read_b64_tr_b16 v[78:79], v135 offset:24576
    v_mfma_f32_16x16x32_bf16 a[68:71], v[4:7], v[40:43], a[68:71]
    ds_read_b128 v[84:87], v136 offset:9216
    v_mfma_f32_16x16x32_bf16 a[72:75], v[8:11], v[40:43], a[72:75]
    ds_read_b128 v[88:91], v136 offset:10240
    buffer_load_dwordx4 v138, s[8:11], s15 offen offset:1024 lds
    v_mfma_f32_16x16x32_bf16 a[76:79], v[12:15], v[40:43], a[76:79]
    ds_read_b128 v[92:95], v136 offset:11264
    v_mfma_f32_16x16x32_bf16 a[80:83], v[16:19], v[40:43], a[80:83]
    v_mfma_f32_16x16x32_bf16 a[84:87], v[20:23], v[40:43], a[84:87]
    buffer_load_dwordx4 v139, s[8:11], s15 offen offset:2048 lds
    v_mfma_f32_16x16x32_bf16 a[88:91], v[24:27], v[40:43], a[88:91]
    v_mfma_f32_16x16x32_bf16 a[92:95], v[28:31], v[40:43], a[92:95]
    v_mfma_f32_16x16x32_bf16 a[96:99], v[0:3], v[44:47], a[96:99]
    buffer_load_dwordx4 v140, s[8:11], s15 offen offset:3072 lds
    v_mfma_f32_16x16x32_bf16 a[100:103], v[4:7], v[44:47], a[100:103]
    v_mfma_f32_16x16x32_bf16 a[104:107], v[8:11], v[44:47], a[104:107]
    v_mfma_f32_16x16x32_bf16 a[108:111], v[12:15], v[44:47], a[108:111]
    s_add_u32 s15, s15, s17
    v_mfma_f32_16x16x32_bf16 a[112:115], v[16:19], v[44:47], a[112:115]
    v_mfma_f32_16x16x32_bf16 a[116:119], v[20:23], v[44:47], a[116:119]
    v_mfma_f32_16x16x32_bf16 a[120:123], v[24:27], v[44:47], a[120:123]
    v_mfma_f32_16x16x32_bf16 a[124:127], v[28:31], v[44:47], a[124:127]
    s_waitcnt lgkmcnt(0)
    v_mfma_f32_16x16x32_bf16 a[0:3], v[48:51], v[80:83], a[0:3]
    s_waitcnt vmcnt(12)
    s_barrier
    ds_read_b128 v[32:35], v136 offset:16384
    s_add_u32 m0, s20, 8192
    s_nop 0
    v_mfma_f32_16x16x32_bf16 a[4:7], v[52:55], v[80:83], a[4:7]
    ds_read_b64_tr_b16 v[0:1], v128 offset:32768
    v_mfma_f32_16x16x32_bf16 a[8:11], v[56:59], v[80:83], a[8:11]
    ds_read_b64_tr_b16 v[2:3], v128 offset:40960
    v_mfma_f32_16x16x32_bf16 a[12:15], v[60:63], v[80:83], a[12:15]
    ds_read_b64_tr_b16 v[4:5], v129 offset:32768
    buffer_load_dwordx4 v141, s[4:7], s16 offen offset:0 sc1 lds
    v_mfma_f32_16x16x32_bf16 a[16:19], v[64:67], v[80:83], a[16:19]
    ds_read_b64_tr_b16 v[6:7], v129 offset:40960
    v_mfma_f32_16x16x32_bf16 a[20:23], v[68:71], v[80:83], a[20:23]
    ds_read_b64_tr_b16 v[8:9], v130 offset:32768
    v_mfma_f32_16x16x32_bf16 a[24:27], v[72:75], v[80:83], a[24:27]
    ds_read_b64_tr_b16 v[10:11], v130 offset:40960
    buffer_load_dwordx4 v142, s[4:7], s16 offen offset:1024 sc1 lds
    v_mfma_f32_16x16x32_bf16 a[28:31], v[76:79], v[80:83], a[28:31]
    ds_read_b64_tr_b16 v[12:13], v131 offset:32768
    v_mfma_f32_16x16x32_bf16 a[32:35], v[48:51], v[84:87], a[32:35]
    ds_read_b64_tr_b16 v[14:15], v131 offset:40960
    v_mfma_f32_16x16x32_bf16 a[36:39], v[52:55], v[84:87], a[36:39]
    ds_read_b64_tr_b16 v[16:17], v132 offset:32768
    s_add_u32 s16, s16, 1024
    v_mfma_f32_16x16x32_bf16 a[40:43], v[56:59], v[84:87], a[40:43]
    ds_read_b64_tr_b16 v[18:19], v132 offset:40960
    v_mfma_f32_16x16x32_bf16 a[44:47], v[60:63], v[84:87], a[44:47]
    ds_read_b64_tr_b16 v[20:21], v133 offset:32768
    v_mfma_f32_16x16x32_bf16 a[48:51], v[64:67], v[84:87], a[48:51]
    ds_read_b64_tr_b16 v[22:23], v133 offset:40960
    s_add_u32 m0, s19, 16384
    s_nop 0
    v_mfma_f32_16x16x32_bf16 a[52:55], v[68:71], v[84:87], a[52:55]
    ds_read_b64_tr_b16 v[24:25], v134 offset:32768
    v_mfma_f32_16x16x32_bf16 a[56:59], v[72:75], v[84:87], a[56:59]
    ds_read_b64_tr_b16 v[26:27], v134 offset:40960
    v_mfma_f32_16x16x32_bf16 a[60:63], v[76:79], v[84:87], a[60:63]
    ds_read_b64_tr_b16 v[28:29], v135 offset:32768
    buffer_load_dwordx4 v137, s[8:11], s15 offen offset:0 lds
    v_mfma_f32_16x16x32_bf16 a[64:67], v[48:51], v[88:91], a[64:67]
    ds_read_b64_tr_b16 v[30:31], v135 offset:40960
    v_mfma_f32_16x16x32_bf16 a[68:71], v[52:55], v[88:91], a[68:71]
    ds_read_b128 v[36:39], v136 offset:17408
    v_mfma_f32_16x16x32_bf16 a[72:75], v[56:59], v[88:91], a[72:75]
    ds_read_b128 v[40:43], v136 offset:18432
    buffer_load_dwordx4 v138, s[8:11], s15 offen offset:1024 lds
    v_mfma_f32_16x16x32_bf16 a[76:79], v[60:63], v[88:91], a[76:79]
    ds_read_b128 v[44:47], v136 offset:19456
    v_mfma_f32_16x16x32_bf16 a[80:83], v[64:67], v[88:91], a[80:83]
    v_mfma_f32_16x16x32_bf16 a[84:87], v[68:71], v[88:91], a[84:87]
    buffer_load_dwordx4 v139, s[8:11], s15 offen offset:2048 lds
    v_mfma_f32_16x16x32_bf16 a[88:91], v[72:75], v[88:91], a[88:91]
    v_mfma_f32_16x16x32_bf16 a[92:95], v[76:79], v[88:91], a[92:95]
    v_mfma_f32_16x16x32_bf16 a[96:99], v[48:51], v[92:95], a[96:99]
    buffer_load_dwordx4 v140, s[8:11], s15 offen offset:3072 lds
    v_mfma_f32_16x16x32_bf16 a[100:103], v[52:55], v[92:95], a[100:103]
    v_mfma_f32_16x16x32_bf16 a[104:107], v[56:59], v[92:95], a[104:107]
    v_mfma_f32_16x16x32_bf16 a[108:111], v[60:63], v[92:95], a[108:111]
    s_add_u32 s15, s15, s17
    v_mfma_f32_16x16x32_bf16 a[112:115], v[64:67], v[92:95], a[112:115]
    v_mfma_f32_16x16x32_bf16 a[116:119], v[68:71], v[92:95], a[116:119]
    v_mfma_f32_16x16x32_bf16 a[120:123], v[72:75], v[92:95], a[120:123]
    v_mfma_f32_16x16x32_bf16 a[124:127], v[76:79], v[92:95], a[124:127]
    s_waitcnt lgkmcnt(0)
    v_mfma_f32_16x16x32_bf16 a[0:3], v[0:3], v[32:35], a[0:3]
    s_waitcnt vmcnt(12)
    s_barrier
    ds_read_b128 v[80:83], v136 offset:24576
    s_add_u32 m0, s20, 16384
    s_nop 0
    v_mfma_f32_16x16x32_bf16 a[4:7], v[4:7], v[32:35], a[4:7]
    ds_read_b64_tr_b16 v[48:49], v128 offset:49152
    v_mfma_f32_16x16x32_bf16 a[8:11], v[8:11], v[32:35], a[8:11]
    ds_read_b64_tr_b16 v[50:51], v128 offset:57344
    v_mfma_f32_16x16x32_bf16 a[12:15], v[12:15], v[32:35], a[12:15]
    ds_read_b64_tr_b16 v[52:53], v129 offset:49152
    buffer_load_dwordx4 v141, s[4:7], s16 offen offset:0 sc1 lds
    v_mfma_f32_16x16x32_bf16 a[16:19], v[16:19], v[32:35], a[16:19]
    ds_read_b64_tr_b16 v[54:55], v129 offset:57344
    v_mfma_f32_16x16x32_bf16 a[20:23], v[20:23], v[32:35], a[20:23]
    ds_read_b64_tr_b16 v[56:57], v130 offset:49152
    v_mfma_f32_16x16x32_bf16 a[24:27], v[24:27], v[32:35], a[24:27]
    ds_read_b64_tr_b16 v[58:59], v130 offset:57344
    buffer_load_dwordx4 v142, s[4:7], s16 offen offset:1024 sc1 lds
    v_mfma_f32_16x16x32_bf16 a[28:31], v[28:31], v[32:35], a[28:31]
    ds_read_b64_tr_b16 v[60:61], v131 offset:49152
    v_mfma_f32_16x16x32_bf16 a[32:35], v[0:3], v[36:39], a[32:35]
    ds_read_b64_tr_b16 v[62:63], v131 offset:57344
    v_mfma_f32_16x16x32_bf16 a[36:39], v[4:7], v[36:39], a[36:39]
    ds_read_b64_tr_b16 v[64:65], v132 offset:49152
    s_add_u32 s16, s16, 1024
    v_mfma_f32_16x16x32_bf16 a[40:43], v[8:11], v[36:39], a[40:43]
    ds_read_b64_tr_b16 v[66:67], v132 offset:57344
    v_mfma_f32_16x16x32_bf16 a[44:47], v[12:15], v[36:39], a[44:47]
    ds_read_b64_tr_b16 v[68:69], v133 offset:49152
    v_mfma_f32_16x16x32_bf16 a[48:51], v[16:19], v[36:39], a[48:51]
    ds_read_b64_tr_b16 v[70:71], v133 offset:57344
    s_add_u32 m0, s19, 32768
    s_nop 0
    v_mfma_f32_16x16x32_bf16 a[52:55], v[20:23], v[36:39], a[52:55]
    ds_read_b64_tr_b16 v[72:73], v134 offset:49152
    v_mfma_f32_16x16x32_bf16 a[56:59], v[24:27], v[36:39], a[56:59]
    ds_read_b64_tr_b16 v[74:75], v134 offset:57344
    v_mfma_f32_16x16x32_bf16 a[60:63], v[28:31], v[36:39], a[60:63]
    ds_read_b64_tr_b16 v[76:77], v135 offset:49152
    buffer_load_dwordx4 v137, s[8:11], s15 offen offset:0 lds
    v_mfma_f32_16x16x32_bf16 a[64:67], v[0:3], v[40:43], a[64:67]
    ds_read_b64_tr_b16 v[78:79], v135 offset:57344
    v_mfma_f32_16x16x32_bf16 a[68:71], v[4:7], v[40:43], a[68:71]
    ds_read_b128 v[84:87], v136 offset:25600
    v_mfma_f32_16x16x32_bf16 a[72:75], v[8:11], v[40:43], a[72:75]
    ds_read_b128 v[88:91], v136 offset:26624
    buffer_load_dwordx4 v138, s[8:11], s15 offen offset:1024 lds
    v_mfma_f32_16x16x32_bf16 a[76:79], v[12:15], v[40:43], a[76:79]
    ds_read_b128 v[92:95], v136 offset:27648
    v_mfma_f32_16x16x32_bf16 a[80:83], v[16:19], v[40:43], a[80:83]
    v_mfma_f32_16x16x32_bf16 a[84:87], v[20:23], v[40:43], a[84:87]
    buffer_load_dwordx4 v139, s[8:11], s15 offen offset:2048 lds
    v_mfma_f32_16x16x32_bf16 a[88:91], v[24:27], v[40:43], a[88:91]
    v_mfma_f32_16x16x32_bf16 a[92:95], v[28:31], v[40:43], a[92:95]
    v_mfma_f32_16x16x32_bf16 a[96:99], v[0:3], v[44:47], a[96:99]
    buffer_load_dwordx4 v140, s[8:11], s15 offen offset:3072 lds
    v_mfma_f32_16x16x32_bf16 a[100:103], v[4:7], v[44:47], a[100:103]
    v_mfma_f32_16x16x32_bf16 a[104:107], v[8:11], v[44:47], a[104:107]
    v_mfma_f32_16x16x32_bf16 a[108:111], v[12:15], v[44:47], a[108:111]
    s_add_u32 s15, s15, s17
    v_mfma_f32_16x16x32_bf16 a[112:115], v[16:19], v[44:47], a[112:115]
    v_mfma_f32_16x16x32_bf16 a[116:119], v[20:23], v[44:47], a[116:119]
    v_mfma_f32_16x16x32_bf16 a[120:123], v[24:27], v[44:47], a[120:123]
    v_mfma_f32_16x16x32_bf16 a[124:127], v[28:31], v[44:47], a[124:127]
    s_waitcnt lgkmcnt(0)
    v_mfma_f32_16x16x32_bf16 a[0:3], v[48:51], v[80:83], a[0:3]
    s_waitcnt vmcnt(12)
    s_barrier
    ds_read_b128 v[32:35], v136 offset:0
    s_add_u32 m0, s20, 24576
    s_nop 0
    v_mfma_f32_16x16x32_bf16 a[4:7], v[52:55], v[80:83], a[4:7]
    ds_read_b64_tr_b16 v[0:1], v128 offset:0
    v_mfma_f32_16x16x32_bf16 a[8:11], v[56:59], v[80:83], a[8:11]
    ds_read_b64_tr_b16 v[2:3], v128 offset:8192
    v_mfma_f32_16x16x32_bf16 a[12:15], v[60:63], v[80:83], a[12:15]
    ds_read_b64_tr_b16 v[4:5], v129 offset:0
    buffer_load_dwordx4 v141, s[4:7], s16 offen offset:0 sc1 lds
    v_mfma_f32_16x16x32_bf16 a[16:19], v[64:67], v[80:83], a[16:19]
    ds_read_b64_tr_b16 v[6:7], v129 offset:8192
    v_mfma_f32_16x16x32_bf16 a[20:23], v[68:71], v[80:83], a[20:23]
    ds_read_b64_tr_b16 v[8:9], v130 offset:0
    v_mfma_f32_16x16x32_bf16 a[24:27], v[72:75], v[80:83], a[24:27]
    ds_read_b64_tr_b16 v[10:11], v130 offset:8192
    buffer_load_dwordx4 v142, s[4:7], s16 offen offset:1024 sc1 lds
    v_mfma_f32_16x16x32_bf16 a[28:31], v[76:79], v[80:83], a[28:31]
    ds_read_b64_tr_b16 v[12:13], v131 offset:0
    v_mfma_f32_16x16x32_bf16 a[32:35], v[48:51], v[84:87], a[32:35]
    ds_read_b64_tr_b16 v[14:15], v131 offset:8192
    v_mfma_f32_16x16x32_bf16 a[36:39], v[52:55], v[84:87], a[36:39]
    ds_read_b64_tr_b16 v[16:17], v132 offset:0
    s_add_u32 s16, s16, 1024
    v_mfma_f32_16x16x32_bf16 a[40:43], v[56:59], v[84:87], a[40:43]
    ds_read_b64_tr_b16 v[18:19], v132 offset:8192
    v_mfma_f32_16x16x32_bf16 a[44:47], v[60:63], v[84:87], a[44:47]
    ds_read_b64_tr_b16 v[20:21], v133 offset:0
    v_mfma_f32_16x16x32_bf16 a[48:51], v[64:67], v[84:87], a[48:51]
    ds_read_b64_tr_b16 v[22:23], v133 offset:8192
    s_add_u32 m0, s19, 49152
    s_nop 0
    v_mfma_f32_16x16x32_bf16 a[52:55], v[68:71], v[84:87], a[52:55]
    ds_read_b64_tr_b16 v[24:25], v134 offset:0
    v_mfma_f32_16x16x32_bf16 a[56:59], v[72:75], v[84:87], a[56:59]
    ds_read_b64_tr_b16 v[26:27], v134 offset:8192
    v_mfma_f32_16x16x32_bf16 a[60:63], v[76:79], v[84:87], a[60:63]
    ds_read_b64_tr_b16 v[28:29], v135 offset:0
    buffer_load_dwordx4 v137, s[8:11], s15 offen offset:0 lds
    v_mfma_f32_16x16x32_bf16 a[64:67], v[48:51], v[88:91], a[64:67]
    ds_read_b64_tr_b16 v[30:31], v135 offset:8192
    v_mfma_f32_16x16x32_bf16 a[68:71], v[52:55], v[88:91], a[68:71]
    ds_read_b128 v[36:39], v136 offset:1024
    v_mfma_f32_16x16x32_bf16 a[72:75], v[56:59], v[88:91], a[72:75]
    ds_read_b128 v[40:43], v136 offset:2048
    buffer_load_dwordx4 v138, s[8:11], s15 offen offset:1024 lds
    v_mfma_f32_16x16x32_bf16 a[76:79], v[60:63], v[88:91], a[76:79]
    ds_read_b128 v[44:47], v136 offset:3072
    v_mfma_f32_16x16x32_bf16 a[80:83], v[64:67], v[88:91], a[80:83]
    v_mfma_f32_16x16x32_bf16 a[84:87], v[68:71], v[88:91], a[84:87]
    buffer_load_dwordx4 v139, s[8:11], s15 offen offset:2048 lds
    v_mfma_f32_16x16x32_bf16 a[88:91], v[72:75], v[88:91], a[88:91]
    v_mfma_f32_16x16x32_bf16 a[92:95], v[76:79], v[88:91], a[92:95]
    v_mfma_f32_16x16x32_bf16 a[96:99], v[48:51], v[92:95], a[96:99]
    buffer_load_dwordx4 v140, s[8:11], s15 offen offset:3072 lds
    v_mfma_f32_16x16x32_bf16 a[100:103], v[52:55], v[92:95], a[100:103]
    v_mfma_f32_16x16x32_bf16 a[104:107], v[56:59], v[92:95], a[104:107]
    v_mfma_f32_16x16x32_bf16 a[108:111], v[60:63], v[92:95], a[108:111]
    s_add_u32 s15, s15, s17
    v_mfma_f32_16x16x32_bf16 a[112:115], v[64:67], v[92:95], a[112:115]
    v_mfma_f32_16x16x32_bf16 a[116:119], v[68:71], v[92:95], a[116:119]
    v_mfma_f32_16x16x32_bf16 a[120:123], v[72:75], v[92:95], a[120:123]
    v_mfma_f32_16x16x32_bf16 a[124:127], v[76:79], v[92:95], a[124:127]
    s_sub_u32 s18, s18, 1
    s_cmp_lg_u32 s18, 0
    s_cbranch_scc1 main_kernel_w_c1_n_loop
    s_cmp_lg_u32 s14, 0
    s_cbranch_scc1 main_kernel_w_c1_n_nt
    s_lshl_b32 s32, s27, 8
    s_add_u32 s32, s32, 0x841e000
    v_mov_b32 v255, 1
    s_mov_b64 exec, 1
    buffer_atomic_add v255, off, s[4:7], s32 sc0 sc1
    s_mov_b64 exec, -1
main_kernel_w_c1_n_nt:
    s_waitcnt lgkmcnt(0)
    v_mfma_f32_16x16x32_bf16 a[0:3], v[0:3], v[32:35], a[0:3]
    s_waitcnt vmcnt(12)
    s_barrier
    ds_read_b128 v[80:83], v136 offset:8192
    v_mfma_f32_16x16x32_bf16 a[4:7], v[4:7], v[32:35], a[4:7]
    ds_read_b64_tr_b16 v[48:49], v128 offset:16384
    v_mfma_f32_16x16x32_bf16 a[8:11], v[8:11], v[32:35], a[8:11]
    ds_read_b64_tr_b16 v[50:51], v128 offset:24576
    v_mfma_f32_16x16x32_bf16 a[12:15], v[12:15], v[32:35], a[12:15]
    ds_read_b64_tr_b16 v[52:53], v129 offset:16384
    v_mfma_f32_16x16x32_bf16 a[16:19], v[16:19], v[32:35], a[16:19]
    ds_read_b64_tr_b16 v[54:55], v129 offset:24576
    v_mfma_f32_16x16x32_bf16 a[20:23], v[20:23], v[32:35], a[20:23]
    ds_read_b64_tr_b16 v[56:57], v130 offset:16384
    v_mfma_f32_16x16x32_bf16 a[24:27], v[24:27], v[32:35], a[24:27]
    ds_read_b64_tr_b16 v[58:59], v130 offset:24576
    v_mfma_f32_16x16x32_bf16 a[28:31], v[28:31], v[32:35], a[28:31]
    ds_read_b64_tr_b16 v[60:61], v131 offset:16384
    v_mfma_f32_16x16x32_bf16 a[32:35], v[0:3], v[36:39], a[32:35]
    ds_read_b64_tr_b16 v[62:63], v131 offset:24576
    v_mfma_f32_16x16x32_bf16 a[36:39], v[4:7], v[36:39], a[36:39]
    ds_read_b64_tr_b16 v[64:65], v132 offset:16384
    v_mfma_f32_16x16x32_bf16 a[40:43], v[8:11], v[36:39], a[40:43]
    ds_read_b64_tr_b16 v[66:67], v132 offset:24576
    v_mfma_f32_16x16x32_bf16 a[44:47], v[12:15], v[36:39], a[44:47]
    ds_read_b64_tr_b16 v[68:69], v133 offset:16384
    v_mfma_f32_16x16x32_bf16 a[48:51], v[16:19], v[36:39], a[48:51]
    ds_read_b64_tr_b16 v[70:71], v133 offset:24576
    v_mfma_f32_16x16x32_bf16 a[52:55], v[20:23], v[36:39], a[52:55]
    ds_read_b64_tr_b16 v[72:73], v134 offset:16384
    v_mfma_f32_16x16x32_bf16 a[56:59], v[24:27], v[36:39], a[56:59]
    ds_read_b64_tr_b16 v[74:75], v134 offset:24576
    v_mfma_f32_16x16x32_bf16 a[60:63], v[28:31], v[36:39], a[60:63]
    ds_read_b64_tr_b16 v[76:77], v135 offset:16384
    v_mfma_f32_16x16x32_bf16 a[64:67], v[0:3], v[40:43], a[64:67]
    ds_read_b64_tr_b16 v[78:79], v135 offset:24576
    v_mfma_f32_16x16x32_bf16 a[68:71], v[4:7], v[40:43], a[68:71]
    ds_read_b128 v[84:87], v136 offset:9216
    v_mfma_f32_16x16x32_bf16 a[72:75], v[8:11], v[40:43], a[72:75]
    ds_read_b128 v[88:91], v136 offset:10240
    v_mfma_f32_16x16x32_bf16 a[76:79], v[12:15], v[40:43], a[76:79]
    ds_read_b128 v[92:95], v136 offset:11264
    v_mfma_f32_16x16x32_bf16 a[80:83], v[16:19], v[40:43], a[80:83]
    v_mfma_f32_16x16x32_bf16 a[84:87], v[20:23], v[40:43], a[84:87]
    v_mfma_f32_16x16x32_bf16 a[88:91], v[24:27], v[40:43], a[88:91]
    v_mfma_f32_16x16x32_bf16 a[92:95], v[28:31], v[40:43], a[92:95]
    v_mfma_f32_16x16x32_bf16 a[96:99], v[0:3], v[44:47], a[96:99]
    v_mfma_f32_16x16x32_bf16 a[100:103], v[4:7], v[44:47], a[100:103]
    v_mfma_f32_16x16x32_bf16 a[104:107], v[8:11], v[44:47], a[104:107]
    v_mfma_f32_16x16x32_bf16 a[108:111], v[12:15], v[44:47], a[108:111]
    v_mfma_f32_16x16x32_bf16 a[112:115], v[16:19], v[44:47], a[112:115]
    v_mfma_f32_16x16x32_bf16 a[116:119], v[20:23], v[44:47], a[116:119]
    v_mfma_f32_16x16x32_bf16 a[120:123], v[24:27], v[44:47], a[120:123]
    v_mfma_f32_16x16x32_bf16 a[124:127], v[28:31], v[44:47], a[124:127]
    s_waitcnt lgkmcnt(0)
    v_mfma_f32_16x16x32_bf16 a[0:3], v[48:51], v[80:83], a[0:3]
    s_waitcnt vmcnt(6)
    s_barrier
    ds_read_b128 v[32:35], v136 offset:16384
    v_mfma_f32_16x16x32_bf16 a[4:7], v[52:55], v[80:83], a[4:7]
    ds_read_b64_tr_b16 v[0:1], v128 offset:32768
    v_mfma_f32_16x16x32_bf16 a[8:11], v[56:59], v[80:83], a[8:11]
    ds_read_b64_tr_b16 v[2:3], v128 offset:40960
    v_mfma_f32_16x16x32_bf16 a[12:15], v[60:63], v[80:83], a[12:15]
    ds_read_b64_tr_b16 v[4:5], v129 offset:32768
    v_mfma_f32_16x16x32_bf16 a[16:19], v[64:67], v[80:83], a[16:19]
    ds_read_b64_tr_b16 v[6:7], v129 offset:40960
    v_mfma_f32_16x16x32_bf16 a[20:23], v[68:71], v[80:83], a[20:23]
    ds_read_b64_tr_b16 v[8:9], v130 offset:32768
    v_mfma_f32_16x16x32_bf16 a[24:27], v[72:75], v[80:83], a[24:27]
    ds_read_b64_tr_b16 v[10:11], v130 offset:40960
    v_mfma_f32_16x16x32_bf16 a[28:31], v[76:79], v[80:83], a[28:31]
    ds_read_b64_tr_b16 v[12:13], v131 offset:32768
    v_mfma_f32_16x16x32_bf16 a[32:35], v[48:51], v[84:87], a[32:35]
    ds_read_b64_tr_b16 v[14:15], v131 offset:40960
    v_mfma_f32_16x16x32_bf16 a[36:39], v[52:55], v[84:87], a[36:39]
    ds_read_b64_tr_b16 v[16:17], v132 offset:32768
    v_mfma_f32_16x16x32_bf16 a[40:43], v[56:59], v[84:87], a[40:43]
    ds_read_b64_tr_b16 v[18:19], v132 offset:40960
    v_mfma_f32_16x16x32_bf16 a[44:47], v[60:63], v[84:87], a[44:47]
    ds_read_b64_tr_b16 v[20:21], v133 offset:32768
    v_mfma_f32_16x16x32_bf16 a[48:51], v[64:67], v[84:87], a[48:51]
    ds_read_b64_tr_b16 v[22:23], v133 offset:40960
    v_mfma_f32_16x16x32_bf16 a[52:55], v[68:71], v[84:87], a[52:55]
    ds_read_b64_tr_b16 v[24:25], v134 offset:32768
    v_mfma_f32_16x16x32_bf16 a[56:59], v[72:75], v[84:87], a[56:59]
    ds_read_b64_tr_b16 v[26:27], v134 offset:40960
    v_mfma_f32_16x16x32_bf16 a[60:63], v[76:79], v[84:87], a[60:63]
    ds_read_b64_tr_b16 v[28:29], v135 offset:32768
    v_mfma_f32_16x16x32_bf16 a[64:67], v[48:51], v[88:91], a[64:67]
    ds_read_b64_tr_b16 v[30:31], v135 offset:40960
    v_mfma_f32_16x16x32_bf16 a[68:71], v[52:55], v[88:91], a[68:71]
    ds_read_b128 v[36:39], v136 offset:17408
    v_mfma_f32_16x16x32_bf16 a[72:75], v[56:59], v[88:91], a[72:75]
    ds_read_b128 v[40:43], v136 offset:18432
    v_mfma_f32_16x16x32_bf16 a[76:79], v[60:63], v[88:91], a[76:79]
    ds_read_b128 v[44:47], v136 offset:19456
    v_mfma_f32_16x16x32_bf16 a[80:83], v[64:67], v[88:91], a[80:83]
    v_mfma_f32_16x16x32_bf16 a[84:87], v[68:71], v[88:91], a[84:87]
    v_mfma_f32_16x16x32_bf16 a[88:91], v[72:75], v[88:91], a[88:91]
    v_mfma_f32_16x16x32_bf16 a[92:95], v[76:79], v[88:91], a[92:95]
    v_mfma_f32_16x16x32_bf16 a[96:99], v[48:51], v[92:95], a[96:99]
    v_mfma_f32_16x16x32_bf16 a[100:103], v[52:55], v[92:95], a[100:103]
    v_mfma_f32_16x16x32_bf16 a[104:107], v[56:59], v[92:95], a[104:107]
    v_mfma_f32_16x16x32_bf16 a[108:111], v[60:63], v[92:95], a[108:111]
    v_mfma_f32_16x16x32_bf16 a[112:115], v[64:67], v[92:95], a[112:115]
    v_mfma_f32_16x16x32_bf16 a[116:119], v[68:71], v[92:95], a[116:119]
    v_mfma_f32_16x16x32_bf16 a[120:123], v[72:75], v[92:95], a[120:123]
    v_mfma_f32_16x16x32_bf16 a[124:127], v[76:79], v[92:95], a[124:127]
    s_waitcnt lgkmcnt(0)
    v_mfma_f32_16x16x32_bf16 a[0:3], v[0:3], v[32:35], a[0:3]
    s_waitcnt vmcnt(0)
    s_barrier
    ds_read_b128 v[80:83], v136 offset:24576
    v_mfma_f32_16x16x32_bf16 a[4:7], v[4:7], v[32:35], a[4:7]
    ds_read_b64_tr_b16 v[48:49], v128 offset:49152
    v_mfma_f32_16x16x32_bf16 a[8:11], v[8:11], v[32:35], a[8:11]
    ds_read_b64_tr_b16 v[50:51], v128 offset:57344
    v_mfma_f32_16x16x32_bf16 a[12:15], v[12:15], v[32:35], a[12:15]
    ds_read_b64_tr_b16 v[52:53], v129 offset:49152
    v_mfma_f32_16x16x32_bf16 a[16:19], v[16:19], v[32:35], a[16:19]
    ds_read_b64_tr_b16 v[54:55], v129 offset:57344
    v_mfma_f32_16x16x32_bf16 a[20:23], v[20:23], v[32:35], a[20:23]
    ds_read_b64_tr_b16 v[56:57], v130 offset:49152
    v_mfma_f32_16x16x32_bf16 a[24:27], v[24:27], v[32:35], a[24:27]
    ds_read_b64_tr_b16 v[58:59], v130 offset:57344
    v_mfma_f32_16x16x32_bf16 a[28:31], v[28:31], v[32:35], a[28:31]
    ds_read_b64_tr_b16 v[60:61], v131 offset:49152
    v_mfma_f32_16x16x32_bf16 a[32:35], v[0:3], v[36:39], a[32:35]
    ds_read_b64_tr_b16 v[62:63], v131 offset:57344
    v_mfma_f32_16x16x32_bf16 a[36:39], v[4:7], v[36:39], a[36:39]
    ds_read_b64_tr_b16 v[64:65], v132 offset:49152
    v_mfma_f32_16x16x32_bf16 a[40:43], v[8:11], v[36:39], a[40:43]
    ds_read_b64_tr_b16 v[66:67], v132 offset:57344
    v_mfma_f32_16x16x32_bf16 a[44:47], v[12:15], v[36:39], a[44:47]
    ds_read_b64_tr_b16 v[68:69], v133 offset:49152
    v_mfma_f32_16x16x32_bf16 a[48:51], v[16:19], v[36:39], a[48:51]
    ds_read_b64_tr_b16 v[70:71], v133 offset:57344
    v_mfma_f32_16x16x32_bf16 a[52:55], v[20:23], v[36:39], a[52:55]
    ds_read_b64_tr_b16 v[72:73], v134 offset:49152
    v_mfma_f32_16x16x32_bf16 a[56:59], v[24:27], v[36:39], a[56:59]
    ds_read_b64_tr_b16 v[74:75], v134 offset:57344
    v_mfma_f32_16x16x32_bf16 a[60:63], v[28:31], v[36:39], a[60:63]
    ds_read_b64_tr_b16 v[76:77], v135 offset:49152
    v_mfma_f32_16x16x32_bf16 a[64:67], v[0:3], v[40:43], a[64:67]
    ds_read_b64_tr_b16 v[78:79], v135 offset:57344
    v_mfma_f32_16x16x32_bf16 a[68:71], v[4:7], v[40:43], a[68:71]
    ds_read_b128 v[84:87], v136 offset:25600
    v_mfma_f32_16x16x32_bf16 a[72:75], v[8:11], v[40:43], a[72:75]
    ds_read_b128 v[88:91], v136 offset:26624
    v_mfma_f32_16x16x32_bf16 a[76:79], v[12:15], v[40:43], a[76:79]
    ds_read_b128 v[92:95], v136 offset:27648
    v_mfma_f32_16x16x32_bf16 a[80:83], v[16:19], v[40:43], a[80:83]
    v_mfma_f32_16x16x32_bf16 a[84:87], v[20:23], v[40:43], a[84:87]
    v_mfma_f32_16x16x32_bf16 a[88:91], v[24:27], v[40:43], a[88:91]
    v_mfma_f32_16x16x32_bf16 a[92:95], v[28:31], v[40:43], a[92:95]
    v_mfma_f32_16x16x32_bf16 a[96:99], v[0:3], v[44:47], a[96:99]
    v_mfma_f32_16x16x32_bf16 a[100:103], v[4:7], v[44:47], a[100:103]
    v_mfma_f32_16x16x32_bf16 a[104:107], v[8:11], v[44:47], a[104:107]
    v_mfma_f32_16x16x32_bf16 a[108:111], v[12:15], v[44:47], a[108:111]
    v_mfma_f32_16x16x32_bf16 a[112:115], v[16:19], v[44:47], a[112:115]
    v_mfma_f32_16x16x32_bf16 a[116:119], v[20:23], v[44:47], a[116:119]
    v_mfma_f32_16x16x32_bf16 a[120:123], v[24:27], v[44:47], a[120:123]
    v_mfma_f32_16x16x32_bf16 a[124:127], v[28:31], v[44:47], a[124:127]
    v_readfirstlane_b32 s55, v255
    s_waitcnt lgkmcnt(0)
    v_mfma_f32_16x16x32_bf16 a[0:3], v[48:51], v[80:83], a[0:3]
    v_mfma_f32_16x16x32_bf16 a[4:7], v[52:55], v[80:83], a[4:7]
    v_mfma_f32_16x16x32_bf16 a[8:11], v[56:59], v[80:83], a[8:11]
    v_mfma_f32_16x16x32_bf16 a[12:15], v[60:63], v[80:83], a[12:15]
    v_mfma_f32_16x16x32_bf16 a[16:19], v[64:67], v[80:83], a[16:19]
    v_mfma_f32_16x16x32_bf16 a[20:23], v[68:71], v[80:83], a[20:23]
    v_mfma_f32_16x16x32_bf16 a[24:27], v[72:75], v[80:83], a[24:27]
    v_mfma_f32_16x16x32_bf16 a[28:31], v[76:79], v[80:83], a[28:31]
    v_mfma_f32_16x16x32_bf16 a[32:35], v[48:51], v[84:87], a[32:35]
    v_mfma_f32_16x16x32_bf16 a[36:39], v[52:55], v[84:87], a[36:39]
    v_mfma_f32_16x16x32_bf16 a[40:43], v[56:59], v[84:87], a[40:43]
    v_mfma_f32_16x16x32_bf16 a[44:47], v[60:63], v[84:87], a[44:47]
    v_mfma_f32_16x16x32_bf16 a[48:51], v[64:67], v[84:87], a[48:51]
    v_mfma_f32_16x16x32_bf16 a[52:55], v[68:71], v[84:87], a[52:55]
    v_mfma_f32_16x16x32_bf16 a[56:59], v[72:75], v[84:87], a[56:59]
    v_mfma_f32_16x16x32_bf16 a[60:63], v[76:79], v[84:87], a[60:63]
    v_mfma_f32_16x16x32_bf16 a[64:67], v[48:51], v[88:91], a[64:67]
    v_mfma_f32_16x16x32_bf16 a[68:71], v[52:55], v[88:91], a[68:71]
    v_mfma_f32_16x16x32_bf16 a[72:75], v[56:59], v[88:91], a[72:75]
    v_mfma_f32_16x16x32_bf16 a[76:79], v[60:63], v[88:91], a[76:79]
    v_mfma_f32_16x16x32_bf16 a[80:83], v[64:67], v[88:91], a[80:83]
    v_mfma_f32_16x16x32_bf16 a[84:87], v[68:71], v[88:91], a[84:87]
    v_mfma_f32_16x16x32_bf16 a[88:91], v[72:75], v[88:91], a[88:91]
    v_mfma_f32_16x16x32_bf16 a[92:95], v[76:79], v[88:91], a[92:95]
    v_mfma_f32_16x16x32_bf16 a[96:99], v[48:51], v[92:95], a[96:99]
    v_mfma_f32_16x16x32_bf16 a[100:103], v[52:55], v[92:95], a[100:103]
    v_mfma_f32_16x16x32_bf16 a[104:107], v[56:59], v[92:95], a[104:107]
    v_mfma_f32_16x16x32_bf16 a[108:111], v[60:63], v[92:95], a[108:111]
    v_mfma_f32_16x16x32_bf16 a[112:115], v[64:67], v[92:95], a[112:115]
    v_mfma_f32_16x16x32_bf16 a[116:119], v[68:71], v[92:95], a[116:119]
    v_mfma_f32_16x16x32_bf16 a[120:123], v[72:75], v[92:95], a[120:123]
    v_mfma_f32_16x16x32_bf16 a[124:127], v[76:79], v[92:95], a[124:127]
    s_nop 7
    s_cmp_eq_u32 s23, 1
    s_cbranch_scc1 main_kernel_w_c1_escl
    s_cmp_eq_u32 s23, 3
    s_cbranch_scc1 main_kernel_w_c1_egelus
    s_cmp_eq_u32 s23, 6
    s_cbranch_scc1 main_kernel_w_c1_egelu
main_kernel_w_c1_eplain:
    s_mov_b32 s53, s21
    v_accvgpr_read_b32 v0, a0
    v_accvgpr_read_b32 v1, a1
    v_accvgpr_read_b32 v2, a2
    v_accvgpr_read_b32 v3, a3
    v_accvgpr_read_b32 v4, a4
    v_accvgpr_read_b32 v5, a5
    v_accvgpr_read_b32 v6, a6
    v_accvgpr_read_b32 v7, a7
    v_cvt_pk_bf16_f32 v16, v0, v1
    v_cvt_pk_bf16_f32 v17, v2, v3
    v_cvt_pk_bf16_f32 v18, v4, v5
    v_cvt_pk_bf16_f32 v19, v6, v7
    buffer_store_dwordx4 v[16:19], v251, s[4:7], s53 offen offset:0 sc1
    v_accvgpr_read_b32 v20, a8
    v_accvgpr_read_b32 v21, a9
    v_accvgpr_read_b32 v22, a10
    v_accvgpr_read_b32 v23, a11
    v_accvgpr_read_b32 v24, a12
    v_accvgpr_read_b32 v25, a13
    v_accvgpr_read_b32 v26, a14
    v_accvgpr_read_b32 v27, a15
    v_cvt_pk_bf16_f32 v36, v20, v21
    v_cvt_pk_bf16_f32 v37, v22, v23
    v_cvt_pk_bf16_f32 v38, v24, v25
    v_cvt_pk_bf16_f32 v39, v26, v27
    buffer_store_dwordx4 v[36:39], v251, s[4:7], s53 offen offset:1024 sc1
    v_accvgpr_read_b32 v40, a16
    v_accvgpr_read_b32 v41, a17
    v_accvgpr_read_b32 v42, a18
    v_accvgpr_read_b32 v43, a19
    v_accvgpr_read_b32 v44, a20
    v_accvgpr_read_b32 v45, a21
    v_accvgpr_read_b32 v46, a22
    v_accvgpr_read_b32 v47, a23
    v_cvt_pk_bf16_f32 v56, v40, v41
    v_cvt_pk_bf16_f32 v57, v42, v43
    v_cvt_pk_bf16_f32 v58, v44, v45
    v_cvt_pk_bf16_f32 v59, v46, v47
    buffer_store_dwordx4 v[56:59], v251, s[4:7], s53 offen offset:2048 sc1
    v_accvgpr_read_b32 v0, a24
    v_accvgpr_read_b32 v1, a25
    v_accvgpr_read_b32 v2, a26
    v_accvgpr_read_b32 v3, a27
    v_accvgpr_read_b32 v4, a28
    v_accvgpr_read_b32 v5, a29
    v_accvgpr_read_b32 v6, a30
    v_accvgpr_read_b32 v7, a31
    v_cvt_pk_bf16_f32 v16, v0, v1
    v_cvt_pk_bf16_f32 v17, v2, v3
    v_cvt_pk_bf16_f32 v18, v4, v5
    v_cvt_pk_bf16_f32 v19, v6, v7
    buffer_store_dwordx4 v[16:19], v251, s[4:7], s53 offen offset:3072 sc1
    s_add_u32 s53, s53, s22
    v_accvgpr_read_b32 v20, a32
    v_accvgpr_read_b32 v21, a33
    v_accvgpr_read_b32 v22, a34
    v_accvgpr_read_b32 v23, a35
    v_accvgpr_read_b32 v24, a36
    v_accvgpr_read_b32 v25, a37
    v_accvgpr_read_b32 v26, a38
    v_accvgpr_read_b32 v27, a39
    v_cvt_pk_bf16_f32 v36, v20, v21
    v_cvt_pk_bf16_f32 v37, v22, v23
    v_cvt_pk_bf16_f32 v38, v24, v25
    v_cvt_pk_bf16_f32 v39, v26, v27
    buffer_store_dwordx4 v[36:39], v251, s[4:7], s53 offen offset:0 sc1
    v_accvgpr_read_b32 v40, a40
    v_accvgpr_read_b32 v41, a41
    v_accvgpr_read_b32 v42, a42
    v_accvgpr_read_b32 v43, a43
    v_accvgpr_read_b32 v44, a44
    v_accvgpr_read_b32 v45, a45
    v_accvgpr_read_b32 v46, a46
    v_accvgpr_read_b32 v47, a47
    v_cvt_pk_bf16_f32 v56, v40, v41
    v_cvt_pk_bf16_f32 v57, v42, v43
    v_cvt_pk_bf16_f32 v58, v44, v45
    v_cvt_pk_bf16_f32 v59, v46, v47
    buffer_store_dwordx4 v[56:59], v251, s[4:7], s53 offen offset:1024 sc1
    v_accvgpr_read_b32 v0, a48
    v_accvgpr_read_b32 v1, a49
    v_accvgpr_read_b32 v2, a50
    v_accvgpr_read_b32 v3, a51
    v_accvgpr_read_b32 v4, a52
    v_accvgpr_read_b32 v5, a53
    v_accvgpr_read_b32 v6, a54
    v_accvgpr_read_b32 v7, a55
    v_cvt_pk_bf16_f32 v16, v0, v1
    v_cvt_pk_bf16_f32 v17, v2, v3
    v_cvt_pk_bf16_f32 v18, v4, v5
    v_cvt_pk_bf16_f32 v19, v6, v7
    buffer_store_dwordx4 v[16:19], v251, s[4:7], s53 offen offset:2048 sc1
    v_accvgpr_read_b32 v20, a56
    v_accvgpr_read_b32 v21, a57
    v_accvgpr_read_b32 v22, a58
    v_accvgpr_read_b32 v23, a59
    v_accvgpr_read_b32 v24, a60
    v_accvgpr_read_b32 v25, a61
    v_accvgpr_read_b32 v26, a62
    v_accvgpr_read_b32 v27, a63
    v_cvt_pk_bf16_f32 v36, v20, v21
    v_cvt_pk_bf16_f32 v37, v22, v23
    v_cvt_pk_bf16_f32 v38, v24, v25
    v_cvt_pk_bf16_f32 v39, v26, v27
    buffer_store_dwordx4 v[36:39], v251, s[4:7], s53 offen offset:3072 sc1
    s_add_u32 s53, s53, s22
    v_accvgpr_read_b32 v40, a64
    v_accvgpr_read_b32 v41, a65
    v_accvgpr_read_b32 v42, a66
    v_accvgpr_read_b32 v43, a67
    v_accvgpr_read_b32 v44, a68
    v_accvgpr_read_b32 v45, a69
    v_accvgpr_read_b32 v46, a70
    v_accvgpr_read_b32 v47, a71
    v_cvt_pk_bf16_f32 v56, v40, v41
    v_cvt_pk_bf16_f32 v57, v42, v43
    v_cvt_pk_bf16_f32 v58, v44, v45
    v_cvt_pk_bf16_f32 v59, v46, v47
    buffer_store_dwordx4 v[56:59], v251, s[4:7], s53 offen offset:0 sc1
    v_accvgpr_read_b32 v0, a72
    v_accvgpr_read_b32 v1, a73
    v_accvgpr_read_b32 v2, a74
    v_accvgpr_read_b32 v3, a75
    v_accvgpr_read_b32 v4, a76
    v_accvgpr_read_b32 v5, a77
    v_accvgpr_read_b32 v6, a78
    v_accvgpr_read_b32 v7, a79
    v_cvt_pk_bf16_f32 v16, v0, v1
    v_cvt_pk_bf16_f32 v17, v2, v3
    v_cvt_pk_bf16_f32 v18, v4, v5
    v_cvt_pk_bf16_f32 v19, v6, v7
    buffer_store_dwordx4 v[16:19], v251, s[4:7], s53 offen offset:1024 sc1
    v_accvgpr_read_b32 v20, a80
    v_accvgpr_read_b32 v21, a81
    v_accvgpr_read_b32 v22, a82
    v_accvgpr_read_b32 v23, a83
    v_accvgpr_read_b32 v24, a84
    v_accvgpr_read_b32 v25, a85
    v_accvgpr_read_b32 v26, a86
    v_accvgpr_read_b32 v27, a87
    v_cvt_pk_bf16_f32 v36, v20, v21
    v_cvt_pk_bf16_f32 v37, v22, v23
    v_cvt_pk_bf16_f32 v38, v24, v25
    v_cvt_pk_bf16_f32 v39, v26, v27
    buffer_store_dwordx4 v[36:39], v251, s[4:7], s53 offen offset:2048 sc1
    v_accvgpr_read_b32 v40, a88
    v_accvgpr_read_b32 v41, a89
    v_accvgpr_read_b32 v42, a90
    v_accvgpr_read_b32 v43, a91
    v_accvgpr_read_b32 v44, a92
    v_accvgpr_read_b32 v45, a93
    v_accvgpr_read_b32 v46, a94
    v_accvgpr_read_b32 v47, a95
    v_cvt_pk_bf16_f32 v56, v40, v41
    v_cvt_pk_bf16_f32 v57, v42, v43
    v_cvt_pk_bf16_f32 v58, v44, v45
    v_cvt_pk_bf16_f32 v59, v46, v47
    buffer_store_dwordx4 v[56:59], v251, s[4:7], s53 offen offset:3072 sc1
    s_add_u32 s53, s53, s22
    v_accvgpr_read_b32 v0, a96
    v_accvgpr_read_b32 v1, a97
    v_accvgpr_read_b32 v2, a98
    v_accvgpr_read_b32 v3, a99
    v_accvgpr_read_b32 v4, a100
    v_accvgpr_read_b32 v5, a101
    v_accvgpr_read_b32 v6, a102
    v_accvgpr_read_b32 v7, a103
    v_cvt_pk_bf16_f32 v16, v0, v1
    v_cvt_pk_bf16_f32 v17, v2, v3
    v_cvt_pk_bf16_f32 v18, v4, v5
    v_cvt_pk_bf16_f32 v19, v6, v7
    buffer_store_dwordx4 v[16:19], v251, s[4:7], s53 offen offset:0 sc1
    v_accvgpr_read_b32 v20, a104
    v_accvgpr_read_b32 v21, a105
    v_accvgpr_read_b32 v22, a106
    v_accvgpr_read_b32 v23, a107
    v_accvgpr_read_b32 v24, a108
    v_accvgpr_read_b32 v25, a109
    v_accvgpr_read_b32 v26, a110
    v_accvgpr_read_b32 v27, a111
    v_cvt_pk_bf16_f32 v36, v20, v21
    v_cvt_pk_bf16_f32 v37, v22, v23
    v_cvt_pk_bf16_f32 v38, v24, v25
    v_cvt_pk_bf16_f32 v39, v26, v27
    buffer_store_dwordx4 v[36:39], v251, s[4:7], s53 offen offset:1024 sc1
    v_accvgpr_read_b32 v40, a112
    v_accvgpr_read_b32 v41, a113
    v_accvgpr_read_b32 v42, a114
    v_accvgpr_read_b32 v43, a115
    v_accvgpr_read_b32 v44, a116
    v_accvgpr_read_b32 v45, a117
    v_accvgpr_read_b32 v46, a118
    v_accvgpr_read_b32 v47, a119
    v_cvt_pk_bf16_f32 v56, v40, v41
    v_cvt_pk_bf16_f32 v57, v42, v43
    v_cvt_pk_bf16_f32 v58, v44, v45
    v_cvt_pk_bf16_f32 v59, v46, v47
    buffer_store_dwordx4 v[56:59], v251, s[4:7], s53 offen offset:2048 sc1
    v_accvgpr_read_b32 v0, a120
    v_accvgpr_read_b32 v1, a121
    v_accvgpr_read_b32 v2, a122
    v_accvgpr_read_b32 v3, a123
    v_accvgpr_read_b32 v4, a124
    v_accvgpr_read_b32 v5, a125
    v_accvgpr_read_b32 v6, a126
    v_accvgpr_read_b32 v7, a127
    v_cvt_pk_bf16_f32 v16, v0, v1
    v_cvt_pk_bf16_f32 v17, v2, v3
    v_cvt_pk_bf16_f32 v18, v4, v5
    v_cvt_pk_bf16_f32 v19, v6, v7
    buffer_store_dwordx4 v[16:19], v251, s[4:7], s53 offen offset:3072 sc1
    s_branch main_kernel_w_done
main_kernel_w_c1_escl:
    s_mov_b32 s53, s21
    v_accvgpr_read_b32 v0, a0
    v_accvgpr_read_b32 v1, a1
    v_accvgpr_read_b32 v2, a2
    v_accvgpr_read_b32 v3, a3
    v_accvgpr_read_b32 v4, a4
    v_accvgpr_read_b32 v5, a5
    v_accvgpr_read_b32 v6, a6
    v_accvgpr_read_b32 v7, a7
    v_mul_f32 v0, 0x3e0293ee, v0
    v_mul_f32 v1, 0x3e0293ee, v1
    v_mul_f32 v2, 0x3e0293ee, v2
    v_mul_f32 v3, 0x3e0293ee, v3
    v_mul_f32 v4, 0x3e0293ee, v4
    v_mul_f32 v5, 0x3e0293ee, v5
    v_mul_f32 v6, 0x3e0293ee, v6
    v_mul_f32 v7, 0x3e0293ee, v7
    v_cvt_pk_bf16_f32 v16, v0, v1
    v_cvt_pk_bf16_f32 v17, v2, v3
    v_cvt_pk_bf16_f32 v18, v4, v5
    v_cvt_pk_bf16_f32 v19, v6, v7
    buffer_store_dwordx4 v[16:19], v251, s[4:7], s53 offen offset:0 sc1
    v_accvgpr_read_b32 v20, a8
    v_accvgpr_read_b32 v21, a9
    v_accvgpr_read_b32 v22, a10
    v_accvgpr_read_b32 v23, a11
    v_accvgpr_read_b32 v24, a12
    v_accvgpr_read_b32 v25, a13
    v_accvgpr_read_b32 v26, a14
    v_accvgpr_read_b32 v27, a15
    v_mul_f32 v20, 0x3e0293ee, v20
    v_mul_f32 v21, 0x3e0293ee, v21
    v_mul_f32 v22, 0x3e0293ee, v22
    v_mul_f32 v23, 0x3e0293ee, v23
    v_mul_f32 v24, 0x3e0293ee, v24
    v_mul_f32 v25, 0x3e0293ee, v25
    v_mul_f32 v26, 0x3e0293ee, v26
    v_mul_f32 v27, 0x3e0293ee, v27
    v_cvt_pk_bf16_f32 v36, v20, v21
    v_cvt_pk_bf16_f32 v37, v22, v23
    v_cvt_pk_bf16_f32 v38, v24, v25
    v_cvt_pk_bf16_f32 v39, v26, v27
    buffer_store_dwordx4 v[36:39], v251, s[4:7], s53 offen offset:1024 sc1
    v_accvgpr_read_b32 v40, a16
    v_accvgpr_read_b32 v41, a17
    v_accvgpr_read_b32 v42, a18
    v_accvgpr_read_b32 v43, a19
    v_accvgpr_read_b32 v44, a20
    v_accvgpr_read_b32 v45, a21
    v_accvgpr_read_b32 v46, a22
    v_accvgpr_read_b32 v47, a23
    v_mul_f32 v40, 0x3e0293ee, v40
    v_mul_f32 v41, 0x3e0293ee, v41
    v_mul_f32 v42, 0x3e0293ee, v42
    v_mul_f32 v43, 0x3e0293ee, v43
    v_mul_f32 v44, 0x3e0293ee, v44
    v_mul_f32 v45, 0x3e0293ee, v45
    v_mul_f32 v46, 0x3e0293ee, v46
    v_mul_f32 v47, 0x3e0293ee, v47
    v_cvt_pk_bf16_f32 v56, v40, v41
    v_cvt_pk_bf16_f32 v57, v42, v43
    v_cvt_pk_bf16_f32 v58, v44, v45
    v_cvt_pk_bf16_f32 v59, v46, v47
    buffer_store_dwordx4 v[56:59], v251, s[4:7], s53 offen offset:2048 sc1
    v_accvgpr_read_b32 v0, a24
    v_accvgpr_read_b32 v1, a25
    v_accvgpr_read_b32 v2, a26
    v_accvgpr_read_b32 v3, a27
    v_accvgpr_read_b32 v4, a28
    v_accvgpr_read_b32 v5, a29
    v_accvgpr_read_b32 v6, a30
    v_accvgpr_read_b32 v7, a31
    v_mul_f32 v0, 0x3e0293ee, v0
    v_mul_f32 v1, 0x3e0293ee, v1
    v_mul_f32 v2, 0x3e0293ee, v2
    v_mul_f32 v3, 0x3e0293ee, v3
    v_mul_f32 v4, 0x3e0293ee, v4
    v_mul_f32 v5, 0x3e0293ee, v5
    v_mul_f32 v6, 0x3e0293ee, v6
    v_mul_f32 v7, 0x3e0293ee, v7
    v_cvt_pk_bf16_f32 v16, v0, v1
    v_cvt_pk_bf16_f32 v17, v2, v3
    v_cvt_pk_bf16_f32 v18, v4, v5
    v_cvt_pk_bf16_f32 v19, v6, v7
    buffer_store_dwordx4 v[16:19], v251, s[4:7], s53 offen offset:3072 sc1
    s_add_u32 s53, s53, s22
    v_accvgpr_read_b32 v20, a32
    v_accvgpr_read_b32 v21, a33
    v_accvgpr_read_b32 v22, a34
    v_accvgpr_read_b32 v23, a35
    v_accvgpr_read_b32 v24, a36
    v_accvgpr_read_b32 v25, a37
    v_accvgpr_read_b32 v26, a38
    v_accvgpr_read_b32 v27, a39
    v_mul_f32 v20, 0x3e0293ee, v20
    v_mul_f32 v21, 0x3e0293ee, v21
    v_mul_f32 v22, 0x3e0293ee, v22
    v_mul_f32 v23, 0x3e0293ee, v23
    v_mul_f32 v24, 0x3e0293ee, v24
    v_mul_f32 v25, 0x3e0293ee, v25
    v_mul_f32 v26, 0x3e0293ee, v26
    v_mul_f32 v27, 0x3e0293ee, v27
    v_cvt_pk_bf16_f32 v36, v20, v21
    v_cvt_pk_bf16_f32 v37, v22, v23
    v_cvt_pk_bf16_f32 v38, v24, v25
    v_cvt_pk_bf16_f32 v39, v26, v27
    buffer_store_dwordx4 v[36:39], v251, s[4:7], s53 offen offset:0 sc1
    v_accvgpr_read_b32 v40, a40
    v_accvgpr_read_b32 v41, a41
    v_accvgpr_read_b32 v42, a42
    v_accvgpr_read_b32 v43, a43
    v_accvgpr_read_b32 v44, a44
    v_accvgpr_read_b32 v45, a45
    v_accvgpr_read_b32 v46, a46
    v_accvgpr_read_b32 v47, a47
    v_mul_f32 v40, 0x3e0293ee, v40
    v_mul_f32 v41, 0x3e0293ee, v41
    v_mul_f32 v42, 0x3e0293ee, v42
    v_mul_f32 v43, 0x3e0293ee, v43
    v_mul_f32 v44, 0x3e0293ee, v44
    v_mul_f32 v45, 0x3e0293ee, v45
    v_mul_f32 v46, 0x3e0293ee, v46
    v_mul_f32 v47, 0x3e0293ee, v47
    v_cvt_pk_bf16_f32 v56, v40, v41
    v_cvt_pk_bf16_f32 v57, v42, v43
    v_cvt_pk_bf16_f32 v58, v44, v45
    v_cvt_pk_bf16_f32 v59, v46, v47
    buffer_store_dwordx4 v[56:59], v251, s[4:7], s53 offen offset:1024 sc1
    v_accvgpr_read_b32 v0, a48
    v_accvgpr_read_b32 v1, a49
    v_accvgpr_read_b32 v2, a50
    v_accvgpr_read_b32 v3, a51
    v_accvgpr_read_b32 v4, a52
    v_accvgpr_read_b32 v5, a53
    v_accvgpr_read_b32 v6, a54
    v_accvgpr_read_b32 v7, a55
    v_mul_f32 v0, 0x3e0293ee, v0
    v_mul_f32 v1, 0x3e0293ee, v1
    v_mul_f32 v2, 0x3e0293ee, v2
    v_mul_f32 v3, 0x3e0293ee, v3
    v_mul_f32 v4, 0x3e0293ee, v4
    v_mul_f32 v5, 0x3e0293ee, v5
    v_mul_f32 v6, 0x3e0293ee, v6
    v_mul_f32 v7, 0x3e0293ee, v7
    v_cvt_pk_bf16_f32 v16, v0, v1
    v_cvt_pk_bf16_f32 v17, v2, v3
    v_cvt_pk_bf16_f32 v18, v4, v5
    v_cvt_pk_bf16_f32 v19, v6, v7
    buffer_store_dwordx4 v[16:19], v251, s[4:7], s53 offen offset:2048 sc1
    v_accvgpr_read_b32 v20, a56
    v_accvgpr_read_b32 v21, a57
    v_accvgpr_read_b32 v22, a58
    v_accvgpr_read_b32 v23, a59
    v_accvgpr_read_b32 v24, a60
    v_accvgpr_read_b32 v25, a61
    v_accvgpr_read_b32 v26, a62
    v_accvgpr_read_b32 v27, a63
    v_mul_f32 v20, 0x3e0293ee, v20
    v_mul_f32 v21, 0x3e0293ee, v21
    v_mul_f32 v22, 0x3e0293ee, v22
    v_mul_f32 v23, 0x3e0293ee, v23
    v_mul_f32 v24, 0x3e0293ee, v24
    v_mul_f32 v25, 0x3e0293ee, v25
    v_mul_f32 v26, 0x3e0293ee, v26
    v_mul_f32 v27, 0x3e0293ee, v27
    v_cvt_pk_bf16_f32 v36, v20, v21
    v_cvt_pk_bf16_f32 v37, v22, v23
    v_cvt_pk_bf16_f32 v38, v24, v25
    v_cvt_pk_bf16_f32 v39, v26, v27
    buffer_store_dwordx4 v[36:39], v251, s[4:7], s53 offen offset:3072 sc1
    s_add_u32 s53, s53, s22
    v_accvgpr_read_b32 v40, a64
    v_accvgpr_read_b32 v41, a65
    v_accvgpr_read_b32 v42, a66
    v_accvgpr_read_b32 v43, a67
    v_accvgpr_read_b32 v44, a68
    v_accvgpr_read_b32 v45, a69
    v_accvgpr_read_b32 v46, a70
    v_accvgpr_read_b32 v47, a71
    v_mul_f32 v40, 0x3e0293ee, v40
    v_mul_f32 v41, 0x3e0293ee, v41
    v_mul_f32 v42, 0x3e0293ee, v42
    v_mul_f32 v43, 0x3e0293ee, v43
    v_mul_f32 v44, 0x3e0293ee, v44
    v_mul_f32 v45, 0x3e0293ee, v45
    v_mul_f32 v46, 0x3e0293ee, v46
    v_mul_f32 v47, 0x3e0293ee, v47
    v_cvt_pk_bf16_f32 v56, v40, v41
    v_cvt_pk_bf16_f32 v57, v42, v43
    v_cvt_pk_bf16_f32 v58, v44, v45
    v_cvt_pk_bf16_f32 v59, v46, v47
    buffer_store_dwordx4 v[56:59], v251, s[4:7], s53 offen offset:0 sc1
    v_accvgpr_read_b32 v0, a72
    v_accvgpr_read_b32 v1, a73
    v_accvgpr_read_b32 v2, a74
    v_accvgpr_read_b32 v3, a75
    v_accvgpr_read_b32 v4, a76
    v_accvgpr_read_b32 v5, a77
    v_accvgpr_read_b32 v6, a78
    v_accvgpr_read_b32 v7, a79
    v_mul_f32 v0, 0x3e0293ee, v0
    v_mul_f32 v1, 0x3e0293ee, v1
    v_mul_f32 v2, 0x3e0293ee, v2
    v_mul_f32 v3, 0x3e0293ee, v3
    v_mul_f32 v4, 0x3e0293ee, v4
    v_mul_f32 v5, 0x3e0293ee, v5
    v_mul_f32 v6, 0x3e0293ee, v6
    v_mul_f32 v7, 0x3e0293ee, v7
    v_cvt_pk_bf16_f32 v16, v0, v1
    v_cvt_pk_bf16_f32 v17, v2, v3
    v_cvt_pk_bf16_f32 v18, v4, v5
    v_cvt_pk_bf16_f32 v19, v6, v7
    buffer_store_dwordx4 v[16:19], v251, s[4:7], s53 offen offset:1024 sc1
    v_accvgpr_read_b32 v20, a80
    v_accvgpr_read_b32 v21, a81
    v_accvgpr_read_b32 v22, a82
    v_accvgpr_read_b32 v23, a83
    v_accvgpr_read_b32 v24, a84
    v_accvgpr_read_b32 v25, a85
    v_accvgpr_read_b32 v26, a86
    v_accvgpr_read_b32 v27, a87
    v_mul_f32 v20, 0x3e0293ee, v20
    v_mul_f32 v21, 0x3e0293ee, v21
    v_mul_f32 v22, 0x3e0293ee, v22
    v_mul_f32 v23, 0x3e0293ee, v23
    v_mul_f32 v24, 0x3e0293ee, v24
    v_mul_f32 v25, 0x3e0293ee, v25
    v_mul_f32 v26, 0x3e0293ee, v26
    v_mul_f32 v27, 0x3e0293ee, v27
    v_cvt_pk_bf16_f32 v36, v20, v21
    v_cvt_pk_bf16_f32 v37, v22, v23
    v_cvt_pk_bf16_f32 v38, v24, v25
    v_cvt_pk_bf16_f32 v39, v26, v27
    buffer_store_dwordx4 v[36:39], v251, s[4:7], s53 offen offset:2048 sc1
    v_accvgpr_read_b32 v40, a88
    v_accvgpr_read_b32 v41, a89
    v_accvgpr_read_b32 v42, a90
    v_accvgpr_read_b32 v43, a91
    v_accvgpr_read_b32 v44, a92
    v_accvgpr_read_b32 v45, a93
    v_accvgpr_read_b32 v46, a94
    v_accvgpr_read_b32 v47, a95
    v_mul_f32 v40, 0x3e0293ee, v40
    v_mul_f32 v41, 0x3e0293ee, v41
    v_mul_f32 v42, 0x3e0293ee, v42
    v_mul_f32 v43, 0x3e0293ee, v43
    v_mul_f32 v44, 0x3e0293ee, v44
    v_mul_f32 v45, 0x3e0293ee, v45
    v_mul_f32 v46, 0x3e0293ee, v46
    v_mul_f32 v47, 0x3e0293ee, v47
    v_cvt_pk_bf16_f32 v56, v40, v41
    v_cvt_pk_bf16_f32 v57, v42, v43
    v_cvt_pk_bf16_f32 v58, v44, v45
    v_cvt_pk_bf16_f32 v59, v46, v47
    buffer_store_dwordx4 v[56:59], v251, s[4:7], s53 offen offset:3072 sc1
    s_add_u32 s53, s53, s22
    v_accvgpr_read_b32 v0, a96
    v_accvgpr_read_b32 v1, a97
    v_accvgpr_read_b32 v2, a98
    v_accvgpr_read_b32 v3, a99
    v_accvgpr_read_b32 v4, a100
    v_accvgpr_read_b32 v5, a101
    v_accvgpr_read_b32 v6, a102
    v_accvgpr_read_b32 v7, a103
    v_mul_f32 v0, 0x3e0293ee, v0
    v_mul_f32 v1, 0x3e0293ee, v1
    v_mul_f32 v2, 0x3e0293ee, v2
    v_mul_f32 v3, 0x3e0293ee, v3
    v_mul_f32 v4, 0x3e0293ee, v4
    v_mul_f32 v5, 0x3e0293ee, v5
    v_mul_f32 v6, 0x3e0293ee, v6
    v_mul_f32 v7, 0x3e0293ee, v7
    v_cvt_pk_bf16_f32 v16, v0, v1
    v_cvt_pk_bf16_f32 v17, v2, v3
    v_cvt_pk_bf16_f32 v18, v4, v5
    v_cvt_pk_bf16_f32 v19, v6, v7
    buffer_store_dwordx4 v[16:19], v251, s[4:7], s53 offen offset:0 sc1
    v_accvgpr_read_b32 v20, a104
    v_accvgpr_read_b32 v21, a105
    v_accvgpr_read_b32 v22, a106
    v_accvgpr_read_b32 v23, a107
    v_accvgpr_read_b32 v24, a108
    v_accvgpr_read_b32 v25, a109
    v_accvgpr_read_b32 v26, a110
    v_accvgpr_read_b32 v27, a111
    v_mul_f32 v20, 0x3e0293ee, v20
    v_mul_f32 v21, 0x3e0293ee, v21
    v_mul_f32 v22, 0x3e0293ee, v22
    v_mul_f32 v23, 0x3e0293ee, v23
    v_mul_f32 v24, 0x3e0293ee, v24
    v_mul_f32 v25, 0x3e0293ee, v25
    v_mul_f32 v26, 0x3e0293ee, v26
    v_mul_f32 v27, 0x3e0293ee, v27
    v_cvt_pk_bf16_f32 v36, v20, v21
    v_cvt_pk_bf16_f32 v37, v22, v23
    v_cvt_pk_bf16_f32 v38, v24, v25
    v_cvt_pk_bf16_f32 v39, v26, v27
    buffer_store_dwordx4 v[36:39], v251, s[4:7], s53 offen offset:1024 sc1
    v_accvgpr_read_b32 v40, a112
    v_accvgpr_read_b32 v41, a113
    v_accvgpr_read_b32 v42, a114
    v_accvgpr_read_b32 v43, a115
    v_accvgpr_read_b32 v44, a116
    v_accvgpr_read_b32 v45, a117
    v_accvgpr_read_b32 v46, a118
    v_accvgpr_read_b32 v47, a119
    v_mul_f32 v40, 0x3e0293ee, v40
    v_mul_f32 v41, 0x3e0293ee, v41
    v_mul_f32 v42, 0x3e0293ee, v42
    v_mul_f32 v43, 0x3e0293ee, v43
    v_mul_f32 v44, 0x3e0293ee, v44
    v_mul_f32 v45, 0x3e0293ee, v45
    v_mul_f32 v46, 0x3e0293ee, v46
    v_mul_f32 v47, 0x3e0293ee, v47
    v_cvt_pk_bf16_f32 v56, v40, v41
    v_cvt_pk_bf16_f32 v57, v42, v43
    v_cvt_pk_bf16_f32 v58, v44, v45
    v_cvt_pk_bf16_f32 v59, v46, v47
    buffer_store_dwordx4 v[56:59], v251, s[4:7], s53 offen offset:2048 sc1
    v_accvgpr_read_b32 v0, a120
    v_accvgpr_read_b32 v1, a121
    v_accvgpr_read_b32 v2, a122
    v_accvgpr_read_b32 v3, a123
    v_accvgpr_read_b32 v4, a124
    v_accvgpr_read_b32 v5, a125
    v_accvgpr_read_b32 v6, a126
    v_accvgpr_read_b32 v7, a127
    v_mul_f32 v0, 0x3e0293ee, v0
    v_mul_f32 v1, 0x3e0293ee, v1
    v_mul_f32 v2, 0x3e0293ee, v2
    v_mul_f32 v3, 0x3e0293ee, v3
    v_mul_f32 v4, 0x3e0293ee, v4
    v_mul_f32 v5, 0x3e0293ee, v5
    v_mul_f32 v6, 0x3e0293ee, v6
    v_mul_f32 v7, 0x3e0293ee, v7
    v_cvt_pk_bf16_f32 v16, v0, v1
    v_cvt_pk_bf16_f32 v17, v2, v3
    v_cvt_pk_bf16_f32 v18, v4, v5
    v_cvt_pk_bf16_f32 v19, v6, v7
    buffer_store_dwordx4 v[16:19], v251, s[4:7], s53 offen offset:3072 sc1
    s_branch main_kernel_w_done
main_kernel_w_c1_egelus:
    s_mov_b32 s53, s21
    v_accvgpr_read_b32 v0, a0
    v_accvgpr_read_b32 v1, a1
    v_accvgpr_read_b32 v2, a2
    v_accvgpr_read_b32 v3, a3
    v_accvgpr_read_b32 v4, a4
    v_accvgpr_read_b32 v5, a5
    v_accvgpr_read_b32 v6, a6
    v_accvgpr_read_b32 v7, a7
    v_pk_mul_f32 v[8:9], v[0:1], v[0:1]
    v_pk_mul_f32 v[10:11], v[2:3], v[2:3]
    v_pk_mul_f32 v[12:13], v[4:5], v[4:5]
    v_pk_mul_f32 v[14:15], v[6:7], v[6:7]
    v_pk_fma_f32 v[8:9], v[8:9], v[242:243], v[240:241]
    v_pk_fma_f32 v[10:11], v[10:11], v[242:243], v[240:241]
    v_pk_fma_f32 v[12:13], v[12:13], v[242:243], v[240:241]
    v_pk_fma_f32 v[14:15], v[14:15], v[242:243], v[240:241]
    v_pk_mul_f32 v[8:9], v[8:9], v[0:1]
    v_pk_mul_f32 v[10:11], v[10:11], v[2:3]
    v_pk_mul_f32 v[12:13], v[12:13], v[4:5]
    v_pk_mul_f32 v[14:15], v[14:15], v[6:7]
    v_exp_f32 v8, v8
    v_exp_f32 v9, v9
    v_exp_f32 v10, v10
    v_exp_f32 v11, v11
    v_exp_f32 v12, v12
    v_exp_f32 v13, v13
    v_exp_f32 v14, v14
    v_exp_f32 v15, v15
    v_pk_add_f32 v[8:9], v[8:9], v[244:245]
    v_pk_add_f32 v[10:11], v[10:11], v[244:245]
    v_pk_add_f32 v[12:13], v[12:13], v[244:245]
    v_pk_add_f32 v[14:15], v[14:15], v[244:245]
    v_rcp_f32 v8, v8
    v_rcp_f32 v9, v9
    v_rcp_f32 v10, v10
    v_rcp_f32 v11, v11
    v_rcp_f32 v12, v12
    v_rcp_f32 v13, v13
    v_rcp_f32 v14, v14
    v_rcp_f32 v15, v15
    v_pk_mul_f32 v[0:1], v[8:9], v[0:1]
    v_pk_mul_f32 v[2:3], v[10:11], v[2:3]
    v_pk_mul_f32 v[4:5], v[12:13], v[4:5]
    v_pk_mul_f32 v[6:7], v[14:15], v[6:7]
    v_cvt_pk_bf16_f32 v16, v0, v1
    v_cvt_pk_bf16_f32 v17, v2, v3
    v_cvt_pk_bf16_f32 v18, v4, v5
    v_cvt_pk_bf16_f32 v19, v6, v7
    buffer_store_dwordx4 v[16:19], v252, s[4:7], s53 offen offset:0 sc1
    v_accvgpr_read_b32 v20, a8
    v_accvgpr_read_b32 v21, a9
    v_accvgpr_read_b32 v22, a10
    v_accvgpr_read_b32 v23, a11
    v_accvgpr_read_b32 v24, a12
    v_accvgpr_read_b32 v25, a13
    v_accvgpr_read_b32 v26, a14
    v_accvgpr_read_b32 v27, a15
    v_pk_mul_f32 v[28:29], v[20:21], v[20:21]
    v_pk_mul_f32 v[30:31], v[22:23], v[22:23]
    v_pk_mul_f32 v[32:33], v[24:25], v[24:25]
    v_pk_mul_f32 v[34:35], v[26:27], v[26:27]
    v_pk_fma_f32 v[28:29], v[28:29], v[242:243], v[240:241]
    v_pk_fma_f32 v[30:31], v[30:31], v[242:243], v[240:241]
    v_pk_fma_f32 v[32:33], v[32:33], v[242:243], v[240:241]
    v_pk_fma_f32 v[34:35], v[34:35], v[242:243], v[240:241]
    v_pk_mul_f32 v[28:29], v[28:29], v[20:21]
    v_pk_mul_f32 v[30:31], v[30:31], v[22:23]
    v_pk_mul_f32 v[32:33], v[32:33], v[24:25]
    v_pk_mul_f32 v[34:35], v[34:35], v[26:27]
    v_exp_f32 v28, v28
    v_exp_f32 v29, v29
    v_exp_f32 v30, v30
    v_exp_f32 v31, v31
    v_exp_f32 v32, v32
    v_exp_f32 v33, v33
    v_exp_f32 v34, v34
    v_exp_f32 v35, v35
    v_pk_add_f32 v[28:29], v[28:29], v[244:245]
    v_pk_add_f32 v[30:31], v[30:31], v[244:245]
    v_pk_add_f32 v[32:33], v[32:33], v[244:245]
    v_pk_add_f32 v[34:35], v[34:35], v[244:245]
    v_rcp_f32 v28, v28
    v_rcp_f32 v29, v29
    v_rcp_f32 v30, v30
    v_rcp_f32 v31, v31
    v_rcp_f32 v32, v32
    v_rcp_f32 v33, v33
    v_rcp_f32 v34, v34
    v_rcp_f32 v35, v35
    v_pk_mul_f32 v[20:21], v[28:29], v[20:21]
    v_pk_mul_f32 v[22:23], v[30:31], v[22:23]
    v_pk_mul_f32 v[24:25], v[32:33], v[24:25]
    v_pk_mul_f32 v[26:27], v[34:35], v[26:27]
    v_cvt_pk_bf16_f32 v36, v20, v21
    v_cvt_pk_bf16_f32 v37, v22, v23
    v_cvt_pk_bf16_f32 v38, v24, v25
    v_cvt_pk_bf16_f32 v39, v26, v27
    buffer_store_dwordx4 v[36:39], v252, s[4:7], s53 offen offset:1024 sc1
    v_accvgpr_read_b32 v40, a16
    v_accvgpr_read_b32 v41, a17
    v_accvgpr_read_b32 v42, a18
    v_accvgpr_read_b32 v43, a19
    v_accvgpr_read_b32 v44, a20
    v_accvgpr_read_b32 v45, a21
    v_accvgpr_read_b32 v46, a22
    v_accvgpr_read_b32 v47, a23
    v_pk_mul_f32 v[48:49], v[40:41], v[40:41]
    v_pk_mul_f32 v[50:51], v[42:43], v[42:43]
    v_pk_mul_f32 v[52:53], v[44:45], v[44:45]
    v_pk_mul_f32 v[54:55], v[46:47], v[46:47]
    v_pk_fma_f32 v[48:49], v[48:49], v[242:243], v[240:241]
    v_pk_fma_f32 v[50:51], v[50:51], v[242:243], v[240:241]
    v_pk_fma_f32 v[52:53], v[52:53], v[242:243], v[240:241]
    v_pk_fma_f32 v[54:55], v[54:55], v[242:243], v[240:241]
    v_pk_mul_f32 v[48:49], v[48:49], v[40:41]
    v_pk_mul_f32 v[50:51], v[50:51], v[42:43]
    v_pk_mul_f32 v[52:53], v[52:53], v[44:45]
    v_pk_mul_f32 v[54:55], v[54:55], v[46:47]
    v_exp_f32 v48, v48
    v_exp_f32 v49, v49
    v_exp_f32 v50, v50
    v_exp_f32 v51, v51
    v_exp_f32 v52, v52
    v_exp_f32 v53, v53
    v_exp_f32 v54, v54
    v_exp_f32 v55, v55
    v_pk_add_f32 v[48:49], v[48:49], v[244:245]
    v_pk_add_f32 v[50:51], v[50:51], v[244:245]
    v_pk_add_f32 v[52:53], v[52:53], v[244:245]
    v_pk_add_f32 v[54:55], v[54:55], v[244:245]
    v_rcp_f32 v48, v48
    v_rcp_f32 v49, v49
    v_rcp_f32 v50, v50
    v_rcp_f32 v51, v51
    v_rcp_f32 v52, v52
    v_rcp_f32 v53, v53
    v_rcp_f32 v54, v54
    v_rcp_f32 v55, v55
    v_pk_mul_f32 v[40:41], v[48:49], v[40:41]
    v_pk_mul_f32 v[42:43], v[50:51], v[42:43]
    v_pk_mul_f32 v[44:45], v[52:53], v[44:45]
    v_pk_mul_f32 v[46:47], v[54:55], v[46:47]
    v_cvt_pk_bf16_f32 v56, v40, v41
    v_cvt_pk_bf16_f32 v57, v42, v43
    v_cvt_pk_bf16_f32 v58, v44, v45
    v_cvt_pk_bf16_f32 v59, v46, v47
    buffer_store_dwordx4 v[56:59], v252, s[4:7], s53 offen offset:2048 sc1
    v_accvgpr_read_b32 v0, a24
    v_accvgpr_read_b32 v1, a25
    v_accvgpr_read_b32 v2, a26
    v_accvgpr_read_b32 v3, a27
    v_accvgpr_read_b32 v4, a28
    v_accvgpr_read_b32 v5, a29
    v_accvgpr_read_b32 v6, a30
    v_accvgpr_read_b32 v7, a31
    v_pk_mul_f32 v[8:9], v[0:1], v[0:1]
    v_pk_mul_f32 v[10:11], v[2:3], v[2:3]
    v_pk_mul_f32 v[12:13], v[4:5], v[4:5]
    v_pk_mul_f32 v[14:15], v[6:7], v[6:7]
    v_pk_fma_f32 v[8:9], v[8:9], v[242:243], v[240:241]
    v_pk_fma_f32 v[10:11], v[10:11], v[242:243], v[240:241]
    v_pk_fma_f32 v[12:13], v[12:13], v[242:243], v[240:241]
    v_pk_fma_f32 v[14:15], v[14:15], v[242:243], v[240:241]
    v_pk_mul_f32 v[8:9], v[8:9], v[0:1]
    v_pk_mul_f32 v[10:11], v[10:11], v[2:3]
    v_pk_mul_f32 v[12:13], v[12:13], v[4:5]
    v_pk_mul_f32 v[14:15], v[14:15], v[6:7]
    v_exp_f32 v8, v8
    v_exp_f32 v9, v9
    v_exp_f32 v10, v10
    v_exp_f32 v11, v11
    v_exp_f32 v12, v12
    v_exp_f32 v13, v13
    v_exp_f32 v14, v14
    v_exp_f32 v15, v15
    v_pk_add_f32 v[8:9], v[8:9], v[244:245]
    v_pk_add_f32 v[10:11], v[10:11], v[244:245]
    v_pk_add_f32 v[12:13], v[12:13], v[244:245]
    v_pk_add_f32 v[14:15], v[14:15], v[244:245]
    v_rcp_f32 v8, v8
    v_rcp_f32 v9, v9
    v_rcp_f32 v10, v10
    v_rcp_f32 v11, v11
    v_rcp_f32 v12, v12
    v_rcp_f32 v13, v13
    v_rcp_f32 v14, v14
    v_rcp_f32 v15, v15
    v_pk_mul_f32 v[0:1], v[8:9], v[0:1]
    v_pk_mul_f32 v[2:3], v[10:11], v[2:3]
    v_pk_mul_f32 v[4:5], v[12:13], v[4:5]
    v_pk_mul_f32 v[6:7], v[14:15], v[6:7]
    v_cvt_pk_bf16_f32 v16, v0, v1
    v_cvt_pk_bf16_f32 v17, v2, v3
    v_cvt_pk_bf16_f32 v18, v4, v5
    v_cvt_pk_bf16_f32 v19, v6, v7
    buffer_store_dwordx4 v[16:19], v252, s[4:7], s53 offen offset:3072 sc1
    s_add_u32 s53, s53, s22
    v_accvgpr_read_b32 v20, a32
    v_accvgpr_read_b32 v21, a33
    v_accvgpr_read_b32 v22, a34
    v_accvgpr_read_b32 v23, a35
    v_accvgpr_read_b32 v24, a36
    v_accvgpr_read_b32 v25, a37
    v_accvgpr_read_b32 v26, a38
    v_accvgpr_read_b32 v27, a39
    v_pk_mul_f32 v[28:29], v[20:21], v[20:21]
    v_pk_mul_f32 v[30:31], v[22:23], v[22:23]
    v_pk_mul_f32 v[32:33], v[24:25], v[24:25]
    v_pk_mul_f32 v[34:35], v[26:27], v[26:27]
    v_pk_fma_f32 v[28:29], v[28:29], v[242:243], v[240:241]
    v_pk_fma_f32 v[30:31], v[30:31], v[242:243], v[240:241]
    v_pk_fma_f32 v[32:33], v[32:33], v[242:243], v[240:241]
    v_pk_fma_f32 v[34:35], v[34:35], v[242:243], v[240:241]
    v_pk_mul_f32 v[28:29], v[28:29], v[20:21]
    v_pk_mul_f32 v[30:31], v[30:31], v[22:23]
    v_pk_mul_f32 v[32:33], v[32:33], v[24:25]
    v_pk_mul_f32 v[34:35], v[34:35], v[26:27]
    v_exp_f32 v28, v28
    v_exp_f32 v29, v29
    v_exp_f32 v30, v30
    v_exp_f32 v31, v31
    v_exp_f32 v32, v32
    v_exp_f32 v33, v33
    v_exp_f32 v34, v34
    v_exp_f32 v35, v35
    v_pk_add_f32 v[28:29], v[28:29], v[244:245]
    v_pk_add_f32 v[30:31], v[30:31], v[244:245]
    v_pk_add_f32 v[32:33], v[32:33], v[244:245]
    v_pk_add_f32 v[34:35], v[34:35], v[244:245]
    v_rcp_f32 v28, v28
    v_rcp_f32 v29, v29
    v_rcp_f32 v30, v30
    v_rcp_f32 v31, v31
    v_rcp_f32 v32, v32
    v_rcp_f32 v33, v33
    v_rcp_f32 v34, v34
    v_rcp_f32 v35, v35
    v_pk_mul_f32 v[20:21], v[28:29], v[20:21]
    v_pk_mul_f32 v[22:23], v[30:31], v[22:23]
    v_pk_mul_f32 v[24:25], v[32:33], v[24:25]
    v_pk_mul_f32 v[26:27], v[34:35], v[26:27]
    v_cvt_pk_bf16_f32 v36, v20, v21
    v_cvt_pk_bf16_f32 v37, v22, v23
    v_cvt_pk_bf16_f32 v38, v24, v25
    v_cvt_pk_bf16_f32 v39, v26, v27
    buffer_store_dwordx4 v[36:39], v252, s[4:7], s53 offen offset:0 sc1
    v_accvgpr_read_b32 v40, a40
    v_accvgpr_read_b32 v41, a41
    v_accvgpr_read_b32 v42, a42
    v_accvgpr_read_b32 v43, a43
    v_accvgpr_read_b32 v44, a44
    v_accvgpr_read_b32 v45, a45
    v_accvgpr_read_b32 v46, a46
    v_accvgpr_read_b32 v47, a47
    v_pk_mul_f32 v[48:49], v[40:41], v[40:41]
    v_pk_mul_f32 v[50:51], v[42:43], v[42:43]
    v_pk_mul_f32 v[52:53], v[44:45], v[44:45]
    v_pk_mul_f32 v[54:55], v[46:47], v[46:47]
    v_pk_fma_f32 v[48:49], v[48:49], v[242:243], v[240:241]
    v_pk_fma_f32 v[50:51], v[50:51], v[242:243], v[240:241]
    v_pk_fma_f32 v[52:53], v[52:53], v[242:243], v[240:241]
    v_pk_fma_f32 v[54:55], v[54:55], v[242:243], v[240:241]
    v_pk_mul_f32 v[48:49], v[48:49], v[40:41]
    v_pk_mul_f32 v[50:51], v[50:51], v[42:43]
    v_pk_mul_f32 v[52:53], v[52:53], v[44:45]
    v_pk_mul_f32 v[54:55], v[54:55], v[46:47]
    v_exp_f32 v48, v48
    v_exp_f32 v49, v49
    v_exp_f32 v50, v50
    v_exp_f32 v51, v51
    v_exp_f32 v52, v52
    v_exp_f32 v53, v53
    v_exp_f32 v54, v54
    v_exp_f32 v55, v55
    v_pk_add_f32 v[48:49], v[48:49], v[244:245]
    v_pk_add_f32 v[50:51], v[50:51], v[244:245]
    v_pk_add_f32 v[52:53], v[52:53], v[244:245]
    v_pk_add_f32 v[54:55], v[54:55], v[244:245]
    v_rcp_f32 v48, v48
    v_rcp_f32 v49, v49
    v_rcp_f32 v50, v50
    v_rcp_f32 v51, v51
    v_rcp_f32 v52, v52
    v_rcp_f32 v53, v53
    v_rcp_f32 v54, v54
    v_rcp_f32 v55, v55
    v_pk_mul_f32 v[40:41], v[48:49], v[40:41]
    v_pk_mul_f32 v[42:43], v[50:51], v[42:43]
    v_pk_mul_f32 v[44:45], v[52:53], v[44:45]
    v_pk_mul_f32 v[46:47], v[54:55], v[46:47]
    v_cvt_pk_bf16_f32 v56, v40, v41
    v_cvt_pk_bf16_f32 v57, v42, v43
    v_cvt_pk_bf16_f32 v58, v44, v45
    v_cvt_pk_bf16_f32 v59, v46, v47
    buffer_store_dwordx4 v[56:59], v252, s[4:7], s53 offen offset:1024 sc1
    v_accvgpr_read_b32 v0, a48
    v_accvgpr_read_b32 v1, a49
    v_accvgpr_read_b32 v2, a50
    v_accvgpr_read_b32 v3, a51
    v_accvgpr_read_b32 v4, a52
    v_accvgpr_read_b32 v5, a53
    v_accvgpr_read_b32 v6, a54
    v_accvgpr_read_b32 v7, a55
    v_pk_mul_f32 v[8:9], v[0:1], v[0:1]
    v_pk_mul_f32 v[10:11], v[2:3], v[2:3]
    v_pk_mul_f32 v[12:13], v[4:5], v[4:5]
    v_pk_mul_f32 v[14:15], v[6:7], v[6:7]
    v_pk_fma_f32 v[8:9], v[8:9], v[242:243], v[240:241]
    v_pk_fma_f32 v[10:11], v[10:11], v[242:243], v[240:241]
    v_pk_fma_f32 v[12:13], v[12:13], v[242:243], v[240:241]
    v_pk_fma_f32 v[14:15], v[14:15], v[242:243], v[240:241]
    v_pk_mul_f32 v[8:9], v[8:9], v[0:1]
    v_pk_mul_f32 v[10:11], v[10:11], v[2:3]
    v_pk_mul_f32 v[12:13], v[12:13], v[4:5]
    v_pk_mul_f32 v[14:15], v[14:15], v[6:7]
    v_exp_f32 v8, v8
    v_exp_f32 v9, v9
    v_exp_f32 v10, v10
    v_exp_f32 v11, v11
    v_exp_f32 v12, v12
    v_exp_f32 v13, v13
    v_exp_f32 v14, v14
    v_exp_f32 v15, v15
    v_pk_add_f32 v[8:9], v[8:9], v[244:245]
    v_pk_add_f32 v[10:11], v[10:11], v[244:245]
    v_pk_add_f32 v[12:13], v[12:13], v[244:245]
    v_pk_add_f32 v[14:15], v[14:15], v[244:245]
    v_rcp_f32 v8, v8
    v_rcp_f32 v9, v9
    v_rcp_f32 v10, v10
    v_rcp_f32 v11, v11
    v_rcp_f32 v12, v12
    v_rcp_f32 v13, v13
    v_rcp_f32 v14, v14
    v_rcp_f32 v15, v15
    v_pk_mul_f32 v[0:1], v[8:9], v[0:1]
    v_pk_mul_f32 v[2:3], v[10:11], v[2:3]
    v_pk_mul_f32 v[4:5], v[12:13], v[4:5]
    v_pk_mul_f32 v[6:7], v[14:15], v[6:7]
    v_cvt_pk_bf16_f32 v16, v0, v1
    v_cvt_pk_bf16_f32 v17, v2, v3
    v_cvt_pk_bf16_f32 v18, v4, v5
    v_cvt_pk_bf16_f32 v19, v6, v7
    buffer_store_dwordx4 v[16:19], v252, s[4:7], s53 offen offset:2048 sc1
    v_accvgpr_read_b32 v20, a56
    v_accvgpr_read_b32 v21, a57
    v_accvgpr_read_b32 v22, a58
    v_accvgpr_read_b32 v23, a59
    v_accvgpr_read_b32 v24, a60
    v_accvgpr_read_b32 v25, a61
    v_accvgpr_read_b32 v26, a62
    v_accvgpr_read_b32 v27, a63
    v_pk_mul_f32 v[28:29], v[20:21], v[20:21]
    v_pk_mul_f32 v[30:31], v[22:23], v[22:23]
    v_pk_mul_f32 v[32:33], v[24:25], v[24:25]
    v_pk_mul_f32 v[34:35], v[26:27], v[26:27]
    v_pk_fma_f32 v[28:29], v[28:29], v[242:243], v[240:241]
    v_pk_fma_f32 v[30:31], v[30:31], v[242:243], v[240:241]
    v_pk_fma_f32 v[32:33], v[32:33], v[242:243], v[240:241]
    v_pk_fma_f32 v[34:35], v[34:35], v[242:243], v[240:241]
    v_pk_mul_f32 v[28:29], v[28:29], v[20:21]
    v_pk_mul_f32 v[30:31], v[30:31], v[22:23]
    v_pk_mul_f32 v[32:33], v[32:33], v[24:25]
    v_pk_mul_f32 v[34:35], v[34:35], v[26:27]
    v_exp_f32 v28, v28
    v_exp_f32 v29, v29
    v_exp_f32 v30, v30
    v_exp_f32 v31, v31
    v_exp_f32 v32, v32
    v_exp_f32 v33, v33
    v_exp_f32 v34, v34
    v_exp_f32 v35, v35
    v_pk_add_f32 v[28:29], v[28:29], v[244:245]
    v_pk_add_f32 v[30:31], v[30:31], v[244:245]
    v_pk_add_f32 v[32:33], v[32:33], v[244:245]
    v_pk_add_f32 v[34:35], v[34:35], v[244:245]
    v_rcp_f32 v28, v28
    v_rcp_f32 v29, v29
    v_rcp_f32 v30, v30
    v_rcp_f32 v31, v31
    v_rcp_f32 v32, v32
    v_rcp_f32 v33, v33
    v_rcp_f32 v34, v34
    v_rcp_f32 v35, v35
    v_pk_mul_f32 v[20:21], v[28:29], v[20:21]
    v_pk_mul_f32 v[22:23], v[30:31], v[22:23]
    v_pk_mul_f32 v[24:25], v[32:33], v[24:25]
    v_pk_mul_f32 v[26:27], v[34:35], v[26:27]
    v_cvt_pk_bf16_f32 v36, v20, v21
    v_cvt_pk_bf16_f32 v37, v22, v23
    v_cvt_pk_bf16_f32 v38, v24, v25
    v_cvt_pk_bf16_f32 v39, v26, v27
    buffer_store_dwordx4 v[36:39], v252, s[4:7], s53 offen offset:3072 sc1
    s_add_u32 s53, s53, s22
    v_accvgpr_read_b32 v40, a64
    v_accvgpr_read_b32 v41, a65
    v_accvgpr_read_b32 v42, a66
    v_accvgpr_read_b32 v43, a67
    v_accvgpr_read_b32 v44, a68
    v_accvgpr_read_b32 v45, a69
    v_accvgpr_read_b32 v46, a70
    v_accvgpr_read_b32 v47, a71
    v_pk_mul_f32 v[48:49], v[40:41], v[40:41]
    v_pk_mul_f32 v[50:51], v[42:43], v[42:43]
    v_pk_mul_f32 v[52:53], v[44:45], v[44:45]
    v_pk_mul_f32 v[54:55], v[46:47], v[46:47]
    v_pk_fma_f32 v[48:49], v[48:49], v[242:243], v[240:241]
    v_pk_fma_f32 v[50:51], v[50:51], v[242:243], v[240:241]
    v_pk_fma_f32 v[52:53], v[52:53], v[242:243], v[240:241]
    v_pk_fma_f32 v[54:55], v[54:55], v[242:243], v[240:241]
    v_pk_mul_f32 v[48:49], v[48:49], v[40:41]
    v_pk_mul_f32 v[50:51], v[50:51], v[42:43]
    v_pk_mul_f32 v[52:53], v[52:53], v[44:45]
    v_pk_mul_f32 v[54:55], v[54:55], v[46:47]
    v_exp_f32 v48, v48
    v_exp_f32 v49, v49
    v_exp_f32 v50, v50
    v_exp_f32 v51, v51
    v_exp_f32 v52, v52
    v_exp_f32 v53, v53
    v_exp_f32 v54, v54
    v_exp_f32 v55, v55
    v_pk_add_f32 v[48:49], v[48:49], v[244:245]
    v_pk_add_f32 v[50:51], v[50:51], v[244:245]
    v_pk_add_f32 v[52:53], v[52:53], v[244:245]
    v_pk_add_f32 v[54:55], v[54:55], v[244:245]
    v_rcp_f32 v48, v48
    v_rcp_f32 v49, v49
    v_rcp_f32 v50, v50
    v_rcp_f32 v51, v51
    v_rcp_f32 v52, v52
    v_rcp_f32 v53, v53
    v_rcp_f32 v54, v54
    v_rcp_f32 v55, v55
    v_pk_mul_f32 v[40:41], v[48:49], v[40:41]
    v_pk_mul_f32 v[42:43], v[50:51], v[42:43]
    v_pk_mul_f32 v[44:45], v[52:53], v[44:45]
    v_pk_mul_f32 v[46:47], v[54:55], v[46:47]
    v_cvt_pk_bf16_f32 v56, v40, v41
    v_cvt_pk_bf16_f32 v57, v42, v43
    v_cvt_pk_bf16_f32 v58, v44, v45
    v_cvt_pk_bf16_f32 v59, v46, v47
    buffer_store_dwordx4 v[56:59], v252, s[4:7], s53 offen offset:0 sc1
    v_accvgpr_read_b32 v0, a72
    v_accvgpr_read_b32 v1, a73
    v_accvgpr_read_b32 v2, a74
    v_accvgpr_read_b32 v3, a75
    v_accvgpr_read_b32 v4, a76
    v_accvgpr_read_b32 v5, a77
    v_accvgpr_read_b32 v6, a78
    v_accvgpr_read_b32 v7, a79
    v_pk_mul_f32 v[8:9], v[0:1], v[0:1]
    v_pk_mul_f32 v[10:11], v[2:3], v[2:3]
    v_pk_mul_f32 v[12:13], v[4:5], v[4:5]
    v_pk_mul_f32 v[14:15], v[6:7], v[6:7]
    v_pk_fma_f32 v[8:9], v[8:9], v[242:243], v[240:241]
    v_pk_fma_f32 v[10:11], v[10:11], v[242:243], v[240:241]
    v_pk_fma_f32 v[12:13], v[12:13], v[242:243], v[240:241]
    v_pk_fma_f32 v[14:15], v[14:15], v[242:243], v[240:241]
    v_pk_mul_f32 v[8:9], v[8:9], v[0:1]
    v_pk_mul_f32 v[10:11], v[10:11], v[2:3]
    v_pk_mul_f32 v[12:13], v[12:13], v[4:5]
    v_pk_mul_f32 v[14:15], v[14:15], v[6:7]
    v_exp_f32 v8, v8
    v_exp_f32 v9, v9
    v_exp_f32 v10, v10
    v_exp_f32 v11, v11
    v_exp_f32 v12, v12
    v_exp_f32 v13, v13
    v_exp_f32 v14, v14
    v_exp_f32 v15, v15
    v_pk_add_f32 v[8:9], v[8:9], v[244:245]
    v_pk_add_f32 v[10:11], v[10:11], v[244:245]
    v_pk_add_f32 v[12:13], v[12:13], v[244:245]
    v_pk_add_f32 v[14:15], v[14:15], v[244:245]
    v_rcp_f32 v8, v8
    v_rcp_f32 v9, v9
    v_rcp_f32 v10, v10
    v_rcp_f32 v11, v11
    v_rcp_f32 v12, v12
    v_rcp_f32 v13, v13
    v_rcp_f32 v14, v14
    v_rcp_f32 v15, v15
    v_pk_mul_f32 v[0:1], v[8:9], v[0:1]
    v_pk_mul_f32 v[2:3], v[10:11], v[2:3]
    v_pk_mul_f32 v[4:5], v[12:13], v[4:5]
    v_pk_mul_f32 v[6:7], v[14:15], v[6:7]
    v_cvt_pk_bf16_f32 v16, v0, v1
    v_cvt_pk_bf16_f32 v17, v2, v3
    v_cvt_pk_bf16_f32 v18, v4, v5
    v_cvt_pk_bf16_f32 v19, v6, v7
    buffer_store_dwordx4 v[16:19], v252, s[4:7], s53 offen offset:1024 sc1
    v_accvgpr_read_b32 v20, a80
    v_accvgpr_read_b32 v21, a81
    v_accvgpr_read_b32 v22, a82
    v_accvgpr_read_b32 v23, a83
    v_accvgpr_read_b32 v24, a84
    v_accvgpr_read_b32 v25, a85
    v_accvgpr_read_b32 v26, a86
    v_accvgpr_read_b32 v27, a87
    v_pk_mul_f32 v[28:29], v[20:21], v[20:21]
    v_pk_mul_f32 v[30:31], v[22:23], v[22:23]
    v_pk_mul_f32 v[32:33], v[24:25], v[24:25]
    v_pk_mul_f32 v[34:35], v[26:27], v[26:27]
    v_pk_fma_f32 v[28:29], v[28:29], v[242:243], v[240:241]
    v_pk_fma_f32 v[30:31], v[30:31], v[242:243], v[240:241]
    v_pk_fma_f32 v[32:33], v[32:33], v[242:243], v[240:241]
    v_pk_fma_f32 v[34:35], v[34:35], v[242:243], v[240:241]
    v_pk_mul_f32 v[28:29], v[28:29], v[20:21]
    v_pk_mul_f32 v[30:31], v[30:31], v[22:23]
    v_pk_mul_f32 v[32:33], v[32:33], v[24:25]
    v_pk_mul_f32 v[34:35], v[34:35], v[26:27]
    v_exp_f32 v28, v28
    v_exp_f32 v29, v29
    v_exp_f32 v30, v30
    v_exp_f32 v31, v31
    v_exp_f32 v32, v32
    v_exp_f32 v33, v33
    v_exp_f32 v34, v34
    v_exp_f32 v35, v35
    v_pk_add_f32 v[28:29], v[28:29], v[244:245]
    v_pk_add_f32 v[30:31], v[30:31], v[244:245]
    v_pk_add_f32 v[32:33], v[32:33], v[244:245]
    v_pk_add_f32 v[34:35], v[34:35], v[244:245]
    v_rcp_f32 v28, v28
    v_rcp_f32 v29, v29
    v_rcp_f32 v30, v30
    v_rcp_f32 v31, v31
    v_rcp_f32 v32, v32
    v_rcp_f32 v33, v33
    v_rcp_f32 v34, v34
    v_rcp_f32 v35, v35
    v_pk_mul_f32 v[20:21], v[28:29], v[20:21]
    v_pk_mul_f32 v[22:23], v[30:31], v[22:23]
    v_pk_mul_f32 v[24:25], v[32:33], v[24:25]
    v_pk_mul_f32 v[26:27], v[34:35], v[26:27]
    v_cvt_pk_bf16_f32 v36, v20, v21
    v_cvt_pk_bf16_f32 v37, v22, v23
    v_cvt_pk_bf16_f32 v38, v24, v25
    v_cvt_pk_bf16_f32 v39, v26, v27
    buffer_store_dwordx4 v[36:39], v252, s[4:7], s53 offen offset:2048 sc1
    v_accvgpr_read_b32 v40, a88
    v_accvgpr_read_b32 v41, a89
    v_accvgpr_read_b32 v42, a90
    v_accvgpr_read_b32 v43, a91
    v_accvgpr_read_b32 v44, a92
    v_accvgpr_read_b32 v45, a93
    v_accvgpr_read_b32 v46, a94
    v_accvgpr_read_b32 v47, a95
    v_pk_mul_f32 v[48:49], v[40:41], v[40:41]
    v_pk_mul_f32 v[50:51], v[42:43], v[42:43]
    v_pk_mul_f32 v[52:53], v[44:45], v[44:45]
    v_pk_mul_f32 v[54:55], v[46:47], v[46:47]
    v_pk_fma_f32 v[48:49], v[48:49], v[242:243], v[240:241]
    v_pk_fma_f32 v[50:51], v[50:51], v[242:243], v[240:241]
    v_pk_fma_f32 v[52:53], v[52:53], v[242:243], v[240:241]
    v_pk_fma_f32 v[54:55], v[54:55], v[242:243], v[240:241]
    v_pk_mul_f32 v[48:49], v[48:49], v[40:41]
    v_pk_mul_f32 v[50:51], v[50:51], v[42:43]
    v_pk_mul_f32 v[52:53], v[52:53], v[44:45]
    v_pk_mul_f32 v[54:55], v[54:55], v[46:47]
    v_exp_f32 v48, v48
    v_exp_f32 v49, v49
    v_exp_f32 v50, v50
    v_exp_f32 v51, v51
    v_exp_f32 v52, v52
    v_exp_f32 v53, v53
    v_exp_f32 v54, v54
    v_exp_f32 v55, v55
    v_pk_add_f32 v[48:49], v[48:49], v[244:245]
    v_pk_add_f32 v[50:51], v[50:51], v[244:245]
    v_pk_add_f32 v[52:53], v[52:53], v[244:245]
    v_pk_add_f32 v[54:55], v[54:55], v[244:245]
    v_rcp_f32 v48, v48
    v_rcp_f32 v49, v49
    v_rcp_f32 v50, v50
    v_rcp_f32 v51, v51
    v_rcp_f32 v52, v52
    v_rcp_f32 v53, v53
    v_rcp_f32 v54, v54
    v_rcp_f32 v55, v55
    v_pk_mul_f32 v[40:41], v[48:49], v[40:41]
    v_pk_mul_f32 v[42:43], v[50:51], v[42:43]
    v_pk_mul_f32 v[44:45], v[52:53], v[44:45]
    v_pk_mul_f32 v[46:47], v[54:55], v[46:47]
    v_cvt_pk_bf16_f32 v56, v40, v41
    v_cvt_pk_bf16_f32 v57, v42, v43
    v_cvt_pk_bf16_f32 v58, v44, v45
    v_cvt_pk_bf16_f32 v59, v46, v47
    buffer_store_dwordx4 v[56:59], v252, s[4:7], s53 offen offset:3072 sc1
    s_add_u32 s53, s53, s22
    v_accvgpr_read_b32 v0, a96
    v_accvgpr_read_b32 v1, a97
    v_accvgpr_read_b32 v2, a98
    v_accvgpr_read_b32 v3, a99
    v_accvgpr_read_b32 v4, a100
    v_accvgpr_read_b32 v5, a101
    v_accvgpr_read_b32 v6, a102
    v_accvgpr_read_b32 v7, a103
    v_pk_mul_f32 v[8:9], v[0:1], v[0:1]
    v_pk_mul_f32 v[10:11], v[2:3], v[2:3]
    v_pk_mul_f32 v[12:13], v[4:5], v[4:5]
    v_pk_mul_f32 v[14:15], v[6:7], v[6:7]
    v_pk_fma_f32 v[8:9], v[8:9], v[242:243], v[240:241]
    v_pk_fma_f32 v[10:11], v[10:11], v[242:243], v[240:241]
    v_pk_fma_f32 v[12:13], v[12:13], v[242:243], v[240:241]
    v_pk_fma_f32 v[14:15], v[14:15], v[242:243], v[240:241]
    v_pk_mul_f32 v[8:9], v[8:9], v[0:1]
    v_pk_mul_f32 v[10:11], v[10:11], v[2:3]
    v_pk_mul_f32 v[12:13], v[12:13], v[4:5]
    v_pk_mul_f32 v[14:15], v[14:15], v[6:7]
    v_exp_f32 v8, v8
    v_exp_f32 v9, v9
    v_exp_f32 v10, v10
    v_exp_f32 v11, v11
    v_exp_f32 v12, v12
    v_exp_f32 v13, v13
    v_exp_f32 v14, v14
    v_exp_f32 v15, v15
    v_pk_add_f32 v[8:9], v[8:9], v[244:245]
    v_pk_add_f32 v[10:11], v[10:11], v[244:245]
    v_pk_add_f32 v[12:13], v[12:13], v[244:245]
    v_pk_add_f32 v[14:15], v[14:15], v[244:245]
    v_rcp_f32 v8, v8
    v_rcp_f32 v9, v9
    v_rcp_f32 v10, v10
    v_rcp_f32 v11, v11
    v_rcp_f32 v12, v12
    v_rcp_f32 v13, v13
    v_rcp_f32 v14, v14
    v_rcp_f32 v15, v15
    v_pk_mul_f32 v[0:1], v[8:9], v[0:1]
    v_pk_mul_f32 v[2:3], v[10:11], v[2:3]
    v_pk_mul_f32 v[4:5], v[12:13], v[4:5]
    v_pk_mul_f32 v[6:7], v[14:15], v[6:7]
    v_cvt_pk_bf16_f32 v16, v0, v1
    v_cvt_pk_bf16_f32 v17, v2, v3
    v_cvt_pk_bf16_f32 v18, v4, v5
    v_cvt_pk_bf16_f32 v19, v6, v7
    buffer_store_dwordx4 v[16:19], v252, s[4:7], s53 offen offset:0 sc1
    v_accvgpr_read_b32 v20, a104
    v_accvgpr_read_b32 v21, a105
    v_accvgpr_read_b32 v22, a106
    v_accvgpr_read_b32 v23, a107
    v_accvgpr_read_b32 v24, a108
    v_accvgpr_read_b32 v25, a109
    v_accvgpr_read_b32 v26, a110
    v_accvgpr_read_b32 v27, a111
    v_pk_mul_f32 v[28:29], v[20:21], v[20:21]
    v_pk_mul_f32 v[30:31], v[22:23], v[22:23]
    v_pk_mul_f32 v[32:33], v[24:25], v[24:25]
    v_pk_mul_f32 v[34:35], v[26:27], v[26:27]
    v_pk_fma_f32 v[28:29], v[28:29], v[242:243], v[240:241]
    v_pk_fma_f32 v[30:31], v[30:31], v[242:243], v[240:241]
    v_pk_fma_f32 v[32:33], v[32:33], v[242:243], v[240:241]
    v_pk_fma_f32 v[34:35], v[34:35], v[242:243], v[240:241]
    v_pk_mul_f32 v[28:29], v[28:29], v[20:21]
    v_pk_mul_f32 v[30:31], v[30:31], v[22:23]
    v_pk_mul_f32 v[32:33], v[32:33], v[24:25]
    v_pk_mul_f32 v[34:35], v[34:35], v[26:27]
    v_exp_f32 v28, v28
    v_exp_f32 v29, v29
    v_exp_f32 v30, v30
    v_exp_f32 v31, v31
    v_exp_f32 v32, v32
    v_exp_f32 v33, v33
    v_exp_f32 v34, v34
    v_exp_f32 v35, v35
    v_pk_add_f32 v[28:29], v[28:29], v[244:245]
    v_pk_add_f32 v[30:31], v[30:31], v[244:245]
    v_pk_add_f32 v[32:33], v[32:33], v[244:245]
    v_pk_add_f32 v[34:35], v[34:35], v[244:245]
    v_rcp_f32 v28, v28
    v_rcp_f32 v29, v29
    v_rcp_f32 v30, v30
    v_rcp_f32 v31, v31
    v_rcp_f32 v32, v32
    v_rcp_f32 v33, v33
    v_rcp_f32 v34, v34
    v_rcp_f32 v35, v35
    v_pk_mul_f32 v[20:21], v[28:29], v[20:21]
    v_pk_mul_f32 v[22:23], v[30:31], v[22:23]
    v_pk_mul_f32 v[24:25], v[32:33], v[24:25]
    v_pk_mul_f32 v[26:27], v[34:35], v[26:27]
    v_cvt_pk_bf16_f32 v36, v20, v21
    v_cvt_pk_bf16_f32 v37, v22, v23
    v_cvt_pk_bf16_f32 v38, v24, v25
    v_cvt_pk_bf16_f32 v39, v26, v27
    buffer_store_dwordx4 v[36:39], v252, s[4:7], s53 offen offset:1024 sc1
    v_accvgpr_read_b32 v40, a112
    v_accvgpr_read_b32 v41, a113
    v_accvgpr_read_b32 v42, a114
    v_accvgpr_read_b32 v43, a115
    v_accvgpr_read_b32 v44, a116
    v_accvgpr_read_b32 v45, a117
    v_accvgpr_read_b32 v46, a118
    v_accvgpr_read_b32 v47, a119
    v_pk_mul_f32 v[48:49], v[40:41], v[40:41]
    v_pk_mul_f32 v[50:51], v[42:43], v[42:43]
    v_pk_mul_f32 v[52:53], v[44:45], v[44:45]
    v_pk_mul_f32 v[54:55], v[46:47], v[46:47]
    v_pk_fma_f32 v[48:49], v[48:49], v[242:243], v[240:241]
    v_pk_fma_f32 v[50:51], v[50:51], v[242:243], v[240:241]
    v_pk_fma_f32 v[52:53], v[52:53], v[242:243], v[240:241]
    v_pk_fma_f32 v[54:55], v[54:55], v[242:243], v[240:241]
    v_pk_mul_f32 v[48:49], v[48:49], v[40:41]
    v_pk_mul_f32 v[50:51], v[50:51], v[42:43]
    v_pk_mul_f32 v[52:53], v[52:53], v[44:45]
    v_pk_mul_f32 v[54:55], v[54:55], v[46:47]
    v_exp_f32 v48, v48
    v_exp_f32 v49, v49
    v_exp_f32 v50, v50
    v_exp_f32 v51, v51
    v_exp_f32 v52, v52
    v_exp_f32 v53, v53
    v_exp_f32 v54, v54
    v_exp_f32 v55, v55
    v_pk_add_f32 v[48:49], v[48:49], v[244:245]
    v_pk_add_f32 v[50:51], v[50:51], v[244:245]
    v_pk_add_f32 v[52:53], v[52:53], v[244:245]
    v_pk_add_f32 v[54:55], v[54:55], v[244:245]
    v_rcp_f32 v48, v48
    v_rcp_f32 v49, v49
    v_rcp_f32 v50, v50
    v_rcp_f32 v51, v51
    v_rcp_f32 v52, v52
    v_rcp_f32 v53, v53
    v_rcp_f32 v54, v54
    v_rcp_f32 v55, v55
    v_pk_mul_f32 v[40:41], v[48:49], v[40:41]
    v_pk_mul_f32 v[42:43], v[50:51], v[42:43]
    v_pk_mul_f32 v[44:45], v[52:53], v[44:45]
    v_pk_mul_f32 v[46:47], v[54:55], v[46:47]
    v_cvt_pk_bf16_f32 v56, v40, v41
    v_cvt_pk_bf16_f32 v57, v42, v43
    v_cvt_pk_bf16_f32 v58, v44, v45
    v_cvt_pk_bf16_f32 v59, v46, v47
    buffer_store_dwordx4 v[56:59], v252, s[4:7], s53 offen offset:2048 sc1
    v_accvgpr_read_b32 v0, a120
    v_accvgpr_read_b32 v1, a121
    v_accvgpr_read_b32 v2, a122
    v_accvgpr_read_b32 v3, a123
    v_accvgpr_read_b32 v4, a124
    v_accvgpr_read_b32 v5, a125
    v_accvgpr_read_b32 v6, a126
    v_accvgpr_read_b32 v7, a127
    v_pk_mul_f32 v[8:9], v[0:1], v[0:1]
    v_pk_mul_f32 v[10:11], v[2:3], v[2:3]
    v_pk_mul_f32 v[12:13], v[4:5], v[4:5]
    v_pk_mul_f32 v[14:15], v[6:7], v[6:7]
    v_pk_fma_f32 v[8:9], v[8:9], v[242:243], v[240:241]
    v_pk_fma_f32 v[10:11], v[10:11], v[242:243], v[240:241]
    v_pk_fma_f32 v[12:13], v[12:13], v[242:243], v[240:241]
    v_pk_fma_f32 v[14:15], v[14:15], v[242:243], v[240:241]
    v_pk_mul_f32 v[8:9], v[8:9], v[0:1]
    v_pk_mul_f32 v[10:11], v[10:11], v[2:3]
    v_pk_mul_f32 v[12:13], v[12:13], v[4:5]
    v_pk_mul_f32 v[14:15], v[14:15], v[6:7]
    v_exp_f32 v8, v8
    v_exp_f32 v9, v9
    v_exp_f32 v10, v10
    v_exp_f32 v11, v11
    v_exp_f32 v12, v12
    v_exp_f32 v13, v13
    v_exp_f32 v14, v14
    v_exp_f32 v15, v15
    v_pk_add_f32 v[8:9], v[8:9], v[244:245]
    v_pk_add_f32 v[10:11], v[10:11], v[244:245]
    v_pk_add_f32 v[12:13], v[12:13], v[244:245]
    v_pk_add_f32 v[14:15], v[14:15], v[244:245]
    v_rcp_f32 v8, v8
    v_rcp_f32 v9, v9
    v_rcp_f32 v10, v10
    v_rcp_f32 v11, v11
    v_rcp_f32 v12, v12
    v_rcp_f32 v13, v13
    v_rcp_f32 v14, v14
    v_rcp_f32 v15, v15
    v_pk_mul_f32 v[0:1], v[8:9], v[0:1]
    v_pk_mul_f32 v[2:3], v[10:11], v[2:3]
    v_pk_mul_f32 v[4:5], v[12:13], v[4:5]
    v_pk_mul_f32 v[6:7], v[14:15], v[6:7]
    v_cvt_pk_bf16_f32 v16, v0, v1
    v_cvt_pk_bf16_f32 v17, v2, v3
    v_cvt_pk_bf16_f32 v18, v4, v5
    v_cvt_pk_bf16_f32 v19, v6, v7
    buffer_store_dwordx4 v[16:19], v252, s[4:7], s53 offen offset:3072 sc1
    s_branch main_kernel_w_done
main_kernel_w_c1_egelu:
    s_mov_b32 s53, s21
    v_accvgpr_read_b32 v0, a0
    v_accvgpr_read_b32 v1, a1
    v_accvgpr_read_b32 v2, a2
    v_accvgpr_read_b32 v3, a3
    v_accvgpr_read_b32 v4, a4
    v_accvgpr_read_b32 v5, a5
    v_accvgpr_read_b32 v6, a6
    v_accvgpr_read_b32 v7, a7
    v_pk_mul_f32 v[8:9], v[0:1], v[0:1]
    v_pk_mul_f32 v[10:11], v[2:3], v[2:3]
    v_pk_mul_f32 v[12:13], v[4:5], v[4:5]
    v_pk_mul_f32 v[14:15], v[6:7], v[6:7]
    v_pk_fma_f32 v[8:9], v[8:9], v[242:243], v[240:241]
    v_pk_fma_f32 v[10:11], v[10:11], v[242:243], v[240:241]
    v_pk_fma_f32 v[12:13], v[12:13], v[242:243], v[240:241]
    v_pk_fma_f32 v[14:15], v[14:15], v[242:243], v[240:241]
    v_pk_mul_f32 v[8:9], v[8:9], v[0:1]
    v_pk_mul_f32 v[10:11], v[10:11], v[2:3]
    v_pk_mul_f32 v[12:13], v[12:13], v[4:5]
    v_pk_mul_f32 v[14:15], v[14:15], v[6:7]
    v_exp_f32 v8, v8
    v_exp_f32 v9, v9
    v_exp_f32 v10, v10
    v_exp_f32 v11, v11
    v_exp_f32 v12, v12
    v_exp_f32 v13, v13
    v_exp_f32 v14, v14
    v_exp_f32 v15, v15
    v_pk_add_f32 v[8:9], v[8:9], v[244:245]
    v_pk_add_f32 v[10:11], v[10:11], v[244:245]
    v_pk_add_f32 v[12:13], v[12:13], v[244:245]
    v_pk_add_f32 v[14:15], v[14:15], v[244:245]
    v_rcp_f32 v8, v8
    v_rcp_f32 v9, v9
    v_rcp_f32 v10, v10
    v_rcp_f32 v11, v11
    v_rcp_f32 v12, v12
    v_rcp_f32 v13, v13
    v_rcp_f32 v14, v14
    v_rcp_f32 v15, v15
    v_pk_mul_f32 v[0:1], v[8:9], v[0:1]
    v_pk_mul_f32 v[2:3], v[10:11], v[2:3]
    v_pk_mul_f32 v[4:5], v[12:13], v[4:5]
    v_pk_mul_f32 v[6:7], v[14:15], v[6:7]
    v_cvt_pk_bf16_f32 v16, v0, v1
    v_cvt_pk_bf16_f32 v17, v2, v3
    v_cvt_pk_bf16_f32 v18, v4, v5
    v_cvt_pk_bf16_f32 v19, v6, v7
    buffer_store_dwordx4 v[16:19], v251, s[4:7], s53 offen offset:0 sc1
    v_accvgpr_read_b32 v20, a8
    v_accvgpr_read_b32 v21, a9
    v_accvgpr_read_b32 v22, a10
    v_accvgpr_read_b32 v23, a11
    v_accvgpr_read_b32 v24, a12
    v_accvgpr_read_b32 v25, a13
    v_accvgpr_read_b32 v26, a14
    v_accvgpr_read_b32 v27, a15
    v_pk_mul_f32 v[28:29], v[20:21], v[20:21]
    v_pk_mul_f32 v[30:31], v[22:23], v[22:23]
    v_pk_mul_f32 v[32:33], v[24:25], v[24:25]
    v_pk_mul_f32 v[34:35], v[26:27], v[26:27]
    v_pk_fma_f32 v[28:29], v[28:29], v[242:243], v[240:241]
    v_pk_fma_f32 v[30:31], v[30:31], v[242:243], v[240:241]
    v_pk_fma_f32 v[32:33], v[32:33], v[242:243], v[240:241]
    v_pk_fma_f32 v[34:35], v[34:35], v[242:243], v[240:241]
    v_pk_mul_f32 v[28:29], v[28:29], v[20:21]
    v_pk_mul_f32 v[30:31], v[30:31], v[22:23]
    v_pk_mul_f32 v[32:33], v[32:33], v[24:25]
    v_pk_mul_f32 v[34:35], v[34:35], v[26:27]
    v_exp_f32 v28, v28
    v_exp_f32 v29, v29
    v_exp_f32 v30, v30
    v_exp_f32 v31, v31
    v_exp_f32 v32, v32
    v_exp_f32 v33, v33
    v_exp_f32 v34, v34
    v_exp_f32 v35, v35
    v_pk_add_f32 v[28:29], v[28:29], v[244:245]
    v_pk_add_f32 v[30:31], v[30:31], v[244:245]
    v_pk_add_f32 v[32:33], v[32:33], v[244:245]
    v_pk_add_f32 v[34:35], v[34:35], v[244:245]
    v_rcp_f32 v28, v28
    v_rcp_f32 v29, v29
    v_rcp_f32 v30, v30
    v_rcp_f32 v31, v31
    v_rcp_f32 v32, v32
    v_rcp_f32 v33, v33
    v_rcp_f32 v34, v34
    v_rcp_f32 v35, v35
    v_pk_mul_f32 v[20:21], v[28:29], v[20:21]
    v_pk_mul_f32 v[22:23], v[30:31], v[22:23]
    v_pk_mul_f32 v[24:25], v[32:33], v[24:25]
    v_pk_mul_f32 v[26:27], v[34:35], v[26:27]
    v_cvt_pk_bf16_f32 v36, v20, v21
    v_cvt_pk_bf16_f32 v37, v22, v23
    v_cvt_pk_bf16_f32 v38, v24, v25
    v_cvt_pk_bf16_f32 v39, v26, v27
    buffer_store_dwordx4 v[36:39], v251, s[4:7], s53 offen offset:1024 sc1
    v_accvgpr_read_b32 v40, a16
    v_accvgpr_read_b32 v41, a17
    v_accvgpr_read_b32 v42, a18
    v_accvgpr_read_b32 v43, a19
    v_accvgpr_read_b32 v44, a20
    v_accvgpr_read_b32 v45, a21
    v_accvgpr_read_b32 v46, a22
    v_accvgpr_read_b32 v47, a23
    v_pk_mul_f32 v[48:49], v[40:41], v[40:41]
    v_pk_mul_f32 v[50:51], v[42:43], v[42:43]
    v_pk_mul_f32 v[52:53], v[44:45], v[44:45]
    v_pk_mul_f32 v[54:55], v[46:47], v[46:47]
    v_pk_fma_f32 v[48:49], v[48:49], v[242:243], v[240:241]
    v_pk_fma_f32 v[50:51], v[50:51], v[242:243], v[240:241]
    v_pk_fma_f32 v[52:53], v[52:53], v[242:243], v[240:241]
    v_pk_fma_f32 v[54:55], v[54:55], v[242:243], v[240:241]
    v_pk_mul_f32 v[48:49], v[48:49], v[40:41]
    v_pk_mul_f32 v[50:51], v[50:51], v[42:43]
    v_pk_mul_f32 v[52:53], v[52:53], v[44:45]
    v_pk_mul_f32 v[54:55], v[54:55], v[46:47]
    v_exp_f32 v48, v48
    v_exp_f32 v49, v49
    v_exp_f32 v50, v50
    v_exp_f32 v51, v51
    v_exp_f32 v52, v52
    v_exp_f32 v53, v53
    v_exp_f32 v54, v54
    v_exp_f32 v55, v55
    v_pk_add_f32 v[48:49], v[48:49], v[244:245]
    v_pk_add_f32 v[50:51], v[50:51], v[244:245]
    v_pk_add_f32 v[52:53], v[52:53], v[244:245]
    v_pk_add_f32 v[54:55], v[54:55], v[244:245]
    v_rcp_f32 v48, v48
    v_rcp_f32 v49, v49
    v_rcp_f32 v50, v50
    v_rcp_f32 v51, v51
    v_rcp_f32 v52, v52
    v_rcp_f32 v53, v53
    v_rcp_f32 v54, v54
    v_rcp_f32 v55, v55
    v_pk_mul_f32 v[40:41], v[48:49], v[40:41]
    v_pk_mul_f32 v[42:43], v[50:51], v[42:43]
    v_pk_mul_f32 v[44:45], v[52:53], v[44:45]
    v_pk_mul_f32 v[46:47], v[54:55], v[46:47]
    v_cvt_pk_bf16_f32 v56, v40, v41
    v_cvt_pk_bf16_f32 v57, v42, v43
    v_cvt_pk_bf16_f32 v58, v44, v45
    v_cvt_pk_bf16_f32 v59, v46, v47
    buffer_store_dwordx4 v[56:59], v251, s[4:7], s53 offen offset:2048 sc1
    v_accvgpr_read_b32 v0, a24
    v_accvgpr_read_b32 v1, a25
    v_accvgpr_read_b32 v2, a26
    v_accvgpr_read_b32 v3, a27
    v_accvgpr_read_b32 v4, a28
    v_accvgpr_read_b32 v5, a29
    v_accvgpr_read_b32 v6, a30
    v_accvgpr_read_b32 v7, a31
    v_pk_mul_f32 v[8:9], v[0:1], v[0:1]
    v_pk_mul_f32 v[10:11], v[2:3], v[2:3]
    v_pk_mul_f32 v[12:13], v[4:5], v[4:5]
    v_pk_mul_f32 v[14:15], v[6:7], v[6:7]
    v_pk_fma_f32 v[8:9], v[8:9], v[242:243], v[240:241]
    v_pk_fma_f32 v[10:11], v[10:11], v[242:243], v[240:241]
    v_pk_fma_f32 v[12:13], v[12:13], v[242:243], v[240:241]
    v_pk_fma_f32 v[14:15], v[14:15], v[242:243], v[240:241]
    v_pk_mul_f32 v[8:9], v[8:9], v[0:1]
    v_pk_mul_f32 v[10:11], v[10:11], v[2:3]
    v_pk_mul_f32 v[12:13], v[12:13], v[4:5]
    v_pk_mul_f32 v[14:15], v[14:15], v[6:7]
    v_exp_f32 v8, v8
    v_exp_f32 v9, v9
    v_exp_f32 v10, v10
    v_exp_f32 v11, v11
    v_exp_f32 v12, v12
    v_exp_f32 v13, v13
    v_exp_f32 v14, v14
    v_exp_f32 v15, v15
    v_pk_add_f32 v[8:9], v[8:9], v[244:245]
    v_pk_add_f32 v[10:11], v[10:11], v[244:245]
    v_pk_add_f32 v[12:13], v[12:13], v[244:245]
    v_pk_add_f32 v[14:15], v[14:15], v[244:245]
    v_rcp_f32 v8, v8
    v_rcp_f32 v9, v9
    v_rcp_f32 v10, v10
    v_rcp_f32 v11, v11
    v_rcp_f32 v12, v12
    v_rcp_f32 v13, v13
    v_rcp_f32 v14, v14
    v_rcp_f32 v15, v15
    v_pk_mul_f32 v[0:1], v[8:9], v[0:1]
    v_pk_mul_f32 v[2:3], v[10:11], v[2:3]
    v_pk_mul_f32 v[4:5], v[12:13], v[4:5]
    v_pk_mul_f32 v[6:7], v[14:15], v[6:7]
    v_cvt_pk_bf16_f32 v16, v0, v1
    v_cvt_pk_bf16_f32 v17, v2, v3
    v_cvt_pk_bf16_f32 v18, v4, v5
    v_cvt_pk_bf16_f32 v19, v6, v7
    buffer_store_dwordx4 v[16:19], v251, s[4:7], s53 offen offset:3072 sc1
    s_add_u32 s53, s53, s22
    v_accvgpr_read_b32 v20, a32
    v_accvgpr_read_b32 v21, a33
    v_accvgpr_read_b32 v22, a34
    v_accvgpr_read_b32 v23, a35
    v_accvgpr_read_b32 v24, a36
    v_accvgpr_read_b32 v25, a37
    v_accvgpr_read_b32 v26, a38
    v_accvgpr_read_b32 v27, a39
    v_pk_mul_f32 v[28:29], v[20:21], v[20:21]
    v_pk_mul_f32 v[30:31], v[22:23], v[22:23]
    v_pk_mul_f32 v[32:33], v[24:25], v[24:25]
    v_pk_mul_f32 v[34:35], v[26:27], v[26:27]
    v_pk_fma_f32 v[28:29], v[28:29], v[242:243], v[240:241]
    v_pk_fma_f32 v[30:31], v[30:31], v[242:243], v[240:241]
    v_pk_fma_f32 v[32:33], v[32:33], v[242:243], v[240:241]
    v_pk_fma_f32 v[34:35], v[34:35], v[242:243], v[240:241]
    v_pk_mul_f32 v[28:29], v[28:29], v[20:21]
    v_pk_mul_f32 v[30:31], v[30:31], v[22:23]
    v_pk_mul_f32 v[32:33], v[32:33], v[24:25]
    v_pk_mul_f32 v[34:35], v[34:35], v[26:27]
    v_exp_f32 v28, v28
    v_exp_f32 v29, v29
    v_exp_f32 v30, v30
    v_exp_f32 v31, v31
    v_exp_f32 v32, v32
    v_exp_f32 v33, v33
    v_exp_f32 v34, v34
    v_exp_f32 v35, v35
    v_pk_add_f32 v[28:29], v[28:29], v[244:245]
    v_pk_add_f32 v[30:31], v[30:31], v[244:245]
    v_pk_add_f32 v[32:33], v[32:33], v[244:245]
    v_pk_add_f32 v[34:35], v[34:35], v[244:245]
    v_rcp_f32 v28, v28
    v_rcp_f32 v29, v29
    v_rcp_f32 v30, v30
    v_rcp_f32 v31, v31
    v_rcp_f32 v32, v32
    v_rcp_f32 v33, v33
    v_rcp_f32 v34, v34
    v_rcp_f32 v35, v35
    v_pk_mul_f32 v[20:21], v[28:29], v[20:21]
    v_pk_mul_f32 v[22:23], v[30:31], v[22:23]
    v_pk_mul_f32 v[24:25], v[32:33], v[24:25]
    v_pk_mul_f32 v[26:27], v[34:35], v[26:27]
    v_cvt_pk_bf16_f32 v36, v20, v21
    v_cvt_pk_bf16_f32 v37, v22, v23
    v_cvt_pk_bf16_f32 v38, v24, v25
    v_cvt_pk_bf16_f32 v39, v26, v27
    buffer_store_dwordx4 v[36:39], v251, s[4:7], s53 offen offset:0 sc1
    v_accvgpr_read_b32 v40, a40
    v_accvgpr_read_b32 v41, a41
    v_accvgpr_read_b32 v42, a42
    v_accvgpr_read_b32 v43, a43
    v_accvgpr_read_b32 v44, a44
    v_accvgpr_read_b32 v45, a45
    v_accvgpr_read_b32 v46, a46
    v_accvgpr_read_b32 v47, a47
    v_pk_mul_f32 v[48:49], v[40:41], v[40:41]
    v_pk_mul_f32 v[50:51], v[42:43], v[42:43]
    v_pk_mul_f32 v[52:53], v[44:45], v[44:45]
    v_pk_mul_f32 v[54:55], v[46:47], v[46:47]
    v_pk_fma_f32 v[48:49], v[48:49], v[242:243], v[240:241]
    v_pk_fma_f32 v[50:51], v[50:51], v[242:243], v[240:241]
    v_pk_fma_f32 v[52:53], v[52:53], v[242:243], v[240:241]
    v_pk_fma_f32 v[54:55], v[54:55], v[242:243], v[240:241]
    v_pk_mul_f32 v[48:49], v[48:49], v[40:41]
    v_pk_mul_f32 v[50:51], v[50:51], v[42:43]
    v_pk_mul_f32 v[52:53], v[52:53], v[44:45]
    v_pk_mul_f32 v[54:55], v[54:55], v[46:47]
    v_exp_f32 v48, v48
    v_exp_f32 v49, v49
    v_exp_f32 v50, v50
    v_exp_f32 v51, v51
    v_exp_f32 v52, v52
    v_exp_f32 v53, v53
    v_exp_f32 v54, v54
    v_exp_f32 v55, v55
    v_pk_add_f32 v[48:49], v[48:49], v[244:245]
    v_pk_add_f32 v[50:51], v[50:51], v[244:245]
    v_pk_add_f32 v[52:53], v[52:53], v[244:245]
    v_pk_add_f32 v[54:55], v[54:55], v[244:245]
    v_rcp_f32 v48, v48
    v_rcp_f32 v49, v49
    v_rcp_f32 v50, v50
    v_rcp_f32 v51, v51
    v_rcp_f32 v52, v52
    v_rcp_f32 v53, v53
    v_rcp_f32 v54, v54
    v_rcp_f32 v55, v55
    v_pk_mul_f32 v[40:41], v[48:49], v[40:41]
    v_pk_mul_f32 v[42:43], v[50:51], v[42:43]
    v_pk_mul_f32 v[44:45], v[52:53], v[44:45]
    v_pk_mul_f32 v[46:47], v[54:55], v[46:47]
    v_cvt_pk_bf16_f32 v56, v40, v41
    v_cvt_pk_bf16_f32 v57, v42, v43
    v_cvt_pk_bf16_f32 v58, v44, v45
    v_cvt_pk_bf16_f32 v59, v46, v47
    buffer_store_dwordx4 v[56:59], v251, s[4:7], s53 offen offset:1024 sc1
    v_accvgpr_read_b32 v0, a48
    v_accvgpr_read_b32 v1, a49
    v_accvgpr_read_b32 v2, a50
    v_accvgpr_read_b32 v3, a51
    v_accvgpr_read_b32 v4, a52
    v_accvgpr_read_b32 v5, a53
    v_accvgpr_read_b32 v6, a54
    v_accvgpr_read_b32 v7, a55
    v_pk_mul_f32 v[8:9], v[0:1], v[0:1]
    v_pk_mul_f32 v[10:11], v[2:3], v[2:3]
    v_pk_mul_f32 v[12:13], v[4:5], v[4:5]
    v_pk_mul_f32 v[14:15], v[6:7], v[6:7]
    v_pk_fma_f32 v[8:9], v[8:9], v[242:243], v[240:241]
    v_pk_fma_f32 v[10:11], v[10:11], v[242:243], v[240:241]
    v_pk_fma_f32 v[12:13], v[12:13], v[242:243], v[240:241]
    v_pk_fma_f32 v[14:15], v[14:15], v[242:243], v[240:241]
    v_pk_mul_f32 v[8:9], v[8:9], v[0:1]
    v_pk_mul_f32 v[10:11], v[10:11], v[2:3]
    v_pk_mul_f32 v[12:13], v[12:13], v[4:5]
    v_pk_mul_f32 v[14:15], v[14:15], v[6:7]
    v_exp_f32 v8, v8
    v_exp_f32 v9, v9
    v_exp_f32 v10, v10
    v_exp_f32 v11, v11
    v_exp_f32 v12, v12
    v_exp_f32 v13, v13
    v_exp_f32 v14, v14
    v_exp_f32 v15, v15
    v_pk_add_f32 v[8:9], v[8:9], v[244:245]
    v_pk_add_f32 v[10:11], v[10:11], v[244:245]
    v_pk_add_f32 v[12:13], v[12:13], v[244:245]
    v_pk_add_f32 v[14:15], v[14:15], v[244:245]
    v_rcp_f32 v8, v8
    v_rcp_f32 v9, v9
    v_rcp_f32 v10, v10
    v_rcp_f32 v11, v11
    v_rcp_f32 v12, v12
    v_rcp_f32 v13, v13
    v_rcp_f32 v14, v14
    v_rcp_f32 v15, v15
    v_pk_mul_f32 v[0:1], v[8:9], v[0:1]
    v_pk_mul_f32 v[2:3], v[10:11], v[2:3]
    v_pk_mul_f32 v[4:5], v[12:13], v[4:5]
    v_pk_mul_f32 v[6:7], v[14:15], v[6:7]
    v_cvt_pk_bf16_f32 v16, v0, v1
    v_cvt_pk_bf16_f32 v17, v2, v3
    v_cvt_pk_bf16_f32 v18, v4, v5
    v_cvt_pk_bf16_f32 v19, v6, v7
    buffer_store_dwordx4 v[16:19], v251, s[4:7], s53 offen offset:2048 sc1
    v_accvgpr_read_b32 v20, a56
    v_accvgpr_read_b32 v21, a57
    v_accvgpr_read_b32 v22, a58
    v_accvgpr_read_b32 v23, a59
    v_accvgpr_read_b32 v24, a60
    v_accvgpr_read_b32 v25, a61
    v_accvgpr_read_b32 v26, a62
    v_accvgpr_read_b32 v27, a63
    v_pk_mul_f32 v[28:29], v[20:21], v[20:21]
    v_pk_mul_f32 v[30:31], v[22:23], v[22:23]
    v_pk_mul_f32 v[32:33], v[24:25], v[24:25]
    v_pk_mul_f32 v[34:35], v[26:27], v[26:27]
    v_pk_fma_f32 v[28:29], v[28:29], v[242:243], v[240:241]
    v_pk_fma_f32 v[30:31], v[30:31], v[242:243], v[240:241]
    v_pk_fma_f32 v[32:33], v[32:33], v[242:243], v[240:241]
    v_pk_fma_f32 v[34:35], v[34:35], v[242:243], v[240:241]
    v_pk_mul_f32 v[28:29], v[28:29], v[20:21]
    v_pk_mul_f32 v[30:31], v[30:31], v[22:23]
    v_pk_mul_f32 v[32:33], v[32:33], v[24:25]
    v_pk_mul_f32 v[34:35], v[34:35], v[26:27]
    v_exp_f32 v28, v28
    v_exp_f32 v29, v29
    v_exp_f32 v30, v30
    v_exp_f32 v31, v31
    v_exp_f32 v32, v32
    v_exp_f32 v33, v33
    v_exp_f32 v34, v34
    v_exp_f32 v35, v35
    v_pk_add_f32 v[28:29], v[28:29], v[244:245]
    v_pk_add_f32 v[30:31], v[30:31], v[244:245]
    v_pk_add_f32 v[32:33], v[32:33], v[244:245]
    v_pk_add_f32 v[34:35], v[34:35], v[244:245]
    v_rcp_f32 v28, v28
    v_rcp_f32 v29, v29
    v_rcp_f32 v30, v30
    v_rcp_f32 v31, v31
    v_rcp_f32 v32, v32
    v_rcp_f32 v33, v33
    v_rcp_f32 v34, v34
    v_rcp_f32 v35, v35
    v_pk_mul_f32 v[20:21], v[28:29], v[20:21]
    v_pk_mul_f32 v[22:23], v[30:31], v[22:23]
    v_pk_mul_f32 v[24:25], v[32:33], v[24:25]
    v_pk_mul_f32 v[26:27], v[34:35], v[26:27]
    v_cvt_pk_bf16_f32 v36, v20, v21
    v_cvt_pk_bf16_f32 v37, v22, v23
    v_cvt_pk_bf16_f32 v38, v24, v25
    v_cvt_pk_bf16_f32 v39, v26, v27
    buffer_store_dwordx4 v[36:39], v251, s[4:7], s53 offen offset:3072 sc1
    s_add_u32 s53, s53, s22
    v_accvgpr_read_b32 v40, a64
    v_accvgpr_read_b32 v41, a65
    v_accvgpr_read_b32 v42, a66
    v_accvgpr_read_b32 v43, a67
    v_accvgpr_read_b32 v44, a68
    v_accvgpr_read_b32 v45, a69
    v_accvgpr_read_b32 v46, a70
    v_accvgpr_read_b32 v47, a71
    v_pk_mul_f32 v[48:49], v[40:41], v[40:41]
    v_pk_mul_f32 v[50:51], v[42:43], v[42:43]
    v_pk_mul_f32 v[52:53], v[44:45], v[44:45]
    v_pk_mul_f32 v[54:55], v[46:47], v[46:47]
    v_pk_fma_f32 v[48:49], v[48:49], v[242:243], v[240:241]
    v_pk_fma_f32 v[50:51], v[50:51], v[242:243], v[240:241]
    v_pk_fma_f32 v[52:53], v[52:53], v[242:243], v[240:241]
    v_pk_fma_f32 v[54:55], v[54:55], v[242:243], v[240:241]
    v_pk_mul_f32 v[48:49], v[48:49], v[40:41]
    v_pk_mul_f32 v[50:51], v[50:51], v[42:43]
    v_pk_mul_f32 v[52:53], v[52:53], v[44:45]
    v_pk_mul_f32 v[54:55], v[54:55], v[46:47]
    v_exp_f32 v48, v48
    v_exp_f32 v49, v49
    v_exp_f32 v50, v50
    v_exp_f32 v51, v51
    v_exp_f32 v52, v52
    v_exp_f32 v53, v53
    v_exp_f32 v54, v54
    v_exp_f32 v55, v55
    v_pk_add_f32 v[48:49], v[48:49], v[244:245]
    v_pk_add_f32 v[50:51], v[50:51], v[244:245]
    v_pk_add_f32 v[52:53], v[52:53], v[244:245]
    v_pk_add_f32 v[54:55], v[54:55], v[244:245]
    v_rcp_f32 v48, v48
    v_rcp_f32 v49, v49
    v_rcp_f32 v50, v50
    v_rcp_f32 v51, v51
    v_rcp_f32 v52, v52
    v_rcp_f32 v53, v53
    v_rcp_f32 v54, v54
    v_rcp_f32 v55, v55
    v_pk_mul_f32 v[40:41], v[48:49], v[40:41]
    v_pk_mul_f32 v[42:43], v[50:51], v[42:43]
    v_pk_mul_f32 v[44:45], v[52:53], v[44:45]
    v_pk_mul_f32 v[46:47], v[54:55], v[46:47]
    v_cvt_pk_bf16_f32 v56, v40, v41
    v_cvt_pk_bf16_f32 v57, v42, v43
    v_cvt_pk_bf16_f32 v58, v44, v45
    v_cvt_pk_bf16_f32 v59, v46, v47
    buffer_store_dwordx4 v[56:59], v251, s[4:7], s53 offen offset:0 sc1
    v_accvgpr_read_b32 v0, a72
    v_accvgpr_read_b32 v1, a73
    v_accvgpr_read_b32 v2, a74
    v_accvgpr_read_b32 v3, a75
    v_accvgpr_read_b32 v4, a76
    v_accvgpr_read_b32 v5, a77
    v_accvgpr_read_b32 v6, a78
    v_accvgpr_read_b32 v7, a79
    v_pk_mul_f32 v[8:9], v[0:1], v[0:1]
    v_pk_mul_f32 v[10:11], v[2:3], v[2:3]
    v_pk_mul_f32 v[12:13], v[4:5], v[4:5]
    v_pk_mul_f32 v[14:15], v[6:7], v[6:7]
    v_pk_fma_f32 v[8:9], v[8:9], v[242:243], v[240:241]
    v_pk_fma_f32 v[10:11], v[10:11], v[242:243], v[240:241]
    v_pk_fma_f32 v[12:13], v[12:13], v[242:243], v[240:241]
    v_pk_fma_f32 v[14:15], v[14:15], v[242:243], v[240:241]
    v_pk_mul_f32 v[8:9], v[8:9], v[0:1]
    v_pk_mul_f32 v[10:11], v[10:11], v[2:3]
    v_pk_mul_f32 v[12:13], v[12:13], v[4:5]
    v_pk_mul_f32 v[14:15], v[14:15], v[6:7]
    v_exp_f32 v8, v8
    v_exp_f32 v9, v9
    v_exp_f32 v10, v10
    v_exp_f32 v11, v11
    v_exp_f32 v12, v12
    v_exp_f32 v13, v13
    v_exp_f32 v14, v14
    v_exp_f32 v15, v15
    v_pk_add_f32 v[8:9], v[8:9], v[244:245]
    v_pk_add_f32 v[10:11], v[10:11], v[244:245]
    v_pk_add_f32 v[12:13], v[12:13], v[244:245]
    v_pk_add_f32 v[14:15], v[14:15], v[244:245]
    v_rcp_f32 v8, v8
    v_rcp_f32 v9, v9
    v_rcp_f32 v10, v10
    v_rcp_f32 v11, v11
    v_rcp_f32 v12, v12
    v_rcp_f32 v13, v13
    v_rcp_f32 v14, v14
    v_rcp_f32 v15, v15
    v_pk_mul_f32 v[0:1], v[8:9], v[0:1]
    v_pk_mul_f32 v[2:3], v[10:11], v[2:3]
    v_pk_mul_f32 v[4:5], v[12:13], v[4:5]
    v_pk_mul_f32 v[6:7], v[14:15], v[6:7]
    v_cvt_pk_bf16_f32 v16, v0, v1
    v_cvt_pk_bf16_f32 v17, v2, v3
    v_cvt_pk_bf16_f32 v18, v4, v5
    v_cvt_pk_bf16_f32 v19, v6, v7
    buffer_store_dwordx4 v[16:19], v251, s[4:7], s53 offen offset:1024 sc1
    v_accvgpr_read_b32 v20, a80
    v_accvgpr_read_b32 v21, a81
    v_accvgpr_read_b32 v22, a82
    v_accvgpr_read_b32 v23, a83
    v_accvgpr_read_b32 v24, a84
    v_accvgpr_read_b32 v25, a85
    v_accvgpr_read_b32 v26, a86
    v_accvgpr_read_b32 v27, a87
    v_pk_mul_f32 v[28:29], v[20:21], v[20:21]
    v_pk_mul_f32 v[30:31], v[22:23], v[22:23]
    v_pk_mul_f32 v[32:33], v[24:25], v[24:25]
    v_pk_mul_f32 v[34:35], v[26:27], v[26:27]
    v_pk_fma_f32 v[28:29], v[28:29], v[242:243], v[240:241]
    v_pk_fma_f32 v[30:31], v[30:31], v[242:243], v[240:241]
    v_pk_fma_f32 v[32:33], v[32:33], v[242:243], v[240:241]
    v_pk_fma_f32 v[34:35], v[34:35], v[242:243], v[240:241]
    v_pk_mul_f32 v[28:29], v[28:29], v[20:21]
    v_pk_mul_f32 v[30:31], v[30:31], v[22:23]
    v_pk_mul_f32 v[32:33], v[32:33], v[24:25]
    v_pk_mul_f32 v[34:35], v[34:35], v[26:27]
    v_exp_f32 v28, v28
    v_exp_f32 v29, v29
    v_exp_f32 v30, v30
    v_exp_f32 v31, v31
    v_exp_f32 v32, v32
    v_exp_f32 v33, v33
    v_exp_f32 v34, v34
    v_exp_f32 v35, v35
    v_pk_add_f32 v[28:29], v[28:29], v[244:245]
    v_pk_add_f32 v[30:31], v[30:31], v[244:245]
    v_pk_add_f32 v[32:33], v[32:33], v[244:245]
    v_pk_add_f32 v[34:35], v[34:35], v[244:245]
    v_rcp_f32 v28, v28
    v_rcp_f32 v29, v29
    v_rcp_f32 v30, v30
    v_rcp_f32 v31, v31
    v_rcp_f32 v32, v32
    v_rcp_f32 v33, v33
    v_rcp_f32 v34, v34
    v_rcp_f32 v35, v35
    v_pk_mul_f32 v[20:21], v[28:29], v[20:21]
    v_pk_mul_f32 v[22:23], v[30:31], v[22:23]
    v_pk_mul_f32 v[24:25], v[32:33], v[24:25]
    v_pk_mul_f32 v[26:27], v[34:35], v[26:27]
    v_cvt_pk_bf16_f32 v36, v20, v21
    v_cvt_pk_bf16_f32 v37, v22, v23
    v_cvt_pk_bf16_f32 v38, v24, v25
    v_cvt_pk_bf16_f32 v39, v26, v27
    buffer_store_dwordx4 v[36:39], v251, s[4:7], s53 offen offset:2048 sc1
    v_accvgpr_read_b32 v40, a88
    v_accvgpr_read_b32 v41, a89
    v_accvgpr_read_b32 v42, a90
    v_accvgpr_read_b32 v43, a91
    v_accvgpr_read_b32 v44, a92
    v_accvgpr_read_b32 v45, a93
    v_accvgpr_read_b32 v46, a94
    v_accvgpr_read_b32 v47, a95
    v_pk_mul_f32 v[48:49], v[40:41], v[40:41]
    v_pk_mul_f32 v[50:51], v[42:43], v[42:43]
    v_pk_mul_f32 v[52:53], v[44:45], v[44:45]
    v_pk_mul_f32 v[54:55], v[46:47], v[46:47]
    v_pk_fma_f32 v[48:49], v[48:49], v[242:243], v[240:241]
    v_pk_fma_f32 v[50:51], v[50:51], v[242:243], v[240:241]
    v_pk_fma_f32 v[52:53], v[52:53], v[242:243], v[240:241]
    v_pk_fma_f32 v[54:55], v[54:55], v[242:243], v[240:241]
    v_pk_mul_f32 v[48:49], v[48:49], v[40:41]
    v_pk_mul_f32 v[50:51], v[50:51], v[42:43]
    v_pk_mul_f32 v[52:53], v[52:53], v[44:45]
    v_pk_mul_f32 v[54:55], v[54:55], v[46:47]
    v_exp_f32 v48, v48
    v_exp_f32 v49, v49
    v_exp_f32 v50, v50
    v_exp_f32 v51, v51
    v_exp_f32 v52, v52
    v_exp_f32 v53, v53
    v_exp_f32 v54, v54
    v_exp_f32 v55, v55
    v_pk_add_f32 v[48:49], v[48:49], v[244:245]
    v_pk_add_f32 v[50:51], v[50:51], v[244:245]
    v_pk_add_f32 v[52:53], v[52:53], v[244:245]
    v_pk_add_f32 v[54:55], v[54:55], v[244:245]
    v_rcp_f32 v48, v48
    v_rcp_f32 v49, v49
    v_rcp_f32 v50, v50
    v_rcp_f32 v51, v51
    v_rcp_f32 v52, v52
    v_rcp_f32 v53, v53
    v_rcp_f32 v54, v54
    v_rcp_f32 v55, v55
    v_pk_mul_f32 v[40:41], v[48:49], v[40:41]
    v_pk_mul_f32 v[42:43], v[50:51], v[42:43]
    v_pk_mul_f32 v[44:45], v[52:53], v[44:45]
    v_pk_mul_f32 v[46:47], v[54:55], v[46:47]
    v_cvt_pk_bf16_f32 v56, v40, v41
    v_cvt_pk_bf16_f32 v57, v42, v43
    v_cvt_pk_bf16_f32 v58, v44, v45
    v_cvt_pk_bf16_f32 v59, v46, v47
    buffer_store_dwordx4 v[56:59], v251, s[4:7], s53 offen offset:3072 sc1
    s_add_u32 s53, s53, s22
    v_accvgpr_read_b32 v0, a96
    v_accvgpr_read_b32 v1, a97
    v_accvgpr_read_b32 v2, a98
    v_accvgpr_read_b32 v3, a99
    v_accvgpr_read_b32 v4, a100
    v_accvgpr_read_b32 v5, a101
    v_accvgpr_read_b32 v6, a102
    v_accvgpr_read_b32 v7, a103
    v_pk_mul_f32 v[8:9], v[0:1], v[0:1]
    v_pk_mul_f32 v[10:11], v[2:3], v[2:3]
    v_pk_mul_f32 v[12:13], v[4:5], v[4:5]
    v_pk_mul_f32 v[14:15], v[6:7], v[6:7]
    v_pk_fma_f32 v[8:9], v[8:9], v[242:243], v[240:241]
    v_pk_fma_f32 v[10:11], v[10:11], v[242:243], v[240:241]
    v_pk_fma_f32 v[12:13], v[12:13], v[242:243], v[240:241]
    v_pk_fma_f32 v[14:15], v[14:15], v[242:243], v[240:241]
    v_pk_mul_f32 v[8:9], v[8:9], v[0:1]
    v_pk_mul_f32 v[10:11], v[10:11], v[2:3]
    v_pk_mul_f32 v[12:13], v[12:13], v[4:5]
    v_pk_mul_f32 v[14:15], v[14:15], v[6:7]
    v_exp_f32 v8, v8
    v_exp_f32 v9, v9
    v_exp_f32 v10, v10
    v_exp_f32 v11, v11
    v_exp_f32 v12, v12
    v_exp_f32 v13, v13
    v_exp_f32 v14, v14
    v_exp_f32 v15, v15
    v_pk_add_f32 v[8:9], v[8:9], v[244:245]
    v_pk_add_f32 v[10:11], v[10:11], v[244:245]
    v_pk_add_f32 v[12:13], v[12:13], v[244:245]
    v_pk_add_f32 v[14:15], v[14:15], v[244:245]
    v_rcp_f32 v8, v8
    v_rcp_f32 v9, v9
    v_rcp_f32 v10, v10
    v_rcp_f32 v11, v11
    v_rcp_f32 v12, v12
    v_rcp_f32 v13, v13
    v_rcp_f32 v14, v14
    v_rcp_f32 v15, v15
    v_pk_mul_f32 v[0:1], v[8:9], v[0:1]
    v_pk_mul_f32 v[2:3], v[10:11], v[2:3]
    v_pk_mul_f32 v[4:5], v[12:13], v[4:5]
    v_pk_mul_f32 v[6:7], v[14:15], v[6:7]
    v_cvt_pk_bf16_f32 v16, v0, v1
    v_cvt_pk_bf16_f32 v17, v2, v3
    v_cvt_pk_bf16_f32 v18, v4, v5
    v_cvt_pk_bf16_f32 v19, v6, v7
    buffer_store_dwordx4 v[16:19], v251, s[4:7], s53 offen offset:0 sc1
    v_accvgpr_read_b32 v20, a104
    v_accvgpr_read_b32 v21, a105
    v_accvgpr_read_b32 v22, a106
    v_accvgpr_read_b32 v23, a107
    v_accvgpr_read_b32 v24, a108
    v_accvgpr_read_b32 v25, a109
    v_accvgpr_read_b32 v26, a110
    v_accvgpr_read_b32 v27, a111
    v_pk_mul_f32 v[28:29], v[20:21], v[20:21]
    v_pk_mul_f32 v[30:31], v[22:23], v[22:23]
    v_pk_mul_f32 v[32:33], v[24:25], v[24:25]
    v_pk_mul_f32 v[34:35], v[26:27], v[26:27]
    v_pk_fma_f32 v[28:29], v[28:29], v[242:243], v[240:241]
    v_pk_fma_f32 v[30:31], v[30:31], v[242:243], v[240:241]
    v_pk_fma_f32 v[32:33], v[32:33], v[242:243], v[240:241]
    v_pk_fma_f32 v[34:35], v[34:35], v[242:243], v[240:241]
    v_pk_mul_f32 v[28:29], v[28:29], v[20:21]
    v_pk_mul_f32 v[30:31], v[30:31], v[22:23]
    v_pk_mul_f32 v[32:33], v[32:33], v[24:25]
    v_pk_mul_f32 v[34:35], v[34:35], v[26:27]
    v_exp_f32 v28, v28
    v_exp_f32 v29, v29
    v_exp_f32 v30, v30
    v_exp_f32 v31, v31
    v_exp_f32 v32, v32
    v_exp_f32 v33, v33
    v_exp_f32 v34, v34
    v_exp_f32 v35, v35
    v_pk_add_f32 v[28:29], v[28:29], v[244:245]
    v_pk_add_f32 v[30:31], v[30:31], v[244:245]
    v_pk_add_f32 v[32:33], v[32:33], v[244:245]
    v_pk_add_f32 v[34:35], v[34:35], v[244:245]
    v_rcp_f32 v28, v28
    v_rcp_f32 v29, v29
    v_rcp_f32 v30, v30
    v_rcp_f32 v31, v31
    v_rcp_f32 v32, v32
    v_rcp_f32 v33, v33
    v_rcp_f32 v34, v34
    v_rcp_f32 v35, v35
    v_pk_mul_f32 v[20:21], v[28:29], v[20:21]
    v_pk_mul_f32 v[22:23], v[30:31], v[22:23]
    v_pk_mul_f32 v[24:25], v[32:33], v[24:25]
    v_pk_mul_f32 v[26:27], v[34:35], v[26:27]
    v_cvt_pk_bf16_f32 v36, v20, v21
    v_cvt_pk_bf16_f32 v37, v22, v23
    v_cvt_pk_bf16_f32 v38, v24, v25
    v_cvt_pk_bf16_f32 v39, v26, v27
    buffer_store_dwordx4 v[36:39], v251, s[4:7], s53 offen offset:1024 sc1
    v_accvgpr_read_b32 v40, a112
    v_accvgpr_read_b32 v41, a113
    v_accvgpr_read_b32 v42, a114
    v_accvgpr_read_b32 v43, a115
    v_accvgpr_read_b32 v44, a116
    v_accvgpr_read_b32 v45, a117
    v_accvgpr_read_b32 v46, a118
    v_accvgpr_read_b32 v47, a119
    v_pk_mul_f32 v[48:49], v[40:41], v[40:41]
    v_pk_mul_f32 v[50:51], v[42:43], v[42:43]
    v_pk_mul_f32 v[52:53], v[44:45], v[44:45]
    v_pk_mul_f32 v[54:55], v[46:47], v[46:47]
    v_pk_fma_f32 v[48:49], v[48:49], v[242:243], v[240:241]
    v_pk_fma_f32 v[50:51], v[50:51], v[242:243], v[240:241]
    v_pk_fma_f32 v[52:53], v[52:53], v[242:243], v[240:241]
    v_pk_fma_f32 v[54:55], v[54:55], v[242:243], v[240:241]
    v_pk_mul_f32 v[48:49], v[48:49], v[40:41]
    v_pk_mul_f32 v[50:51], v[50:51], v[42:43]
    v_pk_mul_f32 v[52:53], v[52:53], v[44:45]
    v_pk_mul_f32 v[54:55], v[54:55], v[46:47]
    v_exp_f32 v48, v48
    v_exp_f32 v49, v49
    v_exp_f32 v50, v50
    v_exp_f32 v51, v51
    v_exp_f32 v52, v52
    v_exp_f32 v53, v53
    v_exp_f32 v54, v54
    v_exp_f32 v55, v55
    v_pk_add_f32 v[48:49], v[48:49], v[244:245]
    v_pk_add_f32 v[50:51], v[50:51], v[244:245]
    v_pk_add_f32 v[52:53], v[52:53], v[244:245]
    v_pk_add_f32 v[54:55], v[54:55], v[244:245]
    v_rcp_f32 v48, v48
    v_rcp_f32 v49, v49
    v_rcp_f32 v50, v50
    v_rcp_f32 v51, v51
    v_rcp_f32 v52, v52
    v_rcp_f32 v53, v53
    v_rcp_f32 v54, v54
    v_rcp_f32 v55, v55
    v_pk_mul_f32 v[40:41], v[48:49], v[40:41]
    v_pk_mul_f32 v[42:43], v[50:51], v[42:43]
    v_pk_mul_f32 v[44:45], v[52:53], v[44:45]
    v_pk_mul_f32 v[46:47], v[54:55], v[46:47]
    v_cvt_pk_bf16_f32 v56, v40, v41
    v_cvt_pk_bf16_f32 v57, v42, v43
    v_cvt_pk_bf16_f32 v58, v44, v45
    v_cvt_pk_bf16_f32 v59, v46, v47
    buffer_store_dwordx4 v[56:59], v251, s[4:7], s53 offen offset:2048 sc1
    v_accvgpr_read_b32 v0, a120
    v_accvgpr_read_b32 v1, a121
    v_accvgpr_read_b32 v2, a122
    v_accvgpr_read_b32 v3, a123
    v_accvgpr_read_b32 v4, a124
    v_accvgpr_read_b32 v5, a125
    v_accvgpr_read_b32 v6, a126
    v_accvgpr_read_b32 v7, a127
    v_pk_mul_f32 v[8:9], v[0:1], v[0:1]
    v_pk_mul_f32 v[10:11], v[2:3], v[2:3]
    v_pk_mul_f32 v[12:13], v[4:5], v[4:5]
    v_pk_mul_f32 v[14:15], v[6:7], v[6:7]
    v_pk_fma_f32 v[8:9], v[8:9], v[242:243], v[240:241]
    v_pk_fma_f32 v[10:11], v[10:11], v[242:243], v[240:241]
    v_pk_fma_f32 v[12:13], v[12:13], v[242:243], v[240:241]
    v_pk_fma_f32 v[14:15], v[14:15], v[242:243], v[240:241]
    v_pk_mul_f32 v[8:9], v[8:9], v[0:1]
    v_pk_mul_f32 v[10:11], v[10:11], v[2:3]
    v_pk_mul_f32 v[12:13], v[12:13], v[4:5]
    v_pk_mul_f32 v[14:15], v[14:15], v[6:7]
    v_exp_f32 v8, v8
    v_exp_f32 v9, v9
    v_exp_f32 v10, v10
    v_exp_f32 v11, v11
    v_exp_f32 v12, v12
    v_exp_f32 v13, v13
    v_exp_f32 v14, v14
    v_exp_f32 v15, v15
    v_pk_add_f32 v[8:9], v[8:9], v[244:245]
    v_pk_add_f32 v[10:11], v[10:11], v[244:245]
    v_pk_add_f32 v[12:13], v[12:13], v[244:245]
    v_pk_add_f32 v[14:15], v[14:15], v[244:245]
    v_rcp_f32 v8, v8
    v_rcp_f32 v9, v9
    v_rcp_f32 v10, v10
    v_rcp_f32 v11, v11
    v_rcp_f32 v12, v12
    v_rcp_f32 v13, v13
    v_rcp_f32 v14, v14
    v_rcp_f32 v15, v15
    v_pk_mul_f32 v[0:1], v[8:9], v[0:1]
    v_pk_mul_f32 v[2:3], v[10:11], v[2:3]
    v_pk_mul_f32 v[4:5], v[12:13], v[4:5]
    v_pk_mul_f32 v[6:7], v[14:15], v[6:7]
    v_cvt_pk_bf16_f32 v16, v0, v1
    v_cvt_pk_bf16_f32 v17, v2, v3
    v_cvt_pk_bf16_f32 v18, v4, v5
    v_cvt_pk_bf16_f32 v19, v6, v7
    buffer_store_dwordx4 v[16:19], v251, s[4:7], s53 offen offset:3072 sc1
    s_branch main_kernel_w_done
main_kernel_w_c1_gov:
    v_lshrrev_b32 v0, 4, v250
    v_bfe_u32 v1, v250, 2, 2
    v_lshl_add_u32 v4, v0, 2, v1
    v_and_b32 v5, 7, v4
    v_mul_u32_u24 v4, 512, v4
    v_and_b32 v6, 3, v250
    v_lshl_add_u32 v4, v6, 3, v4
    s_mul_i32 s32, s37, 8
    v_xor_b32 v5, s32, v5
    v_lshl_add_u32 v128, v5, 5, v4
    v_xor_b32 v129, 32, v128
    v_xor_b32 v130, 64, v128
    v_xor_b32 v131, 96, v128
    v_xor_b32 v132, 128, v128
    v_xor_b32 v133, 160, v128
    v_xor_b32 v134, 192, v128
    v_xor_b32 v135, 224, v128
    s_mul_i32 s32, s38, 4096
    s_add_u32 s32, s32, 65536
    v_add_u32 v136, s32, v251
    v_lshrrev_b32 v2, 5, v250
    v_and_b32 v3, 31, v250
    s_mul_i32 s32, s14, 8
    v_add_u32 v4, s32, v2
    v_add_u32 v5, 0, v4
    v_and_b32 v6, 7, v5
    v_lshlrev_b32 v6, 1, v6
    v_xor_b32 v6, v6, v3
    v_mul_lo_u32 v5, v5, s30
    v_lshl_add_u32 v5, v6, 4, v5
    v_subrev_u32 v137, 0, v5
    v_add_u32 v5, 2, v4
    v_and_b32 v6, 7, v5
    v_lshlrev_b32 v6, 1, v6
    v_xor_b32 v6, v6, v3
    v_mul_lo_u32 v5, v5, s30
    v_lshl_add_u32 v5, v6, 4, v5
    v_subrev_u32 v138, 1024, v5
    v_add_u32 v5, 4, v4
    v_and_b32 v6, 7, v5
    v_lshlrev_b32 v6, 1, v6
    v_xor_b32 v6, v6, v3
    v_mul_lo_u32 v5, v5, s30
    v_lshl_add_u32 v5, v6, 4, v5
    v_subrev_u32 v139, 2048, v5
    v_add_u32 v5, 6, v4
    v_and_b32 v6, 7, v5
    v_lshlrev_b32 v6, 1, v6
    v_xor_b32 v6, v6, v3
    v_mul_lo_u32 v5, v5, s30
    v_lshl_add_u32 v5, v6, 4, v5
    v_subrev_u32 v140, 3072, v5
    s_mul_i32 s32, s14, 2
    s_mul_i32 s32, s32, s31
    v_add_u32 v141, s32, v251
    s_add_u32 s32, s32, s31
    s_sub_u32 s32, s32, 1024
    v_add_u32 v142, s32, v251
    s_mul_i32 s19, s14, 4096
    s_mul_i32 s20, s14, 2048
    s_add_u32 s20, s20, 65536
    s_mul_i32 s17, s30, 32
    s_mov_b32 s15, 0
    s_add_u32 m0, s20, 0
    s_nop 0
    buffer_load_dwordx4 v141, s[4:7], s16 offen offset:0 sc1 lds
    buffer_load_dwordx4 v142, s[4:7], s16 offen offset:1024 sc1 lds
    s_add_u32 s16, s16, 1024
    s_add_u32 m0, s19, 0
    s_nop 0
    buffer_load_dwordx4 v137, s[8:11], s15 offen offset:0 lds
    buffer_load_dwordx4 v138, s[8:11], s15 offen offset:1024 lds
    buffer_load_dwordx4 v139, s[8:11], s15 offen offset:2048 lds
    buffer_load_dwordx4 v140, s[8:11], s15 offen offset:3072 lds
    s_add_u32 s15, s15, s17
    s_add_u32 m0, s20, 8192
    s_nop 0
    buffer_load_dwordx4 v141, s[4:7], s16 offen offset:0 sc1 lds
    buffer_load_dwordx4 v142, s[4:7], s16 offen offset:1024 sc1 lds
    s_add_u32 s16, s16, 1024
    s_add_u32 m0, s19, 16384
    s_nop 0
    buffer_load_dwordx4 v137, s[8:11], s15 offen offset:0 lds
    buffer_load_dwordx4 v138, s[8:11], s15 offen offset:1024 lds
    buffer_load_dwordx4 v139, s[8:11], s15 offen offset:2048 lds
    buffer_load_dwordx4 v140, s[8:11], s15 offen offset:3072 lds
    s_add_u32 s15, s15, s17
    s_add_u32 m0, s20, 16384
    s_nop 0
    buffer_load_dwordx4 v141, s[4:7], s16 offen offset:0 sc1 lds
    buffer_load_dwordx4 v142, s[4:7], s16 offen offset:1024 sc1 lds
    s_add_u32 s16, s16, 1024
    s_add_u32 m0, s19, 32768
    s_nop 0
    buffer_load_dwordx4 v137, s[8:11], s15 offen offset:0 lds
    buffer_load_dwordx4 v138, s[8:11], s15 offen offset:1024 lds
    buffer_load_dwordx4 v139, s[8:11], s15 offen offset:2048 lds
    buffer_load_dwordx4 v140, s[8:11], s15 offen offset:3072 lds
    s_add_u32 s15, s15, s17
    s_add_u32 m0, s20, 24576
    s_nop 0
    buffer_load_dwordx4 v141, s[4:7], s16 offen offset:0 sc1 lds
    buffer_load_dwordx4 v142, s[4:7], s16 offen offset:1024 sc1 lds
    s_add_u32 s16, s16, 1024
    s_add_u32 m0, s19, 49152
    s_nop 0
    buffer_load_dwordx4 v137, s[8:11], s15 offen offset:0 lds
    buffer_load_dwordx4 v138, s[8:11], s15 offen offset:1024 lds
    buffer_load_dwordx4 v139, s[8:11], s15 offen offset:2048 lds
    buffer_load_dwordx4 v140, s[8:11], s15 offen offset:3072 lds
    s_add_u32 s15, s15, s17
    v_accvgpr_write_b32 a0, 0
    v_accvgpr_write_b32 a1, 0
    v_accvgpr_write_b32 a2, 0
    v_accvgpr_write_b32 a3, 0
    v_accvgpr_write_b32 a4, 0
    v_accvgpr_write_b32 a5, 0
    v_accvgpr_write_b32 a6, 0
    v_accvgpr_write_b32 a7, 0
    v_accvgpr_write_b32 a8, 0
    v_accvgpr_write_b32 a9, 0
    v_accvgpr_write_b32 a10, 0
    v_accvgpr_write_b32 a11, 0
    v_accvgpr_write_b32 a12, 0
    v_accvgpr_write_b32 a13, 0
    v_accvgpr_write_b32 a14, 0
    v_accvgpr_write_b32 a15, 0
    v_accvgpr_write_b32 a16, 0
    v_accvgpr_write_b32 a17, 0
    v_accvgpr_write_b32 a18, 0
    v_accvgpr_write_b32 a19, 0
    v_accvgpr_write_b32 a20, 0
    v_accvgpr_write_b32 a21, 0
    v_accvgpr_write_b32 a22, 0
    v_accvgpr_write_b32 a23, 0
    v_accvgpr_write_b32 a24, 0
    v_accvgpr_write_b32 a25, 0
    v_accvgpr_write_b32 a26, 0
    v_accvgpr_write_b32 a27, 0
    v_accvgpr_write_b32 a28, 0
    v_accvgpr_write_b32 a29, 0
    v_accvgpr_write_b32 a30, 0
    v_accvgpr_write_b32 a31, 0
    v_accvgpr_write_b32 a32, 0
    v_accvgpr_write_b32 a33, 0
    v_accvgpr_write_b32 a34, 0
    v_accvgpr_write_b32 a35, 0
    v_accvgpr_write_b32 a36, 0
    v_accvgpr_write_b32 a37, 0
    v_accvgpr_write_b32 a38, 0
    v_accvgpr_write_b32 a39, 0
    v_accvgpr_write_b32 a40, 0
    v_accvgpr_write_b32 a41, 0
    v_accvgpr_write_b32 a42, 0
    v_accvgpr_write_b32 a43, 0
    v_accvgpr_write_b32 a44, 0
    v_accvgpr_write_b32 a45, 0
    v_accvgpr_write_b32 a46, 0
    v_accvgpr_write_b32 a47, 0
    v_accvgpr_write_b32 a48, 0
    v_accvgpr_write_b32 a49, 0
    v_accvgpr_write_b32 a50, 0
    v_accvgpr_write_b32 a51, 0
    v_accvgpr_write_b32 a52, 0
    v_accvgpr_write_b32 a53, 0
    v_accvgpr_write_b32 a54, 0
    v_accvgpr_write_b32 a55, 0
    v_accvgpr_write_b32 a56, 0
    v_accvgpr_write_b32 a57, 0
    v_accvgpr_write_b32 a58, 0
    v_accvgpr_write_b32 a59, 0
    v_accvgpr_write_b32 a60, 0
    v_accvgpr_write_b32 a61, 0
    v_accvgpr_write_b32 a62, 0
    v_accvgpr_write_b32 a63, 0
    v_accvgpr_write_b32 a64, 0
    v_accvgpr_write_b32 a65, 0
    v_accvgpr_write_b32 a66, 0
    v_accvgpr_write_b32 a67, 0
    v_accvgpr_write_b32 a68, 0
    v_accvgpr_write_b32 a69, 0
    v_accvgpr_write_b32 a70, 0
    v_accvgpr_write_b32 a71, 0
    v_accvgpr_write_b32 a72, 0
    v_accvgpr_write_b32 a73, 0
    v_accvgpr_write_b32 a74, 0
    v_accvgpr_write_b32 a75, 0
    v_accvgpr_write_b32 a76, 0
    v_accvgpr_write_b32 a77, 0
    v_accvgpr_write_b32 a78, 0
    v_accvgpr_write_b32 a79, 0
    v_accvgpr_write_b32 a80, 0
    v_accvgpr_write_b32 a81, 0
    v_accvgpr_write_b32 a82, 0
    v_accvgpr_write_b32 a83, 0
    v_accvgpr_write_b32 a84, 0
    v_accvgpr_write_b32 a85, 0
    v_accvgpr_write_b32 a86, 0
    v_accvgpr_write_b32 a87, 0
    v_accvgpr_write_b32 a88, 0
    v_accvgpr_write_b32 a89, 0
    v_accvgpr_write_b32 a90, 0
    v_accvgpr_write_b32 a91, 0
    v_accvgpr_write_b32 a92, 0
    v_accvgpr_write_b32 a93, 0
    v_accvgpr_write_b32 a94, 0
    v_accvgpr_write_b32 a95, 0
    v_accvgpr_write_b32 a96, 0
    v_accvgpr_write_b32 a97, 0
    v_accvgpr_write_b32 a98, 0
    v_accvgpr_write_b32 a99, 0
    v_accvgpr_write_b32 a100, 0
    v_accvgpr_write_b32 a101, 0
    v_accvgpr_write_b32 a102, 0
    v_accvgpr_write_b32 a103, 0
    v_accvgpr_write_b32 a104, 0
    v_accvgpr_write_b32 a105, 0
    v_accvgpr_write_b32 a106, 0
    v_accvgpr_write_b32 a107, 0
    v_accvgpr_write_b32 a108, 0
    v_accvgpr_write_b32 a109, 0
    v_accvgpr_write_b32 a110, 0
    v_accvgpr_write_b32 a111, 0
    v_accvgpr_write_b32 a112, 0
    v_accvgpr_write_b32 a113, 0
    v_accvgpr_write_b32 a114, 0
    v_accvgpr_write_b32 a115, 0
    v_accvgpr_write_b32 a116, 0
    v_accvgpr_write_b32 a117, 0
    v_accvgpr_write_b32 a118, 0
    v_accvgpr_write_b32 a119, 0
    v_accvgpr_write_b32 a120, 0
    v_accvgpr_write_b32 a121, 0
    v_accvgpr_write_b32 a122, 0
    v_accvgpr_write_b32 a123, 0
    v_accvgpr_write_b32 a124, 0
    v_accvgpr_write_b32 a125, 0
    v_accvgpr_write_b32 a126, 0
    v_accvgpr_write_b32 a127, 0
    s_waitcnt vmcnt(18)
    s_barrier
    ds_read_b128 v[32:35], v136 offset:0
    ds_read_b64_tr_b16 v[0:1], v128 offset:0
    ds_read_b64_tr_b16 v[2:3], v128 offset:8192
    ds_read_b64_tr_b16 v[4:5], v129 offset:0
    ds_read_b64_tr_b16 v[6:7], v129 offset:8192
    ds_read_b64_tr_b16 v[8:9], v130 offset:0
    ds_read_b64_tr_b16 v[10:11], v130 offset:8192
    ds_read_b64_tr_b16 v[12:13], v131 offset:0
    ds_read_b64_tr_b16 v[14:15], v131 offset:8192
    ds_read_b64_tr_b16 v[16:17], v132 offset:0
    ds_read_b64_tr_b16 v[18:19], v132 offset:8192
    ds_read_b64_tr_b16 v[20:21], v133 offset:0
    ds_read_b64_tr_b16 v[22:23], v133 offset:8192
    ds_read_b64_tr_b16 v[24:25], v134 offset:0
    ds_read_b64_tr_b16 v[26:27], v134 offset:8192
    ds_read_b64_tr_b16 v[28:29], v135 offset:0
    ds_read_b64_tr_b16 v[30:31], v135 offset:8192
    ds_read_b128 v[36:39], v136 offset:1024
    ds_read_b128 v[40:43], v136 offset:2048
    ds_read_b128 v[44:47], v136 offset:3072
main_kernel_w_c1_v_loop:
    s_waitcnt lgkmcnt(0)
    v_mfma_f32_16x16x32_bf16 a[0:3], v[32:35], v[0:3], a[0:3]
    s_waitcnt vmcnt(12)
    s_barrier
    ds_read_b128 v[80:83], v136 offset:8192
    s_add_u32 m0, s20, 0
    s_nop 0
    v_mfma_f32_16x16x32_bf16 a[4:7], v[32:35], v[4:7], a[4:7]
    ds_read_b64_tr_b16 v[48:49], v128 offset:16384
    v_mfma_f32_16x16x32_bf16 a[8:11], v[32:35], v[8:11], a[8:11]
    ds_read_b64_tr_b16 v[50:51], v128 offset:24576
    v_mfma_f32_16x16x32_bf16 a[12:15], v[32:35], v[12:15], a[12:15]
    ds_read_b64_tr_b16 v[52:53], v129 offset:16384
    buffer_load_dwordx4 v141, s[4:7], s16 offen offset:0 sc1 lds
    v_mfma_f32_16x16x32_bf16 a[16:19], v[32:35], v[16:19], a[16:19]
    ds_read_b64_tr_b16 v[54:55], v129 offset:24576
    v_mfma_f32_16x16x32_bf16 a[20:23], v[32:35], v[20:23], a[20:23]
    ds_read_b64_tr_b16 v[56:57], v130 offset:16384
    v_mfma_f32_16x16x32_bf16 a[24:27], v[32:35], v[24:27], a[24:27]
    ds_read_b64_tr_b16 v[58:59], v130 offset:24576
    buffer_load_dwordx4 v142, s[4:7], s16 offen offset:1024 sc1 lds
    v_mfma_f32_16x16x32_bf16 a[28:31], v[32:35], v[28:31], a[28:31]
    ds_read_b64_tr_b16 v[60:61], v131 offset:16384
    v_mfma_f32_16x16x32_bf16 a[32:35], v[36:39], v[0:3], a[32:35]
    ds_read_b64_tr_b16 v[62:63], v131 offset:24576
    v_mfma_f32_16x16x32_bf16 a[36:39], v[36:39], v[4:7], a[36:39]
    ds_read_b64_tr_b16 v[64:65], v132 offset:16384
    s_add_u32 s16, s16, 1024
    v_mfma_f32_16x16x32_bf16 a[40:43], v[36:39], v[8:11], a[40:43]
    ds_read_b64_tr_b16 v[66:67], v132 offset:24576
    v_mfma_f32_16x16x32_bf16 a[44:47], v[36:39], v[12:15], a[44:47]
    ds_read_b64_tr_b16 v[68:69], v133 offset:16384
    v_mfma_f32_16x16x32_bf16 a[48:51], v[36:39], v[16:19], a[48:51]
    ds_read_b64_tr_b16 v[70:71], v133 offset:24576
    s_add_u32 m0, s19, 0
    s_nop 0
    v_mfma_f32_16x16x32_bf16 a[52:55], v[36:39], v[20:23], a[52:55]
    ds_read_b64_tr_b16 v[72:73], v134 offset:16384
    v_mfma_f32_16x16x32_bf16 a[56:59], v[36:39], v[24:27], a[56:59]
    ds_read_b64_tr_b16 v[74:75], v134 offset:24576
    v_mfma_f32_16x16x32_bf16 a[60:63], v[36:39], v[28:31], a[60:63]
    ds_read_b64_tr_b16 v[76:77], v135 offset:16384
    buffer_load_dwordx4 v137, s[8:11], s15 offen offset:0 lds
    v_mfma_f32_16x16x32_bf16 a[64:67], v[40:43], v[0:3], a[64:67]
    ds_read_b64_tr_b16 v[78:79], v135 offset:24576
    v_mfma_f32_16x16x32_bf16 a[68:71], v[40:43], v[4:7], a[68:71]
    ds_read_b128 v[84:87], v136 offset:9216
    v_mfma_f32_16x16x32_bf16 a[72:75], v[40:43], v[8:11], a[72:75]
    ds_read_b128 v[88:91], v136 offset:10240
    buffer_load_dwordx4 v138, s[8:11], s15 offen offset:1024 lds
    v_mfma_f32_16x16x32_bf16 a[76:79], v[40:43], v[12:15], a[76:79]
    ds_read_b128 v[92:95], v136 offset:11264
    v_mfma_f32_16x16x32_bf16 a[80:83], v[40:43], v[16:19], a[80:83]
    v_mfma_f32_16x16x32_bf16 a[84:87], v[40:43], v[20:23], a[84:87]
    buffer_load_dwordx4 v139, s[8:11], s15 offen offset:2048 lds
    v_mfma_f32_16x16x32_bf16 a[88:91], v[40:43], v[24:27], a[88:91]
    v_mfma_f32_16x16x32_bf16 a[92:95], v[40:43], v[28:31], a[92:95]
    v_mfma_f32_16x16x32_bf16 a[96:99], v[44:47], v[0:3], a[96:99]
    buffer_load_dwordx4 v140, s[8:11], s15 offen offset:3072 lds
    v_mfma_f32_16x16x32_bf16 a[100:103], v[44:47], v[4:7], a[100:103]
    v_mfma_f32_16x16x32_bf16 a[104:107], v[44:47], v[8:11], a[104:107]
    v_mfma_f32_16x16x32_bf16 a[108:111], v[44:47], v[12:15], a[108:111]
    s_add_u32 s15, s15, s17
    v_mfma_f32_16x16x32_bf16 a[112:115], v[44:47], v[16:19], a[112:115]
    v_mfma_f32_16x16x32_bf16 a[116:119], v[44:47], v[20:23], a[116:119]
    v_mfma_f32_16x16x32_bf16 a[120:123], v[44:47], v[24:27], a[120:123]
    v_mfma_f32_16x16x32_bf16 a[124:127], v[44:47], v[28:31], a[124:127]
    s_waitcnt lgkmcnt(0)
    v_mfma_f32_16x16x32_bf16 a[0:3], v[80:83], v[48:51], a[0:3]
    s_waitcnt vmcnt(12)
    s_barrier
    ds_read_b128 v[32:35], v136 offset:16384
    s_add_u32 m0, s20, 8192
    s_nop 0
    v_mfma_f32_16x16x32_bf16 a[4:7], v[80:83], v[52:55], a[4:7]
    ds_read_b64_tr_b16 v[0:1], v128 offset:32768
    v_mfma_f32_16x16x32_bf16 a[8:11], v[80:83], v[56:59], a[8:11]
    ds_read_b64_tr_b16 v[2:3], v128 offset:40960
    v_mfma_f32_16x16x32_bf16 a[12:15], v[80:83], v[60:63], a[12:15]
    ds_read_b64_tr_b16 v[4:5], v129 offset:32768
    buffer_load_dwordx4 v141, s[4:7], s16 offen offset:0 sc1 lds
    v_mfma_f32_16x16x32_bf16 a[16:19], v[80:83], v[64:67], a[16:19]
    ds_read_b64_tr_b16 v[6:7], v129 offset:40960
    v_mfma_f32_16x16x32_bf16 a[20:23], v[80:83], v[68:71], a[20:23]
    ds_read_b64_tr_b16 v[8:9], v130 offset:32768
    v_mfma_f32_16x16x32_bf16 a[24:27], v[80:83], v[72:75], a[24:27]
    ds_read_b64_tr_b16 v[10:11], v130 offset:40960
    buffer_load_dwordx4 v142, s[4:7], s16 offen offset:1024 sc1 lds
    v_mfma_f32_16x16x32_bf16 a[28:31], v[80:83], v[76:79], a[28:31]
    ds_read_b64_tr_b16 v[12:13], v131 offset:32768
    v_mfma_f32_16x16x32_bf16 a[32:35], v[84:87], v[48:51], a[32:35]
    ds_read_b64_tr_b16 v[14:15], v131 offset:40960
    v_mfma_f32_16x16x32_bf16 a[36:39], v[84:87], v[52:55], a[36:39]
    ds_read_b64_tr_b16 v[16:17], v132 offset:32768
    s_add_u32 s16, s16, 1024
    v_mfma_f32_16x16x32_bf16 a[40:43], v[84:87], v[56:59], a[40:43]
    ds_read_b64_tr_b16 v[18:19], v132 offset:40960
    v_mfma_f32_16x16x32_bf16 a[44:47], v[84:87], v[60:63], a[44:47]
    ds_read_b64_tr_b16 v[20:21], v133 offset:32768
    v_mfma_f32_16x16x32_bf16 a[48:51], v[84:87], v[64:67], a[48:51]
    ds_read_b64_tr_b16 v[22:23], v133 offset:40960
    s_add_u32 m0, s19, 16384
    s_nop 0
    v_mfma_f32_16x16x32_bf16 a[52:55], v[84:87], v[68:71], a[52:55]
    ds_read_b64_tr_b16 v[24:25], v134 offset:32768
    v_mfma_f32_16x16x32_bf16 a[56:59], v[84:87], v[72:75], a[56:59]
    ds_read_b64_tr_b16 v[26:27], v134 offset:40960
    v_mfma_f32_16x16x32_bf16 a[60:63], v[84:87], v[76:79], a[60:63]
    ds_read_b64_tr_b16 v[28:29], v135 offset:32768
    buffer_load_dwordx4 v137, s[8:11], s15 offen offset:0 lds
    v_mfma_f32_16x16x32_bf16 a[64:67], v[88:91], v[48:51], a[64:67]
    ds_read_b64_tr_b16 v[30:31], v135 offset:40960
    v_mfma_f32_16x16x32_bf16 a[68:71], v[88:91], v[52:55], a[68:71]
    ds_read_b128 v[36:39], v136 offset:17408
    v_mfma_f32_16x16x32_bf16 a[72:75], v[88:91], v[56:59], a[72:75]
    ds_read_b128 v[40:43], v136 offset:18432
    buffer_load_dwordx4 v138, s[8:11], s15 offen offset:1024 lds
    v_mfma_f32_16x16x32_bf16 a[76:79], v[88:91], v[60:63], a[76:79]
    ds_read_b128 v[44:47], v136 offset:19456
    v_mfma_f32_16x16x32_bf16 a[80:83], v[88:91], v[64:67], a[80:83]
    v_mfma_f32_16x16x32_bf16 a[84:87], v[88:91], v[68:71], a[84:87]
    buffer_load_dwordx4 v139, s[8:11], s15 offen offset:2048 lds
    v_mfma_f32_16x16x32_bf16 a[88:91], v[88:91], v[72:75], a[88:91]
    v_mfma_f32_16x16x32_bf16 a[92:95], v[88:91], v[76:79], a[92:95]
    v_mfma_f32_16x16x32_bf16 a[96:99], v[92:95], v[48:51], a[96:99]
    buffer_load_dwordx4 v140, s[8:11], s15 offen offset:3072 lds
    v_mfma_f32_16x16x32_bf16 a[100:103], v[92:95], v[52:55], a[100:103]
    v_mfma_f32_16x16x32_bf16 a[104:107], v[92:95], v[56:59], a[104:107]
    v_mfma_f32_16x16x32_bf16 a[108:111], v[92:95], v[60:63], a[108:111]
    s_add_u32 s15, s15, s17
    v_mfma_f32_16x16x32_bf16 a[112:115], v[92:95], v[64:67], a[112:115]
    v_mfma_f32_16x16x32_bf16 a[116:119], v[92:95], v[68:71], a[116:119]
    v_mfma_f32_16x16x32_bf16 a[120:123], v[92:95], v[72:75], a[120:123]
    v_mfma_f32_16x16x32_bf16 a[124:127], v[92:95], v[76:79], a[124:127]
    s_waitcnt lgkmcnt(0)
    v_mfma_f32_16x16x32_bf16 a[0:3], v[32:35], v[0:3], a[0:3]
    s_waitcnt vmcnt(12)
    s_barrier
    ds_read_b128 v[80:83], v136 offset:24576
    s_add_u32 m0, s20, 16384
    s_nop 0
    v_mfma_f32_16x16x32_bf16 a[4:7], v[32:35], v[4:7], a[4:7]
    ds_read_b64_tr_b16 v[48:49], v128 offset:49152
    v_mfma_f32_16x16x32_bf16 a[8:11], v[32:35], v[8:11], a[8:11]
    ds_read_b64_tr_b16 v[50:51], v128 offset:57344
    v_mfma_f32_16x16x32_bf16 a[12:15], v[32:35], v[12:15], a[12:15]
    ds_read_b64_tr_b16 v[52:53], v129 offset:49152
    buffer_load_dwordx4 v141, s[4:7], s16 offen offset:0 sc1 lds
    v_mfma_f32_16x16x32_bf16 a[16:19], v[32:35], v[16:19], a[16:19]
    ds_read_b64_tr_b16 v[54:55], v129 offset:57344
    v_mfma_f32_16x16x32_bf16 a[20:23], v[32:35], v[20:23], a[20:23]
    ds_read_b64_tr_b16 v[56:57], v130 offset:49152
    v_mfma_f32_16x16x32_bf16 a[24:27], v[32:35], v[24:27], a[24:27]
    ds_read_b64_tr_b16 v[58:59], v130 offset:57344
    buffer_load_dwordx4 v142, s[4:7], s16 offen offset:1024 sc1 lds
    v_mfma_f32_16x16x32_bf16 a[28:31], v[32:35], v[28:31], a[28:31]
    ds_read_b64_tr_b16 v[60:61], v131 offset:49152
    v_mfma_f32_16x16x32_bf16 a[32:35], v[36:39], v[0:3], a[32:35]
    ds_read_b64_tr_b16 v[62:63], v131 offset:57344
    v_mfma_f32_16x16x32_bf16 a[36:39], v[36:39], v[4:7], a[36:39]
    ds_read_b64_tr_b16 v[64:65], v132 offset:49152
    s_add_u32 s16, s16, 1024
    v_mfma_f32_16x16x32_bf16 a[40:43], v[36:39], v[8:11], a[40:43]
    ds_read_b64_tr_b16 v[66:67], v132 offset:57344
    v_mfma_f32_16x16x32_bf16 a[44:47], v[36:39], v[12:15], a[44:47]
    ds_read_b64_tr_b16 v[68:69], v133 offset:49152
    v_mfma_f32_16x16x32_bf16 a[48:51], v[36:39], v[16:19], a[48:51]
    ds_read_b64_tr_b16 v[70:71], v133 offset:57344
    s_add_u32 m0, s19, 32768
    s_nop 0
    v_mfma_f32_16x16x32_bf16 a[52:55], v[36:39], v[20:23], a[52:55]
    ds_read_b64_tr_b16 v[72:73], v134 offset:49152
    v_mfma_f32_16x16x32_bf16 a[56:59], v[36:39], v[24:27], a[56:59]
    ds_read_b64_tr_b16 v[74:75], v134 offset:57344
    v_mfma_f32_16x16x32_bf16 a[60:63], v[36:39], v[28:31], a[60:63]
    ds_read_b64_tr_b16 v[76:77], v135 offset:49152
    buffer_load_dwordx4 v137, s[8:11], s15 offen offset:0 lds
    v_mfma_f32_16x16x32_bf16 a[64:67], v[40:43], v[0:3], a[64:67]
    ds_read_b64_tr_b16 v[78:79], v135 offset:57344
    v_mfma_f32_16x16x32_bf16 a[68:71], v[40:43], v[4:7], a[68:71]
    ds_read_b128 v[84:87], v136 offset:25600
    v_mfma_f32_16x16x32_bf16 a[72:75], v[40:43], v[8:11], a[72:75]
    ds_read_b128 v[88:91], v136 offset:26624
    buffer_load_dwordx4 v138, s[8:11], s15 offen offset:1024 lds
    v_mfma_f32_16x16x32_bf16 a[76:79], v[40:43], v[12:15], a[76:79]
    ds_read_b128 v[92:95], v136 offset:27648
    v_mfma_f32_16x16x32_bf16 a[80:83], v[40:43], v[16:19], a[80:83]
    v_mfma_f32_16x16x32_bf16 a[84:87], v[40:43], v[20:23], a[84:87]
    buffer_load_dwordx4 v139, s[8:11], s15 offen offset:2048 lds
    v_mfma_f32_16x16x32_bf16 a[88:91], v[40:43], v[24:27], a[88:91]
    v_mfma_f32_16x16x32_bf16 a[92:95], v[40:43], v[28:31], a[92:95]
    v_mfma_f32_16x16x32_bf16 a[96:99], v[44:47], v[0:3], a[96:99]
    buffer_load_dwordx4 v140, s[8:11], s15 offen offset:3072 lds
    v_mfma_f32_16x16x32_bf16 a[100:103], v[44:47], v[4:7], a[100:103]
    v_mfma_f32_16x16x32_bf16 a[104:107], v[44:47], v[8:11], a[104:107]
    v_mfma_f32_16x16x32_bf16 a[108:111], v[44:47], v[12:15], a[108:111]
    s_add_u32 s15, s15, s17
    v_mfma_f32_16x16x32_bf16 a[112:115], v[44:47], v[16:19], a[112:115]
    v_mfma_f32_16x16x32_bf16 a[116:119], v[44:47], v[20:23], a[116:119]
    v_mfma_f32_16x16x32_bf16 a[120:123], v[44:47], v[24:27], a[120:123]
    v_mfma_f32_16x16x32_bf16 a[124:127], v[44:47], v[28:31], a[124:127]
    s_waitcnt lgkmcnt(0)
    v_mfma_f32_16x16x32_bf16 a[0:3], v[80:83], v[48:51], a[0:3]
    s_waitcnt vmcnt(12)
    s_barrier
    ds_read_b128 v[32:35], v136 offset:0
    s_add_u32 m0, s20, 24576
    s_nop 0
    v_mfma_f32_16x16x32_bf16 a[4:7], v[80:83], v[52:55], a[4:7]
    ds_read_b64_tr_b16 v[0:1], v128 offset:0
    v_mfma_f32_16x16x32_bf16 a[8:11], v[80:83], v[56:59], a[8:11]
    ds_read_b64_tr_b16 v[2:3], v128 offset:8192
    v_mfma_f32_16x16x32_bf16 a[12:15], v[80:83], v[60:63], a[12:15]
    ds_read_b64_tr_b16 v[4:5], v129 offset:0
    buffer_load_dwordx4 v141, s[4:7], s16 offen offset:0 sc1 lds
    v_mfma_f32_16x16x32_bf16 a[16:19], v[80:83], v[64:67], a[16:19]
    ds_read_b64_tr_b16 v[6:7], v129 offset:8192
    v_mfma_f32_16x16x32_bf16 a[20:23], v[80:83], v[68:71], a[20:23]
    ds_read_b64_tr_b16 v[8:9], v130 offset:0
    v_mfma_f32_16x16x32_bf16 a[24:27], v[80:83], v[72:75], a[24:27]
    ds_read_b64_tr_b16 v[10:11], v130 offset:8192
    buffer_load_dwordx4 v142, s[4:7], s16 offen offset:1024 sc1 lds
    v_mfma_f32_16x16x32_bf16 a[28:31], v[80:83], v[76:79], a[28:31]
    ds_read_b64_tr_b16 v[12:13], v131 offset:0
    v_mfma_f32_16x16x32_bf16 a[32:35], v[84:87], v[48:51], a[32:35]
    ds_read_b64_tr_b16 v[14:15], v131 offset:8192
    v_mfma_f32_16x16x32_bf16 a[36:39], v[84:87], v[52:55], a[36:39]
    ds_read_b64_tr_b16 v[16:17], v132 offset:0
    s_add_u32 s16, s16, 1024
    v_mfma_f32_16x16x32_bf16 a[40:43], v[84:87], v[56:59], a[40:43]
    ds_read_b64_tr_b16 v[18:19], v132 offset:8192
    v_mfma_f32_16x16x32_bf16 a[44:47], v[84:87], v[60:63], a[44:47]
    ds_read_b64_tr_b16 v[20:21], v133 offset:0
    v_mfma_f32_16x16x32_bf16 a[48:51], v[84:87], v[64:67], a[48:51]
    ds_read_b64_tr_b16 v[22:23], v133 offset:8192
    s_add_u32 m0, s19, 49152
    s_nop 0
    v_mfma_f32_16x16x32_bf16 a[52:55], v[84:87], v[68:71], a[52:55]
    ds_read_b64_tr_b16 v[24:25], v134 offset:0
    v_mfma_f32_16x16x32_bf16 a[56:59], v[84:87], v[72:75], a[56:59]
    ds_read_b64_tr_b16 v[26:27], v134 offset:8192
    v_mfma_f32_16x16x32_bf16 a[60:63], v[84:87], v[76:79], a[60:63]
    ds_read_b64_tr_b16 v[28:29], v135 offset:0
    buffer_load_dwordx4 v137, s[8:11], s15 offen offset:0 lds
    v_mfma_f32_16x16x32_bf16 a[64:67], v[88:91], v[48:51], a[64:67]
    ds_read_b64_tr_b16 v[30:31], v135 offset:8192
    v_mfma_f32_16x16x32_bf16 a[68:71], v[88:91], v[52:55], a[68:71]
    ds_read_b128 v[36:39], v136 offset:1024
    v_mfma_f32_16x16x32_bf16 a[72:75], v[88:91], v[56:59], a[72:75]
    ds_read_b128 v[40:43], v136 offset:2048
    buffer_load_dwordx4 v138, s[8:11], s15 offen offset:1024 lds
    v_mfma_f32_16x16x32_bf16 a[76:79], v[88:91], v[60:63], a[76:79]
    ds_read_b128 v[44:47], v136 offset:3072
    v_mfma_f32_16x16x32_bf16 a[80:83], v[88:91], v[64:67], a[80:83]
    v_mfma_f32_16x16x32_bf16 a[84:87], v[88:91], v[68:71], a[84:87]
    buffer_load_dwordx4 v139, s[8:11], s15 offen offset:2048 lds
    v_mfma_f32_16x16x32_bf16 a[88:91], v[88:91], v[72:75], a[88:91]
    v_mfma_f32_16x16x32_bf16 a[92:95], v[88:91], v[76:79], a[92:95]
    v_mfma_f32_16x16x32_bf16 a[96:99], v[92:95], v[48:51], a[96:99]
    buffer_load_dwordx4 v140, s[8:11], s15 offen offset:3072 lds
    v_mfma_f32_16x16x32_bf16 a[100:103], v[92:95], v[52:55], a[100:103]
    v_mfma_f32_16x16x32_bf16 a[104:107], v[92:95], v[56:59], a[104:107]
    v_mfma_f32_16x16x32_bf16 a[108:111], v[92:95], v[60:63], a[108:111]
    s_add_u32 s15, s15, s17
    v_mfma_f32_16x16x32_bf16 a[112:115], v[92:95], v[64:67], a[112:115]
    v_mfma_f32_16x16x32_bf16 a[116:119], v[92:95], v[68:71], a[116:119]
    v_mfma_f32_16x16x32_bf16 a[120:123], v[92:95], v[72:75], a[120:123]
    v_mfma_f32_16x16x32_bf16 a[124:127], v[92:95], v[76:79], a[124:127]
    s_sub_u32 s18, s18, 1
    s_cmp_lg_u32 s18, 0
    s_cbranch_scc1 main_kernel_w_c1_v_loop
    s_cmp_lg_u32 s14, 0
    s_cbranch_scc1 main_kernel_w_c1_v_nt
    s_lshl_b32 s32, s27, 8
    s_add_u32 s32, s32, 0x841e000
    v_mov_b32 v255, 1
    s_mov_b64 exec, 1
    buffer_atomic_add v255, off, s[4:7], s32 sc0 sc1
    s_mov_b64 exec, -1
main_kernel_w_c1_v_nt:
    s_waitcnt lgkmcnt(0)
    v_mfma_f32_16x16x32_bf16 a[0:3], v[32:35], v[0:3], a[0:3]
    s_waitcnt vmcnt(12)
    s_barrier
    ds_read_b128 v[80:83], v136 offset:8192
    v_mfma_f32_16x16x32_bf16 a[4:7], v[32:35], v[4:7], a[4:7]
    ds_read_b64_tr_b16 v[48:49], v128 offset:16384
    v_mfma_f32_16x16x32_bf16 a[8:11], v[32:35], v[8:11], a[8:11]
    ds_read_b64_tr_b16 v[50:51], v128 offset:24576
    v_mfma_f32_16x16x32_bf16 a[12:15], v[32:35], v[12:15], a[12:15]
    ds_read_b64_tr_b16 v[52:53], v129 offset:16384
    v_mfma_f32_16x16x32_bf16 a[16:19], v[32:35], v[16:19], a[16:19]
    ds_read_b64_tr_b16 v[54:55], v129 offset:24576
    v_mfma_f32_16x16x32_bf16 a[20:23], v[32:35], v[20:23], a[20:23]
    ds_read_b64_tr_b16 v[56:57], v130 offset:16384
    v_mfma_f32_16x16x32_bf16 a[24:27], v[32:35], v[24:27], a[24:27]
    ds_read_b64_tr_b16 v[58:59], v130 offset:24576
    v_mfma_f32_16x16x32_bf16 a[28:31], v[32:35], v[28:31], a[28:31]
    ds_read_b64_tr_b16 v[60:61], v131 offset:16384
    v_mfma_f32_16x16x32_bf16 a[32:35], v[36:39], v[0:3], a[32:35]
    ds_read_b64_tr_b16 v[62:63], v131 offset:24576
    v_mfma_f32_16x16x32_bf16 a[36:39], v[36:39], v[4:7], a[36:39]
    ds_read_b64_tr_b16 v[64:65], v132 offset:16384
    v_mfma_f32_16x16x32_bf16 a[40:43], v[36:39], v[8:11], a[40:43]
    ds_read_b64_tr_b16 v[66:67], v132 offset:24576
    v_mfma_f32_16x16x32_bf16 a[44:47], v[36:39], v[12:15], a[44:47]
    ds_read_b64_tr_b16 v[68:69], v133 offset:16384
    v_mfma_f32_16x16x32_bf16 a[48:51], v[36:39], v[16:19], a[48:51]
    ds_read_b64_tr_b16 v[70:71], v133 offset:24576
    v_mfma_f32_16x16x32_bf16 a[52:55], v[36:39], v[20:23], a[52:55]
    ds_read_b64_tr_b16 v[72:73], v134 offset:16384
    v_mfma_f32_16x16x32_bf16 a[56:59], v[36:39], v[24:27], a[56:59]
    ds_read_b64_tr_b16 v[74:75], v134 offset:24576
    v_mfma_f32_16x16x32_bf16 a[60:63], v[36:39], v[28:31], a[60:63]
    ds_read_b64_tr_b16 v[76:77], v135 offset:16384
    v_mfma_f32_16x16x32_bf16 a[64:67], v[40:43], v[0:3], a[64:67]
    ds_read_b64_tr_b16 v[78:79], v135 offset:24576
    v_mfma_f32_16x16x32_bf16 a[68:71], v[40:43], v[4:7], a[68:71]
    ds_read_b128 v[84:87], v136 offset:9216
    v_mfma_f32_16x16x32_bf16 a[72:75], v[40:43], v[8:11], a[72:75]
    ds_read_b128 v[88:91], v136 offset:10240
    v_mfma_f32_16x16x32_bf16 a[76:79], v[40:43], v[12:15], a[76:79]
    ds_read_b128 v[92:95], v136 offset:11264
    v_mfma_f32_16x16x32_bf16 a[80:83], v[40:43], v[16:19], a[80:83]
    v_mfma_f32_16x16x32_bf16 a[84:87], v[40:43], v[20:23], a[84:87]
    v_mfma_f32_16x16x32_bf16 a[88:91], v[40:43], v[24:27], a[88:91]
    v_mfma_f32_16x16x32_bf16 a[92:95], v[40:43], v[28:31], a[92:95]
    v_mfma_f32_16x16x32_bf16 a[96:99], v[44:47], v[0:3], a[96:99]
    v_mfma_f32_16x16x32_bf16 a[100:103], v[44:47], v[4:7], a[100:103]
    v_mfma_f32_16x16x32_bf16 a[104:107], v[44:47], v[8:11], a[104:107]
    v_mfma_f32_16x16x32_bf16 a[108:111], v[44:47], v[12:15], a[108:111]
    v_mfma_f32_16x16x32_bf16 a[112:115], v[44:47], v[16:19], a[112:115]
    v_mfma_f32_16x16x32_bf16 a[116:119], v[44:47], v[20:23], a[116:119]
    v_mfma_f32_16x16x32_bf16 a[120:123], v[44:47], v[24:27], a[120:123]
    v_mfma_f32_16x16x32_bf16 a[124:127], v[44:47], v[28:31], a[124:127]
    s_waitcnt lgkmcnt(0)
    v_mfma_f32_16x16x32_bf16 a[0:3], v[80:83], v[48:51], a[0:3]
    s_waitcnt vmcnt(6)
    s_barrier
    ds_read_b128 v[32:35], v136 offset:16384
    v_mfma_f32_16x16x32_bf16 a[4:7], v[80:83], v[52:55], a[4:7]
    ds_read_b64_tr_b16 v[0:1], v128 offset:32768
    v_mfma_f32_16x16x32_bf16 a[8:11], v[80:83], v[56:59], a[8:11]
    ds_read_b64_tr_b16 v[2:3], v128 offset:40960
    v_mfma_f32_16x16x32_bf16 a[12:15], v[80:83], v[60:63], a[12:15]
    ds_read_b64_tr_b16 v[4:5], v129 offset:32768
    v_mfma_f32_16x16x32_bf16 a[16:19], v[80:83], v[64:67], a[16:19]
    ds_read_b64_tr_b16 v[6:7], v129 offset:40960
    v_mfma_f32_16x16x32_bf16 a[20:23], v[80:83], v[68:71], a[20:23]
    ds_read_b64_tr_b16 v[8:9], v130 offset:32768
    v_mfma_f32_16x16x32_bf16 a[24:27], v[80:83], v[72:75], a[24:27]
    ds_read_b64_tr_b16 v[10:11], v130 offset:40960
    v_mfma_f32_16x16x32_bf16 a[28:31], v[80:83], v[76:79], a[28:31]
    ds_read_b64_tr_b16 v[12:13], v131 offset:32768
    v_mfma_f32_16x16x32_bf16 a[32:35], v[84:87], v[48:51], a[32:35]
    ds_read_b64_tr_b16 v[14:15], v131 offset:40960
    v_mfma_f32_16x16x32_bf16 a[36:39], v[84:87], v[52:55], a[36:39]
    ds_read_b64_tr_b16 v[16:17], v132 offset:32768
    v_mfma_f32_16x16x32_bf16 a[40:43], v[84:87], v[56:59], a[40:43]
    ds_read_b64_tr_b16 v[18:19], v132 offset:40960
    v_mfma_f32_16x16x32_bf16 a[44:47], v[84:87], v[60:63], a[44:47]
    ds_read_b64_tr_b16 v[20:21], v133 offset:32768
    v_mfma_f32_16x16x32_bf16 a[48:51], v[84:87], v[64:67], a[48:51]
    ds_read_b64_tr_b16 v[22:23], v133 offset:40960
    v_mfma_f32_16x16x32_bf16 a[52:55], v[84:87], v[68:71], a[52:55]
    ds_read_b64_tr_b16 v[24:25], v134 offset:32768
    v_mfma_f32_16x16x32_bf16 a[56:59], v[84:87], v[72:75], a[56:59]
    ds_read_b64_tr_b16 v[26:27], v134 offset:40960
    v_mfma_f32_16x16x32_bf16 a[60:63], v[84:87], v[76:79], a[60:63]
    ds_read_b64_tr_b16 v[28:29], v135 offset:32768
    v_mfma_f32_16x16x32_bf16 a[64:67], v[88:91], v[48:51], a[64:67]
    ds_read_b64_tr_b16 v[30:31], v135 offset:40960
    v_mfma_f32_16x16x32_bf16 a[68:71], v[88:91], v[52:55], a[68:71]
    ds_read_b128 v[36:39], v136 offset:17408
    v_mfma_f32_16x16x32_bf16 a[72:75], v[88:91], v[56:59], a[72:75]
    ds_read_b128 v[40:43], v136 offset:18432
    v_mfma_f32_16x16x32_bf16 a[76:79], v[88:91], v[60:63], a[76:79]
    ds_read_b128 v[44:47], v136 offset:19456
    v_mfma_f32_16x16x32_bf16 a[80:83], v[88:91], v[64:67], a[80:83]
    v_mfma_f32_16x16x32_bf16 a[84:87], v[88:91], v[68:71], a[84:87]
    v_mfma_f32_16x16x32_bf16 a[88:91], v[88:91], v[72:75], a[88:91]
    v_mfma_f32_16x16x32_bf16 a[92:95], v[88:91], v[76:79], a[92:95]
    v_mfma_f32_16x16x32_bf16 a[96:99], v[92:95], v[48:51], a[96:99]
    v_mfma_f32_16x16x32_bf16 a[100:103], v[92:95], v[52:55], a[100:103]
    v_mfma_f32_16x16x32_bf16 a[104:107], v[92:95], v[56:59], a[104:107]
    v_mfma_f32_16x16x32_bf16 a[108:111], v[92:95], v[60:63], a[108:111]
    v_mfma_f32_16x16x32_bf16 a[112:115], v[92:95], v[64:67], a[112:115]
    v_mfma_f32_16x16x32_bf16 a[116:119], v[92:95], v[68:71], a[116:119]
    v_mfma_f32_16x16x32_bf16 a[120:123], v[92:95], v[72:75], a[120:123]
    v_mfma_f32_16x16x32_bf16 a[124:127], v[92:95], v[76:79], a[124:127]
    s_waitcnt lgkmcnt(0)
    v_mfma_f32_16x16x32_bf16 a[0:3], v[32:35], v[0:3], a[0:3]
    s_waitcnt vmcnt(0)
    s_barrier
    ds_read_b128 v[80:83], v136 offset:24576
    v_mfma_f32_16x16x32_bf16 a[4:7], v[32:35], v[4:7], a[4:7]
    ds_read_b64_tr_b16 v[48:49], v128 offset:49152
    v_mfma_f32_16x16x32_bf16 a[8:11], v[32:35], v[8:11], a[8:11]
    ds_read_b64_tr_b16 v[50:51], v128 offset:57344
    v_mfma_f32_16x16x32_bf16 a[12:15], v[32:35], v[12:15], a[12:15]
    ds_read_b64_tr_b16 v[52:53], v129 offset:49152
    v_mfma_f32_16x16x32_bf16 a[16:19], v[32:35], v[16:19], a[16:19]
    ds_read_b64_tr_b16 v[54:55], v129 offset:57344
    v_mfma_f32_16x16x32_bf16 a[20:23], v[32:35], v[20:23], a[20:23]
    ds_read_b64_tr_b16 v[56:57], v130 offset:49152
    v_mfma_f32_16x16x32_bf16 a[24:27], v[32:35], v[24:27], a[24:27]
    ds_read_b64_tr_b16 v[58:59], v130 offset:57344
    v_mfma_f32_16x16x32_bf16 a[28:31], v[32:35], v[28:31], a[28:31]
    ds_read_b64_tr_b16 v[60:61], v131 offset:49152
    v_mfma_f32_16x16x32_bf16 a[32:35], v[36:39], v[0:3], a[32:35]
    ds_read_b64_tr_b16 v[62:63], v131 offset:57344
    v_mfma_f32_16x16x32_bf16 a[36:39], v[36:39], v[4:7], a[36:39]
    ds_read_b64_tr_b16 v[64:65], v132 offset:49152
    v_mfma_f32_16x16x32_bf16 a[40:43], v[36:39], v[8:11], a[40:43]
    ds_read_b64_tr_b16 v[66:67], v132 offset:57344
    v_mfma_f32_16x16x32_bf16 a[44:47], v[36:39], v[12:15], a[44:47]
    ds_read_b64_tr_b16 v[68:69], v133 offset:49152
    v_mfma_f32_16x16x32_bf16 a[48:51], v[36:39], v[16:19], a[48:51]
    ds_read_b64_tr_b16 v[70:71], v133 offset:57344
    v_mfma_f32_16x16x32_bf16 a[52:55], v[36:39], v[20:23], a[52:55]
    ds_read_b64_tr_b16 v[72:73], v134 offset:49152
    v_mfma_f32_16x16x32_bf16 a[56:59], v[36:39], v[24:27], a[56:59]
    ds_read_b64_tr_b16 v[74:75], v134 offset:57344
    v_mfma_f32_16x16x32_bf16 a[60:63], v[36:39], v[28:31], a[60:63]
    ds_read_b64_tr_b16 v[76:77], v135 offset:49152
    v_mfma_f32_16x16x32_bf16 a[64:67], v[40:43], v[0:3], a[64:67]
    ds_read_b64_tr_b16 v[78:79], v135 offset:57344
    v_mfma_f32_16x16x32_bf16 a[68:71], v[40:43], v[4:7], a[68:71]
    ds_read_b128 v[84:87], v136 offset:25600
    v_mfma_f32_16x16x32_bf16 a[72:75], v[40:43], v[8:11], a[72:75]
    ds_read_b128 v[88:91], v136 offset:26624
    v_mfma_f32_16x16x32_bf16 a[76:79], v[40:43], v[12:15], a[76:79]
    ds_read_b128 v[92:95], v136 offset:27648
    v_mfma_f32_16x16x32_bf16 a[80:83], v[40:43], v[16:19], a[80:83]
    v_mfma_f32_16x16x32_bf16 a[84:87], v[40:43], v[20:23], a[84:87]
    v_mfma_f32_16x16x32_bf16 a[88:91], v[40:43], v[24:27], a[88:91]
    v_mfma_f32_16x16x32_bf16 a[92:95], v[40:43], v[28:31], a[92:95]
    v_mfma_f32_16x16x32_bf16 a[96:99], v[44:47], v[0:3], a[96:99]
    v_mfma_f32_16x16x32_bf16 a[100:103], v[44:47], v[4:7], a[100:103]
    v_mfma_f32_16x16x32_bf16 a[104:107], v[44:47], v[8:11], a[104:107]
    v_mfma_f32_16x16x32_bf16 a[108:111], v[44:47], v[12:15], a[108:111]
    v_mfma_f32_16x16x32_bf16 a[112:115], v[44:47], v[16:19], a[112:115]
    v_mfma_f32_16x16x32_bf16 a[116:119], v[44:47], v[20:23], a[116:119]
    v_mfma_f32_16x16x32_bf16 a[120:123], v[44:47], v[24:27], a[120:123]
    v_mfma_f32_16x16x32_bf16 a[124:127], v[44:47], v[28:31], a[124:127]
    v_readfirstlane_b32 s55, v255
    s_waitcnt lgkmcnt(0)
    v_mfma_f32_16x16x32_bf16 a[0:3], v[80:83], v[48:51], a[0:3]
    v_mfma_f32_16x16x32_bf16 a[4:7], v[80:83], v[52:55], a[4:7]
    v_mfma_f32_16x16x32_bf16 a[8:11], v[80:83], v[56:59], a[8:11]
    v_mfma_f32_16x16x32_bf16 a[12:15], v[80:83], v[60:63], a[12:15]
    v_mfma_f32_16x16x32_bf16 a[16:19], v[80:83], v[64:67], a[16:19]
    v_mfma_f32_16x16x32_bf16 a[20:23], v[80:83], v[68:71], a[20:23]
    v_mfma_f32_16x16x32_bf16 a[24:27], v[80:83], v[72:75], a[24:27]
    v_mfma_f32_16x16x32_bf16 a[28:31], v[80:83], v[76:79], a[28:31]
    v_mfma_f32_16x16x32_bf16 a[32:35], v[84:87], v[48:51], a[32:35]
    v_mfma_f32_16x16x32_bf16 a[36:39], v[84:87], v[52:55], a[36:39]
    v_mfma_f32_16x16x32_bf16 a[40:43], v[84:87], v[56:59], a[40:43]
    v_mfma_f32_16x16x32_bf16 a[44:47], v[84:87], v[60:63], a[44:47]
    v_mfma_f32_16x16x32_bf16 a[48:51], v[84:87], v[64:67], a[48:51]
    v_mfma_f32_16x16x32_bf16 a[52:55], v[84:87], v[68:71], a[52:55]
    v_mfma_f32_16x16x32_bf16 a[56:59], v[84:87], v[72:75], a[56:59]
    v_mfma_f32_16x16x32_bf16 a[60:63], v[84:87], v[76:79], a[60:63]
    v_mfma_f32_16x16x32_bf16 a[64:67], v[88:91], v[48:51], a[64:67]
    v_mfma_f32_16x16x32_bf16 a[68:71], v[88:91], v[52:55], a[68:71]
    v_mfma_f32_16x16x32_bf16 a[72:75], v[88:91], v[56:59], a[72:75]
    v_mfma_f32_16x16x32_bf16 a[76:79], v[88:91], v[60:63], a[76:79]
    v_mfma_f32_16x16x32_bf16 a[80:83], v[88:91], v[64:67], a[80:83]
    v_mfma_f32_16x16x32_bf16 a[84:87], v[88:91], v[68:71], a[84:87]
    v_mfma_f32_16x16x32_bf16 a[88:91], v[88:91], v[72:75], a[88:91]
    v_mfma_f32_16x16x32_bf16 a[92:95], v[88:91], v[76:79], a[92:95]
    v_mfma_f32_16x16x32_bf16 a[96:99], v[92:95], v[48:51], a[96:99]
    v_mfma_f32_16x16x32_bf16 a[100:103], v[92:95], v[52:55], a[100:103]
    v_mfma_f32_16x16x32_bf16 a[104:107], v[92:95], v[56:59], a[104:107]
    v_mfma_f32_16x16x32_bf16 a[108:111], v[92:95], v[60:63], a[108:111]
    v_mfma_f32_16x16x32_bf16 a[112:115], v[92:95], v[64:67], a[112:115]
    v_mfma_f32_16x16x32_bf16 a[116:119], v[92:95], v[68:71], a[116:119]
    v_mfma_f32_16x16x32_bf16 a[120:123], v[92:95], v[72:75], a[120:123]
    v_mfma_f32_16x16x32_bf16 a[124:127], v[92:95], v[76:79], a[124:127]
    s_nop 7
    s_mov_b32 s53, s21
    v_accvgpr_read_b32 v0, a0
    v_accvgpr_read_b32 v1, a1
    v_accvgpr_read_b32 v2, a2
    v_accvgpr_read_b32 v3, a3
    v_accvgpr_read_b32 v4, a32
    v_accvgpr_read_b32 v5, a33
    v_accvgpr_read_b32 v6, a34
    v_accvgpr_read_b32 v7, a35
    v_cvt_pk_bf16_f32 v8, v0, v1
    v_cvt_pk_bf16_f32 v9, v2, v3
    v_cvt_pk_bf16_f32 v10, v4, v5
    v_cvt_pk_bf16_f32 v11, v6, v7
    buffer_store_dwordx4 v[8:11], v251, s[4:7], s53 offen offset:0 sc1
    v_accvgpr_read_b32 v16, a4
    v_accvgpr_read_b32 v17, a5
    v_accvgpr_read_b32 v18, a6
    v_accvgpr_read_b32 v19, a7
    v_accvgpr_read_b32 v20, a36
    v_accvgpr_read_b32 v21, a37
    v_accvgpr_read_b32 v22, a38
    v_accvgpr_read_b32 v23, a39
    v_cvt_pk_bf16_f32 v24, v16, v17
    v_cvt_pk_bf16_f32 v25, v18, v19
    v_cvt_pk_bf16_f32 v26, v20, v21
    v_cvt_pk_bf16_f32 v27, v22, v23
    buffer_store_dwordx4 v[24:27], v251, s[4:7], s53 offen offset:1024 sc1
    v_accvgpr_read_b32 v32, a8
    v_accvgpr_read_b32 v33, a9
    v_accvgpr_read_b32 v34, a10
    v_accvgpr_read_b32 v35, a11
    v_accvgpr_read_b32 v36, a40
    v_accvgpr_read_b32 v37, a41
    v_accvgpr_read_b32 v38, a42
    v_accvgpr_read_b32 v39, a43
    v_cvt_pk_bf16_f32 v40, v32, v33
    v_cvt_pk_bf16_f32 v41, v34, v35
    v_cvt_pk_bf16_f32 v42, v36, v37
    v_cvt_pk_bf16_f32 v43, v38, v39
    buffer_store_dwordx4 v[40:43], v251, s[4:7], s53 offen offset:2048 sc1
    v_accvgpr_read_b32 v48, a12
    v_accvgpr_read_b32 v49, a13
    v_accvgpr_read_b32 v50, a14
    v_accvgpr_read_b32 v51, a15
    v_accvgpr_read_b32 v52, a44
    v_accvgpr_read_b32 v53, a45
    v_accvgpr_read_b32 v54, a46
    v_accvgpr_read_b32 v55, a47
    v_cvt_pk_bf16_f32 v56, v48, v49
    v_cvt_pk_bf16_f32 v57, v50, v51
    v_cvt_pk_bf16_f32 v58, v52, v53
    v_cvt_pk_bf16_f32 v59, v54, v55
    buffer_store_dwordx4 v[56:59], v251, s[4:7], s53 offen offset:3072 sc1
    s_add_u32 s53, s53, 4096
    v_accvgpr_read_b32 v0, a16
    v_accvgpr_read_b32 v1, a17
    v_accvgpr_read_b32 v2, a18
    v_accvgpr_read_b32 v3, a19
    v_accvgpr_read_b32 v4, a48
    v_accvgpr_read_b32 v5, a49
    v_accvgpr_read_b32 v6, a50
    v_accvgpr_read_b32 v7, a51
    v_cvt_pk_bf16_f32 v8, v0, v1
    v_cvt_pk_bf16_f32 v9, v2, v3
    v_cvt_pk_bf16_f32 v10, v4, v5
    v_cvt_pk_bf16_f32 v11, v6, v7
    buffer_store_dwordx4 v[8:11], v251, s[4:7], s53 offen offset:0 sc1
    v_accvgpr_read_b32 v16, a20
    v_accvgpr_read_b32 v17, a21
    v_accvgpr_read_b32 v18, a22
    v_accvgpr_read_b32 v19, a23
    v_accvgpr_read_b32 v20, a52
    v_accvgpr_read_b32 v21, a53
    v_accvgpr_read_b32 v22, a54
    v_accvgpr_read_b32 v23, a55
    v_cvt_pk_bf16_f32 v24, v16, v17
    v_cvt_pk_bf16_f32 v25, v18, v19
    v_cvt_pk_bf16_f32 v26, v20, v21
    v_cvt_pk_bf16_f32 v27, v22, v23
    buffer_store_dwordx4 v[24:27], v251, s[4:7], s53 offen offset:1024 sc1
    v_accvgpr_read_b32 v32, a24
    v_accvgpr_read_b32 v33, a25
    v_accvgpr_read_b32 v34, a26
    v_accvgpr_read_b32 v35, a27
    v_accvgpr_read_b32 v36, a56
    v_accvgpr_read_b32 v37, a57
    v_accvgpr_read_b32 v38, a58
    v_accvgpr_read_b32 v39, a59
    v_cvt_pk_bf16_f32 v40, v32, v33
    v_cvt_pk_bf16_f32 v41, v34, v35
    v_cvt_pk_bf16_f32 v42, v36, v37
    v_cvt_pk_bf16_f32 v43, v38, v39
    buffer_store_dwordx4 v[40:43], v251, s[4:7], s53 offen offset:2048 sc1
    v_accvgpr_read_b32 v48, a28
    v_accvgpr_read_b32 v49, a29
    v_accvgpr_read_b32 v50, a30
    v_accvgpr_read_b32 v51, a31
    v_accvgpr_read_b32 v52, a60
    v_accvgpr_read_b32 v53, a61
    v_accvgpr_read_b32 v54, a62
    v_accvgpr_read_b32 v55, a63
    v_cvt_pk_bf16_f32 v56, v48, v49
    v_cvt_pk_bf16_f32 v57, v50, v51
    v_cvt_pk_bf16_f32 v58, v52, v53
    v_cvt_pk_bf16_f32 v59, v54, v55
    buffer_store_dwordx4 v[56:59], v251, s[4:7], s53 offen offset:3072 sc1
    s_add_u32 s53, s53, 258048
    v_accvgpr_read_b32 v0, a64
    v_accvgpr_read_b32 v1, a65
    v_accvgpr_read_b32 v2, a66
    v_accvgpr_read_b32 v3, a67
    v_accvgpr_read_b32 v4, a96
    v_accvgpr_read_b32 v5, a97
    v_accvgpr_read_b32 v6, a98
    v_accvgpr_read_b32 v7, a99
    v_cvt_pk_bf16_f32 v8, v0, v1
    v_cvt_pk_bf16_f32 v9, v2, v3
    v_cvt_pk_bf16_f32 v10, v4, v5
    v_cvt_pk_bf16_f32 v11, v6, v7
    buffer_store_dwordx4 v[8:11], v251, s[4:7], s53 offen offset:0 sc1
    v_accvgpr_read_b32 v16, a68
    v_accvgpr_read_b32 v17, a69
    v_accvgpr_read_b32 v18, a70
    v_accvgpr_read_b32 v19, a71
    v_accvgpr_read_b32 v20, a100
    v_accvgpr_read_b32 v21, a101
    v_accvgpr_read_b32 v22, a102
    v_accvgpr_read_b32 v23, a103
    v_cvt_pk_bf16_f32 v24, v16, v17
    v_cvt_pk_bf16_f32 v25, v18, v19
    v_cvt_pk_bf16_f32 v26, v20, v21
    v_cvt_pk_bf16_f32 v27, v22, v23
    buffer_store_dwordx4 v[24:27], v251, s[4:7], s53 offen offset:1024 sc1
    v_accvgpr_read_b32 v32, a72
    v_accvgpr_read_b32 v33, a73
    v_accvgpr_read_b32 v34, a74
    v_accvgpr_read_b32 v35, a75
    v_accvgpr_read_b32 v36, a104
    v_accvgpr_read_b32 v37, a105
    v_accvgpr_read_b32 v38, a106
    v_accvgpr_read_b32 v39, a107
    v_cvt_pk_bf16_f32 v40, v32, v33
    v_cvt_pk_bf16_f32 v41, v34, v35
    v_cvt_pk_bf16_f32 v42, v36, v37
    v_cvt_pk_bf16_f32 v43, v38, v39
    buffer_store_dwordx4 v[40:43], v251, s[4:7], s53 offen offset:2048 sc1
    v_accvgpr_read_b32 v48, a76
    v_accvgpr_read_b32 v49, a77
    v_accvgpr_read_b32 v50, a78
    v_accvgpr_read_b32 v51, a79
    v_accvgpr_read_b32 v52, a108
    v_accvgpr_read_b32 v53, a109
    v_accvgpr_read_b32 v54, a110
    v_accvgpr_read_b32 v55, a111
    v_cvt_pk_bf16_f32 v56, v48, v49
    v_cvt_pk_bf16_f32 v57, v50, v51
    v_cvt_pk_bf16_f32 v58, v52, v53
    v_cvt_pk_bf16_f32 v59, v54, v55
    buffer_store_dwordx4 v[56:59], v251, s[4:7], s53 offen offset:3072 sc1
    s_add_u32 s53, s53, 4096
    v_accvgpr_read_b32 v0, a80
    v_accvgpr_read_b32 v1, a81
    v_accvgpr_read_b32 v2, a82
    v_accvgpr_read_b32 v3, a83
    v_accvgpr_read_b32 v4, a112
    v_accvgpr_read_b32 v5, a113
    v_accvgpr_read_b32 v6, a114
    v_accvgpr_read_b32 v7, a115
    v_cvt_pk_bf16_f32 v8, v0, v1
    v_cvt_pk_bf16_f32 v9, v2, v3
    v_cvt_pk_bf16_f32 v10, v4, v5
    v_cvt_pk_bf16_f32 v11, v6, v7
    buffer_store_dwordx4 v[8:11], v251, s[4:7], s53 offen offset:0 sc1
    v_accvgpr_read_b32 v16, a84
    v_accvgpr_read_b32 v17, a85
    v_accvgpr_read_b32 v18, a86
    v_accvgpr_read_b32 v19, a87
    v_accvgpr_read_b32 v20, a116
    v_accvgpr_read_b32 v21, a117
    v_accvgpr_read_b32 v22, a118
    v_accvgpr_read_b32 v23, a119
    v_cvt_pk_bf16_f32 v24, v16, v17
    v_cvt_pk_bf16_f32 v25, v18, v19
    v_cvt_pk_bf16_f32 v26, v20, v21
    v_cvt_pk_bf16_f32 v27, v22, v23
    buffer_store_dwordx4 v[24:27], v251, s[4:7], s53 offen offset:1024 sc1
    v_accvgpr_read_b32 v32, a88
    v_accvgpr_read_b32 v33, a89
    v_accvgpr_read_b32 v34, a90
    v_accvgpr_read_b32 v35, a91
    v_accvgpr_read_b32 v36, a120
    v_accvgpr_read_b32 v37, a121
    v_accvgpr_read_b32 v38, a122
    v_accvgpr_read_b32 v39, a123
    v_cvt_pk_bf16_f32 v40, v32, v33
    v_cvt_pk_bf16_f32 v41, v34, v35
    v_cvt_pk_bf16_f32 v42, v36, v37
    v_cvt_pk_bf16_f32 v43, v38, v39
    buffer_store_dwordx4 v[40:43], v251, s[4:7], s53 offen offset:2048 sc1
    v_accvgpr_read_b32 v48, a92
    v_accvgpr_read_b32 v49, a93
    v_accvgpr_read_b32 v50, a94
    v_accvgpr_read_b32 v51, a95
    v_accvgpr_read_b32 v52, a124
    v_accvgpr_read_b32 v53, a125
    v_accvgpr_read_b32 v54, a126
    v_accvgpr_read_b32 v55, a127
    v_cvt_pk_bf16_f32 v56, v48, v49
    v_cvt_pk_bf16_f32 v57, v50, v51
    v_cvt_pk_bf16_f32 v58, v52, v53
    v_cvt_pk_bf16_f32 v59, v54, v55
    buffer_store_dwordx4 v[56:59], v251, s[4:7], s53 offen offset:3072 sc1
    s_add_u32 s53, s53, 258048
    s_branch main_kernel_w_done
main_kernel_w_c2_task:
    s_cmp_eq_u32 s23, 0
    s_cbranch_scc1 main_kernel_w_c2_set0
    s_cmp_eq_u32 s23, 1
    s_cbranch_scc1 main_kernel_w_c2_set1
    s_cmp_eq_u32 s23, 2
    s_cbranch_scc1 main_kernel_w_c2_set2
    s_cmp_eq_u32 s23, 6
    s_cbranch_scc1 main_kernel_w_c2_set6
    s_branch main_kernel_w_done
main_kernel_w_c2_set0:
    s_lshl_b32 s32, s25, 8
    s_add_u32 s8, s40, s32
    s_addc_u32 s9, s41, 0
    s_and_b32 s9, s9, 0xffff
    s_sub_u32 s10, 0x800000, s32
    s_mov_b32 s11, 0x20000
    s_mov_b32 s30, 8192
    s_mov_b32 s31, 32768
    s_mul_i32 s16, s24, 262144
    s_add_u32 s16, s16, 0x0
    s_mov_b32 s18, 7
    s_lshl_b32 s32, s24, 3
    s_mul_i32 s33, s38, 8
    s_add_u32 s32, s32, s33
    s_mul_i32 s32, s32, 131072
    s_lshl_b32 s33, s25, 12
    s_add_u32 s32, s32, s33
    s_mul_i32 s33, s37, 4096
    s_add_u32 s32, s32, s33
    s_add_u32 s21, s32, 0x800000
    s_mov_b32 s22, 131072
    s_mov_b32 s26, -1
    s_branch main_kernel_w_c2_go
main_kernel_w_c2_set1:
    s_lshl_b32 s32, s25, 8
    s_add_u32 s8, s42, s32
    s_addc_u32 s9, s43, 0
    s_and_b32 s9, s9, 0xffff
    s_sub_u32 s10, 0x800000, s32
    s_mov_b32 s11, 0x20000
    s_mov_b32 s30, 8192
    s_mov_b32 s31, 32768
    s_mul_i32 s16, s24, 262144
    s_add_u32 s16, s16, 0x0
    s_mov_b32 s18, 7
    s_lshl_b32 s32, s24, 3
    s_mul_i32 s33, s38, 8
    s_add_u32 s32, s32, s33
    s_mul_i32 s32, s32, 131072
    s_lshl_b32 s33, s25, 12
    s_add_u32 s32, s32, s33
    s_mul_i32 s33, s37, 4096
    s_add_u32 s32, s32, s33
    s_add_u32 s21, s32, 0x1800000
    s_mov_b32 s22, 131072
    s_mov_b32 s26, -1
    s_branch main_kernel_w_c2_go
main_kernel_w_c2_set2:
    s_lshl_b32 s32, s25, 8
    s_add_u32 s8, s44, s32
    s_addc_u32 s9, s45, 0
    s_and_b32 s9, s9, 0xffff
    s_sub_u32 s10, 0x800000, s32
    s_mov_b32 s11, 0x20000
    s_mov_b32 s30, 8192
    s_mov_b32 s31, 32768
    s_mul_i32 s16, s24, 262144
    s_add_u32 s16, s16, 0x0
    s_mov_b32 s18, 7
    s_lshl_b32 s32, s24, 2
    s_mul_i32 s33, s38, 4
    s_add_u32 s32, s32, s33
    s_lshl_b32 s32, s32, 18
    s_lshl_b32 s33, s25, 13
    s_add_u32 s32, s32, s33
    s_mul_i32 s33, s37, 8192
    s_add_u32 s32, s32, s33
    s_add_u32 s21, s32, 0x2800000
    s_branch main_kernel_w_c2_gov
main_kernel_w_c2_set6:
    s_lshl_b32 s32, s25, 8
    s_add_u32 s8, s68, s32
    s_addc_u32 s9, s69, 0
    s_and_b32 s9, s9, 0xffff
    s_sub_u32 s10, 0x700000, s32
    s_mov_b32 s11, 0x20000
    s_mov_b32 s30, 7168
    s_mov_b32 s31, 32768
    s_mul_i32 s16, s24, 262144
    s_add_u32 s16, s16, 0x6800000
    s_mov_b32 s18, 7
    s_lshl_b32 s32, s24, 3
    s_mul_i32 s33, s38, 8
    s_add_u32 s32, s32, s33
    s_mul_i32 s32, s32, 114688
    s_lshl_b32 s33, s25, 12
    s_add_u32 s32, s32, s33
    s_mul_i32 s33, s37, 4096
    s_add_u32 s32, s32, s33
    s_add_u32 s21, s32, 0x5400000
    s_mov_b32 s22, 114688
    s_mov_b32 s26, -1
    s_branch main_kernel_w_c2_go
main_kernel_w_c2_go:
    v_lshrrev_b32 v0, 4, v250
    v_bfe_u32 v1, v250, 2, 2
    v_lshl_add_u32 v4, v0, 2, v1
    v_and_b32 v5, 7, v4
    v_mul_u32_u24 v4, 512, v4
    v_and_b32 v6, 3, v250
    v_lshl_add_u32 v4, v6, 3, v4
    s_mul_i32 s32, s37, 8
    v_xor_b32 v5, s32, v5
    v_lshl_add_u32 v128, v5, 5, v4
    v_xor_b32 v129, 32, v128
    v_xor_b32 v130, 64, v128
    v_xor_b32 v131, 96, v128
    v_xor_b32 v132, 128, v128
    v_xor_b32 v133, 160, v128
    v_xor_b32 v134, 192, v128
    v_xor_b32 v135, 224, v128
    s_mul_i32 s32, s38, 8192
    s_add_u32 s32, s32, 65536
    v_add_u32 v136, s32, v251
    v_lshrrev_b32 v2, 5, v250
    v_and_b32 v3, 31, v250
    s_mul_i32 s32, s14, 8
    v_add_u32 v4, s32, v2
    v_add_u32 v5, 0, v4
    v_and_b32 v6, 7, v5
    v_lshlrev_b32 v6, 1, v6
    v_xor_b32 v6, v6, v3
    v_mul_lo_u32 v5, v5, s30
    v_lshl_add_u32 v5, v6, 4, v5
    v_subrev_u32 v137, 0, v5
    v_add_u32 v5, 2, v4
    v_and_b32 v6, 7, v5
    v_lshlrev_b32 v6, 1, v6
    v_xor_b32 v6, v6, v3
    v_mul_lo_u32 v5, v5, s30
    v_lshl_add_u32 v5, v6, 4, v5
    v_subrev_u32 v138, 1024, v5
    v_add_u32 v5, 4, v4
    v_and_b32 v6, 7, v5
    v_lshlrev_b32 v6, 1, v6
    v_xor_b32 v6, v6, v3
    v_mul_lo_u32 v5, v5, s30
    v_lshl_add_u32 v5, v6, 4, v5
    v_subrev_u32 v139, 2048, v5
    v_add_u32 v5, 6, v4
    v_and_b32 v6, 7, v5
    v_lshlrev_b32 v6, 1, v6
    v_xor_b32 v6, v6, v3
    v_mul_lo_u32 v5, v5, s30
    v_lshl_add_u32 v5, v6, 4, v5
    v_subrev_u32 v140, 3072, v5
    s_mul_i32 s32, s14, 4
    s_mul_i32 s32, s32, s31
    v_add_u32 v141, s32, v251
    s_add_u32 s32, s32, s31
    s_sub_u32 s32, s32, 1024
    v_add_u32 v142, s32, v251
    s_add_u32 s32, s32, s31
    s_sub_u32 s32, s32, 1024
    v_add_u32 v143, s32, v251
    s_add_u32 s32, s32, s31
    s_sub_u32 s32, s32, 1024
    v_add_u32 v144, s32, v251
    s_mul_i32 s19, s14, 4096
    s_mul_i32 s20, s14, 4096
    s_add_u32 s20, s20, 65536
    s_mul_i32 s17, s30, 32
    s_mov_b32 s15, 0
    s_add_u32 m0, s20, 0
    s_nop 0
    buffer_load_dwordx4 v141, s[4:7], s16 offen offset:0 sc1 lds
    buffer_load_dwordx4 v142, s[4:7], s16 offen offset:1024 sc1 lds
    buffer_load_dwordx4 v143, s[4:7], s16 offen offset:2048 sc1 lds
    buffer_load_dwordx4 v144, s[4:7], s16 offen offset:3072 sc1 lds
    s_add_u32 s16, s16, 1024
    s_add_u32 m0, s19, 0
    s_nop 0
    buffer_load_dwordx4 v137, s[8:11], s15 offen offset:0 lds
    buffer_load_dwordx4 v138, s[8:11], s15 offen offset:1024 lds
    buffer_load_dwordx4 v139, s[8:11], s15 offen offset:2048 lds
    buffer_load_dwordx4 v140, s[8:11], s15 offen offset:3072 lds
    s_add_u32 s15, s15, s17
    s_add_u32 m0, s20, 16384
    s_nop 0
    buffer_load_dwordx4 v141, s[4:7], s16 offen offset:0 sc1 lds
    buffer_load_dwordx4 v142, s[4:7], s16 offen offset:1024 sc1 lds
    buffer_load_dwordx4 v143, s[4:7], s16 offen offset:2048 sc1 lds
    buffer_load_dwordx4 v144, s[4:7], s16 offen offset:3072 sc1 lds
    s_add_u32 s16, s16, 1024
    s_add_u32 m0, s19, 16384
    s_nop 0
    buffer_load_dwordx4 v137, s[8:11], s15 offen offset:0 lds
    buffer_load_dwordx4 v138, s[8:11], s15 offen offset:1024 lds
    buffer_load_dwordx4 v139, s[8:11], s15 offen offset:2048 lds
    buffer_load_dwordx4 v140, s[8:11], s15 offen offset:3072 lds
    s_add_u32 s15, s15, s17
    s_add_u32 m0, s20, 32768
    s_nop 0
    buffer_load_dwordx4 v141, s[4:7], s16 offen offset:0 sc1 lds
    buffer_load_dwordx4 v142, s[4:7], s16 offen offset:1024 sc1 lds
    buffer_load_dwordx4 v143, s[4:7], s16 offen offset:2048 sc1 lds
    buffer_load_dwordx4 v144, s[4:7], s16 offen offset:3072 sc1 lds
    s_add_u32 s16, s16, 1024
    s_add_u32 m0, s19, 32768
    s_nop 0
    buffer_load_dwordx4 v137, s[8:11], s15 offen offset:0 lds
    buffer_load_dwordx4 v138, s[8:11], s15 offen offset:1024 lds
    buffer_load_dwordx4 v139, s[8:11], s15 offen offset:2048 lds
    buffer_load_dwordx4 v140, s[8:11], s15 offen offset:3072 lds
    s_add_u32 s15, s15, s17
    s_add_u32 m0, s20, 49152
    s_nop 0
    buffer_load_dwordx4 v141, s[4:7], s16 offen offset:0 sc1 lds
    buffer_load_dwordx4 v142, s[4:7], s16 offen offset:1024 sc1 lds
    buffer_load_dwordx4 v143, s[4:7], s16 offen offset:2048 sc1 lds
    buffer_load_dwordx4 v144, s[4:7], s16 offen offset:3072 sc1 lds
    s_add_u32 s16, s16, 1024
    s_add_u32 m0, s19, 49152
    s_nop 0
    buffer_load_dwordx4 v137, s[8:11], s15 offen offset:0 lds
    buffer_load_dwordx4 v138, s[8:11], s15 offen offset:1024 lds
    buffer_load_dwordx4 v139, s[8:11], s15 offen offset:2048 lds
    buffer_load_dwordx4 v140, s[8:11], s15 offen offset:3072 lds
    s_add_u32 s15, s15, s17
    v_accvgpr_write_b32 a0, 0
    v_accvgpr_write_b32 a1, 0
    v_accvgpr_write_b32 a2, 0
    v_accvgpr_write_b32 a3, 0
    v_accvgpr_write_b32 a4, 0
    v_accvgpr_write_b32 a5, 0
    v_accvgpr_write_b32 a6, 0
    v_accvgpr_write_b32 a7, 0
    v_accvgpr_write_b32 a8, 0
    v_accvgpr_write_b32 a9, 0
    v_accvgpr_write_b32 a10, 0
    v_accvgpr_write_b32 a11, 0
    v_accvgpr_write_b32 a12, 0
    v_accvgpr_write_b32 a13, 0
    v_accvgpr_write_b32 a14, 0
    v_accvgpr_write_b32 a15, 0
    v_accvgpr_write_b32 a16, 0
    v_accvgpr_write_b32 a17, 0
    v_accvgpr_write_b32 a18, 0
    v_accvgpr_write_b32 a19, 0
    v_accvgpr_write_b32 a20, 0
    v_accvgpr_write_b32 a21, 0
    v_accvgpr_write_b32 a22, 0
    v_accvgpr_write_b32 a23, 0
    v_accvgpr_write_b32 a24, 0
    v_accvgpr_write_b32 a25, 0
    v_accvgpr_write_b32 a26, 0
    v_accvgpr_write_b32 a27, 0
    v_accvgpr_write_b32 a28, 0
    v_accvgpr_write_b32 a29, 0
    v_accvgpr_write_b32 a30, 0
    v_accvgpr_write_b32 a31, 0
    v_accvgpr_write_b32 a32, 0
    v_accvgpr_write_b32 a33, 0
    v_accvgpr_write_b32 a34, 0
    v_accvgpr_write_b32 a35, 0
    v_accvgpr_write_b32 a36, 0
    v_accvgpr_write_b32 a37, 0
    v_accvgpr_write_b32 a38, 0
    v_accvgpr_write_b32 a39, 0
    v_accvgpr_write_b32 a40, 0
    v_accvgpr_write_b32 a41, 0
    v_accvgpr_write_b32 a42, 0
    v_accvgpr_write_b32 a43, 0
    v_accvgpr_write_b32 a44, 0
    v_accvgpr_write_b32 a45, 0
    v_accvgpr_write_b32 a46, 0
    v_accvgpr_write_b32 a47, 0
    v_accvgpr_write_b32 a48, 0
    v_accvgpr_write_b32 a49, 0
    v_accvgpr_write_b32 a50, 0
    v_accvgpr_write_b32 a51, 0
    v_accvgpr_write_b32 a52, 0
    v_accvgpr_write_b32 a53, 0
    v_accvgpr_write_b32 a54, 0
    v_accvgpr_write_b32 a55, 0
    v_accvgpr_write_b32 a56, 0
    v_accvgpr_write_b32 a57, 0
    v_accvgpr_write_b32 a58, 0
    v_accvgpr_write_b32 a59, 0
    v_accvgpr_write_b32 a60, 0
    v_accvgpr_write_b32 a61, 0
    v_accvgpr_write_b32 a62, 0
    v_accvgpr_write_b32 a63, 0
    v_accvgpr_write_b32 a64, 0
    v_accvgpr_write_b32 a65, 0
    v_accvgpr_write_b32 a66, 0
    v_accvgpr_write_b32 a67, 0
    v_accvgpr_write_b32 a68, 0
    v_accvgpr_write_b32 a69, 0
    v_accvgpr_write_b32 a70, 0
    v_accvgpr_write_b32 a71, 0
    v_accvgpr_write_b32 a72, 0
    v_accvgpr_write_b32 a73, 0
    v_accvgpr_write_b32 a74, 0
    v_accvgpr_write_b32 a75, 0
    v_accvgpr_write_b32 a76, 0
    v_accvgpr_write_b32 a77, 0
    v_accvgpr_write_b32 a78, 0
    v_accvgpr_write_b32 a79, 0
    v_accvgpr_write_b32 a80, 0
    v_accvgpr_write_b32 a81, 0
    v_accvgpr_write_b32 a82, 0
    v_accvgpr_write_b32 a83, 0
    v_accvgpr_write_b32 a84, 0
    v_accvgpr_write_b32 a85, 0
    v_accvgpr_write_b32 a86, 0
    v_accvgpr_write_b32 a87, 0
    v_accvgpr_write_b32 a88, 0
    v_accvgpr_write_b32 a89, 0
    v_accvgpr_write_b32 a90, 0
    v_accvgpr_write_b32 a91, 0
    v_accvgpr_write_b32 a92, 0
    v_accvgpr_write_b32 a93, 0
    v_accvgpr_write_b32 a94, 0
    v_accvgpr_write_b32 a95, 0
    v_accvgpr_write_b32 a96, 0
    v_accvgpr_write_b32 a97, 0
    v_accvgpr_write_b32 a98, 0
    v_accvgpr_write_b32 a99, 0
    v_accvgpr_write_b32 a100, 0
    v_accvgpr_write_b32 a101, 0
    v_accvgpr_write_b32 a102, 0
    v_accvgpr_write_b32 a103, 0
    v_accvgpr_write_b32 a104, 0
    v_accvgpr_write_b32 a105, 0
    v_accvgpr_write_b32 a106, 0
    v_accvgpr_write_b32 a107, 0
    v_accvgpr_write_b32 a108, 0
    v_accvgpr_write_b32 a109, 0
    v_accvgpr_write_b32 a110, 0
    v_accvgpr_write_b32 a111, 0
    v_accvgpr_write_b32 a112, 0
    v_accvgpr_write_b32 a113, 0
    v_accvgpr_write_b32 a114, 0
    v_accvgpr_write_b32 a115, 0
    v_accvgpr_write_b32 a116, 0
    v_accvgpr_write_b32 a117, 0
    v_accvgpr_write_b32 a118, 0
    v_accvgpr_write_b32 a119, 0
    v_accvgpr_write_b32 a120, 0
    v_accvgpr_write_b32 a121, 0
    v_accvgpr_write_b32 a122, 0
    v_accvgpr_write_b32 a123, 0
    v_accvgpr_write_b32 a124, 0
    v_accvgpr_write_b32 a125, 0
    v_accvgpr_write_b32 a126, 0
    v_accvgpr_write_b32 a127, 0
    v_accvgpr_write_b32 a128, 0
    v_accvgpr_write_b32 a129, 0
    v_accvgpr_write_b32 a130, 0
    v_accvgpr_write_b32 a131, 0
    v_accvgpr_write_b32 a132, 0
    v_accvgpr_write_b32 a133, 0
    v_accvgpr_write_b32 a134, 0
    v_accvgpr_write_b32 a135, 0
    v_accvgpr_write_b32 a136, 0
    v_accvgpr_write_b32 a137, 0
    v_accvgpr_write_b32 a138, 0
    v_accvgpr_write_b32 a139, 0
    v_accvgpr_write_b32 a140, 0
    v_accvgpr_write_b32 a141, 0
    v_accvgpr_write_b32 a142, 0
    v_accvgpr_write_b32 a143, 0
    v_accvgpr_write_b32 a144, 0
    v_accvgpr_write_b32 a145, 0
    v_accvgpr_write_b32 a146, 0
    v_accvgpr_write_b32 a147, 0
    v_accvgpr_write_b32 a148, 0
    v_accvgpr_write_b32 a149, 0
    v_accvgpr_write_b32 a150, 0
    v_accvgpr_write_b32 a151, 0
    v_accvgpr_write_b32 a152, 0
    v_accvgpr_write_b32 a153, 0
    v_accvgpr_write_b32 a154, 0
    v_accvgpr_write_b32 a155, 0
    v_accvgpr_write_b32 a156, 0
    v_accvgpr_write_b32 a157, 0
    v_accvgpr_write_b32 a158, 0
    v_accvgpr_write_b32 a159, 0
    v_accvgpr_write_b32 a160, 0
    v_accvgpr_write_b32 a161, 0
    v_accvgpr_write_b32 a162, 0
    v_accvgpr_write_b32 a163, 0
    v_accvgpr_write_b32 a164, 0
    v_accvgpr_write_b32 a165, 0
    v_accvgpr_write_b32 a166, 0
    v_accvgpr_write_b32 a167, 0
    v_accvgpr_write_b32 a168, 0
    v_accvgpr_write_b32 a169, 0
    v_accvgpr_write_b32 a170, 0
    v_accvgpr_write_b32 a171, 0
    v_accvgpr_write_b32 a172, 0
    v_accvgpr_write_b32 a173, 0
    v_accvgpr_write_b32 a174, 0
    v_accvgpr_write_b32 a175, 0
    v_accvgpr_write_b32 a176, 0
    v_accvgpr_write_b32 a177, 0
    v_accvgpr_write_b32 a178, 0
    v_accvgpr_write_b32 a179, 0
    v_accvgpr_write_b32 a180, 0
    v_accvgpr_write_b32 a181, 0
    v_accvgpr_write_b32 a182, 0
    v_accvgpr_write_b32 a183, 0
    v_accvgpr_write_b32 a184, 0
    v_accvgpr_write_b32 a185, 0
    v_accvgpr_write_b32 a186, 0
    v_accvgpr_write_b32 a187, 0
    v_accvgpr_write_b32 a188, 0
    v_accvgpr_write_b32 a189, 0
    v_accvgpr_write_b32 a190, 0
    v_accvgpr_write_b32 a191, 0
    v_accvgpr_write_b32 a192, 0
    v_accvgpr_write_b32 a193, 0
    v_accvgpr_write_b32 a194, 0
    v_accvgpr_write_b32 a195, 0
    v_accvgpr_write_b32 a196, 0
    v_accvgpr_write_b32 a197, 0
    v_accvgpr_write_b32 a198, 0
    v_accvgpr_write_b32 a199, 0
    v_accvgpr_write_b32 a200, 0
    v_accvgpr_write_b32 a201, 0
    v_accvgpr_write_b32 a202, 0
    v_accvgpr_write_b32 a203, 0
    v_accvgpr_write_b32 a204, 0
    v_accvgpr_write_b32 a205, 0
    v_accvgpr_write_b32 a206, 0
    v_accvgpr_write_b32 a207, 0
    v_accvgpr_write_b32 a208, 0
    v_accvgpr_write_b32 a209, 0
    v_accvgpr_write_b32 a210, 0
    v_accvgpr_write_b32 a211, 0
    v_accvgpr_write_b32 a212, 0
    v_accvgpr_write_b32 a213, 0
    v_accvgpr_write_b32 a214, 0
    v_accvgpr_write_b32 a215, 0
    v_accvgpr_write_b32 a216, 0
    v_accvgpr_write_b32 a217, 0
    v_accvgpr_write_b32 a218, 0
    v_accvgpr_write_b32 a219, 0
    v_accvgpr_write_b32 a220, 0
    v_accvgpr_write_b32 a221, 0
    v_accvgpr_write_b32 a222, 0
    v_accvgpr_write_b32 a223, 0
    v_accvgpr_write_b32 a224, 0
    v_accvgpr_write_b32 a225, 0
    v_accvgpr_write_b32 a226, 0
    v_accvgpr_write_b32 a227, 0
    v_accvgpr_write_b32 a228, 0
    v_accvgpr_write_b32 a229, 0
    v_accvgpr_write_b32 a230, 0
    v_accvgpr_write_b32 a231, 0
    v_accvgpr_write_b32 a232, 0
    v_accvgpr_write_b32 a233, 0
    v_accvgpr_write_b32 a234, 0
    v_accvgpr_write_b32 a235, 0
    v_accvgpr_write_b32 a236, 0
    v_accvgpr_write_b32 a237, 0
    v_accvgpr_write_b32 a238, 0
    v_accvgpr_write_b32 a239, 0
    v_accvgpr_write_b32 a240, 0
    v_accvgpr_write_b32 a241, 0
    v_accvgpr_write_b32 a242, 0
    v_accvgpr_write_b32 a243, 0
    v_accvgpr_write_b32 a244, 0
    v_accvgpr_write_b32 a245, 0
    v_accvgpr_write_b32 a246, 0
    v_accvgpr_write_b32 a247, 0
    v_accvgpr_write_b32 a248, 0
    v_accvgpr_write_b32 a249, 0
    v_accvgpr_write_b32 a250, 0
    v_accvgpr_write_b32 a251, 0
    v_accvgpr_write_b32 a252, 0
    v_accvgpr_write_b32 a253, 0
    v_accvgpr_write_b32 a254, 0
    v_accvgpr_write_b32 a255, 0
    s_waitcnt vmcnt(24)
    s_barrier
    ds_read_b128 v[32:35], v136 offset:0
    ds_read_b64_tr_b16 v[0:1], v128 offset:0
    ds_read_b64_tr_b16 v[2:3], v128 offset:8192
    ds_read_b64_tr_b16 v[4:5], v129 offset:0
    ds_read_b64_tr_b16 v[6:7], v129 offset:8192
    ds_read_b64_tr_b16 v[8:9], v130 offset:0
    ds_read_b64_tr_b16 v[10:11], v130 offset:8192
    ds_read_b64_tr_b16 v[12:13], v131 offset:0
    ds_read_b64_tr_b16 v[14:15], v131 offset:8192
    ds_read_b64_tr_b16 v[16:17], v132 offset:0
    ds_read_b64_tr_b16 v[18:19], v132 offset:8192
    ds_read_b64_tr_b16 v[20:21], v133 offset:0
    ds_read_b64_tr_b16 v[22:23], v133 offset:8192
    ds_read_b64_tr_b16 v[24:25], v134 offset:0
    ds_read_b64_tr_b16 v[26:27], v134 offset:8192
    ds_read_b64_tr_b16 v[28:29], v135 offset:0
    ds_read_b64_tr_b16 v[30:31], v135 offset:8192
    ds_read_b128 v[36:39], v136 offset:1024
    ds_read_b128 v[40:43], v136 offset:2048
    ds_read_b128 v[44:47], v136 offset:3072
    ds_read_b128 v[48:51], v136 offset:4096
    ds_read_b128 v[52:55], v136 offset:5120
    ds_read_b128 v[56:59], v136 offset:6144
    ds_read_b128 v[60:63], v136 offset:7168
main_kernel_w_c2_n_loop:
    s_waitcnt lgkmcnt(0)
    v_mfma_f32_16x16x32_bf16 a[0:3], v[0:3], v[32:35], a[0:3]
    s_waitcnt vmcnt(16)
    s_barrier
    ds_read_b128 v[96:99], v136 offset:16384
    s_add_u32 m0, s20, 0
    s_nop 0
    v_mfma_f32_16x16x32_bf16 a[4:7], v[4:7], v[32:35], a[4:7]
    ds_read_b64_tr_b16 v[64:65], v128 offset:16384
    v_mfma_f32_16x16x32_bf16 a[8:11], v[8:11], v[32:35], a[8:11]
    ds_read_b64_tr_b16 v[66:67], v128 offset:24576
    v_mfma_f32_16x16x32_bf16 a[12:15], v[12:15], v[32:35], a[12:15]
    ds_read_b64_tr_b16 v[68:69], v129 offset:16384
    v_mfma_f32_16x16x32_bf16 a[16:19], v[16:19], v[32:35], a[16:19]
    ds_read_b64_tr_b16 v[70:71], v129 offset:24576
    v_mfma_f32_16x16x32_bf16 a[20:23], v[20:23], v[32:35], a[20:23]
    ds_read_b64_tr_b16 v[72:73], v130 offset:16384
    buffer_load_dwordx4 v141, s[4:7], s16 offen offset:0 sc1 lds
    v_mfma_f32_16x16x32_bf16 a[24:27], v[24:27], v[32:35], a[24:27]
    ds_read_b64_tr_b16 v[74:75], v130 offset:24576
    v_mfma_f32_16x16x32_bf16 a[28:31], v[28:31], v[32:35], a[28:31]
    ds_read_b64_tr_b16 v[76:77], v131 offset:16384
    v_mfma_f32_16x16x32_bf16 a[32:35], v[0:3], v[36:39], a[32:35]
    ds_read_b64_tr_b16 v[78:79], v131 offset:24576
    v_mfma_f32_16x16x32_bf16 a[36:39], v[4:7], v[36:39], a[36:39]
    ds_read_b64_tr_b16 v[80:81], v132 offset:16384
    v_mfma_f32_16x16x32_bf16 a[40:43], v[8:11], v[36:39], a[40:43]
    ds_read_b64_tr_b16 v[82:83], v132 offset:24576
    buffer_load_dwordx4 v142, s[4:7], s16 offen offset:1024 sc1 lds
    v_mfma_f32_16x16x32_bf16 a[44:47], v[12:15], v[36:39], a[44:47]
    ds_read_b64_tr_b16 v[84:85], v133 offset:16384
    v_mfma_f32_16x16x32_bf16 a[48:51], v[16:19], v[36:39], a[48:51]
    ds_read_b64_tr_b16 v[86:87], v133 offset:24576
    v_mfma_f32_16x16x32_bf16 a[52:55], v[20:23], v[36:39], a[52:55]
    ds_read_b64_tr_b16 v[88:89], v134 offset:16384
    v_mfma_f32_16x16x32_bf16 a[56:59], v[24:27], v[36:39], a[56:59]
    ds_read_b64_tr_b16 v[90:91], v134 offset:24576
    v_mfma_f32_16x16x32_bf16 a[60:63], v[28:31], v[36:39], a[60:63]
    ds_read_b64_tr_b16 v[92:93], v135 offset:16384
    buffer_load_dwordx4 v143, s[4:7], s16 offen offset:2048 sc1 lds
    v_mfma_f32_16x16x32_bf16 a[64:67], v[0:3], v[40:43], a[64:67]
    ds_read_b64_tr_b16 v[94:95], v135 offset:24576
    v_mfma_f32_16x16x32_bf16 a[68:71], v[4:7], v[40:43], a[68:71]
    ds_read_b128 v[100:103], v136 offset:17408
    v_mfma_f32_16x16x32_bf16 a[72:75], v[8:11], v[40:43], a[72:75]
    ds_read_b128 v[104:107], v136 offset:18432
    v_mfma_f32_16x16x32_bf16 a[76:79], v[12:15], v[40:43], a[76:79]
    ds_read_b128 v[108:111], v136 offset:19456
    v_mfma_f32_16x16x32_bf16 a[80:83], v[16:19], v[40:43], a[80:83]
    ds_read_b128 v[112:115], v136 offset:20480
    v_mfma_f32_16x16x32_bf16 a[84:87], v[20:23], v[40:43], a[84:87]
    ds_read_b128 v[116:119], v136 offset:21504
    buffer_load_dwordx4 v144, s[4:7], s16 offen offset:3072 sc1 lds
    v_mfma_f32_16x16x32_bf16 a[88:91], v[24:27], v[40:43], a[88:91]
    ds_read_b128 v[120:123], v136 offset:22528
    v_mfma_f32_16x16x32_bf16 a[92:95], v[28:31], v[40:43], a[92:95]
    ds_read_b128 v[124:127], v136 offset:23552
    v_mfma_f32_16x16x32_bf16 a[96:99], v[0:3], v[44:47], a[96:99]
    v_mfma_f32_16x16x32_bf16 a[100:103], v[4:7], v[44:47], a[100:103]
    v_mfma_f32_16x16x32_bf16 a[104:107], v[8:11], v[44:47], a[104:107]
    s_add_u32 s16, s16, 1024
    v_mfma_f32_16x16x32_bf16 a[108:111], v[12:15], v[44:47], a[108:111]
    v_mfma_f32_16x16x32_bf16 a[112:115], v[16:19], v[44:47], a[112:115]
    v_mfma_f32_16x16x32_bf16 a[116:119], v[20:23], v[44:47], a[116:119]
    v_mfma_f32_16x16x32_bf16 a[120:123], v[24:27], v[44:47], a[120:123]
    v_mfma_f32_16x16x32_bf16 a[124:127], v[28:31], v[44:47], a[124:127]
    s_add_u32 m0, s19, 0
    s_nop 0
    v_mfma_f32_16x16x32_bf16 a[128:131], v[0:3], v[48:51], a[128:131]
    v_mfma_f32_16x16x32_bf16 a[132:135], v[4:7], v[48:51], a[132:135]
    v_mfma_f32_16x16x32_bf16 a[136:139], v[8:11], v[48:51], a[136:139]
    v_mfma_f32_16x16x32_bf16 a[140:143], v[12:15], v[48:51], a[140:143]
    v_mfma_f32_16x16x32_bf16 a[144:147], v[16:19], v[48:51], a[144:147]
    buffer_load_dwordx4 v137, s[8:11], s15 offen offset:0 lds
    v_mfma_f32_16x16x32_bf16 a[148:151], v[20:23], v[48:51], a[148:151]
    v_mfma_f32_16x16x32_bf16 a[152:155], v[24:27], v[48:51], a[152:155]
    v_mfma_f32_16x16x32_bf16 a[156:159], v[28:31], v[48:51], a[156:159]
    v_mfma_f32_16x16x32_bf16 a[160:163], v[0:3], v[52:55], a[160:163]
    v_mfma_f32_16x16x32_bf16 a[164:167], v[4:7], v[52:55], a[164:167]
    v_mfma_f32_16x16x32_bf16 a[168:171], v[8:11], v[52:55], a[168:171]
    buffer_load_dwordx4 v138, s[8:11], s15 offen offset:1024 lds
    v_mfma_f32_16x16x32_bf16 a[172:175], v[12:15], v[52:55], a[172:175]
    v_mfma_f32_16x16x32_bf16 a[176:179], v[16:19], v[52:55], a[176:179]
    v_mfma_f32_16x16x32_bf16 a[180:183], v[20:23], v[52:55], a[180:183]
    v_mfma_f32_16x16x32_bf16 a[184:187], v[24:27], v[52:55], a[184:187]
    v_mfma_f32_16x16x32_bf16 a[188:191], v[28:31], v[52:55], a[188:191]
    buffer_load_dwordx4 v139, s[8:11], s15 offen offset:2048 lds
    v_mfma_f32_16x16x32_bf16 a[192:195], v[0:3], v[56:59], a[192:195]
    v_mfma_f32_16x16x32_bf16 a[196:199], v[4:7], v[56:59], a[196:199]
    v_mfma_f32_16x16x32_bf16 a[200:203], v[8:11], v[56:59], a[200:203]
    v_mfma_f32_16x16x32_bf16 a[204:207], v[12:15], v[56:59], a[204:207]
    v_mfma_f32_16x16x32_bf16 a[208:211], v[16:19], v[56:59], a[208:211]
    buffer_load_dwordx4 v140, s[8:11], s15 offen offset:3072 lds
    v_mfma_f32_16x16x32_bf16 a[212:215], v[20:23], v[56:59], a[212:215]
    v_mfma_f32_16x16x32_bf16 a[216:219], v[24:27], v[56:59], a[216:219]
    v_mfma_f32_16x16x32_bf16 a[220:223], v[28:31], v[56:59], a[220:223]
    v_mfma_f32_16x16x32_bf16 a[224:227], v[0:3], v[60:63], a[224:227]
    v_mfma_f32_16x16x32_bf16 a[228:231], v[4:7], v[60:63], a[228:231]
    s_add_u32 s15, s15, s17
    v_mfma_f32_16x16x32_bf16 a[232:235], v[8:11], v[60:63], a[232:235]
    v_mfma_f32_16x16x32_bf16 a[236:239], v[12:15], v[60:63], a[236:239]
    v_mfma_f32_16x16x32_bf16 a[240:243], v[16:19], v[60:63], a[240:243]
    v_mfma_f32_16x16x32_bf16 a[244:247], v[20:23], v[60:63], a[244:247]
    v_mfma_f32_16x16x32_bf16 a[248:251], v[24:27], v[60:63], a[248:251]
    v_mfma_f32_16x16x32_bf16 a[252:255], v[28:31], v[60:63], a[252:255]
    s_waitcnt lgkmcnt(0)
    v_mfma_f32_16x16x32_bf16 a[0:3], v[64:67], v[96:99], a[0:3]
    s_waitcnt vmcnt(16)
    s_barrier
    ds_read_b128 v[32:35], v136 offset:32768
    s_add_u32 m0, s20, 16384
    s_nop 0
    v_mfma_f32_16x16x32_bf16 a[4:7], v[68:71], v[96:99], a[4:7]
    ds_read_b64_tr_b16 v[0:1], v128 offset:32768
    v_mfma_f32_16x16x32_bf16 a[8:11], v[72:75], v[96:99], a[8:11]
    ds_read_b64_tr_b16 v[2:3], v128 offset:40960
    v_mfma_f32_16x16x32_bf16 a[12:15], v[76:79], v[96:99], a[12:15]
    ds_read_b64_tr_b16 v[4:5], v129 offset:32768
    v_mfma_f32_16x16x32_bf16 a[16:19], v[80:83], v[96:99], a[16:19]
    ds_read_b64_tr_b16 v[6:7], v129 offset:40960
    v_mfma_f32_16x16x32_bf16 a[20:23], v[84:87], v[96:99], a[20:23]
    ds_read_b64_tr_b16 v[8:9], v130 offset:32768
    buffer_load_dwordx4 v141, s[4:7], s16 offen offset:0 sc1 lds
    v_mfma_f32_16x16x32_bf16 a[24:27], v[88:91], v[96:99], a[24:27]
    ds_read_b64_tr_b16 v[10:11], v130 offset:40960
    v_mfma_f32_16x16x32_bf16 a[28:31], v[92:95], v[96:99], a[28:31]
    ds_read_b64_tr_b16 v[12:13], v131 offset:32768
    v_mfma_f32_16x16x32_bf16 a[32:35], v[64:67], v[100:103], a[32:35]
    ds_read_b64_tr_b16 v[14:15], v131 offset:40960
    v_mfma_f32_16x16x32_bf16 a[36:39], v[68:71], v[100:103], a[36:39]
    ds_read_b64_tr_b16 v[16:17], v132 offset:32768
    v_mfma_f32_16x16x32_bf16 a[40:43], v[72:75], v[100:103], a[40:43]
    ds_read_b64_tr_b16 v[18:19], v132 offset:40960
    buffer_load_dwordx4 v142, s[4:7], s16 offen offset:1024 sc1 lds
    v_mfma_f32_16x16x32_bf16 a[44:47], v[76:79], v[100:103], a[44:47]
    ds_read_b64_tr_b16 v[20:21], v133 offset:32768
    v_mfma_f32_16x16x32_bf16 a[48:51], v[80:83], v[100:103], a[48:51]
    ds_read_b64_tr_b16 v[22:23], v133 offset:40960
    v_mfma_f32_16x16x32_bf16 a[52:55], v[84:87], v[100:103], a[52:55]
    ds_read_b64_tr_b16 v[24:25], v134 offset:32768
    v_mfma_f32_16x16x32_bf16 a[56:59], v[88:91], v[100:103], a[56:59]
    ds_read_b64_tr_b16 v[26:27], v134 offset:40960
    v_mfma_f32_16x16x32_bf16 a[60:63], v[92:95], v[100:103], a[60:63]
    ds_read_b64_tr_b16 v[28:29], v135 offset:32768
    buffer_load_dwordx4 v143, s[4:7], s16 offen offset:2048 sc1 lds
    v_mfma_f32_16x16x32_bf16 a[64:67], v[64:67], v[104:107], a[64:67]
    ds_read_b64_tr_b16 v[30:31], v135 offset:40960
    v_mfma_f32_16x16x32_bf16 a[68:71], v[68:71], v[104:107], a[68:71]
    ds_read_b128 v[36:39], v136 offset:33792
    v_mfma_f32_16x16x32_bf16 a[72:75], v[72:75], v[104:107], a[72:75]
    ds_read_b128 v[40:43], v136 offset:34816
    v_mfma_f32_16x16x32_bf16 a[76:79], v[76:79], v[104:107], a[76:79]
    ds_read_b128 v[44:47], v136 offset:35840
    v_mfma_f32_16x16x32_bf16 a[80:83], v[80:83], v[104:107], a[80:83]
    ds_read_b128 v[48:51], v136 offset:36864
    v_mfma_f32_16x16x32_bf16 a[84:87], v[84:87], v[104:107], a[84:87]
    ds_read_b128 v[52:55], v136 offset:37888
    buffer_load_dwordx4 v144, s[4:7], s16 offen offset:3072 sc1 lds
    v_mfma_f32_16x16x32_bf16 a[88:91], v[88:91], v[104:107], a[88:91]
    ds_read_b128 v[56:59], v136 offset:38912
    v_mfma_f32_16x16x32_bf16 a[92:95], v[92:95], v[104:107], a[92:95]
    ds_read_b128 v[60:63], v136 offset:39936
    v_mfma_f32_16x16x32_bf16 a[96:99], v[64:67], v[108:111], a[96:99]
    v_mfma_f32_16x16x32_bf16 a[100:103], v[68:71], v[108:111], a[100:103]
    v_mfma_f32_16x16x32_bf16 a[104:107], v[72:75], v[108:111], a[104:107]
    s_add_u32 s16, s16, 1024
    v_mfma_f32_16x16x32_bf16 a[108:111], v[76:79], v[108:111], a[108:111]
    v_mfma_f32_16x16x32_bf16 a[112:115], v[80:83], v[108:111], a[112:115]
    v_mfma_f32_16x16x32_bf16 a[116:119], v[84:87], v[108:111], a[116:119]
    v_mfma_f32_16x16x32_bf16 a[120:123], v[88:91], v[108:111], a[120:123]
    v_mfma_f32_16x16x32_bf16 a[124:127], v[92:95], v[108:111], a[124:127]
    s_add_u32 m0, s19, 16384
    s_nop 0
    v_mfma_f32_16x16x32_bf16 a[128:131], v[64:67], v[112:115], a[128:131]
    v_mfma_f32_16x16x32_bf16 a[132:135], v[68:71], v[112:115], a[132:135]
    v_mfma_f32_16x16x32_bf16 a[136:139], v[72:75], v[112:115], a[136:139]
    v_mfma_f32_16x16x32_bf16 a[140:143], v[76:79], v[112:115], a[140:143]
    v_mfma_f32_16x16x32_bf16 a[144:147], v[80:83], v[112:115], a[144:147]
    buffer_load_dwordx4 v137, s[8:11], s15 offen offset:0 lds
    v_mfma_f32_16x16x32_bf16 a[148:151], v[84:87], v[112:115], a[148:151]
    v_mfma_f32_16x16x32_bf16 a[152:155], v[88:91], v[112:115], a[152:155]
    v_mfma_f32_16x16x32_bf16 a[156:159], v[92:95], v[112:115], a[156:159]
    v_mfma_f32_16x16x32_bf16 a[160:163], v[64:67], v[116:119], a[160:163]
    v_mfma_f32_16x16x32_bf16 a[164:167], v[68:71], v[116:119], a[164:167]
    v_mfma_f32_16x16x32_bf16 a[168:171], v[72:75], v[116:119], a[168:171]
    buffer_load_dwordx4 v138, s[8:11], s15 offen offset:1024 lds
    v_mfma_f32_16x16x32_bf16 a[172:175], v[76:79], v[116:119], a[172:175]
    v_mfma_f32_16x16x32_bf16 a[176:179], v[80:83], v[116:119], a[176:179]
    v_mfma_f32_16x16x32_bf16 a[180:183], v[84:87], v[116:119], a[180:183]
    v_mfma_f32_16x16x32_bf16 a[184:187], v[88:91], v[116:119], a[184:187]
    v_mfma_f32_16x16x32_bf16 a[188:191], v[92:95], v[116:119], a[188:191]
    buffer_load_dwordx4 v139, s[8:11], s15 offen offset:2048 lds
    v_mfma_f32_16x16x32_bf16 a[192:195], v[64:67], v[120:123], a[192:195]
    v_mfma_f32_16x16x32_bf16 a[196:199], v[68:71], v[120:123], a[196:199]
    v_mfma_f32_16x16x32_bf16 a[200:203], v[72:75], v[120:123], a[200:203]
    v_mfma_f32_16x16x32_bf16 a[204:207], v[76:79], v[120:123], a[204:207]
    v_mfma_f32_16x16x32_bf16 a[208:211], v[80:83], v[120:123], a[208:211]
    buffer_load_dwordx4 v140, s[8:11], s15 offen offset:3072 lds
    v_mfma_f32_16x16x32_bf16 a[212:215], v[84:87], v[120:123], a[212:215]
    v_mfma_f32_16x16x32_bf16 a[216:219], v[88:91], v[120:123], a[216:219]
    v_mfma_f32_16x16x32_bf16 a[220:223], v[92:95], v[120:123], a[220:223]
    v_mfma_f32_16x16x32_bf16 a[224:227], v[64:67], v[124:127], a[224:227]
    v_mfma_f32_16x16x32_bf16 a[228:231], v[68:71], v[124:127], a[228:231]
    s_add_u32 s15, s15, s17
    v_mfma_f32_16x16x32_bf16 a[232:235], v[72:75], v[124:127], a[232:235]
    v_mfma_f32_16x16x32_bf16 a[236:239], v[76:79], v[124:127], a[236:239]
    v_mfma_f32_16x16x32_bf16 a[240:243], v[80:83], v[124:127], a[240:243]
    v_mfma_f32_16x16x32_bf16 a[244:247], v[84:87], v[124:127], a[244:247]
    v_mfma_f32_16x16x32_bf16 a[248:251], v[88:91], v[124:127], a[248:251]
    v_mfma_f32_16x16x32_bf16 a[252:255], v[92:95], v[124:127], a[252:255]
    s_waitcnt lgkmcnt(0)
    v_mfma_f32_16x16x32_bf16 a[0:3], v[0:3], v[32:35], a[0:3]
    s_waitcnt vmcnt(16)
    s_barrier
    ds_read_b128 v[96:99], v136 offset:49152
    s_add_u32 m0, s20, 32768
    s_nop 0
    v_mfma_f32_16x16x32_bf16 a[4:7], v[4:7], v[32:35], a[4:7]
    ds_read_b64_tr_b16 v[64:65], v128 offset:49152
    v_mfma_f32_16x16x32_bf16 a[8:11], v[8:11], v[32:35], a[8:11]
    ds_read_b64_tr_b16 v[66:67], v128 offset:57344
    v_mfma_f32_16x16x32_bf16 a[12:15], v[12:15], v[32:35], a[12:15]
    ds_read_b64_tr_b16 v[68:69], v129 offset:49152
    v_mfma_f32_16x16x32_bf16 a[16:19], v[16:19], v[32:35], a[16:19]
    ds_read_b64_tr_b16 v[70:71], v129 offset:57344
    v_mfma_f32_16x16x32_bf16 a[20:23], v[20:23], v[32:35], a[20:23]
    ds_read_b64_tr_b16 v[72:73], v130 offset:49152
    buffer_load_dwordx4 v141, s[4:7], s16 offen offset:0 sc1 lds
    v_mfma_f32_16x16x32_bf16 a[24:27], v[24:27], v[32:35], a[24:27]
    ds_read_b64_tr_b16 v[74:75], v130 offset:57344
    v_mfma_f32_16x16x32_bf16 a[28:31], v[28:31], v[32:35], a[28:31]
    ds_read_b64_tr_b16 v[76:77], v131 offset:49152
    v_mfma_f32_16x16x32_bf16 a[32:35], v[0:3], v[36:39], a[32:35]
    ds_read_b64_tr_b16 v[78:79], v131 offset:57344
    v_mfma_f32_16x16x32_bf16 a[36:39], v[4:7], v[36:39], a[36:39]
    ds_read_b64_tr_b16 v[80:81], v132 offset:49152
    v_mfma_f32_16x16x32_bf16 a[40:43], v[8:11], v[36:39], a[40:43]
    ds_read_b64_tr_b16 v[82:83], v132 offset:57344
    buffer_load_dwordx4 v142, s[4:7], s16 offen offset:1024 sc1 lds
    v_mfma_f32_16x16x32_bf16 a[44:47], v[12:15], v[36:39], a[44:47]
    ds_read_b64_tr_b16 v[84:85], v133 offset:49152
    v_mfma_f32_16x16x32_bf16 a[48:51], v[16:19], v[36:39], a[48:51]
    ds_read_b64_tr_b16 v[86:87], v133 offset:57344
    v_mfma_f32_16x16x32_bf16 a[52:55], v[20:23], v[36:39], a[52:55]
    ds_read_b64_tr_b16 v[88:89], v134 offset:49152
    v_mfma_f32_16x16x32_bf16 a[56:59], v[24:27], v[36:39], a[56:59]
    ds_read_b64_tr_b16 v[90:91], v134 offset:57344
    v_mfma_f32_16x16x32_bf16 a[60:63], v[28:31], v[36:39], a[60:63]
    ds_read_b64_tr_b16 v[92:93], v135 offset:49152
    buffer_load_dwordx4 v143, s[4:7], s16 offen offset:2048 sc1 lds
    v_mfma_f32_16x16x32_bf16 a[64:67], v[0:3], v[40:43], a[64:67]
    ds_read_b64_tr_b16 v[94:95], v135 offset:57344
    v_mfma_f32_16x16x32_bf16 a[68:71], v[4:7], v[40:43], a[68:71]
    ds_read_b128 v[100:103], v136 offset:50176
    v_mfma_f32_16x16x32_bf16 a[72:75], v[8:11], v[40:43], a[72:75]
    ds_read_b128 v[104:107], v136 offset:51200
    v_mfma_f32_16x16x32_bf16 a[76:79], v[12:15], v[40:43], a[76:79]
    ds_read_b128 v[108:111], v136 offset:52224
    v_mfma_f32_16x16x32_bf16 a[80:83], v[16:19], v[40:43], a[80:83]
    ds_read_b128 v[112:115], v136 offset:53248
    v_mfma_f32_16x16x32_bf16 a[84:87], v[20:23], v[40:43], a[84:87]
    ds_read_b128 v[116:119], v136 offset:54272
    buffer_load_dwordx4 v144, s[4:7], s16 offen offset:3072 sc1 lds
    v_mfma_f32_16x16x32_bf16 a[88:91], v[24:27], v[40:43], a[88:91]
    ds_read_b128 v[120:123], v136 offset:55296
    v_mfma_f32_16x16x32_bf16 a[92:95], v[28:31], v[40:43], a[92:95]
    ds_read_b128 v[124:127], v136 offset:56320
    v_mfma_f32_16x16x32_bf16 a[96:99], v[0:3], v[44:47], a[96:99]
    v_mfma_f32_16x16x32_bf16 a[100:103], v[4:7], v[44:47], a[100:103]
    v_mfma_f32_16x16x32_bf16 a[104:107], v[8:11], v[44:47], a[104:107]
    s_add_u32 s16, s16, 1024
    v_mfma_f32_16x16x32_bf16 a[108:111], v[12:15], v[44:47], a[108:111]
    v_mfma_f32_16x16x32_bf16 a[112:115], v[16:19], v[44:47], a[112:115]
    v_mfma_f32_16x16x32_bf16 a[116:119], v[20:23], v[44:47], a[116:119]
    v_mfma_f32_16x16x32_bf16 a[120:123], v[24:27], v[44:47], a[120:123]
    v_mfma_f32_16x16x32_bf16 a[124:127], v[28:31], v[44:47], a[124:127]
    s_add_u32 m0, s19, 32768
    s_nop 0
    v_mfma_f32_16x16x32_bf16 a[128:131], v[0:3], v[48:51], a[128:131]
    v_mfma_f32_16x16x32_bf16 a[132:135], v[4:7], v[48:51], a[132:135]
    v_mfma_f32_16x16x32_bf16 a[136:139], v[8:11], v[48:51], a[136:139]
    v_mfma_f32_16x16x32_bf16 a[140:143], v[12:15], v[48:51], a[140:143]
    v_mfma_f32_16x16x32_bf16 a[144:147], v[16:19], v[48:51], a[144:147]
    buffer_load_dwordx4 v137, s[8:11], s15 offen offset:0 lds
    v_mfma_f32_16x16x32_bf16 a[148:151], v[20:23], v[48:51], a[148:151]
    v_mfma_f32_16x16x32_bf16 a[152:155], v[24:27], v[48:51], a[152:155]
    v_mfma_f32_16x16x32_bf16 a[156:159], v[28:31], v[48:51], a[156:159]
    v_mfma_f32_16x16x32_bf16 a[160:163], v[0:3], v[52:55], a[160:163]
    v_mfma_f32_16x16x32_bf16 a[164:167], v[4:7], v[52:55], a[164:167]
    v_mfma_f32_16x16x32_bf16 a[168:171], v[8:11], v[52:55], a[168:171]
    buffer_load_dwordx4 v138, s[8:11], s15 offen offset:1024 lds
    v_mfma_f32_16x16x32_bf16 a[172:175], v[12:15], v[52:55], a[172:175]
    v_mfma_f32_16x16x32_bf16 a[176:179], v[16:19], v[52:55], a[176:179]
    v_mfma_f32_16x16x32_bf16 a[180:183], v[20:23], v[52:55], a[180:183]
    v_mfma_f32_16x16x32_bf16 a[184:187], v[24:27], v[52:55], a[184:187]
    v_mfma_f32_16x16x32_bf16 a[188:191], v[28:31], v[52:55], a[188:191]
    buffer_load_dwordx4 v139, s[8:11], s15 offen offset:2048 lds
    v_mfma_f32_16x16x32_bf16 a[192:195], v[0:3], v[56:59], a[192:195]
    v_mfma_f32_16x16x32_bf16 a[196:199], v[4:7], v[56:59], a[196:199]
    v_mfma_f32_16x16x32_bf16 a[200:203], v[8:11], v[56:59], a[200:203]
    v_mfma_f32_16x16x32_bf16 a[204:207], v[12:15], v[56:59], a[204:207]
    v_mfma_f32_16x16x32_bf16 a[208:211], v[16:19], v[56:59], a[208:211]
    buffer_load_dwordx4 v140, s[8:11], s15 offen offset:3072 lds
    v_mfma_f32_16x16x32_bf16 a[212:215], v[20:23], v[56:59], a[212:215]
    v_mfma_f32_16x16x32_bf16 a[216:219], v[24:27], v[56:59], a[216:219]
    v_mfma_f32_16x16x32_bf16 a[220:223], v[28:31], v[56:59], a[220:223]
    v_mfma_f32_16x16x32_bf16 a[224:227], v[0:3], v[60:63], a[224:227]
    v_mfma_f32_16x16x32_bf16 a[228:231], v[4:7], v[60:63], a[228:231]
    s_add_u32 s15, s15, s17
    v_mfma_f32_16x16x32_bf16 a[232:235], v[8:11], v[60:63], a[232:235]
    v_mfma_f32_16x16x32_bf16 a[236:239], v[12:15], v[60:63], a[236:239]
    v_mfma_f32_16x16x32_bf16 a[240:243], v[16:19], v[60:63], a[240:243]
    v_mfma_f32_16x16x32_bf16 a[244:247], v[20:23], v[60:63], a[244:247]
    v_mfma_f32_16x16x32_bf16 a[248:251], v[24:27], v[60:63], a[248:251]
    v_mfma_f32_16x16x32_bf16 a[252:255], v[28:31], v[60:63], a[252:255]
    s_waitcnt lgkmcnt(0)
    v_mfma_f32_16x16x32_bf16 a[0:3], v[64:67], v[96:99], a[0:3]
    s_waitcnt vmcnt(16)
    s_barrier
    ds_read_b128 v[32:35], v136 offset:0
    s_add_u32 m0, s20, 49152
    s_nop 0
    v_mfma_f32_16x16x32_bf16 a[4:7], v[68:71], v[96:99], a[4:7]
    ds_read_b64_tr_b16 v[0:1], v128 offset:0
    v_mfma_f32_16x16x32_bf16 a[8:11], v[72:75], v[96:99], a[8:11]
    ds_read_b64_tr_b16 v[2:3], v128 offset:8192
    v_mfma_f32_16x16x32_bf16 a[12:15], v[76:79], v[96:99], a[12:15]
    ds_read_b64_tr_b16 v[4:5], v129 offset:0
    v_mfma_f32_16x16x32_bf16 a[16:19], v[80:83], v[96:99], a[16:19]
    ds_read_b64_tr_b16 v[6:7], v129 offset:8192
    v_mfma_f32_16x16x32_bf16 a[20:23], v[84:87], v[96:99], a[20:23]
    ds_read_b64_tr_b16 v[8:9], v130 offset:0
    buffer_load_dwordx4 v141, s[4:7], s16 offen offset:0 sc1 lds
    v_mfma_f32_16x16x32_bf16 a[24:27], v[88:91], v[96:99], a[24:27]
    ds_read_b64_tr_b16 v[10:11], v130 offset:8192
    v_mfma_f32_16x16x32_bf16 a[28:31], v[92:95], v[96:99], a[28:31]
    ds_read_b64_tr_b16 v[12:13], v131 offset:0
    v_mfma_f32_16x16x32_bf16 a[32:35], v[64:67], v[100:103], a[32:35]
    ds_read_b64_tr_b16 v[14:15], v131 offset:8192
    v_mfma_f32_16x16x32_bf16 a[36:39], v[68:71], v[100:103], a[36:39]
    ds_read_b64_tr_b16 v[16:17], v132 offset:0
    v_mfma_f32_16x16x32_bf16 a[40:43], v[72:75], v[100:103], a[40:43]
    ds_read_b64_tr_b16 v[18:19], v132 offset:8192
    buffer_load_dwordx4 v142, s[4:7], s16 offen offset:1024 sc1 lds
    v_mfma_f32_16x16x32_bf16 a[44:47], v[76:79], v[100:103], a[44:47]
    ds_read_b64_tr_b16 v[20:21], v133 offset:0
    v_mfma_f32_16x16x32_bf16 a[48:51], v[80:83], v[100:103], a[48:51]
    ds_read_b64_tr_b16 v[22:23], v133 offset:8192
    v_mfma_f32_16x16x32_bf16 a[52:55], v[84:87], v[100:103], a[52:55]
    ds_read_b64_tr_b16 v[24:25], v134 offset:0
    v_mfma_f32_16x16x32_bf16 a[56:59], v[88:91], v[100:103], a[56:59]
    ds_read_b64_tr_b16 v[26:27], v134 offset:8192
    v_mfma_f32_16x16x32_bf16 a[60:63], v[92:95], v[100:103], a[60:63]
    ds_read_b64_tr_b16 v[28:29], v135 offset:0
    buffer_load_dwordx4 v143, s[4:7], s16 offen offset:2048 sc1 lds
    v_mfma_f32_16x16x32_bf16 a[64:67], v[64:67], v[104:107], a[64:67]
    ds_read_b64_tr_b16 v[30:31], v135 offset:8192
    v_mfma_f32_16x16x32_bf16 a[68:71], v[68:71], v[104:107], a[68:71]
    ds_read_b128 v[36:39], v136 offset:1024
    v_mfma_f32_16x16x32_bf16 a[72:75], v[72:75], v[104:107], a[72:75]
    ds_read_b128 v[40:43], v136 offset:2048
    v_mfma_f32_16x16x32_bf16 a[76:79], v[76:79], v[104:107], a[76:79]
    ds_read_b128 v[44:47], v136 offset:3072
    v_mfma_f32_16x16x32_bf16 a[80:83], v[80:83], v[104:107], a[80:83]
    ds_read_b128 v[48:51], v136 offset:4096
    v_mfma_f32_16x16x32_bf16 a[84:87], v[84:87], v[104:107], a[84:87]
    ds_read_b128 v[52:55], v136 offset:5120
    buffer_load_dwordx4 v144, s[4:7], s16 offen offset:3072 sc1 lds
    v_mfma_f32_16x16x32_bf16 a[88:91], v[88:91], v[104:107], a[88:91]
    ds_read_b128 v[56:59], v136 offset:6144
    v_mfma_f32_16x16x32_bf16 a[92:95], v[92:95], v[104:107], a[92:95]
    ds_read_b128 v[60:63], v136 offset:7168
    v_mfma_f32_16x16x32_bf16 a[96:99], v[64:67], v[108:111], a[96:99]
    v_mfma_f32_16x16x32_bf16 a[100:103], v[68:71], v[108:111], a[100:103]
    v_mfma_f32_16x16x32_bf16 a[104:107], v[72:75], v[108:111], a[104:107]
    s_add_u32 s16, s16, 1024
    v_mfma_f32_16x16x32_bf16 a[108:111], v[76:79], v[108:111], a[108:111]
    v_mfma_f32_16x16x32_bf16 a[112:115], v[80:83], v[108:111], a[112:115]
    v_mfma_f32_16x16x32_bf16 a[116:119], v[84:87], v[108:111], a[116:119]
    v_mfma_f32_16x16x32_bf16 a[120:123], v[88:91], v[108:111], a[120:123]
    v_mfma_f32_16x16x32_bf16 a[124:127], v[92:95], v[108:111], a[124:127]
    s_add_u32 m0, s19, 49152
    s_nop 0
    v_mfma_f32_16x16x32_bf16 a[128:131], v[64:67], v[112:115], a[128:131]
    v_mfma_f32_16x16x32_bf16 a[132:135], v[68:71], v[112:115], a[132:135]
    v_mfma_f32_16x16x32_bf16 a[136:139], v[72:75], v[112:115], a[136:139]
    v_mfma_f32_16x16x32_bf16 a[140:143], v[76:79], v[112:115], a[140:143]
    v_mfma_f32_16x16x32_bf16 a[144:147], v[80:83], v[112:115], a[144:147]
    buffer_load_dwordx4 v137, s[8:11], s15 offen offset:0 lds
    v_mfma_f32_16x16x32_bf16 a[148:151], v[84:87], v[112:115], a[148:151]
    v_mfma_f32_16x16x32_bf16 a[152:155], v[88:91], v[112:115], a[152:155]
    v_mfma_f32_16x16x32_bf16 a[156:159], v[92:95], v[112:115], a[156:159]
    v_mfma_f32_16x16x32_bf16 a[160:163], v[64:67], v[116:119], a[160:163]
    v_mfma_f32_16x16x32_bf16 a[164:167], v[68:71], v[116:119], a[164:167]
    v_mfma_f32_16x16x32_bf16 a[168:171], v[72:75], v[116:119], a[168:171]
    buffer_load_dwordx4 v138, s[8:11], s15 offen offset:1024 lds
    v_mfma_f32_16x16x32_bf16 a[172:175], v[76:79], v[116:119], a[172:175]
    v_mfma_f32_16x16x32_bf16 a[176:179], v[80:83], v[116:119], a[176:179]
    v_mfma_f32_16x16x32_bf16 a[180:183], v[84:87], v[116:119], a[180:183]
    v_mfma_f32_16x16x32_bf16 a[184:187], v[88:91], v[116:119], a[184:187]
    v_mfma_f32_16x16x32_bf16 a[188:191], v[92:95], v[116:119], a[188:191]
    buffer_load_dwordx4 v139, s[8:11], s15 offen offset:2048 lds
    v_mfma_f32_16x16x32_bf16 a[192:195], v[64:67], v[120:123], a[192:195]
    v_mfma_f32_16x16x32_bf16 a[196:199], v[68:71], v[120:123], a[196:199]
    v_mfma_f32_16x16x32_bf16 a[200:203], v[72:75], v[120:123], a[200:203]
    v_mfma_f32_16x16x32_bf16 a[204:207], v[76:79], v[120:123], a[204:207]
    v_mfma_f32_16x16x32_bf16 a[208:211], v[80:83], v[120:123], a[208:211]
    buffer_load_dwordx4 v140, s[8:11], s15 offen offset:3072 lds
    v_mfma_f32_16x16x32_bf16 a[212:215], v[84:87], v[120:123], a[212:215]
    v_mfma_f32_16x16x32_bf16 a[216:219], v[88:91], v[120:123], a[216:219]
    v_mfma_f32_16x16x32_bf16 a[220:223], v[92:95], v[120:123], a[220:223]
    v_mfma_f32_16x16x32_bf16 a[224:227], v[64:67], v[124:127], a[224:227]
    v_mfma_f32_16x16x32_bf16 a[228:231], v[68:71], v[124:127], a[228:231]
    s_add_u32 s15, s15, s17
    v_mfma_f32_16x16x32_bf16 a[232:235], v[72:75], v[124:127], a[232:235]
    v_mfma_f32_16x16x32_bf16 a[236:239], v[76:79], v[124:127], a[236:239]
    v_mfma_f32_16x16x32_bf16 a[240:243], v[80:83], v[124:127], a[240:243]
    v_mfma_f32_16x16x32_bf16 a[244:247], v[84:87], v[124:127], a[244:247]
    v_mfma_f32_16x16x32_bf16 a[248:251], v[88:91], v[124:127], a[248:251]
    v_mfma_f32_16x16x32_bf16 a[252:255], v[92:95], v[124:127], a[252:255]
    s_sub_u32 s18, s18, 1
    s_cmp_lg_u32 s18, 0
    s_cbranch_scc1 main_kernel_w_c2_n_loop
    s_cmp_lg_u32 s14, 0
    s_cbranch_scc1 main_kernel_w_c2_n_nt
    s_lshl_b32 s32, s27, 8
    s_add_u32 s32, s32, 0x841e000
    v_mov_b32 v255, 1
    s_mov_b64 exec, 1
    buffer_atomic_add v255, off, s[4:7], s32 sc0 sc1
    s_mov_b64 exec, -1
main_kernel_w_c2_n_nt:
    s_waitcnt lgkmcnt(0)
    v_mfma_f32_16x16x32_bf16 a[0:3], v[0:3], v[32:35], a[0:3]
    s_waitcnt vmcnt(16)
    s_barrier
    ds_read_b128 v[96:99], v136 offset:16384
    v_mfma_f32_16x16x32_bf16 a[4:7], v[4:7], v[32:35], a[4:7]
    ds_read_b64_tr_b16 v[64:65], v128 offset:16384
    v_mfma_f32_16x16x32_bf16 a[8:11], v[8:11], v[32:35], a[8:11]
    ds_read_b64_tr_b16 v[66:67], v128 offset:24576
    v_mfma_f32_16x16x32_bf16 a[12:15], v[12:15], v[32:35], a[12:15]
    ds_read_b64_tr_b16 v[68:69], v129 offset:16384
    v_mfma_f32_16x16x32_bf16 a[16:19], v[16:19], v[32:35], a[16:19]
    ds_read_b64_tr_b16 v[70:71], v129 offset:24576
    v_mfma_f32_16x16x32_bf16 a[20:23], v[20:23], v[32:35], a[20:23]
    ds_read_b64_tr_b16 v[72:73], v130 offset:16384
    v_mfma_f32_16x16x32_bf16 a[24:27], v[24:27], v[32:35], a[24:27]
    ds_read_b64_tr_b16 v[74:75], v130 offset:24576
    v_mfma_f32_16x16x32_bf16 a[28:31], v[28:31], v[32:35], a[28:31]
    ds_read_b64_tr_b16 v[76:77], v131 offset:16384
    v_mfma_f32_16x16x32_bf16 a[32:35], v[0:3], v[36:39], a[32:35]
    ds_read_b64_tr_b16 v[78:79], v131 offset:24576
    v_mfma_f32_16x16x32_bf16 a[36:39], v[4:7], v[36:39], a[36:39]
    ds_read_b64_tr_b16 v[80:81], v132 offset:16384
    v_mfma_f32_16x16x32_bf16 a[40:43], v[8:11], v[36:39], a[40:43]
    ds_read_b64_tr_b16 v[82:83], v132 offset:24576
    v_mfma_f32_16x16x32_bf16 a[44:47], v[12:15], v[36:39], a[44:47]
    ds_read_b64_tr_b16 v[84:85], v133 offset:16384
    v_mfma_f32_16x16x32_bf16 a[48:51], v[16:19], v[36:39], a[48:51]
    ds_read_b64_tr_b16 v[86:87], v133 offset:24576
    v_mfma_f32_16x16x32_bf16 a[52:55], v[20:23], v[36:39], a[52:55]
    ds_read_b64_tr_b16 v[88:89], v134 offset:16384
    v_mfma_f32_16x16x32_bf16 a[56:59], v[24:27], v[36:39], a[56:59]
    ds_read_b64_tr_b16 v[90:91], v134 offset:24576
    v_mfma_f32_16x16x32_bf16 a[60:63], v[28:31], v[36:39], a[60:63]
    ds_read_b64_tr_b16 v[92:93], v135 offset:16384
    v_mfma_f32_16x16x32_bf16 a[64:67], v[0:3], v[40:43], a[64:67]
    ds_read_b64_tr_b16 v[94:95], v135 offset:24576
    v_mfma_f32_16x16x32_bf16 a[68:71], v[4:7], v[40:43], a[68:71]
    ds_read_b128 v[100:103], v136 offset:17408
    v_mfma_f32_16x16x32_bf16 a[72:75], v[8:11], v[40:43], a[72:75]
    ds_read_b128 v[104:107], v136 offset:18432
    v_mfma_f32_16x16x32_bf16 a[76:79], v[12:15], v[40:43], a[76:79]
    ds_read_b128 v[108:111], v136 offset:19456
    v_mfma_f32_16x16x32_bf16 a[80:83], v[16:19], v[40:43], a[80:83]
    ds_read_b128 v[112:115], v136 offset:20480
    v_mfma_f32_16x16x32_bf16 a[84:87], v[20:23], v[40:43], a[84:87]
    ds_read_b128 v[116:119], v136 offset:21504
    v_mfma_f32_16x16x32_bf16 a[88:91], v[24:27], v[40:43], a[88:91]
    ds_read_b128 v[120:123], v136 offset:22528
    v_mfma_f32_16x16x32_bf16 a[92:95], v[28:31], v[40:43], a[92:95]
    ds_read_b128 v[124:127], v136 offset:23552
    v_mfma_f32_16x16x32_bf16 a[96:99], v[0:3], v[44:47], a[96:99]
    v_mfma_f32_16x16x32_bf16 a[100:103], v[4:7], v[44:47], a[100:103]
    v_mfma_f32_16x16x32_bf16 a[104:107], v[8:11], v[44:47], a[104:107]
    v_mfma_f32_16x16x32_bf16 a[108:111], v[12:15], v[44:47], a[108:111]
    v_mfma_f32_16x16x32_bf16 a[112:115], v[16:19], v[44:47], a[112:115]
    v_mfma_f32_16x16x32_bf16 a[116:119], v[20:23], v[44:47], a[116:119]
    v_mfma_f32_16x16x32_bf16 a[120:123], v[24:27], v[44:47], a[120:123]
    v_mfma_f32_16x16x32_bf16 a[124:127], v[28:31], v[44:47], a[124:127]
    v_mfma_f32_16x16x32_bf16 a[128:131], v[0:3], v[48:51], a[128:131]
    v_mfma_f32_16x16x32_bf16 a[132:135], v[4:7], v[48:51], a[132:135]
    v_mfma_f32_16x16x32_bf16 a[136:139], v[8:11], v[48:51], a[136:139]
    v_mfma_f32_16x16x32_bf16 a[140:143], v[12:15], v[48:51], a[140:143]
    v_mfma_f32_16x16x32_bf16 a[144:147], v[16:19], v[48:51], a[144:147]
    v_mfma_f32_16x16x32_bf16 a[148:151], v[20:23], v[48:51], a[148:151]
    v_mfma_f32_16x16x32_bf16 a[152:155], v[24:27], v[48:51], a[152:155]
    v_mfma_f32_16x16x32_bf16 a[156:159], v[28:31], v[48:51], a[156:159]
    v_mfma_f32_16x16x32_bf16 a[160:163], v[0:3], v[52:55], a[160:163]
    v_mfma_f32_16x16x32_bf16 a[164:167], v[4:7], v[52:55], a[164:167]
    v_mfma_f32_16x16x32_bf16 a[168:171], v[8:11], v[52:55], a[168:171]
    v_mfma_f32_16x16x32_bf16 a[172:175], v[12:15], v[52:55], a[172:175]
    v_mfma_f32_16x16x32_bf16 a[176:179], v[16:19], v[52:55], a[176:179]
    v_mfma_f32_16x16x32_bf16 a[180:183], v[20:23], v[52:55], a[180:183]
    v_mfma_f32_16x16x32_bf16 a[184:187], v[24:27], v[52:55], a[184:187]
    v_mfma_f32_16x16x32_bf16 a[188:191], v[28:31], v[52:55], a[188:191]
    v_mfma_f32_16x16x32_bf16 a[192:195], v[0:3], v[56:59], a[192:195]
    v_mfma_f32_16x16x32_bf16 a[196:199], v[4:7], v[56:59], a[196:199]
    v_mfma_f32_16x16x32_bf16 a[200:203], v[8:11], v[56:59], a[200:203]
    v_mfma_f32_16x16x32_bf16 a[204:207], v[12:15], v[56:59], a[204:207]
    v_mfma_f32_16x16x32_bf16 a[208:211], v[16:19], v[56:59], a[208:211]
    v_mfma_f32_16x16x32_bf16 a[212:215], v[20:23], v[56:59], a[212:215]
    v_mfma_f32_16x16x32_bf16 a[216:219], v[24:27], v[56:59], a[216:219]
    v_mfma_f32_16x16x32_bf16 a[220:223], v[28:31], v[56:59], a[220:223]
    v_mfma_f32_16x16x32_bf16 a[224:227], v[0:3], v[60:63], a[224:227]
    v_mfma_f32_16x16x32_bf16 a[228:231], v[4:7], v[60:63], a[228:231]
    v_mfma_f32_16x16x32_bf16 a[232:235], v[8:11], v[60:63], a[232:235]
    v_mfma_f32_16x16x32_bf16 a[236:239], v[12:15], v[60:63], a[236:239]
    v_mfma_f32_16x16x32_bf16 a[240:243], v[16:19], v[60:63], a[240:243]
    v_mfma_f32_16x16x32_bf16 a[244:247], v[20:23], v[60:63], a[244:247]
    v_mfma_f32_16x16x32_bf16 a[248:251], v[24:27], v[60:63], a[248:251]
    v_mfma_f32_16x16x32_bf16 a[252:255], v[28:31], v[60:63], a[252:255]
    s_waitcnt lgkmcnt(0)
    v_mfma_f32_16x16x32_bf16 a[0:3], v[64:67], v[96:99], a[0:3]
    s_waitcnt vmcnt(8)
    s_barrier
    ds_read_b128 v[32:35], v136 offset:32768
    v_mfma_f32_16x16x32_bf16 a[4:7], v[68:71], v[96:99], a[4:7]
    ds_read_b64_tr_b16 v[0:1], v128 offset:32768
    v_mfma_f32_16x16x32_bf16 a[8:11], v[72:75], v[96:99], a[8:11]
    ds_read_b64_tr_b16 v[2:3], v128 offset:40960
    v_mfma_f32_16x16x32_bf16 a[12:15], v[76:79], v[96:99], a[12:15]
    ds_read_b64_tr_b16 v[4:5], v129 offset:32768
    v_mfma_f32_16x16x32_bf16 a[16:19], v[80:83], v[96:99], a[16:19]
    ds_read_b64_tr_b16 v[6:7], v129 offset:40960
    v_mfma_f32_16x16x32_bf16 a[20:23], v[84:87], v[96:99], a[20:23]
    ds_read_b64_tr_b16 v[8:9], v130 offset:32768
    v_mfma_f32_16x16x32_bf16 a[24:27], v[88:91], v[96:99], a[24:27]
    ds_read_b64_tr_b16 v[10:11], v130 offset:40960
    v_mfma_f32_16x16x32_bf16 a[28:31], v[92:95], v[96:99], a[28:31]
    ds_read_b64_tr_b16 v[12:13], v131 offset:32768
    v_mfma_f32_16x16x32_bf16 a[32:35], v[64:67], v[100:103], a[32:35]
    ds_read_b64_tr_b16 v[14:15], v131 offset:40960
    v_mfma_f32_16x16x32_bf16 a[36:39], v[68:71], v[100:103], a[36:39]
    ds_read_b64_tr_b16 v[16:17], v132 offset:32768
    v_mfma_f32_16x16x32_bf16 a[40:43], v[72:75], v[100:103], a[40:43]
    ds_read_b64_tr_b16 v[18:19], v132 offset:40960
    v_mfma_f32_16x16x32_bf16 a[44:47], v[76:79], v[100:103], a[44:47]
    ds_read_b64_tr_b16 v[20:21], v133 offset:32768
    v_mfma_f32_16x16x32_bf16 a[48:51], v[80:83], v[100:103], a[48:51]
    ds_read_b64_tr_b16 v[22:23], v133 offset:40960
    v_mfma_f32_16x16x32_bf16 a[52:55], v[84:87], v[100:103], a[52:55]
    ds_read_b64_tr_b16 v[24:25], v134 offset:32768
    v_mfma_f32_16x16x32_bf16 a[56:59], v[88:91], v[100:103], a[56:59]
    ds_read_b64_tr_b16 v[26:27], v134 offset:40960
    v_mfma_f32_16x16x32_bf16 a[60:63], v[92:95], v[100:103], a[60:63]
    ds_read_b64_tr_b16 v[28:29], v135 offset:32768
    v_mfma_f32_16x16x32_bf16 a[64:67], v[64:67], v[104:107], a[64:67]
    ds_read_b64_tr_b16 v[30:31], v135 offset:40960
    v_mfma_f32_16x16x32_bf16 a[68:71], v[68:71], v[104:107], a[68:71]
    ds_read_b128 v[36:39], v136 offset:33792
    v_mfma_f32_16x16x32_bf16 a[72:75], v[72:75], v[104:107], a[72:75]
    ds_read_b128 v[40:43], v136 offset:34816
    v_mfma_f32_16x16x32_bf16 a[76:79], v[76:79], v[104:107], a[76:79]
    ds_read_b128 v[44:47], v136 offset:35840
    v_mfma_f32_16x16x32_bf16 a[80:83], v[80:83], v[104:107], a[80:83]
    ds_read_b128 v[48:51], v136 offset:36864
    v_mfma_f32_16x16x32_bf16 a[84:87], v[84:87], v[104:107], a[84:87]
    ds_read_b128 v[52:55], v136 offset:37888
    v_mfma_f32_16x16x32_bf16 a[88:91], v[88:91], v[104:107], a[88:91]
    ds_read_b128 v[56:59], v136 offset:38912
    v_mfma_f32_16x16x32_bf16 a[92:95], v[92:95], v[104:107], a[92:95]
    ds_read_b128 v[60:63], v136 offset:39936
    v_mfma_f32_16x16x32_bf16 a[96:99], v[64:67], v[108:111], a[96:99]
    v_mfma_f32_16x16x32_bf16 a[100:103], v[68:71], v[108:111], a[100:103]
    v_mfma_f32_16x16x32_bf16 a[104:107], v[72:75], v[108:111], a[104:107]
    v_mfma_f32_16x16x32_bf16 a[108:111], v[76:79], v[108:111], a[108:111]
    v_mfma_f32_16x16x32_bf16 a[112:115], v[80:83], v[108:111], a[112:115]
    v_mfma_f32_16x16x32_bf16 a[116:119], v[84:87], v[108:111], a[116:119]
    v_mfma_f32_16x16x32_bf16 a[120:123], v[88:91], v[108:111], a[120:123]
    v_mfma_f32_16x16x32_bf16 a[124:127], v[92:95], v[108:111], a[124:127]
    v_mfma_f32_16x16x32_bf16 a[128:131], v[64:67], v[112:115], a[128:131]
    v_mfma_f32_16x16x32_bf16 a[132:135], v[68:71], v[112:115], a[132:135]
    v_mfma_f32_16x16x32_bf16 a[136:139], v[72:75], v[112:115], a[136:139]
    v_mfma_f32_16x16x32_bf16 a[140:143], v[76:79], v[112:115], a[140:143]
    v_mfma_f32_16x16x32_bf16 a[144:147], v[80:83], v[112:115], a[144:147]
    v_mfma_f32_16x16x32_bf16 a[148:151], v[84:87], v[112:115], a[148:151]
    v_mfma_f32_16x16x32_bf16 a[152:155], v[88:91], v[112:115], a[152:155]
    v_mfma_f32_16x16x32_bf16 a[156:159], v[92:95], v[112:115], a[156:159]
    v_mfma_f32_16x16x32_bf16 a[160:163], v[64:67], v[116:119], a[160:163]
    v_mfma_f32_16x16x32_bf16 a[164:167], v[68:71], v[116:119], a[164:167]
    v_mfma_f32_16x16x32_bf16 a[168:171], v[72:75], v[116:119], a[168:171]
    v_mfma_f32_16x16x32_bf16 a[172:175], v[76:79], v[116:119], a[172:175]
    v_mfma_f32_16x16x32_bf16 a[176:179], v[80:83], v[116:119], a[176:179]
    v_mfma_f32_16x16x32_bf16 a[180:183], v[84:87], v[116:119], a[180:183]
    v_mfma_f32_16x16x32_bf16 a[184:187], v[88:91], v[116:119], a[184:187]
    v_mfma_f32_16x16x32_bf16 a[188:191], v[92:95], v[116:119], a[188:191]
    v_mfma_f32_16x16x32_bf16 a[192:195], v[64:67], v[120:123], a[192:195]
    v_mfma_f32_16x16x32_bf16 a[196:199], v[68:71], v[120:123], a[196:199]
    v_mfma_f32_16x16x32_bf16 a[200:203], v[72:75], v[120:123], a[200:203]
    v_mfma_f32_16x16x32_bf16 a[204:207], v[76:79], v[120:123], a[204:207]
    v_mfma_f32_16x16x32_bf16 a[208:211], v[80:83], v[120:123], a[208:211]
    v_mfma_f32_16x16x32_bf16 a[212:215], v[84:87], v[120:123], a[212:215]
    v_mfma_f32_16x16x32_bf16 a[216:219], v[88:91], v[120:123], a[216:219]
    v_mfma_f32_16x16x32_bf16 a[220:223], v[92:95], v[120:123], a[220:223]
    v_mfma_f32_16x16x32_bf16 a[224:227], v[64:67], v[124:127], a[224:227]
    v_mfma_f32_16x16x32_bf16 a[228:231], v[68:71], v[124:127], a[228:231]
    v_mfma_f32_16x16x32_bf16 a[232:235], v[72:75], v[124:127], a[232:235]
    v_mfma_f32_16x16x32_bf16 a[236:239], v[76:79], v[124:127], a[236:239]
    v_mfma_f32_16x16x32_bf16 a[240:243], v[80:83], v[124:127], a[240:243]
    v_mfma_f32_16x16x32_bf16 a[244:247], v[84:87], v[124:127], a[244:247]
    v_mfma_f32_16x16x32_bf16 a[248:251], v[88:91], v[124:127], a[248:251]
    v_mfma_f32_16x16x32_bf16 a[252:255], v[92:95], v[124:127], a[252:255]
    s_waitcnt lgkmcnt(0)
    v_mfma_f32_16x16x32_bf16 a[0:3], v[0:3], v[32:35], a[0:3]
    s_waitcnt vmcnt(0)
    s_barrier
    ds_read_b128 v[96:99], v136 offset:49152
    v_mfma_f32_16x16x32_bf16 a[4:7], v[4:7], v[32:35], a[4:7]
    ds_read_b64_tr_b16 v[64:65], v128 offset:49152
    v_mfma_f32_16x16x32_bf16 a[8:11], v[8:11], v[32:35], a[8:11]
    ds_read_b64_tr_b16 v[66:67], v128 offset:57344
    v_mfma_f32_16x16x32_bf16 a[12:15], v[12:15], v[32:35], a[12:15]
    ds_read_b64_tr_b16 v[68:69], v129 offset:49152
    v_mfma_f32_16x16x32_bf16 a[16:19], v[16:19], v[32:35], a[16:19]
    ds_read_b64_tr_b16 v[70:71], v129 offset:57344
    v_mfma_f32_16x16x32_bf16 a[20:23], v[20:23], v[32:35], a[20:23]
    ds_read_b64_tr_b16 v[72:73], v130 offset:49152
    v_mfma_f32_16x16x32_bf16 a[24:27], v[24:27], v[32:35], a[24:27]
    ds_read_b64_tr_b16 v[74:75], v130 offset:57344
    v_mfma_f32_16x16x32_bf16 a[28:31], v[28:31], v[32:35], a[28:31]
    ds_read_b64_tr_b16 v[76:77], v131 offset:49152
    v_mfma_f32_16x16x32_bf16 a[32:35], v[0:3], v[36:39], a[32:35]
    ds_read_b64_tr_b16 v[78:79], v131 offset:57344
    v_mfma_f32_16x16x32_bf16 a[36:39], v[4:7], v[36:39], a[36:39]
    ds_read_b64_tr_b16 v[80:81], v132 offset:49152
    v_mfma_f32_16x16x32_bf16 a[40:43], v[8:11], v[36:39], a[40:43]
    ds_read_b64_tr_b16 v[82:83], v132 offset:57344
    v_mfma_f32_16x16x32_bf16 a[44:47], v[12:15], v[36:39], a[44:47]
    ds_read_b64_tr_b16 v[84:85], v133 offset:49152
    v_mfma_f32_16x16x32_bf16 a[48:51], v[16:19], v[36:39], a[48:51]
    ds_read_b64_tr_b16 v[86:87], v133 offset:57344
    v_mfma_f32_16x16x32_bf16 a[52:55], v[20:23], v[36:39], a[52:55]
    ds_read_b64_tr_b16 v[88:89], v134 offset:49152
    v_mfma_f32_16x16x32_bf16 a[56:59], v[24:27], v[36:39], a[56:59]
    ds_read_b64_tr_b16 v[90:91], v134 offset:57344
    v_mfma_f32_16x16x32_bf16 a[60:63], v[28:31], v[36:39], a[60:63]
    ds_read_b64_tr_b16 v[92:93], v135 offset:49152
    v_mfma_f32_16x16x32_bf16 a[64:67], v[0:3], v[40:43], a[64:67]
    ds_read_b64_tr_b16 v[94:95], v135 offset:57344
    v_mfma_f32_16x16x32_bf16 a[68:71], v[4:7], v[40:43], a[68:71]
    ds_read_b128 v[100:103], v136 offset:50176
    v_mfma_f32_16x16x32_bf16 a[72:75], v[8:11], v[40:43], a[72:75]
    ds_read_b128 v[104:107], v136 offset:51200
    v_mfma_f32_16x16x32_bf16 a[76:79], v[12:15], v[40:43], a[76:79]
    ds_read_b128 v[108:111], v136 offset:52224
    v_mfma_f32_16x16x32_bf16 a[80:83], v[16:19], v[40:43], a[80:83]
    ds_read_b128 v[112:115], v136 offset:53248
    v_mfma_f32_16x16x32_bf16 a[84:87], v[20:23], v[40:43], a[84:87]
    ds_read_b128 v[116:119], v136 offset:54272
    v_mfma_f32_16x16x32_bf16 a[88:91], v[24:27], v[40:43], a[88:91]
    ds_read_b128 v[120:123], v136 offset:55296
    v_mfma_f32_16x16x32_bf16 a[92:95], v[28:31], v[40:43], a[92:95]
    ds_read_b128 v[124:127], v136 offset:56320
    v_mfma_f32_16x16x32_bf16 a[96:99], v[0:3], v[44:47], a[96:99]
    v_mfma_f32_16x16x32_bf16 a[100:103], v[4:7], v[44:47], a[100:103]
    v_mfma_f32_16x16x32_bf16 a[104:107], v[8:11], v[44:47], a[104:107]
    v_mfma_f32_16x16x32_bf16 a[108:111], v[12:15], v[44:47], a[108:111]
    v_mfma_f32_16x16x32_bf16 a[112:115], v[16:19], v[44:47], a[112:115]
    v_mfma_f32_16x16x32_bf16 a[116:119], v[20:23], v[44:47], a[116:119]
    v_mfma_f32_16x16x32_bf16 a[120:123], v[24:27], v[44:47], a[120:123]
    v_mfma_f32_16x16x32_bf16 a[124:127], v[28:31], v[44:47], a[124:127]
    v_mfma_f32_16x16x32_bf16 a[128:131], v[0:3], v[48:51], a[128:131]
    v_mfma_f32_16x16x32_bf16 a[132:135], v[4:7], v[48:51], a[132:135]
    v_mfma_f32_16x16x32_bf16 a[136:139], v[8:11], v[48:51], a[136:139]
    v_mfma_f32_16x16x32_bf16 a[140:143], v[12:15], v[48:51], a[140:143]
    v_mfma_f32_16x16x32_bf16 a[144:147], v[16:19], v[48:51], a[144:147]
    v_mfma_f32_16x16x32_bf16 a[148:151], v[20:23], v[48:51], a[148:151]
    v_mfma_f32_16x16x32_bf16 a[152:155], v[24:27], v[48:51], a[152:155]
    v_mfma_f32_16x16x32_bf16 a[156:159], v[28:31], v[48:51], a[156:159]
    v_mfma_f32_16x16x32_bf16 a[160:163], v[0:3], v[52:55], a[160:163]
    v_mfma_f32_16x16x32_bf16 a[164:167], v[4:7], v[52:55], a[164:167]
    v_mfma_f32_16x16x32_bf16 a[168:171], v[8:11], v[52:55], a[168:171]
    v_mfma_f32_16x16x32_bf16 a[172:175], v[12:15], v[52:55], a[172:175]
    v_mfma_f32_16x16x32_bf16 a[176:179], v[16:19], v[52:55], a[176:179]
    v_mfma_f32_16x16x32_bf16 a[180:183], v[20:23], v[52:55], a[180:183]
    v_mfma_f32_16x16x32_bf16 a[184:187], v[24:27], v[52:55], a[184:187]
    v_mfma_f32_16x16x32_bf16 a[188:191], v[28:31], v[52:55], a[188:191]
    v_mfma_f32_16x16x32_bf16 a[192:195], v[0:3], v[56:59], a[192:195]
    v_mfma_f32_16x16x32_bf16 a[196:199], v[4:7], v[56:59], a[196:199]
    v_mfma_f32_16x16x32_bf16 a[200:203], v[8:11], v[56:59], a[200:203]
    v_mfma_f32_16x16x32_bf16 a[204:207], v[12:15], v[56:59], a[204:207]
    v_mfma_f32_16x16x32_bf16 a[208:211], v[16:19], v[56:59], a[208:211]
    v_mfma_f32_16x16x32_bf16 a[212:215], v[20:23], v[56:59], a[212:215]
    v_mfma_f32_16x16x32_bf16 a[216:219], v[24:27], v[56:59], a[216:219]
    v_mfma_f32_16x16x32_bf16 a[220:223], v[28:31], v[56:59], a[220:223]
    v_mfma_f32_16x16x32_bf16 a[224:227], v[0:3], v[60:63], a[224:227]
    v_mfma_f32_16x16x32_bf16 a[228:231], v[4:7], v[60:63], a[228:231]
    v_mfma_f32_16x16x32_bf16 a[232:235], v[8:11], v[60:63], a[232:235]
    v_mfma_f32_16x16x32_bf16 a[236:239], v[12:15], v[60:63], a[236:239]
    v_mfma_f32_16x16x32_bf16 a[240:243], v[16:19], v[60:63], a[240:243]
    v_mfma_f32_16x16x32_bf16 a[244:247], v[20:23], v[60:63], a[244:247]
    v_mfma_f32_16x16x32_bf16 a[248:251], v[24:27], v[60:63], a[248:251]
    v_mfma_f32_16x16x32_bf16 a[252:255], v[28:31], v[60:63], a[252:255]
    v_readfirstlane_b32 s55, v255
    s_waitcnt lgkmcnt(0)
    v_mfma_f32_16x16x32_bf16 a[0:3], v[64:67], v[96:99], a[0:3]
    v_mfma_f32_16x16x32_bf16 a[4:7], v[68:71], v[96:99], a[4:7]
    v_mfma_f32_16x16x32_bf16 a[8:11], v[72:75], v[96:99], a[8:11]
    v_mfma_f32_16x16x32_bf16 a[12:15], v[76:79], v[96:99], a[12:15]
    v_mfma_f32_16x16x32_bf16 a[16:19], v[80:83], v[96:99], a[16:19]
    v_mfma_f32_16x16x32_bf16 a[20:23], v[84:87], v[96:99], a[20:23]
    v_mfma_f32_16x16x32_bf16 a[24:27], v[88:91], v[96:99], a[24:27]
    v_mfma_f32_16x16x32_bf16 a[28:31], v[92:95], v[96:99], a[28:31]
    v_mfma_f32_16x16x32_bf16 a[32:35], v[64:67], v[100:103], a[32:35]
    v_mfma_f32_16x16x32_bf16 a[36:39], v[68:71], v[100:103], a[36:39]
    v_mfma_f32_16x16x32_bf16 a[40:43], v[72:75], v[100:103], a[40:43]
    v_mfma_f32_16x16x32_bf16 a[44:47], v[76:79], v[100:103], a[44:47]
    v_mfma_f32_16x16x32_bf16 a[48:51], v[80:83], v[100:103], a[48:51]
    v_mfma_f32_16x16x32_bf16 a[52:55], v[84:87], v[100:103], a[52:55]
    v_mfma_f32_16x16x32_bf16 a[56:59], v[88:91], v[100:103], a[56:59]
    v_mfma_f32_16x16x32_bf16 a[60:63], v[92:95], v[100:103], a[60:63]
    v_mfma_f32_16x16x32_bf16 a[64:67], v[64:67], v[104:107], a[64:67]
    v_mfma_f32_16x16x32_bf16 a[68:71], v[68:71], v[104:107], a[68:71]
    v_mfma_f32_16x16x32_bf16 a[72:75], v[72:75], v[104:107], a[72:75]
    v_mfma_f32_16x16x32_bf16 a[76:79], v[76:79], v[104:107], a[76:79]
    v_mfma_f32_16x16x32_bf16 a[80:83], v[80:83], v[104:107], a[80:83]
    v_mfma_f32_16x16x32_bf16 a[84:87], v[84:87], v[104:107], a[84:87]
    v_mfma_f32_16x16x32_bf16 a[88:91], v[88:91], v[104:107], a[88:91]
    v_mfma_f32_16x16x32_bf16 a[92:95], v[92:95], v[104:107], a[92:95]
    v_mfma_f32_16x16x32_bf16 a[96:99], v[64:67], v[108:111], a[96:99]
    v_mfma_f32_16x16x32_bf16 a[100:103], v[68:71], v[108:111], a[100:103]
    v_mfma_f32_16x16x32_bf16 a[104:107], v[72:75], v[108:111], a[104:107]
    v_mfma_f32_16x16x32_bf16 a[108:111], v[76:79], v[108:111], a[108:111]
    v_mfma_f32_16x16x32_bf16 a[112:115], v[80:83], v[108:111], a[112:115]
    v_mfma_f32_16x16x32_bf16 a[116:119], v[84:87], v[108:111], a[116:119]
    v_mfma_f32_16x16x32_bf16 a[120:123], v[88:91], v[108:111], a[120:123]
    v_mfma_f32_16x16x32_bf16 a[124:127], v[92:95], v[108:111], a[124:127]
    v_mfma_f32_16x16x32_bf16 a[128:131], v[64:67], v[112:115], a[128:131]
    v_mfma_f32_16x16x32_bf16 a[132:135], v[68:71], v[112:115], a[132:135]
    v_mfma_f32_16x16x32_bf16 a[136:139], v[72:75], v[112:115], a[136:139]
    v_mfma_f32_16x16x32_bf16 a[140:143], v[76:79], v[112:115], a[140:143]
    v_mfma_f32_16x16x32_bf16 a[144:147], v[80:83], v[112:115], a[144:147]
    v_mfma_f32_16x16x32_bf16 a[148:151], v[84:87], v[112:115], a[148:151]
    v_mfma_f32_16x16x32_bf16 a[152:155], v[88:91], v[112:115], a[152:155]
    v_mfma_f32_16x16x32_bf16 a[156:159], v[92:95], v[112:115], a[156:159]
    v_mfma_f32_16x16x32_bf16 a[160:163], v[64:67], v[116:119], a[160:163]
    v_mfma_f32_16x16x32_bf16 a[164:167], v[68:71], v[116:119], a[164:167]
    v_mfma_f32_16x16x32_bf16 a[168:171], v[72:75], v[116:119], a[168:171]
    v_mfma_f32_16x16x32_bf16 a[172:175], v[76:79], v[116:119], a[172:175]
    v_mfma_f32_16x16x32_bf16 a[176:179], v[80:83], v[116:119], a[176:179]
    v_mfma_f32_16x16x32_bf16 a[180:183], v[84:87], v[116:119], a[180:183]
    v_mfma_f32_16x16x32_bf16 a[184:187], v[88:91], v[116:119], a[184:187]
    v_mfma_f32_16x16x32_bf16 a[188:191], v[92:95], v[116:119], a[188:191]
    v_mfma_f32_16x16x32_bf16 a[192:195], v[64:67], v[120:123], a[192:195]
    v_mfma_f32_16x16x32_bf16 a[196:199], v[68:71], v[120:123], a[196:199]
    v_mfma_f32_16x16x32_bf16 a[200:203], v[72:75], v[120:123], a[200:203]
    v_mfma_f32_16x16x32_bf16 a[204:207], v[76:79], v[120:123], a[204:207]
    v_mfma_f32_16x16x32_bf16 a[208:211], v[80:83], v[120:123], a[208:211]
    v_mfma_f32_16x16x32_bf16 a[212:215], v[84:87], v[120:123], a[212:215]
    v_mfma_f32_16x16x32_bf16 a[216:219], v[88:91], v[120:123], a[216:219]
    v_mfma_f32_16x16x32_bf16 a[220:223], v[92:95], v[120:123], a[220:223]
    v_mfma_f32_16x16x32_bf16 a[224:227], v[64:67], v[124:127], a[224:227]
    v_mfma_f32_16x16x32_bf16 a[228:231], v[68:71], v[124:127], a[228:231]
    v_mfma_f32_16x16x32_bf16 a[232:235], v[72:75], v[124:127], a[232:235]
    v_mfma_f32_16x16x32_bf16 a[236:239], v[76:79], v[124:127], a[236:239]
    v_mfma_f32_16x16x32_bf16 a[240:243], v[80:83], v[124:127], a[240:243]
    v_mfma_f32_16x16x32_bf16 a[244:247], v[84:87], v[124:127], a[244:247]
    v_mfma_f32_16x16x32_bf16 a[248:251], v[88:91], v[124:127], a[248:251]
    v_mfma_f32_16x16x32_bf16 a[252:255], v[92:95], v[124:127], a[252:255]
    s_nop 7
    s_cmp_eq_u32 s23, 1
    s_cbranch_scc1 main_kernel_w_c2_escl
    s_cmp_eq_u32 s23, 6
    s_cbranch_scc1 main_kernel_w_c2_egelu
main_kernel_w_c2_eplain:
    s_mov_b32 s53, s21
    v_accvgpr_read_b32 v0, a0
    v_accvgpr_read_b32 v1, a1
    v_accvgpr_read_b32 v2, a2
    v_accvgpr_read_b32 v3, a3
    v_accvgpr_read_b32 v4, a4
    v_accvgpr_read_b32 v5, a5
    v_accvgpr_read_b32 v6, a6
    v_accvgpr_read_b32 v7, a7
    v_cvt_pk_bf16_f32 v16, v0, v1
    v_cvt_pk_bf16_f32 v17, v2, v3
    v_cvt_pk_bf16_f32 v18, v4, v5
    v_cvt_pk_bf16_f32 v19, v6, v7
    buffer_store_dwordx4 v[16:19], v251, s[4:7], s53 offen offset:0 sc1
    v_accvgpr_read_b32 v20, a8
    v_accvgpr_read_b32 v21, a9
    v_accvgpr_read_b32 v22, a10
    v_accvgpr_read_b32 v23, a11
    v_accvgpr_read_b32 v24, a12
    v_accvgpr_read_b32 v25, a13
    v_accvgpr_read_b32 v26, a14
    v_accvgpr_read_b32 v27, a15
    v_cvt_pk_bf16_f32 v36, v20, v21
    v_cvt_pk_bf16_f32 v37, v22, v23
    v_cvt_pk_bf16_f32 v38, v24, v25
    v_cvt_pk_bf16_f32 v39, v26, v27
    buffer_store_dwordx4 v[36:39], v251, s[4:7], s53 offen offset:1024 sc1
    v_accvgpr_read_b32 v40, a16
    v_accvgpr_read_b32 v41, a17
    v_accvgpr_read_b32 v42, a18
    v_accvgpr_read_b32 v43, a19
    v_accvgpr_read_b32 v44, a20
    v_accvgpr_read_b32 v45, a21
    v_accvgpr_read_b32 v46, a22
    v_accvgpr_read_b32 v47, a23
    v_cvt_pk_bf16_f32 v56, v40, v41
    v_cvt_pk_bf16_f32 v57, v42, v43
    v_cvt_pk_bf16_f32 v58, v44, v45
    v_cvt_pk_bf16_f32 v59, v46, v47
    buffer_store_dwordx4 v[56:59], v251, s[4:7], s53 offen offset:2048 sc1
    v_accvgpr_read_b32 v0, a24
    v_accvgpr_read_b32 v1, a25
    v_accvgpr_read_b32 v2, a26
    v_accvgpr_read_b32 v3, a27
    v_accvgpr_read_b32 v4, a28
    v_accvgpr_read_b32 v5, a29
    v_accvgpr_read_b32 v6, a30
    v_accvgpr_read_b32 v7, a31
    v_cvt_pk_bf16_f32 v16, v0, v1
    v_cvt_pk_bf16_f32 v17, v2, v3
    v_cvt_pk_bf16_f32 v18, v4, v5
    v_cvt_pk_bf16_f32 v19, v6, v7
    buffer_store_dwordx4 v[16:19], v251, s[4:7], s53 offen offset:3072 sc1
    s_add_u32 s53, s53, s22
    v_accvgpr_read_b32 v20, a32
    v_accvgpr_read_b32 v21, a33
    v_accvgpr_read_b32 v22, a34
    v_accvgpr_read_b32 v23, a35
    v_accvgpr_read_b32 v24, a36
    v_accvgpr_read_b32 v25, a37
    v_accvgpr_read_b32 v26, a38
    v_accvgpr_read_b32 v27, a39
    v_cvt_pk_bf16_f32 v36, v20, v21
    v_cvt_pk_bf16_f32 v37, v22, v23
    v_cvt_pk_bf16_f32 v38, v24, v25
    v_cvt_pk_bf16_f32 v39, v26, v27
    buffer_store_dwordx4 v[36:39], v251, s[4:7], s53 offen offset:0 sc1
    v_accvgpr_read_b32 v40, a40
    v_accvgpr_read_b32 v41, a41
    v_accvgpr_read_b32 v42, a42
    v_accvgpr_read_b32 v43, a43
    v_accvgpr_read_b32 v44, a44
    v_accvgpr_read_b32 v45, a45
    v_accvgpr_read_b32 v46, a46
    v_accvgpr_read_b32 v47, a47
    v_cvt_pk_bf16_f32 v56, v40, v41
    v_cvt_pk_bf16_f32 v57, v42, v43
    v_cvt_pk_bf16_f32 v58, v44, v45
    v_cvt_pk_bf16_f32 v59, v46, v47
    buffer_store_dwordx4 v[56:59], v251, s[4:7], s53 offen offset:1024 sc1
    v_accvgpr_read_b32 v0, a48
    v_accvgpr_read_b32 v1, a49
    v_accvgpr_read_b32 v2, a50
    v_accvgpr_read_b32 v3, a51
    v_accvgpr_read_b32 v4, a52
    v_accvgpr_read_b32 v5, a53
    v_accvgpr_read_b32 v6, a54
    v_accvgpr_read_b32 v7, a55
    v_cvt_pk_bf16_f32 v16, v0, v1
    v_cvt_pk_bf16_f32 v17, v2, v3
    v_cvt_pk_bf16_f32 v18, v4, v5
    v_cvt_pk_bf16_f32 v19, v6, v7
    buffer_store_dwordx4 v[16:19], v251, s[4:7], s53 offen offset:2048 sc1
    v_accvgpr_read_b32 v20, a56
    v_accvgpr_read_b32 v21, a57
    v_accvgpr_read_b32 v22, a58
    v_accvgpr_read_b32 v23, a59
    v_accvgpr_read_b32 v24, a60
    v_accvgpr_read_b32 v25, a61
    v_accvgpr_read_b32 v26, a62
    v_accvgpr_read_b32 v27, a63
    v_cvt_pk_bf16_f32 v36, v20, v21
    v_cvt_pk_bf16_f32 v37, v22, v23
    v_cvt_pk_bf16_f32 v38, v24, v25
    v_cvt_pk_bf16_f32 v39, v26, v27
    buffer_store_dwordx4 v[36:39], v251, s[4:7], s53 offen offset:3072 sc1
    s_add_u32 s53, s53, s22
    v_accvgpr_read_b32 v40, a64
    v_accvgpr_read_b32 v41, a65
    v_accvgpr_read_b32 v42, a66
    v_accvgpr_read_b32 v43, a67
    v_accvgpr_read_b32 v44, a68
    v_accvgpr_read_b32 v45, a69
    v_accvgpr_read_b32 v46, a70
    v_accvgpr_read_b32 v47, a71
    v_cvt_pk_bf16_f32 v56, v40, v41
    v_cvt_pk_bf16_f32 v57, v42, v43
    v_cvt_pk_bf16_f32 v58, v44, v45
    v_cvt_pk_bf16_f32 v59, v46, v47
    buffer_store_dwordx4 v[56:59], v251, s[4:7], s53 offen offset:0 sc1
    v_accvgpr_read_b32 v0, a72
    v_accvgpr_read_b32 v1, a73
    v_accvgpr_read_b32 v2, a74
    v_accvgpr_read_b32 v3, a75
    v_accvgpr_read_b32 v4, a76
    v_accvgpr_read_b32 v5, a77
    v_accvgpr_read_b32 v6, a78
    v_accvgpr_read_b32 v7, a79
    v_cvt_pk_bf16_f32 v16, v0, v1
    v_cvt_pk_bf16_f32 v17, v2, v3
    v_cvt_pk_bf16_f32 v18, v4, v5
    v_cvt_pk_bf16_f32 v19, v6, v7
    buffer_store_dwordx4 v[16:19], v251, s[4:7], s53 offen offset:1024 sc1
    v_accvgpr_read_b32 v20, a80
    v_accvgpr_read_b32 v21, a81
    v_accvgpr_read_b32 v22, a82
    v_accvgpr_read_b32 v23, a83
    v_accvgpr_read_b32 v24, a84
    v_accvgpr_read_b32 v25, a85
    v_accvgpr_read_b32 v26, a86
    v_accvgpr_read_b32 v27, a87
    v_cvt_pk_bf16_f32 v36, v20, v21
    v_cvt_pk_bf16_f32 v37, v22, v23
    v_cvt_pk_bf16_f32 v38, v24, v25
    v_cvt_pk_bf16_f32 v39, v26, v27
    buffer_store_dwordx4 v[36:39], v251, s[4:7], s53 offen offset:2048 sc1
    v_accvgpr_read_b32 v40, a88
    v_accvgpr_read_b32 v41, a89
    v_accvgpr_read_b32 v42, a90
    v_accvgpr_read_b32 v43, a91
    v_accvgpr_read_b32 v44, a92
    v_accvgpr_read_b32 v45, a93
    v_accvgpr_read_b32 v46, a94
    v_accvgpr_read_b32 v47, a95
    v_cvt_pk_bf16_f32 v56, v40, v41
    v_cvt_pk_bf16_f32 v57, v42, v43
    v_cvt_pk_bf16_f32 v58, v44, v45
    v_cvt_pk_bf16_f32 v59, v46, v47
    buffer_store_dwordx4 v[56:59], v251, s[4:7], s53 offen offset:3072 sc1
    s_add_u32 s53, s53, s22
    v_accvgpr_read_b32 v0, a96
    v_accvgpr_read_b32 v1, a97
    v_accvgpr_read_b32 v2, a98
    v_accvgpr_read_b32 v3, a99
    v_accvgpr_read_b32 v4, a100
    v_accvgpr_read_b32 v5, a101
    v_accvgpr_read_b32 v6, a102
    v_accvgpr_read_b32 v7, a103
    v_cvt_pk_bf16_f32 v16, v0, v1
    v_cvt_pk_bf16_f32 v17, v2, v3
    v_cvt_pk_bf16_f32 v18, v4, v5
    v_cvt_pk_bf16_f32 v19, v6, v7
    buffer_store_dwordx4 v[16:19], v251, s[4:7], s53 offen offset:0 sc1
    v_accvgpr_read_b32 v20, a104
    v_accvgpr_read_b32 v21, a105
    v_accvgpr_read_b32 v22, a106
    v_accvgpr_read_b32 v23, a107
    v_accvgpr_read_b32 v24, a108
    v_accvgpr_read_b32 v25, a109
    v_accvgpr_read_b32 v26, a110
    v_accvgpr_read_b32 v27, a111
    v_cvt_pk_bf16_f32 v36, v20, v21
    v_cvt_pk_bf16_f32 v37, v22, v23
    v_cvt_pk_bf16_f32 v38, v24, v25
    v_cvt_pk_bf16_f32 v39, v26, v27
    buffer_store_dwordx4 v[36:39], v251, s[4:7], s53 offen offset:1024 sc1
    v_accvgpr_read_b32 v40, a112
    v_accvgpr_read_b32 v41, a113
    v_accvgpr_read_b32 v42, a114
    v_accvgpr_read_b32 v43, a115
    v_accvgpr_read_b32 v44, a116
    v_accvgpr_read_b32 v45, a117
    v_accvgpr_read_b32 v46, a118
    v_accvgpr_read_b32 v47, a119
    v_cvt_pk_bf16_f32 v56, v40, v41
    v_cvt_pk_bf16_f32 v57, v42, v43
    v_cvt_pk_bf16_f32 v58, v44, v45
    v_cvt_pk_bf16_f32 v59, v46, v47
    buffer_store_dwordx4 v[56:59], v251, s[4:7], s53 offen offset:2048 sc1
    v_accvgpr_read_b32 v0, a120
    v_accvgpr_read_b32 v1, a121
    v_accvgpr_read_b32 v2, a122
    v_accvgpr_read_b32 v3, a123
    v_accvgpr_read_b32 v4, a124
    v_accvgpr_read_b32 v5, a125
    v_accvgpr_read_b32 v6, a126
    v_accvgpr_read_b32 v7, a127
    v_cvt_pk_bf16_f32 v16, v0, v1
    v_cvt_pk_bf16_f32 v17, v2, v3
    v_cvt_pk_bf16_f32 v18, v4, v5
    v_cvt_pk_bf16_f32 v19, v6, v7
    buffer_store_dwordx4 v[16:19], v251, s[4:7], s53 offen offset:3072 sc1
    s_add_u32 s53, s53, s22
    v_accvgpr_read_b32 v20, a128
    v_accvgpr_read_b32 v21, a129
    v_accvgpr_read_b32 v22, a130
    v_accvgpr_read_b32 v23, a131
    v_accvgpr_read_b32 v24, a132
    v_accvgpr_read_b32 v25, a133
    v_accvgpr_read_b32 v26, a134
    v_accvgpr_read_b32 v27, a135
    v_cvt_pk_bf16_f32 v36, v20, v21
    v_cvt_pk_bf16_f32 v37, v22, v23
    v_cvt_pk_bf16_f32 v38, v24, v25
    v_cvt_pk_bf16_f32 v39, v26, v27
    buffer_store_dwordx4 v[36:39], v251, s[4:7], s53 offen offset:0 sc1
    v_accvgpr_read_b32 v40, a136
    v_accvgpr_read_b32 v41, a137
    v_accvgpr_read_b32 v42, a138
    v_accvgpr_read_b32 v43, a139
    v_accvgpr_read_b32 v44, a140
    v_accvgpr_read_b32 v45, a141
    v_accvgpr_read_b32 v46, a142
    v_accvgpr_read_b32 v47, a143
    v_cvt_pk_bf16_f32 v56, v40, v41
    v_cvt_pk_bf16_f32 v57, v42, v43
    v_cvt_pk_bf16_f32 v58, v44, v45
    v_cvt_pk_bf16_f32 v59, v46, v47
    buffer_store_dwordx4 v[56:59], v251, s[4:7], s53 offen offset:1024 sc1
    v_accvgpr_read_b32 v0, a144
    v_accvgpr_read_b32 v1, a145
    v_accvgpr_read_b32 v2, a146
    v_accvgpr_read_b32 v3, a147
    v_accvgpr_read_b32 v4, a148
    v_accvgpr_read_b32 v5, a149
    v_accvgpr_read_b32 v6, a150
    v_accvgpr_read_b32 v7, a151
    v_cvt_pk_bf16_f32 v16, v0, v1
    v_cvt_pk_bf16_f32 v17, v2, v3
    v_cvt_pk_bf16_f32 v18, v4, v5
    v_cvt_pk_bf16_f32 v19, v6, v7
    buffer_store_dwordx4 v[16:19], v251, s[4:7], s53 offen offset:2048 sc1
    v_accvgpr_read_b32 v20, a152
    v_accvgpr_read_b32 v21, a153
    v_accvgpr_read_b32 v22, a154
    v_accvgpr_read_b32 v23, a155
    v_accvgpr_read_b32 v24, a156
    v_accvgpr_read_b32 v25, a157
    v_accvgpr_read_b32 v26, a158
    v_accvgpr_read_b32 v27, a159
    v_cvt_pk_bf16_f32 v36, v20, v21
    v_cvt_pk_bf16_f32 v37, v22, v23
    v_cvt_pk_bf16_f32 v38, v24, v25
    v_cvt_pk_bf16_f32 v39, v26, v27
    buffer_store_dwordx4 v[36:39], v251, s[4:7], s53 offen offset:3072 sc1
    s_add_u32 s53, s53, s22
    v_accvgpr_read_b32 v40, a160
    v_accvgpr_read_b32 v41, a161
    v_accvgpr_read_b32 v42, a162
    v_accvgpr_read_b32 v43, a163
    v_accvgpr_read_b32 v44, a164
    v_accvgpr_read_b32 v45, a165
    v_accvgpr_read_b32 v46, a166
    v_accvgpr_read_b32 v47, a167
    v_cvt_pk_bf16_f32 v56, v40, v41
    v_cvt_pk_bf16_f32 v57, v42, v43
    v_cvt_pk_bf16_f32 v58, v44, v45
    v_cvt_pk_bf16_f32 v59, v46, v47
    buffer_store_dwordx4 v[56:59], v251, s[4:7], s53 offen offset:0 sc1
    v_accvgpr_read_b32 v0, a168
    v_accvgpr_read_b32 v1, a169
    v_accvgpr_read_b32 v2, a170
    v_accvgpr_read_b32 v3, a171
    v_accvgpr_read_b32 v4, a172
    v_accvgpr_read_b32 v5, a173
    v_accvgpr_read_b32 v6, a174
    v_accvgpr_read_b32 v7, a175
    v_cvt_pk_bf16_f32 v16, v0, v1
    v_cvt_pk_bf16_f32 v17, v2, v3
    v_cvt_pk_bf16_f32 v18, v4, v5
    v_cvt_pk_bf16_f32 v19, v6, v7
    buffer_store_dwordx4 v[16:19], v251, s[4:7], s53 offen offset:1024 sc1
    v_accvgpr_read_b32 v20, a176
    v_accvgpr_read_b32 v21, a177
    v_accvgpr_read_b32 v22, a178
    v_accvgpr_read_b32 v23, a179
    v_accvgpr_read_b32 v24, a180
    v_accvgpr_read_b32 v25, a181
    v_accvgpr_read_b32 v26, a182
    v_accvgpr_read_b32 v27, a183
    v_cvt_pk_bf16_f32 v36, v20, v21
    v_cvt_pk_bf16_f32 v37, v22, v23
    v_cvt_pk_bf16_f32 v38, v24, v25
    v_cvt_pk_bf16_f32 v39, v26, v27
    buffer_store_dwordx4 v[36:39], v251, s[4:7], s53 offen offset:2048 sc1
    v_accvgpr_read_b32 v40, a184
    v_accvgpr_read_b32 v41, a185
    v_accvgpr_read_b32 v42, a186
    v_accvgpr_read_b32 v43, a187
    v_accvgpr_read_b32 v44, a188
    v_accvgpr_read_b32 v45, a189
    v_accvgpr_read_b32 v46, a190
    v_accvgpr_read_b32 v47, a191
    v_cvt_pk_bf16_f32 v56, v40, v41
    v_cvt_pk_bf16_f32 v57, v42, v43
    v_cvt_pk_bf16_f32 v58, v44, v45
    v_cvt_pk_bf16_f32 v59, v46, v47
    buffer_store_dwordx4 v[56:59], v251, s[4:7], s53 offen offset:3072 sc1
    s_add_u32 s53, s53, s22
    v_accvgpr_read_b32 v0, a192
    v_accvgpr_read_b32 v1, a193
    v_accvgpr_read_b32 v2, a194
    v_accvgpr_read_b32 v3, a195
    v_accvgpr_read_b32 v4, a196
    v_accvgpr_read_b32 v5, a197
    v_accvgpr_read_b32 v6, a198
    v_accvgpr_read_b32 v7, a199
    v_cvt_pk_bf16_f32 v16, v0, v1
    v_cvt_pk_bf16_f32 v17, v2, v3
    v_cvt_pk_bf16_f32 v18, v4, v5
    v_cvt_pk_bf16_f32 v19, v6, v7
    buffer_store_dwordx4 v[16:19], v251, s[4:7], s53 offen offset:0 sc1
    v_accvgpr_read_b32 v20, a200
    v_accvgpr_read_b32 v21, a201
    v_accvgpr_read_b32 v22, a202
    v_accvgpr_read_b32 v23, a203
    v_accvgpr_read_b32 v24, a204
    v_accvgpr_read_b32 v25, a205
    v_accvgpr_read_b32 v26, a206
    v_accvgpr_read_b32 v27, a207
    v_cvt_pk_bf16_f32 v36, v20, v21
    v_cvt_pk_bf16_f32 v37, v22, v23
    v_cvt_pk_bf16_f32 v38, v24, v25
    v_cvt_pk_bf16_f32 v39, v26, v27
    buffer_store_dwordx4 v[36:39], v251, s[4:7], s53 offen offset:1024 sc1
    v_accvgpr_read_b32 v40, a208
    v_accvgpr_read_b32 v41, a209
    v_accvgpr_read_b32 v42, a210
    v_accvgpr_read_b32 v43, a211
    v_accvgpr_read_b32 v44, a212
    v_accvgpr_read_b32 v45, a213
    v_accvgpr_read_b32 v46, a214
    v_accvgpr_read_b32 v47, a215
    v_cvt_pk_bf16_f32 v56, v40, v41
    v_cvt_pk_bf16_f32 v57, v42, v43
    v_cvt_pk_bf16_f32 v58, v44, v45
    v_cvt_pk_bf16_f32 v59, v46, v47
    buffer_store_dwordx4 v[56:59], v251, s[4:7], s53 offen offset:2048 sc1
    v_accvgpr_read_b32 v0, a216
    v_accvgpr_read_b32 v1, a217
    v_accvgpr_read_b32 v2, a218
    v_accvgpr_read_b32 v3, a219
    v_accvgpr_read_b32 v4, a220
    v_accvgpr_read_b32 v5, a221
    v_accvgpr_read_b32 v6, a222
    v_accvgpr_read_b32 v7, a223
    v_cvt_pk_bf16_f32 v16, v0, v1
    v_cvt_pk_bf16_f32 v17, v2, v3
    v_cvt_pk_bf16_f32 v18, v4, v5
    v_cvt_pk_bf16_f32 v19, v6, v7
    buffer_store_dwordx4 v[16:19], v251, s[4:7], s53 offen offset:3072 sc1
    s_add_u32 s53, s53, s22
    v_accvgpr_read_b32 v20, a224
    v_accvgpr_read_b32 v21, a225
    v_accvgpr_read_b32 v22, a226
    v_accvgpr_read_b32 v23, a227
    v_accvgpr_read_b32 v24, a228
    v_accvgpr_read_b32 v25, a229
    v_accvgpr_read_b32 v26, a230
    v_accvgpr_read_b32 v27, a231
    v_cvt_pk_bf16_f32 v36, v20, v21
    v_cvt_pk_bf16_f32 v37, v22, v23
    v_cvt_pk_bf16_f32 v38, v24, v25
    v_cvt_pk_bf16_f32 v39, v26, v27
    buffer_store_dwordx4 v[36:39], v251, s[4:7], s53 offen offset:0 sc1
    v_accvgpr_read_b32 v40, a232
    v_accvgpr_read_b32 v41, a233
    v_accvgpr_read_b32 v42, a234
    v_accvgpr_read_b32 v43, a235
    v_accvgpr_read_b32 v44, a236
    v_accvgpr_read_b32 v45, a237
    v_accvgpr_read_b32 v46, a238
    v_accvgpr_read_b32 v47, a239
    v_cvt_pk_bf16_f32 v56, v40, v41
    v_cvt_pk_bf16_f32 v57, v42, v43
    v_cvt_pk_bf16_f32 v58, v44, v45
    v_cvt_pk_bf16_f32 v59, v46, v47
    buffer_store_dwordx4 v[56:59], v251, s[4:7], s53 offen offset:1024 sc1
    v_accvgpr_read_b32 v0, a240
    v_accvgpr_read_b32 v1, a241
    v_accvgpr_read_b32 v2, a242
    v_accvgpr_read_b32 v3, a243
    v_accvgpr_read_b32 v4, a244
    v_accvgpr_read_b32 v5, a245
    v_accvgpr_read_b32 v6, a246
    v_accvgpr_read_b32 v7, a247
    v_cvt_pk_bf16_f32 v16, v0, v1
    v_cvt_pk_bf16_f32 v17, v2, v3
    v_cvt_pk_bf16_f32 v18, v4, v5
    v_cvt_pk_bf16_f32 v19, v6, v7
    buffer_store_dwordx4 v[16:19], v251, s[4:7], s53 offen offset:2048 sc1
    v_accvgpr_read_b32 v20, a248
    v_accvgpr_read_b32 v21, a249
    v_accvgpr_read_b32 v22, a250
    v_accvgpr_read_b32 v23, a251
    v_accvgpr_read_b32 v24, a252
    v_accvgpr_read_b32 v25, a253
    v_accvgpr_read_b32 v26, a254
    v_accvgpr_read_b32 v27, a255
    v_cvt_pk_bf16_f32 v36, v20, v21
    v_cvt_pk_bf16_f32 v37, v22, v23
    v_cvt_pk_bf16_f32 v38, v24, v25
    v_cvt_pk_bf16_f32 v39, v26, v27
    buffer_store_dwordx4 v[36:39], v251, s[4:7], s53 offen offset:3072 sc1
    s_branch main_kernel_w_done
main_kernel_w_c2_escl:
    s_mov_b32 s53, s21
    v_accvgpr_read_b32 v0, a0
    v_accvgpr_read_b32 v1, a1
    v_accvgpr_read_b32 v2, a2
    v_accvgpr_read_b32 v3, a3
    v_accvgpr_read_b32 v4, a4
    v_accvgpr_read_b32 v5, a5
    v_accvgpr_read_b32 v6, a6
    v_accvgpr_read_b32 v7, a7
    v_mul_f32 v0, 0x3e0293ee, v0
    v_mul_f32 v1, 0x3e0293ee, v1
    v_mul_f32 v2, 0x3e0293ee, v2
    v_mul_f32 v3, 0x3e0293ee, v3
    v_mul_f32 v4, 0x3e0293ee, v4
    v_mul_f32 v5, 0x3e0293ee, v5
    v_mul_f32 v6, 0x3e0293ee, v6
    v_mul_f32 v7, 0x3e0293ee, v7
    v_cvt_pk_bf16_f32 v16, v0, v1
    v_cvt_pk_bf16_f32 v17, v2, v3
    v_cvt_pk_bf16_f32 v18, v4, v5
    v_cvt_pk_bf16_f32 v19, v6, v7
    buffer_store_dwordx4 v[16:19], v251, s[4:7], s53 offen offset:0 sc1
    v_accvgpr_read_b32 v20, a8
    v_accvgpr_read_b32 v21, a9
    v_accvgpr_read_b32 v22, a10
    v_accvgpr_read_b32 v23, a11
    v_accvgpr_read_b32 v24, a12
    v_accvgpr_read_b32 v25, a13
    v_accvgpr_read_b32 v26, a14
    v_accvgpr_read_b32 v27, a15
    v_mul_f32 v20, 0x3e0293ee, v20
    v_mul_f32 v21, 0x3e0293ee, v21
    v_mul_f32 v22, 0x3e0293ee, v22
    v_mul_f32 v23, 0x3e0293ee, v23
    v_mul_f32 v24, 0x3e0293ee, v24
    v_mul_f32 v25, 0x3e0293ee, v25
    v_mul_f32 v26, 0x3e0293ee, v26
    v_mul_f32 v27, 0x3e0293ee, v27
    v_cvt_pk_bf16_f32 v36, v20, v21
    v_cvt_pk_bf16_f32 v37, v22, v23
    v_cvt_pk_bf16_f32 v38, v24, v25
    v_cvt_pk_bf16_f32 v39, v26, v27
    buffer_store_dwordx4 v[36:39], v251, s[4:7], s53 offen offset:1024 sc1
    v_accvgpr_read_b32 v40, a16
    v_accvgpr_read_b32 v41, a17
    v_accvgpr_read_b32 v42, a18
    v_accvgpr_read_b32 v43, a19
    v_accvgpr_read_b32 v44, a20
    v_accvgpr_read_b32 v45, a21
    v_accvgpr_read_b32 v46, a22
    v_accvgpr_read_b32 v47, a23
    v_mul_f32 v40, 0x3e0293ee, v40
    v_mul_f32 v41, 0x3e0293ee, v41
    v_mul_f32 v42, 0x3e0293ee, v42
    v_mul_f32 v43, 0x3e0293ee, v43
    v_mul_f32 v44, 0x3e0293ee, v44
    v_mul_f32 v45, 0x3e0293ee, v45
    v_mul_f32 v46, 0x3e0293ee, v46
    v_mul_f32 v47, 0x3e0293ee, v47
    v_cvt_pk_bf16_f32 v56, v40, v41
    v_cvt_pk_bf16_f32 v57, v42, v43
    v_cvt_pk_bf16_f32 v58, v44, v45
    v_cvt_pk_bf16_f32 v59, v46, v47
    buffer_store_dwordx4 v[56:59], v251, s[4:7], s53 offen offset:2048 sc1
    v_accvgpr_read_b32 v0, a24
    v_accvgpr_read_b32 v1, a25
    v_accvgpr_read_b32 v2, a26
    v_accvgpr_read_b32 v3, a27
    v_accvgpr_read_b32 v4, a28
    v_accvgpr_read_b32 v5, a29
    v_accvgpr_read_b32 v6, a30
    v_accvgpr_read_b32 v7, a31
    v_mul_f32 v0, 0x3e0293ee, v0
    v_mul_f32 v1, 0x3e0293ee, v1
    v_mul_f32 v2, 0x3e0293ee, v2
    v_mul_f32 v3, 0x3e0293ee, v3
    v_mul_f32 v4, 0x3e0293ee, v4
    v_mul_f32 v5, 0x3e0293ee, v5
    v_mul_f32 v6, 0x3e0293ee, v6
    v_mul_f32 v7, 0x3e0293ee, v7
    v_cvt_pk_bf16_f32 v16, v0, v1
    v_cvt_pk_bf16_f32 v17, v2, v3
    v_cvt_pk_bf16_f32 v18, v4, v5
    v_cvt_pk_bf16_f32 v19, v6, v7
    buffer_store_dwordx4 v[16:19], v251, s[4:7], s53 offen offset:3072 sc1
    s_add_u32 s53, s53, s22
    v_accvgpr_read_b32 v20, a32
    v_accvgpr_read_b32 v21, a33
    v_accvgpr_read_b32 v22, a34
    v_accvgpr_read_b32 v23, a35
    v_accvgpr_read_b32 v24, a36
    v_accvgpr_read_b32 v25, a37
    v_accvgpr_read_b32 v26, a38
    v_accvgpr_read_b32 v27, a39
    v_mul_f32 v20, 0x3e0293ee, v20
    v_mul_f32 v21, 0x3e0293ee, v21
    v_mul_f32 v22, 0x3e0293ee, v22
    v_mul_f32 v23, 0x3e0293ee, v23
    v_mul_f32 v24, 0x3e0293ee, v24
    v_mul_f32 v25, 0x3e0293ee, v25
    v_mul_f32 v26, 0x3e0293ee, v26
    v_mul_f32 v27, 0x3e0293ee, v27
    v_cvt_pk_bf16_f32 v36, v20, v21
    v_cvt_pk_bf16_f32 v37, v22, v23
    v_cvt_pk_bf16_f32 v38, v24, v25
    v_cvt_pk_bf16_f32 v39, v26, v27
    buffer_store_dwordx4 v[36:39], v251, s[4:7], s53 offen offset:0 sc1
    v_accvgpr_read_b32 v40, a40
    v_accvgpr_read_b32 v41, a41
    v_accvgpr_read_b32 v42, a42
    v_accvgpr_read_b32 v43, a43
    v_accvgpr_read_b32 v44, a44
    v_accvgpr_read_b32 v45, a45
    v_accvgpr_read_b32 v46, a46
    v_accvgpr_read_b32 v47, a47
    v_mul_f32 v40, 0x3e0293ee, v40
    v_mul_f32 v41, 0x3e0293ee, v41
    v_mul_f32 v42, 0x3e0293ee, v42
    v_mul_f32 v43, 0x3e0293ee, v43
    v_mul_f32 v44, 0x3e0293ee, v44
    v_mul_f32 v45, 0x3e0293ee, v45
    v_mul_f32 v46, 0x3e0293ee, v46
    v_mul_f32 v47, 0x3e0293ee, v47
    v_cvt_pk_bf16_f32 v56, v40, v41
    v_cvt_pk_bf16_f32 v57, v42, v43
    v_cvt_pk_bf16_f32 v58, v44, v45
    v_cvt_pk_bf16_f32 v59, v46, v47
    buffer_store_dwordx4 v[56:59], v251, s[4:7], s53 offen offset:1024 sc1
    v_accvgpr_read_b32 v0, a48
    v_accvgpr_read_b32 v1, a49
    v_accvgpr_read_b32 v2, a50
    v_accvgpr_read_b32 v3, a51
    v_accvgpr_read_b32 v4, a52
    v_accvgpr_read_b32 v5, a53
    v_accvgpr_read_b32 v6, a54
    v_accvgpr_read_b32 v7, a55
    v_mul_f32 v0, 0x3e0293ee, v0
    v_mul_f32 v1, 0x3e0293ee, v1
    v_mul_f32 v2, 0x3e0293ee, v2
    v_mul_f32 v3, 0x3e0293ee, v3
    v_mul_f32 v4, 0x3e0293ee, v4
    v_mul_f32 v5, 0x3e0293ee, v5
    v_mul_f32 v6, 0x3e0293ee, v6
    v_mul_f32 v7, 0x3e0293ee, v7
    v_cvt_pk_bf16_f32 v16, v0, v1
    v_cvt_pk_bf16_f32 v17, v2, v3
    v_cvt_pk_bf16_f32 v18, v4, v5
    v_cvt_pk_bf16_f32 v19, v6, v7
    buffer_store_dwordx4 v[16:19], v251, s[4:7], s53 offen offset:2048 sc1
    v_accvgpr_read_b32 v20, a56
    v_accvgpr_read_b32 v21, a57
    v_accvgpr_read_b32 v22, a58
    v_accvgpr_read_b32 v23, a59
    v_accvgpr_read_b32 v24, a60
    v_accvgpr_read_b32 v25, a61
    v_accvgpr_read_b32 v26, a62
    v_accvgpr_read_b32 v27, a63
    v_mul_f32 v20, 0x3e0293ee, v20
    v_mul_f32 v21, 0x3e0293ee, v21
    v_mul_f32 v22, 0x3e0293ee, v22
    v_mul_f32 v23, 0x3e0293ee, v23
    v_mul_f32 v24, 0x3e0293ee, v24
    v_mul_f32 v25, 0x3e0293ee, v25
    v_mul_f32 v26, 0x3e0293ee, v26
    v_mul_f32 v27, 0x3e0293ee, v27
    v_cvt_pk_bf16_f32 v36, v20, v21
    v_cvt_pk_bf16_f32 v37, v22, v23
    v_cvt_pk_bf16_f32 v38, v24, v25
    v_cvt_pk_bf16_f32 v39, v26, v27
    buffer_store_dwordx4 v[36:39], v251, s[4:7], s53 offen offset:3072 sc1
    s_add_u32 s53, s53, s22
    v_accvgpr_read_b32 v40, a64
    v_accvgpr_read_b32 v41, a65
    v_accvgpr_read_b32 v42, a66
    v_accvgpr_read_b32 v43, a67
    v_accvgpr_read_b32 v44, a68
    v_accvgpr_read_b32 v45, a69
    v_accvgpr_read_b32 v46, a70
    v_accvgpr_read_b32 v47, a71
    v_mul_f32 v40, 0x3e0293ee, v40
    v_mul_f32 v41, 0x3e0293ee, v41
    v_mul_f32 v42, 0x3e0293ee, v42
    v_mul_f32 v43, 0x3e0293ee, v43
    v_mul_f32 v44, 0x3e0293ee, v44
    v_mul_f32 v45, 0x3e0293ee, v45
    v_mul_f32 v46, 0x3e0293ee, v46
    v_mul_f32 v47, 0x3e0293ee, v47
    v_cvt_pk_bf16_f32 v56, v40, v41
    v_cvt_pk_bf16_f32 v57, v42, v43
    v_cvt_pk_bf16_f32 v58, v44, v45
    v_cvt_pk_bf16_f32 v59, v46, v47
    buffer_store_dwordx4 v[56:59], v251, s[4:7], s53 offen offset:0 sc1
    v_accvgpr_read_b32 v0, a72
    v_accvgpr_read_b32 v1, a73
    v_accvgpr_read_b32 v2, a74
    v_accvgpr_read_b32 v3, a75
    v_accvgpr_read_b32 v4, a76
    v_accvgpr_read_b32 v5, a77
    v_accvgpr_read_b32 v6, a78
    v_accvgpr_read_b32 v7, a79
    v_mul_f32 v0, 0x3e0293ee, v0
    v_mul_f32 v1, 0x3e0293ee, v1
    v_mul_f32 v2, 0x3e0293ee, v2
    v_mul_f32 v3, 0x3e0293ee, v3
    v_mul_f32 v4, 0x3e0293ee, v4
    v_mul_f32 v5, 0x3e0293ee, v5
    v_mul_f32 v6, 0x3e0293ee, v6
    v_mul_f32 v7, 0x3e0293ee, v7
    v_cvt_pk_bf16_f32 v16, v0, v1
    v_cvt_pk_bf16_f32 v17, v2, v3
    v_cvt_pk_bf16_f32 v18, v4, v5
    v_cvt_pk_bf16_f32 v19, v6, v7
    buffer_store_dwordx4 v[16:19], v251, s[4:7], s53 offen offset:1024 sc1
    v_accvgpr_read_b32 v20, a80
    v_accvgpr_read_b32 v21, a81
    v_accvgpr_read_b32 v22, a82
    v_accvgpr_read_b32 v23, a83
    v_accvgpr_read_b32 v24, a84
    v_accvgpr_read_b32 v25, a85
    v_accvgpr_read_b32 v26, a86
    v_accvgpr_read_b32 v27, a87
    v_mul_f32 v20, 0x3e0293ee, v20
    v_mul_f32 v21, 0x3e0293ee, v21
    v_mul_f32 v22, 0x3e0293ee, v22
    v_mul_f32 v23, 0x3e0293ee, v23
    v_mul_f32 v24, 0x3e0293ee, v24
    v_mul_f32 v25, 0x3e0293ee, v25
    v_mul_f32 v26, 0x3e0293ee, v26
    v_mul_f32 v27, 0x3e0293ee, v27
    v_cvt_pk_bf16_f32 v36, v20, v21
    v_cvt_pk_bf16_f32 v37, v22, v23
    v_cvt_pk_bf16_f32 v38, v24, v25
    v_cvt_pk_bf16_f32 v39, v26, v27
    buffer_store_dwordx4 v[36:39], v251, s[4:7], s53 offen offset:2048 sc1
    v_accvgpr_read_b32 v40, a88
    v_accvgpr_read_b32 v41, a89
    v_accvgpr_read_b32 v42, a90
    v_accvgpr_read_b32 v43, a91
    v_accvgpr_read_b32 v44, a92
    v_accvgpr_read_b32 v45, a93
    v_accvgpr_read_b32 v46, a94
    v_accvgpr_read_b32 v47, a95
    v_mul_f32 v40, 0x3e0293ee, v40
    v_mul_f32 v41, 0x3e0293ee, v41
    v_mul_f32 v42, 0x3e0293ee, v42
    v_mul_f32 v43, 0x3e0293ee, v43
    v_mul_f32 v44, 0x3e0293ee, v44
    v_mul_f32 v45, 0x3e0293ee, v45
    v_mul_f32 v46, 0x3e0293ee, v46
    v_mul_f32 v47, 0x3e0293ee, v47
    v_cvt_pk_bf16_f32 v56, v40, v41
    v_cvt_pk_bf16_f32 v57, v42, v43
    v_cvt_pk_bf16_f32 v58, v44, v45
    v_cvt_pk_bf16_f32 v59, v46, v47
    buffer_store_dwordx4 v[56:59], v251, s[4:7], s53 offen offset:3072 sc1
    s_add_u32 s53, s53, s22
    v_accvgpr_read_b32 v0, a96
    v_accvgpr_read_b32 v1, a97
    v_accvgpr_read_b32 v2, a98
    v_accvgpr_read_b32 v3, a99
    v_accvgpr_read_b32 v4, a100
    v_accvgpr_read_b32 v5, a101
    v_accvgpr_read_b32 v6, a102
    v_accvgpr_read_b32 v7, a103
    v_mul_f32 v0, 0x3e0293ee, v0
    v_mul_f32 v1, 0x3e0293ee, v1
    v_mul_f32 v2, 0x3e0293ee, v2
    v_mul_f32 v3, 0x3e0293ee, v3
    v_mul_f32 v4, 0x3e0293ee, v4
    v_mul_f32 v5, 0x3e0293ee, v5
    v_mul_f32 v6, 0x3e0293ee, v6
    v_mul_f32 v7, 0x3e0293ee, v7
    v_cvt_pk_bf16_f32 v16, v0, v1
    v_cvt_pk_bf16_f32 v17, v2, v3
    v_cvt_pk_bf16_f32 v18, v4, v5
    v_cvt_pk_bf16_f32 v19, v6, v7
    buffer_store_dwordx4 v[16:19], v251, s[4:7], s53 offen offset:0 sc1
    v_accvgpr_read_b32 v20, a104
    v_accvgpr_read_b32 v21, a105
    v_accvgpr_read_b32 v22, a106
    v_accvgpr_read_b32 v23, a107
    v_accvgpr_read_b32 v24, a108
    v_accvgpr_read_b32 v25, a109
    v_accvgpr_read_b32 v26, a110
    v_accvgpr_read_b32 v27, a111
    v_mul_f32 v20, 0x3e0293ee, v20
    v_mul_f32 v21, 0x3e0293ee, v21
    v_mul_f32 v22, 0x3e0293ee, v22
    v_mul_f32 v23, 0x3e0293ee, v23
    v_mul_f32 v24, 0x3e0293ee, v24
    v_mul_f32 v25, 0x3e0293ee, v25
    v_mul_f32 v26, 0x3e0293ee, v26
    v_mul_f32 v27, 0x3e0293ee, v27
    v_cvt_pk_bf16_f32 v36, v20, v21
    v_cvt_pk_bf16_f32 v37, v22, v23
    v_cvt_pk_bf16_f32 v38, v24, v25
    v_cvt_pk_bf16_f32 v39, v26, v27
    buffer_store_dwordx4 v[36:39], v251, s[4:7], s53 offen offset:1024 sc1
    v_accvgpr_read_b32 v40, a112
    v_accvgpr_read_b32 v41, a113
    v_accvgpr_read_b32 v42, a114
    v_accvgpr_read_b32 v43, a115
    v_accvgpr_read_b32 v44, a116
    v_accvgpr_read_b32 v45, a117
    v_accvgpr_read_b32 v46, a118
    v_accvgpr_read_b32 v47, a119
    v_mul_f32 v40, 0x3e0293ee, v40
    v_mul_f32 v41, 0x3e0293ee, v41
    v_mul_f32 v42, 0x3e0293ee, v42
    v_mul_f32 v43, 0x3e0293ee, v43
    v_mul_f32 v44, 0x3e0293ee, v44
    v_mul_f32 v45, 0x3e0293ee, v45
    v_mul_f32 v46, 0x3e0293ee, v46
    v_mul_f32 v47, 0x3e0293ee, v47
    v_cvt_pk_bf16_f32 v56, v40, v41
    v_cvt_pk_bf16_f32 v57, v42, v43
    v_cvt_pk_bf16_f32 v58, v44, v45
    v_cvt_pk_bf16_f32 v59, v46, v47
    buffer_store_dwordx4 v[56:59], v251, s[4:7], s53 offen offset:2048 sc1
    v_accvgpr_read_b32 v0, a120
    v_accvgpr_read_b32 v1, a121
    v_accvgpr_read_b32 v2, a122
    v_accvgpr_read_b32 v3, a123
    v_accvgpr_read_b32 v4, a124
    v_accvgpr_read_b32 v5, a125
    v_accvgpr_read_b32 v6, a126
    v_accvgpr_read_b32 v7, a127
    v_mul_f32 v0, 0x3e0293ee, v0
    v_mul_f32 v1, 0x3e0293ee, v1
    v_mul_f32 v2, 0x3e0293ee, v2
    v_mul_f32 v3, 0x3e0293ee, v3
    v_mul_f32 v4, 0x3e0293ee, v4
    v_mul_f32 v5, 0x3e0293ee, v5
    v_mul_f32 v6, 0x3e0293ee, v6
    v_mul_f32 v7, 0x3e0293ee, v7
    v_cvt_pk_bf16_f32 v16, v0, v1
    v_cvt_pk_bf16_f32 v17, v2, v3
    v_cvt_pk_bf16_f32 v18, v4, v5
    v_cvt_pk_bf16_f32 v19, v6, v7
    buffer_store_dwordx4 v[16:19], v251, s[4:7], s53 offen offset:3072 sc1
    s_add_u32 s53, s53, s22
    v_accvgpr_read_b32 v20, a128
    v_accvgpr_read_b32 v21, a129
    v_accvgpr_read_b32 v22, a130
    v_accvgpr_read_b32 v23, a131
    v_accvgpr_read_b32 v24, a132
    v_accvgpr_read_b32 v25, a133
    v_accvgpr_read_b32 v26, a134
    v_accvgpr_read_b32 v27, a135
    v_mul_f32 v20, 0x3e0293ee, v20
    v_mul_f32 v21, 0x3e0293ee, v21
    v_mul_f32 v22, 0x3e0293ee, v22
    v_mul_f32 v23, 0x3e0293ee, v23
    v_mul_f32 v24, 0x3e0293ee, v24
    v_mul_f32 v25, 0x3e0293ee, v25
    v_mul_f32 v26, 0x3e0293ee, v26
    v_mul_f32 v27, 0x3e0293ee, v27
    v_cvt_pk_bf16_f32 v36, v20, v21
    v_cvt_pk_bf16_f32 v37, v22, v23
    v_cvt_pk_bf16_f32 v38, v24, v25
    v_cvt_pk_bf16_f32 v39, v26, v27
    buffer_store_dwordx4 v[36:39], v251, s[4:7], s53 offen offset:0 sc1
    v_accvgpr_read_b32 v40, a136
    v_accvgpr_read_b32 v41, a137
    v_accvgpr_read_b32 v42, a138
    v_accvgpr_read_b32 v43, a139
    v_accvgpr_read_b32 v44, a140
    v_accvgpr_read_b32 v45, a141
    v_accvgpr_read_b32 v46, a142
    v_accvgpr_read_b32 v47, a143
    v_mul_f32 v40, 0x3e0293ee, v40
    v_mul_f32 v41, 0x3e0293ee, v41
    v_mul_f32 v42, 0x3e0293ee, v42
    v_mul_f32 v43, 0x3e0293ee, v43
    v_mul_f32 v44, 0x3e0293ee, v44
    v_mul_f32 v45, 0x3e0293ee, v45
    v_mul_f32 v46, 0x3e0293ee, v46
    v_mul_f32 v47, 0x3e0293ee, v47
    v_cvt_pk_bf16_f32 v56, v40, v41
    v_cvt_pk_bf16_f32 v57, v42, v43
    v_cvt_pk_bf16_f32 v58, v44, v45
    v_cvt_pk_bf16_f32 v59, v46, v47
    buffer_store_dwordx4 v[56:59], v251, s[4:7], s53 offen offset:1024 sc1
    v_accvgpr_read_b32 v0, a144
    v_accvgpr_read_b32 v1, a145
    v_accvgpr_read_b32 v2, a146
    v_accvgpr_read_b32 v3, a147
    v_accvgpr_read_b32 v4, a148
    v_accvgpr_read_b32 v5, a149
    v_accvgpr_read_b32 v6, a150
    v_accvgpr_read_b32 v7, a151
    v_mul_f32 v0, 0x3e0293ee, v0
    v_mul_f32 v1, 0x3e0293ee, v1
    v_mul_f32 v2, 0x3e0293ee, v2
    v_mul_f32 v3, 0x3e0293ee, v3
    v_mul_f32 v4, 0x3e0293ee, v4
    v_mul_f32 v5, 0x3e0293ee, v5
    v_mul_f32 v6, 0x3e0293ee, v6
    v_mul_f32 v7, 0x3e0293ee, v7
    v_cvt_pk_bf16_f32 v16, v0, v1
    v_cvt_pk_bf16_f32 v17, v2, v3
    v_cvt_pk_bf16_f32 v18, v4, v5
    v_cvt_pk_bf16_f32 v19, v6, v7
    buffer_store_dwordx4 v[16:19], v251, s[4:7], s53 offen offset:2048 sc1
    v_accvgpr_read_b32 v20, a152
    v_accvgpr_read_b32 v21, a153
    v_accvgpr_read_b32 v22, a154
    v_accvgpr_read_b32 v23, a155
    v_accvgpr_read_b32 v24, a156
    v_accvgpr_read_b32 v25, a157
    v_accvgpr_read_b32 v26, a158
    v_accvgpr_read_b32 v27, a159
    v_mul_f32 v20, 0x3e0293ee, v20
    v_mul_f32 v21, 0x3e0293ee, v21
    v_mul_f32 v22, 0x3e0293ee, v22
    v_mul_f32 v23, 0x3e0293ee, v23
    v_mul_f32 v24, 0x3e0293ee, v24
    v_mul_f32 v25, 0x3e0293ee, v25
    v_mul_f32 v26, 0x3e0293ee, v26
    v_mul_f32 v27, 0x3e0293ee, v27
    v_cvt_pk_bf16_f32 v36, v20, v21
    v_cvt_pk_bf16_f32 v37, v22, v23
    v_cvt_pk_bf16_f32 v38, v24, v25
    v_cvt_pk_bf16_f32 v39, v26, v27
    buffer_store_dwordx4 v[36:39], v251, s[4:7], s53 offen offset:3072 sc1
    s_add_u32 s53, s53, s22
    v_accvgpr_read_b32 v40, a160
    v_accvgpr_read_b32 v41, a161
    v_accvgpr_read_b32 v42, a162
    v_accvgpr_read_b32 v43, a163
    v_accvgpr_read_b32 v44, a164
    v_accvgpr_read_b32 v45, a165
    v_accvgpr_read_b32 v46, a166
    v_accvgpr_read_b32 v47, a167
    v_mul_f32 v40, 0x3e0293ee, v40
    v_mul_f32 v41, 0x3e0293ee, v41
    v_mul_f32 v42, 0x3e0293ee, v42
    v_mul_f32 v43, 0x3e0293ee, v43
    v_mul_f32 v44, 0x3e0293ee, v44
    v_mul_f32 v45, 0x3e0293ee, v45
    v_mul_f32 v46, 0x3e0293ee, v46
    v_mul_f32 v47, 0x3e0293ee, v47
    v_cvt_pk_bf16_f32 v56, v40, v41
    v_cvt_pk_bf16_f32 v57, v42, v43
    v_cvt_pk_bf16_f32 v58, v44, v45
    v_cvt_pk_bf16_f32 v59, v46, v47
    buffer_store_dwordx4 v[56:59], v251, s[4:7], s53 offen offset:0 sc1
    v_accvgpr_read_b32 v0, a168
    v_accvgpr_read_b32 v1, a169
    v_accvgpr_read_b32 v2, a170
    v_accvgpr_read_b32 v3, a171
    v_accvgpr_read_b32 v4, a172
    v_accvgpr_read_b32 v5, a173
    v_accvgpr_read_b32 v6, a174
    v_accvgpr_read_b32 v7, a175
    v_mul_f32 v0, 0x3e0293ee, v0
    v_mul_f32 v1, 0x3e0293ee, v1
    v_mul_f32 v2, 0x3e0293ee, v2
    v_mul_f32 v3, 0x3e0293ee, v3
    v_mul_f32 v4, 0x3e0293ee, v4
    v_mul_f32 v5, 0x3e0293ee, v5
    v_mul_f32 v6, 0x3e0293ee, v6
    v_mul_f32 v7, 0x3e0293ee, v7
    v_cvt_pk_bf16_f32 v16, v0, v1
    v_cvt_pk_bf16_f32 v17, v2, v3
    v_cvt_pk_bf16_f32 v18, v4, v5
    v_cvt_pk_bf16_f32 v19, v6, v7
    buffer_store_dwordx4 v[16:19], v251, s[4:7], s53 offen offset:1024 sc1
    v_accvgpr_read_b32 v20, a176
    v_accvgpr_read_b32 v21, a177
    v_accvgpr_read_b32 v22, a178
    v_accvgpr_read_b32 v23, a179
    v_accvgpr_read_b32 v24, a180
    v_accvgpr_read_b32 v25, a181
    v_accvgpr_read_b32 v26, a182
    v_accvgpr_read_b32 v27, a183
    v_mul_f32 v20, 0x3e0293ee, v20
    v_mul_f32 v21, 0x3e0293ee, v21
    v_mul_f32 v22, 0x3e0293ee, v22
    v_mul_f32 v23, 0x3e0293ee, v23
    v_mul_f32 v24, 0x3e0293ee, v24
    v_mul_f32 v25, 0x3e0293ee, v25
    v_mul_f32 v26, 0x3e0293ee, v26
    v_mul_f32 v27, 0x3e0293ee, v27
    v_cvt_pk_bf16_f32 v36, v20, v21
    v_cvt_pk_bf16_f32 v37, v22, v23
    v_cvt_pk_bf16_f32 v38, v24, v25
    v_cvt_pk_bf16_f32 v39, v26, v27
    buffer_store_dwordx4 v[36:39], v251, s[4:7], s53 offen offset:2048 sc1
    v_accvgpr_read_b32 v40, a184
    v_accvgpr_read_b32 v41, a185
    v_accvgpr_read_b32 v42, a186
    v_accvgpr_read_b32 v43, a187
    v_accvgpr_read_b32 v44, a188
    v_accvgpr_read_b32 v45, a189
    v_accvgpr_read_b32 v46, a190
    v_accvgpr_read_b32 v47, a191
    v_mul_f32 v40, 0x3e0293ee, v40
    v_mul_f32 v41, 0x3e0293ee, v41
    v_mul_f32 v42, 0x3e0293ee, v42
    v_mul_f32 v43, 0x3e0293ee, v43
    v_mul_f32 v44, 0x3e0293ee, v44
    v_mul_f32 v45, 0x3e0293ee, v45
    v_mul_f32 v46, 0x3e0293ee, v46
    v_mul_f32 v47, 0x3e0293ee, v47
    v_cvt_pk_bf16_f32 v56, v40, v41
    v_cvt_pk_bf16_f32 v57, v42, v43
    v_cvt_pk_bf16_f32 v58, v44, v45
    v_cvt_pk_bf16_f32 v59, v46, v47
    buffer_store_dwordx4 v[56:59], v251, s[4:7], s53 offen offset:3072 sc1
    s_add_u32 s53, s53, s22
    v_accvgpr_read_b32 v0, a192
    v_accvgpr_read_b32 v1, a193
    v_accvgpr_read_b32 v2, a194
    v_accvgpr_read_b32 v3, a195
    v_accvgpr_read_b32 v4, a196
    v_accvgpr_read_b32 v5, a197
    v_accvgpr_read_b32 v6, a198
    v_accvgpr_read_b32 v7, a199
    v_mul_f32 v0, 0x3e0293ee, v0
    v_mul_f32 v1, 0x3e0293ee, v1
    v_mul_f32 v2, 0x3e0293ee, v2
    v_mul_f32 v3, 0x3e0293ee, v3
    v_mul_f32 v4, 0x3e0293ee, v4
    v_mul_f32 v5, 0x3e0293ee, v5
    v_mul_f32 v6, 0x3e0293ee, v6
    v_mul_f32 v7, 0x3e0293ee, v7
    v_cvt_pk_bf16_f32 v16, v0, v1
    v_cvt_pk_bf16_f32 v17, v2, v3
    v_cvt_pk_bf16_f32 v18, v4, v5
    v_cvt_pk_bf16_f32 v19, v6, v7
    buffer_store_dwordx4 v[16:19], v251, s[4:7], s53 offen offset:0 sc1
    v_accvgpr_read_b32 v20, a200
    v_accvgpr_read_b32 v21, a201
    v_accvgpr_read_b32 v22, a202
    v_accvgpr_read_b32 v23, a203
    v_accvgpr_read_b32 v24, a204
    v_accvgpr_read_b32 v25, a205
    v_accvgpr_read_b32 v26, a206
    v_accvgpr_read_b32 v27, a207
    v_mul_f32 v20, 0x3e0293ee, v20
    v_mul_f32 v21, 0x3e0293ee, v21
    v_mul_f32 v22, 0x3e0293ee, v22
    v_mul_f32 v23, 0x3e0293ee, v23
    v_mul_f32 v24, 0x3e0293ee, v24
    v_mul_f32 v25, 0x3e0293ee, v25
    v_mul_f32 v26, 0x3e0293ee, v26
    v_mul_f32 v27, 0x3e0293ee, v27
    v_cvt_pk_bf16_f32 v36, v20, v21
    v_cvt_pk_bf16_f32 v37, v22, v23
    v_cvt_pk_bf16_f32 v38, v24, v25
    v_cvt_pk_bf16_f32 v39, v26, v27
    buffer_store_dwordx4 v[36:39], v251, s[4:7], s53 offen offset:1024 sc1
    v_accvgpr_read_b32 v40, a208
    v_accvgpr_read_b32 v41, a209
    v_accvgpr_read_b32 v42, a210
    v_accvgpr_read_b32 v43, a211
    v_accvgpr_read_b32 v44, a212
    v_accvgpr_read_b32 v45, a213
    v_accvgpr_read_b32 v46, a214
    v_accvgpr_read_b32 v47, a215
    v_mul_f32 v40, 0x3e0293ee, v40
    v_mul_f32 v41, 0x3e0293ee, v41
    v_mul_f32 v42, 0x3e0293ee, v42
    v_mul_f32 v43, 0x3e0293ee, v43
    v_mul_f32 v44, 0x3e0293ee, v44
    v_mul_f32 v45, 0x3e0293ee, v45
    v_mul_f32 v46, 0x3e0293ee, v46
    v_mul_f32 v47, 0x3e0293ee, v47
    v_cvt_pk_bf16_f32 v56, v40, v41
    v_cvt_pk_bf16_f32 v57, v42, v43
    v_cvt_pk_bf16_f32 v58, v44, v45
    v_cvt_pk_bf16_f32 v59, v46, v47
    buffer_store_dwordx4 v[56:59], v251, s[4:7], s53 offen offset:2048 sc1
    v_accvgpr_read_b32 v0, a216
    v_accvgpr_read_b32 v1, a217
    v_accvgpr_read_b32 v2, a218
    v_accvgpr_read_b32 v3, a219
    v_accvgpr_read_b32 v4, a220
    v_accvgpr_read_b32 v5, a221
    v_accvgpr_read_b32 v6, a222
    v_accvgpr_read_b32 v7, a223
    v_mul_f32 v0, 0x3e0293ee, v0
    v_mul_f32 v1, 0x3e0293ee, v1
    v_mul_f32 v2, 0x3e0293ee, v2
    v_mul_f32 v3, 0x3e0293ee, v3
    v_mul_f32 v4, 0x3e0293ee, v4
    v_mul_f32 v5, 0x3e0293ee, v5
    v_mul_f32 v6, 0x3e0293ee, v6
    v_mul_f32 v7, 0x3e0293ee, v7
    v_cvt_pk_bf16_f32 v16, v0, v1
    v_cvt_pk_bf16_f32 v17, v2, v3
    v_cvt_pk_bf16_f32 v18, v4, v5
    v_cvt_pk_bf16_f32 v19, v6, v7
    buffer_store_dwordx4 v[16:19], v251, s[4:7], s53 offen offset:3072 sc1
    s_add_u32 s53, s53, s22
    v_accvgpr_read_b32 v20, a224
    v_accvgpr_read_b32 v21, a225
    v_accvgpr_read_b32 v22, a226
    v_accvgpr_read_b32 v23, a227
    v_accvgpr_read_b32 v24, a228
    v_accvgpr_read_b32 v25, a229
    v_accvgpr_read_b32 v26, a230
    v_accvgpr_read_b32 v27, a231
    v_mul_f32 v20, 0x3e0293ee, v20
    v_mul_f32 v21, 0x3e0293ee, v21
    v_mul_f32 v22, 0x3e0293ee, v22
    v_mul_f32 v23, 0x3e0293ee, v23
    v_mul_f32 v24, 0x3e0293ee, v24
    v_mul_f32 v25, 0x3e0293ee, v25
    v_mul_f32 v26, 0x3e0293ee, v26
    v_mul_f32 v27, 0x3e0293ee, v27
    v_cvt_pk_bf16_f32 v36, v20, v21
    v_cvt_pk_bf16_f32 v37, v22, v23
    v_cvt_pk_bf16_f32 v38, v24, v25
    v_cvt_pk_bf16_f32 v39, v26, v27
    buffer_store_dwordx4 v[36:39], v251, s[4:7], s53 offen offset:0 sc1
    v_accvgpr_read_b32 v40, a232
    v_accvgpr_read_b32 v41, a233
    v_accvgpr_read_b32 v42, a234
    v_accvgpr_read_b32 v43, a235
    v_accvgpr_read_b32 v44, a236
    v_accvgpr_read_b32 v45, a237
    v_accvgpr_read_b32 v46, a238
    v_accvgpr_read_b32 v47, a239
    v_mul_f32 v40, 0x3e0293ee, v40
    v_mul_f32 v41, 0x3e0293ee, v41
    v_mul_f32 v42, 0x3e0293ee, v42
    v_mul_f32 v43, 0x3e0293ee, v43
    v_mul_f32 v44, 0x3e0293ee, v44
    v_mul_f32 v45, 0x3e0293ee, v45
    v_mul_f32 v46, 0x3e0293ee, v46
    v_mul_f32 v47, 0x3e0293ee, v47
    v_cvt_pk_bf16_f32 v56, v40, v41
    v_cvt_pk_bf16_f32 v57, v42, v43
    v_cvt_pk_bf16_f32 v58, v44, v45
    v_cvt_pk_bf16_f32 v59, v46, v47
    buffer_store_dwordx4 v[56:59], v251, s[4:7], s53 offen offset:1024 sc1
    v_accvgpr_read_b32 v0, a240
    v_accvgpr_read_b32 v1, a241
    v_accvgpr_read_b32 v2, a242
    v_accvgpr_read_b32 v3, a243
    v_accvgpr_read_b32 v4, a244
    v_accvgpr_read_b32 v5, a245
    v_accvgpr_read_b32 v6, a246
    v_accvgpr_read_b32 v7, a247
    v_mul_f32 v0, 0x3e0293ee, v0
    v_mul_f32 v1, 0x3e0293ee, v1
    v_mul_f32 v2, 0x3e0293ee, v2
    v_mul_f32 v3, 0x3e0293ee, v3
    v_mul_f32 v4, 0x3e0293ee, v4
    v_mul_f32 v5, 0x3e0293ee, v5
    v_mul_f32 v6, 0x3e0293ee, v6
    v_mul_f32 v7, 0x3e0293ee, v7
    v_cvt_pk_bf16_f32 v16, v0, v1
    v_cvt_pk_bf16_f32 v17, v2, v3
    v_cvt_pk_bf16_f32 v18, v4, v5
    v_cvt_pk_bf16_f32 v19, v6, v7
    buffer_store_dwordx4 v[16:19], v251, s[4:7], s53 offen offset:2048 sc1
    v_accvgpr_read_b32 v20, a248
    v_accvgpr_read_b32 v21, a249
    v_accvgpr_read_b32 v22, a250
    v_accvgpr_read_b32 v23, a251
    v_accvgpr_read_b32 v24, a252
    v_accvgpr_read_b32 v25, a253
    v_accvgpr_read_b32 v26, a254
    v_accvgpr_read_b32 v27, a255
    v_mul_f32 v20, 0x3e0293ee, v20
    v_mul_f32 v21, 0x3e0293ee, v21
    v_mul_f32 v22, 0x3e0293ee, v22
    v_mul_f32 v23, 0x3e0293ee, v23
    v_mul_f32 v24, 0x3e0293ee, v24
    v_mul_f32 v25, 0x3e0293ee, v25
    v_mul_f32 v26, 0x3e0293ee, v26
    v_mul_f32 v27, 0x3e0293ee, v27
    v_cvt_pk_bf16_f32 v36, v20, v21
    v_cvt_pk_bf16_f32 v37, v22, v23
    v_cvt_pk_bf16_f32 v38, v24, v25
    v_cvt_pk_bf16_f32 v39, v26, v27
    buffer_store_dwordx4 v[36:39], v251, s[4:7], s53 offen offset:3072 sc1
    s_branch main_kernel_w_done
main_kernel_w_c2_egelu:
    s_mov_b32 s53, s21
    v_accvgpr_read_b32 v0, a0
    v_accvgpr_read_b32 v1, a1
    v_accvgpr_read_b32 v2, a2
    v_accvgpr_read_b32 v3, a3
    v_accvgpr_read_b32 v4, a4
    v_accvgpr_read_b32 v5, a5
    v_accvgpr_read_b32 v6, a6
    v_accvgpr_read_b32 v7, a7
    v_pk_mul_f32 v[8:9], v[0:1], v[0:1]
    v_pk_mul_f32 v[10:11], v[2:3], v[2:3]
    v_pk_mul_f32 v[12:13], v[4:5], v[4:5]
    v_pk_mul_f32 v[14:15], v[6:7], v[6:7]
    v_pk_fma_f32 v[8:9], v[8:9], v[242:243], v[240:241]
    v_pk_fma_f32 v[10:11], v[10:11], v[242:243], v[240:241]
    v_pk_fma_f32 v[12:13], v[12:13], v[242:243], v[240:241]
    v_pk_fma_f32 v[14:15], v[14:15], v[242:243], v[240:241]
    v_pk_mul_f32 v[8:9], v[8:9], v[0:1]
    v_pk_mul_f32 v[10:11], v[10:11], v[2:3]
    v_pk_mul_f32 v[12:13], v[12:13], v[4:5]
    v_pk_mul_f32 v[14:15], v[14:15], v[6:7]
    v_exp_f32 v8, v8
    v_exp_f32 v9, v9
    v_exp_f32 v10, v10
    v_exp_f32 v11, v11
    v_exp_f32 v12, v12
    v_exp_f32 v13, v13
    v_exp_f32 v14, v14
    v_exp_f32 v15, v15
    v_pk_add_f32 v[8:9], v[8:9], v[244:245]
    v_pk_add_f32 v[10:11], v[10:11], v[244:245]
    v_pk_add_f32 v[12:13], v[12:13], v[244:245]
    v_pk_add_f32 v[14:15], v[14:15], v[244:245]
    v_rcp_f32 v8, v8
    v_rcp_f32 v9, v9
    v_rcp_f32 v10, v10
    v_rcp_f32 v11, v11
    v_rcp_f32 v12, v12
    v_rcp_f32 v13, v13
    v_rcp_f32 v14, v14
    v_rcp_f32 v15, v15
    v_pk_mul_f32 v[0:1], v[8:9], v[0:1]
    v_pk_mul_f32 v[2:3], v[10:11], v[2:3]
    v_pk_mul_f32 v[4:5], v[12:13], v[4:5]
    v_pk_mul_f32 v[6:7], v[14:15], v[6:7]
    v_cvt_pk_bf16_f32 v16, v0, v1
    v_cvt_pk_bf16_f32 v17, v2, v3
    v_cvt_pk_bf16_f32 v18, v4, v5
    v_cvt_pk_bf16_f32 v19, v6, v7
    buffer_store_dwordx4 v[16:19], v251, s[4:7], s53 offen offset:0 sc1
    v_accvgpr_read_b32 v20, a8
    v_accvgpr_read_b32 v21, a9
    v_accvgpr_read_b32 v22, a10
    v_accvgpr_read_b32 v23, a11
    v_accvgpr_read_b32 v24, a12
    v_accvgpr_read_b32 v25, a13
    v_accvgpr_read_b32 v26, a14
    v_accvgpr_read_b32 v27, a15
    v_pk_mul_f32 v[28:29], v[20:21], v[20:21]
    v_pk_mul_f32 v[30:31], v[22:23], v[22:23]
    v_pk_mul_f32 v[32:33], v[24:25], v[24:25]
    v_pk_mul_f32 v[34:35], v[26:27], v[26:27]
    v_pk_fma_f32 v[28:29], v[28:29], v[242:243], v[240:241]
    v_pk_fma_f32 v[30:31], v[30:31], v[242:243], v[240:241]
    v_pk_fma_f32 v[32:33], v[32:33], v[242:243], v[240:241]
    v_pk_fma_f32 v[34:35], v[34:35], v[242:243], v[240:241]
    v_pk_mul_f32 v[28:29], v[28:29], v[20:21]
    v_pk_mul_f32 v[30:31], v[30:31], v[22:23]
    v_pk_mul_f32 v[32:33], v[32:33], v[24:25]
    v_pk_mul_f32 v[34:35], v[34:35], v[26:27]
    v_exp_f32 v28, v28
    v_exp_f32 v29, v29
    v_exp_f32 v30, v30
    v_exp_f32 v31, v31
    v_exp_f32 v32, v32
    v_exp_f32 v33, v33
    v_exp_f32 v34, v34
    v_exp_f32 v35, v35
    v_pk_add_f32 v[28:29], v[28:29], v[244:245]
    v_pk_add_f32 v[30:31], v[30:31], v[244:245]
    v_pk_add_f32 v[32:33], v[32:33], v[244:245]
    v_pk_add_f32 v[34:35], v[34:35], v[244:245]
    v_rcp_f32 v28, v28
    v_rcp_f32 v29, v29
    v_rcp_f32 v30, v30
    v_rcp_f32 v31, v31
    v_rcp_f32 v32, v32
    v_rcp_f32 v33, v33
    v_rcp_f32 v34, v34
    v_rcp_f32 v35, v35
    v_pk_mul_f32 v[20:21], v[28:29], v[20:21]
    v_pk_mul_f32 v[22:23], v[30:31], v[22:23]
    v_pk_mul_f32 v[24:25], v[32:33], v[24:25]
    v_pk_mul_f32 v[26:27], v[34:35], v[26:27]
    v_cvt_pk_bf16_f32 v36, v20, v21
    v_cvt_pk_bf16_f32 v37, v22, v23
    v_cvt_pk_bf16_f32 v38, v24, v25
    v_cvt_pk_bf16_f32 v39, v26, v27
    buffer_store_dwordx4 v[36:39], v251, s[4:7], s53 offen offset:1024 sc1
    v_accvgpr_read_b32 v40, a16
    v_accvgpr_read_b32 v41, a17
    v_accvgpr_read_b32 v42, a18
    v_accvgpr_read_b32 v43, a19
    v_accvgpr_read_b32 v44, a20
    v_accvgpr_read_b32 v45, a21
    v_accvgpr_read_b32 v46, a22
    v_accvgpr_read_b32 v47, a23
    v_pk_mul_f32 v[48:49], v[40:41], v[40:41]
    v_pk_mul_f32 v[50:51], v[42:43], v[42:43]
    v_pk_mul_f32 v[52:53], v[44:45], v[44:45]
    v_pk_mul_f32 v[54:55], v[46:47], v[46:47]
    v_pk_fma_f32 v[48:49], v[48:49], v[242:243], v[240:241]
    v_pk_fma_f32 v[50:51], v[50:51], v[242:243], v[240:241]
    v_pk_fma_f32 v[52:53], v[52:53], v[242:243], v[240:241]
    v_pk_fma_f32 v[54:55], v[54:55], v[242:243], v[240:241]
    v_pk_mul_f32 v[48:49], v[48:49], v[40:41]
    v_pk_mul_f32 v[50:51], v[50:51], v[42:43]
    v_pk_mul_f32 v[52:53], v[52:53], v[44:45]
    v_pk_mul_f32 v[54:55], v[54:55], v[46:47]
    v_exp_f32 v48, v48
    v_exp_f32 v49, v49
    v_exp_f32 v50, v50
    v_exp_f32 v51, v51
    v_exp_f32 v52, v52
    v_exp_f32 v53, v53
    v_exp_f32 v54, v54
    v_exp_f32 v55, v55
    v_pk_add_f32 v[48:49], v[48:49], v[244:245]
    v_pk_add_f32 v[50:51], v[50:51], v[244:245]
    v_pk_add_f32 v[52:53], v[52:53], v[244:245]
    v_pk_add_f32 v[54:55], v[54:55], v[244:245]
    v_rcp_f32 v48, v48
    v_rcp_f32 v49, v49
    v_rcp_f32 v50, v50
    v_rcp_f32 v51, v51
    v_rcp_f32 v52, v52
    v_rcp_f32 v53, v53
    v_rcp_f32 v54, v54
    v_rcp_f32 v55, v55
    v_pk_mul_f32 v[40:41], v[48:49], v[40:41]
    v_pk_mul_f32 v[42:43], v[50:51], v[42:43]
    v_pk_mul_f32 v[44:45], v[52:53], v[44:45]
    v_pk_mul_f32 v[46:47], v[54:55], v[46:47]
    v_cvt_pk_bf16_f32 v56, v40, v41
    v_cvt_pk_bf16_f32 v57, v42, v43
    v_cvt_pk_bf16_f32 v58, v44, v45
    v_cvt_pk_bf16_f32 v59, v46, v47
    buffer_store_dwordx4 v[56:59], v251, s[4:7], s53 offen offset:2048 sc1
    v_accvgpr_read_b32 v0, a24
    v_accvgpr_read_b32 v1, a25
    v_accvgpr_read_b32 v2, a26
    v_accvgpr_read_b32 v3, a27
    v_accvgpr_read_b32 v4, a28
    v_accvgpr_read_b32 v5, a29
    v_accvgpr_read_b32 v6, a30
    v_accvgpr_read_b32 v7, a31
    v_pk_mul_f32 v[8:9], v[0:1], v[0:1]
    v_pk_mul_f32 v[10:11], v[2:3], v[2:3]
    v_pk_mul_f32 v[12:13], v[4:5], v[4:5]
    v_pk_mul_f32 v[14:15], v[6:7], v[6:7]
    v_pk_fma_f32 v[8:9], v[8:9], v[242:243], v[240:241]
    v_pk_fma_f32 v[10:11], v[10:11], v[242:243], v[240:241]
    v_pk_fma_f32 v[12:13], v[12:13], v[242:243], v[240:241]
    v_pk_fma_f32 v[14:15], v[14:15], v[242:243], v[240:241]
    v_pk_mul_f32 v[8:9], v[8:9], v[0:1]
    v_pk_mul_f32 v[10:11], v[10:11], v[2:3]
    v_pk_mul_f32 v[12:13], v[12:13], v[4:5]
    v_pk_mul_f32 v[14:15], v[14:15], v[6:7]
    v_exp_f32 v8, v8
    v_exp_f32 v9, v9
    v_exp_f32 v10, v10
    v_exp_f32 v11, v11
    v_exp_f32 v12, v12
    v_exp_f32 v13, v13
    v_exp_f32 v14, v14
    v_exp_f32 v15, v15
    v_pk_add_f32 v[8:9], v[8:9], v[244:245]
    v_pk_add_f32 v[10:11], v[10:11], v[244:245]
    v_pk_add_f32 v[12:13], v[12:13], v[244:245]
    v_pk_add_f32 v[14:15], v[14:15], v[244:245]
    v_rcp_f32 v8, v8
    v_rcp_f32 v9, v9
    v_rcp_f32 v10, v10
    v_rcp_f32 v11, v11
    v_rcp_f32 v12, v12
    v_rcp_f32 v13, v13
    v_rcp_f32 v14, v14
    v_rcp_f32 v15, v15
    v_pk_mul_f32 v[0:1], v[8:9], v[0:1]
    v_pk_mul_f32 v[2:3], v[10:11], v[2:3]
    v_pk_mul_f32 v[4:5], v[12:13], v[4:5]
    v_pk_mul_f32 v[6:7], v[14:15], v[6:7]
    v_cvt_pk_bf16_f32 v16, v0, v1
    v_cvt_pk_bf16_f32 v17, v2, v3
    v_cvt_pk_bf16_f32 v18, v4, v5
    v_cvt_pk_bf16_f32 v19, v6, v7
    buffer_store_dwordx4 v[16:19], v251, s[4:7], s53 offen offset:3072 sc1
    s_add_u32 s53, s53, s22
    v_accvgpr_read_b32 v20, a32
    v_accvgpr_read_b32 v21, a33
    v_accvgpr_read_b32 v22, a34
    v_accvgpr_read_b32 v23, a35
    v_accvgpr_read_b32 v24, a36
    v_accvgpr_read_b32 v25, a37
    v_accvgpr_read_b32 v26, a38
    v_accvgpr_read_b32 v27, a39
    v_pk_mul_f32 v[28:29], v[20:21], v[20:21]
    v_pk_mul_f32 v[30:31], v[22:23], v[22:23]
    v_pk_mul_f32 v[32:33], v[24:25], v[24:25]
    v_pk_mul_f32 v[34:35], v[26:27], v[26:27]
    v_pk_fma_f32 v[28:29], v[28:29], v[242:243], v[240:241]
    v_pk_fma_f32 v[30:31], v[30:31], v[242:243], v[240:241]
    v_pk_fma_f32 v[32:33], v[32:33], v[242:243], v[240:241]
    v_pk_fma_f32 v[34:35], v[34:35], v[242:243], v[240:241]
    v_pk_mul_f32 v[28:29], v[28:29], v[20:21]
    v_pk_mul_f32 v[30:31], v[30:31], v[22:23]
    v_pk_mul_f32 v[32:33], v[32:33], v[24:25]
    v_pk_mul_f32 v[34:35], v[34:35], v[26:27]
    v_exp_f32 v28, v28
    v_exp_f32 v29, v29
    v_exp_f32 v30, v30
    v_exp_f32 v31, v31
    v_exp_f32 v32, v32
    v_exp_f32 v33, v33
    v_exp_f32 v34, v34
    v_exp_f32 v35, v35
    v_pk_add_f32 v[28:29], v[28:29], v[244:245]
    v_pk_add_f32 v[30:31], v[30:31], v[244:245]
    v_pk_add_f32 v[32:33], v[32:33], v[244:245]
    v_pk_add_f32 v[34:35], v[34:35], v[244:245]
    v_rcp_f32 v28, v28
    v_rcp_f32 v29, v29
    v_rcp_f32 v30, v30
    v_rcp_f32 v31, v31
    v_rcp_f32 v32, v32
    v_rcp_f32 v33, v33
    v_rcp_f32 v34, v34
    v_rcp_f32 v35, v35
    v_pk_mul_f32 v[20:21], v[28:29], v[20:21]
    v_pk_mul_f32 v[22:23], v[30:31], v[22:23]
    v_pk_mul_f32 v[24:25], v[32:33], v[24:25]
    v_pk_mul_f32 v[26:27], v[34:35], v[26:27]
    v_cvt_pk_bf16_f32 v36, v20, v21
    v_cvt_pk_bf16_f32 v37, v22, v23
    v_cvt_pk_bf16_f32 v38, v24, v25
    v_cvt_pk_bf16_f32 v39, v26, v27
    buffer_store_dwordx4 v[36:39], v251, s[4:7], s53 offen offset:0 sc1
    v_accvgpr_read_b32 v40, a40
    v_accvgpr_read_b32 v41, a41
    v_accvgpr_read_b32 v42, a42
    v_accvgpr_read_b32 v43, a43
    v_accvgpr_read_b32 v44, a44
    v_accvgpr_read_b32 v45, a45
    v_accvgpr_read_b32 v46, a46
    v_accvgpr_read_b32 v47, a47
    v_pk_mul_f32 v[48:49], v[40:41], v[40:41]
    v_pk_mul_f32 v[50:51], v[42:43], v[42:43]
    v_pk_mul_f32 v[52:53], v[44:45], v[44:45]
    v_pk_mul_f32 v[54:55], v[46:47], v[46:47]
    v_pk_fma_f32 v[48:49], v[48:49], v[242:243], v[240:241]
    v_pk_fma_f32 v[50:51], v[50:51], v[242:243], v[240:241]
    v_pk_fma_f32 v[52:53], v[52:53], v[242:243], v[240:241]
    v_pk_fma_f32 v[54:55], v[54:55], v[242:243], v[240:241]
    v_pk_mul_f32 v[48:49], v[48:49], v[40:41]
    v_pk_mul_f32 v[50:51], v[50:51], v[42:43]
    v_pk_mul_f32 v[52:53], v[52:53], v[44:45]
    v_pk_mul_f32 v[54:55], v[54:55], v[46:47]
    v_exp_f32 v48, v48
    v_exp_f32 v49, v49
    v_exp_f32 v50, v50
    v_exp_f32 v51, v51
    v_exp_f32 v52, v52
    v_exp_f32 v53, v53
    v_exp_f32 v54, v54
    v_exp_f32 v55, v55
    v_pk_add_f32 v[48:49], v[48:49], v[244:245]
    v_pk_add_f32 v[50:51], v[50:51], v[244:245]
    v_pk_add_f32 v[52:53], v[52:53], v[244:245]
    v_pk_add_f32 v[54:55], v[54:55], v[244:245]
    v_rcp_f32 v48, v48
    v_rcp_f32 v49, v49
    v_rcp_f32 v50, v50
    v_rcp_f32 v51, v51
    v_rcp_f32 v52, v52
    v_rcp_f32 v53, v53
    v_rcp_f32 v54, v54
    v_rcp_f32 v55, v55
    v_pk_mul_f32 v[40:41], v[48:49], v[40:41]
    v_pk_mul_f32 v[42:43], v[50:51], v[42:43]
    v_pk_mul_f32 v[44:45], v[52:53], v[44:45]
    v_pk_mul_f32 v[46:47], v[54:55], v[46:47]
    v_cvt_pk_bf16_f32 v56, v40, v41
    v_cvt_pk_bf16_f32 v57, v42, v43
    v_cvt_pk_bf16_f32 v58, v44, v45
    v_cvt_pk_bf16_f32 v59, v46, v47
    buffer_store_dwordx4 v[56:59], v251, s[4:7], s53 offen offset:1024 sc1
    v_accvgpr_read_b32 v0, a48
    v_accvgpr_read_b32 v1, a49
    v_accvgpr_read_b32 v2, a50
    v_accvgpr_read_b32 v3, a51
    v_accvgpr_read_b32 v4, a52
    v_accvgpr_read_b32 v5, a53
    v_accvgpr_read_b32 v6, a54
    v_accvgpr_read_b32 v7, a55
    v_pk_mul_f32 v[8:9], v[0:1], v[0:1]
    v_pk_mul_f32 v[10:11], v[2:3], v[2:3]
    v_pk_mul_f32 v[12:13], v[4:5], v[4:5]
    v_pk_mul_f32 v[14:15], v[6:7], v[6:7]
    v_pk_fma_f32 v[8:9], v[8:9], v[242:243], v[240:241]
    v_pk_fma_f32 v[10:11], v[10:11], v[242:243], v[240:241]
    v_pk_fma_f32 v[12:13], v[12:13], v[242:243], v[240:241]
    v_pk_fma_f32 v[14:15], v[14:15], v[242:243], v[240:241]
    v_pk_mul_f32 v[8:9], v[8:9], v[0:1]
    v_pk_mul_f32 v[10:11], v[10:11], v[2:3]
    v_pk_mul_f32 v[12:13], v[12:13], v[4:5]
    v_pk_mul_f32 v[14:15], v[14:15], v[6:7]
    v_exp_f32 v8, v8
    v_exp_f32 v9, v9
    v_exp_f32 v10, v10
    v_exp_f32 v11, v11
    v_exp_f32 v12, v12
    v_exp_f32 v13, v13
    v_exp_f32 v14, v14
    v_exp_f32 v15, v15
    v_pk_add_f32 v[8:9], v[8:9], v[244:245]
    v_pk_add_f32 v[10:11], v[10:11], v[244:245]
    v_pk_add_f32 v[12:13], v[12:13], v[244:245]
    v_pk_add_f32 v[14:15], v[14:15], v[244:245]
    v_rcp_f32 v8, v8
    v_rcp_f32 v9, v9
    v_rcp_f32 v10, v10
    v_rcp_f32 v11, v11
    v_rcp_f32 v12, v12
    v_rcp_f32 v13, v13
    v_rcp_f32 v14, v14
    v_rcp_f32 v15, v15
    v_pk_mul_f32 v[0:1], v[8:9], v[0:1]
    v_pk_mul_f32 v[2:3], v[10:11], v[2:3]
    v_pk_mul_f32 v[4:5], v[12:13], v[4:5]
    v_pk_mul_f32 v[6:7], v[14:15], v[6:7]
    v_cvt_pk_bf16_f32 v16, v0, v1
    v_cvt_pk_bf16_f32 v17, v2, v3
    v_cvt_pk_bf16_f32 v18, v4, v5
    v_cvt_pk_bf16_f32 v19, v6, v7
    buffer_store_dwordx4 v[16:19], v251, s[4:7], s53 offen offset:2048 sc1
    v_accvgpr_read_b32 v20, a56
    v_accvgpr_read_b32 v21, a57
    v_accvgpr_read_b32 v22, a58
    v_accvgpr_read_b32 v23, a59
    v_accvgpr_read_b32 v24, a60
    v_accvgpr_read_b32 v25, a61
    v_accvgpr_read_b32 v26, a62
    v_accvgpr_read_b32 v27, a63
    v_pk_mul_f32 v[28:29], v[20:21], v[20:21]
    v_pk_mul_f32 v[30:31], v[22:23], v[22:23]
    v_pk_mul_f32 v[32:33], v[24:25], v[24:25]
    v_pk_mul_f32 v[34:35], v[26:27], v[26:27]
    v_pk_fma_f32 v[28:29], v[28:29], v[242:243], v[240:241]
    v_pk_fma_f32 v[30:31], v[30:31], v[242:243], v[240:241]
    v_pk_fma_f32 v[32:33], v[32:33], v[242:243], v[240:241]
    v_pk_fma_f32 v[34:35], v[34:35], v[242:243], v[240:241]
    v_pk_mul_f32 v[28:29], v[28:29], v[20:21]
    v_pk_mul_f32 v[30:31], v[30:31], v[22:23]
    v_pk_mul_f32 v[32:33], v[32:33], v[24:25]
    v_pk_mul_f32 v[34:35], v[34:35], v[26:27]
    v_exp_f32 v28, v28
    v_exp_f32 v29, v29
    v_exp_f32 v30, v30
    v_exp_f32 v31, v31
    v_exp_f32 v32, v32
    v_exp_f32 v33, v33
    v_exp_f32 v34, v34
    v_exp_f32 v35, v35
    v_pk_add_f32 v[28:29], v[28:29], v[244:245]
    v_pk_add_f32 v[30:31], v[30:31], v[244:245]
    v_pk_add_f32 v[32:33], v[32:33], v[244:245]
    v_pk_add_f32 v[34:35], v[34:35], v[244:245]
    v_rcp_f32 v28, v28
    v_rcp_f32 v29, v29
    v_rcp_f32 v30, v30
    v_rcp_f32 v31, v31
    v_rcp_f32 v32, v32
    v_rcp_f32 v33, v33
    v_rcp_f32 v34, v34
    v_rcp_f32 v35, v35
    v_pk_mul_f32 v[20:21], v[28:29], v[20:21]
    v_pk_mul_f32 v[22:23], v[30:31], v[22:23]
    v_pk_mul_f32 v[24:25], v[32:33], v[24:25]
    v_pk_mul_f32 v[26:27], v[34:35], v[26:27]
    v_cvt_pk_bf16_f32 v36, v20, v21
    v_cvt_pk_bf16_f32 v37, v22, v23
    v_cvt_pk_bf16_f32 v38, v24, v25
    v_cvt_pk_bf16_f32 v39, v26, v27
    buffer_store_dwordx4 v[36:39], v251, s[4:7], s53 offen offset:3072 sc1
    s_add_u32 s53, s53, s22
    v_accvgpr_read_b32 v40, a64
    v_accvgpr_read_b32 v41, a65
    v_accvgpr_read_b32 v42, a66
    v_accvgpr_read_b32 v43, a67
    v_accvgpr_read_b32 v44, a68
    v_accvgpr_read_b32 v45, a69
    v_accvgpr_read_b32 v46, a70
    v_accvgpr_read_b32 v47, a71
    v_pk_mul_f32 v[48:49], v[40:41], v[40:41]
    v_pk_mul_f32 v[50:51], v[42:43], v[42:43]
    v_pk_mul_f32 v[52:53], v[44:45], v[44:45]
    v_pk_mul_f32 v[54:55], v[46:47], v[46:47]
    v_pk_fma_f32 v[48:49], v[48:49], v[242:243], v[240:241]
    v_pk_fma_f32 v[50:51], v[50:51], v[242:243], v[240:241]
    v_pk_fma_f32 v[52:53], v[52:53], v[242:243], v[240:241]
    v_pk_fma_f32 v[54:55], v[54:55], v[242:243], v[240:241]
    v_pk_mul_f32 v[48:49], v[48:49], v[40:41]
    v_pk_mul_f32 v[50:51], v[50:51], v[42:43]
    v_pk_mul_f32 v[52:53], v[52:53], v[44:45]
    v_pk_mul_f32 v[54:55], v[54:55], v[46:47]
    v_exp_f32 v48, v48
    v_exp_f32 v49, v49
    v_exp_f32 v50, v50
    v_exp_f32 v51, v51
    v_exp_f32 v52, v52
    v_exp_f32 v53, v53
    v_exp_f32 v54, v54
    v_exp_f32 v55, v55
    v_pk_add_f32 v[48:49], v[48:49], v[244:245]
    v_pk_add_f32 v[50:51], v[50:51], v[244:245]
    v_pk_add_f32 v[52:53], v[52:53], v[244:245]
    v_pk_add_f32 v[54:55], v[54:55], v[244:245]
    v_rcp_f32 v48, v48
    v_rcp_f32 v49, v49
    v_rcp_f32 v50, v50
    v_rcp_f32 v51, v51
    v_rcp_f32 v52, v52
    v_rcp_f32 v53, v53
    v_rcp_f32 v54, v54
    v_rcp_f32 v55, v55
    v_pk_mul_f32 v[40:41], v[48:49], v[40:41]
    v_pk_mul_f32 v[42:43], v[50:51], v[42:43]
    v_pk_mul_f32 v[44:45], v[52:53], v[44:45]
    v_pk_mul_f32 v[46:47], v[54:55], v[46:47]
    v_cvt_pk_bf16_f32 v56, v40, v41
    v_cvt_pk_bf16_f32 v57, v42, v43
    v_cvt_pk_bf16_f32 v58, v44, v45
    v_cvt_pk_bf16_f32 v59, v46, v47
    buffer_store_dwordx4 v[56:59], v251, s[4:7], s53 offen offset:0 sc1
    v_accvgpr_read_b32 v0, a72
    v_accvgpr_read_b32 v1, a73
    v_accvgpr_read_b32 v2, a74
    v_accvgpr_read_b32 v3, a75
    v_accvgpr_read_b32 v4, a76
    v_accvgpr_read_b32 v5, a77
    v_accvgpr_read_b32 v6, a78
    v_accvgpr_read_b32 v7, a79
    v_pk_mul_f32 v[8:9], v[0:1], v[0:1]
    v_pk_mul_f32 v[10:11], v[2:3], v[2:3]
    v_pk_mul_f32 v[12:13], v[4:5], v[4:5]
    v_pk_mul_f32 v[14:15], v[6:7], v[6:7]
    v_pk_fma_f32 v[8:9], v[8:9], v[242:243], v[240:241]
    v_pk_fma_f32 v[10:11], v[10:11], v[242:243], v[240:241]
    v_pk_fma_f32 v[12:13], v[12:13], v[242:243], v[240:241]
    v_pk_fma_f32 v[14:15], v[14:15], v[242:243], v[240:241]
    v_pk_mul_f32 v[8:9], v[8:9], v[0:1]
    v_pk_mul_f32 v[10:11], v[10:11], v[2:3]
    v_pk_mul_f32 v[12:13], v[12:13], v[4:5]
    v_pk_mul_f32 v[14:15], v[14:15], v[6:7]
    v_exp_f32 v8, v8
    v_exp_f32 v9, v9
    v_exp_f32 v10, v10
    v_exp_f32 v11, v11
    v_exp_f32 v12, v12
    v_exp_f32 v13, v13
    v_exp_f32 v14, v14
    v_exp_f32 v15, v15
    v_pk_add_f32 v[8:9], v[8:9], v[244:245]
    v_pk_add_f32 v[10:11], v[10:11], v[244:245]
    v_pk_add_f32 v[12:13], v[12:13], v[244:245]
    v_pk_add_f32 v[14:15], v[14:15], v[244:245]
    v_rcp_f32 v8, v8
    v_rcp_f32 v9, v9
    v_rcp_f32 v10, v10
    v_rcp_f32 v11, v11
    v_rcp_f32 v12, v12
    v_rcp_f32 v13, v13
    v_rcp_f32 v14, v14
    v_rcp_f32 v15, v15
    v_pk_mul_f32 v[0:1], v[8:9], v[0:1]
    v_pk_mul_f32 v[2:3], v[10:11], v[2:3]
    v_pk_mul_f32 v[4:5], v[12:13], v[4:5]
    v_pk_mul_f32 v[6:7], v[14:15], v[6:7]
    v_cvt_pk_bf16_f32 v16, v0, v1
    v_cvt_pk_bf16_f32 v17, v2, v3
    v_cvt_pk_bf16_f32 v18, v4, v5
    v_cvt_pk_bf16_f32 v19, v6, v7
    buffer_store_dwordx4 v[16:19], v251, s[4:7], s53 offen offset:1024 sc1
    v_accvgpr_read_b32 v20, a80
    v_accvgpr_read_b32 v21, a81
    v_accvgpr_read_b32 v22, a82
    v_accvgpr_read_b32 v23, a83
    v_accvgpr_read_b32 v24, a84
    v_accvgpr_read_b32 v25, a85
    v_accvgpr_read_b32 v26, a86
    v_accvgpr_read_b32 v27, a87
    v_pk_mul_f32 v[28:29], v[20:21], v[20:21]
    v_pk_mul_f32 v[30:31], v[22:23], v[22:23]
    v_pk_mul_f32 v[32:33], v[24:25], v[24:25]
    v_pk_mul_f32 v[34:35], v[26:27], v[26:27]
    v_pk_fma_f32 v[28:29], v[28:29], v[242:243], v[240:241]
    v_pk_fma_f32 v[30:31], v[30:31], v[242:243], v[240:241]
    v_pk_fma_f32 v[32:33], v[32:33], v[242:243], v[240:241]
    v_pk_fma_f32 v[34:35], v[34:35], v[242:243], v[240:241]
    v_pk_mul_f32 v[28:29], v[28:29], v[20:21]
    v_pk_mul_f32 v[30:31], v[30:31], v[22:23]
    v_pk_mul_f32 v[32:33], v[32:33], v[24:25]
    v_pk_mul_f32 v[34:35], v[34:35], v[26:27]
    v_exp_f32 v28, v28
    v_exp_f32 v29, v29
    v_exp_f32 v30, v30
    v_exp_f32 v31, v31
    v_exp_f32 v32, v32
    v_exp_f32 v33, v33
    v_exp_f32 v34, v34
    v_exp_f32 v35, v35
    v_pk_add_f32 v[28:29], v[28:29], v[244:245]
    v_pk_add_f32 v[30:31], v[30:31], v[244:245]
    v_pk_add_f32 v[32:33], v[32:33], v[244:245]
    v_pk_add_f32 v[34:35], v[34:35], v[244:245]
    v_rcp_f32 v28, v28
    v_rcp_f32 v29, v29
    v_rcp_f32 v30, v30
    v_rcp_f32 v31, v31
    v_rcp_f32 v32, v32
    v_rcp_f32 v33, v33
    v_rcp_f32 v34, v34
    v_rcp_f32 v35, v35
    v_pk_mul_f32 v[20:21], v[28:29], v[20:21]
    v_pk_mul_f32 v[22:23], v[30:31], v[22:23]
    v_pk_mul_f32 v[24:25], v[32:33], v[24:25]
    v_pk_mul_f32 v[26:27], v[34:35], v[26:27]
    v_cvt_pk_bf16_f32 v36, v20, v21
    v_cvt_pk_bf16_f32 v37, v22, v23
    v_cvt_pk_bf16_f32 v38, v24, v25
    v_cvt_pk_bf16_f32 v39, v26, v27
    buffer_store_dwordx4 v[36:39], v251, s[4:7], s53 offen offset:2048 sc1
    v_accvgpr_read_b32 v40, a88
    v_accvgpr_read_b32 v41, a89
    v_accvgpr_read_b32 v42, a90
    v_accvgpr_read_b32 v43, a91
    v_accvgpr_read_b32 v44, a92
    v_accvgpr_read_b32 v45, a93
    v_accvgpr_read_b32 v46, a94
    v_accvgpr_read_b32 v47, a95
    v_pk_mul_f32 v[48:49], v[40:41], v[40:41]
    v_pk_mul_f32 v[50:51], v[42:43], v[42:43]
    v_pk_mul_f32 v[52:53], v[44:45], v[44:45]
    v_pk_mul_f32 v[54:55], v[46:47], v[46:47]
    v_pk_fma_f32 v[48:49], v[48:49], v[242:243], v[240:241]
    v_pk_fma_f32 v[50:51], v[50:51], v[242:243], v[240:241]
    v_pk_fma_f32 v[52:53], v[52:53], v[242:243], v[240:241]
    v_pk_fma_f32 v[54:55], v[54:55], v[242:243], v[240:241]
    v_pk_mul_f32 v[48:49], v[48:49], v[40:41]
    v_pk_mul_f32 v[50:51], v[50:51], v[42:43]
    v_pk_mul_f32 v[52:53], v[52:53], v[44:45]
    v_pk_mul_f32 v[54:55], v[54:55], v[46:47]
    v_exp_f32 v48, v48
    v_exp_f32 v49, v49
    v_exp_f32 v50, v50
    v_exp_f32 v51, v51
    v_exp_f32 v52, v52
    v_exp_f32 v53, v53
    v_exp_f32 v54, v54
    v_exp_f32 v55, v55
    v_pk_add_f32 v[48:49], v[48:49], v[244:245]
    v_pk_add_f32 v[50:51], v[50:51], v[244:245]
    v_pk_add_f32 v[52:53], v[52:53], v[244:245]
    v_pk_add_f32 v[54:55], v[54:55], v[244:245]
    v_rcp_f32 v48, v48
    v_rcp_f32 v49, v49
    v_rcp_f32 v50, v50
    v_rcp_f32 v51, v51
    v_rcp_f32 v52, v52
    v_rcp_f32 v53, v53
    v_rcp_f32 v54, v54
    v_rcp_f32 v55, v55
    v_pk_mul_f32 v[40:41], v[48:49], v[40:41]
    v_pk_mul_f32 v[42:43], v[50:51], v[42:43]
    v_pk_mul_f32 v[44:45], v[52:53], v[44:45]
    v_pk_mul_f32 v[46:47], v[54:55], v[46:47]
    v_cvt_pk_bf16_f32 v56, v40, v41
    v_cvt_pk_bf16_f32 v57, v42, v43
    v_cvt_pk_bf16_f32 v58, v44, v45
    v_cvt_pk_bf16_f32 v59, v46, v47
    buffer_store_dwordx4 v[56:59], v251, s[4:7], s53 offen offset:3072 sc1
    s_add_u32 s53, s53, s22
    v_accvgpr_read_b32 v0, a96
    v_accvgpr_read_b32 v1, a97
    v_accvgpr_read_b32 v2, a98
    v_accvgpr_read_b32 v3, a99
    v_accvgpr_read_b32 v4, a100
    v_accvgpr_read_b32 v5, a101
    v_accvgpr_read_b32 v6, a102
    v_accvgpr_read_b32 v7, a103
    v_pk_mul_f32 v[8:9], v[0:1], v[0:1]
    v_pk_mul_f32 v[10:11], v[2:3], v[2:3]
    v_pk_mul_f32 v[12:13], v[4:5], v[4:5]
    v_pk_mul_f32 v[14:15], v[6:7], v[6:7]
    v_pk_fma_f32 v[8:9], v[8:9], v[242:243], v[240:241]
    v_pk_fma_f32 v[10:11], v[10:11], v[242:243], v[240:241]
    v_pk_fma_f32 v[12:13], v[12:13], v[242:243], v[240:241]
    v_pk_fma_f32 v[14:15], v[14:15], v[242:243], v[240:241]
    v_pk_mul_f32 v[8:9], v[8:9], v[0:1]
    v_pk_mul_f32 v[10:11], v[10:11], v[2:3]
    v_pk_mul_f32 v[12:13], v[12:13], v[4:5]
    v_pk_mul_f32 v[14:15], v[14:15], v[6:7]
    v_exp_f32 v8, v8
    v_exp_f32 v9, v9
    v_exp_f32 v10, v10
    v_exp_f32 v11, v11
    v_exp_f32 v12, v12
    v_exp_f32 v13, v13
    v_exp_f32 v14, v14
    v_exp_f32 v15, v15
    v_pk_add_f32 v[8:9], v[8:9], v[244:245]
    v_pk_add_f32 v[10:11], v[10:11], v[244:245]
    v_pk_add_f32 v[12:13], v[12:13], v[244:245]
    v_pk_add_f32 v[14:15], v[14:15], v[244:245]
    v_rcp_f32 v8, v8
    v_rcp_f32 v9, v9
    v_rcp_f32 v10, v10
    v_rcp_f32 v11, v11
    v_rcp_f32 v12, v12
    v_rcp_f32 v13, v13
    v_rcp_f32 v14, v14
    v_rcp_f32 v15, v15
    v_pk_mul_f32 v[0:1], v[8:9], v[0:1]
    v_pk_mul_f32 v[2:3], v[10:11], v[2:3]
    v_pk_mul_f32 v[4:5], v[12:13], v[4:5]
    v_pk_mul_f32 v[6:7], v[14:15], v[6:7]
    v_cvt_pk_bf16_f32 v16, v0, v1
    v_cvt_pk_bf16_f32 v17, v2, v3
    v_cvt_pk_bf16_f32 v18, v4, v5
    v_cvt_pk_bf16_f32 v19, v6, v7
    buffer_store_dwordx4 v[16:19], v251, s[4:7], s53 offen offset:0 sc1
    v_accvgpr_read_b32 v20, a104
    v_accvgpr_read_b32 v21, a105
    v_accvgpr_read_b32 v22, a106
    v_accvgpr_read_b32 v23, a107
    v_accvgpr_read_b32 v24, a108
    v_accvgpr_read_b32 v25, a109
    v_accvgpr_read_b32 v26, a110
    v_accvgpr_read_b32 v27, a111
    v_pk_mul_f32 v[28:29], v[20:21], v[20:21]
    v_pk_mul_f32 v[30:31], v[22:23], v[22:23]
    v_pk_mul_f32 v[32:33], v[24:25], v[24:25]
    v_pk_mul_f32 v[34:35], v[26:27], v[26:27]
    v_pk_fma_f32 v[28:29], v[28:29], v[242:243], v[240:241]
    v_pk_fma_f32 v[30:31], v[30:31], v[242:243], v[240:241]
    v_pk_fma_f32 v[32:33], v[32:33], v[242:243], v[240:241]
    v_pk_fma_f32 v[34:35], v[34:35], v[242:243], v[240:241]
    v_pk_mul_f32 v[28:29], v[28:29], v[20:21]
    v_pk_mul_f32 v[30:31], v[30:31], v[22:23]
    v_pk_mul_f32 v[32:33], v[32:33], v[24:25]
    v_pk_mul_f32 v[34:35], v[34:35], v[26:27]
    v_exp_f32 v28, v28
    v_exp_f32 v29, v29
    v_exp_f32 v30, v30
    v_exp_f32 v31, v31
    v_exp_f32 v32, v32
    v_exp_f32 v33, v33
    v_exp_f32 v34, v34
    v_exp_f32 v35, v35
    v_pk_add_f32 v[28:29], v[28:29], v[244:245]
    v_pk_add_f32 v[30:31], v[30:31], v[244:245]
    v_pk_add_f32 v[32:33], v[32:33], v[244:245]
    v_pk_add_f32 v[34:35], v[34:35], v[244:245]
    v_rcp_f32 v28, v28
    v_rcp_f32 v29, v29
    v_rcp_f32 v30, v30
    v_rcp_f32 v31, v31
    v_rcp_f32 v32, v32
    v_rcp_f32 v33, v33
    v_rcp_f32 v34, v34
    v_rcp_f32 v35, v35
    v_pk_mul_f32 v[20:21], v[28:29], v[20:21]
    v_pk_mul_f32 v[22:23], v[30:31], v[22:23]
    v_pk_mul_f32 v[24:25], v[32:33], v[24:25]
    v_pk_mul_f32 v[26:27], v[34:35], v[26:27]
    v_cvt_pk_bf16_f32 v36, v20, v21
    v_cvt_pk_bf16_f32 v37, v22, v23
    v_cvt_pk_bf16_f32 v38, v24, v25
    v_cvt_pk_bf16_f32 v39, v26, v27
    buffer_store_dwordx4 v[36:39], v251, s[4:7], s53 offen offset:1024 sc1
    v_accvgpr_read_b32 v40, a112
    v_accvgpr_read_b32 v41, a113
    v_accvgpr_read_b32 v42, a114
    v_accvgpr_read_b32 v43, a115
    v_accvgpr_read_b32 v44, a116
    v_accvgpr_read_b32 v45, a117
    v_accvgpr_read_b32 v46, a118
    v_accvgpr_read_b32 v47, a119
    v_pk_mul_f32 v[48:49], v[40:41], v[40:41]
    v_pk_mul_f32 v[50:51], v[42:43], v[42:43]
    v_pk_mul_f32 v[52:53], v[44:45], v[44:45]
    v_pk_mul_f32 v[54:55], v[46:47], v[46:47]
    v_pk_fma_f32 v[48:49], v[48:49], v[242:243], v[240:241]
    v_pk_fma_f32 v[50:51], v[50:51], v[242:243], v[240:241]
    v_pk_fma_f32 v[52:53], v[52:53], v[242:243], v[240:241]
    v_pk_fma_f32 v[54:55], v[54:55], v[242:243], v[240:241]
    v_pk_mul_f32 v[48:49], v[48:49], v[40:41]
    v_pk_mul_f32 v[50:51], v[50:51], v[42:43]
    v_pk_mul_f32 v[52:53], v[52:53], v[44:45]
    v_pk_mul_f32 v[54:55], v[54:55], v[46:47]
    v_exp_f32 v48, v48
    v_exp_f32 v49, v49
    v_exp_f32 v50, v50
    v_exp_f32 v51, v51
    v_exp_f32 v52, v52
    v_exp_f32 v53, v53
    v_exp_f32 v54, v54
    v_exp_f32 v55, v55
    v_pk_add_f32 v[48:49], v[48:49], v[244:245]
    v_pk_add_f32 v[50:51], v[50:51], v[244:245]
    v_pk_add_f32 v[52:53], v[52:53], v[244:245]
    v_pk_add_f32 v[54:55], v[54:55], v[244:245]
    v_rcp_f32 v48, v48
    v_rcp_f32 v49, v49
    v_rcp_f32 v50, v50
    v_rcp_f32 v51, v51
    v_rcp_f32 v52, v52
    v_rcp_f32 v53, v53
    v_rcp_f32 v54, v54
    v_rcp_f32 v55, v55
    v_pk_mul_f32 v[40:41], v[48:49], v[40:41]
    v_pk_mul_f32 v[42:43], v[50:51], v[42:43]
    v_pk_mul_f32 v[44:45], v[52:53], v[44:45]
    v_pk_mul_f32 v[46:47], v[54:55], v[46:47]
    v_cvt_pk_bf16_f32 v56, v40, v41
    v_cvt_pk_bf16_f32 v57, v42, v43
    v_cvt_pk_bf16_f32 v58, v44, v45
    v_cvt_pk_bf16_f32 v59, v46, v47
    buffer_store_dwordx4 v[56:59], v251, s[4:7], s53 offen offset:2048 sc1
    v_accvgpr_read_b32 v0, a120
    v_accvgpr_read_b32 v1, a121
    v_accvgpr_read_b32 v2, a122
    v_accvgpr_read_b32 v3, a123
    v_accvgpr_read_b32 v4, a124
    v_accvgpr_read_b32 v5, a125
    v_accvgpr_read_b32 v6, a126
    v_accvgpr_read_b32 v7, a127
    v_pk_mul_f32 v[8:9], v[0:1], v[0:1]
    v_pk_mul_f32 v[10:11], v[2:3], v[2:3]
    v_pk_mul_f32 v[12:13], v[4:5], v[4:5]
    v_pk_mul_f32 v[14:15], v[6:7], v[6:7]
    v_pk_fma_f32 v[8:9], v[8:9], v[242:243], v[240:241]
    v_pk_fma_f32 v[10:11], v[10:11], v[242:243], v[240:241]
    v_pk_fma_f32 v[12:13], v[12:13], v[242:243], v[240:241]
    v_pk_fma_f32 v[14:15], v[14:15], v[242:243], v[240:241]
    v_pk_mul_f32 v[8:9], v[8:9], v[0:1]
    v_pk_mul_f32 v[10:11], v[10:11], v[2:3]
    v_pk_mul_f32 v[12:13], v[12:13], v[4:5]
    v_pk_mul_f32 v[14:15], v[14:15], v[6:7]
    v_exp_f32 v8, v8
    v_exp_f32 v9, v9
    v_exp_f32 v10, v10
    v_exp_f32 v11, v11
    v_exp_f32 v12, v12
    v_exp_f32 v13, v13
    v_exp_f32 v14, v14
    v_exp_f32 v15, v15
    v_pk_add_f32 v[8:9], v[8:9], v[244:245]
    v_pk_add_f32 v[10:11], v[10:11], v[244:245]
    v_pk_add_f32 v[12:13], v[12:13], v[244:245]
    v_pk_add_f32 v[14:15], v[14:15], v[244:245]
    v_rcp_f32 v8, v8
    v_rcp_f32 v9, v9
    v_rcp_f32 v10, v10
    v_rcp_f32 v11, v11
    v_rcp_f32 v12, v12
    v_rcp_f32 v13, v13
    v_rcp_f32 v14, v14
    v_rcp_f32 v15, v15
    v_pk_mul_f32 v[0:1], v[8:9], v[0:1]
    v_pk_mul_f32 v[2:3], v[10:11], v[2:3]
    v_pk_mul_f32 v[4:5], v[12:13], v[4:5]
    v_pk_mul_f32 v[6:7], v[14:15], v[6:7]
    v_cvt_pk_bf16_f32 v16, v0, v1
    v_cvt_pk_bf16_f32 v17, v2, v3
    v_cvt_pk_bf16_f32 v18, v4, v5
    v_cvt_pk_bf16_f32 v19, v6, v7
    buffer_store_dwordx4 v[16:19], v251, s[4:7], s53 offen offset:3072 sc1
    s_add_u32 s53, s53, s22
    v_accvgpr_read_b32 v20, a128
    v_accvgpr_read_b32 v21, a129
    v_accvgpr_read_b32 v22, a130
    v_accvgpr_read_b32 v23, a131
    v_accvgpr_read_b32 v24, a132
    v_accvgpr_read_b32 v25, a133
    v_accvgpr_read_b32 v26, a134
    v_accvgpr_read_b32 v27, a135
    v_pk_mul_f32 v[28:29], v[20:21], v[20:21]
    v_pk_mul_f32 v[30:31], v[22:23], v[22:23]
    v_pk_mul_f32 v[32:33], v[24:25], v[24:25]
    v_pk_mul_f32 v[34:35], v[26:27], v[26:27]
    v_pk_fma_f32 v[28:29], v[28:29], v[242:243], v[240:241]
    v_pk_fma_f32 v[30:31], v[30:31], v[242:243], v[240:241]
    v_pk_fma_f32 v[32:33], v[32:33], v[242:243], v[240:241]
    v_pk_fma_f32 v[34:35], v[34:35], v[242:243], v[240:241]
    v_pk_mul_f32 v[28:29], v[28:29], v[20:21]
    v_pk_mul_f32 v[30:31], v[30:31], v[22:23]
    v_pk_mul_f32 v[32:33], v[32:33], v[24:25]
    v_pk_mul_f32 v[34:35], v[34:35], v[26:27]
    v_exp_f32 v28, v28
    v_exp_f32 v29, v29
    v_exp_f32 v30, v30
    v_exp_f32 v31, v31
    v_exp_f32 v32, v32
    v_exp_f32 v33, v33
    v_exp_f32 v34, v34
    v_exp_f32 v35, v35
    v_pk_add_f32 v[28:29], v[28:29], v[244:245]
    v_pk_add_f32 v[30:31], v[30:31], v[244:245]
    v_pk_add_f32 v[32:33], v[32:33], v[244:245]
    v_pk_add_f32 v[34:35], v[34:35], v[244:245]
    v_rcp_f32 v28, v28
    v_rcp_f32 v29, v29
    v_rcp_f32 v30, v30
    v_rcp_f32 v31, v31
    v_rcp_f32 v32, v32
    v_rcp_f32 v33, v33
    v_rcp_f32 v34, v34
    v_rcp_f32 v35, v35
    v_pk_mul_f32 v[20:21], v[28:29], v[20:21]
    v_pk_mul_f32 v[22:23], v[30:31], v[22:23]
    v_pk_mul_f32 v[24:25], v[32:33], v[24:25]
    v_pk_mul_f32 v[26:27], v[34:35], v[26:27]
    v_cvt_pk_bf16_f32 v36, v20, v21
    v_cvt_pk_bf16_f32 v37, v22, v23
    v_cvt_pk_bf16_f32 v38, v24, v25
    v_cvt_pk_bf16_f32 v39, v26, v27
    buffer_store_dwordx4 v[36:39], v251, s[4:7], s53 offen offset:0 sc1
    v_accvgpr_read_b32 v40, a136
    v_accvgpr_read_b32 v41, a137
    v_accvgpr_read_b32 v42, a138
    v_accvgpr_read_b32 v43, a139
    v_accvgpr_read_b32 v44, a140
    v_accvgpr_read_b32 v45, a141
    v_accvgpr_read_b32 v46, a142
    v_accvgpr_read_b32 v47, a143
    v_pk_mul_f32 v[48:49], v[40:41], v[40:41]
    v_pk_mul_f32 v[50:51], v[42:43], v[42:43]
    v_pk_mul_f32 v[52:53], v[44:45], v[44:45]
    v_pk_mul_f32 v[54:55], v[46:47], v[46:47]
    v_pk_fma_f32 v[48:49], v[48:49], v[242:243], v[240:241]
    v_pk_fma_f32 v[50:51], v[50:51], v[242:243], v[240:241]
    v_pk_fma_f32 v[52:53], v[52:53], v[242:243], v[240:241]
    v_pk_fma_f32 v[54:55], v[54:55], v[242:243], v[240:241]
    v_pk_mul_f32 v[48:49], v[48:49], v[40:41]
    v_pk_mul_f32 v[50:51], v[50:51], v[42:43]
    v_pk_mul_f32 v[52:53], v[52:53], v[44:45]
    v_pk_mul_f32 v[54:55], v[54:55], v[46:47]
    v_exp_f32 v48, v48
    v_exp_f32 v49, v49
    v_exp_f32 v50, v50
    v_exp_f32 v51, v51
    v_exp_f32 v52, v52
    v_exp_f32 v53, v53
    v_exp_f32 v54, v54
    v_exp_f32 v55, v55
    v_pk_add_f32 v[48:49], v[48:49], v[244:245]
    v_pk_add_f32 v[50:51], v[50:51], v[244:245]
    v_pk_add_f32 v[52:53], v[52:53], v[244:245]
    v_pk_add_f32 v[54:55], v[54:55], v[244:245]
    v_rcp_f32 v48, v48
    v_rcp_f32 v49, v49
    v_rcp_f32 v50, v50
    v_rcp_f32 v51, v51
    v_rcp_f32 v52, v52
    v_rcp_f32 v53, v53
    v_rcp_f32 v54, v54
    v_rcp_f32 v55, v55
    v_pk_mul_f32 v[40:41], v[48:49], v[40:41]
    v_pk_mul_f32 v[42:43], v[50:51], v[42:43]
    v_pk_mul_f32 v[44:45], v[52:53], v[44:45]
    v_pk_mul_f32 v[46:47], v[54:55], v[46:47]
    v_cvt_pk_bf16_f32 v56, v40, v41
    v_cvt_pk_bf16_f32 v57, v42, v43
    v_cvt_pk_bf16_f32 v58, v44, v45
    v_cvt_pk_bf16_f32 v59, v46, v47
    buffer_store_dwordx4 v[56:59], v251, s[4:7], s53 offen offset:1024 sc1
    v_accvgpr_read_b32 v0, a144
    v_accvgpr_read_b32 v1, a145
    v_accvgpr_read_b32 v2, a146
    v_accvgpr_read_b32 v3, a147
    v_accvgpr_read_b32 v4, a148
    v_accvgpr_read_b32 v5, a149
    v_accvgpr_read_b32 v6, a150
    v_accvgpr_read_b32 v7, a151
    v_pk_mul_f32 v[8:9], v[0:1], v[0:1]
    v_pk_mul_f32 v[10:11], v[2:3], v[2:3]
    v_pk_mul_f32 v[12:13], v[4:5], v[4:5]
    v_pk_mul_f32 v[14:15], v[6:7], v[6:7]
    v_pk_fma_f32 v[8:9], v[8:9], v[242:243], v[240:241]
    v_pk_fma_f32 v[10:11], v[10:11], v[242:243], v[240:241]
    v_pk_fma_f32 v[12:13], v[12:13], v[242:243], v[240:241]
    v_pk_fma_f32 v[14:15], v[14:15], v[242:243], v[240:241]
    v_pk_mul_f32 v[8:9], v[8:9], v[0:1]
    v_pk_mul_f32 v[10:11], v[10:11], v[2:3]
    v_pk_mul_f32 v[12:13], v[12:13], v[4:5]
    v_pk_mul_f32 v[14:15], v[14:15], v[6:7]
    v_exp_f32 v8, v8
    v_exp_f32 v9, v9
    v_exp_f32 v10, v10
    v_exp_f32 v11, v11
    v_exp_f32 v12, v12
    v_exp_f32 v13, v13
    v_exp_f32 v14, v14
    v_exp_f32 v15, v15
    v_pk_add_f32 v[8:9], v[8:9], v[244:245]
    v_pk_add_f32 v[10:11], v[10:11], v[244:245]
    v_pk_add_f32 v[12:13], v[12:13], v[244:245]
    v_pk_add_f32 v[14:15], v[14:15], v[244:245]
    v_rcp_f32 v8, v8
    v_rcp_f32 v9, v9
    v_rcp_f32 v10, v10
    v_rcp_f32 v11, v11
    v_rcp_f32 v12, v12
    v_rcp_f32 v13, v13
    v_rcp_f32 v14, v14
    v_rcp_f32 v15, v15
    v_pk_mul_f32 v[0:1], v[8:9], v[0:1]
    v_pk_mul_f32 v[2:3], v[10:11], v[2:3]
    v_pk_mul_f32 v[4:5], v[12:13], v[4:5]
    v_pk_mul_f32 v[6:7], v[14:15], v[6:7]
    v_cvt_pk_bf16_f32 v16, v0, v1
    v_cvt_pk_bf16_f32 v17, v2, v3
    v_cvt_pk_bf16_f32 v18, v4, v5
    v_cvt_pk_bf16_f32 v19, v6, v7
    buffer_store_dwordx4 v[16:19], v251, s[4:7], s53 offen offset:2048 sc1
    v_accvgpr_read_b32 v20, a152
    v_accvgpr_read_b32 v21, a153
    v_accvgpr_read_b32 v22, a154
    v_accvgpr_read_b32 v23, a155
    v_accvgpr_read_b32 v24, a156
    v_accvgpr_read_b32 v25, a157
    v_accvgpr_read_b32 v26, a158
    v_accvgpr_read_b32 v27, a159
    v_pk_mul_f32 v[28:29], v[20:21], v[20:21]
    v_pk_mul_f32 v[30:31], v[22:23], v[22:23]
    v_pk_mul_f32 v[32:33], v[24:25], v[24:25]
    v_pk_mul_f32 v[34:35], v[26:27], v[26:27]
    v_pk_fma_f32 v[28:29], v[28:29], v[242:243], v[240:241]
    v_pk_fma_f32 v[30:31], v[30:31], v[242:243], v[240:241]
    v_pk_fma_f32 v[32:33], v[32:33], v[242:243], v[240:241]
    v_pk_fma_f32 v[34:35], v[34:35], v[242:243], v[240:241]
    v_pk_mul_f32 v[28:29], v[28:29], v[20:21]
    v_pk_mul_f32 v[30:31], v[30:31], v[22:23]
    v_pk_mul_f32 v[32:33], v[32:33], v[24:25]
    v_pk_mul_f32 v[34:35], v[34:35], v[26:27]
    v_exp_f32 v28, v28
    v_exp_f32 v29, v29
    v_exp_f32 v30, v30
    v_exp_f32 v31, v31
    v_exp_f32 v32, v32
    v_exp_f32 v33, v33
    v_exp_f32 v34, v34
    v_exp_f32 v35, v35
    v_pk_add_f32 v[28:29], v[28:29], v[244:245]
    v_pk_add_f32 v[30:31], v[30:31], v[244:245]
    v_pk_add_f32 v[32:33], v[32:33], v[244:245]
    v_pk_add_f32 v[34:35], v[34:35], v[244:245]
    v_rcp_f32 v28, v28
    v_rcp_f32 v29, v29
    v_rcp_f32 v30, v30
    v_rcp_f32 v31, v31
    v_rcp_f32 v32, v32
    v_rcp_f32 v33, v33
    v_rcp_f32 v34, v34
    v_rcp_f32 v35, v35
    v_pk_mul_f32 v[20:21], v[28:29], v[20:21]
    v_pk_mul_f32 v[22:23], v[30:31], v[22:23]
    v_pk_mul_f32 v[24:25], v[32:33], v[24:25]
    v_pk_mul_f32 v[26:27], v[34:35], v[26:27]
    v_cvt_pk_bf16_f32 v36, v20, v21
    v_cvt_pk_bf16_f32 v37, v22, v23
    v_cvt_pk_bf16_f32 v38, v24, v25
    v_cvt_pk_bf16_f32 v39, v26, v27
    buffer_store_dwordx4 v[36:39], v251, s[4:7], s53 offen offset:3072 sc1
    s_add_u32 s53, s53, s22
    v_accvgpr_read_b32 v40, a160
    v_accvgpr_read_b32 v41, a161
    v_accvgpr_read_b32 v42, a162
    v_accvgpr_read_b32 v43, a163
    v_accvgpr_read_b32 v44, a164
    v_accvgpr_read_b32 v45, a165
    v_accvgpr_read_b32 v46, a166
    v_accvgpr_read_b32 v47, a167
    v_pk_mul_f32 v[48:49], v[40:41], v[40:41]
    v_pk_mul_f32 v[50:51], v[42:43], v[42:43]
    v_pk_mul_f32 v[52:53], v[44:45], v[44:45]
    v_pk_mul_f32 v[54:55], v[46:47], v[46:47]
    v_pk_fma_f32 v[48:49], v[48:49], v[242:243], v[240:241]
    v_pk_fma_f32 v[50:51], v[50:51], v[242:243], v[240:241]
    v_pk_fma_f32 v[52:53], v[52:53], v[242:243], v[240:241]
    v_pk_fma_f32 v[54:55], v[54:55], v[242:243], v[240:241]
    v_pk_mul_f32 v[48:49], v[48:49], v[40:41]
    v_pk_mul_f32 v[50:51], v[50:51], v[42:43]
    v_pk_mul_f32 v[52:53], v[52:53], v[44:45]
    v_pk_mul_f32 v[54:55], v[54:55], v[46:47]
    v_exp_f32 v48, v48
    v_exp_f32 v49, v49
    v_exp_f32 v50, v50
    v_exp_f32 v51, v51
    v_exp_f32 v52, v52
    v_exp_f32 v53, v53
    v_exp_f32 v54, v54
    v_exp_f32 v55, v55
    v_pk_add_f32 v[48:49], v[48:49], v[244:245]
    v_pk_add_f32 v[50:51], v[50:51], v[244:245]
    v_pk_add_f32 v[52:53], v[52:53], v[244:245]
    v_pk_add_f32 v[54:55], v[54:55], v[244:245]
    v_rcp_f32 v48, v48
    v_rcp_f32 v49, v49
    v_rcp_f32 v50, v50
    v_rcp_f32 v51, v51
    v_rcp_f32 v52, v52
    v_rcp_f32 v53, v53
    v_rcp_f32 v54, v54
    v_rcp_f32 v55, v55
    v_pk_mul_f32 v[40:41], v[48:49], v[40:41]
    v_pk_mul_f32 v[42:43], v[50:51], v[42:43]
    v_pk_mul_f32 v[44:45], v[52:53], v[44:45]
    v_pk_mul_f32 v[46:47], v[54:55], v[46:47]
    v_cvt_pk_bf16_f32 v56, v40, v41
    v_cvt_pk_bf16_f32 v57, v42, v43
    v_cvt_pk_bf16_f32 v58, v44, v45
    v_cvt_pk_bf16_f32 v59, v46, v47
    buffer_store_dwordx4 v[56:59], v251, s[4:7], s53 offen offset:0 sc1
    v_accvgpr_read_b32 v0, a168
    v_accvgpr_read_b32 v1, a169
    v_accvgpr_read_b32 v2, a170
    v_accvgpr_read_b32 v3, a171
    v_accvgpr_read_b32 v4, a172
    v_accvgpr_read_b32 v5, a173
    v_accvgpr_read_b32 v6, a174
    v_accvgpr_read_b32 v7, a175
    v_pk_mul_f32 v[8:9], v[0:1], v[0:1]
    v_pk_mul_f32 v[10:11], v[2:3], v[2:3]
    v_pk_mul_f32 v[12:13], v[4:5], v[4:5]
    v_pk_mul_f32 v[14:15], v[6:7], v[6:7]
    v_pk_fma_f32 v[8:9], v[8:9], v[242:243], v[240:241]
    v_pk_fma_f32 v[10:11], v[10:11], v[242:243], v[240:241]
    v_pk_fma_f32 v[12:13], v[12:13], v[242:243], v[240:241]
    v_pk_fma_f32 v[14:15], v[14:15], v[242:243], v[240:241]
    v_pk_mul_f32 v[8:9], v[8:9], v[0:1]
    v_pk_mul_f32 v[10:11], v[10:11], v[2:3]
    v_pk_mul_f32 v[12:13], v[12:13], v[4:5]
    v_pk_mul_f32 v[14:15], v[14:15], v[6:7]
    v_exp_f32 v8, v8
    v_exp_f32 v9, v9
    v_exp_f32 v10, v10
    v_exp_f32 v11, v11
    v_exp_f32 v12, v12
    v_exp_f32 v13, v13
    v_exp_f32 v14, v14
    v_exp_f32 v15, v15
    v_pk_add_f32 v[8:9], v[8:9], v[244:245]
    v_pk_add_f32 v[10:11], v[10:11], v[244:245]
    v_pk_add_f32 v[12:13], v[12:13], v[244:245]
    v_pk_add_f32 v[14:15], v[14:15], v[244:245]
    v_rcp_f32 v8, v8
    v_rcp_f32 v9, v9
    v_rcp_f32 v10, v10
    v_rcp_f32 v11, v11
    v_rcp_f32 v12, v12
    v_rcp_f32 v13, v13
    v_rcp_f32 v14, v14
    v_rcp_f32 v15, v15
    v_pk_mul_f32 v[0:1], v[8:9], v[0:1]
    v_pk_mul_f32 v[2:3], v[10:11], v[2:3]
    v_pk_mul_f32 v[4:5], v[12:13], v[4:5]
    v_pk_mul_f32 v[6:7], v[14:15], v[6:7]
    v_cvt_pk_bf16_f32 v16, v0, v1
    v_cvt_pk_bf16_f32 v17, v2, v3
    v_cvt_pk_bf16_f32 v18, v4, v5
    v_cvt_pk_bf16_f32 v19, v6, v7
    buffer_store_dwordx4 v[16:19], v251, s[4:7], s53 offen offset:1024 sc1
    v_accvgpr_read_b32 v20, a176
    v_accvgpr_read_b32 v21, a177
    v_accvgpr_read_b32 v22, a178
    v_accvgpr_read_b32 v23, a179
    v_accvgpr_read_b32 v24, a180
    v_accvgpr_read_b32 v25, a181
    v_accvgpr_read_b32 v26, a182
    v_accvgpr_read_b32 v27, a183
    v_pk_mul_f32 v[28:29], v[20:21], v[20:21]
    v_pk_mul_f32 v[30:31], v[22:23], v[22:23]
    v_pk_mul_f32 v[32:33], v[24:25], v[24:25]
    v_pk_mul_f32 v[34:35], v[26:27], v[26:27]
    v_pk_fma_f32 v[28:29], v[28:29], v[242:243], v[240:241]
    v_pk_fma_f32 v[30:31], v[30:31], v[242:243], v[240:241]
    v_pk_fma_f32 v[32:33], v[32:33], v[242:243], v[240:241]
    v_pk_fma_f32 v[34:35], v[34:35], v[242:243], v[240:241]
    v_pk_mul_f32 v[28:29], v[28:29], v[20:21]
    v_pk_mul_f32 v[30:31], v[30:31], v[22:23]
    v_pk_mul_f32 v[32:33], v[32:33], v[24:25]
    v_pk_mul_f32 v[34:35], v[34:35], v[26:27]
    v_exp_f32 v28, v28
    v_exp_f32 v29, v29
    v_exp_f32 v30, v30
    v_exp_f32 v31, v31
    v_exp_f32 v32, v32
    v_exp_f32 v33, v33
    v_exp_f32 v34, v34
    v_exp_f32 v35, v35
    v_pk_add_f32 v[28:29], v[28:29], v[244:245]
    v_pk_add_f32 v[30:31], v[30:31], v[244:245]
    v_pk_add_f32 v[32:33], v[32:33], v[244:245]
    v_pk_add_f32 v[34:35], v[34:35], v[244:245]
    v_rcp_f32 v28, v28
    v_rcp_f32 v29, v29
    v_rcp_f32 v30, v30
    v_rcp_f32 v31, v31
    v_rcp_f32 v32, v32
    v_rcp_f32 v33, v33
    v_rcp_f32 v34, v34
    v_rcp_f32 v35, v35
    v_pk_mul_f32 v[20:21], v[28:29], v[20:21]
    v_pk_mul_f32 v[22:23], v[30:31], v[22:23]
    v_pk_mul_f32 v[24:25], v[32:33], v[24:25]
    v_pk_mul_f32 v[26:27], v[34:35], v[26:27]
    v_cvt_pk_bf16_f32 v36, v20, v21
    v_cvt_pk_bf16_f32 v37, v22, v23
    v_cvt_pk_bf16_f32 v38, v24, v25
    v_cvt_pk_bf16_f32 v39, v26, v27
    buffer_store_dwordx4 v[36:39], v251, s[4:7], s53 offen offset:2048 sc1
    v_accvgpr_read_b32 v40, a184
    v_accvgpr_read_b32 v41, a185
    v_accvgpr_read_b32 v42, a186
    v_accvgpr_read_b32 v43, a187
    v_accvgpr_read_b32 v44, a188
    v_accvgpr_read_b32 v45, a189
    v_accvgpr_read_b32 v46, a190
    v_accvgpr_read_b32 v47, a191
    v_pk_mul_f32 v[48:49], v[40:41], v[40:41]
    v_pk_mul_f32 v[50:51], v[42:43], v[42:43]
    v_pk_mul_f32 v[52:53], v[44:45], v[44:45]
    v_pk_mul_f32 v[54:55], v[46:47], v[46:47]
    v_pk_fma_f32 v[48:49], v[48:49], v[242:243], v[240:241]
    v_pk_fma_f32 v[50:51], v[50:51], v[242:243], v[240:241]
    v_pk_fma_f32 v[52:53], v[52:53], v[242:243], v[240:241]
    v_pk_fma_f32 v[54:55], v[54:55], v[242:243], v[240:241]
    v_pk_mul_f32 v[48:49], v[48:49], v[40:41]
    v_pk_mul_f32 v[50:51], v[50:51], v[42:43]
    v_pk_mul_f32 v[52:53], v[52:53], v[44:45]
    v_pk_mul_f32 v[54:55], v[54:55], v[46:47]
    v_exp_f32 v48, v48
    v_exp_f32 v49, v49
    v_exp_f32 v50, v50
    v_exp_f32 v51, v51
    v_exp_f32 v52, v52
    v_exp_f32 v53, v53
    v_exp_f32 v54, v54
    v_exp_f32 v55, v55
    v_pk_add_f32 v[48:49], v[48:49], v[244:245]
    v_pk_add_f32 v[50:51], v[50:51], v[244:245]
    v_pk_add_f32 v[52:53], v[52:53], v[244:245]
    v_pk_add_f32 v[54:55], v[54:55], v[244:245]
    v_rcp_f32 v48, v48
    v_rcp_f32 v49, v49
    v_rcp_f32 v50, v50
    v_rcp_f32 v51, v51
    v_rcp_f32 v52, v52
    v_rcp_f32 v53, v53
    v_rcp_f32 v54, v54
    v_rcp_f32 v55, v55
    v_pk_mul_f32 v[40:41], v[48:49], v[40:41]
    v_pk_mul_f32 v[42:43], v[50:51], v[42:43]
    v_pk_mul_f32 v[44:45], v[52:53], v[44:45]
    v_pk_mul_f32 v[46:47], v[54:55], v[46:47]
    v_cvt_pk_bf16_f32 v56, v40, v41
    v_cvt_pk_bf16_f32 v57, v42, v43
    v_cvt_pk_bf16_f32 v58, v44, v45
    v_cvt_pk_bf16_f32 v59, v46, v47
    buffer_store_dwordx4 v[56:59], v251, s[4:7], s53 offen offset:3072 sc1
    s_add_u32 s53, s53, s22
    v_accvgpr_read_b32 v0, a192
    v_accvgpr_read_b32 v1, a193
    v_accvgpr_read_b32 v2, a194
    v_accvgpr_read_b32 v3, a195
    v_accvgpr_read_b32 v4, a196
    v_accvgpr_read_b32 v5, a197
    v_accvgpr_read_b32 v6, a198
    v_accvgpr_read_b32 v7, a199
    v_pk_mul_f32 v[8:9], v[0:1], v[0:1]
    v_pk_mul_f32 v[10:11], v[2:3], v[2:3]
    v_pk_mul_f32 v[12:13], v[4:5], v[4:5]
    v_pk_mul_f32 v[14:15], v[6:7], v[6:7]
    v_pk_fma_f32 v[8:9], v[8:9], v[242:243], v[240:241]
    v_pk_fma_f32 v[10:11], v[10:11], v[242:243], v[240:241]
    v_pk_fma_f32 v[12:13], v[12:13], v[242:243], v[240:241]
    v_pk_fma_f32 v[14:15], v[14:15], v[242:243], v[240:241]
    v_pk_mul_f32 v[8:9], v[8:9], v[0:1]
    v_pk_mul_f32 v[10:11], v[10:11], v[2:3]
    v_pk_mul_f32 v[12:13], v[12:13], v[4:5]
    v_pk_mul_f32 v[14:15], v[14:15], v[6:7]
    v_exp_f32 v8, v8
    v_exp_f32 v9, v9
    v_exp_f32 v10, v10
    v_exp_f32 v11, v11
    v_exp_f32 v12, v12
    v_exp_f32 v13, v13
    v_exp_f32 v14, v14
    v_exp_f32 v15, v15
    v_pk_add_f32 v[8:9], v[8:9], v[244:245]
    v_pk_add_f32 v[10:11], v[10:11], v[244:245]
    v_pk_add_f32 v[12:13], v[12:13], v[244:245]
    v_pk_add_f32 v[14:15], v[14:15], v[244:245]
    v_rcp_f32 v8, v8
    v_rcp_f32 v9, v9
    v_rcp_f32 v10, v10
    v_rcp_f32 v11, v11
    v_rcp_f32 v12, v12
    v_rcp_f32 v13, v13
    v_rcp_f32 v14, v14
    v_rcp_f32 v15, v15
    v_pk_mul_f32 v[0:1], v[8:9], v[0:1]
    v_pk_mul_f32 v[2:3], v[10:11], v[2:3]
    v_pk_mul_f32 v[4:5], v[12:13], v[4:5]
    v_pk_mul_f32 v[6:7], v[14:15], v[6:7]
    v_cvt_pk_bf16_f32 v16, v0, v1
    v_cvt_pk_bf16_f32 v17, v2, v3
    v_cvt_pk_bf16_f32 v18, v4, v5
    v_cvt_pk_bf16_f32 v19, v6, v7
    buffer_store_dwordx4 v[16:19], v251, s[4:7], s53 offen offset:0 sc1
    v_accvgpr_read_b32 v20, a200
    v_accvgpr_read_b32 v21, a201
    v_accvgpr_read_b32 v22, a202
    v_accvgpr_read_b32 v23, a203
    v_accvgpr_read_b32 v24, a204
    v_accvgpr_read_b32 v25, a205
    v_accvgpr_read_b32 v26, a206
    v_accvgpr_read_b32 v27, a207
    v_pk_mul_f32 v[28:29], v[20:21], v[20:21]
    v_pk_mul_f32 v[30:31], v[22:23], v[22:23]
    v_pk_mul_f32 v[32:33], v[24:25], v[24:25]
    v_pk_mul_f32 v[34:35], v[26:27], v[26:27]
    v_pk_fma_f32 v[28:29], v[28:29], v[242:243], v[240:241]
    v_pk_fma_f32 v[30:31], v[30:31], v[242:243], v[240:241]
    v_pk_fma_f32 v[32:33], v[32:33], v[242:243], v[240:241]
    v_pk_fma_f32 v[34:35], v[34:35], v[242:243], v[240:241]
    v_pk_mul_f32 v[28:29], v[28:29], v[20:21]
    v_pk_mul_f32 v[30:31], v[30:31], v[22:23]
    v_pk_mul_f32 v[32:33], v[32:33], v[24:25]
    v_pk_mul_f32 v[34:35], v[34:35], v[26:27]
    v_exp_f32 v28, v28
    v_exp_f32 v29, v29
    v_exp_f32 v30, v30
    v_exp_f32 v31, v31
    v_exp_f32 v32, v32
    v_exp_f32 v33, v33
    v_exp_f32 v34, v34
    v_exp_f32 v35, v35
    v_pk_add_f32 v[28:29], v[28:29], v[244:245]
    v_pk_add_f32 v[30:31], v[30:31], v[244:245]
    v_pk_add_f32 v[32:33], v[32:33], v[244:245]
    v_pk_add_f32 v[34:35], v[34:35], v[244:245]
    v_rcp_f32 v28, v28
    v_rcp_f32 v29, v29
    v_rcp_f32 v30, v30
    v_rcp_f32 v31, v31
    v_rcp_f32 v32, v32
    v_rcp_f32 v33, v33
    v_rcp_f32 v34, v34
    v_rcp_f32 v35, v35
    v_pk_mul_f32 v[20:21], v[28:29], v[20:21]
    v_pk_mul_f32 v[22:23], v[30:31], v[22:23]
    v_pk_mul_f32 v[24:25], v[32:33], v[24:25]
    v_pk_mul_f32 v[26:27], v[34:35], v[26:27]
    v_cvt_pk_bf16_f32 v36, v20, v21
    v_cvt_pk_bf16_f32 v37, v22, v23
    v_cvt_pk_bf16_f32 v38, v24, v25
    v_cvt_pk_bf16_f32 v39, v26, v27
    buffer_store_dwordx4 v[36:39], v251, s[4:7], s53 offen offset:1024 sc1
    v_accvgpr_read_b32 v40, a208
    v_accvgpr_read_b32 v41, a209
    v_accvgpr_read_b32 v42, a210
    v_accvgpr_read_b32 v43, a211
    v_accvgpr_read_b32 v44, a212
    v_accvgpr_read_b32 v45, a213
    v_accvgpr_read_b32 v46, a214
    v_accvgpr_read_b32 v47, a215
    v_pk_mul_f32 v[48:49], v[40:41], v[40:41]
    v_pk_mul_f32 v[50:51], v[42:43], v[42:43]
    v_pk_mul_f32 v[52:53], v[44:45], v[44:45]
    v_pk_mul_f32 v[54:55], v[46:47], v[46:47]
    v_pk_fma_f32 v[48:49], v[48:49], v[242:243], v[240:241]
    v_pk_fma_f32 v[50:51], v[50:51], v[242:243], v[240:241]
    v_pk_fma_f32 v[52:53], v[52:53], v[242:243], v[240:241]
    v_pk_fma_f32 v[54:55], v[54:55], v[242:243], v[240:241]
    v_pk_mul_f32 v[48:49], v[48:49], v[40:41]
    v_pk_mul_f32 v[50:51], v[50:51], v[42:43]
    v_pk_mul_f32 v[52:53], v[52:53], v[44:45]
    v_pk_mul_f32 v[54:55], v[54:55], v[46:47]
    v_exp_f32 v48, v48
    v_exp_f32 v49, v49
    v_exp_f32 v50, v50
    v_exp_f32 v51, v51
    v_exp_f32 v52, v52
    v_exp_f32 v53, v53
    v_exp_f32 v54, v54
    v_exp_f32 v55, v55
    v_pk_add_f32 v[48:49], v[48:49], v[244:245]
    v_pk_add_f32 v[50:51], v[50:51], v[244:245]
    v_pk_add_f32 v[52:53], v[52:53], v[244:245]
    v_pk_add_f32 v[54:55], v[54:55], v[244:245]
    v_rcp_f32 v48, v48
    v_rcp_f32 v49, v49
    v_rcp_f32 v50, v50
    v_rcp_f32 v51, v51
    v_rcp_f32 v52, v52
    v_rcp_f32 v53, v53
    v_rcp_f32 v54, v54
    v_rcp_f32 v55, v55
    v_pk_mul_f32 v[40:41], v[48:49], v[40:41]
    v_pk_mul_f32 v[42:43], v[50:51], v[42:43]
    v_pk_mul_f32 v[44:45], v[52:53], v[44:45]
    v_pk_mul_f32 v[46:47], v[54:55], v[46:47]
    v_cvt_pk_bf16_f32 v56, v40, v41
    v_cvt_pk_bf16_f32 v57, v42, v43
    v_cvt_pk_bf16_f32 v58, v44, v45
    v_cvt_pk_bf16_f32 v59, v46, v47
    buffer_store_dwordx4 v[56:59], v251, s[4:7], s53 offen offset:2048 sc1
    v_accvgpr_read_b32 v0, a216
    v_accvgpr_read_b32 v1, a217
    v_accvgpr_read_b32 v2, a218
    v_accvgpr_read_b32 v3, a219
    v_accvgpr_read_b32 v4, a220
    v_accvgpr_read_b32 v5, a221
    v_accvgpr_read_b32 v6, a222
    v_accvgpr_read_b32 v7, a223
    v_pk_mul_f32 v[8:9], v[0:1], v[0:1]
    v_pk_mul_f32 v[10:11], v[2:3], v[2:3]
    v_pk_mul_f32 v[12:13], v[4:5], v[4:5]
    v_pk_mul_f32 v[14:15], v[6:7], v[6:7]
    v_pk_fma_f32 v[8:9], v[8:9], v[242:243], v[240:241]
    v_pk_fma_f32 v[10:11], v[10:11], v[242:243], v[240:241]
    v_pk_fma_f32 v[12:13], v[12:13], v[242:243], v[240:241]
    v_pk_fma_f32 v[14:15], v[14:15], v[242:243], v[240:241]
    v_pk_mul_f32 v[8:9], v[8:9], v[0:1]
    v_pk_mul_f32 v[10:11], v[10:11], v[2:3]
    v_pk_mul_f32 v[12:13], v[12:13], v[4:5]
    v_pk_mul_f32 v[14:15], v[14:15], v[6:7]
    v_exp_f32 v8, v8
    v_exp_f32 v9, v9
    v_exp_f32 v10, v10
    v_exp_f32 v11, v11
    v_exp_f32 v12, v12
    v_exp_f32 v13, v13
    v_exp_f32 v14, v14
    v_exp_f32 v15, v15
    v_pk_add_f32 v[8:9], v[8:9], v[244:245]
    v_pk_add_f32 v[10:11], v[10:11], v[244:245]
    v_pk_add_f32 v[12:13], v[12:13], v[244:245]
    v_pk_add_f32 v[14:15], v[14:15], v[244:245]
    v_rcp_f32 v8, v8
    v_rcp_f32 v9, v9
    v_rcp_f32 v10, v10
    v_rcp_f32 v11, v11
    v_rcp_f32 v12, v12
    v_rcp_f32 v13, v13
    v_rcp_f32 v14, v14
    v_rcp_f32 v15, v15
    v_pk_mul_f32 v[0:1], v[8:9], v[0:1]
    v_pk_mul_f32 v[2:3], v[10:11], v[2:3]
    v_pk_mul_f32 v[4:5], v[12:13], v[4:5]
    v_pk_mul_f32 v[6:7], v[14:15], v[6:7]
    v_cvt_pk_bf16_f32 v16, v0, v1
    v_cvt_pk_bf16_f32 v17, v2, v3
    v_cvt_pk_bf16_f32 v18, v4, v5
    v_cvt_pk_bf16_f32 v19, v6, v7
    buffer_store_dwordx4 v[16:19], v251, s[4:7], s53 offen offset:3072 sc1
    s_add_u32 s53, s53, s22
    v_accvgpr_read_b32 v20, a224
    v_accvgpr_read_b32 v21, a225
    v_accvgpr_read_b32 v22, a226
    v_accvgpr_read_b32 v23, a227
    v_accvgpr_read_b32 v24, a228
    v_accvgpr_read_b32 v25, a229
    v_accvgpr_read_b32 v26, a230
    v_accvgpr_read_b32 v27, a231
    v_pk_mul_f32 v[28:29], v[20:21], v[20:21]
    v_pk_mul_f32 v[30:31], v[22:23], v[22:23]
    v_pk_mul_f32 v[32:33], v[24:25], v[24:25]
    v_pk_mul_f32 v[34:35], v[26:27], v[26:27]
    v_pk_fma_f32 v[28:29], v[28:29], v[242:243], v[240:241]
    v_pk_fma_f32 v[30:31], v[30:31], v[242:243], v[240:241]
    v_pk_fma_f32 v[32:33], v[32:33], v[242:243], v[240:241]
    v_pk_fma_f32 v[34:35], v[34:35], v[242:243], v[240:241]
    v_pk_mul_f32 v[28:29], v[28:29], v[20:21]
    v_pk_mul_f32 v[30:31], v[30:31], v[22:23]
    v_pk_mul_f32 v[32:33], v[32:33], v[24:25]
    v_pk_mul_f32 v[34:35], v[34:35], v[26:27]
    v_exp_f32 v28, v28
    v_exp_f32 v29, v29
    v_exp_f32 v30, v30
    v_exp_f32 v31, v31
    v_exp_f32 v32, v32
    v_exp_f32 v33, v33
    v_exp_f32 v34, v34
    v_exp_f32 v35, v35
    v_pk_add_f32 v[28:29], v[28:29], v[244:245]
    v_pk_add_f32 v[30:31], v[30:31], v[244:245]
    v_pk_add_f32 v[32:33], v[32:33], v[244:245]
    v_pk_add_f32 v[34:35], v[34:35], v[244:245]
    v_rcp_f32 v28, v28
    v_rcp_f32 v29, v29
    v_rcp_f32 v30, v30
    v_rcp_f32 v31, v31
    v_rcp_f32 v32, v32
    v_rcp_f32 v33, v33
    v_rcp_f32 v34, v34
    v_rcp_f32 v35, v35
    v_pk_mul_f32 v[20:21], v[28:29], v[20:21]
    v_pk_mul_f32 v[22:23], v[30:31], v[22:23]
    v_pk_mul_f32 v[24:25], v[32:33], v[24:25]
    v_pk_mul_f32 v[26:27], v[34:35], v[26:27]
    v_cvt_pk_bf16_f32 v36, v20, v21
    v_cvt_pk_bf16_f32 v37, v22, v23
    v_cvt_pk_bf16_f32 v38, v24, v25
    v_cvt_pk_bf16_f32 v39, v26, v27
    buffer_store_dwordx4 v[36:39], v251, s[4:7], s53 offen offset:0 sc1
    v_accvgpr_read_b32 v40, a232
    v_accvgpr_read_b32 v41, a233
    v_accvgpr_read_b32 v42, a234
    v_accvgpr_read_b32 v43, a235
    v_accvgpr_read_b32 v44, a236
    v_accvgpr_read_b32 v45, a237
    v_accvgpr_read_b32 v46, a238
    v_accvgpr_read_b32 v47, a239
    v_pk_mul_f32 v[48:49], v[40:41], v[40:41]
    v_pk_mul_f32 v[50:51], v[42:43], v[42:43]
    v_pk_mul_f32 v[52:53], v[44:45], v[44:45]
    v_pk_mul_f32 v[54:55], v[46:47], v[46:47]
    v_pk_fma_f32 v[48:49], v[48:49], v[242:243], v[240:241]
    v_pk_fma_f32 v[50:51], v[50:51], v[242:243], v[240:241]
    v_pk_fma_f32 v[52:53], v[52:53], v[242:243], v[240:241]
    v_pk_fma_f32 v[54:55], v[54:55], v[242:243], v[240:241]
    v_pk_mul_f32 v[48:49], v[48:49], v[40:41]
    v_pk_mul_f32 v[50:51], v[50:51], v[42:43]
    v_pk_mul_f32 v[52:53], v[52:53], v[44:45]
    v_pk_mul_f32 v[54:55], v[54:55], v[46:47]
    v_exp_f32 v48, v48
    v_exp_f32 v49, v49
    v_exp_f32 v50, v50
    v_exp_f32 v51, v51
    v_exp_f32 v52, v52
    v_exp_f32 v53, v53
    v_exp_f32 v54, v54
    v_exp_f32 v55, v55
    v_pk_add_f32 v[48:49], v[48:49], v[244:245]
    v_pk_add_f32 v[50:51], v[50:51], v[244:245]
    v_pk_add_f32 v[52:53], v[52:53], v[244:245]
    v_pk_add_f32 v[54:55], v[54:55], v[244:245]
    v_rcp_f32 v48, v48
    v_rcp_f32 v49, v49
    v_rcp_f32 v50, v50
    v_rcp_f32 v51, v51
    v_rcp_f32 v52, v52
    v_rcp_f32 v53, v53
    v_rcp_f32 v54, v54
    v_rcp_f32 v55, v55
    v_pk_mul_f32 v[40:41], v[48:49], v[40:41]
    v_pk_mul_f32 v[42:43], v[50:51], v[42:43]
    v_pk_mul_f32 v[44:45], v[52:53], v[44:45]
    v_pk_mul_f32 v[46:47], v[54:55], v[46:47]
    v_cvt_pk_bf16_f32 v56, v40, v41
    v_cvt_pk_bf16_f32 v57, v42, v43
    v_cvt_pk_bf16_f32 v58, v44, v45
    v_cvt_pk_bf16_f32 v59, v46, v47
    buffer_store_dwordx4 v[56:59], v251, s[4:7], s53 offen offset:1024 sc1
    v_accvgpr_read_b32 v0, a240
    v_accvgpr_read_b32 v1, a241
    v_accvgpr_read_b32 v2, a242
    v_accvgpr_read_b32 v3, a243
    v_accvgpr_read_b32 v4, a244
    v_accvgpr_read_b32 v5, a245
    v_accvgpr_read_b32 v6, a246
    v_accvgpr_read_b32 v7, a247
    v_pk_mul_f32 v[8:9], v[0:1], v[0:1]
    v_pk_mul_f32 v[10:11], v[2:3], v[2:3]
    v_pk_mul_f32 v[12:13], v[4:5], v[4:5]
    v_pk_mul_f32 v[14:15], v[6:7], v[6:7]
    v_pk_fma_f32 v[8:9], v[8:9], v[242:243], v[240:241]
    v_pk_fma_f32 v[10:11], v[10:11], v[242:243], v[240:241]
    v_pk_fma_f32 v[12:13], v[12:13], v[242:243], v[240:241]
    v_pk_fma_f32 v[14:15], v[14:15], v[242:243], v[240:241]
    v_pk_mul_f32 v[8:9], v[8:9], v[0:1]
    v_pk_mul_f32 v[10:11], v[10:11], v[2:3]
    v_pk_mul_f32 v[12:13], v[12:13], v[4:5]
    v_pk_mul_f32 v[14:15], v[14:15], v[6:7]
    v_exp_f32 v8, v8
    v_exp_f32 v9, v9
    v_exp_f32 v10, v10
    v_exp_f32 v11, v11
    v_exp_f32 v12, v12
    v_exp_f32 v13, v13
    v_exp_f32 v14, v14
    v_exp_f32 v15, v15
    v_pk_add_f32 v[8:9], v[8:9], v[244:245]
    v_pk_add_f32 v[10:11], v[10:11], v[244:245]
    v_pk_add_f32 v[12:13], v[12:13], v[244:245]
    v_pk_add_f32 v[14:15], v[14:15], v[244:245]
    v_rcp_f32 v8, v8
    v_rcp_f32 v9, v9
    v_rcp_f32 v10, v10
    v_rcp_f32 v11, v11
    v_rcp_f32 v12, v12
    v_rcp_f32 v13, v13
    v_rcp_f32 v14, v14
    v_rcp_f32 v15, v15
    v_pk_mul_f32 v[0:1], v[8:9], v[0:1]
    v_pk_mul_f32 v[2:3], v[10:11], v[2:3]
    v_pk_mul_f32 v[4:5], v[12:13], v[4:5]
    v_pk_mul_f32 v[6:7], v[14:15], v[6:7]
    v_cvt_pk_bf16_f32 v16, v0, v1
    v_cvt_pk_bf16_f32 v17, v2, v3
    v_cvt_pk_bf16_f32 v18, v4, v5
    v_cvt_pk_bf16_f32 v19, v6, v7
    buffer_store_dwordx4 v[16:19], v251, s[4:7], s53 offen offset:2048 sc1
    v_accvgpr_read_b32 v20, a248
    v_accvgpr_read_b32 v21, a249
    v_accvgpr_read_b32 v22, a250
    v_accvgpr_read_b32 v23, a251
    v_accvgpr_read_b32 v24, a252
    v_accvgpr_read_b32 v25, a253
    v_accvgpr_read_b32 v26, a254
    v_accvgpr_read_b32 v27, a255
    v_pk_mul_f32 v[28:29], v[20:21], v[20:21]
    v_pk_mul_f32 v[30:31], v[22:23], v[22:23]
    v_pk_mul_f32 v[32:33], v[24:25], v[24:25]
    v_pk_mul_f32 v[34:35], v[26:27], v[26:27]
    v_pk_fma_f32 v[28:29], v[28:29], v[242:243], v[240:241]
    v_pk_fma_f32 v[30:31], v[30:31], v[242:243], v[240:241]
    v_pk_fma_f32 v[32:33], v[32:33], v[242:243], v[240:241]
    v_pk_fma_f32 v[34:35], v[34:35], v[242:243], v[240:241]
    v_pk_mul_f32 v[28:29], v[28:29], v[20:21]
    v_pk_mul_f32 v[30:31], v[30:31], v[22:23]
    v_pk_mul_f32 v[32:33], v[32:33], v[24:25]
    v_pk_mul_f32 v[34:35], v[34:35], v[26:27]
    v_exp_f32 v28, v28
    v_exp_f32 v29, v29
    v_exp_f32 v30, v30
    v_exp_f32 v31, v31
    v_exp_f32 v32, v32
    v_exp_f32 v33, v33
    v_exp_f32 v34, v34
    v_exp_f32 v35, v35
    v_pk_add_f32 v[28:29], v[28:29], v[244:245]
    v_pk_add_f32 v[30:31], v[30:31], v[244:245]
    v_pk_add_f32 v[32:33], v[32:33], v[244:245]
    v_pk_add_f32 v[34:35], v[34:35], v[244:245]
    v_rcp_f32 v28, v28
    v_rcp_f32 v29, v29
    v_rcp_f32 v30, v30
    v_rcp_f32 v31, v31
    v_rcp_f32 v32, v32
    v_rcp_f32 v33, v33
    v_rcp_f32 v34, v34
    v_rcp_f32 v35, v35
    v_pk_mul_f32 v[20:21], v[28:29], v[20:21]
    v_pk_mul_f32 v[22:23], v[30:31], v[22:23]
    v_pk_mul_f32 v[24:25], v[32:33], v[24:25]
    v_pk_mul_f32 v[26:27], v[34:35], v[26:27]
    v_cvt_pk_bf16_f32 v36, v20, v21
    v_cvt_pk_bf16_f32 v37, v22, v23
    v_cvt_pk_bf16_f32 v38, v24, v25
    v_cvt_pk_bf16_f32 v39, v26, v27
    buffer_store_dwordx4 v[36:39], v251, s[4:7], s53 offen offset:3072 sc1
    s_branch main_kernel_w_done
main_kernel_w_c2_gov:
    v_lshrrev_b32 v0, 4, v250
    v_bfe_u32 v1, v250, 2, 2
    v_lshl_add_u32 v4, v0, 2, v1
    v_and_b32 v5, 7, v4
    v_mul_u32_u24 v4, 512, v4
    v_and_b32 v6, 3, v250
    v_lshl_add_u32 v4, v6, 3, v4
    s_mul_i32 s32, s37, 8
    v_xor_b32 v5, s32, v5
    v_lshl_add_u32 v128, v5, 5, v4
    v_xor_b32 v129, 32, v128
    v_xor_b32 v130, 64, v128
    v_xor_b32 v131, 96, v128
    v_xor_b32 v132, 128, v128
    v_xor_b32 v133, 160, v128
    v_xor_b32 v134, 192, v128
    v_xor_b32 v135, 224, v128
    s_mul_i32 s32, s38, 8192
    s_add_u32 s32, s32, 65536
    v_add_u32 v136, s32, v251
    v_lshrrev_b32 v2, 5, v250
    v_and_b32 v3, 31, v250
    s_mul_i32 s32, s14, 8
    v_add_u32 v4, s32, v2
    v_add_u32 v5, 0, v4
    v_and_b32 v6, 7, v5
    v_lshlrev_b32 v6, 1, v6
    v_xor_b32 v6, v6, v3
    v_mul_lo_u32 v5, v5, s30
    v_lshl_add_u32 v5, v6, 4, v5
    v_subrev_u32 v137, 0, v5
    v_add_u32 v5, 2, v4
    v_and_b32 v6, 7, v5
    v_lshlrev_b32 v6, 1, v6
    v_xor_b32 v6, v6, v3
    v_mul_lo_u32 v5, v5, s30
    v_lshl_add_u32 v5, v6, 4, v5
    v_subrev_u32 v138, 1024, v5
    v_add_u32 v5, 4, v4
    v_and_b32 v6, 7, v5
    v_lshlrev_b32 v6, 1, v6
    v_xor_b32 v6, v6, v3
    v_mul_lo_u32 v5, v5, s30
    v_lshl_add_u32 v5, v6, 4, v5
    v_subrev_u32 v139, 2048, v5
    v_add_u32 v5, 6, v4
    v_and_b32 v6, 7, v5
    v_lshlrev_b32 v6, 1, v6
    v_xor_b32 v6, v6, v3
    v_mul_lo_u32 v5, v5, s30
    v_lshl_add_u32 v5, v6, 4, v5
    v_subrev_u32 v140, 3072, v5
    s_mul_i32 s32, s14, 4
    s_mul_i32 s32, s32, s31
    v_add_u32 v141, s32, v251
    s_add_u32 s32, s32, s31
    s_sub_u32 s32, s32, 1024
    v_add_u32 v142, s32, v251
    s_add_u32 s32, s32, s31
    s_sub_u32 s32, s32, 1024
    v_add_u32 v143, s32, v251
    s_add_u32 s32, s32, s31
    s_sub_u32 s32, s32, 1024
    v_add_u32 v144, s32, v251
    s_mul_i32 s19, s14, 4096
    s_mul_i32 s20, s14, 4096
    s_add_u32 s20, s20, 65536
    s_mul_i32 s17, s30, 32
    s_mov_b32 s15, 0
    s_add_u32 m0, s20, 0
    s_nop 0
    buffer_load_dwordx4 v141, s[4:7], s16 offen offset:0 sc1 lds
    buffer_load_dwordx4 v142, s[4:7], s16 offen offset:1024 sc1 lds
    buffer_load_dwordx4 v143, s[4:7], s16 offen offset:2048 sc1 lds
    buffer_load_dwordx4 v144, s[4:7], s16 offen offset:3072 sc1 lds
    s_add_u32 s16, s16, 1024
    s_add_u32 m0, s19, 0
    s_nop 0
    buffer_load_dwordx4 v137, s[8:11], s15 offen offset:0 lds
    buffer_load_dwordx4 v138, s[8:11], s15 offen offset:1024 lds
    buffer_load_dwordx4 v139, s[8:11], s15 offen offset:2048 lds
    buffer_load_dwordx4 v140, s[8:11], s15 offen offset:3072 lds
    s_add_u32 s15, s15, s17
    s_add_u32 m0, s20, 16384
    s_nop 0
    buffer_load_dwordx4 v141, s[4:7], s16 offen offset:0 sc1 lds
    buffer_load_dwordx4 v142, s[4:7], s16 offen offset:1024 sc1 lds
    buffer_load_dwordx4 v143, s[4:7], s16 offen offset:2048 sc1 lds
    buffer_load_dwordx4 v144, s[4:7], s16 offen offset:3072 sc1 lds
    s_add_u32 s16, s16, 1024
    s_add_u32 m0, s19, 16384
    s_nop 0
    buffer_load_dwordx4 v137, s[8:11], s15 offen offset:0 lds
    buffer_load_dwordx4 v138, s[8:11], s15 offen offset:1024 lds
    buffer_load_dwordx4 v139, s[8:11], s15 offen offset:2048 lds
    buffer_load_dwordx4 v140, s[8:11], s15 offen offset:3072 lds
    s_add_u32 s15, s15, s17
    s_add_u32 m0, s20, 32768
    s_nop 0
    buffer_load_dwordx4 v141, s[4:7], s16 offen offset:0 sc1 lds
    buffer_load_dwordx4 v142, s[4:7], s16 offen offset:1024 sc1 lds
    buffer_load_dwordx4 v143, s[4:7], s16 offen offset:2048 sc1 lds
    buffer_load_dwordx4 v144, s[4:7], s16 offen offset:3072 sc1 lds
    s_add_u32 s16, s16, 1024
    s_add_u32 m0, s19, 32768
    s_nop 0
    buffer_load_dwordx4 v137, s[8:11], s15 offen offset:0 lds
    buffer_load_dwordx4 v138, s[8:11], s15 offen offset:1024 lds
    buffer_load_dwordx4 v139, s[8:11], s15 offen offset:2048 lds
    buffer_load_dwordx4 v140, s[8:11], s15 offen offset:3072 lds
    s_add_u32 s15, s15, s17
    s_add_u32 m0, s20, 49152
    s_nop 0
    buffer_load_dwordx4 v141, s[4:7], s16 offen offset:0 sc1 lds
    buffer_load_dwordx4 v142, s[4:7], s16 offen offset:1024 sc1 lds
    buffer_load_dwordx4 v143, s[4:7], s16 offen offset:2048 sc1 lds
    buffer_load_dwordx4 v144, s[4:7], s16 offen offset:3072 sc1 lds
    s_add_u32 s16, s16, 1024
    s_add_u32 m0, s19, 49152
    s_nop 0
    buffer_load_dwordx4 v137, s[8:11], s15 offen offset:0 lds
    buffer_load_dwordx4 v138, s[8:11], s15 offen offset:1024 lds
    buffer_load_dwordx4 v139, s[8:11], s15 offen offset:2048 lds
    buffer_load_dwordx4 v140, s[8:11], s15 offen offset:3072 lds
    s_add_u32 s15, s15, s17
    v_accvgpr_write_b32 a0, 0
    v_accvgpr_write_b32 a1, 0
    v_accvgpr_write_b32 a2, 0
    v_accvgpr_write_b32 a3, 0
    v_accvgpr_write_b32 a4, 0
    v_accvgpr_write_b32 a5, 0
    v_accvgpr_write_b32 a6, 0
    v_accvgpr_write_b32 a7, 0
    v_accvgpr_write_b32 a8, 0
    v_accvgpr_write_b32 a9, 0
    v_accvgpr_write_b32 a10, 0
    v_accvgpr_write_b32 a11, 0
    v_accvgpr_write_b32 a12, 0
    v_accvgpr_write_b32 a13, 0
    v_accvgpr_write_b32 a14, 0
    v_accvgpr_write_b32 a15, 0
    v_accvgpr_write_b32 a16, 0
    v_accvgpr_write_b32 a17, 0
    v_accvgpr_write_b32 a18, 0
    v_accvgpr_write_b32 a19, 0
    v_accvgpr_write_b32 a20, 0
    v_accvgpr_write_b32 a21, 0
    v_accvgpr_write_b32 a22, 0
    v_accvgpr_write_b32 a23, 0
    v_accvgpr_write_b32 a24, 0
    v_accvgpr_write_b32 a25, 0
    v_accvgpr_write_b32 a26, 0
    v_accvgpr_write_b32 a27, 0
    v_accvgpr_write_b32 a28, 0
    v_accvgpr_write_b32 a29, 0
    v_accvgpr_write_b32 a30, 0
    v_accvgpr_write_b32 a31, 0
    v_accvgpr_write_b32 a32, 0
    v_accvgpr_write_b32 a33, 0
    v_accvgpr_write_b32 a34, 0
    v_accvgpr_write_b32 a35, 0
    v_accvgpr_write_b32 a36, 0
    v_accvgpr_write_b32 a37, 0
    v_accvgpr_write_b32 a38, 0
    v_accvgpr_write_b32 a39, 0
    v_accvgpr_write_b32 a40, 0
    v_accvgpr_write_b32 a41, 0
    v_accvgpr_write_b32 a42, 0
    v_accvgpr_write_b32 a43, 0
    v_accvgpr_write_b32 a44, 0
    v_accvgpr_write_b32 a45, 0
    v_accvgpr_write_b32 a46, 0
    v_accvgpr_write_b32 a47, 0
    v_accvgpr_write_b32 a48, 0
    v_accvgpr_write_b32 a49, 0
    v_accvgpr_write_b32 a50, 0
    v_accvgpr_write_b32 a51, 0
    v_accvgpr_write_b32 a52, 0
    v_accvgpr_write_b32 a53, 0
    v_accvgpr_write_b32 a54, 0
    v_accvgpr_write_b32 a55, 0
    v_accvgpr_write_b32 a56, 0
    v_accvgpr_write_b32 a57, 0
    v_accvgpr_write_b32 a58, 0
    v_accvgpr_write_b32 a59, 0
    v_accvgpr_write_b32 a60, 0
    v_accvgpr_write_b32 a61, 0
    v_accvgpr_write_b32 a62, 0
    v_accvgpr_write_b32 a63, 0
    v_accvgpr_write_b32 a64, 0
    v_accvgpr_write_b32 a65, 0
    v_accvgpr_write_b32 a66, 0
    v_accvgpr_write_b32 a67, 0
    v_accvgpr_write_b32 a68, 0
    v_accvgpr_write_b32 a69, 0
    v_accvgpr_write_b32 a70, 0
    v_accvgpr_write_b32 a71, 0
    v_accvgpr_write_b32 a72, 0
    v_accvgpr_write_b32 a73, 0
    v_accvgpr_write_b32 a74, 0
    v_accvgpr_write_b32 a75, 0
    v_accvgpr_write_b32 a76, 0
    v_accvgpr_write_b32 a77, 0
    v_accvgpr_write_b32 a78, 0
    v_accvgpr_write_b32 a79, 0
    v_accvgpr_write_b32 a80, 0
    v_accvgpr_write_b32 a81, 0
    v_accvgpr_write_b32 a82, 0
    v_accvgpr_write_b32 a83, 0
    v_accvgpr_write_b32 a84, 0
    v_accvgpr_write_b32 a85, 0
    v_accvgpr_write_b32 a86, 0
    v_accvgpr_write_b32 a87, 0
    v_accvgpr_write_b32 a88, 0
    v_accvgpr_write_b32 a89, 0
    v_accvgpr_write_b32 a90, 0
    v_accvgpr_write_b32 a91, 0
    v_accvgpr_write_b32 a92, 0
    v_accvgpr_write_b32 a93, 0
    v_accvgpr_write_b32 a94, 0
    v_accvgpr_write_b32 a95, 0
    v_accvgpr_write_b32 a96, 0
    v_accvgpr_write_b32 a97, 0
    v_accvgpr_write_b32 a98, 0
    v_accvgpr_write_b32 a99, 0
    v_accvgpr_write_b32 a100, 0
    v_accvgpr_write_b32 a101, 0
    v_accvgpr_write_b32 a102, 0
    v_accvgpr_write_b32 a103, 0
    v_accvgpr_write_b32 a104, 0
    v_accvgpr_write_b32 a105, 0
    v_accvgpr_write_b32 a106, 0
    v_accvgpr_write_b32 a107, 0
    v_accvgpr_write_b32 a108, 0
    v_accvgpr_write_b32 a109, 0
    v_accvgpr_write_b32 a110, 0
    v_accvgpr_write_b32 a111, 0
    v_accvgpr_write_b32 a112, 0
    v_accvgpr_write_b32 a113, 0
    v_accvgpr_write_b32 a114, 0
    v_accvgpr_write_b32 a115, 0
    v_accvgpr_write_b32 a116, 0
    v_accvgpr_write_b32 a117, 0
    v_accvgpr_write_b32 a118, 0
    v_accvgpr_write_b32 a119, 0
    v_accvgpr_write_b32 a120, 0
    v_accvgpr_write_b32 a121, 0
    v_accvgpr_write_b32 a122, 0
    v_accvgpr_write_b32 a123, 0
    v_accvgpr_write_b32 a124, 0
    v_accvgpr_write_b32 a125, 0
    v_accvgpr_write_b32 a126, 0
    v_accvgpr_write_b32 a127, 0
    v_accvgpr_write_b32 a128, 0
    v_accvgpr_write_b32 a129, 0
    v_accvgpr_write_b32 a130, 0
    v_accvgpr_write_b32 a131, 0
    v_accvgpr_write_b32 a132, 0
    v_accvgpr_write_b32 a133, 0
    v_accvgpr_write_b32 a134, 0
    v_accvgpr_write_b32 a135, 0
    v_accvgpr_write_b32 a136, 0
    v_accvgpr_write_b32 a137, 0
    v_accvgpr_write_b32 a138, 0
    v_accvgpr_write_b32 a139, 0
    v_accvgpr_write_b32 a140, 0
    v_accvgpr_write_b32 a141, 0
    v_accvgpr_write_b32 a142, 0
    v_accvgpr_write_b32 a143, 0
    v_accvgpr_write_b32 a144, 0
    v_accvgpr_write_b32 a145, 0
    v_accvgpr_write_b32 a146, 0
    v_accvgpr_write_b32 a147, 0
    v_accvgpr_write_b32 a148, 0
    v_accvgpr_write_b32 a149, 0
    v_accvgpr_write_b32 a150, 0
    v_accvgpr_write_b32 a151, 0
    v_accvgpr_write_b32 a152, 0
    v_accvgpr_write_b32 a153, 0
    v_accvgpr_write_b32 a154, 0
    v_accvgpr_write_b32 a155, 0
    v_accvgpr_write_b32 a156, 0
    v_accvgpr_write_b32 a157, 0
    v_accvgpr_write_b32 a158, 0
    v_accvgpr_write_b32 a159, 0
    v_accvgpr_write_b32 a160, 0
    v_accvgpr_write_b32 a161, 0
    v_accvgpr_write_b32 a162, 0
    v_accvgpr_write_b32 a163, 0
    v_accvgpr_write_b32 a164, 0
    v_accvgpr_write_b32 a165, 0
    v_accvgpr_write_b32 a166, 0
    v_accvgpr_write_b32 a167, 0
    v_accvgpr_write_b32 a168, 0
    v_accvgpr_write_b32 a169, 0
    v_accvgpr_write_b32 a170, 0
    v_accvgpr_write_b32 a171, 0
    v_accvgpr_write_b32 a172, 0
    v_accvgpr_write_b32 a173, 0
    v_accvgpr_write_b32 a174, 0
    v_accvgpr_write_b32 a175, 0
    v_accvgpr_write_b32 a176, 0
    v_accvgpr_write_b32 a177, 0
    v_accvgpr_write_b32 a178, 0
    v_accvgpr_write_b32 a179, 0
    v_accvgpr_write_b32 a180, 0
    v_accvgpr_write_b32 a181, 0
    v_accvgpr_write_b32 a182, 0
    v_accvgpr_write_b32 a183, 0
    v_accvgpr_write_b32 a184, 0
    v_accvgpr_write_b32 a185, 0
    v_accvgpr_write_b32 a186, 0
    v_accvgpr_write_b32 a187, 0
    v_accvgpr_write_b32 a188, 0
    v_accvgpr_write_b32 a189, 0
    v_accvgpr_write_b32 a190, 0
    v_accvgpr_write_b32 a191, 0
    v_accvgpr_write_b32 a192, 0
    v_accvgpr_write_b32 a193, 0
    v_accvgpr_write_b32 a194, 0
    v_accvgpr_write_b32 a195, 0
    v_accvgpr_write_b32 a196, 0
    v_accvgpr_write_b32 a197, 0
    v_accvgpr_write_b32 a198, 0
    v_accvgpr_write_b32 a199, 0
    v_accvgpr_write_b32 a200, 0
    v_accvgpr_write_b32 a201, 0
    v_accvgpr_write_b32 a202, 0
    v_accvgpr_write_b32 a203, 0
    v_accvgpr_write_b32 a204, 0
    v_accvgpr_write_b32 a205, 0
    v_accvgpr_write_b32 a206, 0
    v_accvgpr_write_b32 a207, 0
    v_accvgpr_write_b32 a208, 0
    v_accvgpr_write_b32 a209, 0
    v_accvgpr_write_b32 a210, 0
    v_accvgpr_write_b32 a211, 0
    v_accvgpr_write_b32 a212, 0
    v_accvgpr_write_b32 a213, 0
    v_accvgpr_write_b32 a214, 0
    v_accvgpr_write_b32 a215, 0
    v_accvgpr_write_b32 a216, 0
    v_accvgpr_write_b32 a217, 0
    v_accvgpr_write_b32 a218, 0
    v_accvgpr_write_b32 a219, 0
    v_accvgpr_write_b32 a220, 0
    v_accvgpr_write_b32 a221, 0
    v_accvgpr_write_b32 a222, 0
    v_accvgpr_write_b32 a223, 0
    v_accvgpr_write_b32 a224, 0
    v_accvgpr_write_b32 a225, 0
    v_accvgpr_write_b32 a226, 0
    v_accvgpr_write_b32 a227, 0
    v_accvgpr_write_b32 a228, 0
    v_accvgpr_write_b32 a229, 0
    v_accvgpr_write_b32 a230, 0
    v_accvgpr_write_b32 a231, 0
    v_accvgpr_write_b32 a232, 0
    v_accvgpr_write_b32 a233, 0
    v_accvgpr_write_b32 a234, 0
    v_accvgpr_write_b32 a235, 0
    v_accvgpr_write_b32 a236, 0
    v_accvgpr_write_b32 a237, 0
    v_accvgpr_write_b32 a238, 0
    v_accvgpr_write_b32 a239, 0
    v_accvgpr_write_b32 a240, 0
    v_accvgpr_write_b32 a241, 0
    v_accvgpr_write_b32 a242, 0
    v_accvgpr_write_b32 a243, 0
    v_accvgpr_write_b32 a244, 0
    v_accvgpr_write_b32 a245, 0
    v_accvgpr_write_b32 a246, 0
    v_accvgpr_write_b32 a247, 0
    v_accvgpr_write_b32 a248, 0
    v_accvgpr_write_b32 a249, 0
    v_accvgpr_write_b32 a250, 0
    v_accvgpr_write_b32 a251, 0
    v_accvgpr_write_b32 a252, 0
    v_accvgpr_write_b32 a253, 0
    v_accvgpr_write_b32 a254, 0
    v_accvgpr_write_b32 a255, 0
    s_waitcnt vmcnt(24)
    s_barrier
    ds_read_b128 v[32:35], v136 offset:0
    ds_read_b64_tr_b16 v[0:1], v128 offset:0
    ds_read_b64_tr_b16 v[2:3], v128 offset:8192
    ds_read_b64_tr_b16 v[4:5], v129 offset:0
    ds_read_b64_tr_b16 v[6:7], v129 offset:8192
    ds_read_b64_tr_b16 v[8:9], v130 offset:0
    ds_read_b64_tr_b16 v[10:11], v130 offset:8192
    ds_read_b64_tr_b16 v[12:13], v131 offset:0
    ds_read_b64_tr_b16 v[14:15], v131 offset:8192
    ds_read_b64_tr_b16 v[16:17], v132 offset:0
    ds_read_b64_tr_b16 v[18:19], v132 offset:8192
    ds_read_b64_tr_b16 v[20:21], v133 offset:0
    ds_read_b64_tr_b16 v[22:23], v133 offset:8192
    ds_read_b64_tr_b16 v[24:25], v134 offset:0
    ds_read_b64_tr_b16 v[26:27], v134 offset:8192
    ds_read_b64_tr_b16 v[28:29], v135 offset:0
    ds_read_b64_tr_b16 v[30:31], v135 offset:8192
    ds_read_b128 v[36:39], v136 offset:1024
    ds_read_b128 v[40:43], v136 offset:2048
    ds_read_b128 v[44:47], v136 offset:3072
    ds_read_b128 v[48:51], v136 offset:4096
    ds_read_b128 v[52:55], v136 offset:5120
    ds_read_b128 v[56:59], v136 offset:6144
    ds_read_b128 v[60:63], v136 offset:7168
main_kernel_w_c2_v_loop:
    s_waitcnt lgkmcnt(0)
    v_mfma_f32_16x16x32_bf16 a[0:3], v[32:35], v[0:3], a[0:3]
    s_waitcnt vmcnt(16)
    s_barrier
    ds_read_b128 v[96:99], v136 offset:16384
    s_add_u32 m0, s20, 0
    s_nop 0
    v_mfma_f32_16x16x32_bf16 a[4:7], v[32:35], v[4:7], a[4:7]
    ds_read_b64_tr_b16 v[64:65], v128 offset:16384
    v_mfma_f32_16x16x32_bf16 a[8:11], v[32:35], v[8:11], a[8:11]
    ds_read_b64_tr_b16 v[66:67], v128 offset:24576
    v_mfma_f32_16x16x32_bf16 a[12:15], v[32:35], v[12:15], a[12:15]
    ds_read_b64_tr_b16 v[68:69], v129 offset:16384
    v_mfma_f32_16x16x32_bf16 a[16:19], v[32:35], v[16:19], a[16:19]
    ds_read_b64_tr_b16 v[70:71], v129 offset:24576
    v_mfma_f32_16x16x32_bf16 a[20:23], v[32:35], v[20:23], a[20:23]
    ds_read_b64_tr_b16 v[72:73], v130 offset:16384
    buffer_load_dwordx4 v141, s[4:7], s16 offen offset:0 sc1 lds
    v_mfma_f32_16x16x32_bf16 a[24:27], v[32:35], v[24:27], a[24:27]
    ds_read_b64_tr_b16 v[74:75], v130 offset:24576
    v_mfma_f32_16x16x32_bf16 a[28:31], v[32:35], v[28:31], a[28:31]
    ds_read_b64_tr_b16 v[76:77], v131 offset:16384
    v_mfma_f32_16x16x32_bf16 a[32:35], v[36:39], v[0:3], a[32:35]
    ds_read_b64_tr_b16 v[78:79], v131 offset:24576
    v_mfma_f32_16x16x32_bf16 a[36:39], v[36:39], v[4:7], a[36:39]
    ds_read_b64_tr_b16 v[80:81], v132 offset:16384
    v_mfma_f32_16x16x32_bf16 a[40:43], v[36:39], v[8:11], a[40:43]
    ds_read_b64_tr_b16 v[82:83], v132 offset:24576
    buffer_load_dwordx4 v142, s[4:7], s16 offen offset:1024 sc1 lds
    v_mfma_f32_16x16x32_bf16 a[44:47], v[36:39], v[12:15], a[44:47]
    ds_read_b64_tr_b16 v[84:85], v133 offset:16384
    v_mfma_f32_16x16x32_bf16 a[48:51], v[36:39], v[16:19], a[48:51]
    ds_read_b64_tr_b16 v[86:87], v133 offset:24576
    v_mfma_f32_16x16x32_bf16 a[52:55], v[36:39], v[20:23], a[52:55]
    ds_read_b64_tr_b16 v[88:89], v134 offset:16384
    v_mfma_f32_16x16x32_bf16 a[56:59], v[36:39], v[24:27], a[56:59]
    ds_read_b64_tr_b16 v[90:91], v134 offset:24576
    v_mfma_f32_16x16x32_bf16 a[60:63], v[36:39], v[28:31], a[60:63]
    ds_read_b64_tr_b16 v[92:93], v135 offset:16384
    buffer_load_dwordx4 v143, s[4:7], s16 offen offset:2048 sc1 lds
    v_mfma_f32_16x16x32_bf16 a[64:67], v[40:43], v[0:3], a[64:67]
    ds_read_b64_tr_b16 v[94:95], v135 offset:24576
    v_mfma_f32_16x16x32_bf16 a[68:71], v[40:43], v[4:7], a[68:71]
    ds_read_b128 v[100:103], v136 offset:17408
    v_mfma_f32_16x16x32_bf16 a[72:75], v[40:43], v[8:11], a[72:75]
    ds_read_b128 v[104:107], v136 offset:18432
    v_mfma_f32_16x16x32_bf16 a[76:79], v[40:43], v[12:15], a[76:79]
    ds_read_b128 v[108:111], v136 offset:19456
    v_mfma_f32_16x16x32_bf16 a[80:83], v[40:43], v[16:19], a[80:83]
    ds_read_b128 v[112:115], v136 offset:20480
    v_mfma_f32_16x16x32_bf16 a[84:87], v[40:43], v[20:23], a[84:87]
    ds_read_b128 v[116:119], v136 offset:21504
    buffer_load_dwordx4 v144, s[4:7], s16 offen offset:3072 sc1 lds
    v_mfma_f32_16x16x32_bf16 a[88:91], v[40:43], v[24:27], a[88:91]
    ds_read_b128 v[120:123], v136 offset:22528
    v_mfma_f32_16x16x32_bf16 a[92:95], v[40:43], v[28:31], a[92:95]
    ds_read_b128 v[124:127], v136 offset:23552
    v_mfma_f32_16x16x32_bf16 a[96:99], v[44:47], v[0:3], a[96:99]
    v_mfma_f32_16x16x32_bf16 a[100:103], v[44:47], v[4:7], a[100:103]
    v_mfma_f32_16x16x32_bf16 a[104:107], v[44:47], v[8:11], a[104:107]
    s_add_u32 s16, s16, 1024
    v_mfma_f32_16x16x32_bf16 a[108:111], v[44:47], v[12:15], a[108:111]
    v_mfma_f32_16x16x32_bf16 a[112:115], v[44:47], v[16:19], a[112:115]
    v_mfma_f32_16x16x32_bf16 a[116:119], v[44:47], v[20:23], a[116:119]
    v_mfma_f32_16x16x32_bf16 a[120:123], v[44:47], v[24:27], a[120:123]
    v_mfma_f32_16x16x32_bf16 a[124:127], v[44:47], v[28:31], a[124:127]
    s_add_u32 m0, s19, 0
    s_nop 0
    v_mfma_f32_16x16x32_bf16 a[128:131], v[48:51], v[0:3], a[128:131]
    v_mfma_f32_16x16x32_bf16 a[132:135], v[48:51], v[4:7], a[132:135]
    v_mfma_f32_16x16x32_bf16 a[136:139], v[48:51], v[8:11], a[136:139]
    v_mfma_f32_16x16x32_bf16 a[140:143], v[48:51], v[12:15], a[140:143]
    v_mfma_f32_16x16x32_bf16 a[144:147], v[48:51], v[16:19], a[144:147]
    buffer_load_dwordx4 v137, s[8:11], s15 offen offset:0 lds
    v_mfma_f32_16x16x32_bf16 a[148:151], v[48:51], v[20:23], a[148:151]
    v_mfma_f32_16x16x32_bf16 a[152:155], v[48:51], v[24:27], a[152:155]
    v_mfma_f32_16x16x32_bf16 a[156:159], v[48:51], v[28:31], a[156:159]
    v_mfma_f32_16x16x32_bf16 a[160:163], v[52:55], v[0:3], a[160:163]
    v_mfma_f32_16x16x32_bf16 a[164:167], v[52:55], v[4:7], a[164:167]
    v_mfma_f32_16x16x32_bf16 a[168:171], v[52:55], v[8:11], a[168:171]
    buffer_load_dwordx4 v138, s[8:11], s15 offen offset:1024 lds
    v_mfma_f32_16x16x32_bf16 a[172:175], v[52:55], v[12:15], a[172:175]
    v_mfma_f32_16x16x32_bf16 a[176:179], v[52:55], v[16:19], a[176:179]
    v_mfma_f32_16x16x32_bf16 a[180:183], v[52:55], v[20:23], a[180:183]
    v_mfma_f32_16x16x32_bf16 a[184:187], v[52:55], v[24:27], a[184:187]
    v_mfma_f32_16x16x32_bf16 a[188:191], v[52:55], v[28:31], a[188:191]
    buffer_load_dwordx4 v139, s[8:11], s15 offen offset:2048 lds
    v_mfma_f32_16x16x32_bf16 a[192:195], v[56:59], v[0:3], a[192:195]
    v_mfma_f32_16x16x32_bf16 a[196:199], v[56:59], v[4:7], a[196:199]
    v_mfma_f32_16x16x32_bf16 a[200:203], v[56:59], v[8:11], a[200:203]
    v_mfma_f32_16x16x32_bf16 a[204:207], v[56:59], v[12:15], a[204:207]
    v_mfma_f32_16x16x32_bf16 a[208:211], v[56:59], v[16:19], a[208:211]
    buffer_load_dwordx4 v140, s[8:11], s15 offen offset:3072 lds
    v_mfma_f32_16x16x32_bf16 a[212:215], v[56:59], v[20:23], a[212:215]
    v_mfma_f32_16x16x32_bf16 a[216:219], v[56:59], v[24:27], a[216:219]
    v_mfma_f32_16x16x32_bf16 a[220:223], v[56:59], v[28:31], a[220:223]
    v_mfma_f32_16x16x32_bf16 a[224:227], v[60:63], v[0:3], a[224:227]
    v_mfma_f32_16x16x32_bf16 a[228:231], v[60:63], v[4:7], a[228:231]
    s_add_u32 s15, s15, s17
    v_mfma_f32_16x16x32_bf16 a[232:235], v[60:63], v[8:11], a[232:235]
    v_mfma_f32_16x16x32_bf16 a[236:239], v[60:63], v[12:15], a[236:239]
    v_mfma_f32_16x16x32_bf16 a[240:243], v[60:63], v[16:19], a[240:243]
    v_mfma_f32_16x16x32_bf16 a[244:247], v[60:63], v[20:23], a[244:247]
    v_mfma_f32_16x16x32_bf16 a[248:251], v[60:63], v[24:27], a[248:251]
    v_mfma_f32_16x16x32_bf16 a[252:255], v[60:63], v[28:31], a[252:255]
    s_waitcnt lgkmcnt(0)
    v_mfma_f32_16x16x32_bf16 a[0:3], v[96:99], v[64:67], a[0:3]
    s_waitcnt vmcnt(16)
    s_barrier
    ds_read_b128 v[32:35], v136 offset:32768
    s_add_u32 m0, s20, 16384
    s_nop 0
    v_mfma_f32_16x16x32_bf16 a[4:7], v[96:99], v[68:71], a[4:7]
    ds_read_b64_tr_b16 v[0:1], v128 offset:32768
    v_mfma_f32_16x16x32_bf16 a[8:11], v[96:99], v[72:75], a[8:11]
    ds_read_b64_tr_b16 v[2:3], v128 offset:40960
    v_mfma_f32_16x16x32_bf16 a[12:15], v[96:99], v[76:79], a[12:15]
    ds_read_b64_tr_b16 v[4:5], v129 offset:32768
    v_mfma_f32_16x16x32_bf16 a[16:19], v[96:99], v[80:83], a[16:19]
    ds_read_b64_tr_b16 v[6:7], v129 offset:40960
    v_mfma_f32_16x16x32_bf16 a[20:23], v[96:99], v[84:87], a[20:23]
    ds_read_b64_tr_b16 v[8:9], v130 offset:32768
    buffer_load_dwordx4 v141, s[4:7], s16 offen offset:0 sc1 lds
    v_mfma_f32_16x16x32_bf16 a[24:27], v[96:99], v[88:91], a[24:27]
    ds_read_b64_tr_b16 v[10:11], v130 offset:40960
    v_mfma_f32_16x16x32_bf16 a[28:31], v[96:99], v[92:95], a[28:31]
    ds_read_b64_tr_b16 v[12:13], v131 offset:32768
    v_mfma_f32_16x16x32_bf16 a[32:35], v[100:103], v[64:67], a[32:35]
    ds_read_b64_tr_b16 v[14:15], v131 offset:40960
    v_mfma_f32_16x16x32_bf16 a[36:39], v[100:103], v[68:71], a[36:39]
    ds_read_b64_tr_b16 v[16:17], v132 offset:32768
    v_mfma_f32_16x16x32_bf16 a[40:43], v[100:103], v[72:75], a[40:43]
    ds_read_b64_tr_b16 v[18:19], v132 offset:40960
    buffer_load_dwordx4 v142, s[4:7], s16 offen offset:1024 sc1 lds
    v_mfma_f32_16x16x32_bf16 a[44:47], v[100:103], v[76:79], a[44:47]
    ds_read_b64_tr_b16 v[20:21], v133 offset:32768
    v_mfma_f32_16x16x32_bf16 a[48:51], v[100:103], v[80:83], a[48:51]
    ds_read_b64_tr_b16 v[22:23], v133 offset:40960
    v_mfma_f32_16x16x32_bf16 a[52:55], v[100:103], v[84:87], a[52:55]
    ds_read_b64_tr_b16 v[24:25], v134 offset:32768
    v_mfma_f32_16x16x32_bf16 a[56:59], v[100:103], v[88:91], a[56:59]
    ds_read_b64_tr_b16 v[26:27], v134 offset:40960
    v_mfma_f32_16x16x32_bf16 a[60:63], v[100:103], v[92:95], a[60:63]
    ds_read_b64_tr_b16 v[28:29], v135 offset:32768
    buffer_load_dwordx4 v143, s[4:7], s16 offen offset:2048 sc1 lds
    v_mfma_f32_16x16x32_bf16 a[64:67], v[104:107], v[64:67], a[64:67]
    ds_read_b64_tr_b16 v[30:31], v135 offset:40960
    v_mfma_f32_16x16x32_bf16 a[68:71], v[104:107], v[68:71], a[68:71]
    ds_read_b128 v[36:39], v136 offset:33792
    v_mfma_f32_16x16x32_bf16 a[72:75], v[104:107], v[72:75], a[72:75]
    ds_read_b128 v[40:43], v136 offset:34816
    v_mfma_f32_16x16x32_bf16 a[76:79], v[104:107], v[76:79], a[76:79]
    ds_read_b128 v[44:47], v136 offset:35840
    v_mfma_f32_16x16x32_bf16 a[80:83], v[104:107], v[80:83], a[80:83]
    ds_read_b128 v[48:51], v136 offset:36864
    v_mfma_f32_16x16x32_bf16 a[84:87], v[104:107], v[84:87], a[84:87]
    ds_read_b128 v[52:55], v136 offset:37888
    buffer_load_dwordx4 v144, s[4:7], s16 offen offset:3072 sc1 lds
    v_mfma_f32_16x16x32_bf16 a[88:91], v[104:107], v[88:91], a[88:91]
    ds_read_b128 v[56:59], v136 offset:38912
    v_mfma_f32_16x16x32_bf16 a[92:95], v[104:107], v[92:95], a[92:95]
    ds_read_b128 v[60:63], v136 offset:39936
    v_mfma_f32_16x16x32_bf16 a[96:99], v[108:111], v[64:67], a[96:99]
    v_mfma_f32_16x16x32_bf16 a[100:103], v[108:111], v[68:71], a[100:103]
    v_mfma_f32_16x16x32_bf16 a[104:107], v[108:111], v[72:75], a[104:107]
    s_add_u32 s16, s16, 1024
    v_mfma_f32_16x16x32_bf16 a[108:111], v[108:111], v[76:79], a[108:111]
    v_mfma_f32_16x16x32_bf16 a[112:115], v[108:111], v[80:83], a[112:115]
    v_mfma_f32_16x16x32_bf16 a[116:119], v[108:111], v[84:87], a[116:119]
    v_mfma_f32_16x16x32_bf16 a[120:123], v[108:111], v[88:91], a[120:123]
    v_mfma_f32_16x16x32_bf16 a[124:127], v[108:111], v[92:95], a[124:127]
    s_add_u32 m0, s19, 16384
    s_nop 0
    v_mfma_f32_16x16x32_bf16 a[128:131], v[112:115], v[64:67], a[128:131]
    v_mfma_f32_16x16x32_bf16 a[132:135], v[112:115], v[68:71], a[132:135]
    v_mfma_f32_16x16x32_bf16 a[136:139], v[112:115], v[72:75], a[136:139]
    v_mfma_f32_16x16x32_bf16 a[140:143], v[112:115], v[76:79], a[140:143]
    v_mfma_f32_16x16x32_bf16 a[144:147], v[112:115], v[80:83], a[144:147]
    buffer_load_dwordx4 v137, s[8:11], s15 offen offset:0 lds
    v_mfma_f32_16x16x32_bf16 a[148:151], v[112:115], v[84:87], a[148:151]
    v_mfma_f32_16x16x32_bf16 a[152:155], v[112:115], v[88:91], a[152:155]
    v_mfma_f32_16x16x32_bf16 a[156:159], v[112:115], v[92:95], a[156:159]
    v_mfma_f32_16x16x32_bf16 a[160:163], v[116:119], v[64:67], a[160:163]
    v_mfma_f32_16x16x32_bf16 a[164:167], v[116:119], v[68:71], a[164:167]
    v_mfma_f32_16x16x32_bf16 a[168:171], v[116:119], v[72:75], a[168:171]
    buffer_load_dwordx4 v138, s[8:11], s15 offen offset:1024 lds
    v_mfma_f32_16x16x32_bf16 a[172:175], v[116:119], v[76:79], a[172:175]
    v_mfma_f32_16x16x32_bf16 a[176:179], v[116:119], v[80:83], a[176:179]
    v_mfma_f32_16x16x32_bf16 a[180:183], v[116:119], v[84:87], a[180:183]
    v_mfma_f32_16x16x32_bf16 a[184:187], v[116:119], v[88:91], a[184:187]
    v_mfma_f32_16x16x32_bf16 a[188:191], v[116:119], v[92:95], a[188:191]
    buffer_load_dwordx4 v139, s[8:11], s15 offen offset:2048 lds
    v_mfma_f32_16x16x32_bf16 a[192:195], v[120:123], v[64:67], a[192:195]
    v_mfma_f32_16x16x32_bf16 a[196:199], v[120:123], v[68:71], a[196:199]
    v_mfma_f32_16x16x32_bf16 a[200:203], v[120:123], v[72:75], a[200:203]
    v_mfma_f32_16x16x32_bf16 a[204:207], v[120:123], v[76:79], a[204:207]
    v_mfma_f32_16x16x32_bf16 a[208:211], v[120:123], v[80:83], a[208:211]
    buffer_load_dwordx4 v140, s[8:11], s15 offen offset:3072 lds
    v_mfma_f32_16x16x32_bf16 a[212:215], v[120:123], v[84:87], a[212:215]
    v_mfma_f32_16x16x32_bf16 a[216:219], v[120:123], v[88:91], a[216:219]
    v_mfma_f32_16x16x32_bf16 a[220:223], v[120:123], v[92:95], a[220:223]
    v_mfma_f32_16x16x32_bf16 a[224:227], v[124:127], v[64:67], a[224:227]
    v_mfma_f32_16x16x32_bf16 a[228:231], v[124:127], v[68:71], a[228:231]
    s_add_u32 s15, s15, s17
    v_mfma_f32_16x16x32_bf16 a[232:235], v[124:127], v[72:75], a[232:235]
    v_mfma_f32_16x16x32_bf16 a[236:239], v[124:127], v[76:79], a[236:239]
    v_mfma_f32_16x16x32_bf16 a[240:243], v[124:127], v[80:83], a[240:243]
    v_mfma_f32_16x16x32_bf16 a[244:247], v[124:127], v[84:87], a[244:247]
    v_mfma_f32_16x16x32_bf16 a[248:251], v[124:127], v[88:91], a[248:251]
    v_mfma_f32_16x16x32_bf16 a[252:255], v[124:127], v[92:95], a[252:255]
    s_waitcnt lgkmcnt(0)
    v_mfma_f32_16x16x32_bf16 a[0:3], v[32:35], v[0:3], a[0:3]
    s_waitcnt vmcnt(16)
    s_barrier
    ds_read_b128 v[96:99], v136 offset:49152
    s_add_u32 m0, s20, 32768
    s_nop 0
    v_mfma_f32_16x16x32_bf16 a[4:7], v[32:35], v[4:7], a[4:7]
    ds_read_b64_tr_b16 v[64:65], v128 offset:49152
    v_mfma_f32_16x16x32_bf16 a[8:11], v[32:35], v[8:11], a[8:11]
    ds_read_b64_tr_b16 v[66:67], v128 offset:57344
    v_mfma_f32_16x16x32_bf16 a[12:15], v[32:35], v[12:15], a[12:15]
    ds_read_b64_tr_b16 v[68:69], v129 offset:49152
    v_mfma_f32_16x16x32_bf16 a[16:19], v[32:35], v[16:19], a[16:19]
    ds_read_b64_tr_b16 v[70:71], v129 offset:57344
    v_mfma_f32_16x16x32_bf16 a[20:23], v[32:35], v[20:23], a[20:23]
    ds_read_b64_tr_b16 v[72:73], v130 offset:49152
    buffer_load_dwordx4 v141, s[4:7], s16 offen offset:0 sc1 lds
    v_mfma_f32_16x16x32_bf16 a[24:27], v[32:35], v[24:27], a[24:27]
    ds_read_b64_tr_b16 v[74:75], v130 offset:57344
    v_mfma_f32_16x16x32_bf16 a[28:31], v[32:35], v[28:31], a[28:31]
    ds_read_b64_tr_b16 v[76:77], v131 offset:49152
    v_mfma_f32_16x16x32_bf16 a[32:35], v[36:39], v[0:3], a[32:35]
    ds_read_b64_tr_b16 v[78:79], v131 offset:57344
    v_mfma_f32_16x16x32_bf16 a[36:39], v[36:39], v[4:7], a[36:39]
    ds_read_b64_tr_b16 v[80:81], v132 offset:49152
    v_mfma_f32_16x16x32_bf16 a[40:43], v[36:39], v[8:11], a[40:43]
    ds_read_b64_tr_b16 v[82:83], v132 offset:57344
    buffer_load_dwordx4 v142, s[4:7], s16 offen offset:1024 sc1 lds
    v_mfma_f32_16x16x32_bf16 a[44:47], v[36:39], v[12:15], a[44:47]
    ds_read_b64_tr_b16 v[84:85], v133 offset:49152
    v_mfma_f32_16x16x32_bf16 a[48:51], v[36:39], v[16:19], a[48:51]
    ds_read_b64_tr_b16 v[86:87], v133 offset:57344
    v_mfma_f32_16x16x32_bf16 a[52:55], v[36:39], v[20:23], a[52:55]
    ds_read_b64_tr_b16 v[88:89], v134 offset:49152
    v_mfma_f32_16x16x32_bf16 a[56:59], v[36:39], v[24:27], a[56:59]
    ds_read_b64_tr_b16 v[90:91], v134 offset:57344
    v_mfma_f32_16x16x32_bf16 a[60:63], v[36:39], v[28:31], a[60:63]
    ds_read_b64_tr_b16 v[92:93], v135 offset:49152
    buffer_load_dwordx4 v143, s[4:7], s16 offen offset:2048 sc1 lds
    v_mfma_f32_16x16x32_bf16 a[64:67], v[40:43], v[0:3], a[64:67]
    ds_read_b64_tr_b16 v[94:95], v135 offset:57344
    v_mfma_f32_16x16x32_bf16 a[68:71], v[40:43], v[4:7], a[68:71]
    ds_read_b128 v[100:103], v136 offset:50176
    v_mfma_f32_16x16x32_bf16 a[72:75], v[40:43], v[8:11], a[72:75]
    ds_read_b128 v[104:107], v136 offset:51200
    v_mfma_f32_16x16x32_bf16 a[76:79], v[40:43], v[12:15], a[76:79]
    ds_read_b128 v[108:111], v136 offset:52224
    v_mfma_f32_16x16x32_bf16 a[80:83], v[40:43], v[16:19], a[80:83]
    ds_read_b128 v[112:115], v136 offset:53248
    v_mfma_f32_16x16x32_bf16 a[84:87], v[40:43], v[20:23], a[84:87]
    ds_read_b128 v[116:119], v136 offset:54272
    buffer_load_dwordx4 v144, s[4:7], s16 offen offset:3072 sc1 lds
    v_mfma_f32_16x16x32_bf16 a[88:91], v[40:43], v[24:27], a[88:91]
    ds_read_b128 v[120:123], v136 offset:55296
    v_mfma_f32_16x16x32_bf16 a[92:95], v[40:43], v[28:31], a[92:95]
    ds_read_b128 v[124:127], v136 offset:56320
    v_mfma_f32_16x16x32_bf16 a[96:99], v[44:47], v[0:3], a[96:99]
    v_mfma_f32_16x16x32_bf16 a[100:103], v[44:47], v[4:7], a[100:103]
    v_mfma_f32_16x16x32_bf16 a[104:107], v[44:47], v[8:11], a[104:107]
    s_add_u32 s16, s16, 1024
    v_mfma_f32_16x16x32_bf16 a[108:111], v[44:47], v[12:15], a[108:111]
    v_mfma_f32_16x16x32_bf16 a[112:115], v[44:47], v[16:19], a[112:115]
    v_mfma_f32_16x16x32_bf16 a[116:119], v[44:47], v[20:23], a[116:119]
    v_mfma_f32_16x16x32_bf16 a[120:123], v[44:47], v[24:27], a[120:123]
    v_mfma_f32_16x16x32_bf16 a[124:127], v[44:47], v[28:31], a[124:127]
    s_add_u32 m0, s19, 32768
    s_nop 0
    v_mfma_f32_16x16x32_bf16 a[128:131], v[48:51], v[0:3], a[128:131]
    v_mfma_f32_16x16x32_bf16 a[132:135], v[48:51], v[4:7], a[132:135]
    v_mfma_f32_16x16x32_bf16 a[136:139], v[48:51], v[8:11], a[136:139]
    v_mfma_f32_16x16x32_bf16 a[140:143], v[48:51], v[12:15], a[140:143]
    v_mfma_f32_16x16x32_bf16 a[144:147], v[48:51], v[16:19], a[144:147]
    buffer_load_dwordx4 v137, s[8:11], s15 offen offset:0 lds
    v_mfma_f32_16x16x32_bf16 a[148:151], v[48:51], v[20:23], a[148:151]
    v_mfma_f32_16x16x32_bf16 a[152:155], v[48:51], v[24:27], a[152:155]
    v_mfma_f32_16x16x32_bf16 a[156:159], v[48:51], v[28:31], a[156:159]
    v_mfma_f32_16x16x32_bf16 a[160:163], v[52:55], v[0:3], a[160:163]
    v_mfma_f32_16x16x32_bf16 a[164:167], v[52:55], v[4:7], a[164:167]
    v_mfma_f32_16x16x32_bf16 a[168:171], v[52:55], v[8:11], a[168:171]
    buffer_load_dwordx4 v138, s[8:11], s15 offen offset:1024 lds
    v_mfma_f32_16x16x32_bf16 a[172:175], v[52:55], v[12:15], a[172:175]
    v_mfma_f32_16x16x32_bf16 a[176:179], v[52:55], v[16:19], a[176:179]
    v_mfma_f32_16x16x32_bf16 a[180:183], v[52:55], v[20:23], a[180:183]
    v_mfma_f32_16x16x32_bf16 a[184:187], v[52:55], v[24:27], a[184:187]
    v_mfma_f32_16x16x32_bf16 a[188:191], v[52:55], v[28:31], a[188:191]
    buffer_load_dwordx4 v139, s[8:11], s15 offen offset:2048 lds
    v_mfma_f32_16x16x32_bf16 a[192:195], v[56:59], v[0:3], a[192:195]
    v_mfma_f32_16x16x32_bf16 a[196:199], v[56:59], v[4:7], a[196:199]
    v_mfma_f32_16x16x32_bf16 a[200:203], v[56:59], v[8:11], a[200:203]
    v_mfma_f32_16x16x32_bf16 a[204:207], v[56:59], v[12:15], a[204:207]
    v_mfma_f32_16x16x32_bf16 a[208:211], v[56:59], v[16:19], a[208:211]
    buffer_load_dwordx4 v140, s[8:11], s15 offen offset:3072 lds
    v_mfma_f32_16x16x32_bf16 a[212:215], v[56:59], v[20:23], a[212:215]
    v_mfma_f32_16x16x32_bf16 a[216:219], v[56:59], v[24:27], a[216:219]
    v_mfma_f32_16x16x32_bf16 a[220:223], v[56:59], v[28:31], a[220:223]
    v_mfma_f32_16x16x32_bf16 a[224:227], v[60:63], v[0:3], a[224:227]
    v_mfma_f32_16x16x32_bf16 a[228:231], v[60:63], v[4:7], a[228:231]
    s_add_u32 s15, s15, s17
    v_mfma_f32_16x16x32_bf16 a[232:235], v[60:63], v[8:11], a[232:235]
    v_mfma_f32_16x16x32_bf16 a[236:239], v[60:63], v[12:15], a[236:239]
    v_mfma_f32_16x16x32_bf16 a[240:243], v[60:63], v[16:19], a[240:243]
    v_mfma_f32_16x16x32_bf16 a[244:247], v[60:63], v[20:23], a[244:247]
    v_mfma_f32_16x16x32_bf16 a[248:251], v[60:63], v[24:27], a[248:251]
    v_mfma_f32_16x16x32_bf16 a[252:255], v[60:63], v[28:31], a[252:255]
    s_waitcnt lgkmcnt(0)
    v_mfma_f32_16x16x32_bf16 a[0:3], v[96:99], v[64:67], a[0:3]
    s_waitcnt vmcnt(16)
    s_barrier
    ds_read_b128 v[32:35], v136 offset:0
    s_add_u32 m0, s20, 49152
    s_nop 0
    v_mfma_f32_16x16x32_bf16 a[4:7], v[96:99], v[68:71], a[4:7]
    ds_read_b64_tr_b16 v[0:1], v128 offset:0
    v_mfma_f32_16x16x32_bf16 a[8:11], v[96:99], v[72:75], a[8:11]
    ds_read_b64_tr_b16 v[2:3], v128 offset:8192
    v_mfma_f32_16x16x32_bf16 a[12:15], v[96:99], v[76:79], a[12:15]
    ds_read_b64_tr_b16 v[4:5], v129 offset:0
    v_mfma_f32_16x16x32_bf16 a[16:19], v[96:99], v[80:83], a[16:19]
    ds_read_b64_tr_b16 v[6:7], v129 offset:8192
    v_mfma_f32_16x16x32_bf16 a[20:23], v[96:99], v[84:87], a[20:23]
    ds_read_b64_tr_b16 v[8:9], v130 offset:0
    buffer_load_dwordx4 v141, s[4:7], s16 offen offset:0 sc1 lds
    v_mfma_f32_16x16x32_bf16 a[24:27], v[96:99], v[88:91], a[24:27]
    ds_read_b64_tr_b16 v[10:11], v130 offset:8192
    v_mfma_f32_16x16x32_bf16 a[28:31], v[96:99], v[92:95], a[28:31]
    ds_read_b64_tr_b16 v[12:13], v131 offset:0
    v_mfma_f32_16x16x32_bf16 a[32:35], v[100:103], v[64:67], a[32:35]
    ds_read_b64_tr_b16 v[14:15], v131 offset:8192
    v_mfma_f32_16x16x32_bf16 a[36:39], v[100:103], v[68:71], a[36:39]
    ds_read_b64_tr_b16 v[16:17], v132 offset:0
    v_mfma_f32_16x16x32_bf16 a[40:43], v[100:103], v[72:75], a[40:43]
    ds_read_b64_tr_b16 v[18:19], v132 offset:8192
    buffer_load_dwordx4 v142, s[4:7], s16 offen offset:1024 sc1 lds
    v_mfma_f32_16x16x32_bf16 a[44:47], v[100:103], v[76:79], a[44:47]
    ds_read_b64_tr_b16 v[20:21], v133 offset:0
    v_mfma_f32_16x16x32_bf16 a[48:51], v[100:103], v[80:83], a[48:51]
    ds_read_b64_tr_b16 v[22:23], v133 offset:8192
    v_mfma_f32_16x16x32_bf16 a[52:55], v[100:103], v[84:87], a[52:55]
    ds_read_b64_tr_b16 v[24:25], v134 offset:0
    v_mfma_f32_16x16x32_bf16 a[56:59], v[100:103], v[88:91], a[56:59]
    ds_read_b64_tr_b16 v[26:27], v134 offset:8192
    v_mfma_f32_16x16x32_bf16 a[60:63], v[100:103], v[92:95], a[60:63]
    ds_read_b64_tr_b16 v[28:29], v135 offset:0
    buffer_load_dwordx4 v143, s[4:7], s16 offen offset:2048 sc1 lds
    v_mfma_f32_16x16x32_bf16 a[64:67], v[104:107], v[64:67], a[64:67]
    ds_read_b64_tr_b16 v[30:31], v135 offset:8192
    v_mfma_f32_16x16x32_bf16 a[68:71], v[104:107], v[68:71], a[68:71]
    ds_read_b128 v[36:39], v136 offset:1024
    v_mfma_f32_16x16x32_bf16 a[72:75], v[104:107], v[72:75], a[72:75]
    ds_read_b128 v[40:43], v136 offset:2048
    v_mfma_f32_16x16x32_bf16 a[76:79], v[104:107], v[76:79], a[76:79]
    ds_read_b128 v[44:47], v136 offset:3072
    v_mfma_f32_16x16x32_bf16 a[80:83], v[104:107], v[80:83], a[80:83]
    ds_read_b128 v[48:51], v136 offset:4096
    v_mfma_f32_16x16x32_bf16 a[84:87], v[104:107], v[84:87], a[84:87]
    ds_read_b128 v[52:55], v136 offset:5120
    buffer_load_dwordx4 v144, s[4:7], s16 offen offset:3072 sc1 lds
    v_mfma_f32_16x16x32_bf16 a[88:91], v[104:107], v[88:91], a[88:91]
    ds_read_b128 v[56:59], v136 offset:6144
    v_mfma_f32_16x16x32_bf16 a[92:95], v[104:107], v[92:95], a[92:95]
    ds_read_b128 v[60:63], v136 offset:7168
    v_mfma_f32_16x16x32_bf16 a[96:99], v[108:111], v[64:67], a[96:99]
    v_mfma_f32_16x16x32_bf16 a[100:103], v[108:111], v[68:71], a[100:103]
    v_mfma_f32_16x16x32_bf16 a[104:107], v[108:111], v[72:75], a[104:107]
    s_add_u32 s16, s16, 1024
    v_mfma_f32_16x16x32_bf16 a[108:111], v[108:111], v[76:79], a[108:111]
    v_mfma_f32_16x16x32_bf16 a[112:115], v[108:111], v[80:83], a[112:115]
    v_mfma_f32_16x16x32_bf16 a[116:119], v[108:111], v[84:87], a[116:119]
    v_mfma_f32_16x16x32_bf16 a[120:123], v[108:111], v[88:91], a[120:123]
    v_mfma_f32_16x16x32_bf16 a[124:127], v[108:111], v[92:95], a[124:127]
    s_add_u32 m0, s19, 49152
    s_nop 0
    v_mfma_f32_16x16x32_bf16 a[128:131], v[112:115], v[64:67], a[128:131]
    v_mfma_f32_16x16x32_bf16 a[132:135], v[112:115], v[68:71], a[132:135]
    v_mfma_f32_16x16x32_bf16 a[136:139], v[112:115], v[72:75], a[136:139]
    v_mfma_f32_16x16x32_bf16 a[140:143], v[112:115], v[76:79], a[140:143]
    v_mfma_f32_16x16x32_bf16 a[144:147], v[112:115], v[80:83], a[144:147]
    buffer_load_dwordx4 v137, s[8:11], s15 offen offset:0 lds
    v_mfma_f32_16x16x32_bf16 a[148:151], v[112:115], v[84:87], a[148:151]
    v_mfma_f32_16x16x32_bf16 a[152:155], v[112:115], v[88:91], a[152:155]
    v_mfma_f32_16x16x32_bf16 a[156:159], v[112:115], v[92:95], a[156:159]
    v_mfma_f32_16x16x32_bf16 a[160:163], v[116:119], v[64:67], a[160:163]
    v_mfma_f32_16x16x32_bf16 a[164:167], v[116:119], v[68:71], a[164:167]
    v_mfma_f32_16x16x32_bf16 a[168:171], v[116:119], v[72:75], a[168:171]
    buffer_load_dwordx4 v138, s[8:11], s15 offen offset:1024 lds
    v_mfma_f32_16x16x32_bf16 a[172:175], v[116:119], v[76:79], a[172:175]
    v_mfma_f32_16x16x32_bf16 a[176:179], v[116:119], v[80:83], a[176:179]
    v_mfma_f32_16x16x32_bf16 a[180:183], v[116:119], v[84:87], a[180:183]
    v_mfma_f32_16x16x32_bf16 a[184:187], v[116:119], v[88:91], a[184:187]
    v_mfma_f32_16x16x32_bf16 a[188:191], v[116:119], v[92:95], a[188:191]
    buffer_load_dwordx4 v139, s[8:11], s15 offen offset:2048 lds
    v_mfma_f32_16x16x32_bf16 a[192:195], v[120:123], v[64:67], a[192:195]
    v_mfma_f32_16x16x32_bf16 a[196:199], v[120:123], v[68:71], a[196:199]
    v_mfma_f32_16x16x32_bf16 a[200:203], v[120:123], v[72:75], a[200:203]
    v_mfma_f32_16x16x32_bf16 a[204:207], v[120:123], v[76:79], a[204:207]
    v_mfma_f32_16x16x32_bf16 a[208:211], v[120:123], v[80:83], a[208:211]
    buffer_load_dwordx4 v140, s[8:11], s15 offen offset:3072 lds
    v_mfma_f32_16x16x32_bf16 a[212:215], v[120:123], v[84:87], a[212:215]
    v_mfma_f32_16x16x32_bf16 a[216:219], v[120:123], v[88:91], a[216:219]
    v_mfma_f32_16x16x32_bf16 a[220:223], v[120:123], v[92:95], a[220:223]
    v_mfma_f32_16x16x32_bf16 a[224:227], v[124:127], v[64:67], a[224:227]
    v_mfma_f32_16x16x32_bf16 a[228:231], v[124:127], v[68:71], a[228:231]
    s_add_u32 s15, s15, s17
    v_mfma_f32_16x16x32_bf16 a[232:235], v[124:127], v[72:75], a[232:235]
    v_mfma_f32_16x16x32_bf16 a[236:239], v[124:127], v[76:79], a[236:239]
    v_mfma_f32_16x16x32_bf16 a[240:243], v[124:127], v[80:83], a[240:243]
    v_mfma_f32_16x16x32_bf16 a[244:247], v[124:127], v[84:87], a[244:247]
    v_mfma_f32_16x16x32_bf16 a[248:251], v[124:127], v[88:91], a[248:251]
    v_mfma_f32_16x16x32_bf16 a[252:255], v[124:127], v[92:95], a[252:255]
    s_sub_u32 s18, s18, 1
    s_cmp_lg_u32 s18, 0
    s_cbranch_scc1 main_kernel_w_c2_v_loop
    s_cmp_lg_u32 s14, 0
    s_cbranch_scc1 main_kernel_w_c2_v_nt
    s_lshl_b32 s32, s27, 8
    s_add_u32 s32, s32, 0x841e000
    v_mov_b32 v255, 1
    s_mov_b64 exec, 1
    buffer_atomic_add v255, off, s[4:7], s32 sc0 sc1
    s_mov_b64 exec, -1
main_kernel_w_c2_v_nt:
    s_waitcnt lgkmcnt(0)
    v_mfma_f32_16x16x32_bf16 a[0:3], v[32:35], v[0:3], a[0:3]
    s_waitcnt vmcnt(16)
    s_barrier
    ds_read_b128 v[96:99], v136 offset:16384
    v_mfma_f32_16x16x32_bf16 a[4:7], v[32:35], v[4:7], a[4:7]
    ds_read_b64_tr_b16 v[64:65], v128 offset:16384
    v_mfma_f32_16x16x32_bf16 a[8:11], v[32:35], v[8:11], a[8:11]
    ds_read_b64_tr_b16 v[66:67], v128 offset:24576
    v_mfma_f32_16x16x32_bf16 a[12:15], v[32:35], v[12:15], a[12:15]
    ds_read_b64_tr_b16 v[68:69], v129 offset:16384
    v_mfma_f32_16x16x32_bf16 a[16:19], v[32:35], v[16:19], a[16:19]
    ds_read_b64_tr_b16 v[70:71], v129 offset:24576
    v_mfma_f32_16x16x32_bf16 a[20:23], v[32:35], v[20:23], a[20:23]
    ds_read_b64_tr_b16 v[72:73], v130 offset:16384
    v_mfma_f32_16x16x32_bf16 a[24:27], v[32:35], v[24:27], a[24:27]
    ds_read_b64_tr_b16 v[74:75], v130 offset:24576
    v_mfma_f32_16x16x32_bf16 a[28:31], v[32:35], v[28:31], a[28:31]
    ds_read_b64_tr_b16 v[76:77], v131 offset:16384
    v_mfma_f32_16x16x32_bf16 a[32:35], v[36:39], v[0:3], a[32:35]
    ds_read_b64_tr_b16 v[78:79], v131 offset:24576
    v_mfma_f32_16x16x32_bf16 a[36:39], v[36:39], v[4:7], a[36:39]
    ds_read_b64_tr_b16 v[80:81], v132 offset:16384
    v_mfma_f32_16x16x32_bf16 a[40:43], v[36:39], v[8:11], a[40:43]
    ds_read_b64_tr_b16 v[82:83], v132 offset:24576
    v_mfma_f32_16x16x32_bf16 a[44:47], v[36:39], v[12:15], a[44:47]
    ds_read_b64_tr_b16 v[84:85], v133 offset:16384
    v_mfma_f32_16x16x32_bf16 a[48:51], v[36:39], v[16:19], a[48:51]
    ds_read_b64_tr_b16 v[86:87], v133 offset:24576
    v_mfma_f32_16x16x32_bf16 a[52:55], v[36:39], v[20:23], a[52:55]
    ds_read_b64_tr_b16 v[88:89], v134 offset:16384
    v_mfma_f32_16x16x32_bf16 a[56:59], v[36:39], v[24:27], a[56:59]
    ds_read_b64_tr_b16 v[90:91], v134 offset:24576
    v_mfma_f32_16x16x32_bf16 a[60:63], v[36:39], v[28:31], a[60:63]
    ds_read_b64_tr_b16 v[92:93], v135 offset:16384
    v_mfma_f32_16x16x32_bf16 a[64:67], v[40:43], v[0:3], a[64:67]
    ds_read_b64_tr_b16 v[94:95], v135 offset:24576
    v_mfma_f32_16x16x32_bf16 a[68:71], v[40:43], v[4:7], a[68:71]
    ds_read_b128 v[100:103], v136 offset:17408
    v_mfma_f32_16x16x32_bf16 a[72:75], v[40:43], v[8:11], a[72:75]
    ds_read_b128 v[104:107], v136 offset:18432
    v_mfma_f32_16x16x32_bf16 a[76:79], v[40:43], v[12:15], a[76:79]
    ds_read_b128 v[108:111], v136 offset:19456
    v_mfma_f32_16x16x32_bf16 a[80:83], v[40:43], v[16:19], a[80:83]
    ds_read_b128 v[112:115], v136 offset:20480
    v_mfma_f32_16x16x32_bf16 a[84:87], v[40:43], v[20:23], a[84:87]
    ds_read_b128 v[116:119], v136 offset:21504
    v_mfma_f32_16x16x32_bf16 a[88:91], v[40:43], v[24:27], a[88:91]
    ds_read_b128 v[120:123], v136 offset:22528
    v_mfma_f32_16x16x32_bf16 a[92:95], v[40:43], v[28:31], a[92:95]
    ds_read_b128 v[124:127], v136 offset:23552
    v_mfma_f32_16x16x32_bf16 a[96:99], v[44:47], v[0:3], a[96:99]
    v_mfma_f32_16x16x32_bf16 a[100:103], v[44:47], v[4:7], a[100:103]
    v_mfma_f32_16x16x32_bf16 a[104:107], v[44:47], v[8:11], a[104:107]
    v_mfma_f32_16x16x32_bf16 a[108:111], v[44:47], v[12:15], a[108:111]
    v_mfma_f32_16x16x32_bf16 a[112:115], v[44:47], v[16:19], a[112:115]
    v_mfma_f32_16x16x32_bf16 a[116:119], v[44:47], v[20:23], a[116:119]
    v_mfma_f32_16x16x32_bf16 a[120:123], v[44:47], v[24:27], a[120:123]
    v_mfma_f32_16x16x32_bf16 a[124:127], v[44:47], v[28:31], a[124:127]
    v_mfma_f32_16x16x32_bf16 a[128:131], v[48:51], v[0:3], a[128:131]
    v_mfma_f32_16x16x32_bf16 a[132:135], v[48:51], v[4:7], a[132:135]
    v_mfma_f32_16x16x32_bf16 a[136:139], v[48:51], v[8:11], a[136:139]
    v_mfma_f32_16x16x32_bf16 a[140:143], v[48:51], v[12:15], a[140:143]
    v_mfma_f32_16x16x32_bf16 a[144:147], v[48:51], v[16:19], a[144:147]
    v_mfma_f32_16x16x32_bf16 a[148:151], v[48:51], v[20:23], a[148:151]
    v_mfma_f32_16x16x32_bf16 a[152:155], v[48:51], v[24:27], a[152:155]
    v_mfma_f32_16x16x32_bf16 a[156:159], v[48:51], v[28:31], a[156:159]
    v_mfma_f32_16x16x32_bf16 a[160:163], v[52:55], v[0:3], a[160:163]
    v_mfma_f32_16x16x32_bf16 a[164:167], v[52:55], v[4:7], a[164:167]
    v_mfma_f32_16x16x32_bf16 a[168:171], v[52:55], v[8:11], a[168:171]
    v_mfma_f32_16x16x32_bf16 a[172:175], v[52:55], v[12:15], a[172:175]
    v_mfma_f32_16x16x32_bf16 a[176:179], v[52:55], v[16:19], a[176:179]
    v_mfma_f32_16x16x32_bf16 a[180:183], v[52:55], v[20:23], a[180:183]
    v_mfma_f32_16x16x32_bf16 a[184:187], v[52:55], v[24:27], a[184:187]
    v_mfma_f32_16x16x32_bf16 a[188:191], v[52:55], v[28:31], a[188:191]
    v_mfma_f32_16x16x32_bf16 a[192:195], v[56:59], v[0:3], a[192:195]
    v_mfma_f32_16x16x32_bf16 a[196:199], v[56:59], v[4:7], a[196:199]
    v_mfma_f32_16x16x32_bf16 a[200:203], v[56:59], v[8:11], a[200:203]
    v_mfma_f32_16x16x32_bf16 a[204:207], v[56:59], v[12:15], a[204:207]
    v_mfma_f32_16x16x32_bf16 a[208:211], v[56:59], v[16:19], a[208:211]
    v_mfma_f32_16x16x32_bf16 a[212:215], v[56:59], v[20:23], a[212:215]
    v_mfma_f32_16x16x32_bf16 a[216:219], v[56:59], v[24:27], a[216:219]
    v_mfma_f32_16x16x32_bf16 a[220:223], v[56:59], v[28:31], a[220:223]
    v_mfma_f32_16x16x32_bf16 a[224:227], v[60:63], v[0:3], a[224:227]
    v_mfma_f32_16x16x32_bf16 a[228:231], v[60:63], v[4:7], a[228:231]
    v_mfma_f32_16x16x32_bf16 a[232:235], v[60:63], v[8:11], a[232:235]
    v_mfma_f32_16x16x32_bf16 a[236:239], v[60:63], v[12:15], a[236:239]
    v_mfma_f32_16x16x32_bf16 a[240:243], v[60:63], v[16:19], a[240:243]
    v_mfma_f32_16x16x32_bf16 a[244:247], v[60:63], v[20:23], a[244:247]
    v_mfma_f32_16x16x32_bf16 a[248:251], v[60:63], v[24:27], a[248:251]
    v_mfma_f32_16x16x32_bf16 a[252:255], v[60:63], v[28:31], a[252:255]
    s_waitcnt lgkmcnt(0)
    v_mfma_f32_16x16x32_bf16 a[0:3], v[96:99], v[64:67], a[0:3]
    s_waitcnt vmcnt(8)
    s_barrier
    ds_read_b128 v[32:35], v136 offset:32768
    v_mfma_f32_16x16x32_bf16 a[4:7], v[96:99], v[68:71], a[4:7]
    ds_read_b64_tr_b16 v[0:1], v128 offset:32768
    v_mfma_f32_16x16x32_bf16 a[8:11], v[96:99], v[72:75], a[8:11]
    ds_read_b64_tr_b16 v[2:3], v128 offset:40960
    v_mfma_f32_16x16x32_bf16 a[12:15], v[96:99], v[76:79], a[12:15]
    ds_read_b64_tr_b16 v[4:5], v129 offset:32768
    v_mfma_f32_16x16x32_bf16 a[16:19], v[96:99], v[80:83], a[16:19]
    ds_read_b64_tr_b16 v[6:7], v129 offset:40960
    v_mfma_f32_16x16x32_bf16 a[20:23], v[96:99], v[84:87], a[20:23]
    ds_read_b64_tr_b16 v[8:9], v130 offset:32768
    v_mfma_f32_16x16x32_bf16 a[24:27], v[96:99], v[88:91], a[24:27]
    ds_read_b64_tr_b16 v[10:11], v130 offset:40960
    v_mfma_f32_16x16x32_bf16 a[28:31], v[96:99], v[92:95], a[28:31]
    ds_read_b64_tr_b16 v[12:13], v131 offset:32768
    v_mfma_f32_16x16x32_bf16 a[32:35], v[100:103], v[64:67], a[32:35]
    ds_read_b64_tr_b16 v[14:15], v131 offset:40960
    v_mfma_f32_16x16x32_bf16 a[36:39], v[100:103], v[68:71], a[36:39]
    ds_read_b64_tr_b16 v[16:17], v132 offset:32768
    v_mfma_f32_16x16x32_bf16 a[40:43], v[100:103], v[72:75], a[40:43]
    ds_read_b64_tr_b16 v[18:19], v132 offset:40960
    v_mfma_f32_16x16x32_bf16 a[44:47], v[100:103], v[76:79], a[44:47]
    ds_read_b64_tr_b16 v[20:21], v133 offset:32768
    v_mfma_f32_16x16x32_bf16 a[48:51], v[100:103], v[80:83], a[48:51]
    ds_read_b64_tr_b16 v[22:23], v133 offset:40960
    v_mfma_f32_16x16x32_bf16 a[52:55], v[100:103], v[84:87], a[52:55]
    ds_read_b64_tr_b16 v[24:25], v134 offset:32768
    v_mfma_f32_16x16x32_bf16 a[56:59], v[100:103], v[88:91], a[56:59]
    ds_read_b64_tr_b16 v[26:27], v134 offset:40960
    v_mfma_f32_16x16x32_bf16 a[60:63], v[100:103], v[92:95], a[60:63]
    ds_read_b64_tr_b16 v[28:29], v135 offset:32768
    v_mfma_f32_16x16x32_bf16 a[64:67], v[104:107], v[64:67], a[64:67]
    ds_read_b64_tr_b16 v[30:31], v135 offset:40960
    v_mfma_f32_16x16x32_bf16 a[68:71], v[104:107], v[68:71], a[68:71]
    ds_read_b128 v[36:39], v136 offset:33792
    v_mfma_f32_16x16x32_bf16 a[72:75], v[104:107], v[72:75], a[72:75]
    ds_read_b128 v[40:43], v136 offset:34816
    v_mfma_f32_16x16x32_bf16 a[76:79], v[104:107], v[76:79], a[76:79]
    ds_read_b128 v[44:47], v136 offset:35840
    v_mfma_f32_16x16x32_bf16 a[80:83], v[104:107], v[80:83], a[80:83]
    ds_read_b128 v[48:51], v136 offset:36864
    v_mfma_f32_16x16x32_bf16 a[84:87], v[104:107], v[84:87], a[84:87]
    ds_read_b128 v[52:55], v136 offset:37888
    v_mfma_f32_16x16x32_bf16 a[88:91], v[104:107], v[88:91], a[88:91]
    ds_read_b128 v[56:59], v136 offset:38912
    v_mfma_f32_16x16x32_bf16 a[92:95], v[104:107], v[92:95], a[92:95]
    ds_read_b128 v[60:63], v136 offset:39936
    v_mfma_f32_16x16x32_bf16 a[96:99], v[108:111], v[64:67], a[96:99]
    v_mfma_f32_16x16x32_bf16 a[100:103], v[108:111], v[68:71], a[100:103]
    v_mfma_f32_16x16x32_bf16 a[104:107], v[108:111], v[72:75], a[104:107]
    v_mfma_f32_16x16x32_bf16 a[108:111], v[108:111], v[76:79], a[108:111]
    v_mfma_f32_16x16x32_bf16 a[112:115], v[108:111], v[80:83], a[112:115]
    v_mfma_f32_16x16x32_bf16 a[116:119], v[108:111], v[84:87], a[116:119]
    v_mfma_f32_16x16x32_bf16 a[120:123], v[108:111], v[88:91], a[120:123]
    v_mfma_f32_16x16x32_bf16 a[124:127], v[108:111], v[92:95], a[124:127]
    v_mfma_f32_16x16x32_bf16 a[128:131], v[112:115], v[64:67], a[128:131]
    v_mfma_f32_16x16x32_bf16 a[132:135], v[112:115], v[68:71], a[132:135]
    v_mfma_f32_16x16x32_bf16 a[136:139], v[112:115], v[72:75], a[136:139]
    v_mfma_f32_16x16x32_bf16 a[140:143], v[112:115], v[76:79], a[140:143]
    v_mfma_f32_16x16x32_bf16 a[144:147], v[112:115], v[80:83], a[144:147]
    v_mfma_f32_16x16x32_bf16 a[148:151], v[112:115], v[84:87], a[148:151]
    v_mfma_f32_16x16x32_bf16 a[152:155], v[112:115], v[88:91], a[152:155]
    v_mfma_f32_16x16x32_bf16 a[156:159], v[112:115], v[92:95], a[156:159]
    v_mfma_f32_16x16x32_bf16 a[160:163], v[116:119], v[64:67], a[160:163]
    v_mfma_f32_16x16x32_bf16 a[164:167], v[116:119], v[68:71], a[164:167]
    v_mfma_f32_16x16x32_bf16 a[168:171], v[116:119], v[72:75], a[168:171]
    v_mfma_f32_16x16x32_bf16 a[172:175], v[116:119], v[76:79], a[172:175]
    v_mfma_f32_16x16x32_bf16 a[176:179], v[116:119], v[80:83], a[176:179]
    v_mfma_f32_16x16x32_bf16 a[180:183], v[116:119], v[84:87], a[180:183]
    v_mfma_f32_16x16x32_bf16 a[184:187], v[116:119], v[88:91], a[184:187]
    v_mfma_f32_16x16x32_bf16 a[188:191], v[116:119], v[92:95], a[188:191]
    v_mfma_f32_16x16x32_bf16 a[192:195], v[120:123], v[64:67], a[192:195]
    v_mfma_f32_16x16x32_bf16 a[196:199], v[120:123], v[68:71], a[196:199]
    v_mfma_f32_16x16x32_bf16 a[200:203], v[120:123], v[72:75], a[200:203]
    v_mfma_f32_16x16x32_bf16 a[204:207], v[120:123], v[76:79], a[204:207]
    v_mfma_f32_16x16x32_bf16 a[208:211], v[120:123], v[80:83], a[208:211]
    v_mfma_f32_16x16x32_bf16 a[212:215], v[120:123], v[84:87], a[212:215]
    v_mfma_f32_16x16x32_bf16 a[216:219], v[120:123], v[88:91], a[216:219]
    v_mfma_f32_16x16x32_bf16 a[220:223], v[120:123], v[92:95], a[220:223]
    v_mfma_f32_16x16x32_bf16 a[224:227], v[124:127], v[64:67], a[224:227]
    v_mfma_f32_16x16x32_bf16 a[228:231], v[124:127], v[68:71], a[228:231]
    v_mfma_f32_16x16x32_bf16 a[232:235], v[124:127], v[72:75], a[232:235]
    v_mfma_f32_16x16x32_bf16 a[236:239], v[124:127], v[76:79], a[236:239]
    v_mfma_f32_16x16x32_bf16 a[240:243], v[124:127], v[80:83], a[240:243]
    v_mfma_f32_16x16x32_bf16 a[244:247], v[124:127], v[84:87], a[244:247]
    v_mfma_f32_16x16x32_bf16 a[248:251], v[124:127], v[88:91], a[248:251]
    v_mfma_f32_16x16x32_bf16 a[252:255], v[124:127], v[92:95], a[252:255]
    s_waitcnt lgkmcnt(0)
    v_mfma_f32_16x16x32_bf16 a[0:3], v[32:35], v[0:3], a[0:3]
    s_waitcnt vmcnt(0)
    s_barrier
    ds_read_b128 v[96:99], v136 offset:49152
    v_mfma_f32_16x16x32_bf16 a[4:7], v[32:35], v[4:7], a[4:7]
    ds_read_b64_tr_b16 v[64:65], v128 offset:49152
    v_mfma_f32_16x16x32_bf16 a[8:11], v[32:35], v[8:11], a[8:11]
    ds_read_b64_tr_b16 v[66:67], v128 offset:57344
    v_mfma_f32_16x16x32_bf16 a[12:15], v[32:35], v[12:15], a[12:15]
    ds_read_b64_tr_b16 v[68:69], v129 offset:49152
    v_mfma_f32_16x16x32_bf16 a[16:19], v[32:35], v[16:19], a[16:19]
    ds_read_b64_tr_b16 v[70:71], v129 offset:57344
    v_mfma_f32_16x16x32_bf16 a[20:23], v[32:35], v[20:23], a[20:23]
    ds_read_b64_tr_b16 v[72:73], v130 offset:49152
    v_mfma_f32_16x16x32_bf16 a[24:27], v[32:35], v[24:27], a[24:27]
    ds_read_b64_tr_b16 v[74:75], v130 offset:57344
    v_mfma_f32_16x16x32_bf16 a[28:31], v[32:35], v[28:31], a[28:31]
    ds_read_b64_tr_b16 v[76:77], v131 offset:49152
    v_mfma_f32_16x16x32_bf16 a[32:35], v[36:39], v[0:3], a[32:35]
    ds_read_b64_tr_b16 v[78:79], v131 offset:57344
    v_mfma_f32_16x16x32_bf16 a[36:39], v[36:39], v[4:7], a[36:39]
    ds_read_b64_tr_b16 v[80:81], v132 offset:49152
    v_mfma_f32_16x16x32_bf16 a[40:43], v[36:39], v[8:11], a[40:43]
    ds_read_b64_tr_b16 v[82:83], v132 offset:57344
    v_mfma_f32_16x16x32_bf16 a[44:47], v[36:39], v[12:15], a[44:47]
    ds_read_b64_tr_b16 v[84:85], v133 offset:49152
    v_mfma_f32_16x16x32_bf16 a[48:51], v[36:39], v[16:19], a[48:51]
    ds_read_b64_tr_b16 v[86:87], v133 offset:57344
    v_mfma_f32_16x16x32_bf16 a[52:55], v[36:39], v[20:23], a[52:55]
    ds_read_b64_tr_b16 v[88:89], v134 offset:49152
    v_mfma_f32_16x16x32_bf16 a[56:59], v[36:39], v[24:27], a[56:59]
    ds_read_b64_tr_b16 v[90:91], v134 offset:57344
    v_mfma_f32_16x16x32_bf16 a[60:63], v[36:39], v[28:31], a[60:63]
    ds_read_b64_tr_b16 v[92:93], v135 offset:49152
    v_mfma_f32_16x16x32_bf16 a[64:67], v[40:43], v[0:3], a[64:67]
    ds_read_b64_tr_b16 v[94:95], v135 offset:57344
    v_mfma_f32_16x16x32_bf16 a[68:71], v[40:43], v[4:7], a[68:71]
    ds_read_b128 v[100:103], v136 offset:50176
    v_mfma_f32_16x16x32_bf16 a[72:75], v[40:43], v[8:11], a[72:75]
    ds_read_b128 v[104:107], v136 offset:51200
    v_mfma_f32_16x16x32_bf16 a[76:79], v[40:43], v[12:15], a[76:79]
    ds_read_b128 v[108:111], v136 offset:52224
    v_mfma_f32_16x16x32_bf16 a[80:83], v[40:43], v[16:19], a[80:83]
    ds_read_b128 v[112:115], v136 offset:53248
    v_mfma_f32_16x16x32_bf16 a[84:87], v[40:43], v[20:23], a[84:87]
    ds_read_b128 v[116:119], v136 offset:54272
    v_mfma_f32_16x16x32_bf16 a[88:91], v[40:43], v[24:27], a[88:91]
    ds_read_b128 v[120:123], v136 offset:55296
    v_mfma_f32_16x16x32_bf16 a[92:95], v[40:43], v[28:31], a[92:95]
    ds_read_b128 v[124:127], v136 offset:56320
    v_mfma_f32_16x16x32_bf16 a[96:99], v[44:47], v[0:3], a[96:99]
    v_mfma_f32_16x16x32_bf16 a[100:103], v[44:47], v[4:7], a[100:103]
    v_mfma_f32_16x16x32_bf16 a[104:107], v[44:47], v[8:11], a[104:107]
    v_mfma_f32_16x16x32_bf16 a[108:111], v[44:47], v[12:15], a[108:111]
    v_mfma_f32_16x16x32_bf16 a[112:115], v[44:47], v[16:19], a[112:115]
    v_mfma_f32_16x16x32_bf16 a[116:119], v[44:47], v[20:23], a[116:119]
    v_mfma_f32_16x16x32_bf16 a[120:123], v[44:47], v[24:27], a[120:123]
    v_mfma_f32_16x16x32_bf16 a[124:127], v[44:47], v[28:31], a[124:127]
    v_mfma_f32_16x16x32_bf16 a[128:131], v[48:51], v[0:3], a[128:131]
    v_mfma_f32_16x16x32_bf16 a[132:135], v[48:51], v[4:7], a[132:135]
    v_mfma_f32_16x16x32_bf16 a[136:139], v[48:51], v[8:11], a[136:139]
    v_mfma_f32_16x16x32_bf16 a[140:143], v[48:51], v[12:15], a[140:143]
    v_mfma_f32_16x16x32_bf16 a[144:147], v[48:51], v[16:19], a[144:147]
    v_mfma_f32_16x16x32_bf16 a[148:151], v[48:51], v[20:23], a[148:151]
    v_mfma_f32_16x16x32_bf16 a[152:155], v[48:51], v[24:27], a[152:155]
    v_mfma_f32_16x16x32_bf16 a[156:159], v[48:51], v[28:31], a[156:159]
    v_mfma_f32_16x16x32_bf16 a[160:163], v[52:55], v[0:3], a[160:163]
    v_mfma_f32_16x16x32_bf16 a[164:167], v[52:55], v[4:7], a[164:167]
    v_mfma_f32_16x16x32_bf16 a[168:171], v[52:55], v[8:11], a[168:171]
    v_mfma_f32_16x16x32_bf16 a[172:175], v[52:55], v[12:15], a[172:175]
    v_mfma_f32_16x16x32_bf16 a[176:179], v[52:55], v[16:19], a[176:179]
    v_mfma_f32_16x16x32_bf16 a[180:183], v[52:55], v[20:23], a[180:183]
    v_mfma_f32_16x16x32_bf16 a[184:187], v[52:55], v[24:27], a[184:187]
    v_mfma_f32_16x16x32_bf16 a[188:191], v[52:55], v[28:31], a[188:191]
    v_mfma_f32_16x16x32_bf16 a[192:195], v[56:59], v[0:3], a[192:195]
    v_mfma_f32_16x16x32_bf16 a[196:199], v[56:59], v[4:7], a[196:199]
    v_mfma_f32_16x16x32_bf16 a[200:203], v[56:59], v[8:11], a[200:203]
    v_mfma_f32_16x16x32_bf16 a[204:207], v[56:59], v[12:15], a[204:207]
    v_mfma_f32_16x16x32_bf16 a[208:211], v[56:59], v[16:19], a[208:211]
    v_mfma_f32_16x16x32_bf16 a[212:215], v[56:59], v[20:23], a[212:215]
    v_mfma_f32_16x16x32_bf16 a[216:219], v[56:59], v[24:27], a[216:219]
    v_mfma_f32_16x16x32_bf16 a[220:223], v[56:59], v[28:31], a[220:223]
    v_mfma_f32_16x16x32_bf16 a[224:227], v[60:63], v[0:3], a[224:227]
    v_mfma_f32_16x16x32_bf16 a[228:231], v[60:63], v[4:7], a[228:231]
    v_mfma_f32_16x16x32_bf16 a[232:235], v[60:63], v[8:11], a[232:235]
    v_mfma_f32_16x16x32_bf16 a[236:239], v[60:63], v[12:15], a[236:239]
    v_mfma_f32_16x16x32_bf16 a[240:243], v[60:63], v[16:19], a[240:243]
    v_mfma_f32_16x16x32_bf16 a[244:247], v[60:63], v[20:23], a[244:247]
    v_mfma_f32_16x16x32_bf16 a[248:251], v[60:63], v[24:27], a[248:251]
    v_mfma_f32_16x16x32_bf16 a[252:255], v[60:63], v[28:31], a[252:255]
    v_readfirstlane_b32 s55, v255
    s_waitcnt lgkmcnt(0)
    v_mfma_f32_16x16x32_bf16 a[0:3], v[96:99], v[64:67], a[0:3]
    v_mfma_f32_16x16x32_bf16 a[4:7], v[96:99], v[68:71], a[4:7]
    v_mfma_f32_16x16x32_bf16 a[8:11], v[96:99], v[72:75], a[8:11]
    v_mfma_f32_16x16x32_bf16 a[12:15], v[96:99], v[76:79], a[12:15]
    v_mfma_f32_16x16x32_bf16 a[16:19], v[96:99], v[80:83], a[16:19]
    v_mfma_f32_16x16x32_bf16 a[20:23], v[96:99], v[84:87], a[20:23]
    v_mfma_f32_16x16x32_bf16 a[24:27], v[96:99], v[88:91], a[24:27]
    v_mfma_f32_16x16x32_bf16 a[28:31], v[96:99], v[92:95], a[28:31]
    v_mfma_f32_16x16x32_bf16 a[32:35], v[100:103], v[64:67], a[32:35]
    v_mfma_f32_16x16x32_bf16 a[36:39], v[100:103], v[68:71], a[36:39]
    v_mfma_f32_16x16x32_bf16 a[40:43], v[100:103], v[72:75], a[40:43]
    v_mfma_f32_16x16x32_bf16 a[44:47], v[100:103], v[76:79], a[44:47]
    v_mfma_f32_16x16x32_bf16 a[48:51], v[100:103], v[80:83], a[48:51]
    v_mfma_f32_16x16x32_bf16 a[52:55], v[100:103], v[84:87], a[52:55]
    v_mfma_f32_16x16x32_bf16 a[56:59], v[100:103], v[88:91], a[56:59]
    v_mfma_f32_16x16x32_bf16 a[60:63], v[100:103], v[92:95], a[60:63]
    v_mfma_f32_16x16x32_bf16 a[64:67], v[104:107], v[64:67], a[64:67]
    v_mfma_f32_16x16x32_bf16 a[68:71], v[104:107], v[68:71], a[68:71]
    v_mfma_f32_16x16x32_bf16 a[72:75], v[104:107], v[72:75], a[72:75]
    v_mfma_f32_16x16x32_bf16 a[76:79], v[104:107], v[76:79], a[76:79]
    v_mfma_f32_16x16x32_bf16 a[80:83], v[104:107], v[80:83], a[80:83]
    v_mfma_f32_16x16x32_bf16 a[84:87], v[104:107], v[84:87], a[84:87]
    v_mfma_f32_16x16x32_bf16 a[88:91], v[104:107], v[88:91], a[88:91]
    v_mfma_f32_16x16x32_bf16 a[92:95], v[104:107], v[92:95], a[92:95]
    v_mfma_f32_16x16x32_bf16 a[96:99], v[108:111], v[64:67], a[96:99]
    v_mfma_f32_16x16x32_bf16 a[100:103], v[108:111], v[68:71], a[100:103]
    v_mfma_f32_16x16x32_bf16 a[104:107], v[108:111], v[72:75], a[104:107]
    v_mfma_f32_16x16x32_bf16 a[108:111], v[108:111], v[76:79], a[108:111]
    v_mfma_f32_16x16x32_bf16 a[112:115], v[108:111], v[80:83], a[112:115]
    v_mfma_f32_16x16x32_bf16 a[116:119], v[108:111], v[84:87], a[116:119]
    v_mfma_f32_16x16x32_bf16 a[120:123], v[108:111], v[88:91], a[120:123]
    v_mfma_f32_16x16x32_bf16 a[124:127], v[108:111], v[92:95], a[124:127]
    v_mfma_f32_16x16x32_bf16 a[128:131], v[112:115], v[64:67], a[128:131]
    v_mfma_f32_16x16x32_bf16 a[132:135], v[112:115], v[68:71], a[132:135]
    v_mfma_f32_16x16x32_bf16 a[136:139], v[112:115], v[72:75], a[136:139]
    v_mfma_f32_16x16x32_bf16 a[140:143], v[112:115], v[76:79], a[140:143]
    v_mfma_f32_16x16x32_bf16 a[144:147], v[112:115], v[80:83], a[144:147]
    v_mfma_f32_16x16x32_bf16 a[148:151], v[112:115], v[84:87], a[148:151]
    v_mfma_f32_16x16x32_bf16 a[152:155], v[112:115], v[88:91], a[152:155]
    v_mfma_f32_16x16x32_bf16 a[156:159], v[112:115], v[92:95], a[156:159]
    v_mfma_f32_16x16x32_bf16 a[160:163], v[116:119], v[64:67], a[160:163]
    v_mfma_f32_16x16x32_bf16 a[164:167], v[116:119], v[68:71], a[164:167]
    v_mfma_f32_16x16x32_bf16 a[168:171], v[116:119], v[72:75], a[168:171]
    v_mfma_f32_16x16x32_bf16 a[172:175], v[116:119], v[76:79], a[172:175]
    v_mfma_f32_16x16x32_bf16 a[176:179], v[116:119], v[80:83], a[176:179]
    v_mfma_f32_16x16x32_bf16 a[180:183], v[116:119], v[84:87], a[180:183]
    v_mfma_f32_16x16x32_bf16 a[184:187], v[116:119], v[88:91], a[184:187]
    v_mfma_f32_16x16x32_bf16 a[188:191], v[116:119], v[92:95], a[188:191]
    v_mfma_f32_16x16x32_bf16 a[192:195], v[120:123], v[64:67], a[192:195]
    v_mfma_f32_16x16x32_bf16 a[196:199], v[120:123], v[68:71], a[196:199]
    v_mfma_f32_16x16x32_bf16 a[200:203], v[120:123], v[72:75], a[200:203]
    v_mfma_f32_16x16x32_bf16 a[204:207], v[120:123], v[76:79], a[204:207]
    v_mfma_f32_16x16x32_bf16 a[208:211], v[120:123], v[80:83], a[208:211]
    v_mfma_f32_16x16x32_bf16 a[212:215], v[120:123], v[84:87], a[212:215]
    v_mfma_f32_16x16x32_bf16 a[216:219], v[120:123], v[88:91], a[216:219]
    v_mfma_f32_16x16x32_bf16 a[220:223], v[120:123], v[92:95], a[220:223]
    v_mfma_f32_16x16x32_bf16 a[224:227], v[124:127], v[64:67], a[224:227]
    v_mfma_f32_16x16x32_bf16 a[228:231], v[124:127], v[68:71], a[228:231]
    v_mfma_f32_16x16x32_bf16 a[232:235], v[124:127], v[72:75], a[232:235]
    v_mfma_f32_16x16x32_bf16 a[236:239], v[124:127], v[76:79], a[236:239]
    v_mfma_f32_16x16x32_bf16 a[240:243], v[124:127], v[80:83], a[240:243]
    v_mfma_f32_16x16x32_bf16 a[244:247], v[124:127], v[84:87], a[244:247]
    v_mfma_f32_16x16x32_bf16 a[248:251], v[124:127], v[88:91], a[248:251]
    v_mfma_f32_16x16x32_bf16 a[252:255], v[124:127], v[92:95], a[252:255]
    s_nop 7
    s_mov_b32 s53, s21
    v_accvgpr_read_b32 v0, a0
    v_accvgpr_read_b32 v1, a1
    v_accvgpr_read_b32 v2, a2
    v_accvgpr_read_b32 v3, a3
    v_accvgpr_read_b32 v4, a32
    v_accvgpr_read_b32 v5, a33
    v_accvgpr_read_b32 v6, a34
    v_accvgpr_read_b32 v7, a35
    v_cvt_pk_bf16_f32 v8, v0, v1
    v_cvt_pk_bf16_f32 v9, v2, v3
    v_cvt_pk_bf16_f32 v10, v4, v5
    v_cvt_pk_bf16_f32 v11, v6, v7
    buffer_store_dwordx4 v[8:11], v251, s[4:7], s53 offen offset:0 sc1
    v_accvgpr_read_b32 v16, a4
    v_accvgpr_read_b32 v17, a5
    v_accvgpr_read_b32 v18, a6
    v_accvgpr_read_b32 v19, a7
    v_accvgpr_read_b32 v20, a36
    v_accvgpr_read_b32 v21, a37
    v_accvgpr_read_b32 v22, a38
    v_accvgpr_read_b32 v23, a39
    v_cvt_pk_bf16_f32 v24, v16, v17
    v_cvt_pk_bf16_f32 v25, v18, v19
    v_cvt_pk_bf16_f32 v26, v20, v21
    v_cvt_pk_bf16_f32 v27, v22, v23
    buffer_store_dwordx4 v[24:27], v251, s[4:7], s53 offen offset:1024 sc1
    v_accvgpr_read_b32 v32, a8
    v_accvgpr_read_b32 v33, a9
    v_accvgpr_read_b32 v34, a10
    v_accvgpr_read_b32 v35, a11
    v_accvgpr_read_b32 v36, a40
    v_accvgpr_read_b32 v37, a41
    v_accvgpr_read_b32 v38, a42
    v_accvgpr_read_b32 v39, a43
    v_cvt_pk_bf16_f32 v40, v32, v33
    v_cvt_pk_bf16_f32 v41, v34, v35
    v_cvt_pk_bf16_f32 v42, v36, v37
    v_cvt_pk_bf16_f32 v43, v38, v39
    buffer_store_dwordx4 v[40:43], v251, s[4:7], s53 offen offset:2048 sc1
    v_accvgpr_read_b32 v48, a12
    v_accvgpr_read_b32 v49, a13
    v_accvgpr_read_b32 v50, a14
    v_accvgpr_read_b32 v51, a15
    v_accvgpr_read_b32 v52, a44
    v_accvgpr_read_b32 v53, a45
    v_accvgpr_read_b32 v54, a46
    v_accvgpr_read_b32 v55, a47
    v_cvt_pk_bf16_f32 v56, v48, v49
    v_cvt_pk_bf16_f32 v57, v50, v51
    v_cvt_pk_bf16_f32 v58, v52, v53
    v_cvt_pk_bf16_f32 v59, v54, v55
    buffer_store_dwordx4 v[56:59], v251, s[4:7], s53 offen offset:3072 sc1
    s_add_u32 s53, s53, 4096
    v_accvgpr_read_b32 v0, a16
    v_accvgpr_read_b32 v1, a17
    v_accvgpr_read_b32 v2, a18
    v_accvgpr_read_b32 v3, a19
    v_accvgpr_read_b32 v4, a48
    v_accvgpr_read_b32 v5, a49
    v_accvgpr_read_b32 v6, a50
    v_accvgpr_read_b32 v7, a51
    v_cvt_pk_bf16_f32 v8, v0, v1
    v_cvt_pk_bf16_f32 v9, v2, v3
    v_cvt_pk_bf16_f32 v10, v4, v5
    v_cvt_pk_bf16_f32 v11, v6, v7
    buffer_store_dwordx4 v[8:11], v251, s[4:7], s53 offen offset:0 sc1
    v_accvgpr_read_b32 v16, a20
    v_accvgpr_read_b32 v17, a21
    v_accvgpr_read_b32 v18, a22
    v_accvgpr_read_b32 v19, a23
    v_accvgpr_read_b32 v20, a52
    v_accvgpr_read_b32 v21, a53
    v_accvgpr_read_b32 v22, a54
    v_accvgpr_read_b32 v23, a55
    v_cvt_pk_bf16_f32 v24, v16, v17
    v_cvt_pk_bf16_f32 v25, v18, v19
    v_cvt_pk_bf16_f32 v26, v20, v21
    v_cvt_pk_bf16_f32 v27, v22, v23
    buffer_store_dwordx4 v[24:27], v251, s[4:7], s53 offen offset:1024 sc1
    v_accvgpr_read_b32 v32, a24
    v_accvgpr_read_b32 v33, a25
    v_accvgpr_read_b32 v34, a26
    v_accvgpr_read_b32 v35, a27
    v_accvgpr_read_b32 v36, a56
    v_accvgpr_read_b32 v37, a57
    v_accvgpr_read_b32 v38, a58
    v_accvgpr_read_b32 v39, a59
    v_cvt_pk_bf16_f32 v40, v32, v33
    v_cvt_pk_bf16_f32 v41, v34, v35
    v_cvt_pk_bf16_f32 v42, v36, v37
    v_cvt_pk_bf16_f32 v43, v38, v39
    buffer_store_dwordx4 v[40:43], v251, s[4:7], s53 offen offset:2048 sc1
    v_accvgpr_read_b32 v48, a28
    v_accvgpr_read_b32 v49, a29
    v_accvgpr_read_b32 v50, a30
    v_accvgpr_read_b32 v51, a31
    v_accvgpr_read_b32 v52, a60
    v_accvgpr_read_b32 v53, a61
    v_accvgpr_read_b32 v54, a62
    v_accvgpr_read_b32 v55, a63
    v_cvt_pk_bf16_f32 v56, v48, v49
    v_cvt_pk_bf16_f32 v57, v50, v51
    v_cvt_pk_bf16_f32 v58, v52, v53
    v_cvt_pk_bf16_f32 v59, v54, v55
    buffer_store_dwordx4 v[56:59], v251, s[4:7], s53 offen offset:3072 sc1
    s_add_u32 s53, s53, 258048
    v_accvgpr_read_b32 v0, a64
    v_accvgpr_read_b32 v1, a65
    v_accvgpr_read_b32 v2, a66
    v_accvgpr_read_b32 v3, a67
    v_accvgpr_read_b32 v4, a96
    v_accvgpr_read_b32 v5, a97
    v_accvgpr_read_b32 v6, a98
    v_accvgpr_read_b32 v7, a99
    v_cvt_pk_bf16_f32 v8, v0, v1
    v_cvt_pk_bf16_f32 v9, v2, v3
    v_cvt_pk_bf16_f32 v10, v4, v5
    v_cvt_pk_bf16_f32 v11, v6, v7
    buffer_store_dwordx4 v[8:11], v251, s[4:7], s53 offen offset:0 sc1
    v_accvgpr_read_b32 v16, a68
    v_accvgpr_read_b32 v17, a69
    v_accvgpr_read_b32 v18, a70
    v_accvgpr_read_b32 v19, a71
    v_accvgpr_read_b32 v20, a100
    v_accvgpr_read_b32 v21, a101
    v_accvgpr_read_b32 v22, a102
    v_accvgpr_read_b32 v23, a103
    v_cvt_pk_bf16_f32 v24, v16, v17
    v_cvt_pk_bf16_f32 v25, v18, v19
    v_cvt_pk_bf16_f32 v26, v20, v21
    v_cvt_pk_bf16_f32 v27, v22, v23
    buffer_store_dwordx4 v[24:27], v251, s[4:7], s53 offen offset:1024 sc1
    v_accvgpr_read_b32 v32, a72
    v_accvgpr_read_b32 v33, a73
    v_accvgpr_read_b32 v34, a74
    v_accvgpr_read_b32 v35, a75
    v_accvgpr_read_b32 v36, a104
    v_accvgpr_read_b32 v37, a105
    v_accvgpr_read_b32 v38, a106
    v_accvgpr_read_b32 v39, a107
    v_cvt_pk_bf16_f32 v40, v32, v33
    v_cvt_pk_bf16_f32 v41, v34, v35
    v_cvt_pk_bf16_f32 v42, v36, v37
    v_cvt_pk_bf16_f32 v43, v38, v39
    buffer_store_dwordx4 v[40:43], v251, s[4:7], s53 offen offset:2048 sc1
    v_accvgpr_read_b32 v48, a76
    v_accvgpr_read_b32 v49, a77
    v_accvgpr_read_b32 v50, a78
    v_accvgpr_read_b32 v51, a79
    v_accvgpr_read_b32 v52, a108
    v_accvgpr_read_b32 v53, a109
    v_accvgpr_read_b32 v54, a110
    v_accvgpr_read_b32 v55, a111
    v_cvt_pk_bf16_f32 v56, v48, v49
    v_cvt_pk_bf16_f32 v57, v50, v51
    v_cvt_pk_bf16_f32 v58, v52, v53
    v_cvt_pk_bf16_f32 v59, v54, v55
    buffer_store_dwordx4 v[56:59], v251, s[4:7], s53 offen offset:3072 sc1
    s_add_u32 s53, s53, 4096
    v_accvgpr_read_b32 v0, a80
    v_accvgpr_read_b32 v1, a81
    v_accvgpr_read_b32 v2, a82
    v_accvgpr_read_b32 v3, a83
    v_accvgpr_read_b32 v4, a112
    v_accvgpr_read_b32 v5, a113
    v_accvgpr_read_b32 v6, a114
    v_accvgpr_read_b32 v7, a115
    v_cvt_pk_bf16_f32 v8, v0, v1
    v_cvt_pk_bf16_f32 v9, v2, v3
    v_cvt_pk_bf16_f32 v10, v4, v5
    v_cvt_pk_bf16_f32 v11, v6, v7
    buffer_store_dwordx4 v[8:11], v251, s[4:7], s53 offen offset:0 sc1
    v_accvgpr_read_b32 v16, a84
    v_accvgpr_read_b32 v17, a85
    v_accvgpr_read_b32 v18, a86
    v_accvgpr_read_b32 v19, a87
    v_accvgpr_read_b32 v20, a116
    v_accvgpr_read_b32 v21, a117
    v_accvgpr_read_b32 v22, a118
    v_accvgpr_read_b32 v23, a119
    v_cvt_pk_bf16_f32 v24, v16, v17
    v_cvt_pk_bf16_f32 v25, v18, v19
    v_cvt_pk_bf16_f32 v26, v20, v21
    v_cvt_pk_bf16_f32 v27, v22, v23
    buffer_store_dwordx4 v[24:27], v251, s[4:7], s53 offen offset:1024 sc1
    v_accvgpr_read_b32 v32, a88
    v_accvgpr_read_b32 v33, a89
    v_accvgpr_read_b32 v34, a90
    v_accvgpr_read_b32 v35, a91
    v_accvgpr_read_b32 v36, a120
    v_accvgpr_read_b32 v37, a121
    v_accvgpr_read_b32 v38, a122
    v_accvgpr_read_b32 v39, a123
    v_cvt_pk_bf16_f32 v40, v32, v33
    v_cvt_pk_bf16_f32 v41, v34, v35
    v_cvt_pk_bf16_f32 v42, v36, v37
    v_cvt_pk_bf16_f32 v43, v38, v39
    buffer_store_dwordx4 v[40:43], v251, s[4:7], s53 offen offset:2048 sc1
    v_accvgpr_read_b32 v48, a92
    v_accvgpr_read_b32 v49, a93
    v_accvgpr_read_b32 v50, a94
    v_accvgpr_read_b32 v51, a95
    v_accvgpr_read_b32 v52, a124
    v_accvgpr_read_b32 v53, a125
    v_accvgpr_read_b32 v54, a126
    v_accvgpr_read_b32 v55, a127
    v_cvt_pk_bf16_f32 v56, v48, v49
    v_cvt_pk_bf16_f32 v57, v50, v51
    v_cvt_pk_bf16_f32 v58, v52, v53
    v_cvt_pk_bf16_f32 v59, v54, v55
    buffer_store_dwordx4 v[56:59], v251, s[4:7], s53 offen offset:3072 sc1
    s_add_u32 s53, s53, 258048
    v_accvgpr_read_b32 v0, a128
    v_accvgpr_read_b32 v1, a129
    v_accvgpr_read_b32 v2, a130
    v_accvgpr_read_b32 v3, a131
    v_accvgpr_read_b32 v4, a160
    v_accvgpr_read_b32 v5, a161
    v_accvgpr_read_b32 v6, a162
    v_accvgpr_read_b32 v7, a163
    v_cvt_pk_bf16_f32 v8, v0, v1
    v_cvt_pk_bf16_f32 v9, v2, v3
    v_cvt_pk_bf16_f32 v10, v4, v5
    v_cvt_pk_bf16_f32 v11, v6, v7
    buffer_store_dwordx4 v[8:11], v251, s[4:7], s53 offen offset:0 sc1
    v_accvgpr_read_b32 v16, a132
    v_accvgpr_read_b32 v17, a133
    v_accvgpr_read_b32 v18, a134
    v_accvgpr_read_b32 v19, a135
    v_accvgpr_read_b32 v20, a164
    v_accvgpr_read_b32 v21, a165
    v_accvgpr_read_b32 v22, a166
    v_accvgpr_read_b32 v23, a167
    v_cvt_pk_bf16_f32 v24, v16, v17
    v_cvt_pk_bf16_f32 v25, v18, v19
    v_cvt_pk_bf16_f32 v26, v20, v21
    v_cvt_pk_bf16_f32 v27, v22, v23
    buffer_store_dwordx4 v[24:27], v251, s[4:7], s53 offen offset:1024 sc1
    v_accvgpr_read_b32 v32, a136
    v_accvgpr_read_b32 v33, a137
    v_accvgpr_read_b32 v34, a138
    v_accvgpr_read_b32 v35, a139
    v_accvgpr_read_b32 v36, a168
    v_accvgpr_read_b32 v37, a169
    v_accvgpr_read_b32 v38, a170
    v_accvgpr_read_b32 v39, a171
    v_cvt_pk_bf16_f32 v40, v32, v33
    v_cvt_pk_bf16_f32 v41, v34, v35
    v_cvt_pk_bf16_f32 v42, v36, v37
    v_cvt_pk_bf16_f32 v43, v38, v39
    buffer_store_dwordx4 v[40:43], v251, s[4:7], s53 offen offset:2048 sc1
    v_accvgpr_read_b32 v48, a140
    v_accvgpr_read_b32 v49, a141
    v_accvgpr_read_b32 v50, a142
    v_accvgpr_read_b32 v51, a143
    v_accvgpr_read_b32 v52, a172
    v_accvgpr_read_b32 v53, a173
    v_accvgpr_read_b32 v54, a174
    v_accvgpr_read_b32 v55, a175
    v_cvt_pk_bf16_f32 v56, v48, v49
    v_cvt_pk_bf16_f32 v57, v50, v51
    v_cvt_pk_bf16_f32 v58, v52, v53
    v_cvt_pk_bf16_f32 v59, v54, v55
    buffer_store_dwordx4 v[56:59], v251, s[4:7], s53 offen offset:3072 sc1
    s_add_u32 s53, s53, 4096
    v_accvgpr_read_b32 v0, a144
    v_accvgpr_read_b32 v1, a145
    v_accvgpr_read_b32 v2, a146
    v_accvgpr_read_b32 v3, a147
    v_accvgpr_read_b32 v4, a176
    v_accvgpr_read_b32 v5, a177
    v_accvgpr_read_b32 v6, a178
    v_accvgpr_read_b32 v7, a179
    v_cvt_pk_bf16_f32 v8, v0, v1
    v_cvt_pk_bf16_f32 v9, v2, v3
    v_cvt_pk_bf16_f32 v10, v4, v5
    v_cvt_pk_bf16_f32 v11, v6, v7
    buffer_store_dwordx4 v[8:11], v251, s[4:7], s53 offen offset:0 sc1
    v_accvgpr_read_b32 v16, a148
    v_accvgpr_read_b32 v17, a149
    v_accvgpr_read_b32 v18, a150
    v_accvgpr_read_b32 v19, a151
    v_accvgpr_read_b32 v20, a180
    v_accvgpr_read_b32 v21, a181
    v_accvgpr_read_b32 v22, a182
    v_accvgpr_read_b32 v23, a183
    v_cvt_pk_bf16_f32 v24, v16, v17
    v_cvt_pk_bf16_f32 v25, v18, v19
    v_cvt_pk_bf16_f32 v26, v20, v21
    v_cvt_pk_bf16_f32 v27, v22, v23
    buffer_store_dwordx4 v[24:27], v251, s[4:7], s53 offen offset:1024 sc1
    v_accvgpr_read_b32 v32, a152
    v_accvgpr_read_b32 v33, a153
    v_accvgpr_read_b32 v34, a154
    v_accvgpr_read_b32 v35, a155
    v_accvgpr_read_b32 v36, a184
    v_accvgpr_read_b32 v37, a185
    v_accvgpr_read_b32 v38, a186
    v_accvgpr_read_b32 v39, a187
    v_cvt_pk_bf16_f32 v40, v32, v33
    v_cvt_pk_bf16_f32 v41, v34, v35
    v_cvt_pk_bf16_f32 v42, v36, v37
    v_cvt_pk_bf16_f32 v43, v38, v39
    buffer_store_dwordx4 v[40:43], v251, s[4:7], s53 offen offset:2048 sc1
    v_accvgpr_read_b32 v48, a156
    v_accvgpr_read_b32 v49, a157
    v_accvgpr_read_b32 v50, a158
    v_accvgpr_read_b32 v51, a159
    v_accvgpr_read_b32 v52, a188
    v_accvgpr_read_b32 v53, a189
    v_accvgpr_read_b32 v54, a190
    v_accvgpr_read_b32 v55, a191
    v_cvt_pk_bf16_f32 v56, v48, v49
    v_cvt_pk_bf16_f32 v57, v50, v51
    v_cvt_pk_bf16_f32 v58, v52, v53
    v_cvt_pk_bf16_f32 v59, v54, v55
    buffer_store_dwordx4 v[56:59], v251, s[4:7], s53 offen offset:3072 sc1
    s_add_u32 s53, s53, 258048
    v_accvgpr_read_b32 v0, a192
    v_accvgpr_read_b32 v1, a193
    v_accvgpr_read_b32 v2, a194
    v_accvgpr_read_b32 v3, a195
    v_accvgpr_read_b32 v4, a224
    v_accvgpr_read_b32 v5, a225
    v_accvgpr_read_b32 v6, a226
    v_accvgpr_read_b32 v7, a227
    v_cvt_pk_bf16_f32 v8, v0, v1
    v_cvt_pk_bf16_f32 v9, v2, v3
    v_cvt_pk_bf16_f32 v10, v4, v5
    v_cvt_pk_bf16_f32 v11, v6, v7
    buffer_store_dwordx4 v[8:11], v251, s[4:7], s53 offen offset:0 sc1
    v_accvgpr_read_b32 v16, a196
    v_accvgpr_read_b32 v17, a197
    v_accvgpr_read_b32 v18, a198
    v_accvgpr_read_b32 v19, a199
    v_accvgpr_read_b32 v20, a228
    v_accvgpr_read_b32 v21, a229
    v_accvgpr_read_b32 v22, a230
    v_accvgpr_read_b32 v23, a231
    v_cvt_pk_bf16_f32 v24, v16, v17
    v_cvt_pk_bf16_f32 v25, v18, v19
    v_cvt_pk_bf16_f32 v26, v20, v21
    v_cvt_pk_bf16_f32 v27, v22, v23
    buffer_store_dwordx4 v[24:27], v251, s[4:7], s53 offen offset:1024 sc1
    v_accvgpr_read_b32 v32, a200
    v_accvgpr_read_b32 v33, a201
    v_accvgpr_read_b32 v34, a202
    v_accvgpr_read_b32 v35, a203
    v_accvgpr_read_b32 v36, a232
    v_accvgpr_read_b32 v37, a233
    v_accvgpr_read_b32 v38, a234
    v_accvgpr_read_b32 v39, a235
    v_cvt_pk_bf16_f32 v40, v32, v33
    v_cvt_pk_bf16_f32 v41, v34, v35
    v_cvt_pk_bf16_f32 v42, v36, v37
    v_cvt_pk_bf16_f32 v43, v38, v39
    buffer_store_dwordx4 v[40:43], v251, s[4:7], s53 offen offset:2048 sc1
    v_accvgpr_read_b32 v48, a204
    v_accvgpr_read_b32 v49, a205
    v_accvgpr_read_b32 v50, a206
    v_accvgpr_read_b32 v51, a207
    v_accvgpr_read_b32 v52, a236
    v_accvgpr_read_b32 v53, a237
    v_accvgpr_read_b32 v54, a238
    v_accvgpr_read_b32 v55, a239
    v_cvt_pk_bf16_f32 v56, v48, v49
    v_cvt_pk_bf16_f32 v57, v50, v51
    v_cvt_pk_bf16_f32 v58, v52, v53
    v_cvt_pk_bf16_f32 v59, v54, v55
    buffer_store_dwordx4 v[56:59], v251, s[4:7], s53 offen offset:3072 sc1
    s_add_u32 s53, s53, 4096
    v_accvgpr_read_b32 v0, a208
    v_accvgpr_read_b32 v1, a209
    v_accvgpr_read_b32 v2, a210
    v_accvgpr_read_b32 v3, a211
    v_accvgpr_read_b32 v4, a240
    v_accvgpr_read_b32 v5, a241
    v_accvgpr_read_b32 v6, a242
    v_accvgpr_read_b32 v7, a243
    v_cvt_pk_bf16_f32 v8, v0, v1
    v_cvt_pk_bf16_f32 v9, v2, v3
    v_cvt_pk_bf16_f32 v10, v4, v5
    v_cvt_pk_bf16_f32 v11, v6, v7
    buffer_store_dwordx4 v[8:11], v251, s[4:7], s53 offen offset:0 sc1
    v_accvgpr_read_b32 v16, a212
    v_accvgpr_read_b32 v17, a213
    v_accvgpr_read_b32 v18, a214
    v_accvgpr_read_b32 v19, a215
    v_accvgpr_read_b32 v20, a244
    v_accvgpr_read_b32 v21, a245
    v_accvgpr_read_b32 v22, a246
    v_accvgpr_read_b32 v23, a247
    v_cvt_pk_bf16_f32 v24, v16, v17
    v_cvt_pk_bf16_f32 v25, v18, v19
    v_cvt_pk_bf16_f32 v26, v20, v21
    v_cvt_pk_bf16_f32 v27, v22, v23
    buffer_store_dwordx4 v[24:27], v251, s[4:7], s53 offen offset:1024 sc1
    v_accvgpr_read_b32 v32, a216
    v_accvgpr_read_b32 v33, a217
    v_accvgpr_read_b32 v34, a218
    v_accvgpr_read_b32 v35, a219
    v_accvgpr_read_b32 v36, a248
    v_accvgpr_read_b32 v37, a249
    v_accvgpr_read_b32 v38, a250
    v_accvgpr_read_b32 v39, a251
    v_cvt_pk_bf16_f32 v40, v32, v33
    v_cvt_pk_bf16_f32 v41, v34, v35
    v_cvt_pk_bf16_f32 v42, v36, v37
    v_cvt_pk_bf16_f32 v43, v38, v39
    buffer_store_dwordx4 v[40:43], v251, s[4:7], s53 offen offset:2048 sc1
    v_accvgpr_read_b32 v48, a220
    v_accvgpr_read_b32 v49, a221
    v_accvgpr_read_b32 v50, a222
    v_accvgpr_read_b32 v51, a223
    v_accvgpr_read_b32 v52, a252
    v_accvgpr_read_b32 v53, a253
    v_accvgpr_read_b32 v54, a254
    v_accvgpr_read_b32 v55, a255
    v_cvt_pk_bf16_f32 v56, v48, v49
    v_cvt_pk_bf16_f32 v57, v50, v51
    v_cvt_pk_bf16_f32 v58, v52, v53
    v_cvt_pk_bf16_f32 v59, v54, v55
    buffer_store_dwordx4 v[56:59], v251, s[4:7], s53 offen offset:3072 sc1
    s_add_u32 s53, s53, 258048
    s_branch main_kernel_w_done
main_kernel_w_pref:
    s_cmp_lg_u32 s24, 0
    s_cbranch_scc1 main_kernel_w_pf0
    s_mov_b32 s8, s64
    s_and_b32 s9, s65, 0xffff
    s_mov_b32 s10, 0x200000
    s_mov_b32 s11, 0x20000
    s_branch main_kernel_w_pfg
main_kernel_w_pf0:
    s_cmp_lg_u32 s24, 1
    s_cbranch_scc1 main_kernel_w_pf1
    s_mov_b32 s8, s66
    s_and_b32 s9, s67, 0xffff
    s_mov_b32 s10, 0x200000
    s_mov_b32 s11, 0x20000
    s_branch main_kernel_w_pfg
main_kernel_w_pf1:
    s_cmp_lg_u32 s24, 2
    s_cbranch_scc1 main_kernel_w_pf2
    s_mov_b32 s8, s68
    s_and_b32 s9, s69, 0xffff
    s_mov_b32 s10, 0x700000
    s_mov_b32 s11, 0x20000
    s_branch main_kernel_w_pfg
main_kernel_w_pf2:
    s_mov_b32 s8, s70
    s_and_b32 s9, s71, 0xffff
    s_mov_b32 s10, 0x700000
    s_mov_b32 s11, 0x20000
main_kernel_w_pfg:
    s_lshl_b32 s32, s25, 19
    s_lshl_b32 s33, s14, 17
    s_add_u32 s32, s32, s33
    v_lshlrev_b32 v253, 7, v250
    buffer_load_dword v0, v253, s[8:11], s32 offen
    s_add_u32 s32, s32, 8192
    buffer_load_dword v0, v253, s[8:11], s32 offen
    s_add_u32 s32, s32, 8192
    buffer_load_dword v0, v253, s[8:11], s32 offen
    s_add_u32 s32, s32, 8192
    buffer_load_dword v0, v253, s[8:11], s32 offen
    s_add_u32 s32, s32, 8192
    buffer_load_dword v0, v253, s[8:11], s32 offen
    s_add_u32 s32, s32, 8192
    buffer_load_dword v0, v253, s[8:11], s32 offen
    s_add_u32 s32, s32, 8192
    buffer_load_dword v0, v253, s[8:11], s32 offen
    s_add_u32 s32, s32, 8192
    buffer_load_dword v0, v253, s[8:11], s32 offen
    s_add_u32 s32, s32, 8192
    buffer_load_dword v0, v253, s[8:11], s32 offen
    s_add_u32 s32, s32, 8192
    buffer_load_dword v0, v253, s[8:11], s32 offen
    s_add_u32 s32, s32, 8192
    buffer_load_dword v0, v253, s[8:11], s32 offen
    s_add_u32 s32, s32, 8192
    buffer_load_dword v0, v253, s[8:11], s32 offen
    s_add_u32 s32, s32, 8192
    buffer_load_dword v0, v253, s[8:11], s32 offen
    s_add_u32 s32, s32, 8192
    buffer_load_dword v0, v253, s[8:11], s32 offen
    s_add_u32 s32, s32, 8192
    buffer_load_dword v0, v253, s[8:11], s32 offen
    s_add_u32 s32, s32, 8192
    buffer_load_dword v0, v253, s[8:11], s32 offen
    s_add_u32 s32, s32, 8192
    s_branch main_kernel_w_done
main_kernel_w_fill:
    s_lshl_b32 s32, s24, 2
    s_add_u32 s32, s32, s25
    s_lshl_b32 s33, s32, 16
    s_add_u32 s32, s33, 0x6e00000
    s_add_u32 s35, s33, 0x8c00000
    s_add_u32 s33, s33, 0x8000000
    s_lshl_b32 s34, s14, 12
    v_add_u32 v253, s34, v251
    v_mov_b32 v0, -1
    v_mov_b32 v1, -1
    v_mov_b32 v2, -1
    v_mov_b32 v3, -1
    s_mov_b32 s18, 4
main_kernel_w_fl:
    buffer_store_dwordx4 v[0:3], v253, s[4:7], s32 offen offset:0 sc1
    buffer_store_dwordx4 v[0:3], v253, s[4:7], s32 offen offset:1024 sc1
    buffer_store_dwordx4 v[0:3], v253, s[4:7], s32 offen offset:2048 sc1
    buffer_store_dwordx4 v[0:3], v253, s[4:7], s32 offen offset:3072 sc1
    s_add_u32 s32, s32, 16384
    buffer_store_dwordx4 v[0:3], v253, s[4:7], s33 offen offset:0 sc1
    buffer_store_dwordx4 v[0:3], v253, s[4:7], s33 offen offset:1024 sc1
    buffer_store_dwordx4 v[0:3], v253, s[4:7], s33 offen offset:2048 sc1
    buffer_store_dwordx4 v[0:3], v253, s[4:7], s33 offen offset:3072 sc1
    s_add_u32 s33, s33, 16384
    s_sub_u32 s18, s18, 1
    s_cmp_lg_u32 s18, 0
    s_cbranch_scc1 main_kernel_w_fl
    s_branch main_kernel_w_done
main_kernel_w_ln2:
    s_lshl_b32 s32, s24, 3
    s_mul_i32 s33, s25, 2
    s_add_u32 s32, s32, s33
    s_lshl_b32 s32, s32, 15
    s_lshl_b32 s33, s14, 13
    s_add_u32 s32, s32, s33
    s_add_u32 s21, s32, 0x6800000
    s_add_u32 s32, s32, 0x5000000
    buffer_load_dwordx4 v[0:3], v251, s[4:7], s32 offen offset:0 sc1
    buffer_load_dwordx4 v[4:7], v251, s[4:7], s32 offen offset:1024 sc1
    buffer_load_dwordx4 v[8:11], v251, s[4:7], s32 offen offset:2048 sc1
    buffer_load_dwordx4 v[12:15], v251, s[4:7], s32 offen offset:3072 sc1
    s_add_u32 s32, s32, 4096
    buffer_load_dwordx4 v[16:19], v251, s[4:7], s32 offen offset:0 sc1
    buffer_load_dwordx4 v[20:23], v251, s[4:7], s32 offen offset:1024 sc1
    buffer_load_dwordx4 v[24:27], v251, s[4:7], s32 offen offset:2048 sc1
    buffer_load_dwordx4 v[28:31], v251, s[4:7], s32 offen offset:3072 sc1
    s_add_u32 s32, s32, 28672
    buffer_load_dwordx4 v[32:35], v251, s[4:7], s32 offen offset:0 sc1
    buffer_load_dwordx4 v[36:39], v251, s[4:7], s32 offen offset:1024 sc1
    buffer_load_dwordx4 v[40:43], v251, s[4:7], s32 offen offset:2048 sc1
    buffer_load_dwordx4 v[44:47], v251, s[4:7], s32 offen offset:3072 sc1
    s_add_u32 s32, s32, 4096
    buffer_load_dwordx4 v[48:51], v251, s[4:7], s32 offen offset:0 sc1
    buffer_load_dwordx4 v[52:55], v251, s[4:7], s32 offen offset:1024 sc1
    buffer_load_dwordx4 v[56:59], v251, s[4:7], s32 offen offset:2048 sc1
    buffer_load_dwordx4 v[60:63], v251, s[4:7], s32 offen offset:3072 sc1
    s_add_u32 s32, s32, 28672
    v_and_b32 v255, 15, v250
    v_lshlrev_b32 v254, 6, v255
    v_add_u32 v254, 132096, v254
    v_lshrrev_b32 v255, 4, v250
    v_lshl_add_u32 v253, v255, 2, v254
    v_lshl_add_u32 v253, s14, 4, v253
    s_waitcnt vmcnt(8)
    v_lshlrev_b32 v128, 16, v0
    v_and_b32 v129, 0xffff0000, v0
    v_lshlrev_b32 v130, 16, v1
    v_and_b32 v131, 0xffff0000, v1
    v_lshlrev_b32 v132, 16, v2
    v_and_b32 v133, 0xffff0000, v2
    v_lshlrev_b32 v134, 16, v3
    v_and_b32 v135, 0xffff0000, v3
    v_lshlrev_b32 v136, 16, v4
    v_and_b32 v137, 0xffff0000, v4
    v_lshlrev_b32 v138, 16, v5
    v_and_b32 v139, 0xffff0000, v5
    v_lshlrev_b32 v140, 16, v6
    v_and_b32 v141, 0xffff0000, v6
    v_lshlrev_b32 v142, 16, v7
    v_and_b32 v143, 0xffff0000, v7
    v_lshlrev_b32 v144, 16, v8
    v_and_b32 v145, 0xffff0000, v8
    v_lshlrev_b32 v146, 16, v9
    v_and_b32 v147, 0xffff0000, v9
    v_lshlrev_b32 v148, 16, v10
    v_and_b32 v149, 0xffff0000, v10
    v_lshlrev_b32 v150, 16, v11
    v_and_b32 v151, 0xffff0000, v11
    v_lshlrev_b32 v152, 16, v12
    v_and_b32 v153, 0xffff0000, v12
    v_lshlrev_b32 v154, 16, v13
    v_and_b32 v155, 0xffff0000, v13
    v_lshlrev_b32 v156, 16, v14
    v_and_b32 v157, 0xffff0000, v14
    v_lshlrev_b32 v158, 16, v15
    v_and_b32 v159, 0xffff0000, v15
    v_lshlrev_b32 v160, 16, v16
    v_and_b32 v161, 0xffff0000, v16
    v_lshlrev_b32 v162, 16, v17
    v_and_b32 v163, 0xffff0000, v17
    v_lshlrev_b32 v164, 16, v18
    v_and_b32 v165, 0xffff0000, v18
    v_lshlrev_b32 v166, 16, v19
    v_and_b32 v167, 0xffff0000, v19
    v_lshlrev_b32 v168, 16, v20
    v_and_b32 v169, 0xffff0000, v20
    v_lshlrev_b32 v170, 16, v21
    v_and_b32 v171, 0xffff0000, v21
    v_lshlrev_b32 v172, 16, v22
    v_and_b32 v173, 0xffff0000, v22
    v_lshlrev_b32 v174, 16, v23
    v_and_b32 v175, 0xffff0000, v23
    v_lshlrev_b32 v176, 16, v24
    v_and_b32 v177, 0xffff0000, v24
    v_lshlrev_b32 v178, 16, v25
    v_and_b32 v179, 0xffff0000, v25
    v_lshlrev_b32 v180, 16, v26
    v_and_b32 v181, 0xffff0000, v26
    v_lshlrev_b32 v182, 16, v27
    v_and_b32 v183, 0xffff0000, v27
    v_lshlrev_b32 v184, 16, v28
    v_and_b32 v185, 0xffff0000, v28
    v_lshlrev_b32 v186, 16, v29
    v_and_b32 v187, 0xffff0000, v29
    v_lshlrev_b32 v188, 16, v30
    v_and_b32 v189, 0xffff0000, v30
    v_lshlrev_b32 v190, 16, v31
    v_and_b32 v191, 0xffff0000, v31
    v_pk_add_f32 v[192:193], v[128:129], v[136:137]
    v_pk_add_f32 v[194:195], v[130:131], v[138:139]
    v_pk_add_f32 v[196:197], v[132:133], v[140:141]
    v_pk_add_f32 v[198:199], v[134:135], v[142:143]
    v_pk_add_f32 v[192:193], v[192:193], v[144:145]
    v_pk_add_f32 v[194:195], v[194:195], v[146:147]
    v_pk_add_f32 v[196:197], v[196:197], v[148:149]
    v_pk_add_f32 v[198:199], v[198:199], v[150:151]
    v_pk_add_f32 v[192:193], v[192:193], v[152:153]
    v_pk_add_f32 v[194:195], v[194:195], v[154:155]
    v_pk_add_f32 v[196:197], v[196:197], v[156:157]
    v_pk_add_f32 v[198:199], v[198:199], v[158:159]
    v_pk_add_f32 v[192:193], v[192:193], v[160:161]
    v_pk_add_f32 v[194:195], v[194:195], v[162:163]
    v_pk_add_f32 v[196:197], v[196:197], v[164:165]
    v_pk_add_f32 v[198:199], v[198:199], v[166:167]
    v_pk_add_f32 v[192:193], v[192:193], v[168:169]
    v_pk_add_f32 v[194:195], v[194:195], v[170:171]
    v_pk_add_f32 v[196:197], v[196:197], v[172:173]
    v_pk_add_f32 v[198:199], v[198:199], v[174:175]
    v_pk_add_f32 v[192:193], v[192:193], v[176:177]
    v_pk_add_f32 v[194:195], v[194:195], v[178:179]
    v_pk_add_f32 v[196:197], v[196:197], v[180:181]
    v_pk_add_f32 v[198:199], v[198:199], v[182:183]
    v_pk_add_f32 v[192:193], v[192:193], v[184:185]
    v_pk_add_f32 v[194:195], v[194:195], v[186:187]
    v_pk_add_f32 v[196:197], v[196:197], v[188:189]
    v_pk_add_f32 v[198:199], v[198:199], v[190:191]
    v_pk_add_f32 v[192:193], v[192:193], v[194:195]
    v_pk_add_f32 v[196:197], v[196:197], v[198:199]
    v_pk_add_f32 v[192:193], v[192:193], v[196:197]
    v_add_f32 v192, v192, v193
    ds_write_b32 v253, v192 offset:0
    s_waitcnt lgkmcnt(0)
    s_barrier
    ds_read_b128 v[192:195], v254 offset:0
    ds_read_b128 v[196:199], v254 offset:16
    ds_read_b128 v[200:203], v254 offset:32
    ds_read_b128 v[204:207], v254 offset:48
    s_waitcnt lgkmcnt(2)
    v_pk_add_f32 v[192:193], v[192:193], v[194:195]
    v_pk_add_f32 v[196:197], v[196:197], v[198:199]
    s_waitcnt lgkmcnt(0)
    v_pk_add_f32 v[200:201], v[200:201], v[202:203]
    v_pk_add_f32 v[204:205], v[204:205], v[206:207]
    v_pk_add_f32 v[192:193], v[192:193], v[196:197]
    v_pk_add_f32 v[200:201], v[200:201], v[204:205]
    v_pk_add_f32 v[192:193], v[192:193], v[200:201]
    v_add_f32 v192, v192, v193
    v_mul_f32 v192, 0xba800000, v192
    v_mov_b32 v193, v192
    v_pk_add_f32 v[128:129], v[128:129], v[192:193]
    v_pk_add_f32 v[130:131], v[130:131], v[192:193]
    v_pk_add_f32 v[132:133], v[132:133], v[192:193]
    v_pk_add_f32 v[134:135], v[134:135], v[192:193]
    v_pk_add_f32 v[136:137], v[136:137], v[192:193]
    v_pk_add_f32 v[138:139], v[138:139], v[192:193]
    v_pk_add_f32 v[140:141], v[140:141], v[192:193]
    v_pk_add_f32 v[142:143], v[142:143], v[192:193]
    v_pk_add_f32 v[144:145], v[144:145], v[192:193]
    v_pk_add_f32 v[146:147], v[146:147], v[192:193]
    v_pk_add_f32 v[148:149], v[148:149], v[192:193]
    v_pk_add_f32 v[150:151], v[150:151], v[192:193]
    v_pk_add_f32 v[152:153], v[152:153], v[192:193]
    v_pk_add_f32 v[154:155], v[154:155], v[192:193]
    v_pk_add_f32 v[156:157], v[156:157], v[192:193]
    v_pk_add_f32 v[158:159], v[158:159], v[192:193]
    v_pk_add_f32 v[160:161], v[160:161], v[192:193]
    v_pk_add_f32 v[162:163], v[162:163], v[192:193]
    v_pk_add_f32 v[164:165], v[164:165], v[192:193]
    v_pk_add_f32 v[166:167], v[166:167], v[192:193]
    v_pk_add_f32 v[168:169], v[168:169], v[192:193]
    v_pk_add_f32 v[170:171], v[170:171], v[192:193]
    v_pk_add_f32 v[172:173], v[172:173], v[192:193]
    v_pk_add_f32 v[174:175], v[174:175], v[192:193]
    v_pk_add_f32 v[176:177], v[176:177], v[192:193]
    v_pk_add_f32 v[178:179], v[178:179], v[192:193]
    v_pk_add_f32 v[180:181], v[180:181], v[192:193]
    v_pk_add_f32 v[182:183], v[182:183], v[192:193]
    v_pk_add_f32 v[184:185], v[184:185], v[192:193]
    v_pk_add_f32 v[186:187], v[186:187], v[192:193]
    v_pk_add_f32 v[188:189], v[188:189], v[192:193]
    v_pk_add_f32 v[190:191], v[190:191], v[192:193]
    v_pk_mul_f32 v[192:193], v[128:129], v[128:129]
    v_pk_mul_f32 v[194:195], v[130:131], v[130:131]
    v_pk_mul_f32 v[196:197], v[132:133], v[132:133]
    v_pk_mul_f32 v[198:199], v[134:135], v[134:135]
    v_pk_fma_f32 v[192:193], v[136:137], v[136:137], v[192:193]
    v_pk_fma_f32 v[194:195], v[138:139], v[138:139], v[194:195]
    v_pk_fma_f32 v[196:197], v[140:141], v[140:141], v[196:197]
    v_pk_fma_f32 v[198:199], v[142:143], v[142:143], v[198:199]
    v_pk_fma_f32 v[192:193], v[144:145], v[144:145], v[192:193]
    v_pk_fma_f32 v[194:195], v[146:147], v[146:147], v[194:195]
    v_pk_fma_f32 v[196:197], v[148:149], v[148:149], v[196:197]
    v_pk_fma_f32 v[198:199], v[150:151], v[150:151], v[198:199]
    v_pk_fma_f32 v[192:193], v[152:153], v[152:153], v[192:193]
    v_pk_fma_f32 v[194:195], v[154:155], v[154:155], v[194:195]
    v_pk_fma_f32 v[196:197], v[156:157], v[156:157], v[196:197]
    v_pk_fma_f32 v[198:199], v[158:159], v[158:159], v[198:199]
    v_pk_fma_f32 v[192:193], v[160:161], v[160:161], v[192:193]
    v_pk_fma_f32 v[194:195], v[162:163], v[162:163], v[194:195]
    v_pk_fma_f32 v[196:197], v[164:165], v[164:165], v[196:197]
    v_pk_fma_f32 v[198:199], v[166:167], v[166:167], v[198:199]
    v_pk_fma_f32 v[192:193], v[168:169], v[168:169], v[192:193]
    v_pk_fma_f32 v[194:195], v[170:171], v[170:171], v[194:195]
    v_pk_fma_f32 v[196:197], v[172:173], v[172:173], v[196:197]
    v_pk_fma_f32 v[198:199], v[174:175], v[174:175], v[198:199]
    v_pk_fma_f32 v[192:193], v[176:177], v[176:177], v[192:193]
    v_pk_fma_f32 v[194:195], v[178:179], v[178:179], v[194:195]
    v_pk_fma_f32 v[196:197], v[180:181], v[180:181], v[196:197]
    v_pk_fma_f32 v[198:199], v[182:183], v[182:183], v[198:199]
    v_pk_fma_f32 v[192:193], v[184:185], v[184:185], v[192:193]
    v_pk_fma_f32 v[194:195], v[186:187], v[186:187], v[194:195]
    v_pk_fma_f32 v[196:197], v[188:189], v[188:189], v[196:197]
    v_pk_fma_f32 v[198:199], v[190:191], v[190:191], v[198:199]
    v_pk_add_f32 v[192:193], v[192:193], v[194:195]
    v_pk_add_f32 v[196:197], v[196:197], v[198:199]
    v_pk_add_f32 v[192:193], v[192:193], v[196:197]
    v_add_f32 v192, v192, v193
    ds_write_b32 v253, v192 offset:1024
    s_waitcnt lgkmcnt(0)
    s_barrier
    ds_read_b128 v[192:195], v254 offset:1024
    ds_read_b128 v[196:199], v254 offset:1040
    ds_read_b128 v[200:203], v254 offset:1056
    ds_read_b128 v[204:207], v254 offset:1072
    s_waitcnt lgkmcnt(2)
    v_pk_add_f32 v[192:193], v[192:193], v[194:195]
    v_pk_add_f32 v[196:197], v[196:197], v[198:199]
    s_waitcnt lgkmcnt(0)
    v_pk_add_f32 v[200:201], v[200:201], v[202:203]
    v_pk_add_f32 v[204:205], v[204:205], v[206:207]
    v_pk_add_f32 v[192:193], v[192:193], v[196:197]
    v_pk_add_f32 v[200:201], v[200:201], v[204:205]
    v_pk_add_f32 v[192:193], v[192:193], v[200:201]
    v_add_f32 v192, v192, v193
    v_mov_b32 v193, 0x3727c5ac
    v_fmac_f32 v193, 0x3a800000, v192
    v_rsq_f32 v192, v193
    s_nop 0
    v_mov_b32 v193, v192
    v_pk_mul_f32 v[128:129], v[128:129], v[192:193]
    v_pk_mul_f32 v[130:131], v[130:131], v[192:193]
    v_pk_mul_f32 v[132:133], v[132:133], v[192:193]
    v_pk_mul_f32 v[134:135], v[134:135], v[192:193]
    v_pk_mul_f32 v[136:137], v[136:137], v[192:193]
    v_pk_mul_f32 v[138:139], v[138:139], v[192:193]
    v_pk_mul_f32 v[140:141], v[140:141], v[192:193]
    v_pk_mul_f32 v[142:143], v[142:143], v[192:193]
    v_pk_mul_f32 v[144:145], v[144:145], v[192:193]
    v_pk_mul_f32 v[146:147], v[146:147], v[192:193]
    v_pk_mul_f32 v[148:149], v[148:149], v[192:193]
    v_pk_mul_f32 v[150:151], v[150:151], v[192:193]
    v_pk_mul_f32 v[152:153], v[152:153], v[192:193]
    v_pk_mul_f32 v[154:155], v[154:155], v[192:193]
    v_pk_mul_f32 v[156:157], v[156:157], v[192:193]
    v_pk_mul_f32 v[158:159], v[158:159], v[192:193]
    v_pk_mul_f32 v[160:161], v[160:161], v[192:193]
    v_pk_mul_f32 v[162:163], v[162:163], v[192:193]
    v_pk_mul_f32 v[164:165], v[164:165], v[192:193]
    v_pk_mul_f32 v[166:167], v[166:167], v[192:193]
    v_pk_mul_f32 v[168:169], v[168:169], v[192:193]
    v_pk_mul_f32 v[170:171], v[170:171], v[192:193]
    v_pk_mul_f32 v[172:173], v[172:173], v[192:193]
    v_pk_mul_f32 v[174:175], v[174:175], v[192:193]
    v_pk_mul_f32 v[176:177], v[176:177], v[192:193]
    v_pk_mul_f32 v[178:179], v[178:179], v[192:193]
    v_pk_mul_f32 v[180:181], v[180:181], v[192:193]
    v_pk_mul_f32 v[182:183], v[182:183], v[192:193]
    v_pk_mul_f32 v[184:185], v[184:185], v[192:193]
    v_pk_mul_f32 v[186:187], v[186:187], v[192:193]
    v_pk_mul_f32 v[188:189], v[188:189], v[192:193]
    v_pk_mul_f32 v[190:191], v[190:191], v[192:193]
    v_cvt_pk_bf16_f32 v0, v128, v129
    v_cvt_pk_bf16_f32 v1, v130, v131
    v_cvt_pk_bf16_f32 v2, v132, v133
    v_cvt_pk_bf16_f32 v3, v134, v135
    v_cvt_pk_bf16_f32 v4, v136, v137
    v_cvt_pk_bf16_f32 v5, v138, v139
    v_cvt_pk_bf16_f32 v6, v140, v141
    v_cvt_pk_bf16_f32 v7, v142, v143
    v_cvt_pk_bf16_f32 v8, v144, v145
    v_cvt_pk_bf16_f32 v9, v146, v147
    v_cvt_pk_bf16_f32 v10, v148, v149
    v_cvt_pk_bf16_f32 v11, v150, v151
    v_cvt_pk_bf16_f32 v12, v152, v153
    v_cvt_pk_bf16_f32 v13, v154, v155
    v_cvt_pk_bf16_f32 v14, v156, v157
    v_cvt_pk_bf16_f32 v15, v158, v159
    v_cvt_pk_bf16_f32 v16, v160, v161
    v_cvt_pk_bf16_f32 v17, v162, v163
    v_cvt_pk_bf16_f32 v18, v164, v165
    v_cvt_pk_bf16_f32 v19, v166, v167
    v_cvt_pk_bf16_f32 v20, v168, v169
    v_cvt_pk_bf16_f32 v21, v170, v171
    v_cvt_pk_bf16_f32 v22, v172, v173
    v_cvt_pk_bf16_f32 v23, v174, v175
    v_cvt_pk_bf16_f32 v24, v176, v177
    v_cvt_pk_bf16_f32 v25, v178, v179
    v_cvt_pk_bf16_f32 v26, v180, v181
    v_cvt_pk_bf16_f32 v27, v182, v183
    v_cvt_pk_bf16_f32 v28, v184, v185
    v_cvt_pk_bf16_f32 v29, v186, v187
    v_cvt_pk_bf16_f32 v30, v188, v189
    v_cvt_pk_bf16_f32 v31, v190, v191
    buffer_store_dwordx4 v[0:3], v251, s[4:7], s21 offen offset:0 sc1
    buffer_store_dwordx4 v[4:7], v251, s[4:7], s21 offen offset:1024 sc1
    buffer_store_dwordx4 v[8:11], v251, s[4:7], s21 offen offset:2048 sc1
    buffer_store_dwordx4 v[12:15], v251, s[4:7], s21 offen offset:3072 sc1
    s_add_u32 s21, s21, 4096
    buffer_store_dwordx4 v[16:19], v251, s[4:7], s21 offen offset:0 sc1
    buffer_store_dwordx4 v[20:23], v251, s[4:7], s21 offen offset:1024 sc1
    buffer_store_dwordx4 v[24:27], v251, s[4:7], s21 offen offset:2048 sc1
    buffer_store_dwordx4 v[28:31], v251, s[4:7], s21 offen offset:3072 sc1
    s_add_u32 s21, s21, 28672
    s_waitcnt vmcnt(8)
    v_lshlrev_b32 v128, 16, v32
    v_and_b32 v129, 0xffff0000, v32
    v_lshlrev_b32 v130, 16, v33
    v_and_b32 v131, 0xffff0000, v33
    v_lshlrev_b32 v132, 16, v34
    v_and_b32 v133, 0xffff0000, v34
    v_lshlrev_b32 v134, 16, v35
    v_and_b32 v135, 0xffff0000, v35
    v_lshlrev_b32 v136, 16, v36
    v_and_b32 v137, 0xffff0000, v36
    v_lshlrev_b32 v138, 16, v37
    v_and_b32 v139, 0xffff0000, v37
    v_lshlrev_b32 v140, 16, v38
    v_and_b32 v141, 0xffff0000, v38
    v_lshlrev_b32 v142, 16, v39
    v_and_b32 v143, 0xffff0000, v39
    v_lshlrev_b32 v144, 16, v40
    v_and_b32 v145, 0xffff0000, v40
    v_lshlrev_b32 v146, 16, v41
    v_and_b32 v147, 0xffff0000, v41
    v_lshlrev_b32 v148, 16, v42
    v_and_b32 v149, 0xffff0000, v42
    v_lshlrev_b32 v150, 16, v43
    v_and_b32 v151, 0xffff0000, v43
    v_lshlrev_b32 v152, 16, v44
    v_and_b32 v153, 0xffff0000, v44
    v_lshlrev_b32 v154, 16, v45
    v_and_b32 v155, 0xffff0000, v45
    v_lshlrev_b32 v156, 16, v46
    v_and_b32 v157, 0xffff0000, v46
    v_lshlrev_b32 v158, 16, v47
    v_and_b32 v159, 0xffff0000, v47
    v_lshlrev_b32 v160, 16, v48
    v_and_b32 v161, 0xffff0000, v48
    v_lshlrev_b32 v162, 16, v49
    v_and_b32 v163, 0xffff0000, v49
    v_lshlrev_b32 v164, 16, v50
    v_and_b32 v165, 0xffff0000, v50
    v_lshlrev_b32 v166, 16, v51
    v_and_b32 v167, 0xffff0000, v51
    v_lshlrev_b32 v168, 16, v52
    v_and_b32 v169, 0xffff0000, v52
    v_lshlrev_b32 v170, 16, v53
    v_and_b32 v171, 0xffff0000, v53
    v_lshlrev_b32 v172, 16, v54
    v_and_b32 v173, 0xffff0000, v54
    v_lshlrev_b32 v174, 16, v55
    v_and_b32 v175, 0xffff0000, v55
    v_lshlrev_b32 v176, 16, v56
    v_and_b32 v177, 0xffff0000, v56
    v_lshlrev_b32 v178, 16, v57
    v_and_b32 v179, 0xffff0000, v57
    v_lshlrev_b32 v180, 16, v58
    v_and_b32 v181, 0xffff0000, v58
    v_lshlrev_b32 v182, 16, v59
    v_and_b32 v183, 0xffff0000, v59
    v_lshlrev_b32 v184, 16, v60
    v_and_b32 v185, 0xffff0000, v60
    v_lshlrev_b32 v186, 16, v61
    v_and_b32 v187, 0xffff0000, v61
    v_lshlrev_b32 v188, 16, v62
    v_and_b32 v189, 0xffff0000, v62
    v_lshlrev_b32 v190, 16, v63
    v_and_b32 v191, 0xffff0000, v63
    v_pk_add_f32 v[192:193], v[128:129], v[136:137]
    v_pk_add_f32 v[194:195], v[130:131], v[138:139]
    v_pk_add_f32 v[196:197], v[132:133], v[140:141]
    v_pk_add_f32 v[198:199], v[134:135], v[142:143]
    v_pk_add_f32 v[192:193], v[192:193], v[144:145]
    v_pk_add_f32 v[194:195], v[194:195], v[146:147]
    v_pk_add_f32 v[196:197], v[196:197], v[148:149]
    v_pk_add_f32 v[198:199], v[198:199], v[150:151]
    v_pk_add_f32 v[192:193], v[192:193], v[152:153]
    v_pk_add_f32 v[194:195], v[194:195], v[154:155]
    v_pk_add_f32 v[196:197], v[196:197], v[156:157]
    v_pk_add_f32 v[198:199], v[198:199], v[158:159]
    v_pk_add_f32 v[192:193], v[192:193], v[160:161]
    v_pk_add_f32 v[194:195], v[194:195], v[162:163]
    v_pk_add_f32 v[196:197], v[196:197], v[164:165]
    v_pk_add_f32 v[198:199], v[198:199], v[166:167]
    v_pk_add_f32 v[192:193], v[192:193], v[168:169]
    v_pk_add_f32 v[194:195], v[194:195], v[170:171]
    v_pk_add_f32 v[196:197], v[196:197], v[172:173]
    v_pk_add_f32 v[198:199], v[198:199], v[174:175]
    v_pk_add_f32 v[192:193], v[192:193], v[176:177]
    v_pk_add_f32 v[194:195], v[194:195], v[178:179]
    v_pk_add_f32 v[196:197], v[196:197], v[180:181]
    v_pk_add_f32 v[198:199], v[198:199], v[182:183]
    v_pk_add_f32 v[192:193], v[192:193], v[184:185]
    v_pk_add_f32 v[194:195], v[194:195], v[186:187]
    v_pk_add_f32 v[196:197], v[196:197], v[188:189]
    v_pk_add_f32 v[198:199], v[198:199], v[190:191]
    v_pk_add_f32 v[192:193], v[192:193], v[194:195]
    v_pk_add_f32 v[196:197], v[196:197], v[198:199]
    v_pk_add_f32 v[192:193], v[192:193], v[196:197]
    v_add_f32 v192, v192, v193
    ds_write_b32 v253, v192 offset:0
    s_waitcnt lgkmcnt(0)
    s_barrier
    ds_read_b128 v[192:195], v254 offset:0
    ds_read_b128 v[196:199], v254 offset:16
    ds_read_b128 v[200:203], v254 offset:32
    ds_read_b128 v[204:207], v254 offset:48
    s_waitcnt lgkmcnt(2)
    v_pk_add_f32 v[192:193], v[192:193], v[194:195]
    v_pk_add_f32 v[196:197], v[196:197], v[198:199]
    s_waitcnt lgkmcnt(0)
    v_pk_add_f32 v[200:201], v[200:201], v[202:203]
    v_pk_add_f32 v[204:205], v[204:205], v[206:207]
    v_pk_add_f32 v[192:193], v[192:193], v[196:197]
    v_pk_add_f32 v[200:201], v[200:201], v[204:205]
    v_pk_add_f32 v[192:193], v[192:193], v[200:201]
    v_add_f32 v192, v192, v193
    v_mul_f32 v192, 0xba800000, v192
    v_mov_b32 v193, v192
    v_pk_add_f32 v[128:129], v[128:129], v[192:193]
    v_pk_add_f32 v[130:131], v[130:131], v[192:193]
    v_pk_add_f32 v[132:133], v[132:133], v[192:193]
    v_pk_add_f32 v[134:135], v[134:135], v[192:193]
    v_pk_add_f32 v[136:137], v[136:137], v[192:193]
    v_pk_add_f32 v[138:139], v[138:139], v[192:193]
    v_pk_add_f32 v[140:141], v[140:141], v[192:193]
    v_pk_add_f32 v[142:143], v[142:143], v[192:193]
    v_pk_add_f32 v[144:145], v[144:145], v[192:193]
    v_pk_add_f32 v[146:147], v[146:147], v[192:193]
    v_pk_add_f32 v[148:149], v[148:149], v[192:193]
    v_pk_add_f32 v[150:151], v[150:151], v[192:193]
    v_pk_add_f32 v[152:153], v[152:153], v[192:193]
    v_pk_add_f32 v[154:155], v[154:155], v[192:193]
    v_pk_add_f32 v[156:157], v[156:157], v[192:193]
    v_pk_add_f32 v[158:159], v[158:159], v[192:193]
    v_pk_add_f32 v[160:161], v[160:161], v[192:193]
    v_pk_add_f32 v[162:163], v[162:163], v[192:193]
    v_pk_add_f32 v[164:165], v[164:165], v[192:193]
    v_pk_add_f32 v[166:167], v[166:167], v[192:193]
    v_pk_add_f32 v[168:169], v[168:169], v[192:193]
    v_pk_add_f32 v[170:171], v[170:171], v[192:193]
    v_pk_add_f32 v[172:173], v[172:173], v[192:193]
    v_pk_add_f32 v[174:175], v[174:175], v[192:193]
    v_pk_add_f32 v[176:177], v[176:177], v[192:193]
    v_pk_add_f32 v[178:179], v[178:179], v[192:193]
    v_pk_add_f32 v[180:181], v[180:181], v[192:193]
    v_pk_add_f32 v[182:183], v[182:183], v[192:193]
    v_pk_add_f32 v[184:185], v[184:185], v[192:193]
    v_pk_add_f32 v[186:187], v[186:187], v[192:193]
    v_pk_add_f32 v[188:189], v[188:189], v[192:193]
    v_pk_add_f32 v[190:191], v[190:191], v[192:193]
    v_pk_mul_f32 v[192:193], v[128:129], v[128:129]
    v_pk_mul_f32 v[194:195], v[130:131], v[130:131]
    v_pk_mul_f32 v[196:197], v[132:133], v[132:133]
    v_pk_mul_f32 v[198:199], v[134:135], v[134:135]
    v_pk_fma_f32 v[192:193], v[136:137], v[136:137], v[192:193]
    v_pk_fma_f32 v[194:195], v[138:139], v[138:139], v[194:195]
    v_pk_fma_f32 v[196:197], v[140:141], v[140:141], v[196:197]
    v_pk_fma_f32 v[198:199], v[142:143], v[142:143], v[198:199]
    v_pk_fma_f32 v[192:193], v[144:145], v[144:145], v[192:193]
    v_pk_fma_f32 v[194:195], v[146:147], v[146:147], v[194:195]
    v_pk_fma_f32 v[196:197], v[148:149], v[148:149], v[196:197]
    v_pk_fma_f32 v[198:199], v[150:151], v[150:151], v[198:199]
    v_pk_fma_f32 v[192:193], v[152:153], v[152:153], v[192:193]
    v_pk_fma_f32 v[194:195], v[154:155], v[154:155], v[194:195]
    v_pk_fma_f32 v[196:197], v[156:157], v[156:157], v[196:197]
    v_pk_fma_f32 v[198:199], v[158:159], v[158:159], v[198:199]
    v_pk_fma_f32 v[192:193], v[160:161], v[160:161], v[192:193]
    v_pk_fma_f32 v[194:195], v[162:163], v[162:163], v[194:195]
    v_pk_fma_f32 v[196:197], v[164:165], v[164:165], v[196:197]
    v_pk_fma_f32 v[198:199], v[166:167], v[166:167], v[198:199]
    v_pk_fma_f32 v[192:193], v[168:169], v[168:169], v[192:193]
    v_pk_fma_f32 v[194:195], v[170:171], v[170:171], v[194:195]
    v_pk_fma_f32 v[196:197], v[172:173], v[172:173], v[196:197]
    v_pk_fma_f32 v[198:199], v[174:175], v[174:175], v[198:199]
    v_pk_fma_f32 v[192:193], v[176:177], v[176:177], v[192:193]
    v_pk_fma_f32 v[194:195], v[178:179], v[178:179], v[194:195]
    v_pk_fma_f32 v[196:197], v[180:181], v[180:181], v[196:197]
    v_pk_fma_f32 v[198:199], v[182:183], v[182:183], v[198:199]
    v_pk_fma_f32 v[192:193], v[184:185], v[184:185], v[192:193]
    v_pk_fma_f32 v[194:195], v[186:187], v[186:187], v[194:195]
    v_pk_fma_f32 v[196:197], v[188:189], v[188:189], v[196:197]
    v_pk_fma_f32 v[198:199], v[190:191], v[190:191], v[198:199]
    v_pk_add_f32 v[192:193], v[192:193], v[194:195]
    v_pk_add_f32 v[196:197], v[196:197], v[198:199]
    v_pk_add_f32 v[192:193], v[192:193], v[196:197]
    v_add_f32 v192, v192, v193
    ds_write_b32 v253, v192 offset:1024
    s_waitcnt lgkmcnt(0)
    s_barrier
    ds_read_b128 v[192:195], v254 offset:1024
    ds_read_b128 v[196:199], v254 offset:1040
    ds_read_b128 v[200:203], v254 offset:1056
    ds_read_b128 v[204:207], v254 offset:1072
    s_waitcnt lgkmcnt(2)
    v_pk_add_f32 v[192:193], v[192:193], v[194:195]
    v_pk_add_f32 v[196:197], v[196:197], v[198:199]
    s_waitcnt lgkmcnt(0)
    v_pk_add_f32 v[200:201], v[200:201], v[202:203]
    v_pk_add_f32 v[204:205], v[204:205], v[206:207]
    v_pk_add_f32 v[192:193], v[192:193], v[196:197]
    v_pk_add_f32 v[200:201], v[200:201], v[204:205]
    v_pk_add_f32 v[192:193], v[192:193], v[200:201]
    v_add_f32 v192, v192, v193
    v_mov_b32 v193, 0x3727c5ac
    v_fmac_f32 v193, 0x3a800000, v192
    v_rsq_f32 v192, v193
    s_nop 0
    v_mov_b32 v193, v192
    v_pk_mul_f32 v[128:129], v[128:129], v[192:193]
    v_pk_mul_f32 v[130:131], v[130:131], v[192:193]
    v_pk_mul_f32 v[132:133], v[132:133], v[192:193]
    v_pk_mul_f32 v[134:135], v[134:135], v[192:193]
    v_pk_mul_f32 v[136:137], v[136:137], v[192:193]
    v_pk_mul_f32 v[138:139], v[138:139], v[192:193]
    v_pk_mul_f32 v[140:141], v[140:141], v[192:193]
    v_pk_mul_f32 v[142:143], v[142:143], v[192:193]
    v_pk_mul_f32 v[144:145], v[144:145], v[192:193]
    v_pk_mul_f32 v[146:147], v[146:147], v[192:193]
    v_pk_mul_f32 v[148:149], v[148:149], v[192:193]
    v_pk_mul_f32 v[150:151], v[150:151], v[192:193]
    v_pk_mul_f32 v[152:153], v[152:153], v[192:193]
    v_pk_mul_f32 v[154:155], v[154:155], v[192:193]
    v_pk_mul_f32 v[156:157], v[156:157], v[192:193]
    v_pk_mul_f32 v[158:159], v[158:159], v[192:193]
    v_pk_mul_f32 v[160:161], v[160:161], v[192:193]
    v_pk_mul_f32 v[162:163], v[162:163], v[192:193]
    v_pk_mul_f32 v[164:165], v[164:165], v[192:193]
    v_pk_mul_f32 v[166:167], v[166:167], v[192:193]
    v_pk_mul_f32 v[168:169], v[168:169], v[192:193]
    v_pk_mul_f32 v[170:171], v[170:171], v[192:193]
    v_pk_mul_f32 v[172:173], v[172:173], v[192:193]
    v_pk_mul_f32 v[174:175], v[174:175], v[192:193]
    v_pk_mul_f32 v[176:177], v[176:177], v[192:193]
    v_pk_mul_f32 v[178:179], v[178:179], v[192:193]
    v_pk_mul_f32 v[180:181], v[180:181], v[192:193]
    v_pk_mul_f32 v[182:183], v[182:183], v[192:193]
    v_pk_mul_f32 v[184:185], v[184:185], v[192:193]
    v_pk_mul_f32 v[186:187], v[186:187], v[192:193]
    v_pk_mul_f32 v[188:189], v[188:189], v[192:193]
    v_pk_mul_f32 v[190:191], v[190:191], v[192:193]
    v_cvt_pk_bf16_f32 v32, v128, v129
    v_cvt_pk_bf16_f32 v33, v130, v131
    v_cvt_pk_bf16_f32 v34, v132, v133
    v_cvt_pk_bf16_f32 v35, v134, v135
    v_cvt_pk_bf16_f32 v36, v136, v137
    v_cvt_pk_bf16_f32 v37, v138, v139
    v_cvt_pk_bf16_f32 v38, v140, v141
    v_cvt_pk_bf16_f32 v39, v142, v143
    v_cvt_pk_bf16_f32 v40, v144, v145
    v_cvt_pk_bf16_f32 v41, v146, v147
    v_cvt_pk_bf16_f32 v42, v148, v149
    v_cvt_pk_bf16_f32 v43, v150, v151
    v_cvt_pk_bf16_f32 v44, v152, v153
    v_cvt_pk_bf16_f32 v45, v154, v155
    v_cvt_pk_bf16_f32 v46, v156, v157
    v_cvt_pk_bf16_f32 v47, v158, v159
    v_cvt_pk_bf16_f32 v48, v160, v161
    v_cvt_pk_bf16_f32 v49, v162, v163
    v_cvt_pk_bf16_f32 v50, v164, v165
    v_cvt_pk_bf16_f32 v51, v166, v167
    v_cvt_pk_bf16_f32 v52, v168, v169
    v_cvt_pk_bf16_f32 v53, v170, v171
    v_cvt_pk_bf16_f32 v54, v172, v173
    v_cvt_pk_bf16_f32 v55, v174, v175
    v_cvt_pk_bf16_f32 v56, v176, v177
    v_cvt_pk_bf16_f32 v57, v178, v179
    v_cvt_pk_bf16_f32 v58, v180, v181
    v_cvt_pk_bf16_f32 v59, v182, v183
    v_cvt_pk_bf16_f32 v60, v184, v185
    v_cvt_pk_bf16_f32 v61, v186, v187
    v_cvt_pk_bf16_f32 v62, v188, v189
    v_cvt_pk_bf16_f32 v63, v190, v191
    buffer_store_dwordx4 v[32:35], v251, s[4:7], s21 offen offset:0 sc1
    buffer_store_dwordx4 v[36:39], v251, s[4:7], s21 offen offset:1024 sc1
    buffer_store_dwordx4 v[40:43], v251, s[4:7], s21 offen offset:2048 sc1
    buffer_store_dwordx4 v[44:47], v251, s[4:7], s21 offen offset:3072 sc1
    s_add_u32 s21, s21, 4096
    buffer_store_dwordx4 v[48:51], v251, s[4:7], s21 offen offset:0 sc1
    buffer_store_dwordx4 v[52:55], v251, s[4:7], s21 offen offset:1024 sc1
    buffer_store_dwordx4 v[56:59], v251, s[4:7], s21 offen offset:2048 sc1
    buffer_store_dwordx4 v[60:63], v251, s[4:7], s21 offen offset:3072 sc1
    s_add_u32 s21, s21, 28672
    s_mov_b32 s54, 0
main_kernel_w_done:
    s_cmp_eq_u32 s14, 0
    s_cbranch_scc1 main_kernel_w_dw0
    s_waitcnt vmcnt(0)
    s_barrier
    s_branch main_kernel_w_bar
main_kernel_w_dw0:
    s_add_u32 s32, s23, 1
    s_bitcmp0_b32 s32, 2
    s_cselect_b32 s34, 4, 9
    s_cselect_b32 s35, 8, 4
    s_lshl_b32 s32, s23, 13
    s_add_u32 s56, s32, 0x8404000
    v_lshrrev_b32 v253, 1, v250
    v_add_u32 v253, s24, v253
    v_lshlrev_b32 v253, s34, v253
    v_and_b32 v254, 1, v250
    v_add_u32 v254, s25, v254
    v_lshlrev_b32 v254, s35, v254
    v_add_u32 v249, v254, v253
    s_lshl_b32 s57, 1, s54
    s_mov_b32 s28, s55
    s_cmp_eq_u32 s55, -1
    s_cbranch_scc0 main_kernel_w_have
    s_branch main_kernel_w_try
.section .rodata,"a"
.p2align 6
.amdhsa_kernel main_kernel
  .amdhsa_next_free_vgpr 512
  .amdhsa_next_free_sgpr 102
  .amdhsa_accum_offset 256
  .amdhsa_group_segment_fixed_size 0
  .amdhsa_kernarg_size 120
  .amdhsa_user_sgpr_count 2
  .amdhsa_user_sgpr_kernarg_segment_ptr 1
  .amdhsa_system_sgpr_workgroup_id_x 1
.end_amdhsa_kernel
```

```asm
; @launch kernel=main_kernel grid=(256,1,1) block=(256,1,1) lds=163840
.amdgcn_target "amdgcn-amd-amdhsa--gfx950"
.text
.text
.globl main_kernel
.p2align 8
.type main_kernel,@function
main_kernel:
    s_load_dwordx4 s[20:23], s[0:1], 104
    s_load_dwordx8 s[40:47], s[0:1], 16
    s_load_dwordx8 s[64:71], s[0:1], 64
    s_load_dwordx2 s[72:73], s[0:1], 0
    s_load_dwordx2 s[74:75], s[0:1], 96
    s_load_dwordx2 s[76:77], s[0:1], 8
    s_cmp_ge_u32 s2, 256
    s_cbranch_scc1 main_kernel_end
    v_lshrrev_b32 v126, 6, v0
    v_and_b32 v94, 63, v0
    v_and_b32 v250, 63, v0
    v_readfirstlane_b32 s14, v126
    s_mov_b32 s29, 0x80000
    s_waitcnt lgkmcnt(0)
    s_mov_b32 s60, s20
    s_and_b32 s61, s21, 0xffff
    s_mov_b32 s62, 0x100
    s_mov_b32 s63, 0x20000
    s_mov_b32 s4, s22
    s_and_b32 s5, s23, 0xffff
    s_mov_b32 s6, 0x10000000
    s_mov_b32 s7, 0x20000
    s_cmp_lg_u32 s14, 0
    s_cbranch_scc1 main_kernel_slot_wait
    s_getreg_b32 s12, hwreg(HW_REG_XCC_ID, 0, 4)
    s_and_b32 s12, s12, 7
    s_lshl_b32 s32, s12, 5
    v_mov_b32 v126, 0
    v_mov_b32 v127, 1
    s_mov_b64 exec, 1
    buffer_atomic_add v127, v126, s[60:63], s32 offen sc0 sc1
    s_waitcnt vmcnt(0)
    s_mov_b64 exec, -1
    v_readfirstlane_b32 s13, v127
    s_nop 3
    s_cmp_lt_u32 s13, 32
    s_cbranch_scc1 main_kernel_slot_pub
    v_and_b32 v126, 7, v94
    v_lshlrev_b32 v126, 5, v126
main_kernel_ovf_cnt:
    buffer_load_dword v127, v126, s[60:63], 0 offen sc1
    s_waitcnt vmcnt(0)
    v_readlane_b32 s48, v127, 0
    v_readlane_b32 s49, v127, 1
    v_readlane_b32 s50, v127, 2
    v_readlane_b32 s51, v127, 3
    v_readlane_b32 s52, v127, 4
    v_readlane_b32 s53, v127, 5
    v_readlane_b32 s54, v127, 6
    v_readlane_b32 s55, v127, 7
    s_nop 3
    s_add_u32 s33, s48, s49
    s_add_u32 s33, s33, s50
    s_add_u32 s33, s33, s51
    s_add_u32 s33, s33, s52
    s_add_u32 s33, s33, s53
    s_add_u32 s33, s33, s54
    s_add_u32 s33, s33, s55
    s_cmp_ge_u32 s33, 256
    s_cbranch_scc1 main_kernel_ovf_cnt_ok
    s_sub_u32 s29, s29, 1
    s_cbranch_scc1 main_kernel_end
    s_sleep 4
    s_branch main_kernel_ovf_cnt
main_kernel_ovf_cnt_ok:
    v_mov_b32 v126, 0
    v_mov_b32 v127, 1
    s_mov_b64 exec, 1
    buffer_atomic_add v127, v126, s[60:63], 0 offen offset:8 sc0 sc1
    s_waitcnt vmcnt(0)
    s_mov_b64 exec, -1
    v_readfirstlane_b32 s33, v127
    s_nop 3
    s_min_u32 s34, s48, 32
    s_sub_u32 s35, 32, s34
    s_mov_b32 s12, 0
    s_add_u32 s13, s34, s33
    s_cmp_lt_u32 s33, s35
    s_cbranch_scc1 main_kernel_slot_pub
    s_sub_u32 s33, s33, s35
    s_min_u32 s34, s49, 32
    s_sub_u32 s35, 32, s34
    s_mov_b32 s12, 1
    s_add_u32 s13, s34, s33
    s_cmp_lt_u32 s33, s35
    s_cbranch_scc1 main_kernel_slot_pub
    s_sub_u32 s33, s33, s35
    s_min_u32 s34, s50, 32
    s_sub_u32 s35, 32, s34
    s_mov_b32 s12, 2
    s_add_u32 s13, s34, s33
    s_cmp_lt_u32 s33, s35
    s_cbranch_scc1 main_kernel_slot_pub
    s_sub_u32 s33, s33, s35
    s_min_u32 s34, s51, 32
    s_sub_u32 s35, 32, s34
    s_mov_b32 s12, 3
    s_add_u32 s13, s34, s33
    s_cmp_lt_u32 s33, s35
    s_cbranch_scc1 main_kernel_slot_pub
    s_sub_u32 s33, s33, s35
    s_min_u32 s34, s52, 32
    s_sub_u32 s35, 32, s34
    s_mov_b32 s12, 4
    s_add_u32 s13, s34, s33
    s_cmp_lt_u32 s33, s35
    s_cbranch_scc1 main_kernel_slot_pub
    s_sub_u32 s33, s33, s35
    s_min_u32 s34, s53, 32
    s_sub_u32 s35, 32, s34
    s_mov_b32 s12, 5
    s_add_u32 s13, s34, s33
    s_cmp_lt_u32 s33, s35
    s_cbranch_scc1 main_kernel_slot_pub
    s_sub_u32 s33, s33, s35
    s_min_u32 s34, s54, 32
    s_sub_u32 s35, 32, s34
    s_mov_b32 s12, 6
    s_add_u32 s13, s34, s33
    s_cmp_lt_u32 s33, s35
    s_cbranch_scc1 main_kernel_slot_pub
    s_sub_u32 s33, s33, s35
    s_min_u32 s34, s55, 32
    s_sub_u32 s35, 32, s34
    s_mov_b32 s12, 7
    s_add_u32 s13, s34, s33
    s_cmp_lt_u32 s33, s35
    s_cbranch_scc1 main_kernel_slot_pub
    s_sub_u32 s33, s33, s35
    s_mov_b32 s12, 8
    s_mov_b32 s13, 0
main_kernel_slot_pub:
    v_mov_b32 v126, 0
    v_mov_b32 v127, s12
    v_mov_b32 v95, s13
    ds_write_b32 v126, v127
    ds_write_b32 v126, v95 offset:4
    s_waitcnt lgkmcnt(0)
main_kernel_slot_wait:
    s_barrier
    v_mov_b32 v126, 0
    ds_read_b32 v127, v126
    ds_read_b32 v95, v126 offset:4
    s_waitcnt lgkmcnt(0)
    v_readfirstlane_b32 s12, v127
    v_readfirstlane_b32 s13, v95
    s_nop 3
    s_barrier
    s_cmp_ge_u32 s12, 8
    s_cbranch_scc1 main_kernel_end
    s_cmp_lt_u32 s12, 2
    s_cbranch_scc1 main_kernel_chain
    s_mov_b32 s96, s72
    s_and_b32 s97, s73, 0xffff
    s_mov_b32 s98, 0x400000
    s_mov_b32 s99, 0x20000
    s_mov_b32 s92, s74
    s_and_b32 s93, s75, 0xffff
    s_mov_b32 s94, 0x400000
    s_mov_b32 s95, 0x20000
    v_lshlrev_b32 v1, 4, v0
    v_lshlrev_b32 v251, 4, v250
    v_mov_b32 v4, 0
    v_mov_b32 v8, -1
    v_mov_b32 v5, 0
    v_mov_b32 v9, -1
    v_mov_b32 v6, 0
    v_mov_b32 v10, -1
    v_mov_b32 v7, 0
    v_mov_b32 v11, -1
    v_mul_u32_u24 v12, 128, v0
    s_lshl_b32 s15, s12, 4
    s_and_b32 s32, s12, 1
    s_lshl_b32 s32, s32, 5
    s_cmp_lt_u32 s12, 4
    s_cselect_b32 s15, s32, s15
    s_cselect_b32 s32, 32, 16
    s_add_u32 s15, s15, s13
    s_sub_u32 s16, s15, 80
    s_sub_u32 s27, s12, 2
    s_mov_b32 s52, 0
    s_cmp_lt_u32 s13, s32
    s_cbranch_scc1 main_kernel_s_ln
    s_cmp_lg_u32 s13, 16
    s_cbranch_scc1 main_kernel_s_fill
    s_lshl_b32 s32, s16, 11
    s_add_u32 s32, s32, 0x8400000
    buffer_store_dwordx4 v[4:7], v1, s[4:7], s32 offen sc1
    s_add_u32 s32, s32, 4096
    buffer_store_dwordx4 v[4:7], v1, s[4:7], s32 offen sc1
    s_add_u32 s32, s32, 4096
    buffer_store_dwordx4 v[4:7], v1, s[4:7], s32 offen sc1
    s_add_u32 s32, s32, 4096
    buffer_store_dwordx4 v[4:7], v1, s[4:7], s32 offen sc1
    s_add_u32 s32, s32, 4096
    buffer_store_dwordx4 v[4:7], v1, s[4:7], s32 offen sc1
    s_add_u32 s32, s32, 4096
    buffer_store_dwordx4 v[4:7], v1, s[4:7], s32 offen sc1
    s_add_u32 s32, s32, 4096
    buffer_store_dwordx4 v[4:7], v1, s[4:7], s32 offen sc1
    s_add_u32 s32, s32, 4096
    buffer_store_dwordx4 v[4:7], v1, s[4:7], s32 offen sc1
    s_add_u32 s32, s32, 4096
    v_bfe_u32 v2, v0, 2, 1
    s_lshr_b32 s32, s14, 1
    v_and_b32 v2, s32, v2
    s_bitcmp1_b32 s14, 0
    s_cselect_b32 s32, 15, 0
    s_cselect_b32 s33, 4161536, 0
    v_xor_b32 v2, s32, v2
    v_lshlrev_b32 v2, 4, v2
    v_and_b32 v3, 3, v0
    v_lshl_add_u32 v2, v3, 8, v2
    v_lshrrev_b32 v3, 3, v0
    v_lshl_add_u32 v2, v3, 10, v2
    s_add_u32 s33, s33, 0x4808000
    buffer_store_dwordx4 v[4:7], v2, s[4:7], s33 offen sc1
    s_waitcnt vmcnt(0)
    s_barrier
    s_cmp_lg_u32 s14, 0
    s_cbranch_scc1 main_kernel_s_fill
    v_mov_b32 v2, 1
    s_mov_b64 exec, 1
    buffer_atomic_add v2, v4, s[60:63], 0 offen offset:12 sc1
    s_mov_b64 exec, -1
    s_branch main_kernel_s_fill
main_kernel_s_ln:
    v_and_b32 v3, 15, v250
    v_and_b32 v2, 48, v250
    v_lshl_add_u32 v3, v3, 11, v2
    s_lshl_b32 s34, s15, 15
    s_lshl_b32 s32, s14, 9
    s_add_u32 s32, s34, s32
    buffer_load_dwordx4 v[32:35], v3, s[96:99], s32 offen offset:0
    buffer_load_dwordx4 v[36:39], v3, s[96:99], s32 offen offset:64
    buffer_load_dwordx4 v[40:43], v3, s[96:99], s32 offen offset:128
    buffer_load_dwordx4 v[44:47], v3, s[96:99], s32 offen offset:192
    buffer_load_dwordx4 v[48:51], v3, s[96:99], s32 offen offset:256
    buffer_load_dwordx4 v[52:55], v3, s[96:99], s32 offen offset:320
    buffer_load_dwordx4 v[56:59], v3, s[96:99], s32 offen offset:384
    buffer_load_dwordx4 v[60:63], v3, s[96:99], s32 offen offset:448
    v_and_b32 v255, 15, v250
    v_lshlrev_b32 v254, 6, v255
    v_add_u32 v254, 132096, v254
    v_lshrrev_b32 v255, 4, v250
    v_lshl_add_u32 v253, v255, 2, v254
    v_lshl_add_u32 v253, s14, 4, v253
    s_lshl_b32 s32, s14, 13
    s_add_u32 s34, s34, s32
    s_waitcnt vmcnt(0)
    v_permlane16_swap_b32 v32, v34
    v_permlane16_swap_b32 v33, v35
    v_permlane16_swap_b32 v36, v38
    v_permlane16_swap_b32 v37, v39
    v_permlane16_swap_b32 v40, v42
    v_permlane16_swap_b32 v41, v43
    v_permlane16_swap_b32 v44, v46
    v_permlane16_swap_b32 v45, v47
    v_permlane16_swap_b32 v48, v50
    v_permlane16_swap_b32 v49, v51
    v_permlane16_swap_b32 v52, v54
    v_permlane16_swap_b32 v53, v55
    v_permlane16_swap_b32 v56, v58
    v_permlane16_swap_b32 v57, v59
    v_permlane16_swap_b32 v60, v62
    v_permlane16_swap_b32 v61, v63
    v_permlane32_swap_b32 v32, v34
    v_permlane32_swap_b32 v33, v35
    v_permlane32_swap_b32 v36, v38
    v_permlane32_swap_b32 v37, v39
    v_permlane32_swap_b32 v40, v42
    v_permlane32_swap_b32 v41, v43
    v_permlane32_swap_b32 v44, v46
    v_permlane32_swap_b32 v45, v47
    v_permlane32_swap_b32 v48, v50
    v_permlane32_swap_b32 v49, v51
    v_permlane32_swap_b32 v52, v54
    v_permlane32_swap_b32 v53, v55
    v_permlane32_swap_b32 v56, v58
    v_permlane32_swap_b32 v57, v59
    v_permlane32_swap_b32 v60, v62
    v_permlane32_swap_b32 v61, v63
    s_lshr_b32 s32, s15, 3
    s_lshl_b32 s32, s32, 9
    s_and_b32 s33, s15, 7
    s_lshl_b32 s33, s33, 4
    s_add_u32 s32, s32, s33
    s_add_u32 s16, s32, 0x8416000
    v_lshlrev_b32 v64, 16, v32
    v_and_b32 v65, 0xffff0000, v32
    v_lshlrev_b32 v66, 16, v33
    v_and_b32 v67, 0xffff0000, v33
    v_lshlrev_b32 v68, 16, v34
    v_and_b32 v69, 0xffff0000, v34
    v_lshlrev_b32 v70, 16, v35
    v_and_b32 v71, 0xffff0000, v35
    v_lshlrev_b32 v72, 16, v36
    v_and_b32 v73, 0xffff0000, v36
    v_lshlrev_b32 v74, 16, v37
    v_and_b32 v75, 0xffff0000, v37
    v_lshlrev_b32 v76, 16, v38
    v_and_b32 v77, 0xffff0000, v38
    v_lshlrev_b32 v78, 16, v39
    v_and_b32 v79, 0xffff0000, v39
    v_lshlrev_b32 v80, 16, v40
    v_and_b32 v81, 0xffff0000, v40
    v_lshlrev_b32 v82, 16, v41
    v_and_b32 v83, 0xffff0000, v41
    v_lshlrev_b32 v84, 16, v42
    v_and_b32 v85, 0xffff0000, v42
    v_lshlrev_b32 v86, 16, v43
    v_and_b32 v87, 0xffff0000, v43
    v_lshlrev_b32 v88, 16, v44
    v_and_b32 v89, 0xffff0000, v44
    v_lshlrev_b32 v90, 16, v45
    v_and_b32 v91, 0xffff0000, v45
    v_lshlrev_b32 v92, 16, v46
    v_and_b32 v93, 0xffff0000, v46
    v_lshlrev_b32 v94, 16, v47
    v_and_b32 v95, 0xffff0000, v47
    v_lshlrev_b32 v96, 16, v48
    v_and_b32 v97, 0xffff0000, v48
    v_lshlrev_b32 v98, 16, v49
    v_and_b32 v99, 0xffff0000, v49
    v_lshlrev_b32 v100, 16, v50
    v_and_b32 v101, 0xffff0000, v50
    v_lshlrev_b32 v102, 16, v51
    v_and_b32 v103, 0xffff0000, v51
    v_lshlrev_b32 v104, 16, v52
    v_and_b32 v105, 0xffff0000, v52
    v_lshlrev_b32 v106, 16, v53
    v_and_b32 v107, 0xffff0000, v53
    v_lshlrev_b32 v108, 16, v54
    v_and_b32 v109, 0xffff0000, v54
    v_lshlrev_b32 v110, 16, v55
    v_and_b32 v111, 0xffff0000, v55
    v_lshlrev_b32 v112, 16, v56
    v_and_b32 v113, 0xffff0000, v56
    v_lshlrev_b32 v114, 16, v57
    v_and_b32 v115, 0xffff0000, v57
    v_lshlrev_b32 v116, 16, v58
    v_and_b32 v117, 0xffff0000, v58
    v_lshlrev_b32 v118, 16, v59
    v_and_b32 v119, 0xffff0000, v59
    v_lshlrev_b32 v120, 16, v60
    v_and_b32 v121, 0xffff0000, v60
    v_lshlrev_b32 v122, 16, v61
    v_and_b32 v123, 0xffff0000, v61
    v_lshlrev_b32 v124, 16, v62
    v_and_b32 v125, 0xffff0000, v62
    v_lshlrev_b32 v126, 16, v63
    v_and_b32 v127, 0xffff0000, v63
    v_pk_add_f32 v[16:17], v[64:65], v[72:73]
    v_pk_add_f32 v[18:19], v[66:67], v[74:75]
    v_pk_add_f32 v[20:21], v[68:69], v[76:77]
    v_pk_add_f32 v[22:23], v[70:71], v[78:79]
    v_pk_add_f32 v[16:17], v[16:17], v[80:81]
    v_pk_add_f32 v[18:19], v[18:19], v[82:83]
    v_pk_add_f32 v[20:21], v[20:21], v[84:85]
    v_pk_add_f32 v[22:23], v[22:23], v[86:87]
    v_pk_add_f32 v[16:17], v[16:17], v[88:89]
    v_pk_add_f32 v[18:19], v[18:19], v[90:91]
    v_pk_add_f32 v[20:21], v[20:21], v[92:93]
    v_pk_add_f32 v[22:23], v[22:23], v[94:95]
    v_pk_add_f32 v[16:17], v[16:17], v[96:97]
    v_pk_add_f32 v[18:19], v[18:19], v[98:99]
    v_pk_add_f32 v[20:21], v[20:21], v[100:101]
    v_pk_add_f32 v[22:23], v[22:23], v[102:103]
    v_pk_add_f32 v[16:17], v[16:17], v[104:105]
    v_pk_add_f32 v[18:19], v[18:19], v[106:107]
    v_pk_add_f32 v[20:21], v[20:21], v[108:109]
    v_pk_add_f32 v[22:23], v[22:23], v[110:111]
    v_pk_add_f32 v[16:17], v[16:17], v[112:113]
    v_pk_add_f32 v[18:19], v[18:19], v[114:115]
    v_pk_add_f32 v[20:21], v[20:21], v[116:117]
    v_pk_add_f32 v[22:23], v[22:23], v[118:119]
    v_pk_add_f32 v[16:17], v[16:17], v[120:121]
    v_pk_add_f32 v[18:19], v[18:19], v[122:123]
    v_pk_add_f32 v[20:21], v[20:21], v[124:125]
    v_pk_add_f32 v[22:23], v[22:23], v[126:127]
    v_pk_add_f32 v[16:17], v[16:17], v[18:19]
    v_pk_add_f32 v[20:21], v[20:21], v[22:23]
    v_pk_add_f32 v[16:17], v[16:17], v[20:21]
    v_add_f32 v16, v16, v17
    ds_write_b32 v253, v16 offset:0
    s_waitcnt lgkmcnt(0)
    s_barrier
    ds_read_b128 v[16:19], v254 offset:0
    ds_read_b128 v[20:23], v254 offset:16
    ds_read_b128 v[24:27], v254 offset:32
    ds_read_b128 v[28:31], v254 offset:48
    s_waitcnt lgkmcnt(2)
    v_pk_add_f32 v[16:17], v[16:17], v[18:19]
    v_pk_add_f32 v[20:21], v[20:21], v[22:23]
    s_waitcnt lgkmcnt(0)
    v_pk_add_f32 v[24:25], v[24:25], v[26:27]
    v_pk_add_f32 v[28:29], v[28:29], v[30:31]
    v_pk_add_f32 v[16:17], v[16:17], v[20:21]
    v_pk_add_f32 v[24:25], v[24:25], v[28:29]
    v_pk_add_f32 v[16:17], v[16:17], v[24:25]
    v_add_f32 v16, v16, v17
    v_mul_f32 v16, 0xba800000, v16
    v_mov_b32 v17, v16
    v_pk_add_f32 v[64:65], v[64:65], v[16:17]
    v_pk_add_f32 v[66:67], v[66:67], v[16:17]
    v_pk_add_f32 v[68:69], v[68:69], v[16:17]
    v_pk_add_f32 v[70:71], v[70:71], v[16:17]
    v_pk_add_f32 v[72:73], v[72:73], v[16:17]
    v_pk_add_f32 v[74:75], v[74:75], v[16:17]
    v_pk_add_f32 v[76:77], v[76:77], v[16:17]
    v_pk_add_f32 v[78:79], v[78:79], v[16:17]
    v_pk_add_f32 v[80:81], v[80:81], v[16:17]
    v_pk_add_f32 v[82:83], v[82:83], v[16:17]
    v_pk_add_f32 v[84:85], v[84:85], v[16:17]
    v_pk_add_f32 v[86:87], v[86:87], v[16:17]
    v_pk_add_f32 v[88:89], v[88:89], v[16:17]
    v_pk_add_f32 v[90:91], v[90:91], v[16:17]
    v_pk_add_f32 v[92:93], v[92:93], v[16:17]
    v_pk_add_f32 v[94:95], v[94:95], v[16:17]
    v_pk_add_f32 v[96:97], v[96:97], v[16:17]
    v_pk_add_f32 v[98:99], v[98:99], v[16:17]
    v_pk_add_f32 v[100:101], v[100:101], v[16:17]
    v_pk_add_f32 v[102:103], v[102:103], v[16:17]
    v_pk_add_f32 v[104:105], v[104:105], v[16:17]
    v_pk_add_f32 v[106:107], v[106:107], v[16:17]
    v_pk_add_f32 v[108:109], v[108:109], v[16:17]
    v_pk_add_f32 v[110:111], v[110:111], v[16:17]
    v_pk_add_f32 v[112:113], v[112:113], v[16:17]
    v_pk_add_f32 v[114:115], v[114:115], v[16:17]
    v_pk_add_f32 v[116:117], v[116:117], v[16:17]
    v_pk_add_f32 v[118:119], v[118:119], v[16:17]
    v_pk_add_f32 v[120:121], v[120:121], v[16:17]
    v_pk_add_f32 v[122:123], v[122:123], v[16:17]
    v_pk_add_f32 v[124:125], v[124:125], v[16:17]
    v_pk_add_f32 v[126:127], v[126:127], v[16:17]
    v_pk_mul_f32 v[16:17], v[64:65], v[64:65]
    v_pk_mul_f32 v[18:19], v[66:67], v[66:67]
    v_pk_mul_f32 v[20:21], v[68:69], v[68:69]
    v_pk_mul_f32 v[22:23], v[70:71], v[70:71]
    v_pk_fma_f32 v[16:17], v[72:73], v[72:73], v[16:17]
    v_pk_fma_f32 v[18:19], v[74:75], v[74:75], v[18:19]
    v_pk_fma_f32 v[20:21], v[76:77], v[76:77], v[20:21]
    v_pk_fma_f32 v[22:23], v[78:79], v[78:79], v[22:23]
    v_pk_fma_f32 v[16:17], v[80:81], v[80:81], v[16:17]
    v_pk_fma_f32 v[18:19], v[82:83], v[82:83], v[18:19]
    v_pk_fma_f32 v[20:21], v[84:85], v[84:85], v[20:21]
    v_pk_fma_f32 v[22:23], v[86:87], v[86:87], v[22:23]
    v_pk_fma_f32 v[16:17], v[88:89], v[88:89], v[16:17]
    v_pk_fma_f32 v[18:19], v[90:91], v[90:91], v[18:19]
    v_pk_fma_f32 v[20:21], v[92:93], v[92:93], v[20:21]
    v_pk_fma_f32 v[22:23], v[94:95], v[94:95], v[22:23]
    v_pk_fma_f32 v[16:17], v[96:97], v[96:97], v[16:17]
    v_pk_fma_f32 v[18:19], v[98:99], v[98:99], v[18:19]
    v_pk_fma_f32 v[20:21], v[100:101], v[100:101], v[20:21]
    v_pk_fma_f32 v[22:23], v[102:103], v[102:103], v[22:23]
    v_pk_fma_f32 v[16:17], v[104:105], v[104:105], v[16:17]
    v_pk_fma_f32 v[18:19], v[106:107], v[106:107], v[18:19]
    v_pk_fma_f32 v[20:21], v[108:109], v[108:109], v[20:21]
    v_pk_fma_f32 v[22:23], v[110:111], v[110:111], v[22:23]
    v_pk_fma_f32 v[16:17], v[112:113], v[112:113], v[16:17]
    v_pk_fma_f32 v[18:19], v[114:115], v[114:115], v[18:19]
    v_pk_fma_f32 v[20:21], v[116:117], v[116:117], v[20:21]
    v_pk_fma_f32 v[22:23], v[118:119], v[118:119], v[22:23]
    v_pk_fma_f32 v[16:17], v[120:121], v[120:121], v[16:17]
    v_pk_fma_f32 v[18:19], v[122:123], v[122:123], v[18:19]
    v_pk_fma_f32 v[20:21], v[124:125], v[124:125], v[20:21]
    v_pk_fma_f32 v[22:23], v[126:127], v[126:127], v[22:23]
    v_pk_add_f32 v[16:17], v[16:17], v[18:19]
    v_pk_add_f32 v[20:21], v[20:21], v[22:23]
    v_pk_add_f32 v[16:17], v[16:17], v[20:21]
    v_add_f32 v16, v16, v17
    ds_write_b32 v253, v16 offset:1024
    s_waitcnt lgkmcnt(0)
    s_barrier
    ds_read_b128 v[16:19], v254 offset:1024
    ds_read_b128 v[20:23], v254 offset:1040
    ds_read_b128 v[24:27], v254 offset:1056
    ds_read_b128 v[28:31], v254 offset:1072
    s_waitcnt lgkmcnt(2)
    v_pk_add_f32 v[16:17], v[16:17], v[18:19]
    v_pk_add_f32 v[20:21], v[20:21], v[22:23]
    s_waitcnt lgkmcnt(0)
    v_pk_add_f32 v[24:25], v[24:25], v[26:27]
    v_pk_add_f32 v[28:29], v[28:29], v[30:31]
    v_pk_add_f32 v[16:17], v[16:17], v[20:21]
    v_pk_add_f32 v[24:25], v[24:25], v[28:29]
    v_pk_add_f32 v[16:17], v[16:17], v[24:25]
    v_add_f32 v16, v16, v17
    v_mov_b32 v17, 0x3727c5ac
    v_fmac_f32 v17, 0x3a800000, v16
    v_rsq_f32 v16, v17
    s_nop 0
    v_mov_b32 v17, v16
    v_pk_mul_f32 v[64:65], v[64:65], v[16:17]
    v_pk_mul_f32 v[66:67], v[66:67], v[16:17]
    v_pk_mul_f32 v[68:69], v[68:69], v[16:17]
    v_pk_mul_f32 v[70:71], v[70:71], v[16:17]
    v_pk_mul_f32 v[72:73], v[72:73], v[16:17]
    v_pk_mul_f32 v[74:75], v[74:75], v[16:17]
    v_pk_mul_f32 v[76:77], v[76:77], v[16:17]
    v_pk_mul_f32 v[78:79], v[78:79], v[16:17]
    v_pk_mul_f32 v[80:81], v[80:81], v[16:17]
    v_pk_mul_f32 v[82:83], v[82:83], v[16:17]
    v_pk_mul_f32 v[84:85], v[84:85], v[16:17]
    v_pk_mul_f32 v[86:87], v[86:87], v[16:17]
    v_pk_mul_f32 v[88:89], v[88:89], v[16:17]
    v_pk_mul_f32 v[90:91], v[90:91], v[16:17]
    v_pk_mul_f32 v[92:93], v[92:93], v[16:17]
    v_pk_mul_f32 v[94:95], v[94:95], v[16:17]
    v_pk_mul_f32 v[96:97], v[96:97], v[16:17]
    v_pk_mul_f32 v[98:99], v[98:99], v[16:17]
    v_pk_mul_f32 v[100:101], v[100:101], v[16:17]
    v_pk_mul_f32 v[102:103], v[102:103], v[16:17]
    v_pk_mul_f32 v[104:105], v[104:105], v[16:17]
    v_pk_mul_f32 v[106:107], v[106:107], v[16:17]
    v_pk_mul_f32 v[108:109], v[108:109], v[16:17]
    v_pk_mul_f32 v[110:111], v[110:111], v[16:17]
    v_pk_mul_f32 v[112:113], v[112:113], v[16:17]
    v_pk_mul_f32 v[114:115], v[114:115], v[16:17]
    v_pk_mul_f32 v[116:117], v[116:117], v[16:17]
    v_pk_mul_f32 v[118:119], v[118:119], v[16:17]
    v_pk_mul_f32 v[120:121], v[120:121], v[16:17]
    v_pk_mul_f32 v[122:123], v[122:123], v[16:17]
    v_pk_mul_f32 v[124:125], v[124:125], v[16:17]
    v_pk_mul_f32 v[126:127], v[126:127], v[16:17]
    v_cvt_pk_bf16_f32 v128, v64, v65
    v_cvt_pk_bf16_f32 v129, v66, v67
    v_cvt_pk_bf16_f32 v130, v68, v69
    v_cvt_pk_bf16_f32 v131, v70, v71
    v_cvt_pk_bf16_f32 v132, v72, v73
    v_cvt_pk_bf16_f32 v133, v74, v75
    v_cvt_pk_bf16_f32 v134, v76, v77
    v_cvt_pk_bf16_f32 v135, v78, v79
    v_cvt_pk_bf16_f32 v136, v80, v81
    v_cvt_pk_bf16_f32 v137, v82, v83
    v_cvt_pk_bf16_f32 v138, v84, v85
    v_cvt_pk_bf16_f32 v139, v86, v87
    v_cvt_pk_bf16_f32 v140, v88, v89
    v_cvt_pk_bf16_f32 v141, v90, v91
    v_cvt_pk_bf16_f32 v142, v92, v93
    v_cvt_pk_bf16_f32 v143, v94, v95
    v_cvt_pk_bf16_f32 v144, v96, v97
    v_cvt_pk_bf16_f32 v145, v98, v99
    v_cvt_pk_bf16_f32 v146, v100, v101
    v_cvt_pk_bf16_f32 v147, v102, v103
    v_cvt_pk_bf16_f32 v148, v104, v105
    v_cvt_pk_bf16_f32 v149, v106, v107
    v_cvt_pk_bf16_f32 v150, v108, v109
    v_cvt_pk_bf16_f32 v151, v110, v111
    v_cvt_pk_bf16_f32 v152, v112, v113
    v_cvt_pk_bf16_f32 v153, v114, v115
    v_cvt_pk_bf16_f32 v154, v116, v117
    v_cvt_pk_bf16_f32 v155, v118, v119
    v_cvt_pk_bf16_f32 v156, v120, v121
    v_cvt_pk_bf16_f32 v157, v122, v123
    v_cvt_pk_bf16_f32 v158, v124, v125
    v_cvt_pk_bf16_f32 v159, v126, v127
    s_add_u32 s32, s34, 0x0
    s_add_u32 s33, s32, 4096
    buffer_store_dwordx4 v[128:131], v251, s[4:7], s32 offen offset:0 sc1
    buffer_store_dwordx4 v[132:135], v251, s[4:7], s32 offen offset:1024 sc1
    buffer_store_dwordx4 v[136:139], v251, s[4:7], s32 offen offset:2048 sc1
    buffer_store_dwordx4 v[140:143], v251, s[4:7], s32 offen offset:3072 sc1
    buffer_store_dwordx4 v[144:147], v251, s[4:7], s33 offen offset:0 sc1
    buffer_store_dwordx4 v[148:151], v251, s[4:7], s33 offen offset:1024 sc1
    buffer_store_dwordx4 v[152:155], v251, s[4:7], s33 offen offset:2048 sc1
    buffer_store_dwordx4 v[156:159], v251, s[4:7], s33 offen offset:3072 sc1
    buffer_load_dword v2, v4, s[60:63], 0 offen offset:12 sc1
    v_lshlrev_b32 v64, 16, v128
    v_and_b32 v65, 0xffff0000, v128
    v_lshlrev_b32 v66, 16, v129
    v_and_b32 v67, 0xffff0000, v129
    v_lshlrev_b32 v68, 16, v130
    v_and_b32 v69, 0xffff0000, v130
    v_lshlrev_b32 v70, 16, v131
    v_and_b32 v71, 0xffff0000, v131
    v_lshlrev_b32 v72, 16, v132
    v_and_b32 v73, 0xffff0000, v132
    v_lshlrev_b32 v74, 16, v133
    v_and_b32 v75, 0xffff0000, v133
    v_lshlrev_b32 v76, 16, v134
    v_and_b32 v77, 0xffff0000, v134
    v_lshlrev_b32 v78, 16, v135
    v_and_b32 v79, 0xffff0000, v135
    v_lshlrev_b32 v80, 16, v136
    v_and_b32 v81, 0xffff0000, v136
    v_lshlrev_b32 v82, 16, v137
    v_and_b32 v83, 0xffff0000, v137
    v_lshlrev_b32 v84, 16, v138
    v_and_b32 v85, 0xffff0000, v138
    v_lshlrev_b32 v86, 16, v139
    v_and_b32 v87, 0xffff0000, v139
    v_lshlrev_b32 v88, 16, v140
    v_and_b32 v89, 0xffff0000, v140
    v_lshlrev_b32 v90, 16, v141
    v_and_b32 v91, 0xffff0000, v141
    v_lshlrev_b32 v92, 16, v142
    v_and_b32 v93, 0xffff0000, v142
    v_lshlrev_b32 v94, 16, v143
    v_and_b32 v95, 0xffff0000, v143
    v_lshlrev_b32 v96, 16, v144
    v_and_b32 v97, 0xffff0000, v144
    v_lshlrev_b32 v98, 16, v145
    v_and_b32 v99, 0xffff0000, v145
    v_lshlrev_b32 v100, 16, v146
    v_and_b32 v101, 0xffff0000, v146
    v_lshlrev_b32 v102, 16, v147
    v_and_b32 v103, 0xffff0000, v147
    v_lshlrev_b32 v104, 16, v148
    v_and_b32 v105, 0xffff0000, v148
    v_lshlrev_b32 v106, 16, v149
    v_and_b32 v107, 0xffff0000, v149
    v_lshlrev_b32 v108, 16, v150
    v_and_b32 v109, 0xffff0000, v150
    v_lshlrev_b32 v110, 16, v151
    v_and_b32 v111, 0xffff0000, v151
    v_lshlrev_b32 v112, 16, v152
    v_and_b32 v113, 0xffff0000, v152
    v_lshlrev_b32 v114, 16, v153
    v_and_b32 v115, 0xffff0000, v153
    v_lshlrev_b32 v116, 16, v154
    v_and_b32 v117, 0xffff0000, v154
    v_lshlrev_b32 v118, 16, v155
    v_and_b32 v119, 0xffff0000, v155
    v_lshlrev_b32 v120, 16, v156
    v_and_b32 v121, 0xffff0000, v156
    v_lshlrev_b32 v122, 16, v157
    v_and_b32 v123, 0xffff0000, v157
    v_lshlrev_b32 v124, 16, v158
    v_and_b32 v125, 0xffff0000, v158
    v_lshlrev_b32 v126, 16, v159
    v_and_b32 v127, 0xffff0000, v159
    v_pk_add_f32 v[16:17], v[64:65], v[72:73]
    v_pk_add_f32 v[18:19], v[66:67], v[74:75]
    v_pk_add_f32 v[20:21], v[68:69], v[76:77]
    v_pk_add_f32 v[22:23], v[70:71], v[78:79]
    v_pk_add_f32 v[16:17], v[16:17], v[80:81]
    v_pk_add_f32 v[18:19], v[18:19], v[82:83]
    v_pk_add_f32 v[20:21], v[20:21], v[84:85]
    v_pk_add_f32 v[22:23], v[22:23], v[86:87]
    v_pk_add_f32 v[16:17], v[16:17], v[88:89]
    v_pk_add_f32 v[18:19], v[18:19], v[90:91]
    v_pk_add_f32 v[20:21], v[20:21], v[92:93]
    v_pk_add_f32 v[22:23], v[22:23], v[94:95]
    v_pk_add_f32 v[16:17], v[16:17], v[96:97]
    v_pk_add_f32 v[18:19], v[18:19], v[98:99]
    v_pk_add_f32 v[20:21], v[20:21], v[100:101]
    v_pk_add_f32 v[22:23], v[22:23], v[102:103]
    v_pk_add_f32 v[16:17], v[16:17], v[104:105]
    v_pk_add_f32 v[18:19], v[18:19], v[106:107]
    v_pk_add_f32 v[20:21], v[20:21], v[108:109]
    v_pk_add_f32 v[22:23], v[22:23], v[110:111]
    v_pk_add_f32 v[16:17], v[16:17], v[112:113]
    v_pk_add_f32 v[18:19], v[18:19], v[114:115]
    v_pk_add_f32 v[20:21], v[20:21], v[116:117]
    v_pk_add_f32 v[22:23], v[22:23], v[118:119]
    v_pk_add_f32 v[16:17], v[16:17], v[120:121]
    v_pk_add_f32 v[18:19], v[18:19], v[122:123]
    v_pk_add_f32 v[20:21], v[20:21], v[124:125]
    v_pk_add_f32 v[22:23], v[22:23], v[126:127]
    v_pk_add_f32 v[16:17], v[16:17], v[18:19]
    v_pk_add_f32 v[20:21], v[20:21], v[22:23]
    v_pk_add_f32 v[16:17], v[16:17], v[20:21]
    v_add_f32 v16, v16, v17
    ds_write_b32 v253, v16 offset:0
    s_waitcnt lgkmcnt(0)
    s_barrier
    ds_read_b128 v[16:19], v254 offset:0
    ds_read_b128 v[20:23], v254 offset:16
    ds_read_b128 v[24:27], v254 offset:32
    ds_read_b128 v[28:31], v254 offset:48
    s_waitcnt lgkmcnt(2)
    v_pk_add_f32 v[16:17], v[16:17], v[18:19]
    v_pk_add_f32 v[20:21], v[20:21], v[22:23]
    s_waitcnt lgkmcnt(0)
    v_pk_add_f32 v[24:25], v[24:25], v[26:27]
    v_pk_add_f32 v[28:29], v[28:29], v[30:31]
    v_pk_add_f32 v[16:17], v[16:17], v[20:21]
    v_pk_add_f32 v[24:25], v[24:25], v[28:29]
    v_pk_add_f32 v[16:17], v[16:17], v[24:25]
    v_add_f32 v16, v16, v17
    v_mul_f32 v16, 0xba800000, v16
    v_mov_b32 v17, v16
    v_pk_add_f32 v[64:65], v[64:65], v[16:17]
    v_pk_add_f32 v[66:67], v[66:67], v[16:17]
    v_pk_add_f32 v[68:69], v[68:69], v[16:17]
    v_pk_add_f32 v[70:71], v[70:71], v[16:17]
    v_pk_add_f32 v[72:73], v[72:73], v[16:17]
    v_pk_add_f32 v[74:75], v[74:75], v[16:17]
    v_pk_add_f32 v[76:77], v[76:77], v[16:17]
    v_pk_add_f32 v[78:79], v[78:79], v[16:17]
    v_pk_add_f32 v[80:81], v[80:81], v[16:17]
    v_pk_add_f32 v[82:83], v[82:83], v[16:17]
    v_pk_add_f32 v[84:85], v[84:85], v[16:17]
    v_pk_add_f32 v[86:87], v[86:87], v[16:17]
    v_pk_add_f32 v[88:89], v[88:89], v[16:17]
    v_pk_add_f32 v[90:91], v[90:91], v[16:17]
    v_pk_add_f32 v[92:93], v[92:93], v[16:17]
    v_pk_add_f32 v[94:95], v[94:95], v[16:17]
    v_pk_add_f32 v[96:97], v[96:97], v[16:17]
    v_pk_add_f32 v[98:99], v[98:99], v[16:17]
    v_pk_add_f32 v[100:101], v[100:101], v[16:17]
    v_pk_add_f32 v[102:103], v[102:103], v[16:17]
    v_pk_add_f32 v[104:105], v[104:105], v[16:17]
    v_pk_add_f32 v[106:107], v[106:107], v[16:17]
    v_pk_add_f32 v[108:109], v[108:109], v[16:17]
    v_pk_add_f32 v[110:111], v[110:111], v[16:17]
    v_pk_add_f32 v[112:113], v[112:113], v[16:17]
    v_pk_add_f32 v[114:115], v[114:115], v[16:17]
    v_pk_add_f32 v[116:117], v[116:117], v[16:17]
    v_pk_add_f32 v[118:119], v[118:119], v[16:17]
    v_pk_add_f32 v[120:121], v[120:121], v[16:17]
    v_pk_add_f32 v[122:123], v[122:123], v[16:17]
    v_pk_add_f32 v[124:125], v[124:125], v[16:17]
    v_pk_add_f32 v[126:127], v[126:127], v[16:17]
    v_pk_mul_f32 v[16:17], v[64:65], v[64:65]
    v_pk_mul_f32 v[18:19], v[66:67], v[66:67]
    v_pk_mul_f32 v[20:21], v[68:69], v[68:69]
    v_pk_mul_f32 v[22:23], v[70:71], v[70:71]
    v_pk_fma_f32 v[16:17], v[72:73], v[72:73], v[16:17]
    v_pk_fma_f32 v[18:19], v[74:75], v[74:75], v[18:19]
    v_pk_fma_f32 v[20:21], v[76:77], v[76:77], v[20:21]
    v_pk_fma_f32 v[22:23], v[78:79], v[78:79], v[22:23]
    v_pk_fma_f32 v[16:17], v[80:81], v[80:81], v[16:17]
    v_pk_fma_f32 v[18:19], v[82:83], v[82:83], v[18:19]
    v_pk_fma_f32 v[20:21], v[84:85], v[84:85], v[20:21]
    v_pk_fma_f32 v[22:23], v[86:87], v[86:87], v[22:23]
    v_pk_fma_f32 v[16:17], v[88:89], v[88:89], v[16:17]
    v_pk_fma_f32 v[18:19], v[90:91], v[90:91], v[18:19]
    v_pk_fma_f32 v[20:21], v[92:93], v[92:93], v[20:21]
    v_pk_fma_f32 v[22:23], v[94:95], v[94:95], v[22:23]
    v_pk_fma_f32 v[16:17], v[96:97], v[96:97], v[16:17]
    v_pk_fma_f32 v[18:19], v[98:99], v[98:99], v[18:19]
    v_pk_fma_f32 v[20:21], v[100:101], v[100:101], v[20:21]
    v_pk_fma_f32 v[22:23], v[102:103], v[102:103], v[22:23]
    v_pk_fma_f32 v[16:17], v[104:105], v[104:105], v[16:17]
    v_pk_fma_f32 v[18:19], v[106:107], v[106:107], v[18:19]
    v_pk_fma_f32 v[20:21], v[108:109], v[108:109], v[20:21]
    v_pk_fma_f32 v[22:23], v[110:111], v[110:111], v[22:23]
    v_pk_fma_f32 v[16:17], v[112:113], v[112:113], v[16:17]
    v_pk_fma_f32 v[18:19], v[114:115], v[114:115], v[18:19]
    v_pk_fma_f32 v[20:21], v[116:117], v[116:117], v[20:21]
    v_pk_fma_f32 v[22:23], v[118:119], v[118:119], v[22:23]
    v_pk_fma_f32 v[16:17], v[120:121], v[120:121], v[16:17]
    v_pk_fma_f32 v[18:19], v[122:123], v[122:123], v[18:19]
    v_pk_fma_f32 v[20:21], v[124:125], v[124:125], v[20:21]
    v_pk_fma_f32 v[22:23], v[126:127], v[126:127], v[22:23]
    v_pk_add_f32 v[16:17], v[16:17], v[18:19]
    v_pk_add_f32 v[20:21], v[20:21], v[22:23]
    v_pk_add_f32 v[16:17], v[16:17], v[20:21]
    v_add_f32 v16, v16, v17
    ds_write_b32 v253, v16 offset:1024
    s_waitcnt lgkmcnt(0)
    s_waitcnt vmcnt(0)
    s_barrier
    s_cmp_lg_u32 s14, 0
    s_cbranch_scc1 main_kernel_s_nf
    v_cmp_gt_u32 vcc, 4, v2
    s_cbranch_vccz main_kernel_s_wa1_ok
    v_mov_b32 v2, 0
main_kernel_s_wa1:
    buffer_load_dword v3, v2, s[60:63], 0 offen offset:12 sc1
    s_waitcnt vmcnt(0)
    v_cmp_gt_u32 vcc, 4, v3
    s_cbranch_vccz main_kernel_s_wa1_ok
    s_sleep 4
    s_sub_u32 s29, s29, 1
    s_cbranch_scc0 main_kernel_s_wa1
    s_branch main_kernel_end
main_kernel_s_wa1_ok:
    s_mov_b64 exec, 1
    buffer_store_dword v8, v4, s[4:7], s16 offen sc1
    s_mov_b64 exec, -1
main_kernel_s_nf:
    ds_read_b128 v[16:19], v254 offset:1024
    ds_read_b128 v[20:23], v254 offset:1040
    ds_read_b128 v[24:27], v254 offset:1056
    ds_read_b128 v[28:31], v254 offset:1072
    s_waitcnt lgkmcnt(2)
    v_pk_add_f32 v[16:17], v[16:17], v[18:19]
    v_pk_add_f32 v[20:21], v[20:21], v[22:23]
    s_waitcnt lgkmcnt(0)
    v_pk_add_f32 v[24:25], v[24:25], v[26:27]
    v_pk_add_f32 v[28:29], v[28:29], v[30:31]
    v_pk_add_f32 v[16:17], v[16:17], v[20:21]
    v_pk_add_f32 v[24:25], v[24:25], v[28:29]
    v_pk_add_f32 v[16:17], v[16:17], v[24:25]
    v_add_f32 v16, v16, v17
    v_mov_b32 v17, 0x3727c5ac
    v_fmac_f32 v17, 0x3a800000, v16
    v_rsq_f32 v16, v17
    s_nop 0
    v_mov_b32 v17, v16
    v_pk_mul_f32 v[64:65], v[64:65], v[16:17]
    v_pk_mul_f32 v[66:67], v[66:67], v[16:17]
    v_pk_mul_f32 v[68:69], v[68:69], v[16:17]
    v_pk_mul_f32 v[70:71], v[70:71], v[16:17]
    v_pk_mul_f32 v[72:73], v[72:73], v[16:17]
    v_pk_mul_f32 v[74:75], v[74:75], v[16:17]
    v_pk_mul_f32 v[76:77], v[76:77], v[16:17]
    v_pk_mul_f32 v[78:79], v[78:79], v[16:17]
    v_pk_mul_f32 v[80:81], v[80:81], v[16:17]
    v_pk_mul_f32 v[82:83], v[82:83], v[16:17]
    v_pk_mul_f32 v[84:85], v[84:85], v[16:17]
    v_pk_mul_f32 v[86:87], v[86:87], v[16:17]
    v_pk_mul_f32 v[88:89], v[88:89], v[16:17]
    v_pk_mul_f32 v[90:91], v[90:91], v[16:17]
    v_pk_mul_f32 v[92:93], v[92:93], v[16:17]
    v_pk_mul_f32 v[94:95], v[94:95], v[16:17]
    v_pk_mul_f32 v[96:97], v[96:97], v[16:17]
    v_pk_mul_f32 v[98:99], v[98:99], v[16:17]
    v_pk_mul_f32 v[100:101], v[100:101], v[16:17]
    v_pk_mul_f32 v[102:103], v[102:103], v[16:17]
    v_pk_mul_f32 v[104:105], v[104:105], v[16:17]
    v_pk_mul_f32 v[106:107], v[106:107], v[16:17]
    v_pk_mul_f32 v[108:109], v[108:109], v[16:17]
    v_pk_mul_f32 v[110:111], v[110:111], v[16:17]
    v_pk_mul_f32 v[112:113], v[112:113], v[16:17]
    v_pk_mul_f32 v[114:115], v[114:115], v[16:17]
    v_pk_mul_f32 v[116:117], v[116:117], v[16:17]
    v_pk_mul_f32 v[118:119], v[118:119], v[16:17]
    v_pk_mul_f32 v[120:121], v[120:121], v[16:17]
    v_pk_mul_f32 v[122:123], v[122:123], v[16:17]
    v_pk_mul_f32 v[124:125], v[124:125], v[16:17]
    v_pk_mul_f32 v[126:127], v[126:127], v[16:17]
    v_cvt_pk_bf16_f32 v32, v64, v65
    v_cvt_pk_bf16_f32 v33, v66, v67
    v_cvt_pk_bf16_f32 v34, v68, v69
    v_cvt_pk_bf16_f32 v35, v70, v71
    v_cvt_pk_bf16_f32 v36, v72, v73
    v_cvt_pk_bf16_f32 v37, v74, v75
    v_cvt_pk_bf16_f32 v38, v76, v77
    v_cvt_pk_bf16_f32 v39, v78, v79
    v_cvt_pk_bf16_f32 v40, v80, v81
    v_cvt_pk_bf16_f32 v41, v82, v83
    v_cvt_pk_bf16_f32 v42, v84, v85
    v_cvt_pk_bf16_f32 v43, v86, v87
    v_cvt_pk_bf16_f32 v44, v88, v89
    v_cvt_pk_bf16_f32 v45, v90, v91
    v_cvt_pk_bf16_f32 v46, v92, v93
    v_cvt_pk_bf16_f32 v47, v94, v95
    v_cvt_pk_bf16_f32 v48, v96, v97
    v_cvt_pk_bf16_f32 v49, v98, v99
    v_cvt_pk_bf16_f32 v50, v100, v101
    v_cvt_pk_bf16_f32 v51, v102, v103
    v_cvt_pk_bf16_f32 v52, v104, v105
    v_cvt_pk_bf16_f32 v53, v106, v107
    v_cvt_pk_bf16_f32 v54, v108, v109
    v_cvt_pk_bf16_f32 v55, v110, v111
    v_cvt_pk_bf16_f32 v56, v112, v113
    v_cvt_pk_bf16_f32 v57, v114, v115
    v_cvt_pk_bf16_f32 v58, v116, v117
    v_cvt_pk_bf16_f32 v59, v118, v119
    v_cvt_pk_bf16_f32 v60, v120, v121
    v_cvt_pk_bf16_f32 v61, v122, v123
    v_cvt_pk_bf16_f32 v62, v124, v125
    v_cvt_pk_bf16_f32 v63, v126, v127
    s_add_u32 s32, s34, 0x400000
    s_add_u32 s33, s32, 4096
    buffer_store_dwordx4 v[32:35], v251, s[4:7], s32 offen offset:0 sc1
    buffer_store_dwordx4 v[36:39], v251, s[4:7], s32 offen offset:1024 sc1
    buffer_store_dwordx4 v[40:43], v251, s[4:7], s32 offen offset:2048 sc1
    buffer_store_dwordx4 v[44:47], v251, s[4:7], s32 offen offset:3072 sc1
    buffer_store_dwordx4 v[48:51], v251, s[4:7], s33 offen offset:0 sc1
    buffer_store_dwordx4 v[52:55], v251, s[4:7], s33 offen offset:1024 sc1
    buffer_store_dwordx4 v[56:59], v251, s[4:7], s33 offen offset:2048 sc1
    buffer_store_dwordx4 v[60:63], v251, s[4:7], s33 offen offset:3072 sc1
    s_add_u32 s16, s16, 4
    s_branch main_kernel_s_wa2_ok
main_kernel_s_fill:
    s_lshl_b32 s32, s16, 14
    s_add_u32 s34, s32, 0x6c00000
    buffer_store_dwordx4 v[8:11], v1, s[4:7], s34 offen sc1
    s_add_u32 s34, s32, 0x6c01000
    buffer_store_dwordx4 v[8:11], v1, s[4:7], s34 offen sc1
    s_add_u32 s34, s32, 0x6c02000
    buffer_store_dwordx4 v[8:11], v1, s[4:7], s34 offen sc1
    s_add_u32 s34, s32, 0x6c03000
    buffer_store_dwordx4 v[8:11], v1, s[4:7], s34 offen sc1
    s_lshl_b32 s32, s16, 14
    s_add_u32 s34, s32, 0x8c00000
    buffer_store_dwordx4 v[8:11], v1, s[4:7], s34 offen sc1
    s_add_u32 s34, s32, 0x8c01000
    buffer_store_dwordx4 v[8:11], v1, s[4:7], s34 offen sc1
    s_add_u32 s34, s32, 0x8c02000
    buffer_store_dwordx4 v[8:11], v1, s[4:7], s34 offen sc1
    s_add_u32 s34, s32, 0x8c03000
    buffer_store_dwordx4 v[8:11], v1, s[4:7], s34 offen sc1
    s_add_u32 s34, s32, 0x8d00000
    buffer_store_dwordx4 v[8:11], v1, s[4:7], s34 offen sc1
    s_add_u32 s34, s32, 0x8d01000
    buffer_store_dwordx4 v[8:11], v1, s[4:7], s34 offen sc1
    s_add_u32 s34, s32, 0x8d02000
    buffer_store_dwordx4 v[8:11], v1, s[4:7], s34 offen sc1
    s_add_u32 s34, s32, 0x8d03000
    buffer_store_dwordx4 v[8:11], v1, s[4:7], s34 offen sc1
    s_lshl_b32 s32, s16, 2
    s_lshl_b32 s32, s16, 12
    s_add_u32 s33, s32, 0x8c00000
    s_add_u32 s34, s32, 0x6e00000
    buffer_store_dwordx4 v[8:11], v1, s[4:7], s34 offen sc1
    s_add_u32 s32, s32, 0x8000000
    buffer_store_dwordx4 v[8:11], v1, s[4:7], s32 offen sc1
    s_lshl_b32 s16, s16, 2
    s_add_u32 s16, s16, 0x841f000
    s_cmp_lg_u32 s16, 0x841f034
    s_cbranch_scc1 main_kernel_s_fd
    s_mov_b32 s8, s76
    s_and_b32 s9, s77, 0xffff
    s_mov_b32 s10, 0x4000
    s_mov_b32 s11, 0x20000
    v_and_b32 v2, 7, v0
    v_lshlrev_b32 v2, 11, v2
    v_lshrrev_b32 v3, 6, v0
    v_lshl_add_u32 v2, v3, 7, v2
    v_bfe_u32 v3, v0, 4, 2
    v_lshl_add_u32 v2, v3, 5, v2
    v_bfe_u32 v3, v0, 3, 1
    v_lshl_add_u32 v2, v3, 4, v2
    buffer_load_dwordx4 v[16:19], v2, s[8:11], 0 offen offset:0
    buffer_load_dwordx4 v[20:23], v2, s[8:11], 0 offen offset:512
    buffer_load_dwordx4 v[24:27], v2, s[8:11], 0 offen offset:1024
    buffer_load_dwordx4 v[28:31], v2, s[8:11], 0 offen offset:1536
    s_mov_b32 s32, 0x6d00000
    s_waitcnt vmcnt(0)
    buffer_store_dwordx4 v[16:19], v1, s[4:7], s32 offen sc1
    s_add_u32 s32, s32, 4096
    buffer_store_dwordx4 v[20:23], v1, s[4:7], s32 offen sc1
    s_add_u32 s32, s32, 4096
    buffer_store_dwordx4 v[24:27], v1, s[4:7], s32 offen sc1
    s_add_u32 s32, s32, 4096
    buffer_store_dwordx4 v[28:31], v1, s[4:7], s32 offen sc1
    s_add_u32 s32, s32, 4096
    buffer_store_dwordx4 v[8:11], v1, s[4:7], s32 offen sc1
    s_add_u32 s32, s32, 4096
    buffer_store_dwordx4 v[8:11], v1, s[4:7], s32 offen sc1
    s_add_u32 s32, s32, 4096
    buffer_store_dwordx4 v[8:11], v1, s[4:7], s32 offen sc1
    s_add_u32 s32, s32, 4096
    buffer_store_dwordx4 v[8:11], v1, s[4:7], s32 offen sc1
    s_add_u32 s32, s32, 4096
    v_xor_b32 v2, 0, v1
    v_mov_b32 v2, 0
main_kernel_s_wa3:
    buffer_load_dword v3, v2, s[60:63], 0 offen offset:12 sc1
    s_waitcnt vmcnt(0)
    v_cmp_gt_u32 vcc, 4, v3
    s_cbranch_vccz main_kernel_s_wa3_ok
    s_sleep 4
    s_sub_u32 s29, s29, 1
    s_cbranch_scc0 main_kernel_s_wa3
    s_branch main_kernel_end
main_kernel_s_wa3_ok:
    v_lshlrev_b32 v2, 8, v250
    s_mov_b32 s32, 0x8418100
    s_mov_b64 exec, 15
    buffer_store_dwordx4 v[8:11], v2, s[4:7], s32 offen sc1
    s_mov_b64 exec, -1
main_kernel_s_fd:
    s_cmp_lg_u32 s14, 0
    s_cbranch_scc1 main_kernel_s_wa2_ok
    v_mov_b32 v2, 0
main_kernel_s_wa2:
    buffer_load_dword v3, v2, s[60:63], 0 offen offset:12 sc1
    s_waitcnt vmcnt(0)
    v_cmp_gt_u32 vcc, 4, v3
    s_cbranch_vccz main_kernel_s_wa2_ok
    s_sleep 4
    s_sub_u32 s29, s29, 1
    s_cbranch_scc0 main_kernel_s_wa2
    s_branch main_kernel_end
main_kernel_s_wa2_ok:
    s_waitcnt vmcnt(0)
    s_barrier
    s_cmp_lg_u32 s14, 0
    s_cbranch_scc1 main_kernel_s_end
    s_mov_b64 exec, 1
    buffer_store_dword v8, v4, s[4:7], s16 offen sc1
    s_mov_b64 exec, -1
main_kernel_s_end:
    s_lshl_b32 s32, s12, 5
    s_add_u32 s32, s32, s13
    s_sub_u32 s32, s32, 96
    s_cmp_lt_u32 s32, 16
    s_cbranch_scc1 main_kernel_att
    s_branch main_kernel_worker
main_kernel_end:
    s_endpgm
main_kernel_chain:
    s_lshl_b32 s36, s14, 15
    s_add_u32 s36, s36, 32768
    v_lshlrev_b32 v116, 4, v94
    v_add_u32 v113, s36, v116
    v_lshrrev_b32 v126, 4, v94
    v_and_b32 v127, 15, v94
    v_lshlrev_b32 v95, 2, v126
    v_xor_b32 v127, v127, v95
    v_lshlrev_b32 v127, 4, v127
    v_and_b32 v95, 1, v126
    v_lshrrev_b32 v126, 1, v126
    v_lshl_add_u32 v127, v126, 15, v127
    v_lshl_add_u32 v65, v95, 13, v127
    v_lshl_add_u32 v66, v95, 11, v127
    s_lshr_b32 s32, s14, 1
    s_lshl_b32 s32, s32, 5
    v_xor_b32 v64, s32, v65
    v_bfe_u32 v127, v94, 2, 1
    v_bfe_u32 v95, v94, 4, 1
    v_lshl_add_u32 v78, v95, 1, v127
    v_lshl_add_u32 v126, v126, 3, v78
    v_and_b32 v127, 3, v94
    v_lshlrev_b32 v127, 3, v127
    v_lshl_add_u32 v71, v126, 8, v127
    v_bfe_u32 v95, v94, 3, 1
    v_lshl_add_u32 v71, v95, 5, v71
    v_xor_b32 v126, s14, v78
    v_lshl_add_u32 v126, v126, 6, v71
    v_add_u32 v69, 32768, v126
    v_add_u32 v70, 0x10000, v69
    v_lshl_add_u32 v126, v78, 6, v71
    v_add_u32 v80, s36, v126
    s_lshl_b32 s32, s14, 5
    s_add_u32 s32, s32, 32768
    v_xor_b32 v126, s32, v126
    v_lshl_add_u32 v67, v95, 16, v126
    v_xor_b32 v68, 0x80, v67
    v_xor_b32 v81, 64, v80
    v_xor_b32 v82, 128, v80
    v_xor_b32 v83, 192, v80
    v_and_b32 v126, 7, v94
    v_lshl_add_u32 v126, s13, 3, v126
    v_lshlrev_b32 v77, 10, v126
    s_lshl_b32 s32, s12, 22
    s_lshl_b32 s33, s13, 8
    s_add_u32 s32, s32, s33
    s_lshl_b32 s33, s14, 18
    s_add_u32 s35, s32, s33
    s_bitset0_b32 s33, 19
    s_add_u32 s34, s32, s33
    s_lshl_b32 s3, s13, 18
    s_lshl2_add_u32 s32, s12, s14
    s_lshl_b32 s32, s32, 8
    s_add_u32 s3, s3, s32
    s_cmp_lt_u32 s14, 2
    s_cbranch_scc1 main_kernel_c_pq
    s_mov_b64 s[40:41], s[42:43]
main_kernel_c_pq:
    v_min_u32 v73, 8, v94
    v_lshlrev_b32 v73, 5, v73
    v_mov_b32 v126, 12
    v_cmp_gt_u32 vcc, 8, v94
    v_lshlrev_b32 v74, 2, v94
    v_add_u32 v74, 0x841f000, v74
    v_cndmask_b32 v73, v126, v73, vcc
    v_and_b32 v75, 1, v94
    s_lshl_b32 s32, s13, 8
    s_add_u32 s32, s32, 0x8406000
    v_lshl_add_u32 v75, v75, 13, s32
    s_mov_b32 s8, s44
    s_and_b32 s9, s45, 0xffff
    s_mov_b32 s10, 0x800000
    s_mov_b32 s11, 0x20000
    s_sub_u32 s39, 511, s44
    s_and_b32 s39, s39, 0x380
    s_andn2_b32 s32, s35, 0x1fff
    s_add_u32 s39, s39, s32
    s_add_u32 s32, s39, 0x0
    buffer_load_dword v86, v77, s[8:11], s32 offen
    s_add_u32 s32, s35, 0x0
    s_add_u32 m0, s36, 0
    s_nop 0
    buffer_load_dwordx4 v65, s[8:11], s32 offen lds
    s_add_u32 s32, s35, 0x4000
    s_add_u32 m0, s36, 1024
    s_nop 0
    buffer_load_dwordx4 v65, s[8:11], s32 offen lds
    s_add_u32 s32, s35, 0x10000
    s_add_u32 m0, s36, 2048
    s_nop 0
    buffer_load_dwordx4 v65, s[8:11], s32 offen lds
    s_add_u32 s32, s35, 0x14000
    s_add_u32 m0, s36, 3072
    s_nop 0
    buffer_load_dwordx4 v65, s[8:11], s32 offen lds
    s_add_u32 s32, s35, 0x20000
    s_add_u32 m0, s36, 4096
    s_nop 0
    buffer_load_dwordx4 v65, s[8:11], s32 offen lds
    s_add_u32 s32, s35, 0x24000
    s_add_u32 m0, s36, 5120
    s_nop 0
    buffer_load_dwordx4 v65, s[8:11], s32 offen lds
    s_add_u32 s32, s35, 0x30000
    s_add_u32 m0, s36, 6144
    s_nop 0
    buffer_load_dwordx4 v65, s[8:11], s32 offen lds
    s_add_u32 s32, s35, 0x34000
    s_add_u32 m0, s36, 7168
    s_nop 0
    buffer_load_dwordx4 v65, s[8:11], s32 offen lds
    s_add_u32 s32, s39, 0x100000
    buffer_load_dword v86, v77, s[8:11], s32 offen
    s_add_u32 s32, s35, 0x100000
    s_add_u32 m0, s36, 8192
    s_nop 0
    buffer_load_dwordx4 v65, s[8:11], s32 offen lds
    s_add_u32 s32, s35, 0x104000
    s_add_u32 m0, s36, 9216
    s_nop 0
    buffer_load_dwordx4 v65, s[8:11], s32 offen lds
    s_add_u32 s32, s35, 0x110000
    s_add_u32 m0, s36, 10240
    s_nop 0
    buffer_load_dwordx4 v65, s[8:11], s32 offen lds
    s_add_u32 s32, s35, 0x114000
    s_add_u32 m0, s36, 11264
    s_nop 0
    buffer_load_dwordx4 v65, s[8:11], s32 offen lds
    s_add_u32 s32, s35, 0x120000
    s_add_u32 m0, s36, 12288
    s_nop 0
    buffer_load_dwordx4 v65, s[8:11], s32 offen lds
    s_add_u32 s32, s35, 0x124000
    s_add_u32 m0, s36, 13312
    s_nop 0
    buffer_load_dwordx4 v65, s[8:11], s32 offen lds
    s_add_u32 s32, s35, 0x130000
    s_add_u32 m0, s36, 14336
    s_nop 0
    buffer_load_dwordx4 v65, s[8:11], s32 offen lds
    s_add_u32 s32, s35, 0x134000
    s_add_u32 m0, s36, 15360
    s_nop 0
    buffer_load_dwordx4 v65, s[8:11], s32 offen lds
    s_mov_b32 s8, s40
    s_and_b32 s9, s41, 0xffff
    s_mov_b32 s10, 0x800000
    s_mov_b32 s11, 0x20000
    s_sub_u32 s39, 511, s40
    s_and_b32 s39, s39, 0x380
    s_andn2_b32 s32, s34, 0x1fff
    s_add_u32 s39, s39, s32
    s_add_u32 s32, s39, 0x0
    buffer_load_dword v86, v77, s[8:11], s32 offen
    s_add_u32 s32, s34, 0x0
    s_add_u32 m0, s36, 16384
    s_nop 0
    buffer_load_dwordx4 v64, s[8:11], s32 offen lds
    s_add_u32 s32, s34, 0x4000
    s_add_u32 m0, s36, 17408
    s_nop 0
    buffer_load_dwordx4 v64, s[8:11], s32 offen lds
    s_add_u32 s32, s34, 0x10000
    s_add_u32 m0, s36, 18432
    s_nop 0
    buffer_load_dwordx4 v64, s[8:11], s32 offen lds
    s_add_u32 s32, s34, 0x14000
    s_add_u32 m0, s36, 19456
    s_nop 0
    buffer_load_dwordx4 v64, s[8:11], s32 offen lds
    s_add_u32 s32, s34, 0x20000
    s_add_u32 m0, s36, 20480
    s_nop 0
    buffer_load_dwordx4 v64, s[8:11], s32 offen lds
    s_add_u32 s32, s34, 0x24000
    s_add_u32 m0, s36, 21504
    s_nop 0
    buffer_load_dwordx4 v64, s[8:11], s32 offen lds
    s_add_u32 s32, s34, 0x30000
    s_add_u32 m0, s36, 22528
    s_nop 0
    buffer_load_dwordx4 v64, s[8:11], s32 offen lds
    s_add_u32 s32, s34, 0x34000
    s_add_u32 m0, s36, 23552
    s_nop 0
    buffer_load_dwordx4 v64, s[8:11], s32 offen lds
    s_add_u32 s32, s39, 0x80000
    buffer_load_dword v86, v77, s[8:11], s32 offen
    s_add_u32 s32, s34, 0x80000
    s_add_u32 m0, s36, 24576
    s_nop 0
    buffer_load_dwordx4 v64, s[8:11], s32 offen lds
    s_add_u32 s32, s34, 0x84000
    s_add_u32 m0, s36, 25600
    s_nop 0
    buffer_load_dwordx4 v64, s[8:11], s32 offen lds
    s_add_u32 s32, s34, 0x90000
    s_add_u32 m0, s36, 26624
    s_nop 0
    buffer_load_dwordx4 v64, s[8:11], s32 offen lds
    s_add_u32 s32, s34, 0x94000
    s_add_u32 m0, s36, 27648
    s_nop 0
    buffer_load_dwordx4 v64, s[8:11], s32 offen lds
    s_add_u32 s32, s34, 0xa0000
    s_add_u32 m0, s36, 28672
    s_nop 0
    buffer_load_dwordx4 v64, s[8:11], s32 offen lds
    s_add_u32 s32, s34, 0xa4000
    s_add_u32 m0, s36, 29696
    s_nop 0
    buffer_load_dwordx4 v64, s[8:11], s32 offen lds
    s_add_u32 s32, s34, 0xb0000
    s_add_u32 m0, s36, 30720
    s_nop 0
    buffer_load_dwordx4 v64, s[8:11], s32 offen lds
    s_add_u32 s32, s34, 0xb4000
    s_add_u32 m0, s36, 31744
    s_nop 0
    buffer_load_dwordx4 v64, s[8:11], s32 offen lds
    s_waitcnt vmcnt(27)
    s_barrier
    ds_read_b64_tr_b16 v[128:129], v69 offset:0
    ds_read_b64_tr_b16 v[130:131], v69 offset:1024
    ds_read_b64_tr_b16 v[132:133], v69 offset:4096
    ds_read_b64_tr_b16 v[134:135], v69 offset:5120
    ds_read_b64_tr_b16 v[136:137], v69 offset:32768
    ds_read_b64_tr_b16 v[138:139], v69 offset:33792
    ds_read_b64_tr_b16 v[140:141], v69 offset:36864
    ds_read_b64_tr_b16 v[142:143], v69 offset:37888
    ds_read_b64_tr_b16 v[144:145], v70 offset:0
    ds_read_b64_tr_b16 v[146:147], v70 offset:1024
    ds_read_b64_tr_b16 v[148:149], v70 offset:4096
    ds_read_b64_tr_b16 v[150:151], v70 offset:5120
    ds_read_b64_tr_b16 v[152:153], v70 offset:32768
    ds_read_b64_tr_b16 v[154:155], v70 offset:33792
    ds_read_b64_tr_b16 v[156:157], v70 offset:36864
    ds_read_b64_tr_b16 v[158:159], v70 offset:37888
    s_waitcnt lgkmcnt(0)
    s_waitcnt vmcnt(18)
    s_barrier
    s_add_u32 s32, s39, 0x100000
    buffer_load_dword v86, v77, s[8:11], s32 offen
    s_add_u32 s32, s34, 0x100000
    s_add_u32 m0, s36, 0
    s_nop 0
    buffer_load_dwordx4 v64, s[8:11], s32 offen lds
    s_add_u32 s32, s34, 0x104000
    s_add_u32 m0, s36, 1024
    s_nop 0
    buffer_load_dwordx4 v64, s[8:11], s32 offen lds
    s_add_u32 s32, s34, 0x110000
    s_add_u32 m0, s36, 2048
    s_nop 0
    buffer_load_dwordx4 v64, s[8:11], s32 offen lds
    s_add_u32 s32, s34, 0x114000
    s_add_u32 m0, s36, 3072
    s_nop 0
    buffer_load_dwordx4 v64, s[8:11], s32 offen lds
    s_add_u32 s32, s34, 0x120000
    s_add_u32 m0, s36, 4096
    s_nop 0
    buffer_load_dwordx4 v64, s[8:11], s32 offen lds
    s_add_u32 s32, s34, 0x124000
    s_add_u32 m0, s36, 5120
    s_nop 0
    buffer_load_dwordx4 v64, s[8:11], s32 offen lds
    s_add_u32 s32, s34, 0x130000
    s_add_u32 m0, s36, 6144
    s_nop 0
    buffer_load_dwordx4 v64, s[8:11], s32 offen lds
    s_add_u32 s32, s34, 0x134000
    s_add_u32 m0, s36, 7168
    s_nop 0
    buffer_load_dwordx4 v64, s[8:11], s32 offen lds
    ds_read_b64_tr_b16 v[160:161], v69 offset:8192
    ds_read_b64_tr_b16 v[162:163], v69 offset:9216
    ds_read_b64_tr_b16 v[164:165], v69 offset:12288
    ds_read_b64_tr_b16 v[166:167], v69 offset:13312
    ds_read_b64_tr_b16 v[168:169], v69 offset:40960
    ds_read_b64_tr_b16 v[170:171], v69 offset:41984
    ds_read_b64_tr_b16 v[172:173], v69 offset:45056
    ds_read_b64_tr_b16 v[174:175], v69 offset:46080
    ds_read_b64_tr_b16 v[176:177], v70 offset:8192
    ds_read_b64_tr_b16 v[178:179], v70 offset:9216
    ds_read_b64_tr_b16 v[180:181], v70 offset:12288
    ds_read_b64_tr_b16 v[182:183], v70 offset:13312
    ds_read_b64_tr_b16 v[184:185], v70 offset:40960
    ds_read_b64_tr_b16 v[186:187], v70 offset:41984
    ds_read_b64_tr_b16 v[188:189], v70 offset:45056
    ds_read_b64_tr_b16 v[190:191], v70 offset:46080
    s_waitcnt lgkmcnt(0)
    s_waitcnt vmcnt(18)
    s_barrier
    s_add_u32 s32, s39, 0x180000
    buffer_load_dword v86, v77, s[8:11], s32 offen
    s_add_u32 s32, s34, 0x180000
    s_add_u32 m0, s36, 8192
    s_nop 0
    buffer_load_dwordx4 v64, s[8:11], s32 offen lds
    s_add_u32 s32, s34, 0x184000
    s_add_u32 m0, s36, 9216
    s_nop 0
    buffer_load_dwordx4 v64, s[8:11], s32 offen lds
    s_add_u32 s32, s34, 0x190000
    s_add_u32 m0, s36, 10240
    s_nop 0
    buffer_load_dwordx4 v64, s[8:11], s32 offen lds
    s_add_u32 s32, s34, 0x194000
    s_add_u32 m0, s36, 11264
    s_nop 0
    buffer_load_dwordx4 v64, s[8:11], s32 offen lds
    s_add_u32 s32, s34, 0x1a0000
    s_add_u32 m0, s36, 12288
    s_nop 0
    buffer_load_dwordx4 v64, s[8:11], s32 offen lds
    s_add_u32 s32, s34, 0x1a4000
    s_add_u32 m0, s36, 13312
    s_nop 0
    buffer_load_dwordx4 v64, s[8:11], s32 offen lds
    s_add_u32 s32, s34, 0x1b0000
    s_add_u32 m0, s36, 14336
    s_nop 0
    buffer_load_dwordx4 v64, s[8:11], s32 offen lds
    s_add_u32 s32, s34, 0x1b4000
    s_add_u32 m0, s36, 15360
    s_nop 0
    buffer_load_dwordx4 v64, s[8:11], s32 offen lds
    ds_read_b64_tr_b16 a[0:1], v67 offset:16384
    ds_read_b64_tr_b16 a[2:3], v67 offset:17408
    ds_read_b64_tr_b16 a[4:5], v67 offset:20480
    ds_read_b64_tr_b16 a[6:7], v67 offset:21504
    ds_read_b64_tr_b16 a[8:9], v67 offset:49152
    ds_read_b64_tr_b16 a[10:11], v67 offset:50176
    ds_read_b64_tr_b16 a[12:13], v67 offset:53248
    ds_read_b64_tr_b16 a[14:15], v67 offset:54272
    ds_read_b64_tr_b16 a[128:129], v68 offset:16384
    ds_read_b64_tr_b16 a[130:131], v68 offset:17408
    ds_read_b64_tr_b16 a[132:133], v68 offset:20480
    ds_read_b64_tr_b16 a[134:135], v68 offset:21504
    ds_read_b64_tr_b16 a[136:137], v68 offset:49152
    ds_read_b64_tr_b16 a[138:139], v68 offset:50176
    ds_read_b64_tr_b16 a[140:141], v68 offset:53248
    ds_read_b64_tr_b16 a[142:143], v68 offset:54272
    s_waitcnt lgkmcnt(0)
    s_waitcnt vmcnt(18)
    s_barrier
    s_add_u32 s32, s39, 0x200000
    buffer_load_dword v86, v77, s[8:11], s32 offen
    s_add_u32 s32, s34, 0x200000
    s_add_u32 m0, s36, 16384
    s_nop 0
    buffer_load_dwordx4 v64, s[8:11], s32 offen lds
    s_add_u32 s32, s34, 0x204000
    s_add_u32 m0, s36, 17408
    s_nop 0
    buffer_load_dwordx4 v64, s[8:11], s32 offen lds
    s_add_u32 s32, s34, 0x210000
    s_add_u32 m0, s36, 18432
    s_nop 0
    buffer_load_dwordx4 v64, s[8:11], s32 offen lds
    s_add_u32 s32, s34, 0x214000
    s_add_u32 m0, s36, 19456
    s_nop 0
    buffer_load_dwordx4 v64, s[8:11], s32 offen lds
    s_add_u32 s32, s34, 0x220000
    s_add_u32 m0, s36, 20480
    s_nop 0
    buffer_load_dwordx4 v64, s[8:11], s32 offen lds
    s_add_u32 s32, s34, 0x224000
    s_add_u32 m0, s36, 21504
    s_nop 0
    buffer_load_dwordx4 v64, s[8:11], s32 offen lds
    s_add_u32 s32, s34, 0x230000
    s_add_u32 m0, s36, 22528
    s_nop 0
    buffer_load_dwordx4 v64, s[8:11], s32 offen lds
    s_add_u32 s32, s34, 0x234000
    s_add_u32 m0, s36, 23552
    s_nop 0
    buffer_load_dwordx4 v64, s[8:11], s32 offen lds
    ds_read_b64_tr_b16 a[16:17], v67 offset:24576
    ds_read_b64_tr_b16 a[18:19], v67 offset:25600
    ds_read_b64_tr_b16 a[20:21], v67 offset:28672
    ds_read_b64_tr_b16 a[22:23], v67 offset:29696
    ds_read_b64_tr_b16 a[24:25], v67 offset:57344
    ds_read_b64_tr_b16 a[26:27], v67 offset:58368
    ds_read_b64_tr_b16 a[28:29], v67 offset:61440
    ds_read_b64_tr_b16 a[30:31], v67 offset:62464
    ds_read_b64_tr_b16 a[144:145], v68 offset:24576
    ds_read_b64_tr_b16 a[146:147], v68 offset:25600
    ds_read_b64_tr_b16 a[148:149], v68 offset:28672
    ds_read_b64_tr_b16 a[150:151], v68 offset:29696
    ds_read_b64_tr_b16 a[152:153], v68 offset:57344
    ds_read_b64_tr_b16 a[154:155], v68 offset:58368
    ds_read_b64_tr_b16 a[156:157], v68 offset:61440
    ds_read_b64_tr_b16 a[158:159], v68 offset:62464
    s_waitcnt lgkmcnt(0)
    s_waitcnt vmcnt(18)
    s_barrier
    s_add_u32 s32, s39, 0x280000
    buffer_load_dword v86, v77, s[8:11], s32 offen
    s_add_u32 s32, s34, 0x280000
    s_add_u32 m0, s36, 24576
    s_nop 0
    buffer_load_dwordx4 v64, s[8:11], s32 offen lds
    s_add_u32 s32, s34, 0x284000
    s_add_u32 m0, s36, 25600
    s_nop 0
    buffer_load_dwordx4 v64, s[8:11], s32 offen lds
    s_add_u32 s32, s34, 0x290000
    s_add_u32 m0, s36, 26624
    s_nop 0
    buffer_load_dwordx4 v64, s[8:11], s32 offen lds
    s_add_u32 s32, s34, 0x294000
    s_add_u32 m0, s36, 27648
    s_nop 0
    buffer_load_dwordx4 v64, s[8:11], s32 offen lds
    s_add_u32 s32, s34, 0x2a0000
    s_add_u32 m0, s36, 28672
    s_nop 0
    buffer_load_dwordx4 v64, s[8:11], s32 offen lds
    s_add_u32 s32, s34, 0x2a4000
    s_add_u32 m0, s36, 29696
    s_nop 0
    buffer_load_dwordx4 v64, s[8:11], s32 offen lds
    s_add_u32 s32, s34, 0x2b0000
    s_add_u32 m0, s36, 30720
    s_nop 0
    buffer_load_dwordx4 v64, s[8:11], s32 offen lds
    s_add_u32 s32, s34, 0x2b4000
    s_add_u32 m0, s36, 31744
    s_nop 0
    buffer_load_dwordx4 v64, s[8:11], s32 offen lds
    ds_read_b64_tr_b16 a[32:33], v67 offset:0
    ds_read_b64_tr_b16 a[34:35], v67 offset:1024
    ds_read_b64_tr_b16 a[36:37], v67 offset:4096
    ds_read_b64_tr_b16 a[38:39], v67 offset:5120
    ds_read_b64_tr_b16 a[40:41], v67 offset:32768
    ds_read_b64_tr_b16 a[42:43], v67 offset:33792
    ds_read_b64_tr_b16 a[44:45], v67 offset:36864
    ds_read_b64_tr_b16 a[46:47], v67 offset:37888
    ds_read_b64_tr_b16 a[160:161], v68 offset:0
    ds_read_b64_tr_b16 a[162:163], v68 offset:1024
    ds_read_b64_tr_b16 a[164:165], v68 offset:4096
    ds_read_b64_tr_b16 a[166:167], v68 offset:5120
    ds_read_b64_tr_b16 a[168:169], v68 offset:32768
    ds_read_b64_tr_b16 a[170:171], v68 offset:33792
    ds_read_b64_tr_b16 a[172:173], v68 offset:36864
    ds_read_b64_tr_b16 a[174:175], v68 offset:37888
    s_waitcnt lgkmcnt(0)
    s_waitcnt vmcnt(18)
    s_barrier
    s_add_u32 s32, s39, 0x300000
    buffer_load_dword v86, v77, s[8:11], s32 offen
    s_add_u32 s32, s34, 0x300000
    s_add_u32 m0, s36, 0
    s_nop 0
    buffer_load_dwordx4 v64, s[8:11], s32 offen lds
    s_add_u32 s32, s34, 0x304000
    s_add_u32 m0, s36, 1024
    s_nop 0
    buffer_load_dwordx4 v64, s[8:11], s32 offen lds
    s_add_u32 s32, s34, 0x310000
    s_add_u32 m0, s36, 2048
    s_nop 0
    buffer_load_dwordx4 v64, s[8:11], s32 offen lds
    s_add_u32 s32, s34, 0x314000
    s_add_u32 m0, s36, 3072
    s_nop 0
    buffer_load_dwordx4 v64, s[8:11], s32 offen lds
    s_add_u32 s32, s34, 0x320000
    s_add_u32 m0, s36, 4096
    s_nop 0
    buffer_load_dwordx4 v64, s[8:11], s32 offen lds
    s_add_u32 s32, s34, 0x324000
    s_add_u32 m0, s36, 5120
    s_nop 0
    buffer_load_dwordx4 v64, s[8:11], s32 offen lds
    s_add_u32 s32, s34, 0x330000
    s_add_u32 m0, s36, 6144
    s_nop 0
    buffer_load_dwordx4 v64, s[8:11], s32 offen lds
    s_add_u32 s32, s34, 0x334000
    s_add_u32 m0, s36, 7168
    s_nop 0
    buffer_load_dwordx4 v64, s[8:11], s32 offen lds
    ds_read_b64_tr_b16 a[48:49], v67 offset:8192
    ds_read_b64_tr_b16 a[50:51], v67 offset:9216
    ds_read_b64_tr_b16 a[52:53], v67 offset:12288
    ds_read_b64_tr_b16 a[54:55], v67 offset:13312
    ds_read_b64_tr_b16 a[56:57], v67 offset:40960
    ds_read_b64_tr_b16 a[58:59], v67 offset:41984
    ds_read_b64_tr_b16 a[60:61], v67 offset:45056
    ds_read_b64_tr_b16 a[62:63], v67 offset:46080
    ds_read_b64_tr_b16 a[176:177], v68 offset:8192
    ds_read_b64_tr_b16 a[178:179], v68 offset:9216
    ds_read_b64_tr_b16 a[180:181], v68 offset:12288
    ds_read_b64_tr_b16 a[182:183], v68 offset:13312
    ds_read_b64_tr_b16 a[184:185], v68 offset:40960
    ds_read_b64_tr_b16 a[186:187], v68 offset:41984
    ds_read_b64_tr_b16 a[188:189], v68 offset:45056
    ds_read_b64_tr_b16 a[190:191], v68 offset:46080
    s_waitcnt lgkmcnt(0)
    s_waitcnt vmcnt(18)
    s_barrier
    s_add_u32 s32, s39, 0x380000
    buffer_load_dword v86, v77, s[8:11], s32 offen
    s_add_u32 s32, s34, 0x380000
    s_add_u32 m0, s36, 8192
    s_nop 0
    buffer_load_dwordx4 v64, s[8:11], s32 offen lds
    s_add_u32 s32, s34, 0x384000
    s_add_u32 m0, s36, 9216
    s_nop 0
    buffer_load_dwordx4 v64, s[8:11], s32 offen lds
    s_add_u32 s32, s34, 0x390000
    s_add_u32 m0, s36, 10240
    s_nop 0
    buffer_load_dwordx4 v64, s[8:11], s32 offen lds
    s_add_u32 s32, s34, 0x394000
    s_add_u32 m0, s36, 11264
    s_nop 0
    buffer_load_dwordx4 v64, s[8:11], s32 offen lds
    s_add_u32 s32, s34, 0x3a0000
    s_add_u32 m0, s36, 12288
    s_nop 0
    buffer_load_dwordx4 v64, s[8:11], s32 offen lds
    s_add_u32 s32, s34, 0x3a4000
    s_add_u32 m0, s36, 13312
    s_nop 0
    buffer_load_dwordx4 v64, s[8:11], s32 offen lds
    s_add_u32 s32, s34, 0x3b0000
    s_add_u32 m0, s36, 14336
    s_nop 0
    buffer_load_dwordx4 v64, s[8:11], s32 offen lds
    s_add_u32 s32, s34, 0x3b4000
    s_add_u32 m0, s36, 15360
    s_nop 0
    buffer_load_dwordx4 v64, s[8:11], s32 offen lds
    ds_read_b64_tr_b16 a[64:65], v67 offset:16384
    ds_read_b64_tr_b16 a[66:67], v67 offset:17408
    ds_read_b64_tr_b16 a[68:69], v67 offset:20480
    ds_read_b64_tr_b16 a[70:71], v67 offset:21504
    ds_read_b64_tr_b16 a[72:73], v67 offset:49152
    ds_read_b64_tr_b16 a[74:75], v67 offset:50176
    ds_read_b64_tr_b16 a[76:77], v67 offset:53248
    ds_read_b64_tr_b16 a[78:79], v67 offset:54272
    ds_read_b64_tr_b16 a[192:193], v68 offset:16384
    ds_read_b64_tr_b16 a[194:195], v68 offset:17408
    ds_read_b64_tr_b16 a[196:197], v68 offset:20480
    ds_read_b64_tr_b16 a[198:199], v68 offset:21504
    ds_read_b64_tr_b16 a[200:201], v68 offset:49152
    ds_read_b64_tr_b16 a[202:203], v68 offset:50176
    ds_read_b64_tr_b16 a[204:205], v68 offset:53248
    ds_read_b64_tr_b16 a[206:207], v68 offset:54272
    s_waitcnt lgkmcnt(0)
    buffer_load_dword v72, v73, s[60:63], 0 offen sc1
    buffer_load_dwordx2 v[84:85], off, s[60:63], 0 offset:16 sc1
    s_waitcnt vmcnt(20)
    s_barrier
    s_mov_b32 s8, s46
    s_and_b32 s9, s47, 0xffff
    s_mov_b32 s10, 0x800000
    s_mov_b32 s11, 0x20000
    s_xor_b32 s32, s3, 0x0
    s_add_u32 m0, s36, 16384
    s_nop 0
    buffer_load_dwordx4 v66, s[8:11], s32 offen lds
    s_xor_b32 s32, s3, 0x1000
    s_add_u32 m0, s36, 17408
    s_nop 0
    buffer_load_dwordx4 v66, s[8:11], s32 offen lds
    s_xor_b32 s32, s3, 0x2000
    s_add_u32 m0, s36, 18432
    s_nop 0
    buffer_load_dwordx4 v66, s[8:11], s32 offen lds
    s_xor_b32 s32, s3, 0x3000
    s_add_u32 m0, s36, 19456
    s_nop 0
    buffer_load_dwordx4 v66, s[8:11], s32 offen lds
    s_xor_b32 s32, s3, 0x4000
    s_add_u32 m0, s36, 20480
    s_nop 0
    buffer_load_dwordx4 v66, s[8:11], s32 offen lds
    s_xor_b32 s32, s3, 0x5000
    s_add_u32 m0, s36, 21504
    s_nop 0
    buffer_load_dwordx4 v66, s[8:11], s32 offen lds
    s_xor_b32 s32, s3, 0x6000
    s_add_u32 m0, s36, 22528
    s_nop 0
    buffer_load_dwordx4 v66, s[8:11], s32 offen lds
    s_xor_b32 s32, s3, 0x7000
    s_add_u32 m0, s36, 23552
    s_nop 0
    buffer_load_dwordx4 v66, s[8:11], s32 offen lds
    ds_read_b64_tr_b16 a[80:81], v67 offset:24576
    ds_read_b64_tr_b16 a[82:83], v67 offset:25600
    ds_read_b64_tr_b16 a[84:85], v67 offset:28672
    ds_read_b64_tr_b16 a[86:87], v67 offset:29696
    ds_read_b64_tr_b16 a[88:89], v67 offset:57344
    ds_read_b64_tr_b16 a[90:91], v67 offset:58368
    ds_read_b64_tr_b16 a[92:93], v67 offset:61440
    ds_read_b64_tr_b16 a[94:95], v67 offset:62464
    ds_read_b64_tr_b16 a[208:209], v68 offset:24576
    ds_read_b64_tr_b16 a[210:211], v68 offset:25600
    ds_read_b64_tr_b16 a[212:213], v68 offset:28672
    ds_read_b64_tr_b16 a[214:215], v68 offset:29696
    ds_read_b64_tr_b16 a[216:217], v68 offset:57344
    ds_read_b64_tr_b16 a[218:219], v68 offset:58368
    ds_read_b64_tr_b16 a[220:221], v68 offset:61440
    ds_read_b64_tr_b16 a[222:223], v68 offset:62464
    s_waitcnt lgkmcnt(0)
    s_waitcnt vmcnt(19)
    s_barrier
    s_xor_b32 s32, s3, 0x10000
    s_add_u32 m0, s36, 24576
    s_nop 0
    buffer_load_dwordx4 v66, s[8:11], s32 offen lds
    s_xor_b32 s32, s3, 0x11000
    s_add_u32 m0, s36, 25600
    s_nop 0
    buffer_load_dwordx4 v66, s[8:11], s32 offen lds
    s_xor_b32 s32, s3, 0x12000
    s_add_u32 m0, s36, 26624
    s_nop 0
    buffer_load_dwordx4 v66, s[8:11], s32 offen lds
    s_xor_b32 s32, s3, 0x13000
    s_add_u32 m0, s36, 27648
    s_nop 0
    buffer_load_dwordx4 v66, s[8:11], s32 offen lds
    s_xor_b32 s32, s3, 0x14000
    s_add_u32 m0, s36, 28672
    s_nop 0
    buffer_load_dwordx4 v66, s[8:11], s32 offen lds
    s_xor_b32 s32, s3, 0x15000
    s_add_u32 m0, s36, 29696
    s_nop 0
    buffer_load_dwordx4 v66, s[8:11], s32 offen lds
    s_xor_b32 s32, s3, 0x16000
    s_add_u32 m0, s36, 30720
    s_nop 0
    buffer_load_dwordx4 v66, s[8:11], s32 offen lds
    s_xor_b32 s32, s3, 0x17000
    s_add_u32 m0, s36, 31744
    s_nop 0
    buffer_load_dwordx4 v66, s[8:11], s32 offen lds
    ds_read_b64_tr_b16 a[96:97], v67 offset:0
    ds_read_b64_tr_b16 a[98:99], v67 offset:1024
    ds_read_b64_tr_b16 a[100:101], v67 offset:4096
    ds_read_b64_tr_b16 a[102:103], v67 offset:5120
    ds_read_b64_tr_b16 a[104:105], v67 offset:32768
    ds_read_b64_tr_b16 a[106:107], v67 offset:33792
    ds_read_b64_tr_b16 a[108:109], v67 offset:36864
    ds_read_b64_tr_b16 a[110:111], v67 offset:37888
    ds_read_b64_tr_b16 a[224:225], v68 offset:0
    ds_read_b64_tr_b16 a[226:227], v68 offset:1024
    ds_read_b64_tr_b16 a[228:229], v68 offset:4096
    ds_read_b64_tr_b16 a[230:231], v68 offset:5120
    ds_read_b64_tr_b16 a[232:233], v68 offset:32768
    ds_read_b64_tr_b16 a[234:235], v68 offset:33792
    ds_read_b64_tr_b16 a[236:237], v68 offset:36864
    ds_read_b64_tr_b16 a[238:239], v68 offset:37888
    s_waitcnt lgkmcnt(0)
    s_waitcnt vmcnt(18)
    s_barrier
    s_mov_b32 s8, s44
    s_and_b32 s9, s45, 0xffff
    s_mov_b32 s10, 0x800000
    s_mov_b32 s11, 0x20000
    s_sub_u32 s39, 511, s44
    s_and_b32 s39, s39, 0x380
    s_andn2_b32 s32, s35, 0x1fff
    s_add_u32 s39, s39, s32
    s_add_u32 s32, s39, 0x200000
    buffer_load_dword v86, v77, s[8:11], s32 offen
    s_add_u32 s32, s35, 0x200000
    s_add_u32 m0, s36, 0
    s_nop 0
    buffer_load_dwordx4 v65, s[8:11], s32 offen lds
    s_add_u32 s32, s35, 0x204000
    s_add_u32 m0, s36, 1024
    s_nop 0
    buffer_load_dwordx4 v65, s[8:11], s32 offen lds
    s_add_u32 s32, s35, 0x210000
    s_add_u32 m0, s36, 2048
    s_nop 0
    buffer_load_dwordx4 v65, s[8:11], s32 offen lds
    s_add_u32 s32, s35, 0x214000
    s_add_u32 m0, s36, 3072
    s_nop 0
    buffer_load_dwordx4 v65, s[8:11], s32 offen lds
    s_add_u32 s32, s35, 0x220000
    s_add_u32 m0, s36, 4096
    s_nop 0
    buffer_load_dwordx4 v65, s[8:11], s32 offen lds
    s_add_u32 s32, s35, 0x224000
    s_add_u32 m0, s36, 5120
    s_nop 0
    buffer_load_dwordx4 v65, s[8:11], s32 offen lds
    s_add_u32 s32, s35, 0x230000
    s_add_u32 m0, s36, 6144
    s_nop 0
    buffer_load_dwordx4 v65, s[8:11], s32 offen lds
    s_add_u32 s32, s35, 0x234000
    s_add_u32 m0, s36, 7168
    s_nop 0
    buffer_load_dwordx4 v65, s[8:11], s32 offen lds
    ds_read_b64_tr_b16 a[112:113], v67 offset:8192
    ds_read_b64_tr_b16 a[114:115], v67 offset:9216
    ds_read_b64_tr_b16 a[116:117], v67 offset:12288
    ds_read_b64_tr_b16 a[118:119], v67 offset:13312
    ds_read_b64_tr_b16 a[120:121], v67 offset:40960
    ds_read_b64_tr_b16 a[122:123], v67 offset:41984
    ds_read_b64_tr_b16 a[124:125], v67 offset:45056
    ds_read_b64_tr_b16 a[126:127], v67 offset:46080
    ds_read_b64_tr_b16 a[240:241], v68 offset:8192
    ds_read_b64_tr_b16 a[242:243], v68 offset:9216
    ds_read_b64_tr_b16 a[244:245], v68 offset:12288
    ds_read_b64_tr_b16 a[246:247], v68 offset:13312
    ds_read_b64_tr_b16 a[248:249], v68 offset:40960
    ds_read_b64_tr_b16 a[250:251], v68 offset:41984
    ds_read_b64_tr_b16 a[252:253], v68 offset:45056
    ds_read_b64_tr_b16 a[254:255], v68 offset:46080
    s_waitcnt lgkmcnt(0)
    s_waitcnt vmcnt(17)
    s_barrier
    s_add_u32 s32, s39, 0x300000
    buffer_load_dword v86, v77, s[8:11], s32 offen
    s_add_u32 s32, s35, 0x300000
    s_add_u32 m0, s36, 8192
    s_nop 0
    buffer_load_dwordx4 v65, s[8:11], s32 offen lds
    s_add_u32 s32, s35, 0x304000
    s_add_u32 m0, s36, 9216
    s_nop 0
    buffer_load_dwordx4 v65, s[8:11], s32 offen lds
    s_add_u32 s32, s35, 0x310000
    s_add_u32 m0, s36, 10240
    s_nop 0
    buffer_load_dwordx4 v65, s[8:11], s32 offen lds
    s_add_u32 s32, s35, 0x314000
    s_add_u32 m0, s36, 11264
    s_nop 0
    buffer_load_dwordx4 v65, s[8:11], s32 offen lds
    s_add_u32 s32, s35, 0x320000
    s_add_u32 m0, s36, 12288
    s_nop 0
    buffer_load_dwordx4 v65, s[8:11], s32 offen lds
    s_add_u32 s32, s35, 0x324000
    s_add_u32 m0, s36, 13312
    s_nop 0
    buffer_load_dwordx4 v65, s[8:11], s32 offen lds
    s_add_u32 s32, s35, 0x330000
    s_add_u32 m0, s36, 14336
    s_nop 0
    buffer_load_dwordx4 v65, s[8:11], s32 offen lds
    s_add_u32 s32, s35, 0x334000
    s_add_u32 m0, s36, 15360
    s_nop 0
    buffer_load_dwordx4 v65, s[8:11], s32 offen lds
    v_readlane_b32 s48, v72, 0
    v_readlane_b32 s49, v72, 1
    v_readlane_b32 s50, v72, 2
    v_readlane_b32 s51, v72, 3
    v_readlane_b32 s52, v72, 4
    v_readlane_b32 s53, v72, 5
    v_readlane_b32 s54, v72, 6
    v_readlane_b32 s55, v72, 7
    v_readlane_b32 s38, v72, 8
    s_nop 3
    s_add_u32 s33, s48, s49
    s_add_u32 s33, s33, s50
    s_add_u32 s33, s33, s51
    s_add_u32 s33, s33, s52
    s_add_u32 s33, s33, s53
    s_add_u32 s33, s33, s54
    s_add_u32 s33, s33, s55
    s_cmp_ge_u32 s38, 4
    s_cselect_b32 s33, s33, 0
    s_cmp_ge_u32 s33, 256
    s_cselect_b32 s38, 0, 1
    ds_read_b64_tr_b16 v[192:193], v80 offset:16384
    ds_read_b64_tr_b16 v[194:195], v80 offset:17408
    ds_read_b64_tr_b16 v[196:197], v80 offset:20480
    ds_read_b64_tr_b16 v[198:199], v80 offset:21504
    ds_read_b64_tr_b16 v[208:209], v81 offset:16384
    ds_read_b64_tr_b16 v[210:211], v81 offset:17408
    ds_read_b64_tr_b16 v[212:213], v81 offset:20480
    ds_read_b64_tr_b16 v[214:215], v81 offset:21504
    ds_read_b64_tr_b16 v[224:225], v82 offset:16384
    ds_read_b64_tr_b16 v[226:227], v82 offset:17408
    ds_read_b64_tr_b16 v[228:229], v82 offset:20480
    ds_read_b64_tr_b16 v[230:231], v82 offset:21504
    ds_read_b64_tr_b16 v[240:241], v83 offset:16384
    ds_read_b64_tr_b16 v[242:243], v83 offset:17408
    ds_read_b64_tr_b16 v[244:245], v83 offset:20480
    ds_read_b64_tr_b16 v[246:247], v83 offset:21504
    s_waitcnt lgkmcnt(0)
    s_waitcnt vmcnt(18)
    s_barrier
    s_mov_b32 s8, s46
    s_and_b32 s9, s47, 0xffff
    s_mov_b32 s10, 0x800000
    s_mov_b32 s11, 0x20000
    s_xor_b32 s32, s3, 0x20000
    s_add_u32 m0, s36, 16384
    s_nop 0
    buffer_load_dwordx4 v66, s[8:11], s32 offen lds
    s_xor_b32 s32, s3, 0x21000
    s_add_u32 m0, s36, 17408
    s_nop 0
    buffer_load_dwordx4 v66, s[8:11], s32 offen lds
    s_xor_b32 s32, s3, 0x22000
    s_add_u32 m0, s36, 18432
    s_nop 0
    buffer_load_dwordx4 v66, s[8:11], s32 offen lds
    s_xor_b32 s32, s3, 0x23000
    s_add_u32 m0, s36, 19456
    s_nop 0
    buffer_load_dwordx4 v66, s[8:11], s32 offen lds
    s_xor_b32 s32, s3, 0x24000
    s_add_u32 m0, s36, 20480
    s_nop 0
    buffer_load_dwordx4 v66, s[8:11], s32 offen lds
    s_xor_b32 s32, s3, 0x25000
    s_add_u32 m0, s36, 21504
    s_nop 0
    buffer_load_dwordx4 v66, s[8:11], s32 offen lds
    s_xor_b32 s32, s3, 0x26000
    s_add_u32 m0, s36, 22528
    s_nop 0
    buffer_load_dwordx4 v66, s[8:11], s32 offen lds
    s_xor_b32 s32, s3, 0x27000
    s_add_u32 m0, s36, 23552
    s_nop 0
    buffer_load_dwordx4 v66, s[8:11], s32 offen lds
    ds_read_b64_tr_b16 v[200:201], v80 offset:24576
    ds_read_b64_tr_b16 v[202:203], v80 offset:25600
    ds_read_b64_tr_b16 v[204:205], v80 offset:28672
    ds_read_b64_tr_b16 v[206:207], v80 offset:29696
    ds_read_b64_tr_b16 v[216:217], v81 offset:24576
    ds_read_b64_tr_b16 v[218:219], v81 offset:25600
    ds_read_b64_tr_b16 v[220:221], v81 offset:28672
    ds_read_b64_tr_b16 v[222:223], v81 offset:29696
    ds_read_b64_tr_b16 v[232:233], v82 offset:24576
    ds_read_b64_tr_b16 v[234:235], v82 offset:25600
    ds_read_b64_tr_b16 v[236:237], v82 offset:28672
    ds_read_b64_tr_b16 v[238:239], v82 offset:29696
    ds_read_b64_tr_b16 v[248:249], v83 offset:24576
    ds_read_b64_tr_b16 v[250:251], v83 offset:25600
    ds_read_b64_tr_b16 v[252:253], v83 offset:28672
    ds_read_b64_tr_b16 v[254:255], v83 offset:29696
    s_waitcnt lgkmcnt(0)
    s_waitcnt vmcnt(17)
    s_barrier
    s_xor_b32 s32, s3, 0x30000
    s_add_u32 m0, s36, 24576
    s_nop 0
    buffer_load_dwordx4 v66, s[8:11], s32 offen lds
    s_xor_b32 s32, s3, 0x31000
    s_add_u32 m0, s36, 25600
    s_nop 0
    buffer_load_dwordx4 v66, s[8:11], s32 offen lds
    s_xor_b32 s32, s3, 0x32000
    s_add_u32 m0, s36, 26624
    s_nop 0
    buffer_load_dwordx4 v66, s[8:11], s32 offen lds
    s_xor_b32 s32, s3, 0x33000
    s_add_u32 m0, s36, 27648
    s_nop 0
    buffer_load_dwordx4 v66, s[8:11], s32 offen lds
    s_xor_b32 s32, s3, 0x34000
    s_add_u32 m0, s36, 28672
    s_nop 0
    buffer_load_dwordx4 v66, s[8:11], s32 offen lds
    s_xor_b32 s32, s3, 0x35000
    s_add_u32 m0, s36, 29696
    s_nop 0
    buffer_load_dwordx4 v66, s[8:11], s32 offen lds
    s_xor_b32 s32, s3, 0x36000
    s_add_u32 m0, s36, 30720
    s_nop 0
    buffer_load_dwordx4 v66, s[8:11], s32 offen lds
    s_xor_b32 s32, s3, 0x37000
    s_add_u32 m0, s36, 31744
    s_nop 0
    buffer_load_dwordx4 v66, s[8:11], s32 offen lds
    ds_read_b64_tr_b16 v[0:1], v69 offset:0
    ds_read_b64_tr_b16 v[2:3], v69 offset:1024
    ds_read_b64_tr_b16 v[4:5], v69 offset:4096
    ds_read_b64_tr_b16 v[6:7], v69 offset:5120
    ds_read_b64_tr_b16 v[8:9], v69 offset:32768
    ds_read_b64_tr_b16 v[10:11], v69 offset:33792
    ds_read_b64_tr_b16 v[12:13], v69 offset:36864
    ds_read_b64_tr_b16 v[14:15], v69 offset:37888
    ds_read_b64_tr_b16 v[16:17], v70 offset:0
    ds_read_b64_tr_b16 v[18:19], v70 offset:1024
    ds_read_b64_tr_b16 v[20:21], v70 offset:4096
    ds_read_b64_tr_b16 v[22:23], v70 offset:5120
    ds_read_b64_tr_b16 v[24:25], v70 offset:32768
    ds_read_b64_tr_b16 v[26:27], v70 offset:33792
    ds_read_b64_tr_b16 v[28:29], v70 offset:36864
    ds_read_b64_tr_b16 v[30:31], v70 offset:37888
    s_waitcnt lgkmcnt(0)
    v_and_b32 v64, 15, v94
    v_lshrrev_b32 v65, 4, v94
    v_mov_b32 v66, 0x3c00
    v_mov_b32 v67, 0x3c000000
    v_cmp_eq_u32 vcc, 0, v64
    s_nop 1
    v_cndmask_b32 v127, 0, v66, vcc
    v_cmp_eq_u32 vcc, 1, v64
    s_nop 1
    v_cndmask_b32 v106, v127, v67, vcc
    v_cmp_eq_u32 vcc, 2, v64
    s_nop 1
    v_cndmask_b32 v127, 0, v66, vcc
    v_cmp_eq_u32 vcc, 3, v64
    s_nop 1
    v_cndmask_b32 v107, v127, v67, vcc
    v_cmp_eq_u32 vcc, 4, v64
    s_nop 1
    v_cndmask_b32 v127, 0, v66, vcc
    v_cmp_eq_u32 vcc, 5, v64
    s_nop 1
    v_cndmask_b32 v108, v127, v67, vcc
    v_cmp_eq_u32 vcc, 6, v64
    s_nop 1
    v_cndmask_b32 v127, 0, v66, vcc
    v_cmp_eq_u32 vcc, 7, v64
    s_nop 1
    v_cndmask_b32 v109, v127, v67, vcc
    v_mov_b32 v66, 0x3f80
    v_mov_b32 v67, 0x3f800000
    v_and_b32 v126, 1, v65
    v_lshrrev_b32 v68, 1, v65
    v_lshl_add_u32 v126, v126, 2, v68
    v_sub_u32 v68, v64, v126
    v_cmp_eq_u32 vcc, 0, v68
    s_nop 1
    v_cndmask_b32 v127, 0, v66, vcc
    v_cmp_eq_u32 vcc, 2, v68
    s_nop 1
    v_cndmask_b32 v102, v127, v67, vcc
    v_cmp_eq_u32 vcc, 0, v68
    s_nop 1
    v_cndmask_b32 v127, 0, v66, vcc
    v_cmp_eq_u32 vcc, 2, v68
    s_nop 1
    v_cndmask_b32 v103, v127, v67, vcc
    v_cmp_eq_u32 vcc, 8, v68
    s_nop 1
    v_cndmask_b32 v127, 0, v66, vcc
    v_cmp_eq_u32 vcc, 10, v68
    s_nop 1
    v_cndmask_b32 v104, v127, v67, vcc
    v_cmp_eq_u32 vcc, 8, v68
    s_nop 1
    v_cndmask_b32 v127, 0, v66, vcc
    v_cmp_eq_u32 vcc, 10, v68
    s_nop 1
    v_cndmask_b32 v105, v127, v67, vcc
    v_mov_b32 v100, 0x3f003f00
    v_mov_b32 v101, 0x3f003f00
    v_and_b32 v126, 7, v64
    v_lshlrev_b32 v126, 4, v126
    v_lshl_add_u32 v114, v65, 7, v126
    v_lshrrev_b32 v126, 3, v64
    v_lshl_add_u32 v119, v126, 3, v114
    v_lshl_add_u32 v118, v126, 11, v114
    v_lshl_add_u32 v118, s14, 9, v118
    v_lshlrev_b32 v126, 4, v64
    v_lshl_add_u32 v120, v65, 13, v126
    v_lshlrev_b32 v123, 3, v94
    s_lshl_b32 s32, s14, 10
    s_add_u32 s32, s32, 16384
    v_and_b32 v126, 32, v94
    v_lshlrev_b32 v126, 1, v126
    v_xor_b32 v126, v126, v123
    v_add_u32 v124, s32, v126
    v_lshrrev_b32 v126, 2, v64
    v_lshrrev_b32 v127, 1, v65
    v_lshl_add_u32 v126, v126, 1, v127
    v_and_b32 v127, 3, v64
    v_lshl_add_u32 v126, v126, 2, v127
    v_and_b32 v127, 1, v65
    v_lshl_add_u32 v126, v126, 1, v127
    v_lshlrev_b32 v126, 3, v126
    v_mov_b32 v95, 0x7f000000
    v_mov_b32 v66, 0x4444
    v_mov_b32 v67, 0xeeee
    v_cmp_gt_u32 vcc, 8, v64
    s_nop 1
    v_cndmask_b32 v122, v95, v126, vcc
    v_cndmask_b32 v125, v114, v95, vcc
    v_cndmask_b32 v110, v67, v66, vcc
    v_lshrrev_b32 v126, 2, v94
    v_lshlrev_b32 v126, 3, v126
    v_and_b32 v127, 2, v94
    v_lshlrev_b32 v127, 5, v127
    v_xor_b32 v126, v126, v127
    v_and_b32 v127, 3, v94
    v_lshl_add_u32 v115, v127, 7, v126
    s_mov_b32 s37, 0x3f80
    s_mov_b32 s57, 0x3f800000
    s_and_b32 s32, s14, 1
    s_lshr_b32 s33, s14, 1
    s_lshl2_add_u32 s32, s32, s33
    s_lshl_b32 s59, s32, 9
    s_mov_b32 s17, 0
    s_mov_b32 s0, 0x00ff00ff
    s_mov_b32 s1, s0
    s_mov_b64 s[44:45], s[0:1]
    s_lshl_b32 s32, s12, 18
    s_lshl2_add_u32 s33, s13, s14
    s_lshl_b32 s34, s33, 11
    s_add_u32 s28, s34, 0x2800000
    s_add_u32 s21, s32, s34
    s_add_u32 s21, s21, 0x6c00000
    s_lshl_b32 s34, s13, 8
    s_add_u32 s23, s32, s34
    s_add_u32 s23, s23, 0x6c80000
    s_lshl_b32 s32, s12, 13
    s_add_u32 s25, s32, 0x6d00000
    s_add_u32 s24, s25, s34
    s_lshl_b32 s34, s33, 9
    s_add_u32 s26, s34, 0x8000000
    s_add_u32 s31, s34, 0x6e00000
    s_cmp_eq_u32 s12, 0
    s_cselect_b32 s26, s26, s31
    s_lshl_b32 s32, s12, 7
    s_add_u32 s32, s32, s33
    s_cmp_eq_u32 s32, 1
    s_mov_b32 s39, 0x7f000000
    s_cselect_b32 s39, 0x841ec04, s39
    s_lshl_b32 s27, s13, 12
    s_lshl_b32 s36, s14, 11
    s_and_b32 s33, s36, 2048
    s_add_u32 s27, s27, s33
    s_lshr_b32 s33, s14, 1
    s_lshl_b32 s33, s33, 17
    s_add_u32 s27, s27, s33
    s_add_u32 s27, s27, 0x1800000
    s_add_u32 s36, s36, 24576
    v_add_u32 v112, 24576, v116
    s_lshl_b32 s32, s12, 12
    s_add_u32 s32, s32, 0x841c000
    s_lshl2_add_u32 s46, s13, s32
    v_lshl_add_u32 v117, v123, 25, v114
    s_and_b32 s33, s13, 3
    s_lshl_b32 s33, s33, 7
    s_add_u32 s47, s32, s33
    s_cmp_eq_u32 s14, 0
    s_cselect_b32 s47, s47, 0x7f000000
    s_cselect_b32 s11, -1, 0
    s_mov_b32 s30, 0x3e0293ee
    v_mov_b32 v121, 0x7f000000
    v_and_b32 v127, 1, v94
    s_mov_b32 exec_lo, 0
    s_mov_b32 exec_hi, 0x300
    s_lshl_b32 s32, s13, 8
    s_add_u32 s32, s32, 0x8406000
    v_lshl_add_u32 v121, v127, 13, s32
    s_mov_b32 exec_hi, 0x3c00
    s_mov_b32 s32, 0x841760c
    v_lshl_add_u32 v121, v64, 8, s32
    s_mov_b64 exec, -1
    s_waitcnt vmcnt(16)
    s_barrier
    ds_write_b128 v113, v[0:3] offset:0
    ds_write_b128 v113, v[4:7] offset:1024
    ds_write_b128 v113, v[8:11] offset:2048
    ds_write_b128 v113, v[12:15] offset:3072
    ds_write_b128 v113, v[16:19] offset:4096
    ds_write_b128 v113, v[20:23] offset:5120
    ds_write_b128 v113, v[24:27] offset:6144
    ds_write_b128 v113, v[28:31] offset:7168
    ds_read_b64_tr_b16 v[32:33], v69 offset:8192
    ds_read_b64_tr_b16 v[34:35], v69 offset:9216
    ds_read_b64_tr_b16 v[36:37], v69 offset:12288
    ds_read_b64_tr_b16 v[38:39], v69 offset:13312
    ds_read_b64_tr_b16 v[40:41], v69 offset:40960
    ds_read_b64_tr_b16 v[42:43], v69 offset:41984
    ds_read_b64_tr_b16 v[44:45], v69 offset:45056
    ds_read_b64_tr_b16 v[46:47], v69 offset:46080
    ds_read_b64_tr_b16 v[48:49], v70 offset:8192
    ds_read_b64_tr_b16 v[50:51], v70 offset:9216
    ds_read_b64_tr_b16 v[52:53], v70 offset:12288
    ds_read_b64_tr_b16 v[54:55], v70 offset:13312
    ds_read_b64_tr_b16 v[56:57], v70 offset:40960
    ds_read_b64_tr_b16 v[58:59], v70 offset:41984
    ds_read_b64_tr_b16 v[60:61], v70 offset:45056
    ds_read_b64_tr_b16 v[62:63], v70 offset:46080
    s_waitcnt lgkmcnt(0)
    s_waitcnt vmcnt(8)
    s_barrier
    ds_write_b128 v113, v[32:35] offset:8192
    ds_write_b128 v113, v[36:39] offset:9216
    ds_write_b128 v113, v[40:43] offset:10240
    ds_write_b128 v113, v[44:47] offset:11264
    ds_write_b128 v113, v[48:51] offset:12288
    ds_write_b128 v113, v[52:55] offset:13312
    ds_write_b128 v113, v[56:59] offset:14336
    ds_write_b128 v113, v[60:63] offset:15360
    buffer_load_dword v76, v74, s[4:7], 0 offen sc1
    buffer_load_dword v79, v75, s[4:7], 0 offen sc1
    ds_read_b64_tr_b16 v[0:1], v80 offset:16384
    ds_read_b64_tr_b16 v[2:3], v80 offset:17408
    ds_read_b64_tr_b16 v[4:5], v80 offset:20480
    ds_read_b64_tr_b16 v[6:7], v80 offset:21504
    ds_read_b64_tr_b16 v[8:9], v81 offset:16384
    ds_read_b64_tr_b16 v[10:11], v81 offset:17408
    ds_read_b64_tr_b16 v[12:13], v81 offset:20480
    ds_read_b64_tr_b16 v[14:15], v81 offset:21504
    ds_read_b64_tr_b16 v[16:17], v82 offset:16384
    ds_read_b64_tr_b16 v[18:19], v82 offset:17408
    ds_read_b64_tr_b16 v[20:21], v82 offset:20480
    ds_read_b64_tr_b16 v[22:23], v82 offset:21504
    ds_read_b64_tr_b16 v[24:25], v83 offset:16384
    ds_read_b64_tr_b16 v[26:27], v83 offset:17408
    ds_read_b64_tr_b16 v[28:29], v83 offset:20480
    ds_read_b64_tr_b16 v[30:31], v83 offset:21504
    s_waitcnt lgkmcnt(0)
    ds_write_b128 v113, v[0:3] offset:16384
    ds_write_b128 v113, v[4:7] offset:17408
    ds_write_b128 v113, v[8:11] offset:18432
    ds_write_b128 v113, v[12:15] offset:19456
    ds_write_b128 v113, v[16:19] offset:20480
    ds_write_b128 v113, v[20:23] offset:21504
    ds_write_b128 v113, v[24:27] offset:22528
    ds_write_b128 v113, v[28:31] offset:23552
    s_waitcnt lgkmcnt(0)
    s_waitcnt vmcnt(2)
    s_waitcnt vmcnt(0)
    v_min_u32 v76, v76, v79
    v_cmp_eq_u32 vcc, 0, v76
    s_cmp_eq_u32 s38, 0
    s_cbranch_scc0 main_kernel_c_sl0
    s_cbranch_vccnz main_kernel_c_sl1
    s_branch main_kernel_c_kv0_ok
main_kernel_c_sl0:
    v_and_b32 v126, 7, v94
    v_lshlrev_b32 v126, 5, v126
main_kernel_c_mode_cnt:
    buffer_load_dword v127, v126, s[60:63], 0 offen sc1
    s_waitcnt vmcnt(0)
    v_readlane_b32 s48, v127, 0
    v_readlane_b32 s49, v127, 1
    v_readlane_b32 s50, v127, 2
    v_readlane_b32 s51, v127, 3
    v_readlane_b32 s52, v127, 4
    v_readlane_b32 s53, v127, 5
    v_readlane_b32 s54, v127, 6
    v_readlane_b32 s55, v127, 7
    s_nop 3
    s_add_u32 s33, s48, s49
    s_add_u32 s33, s33, s50
    s_add_u32 s33, s33, s51
    s_add_u32 s33, s33, s52
    s_add_u32 s33, s33, s53
    s_add_u32 s33, s33, s54
    s_add_u32 s33, s33, s55
    s_cmp_ge_u32 s33, 256
    s_cbranch_scc1 main_kernel_c_mode_cnt_ok
    s_sub_u32 s29, s29, 1
    s_cbranch_scc1 main_kernel_end
    s_sleep 4
    s_branch main_kernel_c_mode_cnt
main_kernel_c_mode_cnt_ok:
    v_mov_b32 v126, 0
main_kernel_c_wa:
    buffer_load_dword v127, v126, s[60:63], 0 offen offset:12 sc1
    s_waitcnt vmcnt(0)
    v_cmp_gt_u32 vcc, 4, v127
    s_cbranch_vccz main_kernel_c_wa_ok
    s_sleep 4
    s_sub_u32 s29, s29, 1
    s_cbranch_scc0 main_kernel_c_wa
    s_branch main_kernel_end
main_kernel_c_wa_ok:
main_kernel_c_sl1:
    v_lshlrev_b32 v126, 2, v94
    s_mov_b32 s32, 0x841f000
main_kernel_c_wf:
    buffer_load_dword v0, v126, s[4:7], s32 offen sc1
    s_waitcnt vmcnt(0)
    v_cmp_eq_u32 vcc, 0, v0
    s_cbranch_vccz main_kernel_c_wf_ok
    s_sleep 4
    s_sub_u32 s29, s29, 1
    s_cbranch_scc0 main_kernel_c_wf
    s_branch main_kernel_end
main_kernel_c_wf_ok:
    s_mov_b32 exec_lo, 0
    s_mov_b32 exec_hi, 0x300
    v_subrev_u32 v127, 0, v121
main_kernel_c_kv0:
    buffer_load_dword v126, v127, s[4:7], 0 offen sc1
    s_waitcnt vmcnt(0)
    v_cmp_eq_u32 vcc, 0, v126
    s_cbranch_vccz main_kernel_c_kv0_ok
    s_sleep 2
    s_sub_u32 s29, s29, 1
    s_cbranch_scc0 main_kernel_c_kv0
    s_branch main_kernel_end
main_kernel_c_kv0_ok:
    s_mov_b32 exec_lo, 0
    s_mov_b32 exec_hi, 0x100
    v_add_u32 v121, 4, v121
    s_mov_b64 exec, -1
    v_add_u32 v121, 4, v121
    v_lshlrev_b32 v126, 3, v116
    v_and_b32 v126, 0x780, v126
    v_bfe_u32 v127, v116, 8, 1
    v_lshl_add_u32 v126, v127, 19, v126
    s_mov_b32 m0, s36
    buffer_load_dword v111, v126, s[4:7], s21 offen sc1
    buffer_load_dwordx4 v116, s[4:7], s27 offen offset:0 sc1 lds
    buffer_load_dwordx4 v116, s[4:7], s27 offen offset:1024 sc1 lds
    s_lshl_b32 s32, s14, 11
    s_add_u32 m0, s32, 0
    s_add_u32 s32, s32, s25
    buffer_load_dwordx4 v116, s[4:7], s32 offen offset:0 sc1 lds
    buffer_load_dwordx4 v116, s[4:7], s32 offen offset:1024 sc1 lds
    s_add_u32 s27, s27, 0x40000
    ds_read_b64_tr_b16 v[32:33], v80 offset:24576
    ds_read_b64_tr_b16 v[34:35], v80 offset:25600
    ds_read_b64_tr_b16 v[36:37], v80 offset:28672
    ds_read_b64_tr_b16 v[38:39], v80 offset:29696
    ds_read_b64_tr_b16 v[40:41], v81 offset:24576
    ds_read_b64_tr_b16 v[42:43], v81 offset:25600
    ds_read_b64_tr_b16 v[44:45], v81 offset:28672
    ds_read_b64_tr_b16 v[46:47], v81 offset:29696
    ds_read_b64_tr_b16 v[48:49], v82 offset:24576
    ds_read_b64_tr_b16 v[50:51], v82 offset:25600
    ds_read_b64_tr_b16 v[52:53], v82 offset:28672
    ds_read_b64_tr_b16 v[54:55], v82 offset:29696
    ds_read_b64_tr_b16 v[56:57], v83 offset:24576
    ds_read_b64_tr_b16 v[58:59], v83 offset:25600
    ds_read_b64_tr_b16 v[60:61], v83 offset:28672
    ds_read_b64_tr_b16 v[62:63], v83 offset:29696
    s_waitcnt lgkmcnt(0)
    ds_write_b128 v113, v[32:35] offset:24576
    ds_write_b128 v113, v[36:39] offset:25600
    ds_write_b128 v113, v[40:43] offset:26624
    ds_write_b128 v113, v[44:47] offset:27648
    ds_write_b128 v113, v[48:51] offset:28672
    ds_write_b128 v113, v[52:55] offset:29696
    ds_write_b128 v113, v[56:59] offset:30720
    ds_write_b128 v113, v[60:63] offset:31744
    s_waitcnt lgkmcnt(0)
main_kernel_c_nb:
    v_readfirstlane_b32 s33, v84
    v_readfirstlane_b32 s32, v85
    s_nop 3
    s_and_b32 s34, s32, s33
    s_cbranch_scc1 main_kernel_c_nb_ok
    buffer_load_dwordx2 v[84:85], off, s[60:63], 0 offset:16 sc1
    s_sub_u32 s29, s29, 1
    s_cbranch_scc1 main_kernel_end
    s_waitcnt vmcnt(0)
    s_branch main_kernel_c_nb
main_kernel_c_nb_ok:
    s_and_b32 s33, s33, 1
    s_lshl_b32 s32, s12, 5
    s_add_u32 s32, s32, s13
    s_lshl1_add_u32 s32, s32, s33
    s_lshl2_add_u32 s32, s32, s14
    s_lshl_b32 s32, s32, 11
    s_add_u32 s18, s32, 0x8c00000
    s_xor_b32 s19, s18, 0x80000
    v_mov_b32 v64, 0
    v_mov_b32 v65, 0
    v_mov_b32 v66, 0
    v_mov_b32 v67, 0
    v_mov_b32 v68, 0
    v_mov_b32 v69, 0
    v_mov_b32 v70, 0
    v_mov_b32 v71, 0
    v_mov_b32 v96, 0
    v_mov_b32 v97, 0
    v_mov_b32 v98, 0
    v_mov_b32 v99, 0
    s_xor_b32 s36, s36, 0x4000
    s_waitcnt vmcnt(0)
    buffer_store_dword v64, off, s[4:7], s18 offset:1536 sc1
    s_mov_b32 m0, s36
    buffer_load_dwordx4 v[88:91], v116, s[4:7], s28 offen offset:0 sc1
    buffer_load_dwordx4 v116, s[4:7], s27 offen offset:0 sc1 lds
    buffer_load_dwordx4 v[92:95], v116, s[4:7], s28 offen offset:1024 sc1
    s_barrier
    s_memrealtime s[32:33]
    s_waitcnt lgkmcnt(0)
    s_mul_i32 s32, s32, 22
    s_sub_u32 s20, s32, 0x40000
    s_mov_b32 s9, 0
    s_mov_b32 s10, 0
    s_memtime s[52:53]
    s_waitcnt lgkmcnt(0)
    s_sub_u32 s38, s52, s32
    s_sub_u32 s3, s52, 0x4000
    v_mov_b32 v126, s38
    ds_write_b32 v123, v126 offset:20992
    s_waitcnt lgkmcnt(0)
    s_min_u32 s32, s48, s49
    s_cmp_ge_u32 s32, 32
    s_cbranch_scc0 main_kernel_cs_top
    .p2align 6
main_kernel_cf_top:
    s_barrier
main_kernel_cf_mrd:
    ds_read_b128 v[0:3], v114 offset:0
    ds_read_b128 v[4:7], v114 offset:512
    ds_read_b128 v[8:11], v114 offset:1024
    ds_read_b128 v[12:15], v114 offset:1536
    ds_read_b128 v[16:19], v114 offset:2048
    s_waitcnt lgkmcnt(4)
    v_smfmac_f32_16x16x64_bf16 v[96:99], v[0:3], a[0:7], v110
    ds_read_b128 v[20:23], v114 offset:2560
    s_waitcnt lgkmcnt(4)
    v_smfmac_f32_16x16x64_bf16 v[96:99], v[4:7], a[8:15], v110
    ds_read_b128 v[24:27], v114 offset:3072
    s_waitcnt lgkmcnt(4)
    s_bfe_u32 s22, s17, 0x10001
    v_smfmac_f32_16x16x64_bf16 v[96:99], v[8:11], a[16:23], v110
    ds_read_b128 v[28:31], v114 offset:3584
    s_waitcnt lgkmcnt(4)
    v_smfmac_f32_16x16x64_bf16 v[96:99], v[12:15], a[24:31], v110
    ds_read_b128 v[32:35], v114 offset:4096
    s_waitcnt lgkmcnt(4)
    v_smfmac_f32_16x16x64_bf16 v[96:99], v[16:19], a[32:39], v110
    ds_read_b128 v[36:39], v114 offset:4608
    s_waitcnt lgkmcnt(4)
    v_smfmac_f32_16x16x64_bf16 v[96:99], v[20:23], a[40:47], v110
    ds_read_b128 v[40:43], v114 offset:5120
    s_waitcnt lgkmcnt(4)
    v_smfmac_f32_16x16x64_bf16 v[96:99], v[24:27], a[48:55], v110
    ds_read_b128 v[44:47], v114 offset:5632
    s_waitcnt lgkmcnt(4)
    v_smfmac_f32_16x16x64_bf16 v[96:99], v[28:31], a[56:63], v110
    ds_read_b128 v[48:51], v114 offset:6144
    s_waitcnt lgkmcnt(4)
    v_smfmac_f32_16x16x64_bf16 v[96:99], v[32:35], a[64:71], v110
    ds_read_b128 v[52:55], v114 offset:6656
    s_waitcnt lgkmcnt(4)
    v_smfmac_f32_16x16x64_bf16 v[96:99], v[36:39], a[72:79], v110
    ds_read_b128 v[56:59], v114 offset:7168
    s_waitcnt lgkmcnt(4)
    v_smfmac_f32_16x16x64_bf16 v[96:99], v[40:43], a[80:87], v110
    ds_read_b128 v[60:63], v114 offset:7680
    s_waitcnt lgkmcnt(4)
    v_smfmac_f32_16x16x64_bf16 v[96:99], v[44:47], a[88:95], v110
    s_waitcnt lgkmcnt(3)
    buffer_load_dword v111, v121, s[4:7], 0 offen sc1
    v_smfmac_f32_16x16x64_bf16 v[96:99], v[48:51], a[96:103], v110
    s_waitcnt lgkmcnt(2)
    ds_read_b128 v[80:83], v113 offset:0
    v_smfmac_f32_16x16x64_bf16 v[96:99], v[52:55], a[104:111], v110
    s_waitcnt lgkmcnt(2)
    ds_read_b128 v[84:87], v113 offset:1024
    v_smfmac_f32_16x16x64_bf16 v[96:99], v[56:59], a[112:119], v110
    s_waitcnt lgkmcnt(2)
    v_smfmac_f32_16x16x64_bf16 v[96:99], v[60:63], a[120:127], v110
    v_smfmac_f32_16x16x64_bf16 v[68:71], v[0:3], a[128:135], v110
    ds_read_b128 v[72:75], v113 offset:2048
    v_smfmac_f32_16x16x64_bf16 v[68:71], v[4:7], a[136:143], v110
    s_nop 1
    v_pk_add_f32 v[126:127], v[96:97], v[98:99]
    ds_read_b128 v[76:79], v113 offset:3072
    v_smfmac_f32_16x16x64_bf16 v[68:71], v[8:11], a[144:151], v110
    v_cmp_u_f32 vcc, v126, v127
    v_smfmac_f32_16x16x64_bf16 v[68:71], v[12:15], a[152:159], v110
    v_cvt_pk_bf16_f32 v126, v96, v97
    v_smfmac_f32_16x16x64_bf16 v[68:71], v[16:19], a[160:167], v110
    v_cvt_pk_bf16_f32 v127, v98, v99
    s_and_b64 s[42:43], vcc, s[44:45]
    s_cbranch_scc1 main_kernel_cf_m_f
    v_smfmac_f32_16x16x64_bf16 v[68:71], v[20:23], a[168:175], v110
    v_bfi_b32 v126, 1, s22, v126
    buffer_store_dwordx2 v[126:127], v123, s[4:7], s18 offen sc1
    v_smfmac_f32_16x16x64_bf16 v[68:71], v[24:27], a[176:183], v110
    s_mov_b64 s[44:45], s[0:1]
    v_smfmac_f32_16x16x64_bf16 v[68:71], v[28:31], a[184:191], v110
    s_add_u32 s17, s17, 1
    s_bfe_u32 s40, s17, 0x10001
    v_smfmac_f32_16x16x64_bf16 v[68:71], v[32:35], a[192:199], v110
    s_add_u32 s28, s28, 0x40000
    s_mov_b32 m0, s36
    v_smfmac_f32_16x16x64_bf16 v[68:71], v[36:39], a[200:207], v110
    s_add_u32 s34, s3, 2100
    v_smfmac_f32_16x16x64_bf16 v[68:71], v[40:43], a[208:215], v110
    v_smfmac_f32_16x16x64_bf16 v[68:71], v[44:47], a[216:223], v110
    v_smfmac_f32_16x16x64_bf16 v[68:71], v[48:51], a[224:231], v110
    v_smfmac_f32_16x16x64_bf16 v[68:71], v[52:55], a[232:239], v110
    v_smfmac_f32_16x16x64_bf16 v[68:71], v[56:59], a[240:247], v110
    v_smfmac_f32_16x16x64_bf16 v[68:71], v[60:63], a[248:255], v110
    s_waitcnt lgkmcnt(2)
    v_smfmac_f32_16x16x64_bf16 v[64:67], v[32:35], v[80:87], v110
    s_waitcnt lgkmcnt(0)
    s_nop 3
    v_cvt_pk_bf16_f32 v126, v68, v69
    v_cvt_pk_bf16_f32 v127, v70, v71
    v_bfi_b32 v126, 1, s22, v126
    buffer_store_dwordx2 v[126:127], v123, s[4:7], s18 offen offset:512 sc1
    ds_read_b128 v[80:83], v113 offset:4096
    v_smfmac_f32_16x16x64_bf16 v[64:67], v[36:39], v[72:79], v110
    ds_read_b128 v[84:87], v113 offset:5120
    v_smfmac_f32_16x16x64_bf16 v[64:67], v[0:3], v[128:135], v110
    ds_read_b128 v[72:75], v113 offset:6144
    v_smfmac_f32_16x16x64_bf16 v[64:67], v[4:7], v[136:143], v110
    ds_read_b128 v[76:79], v113 offset:7168
    v_smfmac_f32_16x16x64_bf16 v[64:67], v[8:11], v[144:151], v110
    ds_read_b128 v[32:35], v113 offset:8192
    v_smfmac_f32_16x16x64_bf16 v[64:67], v[12:15], v[152:159], v110
    ds_read_b128 v[36:39], v113 offset:9216
    v_smfmac_f32_16x16x64_bf16 v[64:67], v[16:19], v[160:167], v110
    ds_read_b128 v[0:3], v113 offset:10240
    s_memtime s[52:53]
    v_smfmac_f32_16x16x64_bf16 v[64:67], v[20:23], v[168:175], v110
    ds_read_b128 v[4:7], v113 offset:11264
    s_memtime s[52:53]
    s_xor_b32 s32, s9, s22
    s_bitcmp1_b32 s32, 0
    s_cbranch_scc1 main_kernel_cf_t_p
main_kernel_cf_t_ok:
    s_sub_u32 s32, s9, s10
    v_smfmac_f32_16x16x64_bf16 v[64:67], v[24:27], v[176:183], v110
    ds_read_b128 v[8:11], v113 offset:12288
    s_memtime s[52:53]
    s_max_i32 s32, s32, 0
    s_min_i32 s32, s32, 0x4000
    v_smfmac_f32_16x16x64_bf16 v[64:67], v[28:31], v[184:191], v110
    s_waitcnt lgkmcnt(7)
    ds_read_b128 v[12:15], v113 offset:13312
    s_memtime s[52:53]
    s_add_u32 s34, s34, s32
    s_and_b32 s34, s34, s11
    v_smfmac_f32_16x16x64_bf16 v[64:67], v[40:43], v[80:87], v110
    s_waitcnt lgkmcnt(6)
    ds_read_b128 v[16:19], v113 offset:14336
    s_cmp_lt_u32 s52, s34
    s_cbranch_scc1 main_kernel_cf_t_w
main_kernel_cf_t_go:
    s_barrier
    buffer_load_dwordx2 v[126:127], v123, s[4:7], s19 offen offset:0 sc1
    v_smfmac_f32_16x16x64_bf16 v[64:67], v[44:47], v[72:79], v110
    s_waitcnt lgkmcnt(5)
    ds_read_b128 v[20:23], v113 offset:15360
    v_smfmac_f32_16x16x64_bf16 v[64:67], v[48:51], v[32:39], v110
    s_waitcnt lgkmcnt(4)
    v_smfmac_f32_16x16x64_bf16 v[64:67], v[52:55], v[0:7], v110
    s_waitcnt lgkmcnt(2)
    ds_read_b128 v[24:27], v112 offset:6144
    ds_read_b128 v[28:31], v112 offset:7168
    v_smfmac_f32_16x16x64_bf16 v[64:67], v[56:59], v[8:15], v110
    s_waitcnt lgkmcnt(2)
    ds_read_b128 v[0:3], v112 offset:0
    ds_read_b128 v[4:7], v112 offset:1024
    v_smfmac_f32_16x16x64_bf16 v[64:67], v[60:63], v[16:23], v110
    ds_read_b128 v[8:11], v112 offset:2048
    ds_read_b128 v[12:15], v112 offset:3072
    ds_read_b128 v[16:19], v112 offset:4096
    ds_read_b128 v[20:23], v112 offset:5120
    v_mov_b32 v76, 0
    v_mov_b32 v77, 0
    v_mov_b32 v78, 0
    s_nop 0
    v_permlane32_swap_b32 v64, v65
    v_permlane32_swap_b32 v66, v67
    v_cvt_pk_bf16_f32 v84, v64, v66
    v_cvt_pk_bf16_f32 v85, v65, v67
    v_bfi_b32 v84, 1, s22, v84
    buffer_load_dwordx2 v[42:43], v123, s[4:7], s19 offen offset:512 sc1
    v_mov_b32 v79, 0
    v_mov_b32 v80, 0
    v_mov_b32 v81, 0
    v_mov_b32 v82, 0
    v_mov_b32 v83, 0
    v_mov_b32 v60, 0
    v_mov_b32 v60, 0
    v_mov_b32 v60, 0
    v_mov_b32 v60, 0
    v_mov_b32 v60, 0
    v_mov_b32 v60, 0
    v_mov_b32 v60, 0
    buffer_store_dwordx2 v[84:85], v123, s[4:7], s18 offen offset:1024 sc1
    v_mov_b32 v60, 0
    v_mov_b32 v60, 0
    v_mov_b32 v60, 0
    v_mov_b32 v60, 0
    v_mov_b32 v60, 0
    v_mov_b32 v60, 0
    v_mov_b32 v60, 0
    v_mov_b32 v60, 0
    v_mov_b32 v60, 0
    v_mov_b32 v60, 0
    v_mov_b32 v60, 0
    v_mov_b32 v60, 0
    v_mov_b32 v60, 0
    v_mov_b32 v60, 0
    v_mov_b32 v60, 0
    v_mov_b32 v60, 0
    v_mov_b32 v60, 0
    v_mov_b32 v60, 0
    v_mov_b32 v60, 0
    v_mov_b32 v60, 0
    v_mov_b32 v60, 0
    v_mov_b32 v60, 0
    v_mov_b32 v60, 0
    v_mov_b32 v60, 0
    v_mov_b32 v60, 0
    v_mov_b32 v60, 0
    v_mov_b32 v60, 0
    v_mov_b32 v60, 0
    v_mov_b32 v60, 0
    v_mov_b32 v60, 0
    v_mov_b32 v60, 0
    v_mov_b32 v60, 0
    v_mov_b32 v60, 0
    v_mov_b32 v60, 0
    v_mov_b32 v60, 0
    v_mov_b32 v60, 0
    v_mov_b32 v60, 0
    v_mov_b32 v60, 0
    s_waitcnt vmcnt(2)
main_kernel_cf_z0:
    v_dot2_f32_bf16 v44, v126, s37, v96
    v_dot2_f32_bf16 v45, v126, s57, v97
    v_dot2_f32_bf16 v46, v127, s37, v98
    v_dot2_f32_bf16 v47, v127, s57, v99
    v_bitop3_b32 v60, v126, s22, 1 bitop3:0x28
    v_cvt_pk_bf16_f32 v44, v44, v45
    v_cmp_ne_u32 vcc, 0, v60
    v_cvt_pk_bf16_f32 v45, v46, v47
    ds_write_b64 v124, v[44:45] offset:0
    buffer_load_dwordx2 v[64:65], v123, s[4:7], s19 offen offset:512 sc1
    v_cmp_eq_u32 s[42:43], 0, v111
    s_cbranch_vccnz main_kernel_cf_z0_f
    v_mov_b32 v96, 0x3f803f80
    v_mov_b32 v97, 0x3f803f80
    v_mov_b32 v98, 0x3f803f80
    v_mov_b32 v99, 0x3f803f80
    s_and_b32 s32, s43, 0x3f00
    s_cbranch_scc1 main_kernel_cf_kvw
main_kernel_cf_kvok:
    s_waitcnt lgkmcnt(0)
    s_barrier
    ds_read_b64_tr_b16 v[48:49], v115 offset:16384
    ds_read_b64_tr_b16 v[50:51], v115 offset:17408
    ds_read_b64_tr_b16 v[52:53], v115 offset:18432
    ds_read_b64_tr_b16 v[54:55], v115 offset:19456
    s_waitcnt vmcnt(2)
    s_memtime s[52:53]
    v_dot2_f32_bf16 v44, v42, s37, v68
    v_dot2_f32_bf16 v45, v42, s57, v69
    v_dot2_f32_bf16 v46, v43, s37, v70
    v_dot2_f32_bf16 v47, v43, s57, v71
    v_bitop3_b32 v60, v42, s22, 1 bitop3:0x28
    v_cvt_pk_bf16_f32 v44, v44, v45
    v_cmp_ne_u32 vcc, 0, v60
    v_cvt_pk_bf16_f32 v45, v46, v47
    ds_write_b64 v124, v[44:45] offset:512
    s_waitcnt lgkmcnt(3)
    v_mfma_f32_16x16x32_bf16 v[32:35], v[0:3], v[48:51], 0
    v_mfma_f32_16x16x32_bf16 v[36:39], v[16:19], v[48:51], 0
    s_cbranch_vccnz main_kernel_cf_z1_f
main_kernel_cf_z_ok:
    v_mfma_f32_16x16x32_bf16 v[72:75], v[48:51], v[48:51], 0
    s_waitcnt lgkmcnt(1)
    s_sub_u32 s32, s52, s38
    v_mov_b32 v46, s32
    v_mfma_f32_16x16x32_bf16 v[32:35], v[4:7], v[52:55], v[32:35]
    buffer_load_dwordx2 v[86:87], v123, s[4:7], s19 offen offset:1024 sc1
    buffer_store_dword v46, v117, s[4:7], s46 offen
    s_cmp_eq_u32 s17, 64
    s_waitcnt lgkmcnt(0)
    s_barrier
    ds_read_b64_tr_b16 v[56:57], v115 offset:16896
    ds_read_b64_tr_b16 v[58:59], v115 offset:17920
    ds_read_b64_tr_b16 v[60:61], v115 offset:18944
    ds_read_b64_tr_b16 v[62:63], v115 offset:19968
    s_cbranch_scc1 main_kernel_cf_last
    v_bfe_u32 v47, v123, 1, 7
    buffer_load_dwordx2 v[126:127], v123, s[4:7], s19 offen offset:1024 sc1
    buffer_load_dwordx4 v116, s[4:7], s27 offen offset:1024 sc1 lds
    v_mfma_f32_16x16x32_bf16 v[36:39], v[20:23], v[52:55], v[36:39]
    v_mfma_f32_16x16x32_bf16 v[72:75], v[52:55], v[52:55], v[72:75]
    s_waitcnt lgkmcnt(2)
    v_mfma_f32_16x16x32_bf16 v[72:75], v[56:59], v[56:59], v[72:75]
    v_mfma_f32_16x16x32_bf16 v[32:35], v[8:11], v[56:59], v[32:35]
    s_waitcnt lgkmcnt(0)
    v_mfma_f32_16x16x32_bf16 v[72:75], v[60:63], v[60:63], v[72:75]
    ds_read_b128 v[0:3], v113 offset:16384
    v_mfma_f32_16x16x32_bf16 v[32:35], v[12:15], v[60:63], v[32:35]
    ds_read_b128 v[16:19], v113 offset:18432
    v_mfma_f32_16x16x32_bf16 v[36:39], v[24:27], v[56:59], v[36:39]
    ds_read_b128 v[4:7], v113 offset:17408
    s_nop 0
    v_permlane32_swap_b32 v72, v73
    v_permlane32_swap_b32 v74, v75
    v_mfma_f32_16x16x32_bf16 v[36:39], v[28:31], v[60:63], v[36:39]
    ds_read_b128 v[20:23], v113 offset:19456
    v_mul_f32 v73, s30, v73
    v_mul_f32 v75, s30, v75
    v_exp_f32 v32, v32
    ds_read_b128 v[8:11], v113 offset:24576
    v_exp_f32 v33, v33
    ds_read_b128 v[12:15], v113 offset:25600
    v_exp_f32 v73, v73
    ds_read_b128 v[24:27], v113 offset:26624
    v_exp_f32 v75, v75
    ds_read_b128 v[28:31], v113 offset:27648
    v_exp_f32 v34, v34
    v_cvt_pk_bf16_f32 v72, v73, v75
    v_cvt_pk_bf16_f32 v73, v73, v75
    v_exp_f32 v35, v35
    s_waitcnt vmcnt(4)
    v_mfma_f32_16x16x16_bf16 v[40:43], v[100:101], v[72:73], 0
    v_exp_f32 v36, v36
    v_cvt_pk_bf16_f32 v32, v32, v33
    v_exp_f32 v37, v37
    v_cvt_pk_bf16_f32 v33, v34, v35
    v_exp_f32 v38, v38
    v_exp_f32 v39, v39
    v_cvt_pk_bf16_f32 v34, v36, v37
    v_cvt_pk_bf16_f32 v35, v38, v39
    s_nop 1
    v_mfma_f32_16x16x32_bf16 v[40:43], v[96:99], v[32:35], v[40:43]
    v_mfma_f32_16x16x32_bf16 v[64:67], v[88:91], v[32:35], 0
    v_mfma_f32_16x16x32_bf16 v[68:71], v[92:95], v[32:35], 0
    s_waitcnt vmcnt(3)
main_kernel_cf_v_ok:
    v_bitop3_b32 v44, v86, s22, 1 bitop3:0x28
    v_swap_b32 v85, v86
    v_cmp_ne_u32 vcc, 0, v44
main_kernel_cf_d_ok:
    s_nop 0
    v_mfma_f32_16x16x16_bf16 v[64:67], v[84:85], v[72:73], v[64:67]
    v_mfma_f32_16x16x16_bf16 v[68:71], v[86:87], v[72:73], v[68:71]
    s_cbranch_vccnz main_kernel_cf_v_f
    v_rcp_f32 v42, v40
    v_subrev_u32 v41, 0x21800000, v41
    v_cmp_lt_u32 vcc, 0x3c000000, v41
    s_nop 0
    v_pk_mul_f32 v[64:65], v[64:65], v[42:43] op_sel_hi:[1,0]
    v_pk_mul_f32 v[66:67], v[66:67], v[42:43] op_sel_hi:[1,0]
    v_cvt_pk_bf16_f32 v44, v64, v65
    v_pk_mul_f32 v[68:69], v[68:69], v[42:43] op_sel_hi:[1,0]
    v_cvt_pk_bf16_f32 v45, v66, v67
    v_pk_mul_f32 v[70:71], v[70:71], v[42:43] op_sel_hi:[1,0]
    v_cvt_pk_bf16_f32 v46, v68, v69
    v_cvt_pk_bf16_f32 v47, v70, v71
    ds_write_b128 v118, v[44:47]
    s_and_b64 s[42:43], vcc, s[44:45]
    s_cbranch_scc1 main_kernel_cf_d_f
    s_mov_b64 s[44:45], s[0:1]
    v_mov_b32 v64, 0
    v_mov_b32 v65, 0
    v_mov_b32 v66, 0
    v_mov_b32 v67, 0
    v_mov_b32 v68, 0
    v_mov_b32 v69, 0
    v_mov_b32 v70, 0
    v_mov_b32 v71, 0
    v_bfe_u32 v90, v123, 1, 7
    s_xor_b32 s23, s23, 0x80000
    s_waitcnt lgkmcnt(0)
    s_barrier
    ds_read_b128 v[56:59], v114 offset:1024
    ds_read_b128 v[60:63], v114 offset:1536
    ds_read_b128 v[48:51], v114 offset:0
    ds_read_b128 v[52:55], v114 offset:512
    s_xor_b32 s18, s18, 0x100000
    s_xor_b32 s19, s18, 0x80000
    s_xor_b32 s25, s25, 0x4000
    s_add_u32 s27, s27, 0x40000
    v_add_u32 v121, 4, v121
    v_xor_b32 v112, 0x4000, v112
    s_xor_b32 s36, s36, 0x4000
    s_mov_b32 m0, 0
    s_mov_b32 s54, s24
    s_xor_b32 s24, s24, 0x4000
    s_add_u32 s55, s25, 4096
    v_mov_b32 v89, s17
    s_mov_b32 s15, 0
    s_add_u32 s56, s19, 1536
    s_xor_b32 s9, s11, s40
    s_add_u32 s16, s20, s38
    s_waitcnt lgkmcnt(3)
    v_smfmac_f32_16x16x64_bf16 v[76:79], v[56:59], v[0:7], v110
    s_waitcnt lgkmcnt(2)
    ds_read_b128 v[0:3], v113 offset:20480
    v_smfmac_f32_16x16x64_bf16 v[76:79], v[60:63], v[8:15], v110
    s_waitcnt lgkmcnt(2)
    ds_read_b128 v[4:7], v113 offset:21504
    v_smfmac_f32_16x16x64_bf16 v[76:79], v[48:51], v[192:199], v110
    s_waitcnt lgkmcnt(2)
    ds_read_b128 v[8:11], v113 offset:28672
    v_smfmac_f32_16x16x64_bf16 v[76:79], v[52:55], v[200:207], v110
    ds_read_b128 v[12:15], v113 offset:29696
    buffer_load_dword v111, v90, s[4:7], s47 offen sc1
    v_smfmac_f32_16x16x64_bf16 v[80:83], v[56:59], v[16:23], v110
    ds_read_b128 v[16:19], v113 offset:22528
    v_smfmac_f32_16x16x64_bf16 v[80:83], v[60:63], v[24:31], v110
    ds_read_b128 v[20:23], v113 offset:23552
    v_smfmac_f32_16x16x64_bf16 v[80:83], v[48:51], v[208:215], v110
    ds_read_b128 v[24:27], v113 offset:30720
    v_cvt_pk_f16_f32 v40, v76, v77
    v_smfmac_f32_16x16x64_bf16 v[80:83], v[52:55], v[216:223], v110
    ds_read_b128 v[28:31], v113 offset:31744
    v_cvt_pk_f16_f32 v41, v78, v79
    v_smfmac_f32_16x16x64_bf16 v[64:67], v[48:51], v[224:231], v110
    v_bfi_b32 v40, 1, s22, v40
    v_smfmac_f32_16x16x64_bf16 v[64:67], v[52:55], v[232:239], v110
    s_waitcnt lgkmcnt(6)
    buffer_load_dword v111, v90, s[4:7], s47 offen sc1
    v_smfmac_f32_16x16x64_bf16 v[64:67], v[56:59], v[0:7], v110
    s_waitcnt lgkmcnt(4)
    buffer_store_dwordx2 v[40:41], v119, s[4:7], s21 offen offset:0
    v_cvt_pk_f16_f32 v42, v80, v81
    v_smfmac_f32_16x16x64_bf16 v[64:67], v[60:63], v[8:15], v110
    v_cvt_pk_f16_f32 v43, v82, v83
    v_smfmac_f32_16x16x64_bf16 v[68:71], v[48:51], v[240:247], v110
    v_bfi_b32 v42, 1, s22, v42
    v_smfmac_f32_16x16x64_bf16 v[68:71], v[52:55], v[248:255], v110
    s_waitcnt lgkmcnt(2)
    v_smfmac_f32_16x16x64_bf16 v[68:71], v[56:59], v[16:23], v110
    s_waitcnt lgkmcnt(0)
    buffer_store_dwordx2 v[42:43], v119, s[4:7], s21 offen offset:512
    v_cvt_pk_f16_f32 v44, v64, v65
    v_smfmac_f32_16x16x64_bf16 v[68:71], v[60:63], v[24:31], v110
    v_cvt_pk_f16_f32 v45, v66, v67
    v_bfi_b32 v44, 1, s22, v44
    s_cmp_lg_u32 s14, 0
    buffer_store_dwordx2 v[44:45], v119, s[4:7], s21 offen offset:1024
    s_nop 3
    v_cvt_pk_f16_f32 v46, v68, v69
    v_cvt_pk_f16_f32 v47, v70, v71
    v_bfi_b32 v46, 1, s22, v46
    buffer_store_dwordx2 v[46:47], v119, s[4:7], s21 offen offset:1536
    s_cbranch_scc1 main_kernel_cf_wx
    s_waitcnt vmcnt(5)
    s_xor_b32 s21, s21, 0x80000
main_kernel_cf_rgo:
    v_subrev_u32 v32, s20, v111
    s_memtime s[52:53]
    v_cmp_lt_u32 vcc, 0x100000, v32
    v_max_u32_dpp v32, v32, v32 row_shr:1 row_mask:0xf bank_mask:0xf
    s_nop 0
    s_nop 0
    v_max_u32_dpp v32, v32, v32 row_shr:2 row_mask:0xf bank_mask:0xf
    s_nop 0
    s_cbranch_vccnz main_kernel_cf_fsp
main_kernel_cf_fok:
    s_nop 0
    v_max_u32_dpp v32, v32, v32 row_shr:4 row_mask:0xf bank_mask:0xf
    s_memtime s[52:53]
    s_nop 0
    v_max_u32_dpp v32, v32, v32 row_shr:8 row_mask:0xf bank_mask:0xf
    s_memtime s[52:53]
    s_nop 0
    v_max_u32_dpp v32, v32, v32 row_bcast:15 row_mask:0xa bank_mask:0xf
    s_memtime s[52:53]
    s_sub_u32 s33, s52, s16
    v_readlane_b32 s32, v32, 31
    s_add_u32 s33, s33, 0x400
    s_memtime s[52:53]
    s_add_u32 s34, s16, 1650
    s_memtime s[52:53]
    s_min_u32 s32, s32, s33
    s_max_u32 s32, s32, s15
    s_add_u32 s34, s34, s32
    s_mov_b32 s35, 200
main_kernel_cf_fw:
    s_memtime s[52:53]
    s_cmp_ge_u32 s52, s34
    s_cbranch_scc1 main_kernel_cf_fgo
    s_memtime s[52:53]
    s_cmp_ge_u32 s52, s34
    s_cbranch_scc1 main_kernel_cf_fgo
    s_memtime s[52:53]
    s_cmp_ge_u32 s52, s34
    s_cbranch_scc1 main_kernel_cf_fgo
    s_memtime s[52:53]
    s_cmp_ge_u32 s52, s34
    s_cbranch_scc1 main_kernel_cf_fgo
    s_memtime s[52:53]
    s_cmp_ge_u32 s52, s34
    s_cbranch_scc1 main_kernel_cf_fgo
    s_memtime s[52:53]
    s_cmp_ge_u32 s52, s34
    s_cbranch_scc1 main_kernel_cf_fgo
    s_memtime s[52:53]
    s_cmp_ge_u32 s52, s34
    s_cbranch_scc1 main_kernel_cf_fgo
    s_memtime s[52:53]
    s_cmp_ge_u32 s52, s34
    s_cbranch_scc1 main_kernel_cf_fgo
    s_sub_u32 s35, s35, 1
    s_cbranch_scc0 main_kernel_cf_fw
main_kernel_cf_fgo:
    buffer_load_dwordx4 v[0:3], v120, s[4:7], s23 offen sc1
    s_add_u32 s35, s23, 0x8000
    buffer_load_dwordx4 v[4:7], v120, s[4:7], s35 offen sc1
    s_add_u32 s35, s23, 0x10000
    buffer_load_dwordx4 v[8:11], v120, s[4:7], s35 offen sc1
    ds_read_b32 v33, v123 offset:20992
    s_add_u32 s35, s23, 0x18000
    buffer_load_dwordx4 v[12:15], v120, s[4:7], s35 offen sc1
    s_add_u32 s35, s23, 0x20000
    buffer_load_dwordx4 v[16:19], v120, s[4:7], s35 offen sc1
    s_add_u32 s35, s23, 0x28000
    buffer_load_dwordx4 v[20:23], v120, s[4:7], s35 offen sc1
    s_add_u32 s35, s23, 0x30000
    buffer_load_dwordx4 v[24:27], v120, s[4:7], s35 offen sc1
    s_add_u32 s35, s23, 0x38000
    buffer_load_dwordx4 v[28:31], v120, s[4:7], s35 offen sc1
    s_mov_b64 exec, 1
    s_waitcnt lgkmcnt(0)
    v_sub_u32 v33, s34, v33
    v_bfi_b32 v33, 1, s40, v33
    buffer_store_dword v33, off, s[4:7], s18 offset:1536 sc1
    v_readfirstlane_b32 s10, v33
    s_mov_b64 exec, -1
    s_waitcnt vmcnt(8)
    v_mfma_f32_16x16x32_f16 v[76:79], v[0:3], v[106:109], 0
    v_xor_b32 v36, s22, v0
    v_bitop3_b32 v36, v2, s22, v36 bitop3:0xbe
    s_waitcnt vmcnt(7)
    v_mfma_f32_16x16x32_f16 v[76:79], v[4:7], v[106:109], v[76:79]
    v_bitop3_b32 v36, v4, s22, v36 bitop3:0xbe
    v_bitop3_b32 v36, v6, s22, v36 bitop3:0xbe
    s_waitcnt vmcnt(6)
    v_mfma_f32_16x16x32_f16 v[76:79], v[8:11], v[106:109], v[76:79]
    v_bitop3_b32 v36, v8, s22, v36 bitop3:0xbe
    v_bitop3_b32 v36, v10, s22, v36 bitop3:0xbe
    s_waitcnt vmcnt(5)
    v_mfma_f32_16x16x32_f16 v[76:79], v[12:15], v[106:109], v[76:79]
    v_bitop3_b32 v36, v12, s22, v36 bitop3:0xbe
    v_bitop3_b32 v36, v14, s22, v36 bitop3:0xbe
    s_waitcnt vmcnt(4)
    v_mfma_f32_16x16x32_f16 v[76:79], v[16:19], v[106:109], v[76:79]
    v_bitop3_b32 v36, v16, s22, v36 bitop3:0xbe
    v_bitop3_b32 v36, v18, s22, v36 bitop3:0xbe
    s_waitcnt vmcnt(3)
    v_mfma_f32_16x16x32_f16 v[76:79], v[20:23], v[106:109], v[76:79]
    v_bitop3_b32 v36, v20, s22, v36 bitop3:0xbe
    v_bitop3_b32 v36, v22, s22, v36 bitop3:0xbe
    s_waitcnt vmcnt(2)
    v_mfma_f32_16x16x32_f16 v[76:79], v[24:27], v[106:109], v[76:79]
    v_bitop3_b32 v36, v24, s22, v36 bitop3:0xbe
    v_bitop3_b32 v36, v26, s22, v36 bitop3:0xbe
    s_waitcnt vmcnt(1)
    v_mfma_f32_16x16x32_f16 v[76:79], v[28:31], v[106:109], v[76:79]
    v_bitop3_b32 v36, v28, s22, v36 bitop3:0xbe
    v_bitop3_b32 v36, v30, s22, v36 bitop3:0xbe
    v_and_b32 v36, 1, v36
    v_cmp_ne_u32 vcc, 0, v36
    s_nop 3
    v_cvt_pk_bf16_f32 v126, v76, v77
    v_cvt_pk_bf16_f32 v127, v78, v79
    s_cbranch_vccnz main_kernel_cf_r_f
    buffer_store_dwordx2 v[126:127], v122, s[4:7], s24 offen
    s_sub_u32 s20, s34, s38
    s_mov_b32 s3, s34
    buffer_store_dword v89, v117, s[4:7], s46 offen offset:512
    v_mov_b32 v32, -1
    v_mov_b32 v33, -1
    v_mov_b32 v64, 0
    v_mov_b32 v65, 0
    v_mov_b32 v66, 0
    v_mov_b32 v67, 0
    v_mov_b32 v68, 0
    v_mov_b32 v69, 0
    v_mov_b32 v70, 0
    v_mov_b32 v71, 0
    v_mov_b32 v96, 0
    v_mov_b32 v97, 0
    v_mov_b32 v98, 0
    v_mov_b32 v99, 0
    buffer_store_dwordx2 v[32:33], v122, s[4:7], s54 offen
    s_cmp_eq_u32 s12, 0
    v_add_u32 v56, s59, v115
    s_cbranch_scc0 main_kernel_cf_vma
    ds_read_b64_tr_b16 v[80:81], v56 offset:16384
    ds_read_b64_tr_b16 v[82:83], v56 offset:17408
    s_waitcnt lgkmcnt(0)
    s_nop 15
    s_nop 15
    s_nop 5
    s_buffer_load_dword s9, s[4:7], s56 glc
    buffer_load_dword v111, v90, s[4:7], s47 offen offset:512 sc1
    buffer_load_dwordx4 v116, s[4:7], s25 offen offset:0 sc1 lds
    buffer_load_dwordx4 v116, s[4:7], s25 offen offset:1024 sc1 lds
    buffer_load_dwordx4 v116, s[4:7], s25 offen offset:2048 sc1 lds
    buffer_load_dwordx4 v116, s[4:7], s25 offen offset:3072 sc1 lds
    s_mov_b32 m0, 4096
    s_nop 0
    buffer_load_dwordx4 v116, s[4:7], s55 offen offset:0 sc1 lds
    buffer_load_dwordx4 v116, s[4:7], s55 offen offset:1024 sc1 lds
    buffer_load_dwordx4 v116, s[4:7], s55 offen offset:2048 sc1 lds
    buffer_load_dwordx4 v116, s[4:7], s55 offen offset:3072 sc1 lds
    v_mov_b32 v34, v90
    s_mov_b32 m0, s36
    s_barrier
    ds_read_b32 v35, v123 offset:20480
    buffer_load_dwordx4 v[88:91], v116, s[4:7], s28 offen offset:0 sc1
    buffer_load_dwordx4 v[92:95], v116, s[4:7], s28 offen offset:1024 sc1
    buffer_load_dwordx4 v116, s[4:7], s27 offen offset:0 sc1 lds
    buffer_store_dwordx4 v[80:83], v125, s[4:7], s26 offen sc1
    s_branch main_kernel_cf_kva
main_kernel_cf_vma:
    v_mfma_f32_16x16x32_bf16 v[56:59], v[102:105], v[84:87], 0
    s_nop 7
    v_cvt_pk_bf16_f32 v80, v56, v57
    v_cvt_pk_bf16_f32 v81, v58, v59
    s_nop 15
    s_nop 15
    s_nop 5
    s_buffer_load_dword s9, s[4:7], s56 glc
    buffer_load_dword v111, v90, s[4:7], s47 offen offset:512 sc1
    buffer_load_dwordx4 v116, s[4:7], s25 offen offset:0 sc1 lds
    buffer_load_dwordx4 v116, s[4:7], s25 offen offset:1024 sc1 lds
    buffer_load_dwordx4 v116, s[4:7], s25 offen offset:2048 sc1 lds
    buffer_load_dwordx4 v116, s[4:7], s25 offen offset:3072 sc1 lds
    s_mov_b32 m0, 4096
    s_nop 0
    buffer_load_dwordx4 v116, s[4:7], s55 offen offset:0 sc1 lds
    buffer_load_dwordx4 v116, s[4:7], s55 offen offset:1024 sc1 lds
    buffer_load_dwordx4 v116, s[4:7], s55 offen offset:2048 sc1 lds
    buffer_load_dwordx4 v116, s[4:7], s55 offen offset:3072 sc1 lds
    v_mov_b32 v34, v90
    s_mov_b32 m0, s36
    s_barrier
    ds_read_b32 v35, v123 offset:20480
    buffer_load_dwordx4 v[88:91], v116, s[4:7], s28 offen offset:0 sc1
    buffer_load_dwordx4 v[92:95], v116, s[4:7], s28 offen offset:1024 sc1
    buffer_load_dwordx4 v116, s[4:7], s27 offen offset:0 sc1 lds
    buffer_store_dwordx2 v[80:81], v123, s[4:7], s26 offen sc1
main_kernel_cf_kva:
    s_add_u32 s26, s26, 0x10000
    s_waitcnt vmcnt(12)
    v_cmp_gt_i32 vcc, s17, v111
    v_readfirstlane_b32 s38, v35
    s_cbranch_vccnz main_kernel_cf_mc_f
    s_waitcnt vmcnt(4)
    s_branch main_kernel_cf_top
main_kernel_cf_wx:
    s_cmp_lg_u32 s14, 1
    s_cbranch_scc1 main_kernel_cf_wy
    s_memrealtime s[32:33]
    s_nop 0
    s_nop 0
    s_memrealtime s[32:33]
    s_nop 0
    s_nop 0
    s_memrealtime s[32:33]
    s_nop 0
    s_nop 0
    s_memrealtime s[32:33]
    s_nop 0
    s_nop 0
    s_memrealtime s[32:33]
    s_nop 0
    s_nop 0
    s_memrealtime s[32:33]
    s_nop 0
    s_nop 0
    s_memrealtime s[32:33]
    s_nop 0
    s_nop 0
    s_memrealtime s[32:33]
    s_nop 0
    s_nop 0
    s_memrealtime s[32:33]
    s_nop 0
    s_nop 0
    s_memrealtime s[32:33]
    s_nop 0
    s_nop 0
    s_memrealtime s[32:33]
    s_nop 0
    s_nop 0
    s_memrealtime s[32:33]
    s_nop 0
    s_nop 0
    s_mov_b32 s34, s32
    s_memrealtime s[32:33]
    s_cmp_lg_u32 s32, s34
    s_cbranch_scc1 main_kernel_cf_e1
    s_memrealtime s[32:33]
    s_cmp_lg_u32 s32, s34
    s_cbranch_scc1 main_kernel_cf_e1
    s_memrealtime s[32:33]
    s_cmp_lg_u32 s32, s34
    s_cbranch_scc1 main_kernel_cf_e1
    s_memrealtime s[32:33]
    s_cmp_lg_u32 s32, s34
    s_cbranch_scc1 main_kernel_cf_e1
    s_memrealtime s[32:33]
    s_cmp_lg_u32 s32, s34
    s_cbranch_scc1 main_kernel_cf_e1
    s_memrealtime s[32:33]
    s_cmp_lg_u32 s32, s34
    s_cbranch_scc1 main_kernel_cf_e1
    s_memrealtime s[32:33]
    s_cmp_lg_u32 s32, s34
    s_cbranch_scc1 main_kernel_cf_e1
    s_memrealtime s[32:33]
    s_cmp_lg_u32 s32, s34
    s_cbranch_scc1 main_kernel_cf_e1
    s_memrealtime s[32:33]
    s_cmp_lg_u32 s32, s34
    s_cbranch_scc1 main_kernel_cf_e1
    s_memrealtime s[32:33]
    s_cmp_lg_u32 s32, s34
    s_cbranch_scc1 main_kernel_cf_e1
    s_memrealtime s[32:33]
    s_cmp_lg_u32 s32, s34
    s_cbranch_scc1 main_kernel_cf_e1
    s_memrealtime s[32:33]
    s_cmp_lg_u32 s32, s34
    s_cbranch_scc1 main_kernel_cf_e1
main_kernel_cf_e1:
    s_memtime s[52:53]
    s_mul_i32 s34, s32, 22
    s_waitcnt lgkmcnt(0)
    s_sub_u32 s32, s52, s34
    s_sub_u32 s33, s32, s38
    s_sub_u32 s33, s33, s10
    s_max_i32 s33, s33, -400
    s_min_i32 s33, s33, 400
    s_ashr_i32 s33, s33, 2
    s_add_u32 s10, s10, s33
    s_mov_b32 s33, s10
    s_ashr_i32 s34, s33, 2
    s_add_u32 s34, s34, s32
    v_mov_b32 v34, s34
    v_mov_b32 v33, s32
    ds_write2st64_b32 v123, v33, v34 offset0:80 offset1:82
    v_add_u32 v37, s33, v34
main_kernel_cf_wy:
    s_xor_b32 s21, s21, 0x80000
    v_mov_b32 v64, 0
    v_mov_b32 v65, 0
    v_mov_b32 v66, 0
    v_mov_b32 v67, 0
    v_mov_b32 v68, 0
    v_mov_b32 v69, 0
    v_mov_b32 v70, 0
    v_mov_b32 v71, 0
    v_mov_b32 v96, 0
    v_mov_b32 v97, 0
    v_mov_b32 v98, 0
    v_mov_b32 v99, 0
    s_cmp_eq_u32 s12, 0
    v_add_u32 v56, s59, v115
    s_cbranch_scc0 main_kernel_cf_vmb
    ds_read_b64_tr_b16 v[80:81], v56 offset:16384
    ds_read_b64_tr_b16 v[82:83], v56 offset:17408
    s_waitcnt lgkmcnt(0)
    s_waitcnt vmcnt(0)
    s_mov_b32 m0, s36
    s_barrier
    ds_read_b32 v35, v123 offset:20480
    ds_write_b32 v124, v37 offset:3584
    buffer_load_dwordx4 v[88:91], v116, s[4:7], s28 offen offset:0 sc1
    buffer_load_dwordx4 v[92:95], v116, s[4:7], s28 offen offset:1024 sc1
    buffer_load_dwordx4 v116, s[4:7], s27 offen offset:0 sc1 lds
    buffer_store_dwordx4 v[80:83], v125, s[4:7], s26 offen sc1
    s_branch main_kernel_cf_kvb
main_kernel_cf_vmb:
    v_mfma_f32_16x16x32_bf16 v[56:59], v[102:105], v[84:87], 0
    s_nop 7
    v_cvt_pk_bf16_f32 v80, v56, v57
    v_cvt_pk_bf16_f32 v81, v58, v59
    s_waitcnt vmcnt(0)
    s_mov_b32 m0, s36
    s_barrier
    ds_read_b32 v35, v123 offset:20480
    ds_write_b32 v124, v37 offset:3584
    buffer_load_dwordx4 v[88:91], v116, s[4:7], s28 offen offset:0 sc1
    buffer_load_dwordx4 v[92:95], v116, s[4:7], s28 offen offset:1024 sc1
    buffer_load_dwordx4 v116, s[4:7], s27 offen offset:0 sc1 lds
    buffer_store_dwordx2 v[80:81], v123, s[4:7], s26 offen sc1
main_kernel_cf_kvb:
    s_add_u32 s26, s26, 0x10000
    s_mov_b64 exec, 1
    buffer_store_dword v100, off, s[4:7], s39 sc1
    s_mov_b64 exec, -1
    s_add_u32 s39, s39, 4
    s_waitcnt lgkmcnt(0)
    v_readfirstlane_b32 s38, v35
    v_mov_b32 v35, 0
    v_mov_b32 v35, 0
    v_mov_b32 v35, 0
    v_mov_b32 v35, 0
    v_mov_b32 v35, 0
    v_mov_b32 v35, 0
main_kernel_cf_end:
    s_branch main_kernel_cf_top
main_kernel_cf_mc_f:
    s_mov_b32 m0, 0
    s_sub_u32 s29, s29, 1
    s_cbranch_scc1 main_kernel_end
    buffer_load_dword v111, v34, s[4:7], s47 offen offset:512 sc1
    buffer_load_dwordx4 v116, s[4:7], s25 offen offset:0 sc1 lds
    buffer_load_dwordx4 v116, s[4:7], s25 offen offset:1024 sc1 lds
    buffer_load_dwordx4 v116, s[4:7], s25 offen offset:2048 sc1 lds
    buffer_load_dwordx4 v116, s[4:7], s25 offen offset:3072 sc1 lds
    s_mov_b32 m0, 4096
    s_nop 0
    buffer_load_dwordx4 v116, s[4:7], s55 offen offset:0 sc1 lds
    buffer_load_dwordx4 v116, s[4:7], s55 offen offset:1024 sc1 lds
    buffer_load_dwordx4 v116, s[4:7], s55 offen offset:2048 sc1 lds
    buffer_load_dwordx4 v116, s[4:7], s55 offen offset:3072 sc1 lds
    s_waitcnt vmcnt(8)
    v_cmp_gt_i32 vcc, s17, v111
    v_readfirstlane_b32 s38, v35
    s_cbranch_vccnz main_kernel_cf_mc_f
    s_waitcnt vmcnt(0)
    s_branch main_kernel_cf_end
main_kernel_cf_t_w:
    s_mov_b32 s35, 200
main_kernel_cf_t_s:
    s_memtime s[52:53]
    s_cmp_ge_u32 s52, s34
    s_cbranch_scc1 main_kernel_cf_t_go
    s_memtime s[52:53]
    s_cmp_ge_u32 s52, s34
    s_cbranch_scc1 main_kernel_cf_t_go
    s_memtime s[52:53]
    s_cmp_ge_u32 s52, s34
    s_cbranch_scc1 main_kernel_cf_t_go
    s_memtime s[52:53]
    s_cmp_ge_u32 s52, s34
    s_cbranch_scc1 main_kernel_cf_t_go
    s_memtime s[52:53]
    s_cmp_ge_u32 s52, s34
    s_cbranch_scc1 main_kernel_cf_t_go
    s_memtime s[52:53]
    s_cmp_ge_u32 s52, s34
    s_cbranch_scc1 main_kernel_cf_t_go
    s_memtime s[52:53]
    s_cmp_ge_u32 s52, s34
    s_cbranch_scc1 main_kernel_cf_t_go
    s_memtime s[52:53]
    s_cmp_ge_u32 s52, s34
    s_cbranch_scc1 main_kernel_cf_t_go
    s_sub_u32 s35, s35, 1
    s_cbranch_scc0 main_kernel_cf_t_s
    s_branch main_kernel_cf_t_go
main_kernel_cf_t_p:
    s_waitcnt lgkmcnt(0)
    s_xor_b32 s32, s9, s22
    s_bitcmp1_b32 s32, 0
    s_cbranch_scc0 main_kernel_cf_t_ok
    s_buffer_load_dword s9, s[4:7], s56 glc
    s_sub_u32 s29, s29, 1
    s_cbranch_scc1 main_kernel_end
    s_branch main_kernel_cf_t_p
main_kernel_cf_z0_f:
    buffer_load_dwordx2 v[126:127], v123, s[4:7], s19 offen offset:0 sc1
    s_sub_u32 s29, s29, 1
    s_cbranch_scc1 main_kernel_end
    s_waitcnt vmcnt(0)
    s_branch main_kernel_cf_z0
main_kernel_cf_z2_f:
    buffer_load_dwordx2 v[64:65], v123, s[4:7], s19 offen offset:512 sc1
    s_sub_u32 s29, s29, 1
    s_cbranch_scc1 main_kernel_end
    s_waitcnt vmcnt(0)
main_kernel_cf_z1_f:
    s_waitcnt vmcnt(0)
    s_memtime s[52:53]
    v_dot2_f32_bf16 v44, v64, s37, v68
    v_dot2_f32_bf16 v45, v64, s57, v69
    v_dot2_f32_bf16 v46, v65, s37, v70
    v_dot2_f32_bf16 v47, v65, s57, v71
    v_bitop3_b32 v60, v64, s22, 1 bitop3:0x28
    v_cvt_pk_bf16_f32 v44, v44, v45
    v_cmp_ne_u32 vcc, 0, v60
    v_cvt_pk_bf16_f32 v45, v46, v47
    ds_write_b64 v124, v[44:45] offset:512
    s_cbranch_vccnz main_kernel_cf_z2_f
    s_branch main_kernel_cf_z_ok
main_kernel_cf_kvw:
    s_cmp_eq_u32 s17, 64
    s_cbranch_scc1 main_kernel_cf_kvok
    s_waitcnt vmcnt(0)
    s_mov_b32 exec_lo, 0
    s_mov_b32 exec_hi, 0x3f00
    v_subrev_u32 v127, 0, v121
main_kernel_cf_kvp:
    buffer_load_dword v126, v127, s[4:7], 0 offen sc1
    s_waitcnt vmcnt(0)
    v_cmp_eq_u32 vcc, 0, v126
    s_cbranch_vccz main_kernel_cf_kvp_ok
    s_sleep 2
    s_sub_u32 s29, s29, 1
    s_cbranch_scc0 main_kernel_cf_kvp
    s_branch main_kernel_end
main_kernel_cf_kvp_ok:
    s_mov_b64 exec, -1
    s_branch main_kernel_cf_kvok
main_kernel_cf_las2:
    buffer_load_dwordx2 v[86:87], v123, s[4:7], s19 offen offset:1024 sc1
    s_sub_u32 s29, s29, 1
    s_cbranch_scc1 main_kernel_end
main_kernel_cf_last:
    s_cmp_eq_u32 s12, 0
    s_cbranch_scc1 main_kernel_cf_las3
    s_waitcnt vmcnt(0) lgkmcnt(0)
    v_bitop3_b32 v44, v86, s22, 1 bitop3:0x28
    v_cmp_ne_u32 vcc, 0, v44
    s_cbranch_vccnz main_kernel_cf_las2
    v_swap_b32 v85, v86
main_kernel_cf_las3:
    s_waitcnt lgkmcnt(0)
    s_cmp_eq_u32 s12, 0
    v_add_u32 v56, s59, v115
    s_cbranch_scc0 main_kernel_cf_vmc
    ds_read_b64_tr_b16 v[80:81], v56 offset:16384
    ds_read_b64_tr_b16 v[82:83], v56 offset:17408
    s_waitcnt lgkmcnt(0)
    buffer_store_dwordx4 v[80:83], v125, s[4:7], s26 offen sc1
    s_branch main_kernel_cf_kvc
main_kernel_cf_vmc:
    v_mfma_f32_16x16x32_bf16 v[56:59], v[102:105], v[84:87], 0
    s_nop 7
    v_cvt_pk_bf16_f32 v80, v56, v57
    v_cvt_pk_bf16_f32 v81, v58, v59
    buffer_store_dwordx2 v[80:81], v123, s[4:7], s26 offen sc1
main_kernel_cf_kvc:
    s_add_u32 s26, s26, 0x10000
    s_branch main_kernel_end
main_kernel_cf_m_f:
main_kernel_cf_m_t:
    ds_read_b128 v[0:3], v116 offset:0
    ds_read_b128 v[4:7], v116 offset:1024
    ds_read_b128 v[8:11], v116 offset:2048
    ds_read_b128 v[12:15], v116 offset:3072
    ds_read_b128 v[16:19], v116 offset:4096
    ds_read_b128 v[20:23], v116 offset:5120
    ds_read_b128 v[24:27], v116 offset:6144
    ds_read_b128 v[28:31], v116 offset:7168
    s_waitcnt lgkmcnt(0)
    v_max_u32 v126, v0, v2
    v_max3_u32 v126, v126, v4, v6
    v_max3_u32 v126, v126, v8, v10
    v_max3_u32 v126, v126, v12, v14
    v_max3_u32 v126, v126, v16, v18
    v_max3_u32 v126, v126, v20, v22
    v_max3_u32 v126, v126, v24, v26
    v_max3_u32 v126, v126, v28, v30
    v_cmp_eq_u32 vcc, -1, v126
    s_cbranch_vccz main_kernel_cf_m_g
    s_barrier
    s_lshl_b32 s32, s14, 11
    s_add_u32 m0, s32, 0
    s_add_u32 s32, s32, s25
    buffer_load_dwordx4 v116, s[4:7], s32 offen offset:0 sc1 lds
    buffer_load_dwordx4 v116, s[4:7], s32 offen offset:1024 sc1 lds
    s_sub_u32 s29, s29, 1
    s_cbranch_scc1 main_kernel_end
    s_waitcnt vmcnt(0)
    s_barrier
    s_branch main_kernel_cf_m_t
main_kernel_cf_m_g:
    s_mov_b64 s[44:45], 0
    v_mov_b32 v64, 0
    v_mov_b32 v65, 0
    v_mov_b32 v66, 0
    v_mov_b32 v67, 0
    v_mov_b32 v68, 0
    v_mov_b32 v69, 0
    v_mov_b32 v70, 0
    v_mov_b32 v71, 0
    v_mov_b32 v96, 0
    v_mov_b32 v97, 0
    v_mov_b32 v98, 0
    v_mov_b32 v99, 0
    s_branch main_kernel_cf_mrd
main_kernel_cf_v_f:
    v_swap_b32 v85, v86
    s_nop 7
    s_waitcnt vmcnt(1)
main_kernel_cf_v_t:
    s_memtime s[52:53]
    v_bitop3_b32 v44, v126, s22, 1 bitop3:0x28
    v_cmp_ne_u32 vcc, 0, v44
    s_sub_u32 s29, s29, 1
    s_cbranch_scc1 main_kernel_end
    s_cbranch_vccnz main_kernel_cf_v_g
    v_mfma_f32_16x16x32_bf16 v[64:67], v[88:91], v[32:35], 0
    v_mfma_f32_16x16x32_bf16 v[68:71], v[92:95], v[32:35], 0
    v_mov_b32 v86, v126
    v_mov_b32 v87, v127
    s_waitcnt lgkmcnt(0)
    s_sub_u32 s32, s52, s38
    s_add_u32 s32, s32, -550
    v_mov_b32 v46, s32
    buffer_store_dword v46, v117, s[4:7], s46 offen
    s_branch main_kernel_cf_v_ok
main_kernel_cf_v_g:
    buffer_load_dwordx2 v[126:127], v123, s[4:7], s19 offen offset:1024 sc1
    s_waitcnt lgkmcnt(0)
    s_sub_u32 s32, s52, s38
    s_add_u32 s32, s32, -50
    v_mov_b32 v46, s32
    buffer_store_dword v46, v117, s[4:7], s46 offen
    s_waitcnt vmcnt(0)
    s_branch main_kernel_cf_v_t
main_kernel_cf_d_f:
    s_memtime s[52:53]
    s_waitcnt vmcnt(1) lgkmcnt(0)
    s_sub_u32 s32, s52, s38
    s_add_u32 s32, s32, 300
    v_mov_b32 v46, s32
    buffer_store_dword v46, v117, s[4:7], s46 offen
    ds_read_b128 v[0:3], v112 offset:0
    ds_read_b128 v[4:7], v112 offset:1024
    ds_read_b128 v[8:11], v112 offset:2048
    ds_read_b128 v[12:15], v112 offset:3072
    ds_read_b128 v[16:19], v112 offset:4096
    ds_read_b128 v[20:23], v112 offset:5120
    ds_read_b128 v[24:27], v112 offset:6144
    ds_read_b128 v[28:31], v112 offset:7168
    s_waitcnt lgkmcnt(0)
    v_mfma_f32_16x16x32_bf16 v[32:35], v[0:3], v[48:51], 0
    v_mfma_f32_16x16x32_bf16 v[36:39], v[16:19], v[48:51], 0
    v_mfma_f32_16x16x32_bf16 v[72:75], v[48:51], v[48:51], 0
    v_mfma_f32_16x16x32_bf16 v[32:35], v[4:7], v[52:55], v[32:35]
    v_mfma_f32_16x16x32_bf16 v[36:39], v[20:23], v[52:55], v[36:39]
    v_mfma_f32_16x16x32_bf16 v[72:75], v[52:55], v[52:55], v[72:75]
    v_mfma_f32_16x16x32_bf16 v[32:35], v[8:11], v[56:59], v[32:35]
    v_mfma_f32_16x16x32_bf16 v[36:39], v[24:27], v[56:59], v[36:39]
    v_mfma_f32_16x16x32_bf16 v[72:75], v[56:59], v[56:59], v[72:75]
    v_mfma_f32_16x16x32_bf16 v[32:35], v[12:15], v[60:63], v[32:35]
    v_mfma_f32_16x16x32_bf16 v[36:39], v[28:31], v[60:63], v[36:39]
    v_mfma_f32_16x16x32_bf16 v[72:75], v[60:63], v[60:63], v[72:75]
    s_nop 7
    ds_read_b128 v[0:3], v113 offset:16384
    ds_read_b128 v[16:19], v113 offset:18432
    ds_read_b128 v[4:7], v113 offset:17408
    ds_read_b128 v[20:23], v113 offset:19456
    ds_read_b128 v[8:11], v113 offset:24576
    ds_read_b128 v[24:27], v113 offset:26624
    ds_read_b128 v[12:15], v113 offset:25600
    ds_read_b128 v[28:31], v113 offset:27648
    v_permlane32_swap_b32 v72, v73
    v_permlane32_swap_b32 v74, v75
    v_mul_f32 v73, s30, v73
    v_mul_f32 v75, s30, v75
    v_max_f32 v126, v73, v75
    v_max3_f32 v126, v126, v32, v33
    v_max3_f32 v126, v126, v34, v35
    v_max3_f32 v126, v126, v36, v37
    v_max3_f32 v126, v126, v38, v39
    v_mov_b32 v127, v126
    s_nop 1
    v_permlane32_swap_b32 v126, v127
    v_max_f32 v126, v126, v127
    v_mov_b32 v127, v126
    s_nop 1
    v_permlane16_swap_b32 v126, v127
    v_max_f32 v126, v126, v127
    v_sub_f32 v32, v32, v126
    v_sub_f32 v33, v33, v126
    v_sub_f32 v34, v34, v126
    v_sub_f32 v35, v35, v126
    v_sub_f32 v36, v36, v126
    v_sub_f32 v37, v37, v126
    v_sub_f32 v38, v38, v126
    v_sub_f32 v39, v39, v126
    v_sub_f32 v73, v73, v126
    v_sub_f32 v75, v75, v126
    v_exp_f32 v32, v32
    v_exp_f32 v33, v33
    v_exp_f32 v34, v34
    v_exp_f32 v35, v35
    v_exp_f32 v36, v36
    v_exp_f32 v37, v37
    v_exp_f32 v38, v38
    v_exp_f32 v39, v39
    v_exp_f32 v73, v73
    v_exp_f32 v75, v75
    v_cvt_pk_bf16_f32 v32, v32, v33
    v_cvt_pk_bf16_f32 v33, v34, v35
    v_cvt_pk_bf16_f32 v34, v36, v37
    v_cvt_pk_bf16_f32 v35, v38, v39
    v_cvt_pk_bf16_f32 v72, v73, v75
    v_cvt_pk_bf16_f32 v73, v73, v75
    s_nop 1
    v_mfma_f32_16x16x32_bf16 v[64:67], v[88:91], v[32:35], 0
    v_mfma_f32_16x16x32_bf16 v[68:71], v[92:95], v[32:35], 0
    v_mfma_f32_16x16x32_bf16 v[40:43], v[96:99], v[32:35], 0
    s_nop 3
    s_nop 1
    v_mfma_f32_16x16x16_bf16 v[40:43], v[100:101], v[72:73], v[40:43]
    s_mov_b64 s[44:45], 0
    s_mov_b64 vcc, 0
    s_nop 7
    s_branch main_kernel_cf_d_ok
main_kernel_cf_fsp:
    s_mov_b32 s35, 40
main_kernel_cf_fsl:
    buffer_load_dword v111, v90, s[4:7], s47 offen sc1
    s_waitcnt vmcnt(1)
    v_subrev_u32 v32, s20, v111
    v_cmp_lt_u32 vcc, 0x100000, v32
    s_cbranch_vccz main_kernel_cf_rgo
    s_sub_u32 s35, s35, 1
    s_cbranch_scc0 main_kernel_cf_fsl
    v_mov_b32 v32, 0
    s_branch main_kernel_cf_fok
main_kernel_cf_r_f:
    s_memtime s[52:53]
    buffer_load_dword v111, v90, s[4:7], s47 offen sc1
    s_waitcnt lgkmcnt(0)
    s_sub_u32 s15, s52, s16
    s_add_u32 s15, s15, -1500
    s_waitcnt vmcnt(0)
    s_sub_u32 s29, s29, 1
    s_cbranch_scc1 main_kernel_end
    s_branch main_kernel_cf_rgo
    .p2align 6
main_kernel_cs_top:
    s_barrier
main_kernel_cs_mrd:
    ds_read_b128 v[0:3], v114 offset:0
    ds_read_b128 v[4:7], v114 offset:512
    ds_read_b128 v[8:11], v114 offset:1024
    ds_read_b128 v[12:15], v114 offset:1536
    ds_read_b128 v[16:19], v114 offset:2048
    s_waitcnt lgkmcnt(4)
    v_smfmac_f32_16x16x64_bf16 v[96:99], v[0:3], a[0:7], v110
    ds_read_b128 v[20:23], v114 offset:2560
    s_waitcnt lgkmcnt(4)
    v_smfmac_f32_16x16x64_bf16 v[96:99], v[4:7], a[8:15], v110
    ds_read_b128 v[24:27], v114 offset:3072
    s_waitcnt lgkmcnt(4)
    s_bfe_u32 s22, s17, 0x10001
    v_smfmac_f32_16x16x64_bf16 v[96:99], v[8:11], a[16:23], v110
    ds_read_b128 v[28:31], v114 offset:3584
    s_waitcnt lgkmcnt(4)
    v_smfmac_f32_16x16x64_bf16 v[96:99], v[12:15], a[24:31], v110
    ds_read_b128 v[32:35], v114 offset:4096
    s_waitcnt lgkmcnt(4)
    v_smfmac_f32_16x16x64_bf16 v[96:99], v[16:19], a[32:39], v110
    ds_read_b128 v[36:39], v114 offset:4608
    s_waitcnt lgkmcnt(4)
    v_smfmac_f32_16x16x64_bf16 v[96:99], v[20:23], a[40:47], v110
    ds_read_b128 v[40:43], v114 offset:5120
    s_waitcnt lgkmcnt(4)
    v_smfmac_f32_16x16x64_bf16 v[96:99], v[24:27], a[48:55], v110
    ds_read_b128 v[44:47], v114 offset:5632
    s_waitcnt lgkmcnt(4)
    v_smfmac_f32_16x16x64_bf16 v[96:99], v[28:31], a[56:63], v110
    ds_read_b128 v[48:51], v114 offset:6144
    s_waitcnt lgkmcnt(4)
    v_smfmac_f32_16x16x64_bf16 v[96:99], v[32:35], a[64:71], v110
    ds_read_b128 v[52:55], v114 offset:6656
    s_waitcnt lgkmcnt(4)
    v_smfmac_f32_16x16x64_bf16 v[96:99], v[36:39], a[72:79], v110
    ds_read_b128 v[56:59], v114 offset:7168
    s_waitcnt lgkmcnt(4)
    v_smfmac_f32_16x16x64_bf16 v[96:99], v[40:43], a[80:87], v110
    ds_read_b128 v[60:63], v114 offset:7680
    s_waitcnt lgkmcnt(4)
    v_smfmac_f32_16x16x64_bf16 v[96:99], v[44:47], a[88:95], v110
    s_waitcnt lgkmcnt(3)
    buffer_load_dword v111, v121, s[4:7], 0 offen sc1
    v_smfmac_f32_16x16x64_bf16 v[96:99], v[48:51], a[96:103], v110
    s_waitcnt lgkmcnt(2)
    ds_read_b128 v[80:83], v113 offset:0
    v_smfmac_f32_16x16x64_bf16 v[96:99], v[52:55], a[104:111], v110
    s_waitcnt lgkmcnt(2)
    ds_read_b128 v[84:87], v113 offset:1024
    v_smfmac_f32_16x16x64_bf16 v[96:99], v[56:59], a[112:119], v110
    s_waitcnt lgkmcnt(2)
    v_smfmac_f32_16x16x64_bf16 v[96:99], v[60:63], a[120:127], v110
    v_smfmac_f32_16x16x64_bf16 v[68:71], v[0:3], a[128:135], v110
    ds_read_b128 v[72:75], v113 offset:2048
    v_smfmac_f32_16x16x64_bf16 v[68:71], v[4:7], a[136:143], v110
    s_nop 1
    v_pk_add_f32 v[126:127], v[96:97], v[98:99]
    ds_read_b128 v[76:79], v113 offset:3072
    v_smfmac_f32_16x16x64_bf16 v[68:71], v[8:11], a[144:151], v110
    v_cmp_u_f32 vcc, v126, v127
    v_smfmac_f32_16x16x64_bf16 v[68:71], v[12:15], a[152:159], v110
    v_cvt_pk_bf16_f32 v126, v96, v97
    v_smfmac_f32_16x16x64_bf16 v[68:71], v[16:19], a[160:167], v110
    v_cvt_pk_bf16_f32 v127, v98, v99
    s_and_b64 s[42:43], vcc, s[44:45]
    s_cbranch_scc1 main_kernel_cs_m_f
    v_smfmac_f32_16x16x64_bf16 v[68:71], v[20:23], a[168:175], v110
    v_bfi_b32 v126, 1, s22, v126
    buffer_store_dwordx2 v[126:127], v123, s[4:7], s18 offen sc1
    v_smfmac_f32_16x16x64_bf16 v[68:71], v[24:27], a[176:183], v110
    s_mov_b64 s[44:45], s[0:1]
    v_smfmac_f32_16x16x64_bf16 v[68:71], v[28:31], a[184:191], v110
    s_add_u32 s17, s17, 1
    s_bfe_u32 s40, s17, 0x10001
    v_smfmac_f32_16x16x64_bf16 v[68:71], v[32:35], a[192:199], v110
    s_add_u32 s28, s28, 0x40000
    s_mov_b32 m0, s36
    v_smfmac_f32_16x16x64_bf16 v[68:71], v[36:39], a[200:207], v110
    s_add_u32 s34, s3, 2100
    v_smfmac_f32_16x16x64_bf16 v[68:71], v[40:43], a[208:215], v110
    v_smfmac_f32_16x16x64_bf16 v[68:71], v[44:47], a[216:223], v110
    v_smfmac_f32_16x16x64_bf16 v[68:71], v[48:51], a[224:231], v110
    v_smfmac_f32_16x16x64_bf16 v[68:71], v[52:55], a[232:239], v110
    v_smfmac_f32_16x16x64_bf16 v[68:71], v[56:59], a[240:247], v110
    v_smfmac_f32_16x16x64_bf16 v[68:71], v[60:63], a[248:255], v110
    s_waitcnt lgkmcnt(2)
    v_smfmac_f32_16x16x64_bf16 v[64:67], v[32:35], v[80:87], v110
    s_waitcnt lgkmcnt(0)
    s_nop 3
    v_cvt_pk_bf16_f32 v126, v68, v69
    v_cvt_pk_bf16_f32 v127, v70, v71
    v_bfi_b32 v126, 1, s22, v126
    buffer_store_dwordx2 v[126:127], v123, s[4:7], s18 offen offset:512 sc1
    ds_read_b128 v[80:83], v113 offset:4096
    v_smfmac_f32_16x16x64_bf16 v[64:67], v[36:39], v[72:79], v110
    ds_read_b128 v[84:87], v113 offset:5120
    v_smfmac_f32_16x16x64_bf16 v[64:67], v[0:3], v[128:135], v110
    ds_read_b128 v[72:75], v113 offset:6144
    v_smfmac_f32_16x16x64_bf16 v[64:67], v[4:7], v[136:143], v110
    ds_read_b128 v[76:79], v113 offset:7168
    v_smfmac_f32_16x16x64_bf16 v[64:67], v[8:11], v[144:151], v110
    ds_read_b128 v[32:35], v113 offset:8192
    v_smfmac_f32_16x16x64_bf16 v[64:67], v[12:15], v[152:159], v110
    ds_read_b128 v[36:39], v113 offset:9216
    v_smfmac_f32_16x16x64_bf16 v[64:67], v[16:19], v[160:167], v110
    ds_read_b128 v[0:3], v113 offset:10240
    s_memtime s[52:53]
    v_smfmac_f32_16x16x64_bf16 v[64:67], v[20:23], v[168:175], v110
    ds_read_b128 v[4:7], v113 offset:11264
    s_memtime s[52:53]
    s_xor_b32 s32, s9, s22
    s_bitcmp1_b32 s32, 0
    s_cbranch_scc1 main_kernel_cs_t_p
main_kernel_cs_t_ok:
    s_sub_u32 s32, s9, s10
    v_smfmac_f32_16x16x64_bf16 v[64:67], v[24:27], v[176:183], v110
    ds_read_b128 v[8:11], v113 offset:12288
    s_memtime s[52:53]
    s_max_i32 s32, s32, 0
    s_min_i32 s32, s32, 0x4000
    v_smfmac_f32_16x16x64_bf16 v[64:67], v[28:31], v[184:191], v110
    s_waitcnt lgkmcnt(7)
    ds_read_b128 v[12:15], v113 offset:13312
    s_memtime s[52:53]
    s_add_u32 s34, s34, s32
    s_and_b32 s34, s34, s11
    v_smfmac_f32_16x16x64_bf16 v[64:67], v[40:43], v[80:87], v110
    s_waitcnt lgkmcnt(6)
    ds_read_b128 v[16:19], v113 offset:14336
    s_cmp_lt_u32 s52, s34
    s_cbranch_scc1 main_kernel_cs_t_w
main_kernel_cs_t_go:
    s_barrier
    buffer_load_dwordx2 v[126:127], v123, s[4:7], s19 offen offset:0 sc1
    v_smfmac_f32_16x16x64_bf16 v[64:67], v[44:47], v[72:79], v110
    s_waitcnt lgkmcnt(5)
    ds_read_b128 v[20:23], v113 offset:15360
    v_smfmac_f32_16x16x64_bf16 v[64:67], v[48:51], v[32:39], v110
    s_waitcnt lgkmcnt(4)
    v_smfmac_f32_16x16x64_bf16 v[64:67], v[52:55], v[0:7], v110
    s_waitcnt lgkmcnt(2)
    ds_read_b128 v[24:27], v112 offset:6144
    ds_read_b128 v[28:31], v112 offset:7168
    v_smfmac_f32_16x16x64_bf16 v[64:67], v[56:59], v[8:15], v110
    s_waitcnt lgkmcnt(2)
    ds_read_b128 v[0:3], v112 offset:0
    ds_read_b128 v[4:7], v112 offset:1024
    v_smfmac_f32_16x16x64_bf16 v[64:67], v[60:63], v[16:23], v110
    ds_read_b128 v[8:11], v112 offset:2048
    ds_read_b128 v[12:15], v112 offset:3072
    ds_read_b128 v[16:19], v112 offset:4096
    ds_read_b128 v[20:23], v112 offset:5120
    v_mov_b32 v76, 0
    v_mov_b32 v77, 0
    v_mov_b32 v78, 0
    s_nop 0
    v_permlane32_swap_b32 v64, v65
    v_permlane32_swap_b32 v66, v67
    v_cvt_pk_bf16_f32 v84, v64, v66
    v_cvt_pk_bf16_f32 v85, v65, v67
    v_bfi_b32 v84, 1, s22, v84
    buffer_load_dwordx2 v[42:43], v123, s[4:7], s19 offen offset:512 sc1
    v_mov_b32 v79, 0
    v_mov_b32 v80, 0
    v_mov_b32 v81, 0
    v_mov_b32 v82, 0
    v_mov_b32 v83, 0
    v_mov_b32 v60, 0
    v_mov_b32 v60, 0
    v_mov_b32 v60, 0
    v_mov_b32 v60, 0
    v_mov_b32 v60, 0
    v_mov_b32 v60, 0
    v_mov_b32 v60, 0
    buffer_store_dwordx2 v[84:85], v123, s[4:7], s18 offen offset:1024 sc1
    v_mov_b32 v60, 0
    v_mov_b32 v60, 0
    v_mov_b32 v60, 0
    v_mov_b32 v60, 0
    v_mov_b32 v60, 0
    v_mov_b32 v60, 0
    v_mov_b32 v60, 0
    v_mov_b32 v60, 0
    v_mov_b32 v60, 0
    v_mov_b32 v60, 0
    v_mov_b32 v60, 0
    v_mov_b32 v60, 0
    v_mov_b32 v60, 0
    v_mov_b32 v60, 0
    v_mov_b32 v60, 0
    v_mov_b32 v60, 0
    v_mov_b32 v60, 0
    v_mov_b32 v60, 0
    v_mov_b32 v60, 0
    v_mov_b32 v60, 0
    v_mov_b32 v60, 0
    v_mov_b32 v60, 0
    v_mov_b32 v60, 0
    v_mov_b32 v60, 0
    v_mov_b32 v60, 0
    v_mov_b32 v60, 0
    v_mov_b32 v60, 0
    v_mov_b32 v60, 0
    v_mov_b32 v60, 0
    v_mov_b32 v60, 0
    v_mov_b32 v60, 0
    v_mov_b32 v60, 0
    v_mov_b32 v60, 0
    v_mov_b32 v60, 0
    v_mov_b32 v60, 0
    v_mov_b32 v60, 0
    v_mov_b32 v60, 0
    v_mov_b32 v60, 0
    s_waitcnt vmcnt(2)
main_kernel_cs_z0:
    v_dot2_f32_bf16 v44, v126, s37, v96
    v_dot2_f32_bf16 v45, v126, s57, v97
    v_dot2_f32_bf16 v46, v127, s37, v98
    v_dot2_f32_bf16 v47, v127, s57, v99
    v_bitop3_b32 v60, v126, s22, 1 bitop3:0x28
    v_cvt_pk_bf16_f32 v44, v44, v45
    v_cmp_ne_u32 vcc, 0, v60
    v_cvt_pk_bf16_f32 v45, v46, v47
    ds_write_b64 v124, v[44:45] offset:0
    buffer_load_dwordx2 v[64:65], v123, s[4:7], s19 offen offset:512 sc1
    v_cmp_eq_u32 s[42:43], 0, v111
    s_cbranch_vccnz main_kernel_cs_z0_f
    v_mov_b32 v96, 0x3f803f80
    v_mov_b32 v97, 0x3f803f80
    v_mov_b32 v98, 0x3f803f80
    v_mov_b32 v99, 0x3f803f80
    s_and_b32 s32, s43, 0x3f00
    s_cbranch_scc1 main_kernel_cs_kvw
main_kernel_cs_kvok:
    s_waitcnt lgkmcnt(0)
    s_barrier
    ds_read_b64_tr_b16 v[48:49], v115 offset:16384
    ds_read_b64_tr_b16 v[50:51], v115 offset:17408
    ds_read_b64_tr_b16 v[52:53], v115 offset:18432
    ds_read_b64_tr_b16 v[54:55], v115 offset:19456
    s_waitcnt vmcnt(2)
    s_memtime s[52:53]
    v_dot2_f32_bf16 v44, v42, s37, v68
    v_dot2_f32_bf16 v45, v42, s57, v69
    v_dot2_f32_bf16 v46, v43, s37, v70
    v_dot2_f32_bf16 v47, v43, s57, v71
    v_bitop3_b32 v60, v42, s22, 1 bitop3:0x28
    v_cvt_pk_bf16_f32 v44, v44, v45
    v_cmp_ne_u32 vcc, 0, v60
    v_cvt_pk_bf16_f32 v45, v46, v47
    ds_write_b64 v124, v[44:45] offset:512
    s_waitcnt lgkmcnt(3)
    v_mfma_f32_16x16x32_bf16 v[32:35], v[0:3], v[48:51], 0
    v_mfma_f32_16x16x32_bf16 v[36:39], v[16:19], v[48:51], 0
    s_cbranch_vccnz main_kernel_cs_z1_f
main_kernel_cs_z_ok:
    v_mfma_f32_16x16x32_bf16 v[72:75], v[48:51], v[48:51], 0
    s_waitcnt lgkmcnt(1)
    s_sub_u32 s32, s52, s38
    v_mov_b32 v46, s32
    v_mfma_f32_16x16x32_bf16 v[32:35], v[4:7], v[52:55], v[32:35]
    buffer_load_dwordx2 v[86:87], v123, s[4:7], s19 offen offset:1024 sc1
    buffer_store_dword v46, v117, s[4:7], s46 offen sc1
    s_cmp_eq_u32 s17, 64
    s_waitcnt lgkmcnt(0)
    s_barrier
    ds_read_b64_tr_b16 v[56:57], v115 offset:16896
    ds_read_b64_tr_b16 v[58:59], v115 offset:17920
    ds_read_b64_tr_b16 v[60:61], v115 offset:18944
    ds_read_b64_tr_b16 v[62:63], v115 offset:19968
    s_cbranch_scc1 main_kernel_cs_last
    v_bfe_u32 v47, v123, 1, 7
    buffer_load_dwordx2 v[126:127], v123, s[4:7], s19 offen offset:1024 sc1
    buffer_load_dwordx4 v116, s[4:7], s27 offen offset:1024 sc1 lds
    v_mfma_f32_16x16x32_bf16 v[36:39], v[20:23], v[52:55], v[36:39]
    v_mfma_f32_16x16x32_bf16 v[72:75], v[52:55], v[52:55], v[72:75]
    s_waitcnt lgkmcnt(2)
    v_mfma_f32_16x16x32_bf16 v[72:75], v[56:59], v[56:59], v[72:75]
    v_mfma_f32_16x16x32_bf16 v[32:35], v[8:11], v[56:59], v[32:35]
    s_waitcnt lgkmcnt(0)
    v_mfma_f32_16x16x32_bf16 v[72:75], v[60:63], v[60:63], v[72:75]
    ds_read_b128 v[0:3], v113 offset:16384
    v_mfma_f32_16x16x32_bf16 v[32:35], v[12:15], v[60:63], v[32:35]
    ds_read_b128 v[16:19], v113 offset:18432
    v_mfma_f32_16x16x32_bf16 v[36:39], v[24:27], v[56:59], v[36:39]
    ds_read_b128 v[4:7], v113 offset:17408
    s_nop 0
    v_permlane32_swap_b32 v72, v73
    v_permlane32_swap_b32 v74, v75
    v_mfma_f32_16x16x32_bf16 v[36:39], v[28:31], v[60:63], v[36:39]
    ds_read_b128 v[20:23], v113 offset:19456
    v_mul_f32 v73, s30, v73
    v_mul_f32 v75, s30, v75
    v_exp_f32 v32, v32
    ds_read_b128 v[8:11], v113 offset:24576
    v_exp_f32 v33, v33
    ds_read_b128 v[12:15], v113 offset:25600
    v_exp_f32 v73, v73
    ds_read_b128 v[24:27], v113 offset:26624
    v_exp_f32 v75, v75
    ds_read_b128 v[28:31], v113 offset:27648
    v_exp_f32 v34, v34
    v_cvt_pk_bf16_f32 v72, v73, v75
    v_cvt_pk_bf16_f32 v73, v73, v75
    v_exp_f32 v35, v35
    s_waitcnt vmcnt(4)
    v_mfma_f32_16x16x16_bf16 v[40:43], v[100:101], v[72:73], 0
    v_exp_f32 v36, v36
    v_cvt_pk_bf16_f32 v32, v32, v33
    v_exp_f32 v37, v37
    v_cvt_pk_bf16_f32 v33, v34, v35
    v_exp_f32 v38, v38
    v_exp_f32 v39, v39
    v_cvt_pk_bf16_f32 v34, v36, v37
    v_cvt_pk_bf16_f32 v35, v38, v39
    s_nop 1
    v_mfma_f32_16x16x32_bf16 v[40:43], v[96:99], v[32:35], v[40:43]
    v_mfma_f32_16x16x32_bf16 v[64:67], v[88:91], v[32:35], 0
    v_mfma_f32_16x16x32_bf16 v[68:71], v[92:95], v[32:35], 0
    s_waitcnt vmcnt(3)
main_kernel_cs_v_ok:
    v_bitop3_b32 v44, v86, s22, 1 bitop3:0x28
    v_swap_b32 v85, v86
    v_cmp_ne_u32 vcc, 0, v44
main_kernel_cs_d_ok:
    s_nop 0
    v_mfma_f32_16x16x16_bf16 v[64:67], v[84:85], v[72:73], v[64:67]
    v_mfma_f32_16x16x16_bf16 v[68:71], v[86:87], v[72:73], v[68:71]
    s_cbranch_vccnz main_kernel_cs_v_f
    v_rcp_f32 v42, v40
    v_subrev_u32 v41, 0x21800000, v41
    v_cmp_lt_u32 vcc, 0x3c000000, v41
    s_nop 0
    v_pk_mul_f32 v[64:65], v[64:65], v[42:43] op_sel_hi:[1,0]
    v_pk_mul_f32 v[66:67], v[66:67], v[42:43] op_sel_hi:[1,0]
    v_cvt_pk_bf16_f32 v44, v64, v65
    v_pk_mul_f32 v[68:69], v[68:69], v[42:43] op_sel_hi:[1,0]
    v_cvt_pk_bf16_f32 v45, v66, v67
    v_pk_mul_f32 v[70:71], v[70:71], v[42:43] op_sel_hi:[1,0]
    v_cvt_pk_bf16_f32 v46, v68, v69
    v_cvt_pk_bf16_f32 v47, v70, v71
    ds_write_b128 v118, v[44:47]
    s_and_b64 s[42:43], vcc, s[44:45]
    s_cbranch_scc1 main_kernel_cs_d_f
    s_mov_b64 s[44:45], s[0:1]
    v_mov_b32 v64, 0
    v_mov_b32 v65, 0
    v_mov_b32 v66, 0
    v_mov_b32 v67, 0
    v_mov_b32 v68, 0
    v_mov_b32 v69, 0
    v_mov_b32 v70, 0
    v_mov_b32 v71, 0
    v_bfe_u32 v90, v123, 1, 7
    s_xor_b32 s23, s23, 0x80000
    s_waitcnt lgkmcnt(0)
    s_barrier
    ds_read_b128 v[56:59], v114 offset:1024
    ds_read_b128 v[60:63], v114 offset:1536
    ds_read_b128 v[48:51], v114 offset:0
    ds_read_b128 v[52:55], v114 offset:512
    s_xor_b32 s18, s18, 0x100000
    s_xor_b32 s19, s18, 0x80000
    s_xor_b32 s25, s25, 0x4000
    s_add_u32 s27, s27, 0x40000
    v_add_u32 v121, 4, v121
    v_xor_b32 v112, 0x4000, v112
    s_xor_b32 s36, s36, 0x4000
    s_mov_b32 m0, 0
    s_mov_b32 s54, s24
    s_xor_b32 s24, s24, 0x4000
    s_add_u32 s55, s25, 4096
    v_mov_b32 v89, s17
    s_mov_b32 s15, 0
    s_add_u32 s56, s19, 1536
    s_xor_b32 s9, s11, s40
    s_add_u32 s16, s20, s38
    s_waitcnt lgkmcnt(3)
    v_smfmac_f32_16x16x64_bf16 v[76:79], v[56:59], v[0:7], v110
    s_waitcnt lgkmcnt(2)
    ds_read_b128 v[0:3], v113 offset:20480
    v_smfmac_f32_16x16x64_bf16 v[76:79], v[60:63], v[8:15], v110
    s_waitcnt lgkmcnt(2)
    ds_read_b128 v[4:7], v113 offset:21504
    v_smfmac_f32_16x16x64_bf16 v[76:79], v[48:51], v[192:199], v110
    s_waitcnt lgkmcnt(2)
    ds_read_b128 v[8:11], v113 offset:28672
    v_smfmac_f32_16x16x64_bf16 v[76:79], v[52:55], v[200:207], v110
    ds_read_b128 v[12:15], v113 offset:29696
    buffer_load_dword v111, v90, s[4:7], s47 offen sc1
    v_smfmac_f32_16x16x64_bf16 v[80:83], v[56:59], v[16:23], v110
    ds_read_b128 v[16:19], v113 offset:22528
    v_smfmac_f32_16x16x64_bf16 v[80:83], v[60:63], v[24:31], v110
    ds_read_b128 v[20:23], v113 offset:23552
    v_smfmac_f32_16x16x64_bf16 v[80:83], v[48:51], v[208:215], v110
    ds_read_b128 v[24:27], v113 offset:30720
    v_cvt_pk_f16_f32 v40, v76, v77
    v_smfmac_f32_16x16x64_bf16 v[80:83], v[52:55], v[216:223], v110
    ds_read_b128 v[28:31], v113 offset:31744
    v_cvt_pk_f16_f32 v41, v78, v79
    v_smfmac_f32_16x16x64_bf16 v[64:67], v[48:51], v[224:231], v110
    v_bfi_b32 v40, 1, s22, v40
    v_smfmac_f32_16x16x64_bf16 v[64:67], v[52:55], v[232:239], v110
    s_waitcnt lgkmcnt(6)
    buffer_load_dword v111, v90, s[4:7], s47 offen sc1
    v_smfmac_f32_16x16x64_bf16 v[64:67], v[56:59], v[0:7], v110
    s_waitcnt lgkmcnt(4)
    buffer_store_dwordx2 v[40:41], v119, s[4:7], s21 offen offset:0 sc1
    v_cvt_pk_f16_f32 v42, v80, v81
    v_smfmac_f32_16x16x64_bf16 v[64:67], v[60:63], v[8:15], v110
    v_cvt_pk_f16_f32 v43, v82, v83
    v_smfmac_f32_16x16x64_bf16 v[68:71], v[48:51], v[240:247], v110
    v_bfi_b32 v42, 1, s22, v42
    v_smfmac_f32_16x16x64_bf16 v[68:71], v[52:55], v[248:255], v110
    s_waitcnt lgkmcnt(2)
    v_smfmac_f32_16x16x64_bf16 v[68:71], v[56:59], v[16:23], v110
    s_waitcnt lgkmcnt(0)
    buffer_store_dwordx2 v[42:43], v119, s[4:7], s21 offen offset:512 sc1
    v_cvt_pk_f16_f32 v44, v64, v65
    v_smfmac_f32_16x16x64_bf16 v[68:71], v[60:63], v[24:31], v110
    v_cvt_pk_f16_f32 v45, v66, v67
    v_bfi_b32 v44, 1, s22, v44
    s_cmp_lg_u32 s14, 0
    buffer_store_dwordx2 v[44:45], v119, s[4:7], s21 offen offset:1024 sc1
    s_nop 3
    v_cvt_pk_f16_f32 v46, v68, v69
    v_cvt_pk_f16_f32 v47, v70, v71
    v_bfi_b32 v46, 1, s22, v46
    buffer_store_dwordx2 v[46:47], v119, s[4:7], s21 offen offset:1536 sc1
    s_cbranch_scc1 main_kernel_cs_wx
    s_waitcnt vmcnt(5)
    s_xor_b32 s21, s21, 0x80000
main_kernel_cs_rgo:
    v_subrev_u32 v32, s20, v111
    s_memtime s[52:53]
    v_cmp_lt_u32 vcc, 0x100000, v32
    v_max_u32_dpp v32, v32, v32 row_shr:1 row_mask:0xf bank_mask:0xf
    s_nop 0
    s_nop 0
    v_max_u32_dpp v32, v32, v32 row_shr:2 row_mask:0xf bank_mask:0xf
    s_nop 0
    s_cbranch_vccnz main_kernel_cs_fsp
main_kernel_cs_fok:
    s_nop 0
    v_max_u32_dpp v32, v32, v32 row_shr:4 row_mask:0xf bank_mask:0xf
    s_memtime s[52:53]
    s_nop 0
    v_max_u32_dpp v32, v32, v32 row_shr:8 row_mask:0xf bank_mask:0xf
    s_memtime s[52:53]
    s_nop 0
    v_max_u32_dpp v32, v32, v32 row_bcast:15 row_mask:0xa bank_mask:0xf
    s_memtime s[52:53]
    s_sub_u32 s33, s52, s16
    v_readlane_b32 s32, v32, 31
    s_add_u32 s33, s33, 0x400
    s_memtime s[52:53]
    s_add_u32 s34, s16, 1650
    s_memtime s[52:53]
    s_min_u32 s32, s32, s33
    s_max_u32 s32, s32, s15
    s_add_u32 s34, s34, s32
    s_mov_b32 s35, 200
main_kernel_cs_fw:
    s_memtime s[52:53]
    s_cmp_ge_u32 s52, s34
    s_cbranch_scc1 main_kernel_cs_fgo
    s_memtime s[52:53]
    s_cmp_ge_u32 s52, s34
    s_cbranch_scc1 main_kernel_cs_fgo
    s_memtime s[52:53]
    s_cmp_ge_u32 s52, s34
    s_cbranch_scc1 main_kernel_cs_fgo
    s_memtime s[52:53]
    s_cmp_ge_u32 s52, s34
    s_cbranch_scc1 main_kernel_cs_fgo
    s_memtime s[52:53]
    s_cmp_ge_u32 s52, s34
    s_cbranch_scc1 main_kernel_cs_fgo
    s_memtime s[52:53]
    s_cmp_ge_u32 s52, s34
    s_cbranch_scc1 main_kernel_cs_fgo
    s_memtime s[52:53]
    s_cmp_ge_u32 s52, s34
    s_cbranch_scc1 main_kernel_cs_fgo
    s_memtime s[52:53]
    s_cmp_ge_u32 s52, s34
    s_cbranch_scc1 main_kernel_cs_fgo
    s_sub_u32 s35, s35, 1
    s_cbranch_scc0 main_kernel_cs_fw
main_kernel_cs_fgo:
    buffer_load_dwordx4 v[0:3], v120, s[4:7], s23 offen sc1
    s_add_u32 s35, s23, 0x8000
    buffer_load_dwordx4 v[4:7], v120, s[4:7], s35 offen sc1
    s_add_u32 s35, s23, 0x10000
    buffer_load_dwordx4 v[8:11], v120, s[4:7], s35 offen sc1
    ds_read_b32 v33, v123 offset:20992
    s_add_u32 s35, s23, 0x18000
    buffer_load_dwordx4 v[12:15], v120, s[4:7], s35 offen sc1
    s_add_u32 s35, s23, 0x20000
    buffer_load_dwordx4 v[16:19], v120, s[4:7], s35 offen sc1
    s_add_u32 s35, s23, 0x28000
    buffer_load_dwordx4 v[20:23], v120, s[4:7], s35 offen sc1
    s_add_u32 s35, s23, 0x30000
    buffer_load_dwordx4 v[24:27], v120, s[4:7], s35 offen sc1
    s_add_u32 s35, s23, 0x38000
    buffer_load_dwordx4 v[28:31], v120, s[4:7], s35 offen sc1
    s_mov_b64 exec, 1
    s_waitcnt lgkmcnt(0)
    v_sub_u32 v33, s34, v33
    v_bfi_b32 v33, 1, s40, v33
    buffer_store_dword v33, off, s[4:7], s18 offset:1536 sc1
    v_readfirstlane_b32 s10, v33
    s_mov_b64 exec, -1
    s_waitcnt vmcnt(8)
    v_mfma_f32_16x16x32_f16 v[76:79], v[0:3], v[106:109], 0
    v_xor_b32 v36, s22, v0
    v_bitop3_b32 v36, v2, s22, v36 bitop3:0xbe
    s_waitcnt vmcnt(7)
    v_mfma_f32_16x16x32_f16 v[76:79], v[4:7], v[106:109], v[76:79]
    v_bitop3_b32 v36, v4, s22, v36 bitop3:0xbe
    v_bitop3_b32 v36, v6, s22, v36 bitop3:0xbe
    s_waitcnt vmcnt(6)
    v_mfma_f32_16x16x32_f16 v[76:79], v[8:11], v[106:109], v[76:79]
    v_bitop3_b32 v36, v8, s22, v36 bitop3:0xbe
    v_bitop3_b32 v36, v10, s22, v36 bitop3:0xbe
    s_waitcnt vmcnt(5)
    v_mfma_f32_16x16x32_f16 v[76:79], v[12:15], v[106:109], v[76:79]
    v_bitop3_b32 v36, v12, s22, v36 bitop3:0xbe
    v_bitop3_b32 v36, v14, s22, v36 bitop3:0xbe
    s_waitcnt vmcnt(4)
    v_mfma_f32_16x16x32_f16 v[76:79], v[16:19], v[106:109], v[76:79]
    v_bitop3_b32 v36, v16, s22, v36 bitop3:0xbe
    v_bitop3_b32 v36, v18, s22, v36 bitop3:0xbe
    s_waitcnt vmcnt(3)
    v_mfma_f32_16x16x32_f16 v[76:79], v[20:23], v[106:109], v[76:79]
    v_bitop3_b32 v36, v20, s22, v36 bitop3:0xbe
    v_bitop3_b32 v36, v22, s22, v36 bitop3:0xbe
    s_waitcnt vmcnt(2)
    v_mfma_f32_16x16x32_f16 v[76:79], v[24:27], v[106:109], v[76:79]
    v_bitop3_b32 v36, v24, s22, v36 bitop3:0xbe
    v_bitop3_b32 v36, v26, s22, v36 bitop3:0xbe
    s_waitcnt vmcnt(1)
    v_mfma_f32_16x16x32_f16 v[76:79], v[28:31], v[106:109], v[76:79]
    v_bitop3_b32 v36, v28, s22, v36 bitop3:0xbe
    v_bitop3_b32 v36, v30, s22, v36 bitop3:0xbe
    v_and_b32 v36, 1, v36
    v_cmp_ne_u32 vcc, 0, v36
    s_nop 3
    v_cvt_pk_bf16_f32 v126, v76, v77
    v_cvt_pk_bf16_f32 v127, v78, v79
    s_cbranch_vccnz main_kernel_cs_r_f
    buffer_store_dwordx2 v[126:127], v122, s[4:7], s24 offen sc1
    s_sub_u32 s20, s34, s38
    s_mov_b32 s3, s34
    buffer_store_dword v89, v117, s[4:7], s46 offen offset:512 sc1
    v_mov_b32 v32, -1
    v_mov_b32 v33, -1
    v_mov_b32 v64, 0
    v_mov_b32 v65, 0
    v_mov_b32 v66, 0
    v_mov_b32 v67, 0
    v_mov_b32 v68, 0
    v_mov_b32 v69, 0
    v_mov_b32 v70, 0
    v_mov_b32 v71, 0
    v_mov_b32 v96, 0
    v_mov_b32 v97, 0
    v_mov_b32 v98, 0
    v_mov_b32 v99, 0
    buffer_store_dwordx2 v[32:33], v122, s[4:7], s54 offen sc1
    s_cmp_eq_u32 s12, 0
    v_add_u32 v56, s59, v115
    s_cbranch_scc0 main_kernel_cs_vma
    ds_read_b64_tr_b16 v[80:81], v56 offset:16384
    ds_read_b64_tr_b16 v[82:83], v56 offset:17408
    s_waitcnt lgkmcnt(0)
    s_nop 15
    s_nop 15
    s_nop 5
    s_buffer_load_dword s9, s[4:7], s56 glc
    buffer_load_dword v111, v90, s[4:7], s47 offen offset:512 sc1
    buffer_load_dwordx4 v116, s[4:7], s25 offen offset:0 sc1 lds
    buffer_load_dwordx4 v116, s[4:7], s25 offen offset:1024 sc1 lds
    buffer_load_dwordx4 v116, s[4:7], s25 offen offset:2048 sc1 lds
    buffer_load_dwordx4 v116, s[4:7], s25 offen offset:3072 sc1 lds
    s_mov_b32 m0, 4096
    s_nop 0
    buffer_load_dwordx4 v116, s[4:7], s55 offen offset:0 sc1 lds
    buffer_load_dwordx4 v116, s[4:7], s55 offen offset:1024 sc1 lds
    buffer_load_dwordx4 v116, s[4:7], s55 offen offset:2048 sc1 lds
    buffer_load_dwordx4 v116, s[4:7], s55 offen offset:3072 sc1 lds
    v_mov_b32 v34, v90
    s_mov_b32 m0, s36
    s_barrier
    ds_read_b32 v35, v123 offset:20480
    buffer_load_dwordx4 v[88:91], v116, s[4:7], s28 offen offset:0 sc1
    buffer_load_dwordx4 v[92:95], v116, s[4:7], s28 offen offset:1024 sc1
    buffer_load_dwordx4 v116, s[4:7], s27 offen offset:0 sc1 lds
    buffer_store_dwordx4 v[80:83], v125, s[4:7], s26 offen sc1
    s_branch main_kernel_cs_kva
main_kernel_cs_vma:
    v_mfma_f32_16x16x32_bf16 v[56:59], v[102:105], v[84:87], 0
    s_nop 7
    v_cvt_pk_bf16_f32 v80, v56, v57
    v_cvt_pk_bf16_f32 v81, v58, v59
    s_nop 15
    s_nop 15
    s_nop 5
    s_buffer_load_dword s9, s[4:7], s56 glc
    buffer_load_dword v111, v90, s[4:7], s47 offen offset:512 sc1
    buffer_load_dwordx4 v116, s[4:7], s25 offen offset:0 sc1 lds
    buffer_load_dwordx4 v116, s[4:7], s25 offen offset:1024 sc1 lds
    buffer_load_dwordx4 v116, s[4:7], s25 offen offset:2048 sc1 lds
    buffer_load_dwordx4 v116, s[4:7], s25 offen offset:3072 sc1 lds
    s_mov_b32 m0, 4096
    s_nop 0
    buffer_load_dwordx4 v116, s[4:7], s55 offen offset:0 sc1 lds
    buffer_load_dwordx4 v116, s[4:7], s55 offen offset:1024 sc1 lds
    buffer_load_dwordx4 v116, s[4:7], s55 offen offset:2048 sc1 lds
    buffer_load_dwordx4 v116, s[4:7], s55 offen offset:3072 sc1 lds
    v_mov_b32 v34, v90
    s_mov_b32 m0, s36
    s_barrier
    ds_read_b32 v35, v123 offset:20480
    buffer_load_dwordx4 v[88:91], v116, s[4:7], s28 offen offset:0 sc1
    buffer_load_dwordx4 v[92:95], v116, s[4:7], s28 offen offset:1024 sc1
    buffer_load_dwordx4 v116, s[4:7], s27 offen offset:0 sc1 lds
    buffer_store_dwordx2 v[80:81], v123, s[4:7], s26 offen sc1
main_kernel_cs_kva:
    s_add_u32 s26, s26, 0x10000
    s_waitcnt vmcnt(12)
    v_cmp_gt_i32 vcc, s17, v111
    v_readfirstlane_b32 s38, v35
    s_cbranch_vccnz main_kernel_cs_mc_f
    s_waitcnt vmcnt(4)
    s_branch main_kernel_cs_top
main_kernel_cs_wx:
    s_cmp_lg_u32 s14, 1
    s_cbranch_scc1 main_kernel_cs_wy
    s_memrealtime s[32:33]
    s_nop 0
    s_nop 0
    s_memrealtime s[32:33]
    s_nop 0
    s_nop 0
    s_memrealtime s[32:33]
    s_nop 0
    s_nop 0
    s_memrealtime s[32:33]
    s_nop 0
    s_nop 0
    s_memrealtime s[32:33]
    s_nop 0
    s_nop 0
    s_memrealtime s[32:33]
    s_nop 0
    s_nop 0
    s_memrealtime s[32:33]
    s_nop 0
    s_nop 0
    s_memrealtime s[32:33]
    s_nop 0
    s_nop 0
    s_memrealtime s[32:33]
    s_nop 0
    s_nop 0
    s_memrealtime s[32:33]
    s_nop 0
    s_nop 0
    s_memrealtime s[32:33]
    s_nop 0
    s_nop 0
    s_memrealtime s[32:33]
    s_nop 0
    s_nop 0
    s_mov_b32 s34, s32
    s_memrealtime s[32:33]
    s_cmp_lg_u32 s32, s34
    s_cbranch_scc1 main_kernel_cs_e1
    s_memrealtime s[32:33]
    s_cmp_lg_u32 s32, s34
    s_cbranch_scc1 main_kernel_cs_e1
    s_memrealtime s[32:33]
    s_cmp_lg_u32 s32, s34
    s_cbranch_scc1 main_kernel_cs_e1
    s_memrealtime s[32:33]
    s_cmp_lg_u32 s32, s34
    s_cbranch_scc1 main_kernel_cs_e1
    s_memrealtime s[32:33]
    s_cmp_lg_u32 s32, s34
    s_cbranch_scc1 main_kernel_cs_e1
    s_memrealtime s[32:33]
    s_cmp_lg_u32 s32, s34
    s_cbranch_scc1 main_kernel_cs_e1
    s_memrealtime s[32:33]
    s_cmp_lg_u32 s32, s34
    s_cbranch_scc1 main_kernel_cs_e1
    s_memrealtime s[32:33]
    s_cmp_lg_u32 s32, s34
    s_cbranch_scc1 main_kernel_cs_e1
    s_memrealtime s[32:33]
    s_cmp_lg_u32 s32, s34
    s_cbranch_scc1 main_kernel_cs_e1
    s_memrealtime s[32:33]
    s_cmp_lg_u32 s32, s34
    s_cbranch_scc1 main_kernel_cs_e1
    s_memrealtime s[32:33]
    s_cmp_lg_u32 s32, s34
    s_cbranch_scc1 main_kernel_cs_e1
    s_memrealtime s[32:33]
    s_cmp_lg_u32 s32, s34
    s_cbranch_scc1 main_kernel_cs_e1
main_kernel_cs_e1:
    s_memtime s[52:53]
    s_mul_i32 s34, s32, 22
    s_waitcnt lgkmcnt(0)
    s_sub_u32 s32, s52, s34
    s_sub_u32 s33, s32, s38
    s_sub_u32 s33, s33, s10
    s_max_i32 s33, s33, -400
    s_min_i32 s33, s33, 400
    s_ashr_i32 s33, s33, 2
    s_add_u32 s10, s10, s33
    s_mov_b32 s33, s10
    s_ashr_i32 s34, s33, 2
    s_add_u32 s34, s34, s32
    v_mov_b32 v34, s34
    v_mov_b32 v33, s32
    ds_write2st64_b32 v123, v33, v34 offset0:80 offset1:82
    v_add_u32 v37, s33, v34
main_kernel_cs_wy:
    s_xor_b32 s21, s21, 0x80000
    v_mov_b32 v64, 0
    v_mov_b32 v65, 0
    v_mov_b32 v66, 0
    v_mov_b32 v67, 0
    v_mov_b32 v68, 0
    v_mov_b32 v69, 0
    v_mov_b32 v70, 0
    v_mov_b32 v71, 0
    v_mov_b32 v96, 0
    v_mov_b32 v97, 0
    v_mov_b32 v98, 0
    v_mov_b32 v99, 0
    s_cmp_eq_u32 s12, 0
    v_add_u32 v56, s59, v115
    s_cbranch_scc0 main_kernel_cs_vmb
    ds_read_b64_tr_b16 v[80:81], v56 offset:16384
    ds_read_b64_tr_b16 v[82:83], v56 offset:17408
    s_waitcnt lgkmcnt(0)
    s_waitcnt vmcnt(0)
    s_mov_b32 m0, s36
    s_barrier
    ds_read_b32 v35, v123 offset:20480
    ds_write_b32 v124, v37 offset:3584
    buffer_load_dwordx4 v[88:91], v116, s[4:7], s28 offen offset:0 sc1
    buffer_load_dwordx4 v[92:95], v116, s[4:7], s28 offen offset:1024 sc1
    buffer_load_dwordx4 v116, s[4:7], s27 offen offset:0 sc1 lds
    buffer_store_dwordx4 v[80:83], v125, s[4:7], s26 offen sc1
    s_branch main_kernel_cs_kvb
main_kernel_cs_vmb:
    v_mfma_f32_16x16x32_bf16 v[56:59], v[102:105], v[84:87], 0
    s_nop 7
    v_cvt_pk_bf16_f32 v80, v56, v57
    v_cvt_pk_bf16_f32 v81, v58, v59
    s_waitcnt vmcnt(0)
    s_mov_b32 m0, s36
    s_barrier
    ds_read_b32 v35, v123 offset:20480
    ds_write_b32 v124, v37 offset:3584
    buffer_load_dwordx4 v[88:91], v116, s[4:7], s28 offen offset:0 sc1
    buffer_load_dwordx4 v[92:95], v116, s[4:7], s28 offen offset:1024 sc1
    buffer_load_dwordx4 v116, s[4:7], s27 offen offset:0 sc1 lds
    buffer_store_dwordx2 v[80:81], v123, s[4:7], s26 offen sc1
main_kernel_cs_kvb:
    s_add_u32 s26, s26, 0x10000
    s_mov_b64 exec, 1
    buffer_store_dword v100, off, s[4:7], s39 sc1
    s_mov_b64 exec, -1
    s_add_u32 s39, s39, 4
    s_waitcnt lgkmcnt(0)
    v_readfirstlane_b32 s38, v35
    v_mov_b32 v35, 0
    v_mov_b32 v35, 0
    v_mov_b32 v35, 0
    v_mov_b32 v35, 0
    v_mov_b32 v35, 0
    v_mov_b32 v35, 0
main_kernel_cs_end:
    s_branch main_kernel_cs_top
main_kernel_cs_mc_f:
    s_mov_b32 m0, 0
    s_sub_u32 s29, s29, 1
    s_cbranch_scc1 main_kernel_end
    buffer_load_dword v111, v34, s[4:7], s47 offen offset:512 sc1
    buffer_load_dwordx4 v116, s[4:7], s25 offen offset:0 sc1 lds
    buffer_load_dwordx4 v116, s[4:7], s25 offen offset:1024 sc1 lds
    buffer_load_dwordx4 v116, s[4:7], s25 offen offset:2048 sc1 lds
    buffer_load_dwordx4 v116, s[4:7], s25 offen offset:3072 sc1 lds
    s_mov_b32 m0, 4096
    s_nop 0
    buffer_load_dwordx4 v116, s[4:7], s55 offen offset:0 sc1 lds
    buffer_load_dwordx4 v116, s[4:7], s55 offen offset:1024 sc1 lds
    buffer_load_dwordx4 v116, s[4:7], s55 offen offset:2048 sc1 lds
    buffer_load_dwordx4 v116, s[4:7], s55 offen offset:3072 sc1 lds
    s_waitcnt vmcnt(8)
    v_cmp_gt_i32 vcc, s17, v111
    v_readfirstlane_b32 s38, v35
    s_cbranch_vccnz main_kernel_cs_mc_f
    s_waitcnt vmcnt(0)
    s_branch main_kernel_cs_end
main_kernel_cs_t_w:
    s_mov_b32 s35, 200
main_kernel_cs_t_s:
    s_memtime s[52:53]
    s_cmp_ge_u32 s52, s34
    s_cbranch_scc1 main_kernel_cs_t_go
    s_memtime s[52:53]
    s_cmp_ge_u32 s52, s34
    s_cbranch_scc1 main_kernel_cs_t_go
    s_memtime s[52:53]
    s_cmp_ge_u32 s52, s34
    s_cbranch_scc1 main_kernel_cs_t_go
    s_memtime s[52:53]
    s_cmp_ge_u32 s52, s34
    s_cbranch_scc1 main_kernel_cs_t_go
    s_memtime s[52:53]
    s_cmp_ge_u32 s52, s34
    s_cbranch_scc1 main_kernel_cs_t_go
    s_memtime s[52:53]
    s_cmp_ge_u32 s52, s34
    s_cbranch_scc1 main_kernel_cs_t_go
    s_memtime s[52:53]
    s_cmp_ge_u32 s52, s34
    s_cbranch_scc1 main_kernel_cs_t_go
    s_memtime s[52:53]
    s_cmp_ge_u32 s52, s34
    s_cbranch_scc1 main_kernel_cs_t_go
    s_sub_u32 s35, s35, 1
    s_cbranch_scc0 main_kernel_cs_t_s
    s_branch main_kernel_cs_t_go
main_kernel_cs_t_p:
    s_waitcnt lgkmcnt(0)
    s_xor_b32 s32, s9, s22
    s_bitcmp1_b32 s32, 0
    s_cbranch_scc0 main_kernel_cs_t_ok
    s_buffer_load_dword s9, s[4:7], s56 glc
    s_sub_u32 s29, s29, 1
    s_cbranch_scc1 main_kernel_end
    s_branch main_kernel_cs_t_p
main_kernel_cs_z0_f:
    buffer_load_dwordx2 v[126:127], v123, s[4:7], s19 offen offset:0 sc1
    s_sub_u32 s29, s29, 1
    s_cbranch_scc1 main_kernel_end
    s_waitcnt vmcnt(0)
    s_branch main_kernel_cs_z0
main_kernel_cs_z2_f:
    buffer_load_dwordx2 v[64:65], v123, s[4:7], s19 offen offset:512 sc1
    s_sub_u32 s29, s29, 1
    s_cbranch_scc1 main_kernel_end
    s_waitcnt vmcnt(0)
main_kernel_cs_z1_f:
    s_waitcnt vmcnt(0)
    s_memtime s[52:53]
    v_dot2_f32_bf16 v44, v64, s37, v68
    v_dot2_f32_bf16 v45, v64, s57, v69
    v_dot2_f32_bf16 v46, v65, s37, v70
    v_dot2_f32_bf16 v47, v65, s57, v71
    v_bitop3_b32 v60, v64, s22, 1 bitop3:0x28
    v_cvt_pk_bf16_f32 v44, v44, v45
    v_cmp_ne_u32 vcc, 0, v60
    v_cvt_pk_bf16_f32 v45, v46, v47
    ds_write_b64 v124, v[44:45] offset:512
    s_cbranch_vccnz main_kernel_cs_z2_f
    s_branch main_kernel_cs_z_ok
main_kernel_cs_kvw:
    s_cmp_eq_u32 s17, 64
    s_cbranch_scc1 main_kernel_cs_kvok
    s_waitcnt vmcnt(0)
    s_mov_b32 exec_lo, 0
    s_mov_b32 exec_hi, 0x3f00
    v_subrev_u32 v127, 0, v121
main_kernel_cs_kvp:
    buffer_load_dword v126, v127, s[4:7], 0 offen sc1
    s_waitcnt vmcnt(0)
    v_cmp_eq_u32 vcc, 0, v126
    s_cbranch_vccz main_kernel_cs_kvp_ok
    s_sleep 2
    s_sub_u32 s29, s29, 1
    s_cbranch_scc0 main_kernel_cs_kvp
    s_branch main_kernel_end
main_kernel_cs_kvp_ok:
    s_mov_b64 exec, -1
    s_branch main_kernel_cs_kvok
main_kernel_cs_las2:
    buffer_load_dwordx2 v[86:87], v123, s[4:7], s19 offen offset:1024 sc1
    s_sub_u32 s29, s29, 1
    s_cbranch_scc1 main_kernel_end
main_kernel_cs_last:
    s_cmp_eq_u32 s12, 0
    s_cbranch_scc1 main_kernel_cs_las3
    s_waitcnt vmcnt(0) lgkmcnt(0)
    v_bitop3_b32 v44, v86, s22, 1 bitop3:0x28
    v_cmp_ne_u32 vcc, 0, v44
    s_cbranch_vccnz main_kernel_cs_las2
    v_swap_b32 v85, v86
main_kernel_cs_las3:
    s_waitcnt lgkmcnt(0)
    s_cmp_eq_u32 s12, 0
    v_add_u32 v56, s59, v115
    s_cbranch_scc0 main_kernel_cs_vmc
    ds_read_b64_tr_b16 v[80:81], v56 offset:16384
    ds_read_b64_tr_b16 v[82:83], v56 offset:17408
    s_waitcnt lgkmcnt(0)
    buffer_store_dwordx4 v[80:83], v125, s[4:7], s26 offen sc1
    s_branch main_kernel_cs_kvc
main_kernel_cs_vmc:
    v_mfma_f32_16x16x32_bf16 v[56:59], v[102:105], v[84:87], 0
    s_nop 7
    v_cvt_pk_bf16_f32 v80, v56, v57
    v_cvt_pk_bf16_f32 v81, v58, v59
    buffer_store_dwordx2 v[80:81], v123, s[4:7], s26 offen sc1
main_kernel_cs_kvc:
    s_add_u32 s26, s26, 0x10000
    s_branch main_kernel_end
main_kernel_cs_m_f:
main_kernel_cs_m_t:
    ds_read_b128 v[0:3], v116 offset:0
    ds_read_b128 v[4:7], v116 offset:1024
    ds_read_b128 v[8:11], v116 offset:2048
    ds_read_b128 v[12:15], v116 offset:3072
    ds_read_b128 v[16:19], v116 offset:4096
    ds_read_b128 v[20:23], v116 offset:5120
    ds_read_b128 v[24:27], v116 offset:6144
    ds_read_b128 v[28:31], v116 offset:7168
    s_waitcnt lgkmcnt(0)
    v_max_u32 v126, v0, v2
    v_max3_u32 v126, v126, v4, v6
    v_max3_u32 v126, v126, v8, v10
    v_max3_u32 v126, v126, v12, v14
    v_max3_u32 v126, v126, v16, v18
    v_max3_u32 v126, v126, v20, v22
    v_max3_u32 v126, v126, v24, v26
    v_max3_u32 v126, v126, v28, v30
    v_cmp_eq_u32 vcc, -1, v126
    s_cbranch_vccz main_kernel_cs_m_g
    s_barrier
    s_lshl_b32 s32, s14, 11
    s_add_u32 m0, s32, 0
    s_add_u32 s32, s32, s25
    buffer_load_dwordx4 v116, s[4:7], s32 offen offset:0 sc1 lds
    buffer_load_dwordx4 v116, s[4:7], s32 offen offset:1024 sc1 lds
    s_sub_u32 s29, s29, 1
    s_cbranch_scc1 main_kernel_end
    s_waitcnt vmcnt(0)
    s_barrier
    s_branch main_kernel_cs_m_t
main_kernel_cs_m_g:
    s_mov_b64 s[44:45], 0
    v_mov_b32 v64, 0
    v_mov_b32 v65, 0
    v_mov_b32 v66, 0
    v_mov_b32 v67, 0
    v_mov_b32 v68, 0
    v_mov_b32 v69, 0
    v_mov_b32 v70, 0
    v_mov_b32 v71, 0
    v_mov_b32 v96, 0
    v_mov_b32 v97, 0
    v_mov_b32 v98, 0
    v_mov_b32 v99, 0
    s_branch main_kernel_cs_mrd
main_kernel_cs_v_f:
    v_swap_b32 v85, v86
    s_nop 7
    s_waitcnt vmcnt(1)
main_kernel_cs_v_t:
    s_memtime s[52:53]
    v_bitop3_b32 v44, v126, s22, 1 bitop3:0x28
    v_cmp_ne_u32 vcc, 0, v44
    s_sub_u32 s29, s29, 1
    s_cbranch_scc1 main_kernel_end
    s_cbranch_vccnz main_kernel_cs_v_g
    v_mfma_f32_16x16x32_bf16 v[64:67], v[88:91], v[32:35], 0
    v_mfma_f32_16x16x32_bf16 v[68:71], v[92:95], v[32:35], 0
    v_mov_b32 v86, v126
    v_mov_b32 v87, v127
    s_waitcnt lgkmcnt(0)
    s_sub_u32 s32, s52, s38
    s_add_u32 s32, s32, -550
    v_mov_b32 v46, s32
    buffer_store_dword v46, v117, s[4:7], s46 offen sc1
    s_branch main_kernel_cs_v_ok
main_kernel_cs_v_g:
    buffer_load_dwordx2 v[126:127], v123, s[4:7], s19 offen offset:1024 sc1
    s_waitcnt lgkmcnt(0)
    s_sub_u32 s32, s52, s38
    s_add_u32 s32, s32, -50
    v_mov_b32 v46, s32
    buffer_store_dword v46, v117, s[4:7], s46 offen sc1
    s_waitcnt vmcnt(0)
    s_branch main_kernel_cs_v_t
main_kernel_cs_d_f:
    s_memtime s[52:53]
    s_waitcnt vmcnt(1) lgkmcnt(0)
    s_sub_u32 s32, s52, s38
    s_add_u32 s32, s32, 300
    v_mov_b32 v46, s32
    buffer_store_dword v46, v117, s[4:7], s46 offen sc1
    ds_read_b128 v[0:3], v112 offset:0
    ds_read_b128 v[4:7], v112 offset:1024
    ds_read_b128 v[8:11], v112 offset:2048
    ds_read_b128 v[12:15], v112 offset:3072
    ds_read_b128 v[16:19], v112 offset:4096
    ds_read_b128 v[20:23], v112 offset:5120
    ds_read_b128 v[24:27], v112 offset:6144
    ds_read_b128 v[28:31], v112 offset:7168
    s_waitcnt lgkmcnt(0)
    v_mfma_f32_16x16x32_bf16 v[32:35], v[0:3], v[48:51], 0
    v_mfma_f32_16x16x32_bf16 v[36:39], v[16:19], v[48:51], 0
    v_mfma_f32_16x16x32_bf16 v[72:75], v[48:51], v[48:51], 0
    v_mfma_f32_16x16x32_bf16 v[32:35], v[4:7], v[52:55], v[32:35]
    v_mfma_f32_16x16x32_bf16 v[36:39], v[20:23], v[52:55], v[36:39]
    v_mfma_f32_16x16x32_bf16 v[72:75], v[52:55], v[52:55], v[72:75]
    v_mfma_f32_16x16x32_bf16 v[32:35], v[8:11], v[56:59], v[32:35]
    v_mfma_f32_16x16x32_bf16 v[36:39], v[24:27], v[56:59], v[36:39]
    v_mfma_f32_16x16x32_bf16 v[72:75], v[56:59], v[56:59], v[72:75]
    v_mfma_f32_16x16x32_bf16 v[32:35], v[12:15], v[60:63], v[32:35]
    v_mfma_f32_16x16x32_bf16 v[36:39], v[28:31], v[60:63], v[36:39]
    v_mfma_f32_16x16x32_bf16 v[72:75], v[60:63], v[60:63], v[72:75]
    s_nop 7
    ds_read_b128 v[0:3], v113 offset:16384
    ds_read_b128 v[16:19], v113 offset:18432
    ds_read_b128 v[4:7], v113 offset:17408
    ds_read_b128 v[20:23], v113 offset:19456
    ds_read_b128 v[8:11], v113 offset:24576
    ds_read_b128 v[24:27], v113 offset:26624
    ds_read_b128 v[12:15], v113 offset:25600
    ds_read_b128 v[28:31], v113 offset:27648
    v_permlane32_swap_b32 v72, v73
    v_permlane32_swap_b32 v74, v75
    v_mul_f32 v73, s30, v73
    v_mul_f32 v75, s30, v75
    v_max_f32 v126, v73, v75
    v_max3_f32 v126, v126, v32, v33
    v_max3_f32 v126, v126, v34, v35
    v_max3_f32 v126, v126, v36, v37
    v_max3_f32 v126, v126, v38, v39
    v_mov_b32 v127, v126
    s_nop 1
    v_permlane32_swap_b32 v126, v127
    v_max_f32 v126, v126, v127
    v_mov_b32 v127, v126
    s_nop 1
    v_permlane16_swap_b32 v126, v127
    v_max_f32 v126, v126, v127
    v_sub_f32 v32, v32, v126
    v_sub_f32 v33, v33, v126
    v_sub_f32 v34, v34, v126
    v_sub_f32 v35, v35, v126
    v_sub_f32 v36, v36, v126
    v_sub_f32 v37, v37, v126
    v_sub_f32 v38, v38, v126
    v_sub_f32 v39, v39, v126
    v_sub_f32 v73, v73, v126
    v_sub_f32 v75, v75, v126
    v_exp_f32 v32, v32
    v_exp_f32 v33, v33
    v_exp_f32 v34, v34
    v_exp_f32 v35, v35
    v_exp_f32 v36, v36
    v_exp_f32 v37, v37
    v_exp_f32 v38, v38
    v_exp_f32 v39, v39
    v_exp_f32 v73, v73
    v_exp_f32 v75, v75
    v_cvt_pk_bf16_f32 v32, v32, v33
    v_cvt_pk_bf16_f32 v33, v34, v35
    v_cvt_pk_bf16_f32 v34, v36, v37
    v_cvt_pk_bf16_f32 v35, v38, v39
    v_cvt_pk_bf16_f32 v72, v73, v75
    v_cvt_pk_bf16_f32 v73, v73, v75
    s_nop 1
    v_mfma_f32_16x16x32_bf16 v[64:67], v[88:91], v[32:35], 0
    v_mfma_f32_16x16x32_bf16 v[68:71], v[92:95], v[32:35], 0
    v_mfma_f32_16x16x32_bf16 v[40:43], v[96:99], v[32:35], 0
    s_nop 3
    s_nop 1
    v_mfma_f32_16x16x16_bf16 v[40:43], v[100:101], v[72:73], v[40:43]
    s_mov_b64 s[44:45], 0
    s_mov_b64 vcc, 0
    s_nop 7
    s_branch main_kernel_cs_d_ok
main_kernel_cs_fsp:
    s_mov_b32 s35, 40
main_kernel_cs_fsl:
    buffer_load_dword v111, v90, s[4:7], s47 offen sc1
    s_waitcnt vmcnt(1)
    v_subrev_u32 v32, s20, v111
    v_cmp_lt_u32 vcc, 0x100000, v32
    s_cbranch_vccz main_kernel_cs_rgo
    s_sub_u32 s35, s35, 1
    s_cbranch_scc0 main_kernel_cs_fsl
    v_mov_b32 v32, 0
    s_branch main_kernel_cs_fok
main_kernel_cs_r_f:
    s_memtime s[52:53]
    buffer_load_dword v111, v90, s[4:7], s47 offen sc1
    s_waitcnt lgkmcnt(0)
    s_sub_u32 s15, s52, s16
    s_add_u32 s15, s15, -1500
    s_waitcnt vmcnt(0)
    s_sub_u32 s29, s29, 1
    s_cbranch_scc1 main_kernel_end
    s_branch main_kernel_cs_rgo
main_kernel_att:
    s_cmp_gt_u32 s13, 1
    s_cbranch_scc1 main_kernel_p_end
    s_cmp_lg_u32 s14, 0
    s_cbranch_scc1 main_kernel_p_bar
    s_lshl_b32 s32, s13, 21
    s_add_u32 s32, s32, 0x8c00000
    v_lshlrev_b32 v2, 2, v250
    v_mov_b32 v3, -1
    s_mov_b64 s[20:21], -1
    s_mov_b32 s34, 12
    s_mov_b32 exec_hi, 0
    s_waitcnt vmcnt(0)
main_kernel_p_lp:
    s_memtime s[16:17]
    s_waitcnt lgkmcnt(0)
    buffer_store_dword v3, v2, s[4:7], s32 offen sc1
    s_waitcnt vmcnt(0)
    s_memtime s[18:19]
    s_xor_b32 s32, s32, 0x2000
    s_waitcnt lgkmcnt(0)
    s_sub_u32 s33, s18, s16
    s_min_u32 s20, s20, s33
    s_memtime s[16:17]
    s_waitcnt lgkmcnt(0)
    buffer_store_dword v3, v2, s[4:7], s32 offen sc1
    s_waitcnt vmcnt(0)
    s_memtime s[18:19]
    s_xor_b32 s32, s32, 0x2000
    s_waitcnt lgkmcnt(0)
    s_sub_u32 s33, s18, s16
    s_min_u32 s21, s21, s33
    s_add_u32 s32, s32, 128
    s_sub_u32 s34, s34, 1
    s_cmp_lg_u32 s34, 0
    s_cbranch_scc1 main_kernel_p_lp
    s_cmp_lt_u32 s21, s20
    s_cselect_b32 s32, 3, 2
    s_lshl_b32 s33, s13, 2
    v_mov_b32 v3, s32
    s_mov_b64 exec, 1
    buffer_store_dword v3, off, s[60:63], s33 offset:16 sc1
    s_mov_b64 exec, -1
main_kernel_p_bar:
    s_barrier
main_kernel_p_end:
    v_lshlrev_b32 v0, 2, v250
    s_mov_b32 s32, 0x841f000
main_kernel_awf:
    buffer_load_dword v2, v0, s[4:7], s32 offen sc1
    s_waitcnt vmcnt(0)
    v_cmp_eq_u32 vcc, 0, v2
    s_cbranch_vccz main_kernel_awf_ok
    s_sleep 4
    s_sub_u32 s29, s29, 1
    s_cbranch_scc0 main_kernel_awf
    s_branch main_kernel_end
main_kernel_awf_ok:
main_kernel_att2:
    s_lshl_b32 s28, s13, 1
    s_lshr_b32 s31, s14, 1
    s_add_u32 s28, s28, s31
    s_and_b32 s30, s14, 1
    v_lshlrev_b32 v204, 4, v250
    v_and_b32 v200, 15, v250
    v_lshrrev_b32 v201, 4, v250
    v_and_b32 v202, 7, v250
    v_lshl_add_u32 v202, v201, 3, v202
    v_lshlrev_b32 v205, 4, v202
    v_bfe_u32 v206, v204, 1, 8
    v_min_u32 v207, 2, v250
    v_lshlrev_b32 v207, 13, v207
    s_lshl_b32 s31, s28, 8
    s_sub_u32 s31, 80912, s31
    s_cmp_eq_u32 s12, 7
    s_cselect_b32 s25, 61, 0
    s_cselect_b32 s32, 16, 0
    s_sub_u32 s31, s31, s32
    s_mov_b64 exec, 0xf0
    v_lshl_add_u32 v207, v250, 8, s31
    s_mov_b64 exec, -1
    v_mov_b32 v208, 1
    v_mov_b32 v209, 0
    s_lshl_b32 s31, s30, 4
    v_add_u32 v200, s31, v200
    v_lshlrev_b32 v202, 2, v201
    v_sub_u32 v200, v200, v202
    v_mov_b32 v202, 0xf149f2ca
    v_cmp_le_i32 vcc, 0, v200
    s_nop 1
    v_cndmask_b32 v124, v202, 0, vcc
    v_cmp_le_i32 vcc, 1, v200
    s_nop 1
    v_cndmask_b32 v125, v202, 0, vcc
    v_cmp_le_i32 vcc, 2, v200
    s_nop 1
    v_cndmask_b32 v126, v202, 0, vcc
    v_cmp_le_i32 vcc, 3, v200
    s_nop 1
    v_cndmask_b32 v127, v202, 0, vcc
    v_cmp_le_i32 vcc, 16, v200
    s_nop 1
    v_cndmask_b32 v128, v202, 0, vcc
    v_cmp_le_i32 vcc, 17, v200
    s_nop 1
    v_cndmask_b32 v129, v202, 0, vcc
    v_cmp_le_i32 vcc, 18, v200
    s_nop 1
    v_cndmask_b32 v130, v202, 0, vcc
    v_cmp_le_i32 vcc, 19, v200
    s_nop 1
    v_cndmask_b32 v131, v202, 0, vcc
    v_cmp_le_u32 vcc, 2, v201
    s_nop 1
    v_cndmask_b32 v132, v202, 0, vcc
    v_mov_b32 v180, 0x3f803f80
    v_cndmask_b32 v133, v202, 0, vcc
    v_mov_b32 v181, 0x3f803f80
    v_cndmask_b32 v134, v202, 0, vcc
    v_mov_b32 v182, 0x3f803f80
    v_cndmask_b32 v135, v202, 0, vcc
    v_mov_b32 v183, 0x3f803f80
    s_mov_b32 s26, 0x3e0293ee
    s_mov_b32 s27, 0xbe0293ee
    s_lshl_b32 s31, s28, 12
    s_add_u32 s16, s31, 0x1800000
    s_add_u32 s17, s16, 131072
    s_lshl_b32 s32, s30, 17
    s_add_u32 s31, s31, s32
    s_add_u32 s15, s31, 0x800000
    s_add_u32 s22, s31, 0x3800000
    s_lshl_b32 s31, s28, 13
    s_add_u32 s18, s31, 0x2800000
    s_add_u32 s19, s18, 4096
    s_lshl_b32 s31, s28, 11
    s_add_u32 s20, s31, 0x8000000
    s_add_u32 s21, s31, 0x6e00000
    s_lshl_b32 s31, s28, 8
    s_add_u32 s23, s31, 0x8404000
    s_lshl_b32 s31, s28, 3
    s_lshl_b32 s32, s30, 2
    s_add_u32 s31, s31, s32
    s_add_u32 s24, s31, 0x8400000
    v_and_b32 v210, 3, v250
    s_mov_b32 s39, 0
    v_lshlrev_b32 v210, 2, v210
    s_mov_b32 s33, 0x841ec00
    s_lshl_b32 s31, s25, 18
    s_add_u32 s15, s15, s31
    s_add_u32 s16, s16, s31
    s_add_u32 s17, s17, s31
    s_add_u32 s18, s18, s31
    s_add_u32 s19, s19, s31
    s_add_u32 s22, s22, s31
    s_lshl_b32 s31, s25, 16
    s_add_u32 s20, s20, s31
    s_add_u32 s21, s21, s31
    s_lshl_b32 s31, s25, 8
    s_add_u32 s24, s24, s31
    s_lshl_b32 s31, s25, 2
    s_add_u32 s23, s23, s31
    s_add_u32 s33, s33, s31
    s_cmp_lg_u32 s25, 0
    s_cbranch_scc1 main_kernel_a_npf
    s_cmp_lt_u32 s13, 14
    s_cbranch_scc0 main_kernel_a_pf4
    s_mov_b32 s8, s68
    s_and_b32 s9, s69, 0xffff
    s_mov_b32 s10, 0x700000
    s_mov_b32 s11, 0x20000
    s_lshl_b32 s31, s13, 19
    s_branch main_kernel_a_pfg
main_kernel_a_pf4:
    s_mov_b32 s8, s70
    s_and_b32 s9, s71, 0xffff
    s_mov_b32 s10, 0x700000
    s_mov_b32 s11, 0x20000
    s_sub_u32 s31, s13, 2
    s_lshl_b32 s31, s31, 19
main_kernel_a_pfg:
    s_lshl_b32 s32, s14, 17
    s_add_u32 s31, s31, s32
    v_lshlrev_b32 v200, 7, v250
    buffer_load_dword v0, v200, s[8:11], s31 offen
    s_add_u32 s31, s31, 8192
    buffer_load_dword v0, v200, s[8:11], s31 offen
    s_add_u32 s31, s31, 8192
    buffer_load_dword v0, v200, s[8:11], s31 offen
    s_add_u32 s31, s31, 8192
    buffer_load_dword v0, v200, s[8:11], s31 offen
    s_add_u32 s31, s31, 8192
    buffer_load_dword v0, v200, s[8:11], s31 offen
    s_add_u32 s31, s31, 8192
    buffer_load_dword v0, v200, s[8:11], s31 offen
    s_add_u32 s31, s31, 8192
    buffer_load_dword v0, v200, s[8:11], s31 offen
    s_add_u32 s31, s31, 8192
    buffer_load_dword v0, v200, s[8:11], s31 offen
    s_add_u32 s31, s31, 8192
    buffer_load_dword v0, v200, s[8:11], s31 offen
    s_add_u32 s31, s31, 8192
    buffer_load_dword v0, v200, s[8:11], s31 offen
    s_add_u32 s31, s31, 8192
    buffer_load_dword v0, v200, s[8:11], s31 offen
    s_add_u32 s31, s31, 8192
    buffer_load_dword v0, v200, s[8:11], s31 offen
    s_add_u32 s31, s31, 8192
    buffer_load_dword v0, v200, s[8:11], s31 offen
    s_add_u32 s31, s31, 8192
    buffer_load_dword v0, v200, s[8:11], s31 offen
    s_add_u32 s31, s31, 8192
    buffer_load_dword v0, v200, s[8:11], s31 offen
    s_add_u32 s31, s31, 8192
    buffer_load_dword v0, v200, s[8:11], s31 offen
    s_add_u32 s31, s31, 8192
    s_mov_b32 s8, s70
    s_and_b32 s9, s71, 0xffff
    s_mov_b32 s10, 0x700000
    s_mov_b32 s11, 0x20000
    s_sub_u32 s31, s13, 0
    s_lshl_b32 s31, s31, 19
    s_cmp_ge_u32 s13, 12
    s_cbranch_scc1 main_kernel_a_npf
    s_lshl_b32 s32, s14, 17
    s_add_u32 s31, s31, s32
    v_lshlrev_b32 v200, 7, v250
    buffer_load_dword v0, v200, s[8:11], s31 offen
    s_add_u32 s31, s31, 8192
    buffer_load_dword v0, v200, s[8:11], s31 offen
    s_add_u32 s31, s31, 8192
    buffer_load_dword v0, v200, s[8:11], s31 offen
    s_add_u32 s31, s31, 8192
    buffer_load_dword v0, v200, s[8:11], s31 offen
    s_add_u32 s31, s31, 8192
    buffer_load_dword v0, v200, s[8:11], s31 offen
    s_add_u32 s31, s31, 8192
    buffer_load_dword v0, v200, s[8:11], s31 offen
    s_add_u32 s31, s31, 8192
    buffer_load_dword v0, v200, s[8:11], s31 offen
    s_add_u32 s31, s31, 8192
    buffer_load_dword v0, v200, s[8:11], s31 offen
    s_add_u32 s31, s31, 8192
    buffer_load_dword v0, v200, s[8:11], s31 offen
    s_add_u32 s31, s31, 8192
    buffer_load_dword v0, v200, s[8:11], s31 offen
    s_add_u32 s31, s31, 8192
    buffer_load_dword v0, v200, s[8:11], s31 offen
    s_add_u32 s31, s31, 8192
    buffer_load_dword v0, v200, s[8:11], s31 offen
    s_add_u32 s31, s31, 8192
    buffer_load_dword v0, v200, s[8:11], s31 offen
    s_add_u32 s31, s31, 8192
    buffer_load_dword v0, v200, s[8:11], s31 offen
    s_add_u32 s31, s31, 8192
    buffer_load_dword v0, v200, s[8:11], s31 offen
    s_add_u32 s31, s31, 8192
    buffer_load_dword v0, v200, s[8:11], s31 offen
    s_add_u32 s31, s31, 8192
    s_waitcnt vmcnt(0)
main_kernel_a_npf:
    s_cmp_eq_u32 s25, 0
    s_cbranch_scc1 main_kernel_a_fp
    s_sub_u32 s32, s24, 1280
main_kernel_a_gp:
    buffer_load_dword v200, v209, s[4:7], s32 offen sc1
    s_waitcnt vmcnt(0)
    v_cmp_eq_u32 vcc, 0, v200
    s_and_b32 s31, vcc_lo, 1
    s_cbranch_scc0 main_kernel_a_fp
    s_sleep 32
    s_sub_u32 s29, s29, 1
    s_cbranch_scc0 main_kernel_a_gp
    s_branch main_kernel_end
main_kernel_a_fp:
    buffer_load_dword v200, v207, s[4:7], s23 offen sc1
    s_waitcnt vmcnt(0)
    v_cmp_eq_u32 vcc, 0, v200
    s_and_b32 s31, vcc_lo, -1
    s_cbranch_scc0 main_kernel_a_fok
    s_sleep 8
    s_sub_u32 s29, s29, 1
    s_cbranch_scc0 main_kernel_a_fp
    s_branch main_kernel_end
main_kernel_a_fok:
    buffer_load_dwordx4 v[0:3], v204, s[4:7], s15 offen offset:0 sc1
    buffer_load_dwordx4 v[16:19], v204, s[4:7], s16 offen offset:0 sc1
    buffer_load_dwordx4 v[32:35], v204, s[4:7], s17 offen offset:0 sc1
    buffer_load_dwordx4 v[4:7], v204, s[4:7], s15 offen offset:1024 sc1
    buffer_load_dwordx4 v[20:23], v204, s[4:7], s16 offen offset:1024 sc1
    buffer_load_dwordx4 v[36:39], v204, s[4:7], s17 offen offset:1024 sc1
    buffer_load_dwordx4 v[8:11], v204, s[4:7], s15 offen offset:2048 sc1
    buffer_load_dwordx4 v[24:27], v204, s[4:7], s16 offen offset:2048 sc1
    buffer_load_dwordx4 v[40:43], v204, s[4:7], s17 offen offset:2048 sc1
    buffer_load_dwordx4 v[12:15], v204, s[4:7], s15 offen offset:3072 sc1
    buffer_load_dwordx4 v[28:31], v204, s[4:7], s16 offen offset:3072 sc1
    buffer_load_dwordx4 v[44:47], v204, s[4:7], s17 offen offset:3072 sc1
    buffer_load_dword v211, v210, s[4:7], s33 offen sc1
    buffer_load_dwordx4 v[48:51], v204, s[4:7], s18 offen offset:0 sc1
    buffer_load_dwordx4 v[52:55], v204, s[4:7], s18 offen offset:1024 sc1
    buffer_load_dwordx4 v[56:59], v204, s[4:7], s18 offen offset:2048 sc1
    buffer_load_dwordx4 v[60:63], v204, s[4:7], s18 offen offset:3072 sc1
    buffer_load_dwordx4 v[64:67], v204, s[4:7], s19 offen offset:0 sc1
    buffer_load_dwordx4 v[68:71], v204, s[4:7], s19 offen offset:1024 sc1
    buffer_load_dwordx4 v[72:75], v204, s[4:7], s19 offen offset:2048 sc1
    buffer_load_dwordx4 v[76:79], v204, s[4:7], s19 offen offset:3072 sc1
    s_waitcnt vmcnt(0)
main_kernel_a_top:
    s_cmp_ge_u32 s25, 60
    s_cselect_b32 s38, 2, 1
    s_lshl_b32 s34, s38, 18
    s_lshl_b32 s35, s38, 16
    s_lshl_b32 s36, s38, 8
    s_lshl_b32 s37, s38, 2
    s_waitcnt vmcnt(19)
    v_mfma_f32_16x16x32_bf16 v[112:115], v[16:19], v[0:3], v[124:127]
    v_mfma_f32_16x16x32_bf16 v[116:119], v[32:35], v[0:3], v[128:131]
    s_waitcnt vmcnt(16)
    v_mfma_f32_16x16x32_bf16 v[112:115], v[20:23], v[4:7], v[112:115]
    v_mfma_f32_16x16x32_bf16 v[116:119], v[36:39], v[4:7], v[116:119]
    s_waitcnt vmcnt(13)
    v_mfma_f32_16x16x32_bf16 v[112:115], v[24:27], v[8:11], v[112:115]
    v_mfma_f32_16x16x32_bf16 v[116:119], v[40:43], v[8:11], v[116:119]
    s_waitcnt vmcnt(10)
    v_mfma_f32_16x16x32_bf16 v[112:115], v[28:31], v[12:15], v[112:115]
    v_mfma_f32_16x16x32_bf16 v[116:119], v[44:47], v[12:15], v[116:119]
    s_add_u32 s15, s15, s34
    s_add_u32 s16, s16, s34
    s_add_u32 s17, s17, s34
    s_add_u32 s18, s18, s34
    s_add_u32 s19, s19, s34
    s_add_u32 s23, s23, s37
    s_waitcnt vmcnt(9)
    v_cmp_eq_u32 vcc, 0, v211
    s_nop 0
    v_max3_f32 v202, v112, v113, v114
    s_nop 1
    v_max3_f32 v202, v202, v115, v116
    v_max3_f32 v202, v202, v117, v118
    v_max_f32 v202, v202, v119
    s_cmp_lg_u32 s39, 0
    s_cbranch_scc1 main_kernel_a_mq
    s_cmp_ge_u32 s25, 56
    s_cselect_b32 s32, 1, 2
    s_and_b32 s31, vcc_lo, s32
    s_cbranch_scc0 main_kernel_a_mp
main_kernel_a_pp:
    buffer_load_dword v200, v210, s[4:7], s33 offen sc1
    s_waitcnt vmcnt(0)
    v_cmp_eq_u32 vcc, 0, v200
    s_and_b32 s31, vcc_lo, s32
    s_cbranch_scc0 main_kernel_a_pok
    s_sleep 2
    s_sub_u32 s29, s29, 1
    s_cbranch_scc0 main_kernel_a_pp
    s_branch main_kernel_end
main_kernel_a_pok:
    s_cmp_eq_u32 s32, 2
    s_cbranch_scc1 main_kernel_a_mp
    s_sleep 2
    s_cmp_eq_u32 s25, 63
    s_cbranch_scc1 main_kernel_a_mp
    s_sleep 40
main_kernel_a_mp:
    s_mov_b32 s39, 0
    buffer_load_dwordx4 v[80:83], v205, s[4:7], s20 offen offset:0 sc1
    buffer_load_dwordx4 v[84:87], v205, s[4:7], s20 offen offset:512 sc1
    buffer_load_dwordx4 v[88:91], v205, s[4:7], s20 offen offset:1024 sc1
    buffer_load_dwordx4 v[92:95], v205, s[4:7], s20 offen offset:1536 sc1
    buffer_load_dwordx2 v[96:97], v206, s[4:7], s21 offen offset:0 sc1
    buffer_load_dwordx2 v[98:99], v206, s[4:7], s21 offen offset:256 sc1
    buffer_load_dwordx2 v[100:101], v206, s[4:7], s21 offen offset:512 sc1
    buffer_load_dwordx2 v[102:103], v206, s[4:7], s21 offen offset:768 sc1
    buffer_load_dwordx2 v[104:105], v206, s[4:7], s21 offen offset:1024 sc1
    buffer_load_dwordx2 v[106:107], v206, s[4:7], s21 offen offset:1280 sc1
    buffer_load_dwordx2 v[108:109], v206, s[4:7], s21 offen offset:1536 sc1
    buffer_load_dwordx2 v[110:111], v206, s[4:7], s21 offen offset:1792 sc1
    buffer_load_dword v212, v207, s[4:7], s23 offen offset:0 sc1
    buffer_load_dword v211, v210, s[4:7], s33 offen sc1
main_kernel_a_mq:
    s_waitcnt vmcnt(13)
    v_mfma_f32_16x16x32_bf16 v[120:123], v[80:83], v[0:3], v[132:135]
    v_max3_u32 v200, v80, v81, v82
    v_max_u32 v200, v200, v83
    s_waitcnt vmcnt(12)
    v_mfma_f32_16x16x32_bf16 v[120:123], v[84:87], v[4:7], v[120:123]
    v_max3_u32 v200, v200, v84, v85
    v_max3_u32 v200, v200, v86, v87
    s_waitcnt vmcnt(11)
    v_mfma_f32_16x16x32_bf16 v[120:123], v[88:91], v[8:11], v[120:123]
    v_max3_u32 v200, v200, v88, v89
    v_max3_u32 v200, v200, v90, v91
    s_waitcnt vmcnt(10)
    v_mfma_f32_16x16x32_bf16 v[120:123], v[92:95], v[12:15], v[120:123]
    v_max3_u32 v200, v200, v92, v93
    v_max3_u32 v200, v200, v94, v95
    s_waitcnt vmcnt(8)
    v_max3_u32 v200, v200, v96, v97
    v_max3_u32 v200, v200, v98, v99
    s_waitcnt vmcnt(6)
    v_max3_u32 v200, v200, v100, v101
    v_max3_u32 v200, v200, v102, v103
    s_waitcnt vmcnt(4)
    v_max3_u32 v200, v200, v104, v105
    v_max3_u32 v200, v200, v106, v107
    s_waitcnt vmcnt(2)
    v_max3_u32 v200, v200, v108, v109
    v_max3_u32 v200, v200, v110, v111
    v_cmp_eq_u32 vcc, -1, v200
    s_cbranch_vccz main_kernel_a_mok
    s_sleep 1
    s_sub_u32 s29, s29, 1
    s_cbranch_scc0 main_kernel_a_mp
    s_branch main_kernel_end
main_kernel_a_mok:
    v_mul_f32 v120, s26, v120
    v_mul_f32 v121, s26, v121
    v_mul_f32 v122, s26, v122
    v_mul_f32 v123, s26, v123
    v_max3_f32 v200, v202, v120, v121
    v_max3_f32 v200, v200, v122, v123
    v_mov_b32 v201, v200
    s_add_u32 s20, s20, s35
    s_add_u32 s21, s21, s35
    v_permlane32_swap_b32 v200, v201
    v_max_f32 v200, v200, v201
    v_mov_b32 v201, v200
    s_nop 1
    v_permlane16_swap_b32 v200, v201
    v_max_f32 v200, v200, v201
    v_sub_f32 v112, v112, v200
    v_sub_f32 v113, v113, v200
    v_sub_f32 v114, v114, v200
    v_sub_f32 v115, v115, v200
    v_sub_f32 v116, v116, v200
    v_sub_f32 v117, v117, v200
    v_sub_f32 v118, v118, v200
    v_sub_f32 v119, v119, v200
    v_sub_f32 v120, v120, v200
    v_sub_f32 v121, v121, v200
    v_sub_f32 v122, v122, v200
    v_sub_f32 v123, v123, v200
    v_exp_f32 v112, v112
    v_exp_f32 v113, v113
    v_exp_f32 v114, v114
    v_cvt_pk_bf16_f32 v136, v112, v113
    v_exp_f32 v115, v115
    v_exp_f32 v116, v116
    v_cvt_pk_bf16_f32 v137, v114, v115
    v_exp_f32 v117, v117
    v_exp_f32 v118, v118
    v_cvt_pk_bf16_f32 v138, v116, v117
    v_exp_f32 v119, v119
    v_exp_f32 v120, v120
    v_cvt_pk_bf16_f32 v139, v118, v119
    v_exp_f32 v121, v121
    v_exp_f32 v122, v122
    v_cvt_pk_bf16_f32 v140, v120, v121
    v_exp_f32 v123, v123
    s_nop 0
    v_cvt_pk_bf16_f32 v141, v122, v123
    s_waitcnt vmcnt(1)
    v_mfma_f32_16x16x32_bf16 v[144:147], v[180:183], v[136:139], 0
    v_mfma_f32_16x16x32_bf16 v[148:151], v[48:51], v[136:139], 0
    s_nop 0
    s_nop 0
    s_nop 0
    v_mfma_f32_16x16x16_bf16 v[144:147], v[180:181], v[140:141], v[144:147]
    v_mfma_f32_16x16x32_bf16 v[152:155], v[52:55], v[136:139], 0
    v_mfma_f32_16x16x32_bf16 v[156:159], v[56:59], v[136:139], 0
    v_mfma_f32_16x16x32_bf16 v[160:163], v[60:63], v[136:139], 0
    v_mfma_f32_16x16x32_bf16 v[164:167], v[64:67], v[136:139], 0
    v_mfma_f32_16x16x32_bf16 v[168:171], v[68:71], v[136:139], 0
    v_mfma_f32_16x16x32_bf16 v[172:175], v[72:75], v[136:139], 0
    v_mfma_f32_16x16x32_bf16 v[176:179], v[76:79], v[136:139], 0
    v_rcp_f32 v200, v144
    v_mfma_f32_16x16x16_bf16 v[148:151], v[96:97], v[140:141], v[148:151]
    v_mfma_f32_16x16x16_bf16 v[152:155], v[98:99], v[140:141], v[152:155]
    v_mfma_f32_16x16x16_bf16 v[156:159], v[100:101], v[140:141], v[156:159]
    v_mfma_f32_16x16x16_bf16 v[160:163], v[102:103], v[140:141], v[160:163]
    v_mfma_f32_16x16x16_bf16 v[164:167], v[104:105], v[140:141], v[164:167]
    v_mfma_f32_16x16x16_bf16 v[168:171], v[106:107], v[140:141], v[168:171]
    v_mfma_f32_16x16x16_bf16 v[172:175], v[108:109], v[140:141], v[172:175]
    v_mfma_f32_16x16x16_bf16 v[176:179], v[110:111], v[140:141], v[176:179]
    v_mov_b32 v201, v200
    s_cmp_lg_u32 s39, 0
    s_cbranch_scc1 main_kernel_a_nw
    s_waitcnt vmcnt(0)
main_kernel_a_nw:
    v_cmp_ne_u32 vcc, 0, v211
    s_and_b32 s39, vcc_lo, 4
    v_cmp_eq_u32 vcc, 0, v212
    v_pk_mul_f32 v[148:149], v[148:149], v[200:201]
    v_pk_mul_f32 v[150:151], v[150:151], v[200:201]
    v_pk_mul_f32 v[152:153], v[152:153], v[200:201]
    v_pk_mul_f32 v[154:155], v[154:155], v[200:201]
    v_cvt_pk_bf16_f32 v184, v148, v149
    v_cvt_pk_bf16_f32 v185, v150, v151
    v_cvt_pk_bf16_f32 v186, v152, v153
    v_cvt_pk_bf16_f32 v187, v154, v155
    buffer_store_dwordx4 v[184:187], v204, s[4:7], s22 offen offset:0 sc1
    v_pk_mul_f32 v[156:157], v[156:157], v[200:201]
    v_pk_mul_f32 v[158:159], v[158:159], v[200:201]
    v_pk_mul_f32 v[160:161], v[160:161], v[200:201]
    v_pk_mul_f32 v[162:163], v[162:163], v[200:201]
    v_cvt_pk_bf16_f32 v188, v156, v157
    v_cvt_pk_bf16_f32 v189, v158, v159
    v_cvt_pk_bf16_f32 v190, v160, v161
    v_cvt_pk_bf16_f32 v191, v162, v163
    buffer_store_dwordx4 v[188:191], v204, s[4:7], s22 offen offset:1024 sc1
    v_pk_mul_f32 v[164:165], v[164:165], v[200:201]
    v_pk_mul_f32 v[166:167], v[166:167], v[200:201]
    v_pk_mul_f32 v[168:169], v[168:169], v[200:201]
    v_pk_mul_f32 v[170:171], v[170:171], v[200:201]
    v_cvt_pk_bf16_f32 v192, v164, v165
    v_cvt_pk_bf16_f32 v193, v166, v167
    v_cvt_pk_bf16_f32 v194, v168, v169
    v_cvt_pk_bf16_f32 v195, v170, v171
    buffer_store_dwordx4 v[192:195], v204, s[4:7], s22 offen offset:2048 sc1
    s_nop 0
    v_pk_mul_f32 v[172:173], v[172:173], v[200:201]
    v_pk_mul_f32 v[174:175], v[174:175], v[200:201]
    v_pk_mul_f32 v[176:177], v[176:177], v[200:201]
    v_pk_mul_f32 v[178:179], v[178:179], v[200:201]
    v_cvt_pk_bf16_f32 v196, v172, v173
    v_cvt_pk_bf16_f32 v197, v174, v175
    v_cvt_pk_bf16_f32 v198, v176, v177
    v_cvt_pk_bf16_f32 v199, v178, v179
    buffer_store_dwordx4 v[196:199], v204, s[4:7], s22 offen offset:3072 sc1
    s_add_u32 s22, s22, s34
    s_add_u32 s33, s33, s37
    s_add_u32 s25, s25, s38
    s_cmp_ge_u32 s25, 64
    s_cbranch_scc1 main_kernel_a_last
    s_cbranch_vccnz main_kernel_a_slow
    s_cmp_gt_u32 s25, 60
    s_cbranch_scc1 main_kernel_a_slow
    s_cmp_ge_u32 s25, 56
    s_cselect_b32 s39, 0, s39
    s_cmp_lg_u32 s39, 0
    s_cbranch_scc1 main_kernel_a_pre
    buffer_load_dwordx4 v[0:3], v204, s[4:7], s15 offen offset:0 sc1
    buffer_load_dwordx4 v[16:19], v204, s[4:7], s16 offen offset:0 sc1
    buffer_load_dwordx4 v[32:35], v204, s[4:7], s17 offen offset:0 sc1
    buffer_load_dwordx4 v[4:7], v204, s[4:7], s15 offen offset:1024 sc1
    buffer_load_dwordx4 v[20:23], v204, s[4:7], s16 offen offset:1024 sc1
    buffer_load_dwordx4 v[36:39], v204, s[4:7], s17 offen offset:1024 sc1
    buffer_load_dwordx4 v[8:11], v204, s[4:7], s15 offen offset:2048 sc1
    buffer_load_dwordx4 v[24:27], v204, s[4:7], s16 offen offset:2048 sc1
    buffer_load_dwordx4 v[40:43], v204, s[4:7], s17 offen offset:2048 sc1
    buffer_load_dwordx4 v[12:15], v204, s[4:7], s15 offen offset:3072 sc1
    buffer_load_dwordx4 v[28:31], v204, s[4:7], s16 offen offset:3072 sc1
    buffer_load_dwordx4 v[44:47], v204, s[4:7], s17 offen offset:3072 sc1
    buffer_load_dword v211, v210, s[4:7], s33 offen sc1
    buffer_load_dwordx4 v[48:51], v204, s[4:7], s18 offen offset:0 sc1
    buffer_load_dwordx4 v[52:55], v204, s[4:7], s18 offen offset:1024 sc1
    buffer_load_dwordx4 v[56:59], v204, s[4:7], s18 offen offset:2048 sc1
    buffer_load_dwordx4 v[60:63], v204, s[4:7], s18 offen offset:3072 sc1
    buffer_load_dwordx4 v[64:67], v204, s[4:7], s19 offen offset:0 sc1
    buffer_load_dwordx4 v[68:71], v204, s[4:7], s19 offen offset:1024 sc1
    buffer_load_dwordx4 v[72:75], v204, s[4:7], s19 offen offset:2048 sc1
    buffer_load_dwordx4 v[76:79], v204, s[4:7], s19 offen offset:3072 sc1
    s_waitcnt vmcnt(21)
    s_mov_b64 exec, 1
    buffer_store_dword v208, v209, s[4:7], s24 offen sc1
    s_mov_b64 exec, -1
    s_add_u32 s24, s24, s36
    s_branch main_kernel_a_top
main_kernel_a_pre:
    buffer_load_dwordx4 v[80:83], v205, s[4:7], s20 offen offset:0 sc1
    buffer_load_dwordx4 v[84:87], v205, s[4:7], s20 offen offset:512 sc1
    buffer_load_dwordx4 v[88:91], v205, s[4:7], s20 offen offset:1024 sc1
    buffer_load_dwordx4 v[92:95], v205, s[4:7], s20 offen offset:1536 sc1
    buffer_load_dwordx2 v[96:97], v206, s[4:7], s21 offen offset:0 sc1
    buffer_load_dwordx2 v[98:99], v206, s[4:7], s21 offen offset:256 sc1
    buffer_load_dwordx2 v[100:101], v206, s[4:7], s21 offen offset:512 sc1
    buffer_load_dwordx2 v[102:103], v206, s[4:7], s21 offen offset:768 sc1
    buffer_load_dwordx2 v[104:105], v206, s[4:7], s21 offen offset:1024 sc1
    buffer_load_dwordx2 v[106:107], v206, s[4:7], s21 offen offset:1280 sc1
    buffer_load_dwordx2 v[108:109], v206, s[4:7], s21 offen offset:1536 sc1
    buffer_load_dwordx2 v[110:111], v206, s[4:7], s21 offen offset:1792 sc1
    buffer_load_dword v212, v207, s[4:7], s23 offen offset:4 sc1
    buffer_load_dwordx4 v[0:3], v204, s[4:7], s15 offen offset:0 sc1
    buffer_load_dwordx4 v[16:19], v204, s[4:7], s16 offen offset:0 sc1
    buffer_load_dwordx4 v[32:35], v204, s[4:7], s17 offen offset:0 sc1
    buffer_load_dwordx4 v[4:7], v204, s[4:7], s15 offen offset:1024 sc1
    buffer_load_dwordx4 v[20:23], v204, s[4:7], s16 offen offset:1024 sc1
    buffer_load_dwordx4 v[36:39], v204, s[4:7], s17 offen offset:1024 sc1
    buffer_load_dwordx4 v[8:11], v204, s[4:7], s15 offen offset:2048 sc1
    buffer_load_dwordx4 v[24:27], v204, s[4:7], s16 offen offset:2048 sc1
    buffer_load_dwordx4 v[40:43], v204, s[4:7], s17 offen offset:2048 sc1
    buffer_load_dwordx4 v[12:15], v204, s[4:7], s15 offen offset:3072 sc1
    buffer_load_dwordx4 v[28:31], v204, s[4:7], s16 offen offset:3072 sc1
    buffer_load_dwordx4 v[44:47], v204, s[4:7], s17 offen offset:3072 sc1
    buffer_load_dword v211, v210, s[4:7], s33 offen sc1
    buffer_load_dwordx4 v[48:51], v204, s[4:7], s18 offen offset:0 sc1
    buffer_load_dwordx4 v[52:55], v204, s[4:7], s18 offen offset:1024 sc1
    buffer_load_dwordx4 v[56:59], v204, s[4:7], s18 offen offset:2048 sc1
    buffer_load_dwordx4 v[60:63], v204, s[4:7], s18 offen offset:3072 sc1
    buffer_load_dwordx4 v[64:67], v204, s[4:7], s19 offen offset:0 sc1
    buffer_load_dwordx4 v[68:71], v204, s[4:7], s19 offen offset:1024 sc1
    buffer_load_dwordx4 v[72:75], v204, s[4:7], s19 offen offset:2048 sc1
    buffer_load_dwordx4 v[76:79], v204, s[4:7], s19 offen offset:3072 sc1
    s_waitcnt vmcnt(34)
    s_mov_b64 exec, 1
    buffer_store_dword v208, v209, s[4:7], s24 offen sc1
    s_mov_b64 exec, -1
    s_add_u32 s24, s24, s36
    s_branch main_kernel_a_top
main_kernel_a_slow:
    s_mov_b32 s39, 0
    s_waitcnt vmcnt(0)
    s_mov_b64 exec, 1
    buffer_store_dword v208, v209, s[4:7], s24 offen sc1
    s_mov_b64 exec, -1
    s_add_u32 s24, s24, s36
    s_branch main_kernel_a_fp
main_kernel_a_last:
    s_waitcnt vmcnt(0)
    s_mov_b64 exec, 1
    buffer_store_dword v208, v209, s[4:7], s24 offen sc1
    s_mov_b64 exec, -1
    s_add_u32 s24, s24, s36
    s_branch main_kernel_end
main_kernel_wo:
    s_mov_b32 s8, s46
    s_and_b32 s9, s47, 0xffff
    s_mov_b32 s10, 0x800000
    s_mov_b32 s11, 0x20000
    v_lshlrev_b32 v170, 4, v250
    s_lshr_b32 s23, s12, 2
    s_sub_u32 s21, s12, 5
    s_cselect_b32 s23, s23, s21
    s_cselect_b32 s18, 44, 63
    v_lshrrev_b32 v178, 2, v250
    v_and_b32 v179, 3, v250
    v_lshlrev_b32 v0, 11, v178
    v_lshl_add_u32 v0, v179, 4, v0
    s_lshl_b32 s19, s14, 15
    v_lshl_add_u32 v1, v178, 6, s19
    v_lshl_add_u32 v1, v179, 3, v1
    s_lshl_b32 s20, s14, 21
    s_lshl_b32 s21, s13, 6
    s_add_u32 s20, s20, s21
    s_add_u32 s21, s20, 0x0
    s_add_u32 m0, s19, 0
    s_nop 0
    buffer_load_dwordx4 v0, s[8:11], s21 offen lds
    s_add_u32 s21, s20, 0x8000
    s_add_u32 m0, s19, 1024
    s_nop 0
    buffer_load_dwordx4 v0, s[8:11], s21 offen lds
    s_add_u32 s21, s20, 0x10000
    s_add_u32 m0, s19, 2048
    s_nop 0
    buffer_load_dwordx4 v0, s[8:11], s21 offen lds
    s_add_u32 s21, s20, 0x18000
    s_add_u32 m0, s19, 3072
    s_nop 0
    buffer_load_dwordx4 v0, s[8:11], s21 offen lds
    s_add_u32 s21, s20, 0x20000
    s_add_u32 m0, s19, 4096
    s_nop 0
    buffer_load_dwordx4 v0, s[8:11], s21 offen lds
    s_add_u32 s21, s20, 0x28000
    s_add_u32 m0, s19, 5120
    s_nop 0
    buffer_load_dwordx4 v0, s[8:11], s21 offen lds
    s_add_u32 s21, s20, 0x30000
    s_add_u32 m0, s19, 6144
    s_nop 0
    buffer_load_dwordx4 v0, s[8:11], s21 offen lds
    s_add_u32 s21, s20, 0x38000
    s_add_u32 m0, s19, 7168
    s_nop 0
    buffer_load_dwordx4 v0, s[8:11], s21 offen lds
    s_add_u32 s21, s20, 0x40000
    s_add_u32 m0, s19, 8192
    s_nop 0
    buffer_load_dwordx4 v0, s[8:11], s21 offen lds
    s_add_u32 s21, s20, 0x48000
    s_add_u32 m0, s19, 9216
    s_nop 0
    buffer_load_dwordx4 v0, s[8:11], s21 offen lds
    s_add_u32 s21, s20, 0x50000
    s_add_u32 m0, s19, 10240
    s_nop 0
    buffer_load_dwordx4 v0, s[8:11], s21 offen lds
    s_add_u32 s21, s20, 0x58000
    s_add_u32 m0, s19, 11264
    s_nop 0
    buffer_load_dwordx4 v0, s[8:11], s21 offen lds
    s_add_u32 s21, s20, 0x60000
    s_add_u32 m0, s19, 12288
    s_nop 0
    buffer_load_dwordx4 v0, s[8:11], s21 offen lds
    s_add_u32 s21, s20, 0x68000
    s_add_u32 m0, s19, 13312
    s_nop 0
    buffer_load_dwordx4 v0, s[8:11], s21 offen lds
    s_add_u32 s21, s20, 0x70000
    s_add_u32 m0, s19, 14336
    s_nop 0
    buffer_load_dwordx4 v0, s[8:11], s21 offen lds
    s_add_u32 s21, s20, 0x78000
    s_add_u32 m0, s19, 15360
    s_nop 0
    buffer_load_dwordx4 v0, s[8:11], s21 offen lds
    s_add_u32 s21, s20, 0x80000
    s_add_u32 m0, s19, 16384
    s_nop 0
    buffer_load_dwordx4 v0, s[8:11], s21 offen lds
    s_add_u32 s21, s20, 0x88000
    s_add_u32 m0, s19, 17408
    s_nop 0
    buffer_load_dwordx4 v0, s[8:11], s21 offen lds
    s_add_u32 s21, s20, 0x90000
    s_add_u32 m0, s19, 18432
    s_nop 0
    buffer_load_dwordx4 v0, s[8:11], s21 offen lds
    s_add_u32 s21, s20, 0x98000
    s_add_u32 m0, s19, 19456
    s_nop 0
    buffer_load_dwordx4 v0, s[8:11], s21 offen lds
    s_add_u32 s21, s20, 0xa0000
    s_add_u32 m0, s19, 20480
    s_nop 0
    buffer_load_dwordx4 v0, s[8:11], s21 offen lds
    s_add_u32 s21, s20, 0xa8000
    s_add_u32 m0, s19, 21504
    s_nop 0
    buffer_load_dwordx4 v0, s[8:11], s21 offen lds
    s_add_u32 s21, s20, 0xb0000
    s_add_u32 m0, s19, 22528
    s_nop 0
    buffer_load_dwordx4 v0, s[8:11], s21 offen lds
    s_add_u32 s21, s20, 0xb8000
    s_add_u32 m0, s19, 23552
    s_nop 0
    buffer_load_dwordx4 v0, s[8:11], s21 offen lds
    s_add_u32 s21, s20, 0xc0000
    s_add_u32 m0, s19, 24576
    s_nop 0
    buffer_load_dwordx4 v0, s[8:11], s21 offen lds
    s_add_u32 s21, s20, 0xc8000
    s_add_u32 m0, s19, 25600
    s_nop 0
    buffer_load_dwordx4 v0, s[8:11], s21 offen lds
    s_add_u32 s21, s20, 0xd0000
    s_add_u32 m0, s19, 26624
    s_nop 0
    buffer_load_dwordx4 v0, s[8:11], s21 offen lds
    s_add_u32 s21, s20, 0xd8000
    s_add_u32 m0, s19, 27648
    s_nop 0
    buffer_load_dwordx4 v0, s[8:11], s21 offen lds
    s_add_u32 s21, s20, 0xe0000
    s_add_u32 m0, s19, 28672
    s_nop 0
    buffer_load_dwordx4 v0, s[8:11], s21 offen lds
    s_add_u32 s21, s20, 0xe8000
    s_add_u32 m0, s19, 29696
    s_nop 0
    buffer_load_dwordx4 v0, s[8:11], s21 offen lds
    s_add_u32 s21, s20, 0xf0000
    s_add_u32 m0, s19, 30720
    s_nop 0
    buffer_load_dwordx4 v0, s[8:11], s21 offen lds
    s_add_u32 s21, s20, 0xf8000
    s_add_u32 m0, s19, 31744
    s_nop 0
    buffer_load_dwordx4 v0, s[8:11], s21 offen lds
    v_and_b32 v178, 15, v250
    v_lshrrev_b32 v179, 4, v250
    v_lshlrev_b32 v175, 11, v178
    v_lshl_add_u32 v175, v179, 3, v175
    s_lshl_b32 s21, s14, 11
    s_add_u32 s21, s21, 131072
    v_add_u32 v176, s21, v170
    s_lshl_b32 s21, s14, 10
    s_add_u32 s21, s21, 131072
    v_add_u32 v177, s21, v170
    s_lshr_b32 s21, s13, 2
    s_lshl_b32 s21, s21, 8
    s_add_u32 s21, s21, 0x8412000
    s_lshl2_add_u32 s21, s18, s21
    v_mov_b32 v172, s21
    v_mov_b32 v173, 4
    s_lshl_b32 s21, s14, 4
    s_add_u32 s21, s21, s23
    s_lshl_b32 s21, s21, 2
    s_add_u32 s21, s21, 0x8400000
    s_lshl_b32 s22, s18, 8
    s_add_u32 s21, s21, s22
    s_mov_b64 exec, 0xff
    v_lshl_add_u32 v172, v250, 3, s21
    v_mov_b32 v173, 0x100
    s_mov_b64 exec, -1
    s_lshl_b32 s15, s14, 15
    s_lshl_b32 s21, s23, 17
    s_add_u32 s15, s15, s21
    s_add_u32 s15, s15, 0x3800000
    s_lshl_b32 s21, s18, 18
    s_add_u32 s15, s15, s21
    s_lshl_b32 s21, s23, 15
    s_lshl_b32 s22, s18, 16
    s_add_u32 s21, s21, s22
    s_and_b32 s22, s14, 1
    s_lshl_b32 s16, s13, 1
    s_add_u32 s16, s16, s22
    s_lshl_b32 s16, s16, 5
    s_add_u32 s16, s16, s21
    s_lshl_b32 s17, s13, 7
    s_add_u32 s17, s17, s22
    s_lshl_b32 s17, s17, 3
    s_add_u32 s17, s17, s21
    s_add_u32 s17, s17, 0x6400000
    s_waitcnt vmcnt(24)
    ds_read_b64_tr_b16 a[0:1], v1 offset:0
    ds_read_b64_tr_b16 a[2:3], v1 offset:1024
    ds_read_b64_tr_b16 a[128:129], v1 offset:32
    ds_read_b64_tr_b16 a[130:131], v1 offset:1056
    ds_read_b64_tr_b16 a[4:5], v1 offset:2048
    ds_read_b64_tr_b16 a[6:7], v1 offset:3072
    ds_read_b64_tr_b16 a[132:133], v1 offset:2080
    ds_read_b64_tr_b16 a[134:135], v1 offset:3104
    ds_read_b64_tr_b16 a[8:9], v1 offset:4096
    ds_read_b64_tr_b16 a[10:11], v1 offset:5120
    ds_read_b64_tr_b16 a[136:137], v1 offset:4128
    ds_read_b64_tr_b16 a[138:139], v1 offset:5152
    ds_read_b64_tr_b16 a[12:13], v1 offset:6144
    ds_read_b64_tr_b16 a[14:15], v1 offset:7168
    ds_read_b64_tr_b16 a[140:141], v1 offset:6176
    ds_read_b64_tr_b16 a[142:143], v1 offset:7200
    s_waitcnt lgkmcnt(0)
    s_add_u32 s21, s20, 0x100000
    s_add_u32 m0, s19, 0
    s_nop 0
    buffer_load_dwordx4 v0, s[8:11], s21 offen lds
    s_add_u32 s21, s20, 0x108000
    s_add_u32 m0, s19, 1024
    s_nop 0
    buffer_load_dwordx4 v0, s[8:11], s21 offen lds
    s_add_u32 s21, s20, 0x110000
    s_add_u32 m0, s19, 2048
    s_nop 0
    buffer_load_dwordx4 v0, s[8:11], s21 offen lds
    s_add_u32 s21, s20, 0x118000
    s_add_u32 m0, s19, 3072
    s_nop 0
    buffer_load_dwordx4 v0, s[8:11], s21 offen lds
    s_add_u32 s21, s20, 0x120000
    s_add_u32 m0, s19, 4096
    s_nop 0
    buffer_load_dwordx4 v0, s[8:11], s21 offen lds
    s_add_u32 s21, s20, 0x128000
    s_add_u32 m0, s19, 5120
    s_nop 0
    buffer_load_dwordx4 v0, s[8:11], s21 offen lds
    s_add_u32 s21, s20, 0x130000
    s_add_u32 m0, s19, 6144
    s_nop 0
    buffer_load_dwordx4 v0, s[8:11], s21 offen lds
    s_add_u32 s21, s20, 0x138000
    s_add_u32 m0, s19, 7168
    s_nop 0
    buffer_load_dwordx4 v0, s[8:11], s21 offen lds
    s_waitcnt vmcnt(24)
    ds_read_b64_tr_b16 a[16:17], v1 offset:8192
    ds_read_b64_tr_b16 a[18:19], v1 offset:9216
    ds_read_b64_tr_b16 a[144:145], v1 offset:8224
    ds_read_b64_tr_b16 a[146:147], v1 offset:9248
    ds_read_b64_tr_b16 a[20:21], v1 offset:10240
    ds_read_b64_tr_b16 a[22:23], v1 offset:11264
    ds_read_b64_tr_b16 a[148:149], v1 offset:10272
    ds_read_b64_tr_b16 a[150:151], v1 offset:11296
    ds_read_b64_tr_b16 a[24:25], v1 offset:12288
    ds_read_b64_tr_b16 a[26:27], v1 offset:13312
    ds_read_b64_tr_b16 a[152:153], v1 offset:12320
    ds_read_b64_tr_b16 a[154:155], v1 offset:13344
    ds_read_b64_tr_b16 a[28:29], v1 offset:14336
    ds_read_b64_tr_b16 a[30:31], v1 offset:15360
    ds_read_b64_tr_b16 a[156:157], v1 offset:14368
    ds_read_b64_tr_b16 a[158:159], v1 offset:15392
    s_waitcnt lgkmcnt(0)
    s_add_u32 s21, s20, 0x140000
    s_add_u32 m0, s19, 8192
    s_nop 0
    buffer_load_dwordx4 v0, s[8:11], s21 offen lds
    s_add_u32 s21, s20, 0x148000
    s_add_u32 m0, s19, 9216
    s_nop 0
    buffer_load_dwordx4 v0, s[8:11], s21 offen lds
    s_add_u32 s21, s20, 0x150000
    s_add_u32 m0, s19, 10240
    s_nop 0
    buffer_load_dwordx4 v0, s[8:11], s21 offen lds
    s_add_u32 s21, s20, 0x158000
    s_add_u32 m0, s19, 11264
    s_nop 0
    buffer_load_dwordx4 v0, s[8:11], s21 offen lds
    s_add_u32 s21, s20, 0x160000
    s_add_u32 m0, s19, 12288
    s_nop 0
    buffer_load_dwordx4 v0, s[8:11], s21 offen lds
    s_add_u32 s21, s20, 0x168000
    s_add_u32 m0, s19, 13312
    s_nop 0
    buffer_load_dwordx4 v0, s[8:11], s21 offen lds
    s_add_u32 s21, s20, 0x170000
    s_add_u32 m0, s19, 14336
    s_nop 0
    buffer_load_dwordx4 v0, s[8:11], s21 offen lds
    s_add_u32 s21, s20, 0x178000
    s_add_u32 m0, s19, 15360
    s_nop 0
    buffer_load_dwordx4 v0, s[8:11], s21 offen lds
    s_waitcnt vmcnt(24)
    ds_read_b64_tr_b16 a[32:33], v1 offset:16384
    ds_read_b64_tr_b16 a[34:35], v1 offset:17408
    ds_read_b64_tr_b16 a[160:161], v1 offset:16416
    ds_read_b64_tr_b16 a[162:163], v1 offset:17440
    ds_read_b64_tr_b16 a[36:37], v1 offset:18432
    ds_read_b64_tr_b16 a[38:39], v1 offset:19456
    ds_read_b64_tr_b16 a[164:165], v1 offset:18464
    ds_read_b64_tr_b16 a[166:167], v1 offset:19488
    ds_read_b64_tr_b16 a[40:41], v1 offset:20480
    ds_read_b64_tr_b16 a[42:43], v1 offset:21504
    ds_read_b64_tr_b16 a[168:169], v1 offset:20512
    ds_read_b64_tr_b16 a[170:171], v1 offset:21536
    ds_read_b64_tr_b16 a[44:45], v1 offset:22528
    ds_read_b64_tr_b16 a[46:47], v1 offset:23552
    ds_read_b64_tr_b16 a[172:173], v1 offset:22560
    ds_read_b64_tr_b16 a[174:175], v1 offset:23584
    s_waitcnt lgkmcnt(0)
    s_add_u32 s21, s20, 0x180000
    s_add_u32 m0, s19, 16384
    s_nop 0
    buffer_load_dwordx4 v0, s[8:11], s21 offen lds
    s_add_u32 s21, s20, 0x188000
    s_add_u32 m0, s19, 17408
    s_nop 0
    buffer_load_dwordx4 v0, s[8:11], s21 offen lds
    s_add_u32 s21, s20, 0x190000
    s_add_u32 m0, s19, 18432
    s_nop 0
    buffer_load_dwordx4 v0, s[8:11], s21 offen lds
    s_add_u32 s21, s20, 0x198000
    s_add_u32 m0, s19, 19456
    s_nop 0
    buffer_load_dwordx4 v0, s[8:11], s21 offen lds
    s_add_u32 s21, s20, 0x1a0000
    s_add_u32 m0, s19, 20480
    s_nop 0
    buffer_load_dwordx4 v0, s[8:11], s21 offen lds
    s_add_u32 s21, s20, 0x1a8000
    s_add_u32 m0, s19, 21504
    s_nop 0
    buffer_load_dwordx4 v0, s[8:11], s21 offen lds
    s_add_u32 s21, s20, 0x1b0000
    s_add_u32 m0, s19, 22528
    s_nop 0
    buffer_load_dwordx4 v0, s[8:11], s21 offen lds
    s_add_u32 s21, s20, 0x1b8000
    s_add_u32 m0, s19, 23552
    s_nop 0
    buffer_load_dwordx4 v0, s[8:11], s21 offen lds
    s_waitcnt vmcnt(24)
    ds_read_b64_tr_b16 a[48:49], v1 offset:24576
    ds_read_b64_tr_b16 a[50:51], v1 offset:25600
    ds_read_b64_tr_b16 a[176:177], v1 offset:24608
    ds_read_b64_tr_b16 a[178:179], v1 offset:25632
    ds_read_b64_tr_b16 a[52:53], v1 offset:26624
    ds_read_b64_tr_b16 a[54:55], v1 offset:27648
    ds_read_b64_tr_b16 a[180:181], v1 offset:26656
    ds_read_b64_tr_b16 a[182:183], v1 offset:27680
    ds_read_b64_tr_b16 a[56:57], v1 offset:28672
    ds_read_b64_tr_b16 a[58:59], v1 offset:29696
    ds_read_b64_tr_b16 a[184:185], v1 offset:28704
    ds_read_b64_tr_b16 a[186:187], v1 offset:29728
    ds_read_b64_tr_b16 a[60:61], v1 offset:30720
    ds_read_b64_tr_b16 a[62:63], v1 offset:31744
    ds_read_b64_tr_b16 a[188:189], v1 offset:30752
    ds_read_b64_tr_b16 a[190:191], v1 offset:31776
    s_waitcnt lgkmcnt(0)
    s_add_u32 s21, s20, 0x1c0000
    s_add_u32 m0, s19, 24576
    s_nop 0
    buffer_load_dwordx4 v0, s[8:11], s21 offen lds
    s_add_u32 s21, s20, 0x1c8000
    s_add_u32 m0, s19, 25600
    s_nop 0
    buffer_load_dwordx4 v0, s[8:11], s21 offen lds
    s_add_u32 s21, s20, 0x1d0000
    s_add_u32 m0, s19, 26624
    s_nop 0
    buffer_load_dwordx4 v0, s[8:11], s21 offen lds
    s_add_u32 s21, s20, 0x1d8000
    s_add_u32 m0, s19, 27648
    s_nop 0
    buffer_load_dwordx4 v0, s[8:11], s21 offen lds
    s_add_u32 s21, s20, 0x1e0000
    s_add_u32 m0, s19, 28672
    s_nop 0
    buffer_load_dwordx4 v0, s[8:11], s21 offen lds
    s_add_u32 s21, s20, 0x1e8000
    s_add_u32 m0, s19, 29696
    s_nop 0
    buffer_load_dwordx4 v0, s[8:11], s21 offen lds
    s_add_u32 s21, s20, 0x1f0000
    s_add_u32 m0, s19, 30720
    s_nop 0
    buffer_load_dwordx4 v0, s[8:11], s21 offen lds
    s_add_u32 s21, s20, 0x1f8000
    s_add_u32 m0, s19, 31744
    s_nop 0
    buffer_load_dwordx4 v0, s[8:11], s21 offen lds
    s_waitcnt vmcnt(24)
    ds_read_b64_tr_b16 a[64:65], v1 offset:0
    ds_read_b64_tr_b16 a[66:67], v1 offset:1024
    ds_read_b64_tr_b16 a[192:193], v1 offset:32
    ds_read_b64_tr_b16 a[194:195], v1 offset:1056
    ds_read_b64_tr_b16 a[68:69], v1 offset:2048
    ds_read_b64_tr_b16 a[70:71], v1 offset:3072
    ds_read_b64_tr_b16 a[196:197], v1 offset:2080
    ds_read_b64_tr_b16 a[198:199], v1 offset:3104
    ds_read_b64_tr_b16 a[72:73], v1 offset:4096
    ds_read_b64_tr_b16 a[74:75], v1 offset:5120
    ds_read_b64_tr_b16 a[200:201], v1 offset:4128
    ds_read_b64_tr_b16 a[202:203], v1 offset:5152
    ds_read_b64_tr_b16 a[76:77], v1 offset:6144
    ds_read_b64_tr_b16 a[78:79], v1 offset:7168
    ds_read_b64_tr_b16 a[204:205], v1 offset:6176
    ds_read_b64_tr_b16 a[206:207], v1 offset:7200
    s_waitcnt lgkmcnt(0)
    s_waitcnt vmcnt(16)
    ds_read_b64_tr_b16 a[80:81], v1 offset:8192
    ds_read_b64_tr_b16 a[82:83], v1 offset:9216
    ds_read_b64_tr_b16 a[208:209], v1 offset:8224
    ds_read_b64_tr_b16 a[210:211], v1 offset:9248
    ds_read_b64_tr_b16 a[84:85], v1 offset:10240
    ds_read_b64_tr_b16 a[86:87], v1 offset:11264
    ds_read_b64_tr_b16 a[212:213], v1 offset:10272
    ds_read_b64_tr_b16 a[214:215], v1 offset:11296
    ds_read_b64_tr_b16 a[88:89], v1 offset:12288
    ds_read_b64_tr_b16 a[90:91], v1 offset:13312
    ds_read_b64_tr_b16 a[216:217], v1 offset:12320
    ds_read_b64_tr_b16 a[218:219], v1 offset:13344
    ds_read_b64_tr_b16 a[92:93], v1 offset:14336
    ds_read_b64_tr_b16 a[94:95], v1 offset:15360
    ds_read_b64_tr_b16 a[220:221], v1 offset:14368
    ds_read_b64_tr_b16 a[222:223], v1 offset:15392
    s_waitcnt lgkmcnt(0)
    s_waitcnt vmcnt(8)
    ds_read_b64_tr_b16 a[96:97], v1 offset:16384
    ds_read_b64_tr_b16 a[98:99], v1 offset:17408
    ds_read_b64_tr_b16 a[224:225], v1 offset:16416
    ds_read_b64_tr_b16 a[226:227], v1 offset:17440
    ds_read_b64_tr_b16 a[100:101], v1 offset:18432
    ds_read_b64_tr_b16 a[102:103], v1 offset:19456
    ds_read_b64_tr_b16 a[228:229], v1 offset:18464
    ds_read_b64_tr_b16 a[230:231], v1 offset:19488
    ds_read_b64_tr_b16 a[104:105], v1 offset:20480
    ds_read_b64_tr_b16 a[106:107], v1 offset:21504
    ds_read_b64_tr_b16 a[232:233], v1 offset:20512
    ds_read_b64_tr_b16 a[234:235], v1 offset:21536
    ds_read_b64_tr_b16 a[108:109], v1 offset:22528
    ds_read_b64_tr_b16 a[110:111], v1 offset:23552
    ds_read_b64_tr_b16 a[236:237], v1 offset:22560
    ds_read_b64_tr_b16 a[238:239], v1 offset:23584
    s_waitcnt lgkmcnt(0)
    s_waitcnt vmcnt(0)
    ds_read_b64_tr_b16 a[112:113], v1 offset:24576
    ds_read_b64_tr_b16 a[114:115], v1 offset:25600
    ds_read_b64_tr_b16 a[240:241], v1 offset:24608
    ds_read_b64_tr_b16 a[242:243], v1 offset:25632
    ds_read_b64_tr_b16 a[116:117], v1 offset:26624
    ds_read_b64_tr_b16 a[118:119], v1 offset:27648
    ds_read_b64_tr_b16 a[244:245], v1 offset:26656
    ds_read_b64_tr_b16 a[246:247], v1 offset:27680
    ds_read_b64_tr_b16 a[120:121], v1 offset:28672
    ds_read_b64_tr_b16 a[122:123], v1 offset:29696
    ds_read_b64_tr_b16 a[248:249], v1 offset:28704
    ds_read_b64_tr_b16 a[250:251], v1 offset:29728
    ds_read_b64_tr_b16 a[124:125], v1 offset:30720
    ds_read_b64_tr_b16 a[126:127], v1 offset:31744
    ds_read_b64_tr_b16 a[252:253], v1 offset:30752
    ds_read_b64_tr_b16 a[254:255], v1 offset:31776
    s_waitcnt lgkmcnt(0)
    s_cmp_lt_u32 s12, 5
    s_cbranch_scc1 main_kernel_o_top
    v_mul_u32_u24 v178, 2, v173
    v_sub_u32 v171, v172, v178
main_kernel_o_gp:
    buffer_load_dword v174, v171, s[4:7], 0 offen sc1
    s_waitcnt vmcnt(0)
    v_cmp_eq_u32 vcc, 0, v174
    s_cbranch_vccz main_kernel_o_top
    s_sleep 32
    s_sub_u32 s29, s29, 1
    s_cbranch_scc0 main_kernel_o_gp
    s_branch main_kernel_end
main_kernel_o_top:
    buffer_load_dword v174, v172, s[4:7], 0 offen sc1
    s_waitcnt vmcnt(0)
    v_cmp_eq_u32 vcc, 0, v174
    s_cbranch_vccz main_kernel_o_go
    s_sleep 1
    s_sub_u32 s29, s29, 1
    s_cbranch_scc0 main_kernel_o_top
    s_branch main_kernel_end
main_kernel_o_go:
    v_add_u32 v172, v172, v173
    buffer_load_dword v174, v172, s[4:7], 0 offen sc1
    buffer_load_dwordx4 v[0:3], v170, s[4:7], s15 offen offset:0 sc1
    buffer_load_dwordx4 v[4:7], v170, s[4:7], s15 offen offset:1024 sc1
    buffer_load_dwordx4 v[8:11], v170, s[4:7], s15 offen offset:2048 sc1
    buffer_load_dwordx4 v[12:15], v170, s[4:7], s15 offen offset:3072 sc1
    s_add_u32 s15, s15, 4096
    buffer_load_dwordx4 v[16:19], v170, s[4:7], s15 offen offset:0 sc1
    buffer_load_dwordx4 v[20:23], v170, s[4:7], s15 offen offset:1024 sc1
    buffer_load_dwordx4 v[24:27], v170, s[4:7], s15 offen offset:2048 sc1
    buffer_load_dwordx4 v[28:31], v170, s[4:7], s15 offen offset:3072 sc1
    s_add_u32 s15, s15, 4096
    buffer_load_dwordx4 v[32:35], v170, s[4:7], s15 offen offset:0 sc1
    buffer_load_dwordx4 v[36:39], v170, s[4:7], s15 offen offset:1024 sc1
    buffer_load_dwordx4 v[40:43], v170, s[4:7], s15 offen offset:2048 sc1
    buffer_load_dwordx4 v[44:47], v170, s[4:7], s15 offen offset:3072 sc1
    s_add_u32 s15, s15, 4096
    buffer_load_dwordx4 v[48:51], v170, s[4:7], s15 offen offset:0 sc1
    buffer_load_dwordx4 v[52:55], v170, s[4:7], s15 offen offset:1024 sc1
    buffer_load_dwordx4 v[56:59], v170, s[4:7], s15 offen offset:2048 sc1
    buffer_load_dwordx4 v[60:63], v170, s[4:7], s15 offen offset:3072 sc1
    s_add_u32 s15, s15, 4096
    buffer_load_dwordx4 v[64:67], v170, s[4:7], s15 offen offset:0 sc1
    buffer_load_dwordx4 v[68:71], v170, s[4:7], s15 offen offset:1024 sc1
    buffer_load_dwordx4 v[72:75], v170, s[4:7], s15 offen offset:2048 sc1
    buffer_load_dwordx4 v[76:79], v170, s[4:7], s15 offen offset:3072 sc1
    s_add_u32 s15, s15, 4096
    buffer_load_dwordx4 v[80:83], v170, s[4:7], s15 offen offset:0 sc1
    buffer_load_dwordx4 v[84:87], v170, s[4:7], s15 offen offset:1024 sc1
    buffer_load_dwordx4 v[88:91], v170, s[4:7], s15 offen offset:2048 sc1
    buffer_load_dwordx4 v[92:95], v170, s[4:7], s15 offen offset:3072 sc1
    s_add_u32 s15, s15, 4096
    buffer_load_dwordx4 v[96:99], v170, s[4:7], s15 offen offset:0 sc1
    buffer_load_dwordx4 v[100:103], v170, s[4:7], s15 offen offset:1024 sc1
    buffer_load_dwordx4 v[104:107], v170, s[4:7], s15 offen offset:2048 sc1
    buffer_load_dwordx4 v[108:111], v170, s[4:7], s15 offen offset:3072 sc1
    s_add_u32 s15, s15, 4096
    buffer_load_dwordx4 v[112:115], v170, s[4:7], s15 offen offset:0 sc1
    buffer_load_dwordx4 v[116:119], v170, s[4:7], s15 offen offset:1024 sc1
    buffer_load_dwordx4 v[120:123], v170, s[4:7], s15 offen offset:2048 sc1
    buffer_load_dwordx4 v[124:127], v170, s[4:7], s15 offen offset:3072 sc1
    s_add_u32 s15, s15, 233472
main_kernel_o_x:
    buffer_load_dwordx2 v[160:161], v175, s[96:99], s16 offen
    buffer_load_dwordx2 v[162:163], v170, s[4:7], s17 offen sc1
    s_add_u32 s17, s17, 65536
    s_add_u32 s18, s18, 1
    s_mov_b32 s39, 0
    s_waitcnt vmcnt(34)
    v_cmp_eq_u32 vcc, 0, v174
    s_cmp_le_u32 s18, 62
    s_cbranch_scc0 main_kernel_o_n
    s_cbranch_vccnz main_kernel_o_n
    s_mov_b32 s39, 1
    v_add_u32 v172, v172, v173
    buffer_load_dword v174, v172, s[4:7], 0 offen sc1
    s_waitcnt vmcnt(34)
    v_mfma_f32_16x16x32_bf16 v[128:131], a[0:3], v[0:3], 0
    v_mfma_f32_16x16x32_bf16 v[132:135], a[128:131], v[0:3], 0
    buffer_load_dwordx4 v[0:3], v170, s[4:7], s15 offen offset:0 sc1
    s_waitcnt vmcnt(34)
    v_mfma_f32_16x16x32_bf16 v[128:131], a[4:7], v[4:7], v[128:131]
    v_mfma_f32_16x16x32_bf16 v[132:135], a[132:135], v[4:7], v[132:135]
    buffer_load_dwordx4 v[4:7], v170, s[4:7], s15 offen offset:1024 sc1
    s_waitcnt vmcnt(34)
    v_mfma_f32_16x16x32_bf16 v[128:131], a[8:11], v[8:11], v[128:131]
    v_mfma_f32_16x16x32_bf16 v[132:135], a[136:139], v[8:11], v[132:135]
    buffer_load_dwordx4 v[8:11], v170, s[4:7], s15 offen offset:2048 sc1
    s_waitcnt vmcnt(34)
    v_mfma_f32_16x16x32_bf16 v[128:131], a[12:15], v[12:15], v[128:131]
    v_mfma_f32_16x16x32_bf16 v[132:135], a[140:143], v[12:15], v[132:135]
    buffer_load_dwordx4 v[12:15], v170, s[4:7], s15 offen offset:3072 sc1
    s_add_u32 s15, s15, 4096
    s_waitcnt vmcnt(34)
    v_mfma_f32_16x16x32_bf16 v[128:131], a[16:19], v[16:19], v[128:131]
    v_mfma_f32_16x16x32_bf16 v[132:135], a[144:147], v[16:19], v[132:135]
    buffer_load_dwordx4 v[16:19], v170, s[4:7], s15 offen offset:0 sc1
    s_waitcnt vmcnt(34)
    v_mfma_f32_16x16x32_bf16 v[128:131], a[20:23], v[20:23], v[128:131]
    v_mfma_f32_16x16x32_bf16 v[132:135], a[148:151], v[20:23], v[132:135]
    buffer_load_dwordx4 v[20:23], v170, s[4:7], s15 offen offset:1024 sc1
    s_waitcnt vmcnt(34)
    v_mfma_f32_16x16x32_bf16 v[128:131], a[24:27], v[24:27], v[128:131]
    v_mfma_f32_16x16x32_bf16 v[132:135], a[152:155], v[24:27], v[132:135]
    buffer_load_dwordx4 v[24:27], v170, s[4:7], s15 offen offset:2048 sc1
    s_waitcnt vmcnt(34)
    v_mfma_f32_16x16x32_bf16 v[128:131], a[28:31], v[28:31], v[128:131]
    v_mfma_f32_16x16x32_bf16 v[132:135], a[156:159], v[28:31], v[132:135]
    buffer_load_dwordx4 v[28:31], v170, s[4:7], s15 offen offset:3072 sc1
    s_add_u32 s15, s15, 4096
    s_waitcnt vmcnt(34)
    v_mfma_f32_16x16x32_bf16 v[128:131], a[32:35], v[32:35], v[128:131]
    v_mfma_f32_16x16x32_bf16 v[132:135], a[160:163], v[32:35], v[132:135]
    buffer_load_dwordx4 v[32:35], v170, s[4:7], s15 offen offset:0 sc1
    s_waitcnt vmcnt(34)
    v_mfma_f32_16x16x32_bf16 v[128:131], a[36:39], v[36:39], v[128:131]
    v_mfma_f32_16x16x32_bf16 v[132:135], a[164:167], v[36:39], v[132:135]
    buffer_load_dwordx4 v[36:39], v170, s[4:7], s15 offen offset:1024 sc1
    s_waitcnt vmcnt(34)
    v_mfma_f32_16x16x32_bf16 v[128:131], a[40:43], v[40:43], v[128:131]
    v_mfma_f32_16x16x32_bf16 v[132:135], a[168:171], v[40:43], v[132:135]
    buffer_load_dwordx4 v[40:43], v170, s[4:7], s15 offen offset:2048 sc1
    s_waitcnt vmcnt(34)
    v_mfma_f32_16x16x32_bf16 v[128:131], a[44:47], v[44:47], v[128:131]
    v_mfma_f32_16x16x32_bf16 v[132:135], a[172:175], v[44:47], v[132:135]
    buffer_load_dwordx4 v[44:47], v170, s[4:7], s15 offen offset:3072 sc1
    s_add_u32 s15, s15, 4096
    s_waitcnt vmcnt(34)
    v_mfma_f32_16x16x32_bf16 v[128:131], a[48:51], v[48:51], v[128:131]
    v_mfma_f32_16x16x32_bf16 v[132:135], a[176:179], v[48:51], v[132:135]
    buffer_load_dwordx4 v[48:51], v170, s[4:7], s15 offen offset:0 sc1
    s_waitcnt vmcnt(34)
    v_mfma_f32_16x16x32_bf16 v[128:131], a[52:55], v[52:55], v[128:131]
    v_mfma_f32_16x16x32_bf16 v[132:135], a[180:183], v[52:55], v[132:135]
    buffer_load_dwordx4 v[52:55], v170, s[4:7], s15 offen offset:1024 sc1
    s_waitcnt vmcnt(34)
    v_mfma_f32_16x16x32_bf16 v[128:131], a[56:59], v[56:59], v[128:131]
    v_mfma_f32_16x16x32_bf16 v[132:135], a[184:187], v[56:59], v[132:135]
    buffer_load_dwordx4 v[56:59], v170, s[4:7], s15 offen offset:2048 sc1
    s_waitcnt vmcnt(34)
    v_mfma_f32_16x16x32_bf16 v[128:131], a[60:63], v[60:63], v[128:131]
    v_mfma_f32_16x16x32_bf16 v[132:135], a[188:191], v[60:63], v[132:135]
    buffer_load_dwordx4 v[60:63], v170, s[4:7], s15 offen offset:3072 sc1
    s_add_u32 s15, s15, 4096
    s_waitcnt vmcnt(34)
    v_mfma_f32_16x16x32_bf16 v[128:131], a[64:67], v[64:67], v[128:131]
    v_mfma_f32_16x16x32_bf16 v[132:135], a[192:195], v[64:67], v[132:135]
    buffer_load_dwordx4 v[64:67], v170, s[4:7], s15 offen offset:0 sc1
    s_waitcnt vmcnt(34)
    v_mfma_f32_16x16x32_bf16 v[128:131], a[68:71], v[68:71], v[128:131]
    v_mfma_f32_16x16x32_bf16 v[132:135], a[196:199], v[68:71], v[132:135]
    buffer_load_dwordx4 v[68:71], v170, s[4:7], s15 offen offset:1024 sc1
    s_waitcnt vmcnt(34)
    v_mfma_f32_16x16x32_bf16 v[128:131], a[72:75], v[72:75], v[128:131]
    v_mfma_f32_16x16x32_bf16 v[132:135], a[200:203], v[72:75], v[132:135]
    buffer_load_dwordx4 v[72:75], v170, s[4:7], s15 offen offset:2048 sc1
    s_waitcnt vmcnt(34)
    v_mfma_f32_16x16x32_bf16 v[128:131], a[76:79], v[76:79], v[128:131]
    v_mfma_f32_16x16x32_bf16 v[132:135], a[204:207], v[76:79], v[132:135]
    buffer_load_dwordx4 v[76:79], v170, s[4:7], s15 offen offset:3072 sc1
    s_add_u32 s15, s15, 4096
    s_waitcnt vmcnt(34)
    v_mfma_f32_16x16x32_bf16 v[128:131], a[80:83], v[80:83], v[128:131]
    v_mfma_f32_16x16x32_bf16 v[132:135], a[208:211], v[80:83], v[132:135]
    buffer_load_dwordx4 v[80:83], v170, s[4:7], s15 offen offset:0 sc1
    s_waitcnt vmcnt(34)
    v_mfma_f32_16x16x32_bf16 v[128:131], a[84:87], v[84:87], v[128:131]
    v_mfma_f32_16x16x32_bf16 v[132:135], a[212:215], v[84:87], v[132:135]
    buffer_load_dwordx4 v[84:87], v170, s[4:7], s15 offen offset:1024 sc1
    s_waitcnt vmcnt(34)
    v_mfma_f32_16x16x32_bf16 v[128:131], a[88:91], v[88:91], v[128:131]
    v_mfma_f32_16x16x32_bf16 v[132:135], a[216:219], v[88:91], v[132:135]
    buffer_load_dwordx4 v[88:91], v170, s[4:7], s15 offen offset:2048 sc1
    s_waitcnt vmcnt(34)
    v_mfma_f32_16x16x32_bf16 v[128:131], a[92:95], v[92:95], v[128:131]
    v_mfma_f32_16x16x32_bf16 v[132:135], a[220:223], v[92:95], v[132:135]
    buffer_load_dwordx4 v[92:95], v170, s[4:7], s15 offen offset:3072 sc1
    s_add_u32 s15, s15, 4096
    s_waitcnt vmcnt(34)
    v_mfma_f32_16x16x32_bf16 v[128:131], a[96:99], v[96:99], v[128:131]
    v_mfma_f32_16x16x32_bf16 v[132:135], a[224:227], v[96:99], v[132:135]
    buffer_load_dwordx4 v[96:99], v170, s[4:7], s15 offen offset:0 sc1
    s_waitcnt vmcnt(34)
    v_mfma_f32_16x16x32_bf16 v[128:131], a[100:103], v[100:103], v[128:131]
    v_mfma_f32_16x16x32_bf16 v[132:135], a[228:231], v[100:103], v[132:135]
    buffer_load_dwordx4 v[100:103], v170, s[4:7], s15 offen offset:1024 sc1
    s_waitcnt vmcnt(34)
    v_mfma_f32_16x16x32_bf16 v[128:131], a[104:107], v[104:107], v[128:131]
    v_mfma_f32_16x16x32_bf16 v[132:135], a[232:235], v[104:107], v[132:135]
    buffer_load_dwordx4 v[104:107], v170, s[4:7], s15 offen offset:2048 sc1
    s_waitcnt vmcnt(34)
    v_mfma_f32_16x16x32_bf16 v[128:131], a[108:111], v[108:111], v[128:131]
    v_mfma_f32_16x16x32_bf16 v[132:135], a[236:239], v[108:111], v[132:135]
    buffer_load_dwordx4 v[108:111], v170, s[4:7], s15 offen offset:3072 sc1
    s_add_u32 s15, s15, 4096
    s_waitcnt vmcnt(34)
    v_mfma_f32_16x16x32_bf16 v[128:131], a[112:115], v[112:115], v[128:131]
    v_mfma_f32_16x16x32_bf16 v[132:135], a[240:243], v[112:115], v[132:135]
    buffer_load_dwordx4 v[112:115], v170, s[4:7], s15 offen offset:0 sc1
    s_waitcnt vmcnt(34)
    v_mfma_f32_16x16x32_bf16 v[128:131], a[116:119], v[116:119], v[128:131]
    v_mfma_f32_16x16x32_bf16 v[132:135], a[244:247], v[116:119], v[132:135]
    buffer_load_dwordx4 v[116:119], v170, s[4:7], s15 offen offset:1024 sc1
    s_waitcnt vmcnt(34)
    v_mfma_f32_16x16x32_bf16 v[128:131], a[120:123], v[120:123], v[128:131]
    v_mfma_f32_16x16x32_bf16 v[132:135], a[248:251], v[120:123], v[132:135]
    buffer_load_dwordx4 v[120:123], v170, s[4:7], s15 offen offset:2048 sc1
    s_waitcnt vmcnt(34)
    v_mfma_f32_16x16x32_bf16 v[128:131], a[124:127], v[124:127], v[128:131]
    v_mfma_f32_16x16x32_bf16 v[132:135], a[252:255], v[124:127], v[132:135]
    buffer_load_dwordx4 v[124:127], v170, s[4:7], s15 offen offset:3072 sc1
    s_add_u32 s15, s15, 233472
    s_waitcnt vmcnt(33)
    s_branch main_kernel_o_e
main_kernel_o_n:
    buffer_load_dword v174, v172, s[4:7], 0 offen sc1
    s_waitcnt vmcnt(34)
    v_mfma_f32_16x16x32_bf16 v[128:131], a[0:3], v[0:3], 0
    v_mfma_f32_16x16x32_bf16 v[132:135], a[128:131], v[0:3], 0
    s_waitcnt vmcnt(33)
    v_mfma_f32_16x16x32_bf16 v[128:131], a[4:7], v[4:7], v[128:131]
    v_mfma_f32_16x16x32_bf16 v[132:135], a[132:135], v[4:7], v[132:135]
    s_waitcnt vmcnt(32)
    v_mfma_f32_16x16x32_bf16 v[128:131], a[8:11], v[8:11], v[128:131]
    v_mfma_f32_16x16x32_bf16 v[132:135], a[136:139], v[8:11], v[132:135]
    s_waitcnt vmcnt(31)
    v_mfma_f32_16x16x32_bf16 v[128:131], a[12:15], v[12:15], v[128:131]
    v_mfma_f32_16x16x32_bf16 v[132:135], a[140:143], v[12:15], v[132:135]
    s_waitcnt vmcnt(30)
    v_mfma_f32_16x16x32_bf16 v[128:131], a[16:19], v[16:19], v[128:131]
    v_mfma_f32_16x16x32_bf16 v[132:135], a[144:147], v[16:19], v[132:135]
    s_waitcnt vmcnt(29)
    v_mfma_f32_16x16x32_bf16 v[128:131], a[20:23], v[20:23], v[128:131]
    v_mfma_f32_16x16x32_bf16 v[132:135], a[148:151], v[20:23], v[132:135]
    s_waitcnt vmcnt(28)
    v_mfma_f32_16x16x32_bf16 v[128:131], a[24:27], v[24:27], v[128:131]
    v_mfma_f32_16x16x32_bf16 v[132:135], a[152:155], v[24:27], v[132:135]
    s_waitcnt vmcnt(27)
    v_mfma_f32_16x16x32_bf16 v[128:131], a[28:31], v[28:31], v[128:131]
    v_mfma_f32_16x16x32_bf16 v[132:135], a[156:159], v[28:31], v[132:135]
    s_waitcnt vmcnt(26)
    v_mfma_f32_16x16x32_bf16 v[128:131], a[32:35], v[32:35], v[128:131]
    v_mfma_f32_16x16x32_bf16 v[132:135], a[160:163], v[32:35], v[132:135]
    s_waitcnt vmcnt(25)
    v_mfma_f32_16x16x32_bf16 v[128:131], a[36:39], v[36:39], v[128:131]
    v_mfma_f32_16x16x32_bf16 v[132:135], a[164:167], v[36:39], v[132:135]
    s_waitcnt vmcnt(24)
    v_mfma_f32_16x16x32_bf16 v[128:131], a[40:43], v[40:43], v[128:131]
    v_mfma_f32_16x16x32_bf16 v[132:135], a[168:171], v[40:43], v[132:135]
    s_waitcnt vmcnt(23)
    v_mfma_f32_16x16x32_bf16 v[128:131], a[44:47], v[44:47], v[128:131]
    v_mfma_f32_16x16x32_bf16 v[132:135], a[172:175], v[44:47], v[132:135]
    s_waitcnt vmcnt(22)
    v_mfma_f32_16x16x32_bf16 v[128:131], a[48:51], v[48:51], v[128:131]
    v_mfma_f32_16x16x32_bf16 v[132:135], a[176:179], v[48:51], v[132:135]
    s_waitcnt vmcnt(21)
    v_mfma_f32_16x16x32_bf16 v[128:131], a[52:55], v[52:55], v[128:131]
    v_mfma_f32_16x16x32_bf16 v[132:135], a[180:183], v[52:55], v[132:135]
    s_waitcnt vmcnt(20)
    v_mfma_f32_16x16x32_bf16 v[128:131], a[56:59], v[56:59], v[128:131]
    v_mfma_f32_16x16x32_bf16 v[132:135], a[184:187], v[56:59], v[132:135]
    s_waitcnt vmcnt(19)
    v_mfma_f32_16x16x32_bf16 v[128:131], a[60:63], v[60:63], v[128:131]
    v_mfma_f32_16x16x32_bf16 v[132:135], a[188:191], v[60:63], v[132:135]
    s_waitcnt vmcnt(18)
    v_mfma_f32_16x16x32_bf16 v[128:131], a[64:67], v[64:67], v[128:131]
    v_mfma_f32_16x16x32_bf16 v[132:135], a[192:195], v[64:67], v[132:135]
    s_waitcnt vmcnt(17)
    v_mfma_f32_16x16x32_bf16 v[128:131], a[68:71], v[68:71], v[128:131]
    v_mfma_f32_16x16x32_bf16 v[132:135], a[196:199], v[68:71], v[132:135]
    s_waitcnt vmcnt(16)
    v_mfma_f32_16x16x32_bf16 v[128:131], a[72:75], v[72:75], v[128:131]
    v_mfma_f32_16x16x32_bf16 v[132:135], a[200:203], v[72:75], v[132:135]
    s_waitcnt vmcnt(15)
    v_mfma_f32_16x16x32_bf16 v[128:131], a[76:79], v[76:79], v[128:131]
    v_mfma_f32_16x16x32_bf16 v[132:135], a[204:207], v[76:79], v[132:135]
    s_waitcnt vmcnt(14)
    v_mfma_f32_16x16x32_bf16 v[128:131], a[80:83], v[80:83], v[128:131]
    v_mfma_f32_16x16x32_bf16 v[132:135], a[208:211], v[80:83], v[132:135]
    s_waitcnt vmcnt(13)
    v_mfma_f32_16x16x32_bf16 v[128:131], a[84:87], v[84:87], v[128:131]
    v_mfma_f32_16x16x32_bf16 v[132:135], a[212:215], v[84:87], v[132:135]
    s_waitcnt vmcnt(12)
    v_mfma_f32_16x16x32_bf16 v[128:131], a[88:91], v[88:91], v[128:131]
    v_mfma_f32_16x16x32_bf16 v[132:135], a[216:219], v[88:91], v[132:135]
    s_waitcnt vmcnt(11)
    v_mfma_f32_16x16x32_bf16 v[128:131], a[92:95], v[92:95], v[128:131]
    v_mfma_f32_16x16x32_bf16 v[132:135], a[220:223], v[92:95], v[132:135]
    s_waitcnt vmcnt(10)
    v_mfma_f32_16x16x32_bf16 v[128:131], a[96:99], v[96:99], v[128:131]
    v_mfma_f32_16x16x32_bf16 v[132:135], a[224:227], v[96:99], v[132:135]
    s_waitcnt vmcnt(9)
    v_mfma_f32_16x16x32_bf16 v[128:131], a[100:103], v[100:103], v[128:131]
    v_mfma_f32_16x16x32_bf16 v[132:135], a[228:231], v[100:103], v[132:135]
    s_waitcnt vmcnt(8)
    v_mfma_f32_16x16x32_bf16 v[128:131], a[104:107], v[104:107], v[128:131]
    v_mfma_f32_16x16x32_bf16 v[132:135], a[232:235], v[104:107], v[132:135]
    s_waitcnt vmcnt(7)
    v_mfma_f32_16x16x32_bf16 v[128:131], a[108:111], v[108:111], v[128:131]
    v_mfma_f32_16x16x32_bf16 v[132:135], a[236:239], v[108:111], v[132:135]
    s_waitcnt vmcnt(6)
    v_mfma_f32_16x16x32_bf16 v[128:131], a[112:115], v[112:115], v[128:131]
    v_mfma_f32_16x16x32_bf16 v[132:135], a[240:243], v[112:115], v[132:135]
    s_waitcnt vmcnt(5)
    v_mfma_f32_16x16x32_bf16 v[128:131], a[116:119], v[116:119], v[128:131]
    v_mfma_f32_16x16x32_bf16 v[132:135], a[244:247], v[116:119], v[132:135]
    s_waitcnt vmcnt(4)
    v_mfma_f32_16x16x32_bf16 v[128:131], a[120:123], v[120:123], v[128:131]
    v_mfma_f32_16x16x32_bf16 v[132:135], a[248:251], v[120:123], v[132:135]
    s_waitcnt vmcnt(3)
    v_mfma_f32_16x16x32_bf16 v[128:131], a[124:127], v[124:127], v[128:131]
    v_mfma_f32_16x16x32_bf16 v[132:135], a[252:255], v[124:127], v[132:135]
    s_waitcnt vmcnt(0)
    v_cmp_eq_u32 vcc, 0, v174
main_kernel_o_e:
    v_lshlrev_b32 v164, 16, v160
    v_and_b32 v165, 0xffff0000, v160
    v_lshlrev_b32 v166, 16, v161
    v_and_b32 v167, 0xffff0000, v161
    v_lshlrev_b32 v160, 16, v162
    v_and_b32 v161, 0xffff0000, v162
    v_lshlrev_b32 v162, 16, v163
    v_and_b32 v163, 0xffff0000, v163
    s_cmp_ge_u32 s14, 2
    ds_write_b128 v176, v[128:131] offset:0
    ds_write_b128 v176, v[132:135] offset:1024
    v_xor_b32 v176, 0x4000, v176
    s_waitcnt lgkmcnt(0)
    s_barrier
    s_cbranch_scc1 main_kernel_o_nx
    ds_read_b128 v[144:147], v177 offset:0
    ds_read_b128 v[148:151], v177 offset:2048
    ds_read_b128 v[152:155], v177 offset:4096
    ds_read_b128 v[156:159], v177 offset:6144
    v_xor_b32 v177, 0x4000, v177
    s_waitcnt lgkmcnt(2)
    v_pk_add_f32 v[144:145], v[144:145], v[148:149]
    v_pk_add_f32 v[146:147], v[146:147], v[150:151]
    s_waitcnt lgkmcnt(0)
    v_pk_add_f32 v[152:153], v[152:153], v[156:157]
    v_pk_add_f32 v[154:155], v[154:155], v[158:159]
    v_pk_add_f32 v[144:145], v[144:145], v[152:153]
    v_pk_add_f32 v[146:147], v[146:147], v[154:155]
    v_pk_fma_f32 v[144:145], v[144:145], v[160:161], v[164:165]
    v_pk_fma_f32 v[146:147], v[146:147], v[162:163], v[166:167]
    v_cvt_pk_bf16_f32 v148, v144, v145
    v_cvt_pk_bf16_f32 v149, v146, v147
    buffer_store_dwordx2 v[148:149], v175, s[92:95], s16 offen
main_kernel_o_nx:
    s_add_u32 s16, s16, 65536
    s_cmp_lg_u32 s39, 0
    s_cbranch_scc1 main_kernel_o_x
    s_cmp_le_u32 s18, 62
    s_cbranch_scc0 main_kernel_o_sk
    s_cbranch_vccz main_kernel_o_go
    s_branch main_kernel_o_top
main_kernel_o_sk:
    v_add_u32 v172, v172, v173
    s_add_u32 s17, s17, 65536
    s_add_u32 s16, s16, 65536
    s_add_u32 s15, s15, 262144
    s_add_u32 s18, s18, 1
    s_cmp_lt_u32 s18, 64
    s_cbranch_scc1 main_kernel_o_top
    s_branch main_kernel_end
main_kernel_end2:
    s_endpgm
main_kernel_worker:
    v_lshlrev_b32 v251, 4, v250
    v_mov_b32 v240, 0xc0135761
    v_mov_b32 v241, 0xc0135761
    v_mov_b32 v242, 0xbdd2d3e8
    v_mov_b32 v243, 0xbdd2d3e8
    v_mov_b32 v244, 0x3f800000
    v_mov_b32 v245, 0x3f800000
    v_mov_b32 v246, 0xbfb8aa3b
    v_mov_b32 v247, 0xbfb8aa3b
    s_lshr_b32 s37, s14, 1
    s_and_b32 s38, s14, 1
    v_mov_b32 v252, 0
    s_mov_b32 s8, s40
    s_and_b32 s9, s41, 0xffff
    s_mov_b32 s10, 0x0
    s_mov_b32 s11, 0x20000
    s_mov_b32 s57, 0
    s_mov_b32 s56, 0x7f000000
    v_mov_b32 v249, 0
main_kernel_w_next:
    s_cmp_lg_u32 s14, 0
    s_cbranch_scc1 main_kernel_w_bar
main_kernel_w_try:
    s_lshl_b32 s32, s27, 8
    s_add_u32 s32, s32, 0x841e000
    v_mov_b32 v254, 1
    s_mov_b64 exec, 1
    buffer_atomic_add v254, off, s[4:7], s32 sc0 sc1
    s_mov_b64 exec, -1
    s_waitcnt vmcnt(0)
    v_readfirstlane_b32 s28, v254
    s_cmp_eq_u32 s57, 0
    s_cbranch_scc1 main_kernel_w_fl1
    s_waitcnt vmcnt(0)
    s_barrier
    v_mov_b32 v4, 1
    v_mov_b32 v5, 1
    v_mov_b32 v6, 1
    v_mov_b32 v7, 1
    s_bfm_b64 exec, s57, 0
    buffer_store_dwordx4 v[4:7], v249, s[4:7], s56 offen sc1
    s_mov_b64 exec, -1
    s_mov_b32 s57, 0
main_kernel_w_fl1:
    s_nop 3
main_kernel_w_have:
    s_cmp_lg_u32 s27, 0
    s_cbranch_scc1 main_kernel_w_q1
    s_cmp_lt_u32 s28, 120
    s_cbranch_scc0 main_kernel_w_d_1
    s_cmp_lt_u32 s28, 48
    s_cbranch_scc0 main_kernel_w_d_2
    s_cmp_lt_u32 s28, 24
    s_cbranch_scc0 main_kernel_w_d_3
    s_cmp_lt_u32 s28, 8
    s_cbranch_scc0 main_kernel_w_d_4
    s_mov_b32 s36, 0x4005800
    s_branch main_kernel_w_dec
main_kernel_w_d_4:
    s_mov_b32 s36, 0x8085008
    s_branch main_kernel_w_dec
main_kernel_w_d_3:
    s_cmp_lt_u32 s28, 32
    s_cbranch_scc0 main_kernel_w_d_5
    s_mov_b32 s36, 0x64090818
    s_branch main_kernel_w_dec
main_kernel_w_d_5:
    s_mov_b32 s36, 0x48109820
    s_branch main_kernel_w_dec
main_kernel_w_d_2:
    s_cmp_lt_u32 s28, 72
    s_cbranch_scc0 main_kernel_w_d_6
    s_cmp_lt_u32 s28, 64
    s_cbranch_scc0 main_kernel_w_d_7
    s_mov_b32 s36, 0x8105030
    s_branch main_kernel_w_dec
main_kernel_w_d_7:
    s_mov_b32 s36, 0x65191040
    s_branch main_kernel_w_dec
main_kernel_w_d_6:
    s_cmp_lt_u32 s28, 88
    s_cbranch_scc0 main_kernel_w_d_8
    s_mov_b32 s36, 0x44008048
    s_branch main_kernel_w_dec
main_kernel_w_d_8:
    s_cmp_lt_u32 s28, 104
    s_cbranch_scc0 main_kernel_w_d_9
    s_mov_b32 s36, 0x41c2058
    s_branch main_kernel_w_dec
main_kernel_w_d_9:
    s_mov_b32 s36, 0x46048068
    s_branch main_kernel_w_dec
main_kernel_w_d_1:
    s_cmp_lt_u32 s28, 184
    s_cbranch_scc0 main_kernel_w_d_10
    s_cmp_lt_u32 s28, 152
    s_cbranch_scc0 main_kernel_w_d_11
    s_cmp_lt_u32 s28, 136
    s_cbranch_scc0 main_kernel_w_d_12
    s_mov_b32 s36, 0x4082078
    s_branch main_kernel_w_dec
main_kernel_w_d_12:
    s_mov_b32 s36, 0x8002888
    s_branch main_kernel_w_dec
main_kernel_w_d_11:
    s_cmp_lt_u32 s28, 160
    s_cbranch_scc0 main_kernel_w_d_13
    s_mov_b32 s36, 0x64013098
    s_branch main_kernel_w_dec
main_kernel_w_d_13:
    s_cmp_lt_u32 s28, 176
    s_cbranch_scc0 main_kernel_w_d_14
    s_mov_b32 s36, 0x4b1080a0
    s_branch main_kernel_w_dec
main_kernel_w_d_14:
    s_mov_b32 s36, 0x641130b0
    s_branch main_kernel_w_dec
main_kernel_w_d_10:
    s_cmp_lt_u32 s28, 208
    s_cbranch_scc0 main_kernel_w_d_15
    s_cmp_lt_u32 s28, 200
    s_cbranch_scc0 main_kernel_w_d_16
    s_mov_b32 s36, 0x4918b0b8
    s_branch main_kernel_w_dec
main_kernel_w_d_16:
    s_mov_b32 s36, 0x661908c8
    s_branch main_kernel_w_dec
main_kernel_w_d_15:
    s_cmp_lt_u32 s28, 224
    s_cbranch_scc0 main_kernel_w_d_17
    s_mov_b32 s36, 0x89038d0
    s_branch main_kernel_w_dec
main_kernel_w_d_17:
    s_cmp_lt_u32 s28, 232
    s_cbranch_scc0 main_kernel_w_d_18
    s_mov_b32 s36, 0x641900e0
    s_branch main_kernel_w_dec
main_kernel_w_d_18:
    s_mov_b32 s36, 0xffffffff
    s_branch main_kernel_w_dec
main_kernel_w_q1:
    s_cmp_lg_u32 s27, 1
    s_cbranch_scc1 main_kernel_w_q2
    s_cmp_lt_u32 s28, 68
    s_cbranch_scc0 main_kernel_w_d_19
    s_cmp_lt_u32 s28, 20
    s_cbranch_scc0 main_kernel_w_d_20
    s_cmp_lt_u32 s28, 4
    s_cbranch_scc0 main_kernel_w_d_21
    s_mov_b32 s36, 0x25000
    s_branch main_kernel_w_dec
main_kernel_w_d_21:
    s_cmp_lt_u32 s28, 12
    s_cbranch_scc0 main_kernel_w_d_22
    s_mov_b32 s36, 0x42069004
    s_branch main_kernel_w_dec
main_kernel_w_d_22:
    s_mov_b32 s36, 0x6709100c
    s_branch main_kernel_w_dec
main_kernel_w_d_20:
    s_cmp_lt_u32 s28, 36
    s_cbranch_scc0 main_kernel_w_d_23
    s_mov_b32 s36, 0x46008014
    s_branch main_kernel_w_dec
main_kernel_w_d_23:
    s_cmp_lt_u32 s28, 52
    s_cbranch_scc0 main_kernel_w_d_24
    s_mov_b32 s36, 0x4042024
    s_branch main_kernel_w_dec
main_kernel_w_d_24:
    s_mov_b32 s36, 0x49088034
    s_branch main_kernel_w_dec
main_kernel_w_d_19:
    s_cmp_lt_u32 s28, 112
    s_cbranch_scc0 main_kernel_w_d_25
    s_cmp_lt_u32 s28, 80
    s_cbranch_scc0 main_kernel_w_d_26
    s_mov_b32 s36, 0x4a10b044
    s_branch main_kernel_w_dec
main_kernel_w_d_26:
    s_cmp_lt_u32 s28, 96
    s_cbranch_scc0 main_kernel_w_d_27
    s_mov_b32 s36, 0x4a108050
    s_branch main_kernel_w_dec
main_kernel_w_d_27:
    s_mov_b32 s36, 0x8083860
    s_branch main_kernel_w_dec
main_kernel_w_d_25:
    s_cmp_lt_u32 s28, 120
    s_cbranch_scc0 main_kernel_w_d_28
    s_mov_b32 s36, 0x124070
    s_branch main_kernel_w_dec
main_kernel_w_d_28:
    s_cmp_lt_u32 s28, 128
    s_cbranch_scc0 main_kernel_w_d_29
    s_mov_b32 s36, 0x144078
    s_branch main_kernel_w_dec
main_kernel_w_d_29:
    s_mov_b32 s36, 0xffffffff
    s_branch main_kernel_w_dec
main_kernel_w_q2:
    s_cmp_lg_u32 s27, 2
    s_cbranch_scc1 main_kernel_w_q3
    s_cmp_lt_u32 s28, 112
    s_cbranch_scc0 main_kernel_w_d_30
    s_cmp_lt_u32 s28, 32
    s_cbranch_scc0 main_kernel_w_d_31
    s_cmp_lt_u32 s28, 16
    s_cbranch_scc0 main_kernel_w_d_32
    s_cmp_lt_u32 s28, 8
    s_cbranch_scc0 main_kernel_w_d_33
    s_mov_b32 s36, 0x800
    s_branch main_kernel_w_dec
main_kernel_w_d_33:
    s_mov_b32 s36, 0x1008
    s_branch main_kernel_w_dec
main_kernel_w_d_32:
    s_cmp_lt_u32 s28, 24
    s_cbranch_scc0 main_kernel_w_d_34
    s_mov_b32 s36, 0x44028810
    s_branch main_kernel_w_dec
main_kernel_w_d_34:
    s_mov_b32 s36, 0x44029018
    s_branch main_kernel_w_dec
main_kernel_w_d_31:
    s_cmp_lt_u32 s28, 64
    s_cbranch_scc0 main_kernel_w_d_35
    s_cmp_lt_u32 s28, 48
    s_cbranch_scc0 main_kernel_w_d_36
    s_mov_b32 s36, 0x48189820
    s_branch main_kernel_w_dec
main_kernel_w_d_36:
    s_mov_b32 s36, 0x48009830
    s_branch main_kernel_w_dec
main_kernel_w_d_35:
    s_cmp_lt_u32 s28, 80
    s_cbranch_scc0 main_kernel_w_d_37
    s_mov_b32 s36, 0x4102040
    s_branch main_kernel_w_dec
main_kernel_w_d_37:
    s_cmp_lt_u32 s28, 96
    s_cbranch_scc0 main_kernel_w_d_38
    s_mov_b32 s36, 0x4a109050
    s_branch main_kernel_w_dec
main_kernel_w_d_38:
    s_mov_b32 s36, 0x40c2060
    s_branch main_kernel_w_dec
main_kernel_w_d_30:
    s_cmp_lt_u32 s28, 162
    s_cbranch_scc0 main_kernel_w_d_39
    s_cmp_lt_u32 s28, 136
    s_cbranch_scc0 main_kernel_w_d_40
    s_cmp_lt_u32 s28, 120
    s_cbranch_scc0 main_kernel_w_d_41
    s_mov_b32 s36, 0x67111070
    s_branch main_kernel_w_dec
main_kernel_w_d_41:
    s_mov_b32 s36, 0x49108078
    s_branch main_kernel_w_dec
main_kernel_w_d_40:
    s_cmp_lt_u32 s28, 144
    s_cbranch_scc0 main_kernel_w_d_42
    s_mov_b32 s36, 0x64111088
    s_branch main_kernel_w_dec
main_kernel_w_d_42:
    s_cmp_lt_u32 s28, 150
    s_cbranch_scc0 main_kernel_w_d_43
    s_mov_b32 s36, 0x66c13090
    s_branch main_kernel_w_dec
main_kernel_w_d_43:
    s_mov_b32 s36, 0x4ad0b096
    s_branch main_kernel_w_dec
main_kernel_w_d_39:
    s_cmp_lt_u32 s28, 190
    s_cbranch_scc0 main_kernel_w_d_44
    s_cmp_lt_u32 s28, 174
    s_cbranch_scc0 main_kernel_w_d_45
    s_mov_b32 s36, 0x4ad8b0a2
    s_branch main_kernel_w_dec
main_kernel_w_d_45:
    s_mov_b32 s36, 0x81038ae
    s_branch main_kernel_w_dec
main_kernel_w_d_44:
    s_cmp_lt_u32 s28, 198
    s_cbranch_scc0 main_kernel_w_d_46
    s_mov_b32 s36, 0x671900be
    s_branch main_kernel_w_dec
main_kernel_w_d_46:
    s_cmp_lt_u32 s28, 206
    s_cbranch_scc0 main_kernel_w_d_47
    s_mov_b32 s36, 0x661900c6
    s_branch main_kernel_w_dec
main_kernel_w_d_47:
    s_mov_b32 s36, 0xffffffff
    s_branch main_kernel_w_dec
main_kernel_w_q3:
    s_cmp_lg_u32 s27, 3
    s_cbranch_scc1 main_kernel_w_q4
    s_cmp_lt_u32 s28, 112
    s_cbranch_scc0 main_kernel_w_d_48
    s_cmp_lt_u32 s28, 48
    s_cbranch_scc0 main_kernel_w_d_49
    s_cmp_lt_u32 s28, 16
    s_cbranch_scc0 main_kernel_w_d_50
    s_cmp_lt_u32 s28, 8
    s_cbranch_scc0 main_kernel_w_d_51
    s_mov_b32 s36, 0x1000800
    s_branch main_kernel_w_dec
main_kernel_w_d_51:
    s_mov_b32 s36, 0x1001008
    s_branch main_kernel_w_dec
main_kernel_w_d_50:
    s_cmp_lt_u32 s28, 24
    s_cbranch_scc0 main_kernel_w_d_52
    s_mov_b32 s36, 0x45028810
    s_branch main_kernel_w_dec
main_kernel_w_d_52:
    s_cmp_lt_u32 s28, 32
    s_cbranch_scc0 main_kernel_w_d_53
    s_mov_b32 s36, 0x45029018
    s_branch main_kernel_w_dec
main_kernel_w_d_53:
    s_mov_b32 s36, 0x48089820
    s_branch main_kernel_w_dec
main_kernel_w_d_49:
    s_cmp_lt_u32 s28, 80
    s_cbranch_scc0 main_kernel_w_d_54
    s_cmp_lt_u32 s28, 56
    s_cbranch_scc0 main_kernel_w_d_55
    s_mov_b32 s36, 0x66090830
    s_branch main_kernel_w_dec
main_kernel_w_d_55:
    s_cmp_lt_u32 s28, 64
    s_cbranch_scc0 main_kernel_w_d_56
    s_mov_b32 s36, 0x40068838
    s_branch main_kernel_w_dec
main_kernel_w_d_56:
    s_mov_b32 s36, 0x4142040
    s_branch main_kernel_w_dec
main_kernel_w_d_54:
    s_cmp_lt_u32 s28, 88
    s_cbranch_scc0 main_kernel_w_d_57
    s_mov_b32 s36, 0x67110850
    s_branch main_kernel_w_dec
main_kernel_w_d_57:
    s_cmp_lt_u32 s28, 96
    s_cbranch_scc0 main_kernel_w_d_58
    s_mov_b32 s36, 0x64110858
    s_branch main_kernel_w_dec
main_kernel_w_d_58:
    s_mov_b32 s36, 0x44048060
    s_branch main_kernel_w_dec
main_kernel_w_d_48:
    s_cmp_lt_u32 s28, 168
    s_cbranch_scc0 main_kernel_w_d_59
    s_cmp_lt_u32 s28, 142
    s_cbranch_scc0 main_kernel_w_d_60
    s_cmp_lt_u32 s28, 120
    s_cbranch_scc0 main_kernel_w_d_61
    s_mov_b32 s36, 0x67191070
    s_branch main_kernel_w_dec
main_kernel_w_d_61:
    s_cmp_lt_u32 s28, 136
    s_cbranch_scc0 main_kernel_w_d_62
    s_mov_b32 s36, 0x8082878
    s_branch main_kernel_w_dec
main_kernel_w_d_62:
    s_mov_b32 s36, 0x66013088
    s_branch main_kernel_w_dec
main_kernel_w_d_60:
    s_cmp_lt_u32 s28, 148
    s_cbranch_scc0 main_kernel_w_d_63
    s_mov_b32 s36, 0x6609308e
    s_branch main_kernel_w_dec
main_kernel_w_d_63:
    s_cmp_lt_u32 s28, 156
    s_cbranch_scc0 main_kernel_w_d_64
    s_mov_b32 s36, 0x65093094
    s_branch main_kernel_w_dec
main_kernel_w_d_64:
    s_mov_b32 s36, 0x4ac8b09c
    s_branch main_kernel_w_dec
main_kernel_w_d_59:
    s_cmp_lt_u32 s28, 208
    s_cbranch_scc0 main_kernel_w_d_65
    s_cmp_lt_u32 s28, 184
    s_cbranch_scc0 main_kernel_w_d_66
    s_mov_b32 s36, 0x89838a8
    s_branch main_kernel_w_dec
main_kernel_w_d_66:
    s_cmp_lt_u32 s28, 200
    s_cbranch_scc0 main_kernel_w_d_67
    s_mov_b32 s36, 0x88038b8
    s_branch main_kernel_w_dec
main_kernel_w_d_67:
    s_mov_b32 s36, 0x240c8
    s_branch main_kernel_w_dec
main_kernel_w_d_65:
    s_cmp_lt_u32 s28, 216
    s_cbranch_scc0 main_kernel_w_d_68
    s_mov_b32 s36, 0x840d0
    s_branch main_kernel_w_dec
main_kernel_w_d_68:
    s_cmp_lt_u32 s28, 224
    s_cbranch_scc0 main_kernel_w_d_69
    s_mov_b32 s36, 0x440d8
    s_branch main_kernel_w_dec
main_kernel_w_d_69:
    s_mov_b32 s36, 0xffffffff
    s_branch main_kernel_w_dec
main_kernel_w_q4:
    s_cmp_lg_u32 s27, 4
    s_cbranch_scc1 main_kernel_w_q5
    s_cmp_lt_u32 s28, 112
    s_cbranch_scc0 main_kernel_w_d_70
    s_cmp_lt_u32 s28, 48
    s_cbranch_scc0 main_kernel_w_d_71
    s_cmp_lt_u32 s28, 24
    s_cbranch_scc0 main_kernel_w_d_72
    s_cmp_lt_u32 s28, 8
    s_cbranch_scc0 main_kernel_w_d_73
    s_mov_b32 s36, 0x2000800
    s_branch main_kernel_w_dec
main_kernel_w_d_73:
    s_cmp_lt_u32 s28, 16
    s_cbranch_scc0 main_kernel_w_d_74
    s_mov_b32 s36, 0x2001008
    s_branch main_kernel_w_dec
main_kernel_w_d_74:
    s_mov_b32 s36, 0x46028810
    s_branch main_kernel_w_dec
main_kernel_w_d_72:
    s_cmp_lt_u32 s28, 32
    s_cbranch_scc0 main_kernel_w_d_75
    s_mov_b32 s36, 0x46029018
    s_branch main_kernel_w_dec
main_kernel_w_d_75:
    s_cmp_lt_u32 s28, 40
    s_cbranch_scc0 main_kernel_w_d_76
    s_mov_b32 s36, 0x64091020
    s_branch main_kernel_w_dec
main_kernel_w_d_76:
    s_mov_b32 s36, 0x66091028
    s_branch main_kernel_w_dec
main_kernel_w_d_71:
    s_cmp_lt_u32 s28, 72
    s_cbranch_scc0 main_kernel_w_d_77
    s_cmp_lt_u32 s28, 56
    s_cbranch_scc0 main_kernel_w_d_78
    s_mov_b32 s36, 0x67090830
    s_branch main_kernel_w_dec
main_kernel_w_d_78:
    s_cmp_lt_u32 s28, 64
    s_cbranch_scc0 main_kernel_w_d_79
    s_mov_b32 s36, 0x65090838
    s_branch main_kernel_w_dec
main_kernel_w_d_79:
    s_mov_b32 s36, 0x67090040
    s_branch main_kernel_w_dec
main_kernel_w_d_77:
    s_cmp_lt_u32 s28, 80
    s_cbranch_scc0 main_kernel_w_d_80
    s_mov_b32 s36, 0x65111048
    s_branch main_kernel_w_dec
main_kernel_w_d_80:
    s_cmp_lt_u32 s28, 96
    s_cbranch_scc0 main_kernel_w_d_81
    s_mov_b32 s36, 0x48108050
    s_branch main_kernel_w_dec
main_kernel_w_d_81:
    s_mov_b32 s36, 0x8182860
    s_branch main_kernel_w_dec
main_kernel_w_d_70:
    s_cmp_lt_u32 s28, 172
    s_cbranch_scc0 main_kernel_w_d_82
    s_cmp_lt_u32 s28, 144
    s_cbranch_scc0 main_kernel_w_d_83
    s_cmp_lt_u32 s28, 120
    s_cbranch_scc0 main_kernel_w_d_84
    s_mov_b32 s36, 0x65013070
    s_branch main_kernel_w_dec
main_kernel_w_d_84:
    s_cmp_lt_u32 s28, 136
    s_cbranch_scc0 main_kernel_w_d_85
    s_mov_b32 s36, 0x48188878
    s_branch main_kernel_w_dec
main_kernel_w_d_85:
    s_mov_b32 s36, 0x64193088
    s_branch main_kernel_w_dec
main_kernel_w_d_83:
    s_cmp_lt_u32 s28, 156
    s_cbranch_scc0 main_kernel_w_d_86
    s_mov_b32 s36, 0x4a18b090
    s_branch main_kernel_w_dec
main_kernel_w_d_86:
    s_cmp_lt_u32 s28, 164
    s_cbranch_scc0 main_kernel_w_d_87
    s_mov_b32 s36, 0x6419109c
    s_branch main_kernel_w_dec
main_kernel_w_d_87:
    s_mov_b32 s36, 0x651900a4
    s_branch main_kernel_w_dec
main_kernel_w_d_82:
    s_cmp_lt_u32 s28, 204
    s_cbranch_scc0 main_kernel_w_d_88
    s_cmp_lt_u32 s28, 188
    s_cbranch_scc0 main_kernel_w_d_89
    s_mov_b32 s36, 0x80038ac
    s_branch main_kernel_w_dec
main_kernel_w_d_89:
    s_cmp_lt_u32 s28, 196
    s_cbranch_scc0 main_kernel_w_d_90
    s_mov_b32 s36, 0x640bc
    s_branch main_kernel_w_dec
main_kernel_w_d_90:
    s_mov_b32 s36, 0xa40c4
    s_branch main_kernel_w_dec
main_kernel_w_d_88:
    s_cmp_lt_u32 s28, 212
    s_cbranch_scc0 main_kernel_w_d_91
    s_mov_b32 s36, 0xe40cc
    s_branch main_kernel_w_dec
main_kernel_w_d_91:
    s_cmp_lt_u32 s28, 220
    s_cbranch_scc0 main_kernel_w_d_92
    s_mov_b32 s36, 0x1040d4
    s_branch main_kernel_w_dec
main_kernel_w_d_92:
    s_mov_b32 s36, 0xffffffff
    s_branch main_kernel_w_dec
main_kernel_w_q5:
    s_cmp_lt_u32 s28, 128
    s_cbranch_scc0 main_kernel_w_d_93
    s_cmp_lt_u32 s28, 48
    s_cbranch_scc0 main_kernel_w_d_94
    s_cmp_lt_u32 s28, 24
    s_cbranch_scc0 main_kernel_w_d_95
    s_cmp_lt_u32 s28, 8
    s_cbranch_scc0 main_kernel_w_d_96
    s_mov_b32 s36, 0x3000800
    s_branch main_kernel_w_dec
main_kernel_w_d_96:
    s_cmp_lt_u32 s28, 16
    s_cbranch_scc0 main_kernel_w_d_97
    s_mov_b32 s36, 0x3001008
    s_branch main_kernel_w_dec
main_kernel_w_d_97:
    s_mov_b32 s36, 0x47028810
    s_branch main_kernel_w_dec
main_kernel_w_d_95:
    s_cmp_lt_u32 s28, 32
    s_cbranch_scc0 main_kernel_w_d_98
    s_mov_b32 s36, 0x47029018
    s_branch main_kernel_w_dec
main_kernel_w_d_98:
    s_cmp_lt_u32 s28, 40
    s_cbranch_scc0 main_kernel_w_d_99
    s_mov_b32 s36, 0x65091020
    s_branch main_kernel_w_dec
main_kernel_w_d_99:
    s_mov_b32 s36, 0x4045028
    s_branch main_kernel_w_dec
main_kernel_w_d_94:
    s_cmp_lt_u32 s28, 72
    s_cbranch_scc0 main_kernel_w_d_100
    s_cmp_lt_u32 s28, 56
    s_cbranch_scc0 main_kernel_w_d_101
    s_mov_b32 s36, 0x42068830
    s_branch main_kernel_w_dec
main_kernel_w_d_101:
    s_cmp_lt_u32 s28, 64
    s_cbranch_scc0 main_kernel_w_d_102
    s_mov_b32 s36, 0x66110838
    s_branch main_kernel_w_dec
main_kernel_w_d_102:
    s_mov_b32 s36, 0x40069040
    s_branch main_kernel_w_dec
main_kernel_w_d_100:
    s_cmp_lt_u32 s28, 96
    s_cbranch_scc0 main_kernel_w_d_103
    s_cmp_lt_u32 s28, 80
    s_cbranch_scc0 main_kernel_w_d_104
    s_mov_b32 s36, 0x64090048
    s_branch main_kernel_w_dec
main_kernel_w_d_104:
    s_mov_b32 s36, 0x4182050
    s_branch main_kernel_w_dec
main_kernel_w_d_103:
    s_cmp_lt_u32 s28, 112
    s_cbranch_scc0 main_kernel_w_d_105
    s_mov_b32 s36, 0x8102860
    s_branch main_kernel_w_dec
main_kernel_w_d_105:
    s_mov_b32 s36, 0x4002070
    s_branch main_kernel_w_dec
main_kernel_w_d_93:
    s_cmp_lt_u32 s28, 200
    s_cbranch_scc0 main_kernel_w_d_106
    s_cmp_lt_u32 s28, 160
    s_cbranch_scc0 main_kernel_w_d_107
    s_cmp_lt_u32 s28, 144
    s_cbranch_scc0 main_kernel_w_d_108
    s_mov_b32 s36, 0x8185080
    s_branch main_kernel_w_dec
main_kernel_w_d_108:
    s_cmp_lt_u32 s28, 152
    s_cbranch_scc0 main_kernel_w_d_109
    s_mov_b32 s36, 0x65113090
    s_branch main_kernel_w_dec
main_kernel_w_d_109:
    s_mov_b32 s36, 0x65110898
    s_branch main_kernel_w_dec
main_kernel_w_d_107:
    s_cmp_lt_u32 s28, 176
    s_cbranch_scc0 main_kernel_w_d_110
    s_mov_b32 s36, 0x4a0880a0
    s_branch main_kernel_w_dec
main_kernel_w_d_110:
    s_cmp_lt_u32 s28, 184
    s_cbranch_scc0 main_kernel_w_d_111
    s_mov_b32 s36, 0x651908b0
    s_branch main_kernel_w_dec
main_kernel_w_d_111:
    s_mov_b32 s36, 0x4808b0b8
    s_branch main_kernel_w_dec
main_kernel_w_d_106:
    s_cmp_lt_u32 s28, 232
    s_cbranch_scc0 main_kernel_w_d_112
    s_cmp_lt_u32 s28, 208
    s_cbranch_scc0 main_kernel_w_d_113
    s_mov_b32 s36, 0x671908c8
    s_branch main_kernel_w_dec
main_kernel_w_d_113:
    s_cmp_lt_u32 s28, 216
    s_cbranch_scc0 main_kernel_w_d_114
    s_mov_b32 s36, 0x661910d0
    s_branch main_kernel_w_dec
main_kernel_w_d_114:
    s_mov_b32 s36, 0x81838d8
    s_branch main_kernel_w_dec
main_kernel_w_d_112:
    s_cmp_lt_u32 s28, 256
    s_cbranch_scc0 main_kernel_w_d_115
    s_cmp_lt_u32 s28, 248
    s_cbranch_scc0 main_kernel_w_d_116
    s_mov_b32 s36, 0x88838e8
    s_branch main_kernel_w_dec
main_kernel_w_d_116:
    s_mov_b32 s36, 0x40f8
    s_branch main_kernel_w_dec
main_kernel_w_d_115:
    s_cmp_lt_u32 s28, 264
    s_cbranch_scc0 main_kernel_w_d_117
    s_mov_b32 s36, 0xc4100
    s_branch main_kernel_w_dec
main_kernel_w_d_117:
    s_mov_b32 s36, 0xffffffff
    s_branch main_kernel_w_dec
main_kernel_w_dec:
    s_cmp_lg_u32 s36, -1
    s_cbranch_scc1 main_kernel_w_got
    s_add_u32 s27, s27, 1
    s_cmp_ge_u32 s27, 6
    s_cselect_b32 s27, 0, s27
    s_add_u32 s52, s52, 1
    s_lshl_b32 s32, 1, s12
    s_and_b32 s32, s32, 116
    s_cselect_b32 s36, -2, -1
    s_cbranch_scc1 main_kernel_w_pub
    s_lshl_b32 s32, s12, 5
    s_add_u32 s32, s32, s13
    s_sub_u32 s32, s32, 224
    s_cmp_lt_u32 s32, 16
    s_cselect_b32 s52, 6, s52
    s_cmp_lt_u32 s52, 6
    s_cbranch_scc1 main_kernel_w_try
    s_lshl_b32 s32, s12, 5
    s_add_u32 s32, s32, s13
    s_sub_u32 s32, s32, 160
    s_cmp_lt_u32 s32, 80
    s_cselect_b32 s36, -3, -1
    s_cmp_lt_u32 s32, 64
    s_cselect_b32 s36, -2, s36
    s_branch main_kernel_w_pub
main_kernel_w_got:
    s_and_b32 s32, s36, 0x7ff
    s_sub_u32 s28, s28, s32
    s_bfe_u32 s32, s36, 0x3001a
    s_lshr_b32 s25, s28, s32
    s_lshl_b32 s33, s25, s32
    s_sub_u32 s24, s28, s33
    s_bfe_u32 s34, s36, 0x1001d
    s_lshl_b32 s24, s24, s34
    s_bfe_u32 s35, s36, 0x1001e
    s_lshl_b32 s25, s25, s35
    s_bfe_u32 s32, s36, 0x40011
    s_add_u32 s24, s24, s32
    s_bfe_u32 s32, s36, 0x50015
    s_add_u32 s25, s25, s32
    s_bfe_u32 s23, s36, 0x4000b
    s_bfe_u32 s36, s36, 0x6000b
    s_lshl_b32 s32, s24, 8
    s_or_b32 s36, s36, s32
    s_lshl_b32 s32, s25, 16
    s_or_b32 s36, s36, s32
    s_cmp_eq_u32 s23, 8
    s_cbranch_scc1 main_kernel_w_dwo
    s_cmp_ge_u32 s23, 10
    s_cbranch_scc1 main_kernel_w_pub
    s_mov_b32 s48, s24
    s_add_u32 s49, s24, s34
    s_mov_b32 s50, 4
    s_mov_b32 s51, 7
    s_cmp_lg_u32 s23, 4
    s_cbranch_scc1 main_kernel_w_dp1
    s_sub_u32 s48, s48, 1
    s_max_i32 s48, s48, 0
    s_add_u32 s49, s49, 1
    s_min_u32 s49, s49, 15
main_kernel_w_dp1:
    s_cmp_eq_u32 s23, 6
    s_cselect_b32 s51, 3, s51
    s_cmp_eq_u32 s23, 7
    s_cselect_b32 s51, 27, s51
    s_cselect_b32 s50, 5, s50
    v_lshrrev_b32 v253, s50, v250
    v_lshlrev_b32 v254, s50, v253
    v_sub_u32 v254, v250, v254
    v_min_u32 v254, s51, v254
    v_add_u32 v253, s48, v253
    v_min_u32 v253, s49, v253
    v_lshlrev_b32 v253, 9, v253
    v_lshl_add_u32 v253, v254, 4, v253
    s_cmp_lt_u32 s23, 4
    s_cselect_b32 s39, 10, s23
    s_lshl_b32 s39, s39, 13
    s_cmp_eq_u32 s23, 3
    s_cselect_b32 s32, 4, 0
    s_add_u32 s39, s39, s32
    s_add_u32 s39, s39, 0x8402000
main_kernel_w_poll:
    buffer_load_dword v254, v253, s[4:7], s39 offen sc1
    s_waitcnt vmcnt(0)
    v_cmp_eq_u32 vcc, 0, v254
    s_cmp_eq_u32 s57, 0
    s_cbranch_scc1 main_kernel_w_fl2
    s_waitcnt vmcnt(0)
    s_barrier
    v_mov_b32 v4, 1
    v_mov_b32 v5, 1
    v_mov_b32 v6, 1
    v_mov_b32 v7, 1
    s_bfm_b64 exec, s57, 0
    buffer_store_dwordx4 v[4:7], v249, s[4:7], s56 offen sc1
    s_mov_b64 exec, -1
    s_mov_b32 s57, 0
main_kernel_w_fl2:
    s_cbranch_vccz main_kernel_w_pub
    s_sleep 8
    s_sub_u32 s29, s29, 1
    s_cbranch_scc0 main_kernel_w_poll
    s_mov_b32 s36, -1
    s_branch main_kernel_w_pub
main_kernel_w_dwo:
    s_lshl_b32 s39, s24, 10
    s_add_u32 s39, s39, 0x8400000
main_kernel_w_pollo:
    buffer_load_dwordx4 v[0:3], v251, s[4:7], s39 offen sc1
    s_waitcnt vmcnt(0)
    v_min3_u32 v0, v0, v1, v2
    v_min_u32 v0, v0, v3
    v_cmp_eq_u32 vcc, 0, v0
    s_cmp_eq_u32 s57, 0
    s_cbranch_scc1 main_kernel_w_fl3
    s_waitcnt vmcnt(0)
    s_barrier
    v_mov_b32 v4, 1
    v_mov_b32 v5, 1
    v_mov_b32 v6, 1
    v_mov_b32 v7, 1
    s_bfm_b64 exec, s57, 0
    buffer_store_dwordx4 v[4:7], v249, s[4:7], s56 offen sc1
    s_mov_b64 exec, -1
    s_mov_b32 s57, 0
main_kernel_w_fl3:
    s_cbranch_vccz main_kernel_w_pub
    s_sleep 16
    s_sub_u32 s29, s29, 1
    s_cbranch_scc0 main_kernel_w_pollo
    s_mov_b32 s36, -1
    s_branch main_kernel_w_pub
main_kernel_w_oko:
    v_min_u32 v253, s35, v250
    v_add_u32 v253, s25, v253
    v_lshlrev_b32 v253, 8, v253
    s_lshl_b32 s39, s24, 4
    s_add_u32 s39, s39, 0x8412000
    s_branch main_kernel_w_poll
main_kernel_w_pub:
    s_cmp_eq_u32 s57, 0
    s_cbranch_scc1 main_kernel_w_fl4
    s_waitcnt vmcnt(0)
    s_barrier
    v_mov_b32 v4, 1
    v_mov_b32 v5, 1
    v_mov_b32 v6, 1
    v_mov_b32 v7, 1
    s_bfm_b64 exec, s57, 0
    buffer_store_dwordx4 v[4:7], v249, s[4:7], s56 offen sc1
    s_mov_b64 exec, -1
    s_mov_b32 s57, 0
main_kernel_w_fl4:
    v_mov_b32 v253, 131072
    v_mov_b32 v254, s36
    ds_write_b32 v253, v254
    s_waitcnt lgkmcnt(0)
main_kernel_w_bar:
    s_barrier
    v_mov_b32 v253, 131072
    ds_read_b32 v254, v253
    s_waitcnt lgkmcnt(0)
    v_readfirstlane_b32 s36, v254
    s_nop 3
    s_cmp_eq_u32 s36, -1
    s_cbranch_scc1 main_kernel_end2
    s_cmp_eq_u32 s36, -2
    s_cbranch_scc1 main_kernel_wo
    s_cmp_eq_u32 s36, -3
    s_cbranch_scc1 main_kernel_att2
    s_mov_b32 s55, -1
    s_and_b32 s23, s36, 15
    s_bfe_u32 s54, s36, 0x20004
    s_bfe_u32 s24, s36, 0x80008
    s_lshr_b32 s25, s36, 16
    s_cmp_eq_u32 s23, 5
    s_cbranch_scc1 main_kernel_w_ln2
    s_cmp_eq_u32 s23, 10
    s_cbranch_scc1 main_kernel_w_fill
    s_cmp_eq_u32 s23, 11
    s_cbranch_scc1 main_kernel_w_pref
    s_cmp_eq_u32 s54, 1
    s_cbranch_scc1 main_kernel_w_c1_task
    s_cmp_eq_u32 s54, 2
    s_cbranch_scc1 main_kernel_w_c2_task
main_kernel_w_c0_task:
    s_cmp_eq_u32 s23, 1
    s_cbranch_scc1 main_kernel_w_c0_set1
    s_cmp_eq_u32 s23, 2
    s_cbranch_scc1 main_kernel_w_c0_set2
    s_cmp_eq_u32 s23, 4
    s_cbranch_scc1 main_kernel_w_c0_set4
    s_cmp_eq_u32 s23, 7
    s_cbranch_scc1 main_kernel_w_c0_set7
    s_cmp_eq_u32 s23, 8
    s_cbranch_scc1 main_kernel_w_c0_set8
    s_branch main_kernel_w_done
main_kernel_w_c0_set1:
    s_lshl_b32 s32, s25, 8
    s_add_u32 s8, s42, s32
    s_addc_u32 s9, s43, 0
    s_and_b32 s9, s9, 0xffff
    s_sub_u32 s10, 0x800000, s32
    s_mov_b32 s11, 0x20000
    s_mov_b32 s30, 8192
    s_mov_b32 s31, 32768
    s_mul_i32 s16, s24, 262144
    s_add_u32 s16, s16, 0x0
    s_mov_b32 s18, 3
    s_lshl_b32 s32, s24, 3
    s_mul_i32 s33, s38, 4
    s_add_u32 s32, s32, s33
    s_mul_i32 s32, s32, 131072
    s_lshl_b32 s33, s25, 12
    s_add_u32 s32, s32, s33
    s_mul_i32 s33, s37, 2048
    s_add_u32 s32, s32, s33
    s_add_u32 s21, s32, 0x1800000
    s_mov_b32 s22, 131072
    s_mov_b32 s26, -1
    s_branch main_kernel_w_c0_go
main_kernel_w_c0_set2:
    s_lshl_b32 s32, s25, 8
    s_add_u32 s8, s44, s32
    s_addc_u32 s9, s45, 0
    s_and_b32 s9, s9, 0xffff
    s_sub_u32 s10, 0x800000, s32
    s_mov_b32 s11, 0x20000
    s_mov_b32 s30, 8192
    s_mov_b32 s31, 32768
    s_mul_i32 s16, s24, 262144
    s_add_u32 s16, s16, 0x0
    s_mov_b32 s18, 3
    s_lshl_b32 s32, s24, 2
    s_mul_i32 s33, s38, 2
    s_add_u32 s32, s32, s33
    s_lshl_b32 s32, s32, 18
    s_lshl_b32 s33, s25, 13
    s_add_u32 s32, s32, s33
    s_mul_i32 s33, s37, 4096
    s_add_u32 s32, s32, s33
    s_add_u32 s21, s32, 0x2800000
    s_branch main_kernel_w_c0_gov
main_kernel_w_c0_set4:
    s_lshl_b32 s32, s25, 8
    s_add_u32 s8, s66, s32
    s_addc_u32 s9, s67, 0
    s_and_b32 s9, s9, 0xffff
    s_sub_u32 s10, 0x200000, s32
    s_mov_b32 s11, 0x20000
    s_mov_b32 s30, 2048
    s_mov_b32 s31, 32768
    s_mul_i32 s16, s24, 262144
    s_add_u32 s16, s16, 0x4808000
    s_mov_b32 s18, 3
    s_lshl_b32 s32, s24, 3
    s_mul_i32 s33, s38, 4
    s_add_u32 s32, s32, s33
    s_mul_i32 s32, s32, 32768
    s_lshl_b32 s33, s25, 12
    s_add_u32 s32, s32, s33
    s_mul_i32 s33, s37, 2048
    s_add_u32 s32, s32, s33
    s_add_u32 s21, s32, 0x5000000
    s_mov_b32 s22, 32768
    s_add_u32 s26, s32, 0x0
    s_branch main_kernel_w_c0_go
main_kernel_w_c0_set7:
    s_lshl_b32 s32, s25, 8
    s_add_u32 s8, s70, s32
    s_addc_u32 s9, s71, 0
    s_and_b32 s9, s9, 0xffff
    s_sub_u32 s10, 0x700000, s32
    s_mov_b32 s11, 0x20000
    s_mov_b32 s30, 2048
    s_mov_b32 s31, 114688
    s_mul_i32 s16, s24, 917504
    s_add_u32 s16, s16, 0x5400000
    s_mov_b32 s18, 13
    s_lshl_b32 s32, s24, 3
    s_mul_i32 s33, s38, 4
    s_add_u32 s32, s32, s33
    s_mul_i32 s32, s32, 32768
    s_lshl_b32 s33, s25, 12
    s_add_u32 s32, s32, s33
    s_mul_i32 s33, s37, 2048
    s_add_u32 s32, s32, s33
    s_add_u32 s21, s32, 0x6400000
    s_mov_b32 s22, 32768
    s_add_u32 s26, s32, 0x5000000
    s_branch main_kernel_w_c0_go
main_kernel_w_c0_set8:
    s_lshl_b32 s32, s25, 8
    s_add_u32 s8, s46, s32
    s_addc_u32 s9, s47, 0
    s_and_b32 s9, s9, 0xffff
    s_sub_u32 s10, 0x800000, s32
    s_mov_b32 s11, 0x20000
    s_mov_b32 s30, 2048
    s_mov_b32 s31, 131072
    s_mul_i32 s16, s24, 1048576
    s_add_u32 s16, s16, 0x3800000
    s_mov_b32 s18, 15
    s_lshl_b32 s32, s24, 3
    s_mul_i32 s33, s38, 4
    s_add_u32 s32, s32, s33
    s_mul_i32 s32, s32, 32768
    s_lshl_b32 s33, s25, 8
    s_add_u32 s34, s32, s33
    s_mul_i32 s33, s37, 128
    s_add_u32 s34, s34, s33
    s_lshl_b32 s33, s25, 12
    s_add_u32 s32, s32, s33
    s_mul_i32 s33, s37, 2048
    s_add_u32 s32, s32, s33
    s_add_u32 s21, s32, 0x0
    s_mov_b32 s22, 32768
    s_add_u32 s26, s32, 0x6400000
    s_mov_b32 s21, s34
    v_and_b32 v253, 15, v250
    v_and_b32 v254, 48, v250
    v_lshl_add_u32 v252, v253, 11, v254
    s_branch main_kernel_w_c0_go
main_kernel_w_c0_go:
    v_lshrrev_b32 v0, 4, v250
    v_bfe_u32 v1, v250, 2, 2
    v_lshl_add_u32 v4, v0, 2, v1
    v_and_b32 v5, 7, v4
    v_mul_u32_u24 v4, 256, v4
    v_and_b32 v6, 3, v250
    v_lshl_add_u32 v4, v6, 3, v4
    s_mul_i32 s32, s37, 4
    v_xor_b32 v5, s32, v5
    v_lshl_add_u32 v128, v5, 5, v4
    v_xor_b32 v129, 32, v128
    v_xor_b32 v130, 64, v128
    v_xor_b32 v131, 96, v128
    s_mul_i32 s32, s38, 8192
    s_add_u32 s32, s32, 65536
    v_add_u32 v136, s32, v251
    v_lshrrev_b32 v2, 4, v250
    v_and_b32 v3, 15, v250
    s_mul_i32 s32, s14, 16
    v_add_u32 v4, s32, v2
    v_add_u32 v5, 0, v4
    v_and_b32 v6, 7, v5
    v_lshlrev_b32 v6, 1, v6
    v_xor_b32 v6, v6, v3
    v_mul_lo_u32 v5, v5, s30
    v_lshl_add_u32 v5, v6, 4, v5
    v_subrev_u32 v137, 0, v5
    v_add_u32 v5, 4, v4
    v_and_b32 v6, 7, v5
    v_lshlrev_b32 v6, 1, v6
    v_xor_b32 v6, v6, v3
    v_mul_lo_u32 v5, v5, s30
    v_lshl_add_u32 v5, v6, 4, v5
    v_subrev_u32 v138, 1024, v5
    v_add_u32 v5, 8, v4
    v_and_b32 v6, 7, v5
    v_lshlrev_b32 v6, 1, v6
    v_xor_b32 v6, v6, v3
    v_mul_lo_u32 v5, v5, s30
    v_lshl_add_u32 v5, v6, 4, v5
    v_subrev_u32 v139, 2048, v5
    v_add_u32 v5, 12, v4
    v_and_b32 v6, 7, v5
    v_lshlrev_b32 v6, 1, v6
    v_xor_b32 v6, v6, v3
    v_mul_lo_u32 v5, v5, s30
    v_lshl_add_u32 v5, v6, 4, v5
    v_subrev_u32 v140, 3072, v5
    s_mul_i32 s32, s14, 2
    s_mul_i32 s32, s32, s31
    v_add_u32 v141, s32, v251
    s_add_u32 s32, s32, s31
    s_sub_u32 s32, s32, 2048
    v_add_u32 v142, s32, v251
    s_mul_i32 s19, s14, 4096
    s_mul_i32 s20, s14, 4096
    s_add_u32 s20, s20, 65536
    s_mul_i32 s17, s30, 64
    s_mov_b32 s15, 0
    s_add_u32 m0, s20, 0
    s_nop 0
    buffer_load_dwordx4 v141, s[4:7], s16 offen offset:0 sc1 lds
    buffer_load_dwordx4 v141, s[4:7], s16 offen offset:1024 sc1 lds
    buffer_load_dwordx4 v142, s[4:7], s16 offen offset:2048 sc1 lds
    buffer_load_dwordx4 v142, s[4:7], s16 offen offset:3072 sc1 lds
    s_add_u32 s16, s16, 2048
    s_add_u32 m0, s19, 0
    s_nop 0
    buffer_load_dwordx4 v137, s[8:11], s15 offen offset:0 lds
    buffer_load_dwordx4 v138, s[8:11], s15 offen offset:1024 lds
    buffer_load_dwordx4 v139, s[8:11], s15 offen offset:2048 lds
    buffer_load_dwordx4 v140, s[8:11], s15 offen offset:3072 lds
    s_add_u32 s15, s15, s17
    s_add_u32 m0, s20, 16384
    s_nop 0
    buffer_load_dwordx4 v141, s[4:7], s16 offen offset:0 sc1 lds
    buffer_load_dwordx4 v141, s[4:7], s16 offen offset:1024 sc1 lds
    buffer_load_dwordx4 v142, s[4:7], s16 offen offset:2048 sc1 lds
    buffer_load_dwordx4 v142, s[4:7], s16 offen offset:3072 sc1 lds
    s_add_u32 s16, s16, 2048
    s_add_u32 m0, s19, 16384
    s_nop 0
    buffer_load_dwordx4 v137, s[8:11], s15 offen offset:0 lds
    buffer_load_dwordx4 v138, s[8:11], s15 offen offset:1024 lds
    buffer_load_dwordx4 v139, s[8:11], s15 offen offset:2048 lds
    buffer_load_dwordx4 v140, s[8:11], s15 offen offset:3072 lds
    s_add_u32 s15, s15, s17
    s_add_u32 m0, s20, 32768
    s_nop 0
    buffer_load_dwordx4 v141, s[4:7], s16 offen offset:0 sc1 lds
    buffer_load_dwordx4 v141, s[4:7], s16 offen offset:1024 sc1 lds
    buffer_load_dwordx4 v142, s[4:7], s16 offen offset:2048 sc1 lds
    buffer_load_dwordx4 v142, s[4:7], s16 offen offset:3072 sc1 lds
    s_add_u32 s16, s16, 2048
    s_add_u32 m0, s19, 32768
    s_nop 0
    buffer_load_dwordx4 v137, s[8:11], s15 offen offset:0 lds
    buffer_load_dwordx4 v138, s[8:11], s15 offen offset:1024 lds
    buffer_load_dwordx4 v139, s[8:11], s15 offen offset:2048 lds
    buffer_load_dwordx4 v140, s[8:11], s15 offen offset:3072 lds
    s_add_u32 s15, s15, s17
    s_add_u32 m0, s20, 49152
    s_nop 0
    buffer_load_dwordx4 v141, s[4:7], s16 offen offset:0 sc1 lds
    buffer_load_dwordx4 v141, s[4:7], s16 offen offset:1024 sc1 lds
    buffer_load_dwordx4 v142, s[4:7], s16 offen offset:2048 sc1 lds
    buffer_load_dwordx4 v142, s[4:7], s16 offen offset:3072 sc1 lds
    s_add_u32 s16, s16, 2048
    v_mov_b32 v64, 0
    v_mov_b32 v65, 0
    v_mov_b32 v66, 0
    v_mov_b32 v67, 0
    v_mov_b32 v68, 0
    v_mov_b32 v69, 0
    v_mov_b32 v70, 0
    v_mov_b32 v71, 0
    v_mov_b32 v72, 0
    v_mov_b32 v73, 0
    v_mov_b32 v74, 0
    v_mov_b32 v75, 0
    v_mov_b32 v76, 0
    v_mov_b32 v77, 0
    v_mov_b32 v78, 0
    v_mov_b32 v79, 0
    v_mov_b32 v80, 0
    v_mov_b32 v81, 0
    v_mov_b32 v82, 0
    v_mov_b32 v83, 0
    v_mov_b32 v84, 0
    v_mov_b32 v85, 0
    v_mov_b32 v86, 0
    v_mov_b32 v87, 0
    v_mov_b32 v88, 0
    v_mov_b32 v89, 0
    v_mov_b32 v90, 0
    v_mov_b32 v91, 0
    v_mov_b32 v92, 0
    v_mov_b32 v93, 0
    v_mov_b32 v94, 0
    v_mov_b32 v95, 0
    v_mov_b32 v96, 0
    v_mov_b32 v97, 0
    v_mov_b32 v98, 0
    v_mov_b32 v99, 0
    v_mov_b32 v100, 0
    v_mov_b32 v101, 0
    v_mov_b32 v102, 0
    v_mov_b32 v103, 0
    v_mov_b32 v104, 0
    v_mov_b32 v105, 0
    v_mov_b32 v106, 0
    v_mov_b32 v107, 0
    v_mov_b32 v108, 0
    v_mov_b32 v109, 0
    v_mov_b32 v110, 0
    v_mov_b32 v111, 0
    v_mov_b32 v112, 0
    v_mov_b32 v113, 0
    v_mov_b32 v114, 0
    v_mov_b32 v115, 0
    v_mov_b32 v116, 0
    v_mov_b32 v117, 0
    v_mov_b32 v118, 0
    v_mov_b32 v119, 0
    v_mov_b32 v120, 0
    v_mov_b32 v121, 0
    v_mov_b32 v122, 0
    v_mov_b32 v123, 0
    v_mov_b32 v124, 0
    v_mov_b32 v125, 0
    v_mov_b32 v126, 0
    v_mov_b32 v127, 0
    s_waitcnt vmcnt(20)
    s_barrier
    ds_read_b128 v[16:19], v136 offset:0
    ds_read_b64_tr_b16 v[0:1], v128 offset:0
    ds_read_b64_tr_b16 v[2:3], v128 offset:4096
    ds_read_b64_tr_b16 v[4:5], v129 offset:0
    ds_read_b64_tr_b16 v[6:7], v129 offset:4096
    ds_read_b64_tr_b16 v[8:9], v130 offset:0
    ds_read_b64_tr_b16 v[10:11], v130 offset:4096
    ds_read_b64_tr_b16 v[12:13], v131 offset:0
    ds_read_b64_tr_b16 v[14:15], v131 offset:4096
    ds_read_b128 v[20:23], v136 offset:2048
    ds_read_b128 v[24:27], v136 offset:4096
    ds_read_b128 v[28:31], v136 offset:6144
main_kernel_w_c0_n_loop:
    s_waitcnt lgkmcnt(0)
    ds_read_b128 v[48:51], v136 offset:1024
    s_add_u32 m0, s19, 49152
    s_nop 0
    v_mfma_f32_16x16x32_bf16 v[64:67], v[0:3], v[16:19], v[64:67]
    ds_read_b64_tr_b16 v[32:33], v128 offset:8192
    v_mfma_f32_16x16x32_bf16 v[68:71], v[4:7], v[16:19], v[68:71]
    ds_read_b64_tr_b16 v[34:35], v128 offset:12288
    buffer_load_dwordx4 v137, s[8:11], s15 offen offset:0 lds
    v_mfma_f32_16x16x32_bf16 v[72:75], v[8:11], v[16:19], v[72:75]
    ds_read_b64_tr_b16 v[36:37], v129 offset:8192
    v_mfma_f32_16x16x32_bf16 v[76:79], v[12:15], v[16:19], v[76:79]
    ds_read_b64_tr_b16 v[38:39], v129 offset:12288
    v_mfma_f32_16x16x32_bf16 v[80:83], v[0:3], v[20:23], v[80:83]
    ds_read_b64_tr_b16 v[40:41], v130 offset:8192
    buffer_load_dwordx4 v138, s[8:11], s15 offen offset:1024 lds
    v_mfma_f32_16x16x32_bf16 v[84:87], v[4:7], v[20:23], v[84:87]
    ds_read_b64_tr_b16 v[42:43], v130 offset:12288
    v_mfma_f32_16x16x32_bf16 v[88:91], v[8:11], v[20:23], v[88:91]
    ds_read_b64_tr_b16 v[44:45], v131 offset:8192
    v_mfma_f32_16x16x32_bf16 v[92:95], v[12:15], v[20:23], v[92:95]
    ds_read_b64_tr_b16 v[46:47], v131 offset:12288
    buffer_load_dwordx4 v139, s[8:11], s15 offen offset:2048 lds
    v_mfma_f32_16x16x32_bf16 v[96:99], v[0:3], v[24:27], v[96:99]
    ds_read_b128 v[52:55], v136 offset:3072
    v_mfma_f32_16x16x32_bf16 v[100:103], v[4:7], v[24:27], v[100:103]
    ds_read_b128 v[56:59], v136 offset:5120
    buffer_load_dwordx4 v140, s[8:11], s15 offen offset:3072 lds
    v_mfma_f32_16x16x32_bf16 v[104:107], v[8:11], v[24:27], v[104:107]
    ds_read_b128 v[60:63], v136 offset:7168
    v_mfma_f32_16x16x32_bf16 v[108:111], v[12:15], v[24:27], v[108:111]
    v_mfma_f32_16x16x32_bf16 v[112:115], v[0:3], v[28:31], v[112:115]
    s_add_u32 s15, s15, s17
    v_mfma_f32_16x16x32_bf16 v[116:119], v[4:7], v[28:31], v[116:119]
    v_mfma_f32_16x16x32_bf16 v[120:123], v[8:11], v[28:31], v[120:123]
    v_mfma_f32_16x16x32_bf16 v[124:127], v[12:15], v[28:31], v[124:127]
    s_waitcnt lgkmcnt(0)
    v_mfma_f32_16x16x32_bf16 v[64:67], v[32:35], v[48:51], v[64:67]
    s_waitcnt vmcnt(16)
    s_barrier
    ds_read_b128 v[16:19], v136 offset:16384
    s_add_u32 m0, s20, 0
    s_nop 0
    v_mfma_f32_16x16x32_bf16 v[68:71], v[36:39], v[48:51], v[68:71]
    ds_read_b64_tr_b16 v[0:1], v128 offset:16384
    v_mfma_f32_16x16x32_bf16 v[72:75], v[40:43], v[48:51], v[72:75]
    ds_read_b64_tr_b16 v[2:3], v128 offset:20480
    buffer_load_dwordx4 v141, s[4:7], s16 offen offset:0 sc1 lds
    v_mfma_f32_16x16x32_bf16 v[76:79], v[44:47], v[48:51], v[76:79]
    ds_read_b64_tr_b16 v[4:5], v129 offset:16384
    v_mfma_f32_16x16x32_bf16 v[80:83], v[32:35], v[52:55], v[80:83]
    ds_read_b64_tr_b16 v[6:7], v129 offset:20480
    v_mfma_f32_16x16x32_bf16 v[84:87], v[36:39], v[52:55], v[84:87]
    ds_read_b64_tr_b16 v[8:9], v130 offset:16384
    buffer_load_dwordx4 v141, s[4:7], s16 offen offset:1024 sc1 lds
    v_mfma_f32_16x16x32_bf16 v[88:91], v[40:43], v[52:55], v[88:91]
    ds_read_b64_tr_b16 v[10:11], v130 offset:20480
    v_mfma_f32_16x16x32_bf16 v[92:95], v[44:47], v[52:55], v[92:95]
    ds_read_b64_tr_b16 v[12:13], v131 offset:16384
    buffer_load_dwordx4 v142, s[4:7], s16 offen offset:2048 sc1 lds
    v_mfma_f32_16x16x32_bf16 v[96:99], v[32:35], v[56:59], v[96:99]
    ds_read_b64_tr_b16 v[14:15], v131 offset:20480
    v_mfma_f32_16x16x32_bf16 v[100:103], v[36:39], v[56:59], v[100:103]
    ds_read_b128 v[20:23], v136 offset:18432
    v_mfma_f32_16x16x32_bf16 v[104:107], v[40:43], v[56:59], v[104:107]
    ds_read_b128 v[24:27], v136 offset:20480
    buffer_load_dwordx4 v142, s[4:7], s16 offen offset:3072 sc1 lds
    v_mfma_f32_16x16x32_bf16 v[108:111], v[44:47], v[56:59], v[108:111]
    ds_read_b128 v[28:31], v136 offset:22528
    v_mfma_f32_16x16x32_bf16 v[112:115], v[32:35], v[60:63], v[112:115]
    s_add_u32 s16, s16, 2048
    v_mfma_f32_16x16x32_bf16 v[116:119], v[36:39], v[60:63], v[116:119]
    v_mfma_f32_16x16x32_bf16 v[120:123], v[40:43], v[60:63], v[120:123]
    v_mfma_f32_16x16x32_bf16 v[124:127], v[44:47], v[60:63], v[124:127]
    s_waitcnt lgkmcnt(0)
    ds_read_b128 v[48:51], v136 offset:17408
    s_add_u32 m0, s19, 0
    s_nop 0
    v_mfma_f32_16x16x32_bf16 v[64:67], v[0:3], v[16:19], v[64:67]
    ds_read_b64_tr_b16 v[32:33], v128 offset:24576
    v_mfma_f32_16x16x32_bf16 v[68:71], v[4:7], v[16:19], v[68:71]
    ds_read_b64_tr_b16 v[34:35], v128 offset:28672
    buffer_load_dwordx4 v137, s[8:11], s15 offen offset:0 lds
    v_mfma_f32_16x16x32_bf16 v[72:75], v[8:11], v[16:19], v[72:75]
    ds_read_b64_tr_b16 v[36:37], v129 offset:24576
    v_mfma_f32_16x16x32_bf16 v[76:79], v[12:15], v[16:19], v[76:79]
    ds_read_b64_tr_b16 v[38:39], v129 offset:28672
    v_mfma_f32_16x16x32_bf16 v[80:83], v[0:3], v[20:23], v[80:83]
    ds_read_b64_tr_b16 v[40:41], v130 offset:24576
    buffer_load_dwordx4 v138, s[8:11], s15 offen offset:1024 lds
    v_mfma_f32_16x16x32_bf16 v[84:87], v[4:7], v[20:23], v[84:87]
    ds_read_b64_tr_b16 v[42:43], v130 offset:28672
    v_mfma_f32_16x16x32_bf16 v[88:91], v[8:11], v[20:23], v[88:91]
    ds_read_b64_tr_b16 v[44:45], v131 offset:24576
    v_mfma_f32_16x16x32_bf16 v[92:95], v[12:15], v[20:23], v[92:95]
    ds_read_b64_tr_b16 v[46:47], v131 offset:28672
    buffer_load_dwordx4 v139, s[8:11], s15 offen offset:2048 lds
    v_mfma_f32_16x16x32_bf16 v[96:99], v[0:3], v[24:27], v[96:99]
    ds_read_b128 v[52:55], v136 offset:19456
    v_mfma_f32_16x16x32_bf16 v[100:103], v[4:7], v[24:27], v[100:103]
    ds_read_b128 v[56:59], v136 offset:21504
    buffer_load_dwordx4 v140, s[8:11], s15 offen offset:3072 lds
    v_mfma_f32_16x16x32_bf16 v[104:107], v[8:11], v[24:27], v[104:107]
    ds_read_b128 v[60:63], v136 offset:23552
    v_mfma_f32_16x16x32_bf16 v[108:111], v[12:15], v[24:27], v[108:111]
    v_mfma_f32_16x16x32_bf16 v[112:115], v[0:3], v[28:31], v[112:115]
    s_add_u32 s15, s15, s17
    v_mfma_f32_16x16x32_bf16 v[116:119], v[4:7], v[28:31], v[116:119]
    v_mfma_f32_16x16x32_bf16 v[120:123], v[8:11], v[28:31], v[120:123]
    v_mfma_f32_16x16x32_bf16 v[124:127], v[12:15], v[28:31], v[124:127]
    s_waitcnt lgkmcnt(0)
    v_mfma_f32_16x16x32_bf16 v[64:67], v[32:35], v[48:51], v[64:67]
    s_waitcnt vmcnt(16)
    s_barrier
    ds_read_b128 v[16:19], v136 offset:32768
    s_add_u32 m0, s20, 16384
    s_nop 0
    v_mfma_f32_16x16x32_bf16 v[68:71], v[36:39], v[48:51], v[68:71]
    ds_read_b64_tr_b16 v[0:1], v128 offset:32768
    v_mfma_f32_16x16x32_bf16 v[72:75], v[40:43], v[48:51], v[72:75]
    ds_read_b64_tr_b16 v[2:3], v128 offset:36864
    buffer_load_dwordx4 v141, s[4:7], s16 offen offset:0 sc1 lds
    v_mfma_f32_16x16x32_bf16 v[76:79], v[44:47], v[48:51], v[76:79]
    ds_read_b64_tr_b16 v[4:5], v129 offset:32768
    v_mfma_f32_16x16x32_bf16 v[80:83], v[32:35], v[52:55], v[80:83]
    ds_read_b64_tr_b16 v[6:7], v129 offset:36864
    v_mfma_f32_16x16x32_bf16 v[84:87], v[36:39], v[52:55], v[84:87]
    ds_read_b64_tr_b16 v[8:9], v130 offset:32768
    buffer_load_dwordx4 v141, s[4:7], s16 offen offset:1024 sc1 lds
    v_mfma_f32_16x16x32_bf16 v[88:91], v[40:43], v[52:55], v[88:91]
    ds_read_b64_tr_b16 v[10:11], v130 offset:36864
    v_mfma_f32_16x16x32_bf16 v[92:95], v[44:47], v[52:55], v[92:95]
    ds_read_b64_tr_b16 v[12:13], v131 offset:32768
    buffer_load_dwordx4 v142, s[4:7], s16 offen offset:2048 sc1 lds
    v_mfma_f32_16x16x32_bf16 v[96:99], v[32:35], v[56:59], v[96:99]
    ds_read_b64_tr_b16 v[14:15], v131 offset:36864
    v_mfma_f32_16x16x32_bf16 v[100:103], v[36:39], v[56:59], v[100:103]
    ds_read_b128 v[20:23], v136 offset:34816
    v_mfma_f32_16x16x32_bf16 v[104:107], v[40:43], v[56:59], v[104:107]
    ds_read_b128 v[24:27], v136 offset:36864
    buffer_load_dwordx4 v142, s[4:7], s16 offen offset:3072 sc1 lds
    v_mfma_f32_16x16x32_bf16 v[108:111], v[44:47], v[56:59], v[108:111]
    ds_read_b128 v[28:31], v136 offset:38912
    v_mfma_f32_16x16x32_bf16 v[112:115], v[32:35], v[60:63], v[112:115]
    s_add_u32 s16, s16, 2048
    v_mfma_f32_16x16x32_bf16 v[116:119], v[36:39], v[60:63], v[116:119]
    v_mfma_f32_16x16x32_bf16 v[120:123], v[40:43], v[60:63], v[120:123]
    v_mfma_f32_16x16x32_bf16 v[124:127], v[44:47], v[60:63], v[124:127]
    s_waitcnt lgkmcnt(0)
    ds_read_b128 v[48:51], v136 offset:33792
    s_add_u32 m0, s19, 16384
    s_nop 0
    v_mfma_f32_16x16x32_bf16 v[64:67], v[0:3], v[16:19], v[64:67]
    ds_read_b64_tr_b16 v[32:33], v128 offset:40960
    v_mfma_f32_16x16x32_bf16 v[68:71], v[4:7], v[16:19], v[68:71]
    ds_read_b64_tr_b16 v[34:35], v128 offset:45056
    buffer_load_dwordx4 v137, s[8:11], s15 offen offset:0 lds
    v_mfma_f32_16x16x32_bf16 v[72:75], v[8:11], v[16:19], v[72:75]
    ds_read_b64_tr_b16 v[36:37], v129 offset:40960
    v_mfma_f32_16x16x32_bf16 v[76:79], v[12:15], v[16:19], v[76:79]
    ds_read_b64_tr_b16 v[38:39], v129 offset:45056
    v_mfma_f32_16x16x32_bf16 v[80:83], v[0:3], v[20:23], v[80:83]
    ds_read_b64_tr_b16 v[40:41], v130 offset:40960
    buffer_load_dwordx4 v138, s[8:11], s15 offen offset:1024 lds
    v_mfma_f32_16x16x32_bf16 v[84:87], v[4:7], v[20:23], v[84:87]
    ds_read_b64_tr_b16 v[42:43], v130 offset:45056
    v_mfma_f32_16x16x32_bf16 v[88:91], v[8:11], v[20:23], v[88:91]
    ds_read_b64_tr_b16 v[44:45], v131 offset:40960
    v_mfma_f32_16x16x32_bf16 v[92:95], v[12:15], v[20:23], v[92:95]
    ds_read_b64_tr_b16 v[46:47], v131 offset:45056
    buffer_load_dwordx4 v139, s[8:11], s15 offen offset:2048 lds
    v_mfma_f32_16x16x32_bf16 v[96:99], v[0:3], v[24:27], v[96:99]
    ds_read_b128 v[52:55], v136 offset:35840
    v_mfma_f32_16x16x32_bf16 v[100:103], v[4:7], v[24:27], v[100:103]
    ds_read_b128 v[56:59], v136 offset:37888
    buffer_load_dwordx4 v140, s[8:11], s15 offen offset:3072 lds
    v_mfma_f32_16x16x32_bf16 v[104:107], v[8:11], v[24:27], v[104:107]
    ds_read_b128 v[60:63], v136 offset:39936
    v_mfma_f32_16x16x32_bf16 v[108:111], v[12:15], v[24:27], v[108:111]
    v_mfma_f32_16x16x32_bf16 v[112:115], v[0:3], v[28:31], v[112:115]
    s_add_u32 s15, s15, s17
    v_mfma_f32_16x16x32_bf16 v[116:119], v[4:7], v[28:31], v[116:119]
    v_mfma_f32_16x16x32_bf16 v[120:123], v[8:11], v[28:31], v[120:123]
    v_mfma_f32_16x16x32_bf16 v[124:127], v[12:15], v[28:31], v[124:127]
    s_waitcnt lgkmcnt(0)
    v_mfma_f32_16x16x32_bf16 v[64:67], v[32:35], v[48:51], v[64:67]
    s_waitcnt vmcnt(16)
    s_barrier
    ds_read_b128 v[16:19], v136 offset:49152
    s_add_u32 m0, s20, 32768
    s_nop 0
    v_mfma_f32_16x16x32_bf16 v[68:71], v[36:39], v[48:51], v[68:71]
    ds_read_b64_tr_b16 v[0:1], v128 offset:49152
    v_mfma_f32_16x16x32_bf16 v[72:75], v[40:43], v[48:51], v[72:75]
    ds_read_b64_tr_b16 v[2:3], v128 offset:53248
    buffer_load_dwordx4 v141, s[4:7], s16 offen offset:0 sc1 lds
    v_mfma_f32_16x16x32_bf16 v[76:79], v[44:47], v[48:51], v[76:79]
    ds_read_b64_tr_b16 v[4:5], v129 offset:49152
    v_mfma_f32_16x16x32_bf16 v[80:83], v[32:35], v[52:55], v[80:83]
    ds_read_b64_tr_b16 v[6:7], v129 offset:53248
    v_mfma_f32_16x16x32_bf16 v[84:87], v[36:39], v[52:55], v[84:87]
    ds_read_b64_tr_b16 v[8:9], v130 offset:49152
    buffer_load_dwordx4 v141, s[4:7], s16 offen offset:1024 sc1 lds
    v_mfma_f32_16x16x32_bf16 v[88:91], v[40:43], v[52:55], v[88:91]
    ds_read_b64_tr_b16 v[10:11], v130 offset:53248
    v_mfma_f32_16x16x32_bf16 v[92:95], v[44:47], v[52:55], v[92:95]
    ds_read_b64_tr_b16 v[12:13], v131 offset:49152
    buffer_load_dwordx4 v142, s[4:7], s16 offen offset:2048 sc1 lds
    v_mfma_f32_16x16x32_bf16 v[96:99], v[32:35], v[56:59], v[96:99]
    ds_read_b64_tr_b16 v[14:15], v131 offset:53248
    v_mfma_f32_16x16x32_bf16 v[100:103], v[36:39], v[56:59], v[100:103]
    ds_read_b128 v[20:23], v136 offset:51200
    v_mfma_f32_16x16x32_bf16 v[104:107], v[40:43], v[56:59], v[104:107]
    ds_read_b128 v[24:27], v136 offset:53248
    buffer_load_dwordx4 v142, s[4:7], s16 offen offset:3072 sc1 lds
    v_mfma_f32_16x16x32_bf16 v[108:111], v[44:47], v[56:59], v[108:111]
    ds_read_b128 v[28:31], v136 offset:55296
    v_mfma_f32_16x16x32_bf16 v[112:115], v[32:35], v[60:63], v[112:115]
    s_add_u32 s16, s16, 2048
    v_mfma_f32_16x16x32_bf16 v[116:119], v[36:39], v[60:63], v[116:119]
    v_mfma_f32_16x16x32_bf16 v[120:123], v[40:43], v[60:63], v[120:123]
    v_mfma_f32_16x16x32_bf16 v[124:127], v[44:47], v[60:63], v[124:127]
    s_waitcnt lgkmcnt(0)
    ds_read_b128 v[48:51], v136 offset:50176
    s_add_u32 m0, s19, 32768
    s_nop 0
    v_mfma_f32_16x16x32_bf16 v[64:67], v[0:3], v[16:19], v[64:67]
    ds_read_b64_tr_b16 v[32:33], v128 offset:57344
    v_mfma_f32_16x16x32_bf16 v[68:71], v[4:7], v[16:19], v[68:71]
    ds_read_b64_tr_b16 v[34:35], v128 offset:61440
    buffer_load_dwordx4 v137, s[8:11], s15 offen offset:0 lds
    v_mfma_f32_16x16x32_bf16 v[72:75], v[8:11], v[16:19], v[72:75]
    ds_read_b64_tr_b16 v[36:37], v129 offset:57344
    v_mfma_f32_16x16x32_bf16 v[76:79], v[12:15], v[16:19], v[76:79]
    ds_read_b64_tr_b16 v[38:39], v129 offset:61440
    v_mfma_f32_16x16x32_bf16 v[80:83], v[0:3], v[20:23], v[80:83]
    ds_read_b64_tr_b16 v[40:41], v130 offset:57344
    buffer_load_dwordx4 v138, s[8:11], s15 offen offset:1024 lds
    v_mfma_f32_16x16x32_bf16 v[84:87], v[4:7], v[20:23], v[84:87]
    ds_read_b64_tr_b16 v[42:43], v130 offset:61440
    v_mfma_f32_16x16x32_bf16 v[88:91], v[8:11], v[20:23], v[88:91]
    ds_read_b64_tr_b16 v[44:45], v131 offset:57344
    v_mfma_f32_16x16x32_bf16 v[92:95], v[12:15], v[20:23], v[92:95]
    ds_read_b64_tr_b16 v[46:47], v131 offset:61440
    buffer_load_dwordx4 v139, s[8:11], s15 offen offset:2048 lds
    v_mfma_f32_16x16x32_bf16 v[96:99], v[0:3], v[24:27], v[96:99]
    ds_read_b128 v[52:55], v136 offset:52224
    v_mfma_f32_16x16x32_bf16 v[100:103], v[4:7], v[24:27], v[100:103]
    ds_read_b128 v[56:59], v136 offset:54272
    buffer_load_dwordx4 v140, s[8:11], s15 offen offset:3072 lds
    v_mfma_f32_16x16x32_bf16 v[104:107], v[8:11], v[24:27], v[104:107]
    ds_read_b128 v[60:63], v136 offset:56320
    v_mfma_f32_16x16x32_bf16 v[108:111], v[12:15], v[24:27], v[108:111]
    v_mfma_f32_16x16x32_bf16 v[112:115], v[0:3], v[28:31], v[112:115]
    s_add_u32 s15, s15, s17
    v_mfma_f32_16x16x32_bf16 v[116:119], v[4:7], v[28:31], v[116:119]
    v_mfma_f32_16x16x32_bf16 v[120:123], v[8:11], v[28:31], v[120:123]
    v_mfma_f32_16x16x32_bf16 v[124:127], v[12:15], v[28:31], v[124:127]
    s_waitcnt lgkmcnt(0)
    v_mfma_f32_16x16x32_bf16 v[64:67], v[32:35], v[48:51], v[64:67]
    s_waitcnt vmcnt(16)
    s_barrier
    ds_read_b128 v[16:19], v136 offset:0
    s_add_u32 m0, s20, 49152
    s_nop 0
    v_mfma_f32_16x16x32_bf16 v[68:71], v[36:39], v[48:51], v[68:71]
    ds_read_b64_tr_b16 v[0:1], v128 offset:0
    v_mfma_f32_16x16x32_bf16 v[72:75], v[40:43], v[48:51], v[72:75]
    ds_read_b64_tr_b16 v[2:3], v128 offset:4096
    buffer_load_dwordx4 v141, s[4:7], s16 offen offset:0 sc1 lds
    v_mfma_f32_16x16x32_bf16 v[76:79], v[44:47], v[48:51], v[76:79]
    ds_read_b64_tr_b16 v[4:5], v129 offset:0
    v_mfma_f32_16x16x32_bf16 v[80:83], v[32:35], v[52:55], v[80:83]
    ds_read_b64_tr_b16 v[6:7], v129 offset:4096
    v_mfma_f32_16x16x32_bf16 v[84:87], v[36:39], v[52:55], v[84:87]
    ds_read_b64_tr_b16 v[8:9], v130 offset:0
    buffer_load_dwordx4 v141, s[4:7], s16 offen offset:1024 sc1 lds
    v_mfma_f32_16x16x32_bf16 v[88:91], v[40:43], v[52:55], v[88:91]
    ds_read_b64_tr_b16 v[10:11], v130 offset:4096
    v_mfma_f32_16x16x32_bf16 v[92:95], v[44:47], v[52:55], v[92:95]
    ds_read_b64_tr_b16 v[12:13], v131 offset:0
    buffer_load_dwordx4 v142, s[4:7], s16 offen offset:2048 sc1 lds
    v_mfma_f32_16x16x32_bf16 v[96:99], v[32:35], v[56:59], v[96:99]
    ds_read_b64_tr_b16 v[14:15], v131 offset:4096
    v_mfma_f32_16x16x32_bf16 v[100:103], v[36:39], v[56:59], v[100:103]
    ds_read_b128 v[20:23], v136 offset:2048
    v_mfma_f32_16x16x32_bf16 v[104:107], v[40:43], v[56:59], v[104:107]
    ds_read_b128 v[24:27], v136 offset:4096
    buffer_load_dwordx4 v142, s[4:7], s16 offen offset:3072 sc1 lds
    v_mfma_f32_16x16x32_bf16 v[108:111], v[44:47], v[56:59], v[108:111]
    ds_read_b128 v[28:31], v136 offset:6144
    v_mfma_f32_16x16x32_bf16 v[112:115], v[32:35], v[60:63], v[112:115]
    s_add_u32 s16, s16, 2048
    v_mfma_f32_16x16x32_bf16 v[116:119], v[36:39], v[60:63], v[116:119]
    v_mfma_f32_16x16x32_bf16 v[120:123], v[40:43], v[60:63], v[120:123]
    v_mfma_f32_16x16x32_bf16 v[124:127], v[44:47], v[60:63], v[124:127]
    s_sub_u32 s18, s18, 1
    s_cmp_lg_u32 s18, 0
    s_cbranch_scc1 main_kernel_w_c0_n_loop
    s_cmp_lg_u32 s14, 0
    s_cbranch_scc1 main_kernel_w_c0_n_nt
    s_lshl_b32 s32, s27, 8
    s_add_u32 s32, s32, 0x841e000
    v_mov_b32 v255, 1
    s_mov_b64 exec, 1
    buffer_atomic_add v255, off, s[4:7], s32 sc0 sc1
    s_mov_b64 exec, -1
main_kernel_w_c0_n_nt:
    s_cmp_lg_u32 s23, 8
    s_cbranch_scc1 main_kernel_w_c0_nlw
    s_lshl_b32 s18, s25, 4
    s_add_u32 s18, s18, s24
    s_lshl_b32 s18, s18, 4
    s_add_u32 s18, s18, 0x8412000
    buffer_load_dword v192, off, s[4:7], s18 sc1
main_kernel_w_c0_nlw:
    s_waitcnt lgkmcnt(0)
    ds_read_b128 v[48:51], v136 offset:1024
    s_add_u32 m0, s19, 49152
    s_nop 0
    v_mfma_f32_16x16x32_bf16 v[64:67], v[0:3], v[16:19], v[64:67]
    ds_read_b64_tr_b16 v[32:33], v128 offset:8192
    v_mfma_f32_16x16x32_bf16 v[68:71], v[4:7], v[16:19], v[68:71]
    ds_read_b64_tr_b16 v[34:35], v128 offset:12288
    buffer_load_dwordx4 v137, s[8:11], s15 offen offset:0 lds
    v_mfma_f32_16x16x32_bf16 v[72:75], v[8:11], v[16:19], v[72:75]
    ds_read_b64_tr_b16 v[36:37], v129 offset:8192
    v_mfma_f32_16x16x32_bf16 v[76:79], v[12:15], v[16:19], v[76:79]
    ds_read_b64_tr_b16 v[38:39], v129 offset:12288
    v_mfma_f32_16x16x32_bf16 v[80:83], v[0:3], v[20:23], v[80:83]
    ds_read_b64_tr_b16 v[40:41], v130 offset:8192
    buffer_load_dwordx4 v138, s[8:11], s15 offen offset:1024 lds
    v_mfma_f32_16x16x32_bf16 v[84:87], v[4:7], v[20:23], v[84:87]
    ds_read_b64_tr_b16 v[42:43], v130 offset:12288
    v_mfma_f32_16x16x32_bf16 v[88:91], v[8:11], v[20:23], v[88:91]
    ds_read_b64_tr_b16 v[44:45], v131 offset:8192
    v_mfma_f32_16x16x32_bf16 v[92:95], v[12:15], v[20:23], v[92:95]
    ds_read_b64_tr_b16 v[46:47], v131 offset:12288
    buffer_load_dwordx4 v139, s[8:11], s15 offen offset:2048 lds
    v_mfma_f32_16x16x32_bf16 v[96:99], v[0:3], v[24:27], v[96:99]
    ds_read_b128 v[52:55], v136 offset:3072
    v_mfma_f32_16x16x32_bf16 v[100:103], v[4:7], v[24:27], v[100:103]
    ds_read_b128 v[56:59], v136 offset:5120
    buffer_load_dwordx4 v140, s[8:11], s15 offen offset:3072 lds
    v_mfma_f32_16x16x32_bf16 v[104:107], v[8:11], v[24:27], v[104:107]
    ds_read_b128 v[60:63], v136 offset:7168
    v_mfma_f32_16x16x32_bf16 v[108:111], v[12:15], v[24:27], v[108:111]
    v_mfma_f32_16x16x32_bf16 v[112:115], v[0:3], v[28:31], v[112:115]
    s_add_u32 s15, s15, s17
    v_mfma_f32_16x16x32_bf16 v[116:119], v[4:7], v[28:31], v[116:119]
    v_mfma_f32_16x16x32_bf16 v[120:123], v[8:11], v[28:31], v[120:123]
    v_mfma_f32_16x16x32_bf16 v[124:127], v[12:15], v[28:31], v[124:127]
    s_waitcnt lgkmcnt(0)
    v_mfma_f32_16x16x32_bf16 v[64:67], v[32:35], v[48:51], v[64:67]
    s_waitcnt vmcnt(16)
    s_barrier
    ds_read_b128 v[16:19], v136 offset:16384
    v_mfma_f32_16x16x32_bf16 v[68:71], v[36:39], v[48:51], v[68:71]
    ds_read_b64_tr_b16 v[0:1], v128 offset:16384
    v_mfma_f32_16x16x32_bf16 v[72:75], v[40:43], v[48:51], v[72:75]
    ds_read_b64_tr_b16 v[2:3], v128 offset:20480
    v_mfma_f32_16x16x32_bf16 v[76:79], v[44:47], v[48:51], v[76:79]
    ds_read_b64_tr_b16 v[4:5], v129 offset:16384
    v_mfma_f32_16x16x32_bf16 v[80:83], v[32:35], v[52:55], v[80:83]
    ds_read_b64_tr_b16 v[6:7], v129 offset:20480
    v_mfma_f32_16x16x32_bf16 v[84:87], v[36:39], v[52:55], v[84:87]
    ds_read_b64_tr_b16 v[8:9], v130 offset:16384
    v_mfma_f32_16x16x32_bf16 v[88:91], v[40:43], v[52:55], v[88:91]
    ds_read_b64_tr_b16 v[10:11], v130 offset:20480
    v_mfma_f32_16x16x32_bf16 v[92:95], v[44:47], v[52:55], v[92:95]
    ds_read_b64_tr_b16 v[12:13], v131 offset:16384
    v_mfma_f32_16x16x32_bf16 v[96:99], v[32:35], v[56:59], v[96:99]
    ds_read_b64_tr_b16 v[14:15], v131 offset:20480
    v_mfma_f32_16x16x32_bf16 v[100:103], v[36:39], v[56:59], v[100:103]
    ds_read_b128 v[20:23], v136 offset:18432
    v_mfma_f32_16x16x32_bf16 v[104:107], v[40:43], v[56:59], v[104:107]
    ds_read_b128 v[24:27], v136 offset:20480
    v_mfma_f32_16x16x32_bf16 v[108:111], v[44:47], v[56:59], v[108:111]
    ds_read_b128 v[28:31], v136 offset:22528
    v_mfma_f32_16x16x32_bf16 v[112:115], v[32:35], v[60:63], v[112:115]
    v_mfma_f32_16x16x32_bf16 v[116:119], v[36:39], v[60:63], v[116:119]
    v_mfma_f32_16x16x32_bf16 v[120:123], v[40:43], v[60:63], v[120:123]
    v_mfma_f32_16x16x32_bf16 v[124:127], v[44:47], v[60:63], v[124:127]
    s_waitcnt lgkmcnt(0)
    ds_read_b128 v[48:51], v136 offset:17408
    v_mfma_f32_16x16x32_bf16 v[64:67], v[0:3], v[16:19], v[64:67]
    ds_read_b64_tr_b16 v[32:33], v128 offset:24576
    v_mfma_f32_16x16x32_bf16 v[68:71], v[4:7], v[16:19], v[68:71]
    ds_read_b64_tr_b16 v[34:35], v128 offset:28672
    v_mfma_f32_16x16x32_bf16 v[72:75], v[8:11], v[16:19], v[72:75]
    ds_read_b64_tr_b16 v[36:37], v129 offset:24576
    v_mfma_f32_16x16x32_bf16 v[76:79], v[12:15], v[16:19], v[76:79]
    ds_read_b64_tr_b16 v[38:39], v129 offset:28672
    v_mfma_f32_16x16x32_bf16 v[80:83], v[0:3], v[20:23], v[80:83]
    ds_read_b64_tr_b16 v[40:41], v130 offset:24576
    v_mfma_f32_16x16x32_bf16 v[84:87], v[4:7], v[20:23], v[84:87]
    ds_read_b64_tr_b16 v[42:43], v130 offset:28672
    v_mfma_f32_16x16x32_bf16 v[88:91], v[8:11], v[20:23], v[88:91]
    ds_read_b64_tr_b16 v[44:45], v131 offset:24576
    v_mfma_f32_16x16x32_bf16 v[92:95], v[12:15], v[20:23], v[92:95]
    ds_read_b64_tr_b16 v[46:47], v131 offset:28672
    v_mfma_f32_16x16x32_bf16 v[96:99], v[0:3], v[24:27], v[96:99]
    ds_read_b128 v[52:55], v136 offset:19456
    v_mfma_f32_16x16x32_bf16 v[100:103], v[4:7], v[24:27], v[100:103]
    ds_read_b128 v[56:59], v136 offset:21504
    v_mfma_f32_16x16x32_bf16 v[104:107], v[8:11], v[24:27], v[104:107]
    ds_read_b128 v[60:63], v136 offset:23552
    v_mfma_f32_16x16x32_bf16 v[108:111], v[12:15], v[24:27], v[108:111]
    v_mfma_f32_16x16x32_bf16 v[112:115], v[0:3], v[28:31], v[112:115]
    v_mfma_f32_16x16x32_bf16 v[116:119], v[4:7], v[28:31], v[116:119]
    v_mfma_f32_16x16x32_bf16 v[120:123], v[8:11], v[28:31], v[120:123]
    v_mfma_f32_16x16x32_bf16 v[124:127], v[12:15], v[28:31], v[124:127]
    s_waitcnt lgkmcnt(0)
    v_mfma_f32_16x16x32_bf16 v[64:67], v[32:35], v[48:51], v[64:67]
    s_waitcnt vmcnt(8)
    s_barrier
    ds_read_b128 v[16:19], v136 offset:32768
    v_mfma_f32_16x16x32_bf16 v[68:71], v[36:39], v[48:51], v[68:71]
    ds_read_b64_tr_b16 v[0:1], v128 offset:32768
    v_mfma_f32_16x16x32_bf16 v[72:75], v[40:43], v[48:51], v[72:75]
    ds_read_b64_tr_b16 v[2:3], v128 offset:36864
    v_mfma_f32_16x16x32_bf16 v[76:79], v[44:47], v[48:51], v[76:79]
    ds_read_b64_tr_b16 v[4:5], v129 offset:32768
    v_mfma_f32_16x16x32_bf16 v[80:83], v[32:35], v[52:55], v[80:83]
    ds_read_b64_tr_b16 v[6:7], v129 offset:36864
    v_mfma_f32_16x16x32_bf16 v[84:87], v[36:39], v[52:55], v[84:87]
    ds_read_b64_tr_b16 v[8:9], v130 offset:32768
    v_mfma_f32_16x16x32_bf16 v[88:91], v[40:43], v[52:55], v[88:91]
    ds_read_b64_tr_b16 v[10:11], v130 offset:36864
    v_mfma_f32_16x16x32_bf16 v[92:95], v[44:47], v[52:55], v[92:95]
    ds_read_b64_tr_b16 v[12:13], v131 offset:32768
    v_mfma_f32_16x16x32_bf16 v[96:99], v[32:35], v[56:59], v[96:99]
    ds_read_b64_tr_b16 v[14:15], v131 offset:36864
    v_mfma_f32_16x16x32_bf16 v[100:103], v[36:39], v[56:59], v[100:103]
    ds_read_b128 v[20:23], v136 offset:34816
    v_mfma_f32_16x16x32_bf16 v[104:107], v[40:43], v[56:59], v[104:107]
    ds_read_b128 v[24:27], v136 offset:36864
    v_mfma_f32_16x16x32_bf16 v[108:111], v[44:47], v[56:59], v[108:111]
    ds_read_b128 v[28:31], v136 offset:38912
    v_mfma_f32_16x16x32_bf16 v[112:115], v[32:35], v[60:63], v[112:115]
    v_mfma_f32_16x16x32_bf16 v[116:119], v[36:39], v[60:63], v[116:119]
    v_mfma_f32_16x16x32_bf16 v[120:123], v[40:43], v[60:63], v[120:123]
    v_mfma_f32_16x16x32_bf16 v[124:127], v[44:47], v[60:63], v[124:127]
    s_waitcnt lgkmcnt(0)
    ds_read_b128 v[48:51], v136 offset:33792
    v_mfma_f32_16x16x32_bf16 v[64:67], v[0:3], v[16:19], v[64:67]
    ds_read_b64_tr_b16 v[32:33], v128 offset:40960
    v_mfma_f32_16x16x32_bf16 v[68:71], v[4:7], v[16:19], v[68:71]
    ds_read_b64_tr_b16 v[34:35], v128 offset:45056
    v_mfma_f32_16x16x32_bf16 v[72:75], v[8:11], v[16:19], v[72:75]
    ds_read_b64_tr_b16 v[36:37], v129 offset:40960
    v_mfma_f32_16x16x32_bf16 v[76:79], v[12:15], v[16:19], v[76:79]
    ds_read_b64_tr_b16 v[38:39], v129 offset:45056
    v_mfma_f32_16x16x32_bf16 v[80:83], v[0:3], v[20:23], v[80:83]
    ds_read_b64_tr_b16 v[40:41], v130 offset:40960
    v_mfma_f32_16x16x32_bf16 v[84:87], v[4:7], v[20:23], v[84:87]
    ds_read_b64_tr_b16 v[42:43], v130 offset:45056
    v_mfma_f32_16x16x32_bf16 v[88:91], v[8:11], v[20:23], v[88:91]
    ds_read_b64_tr_b16 v[44:45], v131 offset:40960
    v_mfma_f32_16x16x32_bf16 v[92:95], v[12:15], v[20:23], v[92:95]
    ds_read_b64_tr_b16 v[46:47], v131 offset:45056
    v_mfma_f32_16x16x32_bf16 v[96:99], v[0:3], v[24:27], v[96:99]
    ds_read_b128 v[52:55], v136 offset:35840
    v_mfma_f32_16x16x32_bf16 v[100:103], v[4:7], v[24:27], v[100:103]
    ds_read_b128 v[56:59], v136 offset:37888
    v_mfma_f32_16x16x32_bf16 v[104:107], v[8:11], v[24:27], v[104:107]
    ds_read_b128 v[60:63], v136 offset:39936
    v_mfma_f32_16x16x32_bf16 v[108:111], v[12:15], v[24:27], v[108:111]
    v_mfma_f32_16x16x32_bf16 v[112:115], v[0:3], v[28:31], v[112:115]
    v_mfma_f32_16x16x32_bf16 v[116:119], v[4:7], v[28:31], v[116:119]
    v_mfma_f32_16x16x32_bf16 v[120:123], v[8:11], v[28:31], v[120:123]
    v_mfma_f32_16x16x32_bf16 v[124:127], v[12:15], v[28:31], v[124:127]
    s_waitcnt lgkmcnt(0)
    v_mfma_f32_16x16x32_bf16 v[64:67], v[32:35], v[48:51], v[64:67]
    s_waitcnt vmcnt(0)
    s_barrier
    ds_read_b128 v[16:19], v136 offset:49152
    v_mfma_f32_16x16x32_bf16 v[68:71], v[36:39], v[48:51], v[68:71]
    ds_read_b64_tr_b16 v[0:1], v128 offset:49152
    v_mfma_f32_16x16x32_bf16 v[72:75], v[40:43], v[48:51], v[72:75]
    ds_read_b64_tr_b16 v[2:3], v128 offset:53248
    v_mfma_f32_16x16x32_bf16 v[76:79], v[44:47], v[48:51], v[76:79]
    ds_read_b64_tr_b16 v[4:5], v129 offset:49152
    v_mfma_f32_16x16x32_bf16 v[80:83], v[32:35], v[52:55], v[80:83]
    ds_read_b64_tr_b16 v[6:7], v129 offset:53248
    v_mfma_f32_16x16x32_bf16 v[84:87], v[36:39], v[52:55], v[84:87]
    ds_read_b64_tr_b16 v[8:9], v130 offset:49152
    v_mfma_f32_16x16x32_bf16 v[88:91], v[40:43], v[52:55], v[88:91]
    ds_read_b64_tr_b16 v[10:11], v130 offset:53248
    v_mfma_f32_16x16x32_bf16 v[92:95], v[44:47], v[52:55], v[92:95]
    ds_read_b64_tr_b16 v[12:13], v131 offset:49152
    v_mfma_f32_16x16x32_bf16 v[96:99], v[32:35], v[56:59], v[96:99]
    ds_read_b64_tr_b16 v[14:15], v131 offset:53248
    v_mfma_f32_16x16x32_bf16 v[100:103], v[36:39], v[56:59], v[100:103]
    ds_read_b128 v[20:23], v136 offset:51200
    v_mfma_f32_16x16x32_bf16 v[104:107], v[40:43], v[56:59], v[104:107]
    ds_read_b128 v[24:27], v136 offset:53248
    v_mfma_f32_16x16x32_bf16 v[108:111], v[44:47], v[56:59], v[108:111]
    ds_read_b128 v[28:31], v136 offset:55296
    v_mfma_f32_16x16x32_bf16 v[112:115], v[32:35], v[60:63], v[112:115]
    v_mfma_f32_16x16x32_bf16 v[116:119], v[36:39], v[60:63], v[116:119]
    v_mfma_f32_16x16x32_bf16 v[120:123], v[40:43], v[60:63], v[120:123]
    v_mfma_f32_16x16x32_bf16 v[124:127], v[44:47], v[60:63], v[124:127]
    v_readfirstlane_b32 s55, v255
    s_cmp_lg_u32 s23, 8
    s_cbranch_scc1 main_kernel_w_c0_lwk
main_kernel_w_c0_lwp:
    v_cmp_eq_u32 vcc, 0, v192
    s_cbranch_vccz main_kernel_w_c0_lwk
    s_sleep 8
    buffer_load_dword v192, off, s[4:7], s18 sc1
    s_waitcnt vmcnt(0)
    s_sub_u32 s29, s29, 1
    s_cbranch_scc0 main_kernel_w_c0_lwp
main_kernel_w_c0_lwk:
    s_cmp_eq_u32 s26, -1
    s_cbranch_scc1 main_kernel_w_c0_nores
    s_add_u32 s32, s26, 0
    buffer_load_dwordx4 v[192:195], v251, s[4:7], s32 offen offset:0 sc1
    buffer_load_dwordx4 v[196:199], v251, s[4:7], s32 offen offset:1024 sc1
    s_add_u32 s32, s26, 32768
    buffer_load_dwordx4 v[200:203], v251, s[4:7], s32 offen offset:0 sc1
    buffer_load_dwordx4 v[204:207], v251, s[4:7], s32 offen offset:1024 sc1
    s_add_u32 s32, s26, 65536
    buffer_load_dwordx4 v[208:211], v251, s[4:7], s32 offen offset:0 sc1
    buffer_load_dwordx4 v[212:215], v251, s[4:7], s32 offen offset:1024 sc1
    s_add_u32 s32, s26, 98304
    buffer_load_dwordx4 v[216:219], v251, s[4:7], s32 offen offset:0 sc1
    buffer_load_dwordx4 v[220:223], v251, s[4:7], s32 offen offset:1024 sc1
main_kernel_w_c0_nores:
    s_waitcnt lgkmcnt(0)
    ds_read_b128 v[48:51], v136 offset:50176
    v_mfma_f32_16x16x32_bf16 v[64:67], v[0:3], v[16:19], v[64:67]
    ds_read_b64_tr_b16 v[32:33], v128 offset:57344
    v_mfma_f32_16x16x32_bf16 v[68:71], v[4:7], v[16:19], v[68:71]
    ds_read_b64_tr_b16 v[34:35], v128 offset:61440
    v_mfma_f32_16x16x32_bf16 v[72:75], v[8:11], v[16:19], v[72:75]
    ds_read_b64_tr_b16 v[36:37], v129 offset:57344
    v_mfma_f32_16x16x32_bf16 v[76:79], v[12:15], v[16:19], v[76:79]
    ds_read_b64_tr_b16 v[38:39], v129 offset:61440
    v_mfma_f32_16x16x32_bf16 v[80:83], v[0:3], v[20:23], v[80:83]
    ds_read_b64_tr_b16 v[40:41], v130 offset:57344
    v_mfma_f32_16x16x32_bf16 v[84:87], v[4:7], v[20:23], v[84:87]
    ds_read_b64_tr_b16 v[42:43], v130 offset:61440
    v_mfma_f32_16x16x32_bf16 v[88:91], v[8:11], v[20:23], v[88:91]
    ds_read_b64_tr_b16 v[44:45], v131 offset:57344
    v_mfma_f32_16x16x32_bf16 v[92:95], v[12:15], v[20:23], v[92:95]
    ds_read_b64_tr_b16 v[46:47], v131 offset:61440
    v_mfma_f32_16x16x32_bf16 v[96:99], v[0:3], v[24:27], v[96:99]
    ds_read_b128 v[52:55], v136 offset:52224
    v_mfma_f32_16x16x32_bf16 v[100:103], v[4:7], v[24:27], v[100:103]
    ds_read_b128 v[56:59], v136 offset:54272
    v_mfma_f32_16x16x32_bf16 v[104:107], v[8:11], v[24:27], v[104:107]
    ds_read_b128 v[60:63], v136 offset:56320
    v_mfma_f32_16x16x32_bf16 v[108:111], v[12:15], v[24:27], v[108:111]
    v_mfma_f32_16x16x32_bf16 v[112:115], v[0:3], v[28:31], v[112:115]
    v_mfma_f32_16x16x32_bf16 v[116:119], v[4:7], v[28:31], v[116:119]
    v_mfma_f32_16x16x32_bf16 v[120:123], v[8:11], v[28:31], v[120:123]
    v_mfma_f32_16x16x32_bf16 v[124:127], v[12:15], v[28:31], v[124:127]
    s_waitcnt lgkmcnt(0)
    v_mfma_f32_16x16x32_bf16 v[64:67], v[32:35], v[48:51], v[64:67]
    v_mfma_f32_16x16x32_bf16 v[68:71], v[36:39], v[48:51], v[68:71]
    v_mfma_f32_16x16x32_bf16 v[72:75], v[40:43], v[48:51], v[72:75]
    v_mfma_f32_16x16x32_bf16 v[76:79], v[44:47], v[48:51], v[76:79]
    v_mfma_f32_16x16x32_bf16 v[80:83], v[32:35], v[52:55], v[80:83]
    v_mfma_f32_16x16x32_bf16 v[84:87], v[36:39], v[52:55], v[84:87]
    v_mfma_f32_16x16x32_bf16 v[88:91], v[40:43], v[52:55], v[88:91]
    v_mfma_f32_16x16x32_bf16 v[92:95], v[44:47], v[52:55], v[92:95]
    v_mfma_f32_16x16x32_bf16 v[96:99], v[32:35], v[56:59], v[96:99]
    v_mfma_f32_16x16x32_bf16 v[100:103], v[36:39], v[56:59], v[100:103]
    v_mfma_f32_16x16x32_bf16 v[104:107], v[40:43], v[56:59], v[104:107]
    v_mfma_f32_16x16x32_bf16 v[108:111], v[44:47], v[56:59], v[108:111]
    v_mfma_f32_16x16x32_bf16 v[112:115], v[32:35], v[60:63], v[112:115]
    v_mfma_f32_16x16x32_bf16 v[116:119], v[36:39], v[60:63], v[116:119]
    v_mfma_f32_16x16x32_bf16 v[120:123], v[40:43], v[60:63], v[120:123]
    v_mfma_f32_16x16x32_bf16 v[124:127], v[44:47], v[60:63], v[124:127]
    s_nop 7
    s_cmp_eq_u32 s23, 4
    s_cbranch_scc1 main_kernel_w_c0_eadd
    s_cmp_eq_u32 s23, 7
    s_cbranch_scc1 main_kernel_w_c0_esilu
    s_cmp_eq_u32 s23, 8
    s_cbranch_scc1 main_kernel_w_c0_efin
main_kernel_w_c0_escl:
    s_mov_b32 s53, s21
    v_mul_f32 v64, 0x3e0293ee, v64
    v_mul_f32 v65, 0x3e0293ee, v65
    v_mul_f32 v66, 0x3e0293ee, v66
    v_mul_f32 v67, 0x3e0293ee, v67
    v_mul_f32 v68, 0x3e0293ee, v68
    v_mul_f32 v69, 0x3e0293ee, v69
    v_mul_f32 v70, 0x3e0293ee, v70
    v_mul_f32 v71, 0x3e0293ee, v71
    v_cvt_pk_bf16_f32 v16, v64, v65
    v_cvt_pk_bf16_f32 v17, v66, v67
    v_cvt_pk_bf16_f32 v18, v68, v69
    v_cvt_pk_bf16_f32 v19, v70, v71
    buffer_store_dwordx4 v[16:19], v251, s[4:7], s53 offen offset:0 sc1
    v_mul_f32 v72, 0x3e0293ee, v72
    v_mul_f32 v73, 0x3e0293ee, v73
    v_mul_f32 v74, 0x3e0293ee, v74
    v_mul_f32 v75, 0x3e0293ee, v75
    v_mul_f32 v76, 0x3e0293ee, v76
    v_mul_f32 v77, 0x3e0293ee, v77
    v_mul_f32 v78, 0x3e0293ee, v78
    v_mul_f32 v79, 0x3e0293ee, v79
    v_cvt_pk_bf16_f32 v36, v72, v73
    v_cvt_pk_bf16_f32 v37, v74, v75
    v_cvt_pk_bf16_f32 v38, v76, v77
    v_cvt_pk_bf16_f32 v39, v78, v79
    buffer_store_dwordx4 v[36:39], v251, s[4:7], s53 offen offset:1024 sc1
    s_add_u32 s53, s53, s22
    v_mul_f32 v80, 0x3e0293ee, v80
    v_mul_f32 v81, 0x3e0293ee, v81
    v_mul_f32 v82, 0x3e0293ee, v82
    v_mul_f32 v83, 0x3e0293ee, v83
    v_mul_f32 v84, 0x3e0293ee, v84
    v_mul_f32 v85, 0x3e0293ee, v85
    v_mul_f32 v86, 0x3e0293ee, v86
    v_mul_f32 v87, 0x3e0293ee, v87
    v_cvt_pk_bf16_f32 v56, v80, v81
    v_cvt_pk_bf16_f32 v57, v82, v83
    v_cvt_pk_bf16_f32 v58, v84, v85
    v_cvt_pk_bf16_f32 v59, v86, v87
    buffer_store_dwordx4 v[56:59], v251, s[4:7], s53 offen offset:0 sc1
    v_mul_f32 v88, 0x3e0293ee, v88
    v_mul_f32 v89, 0x3e0293ee, v89
    v_mul_f32 v90, 0x3e0293ee, v90
    v_mul_f32 v91, 0x3e0293ee, v91
    v_mul_f32 v92, 0x3e0293ee, v92
    v_mul_f32 v93, 0x3e0293ee, v93
    v_mul_f32 v94, 0x3e0293ee, v94
    v_mul_f32 v95, 0x3e0293ee, v95
    v_cvt_pk_bf16_f32 v16, v88, v89
    v_cvt_pk_bf16_f32 v17, v90, v91
    v_cvt_pk_bf16_f32 v18, v92, v93
    v_cvt_pk_bf16_f32 v19, v94, v95
    buffer_store_dwordx4 v[16:19], v251, s[4:7], s53 offen offset:1024 sc1
    s_add_u32 s53, s53, s22
    v_mul_f32 v96, 0x3e0293ee, v96
    v_mul_f32 v97, 0x3e0293ee, v97
    v_mul_f32 v98, 0x3e0293ee, v98
    v_mul_f32 v99, 0x3e0293ee, v99
    v_mul_f32 v100, 0x3e0293ee, v100
    v_mul_f32 v101, 0x3e0293ee, v101
    v_mul_f32 v102, 0x3e0293ee, v102
    v_mul_f32 v103, 0x3e0293ee, v103
    v_cvt_pk_bf16_f32 v36, v96, v97
    v_cvt_pk_bf16_f32 v37, v98, v99
    v_cvt_pk_bf16_f32 v38, v100, v101
    v_cvt_pk_bf16_f32 v39, v102, v103
    buffer_store_dwordx4 v[36:39], v251, s[4:7], s53 offen offset:0 sc1
    v_mul_f32 v104, 0x3e0293ee, v104
    v_mul_f32 v105, 0x3e0293ee, v105
    v_mul_f32 v106, 0x3e0293ee, v106
    v_mul_f32 v107, 0x3e0293ee, v107
    v_mul_f32 v108, 0x3e0293ee, v108
    v_mul_f32 v109, 0x3e0293ee, v109
    v_mul_f32 v110, 0x3e0293ee, v110
    v_mul_f32 v111, 0x3e0293ee, v111
    v_cvt_pk_bf16_f32 v56, v104, v105
    v_cvt_pk_bf16_f32 v57, v106, v107
    v_cvt_pk_bf16_f32 v58, v108, v109
    v_cvt_pk_bf16_f32 v59, v110, v111
    buffer_store_dwordx4 v[56:59], v251, s[4:7], s53 offen offset:1024 sc1
    s_add_u32 s53, s53, s22
    v_mul_f32 v112, 0x3e0293ee, v112
    v_mul_f32 v113, 0x3e0293ee, v113
    v_mul_f32 v114, 0x3e0293ee, v114
    v_mul_f32 v115, 0x3e0293ee, v115
    v_mul_f32 v116, 0x3e0293ee, v116
    v_mul_f32 v117, 0x3e0293ee, v117
    v_mul_f32 v118, 0x3e0293ee, v118
    v_mul_f32 v119, 0x3e0293ee, v119
    v_cvt_pk_bf16_f32 v16, v112, v113
    v_cvt_pk_bf16_f32 v17, v114, v115
    v_cvt_pk_bf16_f32 v18, v116, v117
    v_cvt_pk_bf16_f32 v19, v118, v119
    buffer_store_dwordx4 v[16:19], v251, s[4:7], s53 offen offset:0 sc1
    v_mul_f32 v120, 0x3e0293ee, v120
    v_mul_f32 v121, 0x3e0293ee, v121
    v_mul_f32 v122, 0x3e0293ee, v122
    v_mul_f32 v123, 0x3e0293ee, v123
    v_mul_f32 v124, 0x3e0293ee, v124
    v_mul_f32 v125, 0x3e0293ee, v125
    v_mul_f32 v126, 0x3e0293ee, v126
    v_mul_f32 v127, 0x3e0293ee, v127
    v_cvt_pk_bf16_f32 v36, v120, v121
    v_cvt_pk_bf16_f32 v37, v122, v123
    v_cvt_pk_bf16_f32 v38, v124, v125
    v_cvt_pk_bf16_f32 v39, v126, v127
    buffer_store_dwordx4 v[36:39], v251, s[4:7], s53 offen offset:1024 sc1
    s_branch main_kernel_w_done
main_kernel_w_c0_eadd:
    s_mov_b32 s53, s21
    s_waitcnt vmcnt(7)
    v_lshlrev_b32 v8, 16, v192
    v_and_b32 v9, 0xffff0000, v192
    v_lshlrev_b32 v10, 16, v193
    v_and_b32 v11, 0xffff0000, v193
    v_lshlrev_b32 v12, 16, v194
    v_and_b32 v13, 0xffff0000, v194
    v_lshlrev_b32 v14, 16, v195
    v_and_b32 v15, 0xffff0000, v195
    v_pk_add_f32 v[64:65], v[64:65], v[8:9]
    v_pk_add_f32 v[66:67], v[66:67], v[10:11]
    v_pk_add_f32 v[68:69], v[68:69], v[12:13]
    v_pk_add_f32 v[70:71], v[70:71], v[14:15]
    v_cvt_pk_bf16_f32 v16, v64, v65
    v_cvt_pk_bf16_f32 v17, v66, v67
    v_cvt_pk_bf16_f32 v18, v68, v69
    v_cvt_pk_bf16_f32 v19, v70, v71
    buffer_store_dwordx4 v[16:19], v251, s[4:7], s53 offen offset:0 sc1
    s_waitcnt vmcnt(7)
    v_lshlrev_b32 v28, 16, v196
    v_and_b32 v29, 0xffff0000, v196
    v_lshlrev_b32 v30, 16, v197
    v_and_b32 v31, 0xffff0000, v197
    v_lshlrev_b32 v32, 16, v198
    v_and_b32 v33, 0xffff0000, v198
    v_lshlrev_b32 v34, 16, v199
    v_and_b32 v35, 0xffff0000, v199
    v_pk_add_f32 v[72:73], v[72:73], v[28:29]
    v_pk_add_f32 v[74:75], v[74:75], v[30:31]
    v_pk_add_f32 v[76:77], v[76:77], v[32:33]
    v_pk_add_f32 v[78:79], v[78:79], v[34:35]
    v_cvt_pk_bf16_f32 v36, v72, v73
    v_cvt_pk_bf16_f32 v37, v74, v75
    v_cvt_pk_bf16_f32 v38, v76, v77
    v_cvt_pk_bf16_f32 v39, v78, v79
    buffer_store_dwordx4 v[36:39], v251, s[4:7], s53 offen offset:1024 sc1
    s_add_u32 s53, s53, s22
    s_waitcnt vmcnt(7)
    v_lshlrev_b32 v48, 16, v200
    v_and_b32 v49, 0xffff0000, v200
    v_lshlrev_b32 v50, 16, v201
    v_and_b32 v51, 0xffff0000, v201
    v_lshlrev_b32 v52, 16, v202
    v_and_b32 v53, 0xffff0000, v202
    v_lshlrev_b32 v54, 16, v203
    v_and_b32 v55, 0xffff0000, v203
    v_pk_add_f32 v[80:81], v[80:81], v[48:49]
    v_pk_add_f32 v[82:83], v[82:83], v[50:51]
    v_pk_add_f32 v[84:85], v[84:85], v[52:53]
    v_pk_add_f32 v[86:87], v[86:87], v[54:55]
    v_cvt_pk_bf16_f32 v56, v80, v81
    v_cvt_pk_bf16_f32 v57, v82, v83
    v_cvt_pk_bf16_f32 v58, v84, v85
    v_cvt_pk_bf16_f32 v59, v86, v87
    buffer_store_dwordx4 v[56:59], v251, s[4:7], s53 offen offset:0 sc1
    s_waitcnt vmcnt(7)
    v_lshlrev_b32 v8, 16, v204
    v_and_b32 v9, 0xffff0000, v204
    v_lshlrev_b32 v10, 16, v205
    v_and_b32 v11, 0xffff0000, v205
    v_lshlrev_b32 v12, 16, v206
    v_and_b32 v13, 0xffff0000, v206
    v_lshlrev_b32 v14, 16, v207
    v_and_b32 v15, 0xffff0000, v207
    v_pk_add_f32 v[88:89], v[88:89], v[8:9]
    v_pk_add_f32 v[90:91], v[90:91], v[10:11]
    v_pk_add_f32 v[92:93], v[92:93], v[12:13]
    v_pk_add_f32 v[94:95], v[94:95], v[14:15]
    v_cvt_pk_bf16_f32 v16, v88, v89
    v_cvt_pk_bf16_f32 v17, v90, v91
    v_cvt_pk_bf16_f32 v18, v92, v93
    v_cvt_pk_bf16_f32 v19, v94, v95
    buffer_store_dwordx4 v[16:19], v251, s[4:7], s53 offen offset:1024 sc1
    s_add_u32 s53, s53, s22
    s_waitcnt vmcnt(7)
    v_lshlrev_b32 v28, 16, v208
    v_and_b32 v29, 0xffff0000, v208
    v_lshlrev_b32 v30, 16, v209
    v_and_b32 v31, 0xffff0000, v209
    v_lshlrev_b32 v32, 16, v210
    v_and_b32 v33, 0xffff0000, v210
    v_lshlrev_b32 v34, 16, v211
    v_and_b32 v35, 0xffff0000, v211
    v_pk_add_f32 v[96:97], v[96:97], v[28:29]
    v_pk_add_f32 v[98:99], v[98:99], v[30:31]
    v_pk_add_f32 v[100:101], v[100:101], v[32:33]
    v_pk_add_f32 v[102:103], v[102:103], v[34:35]
    v_cvt_pk_bf16_f32 v36, v96, v97
    v_cvt_pk_bf16_f32 v37, v98, v99
    v_cvt_pk_bf16_f32 v38, v100, v101
    v_cvt_pk_bf16_f32 v39, v102, v103
    buffer_store_dwordx4 v[36:39], v251, s[4:7], s53 offen offset:0 sc1
    s_waitcnt vmcnt(7)
    v_lshlrev_b32 v48, 16, v212
    v_and_b32 v49, 0xffff0000, v212
    v_lshlrev_b32 v50, 16, v213
    v_and_b32 v51, 0xffff0000, v213
    v_lshlrev_b32 v52, 16, v214
    v_and_b32 v53, 0xffff0000, v214
    v_lshlrev_b32 v54, 16, v215
    v_and_b32 v55, 0xffff0000, v215
    v_pk_add_f32 v[104:105], v[104:105], v[48:49]
    v_pk_add_f32 v[106:107], v[106:107], v[50:51]
    v_pk_add_f32 v[108:109], v[108:109], v[52:53]
    v_pk_add_f32 v[110:111], v[110:111], v[54:55]
    v_cvt_pk_bf16_f32 v56, v104, v105
    v_cvt_pk_bf16_f32 v57, v106, v107
    v_cvt_pk_bf16_f32 v58, v108, v109
    v_cvt_pk_bf16_f32 v59, v110, v111
    buffer_store_dwordx4 v[56:59], v251, s[4:7], s53 offen offset:1024 sc1
    s_add_u32 s53, s53, s22
    s_waitcnt vmcnt(7)
    v_lshlrev_b32 v8, 16, v216
    v_and_b32 v9, 0xffff0000, v216
    v_lshlrev_b32 v10, 16, v217
    v_and_b32 v11, 0xffff0000, v217
    v_lshlrev_b32 v12, 16, v218
    v_and_b32 v13, 0xffff0000, v218
    v_lshlrev_b32 v14, 16, v219
    v_and_b32 v15, 0xffff0000, v219
    v_pk_add_f32 v[112:113], v[112:113], v[8:9]
    v_pk_add_f32 v[114:115], v[114:115], v[10:11]
    v_pk_add_f32 v[116:117], v[116:117], v[12:13]
    v_pk_add_f32 v[118:119], v[118:119], v[14:15]
    v_cvt_pk_bf16_f32 v16, v112, v113
    v_cvt_pk_bf16_f32 v17, v114, v115
    v_cvt_pk_bf16_f32 v18, v116, v117
    v_cvt_pk_bf16_f32 v19, v118, v119
    buffer_store_dwordx4 v[16:19], v251, s[4:7], s53 offen offset:0 sc1
    s_waitcnt vmcnt(7)
    v_lshlrev_b32 v28, 16, v220
    v_and_b32 v29, 0xffff0000, v220
    v_lshlrev_b32 v30, 16, v221
    v_and_b32 v31, 0xffff0000, v221
    v_lshlrev_b32 v32, 16, v222
    v_and_b32 v33, 0xffff0000, v222
    v_lshlrev_b32 v34, 16, v223
    v_and_b32 v35, 0xffff0000, v223
    v_pk_add_f32 v[120:121], v[120:121], v[28:29]
    v_pk_add_f32 v[122:123], v[122:123], v[30:31]
    v_pk_add_f32 v[124:125], v[124:125], v[32:33]
    v_pk_add_f32 v[126:127], v[126:127], v[34:35]
    v_cvt_pk_bf16_f32 v36, v120, v121
    v_cvt_pk_bf16_f32 v37, v122, v123
    v_cvt_pk_bf16_f32 v38, v124, v125
    v_cvt_pk_bf16_f32 v39, v126, v127
    buffer_store_dwordx4 v[36:39], v251, s[4:7], s53 offen offset:1024 sc1
    s_branch main_kernel_w_done
main_kernel_w_c0_esilu:
    s_mov_b32 s53, s21
    s_waitcnt vmcnt(7)
    v_lshlrev_b32 v8, 16, v192
    v_and_b32 v9, 0xffff0000, v192
    v_lshlrev_b32 v10, 16, v193
    v_and_b32 v11, 0xffff0000, v193
    v_lshlrev_b32 v12, 16, v194
    v_and_b32 v13, 0xffff0000, v194
    v_lshlrev_b32 v14, 16, v195
    v_and_b32 v15, 0xffff0000, v195
    v_pk_add_f32 v[64:65], v[64:65], v[8:9]
    v_pk_add_f32 v[66:67], v[66:67], v[10:11]
    v_pk_add_f32 v[68:69], v[68:69], v[12:13]
    v_pk_add_f32 v[70:71], v[70:71], v[14:15]
    v_pk_mul_f32 v[8:9], v[64:65], v[246:247]
    v_pk_mul_f32 v[10:11], v[66:67], v[246:247]
    v_pk_mul_f32 v[12:13], v[68:69], v[246:247]
    v_pk_mul_f32 v[14:15], v[70:71], v[246:247]
    v_exp_f32 v8, v8
    v_exp_f32 v9, v9
    v_exp_f32 v10, v10
    v_exp_f32 v11, v11
    v_exp_f32 v12, v12
    v_exp_f32 v13, v13
    v_exp_f32 v14, v14
    v_exp_f32 v15, v15
    v_pk_add_f32 v[8:9], v[8:9], v[244:245]
    v_pk_add_f32 v[10:11], v[10:11], v[244:245]
    v_pk_add_f32 v[12:13], v[12:13], v[244:245]
    v_pk_add_f32 v[14:15], v[14:15], v[244:245]
    v_rcp_f32 v8, v8
    v_rcp_f32 v9, v9
    v_rcp_f32 v10, v10
    v_rcp_f32 v11, v11
    v_rcp_f32 v12, v12
    v_rcp_f32 v13, v13
    v_rcp_f32 v14, v14
    v_rcp_f32 v15, v15
    v_pk_mul_f32 v[64:65], v[8:9], v[64:65]
    v_pk_mul_f32 v[66:67], v[10:11], v[66:67]
    v_pk_mul_f32 v[68:69], v[12:13], v[68:69]
    v_pk_mul_f32 v[70:71], v[14:15], v[70:71]
    v_cvt_pk_bf16_f32 v16, v64, v65
    v_cvt_pk_bf16_f32 v17, v66, v67
    v_cvt_pk_bf16_f32 v18, v68, v69
    v_cvt_pk_bf16_f32 v19, v70, v71
    buffer_store_dwordx4 v[16:19], v251, s[4:7], s53 offen offset:0 sc1
    s_waitcnt vmcnt(7)
    v_lshlrev_b32 v28, 16, v196
    v_and_b32 v29, 0xffff0000, v196
    v_lshlrev_b32 v30, 16, v197
    v_and_b32 v31, 0xffff0000, v197
    v_lshlrev_b32 v32, 16, v198
    v_and_b32 v33, 0xffff0000, v198
    v_lshlrev_b32 v34, 16, v199
    v_and_b32 v35, 0xffff0000, v199
    v_pk_add_f32 v[72:73], v[72:73], v[28:29]
    v_pk_add_f32 v[74:75], v[74:75], v[30:31]
    v_pk_add_f32 v[76:77], v[76:77], v[32:33]
    v_pk_add_f32 v[78:79], v[78:79], v[34:35]
    v_pk_mul_f32 v[28:29], v[72:73], v[246:247]
    v_pk_mul_f32 v[30:31], v[74:75], v[246:247]
    v_pk_mul_f32 v[32:33], v[76:77], v[246:247]
    v_pk_mul_f32 v[34:35], v[78:79], v[246:247]
    v_exp_f32 v28, v28
    v_exp_f32 v29, v29
    v_exp_f32 v30, v30
    v_exp_f32 v31, v31
    v_exp_f32 v32, v32
    v_exp_f32 v33, v33
    v_exp_f32 v34, v34
    v_exp_f32 v35, v35
    v_pk_add_f32 v[28:29], v[28:29], v[244:245]
    v_pk_add_f32 v[30:31], v[30:31], v[244:245]
    v_pk_add_f32 v[32:33], v[32:33], v[244:245]
    v_pk_add_f32 v[34:35], v[34:35], v[244:245]
    v_rcp_f32 v28, v28
    v_rcp_f32 v29, v29
    v_rcp_f32 v30, v30
    v_rcp_f32 v31, v31
    v_rcp_f32 v32, v32
    v_rcp_f32 v33, v33
    v_rcp_f32 v34, v34
    v_rcp_f32 v35, v35
    v_pk_mul_f32 v[72:73], v[28:29], v[72:73]
    v_pk_mul_f32 v[74:75], v[30:31], v[74:75]
    v_pk_mul_f32 v[76:77], v[32:33], v[76:77]
    v_pk_mul_f32 v[78:79], v[34:35], v[78:79]
    v_cvt_pk_bf16_f32 v36, v72, v73
    v_cvt_pk_bf16_f32 v37, v74, v75
    v_cvt_pk_bf16_f32 v38, v76, v77
    v_cvt_pk_bf16_f32 v39, v78, v79
    buffer_store_dwordx4 v[36:39], v251, s[4:7], s53 offen offset:1024 sc1
    s_add_u32 s53, s53, s22
    s_waitcnt vmcnt(7)
    v_lshlrev_b32 v48, 16, v200
    v_and_b32 v49, 0xffff0000, v200
    v_lshlrev_b32 v50, 16, v201
    v_and_b32 v51, 0xffff0000, v201
    v_lshlrev_b32 v52, 16, v202
    v_and_b32 v53, 0xffff0000, v202
    v_lshlrev_b32 v54, 16, v203
    v_and_b32 v55, 0xffff0000, v203
    v_pk_add_f32 v[80:81], v[80:81], v[48:49]
    v_pk_add_f32 v[82:83], v[82:83], v[50:51]
    v_pk_add_f32 v[84:85], v[84:85], v[52:53]
    v_pk_add_f32 v[86:87], v[86:87], v[54:55]
    v_pk_mul_f32 v[48:49], v[80:81], v[246:247]
    v_pk_mul_f32 v[50:51], v[82:83], v[246:247]
    v_pk_mul_f32 v[52:53], v[84:85], v[246:247]
    v_pk_mul_f32 v[54:55], v[86:87], v[246:247]
    v_exp_f32 v48, v48
    v_exp_f32 v49, v49
    v_exp_f32 v50, v50
    v_exp_f32 v51, v51
    v_exp_f32 v52, v52
    v_exp_f32 v53, v53
    v_exp_f32 v54, v54
    v_exp_f32 v55, v55
    v_pk_add_f32 v[48:49], v[48:49], v[244:245]
    v_pk_add_f32 v[50:51], v[50:51], v[244:245]
    v_pk_add_f32 v[52:53], v[52:53], v[244:245]
    v_pk_add_f32 v[54:55], v[54:55], v[244:245]
    v_rcp_f32 v48, v48
    v_rcp_f32 v49, v49
    v_rcp_f32 v50, v50
    v_rcp_f32 v51, v51
    v_rcp_f32 v52, v52
    v_rcp_f32 v53, v53
    v_rcp_f32 v54, v54
    v_rcp_f32 v55, v55
    v_pk_mul_f32 v[80:81], v[48:49], v[80:81]
    v_pk_mul_f32 v[82:83], v[50:51], v[82:83]
    v_pk_mul_f32 v[84:85], v[52:53], v[84:85]
    v_pk_mul_f32 v[86:87], v[54:55], v[86:87]
    v_cvt_pk_bf16_f32 v56, v80, v81
    v_cvt_pk_bf16_f32 v57, v82, v83
    v_cvt_pk_bf16_f32 v58, v84, v85
    v_cvt_pk_bf16_f32 v59, v86, v87
    buffer_store_dwordx4 v[56:59], v251, s[4:7], s53 offen offset:0 sc1
    s_waitcnt vmcnt(7)
    v_lshlrev_b32 v8, 16, v204
    v_and_b32 v9, 0xffff0000, v204
    v_lshlrev_b32 v10, 16, v205
    v_and_b32 v11, 0xffff0000, v205
    v_lshlrev_b32 v12, 16, v206
    v_and_b32 v13, 0xffff0000, v206
    v_lshlrev_b32 v14, 16, v207
    v_and_b32 v15, 0xffff0000, v207
    v_pk_add_f32 v[88:89], v[88:89], v[8:9]
    v_pk_add_f32 v[90:91], v[90:91], v[10:11]
    v_pk_add_f32 v[92:93], v[92:93], v[12:13]
    v_pk_add_f32 v[94:95], v[94:95], v[14:15]
    v_pk_mul_f32 v[8:9], v[88:89], v[246:247]
    v_pk_mul_f32 v[10:11], v[90:91], v[246:247]
    v_pk_mul_f32 v[12:13], v[92:93], v[246:247]
    v_pk_mul_f32 v[14:15], v[94:95], v[246:247]
    v_exp_f32 v8, v8
    v_exp_f32 v9, v9
    v_exp_f32 v10, v10
    v_exp_f32 v11, v11
    v_exp_f32 v12, v12
    v_exp_f32 v13, v13
    v_exp_f32 v14, v14
    v_exp_f32 v15, v15
    v_pk_add_f32 v[8:9], v[8:9], v[244:245]
    v_pk_add_f32 v[10:11], v[10:11], v[244:245]
    v_pk_add_f32 v[12:13], v[12:13], v[244:245]
    v_pk_add_f32 v[14:15], v[14:15], v[244:245]
    v_rcp_f32 v8, v8
    v_rcp_f32 v9, v9
    v_rcp_f32 v10, v10
    v_rcp_f32 v11, v11
    v_rcp_f32 v12, v12
    v_rcp_f32 v13, v13
    v_rcp_f32 v14, v14
    v_rcp_f32 v15, v15
    v_pk_mul_f32 v[88:89], v[8:9], v[88:89]
    v_pk_mul_f32 v[90:91], v[10:11], v[90:91]
    v_pk_mul_f32 v[92:93], v[12:13], v[92:93]
    v_pk_mul_f32 v[94:95], v[14:15], v[94:95]
    v_cvt_pk_bf16_f32 v16, v88, v89
    v_cvt_pk_bf16_f32 v17, v90, v91
    v_cvt_pk_bf16_f32 v18, v92, v93
    v_cvt_pk_bf16_f32 v19, v94, v95
    buffer_store_dwordx4 v[16:19], v251, s[4:7], s53 offen offset:1024 sc1
    s_add_u32 s53, s53, s22
    s_waitcnt vmcnt(7)
    v_lshlrev_b32 v28, 16, v208
    v_and_b32 v29, 0xffff0000, v208
    v_lshlrev_b32 v30, 16, v209
    v_and_b32 v31, 0xffff0000, v209
    v_lshlrev_b32 v32, 16, v210
    v_and_b32 v33, 0xffff0000, v210
    v_lshlrev_b32 v34, 16, v211
    v_and_b32 v35, 0xffff0000, v211
    v_pk_add_f32 v[96:97], v[96:97], v[28:29]
    v_pk_add_f32 v[98:99], v[98:99], v[30:31]
    v_pk_add_f32 v[100:101], v[100:101], v[32:33]
    v_pk_add_f32 v[102:103], v[102:103], v[34:35]
    v_pk_mul_f32 v[28:29], v[96:97], v[246:247]
    v_pk_mul_f32 v[30:31], v[98:99], v[246:247]
    v_pk_mul_f32 v[32:33], v[100:101], v[246:247]
    v_pk_mul_f32 v[34:35], v[102:103], v[246:247]
    v_exp_f32 v28, v28
    v_exp_f32 v29, v29
    v_exp_f32 v30, v30
    v_exp_f32 v31, v31
    v_exp_f32 v32, v32
    v_exp_f32 v33, v33
    v_exp_f32 v34, v34
    v_exp_f32 v35, v35
    v_pk_add_f32 v[28:29], v[28:29], v[244:245]
    v_pk_add_f32 v[30:31], v[30:31], v[244:245]
    v_pk_add_f32 v[32:33], v[32:33], v[244:245]
    v_pk_add_f32 v[34:35], v[34:35], v[244:245]
    v_rcp_f32 v28, v28
    v_rcp_f32 v29, v29
    v_rcp_f32 v30, v30
    v_rcp_f32 v31, v31
    v_rcp_f32 v32, v32
    v_rcp_f32 v33, v33
    v_rcp_f32 v34, v34
    v_rcp_f32 v35, v35
    v_pk_mul_f32 v[96:97], v[28:29], v[96:97]
    v_pk_mul_f32 v[98:99], v[30:31], v[98:99]
    v_pk_mul_f32 v[100:101], v[32:33], v[100:101]
    v_pk_mul_f32 v[102:103], v[34:35], v[102:103]
    v_cvt_pk_bf16_f32 v36, v96, v97
    v_cvt_pk_bf16_f32 v37, v98, v99
    v_cvt_pk_bf16_f32 v38, v100, v101
    v_cvt_pk_bf16_f32 v39, v102, v103
    buffer_store_dwordx4 v[36:39], v251, s[4:7], s53 offen offset:0 sc1
    s_waitcnt vmcnt(7)
    v_lshlrev_b32 v48, 16, v212
    v_and_b32 v49, 0xffff0000, v212
    v_lshlrev_b32 v50, 16, v213
    v_and_b32 v51, 0xffff0000, v213
    v_lshlrev_b32 v52, 16, v214
    v_and_b32 v53, 0xffff0000, v214
    v_lshlrev_b32 v54, 16, v215
    v_and_b32 v55, 0xffff0000, v215
    v_pk_add_f32 v[104:105], v[104:105], v[48:49]
    v_pk_add_f32 v[106:107], v[106:107], v[50:51]
    v_pk_add_f32 v[108:109], v[108:109], v[52:53]
    v_pk_add_f32 v[110:111], v[110:111], v[54:55]
    v_pk_mul_f32 v[48:49], v[104:105], v[246:247]
    v_pk_mul_f32 v[50:51], v[106:107], v[246:247]
    v_pk_mul_f32 v[52:53], v[108:109], v[246:247]
    v_pk_mul_f32 v[54:55], v[110:111], v[246:247]
    v_exp_f32 v48, v48
    v_exp_f32 v49, v49
    v_exp_f32 v50, v50
    v_exp_f32 v51, v51
    v_exp_f32 v52, v52
    v_exp_f32 v53, v53
    v_exp_f32 v54, v54
    v_exp_f32 v55, v55
    v_pk_add_f32 v[48:49], v[48:49], v[244:245]
    v_pk_add_f32 v[50:51], v[50:51], v[244:245]
    v_pk_add_f32 v[52:53], v[52:53], v[244:245]
    v_pk_add_f32 v[54:55], v[54:55], v[244:245]
    v_rcp_f32 v48, v48
    v_rcp_f32 v49, v49
    v_rcp_f32 v50, v50
    v_rcp_f32 v51, v51
    v_rcp_f32 v52, v52
    v_rcp_f32 v53, v53
    v_rcp_f32 v54, v54
    v_rcp_f32 v55, v55
    v_pk_mul_f32 v[104:105], v[48:49], v[104:105]
    v_pk_mul_f32 v[106:107], v[50:51], v[106:107]
    v_pk_mul_f32 v[108:109], v[52:53], v[108:109]
    v_pk_mul_f32 v[110:111], v[54:55], v[110:111]
    v_cvt_pk_bf16_f32 v56, v104, v105
    v_cvt_pk_bf16_f32 v57, v106, v107
    v_cvt_pk_bf16_f32 v58, v108, v109
    v_cvt_pk_bf16_f32 v59, v110, v111
    buffer_store_dwordx4 v[56:59], v251, s[4:7], s53 offen offset:1024 sc1
    s_add_u32 s53, s53, s22
    s_waitcnt vmcnt(7)
    v_lshlrev_b32 v8, 16, v216
    v_and_b32 v9, 0xffff0000, v216
    v_lshlrev_b32 v10, 16, v217
    v_and_b32 v11, 0xffff0000, v217
    v_lshlrev_b32 v12, 16, v218
    v_and_b32 v13, 0xffff0000, v218
    v_lshlrev_b32 v14, 16, v219
    v_and_b32 v15, 0xffff0000, v219
    v_pk_add_f32 v[112:113], v[112:113], v[8:9]
    v_pk_add_f32 v[114:115], v[114:115], v[10:11]
    v_pk_add_f32 v[116:117], v[116:117], v[12:13]
    v_pk_add_f32 v[118:119], v[118:119], v[14:15]
    v_pk_mul_f32 v[8:9], v[112:113], v[246:247]
    v_pk_mul_f32 v[10:11], v[114:115], v[246:247]
    v_pk_mul_f32 v[12:13], v[116:117], v[246:247]
    v_pk_mul_f32 v[14:15], v[118:119], v[246:247]
    v_exp_f32 v8, v8
    v_exp_f32 v9, v9
    v_exp_f32 v10, v10
    v_exp_f32 v11, v11
    v_exp_f32 v12, v12
    v_exp_f32 v13, v13
    v_exp_f32 v14, v14
    v_exp_f32 v15, v15
    v_pk_add_f32 v[8:9], v[8:9], v[244:245]
    v_pk_add_f32 v[10:11], v[10:11], v[244:245]
    v_pk_add_f32 v[12:13], v[12:13], v[244:245]
    v_pk_add_f32 v[14:15], v[14:15], v[244:245]
    v_rcp_f32 v8, v8
    v_rcp_f32 v9, v9
    v_rcp_f32 v10, v10
    v_rcp_f32 v11, v11
    v_rcp_f32 v12, v12
    v_rcp_f32 v13, v13
    v_rcp_f32 v14, v14
    v_rcp_f32 v15, v15
    v_pk_mul_f32 v[112:113], v[8:9], v[112:113]
    v_pk_mul_f32 v[114:115], v[10:11], v[114:115]
    v_pk_mul_f32 v[116:117], v[12:13], v[116:117]
    v_pk_mul_f32 v[118:119], v[14:15], v[118:119]
    v_cvt_pk_bf16_f32 v16, v112, v113
    v_cvt_pk_bf16_f32 v17, v114, v115
    v_cvt_pk_bf16_f32 v18, v116, v117
    v_cvt_pk_bf16_f32 v19, v118, v119
    buffer_store_dwordx4 v[16:19], v251, s[4:7], s53 offen offset:0 sc1
    s_waitcnt vmcnt(7)
    v_lshlrev_b32 v28, 16, v220
    v_and_b32 v29, 0xffff0000, v220
    v_lshlrev_b32 v30, 16, v221
    v_and_b32 v31, 0xffff0000, v221
    v_lshlrev_b32 v32, 16, v222
    v_and_b32 v33, 0xffff0000, v222
    v_lshlrev_b32 v34, 16, v223
    v_and_b32 v35, 0xffff0000, v223
    v_pk_add_f32 v[120:121], v[120:121], v[28:29]
    v_pk_add_f32 v[122:123], v[122:123], v[30:31]
    v_pk_add_f32 v[124:125], v[124:125], v[32:33]
    v_pk_add_f32 v[126:127], v[126:127], v[34:35]
    v_pk_mul_f32 v[28:29], v[120:121], v[246:247]
    v_pk_mul_f32 v[30:31], v[122:123], v[246:247]
    v_pk_mul_f32 v[32:33], v[124:125], v[246:247]
    v_pk_mul_f32 v[34:35], v[126:127], v[246:247]
    v_exp_f32 v28, v28
    v_exp_f32 v29, v29
    v_exp_f32 v30, v30
    v_exp_f32 v31, v31
    v_exp_f32 v32, v32
    v_exp_f32 v33, v33
    v_exp_f32 v34, v34
    v_exp_f32 v35, v35
    v_pk_add_f32 v[28:29], v[28:29], v[244:245]
    v_pk_add_f32 v[30:31], v[30:31], v[244:245]
    v_pk_add_f32 v[32:33], v[32:33], v[244:245]
    v_pk_add_f32 v[34:35], v[34:35], v[244:245]
    v_rcp_f32 v28, v28
    v_rcp_f32 v29, v29
    v_rcp_f32 v30, v30
    v_rcp_f32 v31, v31
    v_rcp_f32 v32, v32
    v_rcp_f32 v33, v33
    v_rcp_f32 v34, v34
    v_rcp_f32 v35, v35
    v_pk_mul_f32 v[120:121], v[28:29], v[120:121]
    v_pk_mul_f32 v[122:123], v[30:31], v[122:123]
    v_pk_mul_f32 v[124:125], v[32:33], v[124:125]
    v_pk_mul_f32 v[126:127], v[34:35], v[126:127]
    v_cvt_pk_bf16_f32 v36, v120, v121
    v_cvt_pk_bf16_f32 v37, v122, v123
    v_cvt_pk_bf16_f32 v38, v124, v125
    v_cvt_pk_bf16_f32 v39, v126, v127
    buffer_store_dwordx4 v[36:39], v251, s[4:7], s53 offen offset:1024 sc1
    s_branch main_kernel_w_done
main_kernel_w_c0_efin:
    s_mov_b32 s53, s21
    s_add_u32 s32, s21, 0
    buffer_load_dwordx4 v[160:163], v252, s[96:99], s32 offen offset:0
    buffer_load_dwordx4 v[164:167], v252, s[96:99], s32 offen offset:64
    s_add_u32 s32, s21, 32768
    buffer_load_dwordx4 v[168:171], v252, s[96:99], s32 offen offset:0
    buffer_load_dwordx4 v[172:175], v252, s[96:99], s32 offen offset:64
    s_add_u32 s32, s21, 65536
    buffer_load_dwordx4 v[176:179], v252, s[96:99], s32 offen offset:0
    buffer_load_dwordx4 v[180:183], v252, s[96:99], s32 offen offset:64
    s_add_u32 s32, s21, 98304
    buffer_load_dwordx4 v[184:187], v252, s[96:99], s32 offen offset:0
    buffer_load_dwordx4 v[188:191], v252, s[96:99], s32 offen offset:64
    s_waitcnt vmcnt(7)
    v_permlane16_swap_b32 v160, v162
    v_permlane16_swap_b32 v161, v163
    v_lshlrev_b32 v8, 16, v192
    v_and_b32 v9, 0xffff0000, v192
    v_lshlrev_b32 v10, 16, v193
    v_and_b32 v11, 0xffff0000, v193
    v_lshlrev_b32 v12, 16, v194
    v_and_b32 v13, 0xffff0000, v194
    v_lshlrev_b32 v14, 16, v195
    v_and_b32 v15, 0xffff0000, v195
    v_permlane32_swap_b32 v160, v162
    v_permlane32_swap_b32 v161, v163
    v_lshlrev_b32 v16, 16, v160
    v_and_b32 v17, 0xffff0000, v160
    v_lshlrev_b32 v18, 16, v161
    v_and_b32 v19, 0xffff0000, v161
    v_lshlrev_b32 v20, 16, v162
    v_and_b32 v21, 0xffff0000, v162
    v_lshlrev_b32 v22, 16, v163
    v_and_b32 v23, 0xffff0000, v163
    v_pk_fma_f32 v[8:9], v[64:65], v[8:9], v[16:17]
    v_pk_fma_f32 v[10:11], v[66:67], v[10:11], v[18:19]
    v_pk_fma_f32 v[12:13], v[68:69], v[12:13], v[20:21]
    v_pk_fma_f32 v[14:15], v[70:71], v[14:15], v[22:23]
    v_cvt_pk_bf16_f32 v24, v8, v9
    v_cvt_pk_bf16_f32 v25, v10, v11
    v_cvt_pk_bf16_f32 v26, v12, v13
    v_cvt_pk_bf16_f32 v27, v14, v15
    s_nop 0
    v_permlane32_swap_b32 v24, v26
    v_permlane32_swap_b32 v25, v27
    s_nop 0
    v_permlane16_swap_b32 v24, v26
    v_permlane16_swap_b32 v25, v27
    buffer_store_dwordx4 v[24:27], v252, s[92:95], s53 offen offset:0 sc1
    s_waitcnt vmcnt(7)
    v_permlane16_swap_b32 v164, v166
    v_permlane16_swap_b32 v165, v167
    v_lshlrev_b32 v36, 16, v196
    v_and_b32 v37, 0xffff0000, v196
    v_lshlrev_b32 v38, 16, v197
    v_and_b32 v39, 0xffff0000, v197
    v_lshlrev_b32 v40, 16, v198
    v_and_b32 v41, 0xffff0000, v198
    v_lshlrev_b32 v42, 16, v199
    v_and_b32 v43, 0xffff0000, v199
    v_permlane32_swap_b32 v164, v166
    v_permlane32_swap_b32 v165, v167
    v_lshlrev_b32 v44, 16, v164
    v_and_b32 v45, 0xffff0000, v164
    v_lshlrev_b32 v46, 16, v165
    v_and_b32 v47, 0xffff0000, v165
    v_lshlrev_b32 v48, 16, v166
    v_and_b32 v49, 0xffff0000, v166
    v_lshlrev_b32 v50, 16, v167
    v_and_b32 v51, 0xffff0000, v167
    v_pk_fma_f32 v[36:37], v[72:73], v[36:37], v[44:45]
    v_pk_fma_f32 v[38:39], v[74:75], v[38:39], v[46:47]
    v_pk_fma_f32 v[40:41], v[76:77], v[40:41], v[48:49]
    v_pk_fma_f32 v[42:43], v[78:79], v[42:43], v[50:51]
    v_cvt_pk_bf16_f32 v52, v36, v37
    v_cvt_pk_bf16_f32 v53, v38, v39
    v_cvt_pk_bf16_f32 v54, v40, v41
    v_cvt_pk_bf16_f32 v55, v42, v43
    s_nop 0
    v_permlane32_swap_b32 v52, v54
    v_permlane32_swap_b32 v53, v55
    s_nop 0
    v_permlane16_swap_b32 v52, v54
    v_permlane16_swap_b32 v53, v55
    buffer_store_dwordx4 v[52:55], v252, s[92:95], s53 offen offset:64 sc1
    s_add_u32 s53, s53, 32768
    s_waitcnt vmcnt(7)
    v_permlane16_swap_b32 v168, v170
    v_permlane16_swap_b32 v169, v171
    v_lshlrev_b32 v8, 16, v200
    v_and_b32 v9, 0xffff0000, v200
    v_lshlrev_b32 v10, 16, v201
    v_and_b32 v11, 0xffff0000, v201
    v_lshlrev_b32 v12, 16, v202
    v_and_b32 v13, 0xffff0000, v202
    v_lshlrev_b32 v14, 16, v203
    v_and_b32 v15, 0xffff0000, v203
    v_permlane32_swap_b32 v168, v170
    v_permlane32_swap_b32 v169, v171
    v_lshlrev_b32 v16, 16, v168
    v_and_b32 v17, 0xffff0000, v168
    v_lshlrev_b32 v18, 16, v169
    v_and_b32 v19, 0xffff0000, v169
    v_lshlrev_b32 v20, 16, v170
    v_and_b32 v21, 0xffff0000, v170
    v_lshlrev_b32 v22, 16, v171
    v_and_b32 v23, 0xffff0000, v171
    v_pk_fma_f32 v[8:9], v[80:81], v[8:9], v[16:17]
    v_pk_fma_f32 v[10:11], v[82:83], v[10:11], v[18:19]
    v_pk_fma_f32 v[12:13], v[84:85], v[12:13], v[20:21]
    v_pk_fma_f32 v[14:15], v[86:87], v[14:15], v[22:23]
    v_cvt_pk_bf16_f32 v24, v8, v9
    v_cvt_pk_bf16_f32 v25, v10, v11
    v_cvt_pk_bf16_f32 v26, v12, v13
    v_cvt_pk_bf16_f32 v27, v14, v15
    s_nop 0
    v_permlane32_swap_b32 v24, v26
    v_permlane32_swap_b32 v25, v27
    s_nop 0
    v_permlane16_swap_b32 v24, v26
    v_permlane16_swap_b32 v25, v27
    buffer_store_dwordx4 v[24:27], v252, s[92:95], s53 offen offset:0 sc1
    s_waitcnt vmcnt(7)
    v_permlane16_swap_b32 v172, v174
    v_permlane16_swap_b32 v173, v175
    v_lshlrev_b32 v36, 16, v204
    v_and_b32 v37, 0xffff0000, v204
    v_lshlrev_b32 v38, 16, v205
    v_and_b32 v39, 0xffff0000, v205
    v_lshlrev_b32 v40, 16, v206
    v_and_b32 v41, 0xffff0000, v206
    v_lshlrev_b32 v42, 16, v207
    v_and_b32 v43, 0xffff0000, v207
    v_permlane32_swap_b32 v172, v174
    v_permlane32_swap_b32 v173, v175
    v_lshlrev_b32 v44, 16, v172
    v_and_b32 v45, 0xffff0000, v172
    v_lshlrev_b32 v46, 16, v173
    v_and_b32 v47, 0xffff0000, v173
    v_lshlrev_b32 v48, 16, v174
    v_and_b32 v49, 0xffff0000, v174
    v_lshlrev_b32 v50, 16, v175
    v_and_b32 v51, 0xffff0000, v175
    v_pk_fma_f32 v[36:37], v[88:89], v[36:37], v[44:45]
    v_pk_fma_f32 v[38:39], v[90:91], v[38:39], v[46:47]
    v_pk_fma_f32 v[40:41], v[92:93], v[40:41], v[48:49]
    v_pk_fma_f32 v[42:43], v[94:95], v[42:43], v[50:51]
    v_cvt_pk_bf16_f32 v52, v36, v37
    v_cvt_pk_bf16_f32 v53, v38, v39
    v_cvt_pk_bf16_f32 v54, v40, v41
    v_cvt_pk_bf16_f32 v55, v42, v43
    s_nop 0
    v_permlane32_swap_b32 v52, v54
    v_permlane32_swap_b32 v53, v55
    s_nop 0
    v_permlane16_swap_b32 v52, v54
    v_permlane16_swap_b32 v53, v55
    buffer_store_dwordx4 v[52:55], v252, s[92:95], s53 offen offset:64 sc1
    s_add_u32 s53, s53, 32768
    s_waitcnt vmcnt(7)
    v_permlane16_swap_b32 v176, v178
    v_permlane16_swap_b32 v177, v179
    v_lshlrev_b32 v8, 16, v208
    v_and_b32 v9, 0xffff0000, v208
    v_lshlrev_b32 v10, 16, v209
    v_and_b32 v11, 0xffff0000, v209
    v_lshlrev_b32 v12, 16, v210
    v_and_b32 v13, 0xffff0000, v210
    v_lshlrev_b32 v14, 16, v211
    v_and_b32 v15, 0xffff0000, v211
    v_permlane32_swap_b32 v176, v178
    v_permlane32_swap_b32 v177, v179
    v_lshlrev_b32 v16, 16, v176
    v_and_b32 v17, 0xffff0000, v176
    v_lshlrev_b32 v18, 16, v177
    v_and_b32 v19, 0xffff0000, v177
    v_lshlrev_b32 v20, 16, v178
    v_and_b32 v21, 0xffff0000, v178
    v_lshlrev_b32 v22, 16, v179
    v_and_b32 v23, 0xffff0000, v179
    v_pk_fma_f32 v[8:9], v[96:97], v[8:9], v[16:17]
    v_pk_fma_f32 v[10:11], v[98:99], v[10:11], v[18:19]
    v_pk_fma_f32 v[12:13], v[100:101], v[12:13], v[20:21]
    v_pk_fma_f32 v[14:15], v[102:103], v[14:15], v[22:23]
    v_cvt_pk_bf16_f32 v24, v8, v9
    v_cvt_pk_bf16_f32 v25, v10, v11
    v_cvt_pk_bf16_f32 v26, v12, v13
    v_cvt_pk_bf16_f32 v27, v14, v15
    s_nop 0
    v_permlane32_swap_b32 v24, v26
    v_permlane32_swap_b32 v25, v27
    s_nop 0
    v_permlane16_swap_b32 v24, v26
    v_permlane16_swap_b32 v25, v27
    buffer_store_dwordx4 v[24:27], v252, s[92:95], s53 offen offset:0 sc1
    s_waitcnt vmcnt(7)
    v_permlane16_swap_b32 v180, v182
    v_permlane16_swap_b32 v181, v183
    v_lshlrev_b32 v36, 16, v212
    v_and_b32 v37, 0xffff0000, v212
    v_lshlrev_b32 v38, 16, v213
    v_and_b32 v39, 0xffff0000, v213
    v_lshlrev_b32 v40, 16, v214
    v_and_b32 v41, 0xffff0000, v214
    v_lshlrev_b32 v42, 16, v215
    v_and_b32 v43, 0xffff0000, v215
    v_permlane32_swap_b32 v180, v182
    v_permlane32_swap_b32 v181, v183
    v_lshlrev_b32 v44, 16, v180
    v_and_b32 v45, 0xffff0000, v180
    v_lshlrev_b32 v46, 16, v181
    v_and_b32 v47, 0xffff0000, v181
    v_lshlrev_b32 v48, 16, v182
    v_and_b32 v49, 0xffff0000, v182
    v_lshlrev_b32 v50, 16, v183
    v_and_b32 v51, 0xffff0000, v183
    v_pk_fma_f32 v[36:37], v[104:105], v[36:37], v[44:45]
    v_pk_fma_f32 v[38:39], v[106:107], v[38:39], v[46:47]
    v_pk_fma_f32 v[40:41], v[108:109], v[40:41], v[48:49]
    v_pk_fma_f32 v[42:43], v[110:111], v[42:43], v[50:51]
    v_cvt_pk_bf16_f32 v52, v36, v37
    v_cvt_pk_bf16_f32 v53, v38, v39
    v_cvt_pk_bf16_f32 v54, v40, v41
    v_cvt_pk_bf16_f32 v55, v42, v43
    s_nop 0
    v_permlane32_swap_b32 v52, v54
    v_permlane32_swap_b32 v53, v55
    s_nop 0
    v_permlane16_swap_b32 v52, v54
    v_permlane16_swap_b32 v53, v55
    buffer_store_dwordx4 v[52:55], v252, s[92:95], s53 offen offset:64 sc1
    s_add_u32 s53, s53, 32768
    s_waitcnt vmcnt(7)
    v_permlane16_swap_b32 v184, v186
    v_permlane16_swap_b32 v185, v187
    v_lshlrev_b32 v8, 16, v216
    v_and_b32 v9, 0xffff0000, v216
    v_lshlrev_b32 v10, 16, v217
    v_and_b32 v11, 0xffff0000, v217
    v_lshlrev_b32 v12, 16, v218
    v_and_b32 v13, 0xffff0000, v218
    v_lshlrev_b32 v14, 16, v219
    v_and_b32 v15, 0xffff0000, v219
    v_permlane32_swap_b32 v184, v186
    v_permlane32_swap_b32 v185, v187
    v_lshlrev_b32 v16, 16, v184
    v_and_b32 v17, 0xffff0000, v184
    v_lshlrev_b32 v18, 16, v185
    v_and_b32 v19, 0xffff0000, v185
    v_lshlrev_b32 v20, 16, v186
    v_and_b32 v21, 0xffff0000, v186
    v_lshlrev_b32 v22, 16, v187
    v_and_b32 v23, 0xffff0000, v187
    v_pk_fma_f32 v[8:9], v[112:113], v[8:9], v[16:17]
    v_pk_fma_f32 v[10:11], v[114:115], v[10:11], v[18:19]
    v_pk_fma_f32 v[12:13], v[116:117], v[12:13], v[20:21]
    v_pk_fma_f32 v[14:15], v[118:119], v[14:15], v[22:23]
    v_cvt_pk_bf16_f32 v24, v8, v9
    v_cvt_pk_bf16_f32 v25, v10, v11
    v_cvt_pk_bf16_f32 v26, v12, v13
    v_cvt_pk_bf16_f32 v27, v14, v15
    s_nop 0
    v_permlane32_swap_b32 v24, v26
    v_permlane32_swap_b32 v25, v27
    s_nop 0
    v_permlane16_swap_b32 v24, v26
    v_permlane16_swap_b32 v25, v27
    buffer_store_dwordx4 v[24:27], v252, s[92:95], s53 offen offset:0 sc1
    s_waitcnt vmcnt(7)
    v_permlane16_swap_b32 v188, v190
    v_permlane16_swap_b32 v189, v191
    v_lshlrev_b32 v36, 16, v220
    v_and_b32 v37, 0xffff0000, v220
    v_lshlrev_b32 v38, 16, v221
    v_and_b32 v39, 0xffff0000, v221
    v_lshlrev_b32 v40, 16, v222
    v_and_b32 v41, 0xffff0000, v222
    v_lshlrev_b32 v42, 16, v223
    v_and_b32 v43, 0xffff0000, v223
    v_permlane32_swap_b32 v188, v190
    v_permlane32_swap_b32 v189, v191
    v_lshlrev_b32 v44, 16, v188
    v_and_b32 v45, 0xffff0000, v188
    v_lshlrev_b32 v46, 16, v189
    v_and_b32 v47, 0xffff0000, v189
    v_lshlrev_b32 v48, 16, v190
    v_and_b32 v49, 0xffff0000, v190
    v_lshlrev_b32 v50, 16, v191
    v_and_b32 v51, 0xffff0000, v191
    v_pk_fma_f32 v[36:37], v[120:121], v[36:37], v[44:45]
    v_pk_fma_f32 v[38:39], v[122:123], v[38:39], v[46:47]
    v_pk_fma_f32 v[40:41], v[124:125], v[40:41], v[48:49]
    v_pk_fma_f32 v[42:43], v[126:127], v[42:43], v[50:51]
    v_cvt_pk_bf16_f32 v52, v36, v37
    v_cvt_pk_bf16_f32 v53, v38, v39
    v_cvt_pk_bf16_f32 v54, v40, v41
    v_cvt_pk_bf16_f32 v55, v42, v43
    s_nop 0
    v_permlane32_swap_b32 v52, v54
    v_permlane32_swap_b32 v53, v55
    s_nop 0
    v_permlane16_swap_b32 v52, v54
    v_permlane16_swap_b32 v53, v55
    buffer_store_dwordx4 v[52:55], v252, s[92:95], s53 offen offset:64 sc1
    s_branch main_kernel_w_done
main_kernel_w_c0_gov:
    v_lshrrev_b32 v0, 4, v250
    v_bfe_u32 v1, v250, 2, 2
    v_lshl_add_u32 v4, v0, 2, v1
    v_and_b32 v5, 7, v4
    v_mul_u32_u24 v4, 256, v4
    v_and_b32 v6, 3, v250
    v_lshl_add_u32 v4, v6, 3, v4
    s_mul_i32 s32, s37, 4
    v_xor_b32 v5, s32, v5
    v_lshl_add_u32 v128, v5, 5, v4
    v_xor_b32 v129, 32, v128
    v_xor_b32 v130, 64, v128
    v_xor_b32 v131, 96, v128
    s_mul_i32 s32, s38, 8192
    s_add_u32 s32, s32, 65536
    v_add_u32 v136, s32, v251
    v_lshrrev_b32 v2, 4, v250
    v_and_b32 v3, 15, v250
    s_mul_i32 s32, s14, 16
    v_add_u32 v4, s32, v2
    v_add_u32 v5, 0, v4
    v_and_b32 v6, 7, v5
    v_lshlrev_b32 v6, 1, v6
    v_xor_b32 v6, v6, v3
    v_mul_lo_u32 v5, v5, s30
    v_lshl_add_u32 v5, v6, 4, v5
    v_subrev_u32 v137, 0, v5
    v_add_u32 v5, 4, v4
    v_and_b32 v6, 7, v5
    v_lshlrev_b32 v6, 1, v6
    v_xor_b32 v6, v6, v3
    v_mul_lo_u32 v5, v5, s30
    v_lshl_add_u32 v5, v6, 4, v5
    v_subrev_u32 v138, 1024, v5
    v_add_u32 v5, 8, v4
    v_and_b32 v6, 7, v5
    v_lshlrev_b32 v6, 1, v6
    v_xor_b32 v6, v6, v3
    v_mul_lo_u32 v5, v5, s30
    v_lshl_add_u32 v5, v6, 4, v5
    v_subrev_u32 v139, 2048, v5
    v_add_u32 v5, 12, v4
    v_and_b32 v6, 7, v5
    v_lshlrev_b32 v6, 1, v6
    v_xor_b32 v6, v6, v3
    v_mul_lo_u32 v5, v5, s30
    v_lshl_add_u32 v5, v6, 4, v5
    v_subrev_u32 v140, 3072, v5
    s_mul_i32 s32, s14, 2
    s_mul_i32 s32, s32, s31
    v_add_u32 v141, s32, v251
    s_add_u32 s32, s32, s31
    s_sub_u32 s32, s32, 2048
    v_add_u32 v142, s32, v251
    s_mul_i32 s19, s14, 4096
    s_mul_i32 s20, s14, 4096
    s_add_u32 s20, s20, 65536
    s_mul_i32 s17, s30, 64
    s_mov_b32 s15, 0
    s_add_u32 m0, s20, 0
    s_nop 0
    buffer_load_dwordx4 v141, s[4:7], s16 offen offset:0 sc1 lds
    buffer_load_dwordx4 v141, s[4:7], s16 offen offset:1024 sc1 lds
    buffer_load_dwordx4 v142, s[4:7], s16 offen offset:2048 sc1 lds
    buffer_load_dwordx4 v142, s[4:7], s16 offen offset:3072 sc1 lds
    s_add_u32 s16, s16, 2048
    s_add_u32 m0, s19, 0
    s_nop 0
    buffer_load_dwordx4 v137, s[8:11], s15 offen offset:0 lds
    buffer_load_dwordx4 v138, s[8:11], s15 offen offset:1024 lds
    buffer_load_dwordx4 v139, s[8:11], s15 offen offset:2048 lds
    buffer_load_dwordx4 v140, s[8:11], s15 offen offset:3072 lds
    s_add_u32 s15, s15, s17
    s_add_u32 m0, s20, 16384
    s_nop 0
    buffer_load_dwordx4 v141, s[4:7], s16 offen offset:0 sc1 lds
    buffer_load_dwordx4 v141, s[4:7], s16 offen offset:1024 sc1 lds
    buffer_load_dwordx4 v142, s[4:7], s16 offen offset:2048 sc1 lds
    buffer_load_dwordx4 v142, s[4:7], s16 offen offset:3072 sc1 lds
    s_add_u32 s16, s16, 2048
    s_add_u32 m0, s19, 16384
    s_nop 0
    buffer_load_dwordx4 v137, s[8:11], s15 offen offset:0 lds
    buffer_load_dwordx4 v138, s[8:11], s15 offen offset:1024 lds
    buffer_load_dwordx4 v139, s[8:11], s15 offen offset:2048 lds
    buffer_load_dwordx4 v140, s[8:11], s15 offen offset:3072 lds
    s_add_u32 s15, s15, s17
    s_add_u32 m0, s20, 32768
    s_nop 0
    buffer_load_dwordx4 v141, s[4:7], s16 offen offset:0 sc1 lds
    buffer_load_dwordx4 v141, s[4:7], s16 offen offset:1024 sc1 lds
    buffer_load_dwordx4 v142, s[4:7], s16 offen offset:2048 sc1 lds
    buffer_load_dwordx4 v142, s[4:7], s16 offen offset:3072 sc1 lds
    s_add_u32 s16, s16, 2048
    s_add_u32 m0, s19, 32768
    s_nop 0
    buffer_load_dwordx4 v137, s[8:11], s15 offen offset:0 lds
    buffer_load_dwordx4 v138, s[8:11], s15 offen offset:1024 lds
    buffer_load_dwordx4 v139, s[8:11], s15 offen offset:2048 lds
    buffer_load_dwordx4 v140, s[8:11], s15 offen offset:3072 lds
    s_add_u32 s15, s15, s17
    s_add_u32 m0, s20, 49152
    s_nop 0
    buffer_load_dwordx4 v141, s[4:7], s16 offen offset:0 sc1 lds
    buffer_load_dwordx4 v141, s[4:7], s16 offen offset:1024 sc1 lds
    buffer_load_dwordx4 v142, s[4:7], s16 offen offset:2048 sc1 lds
    buffer_load_dwordx4 v142, s[4:7], s16 offen offset:3072 sc1 lds
    s_add_u32 s16, s16, 2048
    v_mov_b32 v64, 0
    v_mov_b32 v65, 0
    v_mov_b32 v66, 0
    v_mov_b32 v67, 0
    v_mov_b32 v68, 0
    v_mov_b32 v69, 0
    v_mov_b32 v70, 0
    v_mov_b32 v71, 0
    v_mov_b32 v72, 0
    v_mov_b32 v73, 0
    v_mov_b32 v74, 0
    v_mov_b32 v75, 0
    v_mov_b32 v76, 0
    v_mov_b32 v77, 0
    v_mov_b32 v78, 0
    v_mov_b32 v79, 0
    v_mov_b32 v80, 0
    v_mov_b32 v81, 0
    v_mov_b32 v82, 0
    v_mov_b32 v83, 0
    v_mov_b32 v84, 0
    v_mov_b32 v85, 0
    v_mov_b32 v86, 0
    v_mov_b32 v87, 0
    v_mov_b32 v88, 0
    v_mov_b32 v89, 0
    v_mov_b32 v90, 0
    v_mov_b32 v91, 0
    v_mov_b32 v92, 0
    v_mov_b32 v93, 0
    v_mov_b32 v94, 0
    v_mov_b32 v95, 0
    v_mov_b32 v96, 0
    v_mov_b32 v97, 0
    v_mov_b32 v98, 0
    v_mov_b32 v99, 0
    v_mov_b32 v100, 0
    v_mov_b32 v101, 0
    v_mov_b32 v102, 0
    v_mov_b32 v103, 0
    v_mov_b32 v104, 0
    v_mov_b32 v105, 0
    v_mov_b32 v106, 0
    v_mov_b32 v107, 0
    v_mov_b32 v108, 0
    v_mov_b32 v109, 0
    v_mov_b32 v110, 0
    v_mov_b32 v111, 0
    v_mov_b32 v112, 0
    v_mov_b32 v113, 0
    v_mov_b32 v114, 0
    v_mov_b32 v115, 0
    v_mov_b32 v116, 0
    v_mov_b32 v117, 0
    v_mov_b32 v118, 0
    v_mov_b32 v119, 0
    v_mov_b32 v120, 0
    v_mov_b32 v121, 0
    v_mov_b32 v122, 0
    v_mov_b32 v123, 0
    v_mov_b32 v124, 0
    v_mov_b32 v125, 0
    v_mov_b32 v126, 0
    v_mov_b32 v127, 0
    s_waitcnt vmcnt(20)
    s_barrier
    ds_read_b128 v[16:19], v136 offset:0
    ds_read_b64_tr_b16 v[0:1], v128 offset:0
    ds_read_b64_tr_b16 v[2:3], v128 offset:4096
    ds_read_b64_tr_b16 v[4:5], v129 offset:0
    ds_read_b64_tr_b16 v[6:7], v129 offset:4096
    ds_read_b64_tr_b16 v[8:9], v130 offset:0
    ds_read_b64_tr_b16 v[10:11], v130 offset:4096
    ds_read_b64_tr_b16 v[12:13], v131 offset:0
    ds_read_b64_tr_b16 v[14:15], v131 offset:4096
    ds_read_b128 v[20:23], v136 offset:2048
    ds_read_b128 v[24:27], v136 offset:4096
    ds_read_b128 v[28:31], v136 offset:6144
main_kernel_w_c0_v_loop:
    s_waitcnt lgkmcnt(0)
    ds_read_b128 v[48:51], v136 offset:1024
    s_add_u32 m0, s19, 49152
    s_nop 0
    v_mfma_f32_16x16x32_bf16 v[64:67], v[16:19], v[0:3], v[64:67]
    ds_read_b64_tr_b16 v[32:33], v128 offset:8192
    v_mfma_f32_16x16x32_bf16 v[68:71], v[16:19], v[4:7], v[68:71]
    ds_read_b64_tr_b16 v[34:35], v128 offset:12288
    buffer_load_dwordx4 v137, s[8:11], s15 offen offset:0 lds
    v_mfma_f32_16x16x32_bf16 v[72:75], v[16:19], v[8:11], v[72:75]
    ds_read_b64_tr_b16 v[36:37], v129 offset:8192
    v_mfma_f32_16x16x32_bf16 v[76:79], v[16:19], v[12:15], v[76:79]
    ds_read_b64_tr_b16 v[38:39], v129 offset:12288
    v_mfma_f32_16x16x32_bf16 v[80:83], v[20:23], v[0:3], v[80:83]
    ds_read_b64_tr_b16 v[40:41], v130 offset:8192
    buffer_load_dwordx4 v138, s[8:11], s15 offen offset:1024 lds
    v_mfma_f32_16x16x32_bf16 v[84:87], v[20:23], v[4:7], v[84:87]
    ds_read_b64_tr_b16 v[42:43], v130 offset:12288
    v_mfma_f32_16x16x32_bf16 v[88:91], v[20:23], v[8:11], v[88:91]
    ds_read_b64_tr_b16 v[44:45], v131 offset:8192
    v_mfma_f32_16x16x32_bf16 v[92:95], v[20:23], v[12:15], v[92:95]
    ds_read_b64_tr_b16 v[46:47], v131 offset:12288
    buffer_load_dwordx4 v139, s[8:11], s15 offen offset:2048 lds
    v_mfma_f32_16x16x32_bf16 v[96:99], v[24:27], v[0:3], v[96:99]
    ds_read_b128 v[52:55], v136 offset:3072
    v_mfma_f32_16x16x32_bf16 v[100:103], v[24:27], v[4:7], v[100:103]
    ds_read_b128 v[56:59], v136 offset:5120
    buffer_load_dwordx4 v140, s[8:11], s15 offen offset:3072 lds
    v_mfma_f32_16x16x32_bf16 v[104:107], v[24:27], v[8:11], v[104:107]
    ds_read_b128 v[60:63], v136 offset:7168
    v_mfma_f32_16x16x32_bf16 v[108:111], v[24:27], v[12:15], v[108:111]
    v_mfma_f32_16x16x32_bf16 v[112:115], v[28:31], v[0:3], v[112:115]
    s_add_u32 s15, s15, s17
    v_mfma_f32_16x16x32_bf16 v[116:119], v[28:31], v[4:7], v[116:119]
    v_mfma_f32_16x16x32_bf16 v[120:123], v[28:31], v[8:11], v[120:123]
    v_mfma_f32_16x16x32_bf16 v[124:127], v[28:31], v[12:15], v[124:127]
    s_waitcnt lgkmcnt(0)
    v_mfma_f32_16x16x32_bf16 v[64:67], v[48:51], v[32:35], v[64:67]
    s_waitcnt vmcnt(16)
    s_barrier
    ds_read_b128 v[16:19], v136 offset:16384
    s_add_u32 m0, s20, 0
    s_nop 0
    v_mfma_f32_16x16x32_bf16 v[68:71], v[48:51], v[36:39], v[68:71]
    ds_read_b64_tr_b16 v[0:1], v128 offset:16384
    v_mfma_f32_16x16x32_bf16 v[72:75], v[48:51], v[40:43], v[72:75]
    ds_read_b64_tr_b16 v[2:3], v128 offset:20480
    buffer_load_dwordx4 v141, s[4:7], s16 offen offset:0 sc1 lds
    v_mfma_f32_16x16x32_bf16 v[76:79], v[48:51], v[44:47], v[76:79]
    ds_read_b64_tr_b16 v[4:5], v129 offset:16384
    v_mfma_f32_16x16x32_bf16 v[80:83], v[52:55], v[32:35], v[80:83]
    ds_read_b64_tr_b16 v[6:7], v129 offset:20480
    v_mfma_f32_16x16x32_bf16 v[84:87], v[52:55], v[36:39], v[84:87]
    ds_read_b64_tr_b16 v[8:9], v130 offset:16384
    buffer_load_dwordx4 v141, s[4:7], s16 offen offset:1024 sc1 lds
    v_mfma_f32_16x16x32_bf16 v[88:91], v[52:55], v[40:43], v[88:91]
    ds_read_b64_tr_b16 v[10:11], v130 offset:20480
    v_mfma_f32_16x16x32_bf16 v[92:95], v[52:55], v[44:47], v[92:95]
    ds_read_b64_tr_b16 v[12:13], v131 offset:16384
    buffer_load_dwordx4 v142, s[4:7], s16 offen offset:2048 sc1 lds
    v_mfma_f32_16x16x32_bf16 v[96:99], v[56:59], v[32:35], v[96:99]
    ds_read_b64_tr_b16 v[14:15], v131 offset:20480
    v_mfma_f32_16x16x32_bf16 v[100:103], v[56:59], v[36:39], v[100:103]
    ds_read_b128 v[20:23], v136 offset:18432
    v_mfma_f32_16x16x32_bf16 v[104:107], v[56:59], v[40:43], v[104:107]
    ds_read_b128 v[24:27], v136 offset:20480
    buffer_load_dwordx4 v142, s[4:7], s16 offen offset:3072 sc1 lds
    v_mfma_f32_16x16x32_bf16 v[108:111], v[56:59], v[44:47], v[108:111]
    ds_read_b128 v[28:31], v136 offset:22528
    v_mfma_f32_16x16x32_bf16 v[112:115], v[60:63], v[32:35], v[112:115]
    s_add_u32 s16, s16, 2048
    v_mfma_f32_16x16x32_bf16 v[116:119], v[60:63], v[36:39], v[116:119]
    v_mfma_f32_16x16x32_bf16 v[120:123], v[60:63], v[40:43], v[120:123]
    v_mfma_f32_16x16x32_bf16 v[124:127], v[60:63], v[44:47], v[124:127]
    s_waitcnt lgkmcnt(0)
    ds_read_b128 v[48:51], v136 offset:17408
    s_add_u32 m0, s19, 0
    s_nop 0
    v_mfma_f32_16x16x32_bf16 v[64:67], v[16:19], v[0:3], v[64:67]
    ds_read_b64_tr_b16 v[32:33], v128 offset:24576
    v_mfma_f32_16x16x32_bf16 v[68:71], v[16:19], v[4:7], v[68:71]
    ds_read_b64_tr_b16 v[34:35], v128 offset:28672
    buffer_load_dwordx4 v137, s[8:11], s15 offen offset:0 lds
    v_mfma_f32_16x16x32_bf16 v[72:75], v[16:19], v[8:11], v[72:75]
    ds_read_b64_tr_b16 v[36:37], v129 offset:24576
    v_mfma_f32_16x16x32_bf16 v[76:79], v[16:19], v[12:15], v[76:79]
    ds_read_b64_tr_b16 v[38:39], v129 offset:28672
    v_mfma_f32_16x16x32_bf16 v[80:83], v[20:23], v[0:3], v[80:83]
    ds_read_b64_tr_b16 v[40:41], v130 offset:24576
    buffer_load_dwordx4 v138, s[8:11], s15 offen offset:1024 lds
    v_mfma_f32_16x16x32_bf16 v[84:87], v[20:23], v[4:7], v[84:87]
    ds_read_b64_tr_b16 v[42:43], v130 offset:28672
    v_mfma_f32_16x16x32_bf16 v[88:91], v[20:23], v[8:11], v[88:91]
    ds_read_b64_tr_b16 v[44:45], v131 offset:24576
    v_mfma_f32_16x16x32_bf16 v[92:95], v[20:23], v[12:15], v[92:95]
    ds_read_b64_tr_b16 v[46:47], v131 offset:28672
    buffer_load_dwordx4 v139, s[8:11], s15 offen offset:2048 lds
    v_mfma_f32_16x16x32_bf16 v[96:99], v[24:27], v[0:3], v[96:99]
    ds_read_b128 v[52:55], v136 offset:19456
    v_mfma_f32_16x16x32_bf16 v[100:103], v[24:27], v[4:7], v[100:103]
    ds_read_b128 v[56:59], v136 offset:21504
    buffer_load_dwordx4 v140, s[8:11], s15 offen offset:3072 lds
    v_mfma_f32_16x16x32_bf16 v[104:107], v[24:27], v[8:11], v[104:107]
    ds_read_b128 v[60:63], v136 offset:23552
    v_mfma_f32_16x16x32_bf16 v[108:111], v[24:27], v[12:15], v[108:111]
    v_mfma_f32_16x16x32_bf16 v[112:115], v[28:31], v[0:3], v[112:115]
    s_add_u32 s15, s15, s17
    v_mfma_f32_16x16x32_bf16 v[116:119], v[28:31], v[4:7], v[116:119]
    v_mfma_f32_16x16x32_bf16 v[120:123], v[28:31], v[8:11], v[120:123]
    v_mfma_f32_16x16x32_bf16 v[124:127], v[28:31], v[12:15], v[124:127]
    s_waitcnt lgkmcnt(0)
    v_mfma_f32_16x16x32_bf16 v[64:67], v[48:51], v[32:35], v[64:67]
    s_waitcnt vmcnt(16)
    s_barrier
    ds_read_b128 v[16:19], v136 offset:32768
    s_add_u32 m0, s20, 16384
    s_nop 0
    v_mfma_f32_16x16x32_bf16 v[68:71], v[48:51], v[36:39], v[68:71]
    ds_read_b64_tr_b16 v[0:1], v128 offset:32768
    v_mfma_f32_16x16x32_bf16 v[72:75], v[48:51], v[40:43], v[72:75]
    ds_read_b64_tr_b16 v[2:3], v128 offset:36864
    buffer_load_dwordx4 v141, s[4:7], s16 offen offset:0 sc1 lds
    v_mfma_f32_16x16x32_bf16 v[76:79], v[48:51], v[44:47], v[76:79]
    ds_read_b64_tr_b16 v[4:5], v129 offset:32768
    v_mfma_f32_16x16x32_bf16 v[80:83], v[52:55], v[32:35], v[80:83]
    ds_read_b64_tr_b16 v[6:7], v129 offset:36864
    v_mfma_f32_16x16x32_bf16 v[84:87], v[52:55], v[36:39], v[84:87]
    ds_read_b64_tr_b16 v[8:9], v130 offset:32768
    buffer_load_dwordx4 v141, s[4:7], s16 offen offset:1024 sc1 lds
    v_mfma_f32_16x16x32_bf16 v[88:91], v[52:55], v[40:43], v[88:91]
    ds_read_b64_tr_b16 v[10:11], v130 offset:36864
    v_mfma_f32_16x16x32_bf16 v[92:95], v[52:55], v[44:47], v[92:95]
    ds_read_b64_tr_b16 v[12:13], v131 offset:32768
    buffer_load_dwordx4 v142, s[4:7], s16 offen offset:2048 sc1 lds
    v_mfma_f32_16x16x32_bf16 v[96:99], v[56:59], v[32:35], v[96:99]
    ds_read_b64_tr_b16 v[14:15], v131 offset:36864
    v_mfma_f32_16x16x32_bf16 v[100:103], v[56:59], v[36:39], v[100:103]
    ds_read_b128 v[20:23], v136 offset:34816
    v_mfma_f32_16x16x32_bf16 v[104:107], v[56:59], v[40:43], v[104:107]
    ds_read_b128 v[24:27], v136 offset:36864
    buffer_load_dwordx4 v142, s[4:7], s16 offen offset:3072 sc1 lds
    v_mfma_f32_16x16x32_bf16 v[108:111], v[56:59], v[44:47], v[108:111]
    ds_read_b128 v[28:31], v136 offset:38912
    v_mfma_f32_16x16x32_bf16 v[112:115], v[60:63], v[32:35], v[112:115]
    s_add_u32 s16, s16, 2048
    v_mfma_f32_16x16x32_bf16 v[116:119], v[60:63], v[36:39], v[116:119]
    v_mfma_f32_16x16x32_bf16 v[120:123], v[60:63], v[40:43], v[120:123]
    v_mfma_f32_16x16x32_bf16 v[124:127], v[60:63], v[44:47], v[124:127]
    s_waitcnt lgkmcnt(0)
    ds_read_b128 v[48:51], v136 offset:33792
    s_add_u32 m0, s19, 16384
    s_nop 0
    v_mfma_f32_16x16x32_bf16 v[64:67], v[16:19], v[0:3], v[64:67]
    ds_read_b64_tr_b16 v[32:33], v128 offset:40960
    v_mfma_f32_16x16x32_bf16 v[68:71], v[16:19], v[4:7], v[68:71]
    ds_read_b64_tr_b16 v[34:35], v128 offset:45056
    buffer_load_dwordx4 v137, s[8:11], s15 offen offset:0 lds
    v_mfma_f32_16x16x32_bf16 v[72:75], v[16:19], v[8:11], v[72:75]
    ds_read_b64_tr_b16 v[36:37], v129 offset:40960
    v_mfma_f32_16x16x32_bf16 v[76:79], v[16:19], v[12:15], v[76:79]
    ds_read_b64_tr_b16 v[38:39], v129 offset:45056
    v_mfma_f32_16x16x32_bf16 v[80:83], v[20:23], v[0:3], v[80:83]
    ds_read_b64_tr_b16 v[40:41], v130 offset:40960
    buffer_load_dwordx4 v138, s[8:11], s15 offen offset:1024 lds
    v_mfma_f32_16x16x32_bf16 v[84:87], v[20:23], v[4:7], v[84:87]
    ds_read_b64_tr_b16 v[42:43], v130 offset:45056
    v_mfma_f32_16x16x32_bf16 v[88:91], v[20:23], v[8:11], v[88:91]
    ds_read_b64_tr_b16 v[44:45], v131 offset:40960
    v_mfma_f32_16x16x32_bf16 v[92:95], v[20:23], v[12:15], v[92:95]
    ds_read_b64_tr_b16 v[46:47], v131 offset:45056
    buffer_load_dwordx4 v139, s[8:11], s15 offen offset:2048 lds
    v_mfma_f32_16x16x32_bf16 v[96:99], v[24:27], v[0:3], v[96:99]
    ds_read_b128 v[52:55], v136 offset:35840
    v_mfma_f32_16x16x32_bf16 v[100:103], v[24:27], v[4:7], v[100:103]
    ds_read_b128 v[56:59], v136 offset:37888
    buffer_load_dwordx4 v140, s[8:11], s15 offen offset:3072 lds
    v_mfma_f32_16x16x32_bf16 v[104:107], v[24:27], v[8:11], v[104:107]
    ds_read_b128 v[60:63], v136 offset:39936
    v_mfma_f32_16x16x32_bf16 v[108:111], v[24:27], v[12:15], v[108:111]
    v_mfma_f32_16x16x32_bf16 v[112:115], v[28:31], v[0:3], v[112:115]
    s_add_u32 s15, s15, s17
    v_mfma_f32_16x16x32_bf16 v[116:119], v[28:31], v[4:7], v[116:119]
    v_mfma_f32_16x16x32_bf16 v[120:123], v[28:31], v[8:11], v[120:123]
    v_mfma_f32_16x16x32_bf16 v[124:127], v[28:31], v[12:15], v[124:127]
    s_waitcnt lgkmcnt(0)
    v_mfma_f32_16x16x32_bf16 v[64:67], v[48:51], v[32:35], v[64:67]
    s_waitcnt vmcnt(16)
    s_barrier
    ds_read_b128 v[16:19], v136 offset:49152
    s_add_u32 m0, s20, 32768
    s_nop 0
    v_mfma_f32_16x16x32_bf16 v[68:71], v[48:51], v[36:39], v[68:71]
    ds_read_b64_tr_b16 v[0:1], v128 offset:49152
    v_mfma_f32_16x16x32_bf16 v[72:75], v[48:51], v[40:43], v[72:75]
    ds_read_b64_tr_b16 v[2:3], v128 offset:53248
    buffer_load_dwordx4 v141, s[4:7], s16 offen offset:0 sc1 lds
    v_mfma_f32_16x16x32_bf16 v[76:79], v[48:51], v[44:47], v[76:79]
    ds_read_b64_tr_b16 v[4:5], v129 offset:49152
    v_mfma_f32_16x16x32_bf16 v[80:83], v[52:55], v[32:35], v[80:83]
    ds_read_b64_tr_b16 v[6:7], v129 offset:53248
    v_mfma_f32_16x16x32_bf16 v[84:87], v[52:55], v[36:39], v[84:87]
    ds_read_b64_tr_b16 v[8:9], v130 offset:49152
    buffer_load_dwordx4 v141, s[4:7], s16 offen offset:1024 sc1 lds
    v_mfma_f32_16x16x32_bf16 v[88:91], v[52:55], v[40:43], v[88:91]
    ds_read_b64_tr_b16 v[10:11], v130 offset:53248
    v_mfma_f32_16x16x32_bf16 v[92:95], v[52:55], v[44:47], v[92:95]
    ds_read_b64_tr_b16 v[12:13], v131 offset:49152
    buffer_load_dwordx4 v142, s[4:7], s16 offen offset:2048 sc1 lds
    v_mfma_f32_16x16x32_bf16 v[96:99], v[56:59], v[32:35], v[96:99]
    ds_read_b64_tr_b16 v[14:15], v131 offset:53248
    v_mfma_f32_16x16x32_bf16 v[100:103], v[56:59], v[36:39], v[100:103]
    ds_read_b128 v[20:23], v136 offset:51200
    v_mfma_f32_16x16x32_bf16 v[104:107], v[56:59], v[40:43], v[104:107]
    ds_read_b128 v[24:27], v136 offset:53248
    buffer_load_dwordx4 v142, s[4:7], s16 offen offset:3072 sc1 lds
    v_mfma_f32_16x16x32_bf16 v[108:111], v[56:59], v[44:47], v[108:111]
    ds_read_b128 v[28:31], v136 offset:55296
    v_mfma_f32_16x16x32_bf16 v[112:115], v[60:63], v[32:35], v[112:115]
    s_add_u32 s16, s16, 2048
    v_mfma_f32_16x16x32_bf16 v[116:119], v[60:63], v[36:39], v[116:119]
    v_mfma_f32_16x16x32_bf16 v[120:123], v[60:63], v[40:43], v[120:123]
    v_mfma_f32_16x16x32_bf16 v[124:127], v[60:63], v[44:47], v[124:127]
    s_waitcnt lgkmcnt(0)
    ds_read_b128 v[48:51], v136 offset:50176
    s_add_u32 m0, s19, 32768
    s_nop 0
    v_mfma_f32_16x16x32_bf16 v[64:67], v[16:19], v[0:3], v[64:67]
    ds_read_b64_tr_b16 v[32:33], v128 offset:57344
    v_mfma_f32_16x16x32_bf16 v[68:71], v[16:19], v[4:7], v[68:71]
    ds_read_b64_tr_b16 v[34:35], v128 offset:61440
    buffer_load_dwordx4 v137, s[8:11], s15 offen offset:0 lds
    v_mfma_f32_16x16x32_bf16 v[72:75], v[16:19], v[8:11], v[72:75]
    ds_read_b64_tr_b16 v[36:37], v129 offset:57344
    v_mfma_f32_16x16x32_bf16 v[76:79], v[16:19], v[12:15], v[76:79]
    ds_read_b64_tr_b16 v[38:39], v129 offset:61440
    v_mfma_f32_16x16x32_bf16 v[80:83], v[20:23], v[0:3], v[80:83]
    ds_read_b64_tr_b16 v[40:41], v130 offset:57344
    buffer_load_dwordx4 v138, s[8:11], s15 offen offset:1024 lds
    v_mfma_f32_16x16x32_bf16 v[84:87], v[20:23], v[4:7], v[84:87]
    ds_read_b64_tr_b16 v[42:43], v130 offset:61440
    v_mfma_f32_16x16x32_bf16 v[88:91], v[20:23], v[8:11], v[88:91]
    ds_read_b64_tr_b16 v[44:45], v131 offset:57344
    v_mfma_f32_16x16x32_bf16 v[92:95], v[20:23], v[12:15], v[92:95]
    ds_read_b64_tr_b16 v[46:47], v131 offset:61440
    buffer_load_dwordx4 v139, s[8:11], s15 offen offset:2048 lds
    v_mfma_f32_16x16x32_bf16 v[96:99], v[24:27], v[0:3], v[96:99]
    ds_read_b128 v[52:55], v136 offset:52224
    v_mfma_f32_16x16x32_bf16 v[100:103], v[24:27], v[4:7], v[100:103]
    ds_read_b128 v[56:59], v136 offset:54272
    buffer_load_dwordx4 v140, s[8:11], s15 offen offset:3072 lds
    v_mfma_f32_16x16x32_bf16 v[104:107], v[24:27], v[8:11], v[104:107]
    ds_read_b128 v[60:63], v136 offset:56320
    v_mfma_f32_16x16x32_bf16 v[108:111], v[24:27], v[12:15], v[108:111]
    v_mfma_f32_16x16x32_bf16 v[112:115], v[28:31], v[0:3], v[112:115]
    s_add_u32 s15, s15, s17
    v_mfma_f32_16x16x32_bf16 v[116:119], v[28:31], v[4:7], v[116:119]
    v_mfma_f32_16x16x32_bf16 v[120:123], v[28:31], v[8:11], v[120:123]
    v_mfma_f32_16x16x32_bf16 v[124:127], v[28:31], v[12:15], v[124:127]
    s_waitcnt lgkmcnt(0)
    v_mfma_f32_16x16x32_bf16 v[64:67], v[48:51], v[32:35], v[64:67]
    s_waitcnt vmcnt(16)
    s_barrier
    ds_read_b128 v[16:19], v136 offset:0
    s_add_u32 m0, s20, 49152
    s_nop 0
    v_mfma_f32_16x16x32_bf16 v[68:71], v[48:51], v[36:39], v[68:71]
    ds_read_b64_tr_b16 v[0:1], v128 offset:0
    v_mfma_f32_16x16x32_bf16 v[72:75], v[48:51], v[40:43], v[72:75]
    ds_read_b64_tr_b16 v[2:3], v128 offset:4096
    buffer_load_dwordx4 v141, s[4:7], s16 offen offset:0 sc1 lds
    v_mfma_f32_16x16x32_bf16 v[76:79], v[48:51], v[44:47], v[76:79]
    ds_read_b64_tr_b16 v[4:5], v129 offset:0
    v_mfma_f32_16x16x32_bf16 v[80:83], v[52:55], v[32:35], v[80:83]
    ds_read_b64_tr_b16 v[6:7], v129 offset:4096
    v_mfma_f32_16x16x32_bf16 v[84:87], v[52:55], v[36:39], v[84:87]
    ds_read_b64_tr_b16 v[8:9], v130 offset:0
    buffer_load_dwordx4 v141, s[4:7], s16 offen offset:1024 sc1 lds
    v_mfma_f32_16x16x32_bf16 v[88:91], v[52:55], v[40:43], v[88:91]
    ds_read_b64_tr_b16 v[10:11], v130 offset:4096
    v_mfma_f32_16x16x32_bf16 v[92:95], v[52:55], v[44:47], v[92:95]
    ds_read_b64_tr_b16 v[12:13], v131 offset:0
    buffer_load_dwordx4 v142, s[4:7], s16 offen offset:2048 sc1 lds
    v_mfma_f32_16x16x32_bf16 v[96:99], v[56:59], v[32:35], v[96:99]
    ds_read_b64_tr_b16 v[14:15], v131 offset:4096
    v_mfma_f32_16x16x32_bf16 v[100:103], v[56:59], v[36:39], v[100:103]
    ds_read_b128 v[20:23], v136 offset:2048
    v_mfma_f32_16x16x32_bf16 v[104:107], v[56:59], v[40:43], v[104:107]
    ds_read_b128 v[24:27], v136 offset:4096
    buffer_load_dwordx4 v142, s[4:7], s16 offen offset:3072 sc1 lds
    v_mfma_f32_16x16x32_bf16 v[108:111], v[56:59], v[44:47], v[108:111]
    ds_read_b128 v[28:31], v136 offset:6144
    v_mfma_f32_16x16x32_bf16 v[112:115], v[60:63], v[32:35], v[112:115]
    s_add_u32 s16, s16, 2048
    v_mfma_f32_16x16x32_bf16 v[116:119], v[60:63], v[36:39], v[116:119]
    v_mfma_f32_16x16x32_bf16 v[120:123], v[60:63], v[40:43], v[120:123]
    v_mfma_f32_16x16x32_bf16 v[124:127], v[60:63], v[44:47], v[124:127]
    s_sub_u32 s18, s18, 1
    s_cmp_lg_u32 s18, 0
    s_cbranch_scc1 main_kernel_w_c0_v_loop
    s_cmp_lg_u32 s14, 0
    s_cbranch_scc1 main_kernel_w_c0_v_nt
    s_lshl_b32 s32, s27, 8
    s_add_u32 s32, s32, 0x841e000
    v_mov_b32 v255, 1
    s_mov_b64 exec, 1
    buffer_atomic_add v255, off, s[4:7], s32 sc0 sc1
    s_mov_b64 exec, -1
main_kernel_w_c0_v_nt:
    s_waitcnt lgkmcnt(0)
    ds_read_b128 v[48:51], v136 offset:1024
    s_add_u32 m0, s19, 49152
    s_nop 0
    v_mfma_f32_16x16x32_bf16 v[64:67], v[16:19], v[0:3], v[64:67]
    ds_read_b64_tr_b16 v[32:33], v128 offset:8192
    v_mfma_f32_16x16x32_bf16 v[68:71], v[16:19], v[4:7], v[68:71]
    ds_read_b64_tr_b16 v[34:35], v128 offset:12288
    buffer_load_dwordx4 v137, s[8:11], s15 offen offset:0 lds
    v_mfma_f32_16x16x32_bf16 v[72:75], v[16:19], v[8:11], v[72:75]
    ds_read_b64_tr_b16 v[36:37], v129 offset:8192
    v_mfma_f32_16x16x32_bf16 v[76:79], v[16:19], v[12:15], v[76:79]
    ds_read_b64_tr_b16 v[38:39], v129 offset:12288
    v_mfma_f32_16x16x32_bf16 v[80:83], v[20:23], v[0:3], v[80:83]
    ds_read_b64_tr_b16 v[40:41], v130 offset:8192
    buffer_load_dwordx4 v138, s[8:11], s15 offen offset:1024 lds
    v_mfma_f32_16x16x32_bf16 v[84:87], v[20:23], v[4:7], v[84:87]
    ds_read_b64_tr_b16 v[42:43], v130 offset:12288
    v_mfma_f32_16x16x32_bf16 v[88:91], v[20:23], v[8:11], v[88:91]
    ds_read_b64_tr_b16 v[44:45], v131 offset:8192
    v_mfma_f32_16x16x32_bf16 v[92:95], v[20:23], v[12:15], v[92:95]
    ds_read_b64_tr_b16 v[46:47], v131 offset:12288
    buffer_load_dwordx4 v139, s[8:11], s15 offen offset:2048 lds
    v_mfma_f32_16x16x32_bf16 v[96:99], v[24:27], v[0:3], v[96:99]
    ds_read_b128 v[52:55], v136 offset:3072
    v_mfma_f32_16x16x32_bf16 v[100:103], v[24:27], v[4:7], v[100:103]
    ds_read_b128 v[56:59], v136 offset:5120
    buffer_load_dwordx4 v140, s[8:11], s15 offen offset:3072 lds
    v_mfma_f32_16x16x32_bf16 v[104:107], v[24:27], v[8:11], v[104:107]
    ds_read_b128 v[60:63], v136 offset:7168
    v_mfma_f32_16x16x32_bf16 v[108:111], v[24:27], v[12:15], v[108:111]
    v_mfma_f32_16x16x32_bf16 v[112:115], v[28:31], v[0:3], v[112:115]
    s_add_u32 s15, s15, s17
    v_mfma_f32_16x16x32_bf16 v[116:119], v[28:31], v[4:7], v[116:119]
    v_mfma_f32_16x16x32_bf16 v[120:123], v[28:31], v[8:11], v[120:123]
    v_mfma_f32_16x16x32_bf16 v[124:127], v[28:31], v[12:15], v[124:127]
    s_waitcnt lgkmcnt(0)
    v_mfma_f32_16x16x32_bf16 v[64:67], v[48:51], v[32:35], v[64:67]
    s_waitcnt vmcnt(16)
    s_barrier
    ds_read_b128 v[16:19], v136 offset:16384
    v_mfma_f32_16x16x32_bf16 v[68:71], v[48:51], v[36:39], v[68:71]
    ds_read_b64_tr_b16 v[0:1], v128 offset:16384
    v_mfma_f32_16x16x32_bf16 v[72:75], v[48:51], v[40:43], v[72:75]
    ds_read_b64_tr_b16 v[2:3], v128 offset:20480
    v_mfma_f32_16x16x32_bf16 v[76:79], v[48:51], v[44:47], v[76:79]
    ds_read_b64_tr_b16 v[4:5], v129 offset:16384
    v_mfma_f32_16x16x32_bf16 v[80:83], v[52:55], v[32:35], v[80:83]
    ds_read_b64_tr_b16 v[6:7], v129 offset:20480
    v_mfma_f32_16x16x32_bf16 v[84:87], v[52:55], v[36:39], v[84:87]
    ds_read_b64_tr_b16 v[8:9], v130 offset:16384
    v_mfma_f32_16x16x32_bf16 v[88:91], v[52:55], v[40:43], v[88:91]
    ds_read_b64_tr_b16 v[10:11], v130 offset:20480
    v_mfma_f32_16x16x32_bf16 v[92:95], v[52:55], v[44:47], v[92:95]
    ds_read_b64_tr_b16 v[12:13], v131 offset:16384
    v_mfma_f32_16x16x32_bf16 v[96:99], v[56:59], v[32:35], v[96:99]
    ds_read_b64_tr_b16 v[14:15], v131 offset:20480
    v_mfma_f32_16x16x32_bf16 v[100:103], v[56:59], v[36:39], v[100:103]
    ds_read_b128 v[20:23], v136 offset:18432
    v_mfma_f32_16x16x32_bf16 v[104:107], v[56:59], v[40:43], v[104:107]
    ds_read_b128 v[24:27], v136 offset:20480
    v_mfma_f32_16x16x32_bf16 v[108:111], v[56:59], v[44:47], v[108:111]
    ds_read_b128 v[28:31], v136 offset:22528
    v_mfma_f32_16x16x32_bf16 v[112:115], v[60:63], v[32:35], v[112:115]
    v_mfma_f32_16x16x32_bf16 v[116:119], v[60:63], v[36:39], v[116:119]
    v_mfma_f32_16x16x32_bf16 v[120:123], v[60:63], v[40:43], v[120:123]
    v_mfma_f32_16x16x32_bf16 v[124:127], v[60:63], v[44:47], v[124:127]
    s_waitcnt lgkmcnt(0)
    ds_read_b128 v[48:51], v136 offset:17408
    v_mfma_f32_16x16x32_bf16 v[64:67], v[16:19], v[0:3], v[64:67]
    ds_read_b64_tr_b16 v[32:33], v128 offset:24576
    v_mfma_f32_16x16x32_bf16 v[68:71], v[16:19], v[4:7], v[68:71]
    ds_read_b64_tr_b16 v[34:35], v128 offset:28672
    v_mfma_f32_16x16x32_bf16 v[72:75], v[16:19], v[8:11], v[72:75]
    ds_read_b64_tr_b16 v[36:37], v129 offset:24576
    v_mfma_f32_16x16x32_bf16 v[76:79], v[16:19], v[12:15], v[76:79]
    ds_read_b64_tr_b16 v[38:39], v129 offset:28672
    v_mfma_f32_16x16x32_bf16 v[80:83], v[20:23], v[0:3], v[80:83]
    ds_read_b64_tr_b16 v[40:41], v130 offset:24576
    v_mfma_f32_16x16x32_bf16 v[84:87], v[20:23], v[4:7], v[84:87]
    ds_read_b64_tr_b16 v[42:43], v130 offset:28672
    v_mfma_f32_16x16x32_bf16 v[88:91], v[20:23], v[8:11], v[88:91]
    ds_read_b64_tr_b16 v[44:45], v131 offset:24576
    v_mfma_f32_16x16x32_bf16 v[92:95], v[20:23], v[12:15], v[92:95]
    ds_read_b64_tr_b16 v[46:47], v131 offset:28672
    v_mfma_f32_16x16x32_bf16 v[96:99], v[24:27], v[0:3], v[96:99]
    ds_read_b128 v[52:55], v136 offset:19456
    v_mfma_f32_16x16x32_bf16 v[100:103], v[24:27], v[4:7], v[100:103]
    ds_read_b128 v[56:59], v136 offset:21504
    v_mfma_f32_16x16x32_bf16 v[104:107], v[24:27], v[8:11], v[104:107]
    ds_read_b128 v[60:63], v136 offset:23552
    v_mfma_f32_16x16x32_bf16 v[108:111], v[24:27], v[12:15], v[108:111]
    v_mfma_f32_16x16x32_bf16 v[112:115], v[28:31], v[0:3], v[112:115]
    v_mfma_f32_16x16x32_bf16 v[116:119], v[28:31], v[4:7], v[116:119]
    v_mfma_f32_16x16x32_bf16 v[120:123], v[28:31], v[8:11], v[120:123]
    v_mfma_f32_16x16x32_bf16 v[124:127], v[28:31], v[12:15], v[124:127]
    s_waitcnt lgkmcnt(0)
    v_mfma_f32_16x16x32_bf16 v[64:67], v[48:51], v[32:35], v[64:67]
    s_waitcnt vmcnt(8)
    s_barrier
    ds_read_b128 v[16:19], v136 offset:32768
    v_mfma_f32_16x16x32_bf16 v[68:71], v[48:51], v[36:39], v[68:71]
    ds_read_b64_tr_b16 v[0:1], v128 offset:32768
    v_mfma_f32_16x16x32_bf16 v[72:75], v[48:51], v[40:43], v[72:75]
    ds_read_b64_tr_b16 v[2:3], v128 offset:36864
    v_mfma_f32_16x16x32_bf16 v[76:79], v[48:51], v[44:47], v[76:79]
    ds_read_b64_tr_b16 v[4:5], v129 offset:32768
    v_mfma_f32_16x16x32_bf16 v[80:83], v[52:55], v[32:35], v[80:83]
    ds_read_b64_tr_b16 v[6:7], v129 offset:36864
    v_mfma_f32_16x16x32_bf16 v[84:87], v[52:55], v[36:39], v[84:87]
    ds_read_b64_tr_b16 v[8:9], v130 offset:32768
    v_mfma_f32_16x16x32_bf16 v[88:91], v[52:55], v[40:43], v[88:91]
    ds_read_b64_tr_b16 v[10:11], v130 offset:36864
    v_mfma_f32_16x16x32_bf16 v[92:95], v[52:55], v[44:47], v[92:95]
    ds_read_b64_tr_b16 v[12:13], v131 offset:32768
    v_mfma_f32_16x16x32_bf16 v[96:99], v[56:59], v[32:35], v[96:99]
    ds_read_b64_tr_b16 v[14:15], v131 offset:36864
    v_mfma_f32_16x16x32_bf16 v[100:103], v[56:59], v[36:39], v[100:103]
    ds_read_b128 v[20:23], v136 offset:34816
    v_mfma_f32_16x16x32_bf16 v[104:107], v[56:59], v[40:43], v[104:107]
    ds_read_b128 v[24:27], v136 offset:36864
    v_mfma_f32_16x16x32_bf16 v[108:111], v[56:59], v[44:47], v[108:111]
    ds_read_b128 v[28:31], v136 offset:38912
    v_mfma_f32_16x16x32_bf16 v[112:115], v[60:63], v[32:35], v[112:115]
    v_mfma_f32_16x16x32_bf16 v[116:119], v[60:63], v[36:39], v[116:119]
    v_mfma_f32_16x16x32_bf16 v[120:123], v[60:63], v[40:43], v[120:123]
    v_mfma_f32_16x16x32_bf16 v[124:127], v[60:63], v[44:47], v[124:127]
    s_waitcnt lgkmcnt(0)
    ds_read_b128 v[48:51], v136 offset:33792
    v_mfma_f32_16x16x32_bf16 v[64:67], v[16:19], v[0:3], v[64:67]
    ds_read_b64_tr_b16 v[32:33], v128 offset:40960
    v_mfma_f32_16x16x32_bf16 v[68:71], v[16:19], v[4:7], v[68:71]
    ds_read_b64_tr_b16 v[34:35], v128 offset:45056
    v_mfma_f32_16x16x32_bf16 v[72:75], v[16:19], v[8:11], v[72:75]
    ds_read_b64_tr_b16 v[36:37], v129 offset:40960
    v_mfma_f32_16x16x32_bf16 v[76:79], v[16:19], v[12:15], v[76:79]
    ds_read_b64_tr_b16 v[38:39], v129 offset:45056
    v_mfma_f32_16x16x32_bf16 v[80:83], v[20:23], v[0:3], v[80:83]
    ds_read_b64_tr_b16 v[40:41], v130 offset:40960
    v_mfma_f32_16x16x32_bf16 v[84:87], v[20:23], v[4:7], v[84:87]
    ds_read_b64_tr_b16 v[42:43], v130 offset:45056
    v_mfma_f32_16x16x32_bf16 v[88:91], v[20:23], v[8:11], v[88:91]
    ds_read_b64_tr_b16 v[44:45], v131 offset:40960
    v_mfma_f32_16x16x32_bf16 v[92:95], v[20:23], v[12:15], v[92:95]
    ds_read_b64_tr_b16 v[46:47], v131 offset:45056
    v_mfma_f32_16x16x32_bf16 v[96:99], v[24:27], v[0:3], v[96:99]
    ds_read_b128 v[52:55], v136 offset:35840
    v_mfma_f32_16x16x32_bf16 v[100:103], v[24:27], v[4:7], v[100:103]
    ds_read_b128 v[56:59], v136 offset:37888
    v_mfma_f32_16x16x32_bf16 v[104:107], v[24:27], v[8:11], v[104:107]
    ds_read_b128 v[60:63], v136 offset:39936
    v_mfma_f32_16x16x32_bf16 v[108:111], v[24:27], v[12:15], v[108:111]
    v_mfma_f32_16x16x32_bf16 v[112:115], v[28:31], v[0:3], v[112:115]
    v_mfma_f32_16x16x32_bf16 v[116:119], v[28:31], v[4:7], v[116:119]
    v_mfma_f32_16x16x32_bf16 v[120:123], v[28:31], v[8:11], v[120:123]
    v_mfma_f32_16x16x32_bf16 v[124:127], v[28:31], v[12:15], v[124:127]
    s_waitcnt lgkmcnt(0)
    v_mfma_f32_16x16x32_bf16 v[64:67], v[48:51], v[32:35], v[64:67]
    s_waitcnt vmcnt(0)
    s_barrier
    ds_read_b128 v[16:19], v136 offset:49152
    v_mfma_f32_16x16x32_bf16 v[68:71], v[48:51], v[36:39], v[68:71]
    ds_read_b64_tr_b16 v[0:1], v128 offset:49152
    v_mfma_f32_16x16x32_bf16 v[72:75], v[48:51], v[40:43], v[72:75]
    ds_read_b64_tr_b16 v[2:3], v128 offset:53248
    v_mfma_f32_16x16x32_bf16 v[76:79], v[48:51], v[44:47], v[76:79]
    ds_read_b64_tr_b16 v[4:5], v129 offset:49152
    v_mfma_f32_16x16x32_bf16 v[80:83], v[52:55], v[32:35], v[80:83]
    ds_read_b64_tr_b16 v[6:7], v129 offset:53248
    v_mfma_f32_16x16x32_bf16 v[84:87], v[52:55], v[36:39], v[84:87]
    ds_read_b64_tr_b16 v[8:9], v130 offset:49152
    v_mfma_f32_16x16x32_bf16 v[88:91], v[52:55], v[40:43], v[88:91]
    ds_read_b64_tr_b16 v[10:11], v130 offset:53248
    v_mfma_f32_16x16x32_bf16 v[92:95], v[52:55], v[44:47], v[92:95]
    ds_read_b64_tr_b16 v[12:13], v131 offset:49152
    v_mfma_f32_16x16x32_bf16 v[96:99], v[56:59], v[32:35], v[96:99]
    ds_read_b64_tr_b16 v[14:15], v131 offset:53248
    v_mfma_f32_16x16x32_bf16 v[100:103], v[56:59], v[36:39], v[100:103]
    ds_read_b128 v[20:23], v136 offset:51200
    v_mfma_f32_16x16x32_bf16 v[104:107], v[56:59], v[40:43], v[104:107]
    ds_read_b128 v[24:27], v136 offset:53248
    v_mfma_f32_16x16x32_bf16 v[108:111], v[56:59], v[44:47], v[108:111]
    ds_read_b128 v[28:31], v136 offset:55296
    v_mfma_f32_16x16x32_bf16 v[112:115], v[60:63], v[32:35], v[112:115]
    v_mfma_f32_16x16x32_bf16 v[116:119], v[60:63], v[36:39], v[116:119]
    v_mfma_f32_16x16x32_bf16 v[120:123], v[60:63], v[40:43], v[120:123]
    v_mfma_f32_16x16x32_bf16 v[124:127], v[60:63], v[44:47], v[124:127]
    v_readfirstlane_b32 s55, v255
    s_waitcnt lgkmcnt(0)
    ds_read_b128 v[48:51], v136 offset:50176
    v_mfma_f32_16x16x32_bf16 v[64:67], v[16:19], v[0:3], v[64:67]
    ds_read_b64_tr_b16 v[32:33], v128 offset:57344
    v_mfma_f32_16x16x32_bf16 v[68:71], v[16:19], v[4:7], v[68:71]
    ds_read_b64_tr_b16 v[34:35], v128 offset:61440
    v_mfma_f32_16x16x32_bf16 v[72:75], v[16:19], v[8:11], v[72:75]
    ds_read_b64_tr_b16 v[36:37], v129 offset:57344
    v_mfma_f32_16x16x32_bf16 v[76:79], v[16:19], v[12:15], v[76:79]
    ds_read_b64_tr_b16 v[38:39], v129 offset:61440
    v_mfma_f32_16x16x32_bf16 v[80:83], v[20:23], v[0:3], v[80:83]
    ds_read_b64_tr_b16 v[40:41], v130 offset:57344
    v_mfma_f32_16x16x32_bf16 v[84:87], v[20:23], v[4:7], v[84:87]
    ds_read_b64_tr_b16 v[42:43], v130 offset:61440
    v_mfma_f32_16x16x32_bf16 v[88:91], v[20:23], v[8:11], v[88:91]
    ds_read_b64_tr_b16 v[44:45], v131 offset:57344
    v_mfma_f32_16x16x32_bf16 v[92:95], v[20:23], v[12:15], v[92:95]
    ds_read_b64_tr_b16 v[46:47], v131 offset:61440
    v_mfma_f32_16x16x32_bf16 v[96:99], v[24:27], v[0:3], v[96:99]
    ds_read_b128 v[52:55], v136 offset:52224
    v_mfma_f32_16x16x32_bf16 v[100:103], v[24:27], v[4:7], v[100:103]
    ds_read_b128 v[56:59], v136 offset:54272
    v_mfma_f32_16x16x32_bf16 v[104:107], v[24:27], v[8:11], v[104:107]
    ds_read_b128 v[60:63], v136 offset:56320
    v_mfma_f32_16x16x32_bf16 v[108:111], v[24:27], v[12:15], v[108:111]
    v_mfma_f32_16x16x32_bf16 v[112:115], v[28:31], v[0:3], v[112:115]
    v_mfma_f32_16x16x32_bf16 v[116:119], v[28:31], v[4:7], v[116:119]
    v_mfma_f32_16x16x32_bf16 v[120:123], v[28:31], v[8:11], v[120:123]
    v_mfma_f32_16x16x32_bf16 v[124:127], v[28:31], v[12:15], v[124:127]
    s_waitcnt lgkmcnt(0)
    v_mfma_f32_16x16x32_bf16 v[64:67], v[48:51], v[32:35], v[64:67]
    v_mfma_f32_16x16x32_bf16 v[68:71], v[48:51], v[36:39], v[68:71]
    v_mfma_f32_16x16x32_bf16 v[72:75], v[48:51], v[40:43], v[72:75]
    v_mfma_f32_16x16x32_bf16 v[76:79], v[48:51], v[44:47], v[76:79]
    v_mfma_f32_16x16x32_bf16 v[80:83], v[52:55], v[32:35], v[80:83]
    v_mfma_f32_16x16x32_bf16 v[84:87], v[52:55], v[36:39], v[84:87]
    v_mfma_f32_16x16x32_bf16 v[88:91], v[52:55], v[40:43], v[88:91]
    v_mfma_f32_16x16x32_bf16 v[92:95], v[52:55], v[44:47], v[92:95]
    v_mfma_f32_16x16x32_bf16 v[96:99], v[56:59], v[32:35], v[96:99]
    v_mfma_f32_16x16x32_bf16 v[100:103], v[56:59], v[36:39], v[100:103]
    v_mfma_f32_16x16x32_bf16 v[104:107], v[56:59], v[40:43], v[104:107]
    v_mfma_f32_16x16x32_bf16 v[108:111], v[56:59], v[44:47], v[108:111]
    v_mfma_f32_16x16x32_bf16 v[112:115], v[60:63], v[32:35], v[112:115]
    v_mfma_f32_16x16x32_bf16 v[116:119], v[60:63], v[36:39], v[116:119]
    v_mfma_f32_16x16x32_bf16 v[120:123], v[60:63], v[40:43], v[120:123]
    v_mfma_f32_16x16x32_bf16 v[124:127], v[60:63], v[44:47], v[124:127]
    s_nop 7
    s_mov_b32 s53, s21
    v_cvt_pk_bf16_f32 v8, v64, v65
    v_cvt_pk_bf16_f32 v9, v66, v67
    v_cvt_pk_bf16_f32 v10, v80, v81
    v_cvt_pk_bf16_f32 v11, v82, v83
    buffer_store_dwordx4 v[8:11], v251, s[4:7], s53 offen offset:0 sc1
    v_cvt_pk_bf16_f32 v24, v68, v69
    v_cvt_pk_bf16_f32 v25, v70, v71
    v_cvt_pk_bf16_f32 v26, v84, v85
    v_cvt_pk_bf16_f32 v27, v86, v87
    buffer_store_dwordx4 v[24:27], v251, s[4:7], s53 offen offset:1024 sc1
    v_cvt_pk_bf16_f32 v40, v72, v73
    v_cvt_pk_bf16_f32 v41, v74, v75
    v_cvt_pk_bf16_f32 v42, v88, v89
    v_cvt_pk_bf16_f32 v43, v90, v91
    buffer_store_dwordx4 v[40:43], v251, s[4:7], s53 offen offset:2048 sc1
    v_cvt_pk_bf16_f32 v56, v76, v77
    v_cvt_pk_bf16_f32 v57, v78, v79
    v_cvt_pk_bf16_f32 v58, v92, v93
    v_cvt_pk_bf16_f32 v59, v94, v95
    buffer_store_dwordx4 v[56:59], v251, s[4:7], s53 offen offset:3072 sc1
    s_add_u32 s53, s53, 262144
    v_cvt_pk_bf16_f32 v8, v96, v97
    v_cvt_pk_bf16_f32 v9, v98, v99
    v_cvt_pk_bf16_f32 v10, v112, v113
    v_cvt_pk_bf16_f32 v11, v114, v115
    buffer_store_dwordx4 v[8:11], v251, s[4:7], s53 offen offset:0 sc1
    v_cvt_pk_bf16_f32 v24, v100, v101
    v_cvt_pk_bf16_f32 v25, v102, v103
    v_cvt_pk_bf16_f32 v26, v116, v117
    v_cvt_pk_bf16_f32 v27, v118, v119
    buffer_store_dwordx4 v[24:27], v251, s[4:7], s53 offen offset:1024 sc1
    v_cvt_pk_bf16_f32 v40, v104, v105
    v_cvt_pk_bf16_f32 v41, v106, v107
    v_cvt_pk_bf16_f32 v42, v120, v121
    v_cvt_pk_bf16_f32 v43, v122, v123
    buffer_store_dwordx4 v[40:43], v251, s[4:7], s53 offen offset:2048 sc1
    v_cvt_pk_bf16_f32 v56, v108, v109
    v_cvt_pk_bf16_f32 v57, v110, v111
    v_cvt_pk_bf16_f32 v58, v124, v125
    v_cvt_pk_bf16_f32 v59, v126, v127
    buffer_store_dwordx4 v[56:59], v251, s[4:7], s53 offen offset:3072 sc1
    s_add_u32 s53, s53, 262144
    s_branch main_kernel_w_done
main_kernel_w_c1_task:
    s_cmp_eq_u32 s23, 0
    s_cbranch_scc1 main_kernel_w_c1_set0
    s_cmp_eq_u32 s23, 1
    s_cbranch_scc1 main_kernel_w_c1_set1
    s_cmp_eq_u32 s23, 2
    s_cbranch_scc1 main_kernel_w_c1_set2
    s_cmp_eq_u32 s23, 3
    s_cbranch_scc1 main_kernel_w_c1_set3
    s_cmp_eq_u32 s23, 6
    s_cbranch_scc1 main_kernel_w_c1_set6
    s_branch main_kernel_w_done
main_kernel_w_c1_set0:
    s_lshl_b32 s32, s25, 8
    s_add_u32 s8, s40, s32
    s_addc_u32 s9, s41, 0
    s_and_b32 s9, s9, 0xffff
    s_sub_u32 s10, 0x800000, s32
    s_mov_b32 s11, 0x20000
    s_mov_b32 s30, 8192
    s_mov_b32 s31, 32768
    s_mul_i32 s16, s24, 262144
    s_add_u32 s16, s16, 0x0
    s_mov_b32 s18, 7
    s_lshl_b32 s32, s24, 3
    s_mul_i32 s33, s38, 4
    s_add_u32 s32, s32, s33
    s_mul_i32 s32, s32, 131072
    s_lshl_b32 s33, s25, 12
    s_add_u32 s32, s32, s33
    s_mul_i32 s33, s37, 4096
    s_add_u32 s32, s32, s33
    s_add_u32 s21, s32, 0x800000
    s_mov_b32 s22, 131072
    s_mov_b32 s26, -1
    s_branch main_kernel_w_c1_go
main_kernel_w_c1_set1:
    s_lshl_b32 s32, s25, 8
    s_add_u32 s8, s42, s32
    s_addc_u32 s9, s43, 0
    s_and_b32 s9, s9, 0xffff
    s_sub_u32 s10, 0x800000, s32
    s_mov_b32 s11, 0x20000
    s_mov_b32 s30, 8192
    s_mov_b32 s31, 32768
    s_mul_i32 s16, s24, 262144
    s_add_u32 s16, s16, 0x0
    s_mov_b32 s18, 7
    s_lshl_b32 s32, s24, 3
    s_mul_i32 s33, s38, 4
    s_add_u32 s32, s32, s33
    s_mul_i32 s32, s32, 131072
    s_lshl_b32 s33, s25, 12
    s_add_u32 s32, s32, s33
    s_mul_i32 s33, s37, 4096
    s_add_u32 s32, s32, s33
    s_add_u32 s21, s32, 0x1800000
    s_mov_b32 s22, 131072
    s_mov_b32 s26, -1
    s_branch main_kernel_w_c1_go
main_kernel_w_c1_set2:
    s_lshl_b32 s32, s25, 8
    s_add_u32 s8, s44, s32
    s_addc_u32 s9, s45, 0
    s_and_b32 s9, s9, 0xffff
    s_sub_u32 s10, 0x800000, s32
    s_mov_b32 s11, 0x20000
    s_mov_b32 s30, 8192
    s_mov_b32 s31, 32768
    s_mul_i32 s16, s24, 262144
    s_add_u32 s16, s16, 0x0
    s_mov_b32 s18, 7
    s_lshl_b32 s32, s24, 2
    s_mul_i32 s33, s38, 2
    s_add_u32 s32, s32, s33
    s_lshl_b32 s32, s32, 18
    s_lshl_b32 s33, s25, 13
    s_add_u32 s32, s32, s33
    s_mul_i32 s33, s37, 8192
    s_add_u32 s32, s32, s33
    s_add_u32 s21, s32, 0x2800000
    s_branch main_kernel_w_c1_gov
main_kernel_w_c1_set3:
    s_lshl_b32 s32, s25, 8
    s_add_u32 s8, s64, s32
    s_addc_u32 s9, s65, 0
    s_and_b32 s9, s9, 0xffff
    s_sub_u32 s10, 0x200000, s32
    s_mov_b32 s11, 0x20000
    s_mov_b32 s30, 2048
    s_mov_b32 s31, 32768
    s_mul_i32 s16, s24, 262144
    s_add_u32 s16, s16, 0x400000
    s_mov_b32 s18, 7
    s_lshl_b32 s32, s24, 3
    s_mul_i32 s33, s38, 4
    s_add_u32 s32, s32, s33
    s_mul_i32 s32, s32, 32768
    s_lshl_b32 s33, s25, 12
    s_add_u32 s32, s32, s33
    s_mul_i32 s33, s37, 4096
    s_add_u32 s32, s32, s33
    s_add_u32 s21, s32, 0x4800000
    s_mov_b32 s22, 32768
    s_mov_b32 s26, -1
    s_lshr_b32 s32, s25, 2
    s_add_u32 s32, s32, 1
    s_sub_u32 s33, 0, s32
    s_bitcmp1_b32 s25, 1
    s_cselect_b32 s32, s33, s32
    s_add_u32 s32, s32, 16
    v_and_b32 v253, 15, v250
    v_add_u32 v253, s32, v253
    v_lshrrev_b32 v254, 4, v253
    v_lshlrev_b32 v254, 15, v254
    v_and_b32 v253, 15, v253
    v_lshl_add_u32 v254, v253, 4, v254
    v_and_b32 v253, 0x300, v251
    v_add_u32 v252, v253, v254
    s_branch main_kernel_w_c1_go
main_kernel_w_c1_set6:
    s_lshl_b32 s32, s25, 8
    s_add_u32 s8, s68, s32
    s_addc_u32 s9, s69, 0
    s_and_b32 s9, s9, 0xffff
    s_sub_u32 s10, 0x700000, s32
    s_mov_b32 s11, 0x20000
    s_mov_b32 s30, 7168
    s_mov_b32 s31, 32768
    s_mul_i32 s16, s24, 262144
    s_add_u32 s16, s16, 0x6800000
    s_mov_b32 s18, 7
    s_lshl_b32 s32, s24, 3
    s_mul_i32 s33, s38, 4
    s_add_u32 s32, s32, s33
    s_mul_i32 s32, s32, 114688
    s_lshl_b32 s33, s25, 12
    s_add_u32 s32, s32, s33
    s_mul_i32 s33, s37, 4096
    s_add_u32 s32, s32, s33
    s_add_u32 s21, s32, 0x5400000
    s_mov_b32 s22, 114688
    s_mov_b32 s26, -1
    s_branch main_kernel_w_c1_go
main_kernel_w_c1_go:
    v_lshrrev_b32 v0, 4, v250
    v_bfe_u32 v1, v250, 2, 2
    v_lshl_add_u32 v4, v0, 2, v1
    v_and_b32 v5, 7, v4
    v_mul_u32_u24 v4, 512, v4
    v_and_b32 v6, 3, v250
    v_lshl_add_u32 v4, v6, 3, v4
    s_mul_i32 s32, s37, 8
    v_xor_b32 v5, s32, v5
    v_lshl_add_u32 v128, v5, 5, v4
    v_xor_b32 v129, 32, v128
    v_xor_b32 v130, 64, v128
    v_xor_b32 v131, 96, v128
    v_xor_b32 v132, 128, v128
    v_xor_b32 v133, 160, v128
    v_xor_b32 v134, 192, v128
    v_xor_b32 v135, 224, v128
    s_mul_i32 s32, s38, 4096
    s_add_u32 s32, s32, 65536
    v_add_u32 v136, s32, v251
    v_lshrrev_b32 v2, 5, v250
    v_and_b32 v3, 31, v250
    s_mul_i32 s32, s14, 8
    v_add_u32 v4, s32, v2
    v_add_u32 v5, 0, v4
    v_and_b32 v6, 7, v5
    v_lshlrev_b32 v6, 1, v6
    v_xor_b32 v6, v6, v3
    v_mul_lo_u32 v5, v5, s30
    v_lshl_add_u32 v5, v6, 4, v5
    v_subrev_u32 v137, 0, v5
    v_add_u32 v5, 2, v4
    v_and_b32 v6, 7, v5
    v_lshlrev_b32 v6, 1, v6
    v_xor_b32 v6, v6, v3
    v_mul_lo_u32 v5, v5, s30
    v_lshl_add_u32 v5, v6, 4, v5
    v_subrev_u32 v138, 1024, v5
    v_add_u32 v5, 4, v4
    v_and_b32 v6, 7, v5
    v_lshlrev_b32 v6, 1, v6
    v_xor_b32 v6, v6, v3
    v_mul_lo_u32 v5, v5, s30
    v_lshl_add_u32 v5, v6, 4, v5
    v_subrev_u32 v139, 2048, v5
    v_add_u32 v5, 6, v4
    v_and_b32 v6, 7, v5
    v_lshlrev_b32 v6, 1, v6
    v_xor_b32 v6, v6, v3
    v_mul_lo_u32 v5, v5, s30
    v_lshl_add_u32 v5, v6, 4, v5
    v_subrev_u32 v140, 3072, v5
    s_mul_i32 s32, s14, 2
    s_mul_i32 s32, s32, s31
    v_add_u32 v141, s32, v251
    s_add_u32 s32, s32, s31
    s_sub_u32 s32, s32, 1024
    v_add_u32 v142, s32, v251
    s_mul_i32 s19, s14, 4096
    s_mul_i32 s20, s14, 2048
    s_add_u32 s20, s20, 65536
    s_mul_i32 s17, s30, 32
    s_mov_b32 s15, 0
    s_add_u32 m0, s20, 0
    s_nop 0
    buffer_load_dwordx4 v141, s[4:7], s16 offen offset:0 sc1 lds
    buffer_load_dwordx4 v142, s[4:7], s16 offen offset:1024 sc1 lds
    s_add_u32 s16, s16, 1024
    s_add_u32 m0, s19, 0
    s_nop 0
    buffer_load_dwordx4 v137, s[8:11], s15 offen offset:0 lds
    buffer_load_dwordx4 v138, s[8:11], s15 offen offset:1024 lds
    buffer_load_dwordx4 v139, s[8:11], s15 offen offset:2048 lds
    buffer_load_dwordx4 v140, s[8:11], s15 offen offset:3072 lds
    s_add_u32 s15, s15, s17
    s_add_u32 m0, s20, 8192
    s_nop 0
    buffer_load_dwordx4 v141, s[4:7], s16 offen offset:0 sc1 lds
    buffer_load_dwordx4 v142, s[4:7], s16 offen offset:1024 sc1 lds
    s_add_u32 s16, s16, 1024
    s_add_u32 m0, s19, 16384
    s_nop 0
    buffer_load_dwordx4 v137, s[8:11], s15 offen offset:0 lds
    buffer_load_dwordx4 v138, s[8:11], s15 offen offset:1024 lds
    buffer_load_dwordx4 v139, s[8:11], s15 offen offset:2048 lds
    buffer_load_dwordx4 v140, s[8:11], s15 offen offset:3072 lds
    s_add_u32 s15, s15, s17
    s_add_u32 m0, s20, 16384
    s_nop 0
    buffer_load_dwordx4 v141, s[4:7], s16 offen offset:0 sc1 lds
    buffer_load_dwordx4 v142, s[4:7], s16 offen offset:1024 sc1 lds
    s_add_u32 s16, s16, 1024
    s_add_u32 m0, s19, 32768
    s_nop 0
    buffer_load_dwordx4 v137, s[8:11], s15 offen offset:0 lds
    buffer_load_dwordx4 v138, s[8:11], s15 offen offset:1024 lds
    buffer_load_dwordx4 v139, s[8:11], s15 offen offset:2048 lds
    buffer_load_dwordx4 v140, s[8:11], s15 offen offset:3072 lds
    s_add_u32 s15, s15, s17
    s_add_u32 m0, s20, 24576
    s_nop 0
    buffer_load_dwordx4 v141, s[4:7], s16 offen offset:0 sc1 lds
    buffer_load_dwordx4 v142, s[4:7], s16 offen offset:1024 sc1 lds
    s_add_u32 s16, s16, 1024
    s_add_u32 m0, s19, 49152
    s_nop 0
    buffer_load_dwordx4 v137, s[8:11], s15 offen offset:0 lds
    buffer_load_dwordx4 v138, s[8:11], s15 offen offset:1024 lds
    buffer_load_dwordx4 v139, s[8:11], s15 offen offset:2048 lds
    buffer_load_dwordx4 v140, s[8:11], s15 offen offset:3072 lds
    s_add_u32 s15, s15, s17
    v_accvgpr_write_b32 a0, 0
    v_accvgpr_write_b32 a1, 0
    v_accvgpr_write_b32 a2, 0
    v_accvgpr_write_b32 a3, 0
    v_accvgpr_write_b32 a4, 0
    v_accvgpr_write_b32 a5, 0
    v_accvgpr_write_b32 a6, 0
    v_accvgpr_write_b32 a7, 0
    v_accvgpr_write_b32 a8, 0
    v_accvgpr_write_b32 a9, 0
    v_accvgpr_write_b32 a10, 0
    v_accvgpr_write_b32 a11, 0
    v_accvgpr_write_b32 a12, 0
    v_accvgpr_write_b32 a13, 0
    v_accvgpr_write_b32 a14, 0
    v_accvgpr_write_b32 a15, 0
    v_accvgpr_write_b32 a16, 0
    v_accvgpr_write_b32 a17, 0
    v_accvgpr_write_b32 a18, 0
    v_accvgpr_write_b32 a19, 0
    v_accvgpr_write_b32 a20, 0
    v_accvgpr_write_b32 a21, 0
    v_accvgpr_write_b32 a22, 0
    v_accvgpr_write_b32 a23, 0
    v_accvgpr_write_b32 a24, 0
    v_accvgpr_write_b32 a25, 0
    v_accvgpr_write_b32 a26, 0
    v_accvgpr_write_b32 a27, 0
    v_accvgpr_write_b32 a28, 0
    v_accvgpr_write_b32 a29, 0
    v_accvgpr_write_b32 a30, 0
    v_accvgpr_write_b32 a31, 0
    v_accvgpr_write_b32 a32, 0
    v_accvgpr_write_b32 a33, 0
    v_accvgpr_write_b32 a34, 0
    v_accvgpr_write_b32 a35, 0
    v_accvgpr_write_b32 a36, 0
    v_accvgpr_write_b32 a37, 0
    v_accvgpr_write_b32 a38, 0
    v_accvgpr_write_b32 a39, 0
    v_accvgpr_write_b32 a40, 0
    v_accvgpr_write_b32 a41, 0
    v_accvgpr_write_b32 a42, 0
    v_accvgpr_write_b32 a43, 0
    v_accvgpr_write_b32 a44, 0
    v_accvgpr_write_b32 a45, 0
    v_accvgpr_write_b32 a46, 0
    v_accvgpr_write_b32 a47, 0
    v_accvgpr_write_b32 a48, 0
    v_accvgpr_write_b32 a49, 0
    v_accvgpr_write_b32 a50, 0
    v_accvgpr_write_b32 a51, 0
    v_accvgpr_write_b32 a52, 0
    v_accvgpr_write_b32 a53, 0
    v_accvgpr_write_b32 a54, 0
    v_accvgpr_write_b32 a55, 0
    v_accvgpr_write_b32 a56, 0
    v_accvgpr_write_b32 a57, 0
    v_accvgpr_write_b32 a58, 0
    v_accvgpr_write_b32 a59, 0
    v_accvgpr_write_b32 a60, 0
    v_accvgpr_write_b32 a61, 0
    v_accvgpr_write_b32 a62, 0
    v_accvgpr_write_b32 a63, 0
    v_accvgpr_write_b32 a64, 0
    v_accvgpr_write_b32 a65, 0
    v_accvgpr_write_b32 a66, 0
    v_accvgpr_write_b32 a67, 0
    v_accvgpr_write_b32 a68, 0
    v_accvgpr_write_b32 a69, 0
    v_accvgpr_write_b32 a70, 0
    v_accvgpr_write_b32 a71, 0
    v_accvgpr_write_b32 a72, 0
    v_accvgpr_write_b32 a73, 0
    v_accvgpr_write_b32 a74, 0
    v_accvgpr_write_b32 a75, 0
    v_accvgpr_write_b32 a76, 0
    v_accvgpr_write_b32 a77, 0
    v_accvgpr_write_b32 a78, 0
    v_accvgpr_write_b32 a79, 0
    v_accvgpr_write_b32 a80, 0
    v_accvgpr_write_b32 a81, 0
    v_accvgpr_write_b32 a82, 0
    v_accvgpr_write_b32 a83, 0
    v_accvgpr_write_b32 a84, 0
    v_accvgpr_write_b32 a85, 0
    v_accvgpr_write_b32 a86, 0
    v_accvgpr_write_b32 a87, 0
    v_accvgpr_write_b32 a88, 0
    v_accvgpr_write_b32 a89, 0
    v_accvgpr_write_b32 a90, 0
    v_accvgpr_write_b32 a91, 0
    v_accvgpr_write_b32 a92, 0
    v_accvgpr_write_b32 a93, 0
    v_accvgpr_write_b32 a94, 0
    v_accvgpr_write_b32 a95, 0
    v_accvgpr_write_b32 a96, 0
    v_accvgpr_write_b32 a97, 0
    v_accvgpr_write_b32 a98, 0
    v_accvgpr_write_b32 a99, 0
    v_accvgpr_write_b32 a100, 0
    v_accvgpr_write_b32 a101, 0
    v_accvgpr_write_b32 a102, 0
    v_accvgpr_write_b32 a103, 0
    v_accvgpr_write_b32 a104, 0
    v_accvgpr_write_b32 a105, 0
    v_accvgpr_write_b32 a106, 0
    v_accvgpr_write_b32 a107, 0
    v_accvgpr_write_b32 a108, 0
    v_accvgpr_write_b32 a109, 0
    v_accvgpr_write_b32 a110, 0
    v_accvgpr_write_b32 a111, 0
    v_accvgpr_write_b32 a112, 0
    v_accvgpr_write_b32 a113, 0
    v_accvgpr_write_b32 a114, 0
    v_accvgpr_write_b32 a115, 0
    v_accvgpr_write_b32 a116, 0
    v_accvgpr_write_b32 a117, 0
    v_accvgpr_write_b32 a118, 0
    v_accvgpr_write_b32 a119, 0
    v_accvgpr_write_b32 a120, 0
    v_accvgpr_write_b32 a121, 0
    v_accvgpr_write_b32 a122, 0
    v_accvgpr_write_b32 a123, 0
    v_accvgpr_write_b32 a124, 0
    v_accvgpr_write_b32 a125, 0
    v_accvgpr_write_b32 a126, 0
    v_accvgpr_write_b32 a127, 0
    s_waitcnt vmcnt(18)
    s_barrier
    ds_read_b128 v[32:35], v136 offset:0
    ds_read_b64_tr_b16 v[0:1], v128 offset:0
    ds_read_b64_tr_b16 v[2:3], v128 offset:8192
    ds_read_b64_tr_b16 v[4:5], v129 offset:0
    ds_read_b64_tr_b16 v[6:7], v129 offset:8192
    ds_read_b64_tr_b16 v[8:9], v130 offset:0
    ds_read_b64_tr_b16 v[10:11], v130 offset:8192
    ds_read_b64_tr_b16 v[12:13], v131 offset:0
    ds_read_b64_tr_b16 v[14:15], v131 offset:8192
    ds_read_b64_tr_b16 v[16:17], v132 offset:0
    ds_read_b64_tr_b16 v[18:19], v132 offset:8192
    ds_read_b64_tr_b16 v[20:21], v133 offset:0
    ds_read_b64_tr_b16 v[22:23], v133 offset:8192
    ds_read_b64_tr_b16 v[24:25], v134 offset:0
    ds_read_b64_tr_b16 v[26:27], v134 offset:8192
    ds_read_b64_tr_b16 v[28:29], v135 offset:0
    ds_read_b64_tr_b16 v[30:31], v135 offset:8192
    ds_read_b128 v[36:39], v136 offset:1024
    ds_read_b128 v[40:43], v136 offset:2048
    ds_read_b128 v[44:47], v136 offset:3072
main_kernel_w_c1_n_loop:
    s_waitcnt lgkmcnt(0)
    v_mfma_f32_16x16x32_bf16 a[0:3], v[0:3], v[32:35], a[0:3]
    s_waitcnt vmcnt(12)
    s_barrier
    ds_read_b128 v[80:83], v136 offset:8192
    s_add_u32 m0, s20, 0
    s_nop 0
    v_mfma_f32_16x16x32_bf16 a[4:7], v[4:7], v[32:35], a[4:7]
    ds_read_b64_tr_b16 v[48:49], v128 offset:16384
    v_mfma_f32_16x16x32_bf16 a[8:11], v[8:11], v[32:35], a[8:11]
    ds_read_b64_tr_b16 v[50:51], v128 offset:24576
    v_mfma_f32_16x16x32_bf16 a[12:15], v[12:15], v[32:35], a[12:15]
    ds_read_b64_tr_b16 v[52:53], v129 offset:16384
    buffer_load_dwordx4 v141, s[4:7], s16 offen offset:0 sc1 lds
    v_mfma_f32_16x16x32_bf16 a[16:19], v[16:19], v[32:35], a[16:19]
    ds_read_b64_tr_b16 v[54:55], v129 offset:24576
    v_mfma_f32_16x16x32_bf16 a[20:23], v[20:23], v[32:35], a[20:23]
    ds_read_b64_tr_b16 v[56:57], v130 offset:16384
    v_mfma_f32_16x16x32_bf16 a[24:27], v[24:27], v[32:35], a[24:27]
    ds_read_b64_tr_b16 v[58:59], v130 offset:24576
    buffer_load_dwordx4 v142, s[4:7], s16 offen offset:1024 sc1 lds
    v_mfma_f32_16x16x32_bf16 a[28:31], v[28:31], v[32:35], a[28:31]
    ds_read_b64_tr_b16 v[60:61], v131 offset:16384
    v_mfma_f32_16x16x32_bf16 a[32:35], v[0:3], v[36:39], a[32:35]
    ds_read_b64_tr_b16 v[62:63], v131 offset:24576
    v_mfma_f32_16x16x32_bf16 a[36:39], v[4:7], v[36:39], a[36:39]
    ds_read_b64_tr_b16 v[64:65], v132 offset:16384
    s_add_u32 s16, s16, 1024
    v_mfma_f32_16x16x32_bf16 a[40:43], v[8:11], v[36:39], a[40:43]
    ds_read_b64_tr_b16 v[66:67], v132 offset:24576
    v_mfma_f32_16x16x32_bf16 a[44:47], v[12:15], v[36:39], a[44:47]
    ds_read_b64_tr_b16 v[68:69], v133 offset:16384
    v_mfma_f32_16x16x32_bf16 a[48:51], v[16:19], v[36:39], a[48:51]
    ds_read_b64_tr_b16 v[70:71], v133 offset:24576
    s_add_u32 m0, s19, 0
    s_nop 0
    v_mfma_f32_16x16x32_bf16 a[52:55], v[20:23], v[36:39], a[52:55]
    ds_read_b64_tr_b16 v[72:73], v134 offset:16384
    v_mfma_f32_16x16x32_bf16 a[56:59], v[24:27], v[36:39], a[56:59]
    ds_read_b64_tr_b16 v[74:75], v134 offset:24576
    v_mfma_f32_16x16x32_bf16 a[60:63], v[28:31], v[36:39], a[60:63]
    ds_read_b64_tr_b16 v[76:77], v135 offset:16384
    buffer_load_dwordx4 v137, s[8:11], s15 offen offset:0 lds
    v_mfma_f32_16x16x32_bf16 a[64:67], v[0:3], v[40:43], a[64:67]
    ds_read_b64_tr_b16 v[78:79], v135 offset:24576
    v_mfma_f32_16x16x32_bf16 a[68:71], v[4:7], v[40:43], a[68:71]
    ds_read_b128 v[84:87], v136 offset:9216
    v_mfma_f32_16x16x32_bf16 a[72:75], v[8:11], v[40:43], a[72:75]
    ds_read_b128 v[88:91], v136 offset:10240
    buffer_load_dwordx4 v138, s[8:11], s15 offen offset:1024 lds
    v_mfma_f32_16x16x32_bf16 a[76:79], v[12:15], v[40:43], a[76:79]
    ds_read_b128 v[92:95], v136 offset:11264
    v_mfma_f32_16x16x32_bf16 a[80:83], v[16:19], v[40:43], a[80:83]
    v_mfma_f32_16x16x32_bf16 a[84:87], v[20:23], v[40:43], a[84:87]
    buffer_load_dwordx4 v139, s[8:11], s15 offen offset:2048 lds
    v_mfma_f32_16x16x32_bf16 a[88:91], v[24:27], v[40:43], a[88:91]
    v_mfma_f32_16x16x32_bf16 a[92:95], v[28:31], v[40:43], a[92:95]
    v_mfma_f32_16x16x32_bf16 a[96:99], v[0:3], v[44:47], a[96:99]
    buffer_load_dwordx4 v140, s[8:11], s15 offen offset:3072 lds
    v_mfma_f32_16x16x32_bf16 a[100:103], v[4:7], v[44:47], a[100:103]
    v_mfma_f32_16x16x32_bf16 a[104:107], v[8:11], v[44:47], a[104:107]
    v_mfma_f32_16x16x32_bf16 a[108:111], v[12:15], v[44:47], a[108:111]
    s_add_u32 s15, s15, s17
    v_mfma_f32_16x16x32_bf16 a[112:115], v[16:19], v[44:47], a[112:115]
    v_mfma_f32_16x16x32_bf16 a[116:119], v[20:23], v[44:47], a[116:119]
    v_mfma_f32_16x16x32_bf16 a[120:123], v[24:27], v[44:47], a[120:123]
    v_mfma_f32_16x16x32_bf16 a[124:127], v[28:31], v[44:47], a[124:127]
    s_waitcnt lgkmcnt(0)
    v_mfma_f32_16x16x32_bf16 a[0:3], v[48:51], v[80:83], a[0:3]
    s_waitcnt vmcnt(12)
    s_barrier
    ds_read_b128 v[32:35], v136 offset:16384
    s_add_u32 m0, s20, 8192
    s_nop 0
    v_mfma_f32_16x16x32_bf16 a[4:7], v[52:55], v[80:83], a[4:7]
    ds_read_b64_tr_b16 v[0:1], v128 offset:32768
    v_mfma_f32_16x16x32_bf16 a[8:11], v[56:59], v[80:83], a[8:11]
    ds_read_b64_tr_b16 v[2:3], v128 offset:40960
    v_mfma_f32_16x16x32_bf16 a[12:15], v[60:63], v[80:83], a[12:15]
    ds_read_b64_tr_b16 v[4:5], v129 offset:32768
    buffer_load_dwordx4 v141, s[4:7], s16 offen offset:0 sc1 lds
    v_mfma_f32_16x16x32_bf16 a[16:19], v[64:67], v[80:83], a[16:19]
    ds_read_b64_tr_b16 v[6:7], v129 offset:40960
    v_mfma_f32_16x16x32_bf16 a[20:23], v[68:71], v[80:83], a[20:23]
    ds_read_b64_tr_b16 v[8:9], v130 offset:32768
    v_mfma_f32_16x16x32_bf16 a[24:27], v[72:75], v[80:83], a[24:27]
    ds_read_b64_tr_b16 v[10:11], v130 offset:40960
    buffer_load_dwordx4 v142, s[4:7], s16 offen offset:1024 sc1 lds
    v_mfma_f32_16x16x32_bf16 a[28:31], v[76:79], v[80:83], a[28:31]
    ds_read_b64_tr_b16 v[12:13], v131 offset:32768
    v_mfma_f32_16x16x32_bf16 a[32:35], v[48:51], v[84:87], a[32:35]
    ds_read_b64_tr_b16 v[14:15], v131 offset:40960
    v_mfma_f32_16x16x32_bf16 a[36:39], v[52:55], v[84:87], a[36:39]
    ds_read_b64_tr_b16 v[16:17], v132 offset:32768
    s_add_u32 s16, s16, 1024
    v_mfma_f32_16x16x32_bf16 a[40:43], v[56:59], v[84:87], a[40:43]
    ds_read_b64_tr_b16 v[18:19], v132 offset:40960
    v_mfma_f32_16x16x32_bf16 a[44:47], v[60:63], v[84:87], a[44:47]
    ds_read_b64_tr_b16 v[20:21], v133 offset:32768
    v_mfma_f32_16x16x32_bf16 a[48:51], v[64:67], v[84:87], a[48:51]
    ds_read_b64_tr_b16 v[22:23], v133 offset:40960
    s_add_u32 m0, s19, 16384
    s_nop 0
    v_mfma_f32_16x16x32_bf16 a[52:55], v[68:71], v[84:87], a[52:55]
    ds_read_b64_tr_b16 v[24:25], v134 offset:32768
    v_mfma_f32_16x16x32_bf16 a[56:59], v[72:75], v[84:87], a[56:59]
    ds_read_b64_tr_b16 v[26:27], v134 offset:40960
    v_mfma_f32_16x16x32_bf16 a[60:63], v[76:79], v[84:87], a[60:63]
    ds_read_b64_tr_b16 v[28:29], v135 offset:32768
    buffer_load_dwordx4 v137, s[8:11], s15 offen offset:0 lds
    v_mfma_f32_16x16x32_bf16 a[64:67], v[48:51], v[88:91], a[64:67]
    ds_read_b64_tr_b16 v[30:31], v135 offset:40960
    v_mfma_f32_16x16x32_bf16 a[68:71], v[52:55], v[88:91], a[68:71]
    ds_read_b128 v[36:39], v136 offset:17408
    v_mfma_f32_16x16x32_bf16 a[72:75], v[56:59], v[88:91], a[72:75]
    ds_read_b128 v[40:43], v136 offset:18432
    buffer_load_dwordx4 v138, s[8:11], s15 offen offset:1024 lds
    v_mfma_f32_16x16x32_bf16 a[76:79], v[60:63], v[88:91], a[76:79]
    ds_read_b128 v[44:47], v136 offset:19456
    v_mfma_f32_16x16x32_bf16 a[80:83], v[64:67], v[88:91], a[80:83]
    v_mfma_f32_16x16x32_bf16 a[84:87], v[68:71], v[88:91], a[84:87]
    buffer_load_dwordx4 v139, s[8:11], s15 offen offset:2048 lds
    v_mfma_f32_16x16x32_bf16 a[88:91], v[72:75], v[88:91], a[88:91]
    v_mfma_f32_16x16x32_bf16 a[92:95], v[76:79], v[88:91], a[92:95]
    v_mfma_f32_16x16x32_bf16 a[96:99], v[48:51], v[92:95], a[96:99]
    buffer_load_dwordx4 v140, s[8:11], s15 offen offset:3072 lds
    v_mfma_f32_16x16x32_bf16 a[100:103], v[52:55], v[92:95], a[100:103]
    v_mfma_f32_16x16x32_bf16 a[104:107], v[56:59], v[92:95], a[104:107]
    v_mfma_f32_16x16x32_bf16 a[108:111], v[60:63], v[92:95], a[108:111]
    s_add_u32 s15, s15, s17
    v_mfma_f32_16x16x32_bf16 a[112:115], v[64:67], v[92:95], a[112:115]
    v_mfma_f32_16x16x32_bf16 a[116:119], v[68:71], v[92:95], a[116:119]
    v_mfma_f32_16x16x32_bf16 a[120:123], v[72:75], v[92:95], a[120:123]
    v_mfma_f32_16x16x32_bf16 a[124:127], v[76:79], v[92:95], a[124:127]
    s_waitcnt lgkmcnt(0)
    v_mfma_f32_16x16x32_bf16 a[0:3], v[0:3], v[32:35], a[0:3]
    s_waitcnt vmcnt(12)
    s_barrier
    ds_read_b128 v[80:83], v136 offset:24576
    s_add_u32 m0, s20, 16384
    s_nop 0
    v_mfma_f32_16x16x32_bf16 a[4:7], v[4:7], v[32:35], a[4:7]
    ds_read_b64_tr_b16 v[48:49], v128 offset:49152
    v_mfma_f32_16x16x32_bf16 a[8:11], v[8:11], v[32:35], a[8:11]
    ds_read_b64_tr_b16 v[50:51], v128 offset:57344
    v_mfma_f32_16x16x32_bf16 a[12:15], v[12:15], v[32:35], a[12:15]
    ds_read_b64_tr_b16 v[52:53], v129 offset:49152
    buffer_load_dwordx4 v141, s[4:7], s16 offen offset:0 sc1 lds
    v_mfma_f32_16x16x32_bf16 a[16:19], v[16:19], v[32:35], a[16:19]
    ds_read_b64_tr_b16 v[54:55], v129 offset:57344
    v_mfma_f32_16x16x32_bf16 a[20:23], v[20:23], v[32:35], a[20:23]
    ds_read_b64_tr_b16 v[56:57], v130 offset:49152
    v_mfma_f32_16x16x32_bf16 a[24:27], v[24:27], v[32:35], a[24:27]
    ds_read_b64_tr_b16 v[58:59], v130 offset:57344
    buffer_load_dwordx4 v142, s[4:7], s16 offen offset:1024 sc1 lds
    v_mfma_f32_16x16x32_bf16 a[28:31], v[28:31], v[32:35], a[28:31]
    ds_read_b64_tr_b16 v[60:61], v131 offset:49152
    v_mfma_f32_16x16x32_bf16 a[32:35], v[0:3], v[36:39], a[32:35]
    ds_read_b64_tr_b16 v[62:63], v131 offset:57344
    v_mfma_f32_16x16x32_bf16 a[36:39], v[4:7], v[36:39], a[36:39]
    ds_read_b64_tr_b16 v[64:65], v132 offset:49152
    s_add_u32 s16, s16, 1024
    v_mfma_f32_16x16x32_bf16 a[40:43], v[8:11], v[36:39], a[40:43]
    ds_read_b64_tr_b16 v[66:67], v132 offset:57344
    v_mfma_f32_16x16x32_bf16 a[44:47], v[12:15], v[36:39], a[44:47]
    ds_read_b64_tr_b16 v[68:69], v133 offset:49152
    v_mfma_f32_16x16x32_bf16 a[48:51], v[16:19], v[36:39], a[48:51]
    ds_read_b64_tr_b16 v[70:71], v133 offset:57344
    s_add_u32 m0, s19, 32768
    s_nop 0
    v_mfma_f32_16x16x32_bf16 a[52:55], v[20:23], v[36:39], a[52:55]
    ds_read_b64_tr_b16 v[72:73], v134 offset:49152
    v_mfma_f32_16x16x32_bf16 a[56:59], v[24:27], v[36:39], a[56:59]
    ds_read_b64_tr_b16 v[74:75], v134 offset:57344
    v_mfma_f32_16x16x32_bf16 a[60:63], v[28:31], v[36:39], a[60:63]
    ds_read_b64_tr_b16 v[76:77], v135 offset:49152
    buffer_load_dwordx4 v137, s[8:11], s15 offen offset:0 lds
    v_mfma_f32_16x16x32_bf16 a[64:67], v[0:3], v[40:43], a[64:67]
    ds_read_b64_tr_b16 v[78:79], v135 offset:57344
    v_mfma_f32_16x16x32_bf16 a[68:71], v[4:7], v[40:43], a[68:71]
    ds_read_b128 v[84:87], v136 offset:25600
    v_mfma_f32_16x16x32_bf16 a[72:75], v[8:11], v[40:43], a[72:75]
    ds_read_b128 v[88:91], v136 offset:26624
    buffer_load_dwordx4 v138, s[8:11], s15 offen offset:1024 lds
    v_mfma_f32_16x16x32_bf16 a[76:79], v[12:15], v[40:43], a[76:79]
    ds_read_b128 v[92:95], v136 offset:27648
    v_mfma_f32_16x16x32_bf16 a[80:83], v[16:19], v[40:43], a[80:83]
    v_mfma_f32_16x16x32_bf16 a[84:87], v[20:23], v[40:43], a[84:87]
    buffer_load_dwordx4 v139, s[8:11], s15 offen offset:2048 lds
    v_mfma_f32_16x16x32_bf16 a[88:91], v[24:27], v[40:43], a[88:91]
    v_mfma_f32_16x16x32_bf16 a[92:95], v[28:31], v[40:43], a[92:95]
    v_mfma_f32_16x16x32_bf16 a[96:99], v[0:3], v[44:47], a[96:99]
    buffer_load_dwordx4 v140, s[8:11], s15 offen offset:3072 lds
    v_mfma_f32_16x16x32_bf16 a[100:103], v[4:7], v[44:47], a[100:103]
    v_mfma_f32_16x16x32_bf16 a[104:107], v[8:11], v[44:47], a[104:107]
    v_mfma_f32_16x16x32_bf16 a[108:111], v[12:15], v[44:47], a[108:111]
    s_add_u32 s15, s15, s17
    v_mfma_f32_16x16x32_bf16 a[112:115], v[16:19], v[44:47], a[112:115]
    v_mfma_f32_16x16x32_bf16 a[116:119], v[20:23], v[44:47], a[116:119]
    v_mfma_f32_16x16x32_bf16 a[120:123], v[24:27], v[44:47], a[120:123]
    v_mfma_f32_16x16x32_bf16 a[124:127], v[28:31], v[44:47], a[124:127]
    s_waitcnt lgkmcnt(0)
    v_mfma_f32_16x16x32_bf16 a[0:3], v[48:51], v[80:83], a[0:3]
    s_waitcnt vmcnt(12)
    s_barrier
    ds_read_b128 v[32:35], v136 offset:0
    s_add_u32 m0, s20, 24576
    s_nop 0
    v_mfma_f32_16x16x32_bf16 a[4:7], v[52:55], v[80:83], a[4:7]
    ds_read_b64_tr_b16 v[0:1], v128 offset:0
    v_mfma_f32_16x16x32_bf16 a[8:11], v[56:59], v[80:83], a[8:11]
    ds_read_b64_tr_b16 v[2:3], v128 offset:8192
    v_mfma_f32_16x16x32_bf16 a[12:15], v[60:63], v[80:83], a[12:15]
    ds_read_b64_tr_b16 v[4:5], v129 offset:0
    buffer_load_dwordx4 v141, s[4:7], s16 offen offset:0 sc1 lds
    v_mfma_f32_16x16x32_bf16 a[16:19], v[64:67], v[80:83], a[16:19]
    ds_read_b64_tr_b16 v[6:7], v129 offset:8192
    v_mfma_f32_16x16x32_bf16 a[20:23], v[68:71], v[80:83], a[20:23]
    ds_read_b64_tr_b16 v[8:9], v130 offset:0
    v_mfma_f32_16x16x32_bf16 a[24:27], v[72:75], v[80:83], a[24:27]
    ds_read_b64_tr_b16 v[10:11], v130 offset:8192
    buffer_load_dwordx4 v142, s[4:7], s16 offen offset:1024 sc1 lds
    v_mfma_f32_16x16x32_bf16 a[28:31], v[76:79], v[80:83], a[28:31]
    ds_read_b64_tr_b16 v[12:13], v131 offset:0
    v_mfma_f32_16x16x32_bf16 a[32:35], v[48:51], v[84:87], a[32:35]
    ds_read_b64_tr_b16 v[14:15], v131 offset:8192
    v_mfma_f32_16x16x32_bf16 a[36:39], v[52:55], v[84:87], a[36:39]
    ds_read_b64_tr_b16 v[16:17], v132 offset:0
    s_add_u32 s16, s16, 1024
    v_mfma_f32_16x16x32_bf16 a[40:43], v[56:59], v[84:87], a[40:43]
    ds_read_b64_tr_b16 v[18:19], v132 offset:8192
    v_mfma_f32_16x16x32_bf16 a[44:47], v[60:63], v[84:87], a[44:47]
    ds_read_b64_tr_b16 v[20:21], v133 offset:0
    v_mfma_f32_16x16x32_bf16 a[48:51], v[64:67], v[84:87], a[48:51]
    ds_read_b64_tr_b16 v[22:23], v133 offset:8192
    s_add_u32 m0, s19, 49152
    s_nop 0
    v_mfma_f32_16x16x32_bf16 a[52:55], v[68:71], v[84:87], a[52:55]
    ds_read_b64_tr_b16 v[24:25], v134 offset:0
    v_mfma_f32_16x16x32_bf16 a[56:59], v[72:75], v[84:87], a[56:59]
    ds_read_b64_tr_b16 v[26:27], v134 offset:8192
    v_mfma_f32_16x16x32_bf16 a[60:63], v[76:79], v[84:87], a[60:63]
    ds_read_b64_tr_b16 v[28:29], v135 offset:0
    buffer_load_dwordx4 v137, s[8:11], s15 offen offset:0 lds
    v_mfma_f32_16x16x32_bf16 a[64:67], v[48:51], v[88:91], a[64:67]
    ds_read_b64_tr_b16 v[30:31], v135 offset:8192
    v_mfma_f32_16x16x32_bf16 a[68:71], v[52:55], v[88:91], a[68:71]
    ds_read_b128 v[36:39], v136 offset:1024
    v_mfma_f32_16x16x32_bf16 a[72:75], v[56:59], v[88:91], a[72:75]
    ds_read_b128 v[40:43], v136 offset:2048
    buffer_load_dwordx4 v138, s[8:11], s15 offen offset:1024 lds
    v_mfma_f32_16x16x32_bf16 a[76:79], v[60:63], v[88:91], a[76:79]
    ds_read_b128 v[44:47], v136 offset:3072
    v_mfma_f32_16x16x32_bf16 a[80:83], v[64:67], v[88:91], a[80:83]
    v_mfma_f32_16x16x32_bf16 a[84:87], v[68:71], v[88:91], a[84:87]
    buffer_load_dwordx4 v139, s[8:11], s15 offen offset:2048 lds
    v_mfma_f32_16x16x32_bf16 a[88:91], v[72:75], v[88:91], a[88:91]
    v_mfma_f32_16x16x32_bf16 a[92:95], v[76:79], v[88:91], a[92:95]
    v_mfma_f32_16x16x32_bf16 a[96:99], v[48:51], v[92:95], a[96:99]
    buffer_load_dwordx4 v140, s[8:11], s15 offen offset:3072 lds
    v_mfma_f32_16x16x32_bf16 a[100:103], v[52:55], v[92:95], a[100:103]
    v_mfma_f32_16x16x32_bf16 a[104:107], v[56:59], v[92:95], a[104:107]
    v_mfma_f32_16x16x32_bf16 a[108:111], v[60:63], v[92:95], a[108:111]
    s_add_u32 s15, s15, s17
    v_mfma_f32_16x16x32_bf16 a[112:115], v[64:67], v[92:95], a[112:115]
    v_mfma_f32_16x16x32_bf16 a[116:119], v[68:71], v[92:95], a[116:119]
    v_mfma_f32_16x16x32_bf16 a[120:123], v[72:75], v[92:95], a[120:123]
    v_mfma_f32_16x16x32_bf16 a[124:127], v[76:79], v[92:95], a[124:127]
    s_sub_u32 s18, s18, 1
    s_cmp_lg_u32 s18, 0
    s_cbranch_scc1 main_kernel_w_c1_n_loop
    s_cmp_lg_u32 s14, 0
    s_cbranch_scc1 main_kernel_w_c1_n_nt
    s_lshl_b32 s32, s27, 8
    s_add_u32 s32, s32, 0x841e000
    v_mov_b32 v255, 1
    s_mov_b64 exec, 1
    buffer_atomic_add v255, off, s[4:7], s32 sc0 sc1
    s_mov_b64 exec, -1
main_kernel_w_c1_n_nt:
    s_waitcnt lgkmcnt(0)
    v_mfma_f32_16x16x32_bf16 a[0:3], v[0:3], v[32:35], a[0:3]
    s_waitcnt vmcnt(12)
    s_barrier
    ds_read_b128 v[80:83], v136 offset:8192
    v_mfma_f32_16x16x32_bf16 a[4:7], v[4:7], v[32:35], a[4:7]
    ds_read_b64_tr_b16 v[48:49], v128 offset:16384
    v_mfma_f32_16x16x32_bf16 a[8:11], v[8:11], v[32:35], a[8:11]
    ds_read_b64_tr_b16 v[50:51], v128 offset:24576
    v_mfma_f32_16x16x32_bf16 a[12:15], v[12:15], v[32:35], a[12:15]
    ds_read_b64_tr_b16 v[52:53], v129 offset:16384
    v_mfma_f32_16x16x32_bf16 a[16:19], v[16:19], v[32:35], a[16:19]
    ds_read_b64_tr_b16 v[54:55], v129 offset:24576
    v_mfma_f32_16x16x32_bf16 a[20:23], v[20:23], v[32:35], a[20:23]
    ds_read_b64_tr_b16 v[56:57], v130 offset:16384
    v_mfma_f32_16x16x32_bf16 a[24:27], v[24:27], v[32:35], a[24:27]
    ds_read_b64_tr_b16 v[58:59], v130 offset:24576
    v_mfma_f32_16x16x32_bf16 a[28:31], v[28:31], v[32:35], a[28:31]
    ds_read_b64_tr_b16 v[60:61], v131 offset:16384
    v_mfma_f32_16x16x32_bf16 a[32:35], v[0:3], v[36:39], a[32:35]
    ds_read_b64_tr_b16 v[62:63], v131 offset:24576
    v_mfma_f32_16x16x32_bf16 a[36:39], v[4:7], v[36:39], a[36:39]
    ds_read_b64_tr_b16 v[64:65], v132 offset:16384
    v_mfma_f32_16x16x32_bf16 a[40:43], v[8:11], v[36:39], a[40:43]
    ds_read_b64_tr_b16 v[66:67], v132 offset:24576
    v_mfma_f32_16x16x32_bf16 a[44:47], v[12:15], v[36:39], a[44:47]
    ds_read_b64_tr_b16 v[68:69], v133 offset:16384
    v_mfma_f32_16x16x32_bf16 a[48:51], v[16:19], v[36:39], a[48:51]
    ds_read_b64_tr_b16 v[70:71], v133 offset:24576
    v_mfma_f32_16x16x32_bf16 a[52:55], v[20:23], v[36:39], a[52:55]
    ds_read_b64_tr_b16 v[72:73], v134 offset:16384
    v_mfma_f32_16x16x32_bf16 a[56:59], v[24:27], v[36:39], a[56:59]
    ds_read_b64_tr_b16 v[74:75], v134 offset:24576
    v_mfma_f32_16x16x32_bf16 a[60:63], v[28:31], v[36:39], a[60:63]
    ds_read_b64_tr_b16 v[76:77], v135 offset:16384
    v_mfma_f32_16x16x32_bf16 a[64:67], v[0:3], v[40:43], a[64:67]
    ds_read_b64_tr_b16 v[78:79], v135 offset:24576
    v_mfma_f32_16x16x32_bf16 a[68:71], v[4:7], v[40:43], a[68:71]
    ds_read_b128 v[84:87], v136 offset:9216
    v_mfma_f32_16x16x32_bf16 a[72:75], v[8:11], v[40:43], a[72:75]
    ds_read_b128 v[88:91], v136 offset:10240
    v_mfma_f32_16x16x32_bf16 a[76:79], v[12:15], v[40:43], a[76:79]
    ds_read_b128 v[92:95], v136 offset:11264
    v_mfma_f32_16x16x32_bf16 a[80:83], v[16:19], v[40:43], a[80:83]
    v_mfma_f32_16x16x32_bf16 a[84:87], v[20:23], v[40:43], a[84:87]
    v_mfma_f32_16x16x32_bf16 a[88:91], v[24:27], v[40:43], a[88:91]
    v_mfma_f32_16x16x32_bf16 a[92:95], v[28:31], v[40:43], a[92:95]
    v_mfma_f32_16x16x32_bf16 a[96:99], v[0:3], v[44:47], a[96:99]
    v_mfma_f32_16x16x32_bf16 a[100:103], v[4:7], v[44:47], a[100:103]
    v_mfma_f32_16x16x32_bf16 a[104:107], v[8:11], v[44:47], a[104:107]
    v_mfma_f32_16x16x32_bf16 a[108:111], v[12:15], v[44:47], a[108:111]
    v_mfma_f32_16x16x32_bf16 a[112:115], v[16:19], v[44:47], a[112:115]
    v_mfma_f32_16x16x32_bf16 a[116:119], v[20:23], v[44:47], a[116:119]
    v_mfma_f32_16x16x32_bf16 a[120:123], v[24:27], v[44:47], a[120:123]
    v_mfma_f32_16x16x32_bf16 a[124:127], v[28:31], v[44:47], a[124:127]
    s_waitcnt lgkmcnt(0)
    v_mfma_f32_16x16x32_bf16 a[0:3], v[48:51], v[80:83], a[0:3]
    s_waitcnt vmcnt(6)
    s_barrier
    ds_read_b128 v[32:35], v136 offset:16384
    v_mfma_f32_16x16x32_bf16 a[4:7], v[52:55], v[80:83], a[4:7]
    ds_read_b64_tr_b16 v[0:1], v128 offset:32768
    v_mfma_f32_16x16x32_bf16 a[8:11], v[56:59], v[80:83], a[8:11]
    ds_read_b64_tr_b16 v[2:3], v128 offset:40960
    v_mfma_f32_16x16x32_bf16 a[12:15], v[60:63], v[80:83], a[12:15]
    ds_read_b64_tr_b16 v[4:5], v129 offset:32768
    v_mfma_f32_16x16x32_bf16 a[16:19], v[64:67], v[80:83], a[16:19]
    ds_read_b64_tr_b16 v[6:7], v129 offset:40960
    v_mfma_f32_16x16x32_bf16 a[20:23], v[68:71], v[80:83], a[20:23]
    ds_read_b64_tr_b16 v[8:9], v130 offset:32768
    v_mfma_f32_16x16x32_bf16 a[24:27], v[72:75], v[80:83], a[24:27]
    ds_read_b64_tr_b16 v[10:11], v130 offset:40960
    v_mfma_f32_16x16x32_bf16 a[28:31], v[76:79], v[80:83], a[28:31]
    ds_read_b64_tr_b16 v[12:13], v131 offset:32768
    v_mfma_f32_16x16x32_bf16 a[32:35], v[48:51], v[84:87], a[32:35]
    ds_read_b64_tr_b16 v[14:15], v131 offset:40960
    v_mfma_f32_16x16x32_bf16 a[36:39], v[52:55], v[84:87], a[36:39]
    ds_read_b64_tr_b16 v[16:17], v132 offset:32768
    v_mfma_f32_16x16x32_bf16 a[40:43], v[56:59], v[84:87], a[40:43]
    ds_read_b64_tr_b16 v[18:19], v132 offset:40960
    v_mfma_f32_16x16x32_bf16 a[44:47], v[60:63], v[84:87], a[44:47]
    ds_read_b64_tr_b16 v[20:21], v133 offset:32768
    v_mfma_f32_16x16x32_bf16 a[48:51], v[64:67], v[84:87], a[48:51]
    ds_read_b64_tr_b16 v[22:23], v133 offset:40960
    v_mfma_f32_16x16x32_bf16 a[52:55], v[68:71], v[84:87], a[52:55]
    ds_read_b64_tr_b16 v[24:25], v134 offset:32768
    v_mfma_f32_16x16x32_bf16 a[56:59], v[72:75], v[84:87], a[56:59]
    ds_read_b64_tr_b16 v[26:27], v134 offset:40960
    v_mfma_f32_16x16x32_bf16 a[60:63], v[76:79], v[84:87], a[60:63]
    ds_read_b64_tr_b16 v[28:29], v135 offset:32768
    v_mfma_f32_16x16x32_bf16 a[64:67], v[48:51], v[88:91], a[64:67]
    ds_read_b64_tr_b16 v[30:31], v135 offset:40960
    v_mfma_f32_16x16x32_bf16 a[68:71], v[52:55], v[88:91], a[68:71]
    ds_read_b128 v[36:39], v136 offset:17408
    v_mfma_f32_16x16x32_bf16 a[72:75], v[56:59], v[88:91], a[72:75]
    ds_read_b128 v[40:43], v136 offset:18432
    v_mfma_f32_16x16x32_bf16 a[76:79], v[60:63], v[88:91], a[76:79]
    ds_read_b128 v[44:47], v136 offset:19456
    v_mfma_f32_16x16x32_bf16 a[80:83], v[64:67], v[88:91], a[80:83]
    v_mfma_f32_16x16x32_bf16 a[84:87], v[68:71], v[88:91], a[84:87]
    v_mfma_f32_16x16x32_bf16 a[88:91], v[72:75], v[88:91], a[88:91]
    v_mfma_f32_16x16x32_bf16 a[92:95], v[76:79], v[88:91], a[92:95]
    v_mfma_f32_16x16x32_bf16 a[96:99], v[48:51], v[92:95], a[96:99]
    v_mfma_f32_16x16x32_bf16 a[100:103], v[52:55], v[92:95], a[100:103]
    v_mfma_f32_16x16x32_bf16 a[104:107], v[56:59], v[92:95], a[104:107]
    v_mfma_f32_16x16x32_bf16 a[108:111], v[60:63], v[92:95], a[108:111]
    v_mfma_f32_16x16x32_bf16 a[112:115], v[64:67], v[92:95], a[112:115]
    v_mfma_f32_16x16x32_bf16 a[116:119], v[68:71], v[92:95], a[116:119]
    v_mfma_f32_16x16x32_bf16 a[120:123], v[72:75], v[92:95], a[120:123]
    v_mfma_f32_16x16x32_bf16 a[124:127], v[76:79], v[92:95], a[124:127]
    s_waitcnt lgkmcnt(0)
    v_mfma_f32_16x16x32_bf16 a[0:3], v[0:3], v[32:35], a[0:3]
    s_waitcnt vmcnt(0)
    s_barrier
    ds_read_b128 v[80:83], v136 offset:24576
    v_mfma_f32_16x16x32_bf16 a[4:7], v[4:7], v[32:35], a[4:7]
    ds_read_b64_tr_b16 v[48:49], v128 offset:49152
    v_mfma_f32_16x16x32_bf16 a[8:11], v[8:11], v[32:35], a[8:11]
    ds_read_b64_tr_b16 v[50:51], v128 offset:57344
    v_mfma_f32_16x16x32_bf16 a[12:15], v[12:15], v[32:35], a[12:15]
    ds_read_b64_tr_b16 v[52:53], v129 offset:49152
    v_mfma_f32_16x16x32_bf16 a[16:19], v[16:19], v[32:35], a[16:19]
    ds_read_b64_tr_b16 v[54:55], v129 offset:57344
    v_mfma_f32_16x16x32_bf16 a[20:23], v[20:23], v[32:35], a[20:23]
    ds_read_b64_tr_b16 v[56:57], v130 offset:49152
    v_mfma_f32_16x16x32_bf16 a[24:27], v[24:27], v[32:35], a[24:27]
    ds_read_b64_tr_b16 v[58:59], v130 offset:57344
    v_mfma_f32_16x16x32_bf16 a[28:31], v[28:31], v[32:35], a[28:31]
    ds_read_b64_tr_b16 v[60:61], v131 offset:49152
    v_mfma_f32_16x16x32_bf16 a[32:35], v[0:3], v[36:39], a[32:35]
    ds_read_b64_tr_b16 v[62:63], v131 offset:57344
    v_mfma_f32_16x16x32_bf16 a[36:39], v[4:7], v[36:39], a[36:39]
    ds_read_b64_tr_b16 v[64:65], v132 offset:49152
    v_mfma_f32_16x16x32_bf16 a[40:43], v[8:11], v[36:39], a[40:43]
    ds_read_b64_tr_b16 v[66:67], v132 offset:57344
    v_mfma_f32_16x16x32_bf16 a[44:47], v[12:15], v[36:39], a[44:47]
    ds_read_b64_tr_b16 v[68:69], v133 offset:49152
    v_mfma_f32_16x16x32_bf16 a[48:51], v[16:19], v[36:39], a[48:51]
    ds_read_b64_tr_b16 v[70:71], v133 offset:57344
    v_mfma_f32_16x16x32_bf16 a[52:55], v[20:23], v[36:39], a[52:55]
    ds_read_b64_tr_b16 v[72:73], v134 offset:49152
    v_mfma_f32_16x16x32_bf16 a[56:59], v[24:27], v[36:39], a[56:59]
    ds_read_b64_tr_b16 v[74:75], v134 offset:57344
    v_mfma_f32_16x16x32_bf16 a[60:63], v[28:31], v[36:39], a[60:63]
    ds_read_b64_tr_b16 v[76:77], v135 offset:49152
    v_mfma_f32_16x16x32_bf16 a[64:67], v[0:3], v[40:43], a[64:67]
    ds_read_b64_tr_b16 v[78:79], v135 offset:57344
    v_mfma_f32_16x16x32_bf16 a[68:71], v[4:7], v[40:43], a[68:71]
    ds_read_b128 v[84:87], v136 offset:25600
    v_mfma_f32_16x16x32_bf16 a[72:75], v[8:11], v[40:43], a[72:75]
    ds_read_b128 v[88:91], v136 offset:26624
    v_mfma_f32_16x16x32_bf16 a[76:79], v[12:15], v[40:43], a[76:79]
    ds_read_b128 v[92:95], v136 offset:27648
    v_mfma_f32_16x16x32_bf16 a[80:83], v[16:19], v[40:43], a[80:83]
    v_mfma_f32_16x16x32_bf16 a[84:87], v[20:23], v[40:43], a[84:87]
    v_mfma_f32_16x16x32_bf16 a[88:91], v[24:27], v[40:43], a[88:91]
    v_mfma_f32_16x16x32_bf16 a[92:95], v[28:31], v[40:43], a[92:95]
    v_mfma_f32_16x16x32_bf16 a[96:99], v[0:3], v[44:47], a[96:99]
    v_mfma_f32_16x16x32_bf16 a[100:103], v[4:7], v[44:47], a[100:103]
    v_mfma_f32_16x16x32_bf16 a[104:107], v[8:11], v[44:47], a[104:107]
    v_mfma_f32_16x16x32_bf16 a[108:111], v[12:15], v[44:47], a[108:111]
    v_mfma_f32_16x16x32_bf16 a[112:115], v[16:19], v[44:47], a[112:115]
    v_mfma_f32_16x16x32_bf16 a[116:119], v[20:23], v[44:47], a[116:119]
    v_mfma_f32_16x16x32_bf16 a[120:123], v[24:27], v[44:47], a[120:123]
    v_mfma_f32_16x16x32_bf16 a[124:127], v[28:31], v[44:47], a[124:127]
    v_readfirstlane_b32 s55, v255
    s_waitcnt lgkmcnt(0)
    v_mfma_f32_16x16x32_bf16 a[0:3], v[48:51], v[80:83], a[0:3]
    v_mfma_f32_16x16x32_bf16 a[4:7], v[52:55], v[80:83], a[4:7]
    v_mfma_f32_16x16x32_bf16 a[8:11], v[56:59], v[80:83], a[8:11]
    v_mfma_f32_16x16x32_bf16 a[12:15], v[60:63], v[80:83], a[12:15]
    v_mfma_f32_16x16x32_bf16 a[16:19], v[64:67], v[80:83], a[16:19]
    v_mfma_f32_16x16x32_bf16 a[20:23], v[68:71], v[80:83], a[20:23]
    v_mfma_f32_16x16x32_bf16 a[24:27], v[72:75], v[80:83], a[24:27]
    v_mfma_f32_16x16x32_bf16 a[28:31], v[76:79], v[80:83], a[28:31]
    v_mfma_f32_16x16x32_bf16 a[32:35], v[48:51], v[84:87], a[32:35]
    v_mfma_f32_16x16x32_bf16 a[36:39], v[52:55], v[84:87], a[36:39]
    v_mfma_f32_16x16x32_bf16 a[40:43], v[56:59], v[84:87], a[40:43]
    v_mfma_f32_16x16x32_bf16 a[44:47], v[60:63], v[84:87], a[44:47]
    v_mfma_f32_16x16x32_bf16 a[48:51], v[64:67], v[84:87], a[48:51]
    v_mfma_f32_16x16x32_bf16 a[52:55], v[68:71], v[84:87], a[52:55]
    v_mfma_f32_16x16x32_bf16 a[56:59], v[72:75], v[84:87], a[56:59]
    v_mfma_f32_16x16x32_bf16 a[60:63], v[76:79], v[84:87], a[60:63]
    v_mfma_f32_16x16x32_bf16 a[64:67], v[48:51], v[88:91], a[64:67]
    v_mfma_f32_16x16x32_bf16 a[68:71], v[52:55], v[88:91], a[68:71]
    v_mfma_f32_16x16x32_bf16 a[72:75], v[56:59], v[88:91], a[72:75]
    v_mfma_f32_16x16x32_bf16 a[76:79], v[60:63], v[88:91], a[76:79]
    v_mfma_f32_16x16x32_bf16 a[80:83], v[64:67], v[88:91], a[80:83]
    v_mfma_f32_16x16x32_bf16 a[84:87], v[68:71], v[88:91], a[84:87]
    v_mfma_f32_16x16x32_bf16 a[88:91], v[72:75], v[88:91], a[88:91]
    v_mfma_f32_16x16x32_bf16 a[92:95], v[76:79], v[88:91], a[92:95]
    v_mfma_f32_16x16x32_bf16 a[96:99], v[48:51], v[92:95], a[96:99]
    v_mfma_f32_16x16x32_bf16 a[100:103], v[52:55], v[92:95], a[100:103]
    v_mfma_f32_16x16x32_bf16 a[104:107], v[56:59], v[92:95], a[104:107]
    v_mfma_f32_16x16x32_bf16 a[108:111], v[60:63], v[92:95], a[108:111]
    v_mfma_f32_16x16x32_bf16 a[112:115], v[64:67], v[92:95], a[112:115]
    v_mfma_f32_16x16x32_bf16 a[116:119], v[68:71], v[92:95], a[116:119]
    v_mfma_f32_16x16x32_bf16 a[120:123], v[72:75], v[92:95], a[120:123]
    v_mfma_f32_16x16x32_bf16 a[124:127], v[76:79], v[92:95], a[124:127]
    s_nop 7
    s_cmp_eq_u32 s23, 1
    s_cbranch_scc1 main_kernel_w_c1_escl
    s_cmp_eq_u32 s23, 3
    s_cbranch_scc1 main_kernel_w_c1_egelus
    s_cmp_eq_u32 s23, 6
    s_cbranch_scc1 main_kernel_w_c1_egelu
main_kernel_w_c1_eplain:
    s_mov_b32 s53, s21
    v_accvgpr_read_b32 v0, a0
    v_accvgpr_read_b32 v1, a1
    v_accvgpr_read_b32 v2, a2
    v_accvgpr_read_b32 v3, a3
    v_accvgpr_read_b32 v4, a4
    v_accvgpr_read_b32 v5, a5
    v_accvgpr_read_b32 v6, a6
    v_accvgpr_read_b32 v7, a7
    v_cvt_pk_bf16_f32 v16, v0, v1
    v_cvt_pk_bf16_f32 v17, v2, v3
    v_cvt_pk_bf16_f32 v18, v4, v5
    v_cvt_pk_bf16_f32 v19, v6, v7
    buffer_store_dwordx4 v[16:19], v251, s[4:7], s53 offen offset:0 sc1
    v_accvgpr_read_b32 v20, a8
    v_accvgpr_read_b32 v21, a9
    v_accvgpr_read_b32 v22, a10
    v_accvgpr_read_b32 v23, a11
    v_accvgpr_read_b32 v24, a12
    v_accvgpr_read_b32 v25, a13
    v_accvgpr_read_b32 v26, a14
    v_accvgpr_read_b32 v27, a15
    v_cvt_pk_bf16_f32 v36, v20, v21
    v_cvt_pk_bf16_f32 v37, v22, v23
    v_cvt_pk_bf16_f32 v38, v24, v25
    v_cvt_pk_bf16_f32 v39, v26, v27
    buffer_store_dwordx4 v[36:39], v251, s[4:7], s53 offen offset:1024 sc1
    v_accvgpr_read_b32 v40, a16
    v_accvgpr_read_b32 v41, a17
    v_accvgpr_read_b32 v42, a18
    v_accvgpr_read_b32 v43, a19
    v_accvgpr_read_b32 v44, a20
    v_accvgpr_read_b32 v45, a21
    v_accvgpr_read_b32 v46, a22
    v_accvgpr_read_b32 v47, a23
    v_cvt_pk_bf16_f32 v56, v40, v41
    v_cvt_pk_bf16_f32 v57, v42, v43
    v_cvt_pk_bf16_f32 v58, v44, v45
    v_cvt_pk_bf16_f32 v59, v46, v47
    buffer_store_dwordx4 v[56:59], v251, s[4:7], s53 offen offset:2048 sc1
    v_accvgpr_read_b32 v0, a24
    v_accvgpr_read_b32 v1, a25
    v_accvgpr_read_b32 v2, a26
    v_accvgpr_read_b32 v3, a27
    v_accvgpr_read_b32 v4, a28
    v_accvgpr_read_b32 v5, a29
    v_accvgpr_read_b32 v6, a30
    v_accvgpr_read_b32 v7, a31
    v_cvt_pk_bf16_f32 v16, v0, v1
    v_cvt_pk_bf16_f32 v17, v2, v3
    v_cvt_pk_bf16_f32 v18, v4, v5
    v_cvt_pk_bf16_f32 v19, v6, v7
    buffer_store_dwordx4 v[16:19], v251, s[4:7], s53 offen offset:3072 sc1
    s_add_u32 s53, s53, s22
    v_accvgpr_read_b32 v20, a32
    v_accvgpr_read_b32 v21, a33
    v_accvgpr_read_b32 v22, a34
    v_accvgpr_read_b32 v23, a35
    v_accvgpr_read_b32 v24, a36
    v_accvgpr_read_b32 v25, a37
    v_accvgpr_read_b32 v26, a38
    v_accvgpr_read_b32 v27, a39
    v_cvt_pk_bf16_f32 v36, v20, v21
    v_cvt_pk_bf16_f32 v37, v22, v23
    v_cvt_pk_bf16_f32 v38, v24, v25
    v_cvt_pk_bf16_f32 v39, v26, v27
    buffer_store_dwordx4 v[36:39], v251, s[4:7], s53 offen offset:0 sc1
    v_accvgpr_read_b32 v40, a40
    v_accvgpr_read_b32 v41, a41
    v_accvgpr_read_b32 v42, a42
    v_accvgpr_read_b32 v43, a43
    v_accvgpr_read_b32 v44, a44
    v_accvgpr_read_b32 v45, a45
    v_accvgpr_read_b32 v46, a46
    v_accvgpr_read_b32 v47, a47
    v_cvt_pk_bf16_f32 v56, v40, v41
    v_cvt_pk_bf16_f32 v57, v42, v43
    v_cvt_pk_bf16_f32 v58, v44, v45
    v_cvt_pk_bf16_f32 v59, v46, v47
    buffer_store_dwordx4 v[56:59], v251, s[4:7], s53 offen offset:1024 sc1
    v_accvgpr_read_b32 v0, a48
    v_accvgpr_read_b32 v1, a49
    v_accvgpr_read_b32 v2, a50
    v_accvgpr_read_b32 v3, a51
    v_accvgpr_read_b32 v4, a52
    v_accvgpr_read_b32 v5, a53
    v_accvgpr_read_b32 v6, a54
    v_accvgpr_read_b32 v7, a55
    v_cvt_pk_bf16_f32 v16, v0, v1
    v_cvt_pk_bf16_f32 v17, v2, v3
    v_cvt_pk_bf16_f32 v18, v4, v5
    v_cvt_pk_bf16_f32 v19, v6, v7
    buffer_store_dwordx4 v[16:19], v251, s[4:7], s53 offen offset:2048 sc1
    v_accvgpr_read_b32 v20, a56
    v_accvgpr_read_b32 v21, a57
    v_accvgpr_read_b32 v22, a58
    v_accvgpr_read_b32 v23, a59
    v_accvgpr_read_b32 v24, a60
    v_accvgpr_read_b32 v25, a61
    v_accvgpr_read_b32 v26, a62
    v_accvgpr_read_b32 v27, a63
    v_cvt_pk_bf16_f32 v36, v20, v21
    v_cvt_pk_bf16_f32 v37, v22, v23
    v_cvt_pk_bf16_f32 v38, v24, v25
    v_cvt_pk_bf16_f32 v39, v26, v27
    buffer_store_dwordx4 v[36:39], v251, s[4:7], s53 offen offset:3072 sc1
    s_add_u32 s53, s53, s22
    v_accvgpr_read_b32 v40, a64
    v_accvgpr_read_b32 v41, a65
    v_accvgpr_read_b32 v42, a66
    v_accvgpr_read_b32 v43, a67
    v_accvgpr_read_b32 v44, a68
    v_accvgpr_read_b32 v45, a69
    v_accvgpr_read_b32 v46, a70
    v_accvgpr_read_b32 v47, a71
    v_cvt_pk_bf16_f32 v56, v40, v41
    v_cvt_pk_bf16_f32 v57, v42, v43
    v_cvt_pk_bf16_f32 v58, v44, v45
    v_cvt_pk_bf16_f32 v59, v46, v47
    buffer_store_dwordx4 v[56:59], v251, s[4:7], s53 offen offset:0 sc1
    v_accvgpr_read_b32 v0, a72
    v_accvgpr_read_b32 v1, a73
    v_accvgpr_read_b32 v2, a74
    v_accvgpr_read_b32 v3, a75
    v_accvgpr_read_b32 v4, a76
    v_accvgpr_read_b32 v5, a77
    v_accvgpr_read_b32 v6, a78
    v_accvgpr_read_b32 v7, a79
    v_cvt_pk_bf16_f32 v16, v0, v1
    v_cvt_pk_bf16_f32 v17, v2, v3
    v_cvt_pk_bf16_f32 v18, v4, v5
    v_cvt_pk_bf16_f32 v19, v6, v7
    buffer_store_dwordx4 v[16:19], v251, s[4:7], s53 offen offset:1024 sc1
    v_accvgpr_read_b32 v20, a80
    v_accvgpr_read_b32 v21, a81
    v_accvgpr_read_b32 v22, a82
    v_accvgpr_read_b32 v23, a83
    v_accvgpr_read_b32 v24, a84
    v_accvgpr_read_b32 v25, a85
    v_accvgpr_read_b32 v26, a86
    v_accvgpr_read_b32 v27, a87
    v_cvt_pk_bf16_f32 v36, v20, v21
    v_cvt_pk_bf16_f32 v37, v22, v23
    v_cvt_pk_bf16_f32 v38, v24, v25
    v_cvt_pk_bf16_f32 v39, v26, v27
    buffer_store_dwordx4 v[36:39], v251, s[4:7], s53 offen offset:2048 sc1
    v_accvgpr_read_b32 v40, a88
    v_accvgpr_read_b32 v41, a89
    v_accvgpr_read_b32 v42, a90
    v_accvgpr_read_b32 v43, a91
    v_accvgpr_read_b32 v44, a92
    v_accvgpr_read_b32 v45, a93
    v_accvgpr_read_b32 v46, a94
    v_accvgpr_read_b32 v47, a95
    v_cvt_pk_bf16_f32 v56, v40, v41
    v_cvt_pk_bf16_f32 v57, v42, v43
    v_cvt_pk_bf16_f32 v58, v44, v45
    v_cvt_pk_bf16_f32 v59, v46, v47
    buffer_store_dwordx4 v[56:59], v251, s[4:7], s53 offen offset:3072 sc1
    s_add_u32 s53, s53, s22
    v_accvgpr_read_b32 v0, a96
    v_accvgpr_read_b32 v1, a97
    v_accvgpr_read_b32 v2, a98
    v_accvgpr_read_b32 v3, a99
    v_accvgpr_read_b32 v4, a100
    v_accvgpr_read_b32 v5, a101
    v_accvgpr_read_b32 v6, a102
    v_accvgpr_read_b32 v7, a103
    v_cvt_pk_bf16_f32 v16, v0, v1
    v_cvt_pk_bf16_f32 v17, v2, v3
    v_cvt_pk_bf16_f32 v18, v4, v5
    v_cvt_pk_bf16_f32 v19, v6, v7
    buffer_store_dwordx4 v[16:19], v251, s[4:7], s53 offen offset:0 sc1
    v_accvgpr_read_b32 v20, a104
    v_accvgpr_read_b32 v21, a105
    v_accvgpr_read_b32 v22, a106
    v_accvgpr_read_b32 v23, a107
    v_accvgpr_read_b32 v24, a108
    v_accvgpr_read_b32 v25, a109
    v_accvgpr_read_b32 v26, a110
    v_accvgpr_read_b32 v27, a111
    v_cvt_pk_bf16_f32 v36, v20, v21
    v_cvt_pk_bf16_f32 v37, v22, v23
    v_cvt_pk_bf16_f32 v38, v24, v25
    v_cvt_pk_bf16_f32 v39, v26, v27
    buffer_store_dwordx4 v[36:39], v251, s[4:7], s53 offen offset:1024 sc1
    v_accvgpr_read_b32 v40, a112
    v_accvgpr_read_b32 v41, a113
    v_accvgpr_read_b32 v42, a114
    v_accvgpr_read_b32 v43, a115
    v_accvgpr_read_b32 v44, a116
    v_accvgpr_read_b32 v45, a117
    v_accvgpr_read_b32 v46, a118
    v_accvgpr_read_b32 v47, a119
    v_cvt_pk_bf16_f32 v56, v40, v41
    v_cvt_pk_bf16_f32 v57, v42, v43
    v_cvt_pk_bf16_f32 v58, v44, v45
    v_cvt_pk_bf16_f32 v59, v46, v47
    buffer_store_dwordx4 v[56:59], v251, s[4:7], s53 offen offset:2048 sc1
    v_accvgpr_read_b32 v0, a120
    v_accvgpr_read_b32 v1, a121
    v_accvgpr_read_b32 v2, a122
    v_accvgpr_read_b32 v3, a123
    v_accvgpr_read_b32 v4, a124
    v_accvgpr_read_b32 v5, a125
    v_accvgpr_read_b32 v6, a126
    v_accvgpr_read_b32 v7, a127
    v_cvt_pk_bf16_f32 v16, v0, v1
    v_cvt_pk_bf16_f32 v17, v2, v3
    v_cvt_pk_bf16_f32 v18, v4, v5
    v_cvt_pk_bf16_f32 v19, v6, v7
    buffer_store_dwordx4 v[16:19], v251, s[4:7], s53 offen offset:3072 sc1
    s_branch main_kernel_w_done
main_kernel_w_c1_escl:
    s_mov_b32 s53, s21
    v_accvgpr_read_b32 v0, a0
    v_accvgpr_read_b32 v1, a1
    v_accvgpr_read_b32 v2, a2
    v_accvgpr_read_b32 v3, a3
    v_accvgpr_read_b32 v4, a4
    v_accvgpr_read_b32 v5, a5
    v_accvgpr_read_b32 v6, a6
    v_accvgpr_read_b32 v7, a7
    v_mul_f32 v0, 0x3e0293ee, v0
    v_mul_f32 v1, 0x3e0293ee, v1
    v_mul_f32 v2, 0x3e0293ee, v2
    v_mul_f32 v3, 0x3e0293ee, v3
    v_mul_f32 v4, 0x3e0293ee, v4
    v_mul_f32 v5, 0x3e0293ee, v5
    v_mul_f32 v6, 0x3e0293ee, v6
    v_mul_f32 v7, 0x3e0293ee, v7
    v_cvt_pk_bf16_f32 v16, v0, v1
    v_cvt_pk_bf16_f32 v17, v2, v3
    v_cvt_pk_bf16_f32 v18, v4, v5
    v_cvt_pk_bf16_f32 v19, v6, v7
    buffer_store_dwordx4 v[16:19], v251, s[4:7], s53 offen offset:0 sc1
    v_accvgpr_read_b32 v20, a8
    v_accvgpr_read_b32 v21, a9
    v_accvgpr_read_b32 v22, a10
    v_accvgpr_read_b32 v23, a11
    v_accvgpr_read_b32 v24, a12
    v_accvgpr_read_b32 v25, a13
    v_accvgpr_read_b32 v26, a14
    v_accvgpr_read_b32 v27, a15
    v_mul_f32 v20, 0x3e0293ee, v20
    v_mul_f32 v21, 0x3e0293ee, v21
    v_mul_f32 v22, 0x3e0293ee, v22
    v_mul_f32 v23, 0x3e0293ee, v23
    v_mul_f32 v24, 0x3e0293ee, v24
    v_mul_f32 v25, 0x3e0293ee, v25
    v_mul_f32 v26, 0x3e0293ee, v26
    v_mul_f32 v27, 0x3e0293ee, v27
    v_cvt_pk_bf16_f32 v36, v20, v21
    v_cvt_pk_bf16_f32 v37, v22, v23
    v_cvt_pk_bf16_f32 v38, v24, v25
    v_cvt_pk_bf16_f32 v39, v26, v27
    buffer_store_dwordx4 v[36:39], v251, s[4:7], s53 offen offset:1024 sc1
    v_accvgpr_read_b32 v40, a16
    v_accvgpr_read_b32 v41, a17
    v_accvgpr_read_b32 v42, a18
    v_accvgpr_read_b32 v43, a19
    v_accvgpr_read_b32 v44, a20
    v_accvgpr_read_b32 v45, a21
    v_accvgpr_read_b32 v46, a22
    v_accvgpr_read_b32 v47, a23
    v_mul_f32 v40, 0x3e0293ee, v40
    v_mul_f32 v41, 0x3e0293ee, v41
    v_mul_f32 v42, 0x3e0293ee, v42
    v_mul_f32 v43, 0x3e0293ee, v43
    v_mul_f32 v44, 0x3e0293ee, v44
    v_mul_f32 v45, 0x3e0293ee, v45
    v_mul_f32 v46, 0x3e0293ee, v46
    v_mul_f32 v47, 0x3e0293ee, v47
    v_cvt_pk_bf16_f32 v56, v40, v41
    v_cvt_pk_bf16_f32 v57, v42, v43
    v_cvt_pk_bf16_f32 v58, v44, v45
    v_cvt_pk_bf16_f32 v59, v46, v47
    buffer_store_dwordx4 v[56:59], v251, s[4:7], s53 offen offset:2048 sc1
    v_accvgpr_read_b32 v0, a24
    v_accvgpr_read_b32 v1, a25
    v_accvgpr_read_b32 v2, a26
    v_accvgpr_read_b32 v3, a27
    v_accvgpr_read_b32 v4, a28
    v_accvgpr_read_b32 v5, a29
    v_accvgpr_read_b32 v6, a30
    v_accvgpr_read_b32 v7, a31
    v_mul_f32 v0, 0x3e0293ee, v0
    v_mul_f32 v1, 0x3e0293ee, v1
    v_mul_f32 v2, 0x3e0293ee, v2
    v_mul_f32 v3, 0x3e0293ee, v3
    v_mul_f32 v4, 0x3e0293ee, v4
    v_mul_f32 v5, 0x3e0293ee, v5
    v_mul_f32 v6, 0x3e0293ee, v6
    v_mul_f32 v7, 0x3e0293ee, v7
    v_cvt_pk_bf16_f32 v16, v0, v1
    v_cvt_pk_bf16_f32 v17, v2, v3
    v_cvt_pk_bf16_f32 v18, v4, v5
    v_cvt_pk_bf16_f32 v19, v6, v7
    buffer_store_dwordx4 v[16:19], v251, s[4:7], s53 offen offset:3072 sc1
    s_add_u32 s53, s53, s22
    v_accvgpr_read_b32 v20, a32
    v_accvgpr_read_b32 v21, a33
    v_accvgpr_read_b32 v22, a34
    v_accvgpr_read_b32 v23, a35
    v_accvgpr_read_b32 v24, a36
    v_accvgpr_read_b32 v25, a37
    v_accvgpr_read_b32 v26, a38
    v_accvgpr_read_b32 v27, a39
    v_mul_f32 v20, 0x3e0293ee, v20
    v_mul_f32 v21, 0x3e0293ee, v21
    v_mul_f32 v22, 0x3e0293ee, v22
    v_mul_f32 v23, 0x3e0293ee, v23
    v_mul_f32 v24, 0x3e0293ee, v24
    v_mul_f32 v25, 0x3e0293ee, v25
    v_mul_f32 v26, 0x3e0293ee, v26
    v_mul_f32 v27, 0x3e0293ee, v27
    v_cvt_pk_bf16_f32 v36, v20, v21
    v_cvt_pk_bf16_f32 v37, v22, v23
    v_cvt_pk_bf16_f32 v38, v24, v25
    v_cvt_pk_bf16_f32 v39, v26, v27
    buffer_store_dwordx4 v[36:39], v251, s[4:7], s53 offen offset:0 sc1
    v_accvgpr_read_b32 v40, a40
    v_accvgpr_read_b32 v41, a41
    v_accvgpr_read_b32 v42, a42
    v_accvgpr_read_b32 v43, a43
    v_accvgpr_read_b32 v44, a44
    v_accvgpr_read_b32 v45, a45
    v_accvgpr_read_b32 v46, a46
    v_accvgpr_read_b32 v47, a47
    v_mul_f32 v40, 0x3e0293ee, v40
    v_mul_f32 v41, 0x3e0293ee, v41
    v_mul_f32 v42, 0x3e0293ee, v42
    v_mul_f32 v43, 0x3e0293ee, v43
    v_mul_f32 v44, 0x3e0293ee, v44
    v_mul_f32 v45, 0x3e0293ee, v45
    v_mul_f32 v46, 0x3e0293ee, v46
    v_mul_f32 v47, 0x3e0293ee, v47
    v_cvt_pk_bf16_f32 v56, v40, v41
    v_cvt_pk_bf16_f32 v57, v42, v43
    v_cvt_pk_bf16_f32 v58, v44, v45
    v_cvt_pk_bf16_f32 v59, v46, v47
    buffer_store_dwordx4 v[56:59], v251, s[4:7], s53 offen offset:1024 sc1
    v_accvgpr_read_b32 v0, a48
    v_accvgpr_read_b32 v1, a49
    v_accvgpr_read_b32 v2, a50
    v_accvgpr_read_b32 v3, a51
    v_accvgpr_read_b32 v4, a52
    v_accvgpr_read_b32 v5, a53
    v_accvgpr_read_b32 v6, a54
    v_accvgpr_read_b32 v7, a55
    v_mul_f32 v0, 0x3e0293ee, v0
    v_mul_f32 v1, 0x3e0293ee, v1
    v_mul_f32 v2, 0x3e0293ee, v2
    v_mul_f32 v3, 0x3e0293ee, v3
    v_mul_f32 v4, 0x3e0293ee, v4
    v_mul_f32 v5, 0x3e0293ee, v5
    v_mul_f32 v6, 0x3e0293ee, v6
    v_mul_f32 v7, 0x3e0293ee, v7
    v_cvt_pk_bf16_f32 v16, v0, v1
    v_cvt_pk_bf16_f32 v17, v2, v3
    v_cvt_pk_bf16_f32 v18, v4, v5
    v_cvt_pk_bf16_f32 v19, v6, v7
    buffer_store_dwordx4 v[16:19], v251, s[4:7], s53 offen offset:2048 sc1
    v_accvgpr_read_b32 v20, a56
    v_accvgpr_read_b32 v21, a57
    v_accvgpr_read_b32 v22, a58
    v_accvgpr_read_b32 v23, a59
    v_accvgpr_read_b32 v24, a60
    v_accvgpr_read_b32 v25, a61
    v_accvgpr_read_b32 v26, a62
    v_accvgpr_read_b32 v27, a63
    v_mul_f32 v20, 0x3e0293ee, v20
    v_mul_f32 v21, 0x3e0293ee, v21
    v_mul_f32 v22, 0x3e0293ee, v22
    v_mul_f32 v23, 0x3e0293ee, v23
    v_mul_f32 v24, 0x3e0293ee, v24
    v_mul_f32 v25, 0x3e0293ee, v25
    v_mul_f32 v26, 0x3e0293ee, v26
    v_mul_f32 v27, 0x3e0293ee, v27
    v_cvt_pk_bf16_f32 v36, v20, v21
    v_cvt_pk_bf16_f32 v37, v22, v23
    v_cvt_pk_bf16_f32 v38, v24, v25
    v_cvt_pk_bf16_f32 v39, v26, v27
    buffer_store_dwordx4 v[36:39], v251, s[4:7], s53 offen offset:3072 sc1
    s_add_u32 s53, s53, s22
    v_accvgpr_read_b32 v40, a64
    v_accvgpr_read_b32 v41, a65
    v_accvgpr_read_b32 v42, a66
    v_accvgpr_read_b32 v43, a67
    v_accvgpr_read_b32 v44, a68
    v_accvgpr_read_b32 v45, a69
    v_accvgpr_read_b32 v46, a70
    v_accvgpr_read_b32 v47, a71
    v_mul_f32 v40, 0x3e0293ee, v40
    v_mul_f32 v41, 0x3e0293ee, v41
    v_mul_f32 v42, 0x3e0293ee, v42
    v_mul_f32 v43, 0x3e0293ee, v43
    v_mul_f32 v44, 0x3e0293ee, v44
    v_mul_f32 v45, 0x3e0293ee, v45
    v_mul_f32 v46, 0x3e0293ee, v46
    v_mul_f32 v47, 0x3e0293ee, v47
    v_cvt_pk_bf16_f32 v56, v40, v41
    v_cvt_pk_bf16_f32 v57, v42, v43
    v_cvt_pk_bf16_f32 v58, v44, v45
    v_cvt_pk_bf16_f32 v59, v46, v47
    buffer_store_dwordx4 v[56:59], v251, s[4:7], s53 offen offset:0 sc1
    v_accvgpr_read_b32 v0, a72
    v_accvgpr_read_b32 v1, a73
    v_accvgpr_read_b32 v2, a74
    v_accvgpr_read_b32 v3, a75
    v_accvgpr_read_b32 v4, a76
    v_accvgpr_read_b32 v5, a77
    v_accvgpr_read_b32 v6, a78
    v_accvgpr_read_b32 v7, a79
    v_mul_f32 v0, 0x3e0293ee, v0
    v_mul_f32 v1, 0x3e0293ee, v1
    v_mul_f32 v2, 0x3e0293ee, v2
    v_mul_f32 v3, 0x3e0293ee, v3
    v_mul_f32 v4, 0x3e0293ee, v4
    v_mul_f32 v5, 0x3e0293ee, v5
    v_mul_f32 v6, 0x3e0293ee, v6
    v_mul_f32 v7, 0x3e0293ee, v7
    v_cvt_pk_bf16_f32 v16, v0, v1
    v_cvt_pk_bf16_f32 v17, v2, v3
    v_cvt_pk_bf16_f32 v18, v4, v5
    v_cvt_pk_bf16_f32 v19, v6, v7
    buffer_store_dwordx4 v[16:19], v251, s[4:7], s53 offen offset:1024 sc1
    v_accvgpr_read_b32 v20, a80
    v_accvgpr_read_b32 v21, a81
    v_accvgpr_read_b32 v22, a82
    v_accvgpr_read_b32 v23, a83
    v_accvgpr_read_b32 v24, a84
    v_accvgpr_read_b32 v25, a85
    v_accvgpr_read_b32 v26, a86
    v_accvgpr_read_b32 v27, a87
    v_mul_f32 v20, 0x3e0293ee, v20
    v_mul_f32 v21, 0x3e0293ee, v21
    v_mul_f32 v22, 0x3e0293ee, v22
    v_mul_f32 v23, 0x3e0293ee, v23
    v_mul_f32 v24, 0x3e0293ee, v24
    v_mul_f32 v25, 0x3e0293ee, v25
    v_mul_f32 v26, 0x3e0293ee, v26
    v_mul_f32 v27, 0x3e0293ee, v27
    v_cvt_pk_bf16_f32 v36, v20, v21
    v_cvt_pk_bf16_f32 v37, v22, v23
    v_cvt_pk_bf16_f32 v38, v24, v25
    v_cvt_pk_bf16_f32 v39, v26, v27
    buffer_store_dwordx4 v[36:39], v251, s[4:7], s53 offen offset:2048 sc1
    v_accvgpr_read_b32 v40, a88
    v_accvgpr_read_b32 v41, a89
    v_accvgpr_read_b32 v42, a90
    v_accvgpr_read_b32 v43, a91
    v_accvgpr_read_b32 v44, a92
    v_accvgpr_read_b32 v45, a93
    v_accvgpr_read_b32 v46, a94
    v_accvgpr_read_b32 v47, a95
    v_mul_f32 v40, 0x3e0293ee, v40
    v_mul_f32 v41, 0x3e0293ee, v41
    v_mul_f32 v42, 0x3e0293ee, v42
    v_mul_f32 v43, 0x3e0293ee, v43
    v_mul_f32 v44, 0x3e0293ee, v44
    v_mul_f32 v45, 0x3e0293ee, v45
    v_mul_f32 v46, 0x3e0293ee, v46
    v_mul_f32 v47, 0x3e0293ee, v47
    v_cvt_pk_bf16_f32 v56, v40, v41
    v_cvt_pk_bf16_f32 v57, v42, v43
    v_cvt_pk_bf16_f32 v58, v44, v45
    v_cvt_pk_bf16_f32 v59, v46, v47
    buffer_store_dwordx4 v[56:59], v251, s[4:7], s53 offen offset:3072 sc1
    s_add_u32 s53, s53, s22
    v_accvgpr_read_b32 v0, a96
    v_accvgpr_read_b32 v1, a97
    v_accvgpr_read_b32 v2, a98
    v_accvgpr_read_b32 v3, a99
    v_accvgpr_read_b32 v4, a100
    v_accvgpr_read_b32 v5, a101
    v_accvgpr_read_b32 v6, a102
    v_accvgpr_read_b32 v7, a103
    v_mul_f32 v0, 0x3e0293ee, v0
    v_mul_f32 v1, 0x3e0293ee, v1
    v_mul_f32 v2, 0x3e0293ee, v2
    v_mul_f32 v3, 0x3e0293ee, v3
    v_mul_f32 v4, 0x3e0293ee, v4
    v_mul_f32 v5, 0x3e0293ee, v5
    v_mul_f32 v6, 0x3e0293ee, v6
    v_mul_f32 v7, 0x3e0293ee, v7
    v_cvt_pk_bf16_f32 v16, v0, v1
    v_cvt_pk_bf16_f32 v17, v2, v3
    v_cvt_pk_bf16_f32 v18, v4, v5
    v_cvt_pk_bf16_f32 v19, v6, v7
    buffer_store_dwordx4 v[16:19], v251, s[4:7], s53 offen offset:0 sc1
    v_accvgpr_read_b32 v20, a104
    v_accvgpr_read_b32 v21, a105
    v_accvgpr_read_b32 v22, a106
    v_accvgpr_read_b32 v23, a107
    v_accvgpr_read_b32 v24, a108
    v_accvgpr_read_b32 v25, a109
    v_accvgpr_read_b32 v26, a110
    v_accvgpr_read_b32 v27, a111
    v_mul_f32 v20, 0x3e0293ee, v20
    v_mul_f32 v21, 0x3e0293ee, v21
    v_mul_f32 v22, 0x3e0293ee, v22
    v_mul_f32 v23, 0x3e0293ee, v23
    v_mul_f32 v24, 0x3e0293ee, v24
    v_mul_f32 v25, 0x3e0293ee, v25
    v_mul_f32 v26, 0x3e0293ee, v26
    v_mul_f32 v27, 0x3e0293ee, v27
    v_cvt_pk_bf16_f32 v36, v20, v21
    v_cvt_pk_bf16_f32 v37, v22, v23
    v_cvt_pk_bf16_f32 v38, v24, v25
    v_cvt_pk_bf16_f32 v39, v26, v27
    buffer_store_dwordx4 v[36:39], v251, s[4:7], s53 offen offset:1024 sc1
    v_accvgpr_read_b32 v40, a112
    v_accvgpr_read_b32 v41, a113
    v_accvgpr_read_b32 v42, a114
    v_accvgpr_read_b32 v43, a115
    v_accvgpr_read_b32 v44, a116
    v_accvgpr_read_b32 v45, a117
    v_accvgpr_read_b32 v46, a118
    v_accvgpr_read_b32 v47, a119
    v_mul_f32 v40, 0x3e0293ee, v40
    v_mul_f32 v41, 0x3e0293ee, v41
    v_mul_f32 v42, 0x3e0293ee, v42
    v_mul_f32 v43, 0x3e0293ee, v43
    v_mul_f32 v44, 0x3e0293ee, v44
    v_mul_f32 v45, 0x3e0293ee, v45
    v_mul_f32 v46, 0x3e0293ee, v46
    v_mul_f32 v47, 0x3e0293ee, v47
    v_cvt_pk_bf16_f32 v56, v40, v41
    v_cvt_pk_bf16_f32 v57, v42, v43
    v_cvt_pk_bf16_f32 v58, v44, v45
    v_cvt_pk_bf16_f32 v59, v46, v47
    buffer_store_dwordx4 v[56:59], v251, s[4:7], s53 offen offset:2048 sc1
    v_accvgpr_read_b32 v0, a120
    v_accvgpr_read_b32 v1, a121
    v_accvgpr_read_b32 v2, a122
    v_accvgpr_read_b32 v3, a123
    v_accvgpr_read_b32 v4, a124
    v_accvgpr_read_b32 v5, a125
    v_accvgpr_read_b32 v6, a126
    v_accvgpr_read_b32 v7, a127
    v_mul_f32 v0, 0x3e0293ee, v0
    v_mul_f32 v1, 0x3e0293ee, v1
    v_mul_f32 v2, 0x3e0293ee, v2
    v_mul_f32 v3, 0x3e0293ee, v3
    v_mul_f32 v4, 0x3e0293ee, v4
    v_mul_f32 v5, 0x3e0293ee, v5
    v_mul_f32 v6, 0x3e0293ee, v6
    v_mul_f32 v7, 0x3e0293ee, v7
    v_cvt_pk_bf16_f32 v16, v0, v1
    v_cvt_pk_bf16_f32 v17, v2, v3
    v_cvt_pk_bf16_f32 v18, v4, v5
    v_cvt_pk_bf16_f32 v19, v6, v7
    buffer_store_dwordx4 v[16:19], v251, s[4:7], s53 offen offset:3072 sc1
    s_branch main_kernel_w_done
main_kernel_w_c1_egelus:
    s_mov_b32 s53, s21
    v_accvgpr_read_b32 v0, a0
    v_accvgpr_read_b32 v1, a1
    v_accvgpr_read_b32 v2, a2
    v_accvgpr_read_b32 v3, a3
    v_accvgpr_read_b32 v4, a4
    v_accvgpr_read_b32 v5, a5
    v_accvgpr_read_b32 v6, a6
    v_accvgpr_read_b32 v7, a7
    v_pk_mul_f32 v[8:9], v[0:1], v[0:1]
    v_pk_mul_f32 v[10:11], v[2:3], v[2:3]
    v_pk_mul_f32 v[12:13], v[4:5], v[4:5]
    v_pk_mul_f32 v[14:15], v[6:7], v[6:7]
    v_pk_fma_f32 v[8:9], v[8:9], v[242:243], v[240:241]
    v_pk_fma_f32 v[10:11], v[10:11], v[242:243], v[240:241]
    v_pk_fma_f32 v[12:13], v[12:13], v[242:243], v[240:241]
    v_pk_fma_f32 v[14:15], v[14:15], v[242:243], v[240:241]
    v_pk_mul_f32 v[8:9], v[8:9], v[0:1]
    v_pk_mul_f32 v[10:11], v[10:11], v[2:3]
    v_pk_mul_f32 v[12:13], v[12:13], v[4:5]
    v_pk_mul_f32 v[14:15], v[14:15], v[6:7]
    v_exp_f32 v8, v8
    v_exp_f32 v9, v9
    v_exp_f32 v10, v10
    v_exp_f32 v11, v11
    v_exp_f32 v12, v12
    v_exp_f32 v13, v13
    v_exp_f32 v14, v14
    v_exp_f32 v15, v15
    v_pk_add_f32 v[8:9], v[8:9], v[244:245]
    v_pk_add_f32 v[10:11], v[10:11], v[244:245]
    v_pk_add_f32 v[12:13], v[12:13], v[244:245]
    v_pk_add_f32 v[14:15], v[14:15], v[244:245]
    v_rcp_f32 v8, v8
    v_rcp_f32 v9, v9
    v_rcp_f32 v10, v10
    v_rcp_f32 v11, v11
    v_rcp_f32 v12, v12
    v_rcp_f32 v13, v13
    v_rcp_f32 v14, v14
    v_rcp_f32 v15, v15
    v_pk_mul_f32 v[0:1], v[8:9], v[0:1]
    v_pk_mul_f32 v[2:3], v[10:11], v[2:3]
    v_pk_mul_f32 v[4:5], v[12:13], v[4:5]
    v_pk_mul_f32 v[6:7], v[14:15], v[6:7]
    v_cvt_pk_bf16_f32 v16, v0, v1
    v_cvt_pk_bf16_f32 v17, v2, v3
    v_cvt_pk_bf16_f32 v18, v4, v5
    v_cvt_pk_bf16_f32 v19, v6, v7
    buffer_store_dwordx4 v[16:19], v252, s[4:7], s53 offen offset:0 sc1
    v_accvgpr_read_b32 v20, a8
    v_accvgpr_read_b32 v21, a9
    v_accvgpr_read_b32 v22, a10
    v_accvgpr_read_b32 v23, a11
    v_accvgpr_read_b32 v24, a12
    v_accvgpr_read_b32 v25, a13
    v_accvgpr_read_b32 v26, a14
    v_accvgpr_read_b32 v27, a15
    v_pk_mul_f32 v[28:29], v[20:21], v[20:21]
    v_pk_mul_f32 v[30:31], v[22:23], v[22:23]
    v_pk_mul_f32 v[32:33], v[24:25], v[24:25]
    v_pk_mul_f32 v[34:35], v[26:27], v[26:27]
    v_pk_fma_f32 v[28:29], v[28:29], v[242:243], v[240:241]
    v_pk_fma_f32 v[30:31], v[30:31], v[242:243], v[240:241]
    v_pk_fma_f32 v[32:33], v[32:33], v[242:243], v[240:241]
    v_pk_fma_f32 v[34:35], v[34:35], v[242:243], v[240:241]
    v_pk_mul_f32 v[28:29], v[28:29], v[20:21]
    v_pk_mul_f32 v[30:31], v[30:31], v[22:23]
    v_pk_mul_f32 v[32:33], v[32:33], v[24:25]
    v_pk_mul_f32 v[34:35], v[34:35], v[26:27]
    v_exp_f32 v28, v28
    v_exp_f32 v29, v29
    v_exp_f32 v30, v30
    v_exp_f32 v31, v31
    v_exp_f32 v32, v32
    v_exp_f32 v33, v33
    v_exp_f32 v34, v34
    v_exp_f32 v35, v35
    v_pk_add_f32 v[28:29], v[28:29], v[244:245]
    v_pk_add_f32 v[30:31], v[30:31], v[244:245]
    v_pk_add_f32 v[32:33], v[32:33], v[244:245]
    v_pk_add_f32 v[34:35], v[34:35], v[244:245]
    v_rcp_f32 v28, v28
    v_rcp_f32 v29, v29
    v_rcp_f32 v30, v30
    v_rcp_f32 v31, v31
    v_rcp_f32 v32, v32
    v_rcp_f32 v33, v33
    v_rcp_f32 v34, v34
    v_rcp_f32 v35, v35
    v_pk_mul_f32 v[20:21], v[28:29], v[20:21]
    v_pk_mul_f32 v[22:23], v[30:31], v[22:23]
    v_pk_mul_f32 v[24:25], v[32:33], v[24:25]
    v_pk_mul_f32 v[26:27], v[34:35], v[26:27]
    v_cvt_pk_bf16_f32 v36, v20, v21
    v_cvt_pk_bf16_f32 v37, v22, v23
    v_cvt_pk_bf16_f32 v38, v24, v25
    v_cvt_pk_bf16_f32 v39, v26, v27
    buffer_store_dwordx4 v[36:39], v252, s[4:7], s53 offen offset:1024 sc1
    v_accvgpr_read_b32 v40, a16
    v_accvgpr_read_b32 v41, a17
    v_accvgpr_read_b32 v42, a18
    v_accvgpr_read_b32 v43, a19
    v_accvgpr_read_b32 v44, a20
    v_accvgpr_read_b32 v45, a21
    v_accvgpr_read_b32 v46, a22
    v_accvgpr_read_b32 v47, a23
    v_pk_mul_f32 v[48:49], v[40:41], v[40:41]
    v_pk_mul_f32 v[50:51], v[42:43], v[42:43]
    v_pk_mul_f32 v[52:53], v[44:45], v[44:45]
    v_pk_mul_f32 v[54:55], v[46:47], v[46:47]
    v_pk_fma_f32 v[48:49], v[48:49], v[242:243], v[240:241]
    v_pk_fma_f32 v[50:51], v[50:51], v[242:243], v[240:241]
    v_pk_fma_f32 v[52:53], v[52:53], v[242:243], v[240:241]
    v_pk_fma_f32 v[54:55], v[54:55], v[242:243], v[240:241]
    v_pk_mul_f32 v[48:49], v[48:49], v[40:41]
    v_pk_mul_f32 v[50:51], v[50:51], v[42:43]
    v_pk_mul_f32 v[52:53], v[52:53], v[44:45]
    v_pk_mul_f32 v[54:55], v[54:55], v[46:47]
    v_exp_f32 v48, v48
    v_exp_f32 v49, v49
    v_exp_f32 v50, v50
    v_exp_f32 v51, v51
    v_exp_f32 v52, v52
    v_exp_f32 v53, v53
    v_exp_f32 v54, v54
    v_exp_f32 v55, v55
    v_pk_add_f32 v[48:49], v[48:49], v[244:245]
    v_pk_add_f32 v[50:51], v[50:51], v[244:245]
    v_pk_add_f32 v[52:53], v[52:53], v[244:245]
    v_pk_add_f32 v[54:55], v[54:55], v[244:245]
    v_rcp_f32 v48, v48
    v_rcp_f32 v49, v49
    v_rcp_f32 v50, v50
    v_rcp_f32 v51, v51
    v_rcp_f32 v52, v52
    v_rcp_f32 v53, v53
    v_rcp_f32 v54, v54
    v_rcp_f32 v55, v55
    v_pk_mul_f32 v[40:41], v[48:49], v[40:41]
    v_pk_mul_f32 v[42:43], v[50:51], v[42:43]
    v_pk_mul_f32 v[44:45], v[52:53], v[44:45]
    v_pk_mul_f32 v[46:47], v[54:55], v[46:47]
    v_cvt_pk_bf16_f32 v56, v40, v41
    v_cvt_pk_bf16_f32 v57, v42, v43
    v_cvt_pk_bf16_f32 v58, v44, v45
    v_cvt_pk_bf16_f32 v59, v46, v47
    buffer_store_dwordx4 v[56:59], v252, s[4:7], s53 offen offset:2048 sc1
    v_accvgpr_read_b32 v0, a24
    v_accvgpr_read_b32 v1, a25
    v_accvgpr_read_b32 v2, a26
    v_accvgpr_read_b32 v3, a27
    v_accvgpr_read_b32 v4, a28
    v_accvgpr_read_b32 v5, a29
    v_accvgpr_read_b32 v6, a30
    v_accvgpr_read_b32 v7, a31
    v_pk_mul_f32 v[8:9], v[0:1], v[0:1]
    v_pk_mul_f32 v[10:11], v[2:3], v[2:3]
    v_pk_mul_f32 v[12:13], v[4:5], v[4:5]
    v_pk_mul_f32 v[14:15], v[6:7], v[6:7]
    v_pk_fma_f32 v[8:9], v[8:9], v[242:243], v[240:241]
    v_pk_fma_f32 v[10:11], v[10:11], v[242:243], v[240:241]
    v_pk_fma_f32 v[12:13], v[12:13], v[242:243], v[240:241]
    v_pk_fma_f32 v[14:15], v[14:15], v[242:243], v[240:241]
    v_pk_mul_f32 v[8:9], v[8:9], v[0:1]
    v_pk_mul_f32 v[10:11], v[10:11], v[2:3]
    v_pk_mul_f32 v[12:13], v[12:13], v[4:5]
    v_pk_mul_f32 v[14:15], v[14:15], v[6:7]
    v_exp_f32 v8, v8
    v_exp_f32 v9, v9
    v_exp_f32 v10, v10
    v_exp_f32 v11, v11
    v_exp_f32 v12, v12
    v_exp_f32 v13, v13
    v_exp_f32 v14, v14
    v_exp_f32 v15, v15
    v_pk_add_f32 v[8:9], v[8:9], v[244:245]
    v_pk_add_f32 v[10:11], v[10:11], v[244:245]
    v_pk_add_f32 v[12:13], v[12:13], v[244:245]
    v_pk_add_f32 v[14:15], v[14:15], v[244:245]
    v_rcp_f32 v8, v8
    v_rcp_f32 v9, v9
    v_rcp_f32 v10, v10
    v_rcp_f32 v11, v11
    v_rcp_f32 v12, v12
    v_rcp_f32 v13, v13
    v_rcp_f32 v14, v14
    v_rcp_f32 v15, v15
    v_pk_mul_f32 v[0:1], v[8:9], v[0:1]
    v_pk_mul_f32 v[2:3], v[10:11], v[2:3]
    v_pk_mul_f32 v[4:5], v[12:13], v[4:5]
    v_pk_mul_f32 v[6:7], v[14:15], v[6:7]
    v_cvt_pk_bf16_f32 v16, v0, v1
    v_cvt_pk_bf16_f32 v17, v2, v3
    v_cvt_pk_bf16_f32 v18, v4, v5
    v_cvt_pk_bf16_f32 v19, v6, v7
    buffer_store_dwordx4 v[16:19], v252, s[4:7], s53 offen offset:3072 sc1
    s_add_u32 s53, s53, s22
    v_accvgpr_read_b32 v20, a32
    v_accvgpr_read_b32 v21, a33
    v_accvgpr_read_b32 v22, a34
    v_accvgpr_read_b32 v23, a35
    v_accvgpr_read_b32 v24, a36
    v_accvgpr_read_b32 v25, a37
    v_accvgpr_read_b32 v26, a38
    v_accvgpr_read_b32 v27, a39
    v_pk_mul_f32 v[28:29], v[20:21], v[20:21]
    v_pk_mul_f32 v[30:31], v[22:23], v[22:23]
    v_pk_mul_f32 v[32:33], v[24:25], v[24:25]
    v_pk_mul_f32 v[34:35], v[26:27], v[26:27]
    v_pk_fma_f32 v[28:29], v[28:29], v[242:243], v[240:241]
    v_pk_fma_f32 v[30:31], v[30:31], v[242:243], v[240:241]
    v_pk_fma_f32 v[32:33], v[32:33], v[242:243], v[240:241]
    v_pk_fma_f32 v[34:35], v[34:35], v[242:243], v[240:241]
    v_pk_mul_f32 v[28:29], v[28:29], v[20:21]
    v_pk_mul_f32 v[30:31], v[30:31], v[22:23]
    v_pk_mul_f32 v[32:33], v[32:33], v[24:25]
    v_pk_mul_f32 v[34:35], v[34:35], v[26:27]
    v_exp_f32 v28, v28
    v_exp_f32 v29, v29
    v_exp_f32 v30, v30
    v_exp_f32 v31, v31
    v_exp_f32 v32, v32
    v_exp_f32 v33, v33
    v_exp_f32 v34, v34
    v_exp_f32 v35, v35
    v_pk_add_f32 v[28:29], v[28:29], v[244:245]
    v_pk_add_f32 v[30:31], v[30:31], v[244:245]
    v_pk_add_f32 v[32:33], v[32:33], v[244:245]
    v_pk_add_f32 v[34:35], v[34:35], v[244:245]
    v_rcp_f32 v28, v28
    v_rcp_f32 v29, v29
    v_rcp_f32 v30, v30
    v_rcp_f32 v31, v31
    v_rcp_f32 v32, v32
    v_rcp_f32 v33, v33
    v_rcp_f32 v34, v34
    v_rcp_f32 v35, v35
    v_pk_mul_f32 v[20:21], v[28:29], v[20:21]
    v_pk_mul_f32 v[22:23], v[30:31], v[22:23]
    v_pk_mul_f32 v[24:25], v[32:33], v[24:25]
    v_pk_mul_f32 v[26:27], v[34:35], v[26:27]
    v_cvt_pk_bf16_f32 v36, v20, v21
    v_cvt_pk_bf16_f32 v37, v22, v23
    v_cvt_pk_bf16_f32 v38, v24, v25
    v_cvt_pk_bf16_f32 v39, v26, v27
    buffer_store_dwordx4 v[36:39], v252, s[4:7], s53 offen offset:0 sc1
    v_accvgpr_read_b32 v40, a40
    v_accvgpr_read_b32 v41, a41
    v_accvgpr_read_b32 v42, a42
    v_accvgpr_read_b32 v43, a43
    v_accvgpr_read_b32 v44, a44
    v_accvgpr_read_b32 v45, a45
    v_accvgpr_read_b32 v46, a46
    v_accvgpr_read_b32 v47, a47
    v_pk_mul_f32 v[48:49], v[40:41], v[40:41]
    v_pk_mul_f32 v[50:51], v[42:43], v[42:43]
    v_pk_mul_f32 v[52:53], v[44:45], v[44:45]
    v_pk_mul_f32 v[54:55], v[46:47], v[46:47]
    v_pk_fma_f32 v[48:49], v[48:49], v[242:243], v[240:241]
    v_pk_fma_f32 v[50:51], v[50:51], v[242:243], v[240:241]
    v_pk_fma_f32 v[52:53], v[52:53], v[242:243], v[240:241]
    v_pk_fma_f32 v[54:55], v[54:55], v[242:243], v[240:241]
    v_pk_mul_f32 v[48:49], v[48:49], v[40:41]
    v_pk_mul_f32 v[50:51], v[50:51], v[42:43]
    v_pk_mul_f32 v[52:53], v[52:53], v[44:45]
    v_pk_mul_f32 v[54:55], v[54:55], v[46:47]
    v_exp_f32 v48, v48
    v_exp_f32 v49, v49
    v_exp_f32 v50, v50
    v_exp_f32 v51, v51
    v_exp_f32 v52, v52
    v_exp_f32 v53, v53
    v_exp_f32 v54, v54
    v_exp_f32 v55, v55
    v_pk_add_f32 v[48:49], v[48:49], v[244:245]
    v_pk_add_f32 v[50:51], v[50:51], v[244:245]
    v_pk_add_f32 v[52:53], v[52:53], v[244:245]
    v_pk_add_f32 v[54:55], v[54:55], v[244:245]
    v_rcp_f32 v48, v48
    v_rcp_f32 v49, v49
    v_rcp_f32 v50, v50
    v_rcp_f32 v51, v51
    v_rcp_f32 v52, v52
    v_rcp_f32 v53, v53
    v_rcp_f32 v54, v54
    v_rcp_f32 v55, v55
    v_pk_mul_f32 v[40:41], v[48:49], v[40:41]
    v_pk_mul_f32 v[42:43], v[50:51], v[42:43]
    v_pk_mul_f32 v[44:45], v[52:53], v[44:45]
    v_pk_mul_f32 v[46:47], v[54:55], v[46:47]
    v_cvt_pk_bf16_f32 v56, v40, v41
    v_cvt_pk_bf16_f32 v57, v42, v43
    v_cvt_pk_bf16_f32 v58, v44, v45
    v_cvt_pk_bf16_f32 v59, v46, v47
    buffer_store_dwordx4 v[56:59], v252, s[4:7], s53 offen offset:1024 sc1
    v_accvgpr_read_b32 v0, a48
    v_accvgpr_read_b32 v1, a49
    v_accvgpr_read_b32 v2, a50
    v_accvgpr_read_b32 v3, a51
    v_accvgpr_read_b32 v4, a52
    v_accvgpr_read_b32 v5, a53
    v_accvgpr_read_b32 v6, a54
    v_accvgpr_read_b32 v7, a55
    v_pk_mul_f32 v[8:9], v[0:1], v[0:1]
    v_pk_mul_f32 v[10:11], v[2:3], v[2:3]
    v_pk_mul_f32 v[12:13], v[4:5], v[4:5]
    v_pk_mul_f32 v[14:15], v[6:7], v[6:7]
    v_pk_fma_f32 v[8:9], v[8:9], v[242:243], v[240:241]
    v_pk_fma_f32 v[10:11], v[10:11], v[242:243], v[240:241]
    v_pk_fma_f32 v[12:13], v[12:13], v[242:243], v[240:241]
    v_pk_fma_f32 v[14:15], v[14:15], v[242:243], v[240:241]
    v_pk_mul_f32 v[8:9], v[8:9], v[0:1]
    v_pk_mul_f32 v[10:11], v[10:11], v[2:3]
    v_pk_mul_f32 v[12:13], v[12:13], v[4:5]
    v_pk_mul_f32 v[14:15], v[14:15], v[6:7]
    v_exp_f32 v8, v8
    v_exp_f32 v9, v9
    v_exp_f32 v10, v10
    v_exp_f32 v11, v11
    v_exp_f32 v12, v12
    v_exp_f32 v13, v13
    v_exp_f32 v14, v14
    v_exp_f32 v15, v15
    v_pk_add_f32 v[8:9], v[8:9], v[244:245]
    v_pk_add_f32 v[10:11], v[10:11], v[244:245]
    v_pk_add_f32 v[12:13], v[12:13], v[244:245]
    v_pk_add_f32 v[14:15], v[14:15], v[244:245]
    v_rcp_f32 v8, v8
    v_rcp_f32 v9, v9
    v_rcp_f32 v10, v10
    v_rcp_f32 v11, v11
    v_rcp_f32 v12, v12
    v_rcp_f32 v13, v13
    v_rcp_f32 v14, v14
    v_rcp_f32 v15, v15
    v_pk_mul_f32 v[0:1], v[8:9], v[0:1]
    v_pk_mul_f32 v[2:3], v[10:11], v[2:3]
    v_pk_mul_f32 v[4:5], v[12:13], v[4:5]
    v_pk_mul_f32 v[6:7], v[14:15], v[6:7]
    v_cvt_pk_bf16_f32 v16, v0, v1
    v_cvt_pk_bf16_f32 v17, v2, v3
    v_cvt_pk_bf16_f32 v18, v4, v5
    v_cvt_pk_bf16_f32 v19, v6, v7
    buffer_store_dwordx4 v[16:19], v252, s[4:7], s53 offen offset:2048 sc1
    v_accvgpr_read_b32 v20, a56
    v_accvgpr_read_b32 v21, a57
    v_accvgpr_read_b32 v22, a58
    v_accvgpr_read_b32 v23, a59
    v_accvgpr_read_b32 v24, a60
    v_accvgpr_read_b32 v25, a61
    v_accvgpr_read_b32 v26, a62
    v_accvgpr_read_b32 v27, a63
    v_pk_mul_f32 v[28:29], v[20:21], v[20:21]
    v_pk_mul_f32 v[30:31], v[22:23], v[22:23]
    v_pk_mul_f32 v[32:33], v[24:25], v[24:25]
    v_pk_mul_f32 v[34:35], v[26:27], v[26:27]
    v_pk_fma_f32 v[28:29], v[28:29], v[242:243], v[240:241]
    v_pk_fma_f32 v[30:31], v[30:31], v[242:243], v[240:241]
    v_pk_fma_f32 v[32:33], v[32:33], v[242:243], v[240:241]
    v_pk_fma_f32 v[34:35], v[34:35], v[242:243], v[240:241]
    v_pk_mul_f32 v[28:29], v[28:29], v[20:21]
    v_pk_mul_f32 v[30:31], v[30:31], v[22:23]
    v_pk_mul_f32 v[32:33], v[32:33], v[24:25]
    v_pk_mul_f32 v[34:35], v[34:35], v[26:27]
    v_exp_f32 v28, v28
    v_exp_f32 v29, v29
    v_exp_f32 v30, v30
    v_exp_f32 v31, v31
    v_exp_f32 v32, v32
    v_exp_f32 v33, v33
    v_exp_f32 v34, v34
    v_exp_f32 v35, v35
    v_pk_add_f32 v[28:29], v[28:29], v[244:245]
    v_pk_add_f32 v[30:31], v[30:31], v[244:245]
    v_pk_add_f32 v[32:33], v[32:33], v[244:245]
    v_pk_add_f32 v[34:35], v[34:35], v[244:245]
    v_rcp_f32 v28, v28
    v_rcp_f32 v29, v29
    v_rcp_f32 v30, v30
    v_rcp_f32 v31, v31
    v_rcp_f32 v32, v32
    v_rcp_f32 v33, v33
    v_rcp_f32 v34, v34
    v_rcp_f32 v35, v35
    v_pk_mul_f32 v[20:21], v[28:29], v[20:21]
    v_pk_mul_f32 v[22:23], v[30:31], v[22:23]
    v_pk_mul_f32 v[24:25], v[32:33], v[24:25]
    v_pk_mul_f32 v[26:27], v[34:35], v[26:27]
    v_cvt_pk_bf16_f32 v36, v20, v21
    v_cvt_pk_bf16_f32 v37, v22, v23
    v_cvt_pk_bf16_f32 v38, v24, v25
    v_cvt_pk_bf16_f32 v39, v26, v27
    buffer_store_dwordx4 v[36:39], v252, s[4:7], s53 offen offset:3072 sc1
    s_add_u32 s53, s53, s22
    v_accvgpr_read_b32 v40, a64
    v_accvgpr_read_b32 v41, a65
    v_accvgpr_read_b32 v42, a66
    v_accvgpr_read_b32 v43, a67
    v_accvgpr_read_b32 v44, a68
    v_accvgpr_read_b32 v45, a69
    v_accvgpr_read_b32 v46, a70
    v_accvgpr_read_b32 v47, a71
    v_pk_mul_f32 v[48:49], v[40:41], v[40:41]
    v_pk_mul_f32 v[50:51], v[42:43], v[42:43]
    v_pk_mul_f32 v[52:53], v[44:45], v[44:45]
    v_pk_mul_f32 v[54:55], v[46:47], v[46:47]
    v_pk_fma_f32 v[48:49], v[48:49], v[242:243], v[240:241]
    v_pk_fma_f32 v[50:51], v[50:51], v[242:243], v[240:241]
    v_pk_fma_f32 v[52:53], v[52:53], v[242:243], v[240:241]
    v_pk_fma_f32 v[54:55], v[54:55], v[242:243], v[240:241]
    v_pk_mul_f32 v[48:49], v[48:49], v[40:41]
    v_pk_mul_f32 v[50:51], v[50:51], v[42:43]
    v_pk_mul_f32 v[52:53], v[52:53], v[44:45]
    v_pk_mul_f32 v[54:55], v[54:55], v[46:47]
    v_exp_f32 v48, v48
    v_exp_f32 v49, v49
    v_exp_f32 v50, v50
    v_exp_f32 v51, v51
    v_exp_f32 v52, v52
    v_exp_f32 v53, v53
    v_exp_f32 v54, v54
    v_exp_f32 v55, v55
    v_pk_add_f32 v[48:49], v[48:49], v[244:245]
    v_pk_add_f32 v[50:51], v[50:51], v[244:245]
    v_pk_add_f32 v[52:53], v[52:53], v[244:245]
    v_pk_add_f32 v[54:55], v[54:55], v[244:245]
    v_rcp_f32 v48, v48
    v_rcp_f32 v49, v49
    v_rcp_f32 v50, v50
    v_rcp_f32 v51, v51
    v_rcp_f32 v52, v52
    v_rcp_f32 v53, v53
    v_rcp_f32 v54, v54
    v_rcp_f32 v55, v55
    v_pk_mul_f32 v[40:41], v[48:49], v[40:41]
    v_pk_mul_f32 v[42:43], v[50:51], v[42:43]
    v_pk_mul_f32 v[44:45], v[52:53], v[44:45]
    v_pk_mul_f32 v[46:47], v[54:55], v[46:47]
    v_cvt_pk_bf16_f32 v56, v40, v41
    v_cvt_pk_bf16_f32 v57, v42, v43
    v_cvt_pk_bf16_f32 v58, v44, v45
    v_cvt_pk_bf16_f32 v59, v46, v47
    buffer_store_dwordx4 v[56:59], v252, s[4:7], s53 offen offset:0 sc1
    v_accvgpr_read_b32 v0, a72
    v_accvgpr_read_b32 v1, a73
    v_accvgpr_read_b32 v2, a74
    v_accvgpr_read_b32 v3, a75
    v_accvgpr_read_b32 v4, a76
    v_accvgpr_read_b32 v5, a77
    v_accvgpr_read_b32 v6, a78
    v_accvgpr_read_b32 v7, a79
    v_pk_mul_f32 v[8:9], v[0:1], v[0:1]
    v_pk_mul_f32 v[10:11], v[2:3], v[2:3]
    v_pk_mul_f32 v[12:13], v[4:5], v[4:5]
    v_pk_mul_f32 v[14:15], v[6:7], v[6:7]
    v_pk_fma_f32 v[8:9], v[8:9], v[242:243], v[240:241]
    v_pk_fma_f32 v[10:11], v[10:11], v[242:243], v[240:241]
    v_pk_fma_f32 v[12:13], v[12:13], v[242:243], v[240:241]
    v_pk_fma_f32 v[14:15], v[14:15], v[242:243], v[240:241]
    v_pk_mul_f32 v[8:9], v[8:9], v[0:1]
    v_pk_mul_f32 v[10:11], v[10:11], v[2:3]
    v_pk_mul_f32 v[12:13], v[12:13], v[4:5]
    v_pk_mul_f32 v[14:15], v[14:15], v[6:7]
    v_exp_f32 v8, v8
    v_exp_f32 v9, v9
    v_exp_f32 v10, v10
    v_exp_f32 v11, v11
    v_exp_f32 v12, v12
    v_exp_f32 v13, v13
    v_exp_f32 v14, v14
    v_exp_f32 v15, v15
    v_pk_add_f32 v[8:9], v[8:9], v[244:245]
    v_pk_add_f32 v[10:11], v[10:11], v[244:245]
    v_pk_add_f32 v[12:13], v[12:13], v[244:245]
    v_pk_add_f32 v[14:15], v[14:15], v[244:245]
    v_rcp_f32 v8, v8
    v_rcp_f32 v9, v9
    v_rcp_f32 v10, v10
    v_rcp_f32 v11, v11
    v_rcp_f32 v12, v12
    v_rcp_f32 v13, v13
    v_rcp_f32 v14, v14
    v_rcp_f32 v15, v15
    v_pk_mul_f32 v[0:1], v[8:9], v[0:1]
    v_pk_mul_f32 v[2:3], v[10:11], v[2:3]
    v_pk_mul_f32 v[4:5], v[12:13], v[4:5]
    v_pk_mul_f32 v[6:7], v[14:15], v[6:7]
    v_cvt_pk_bf16_f32 v16, v0, v1
    v_cvt_pk_bf16_f32 v17, v2, v3
    v_cvt_pk_bf16_f32 v18, v4, v5
    v_cvt_pk_bf16_f32 v19, v6, v7
    buffer_store_dwordx4 v[16:19], v252, s[4:7], s53 offen offset:1024 sc1
    v_accvgpr_read_b32 v20, a80
    v_accvgpr_read_b32 v21, a81
    v_accvgpr_read_b32 v22, a82
    v_accvgpr_read_b32 v23, a83
    v_accvgpr_read_b32 v24, a84
    v_accvgpr_read_b32 v25, a85
    v_accvgpr_read_b32 v26, a86
    v_accvgpr_read_b32 v27, a87
    v_pk_mul_f32 v[28:29], v[20:21], v[20:21]
    v_pk_mul_f32 v[30:31], v[22:23], v[22:23]
    v_pk_mul_f32 v[32:33], v[24:25], v[24:25]
    v_pk_mul_f32 v[34:35], v[26:27], v[26:27]
    v_pk_fma_f32 v[28:29], v[28:29], v[242:243], v[240:241]
    v_pk_fma_f32 v[30:31], v[30:31], v[242:243], v[240:241]
    v_pk_fma_f32 v[32:33], v[32:33], v[242:243], v[240:241]
    v_pk_fma_f32 v[34:35], v[34:35], v[242:243], v[240:241]
    v_pk_mul_f32 v[28:29], v[28:29], v[20:21]
    v_pk_mul_f32 v[30:31], v[30:31], v[22:23]
    v_pk_mul_f32 v[32:33], v[32:33], v[24:25]
    v_pk_mul_f32 v[34:35], v[34:35], v[26:27]
    v_exp_f32 v28, v28
    v_exp_f32 v29, v29
    v_exp_f32 v30, v30
    v_exp_f32 v31, v31
    v_exp_f32 v32, v32
    v_exp_f32 v33, v33
    v_exp_f32 v34, v34
    v_exp_f32 v35, v35
    v_pk_add_f32 v[28:29], v[28:29], v[244:245]
    v_pk_add_f32 v[30:31], v[30:31], v[244:245]
    v_pk_add_f32 v[32:33], v[32:33], v[244:245]
    v_pk_add_f32 v[34:35], v[34:35], v[244:245]
    v_rcp_f32 v28, v28
    v_rcp_f32 v29, v29
    v_rcp_f32 v30, v30
    v_rcp_f32 v31, v31
    v_rcp_f32 v32, v32
    v_rcp_f32 v33, v33
    v_rcp_f32 v34, v34
    v_rcp_f32 v35, v35
    v_pk_mul_f32 v[20:21], v[28:29], v[20:21]
    v_pk_mul_f32 v[22:23], v[30:31], v[22:23]
    v_pk_mul_f32 v[24:25], v[32:33], v[24:25]
    v_pk_mul_f32 v[26:27], v[34:35], v[26:27]
    v_cvt_pk_bf16_f32 v36, v20, v21
    v_cvt_pk_bf16_f32 v37, v22, v23
    v_cvt_pk_bf16_f32 v38, v24, v25
    v_cvt_pk_bf16_f32 v39, v26, v27
    buffer_store_dwordx4 v[36:39], v252, s[4:7], s53 offen offset:2048 sc1
    v_accvgpr_read_b32 v40, a88
    v_accvgpr_read_b32 v41, a89
    v_accvgpr_read_b32 v42, a90
    v_accvgpr_read_b32 v43, a91
    v_accvgpr_read_b32 v44, a92
    v_accvgpr_read_b32 v45, a93
    v_accvgpr_read_b32 v46, a94
    v_accvgpr_read_b32 v47, a95
    v_pk_mul_f32 v[48:49], v[40:41], v[40:41]
    v_pk_mul_f32 v[50:51], v[42:43], v[42:43]
    v_pk_mul_f32 v[52:53], v[44:45], v[44:45]
    v_pk_mul_f32 v[54:55], v[46:47], v[46:47]
    v_pk_fma_f32 v[48:49], v[48:49], v[242:243], v[240:241]
    v_pk_fma_f32 v[50:51], v[50:51], v[242:243], v[240:241]
    v_pk_fma_f32 v[52:53], v[52:53], v[242:243], v[240:241]
    v_pk_fma_f32 v[54:55], v[54:55], v[242:243], v[240:241]
    v_pk_mul_f32 v[48:49], v[48:49], v[40:41]
    v_pk_mul_f32 v[50:51], v[50:51], v[42:43]
    v_pk_mul_f32 v[52:53], v[52:53], v[44:45]
    v_pk_mul_f32 v[54:55], v[54:55], v[46:47]
    v_exp_f32 v48, v48
    v_exp_f32 v49, v49
    v_exp_f32 v50, v50
    v_exp_f32 v51, v51
    v_exp_f32 v52, v52
    v_exp_f32 v53, v53
    v_exp_f32 v54, v54
    v_exp_f32 v55, v55
    v_pk_add_f32 v[48:49], v[48:49], v[244:245]
    v_pk_add_f32 v[50:51], v[50:51], v[244:245]
    v_pk_add_f32 v[52:53], v[52:53], v[244:245]
    v_pk_add_f32 v[54:55], v[54:55], v[244:245]
    v_rcp_f32 v48, v48
    v_rcp_f32 v49, v49
    v_rcp_f32 v50, v50
    v_rcp_f32 v51, v51
    v_rcp_f32 v52, v52
    v_rcp_f32 v53, v53
    v_rcp_f32 v54, v54
    v_rcp_f32 v55, v55
    v_pk_mul_f32 v[40:41], v[48:49], v[40:41]
    v_pk_mul_f32 v[42:43], v[50:51], v[42:43]
    v_pk_mul_f32 v[44:45], v[52:53], v[44:45]
    v_pk_mul_f32 v[46:47], v[54:55], v[46:47]
    v_cvt_pk_bf16_f32 v56, v40, v41
    v_cvt_pk_bf16_f32 v57, v42, v43
    v_cvt_pk_bf16_f32 v58, v44, v45
    v_cvt_pk_bf16_f32 v59, v46, v47
    buffer_store_dwordx4 v[56:59], v252, s[4:7], s53 offen offset:3072 sc1
    s_add_u32 s53, s53, s22
    v_accvgpr_read_b32 v0, a96
    v_accvgpr_read_b32 v1, a97
    v_accvgpr_read_b32 v2, a98
    v_accvgpr_read_b32 v3, a99
    v_accvgpr_read_b32 v4, a100
    v_accvgpr_read_b32 v5, a101
    v_accvgpr_read_b32 v6, a102
    v_accvgpr_read_b32 v7, a103
    v_pk_mul_f32 v[8:9], v[0:1], v[0:1]
    v_pk_mul_f32 v[10:11], v[2:3], v[2:3]
    v_pk_mul_f32 v[12:13], v[4:5], v[4:5]
    v_pk_mul_f32 v[14:15], v[6:7], v[6:7]
    v_pk_fma_f32 v[8:9], v[8:9], v[242:243], v[240:241]
    v_pk_fma_f32 v[10:11], v[10:11], v[242:243], v[240:241]
    v_pk_fma_f32 v[12:13], v[12:13], v[242:243], v[240:241]
    v_pk_fma_f32 v[14:15], v[14:15], v[242:243], v[240:241]
    v_pk_mul_f32 v[8:9], v[8:9], v[0:1]
    v_pk_mul_f32 v[10:11], v[10:11], v[2:3]
    v_pk_mul_f32 v[12:13], v[12:13], v[4:5]
    v_pk_mul_f32 v[14:15], v[14:15], v[6:7]
    v_exp_f32 v8, v8
    v_exp_f32 v9, v9
    v_exp_f32 v10, v10
    v_exp_f32 v11, v11
    v_exp_f32 v12, v12
    v_exp_f32 v13, v13
    v_exp_f32 v14, v14
    v_exp_f32 v15, v15
    v_pk_add_f32 v[8:9], v[8:9], v[244:245]
    v_pk_add_f32 v[10:11], v[10:11], v[244:245]
    v_pk_add_f32 v[12:13], v[12:13], v[244:245]
    v_pk_add_f32 v[14:15], v[14:15], v[244:245]
    v_rcp_f32 v8, v8
    v_rcp_f32 v9, v9
    v_rcp_f32 v10, v10
    v_rcp_f32 v11, v11
    v_rcp_f32 v12, v12
    v_rcp_f32 v13, v13
    v_rcp_f32 v14, v14
    v_rcp_f32 v15, v15
    v_pk_mul_f32 v[0:1], v[8:9], v[0:1]
    v_pk_mul_f32 v[2:3], v[10:11], v[2:3]
    v_pk_mul_f32 v[4:5], v[12:13], v[4:5]
    v_pk_mul_f32 v[6:7], v[14:15], v[6:7]
    v_cvt_pk_bf16_f32 v16, v0, v1
    v_cvt_pk_bf16_f32 v17, v2, v3
    v_cvt_pk_bf16_f32 v18, v4, v5
    v_cvt_pk_bf16_f32 v19, v6, v7
    buffer_store_dwordx4 v[16:19], v252, s[4:7], s53 offen offset:0 sc1
    v_accvgpr_read_b32 v20, a104
    v_accvgpr_read_b32 v21, a105
    v_accvgpr_read_b32 v22, a106
    v_accvgpr_read_b32 v23, a107
    v_accvgpr_read_b32 v24, a108
    v_accvgpr_read_b32 v25, a109
    v_accvgpr_read_b32 v26, a110
    v_accvgpr_read_b32 v27, a111
    v_pk_mul_f32 v[28:29], v[20:21], v[20:21]
    v_pk_mul_f32 v[30:31], v[22:23], v[22:23]
    v_pk_mul_f32 v[32:33], v[24:25], v[24:25]
    v_pk_mul_f32 v[34:35], v[26:27], v[26:27]
    v_pk_fma_f32 v[28:29], v[28:29], v[242:243], v[240:241]
    v_pk_fma_f32 v[30:31], v[30:31], v[242:243], v[240:241]
    v_pk_fma_f32 v[32:33], v[32:33], v[242:243], v[240:241]
    v_pk_fma_f32 v[34:35], v[34:35], v[242:243], v[240:241]
    v_pk_mul_f32 v[28:29], v[28:29], v[20:21]
    v_pk_mul_f32 v[30:31], v[30:31], v[22:23]
    v_pk_mul_f32 v[32:33], v[32:33], v[24:25]
    v_pk_mul_f32 v[34:35], v[34:35], v[26:27]
    v_exp_f32 v28, v28
    v_exp_f32 v29, v29
    v_exp_f32 v30, v30
    v_exp_f32 v31, v31
    v_exp_f32 v32, v32
    v_exp_f32 v33, v33
    v_exp_f32 v34, v34
    v_exp_f32 v35, v35
    v_pk_add_f32 v[28:29], v[28:29], v[244:245]
    v_pk_add_f32 v[30:31], v[30:31], v[244:245]
    v_pk_add_f32 v[32:33], v[32:33], v[244:245]
    v_pk_add_f32 v[34:35], v[34:35], v[244:245]
    v_rcp_f32 v28, v28
    v_rcp_f32 v29, v29
    v_rcp_f32 v30, v30
    v_rcp_f32 v31, v31
    v_rcp_f32 v32, v32
    v_rcp_f32 v33, v33
    v_rcp_f32 v34, v34
    v_rcp_f32 v35, v35
    v_pk_mul_f32 v[20:21], v[28:29], v[20:21]
    v_pk_mul_f32 v[22:23], v[30:31], v[22:23]
    v_pk_mul_f32 v[24:25], v[32:33], v[24:25]
    v_pk_mul_f32 v[26:27], v[34:35], v[26:27]
    v_cvt_pk_bf16_f32 v36, v20, v21
    v_cvt_pk_bf16_f32 v37, v22, v23
    v_cvt_pk_bf16_f32 v38, v24, v25
    v_cvt_pk_bf16_f32 v39, v26, v27
    buffer_store_dwordx4 v[36:39], v252, s[4:7], s53 offen offset:1024 sc1
    v_accvgpr_read_b32 v40, a112
    v_accvgpr_read_b32 v41, a113
    v_accvgpr_read_b32 v42, a114
    v_accvgpr_read_b32 v43, a115
    v_accvgpr_read_b32 v44, a116
    v_accvgpr_read_b32 v45, a117
    v_accvgpr_read_b32 v46, a118
    v_accvgpr_read_b32 v47, a119
    v_pk_mul_f32 v[48:49], v[40:41], v[40:41]
    v_pk_mul_f32 v[50:51], v[42:43], v[42:43]
    v_pk_mul_f32 v[52:53], v[44:45], v[44:45]
    v_pk_mul_f32 v[54:55], v[46:47], v[46:47]
    v_pk_fma_f32 v[48:49], v[48:49], v[242:243], v[240:241]
    v_pk_fma_f32 v[50:51], v[50:51], v[242:243], v[240:241]
    v_pk_fma_f32 v[52:53], v[52:53], v[242:243], v[240:241]
    v_pk_fma_f32 v[54:55], v[54:55], v[242:243], v[240:241]
    v_pk_mul_f32 v[48:49], v[48:49], v[40:41]
    v_pk_mul_f32 v[50:51], v[50:51], v[42:43]
    v_pk_mul_f32 v[52:53], v[52:53], v[44:45]
    v_pk_mul_f32 v[54:55], v[54:55], v[46:47]
    v_exp_f32 v48, v48
    v_exp_f32 v49, v49
    v_exp_f32 v50, v50
    v_exp_f32 v51, v51
    v_exp_f32 v52, v52
    v_exp_f32 v53, v53
    v_exp_f32 v54, v54
    v_exp_f32 v55, v55
    v_pk_add_f32 v[48:49], v[48:49], v[244:245]
    v_pk_add_f32 v[50:51], v[50:51], v[244:245]
    v_pk_add_f32 v[52:53], v[52:53], v[244:245]
    v_pk_add_f32 v[54:55], v[54:55], v[244:245]
    v_rcp_f32 v48, v48
    v_rcp_f32 v49, v49
    v_rcp_f32 v50, v50
    v_rcp_f32 v51, v51
    v_rcp_f32 v52, v52
    v_rcp_f32 v53, v53
    v_rcp_f32 v54, v54
    v_rcp_f32 v55, v55
    v_pk_mul_f32 v[40:41], v[48:49], v[40:41]
    v_pk_mul_f32 v[42:43], v[50:51], v[42:43]
    v_pk_mul_f32 v[44:45], v[52:53], v[44:45]
    v_pk_mul_f32 v[46:47], v[54:55], v[46:47]
    v_cvt_pk_bf16_f32 v56, v40, v41
    v_cvt_pk_bf16_f32 v57, v42, v43
    v_cvt_pk_bf16_f32 v58, v44, v45
    v_cvt_pk_bf16_f32 v59, v46, v47
    buffer_store_dwordx4 v[56:59], v252, s[4:7], s53 offen offset:2048 sc1
    v_accvgpr_read_b32 v0, a120
    v_accvgpr_read_b32 v1, a121
    v_accvgpr_read_b32 v2, a122
    v_accvgpr_read_b32 v3, a123
    v_accvgpr_read_b32 v4, a124
    v_accvgpr_read_b32 v5, a125
    v_accvgpr_read_b32 v6, a126
    v_accvgpr_read_b32 v7, a127
    v_pk_mul_f32 v[8:9], v[0:1], v[0:1]
    v_pk_mul_f32 v[10:11], v[2:3], v[2:3]
    v_pk_mul_f32 v[12:13], v[4:5], v[4:5]
    v_pk_mul_f32 v[14:15], v[6:7], v[6:7]
    v_pk_fma_f32 v[8:9], v[8:9], v[242:243], v[240:241]
    v_pk_fma_f32 v[10:11], v[10:11], v[242:243], v[240:241]
    v_pk_fma_f32 v[12:13], v[12:13], v[242:243], v[240:241]
    v_pk_fma_f32 v[14:15], v[14:15], v[242:243], v[240:241]
    v_pk_mul_f32 v[8:9], v[8:9], v[0:1]
    v_pk_mul_f32 v[10:11], v[10:11], v[2:3]
    v_pk_mul_f32 v[12:13], v[12:13], v[4:5]
    v_pk_mul_f32 v[14:15], v[14:15], v[6:7]
    v_exp_f32 v8, v8
    v_exp_f32 v9, v9
    v_exp_f32 v10, v10
    v_exp_f32 v11, v11
    v_exp_f32 v12, v12
    v_exp_f32 v13, v13
    v_exp_f32 v14, v14
    v_exp_f32 v15, v15
    v_pk_add_f32 v[8:9], v[8:9], v[244:245]
    v_pk_add_f32 v[10:11], v[10:11], v[244:245]
    v_pk_add_f32 v[12:13], v[12:13], v[244:245]
    v_pk_add_f32 v[14:15], v[14:15], v[244:245]
    v_rcp_f32 v8, v8
    v_rcp_f32 v9, v9
    v_rcp_f32 v10, v10
    v_rcp_f32 v11, v11
    v_rcp_f32 v12, v12
    v_rcp_f32 v13, v13
    v_rcp_f32 v14, v14
    v_rcp_f32 v15, v15
    v_pk_mul_f32 v[0:1], v[8:9], v[0:1]
    v_pk_mul_f32 v[2:3], v[10:11], v[2:3]
    v_pk_mul_f32 v[4:5], v[12:13], v[4:5]
    v_pk_mul_f32 v[6:7], v[14:15], v[6:7]
    v_cvt_pk_bf16_f32 v16, v0, v1
    v_cvt_pk_bf16_f32 v17, v2, v3
    v_cvt_pk_bf16_f32 v18, v4, v5
    v_cvt_pk_bf16_f32 v19, v6, v7
    buffer_store_dwordx4 v[16:19], v252, s[4:7], s53 offen offset:3072 sc1
    s_branch main_kernel_w_done
main_kernel_w_c1_egelu:
    s_mov_b32 s53, s21
    v_accvgpr_read_b32 v0, a0
    v_accvgpr_read_b32 v1, a1
    v_accvgpr_read_b32 v2, a2
    v_accvgpr_read_b32 v3, a3
    v_accvgpr_read_b32 v4, a4
    v_accvgpr_read_b32 v5, a5
    v_accvgpr_read_b32 v6, a6
    v_accvgpr_read_b32 v7, a7
    v_pk_mul_f32 v[8:9], v[0:1], v[0:1]
    v_pk_mul_f32 v[10:11], v[2:3], v[2:3]
    v_pk_mul_f32 v[12:13], v[4:5], v[4:5]
    v_pk_mul_f32 v[14:15], v[6:7], v[6:7]
    v_pk_fma_f32 v[8:9], v[8:9], v[242:243], v[240:241]
    v_pk_fma_f32 v[10:11], v[10:11], v[242:243], v[240:241]
    v_pk_fma_f32 v[12:13], v[12:13], v[242:243], v[240:241]
    v_pk_fma_f32 v[14:15], v[14:15], v[242:243], v[240:241]
    v_pk_mul_f32 v[8:9], v[8:9], v[0:1]
    v_pk_mul_f32 v[10:11], v[10:11], v[2:3]
    v_pk_mul_f32 v[12:13], v[12:13], v[4:5]
    v_pk_mul_f32 v[14:15], v[14:15], v[6:7]
    v_exp_f32 v8, v8
    v_exp_f32 v9, v9
    v_exp_f32 v10, v10
    v_exp_f32 v11, v11
    v_exp_f32 v12, v12
    v_exp_f32 v13, v13
    v_exp_f32 v14, v14
    v_exp_f32 v15, v15
    v_pk_add_f32 v[8:9], v[8:9], v[244:245]
    v_pk_add_f32 v[10:11], v[10:11], v[244:245]
    v_pk_add_f32 v[12:13], v[12:13], v[244:245]
    v_pk_add_f32 v[14:15], v[14:15], v[244:245]
    v_rcp_f32 v8, v8
    v_rcp_f32 v9, v9
    v_rcp_f32 v10, v10
    v_rcp_f32 v11, v11
    v_rcp_f32 v12, v12
    v_rcp_f32 v13, v13
    v_rcp_f32 v14, v14
    v_rcp_f32 v15, v15
    v_pk_mul_f32 v[0:1], v[8:9], v[0:1]
    v_pk_mul_f32 v[2:3], v[10:11], v[2:3]
    v_pk_mul_f32 v[4:5], v[12:13], v[4:5]
    v_pk_mul_f32 v[6:7], v[14:15], v[6:7]
    v_cvt_pk_bf16_f32 v16, v0, v1
    v_cvt_pk_bf16_f32 v17, v2, v3
    v_cvt_pk_bf16_f32 v18, v4, v5
    v_cvt_pk_bf16_f32 v19, v6, v7
    buffer_store_dwordx4 v[16:19], v251, s[4:7], s53 offen offset:0 sc1
    v_accvgpr_read_b32 v20, a8
    v_accvgpr_read_b32 v21, a9
    v_accvgpr_read_b32 v22, a10
    v_accvgpr_read_b32 v23, a11
    v_accvgpr_read_b32 v24, a12
    v_accvgpr_read_b32 v25, a13
    v_accvgpr_read_b32 v26, a14
    v_accvgpr_read_b32 v27, a15
    v_pk_mul_f32 v[28:29], v[20:21], v[20:21]
    v_pk_mul_f32 v[30:31], v[22:23], v[22:23]
    v_pk_mul_f32 v[32:33], v[24:25], v[24:25]
    v_pk_mul_f32 v[34:35], v[26:27], v[26:27]
    v_pk_fma_f32 v[28:29], v[28:29], v[242:243], v[240:241]
    v_pk_fma_f32 v[30:31], v[30:31], v[242:243], v[240:241]
    v_pk_fma_f32 v[32:33], v[32:33], v[242:243], v[240:241]
    v_pk_fma_f32 v[34:35], v[34:35], v[242:243], v[240:241]
    v_pk_mul_f32 v[28:29], v[28:29], v[20:21]
    v_pk_mul_f32 v[30:31], v[30:31], v[22:23]
    v_pk_mul_f32 v[32:33], v[32:33], v[24:25]
    v_pk_mul_f32 v[34:35], v[34:35], v[26:27]
    v_exp_f32 v28, v28
    v_exp_f32 v29, v29
    v_exp_f32 v30, v30
    v_exp_f32 v31, v31
    v_exp_f32 v32, v32
    v_exp_f32 v33, v33
    v_exp_f32 v34, v34
    v_exp_f32 v35, v35
    v_pk_add_f32 v[28:29], v[28:29], v[244:245]
    v_pk_add_f32 v[30:31], v[30:31], v[244:245]
    v_pk_add_f32 v[32:33], v[32:33], v[244:245]
    v_pk_add_f32 v[34:35], v[34:35], v[244:245]
    v_rcp_f32 v28, v28
    v_rcp_f32 v29, v29
    v_rcp_f32 v30, v30
    v_rcp_f32 v31, v31
    v_rcp_f32 v32, v32
    v_rcp_f32 v33, v33
    v_rcp_f32 v34, v34
    v_rcp_f32 v35, v35
    v_pk_mul_f32 v[20:21], v[28:29], v[20:21]
    v_pk_mul_f32 v[22:23], v[30:31], v[22:23]
    v_pk_mul_f32 v[24:25], v[32:33], v[24:25]
    v_pk_mul_f32 v[26:27], v[34:35], v[26:27]
    v_cvt_pk_bf16_f32 v36, v20, v21
    v_cvt_pk_bf16_f32 v37, v22, v23
    v_cvt_pk_bf16_f32 v38, v24, v25
    v_cvt_pk_bf16_f32 v39, v26, v27
    buffer_store_dwordx4 v[36:39], v251, s[4:7], s53 offen offset:1024 sc1
    v_accvgpr_read_b32 v40, a16
    v_accvgpr_read_b32 v41, a17
    v_accvgpr_read_b32 v42, a18
    v_accvgpr_read_b32 v43, a19
    v_accvgpr_read_b32 v44, a20
    v_accvgpr_read_b32 v45, a21
    v_accvgpr_read_b32 v46, a22
    v_accvgpr_read_b32 v47, a23
    v_pk_mul_f32 v[48:49], v[40:41], v[40:41]
    v_pk_mul_f32 v[50:51], v[42:43], v[42:43]
    v_pk_mul_f32 v[52:53], v[44:45], v[44:45]
    v_pk_mul_f32 v[54:55], v[46:47], v[46:47]
    v_pk_fma_f32 v[48:49], v[48:49], v[242:243], v[240:241]
    v_pk_fma_f32 v[50:51], v[50:51], v[242:243], v[240:241]
    v_pk_fma_f32 v[52:53], v[52:53], v[242:243], v[240:241]
    v_pk_fma_f32 v[54:55], v[54:55], v[242:243], v[240:241]
    v_pk_mul_f32 v[48:49], v[48:49], v[40:41]
    v_pk_mul_f32 v[50:51], v[50:51], v[42:43]
    v_pk_mul_f32 v[52:53], v[52:53], v[44:45]
    v_pk_mul_f32 v[54:55], v[54:55], v[46:47]
    v_exp_f32 v48, v48
    v_exp_f32 v49, v49
    v_exp_f32 v50, v50
    v_exp_f32 v51, v51
    v_exp_f32 v52, v52
    v_exp_f32 v53, v53
    v_exp_f32 v54, v54
    v_exp_f32 v55, v55
    v_pk_add_f32 v[48:49], v[48:49], v[244:245]
    v_pk_add_f32 v[50:51], v[50:51], v[244:245]
    v_pk_add_f32 v[52:53], v[52:53], v[244:245]
    v_pk_add_f32 v[54:55], v[54:55], v[244:245]
    v_rcp_f32 v48, v48
    v_rcp_f32 v49, v49
    v_rcp_f32 v50, v50
    v_rcp_f32 v51, v51
    v_rcp_f32 v52, v52
    v_rcp_f32 v53, v53
    v_rcp_f32 v54, v54
    v_rcp_f32 v55, v55
    v_pk_mul_f32 v[40:41], v[48:49], v[40:41]
    v_pk_mul_f32 v[42:43], v[50:51], v[42:43]
    v_pk_mul_f32 v[44:45], v[52:53], v[44:45]
    v_pk_mul_f32 v[46:47], v[54:55], v[46:47]
    v_cvt_pk_bf16_f32 v56, v40, v41
    v_cvt_pk_bf16_f32 v57, v42, v43
    v_cvt_pk_bf16_f32 v58, v44, v45
    v_cvt_pk_bf16_f32 v59, v46, v47
    buffer_store_dwordx4 v[56:59], v251, s[4:7], s53 offen offset:2048 sc1
    v_accvgpr_read_b32 v0, a24
    v_accvgpr_read_b32 v1, a25
    v_accvgpr_read_b32 v2, a26
    v_accvgpr_read_b32 v3, a27
    v_accvgpr_read_b32 v4, a28
    v_accvgpr_read_b32 v5, a29
    v_accvgpr_read_b32 v6, a30
    v_accvgpr_read_b32 v7, a31
    v_pk_mul_f32 v[8:9], v[0:1], v[0:1]
    v_pk_mul_f32 v[10:11], v[2:3], v[2:3]
    v_pk_mul_f32 v[12:13], v[4:5], v[4:5]
    v_pk_mul_f32 v[14:15], v[6:7], v[6:7]
    v_pk_fma_f32 v[8:9], v[8:9], v[242:243], v[240:241]
    v_pk_fma_f32 v[10:11], v[10:11], v[242:243], v[240:241]
    v_pk_fma_f32 v[12:13], v[12:13], v[242:243], v[240:241]
    v_pk_fma_f32 v[14:15], v[14:15], v[242:243], v[240:241]
    v_pk_mul_f32 v[8:9], v[8:9], v[0:1]
    v_pk_mul_f32 v[10:11], v[10:11], v[2:3]
    v_pk_mul_f32 v[12:13], v[12:13], v[4:5]
    v_pk_mul_f32 v[14:15], v[14:15], v[6:7]
    v_exp_f32 v8, v8
    v_exp_f32 v9, v9
    v_exp_f32 v10, v10
    v_exp_f32 v11, v11
    v_exp_f32 v12, v12
    v_exp_f32 v13, v13
    v_exp_f32 v14, v14
    v_exp_f32 v15, v15
    v_pk_add_f32 v[8:9], v[8:9], v[244:245]
    v_pk_add_f32 v[10:11], v[10:11], v[244:245]
    v_pk_add_f32 v[12:13], v[12:13], v[244:245]
    v_pk_add_f32 v[14:15], v[14:15], v[244:245]
    v_rcp_f32 v8, v8
    v_rcp_f32 v9, v9
    v_rcp_f32 v10, v10
    v_rcp_f32 v11, v11
    v_rcp_f32 v12, v12
    v_rcp_f32 v13, v13
    v_rcp_f32 v14, v14
    v_rcp_f32 v15, v15
    v_pk_mul_f32 v[0:1], v[8:9], v[0:1]
    v_pk_mul_f32 v[2:3], v[10:11], v[2:3]
    v_pk_mul_f32 v[4:5], v[12:13], v[4:5]
    v_pk_mul_f32 v[6:7], v[14:15], v[6:7]
    v_cvt_pk_bf16_f32 v16, v0, v1
    v_cvt_pk_bf16_f32 v17, v2, v3
    v_cvt_pk_bf16_f32 v18, v4, v5
    v_cvt_pk_bf16_f32 v19, v6, v7
    buffer_store_dwordx4 v[16:19], v251, s[4:7], s53 offen offset:3072 sc1
    s_add_u32 s53, s53, s22
    v_accvgpr_read_b32 v20, a32
    v_accvgpr_read_b32 v21, a33
    v_accvgpr_read_b32 v22, a34
    v_accvgpr_read_b32 v23, a35
    v_accvgpr_read_b32 v24, a36
    v_accvgpr_read_b32 v25, a37
    v_accvgpr_read_b32 v26, a38
    v_accvgpr_read_b32 v27, a39
    v_pk_mul_f32 v[28:29], v[20:21], v[20:21]
    v_pk_mul_f32 v[30:31], v[22:23], v[22:23]
    v_pk_mul_f32 v[32:33], v[24:25], v[24:25]
    v_pk_mul_f32 v[34:35], v[26:27], v[26:27]
    v_pk_fma_f32 v[28:29], v[28:29], v[242:243], v[240:241]
    v_pk_fma_f32 v[30:31], v[30:31], v[242:243], v[240:241]
    v_pk_fma_f32 v[32:33], v[32:33], v[242:243], v[240:241]
    v_pk_fma_f32 v[34:35], v[34:35], v[242:243], v[240:241]
    v_pk_mul_f32 v[28:29], v[28:29], v[20:21]
    v_pk_mul_f32 v[30:31], v[30:31], v[22:23]
    v_pk_mul_f32 v[32:33], v[32:33], v[24:25]
    v_pk_mul_f32 v[34:35], v[34:35], v[26:27]
    v_exp_f32 v28, v28
    v_exp_f32 v29, v29
    v_exp_f32 v30, v30
    v_exp_f32 v31, v31
    v_exp_f32 v32, v32
    v_exp_f32 v33, v33
    v_exp_f32 v34, v34
    v_exp_f32 v35, v35
    v_pk_add_f32 v[28:29], v[28:29], v[244:245]
    v_pk_add_f32 v[30:31], v[30:31], v[244:245]
    v_pk_add_f32 v[32:33], v[32:33], v[244:245]
    v_pk_add_f32 v[34:35], v[34:35], v[244:245]
    v_rcp_f32 v28, v28
    v_rcp_f32 v29, v29
    v_rcp_f32 v30, v30
    v_rcp_f32 v31, v31
    v_rcp_f32 v32, v32
    v_rcp_f32 v33, v33
    v_rcp_f32 v34, v34
    v_rcp_f32 v35, v35
    v_pk_mul_f32 v[20:21], v[28:29], v[20:21]
    v_pk_mul_f32 v[22:23], v[30:31], v[22:23]
    v_pk_mul_f32 v[24:25], v[32:33], v[24:25]
    v_pk_mul_f32 v[26:27], v[34:35], v[26:27]
    v_cvt_pk_bf16_f32 v36, v20, v21
    v_cvt_pk_bf16_f32 v37, v22, v23
    v_cvt_pk_bf16_f32 v38, v24, v25
    v_cvt_pk_bf16_f32 v39, v26, v27
    buffer_store_dwordx4 v[36:39], v251, s[4:7], s53 offen offset:0 sc1
    v_accvgpr_read_b32 v40, a40
    v_accvgpr_read_b32 v41, a41
    v_accvgpr_read_b32 v42, a42
    v_accvgpr_read_b32 v43, a43
    v_accvgpr_read_b32 v44, a44
    v_accvgpr_read_b32 v45, a45
    v_accvgpr_read_b32 v46, a46
    v_accvgpr_read_b32 v47, a47
    v_pk_mul_f32 v[48:49], v[40:41], v[40:41]
    v_pk_mul_f32 v[50:51], v[42:43], v[42:43]
    v_pk_mul_f32 v[52:53], v[44:45], v[44:45]
    v_pk_mul_f32 v[54:55], v[46:47], v[46:47]
    v_pk_fma_f32 v[48:49], v[48:49], v[242:243], v[240:241]
    v_pk_fma_f32 v[50:51], v[50:51], v[242:243], v[240:241]
    v_pk_fma_f32 v[52:53], v[52:53], v[242:243], v[240:241]
    v_pk_fma_f32 v[54:55], v[54:55], v[242:243], v[240:241]
    v_pk_mul_f32 v[48:49], v[48:49], v[40:41]
    v_pk_mul_f32 v[50:51], v[50:51], v[42:43]
    v_pk_mul_f32 v[52:53], v[52:53], v[44:45]
    v_pk_mul_f32 v[54:55], v[54:55], v[46:47]
    v_exp_f32 v48, v48
    v_exp_f32 v49, v49
    v_exp_f32 v50, v50
    v_exp_f32 v51, v51
    v_exp_f32 v52, v52
    v_exp_f32 v53, v53
    v_exp_f32 v54, v54
    v_exp_f32 v55, v55
    v_pk_add_f32 v[48:49], v[48:49], v[244:245]
    v_pk_add_f32 v[50:51], v[50:51], v[244:245]
    v_pk_add_f32 v[52:53], v[52:53], v[244:245]
    v_pk_add_f32 v[54:55], v[54:55], v[244:245]
    v_rcp_f32 v48, v48
    v_rcp_f32 v49, v49
    v_rcp_f32 v50, v50
    v_rcp_f32 v51, v51
    v_rcp_f32 v52, v52
    v_rcp_f32 v53, v53
    v_rcp_f32 v54, v54
    v_rcp_f32 v55, v55
    v_pk_mul_f32 v[40:41], v[48:49], v[40:41]
    v_pk_mul_f32 v[42:43], v[50:51], v[42:43]
    v_pk_mul_f32 v[44:45], v[52:53], v[44:45]
    v_pk_mul_f32 v[46:47], v[54:55], v[46:47]
    v_cvt_pk_bf16_f32 v56, v40, v41
    v_cvt_pk_bf16_f32 v57, v42, v43
    v_cvt_pk_bf16_f32 v58, v44, v45
    v_cvt_pk_bf16_f32 v59, v46, v47
    buffer_store_dwordx4 v[56:59], v251, s[4:7], s53 offen offset:1024 sc1
    v_accvgpr_read_b32 v0, a48
    v_accvgpr_read_b32 v1, a49
    v_accvgpr_read_b32 v2, a50
    v_accvgpr_read_b32 v3, a51
    v_accvgpr_read_b32 v4, a52
    v_accvgpr_read_b32 v5, a53
    v_accvgpr_read_b32 v6, a54
    v_accvgpr_read_b32 v7, a55
    v_pk_mul_f32 v[8:9], v[0:1], v[0:1]
    v_pk_mul_f32 v[10:11], v[2:3], v[2:3]
    v_pk_mul_f32 v[12:13], v[4:5], v[4:5]
    v_pk_mul_f32 v[14:15], v[6:7], v[6:7]
    v_pk_fma_f32 v[8:9], v[8:9], v[242:243], v[240:241]
    v_pk_fma_f32 v[10:11], v[10:11], v[242:243], v[240:241]
    v_pk_fma_f32 v[12:13], v[12:13], v[242:243], v[240:241]
    v_pk_fma_f32 v[14:15], v[14:15], v[242:243], v[240:241]
    v_pk_mul_f32 v[8:9], v[8:9], v[0:1]
    v_pk_mul_f32 v[10:11], v[10:11], v[2:3]
    v_pk_mul_f32 v[12:13], v[12:13], v[4:5]
    v_pk_mul_f32 v[14:15], v[14:15], v[6:7]
    v_exp_f32 v8, v8
    v_exp_f32 v9, v9
    v_exp_f32 v10, v10
    v_exp_f32 v11, v11
    v_exp_f32 v12, v12
    v_exp_f32 v13, v13
    v_exp_f32 v14, v14
    v_exp_f32 v15, v15
    v_pk_add_f32 v[8:9], v[8:9], v[244:245]
    v_pk_add_f32 v[10:11], v[10:11], v[244:245]
    v_pk_add_f32 v[12:13], v[12:13], v[244:245]
    v_pk_add_f32 v[14:15], v[14:15], v[244:245]
    v_rcp_f32 v8, v8
    v_rcp_f32 v9, v9
    v_rcp_f32 v10, v10
    v_rcp_f32 v11, v11
    v_rcp_f32 v12, v12
    v_rcp_f32 v13, v13
    v_rcp_f32 v14, v14
    v_rcp_f32 v15, v15
    v_pk_mul_f32 v[0:1], v[8:9], v[0:1]
    v_pk_mul_f32 v[2:3], v[10:11], v[2:3]
    v_pk_mul_f32 v[4:5], v[12:13], v[4:5]
    v_pk_mul_f32 v[6:7], v[14:15], v[6:7]
    v_cvt_pk_bf16_f32 v16, v0, v1
    v_cvt_pk_bf16_f32 v17, v2, v3
    v_cvt_pk_bf16_f32 v18, v4, v5
    v_cvt_pk_bf16_f32 v19, v6, v7
    buffer_store_dwordx4 v[16:19], v251, s[4:7], s53 offen offset:2048 sc1
    v_accvgpr_read_b32 v20, a56
    v_accvgpr_read_b32 v21, a57
    v_accvgpr_read_b32 v22, a58
    v_accvgpr_read_b32 v23, a59
    v_accvgpr_read_b32 v24, a60
    v_accvgpr_read_b32 v25, a61
    v_accvgpr_read_b32 v26, a62
    v_accvgpr_read_b32 v27, a63
    v_pk_mul_f32 v[28:29], v[20:21], v[20:21]
    v_pk_mul_f32 v[30:31], v[22:23], v[22:23]
    v_pk_mul_f32 v[32:33], v[24:25], v[24:25]
    v_pk_mul_f32 v[34:35], v[26:27], v[26:27]
    v_pk_fma_f32 v[28:29], v[28:29], v[242:243], v[240:241]
    v_pk_fma_f32 v[30:31], v[30:31], v[242:243], v[240:241]
    v_pk_fma_f32 v[32:33], v[32:33], v[242:243], v[240:241]
    v_pk_fma_f32 v[34:35], v[34:35], v[242:243], v[240:241]
    v_pk_mul_f32 v[28:29], v[28:29], v[20:21]
    v_pk_mul_f32 v[30:31], v[30:31], v[22:23]
    v_pk_mul_f32 v[32:33], v[32:33], v[24:25]
    v_pk_mul_f32 v[34:35], v[34:35], v[26:27]
    v_exp_f32 v28, v28
    v_exp_f32 v29, v29
    v_exp_f32 v30, v30
    v_exp_f32 v31, v31
    v_exp_f32 v32, v32
    v_exp_f32 v33, v33
    v_exp_f32 v34, v34
    v_exp_f32 v35, v35
    v_pk_add_f32 v[28:29], v[28:29], v[244:245]
    v_pk_add_f32 v[30:31], v[30:31], v[244:245]
    v_pk_add_f32 v[32:33], v[32:33], v[244:245]
    v_pk_add_f32 v[34:35], v[34:35], v[244:245]
    v_rcp_f32 v28, v28
    v_rcp_f32 v29, v29
    v_rcp_f32 v30, v30
    v_rcp_f32 v31, v31
    v_rcp_f32 v32, v32
    v_rcp_f32 v33, v33
    v_rcp_f32 v34, v34
    v_rcp_f32 v35, v35
    v_pk_mul_f32 v[20:21], v[28:29], v[20:21]
    v_pk_mul_f32 v[22:23], v[30:31], v[22:23]
    v_pk_mul_f32 v[24:25], v[32:33], v[24:25]
    v_pk_mul_f32 v[26:27], v[34:35], v[26:27]
    v_cvt_pk_bf16_f32 v36, v20, v21
    v_cvt_pk_bf16_f32 v37, v22, v23
    v_cvt_pk_bf16_f32 v38, v24, v25
    v_cvt_pk_bf16_f32 v39, v26, v27
    buffer_store_dwordx4 v[36:39], v251, s[4:7], s53 offen offset:3072 sc1
    s_add_u32 s53, s53, s22
    v_accvgpr_read_b32 v40, a64
    v_accvgpr_read_b32 v41, a65
    v_accvgpr_read_b32 v42, a66
    v_accvgpr_read_b32 v43, a67
    v_accvgpr_read_b32 v44, a68
    v_accvgpr_read_b32 v45, a69
    v_accvgpr_read_b32 v46, a70
    v_accvgpr_read_b32 v47, a71
    v_pk_mul_f32 v[48:49], v[40:41], v[40:41]
    v_pk_mul_f32 v[50:51], v[42:43], v[42:43]
    v_pk_mul_f32 v[52:53], v[44:45], v[44:45]
    v_pk_mul_f32 v[54:55], v[46:47], v[46:47]
    v_pk_fma_f32 v[48:49], v[48:49], v[242:243], v[240:241]
    v_pk_fma_f32 v[50:51], v[50:51], v[242:243], v[240:241]
    v_pk_fma_f32 v[52:53], v[52:53], v[242:243], v[240:241]
    v_pk_fma_f32 v[54:55], v[54:55], v[242:243], v[240:241]
    v_pk_mul_f32 v[48:49], v[48:49], v[40:41]
    v_pk_mul_f32 v[50:51], v[50:51], v[42:43]
    v_pk_mul_f32 v[52:53], v[52:53], v[44:45]
    v_pk_mul_f32 v[54:55], v[54:55], v[46:47]
    v_exp_f32 v48, v48
    v_exp_f32 v49, v49
    v_exp_f32 v50, v50
    v_exp_f32 v51, v51
    v_exp_f32 v52, v52
    v_exp_f32 v53, v53
    v_exp_f32 v54, v54
    v_exp_f32 v55, v55
    v_pk_add_f32 v[48:49], v[48:49], v[244:245]
    v_pk_add_f32 v[50:51], v[50:51], v[244:245]
    v_pk_add_f32 v[52:53], v[52:53], v[244:245]
    v_pk_add_f32 v[54:55], v[54:55], v[244:245]
    v_rcp_f32 v48, v48
    v_rcp_f32 v49, v49
    v_rcp_f32 v50, v50
    v_rcp_f32 v51, v51
    v_rcp_f32 v52, v52
    v_rcp_f32 v53, v53
    v_rcp_f32 v54, v54
    v_rcp_f32 v55, v55
    v_pk_mul_f32 v[40:41], v[48:49], v[40:41]
    v_pk_mul_f32 v[42:43], v[50:51], v[42:43]
    v_pk_mul_f32 v[44:45], v[52:53], v[44:45]
    v_pk_mul_f32 v[46:47], v[54:55], v[46:47]
    v_cvt_pk_bf16_f32 v56, v40, v41
    v_cvt_pk_bf16_f32 v57, v42, v43
    v_cvt_pk_bf16_f32 v58, v44, v45
    v_cvt_pk_bf16_f32 v59, v46, v47
    buffer_store_dwordx4 v[56:59], v251, s[4:7], s53 offen offset:0 sc1
    v_accvgpr_read_b32 v0, a72
    v_accvgpr_read_b32 v1, a73
    v_accvgpr_read_b32 v2, a74
    v_accvgpr_read_b32 v3, a75
    v_accvgpr_read_b32 v4, a76
    v_accvgpr_read_b32 v5, a77
    v_accvgpr_read_b32 v6, a78
    v_accvgpr_read_b32 v7, a79
    v_pk_mul_f32 v[8:9], v[0:1], v[0:1]
    v_pk_mul_f32 v[10:11], v[2:3], v[2:3]
    v_pk_mul_f32 v[12:13], v[4:5], v[4:5]
    v_pk_mul_f32 v[14:15], v[6:7], v[6:7]
    v_pk_fma_f32 v[8:9], v[8:9], v[242:243], v[240:241]
    v_pk_fma_f32 v[10:11], v[10:11], v[242:243], v[240:241]
    v_pk_fma_f32 v[12:13], v[12:13], v[242:243], v[240:241]
    v_pk_fma_f32 v[14:15], v[14:15], v[242:243], v[240:241]
    v_pk_mul_f32 v[8:9], v[8:9], v[0:1]
    v_pk_mul_f32 v[10:11], v[10:11], v[2:3]
    v_pk_mul_f32 v[12:13], v[12:13], v[4:5]
    v_pk_mul_f32 v[14:15], v[14:15], v[6:7]
    v_exp_f32 v8, v8
    v_exp_f32 v9, v9
    v_exp_f32 v10, v10
    v_exp_f32 v11, v11
    v_exp_f32 v12, v12
    v_exp_f32 v13, v13
    v_exp_f32 v14, v14
    v_exp_f32 v15, v15
    v_pk_add_f32 v[8:9], v[8:9], v[244:245]
    v_pk_add_f32 v[10:11], v[10:11], v[244:245]
    v_pk_add_f32 v[12:13], v[12:13], v[244:245]
    v_pk_add_f32 v[14:15], v[14:15], v[244:245]
    v_rcp_f32 v8, v8
    v_rcp_f32 v9, v9
    v_rcp_f32 v10, v10
    v_rcp_f32 v11, v11
    v_rcp_f32 v12, v12
    v_rcp_f32 v13, v13
    v_rcp_f32 v14, v14
    v_rcp_f32 v15, v15
    v_pk_mul_f32 v[0:1], v[8:9], v[0:1]
    v_pk_mul_f32 v[2:3], v[10:11], v[2:3]
    v_pk_mul_f32 v[4:5], v[12:13], v[4:5]
    v_pk_mul_f32 v[6:7], v[14:15], v[6:7]
    v_cvt_pk_bf16_f32 v16, v0, v1
    v_cvt_pk_bf16_f32 v17, v2, v3
    v_cvt_pk_bf16_f32 v18, v4, v5
    v_cvt_pk_bf16_f32 v19, v6, v7
    buffer_store_dwordx4 v[16:19], v251, s[4:7], s53 offen offset:1024 sc1
    v_accvgpr_read_b32 v20, a80
    v_accvgpr_read_b32 v21, a81
    v_accvgpr_read_b32 v22, a82
    v_accvgpr_read_b32 v23, a83
    v_accvgpr_read_b32 v24, a84
    v_accvgpr_read_b32 v25, a85
    v_accvgpr_read_b32 v26, a86
    v_accvgpr_read_b32 v27, a87
    v_pk_mul_f32 v[28:29], v[20:21], v[20:21]
    v_pk_mul_f32 v[30:31], v[22:23], v[22:23]
    v_pk_mul_f32 v[32:33], v[24:25], v[24:25]
    v_pk_mul_f32 v[34:35], v[26:27], v[26:27]
    v_pk_fma_f32 v[28:29], v[28:29], v[242:243], v[240:241]
    v_pk_fma_f32 v[30:31], v[30:31], v[242:243], v[240:241]
    v_pk_fma_f32 v[32:33], v[32:33], v[242:243], v[240:241]
    v_pk_fma_f32 v[34:35], v[34:35], v[242:243], v[240:241]
    v_pk_mul_f32 v[28:29], v[28:29], v[20:21]
    v_pk_mul_f32 v[30:31], v[30:31], v[22:23]
    v_pk_mul_f32 v[32:33], v[32:33], v[24:25]
    v_pk_mul_f32 v[34:35], v[34:35], v[26:27]
    v_exp_f32 v28, v28
    v_exp_f32 v29, v29
    v_exp_f32 v30, v30
    v_exp_f32 v31, v31
    v_exp_f32 v32, v32
    v_exp_f32 v33, v33
    v_exp_f32 v34, v34
    v_exp_f32 v35, v35
    v_pk_add_f32 v[28:29], v[28:29], v[244:245]
    v_pk_add_f32 v[30:31], v[30:31], v[244:245]
    v_pk_add_f32 v[32:33], v[32:33], v[244:245]
    v_pk_add_f32 v[34:35], v[34:35], v[244:245]
    v_rcp_f32 v28, v28
    v_rcp_f32 v29, v29
    v_rcp_f32 v30, v30
    v_rcp_f32 v31, v31
    v_rcp_f32 v32, v32
    v_rcp_f32 v33, v33
    v_rcp_f32 v34, v34
    v_rcp_f32 v35, v35
    v_pk_mul_f32 v[20:21], v[28:29], v[20:21]
    v_pk_mul_f32 v[22:23], v[30:31], v[22:23]
    v_pk_mul_f32 v[24:25], v[32:33], v[24:25]
    v_pk_mul_f32 v[26:27], v[34:35], v[26:27]
    v_cvt_pk_bf16_f32 v36, v20, v21
    v_cvt_pk_bf16_f32 v37, v22, v23
    v_cvt_pk_bf16_f32 v38, v24, v25
    v_cvt_pk_bf16_f32 v39, v26, v27
    buffer_store_dwordx4 v[36:39], v251, s[4:7], s53 offen offset:2048 sc1
    v_accvgpr_read_b32 v40, a88
    v_accvgpr_read_b32 v41, a89
    v_accvgpr_read_b32 v42, a90
    v_accvgpr_read_b32 v43, a91
    v_accvgpr_read_b32 v44, a92
    v_accvgpr_read_b32 v45, a93
    v_accvgpr_read_b32 v46, a94
    v_accvgpr_read_b32 v47, a95
    v_pk_mul_f32 v[48:49], v[40:41], v[40:41]
    v_pk_mul_f32 v[50:51], v[42:43], v[42:43]
    v_pk_mul_f32 v[52:53], v[44:45], v[44:45]
    v_pk_mul_f32 v[54:55], v[46:47], v[46:47]
    v_pk_fma_f32 v[48:49], v[48:49], v[242:243], v[240:241]
    v_pk_fma_f32 v[50:51], v[50:51], v[242:243], v[240:241]
    v_pk_fma_f32 v[52:53], v[52:53], v[242:243], v[240:241]
    v_pk_fma_f32 v[54:55], v[54:55], v[242:243], v[240:241]
    v_pk_mul_f32 v[48:49], v[48:49], v[40:41]
    v_pk_mul_f32 v[50:51], v[50:51], v[42:43]
    v_pk_mul_f32 v[52:53], v[52:53], v[44:45]
    v_pk_mul_f32 v[54:55], v[54:55], v[46:47]
    v_exp_f32 v48, v48
    v_exp_f32 v49, v49
    v_exp_f32 v50, v50
    v_exp_f32 v51, v51
    v_exp_f32 v52, v52
    v_exp_f32 v53, v53
    v_exp_f32 v54, v54
    v_exp_f32 v55, v55
    v_pk_add_f32 v[48:49], v[48:49], v[244:245]
    v_pk_add_f32 v[50:51], v[50:51], v[244:245]
    v_pk_add_f32 v[52:53], v[52:53], v[244:245]
    v_pk_add_f32 v[54:55], v[54:55], v[244:245]
    v_rcp_f32 v48, v48
    v_rcp_f32 v49, v49
    v_rcp_f32 v50, v50
    v_rcp_f32 v51, v51
    v_rcp_f32 v52, v52
    v_rcp_f32 v53, v53
    v_rcp_f32 v54, v54
    v_rcp_f32 v55, v55
    v_pk_mul_f32 v[40:41], v[48:49], v[40:41]
    v_pk_mul_f32 v[42:43], v[50:51], v[42:43]
    v_pk_mul_f32 v[44:45], v[52:53], v[44:45]
    v_pk_mul_f32 v[46:47], v[54:55], v[46:47]
    v_cvt_pk_bf16_f32 v56, v40, v41
    v_cvt_pk_bf16_f32 v57, v42, v43
    v_cvt_pk_bf16_f32 v58, v44, v45
    v_cvt_pk_bf16_f32 v59, v46, v47
    buffer_store_dwordx4 v[56:59], v251, s[4:7], s53 offen offset:3072 sc1
    s_add_u32 s53, s53, s22
    v_accvgpr_read_b32 v0, a96
    v_accvgpr_read_b32 v1, a97
    v_accvgpr_read_b32 v2, a98
    v_accvgpr_read_b32 v3, a99
    v_accvgpr_read_b32 v4, a100
    v_accvgpr_read_b32 v5, a101
    v_accvgpr_read_b32 v6, a102
    v_accvgpr_read_b32 v7, a103
    v_pk_mul_f32 v[8:9], v[0:1], v[0:1]
    v_pk_mul_f32 v[10:11], v[2:3], v[2:3]
    v_pk_mul_f32 v[12:13], v[4:5], v[4:5]
    v_pk_mul_f32 v[14:15], v[6:7], v[6:7]
    v_pk_fma_f32 v[8:9], v[8:9], v[242:243], v[240:241]
    v_pk_fma_f32 v[10:11], v[10:11], v[242:243], v[240:241]
    v_pk_fma_f32 v[12:13], v[12:13], v[242:243], v[240:241]
    v_pk_fma_f32 v[14:15], v[14:15], v[242:243], v[240:241]
    v_pk_mul_f32 v[8:9], v[8:9], v[0:1]
    v_pk_mul_f32 v[10:11], v[10:11], v[2:3]
    v_pk_mul_f32 v[12:13], v[12:13], v[4:5]
    v_pk_mul_f32 v[14:15], v[14:15], v[6:7]
    v_exp_f32 v8, v8
    v_exp_f32 v9, v9
    v_exp_f32 v10, v10
    v_exp_f32 v11, v11
    v_exp_f32 v12, v12
    v_exp_f32 v13, v13
    v_exp_f32 v14, v14
    v_exp_f32 v15, v15
    v_pk_add_f32 v[8:9], v[8:9], v[244:245]
    v_pk_add_f32 v[10:11], v[10:11], v[244:245]
    v_pk_add_f32 v[12:13], v[12:13], v[244:245]
    v_pk_add_f32 v[14:15], v[14:15], v[244:245]
    v_rcp_f32 v8, v8
    v_rcp_f32 v9, v9
    v_rcp_f32 v10, v10
    v_rcp_f32 v11, v11
    v_rcp_f32 v12, v12
    v_rcp_f32 v13, v13
    v_rcp_f32 v14, v14
    v_rcp_f32 v15, v15
    v_pk_mul_f32 v[0:1], v[8:9], v[0:1]
    v_pk_mul_f32 v[2:3], v[10:11], v[2:3]
    v_pk_mul_f32 v[4:5], v[12:13], v[4:5]
    v_pk_mul_f32 v[6:7], v[14:15], v[6:7]
    v_cvt_pk_bf16_f32 v16, v0, v1
    v_cvt_pk_bf16_f32 v17, v2, v3
    v_cvt_pk_bf16_f32 v18, v4, v5
    v_cvt_pk_bf16_f32 v19, v6, v7
    buffer_store_dwordx4 v[16:19], v251, s[4:7], s53 offen offset:0 sc1
    v_accvgpr_read_b32 v20, a104
    v_accvgpr_read_b32 v21, a105
    v_accvgpr_read_b32 v22, a106
    v_accvgpr_read_b32 v23, a107
    v_accvgpr_read_b32 v24, a108
    v_accvgpr_read_b32 v25, a109
    v_accvgpr_read_b32 v26, a110
    v_accvgpr_read_b32 v27, a111
    v_pk_mul_f32 v[28:29], v[20:21], v[20:21]
    v_pk_mul_f32 v[30:31], v[22:23], v[22:23]
    v_pk_mul_f32 v[32:33], v[24:25], v[24:25]
    v_pk_mul_f32 v[34:35], v[26:27], v[26:27]
    v_pk_fma_f32 v[28:29], v[28:29], v[242:243], v[240:241]
    v_pk_fma_f32 v[30:31], v[30:31], v[242:243], v[240:241]
    v_pk_fma_f32 v[32:33], v[32:33], v[242:243], v[240:241]
    v_pk_fma_f32 v[34:35], v[34:35], v[242:243], v[240:241]
    v_pk_mul_f32 v[28:29], v[28:29], v[20:21]
    v_pk_mul_f32 v[30:31], v[30:31], v[22:23]
    v_pk_mul_f32 v[32:33], v[32:33], v[24:25]
    v_pk_mul_f32 v[34:35], v[34:35], v[26:27]
    v_exp_f32 v28, v28
    v_exp_f32 v29, v29
    v_exp_f32 v30, v30
    v_exp_f32 v31, v31
    v_exp_f32 v32, v32
    v_exp_f32 v33, v33
    v_exp_f32 v34, v34
    v_exp_f32 v35, v35
    v_pk_add_f32 v[28:29], v[28:29], v[244:245]
    v_pk_add_f32 v[30:31], v[30:31], v[244:245]
    v_pk_add_f32 v[32:33], v[32:33], v[244:245]
    v_pk_add_f32 v[34:35], v[34:35], v[244:245]
    v_rcp_f32 v28, v28
    v_rcp_f32 v29, v29
    v_rcp_f32 v30, v30
    v_rcp_f32 v31, v31
    v_rcp_f32 v32, v32
    v_rcp_f32 v33, v33
    v_rcp_f32 v34, v34
    v_rcp_f32 v35, v35
    v_pk_mul_f32 v[20:21], v[28:29], v[20:21]
    v_pk_mul_f32 v[22:23], v[30:31], v[22:23]
    v_pk_mul_f32 v[24:25], v[32:33], v[24:25]
    v_pk_mul_f32 v[26:27], v[34:35], v[26:27]
    v_cvt_pk_bf16_f32 v36, v20, v21
    v_cvt_pk_bf16_f32 v37, v22, v23
    v_cvt_pk_bf16_f32 v38, v24, v25
    v_cvt_pk_bf16_f32 v39, v26, v27
    buffer_store_dwordx4 v[36:39], v251, s[4:7], s53 offen offset:1024 sc1
    v_accvgpr_read_b32 v40, a112
    v_accvgpr_read_b32 v41, a113
    v_accvgpr_read_b32 v42, a114
    v_accvgpr_read_b32 v43, a115
    v_accvgpr_read_b32 v44, a116
    v_accvgpr_read_b32 v45, a117
    v_accvgpr_read_b32 v46, a118
    v_accvgpr_read_b32 v47, a119
    v_pk_mul_f32 v[48:49], v[40:41], v[40:41]
    v_pk_mul_f32 v[50:51], v[42:43], v[42:43]
    v_pk_mul_f32 v[52:53], v[44:45], v[44:45]
    v_pk_mul_f32 v[54:55], v[46:47], v[46:47]
    v_pk_fma_f32 v[48:49], v[48:49], v[242:243], v[240:241]
    v_pk_fma_f32 v[50:51], v[50:51], v[242:243], v[240:241]
    v_pk_fma_f32 v[52:53], v[52:53], v[242:243], v[240:241]
    v_pk_fma_f32 v[54:55], v[54:55], v[242:243], v[240:241]
    v_pk_mul_f32 v[48:49], v[48:49], v[40:41]
    v_pk_mul_f32 v[50:51], v[50:51], v[42:43]
    v_pk_mul_f32 v[52:53], v[52:53], v[44:45]
    v_pk_mul_f32 v[54:55], v[54:55], v[46:47]
    v_exp_f32 v48, v48
    v_exp_f32 v49, v49
    v_exp_f32 v50, v50
    v_exp_f32 v51, v51
    v_exp_f32 v52, v52
    v_exp_f32 v53, v53
    v_exp_f32 v54, v54
    v_exp_f32 v55, v55
    v_pk_add_f32 v[48:49], v[48:49], v[244:245]
    v_pk_add_f32 v[50:51], v[50:51], v[244:245]
    v_pk_add_f32 v[52:53], v[52:53], v[244:245]
    v_pk_add_f32 v[54:55], v[54:55], v[244:245]
    v_rcp_f32 v48, v48
    v_rcp_f32 v49, v49
    v_rcp_f32 v50, v50
    v_rcp_f32 v51, v51
    v_rcp_f32 v52, v52
    v_rcp_f32 v53, v53
    v_rcp_f32 v54, v54
    v_rcp_f32 v55, v55
    v_pk_mul_f32 v[40:41], v[48:49], v[40:41]
    v_pk_mul_f32 v[42:43], v[50:51], v[42:43]
    v_pk_mul_f32 v[44:45], v[52:53], v[44:45]
    v_pk_mul_f32 v[46:47], v[54:55], v[46:47]
    v_cvt_pk_bf16_f32 v56, v40, v41
    v_cvt_pk_bf16_f32 v57, v42, v43
    v_cvt_pk_bf16_f32 v58, v44, v45
    v_cvt_pk_bf16_f32 v59, v46, v47
    buffer_store_dwordx4 v[56:59], v251, s[4:7], s53 offen offset:2048 sc1
    v_accvgpr_read_b32 v0, a120
    v_accvgpr_read_b32 v1, a121
    v_accvgpr_read_b32 v2, a122
    v_accvgpr_read_b32 v3, a123
    v_accvgpr_read_b32 v4, a124
    v_accvgpr_read_b32 v5, a125
    v_accvgpr_read_b32 v6, a126
    v_accvgpr_read_b32 v7, a127
    v_pk_mul_f32 v[8:9], v[0:1], v[0:1]
    v_pk_mul_f32 v[10:11], v[2:3], v[2:3]
    v_pk_mul_f32 v[12:13], v[4:5], v[4:5]
    v_pk_mul_f32 v[14:15], v[6:7], v[6:7]
    v_pk_fma_f32 v[8:9], v[8:9], v[242:243], v[240:241]
    v_pk_fma_f32 v[10:11], v[10:11], v[242:243], v[240:241]
    v_pk_fma_f32 v[12:13], v[12:13], v[242:243], v[240:241]
    v_pk_fma_f32 v[14:15], v[14:15], v[242:243], v[240:241]
    v_pk_mul_f32 v[8:9], v[8:9], v[0:1]
    v_pk_mul_f32 v[10:11], v[10:11], v[2:3]
    v_pk_mul_f32 v[12:13], v[12:13], v[4:5]
    v_pk_mul_f32 v[14:15], v[14:15], v[6:7]
    v_exp_f32 v8, v8
    v_exp_f32 v9, v9
    v_exp_f32 v10, v10
    v_exp_f32 v11, v11
    v_exp_f32 v12, v12
    v_exp_f32 v13, v13
    v_exp_f32 v14, v14
    v_exp_f32 v15, v15
    v_pk_add_f32 v[8:9], v[8:9], v[244:245]
    v_pk_add_f32 v[10:11], v[10:11], v[244:245]
    v_pk_add_f32 v[12:13], v[12:13], v[244:245]
    v_pk_add_f32 v[14:15], v[14:15], v[244:245]
    v_rcp_f32 v8, v8
    v_rcp_f32 v9, v9
    v_rcp_f32 v10, v10
    v_rcp_f32 v11, v11
    v_rcp_f32 v12, v12
    v_rcp_f32 v13, v13
    v_rcp_f32 v14, v14
    v_rcp_f32 v15, v15
    v_pk_mul_f32 v[0:1], v[8:9], v[0:1]
    v_pk_mul_f32 v[2:3], v[10:11], v[2:3]
    v_pk_mul_f32 v[4:5], v[12:13], v[4:5]
    v_pk_mul_f32 v[6:7], v[14:15], v[6:7]
    v_cvt_pk_bf16_f32 v16, v0, v1
    v_cvt_pk_bf16_f32 v17, v2, v3
    v_cvt_pk_bf16_f32 v18, v4, v5
    v_cvt_pk_bf16_f32 v19, v6, v7
    buffer_store_dwordx4 v[16:19], v251, s[4:7], s53 offen offset:3072 sc1
    s_branch main_kernel_w_done
main_kernel_w_c1_gov:
    v_lshrrev_b32 v0, 4, v250
    v_bfe_u32 v1, v250, 2, 2
    v_lshl_add_u32 v4, v0, 2, v1
    v_and_b32 v5, 7, v4
    v_mul_u32_u24 v4, 512, v4
    v_and_b32 v6, 3, v250
    v_lshl_add_u32 v4, v6, 3, v4
    s_mul_i32 s32, s37, 8
    v_xor_b32 v5, s32, v5
    v_lshl_add_u32 v128, v5, 5, v4
    v_xor_b32 v129, 32, v128
    v_xor_b32 v130, 64, v128
    v_xor_b32 v131, 96, v128
    v_xor_b32 v132, 128, v128
    v_xor_b32 v133, 160, v128
    v_xor_b32 v134, 192, v128
    v_xor_b32 v135, 224, v128
    s_mul_i32 s32, s38, 4096
    s_add_u32 s32, s32, 65536
    v_add_u32 v136, s32, v251
    v_lshrrev_b32 v2, 5, v250
    v_and_b32 v3, 31, v250
    s_mul_i32 s32, s14, 8
    v_add_u32 v4, s32, v2
    v_add_u32 v5, 0, v4
    v_and_b32 v6, 7, v5
    v_lshlrev_b32 v6, 1, v6
    v_xor_b32 v6, v6, v3
    v_mul_lo_u32 v5, v5, s30
    v_lshl_add_u32 v5, v6, 4, v5
    v_subrev_u32 v137, 0, v5
    v_add_u32 v5, 2, v4
    v_and_b32 v6, 7, v5
    v_lshlrev_b32 v6, 1, v6
    v_xor_b32 v6, v6, v3
    v_mul_lo_u32 v5, v5, s30
    v_lshl_add_u32 v5, v6, 4, v5
    v_subrev_u32 v138, 1024, v5
    v_add_u32 v5, 4, v4
    v_and_b32 v6, 7, v5
    v_lshlrev_b32 v6, 1, v6
    v_xor_b32 v6, v6, v3
    v_mul_lo_u32 v5, v5, s30
    v_lshl_add_u32 v5, v6, 4, v5
    v_subrev_u32 v139, 2048, v5
    v_add_u32 v5, 6, v4
    v_and_b32 v6, 7, v5
    v_lshlrev_b32 v6, 1, v6
    v_xor_b32 v6, v6, v3
    v_mul_lo_u32 v5, v5, s30
    v_lshl_add_u32 v5, v6, 4, v5
    v_subrev_u32 v140, 3072, v5
    s_mul_i32 s32, s14, 2
    s_mul_i32 s32, s32, s31
    v_add_u32 v141, s32, v251
    s_add_u32 s32, s32, s31
    s_sub_u32 s32, s32, 1024
    v_add_u32 v142, s32, v251
    s_mul_i32 s19, s14, 4096
    s_mul_i32 s20, s14, 2048
    s_add_u32 s20, s20, 65536
    s_mul_i32 s17, s30, 32
    s_mov_b32 s15, 0
    s_add_u32 m0, s20, 0
    s_nop 0
    buffer_load_dwordx4 v141, s[4:7], s16 offen offset:0 sc1 lds
    buffer_load_dwordx4 v142, s[4:7], s16 offen offset:1024 sc1 lds
    s_add_u32 s16, s16, 1024
    s_add_u32 m0, s19, 0
    s_nop 0
    buffer_load_dwordx4 v137, s[8:11], s15 offen offset:0 lds
    buffer_load_dwordx4 v138, s[8:11], s15 offen offset:1024 lds
    buffer_load_dwordx4 v139, s[8:11], s15 offen offset:2048 lds
    buffer_load_dwordx4 v140, s[8:11], s15 offen offset:3072 lds
    s_add_u32 s15, s15, s17
    s_add_u32 m0, s20, 8192
    s_nop 0
    buffer_load_dwordx4 v141, s[4:7], s16 offen offset:0 sc1 lds
    buffer_load_dwordx4 v142, s[4:7], s16 offen offset:1024 sc1 lds
    s_add_u32 s16, s16, 1024
    s_add_u32 m0, s19, 16384
    s_nop 0
    buffer_load_dwordx4 v137, s[8:11], s15 offen offset:0 lds
    buffer_load_dwordx4 v138, s[8:11], s15 offen offset:1024 lds
    buffer_load_dwordx4 v139, s[8:11], s15 offen offset:2048 lds
    buffer_load_dwordx4 v140, s[8:11], s15 offen offset:3072 lds
    s_add_u32 s15, s15, s17
    s_add_u32 m0, s20, 16384
    s_nop 0
    buffer_load_dwordx4 v141, s[4:7], s16 offen offset:0 sc1 lds
    buffer_load_dwordx4 v142, s[4:7], s16 offen offset:1024 sc1 lds
    s_add_u32 s16, s16, 1024
    s_add_u32 m0, s19, 32768
    s_nop 0
    buffer_load_dwordx4 v137, s[8:11], s15 offen offset:0 lds
    buffer_load_dwordx4 v138, s[8:11], s15 offen offset:1024 lds
    buffer_load_dwordx4 v139, s[8:11], s15 offen offset:2048 lds
    buffer_load_dwordx4 v140, s[8:11], s15 offen offset:3072 lds
    s_add_u32 s15, s15, s17
    s_add_u32 m0, s20, 24576
    s_nop 0
    buffer_load_dwordx4 v141, s[4:7], s16 offen offset:0 sc1 lds
    buffer_load_dwordx4 v142, s[4:7], s16 offen offset:1024 sc1 lds
    s_add_u32 s16, s16, 1024
    s_add_u32 m0, s19, 49152
    s_nop 0
    buffer_load_dwordx4 v137, s[8:11], s15 offen offset:0 lds
    buffer_load_dwordx4 v138, s[8:11], s15 offen offset:1024 lds
    buffer_load_dwordx4 v139, s[8:11], s15 offen offset:2048 lds
    buffer_load_dwordx4 v140, s[8:11], s15 offen offset:3072 lds
    s_add_u32 s15, s15, s17
    v_accvgpr_write_b32 a0, 0
    v_accvgpr_write_b32 a1, 0
    v_accvgpr_write_b32 a2, 0
    v_accvgpr_write_b32 a3, 0
    v_accvgpr_write_b32 a4, 0
    v_accvgpr_write_b32 a5, 0
    v_accvgpr_write_b32 a6, 0
    v_accvgpr_write_b32 a7, 0
    v_accvgpr_write_b32 a8, 0
    v_accvgpr_write_b32 a9, 0
    v_accvgpr_write_b32 a10, 0
    v_accvgpr_write_b32 a11, 0
    v_accvgpr_write_b32 a12, 0
    v_accvgpr_write_b32 a13, 0
    v_accvgpr_write_b32 a14, 0
    v_accvgpr_write_b32 a15, 0
    v_accvgpr_write_b32 a16, 0
    v_accvgpr_write_b32 a17, 0
    v_accvgpr_write_b32 a18, 0
    v_accvgpr_write_b32 a19, 0
    v_accvgpr_write_b32 a20, 0
    v_accvgpr_write_b32 a21, 0
    v_accvgpr_write_b32 a22, 0
    v_accvgpr_write_b32 a23, 0
    v_accvgpr_write_b32 a24, 0
    v_accvgpr_write_b32 a25, 0
    v_accvgpr_write_b32 a26, 0
    v_accvgpr_write_b32 a27, 0
    v_accvgpr_write_b32 a28, 0
    v_accvgpr_write_b32 a29, 0
    v_accvgpr_write_b32 a30, 0
    v_accvgpr_write_b32 a31, 0
    v_accvgpr_write_b32 a32, 0
    v_accvgpr_write_b32 a33, 0
    v_accvgpr_write_b32 a34, 0
    v_accvgpr_write_b32 a35, 0
    v_accvgpr_write_b32 a36, 0
    v_accvgpr_write_b32 a37, 0
    v_accvgpr_write_b32 a38, 0
    v_accvgpr_write_b32 a39, 0
    v_accvgpr_write_b32 a40, 0
    v_accvgpr_write_b32 a41, 0
    v_accvgpr_write_b32 a42, 0
    v_accvgpr_write_b32 a43, 0
    v_accvgpr_write_b32 a44, 0
    v_accvgpr_write_b32 a45, 0
    v_accvgpr_write_b32 a46, 0
    v_accvgpr_write_b32 a47, 0
    v_accvgpr_write_b32 a48, 0
    v_accvgpr_write_b32 a49, 0
    v_accvgpr_write_b32 a50, 0
    v_accvgpr_write_b32 a51, 0
    v_accvgpr_write_b32 a52, 0
    v_accvgpr_write_b32 a53, 0
    v_accvgpr_write_b32 a54, 0
    v_accvgpr_write_b32 a55, 0
    v_accvgpr_write_b32 a56, 0
    v_accvgpr_write_b32 a57, 0
    v_accvgpr_write_b32 a58, 0
    v_accvgpr_write_b32 a59, 0
    v_accvgpr_write_b32 a60, 0
    v_accvgpr_write_b32 a61, 0
    v_accvgpr_write_b32 a62, 0
    v_accvgpr_write_b32 a63, 0
    v_accvgpr_write_b32 a64, 0
    v_accvgpr_write_b32 a65, 0
    v_accvgpr_write_b32 a66, 0
    v_accvgpr_write_b32 a67, 0
    v_accvgpr_write_b32 a68, 0
    v_accvgpr_write_b32 a69, 0
    v_accvgpr_write_b32 a70, 0
    v_accvgpr_write_b32 a71, 0
    v_accvgpr_write_b32 a72, 0
    v_accvgpr_write_b32 a73, 0
    v_accvgpr_write_b32 a74, 0
    v_accvgpr_write_b32 a75, 0
    v_accvgpr_write_b32 a76, 0
    v_accvgpr_write_b32 a77, 0
    v_accvgpr_write_b32 a78, 0
    v_accvgpr_write_b32 a79, 0
    v_accvgpr_write_b32 a80, 0
    v_accvgpr_write_b32 a81, 0
    v_accvgpr_write_b32 a82, 0
    v_accvgpr_write_b32 a83, 0
    v_accvgpr_write_b32 a84, 0
    v_accvgpr_write_b32 a85, 0
    v_accvgpr_write_b32 a86, 0
    v_accvgpr_write_b32 a87, 0
    v_accvgpr_write_b32 a88, 0
    v_accvgpr_write_b32 a89, 0
    v_accvgpr_write_b32 a90, 0
    v_accvgpr_write_b32 a91, 0
    v_accvgpr_write_b32 a92, 0
    v_accvgpr_write_b32 a93, 0
    v_accvgpr_write_b32 a94, 0
    v_accvgpr_write_b32 a95, 0
    v_accvgpr_write_b32 a96, 0
    v_accvgpr_write_b32 a97, 0
    v_accvgpr_write_b32 a98, 0
    v_accvgpr_write_b32 a99, 0
    v_accvgpr_write_b32 a100, 0
    v_accvgpr_write_b32 a101, 0
    v_accvgpr_write_b32 a102, 0
    v_accvgpr_write_b32 a103, 0
    v_accvgpr_write_b32 a104, 0
    v_accvgpr_write_b32 a105, 0
    v_accvgpr_write_b32 a106, 0
    v_accvgpr_write_b32 a107, 0
    v_accvgpr_write_b32 a108, 0
    v_accvgpr_write_b32 a109, 0
    v_accvgpr_write_b32 a110, 0
    v_accvgpr_write_b32 a111, 0
    v_accvgpr_write_b32 a112, 0
    v_accvgpr_write_b32 a113, 0
    v_accvgpr_write_b32 a114, 0
    v_accvgpr_write_b32 a115, 0
    v_accvgpr_write_b32 a116, 0
    v_accvgpr_write_b32 a117, 0
    v_accvgpr_write_b32 a118, 0
    v_accvgpr_write_b32 a119, 0
    v_accvgpr_write_b32 a120, 0
    v_accvgpr_write_b32 a121, 0
    v_accvgpr_write_b32 a122, 0
    v_accvgpr_write_b32 a123, 0
    v_accvgpr_write_b32 a124, 0
    v_accvgpr_write_b32 a125, 0
    v_accvgpr_write_b32 a126, 0
    v_accvgpr_write_b32 a127, 0
    s_waitcnt vmcnt(18)
    s_barrier
    ds_read_b128 v[32:35], v136 offset:0
    ds_read_b64_tr_b16 v[0:1], v128 offset:0
    ds_read_b64_tr_b16 v[2:3], v128 offset:8192
    ds_read_b64_tr_b16 v[4:5], v129 offset:0
    ds_read_b64_tr_b16 v[6:7], v129 offset:8192
    ds_read_b64_tr_b16 v[8:9], v130 offset:0
    ds_read_b64_tr_b16 v[10:11], v130 offset:8192
    ds_read_b64_tr_b16 v[12:13], v131 offset:0
    ds_read_b64_tr_b16 v[14:15], v131 offset:8192
    ds_read_b64_tr_b16 v[16:17], v132 offset:0
    ds_read_b64_tr_b16 v[18:19], v132 offset:8192
    ds_read_b64_tr_b16 v[20:21], v133 offset:0
    ds_read_b64_tr_b16 v[22:23], v133 offset:8192
    ds_read_b64_tr_b16 v[24:25], v134 offset:0
    ds_read_b64_tr_b16 v[26:27], v134 offset:8192
    ds_read_b64_tr_b16 v[28:29], v135 offset:0
    ds_read_b64_tr_b16 v[30:31], v135 offset:8192
    ds_read_b128 v[36:39], v136 offset:1024
    ds_read_b128 v[40:43], v136 offset:2048
    ds_read_b128 v[44:47], v136 offset:3072
main_kernel_w_c1_v_loop:
    s_waitcnt lgkmcnt(0)
    v_mfma_f32_16x16x32_bf16 a[0:3], v[32:35], v[0:3], a[0:3]
    s_waitcnt vmcnt(12)
    s_barrier
    ds_read_b128 v[80:83], v136 offset:8192
    s_add_u32 m0, s20, 0
    s_nop 0
    v_mfma_f32_16x16x32_bf16 a[4:7], v[32:35], v[4:7], a[4:7]
    ds_read_b64_tr_b16 v[48:49], v128 offset:16384
    v_mfma_f32_16x16x32_bf16 a[8:11], v[32:35], v[8:11], a[8:11]
    ds_read_b64_tr_b16 v[50:51], v128 offset:24576
    v_mfma_f32_16x16x32_bf16 a[12:15], v[32:35], v[12:15], a[12:15]
    ds_read_b64_tr_b16 v[52:53], v129 offset:16384
    buffer_load_dwordx4 v141, s[4:7], s16 offen offset:0 sc1 lds
    v_mfma_f32_16x16x32_bf16 a[16:19], v[32:35], v[16:19], a[16:19]
    ds_read_b64_tr_b16 v[54:55], v129 offset:24576
    v_mfma_f32_16x16x32_bf16 a[20:23], v[32:35], v[20:23], a[20:23]
    ds_read_b64_tr_b16 v[56:57], v130 offset:16384
    v_mfma_f32_16x16x32_bf16 a[24:27], v[32:35], v[24:27], a[24:27]
    ds_read_b64_tr_b16 v[58:59], v130 offset:24576
    buffer_load_dwordx4 v142, s[4:7], s16 offen offset:1024 sc1 lds
    v_mfma_f32_16x16x32_bf16 a[28:31], v[32:35], v[28:31], a[28:31]
    ds_read_b64_tr_b16 v[60:61], v131 offset:16384
    v_mfma_f32_16x16x32_bf16 a[32:35], v[36:39], v[0:3], a[32:35]
    ds_read_b64_tr_b16 v[62:63], v131 offset:24576
    v_mfma_f32_16x16x32_bf16 a[36:39], v[36:39], v[4:7], a[36:39]
    ds_read_b64_tr_b16 v[64:65], v132 offset:16384
    s_add_u32 s16, s16, 1024
    v_mfma_f32_16x16x32_bf16 a[40:43], v[36:39], v[8:11], a[40:43]
    ds_read_b64_tr_b16 v[66:67], v132 offset:24576
    v_mfma_f32_16x16x32_bf16 a[44:47], v[36:39], v[12:15], a[44:47]
    ds_read_b64_tr_b16 v[68:69], v133 offset:16384
    v_mfma_f32_16x16x32_bf16 a[48:51], v[36:39], v[16:19], a[48:51]
    ds_read_b64_tr_b16 v[70:71], v133 offset:24576
    s_add_u32 m0, s19, 0
    s_nop 0
    v_mfma_f32_16x16x32_bf16 a[52:55], v[36:39], v[20:23], a[52:55]
    ds_read_b64_tr_b16 v[72:73], v134 offset:16384
    v_mfma_f32_16x16x32_bf16 a[56:59], v[36:39], v[24:27], a[56:59]
    ds_read_b64_tr_b16 v[74:75], v134 offset:24576
    v_mfma_f32_16x16x32_bf16 a[60:63], v[36:39], v[28:31], a[60:63]
    ds_read_b64_tr_b16 v[76:77], v135 offset:16384
    buffer_load_dwordx4 v137, s[8:11], s15 offen offset:0 lds
    v_mfma_f32_16x16x32_bf16 a[64:67], v[40:43], v[0:3], a[64:67]
    ds_read_b64_tr_b16 v[78:79], v135 offset:24576
    v_mfma_f32_16x16x32_bf16 a[68:71], v[40:43], v[4:7], a[68:71]
    ds_read_b128 v[84:87], v136 offset:9216
    v_mfma_f32_16x16x32_bf16 a[72:75], v[40:43], v[8:11], a[72:75]
    ds_read_b128 v[88:91], v136 offset:10240
    buffer_load_dwordx4 v138, s[8:11], s15 offen offset:1024 lds
    v_mfma_f32_16x16x32_bf16 a[76:79], v[40:43], v[12:15], a[76:79]
    ds_read_b128 v[92:95], v136 offset:11264
    v_mfma_f32_16x16x32_bf16 a[80:83], v[40:43], v[16:19], a[80:83]
    v_mfma_f32_16x16x32_bf16 a[84:87], v[40:43], v[20:23], a[84:87]
    buffer_load_dwordx4 v139, s[8:11], s15 offen offset:2048 lds
    v_mfma_f32_16x16x32_bf16 a[88:91], v[40:43], v[24:27], a[88:91]
    v_mfma_f32_16x16x32_bf16 a[92:95], v[40:43], v[28:31], a[92:95]
    v_mfma_f32_16x16x32_bf16 a[96:99], v[44:47], v[0:3], a[96:99]
    buffer_load_dwordx4 v140, s[8:11], s15 offen offset:3072 lds
    v_mfma_f32_16x16x32_bf16 a[100:103], v[44:47], v[4:7], a[100:103]
    v_mfma_f32_16x16x32_bf16 a[104:107], v[44:47], v[8:11], a[104:107]
    v_mfma_f32_16x16x32_bf16 a[108:111], v[44:47], v[12:15], a[108:111]
    s_add_u32 s15, s15, s17
    v_mfma_f32_16x16x32_bf16 a[112:115], v[44:47], v[16:19], a[112:115]
    v_mfma_f32_16x16x32_bf16 a[116:119], v[44:47], v[20:23], a[116:119]
    v_mfma_f32_16x16x32_bf16 a[120:123], v[44:47], v[24:27], a[120:123]
    v_mfma_f32_16x16x32_bf16 a[124:127], v[44:47], v[28:31], a[124:127]
    s_waitcnt lgkmcnt(0)
    v_mfma_f32_16x16x32_bf16 a[0:3], v[80:83], v[48:51], a[0:3]
    s_waitcnt vmcnt(12)
    s_barrier
    ds_read_b128 v[32:35], v136 offset:16384
    s_add_u32 m0, s20, 8192
    s_nop 0
    v_mfma_f32_16x16x32_bf16 a[4:7], v[80:83], v[52:55], a[4:7]
    ds_read_b64_tr_b16 v[0:1], v128 offset:32768
    v_mfma_f32_16x16x32_bf16 a[8:11], v[80:83], v[56:59], a[8:11]
    ds_read_b64_tr_b16 v[2:3], v128 offset:40960
    v_mfma_f32_16x16x32_bf16 a[12:15], v[80:83], v[60:63], a[12:15]
    ds_read_b64_tr_b16 v[4:5], v129 offset:32768
    buffer_load_dwordx4 v141, s[4:7], s16 offen offset:0 sc1 lds
    v_mfma_f32_16x16x32_bf16 a[16:19], v[80:83], v[64:67], a[16:19]
    ds_read_b64_tr_b16 v[6:7], v129 offset:40960
    v_mfma_f32_16x16x32_bf16 a[20:23], v[80:83], v[68:71], a[20:23]
    ds_read_b64_tr_b16 v[8:9], v130 offset:32768
    v_mfma_f32_16x16x32_bf16 a[24:27], v[80:83], v[72:75], a[24:27]
    ds_read_b64_tr_b16 v[10:11], v130 offset:40960
    buffer_load_dwordx4 v142, s[4:7], s16 offen offset:1024 sc1 lds
    v_mfma_f32_16x16x32_bf16 a[28:31], v[80:83], v[76:79], a[28:31]
    ds_read_b64_tr_b16 v[12:13], v131 offset:32768
    v_mfma_f32_16x16x32_bf16 a[32:35], v[84:87], v[48:51], a[32:35]
    ds_read_b64_tr_b16 v[14:15], v131 offset:40960
    v_mfma_f32_16x16x32_bf16 a[36:39], v[84:87], v[52:55], a[36:39]
    ds_read_b64_tr_b16 v[16:17], v132 offset:32768
    s_add_u32 s16, s16, 1024
    v_mfma_f32_16x16x32_bf16 a[40:43], v[84:87], v[56:59], a[40:43]
    ds_read_b64_tr_b16 v[18:19], v132 offset:40960
    v_mfma_f32_16x16x32_bf16 a[44:47], v[84:87], v[60:63], a[44:47]
    ds_read_b64_tr_b16 v[20:21], v133 offset:32768
    v_mfma_f32_16x16x32_bf16 a[48:51], v[84:87], v[64:67], a[48:51]
    ds_read_b64_tr_b16 v[22:23], v133 offset:40960
    s_add_u32 m0, s19, 16384
    s_nop 0
    v_mfma_f32_16x16x32_bf16 a[52:55], v[84:87], v[68:71], a[52:55]
    ds_read_b64_tr_b16 v[24:25], v134 offset:32768
    v_mfma_f32_16x16x32_bf16 a[56:59], v[84:87], v[72:75], a[56:59]
    ds_read_b64_tr_b16 v[26:27], v134 offset:40960
    v_mfma_f32_16x16x32_bf16 a[60:63], v[84:87], v[76:79], a[60:63]
    ds_read_b64_tr_b16 v[28:29], v135 offset:32768
    buffer_load_dwordx4 v137, s[8:11], s15 offen offset:0 lds
    v_mfma_f32_16x16x32_bf16 a[64:67], v[88:91], v[48:51], a[64:67]
    ds_read_b64_tr_b16 v[30:31], v135 offset:40960
    v_mfma_f32_16x16x32_bf16 a[68:71], v[88:91], v[52:55], a[68:71]
    ds_read_b128 v[36:39], v136 offset:17408
    v_mfma_f32_16x16x32_bf16 a[72:75], v[88:91], v[56:59], a[72:75]
    ds_read_b128 v[40:43], v136 offset:18432
    buffer_load_dwordx4 v138, s[8:11], s15 offen offset:1024 lds
    v_mfma_f32_16x16x32_bf16 a[76:79], v[88:91], v[60:63], a[76:79]
    ds_read_b128 v[44:47], v136 offset:19456
    v_mfma_f32_16x16x32_bf16 a[80:83], v[88:91], v[64:67], a[80:83]
    v_mfma_f32_16x16x32_bf16 a[84:87], v[88:91], v[68:71], a[84:87]
    buffer_load_dwordx4 v139, s[8:11], s15 offen offset:2048 lds
    v_mfma_f32_16x16x32_bf16 a[88:91], v[88:91], v[72:75], a[88:91]
    v_mfma_f32_16x16x32_bf16 a[92:95], v[88:91], v[76:79], a[92:95]
    v_mfma_f32_16x16x32_bf16 a[96:99], v[92:95], v[48:51], a[96:99]
    buffer_load_dwordx4 v140, s[8:11], s15 offen offset:3072 lds
    v_mfma_f32_16x16x32_bf16 a[100:103], v[92:95], v[52:55], a[100:103]
    v_mfma_f32_16x16x32_bf16 a[104:107], v[92:95], v[56:59], a[104:107]
    v_mfma_f32_16x16x32_bf16 a[108:111], v[92:95], v[60:63], a[108:111]
    s_add_u32 s15, s15, s17
    v_mfma_f32_16x16x32_bf16 a[112:115], v[92:95], v[64:67], a[112:115]
    v_mfma_f32_16x16x32_bf16 a[116:119], v[92:95], v[68:71], a[116:119]
    v_mfma_f32_16x16x32_bf16 a[120:123], v[92:95], v[72:75], a[120:123]
    v_mfma_f32_16x16x32_bf16 a[124:127], v[92:95], v[76:79], a[124:127]
    s_waitcnt lgkmcnt(0)
    v_mfma_f32_16x16x32_bf16 a[0:3], v[32:35], v[0:3], a[0:3]
    s_waitcnt vmcnt(12)
    s_barrier
    ds_read_b128 v[80:83], v136 offset:24576
    s_add_u32 m0, s20, 16384
    s_nop 0
    v_mfma_f32_16x16x32_bf16 a[4:7], v[32:35], v[4:7], a[4:7]
    ds_read_b64_tr_b16 v[48:49], v128 offset:49152
    v_mfma_f32_16x16x32_bf16 a[8:11], v[32:35], v[8:11], a[8:11]
    ds_read_b64_tr_b16 v[50:51], v128 offset:57344
    v_mfma_f32_16x16x32_bf16 a[12:15], v[32:35], v[12:15], a[12:15]
    ds_read_b64_tr_b16 v[52:53], v129 offset:49152
    buffer_load_dwordx4 v141, s[4:7], s16 offen offset:0 sc1 lds
    v_mfma_f32_16x16x32_bf16 a[16:19], v[32:35], v[16:19], a[16:19]
    ds_read_b64_tr_b16 v[54:55], v129 offset:57344
    v_mfma_f32_16x16x32_bf16 a[20:23], v[32:35], v[20:23], a[20:23]
    ds_read_b64_tr_b16 v[56:57], v130 offset:49152
    v_mfma_f32_16x16x32_bf16 a[24:27], v[32:35], v[24:27], a[24:27]
    ds_read_b64_tr_b16 v[58:59], v130 offset:57344
    buffer_load_dwordx4 v142, s[4:7], s16 offen offset:1024 sc1 lds
    v_mfma_f32_16x16x32_bf16 a[28:31], v[32:35], v[28:31], a[28:31]
    ds_read_b64_tr_b16 v[60:61], v131 offset:49152
    v_mfma_f32_16x16x32_bf16 a[32:35], v[36:39], v[0:3], a[32:35]
    ds_read_b64_tr_b16 v[62:63], v131 offset:57344
    v_mfma_f32_16x16x32_bf16 a[36:39], v[36:39], v[4:7], a[36:39]
    ds_read_b64_tr_b16 v[64:65], v132 offset:49152
    s_add_u32 s16, s16, 1024
    v_mfma_f32_16x16x32_bf16 a[40:43], v[36:39], v[8:11], a[40:43]
    ds_read_b64_tr_b16 v[66:67], v132 offset:57344
    v_mfma_f32_16x16x32_bf16 a[44:47], v[36:39], v[12:15], a[44:47]
    ds_read_b64_tr_b16 v[68:69], v133 offset:49152
    v_mfma_f32_16x16x32_bf16 a[48:51], v[36:39], v[16:19], a[48:51]
    ds_read_b64_tr_b16 v[70:71], v133 offset:57344
    s_add_u32 m0, s19, 32768
    s_nop 0
    v_mfma_f32_16x16x32_bf16 a[52:55], v[36:39], v[20:23], a[52:55]
    ds_read_b64_tr_b16 v[72:73], v134 offset:49152
    v_mfma_f32_16x16x32_bf16 a[56:59], v[36:39], v[24:27], a[56:59]
    ds_read_b64_tr_b16 v[74:75], v134 offset:57344
    v_mfma_f32_16x16x32_bf16 a[60:63], v[36:39], v[28:31], a[60:63]
    ds_read_b64_tr_b16 v[76:77], v135 offset:49152
    buffer_load_dwordx4 v137, s[8:11], s15 offen offset:0 lds
    v_mfma_f32_16x16x32_bf16 a[64:67], v[40:43], v[0:3], a[64:67]
    ds_read_b64_tr_b16 v[78:79], v135 offset:57344
    v_mfma_f32_16x16x32_bf16 a[68:71], v[40:43], v[4:7], a[68:71]
    ds_read_b128 v[84:87], v136 offset:25600
    v_mfma_f32_16x16x32_bf16 a[72:75], v[40:43], v[8:11], a[72:75]
    ds_read_b128 v[88:91], v136 offset:26624
    buffer_load_dwordx4 v138, s[8:11], s15 offen offset:1024 lds
    v_mfma_f32_16x16x32_bf16 a[76:79], v[40:43], v[12:15], a[76:79]
    ds_read_b128 v[92:95], v136 offset:27648
    v_mfma_f32_16x16x32_bf16 a[80:83], v[40:43], v[16:19], a[80:83]
    v_mfma_f32_16x16x32_bf16 a[84:87], v[40:43], v[20:23], a[84:87]
    buffer_load_dwordx4 v139, s[8:11], s15 offen offset:2048 lds
    v_mfma_f32_16x16x32_bf16 a[88:91], v[40:43], v[24:27], a[88:91]
    v_mfma_f32_16x16x32_bf16 a[92:95], v[40:43], v[28:31], a[92:95]
    v_mfma_f32_16x16x32_bf16 a[96:99], v[44:47], v[0:3], a[96:99]
    buffer_load_dwordx4 v140, s[8:11], s15 offen offset:3072 lds
    v_mfma_f32_16x16x32_bf16 a[100:103], v[44:47], v[4:7], a[100:103]
    v_mfma_f32_16x16x32_bf16 a[104:107], v[44:47], v[8:11], a[104:107]
    v_mfma_f32_16x16x32_bf16 a[108:111], v[44:47], v[12:15], a[108:111]
    s_add_u32 s15, s15, s17
    v_mfma_f32_16x16x32_bf16 a[112:115], v[44:47], v[16:19], a[112:115]
    v_mfma_f32_16x16x32_bf16 a[116:119], v[44:47], v[20:23], a[116:119]
    v_mfma_f32_16x16x32_bf16 a[120:123], v[44:47], v[24:27], a[120:123]
    v_mfma_f32_16x16x32_bf16 a[124:127], v[44:47], v[28:31], a[124:127]
    s_waitcnt lgkmcnt(0)
    v_mfma_f32_16x16x32_bf16 a[0:3], v[80:83], v[48:51], a[0:3]
    s_waitcnt vmcnt(12)
    s_barrier
    ds_read_b128 v[32:35], v136 offset:0
    s_add_u32 m0, s20, 24576
    s_nop 0
    v_mfma_f32_16x16x32_bf16 a[4:7], v[80:83], v[52:55], a[4:7]
    ds_read_b64_tr_b16 v[0:1], v128 offset:0
    v_mfma_f32_16x16x32_bf16 a[8:11], v[80:83], v[56:59], a[8:11]
    ds_read_b64_tr_b16 v[2:3], v128 offset:8192
    v_mfma_f32_16x16x32_bf16 a[12:15], v[80:83], v[60:63], a[12:15]
    ds_read_b64_tr_b16 v[4:5], v129 offset:0
    buffer_load_dwordx4 v141, s[4:7], s16 offen offset:0 sc1 lds
    v_mfma_f32_16x16x32_bf16 a[16:19], v[80:83], v[64:67], a[16:19]
    ds_read_b64_tr_b16 v[6:7], v129 offset:8192
    v_mfma_f32_16x16x32_bf16 a[20:23], v[80:83], v[68:71], a[20:23]
    ds_read_b64_tr_b16 v[8:9], v130 offset:0
    v_mfma_f32_16x16x32_bf16 a[24:27], v[80:83], v[72:75], a[24:27]
    ds_read_b64_tr_b16 v[10:11], v130 offset:8192
    buffer_load_dwordx4 v142, s[4:7], s16 offen offset:1024 sc1 lds
    v_mfma_f32_16x16x32_bf16 a[28:31], v[80:83], v[76:79], a[28:31]
    ds_read_b64_tr_b16 v[12:13], v131 offset:0
    v_mfma_f32_16x16x32_bf16 a[32:35], v[84:87], v[48:51], a[32:35]
    ds_read_b64_tr_b16 v[14:15], v131 offset:8192
    v_mfma_f32_16x16x32_bf16 a[36:39], v[84:87], v[52:55], a[36:39]
    ds_read_b64_tr_b16 v[16:17], v132 offset:0
    s_add_u32 s16, s16, 1024
    v_mfma_f32_16x16x32_bf16 a[40:43], v[84:87], v[56:59], a[40:43]
    ds_read_b64_tr_b16 v[18:19], v132 offset:8192
    v_mfma_f32_16x16x32_bf16 a[44:47], v[84:87], v[60:63], a[44:47]
    ds_read_b64_tr_b16 v[20:21], v133 offset:0
    v_mfma_f32_16x16x32_bf16 a[48:51], v[84:87], v[64:67], a[48:51]
    ds_read_b64_tr_b16 v[22:23], v133 offset:8192
    s_add_u32 m0, s19, 49152
    s_nop 0
    v_mfma_f32_16x16x32_bf16 a[52:55], v[84:87], v[68:71], a[52:55]
    ds_read_b64_tr_b16 v[24:25], v134 offset:0
    v_mfma_f32_16x16x32_bf16 a[56:59], v[84:87], v[72:75], a[56:59]
    ds_read_b64_tr_b16 v[26:27], v134 offset:8192
    v_mfma_f32_16x16x32_bf16 a[60:63], v[84:87], v[76:79], a[60:63]
    ds_read_b64_tr_b16 v[28:29], v135 offset:0
    buffer_load_dwordx4 v137, s[8:11], s15 offen offset:0 lds
    v_mfma_f32_16x16x32_bf16 a[64:67], v[88:91], v[48:51], a[64:67]
    ds_read_b64_tr_b16 v[30:31], v135 offset:8192
    v_mfma_f32_16x16x32_bf16 a[68:71], v[88:91], v[52:55], a[68:71]
    ds_read_b128 v[36:39], v136 offset:1024
    v_mfma_f32_16x16x32_bf16 a[72:75], v[88:91], v[56:59], a[72:75]
    ds_read_b128 v[40:43], v136 offset:2048
    buffer_load_dwordx4 v138, s[8:11], s15 offen offset:1024 lds
    v_mfma_f32_16x16x32_bf16 a[76:79], v[88:91], v[60:63], a[76:79]
    ds_read_b128 v[44:47], v136 offset:3072
    v_mfma_f32_16x16x32_bf16 a[80:83], v[88:91], v[64:67], a[80:83]
    v_mfma_f32_16x16x32_bf16 a[84:87], v[88:91], v[68:71], a[84:87]
    buffer_load_dwordx4 v139, s[8:11], s15 offen offset:2048 lds
    v_mfma_f32_16x16x32_bf16 a[88:91], v[88:91], v[72:75], a[88:91]
    v_mfma_f32_16x16x32_bf16 a[92:95], v[88:91], v[76:79], a[92:95]
    v_mfma_f32_16x16x32_bf16 a[96:99], v[92:95], v[48:51], a[96:99]
    buffer_load_dwordx4 v140, s[8:11], s15 offen offset:3072 lds
    v_mfma_f32_16x16x32_bf16 a[100:103], v[92:95], v[52:55], a[100:103]
    v_mfma_f32_16x16x32_bf16 a[104:107], v[92:95], v[56:59], a[104:107]
    v_mfma_f32_16x16x32_bf16 a[108:111], v[92:95], v[60:63], a[108:111]
    s_add_u32 s15, s15, s17
    v_mfma_f32_16x16x32_bf16 a[112:115], v[92:95], v[64:67], a[112:115]
    v_mfma_f32_16x16x32_bf16 a[116:119], v[92:95], v[68:71], a[116:119]
    v_mfma_f32_16x16x32_bf16 a[120:123], v[92:95], v[72:75], a[120:123]
    v_mfma_f32_16x16x32_bf16 a[124:127], v[92:95], v[76:79], a[124:127]
    s_sub_u32 s18, s18, 1
    s_cmp_lg_u32 s18, 0
    s_cbranch_scc1 main_kernel_w_c1_v_loop
    s_cmp_lg_u32 s14, 0
    s_cbranch_scc1 main_kernel_w_c1_v_nt
    s_lshl_b32 s32, s27, 8
    s_add_u32 s32, s32, 0x841e000
    v_mov_b32 v255, 1
    s_mov_b64 exec, 1
    buffer_atomic_add v255, off, s[4:7], s32 sc0 sc1
    s_mov_b64 exec, -1
main_kernel_w_c1_v_nt:
    s_waitcnt lgkmcnt(0)
    v_mfma_f32_16x16x32_bf16 a[0:3], v[32:35], v[0:3], a[0:3]
    s_waitcnt vmcnt(12)
    s_barrier
    ds_read_b128 v[80:83], v136 offset:8192
    v_mfma_f32_16x16x32_bf16 a[4:7], v[32:35], v[4:7], a[4:7]
    ds_read_b64_tr_b16 v[48:49], v128 offset:16384
    v_mfma_f32_16x16x32_bf16 a[8:11], v[32:35], v[8:11], a[8:11]
    ds_read_b64_tr_b16 v[50:51], v128 offset:24576
    v_mfma_f32_16x16x32_bf16 a[12:15], v[32:35], v[12:15], a[12:15]
    ds_read_b64_tr_b16 v[52:53], v129 offset:16384
    v_mfma_f32_16x16x32_bf16 a[16:19], v[32:35], v[16:19], a[16:19]
    ds_read_b64_tr_b16 v[54:55], v129 offset:24576
    v_mfma_f32_16x16x32_bf16 a[20:23], v[32:35], v[20:23], a[20:23]
    ds_read_b64_tr_b16 v[56:57], v130 offset:16384
    v_mfma_f32_16x16x32_bf16 a[24:27], v[32:35], v[24:27], a[24:27]
    ds_read_b64_tr_b16 v[58:59], v130 offset:24576
    v_mfma_f32_16x16x32_bf16 a[28:31], v[32:35], v[28:31], a[28:31]
    ds_read_b64_tr_b16 v[60:61], v131 offset:16384
    v_mfma_f32_16x16x32_bf16 a[32:35], v[36:39], v[0:3], a[32:35]
    ds_read_b64_tr_b16 v[62:63], v131 offset:24576
    v_mfma_f32_16x16x32_bf16 a[36:39], v[36:39], v[4:7], a[36:39]
    ds_read_b64_tr_b16 v[64:65], v132 offset:16384
    v_mfma_f32_16x16x32_bf16 a[40:43], v[36:39], v[8:11], a[40:43]
    ds_read_b64_tr_b16 v[66:67], v132 offset:24576
    v_mfma_f32_16x16x32_bf16 a[44:47], v[36:39], v[12:15], a[44:47]
    ds_read_b64_tr_b16 v[68:69], v133 offset:16384
    v_mfma_f32_16x16x32_bf16 a[48:51], v[36:39], v[16:19], a[48:51]
    ds_read_b64_tr_b16 v[70:71], v133 offset:24576
    v_mfma_f32_16x16x32_bf16 a[52:55], v[36:39], v[20:23], a[52:55]
    ds_read_b64_tr_b16 v[72:73], v134 offset:16384
    v_mfma_f32_16x16x32_bf16 a[56:59], v[36:39], v[24:27], a[56:59]
    ds_read_b64_tr_b16 v[74:75], v134 offset:24576
    v_mfma_f32_16x16x32_bf16 a[60:63], v[36:39], v[28:31], a[60:63]
    ds_read_b64_tr_b16 v[76:77], v135 offset:16384
    v_mfma_f32_16x16x32_bf16 a[64:67], v[40:43], v[0:3], a[64:67]
    ds_read_b64_tr_b16 v[78:79], v135 offset:24576
    v_mfma_f32_16x16x32_bf16 a[68:71], v[40:43], v[4:7], a[68:71]
    ds_read_b128 v[84:87], v136 offset:9216
    v_mfma_f32_16x16x32_bf16 a[72:75], v[40:43], v[8:11], a[72:75]
    ds_read_b128 v[88:91], v136 offset:10240
    v_mfma_f32_16x16x32_bf16 a[76:79], v[40:43], v[12:15], a[76:79]
    ds_read_b128 v[92:95], v136 offset:11264
    v_mfma_f32_16x16x32_bf16 a[80:83], v[40:43], v[16:19], a[80:83]
    v_mfma_f32_16x16x32_bf16 a[84:87], v[40:43], v[20:23], a[84:87]
    v_mfma_f32_16x16x32_bf16 a[88:91], v[40:43], v[24:27], a[88:91]
    v_mfma_f32_16x16x32_bf16 a[92:95], v[40:43], v[28:31], a[92:95]
    v_mfma_f32_16x16x32_bf16 a[96:99], v[44:47], v[0:3], a[96:99]
    v_mfma_f32_16x16x32_bf16 a[100:103], v[44:47], v[4:7], a[100:103]
    v_mfma_f32_16x16x32_bf16 a[104:107], v[44:47], v[8:11], a[104:107]
    v_mfma_f32_16x16x32_bf16 a[108:111], v[44:47], v[12:15], a[108:111]
    v_mfma_f32_16x16x32_bf16 a[112:115], v[44:47], v[16:19], a[112:115]
    v_mfma_f32_16x16x32_bf16 a[116:119], v[44:47], v[20:23], a[116:119]
    v_mfma_f32_16x16x32_bf16 a[120:123], v[44:47], v[24:27], a[120:123]
    v_mfma_f32_16x16x32_bf16 a[124:127], v[44:47], v[28:31], a[124:127]
    s_waitcnt lgkmcnt(0)
    v_mfma_f32_16x16x32_bf16 a[0:3], v[80:83], v[48:51], a[0:3]
    s_waitcnt vmcnt(6)
    s_barrier
    ds_read_b128 v[32:35], v136 offset:16384
    v_mfma_f32_16x16x32_bf16 a[4:7], v[80:83], v[52:55], a[4:7]
    ds_read_b64_tr_b16 v[0:1], v128 offset:32768
    v_mfma_f32_16x16x32_bf16 a[8:11], v[80:83], v[56:59], a[8:11]
    ds_read_b64_tr_b16 v[2:3], v128 offset:40960
    v_mfma_f32_16x16x32_bf16 a[12:15], v[80:83], v[60:63], a[12:15]
    ds_read_b64_tr_b16 v[4:5], v129 offset:32768
    v_mfma_f32_16x16x32_bf16 a[16:19], v[80:83], v[64:67], a[16:19]
    ds_read_b64_tr_b16 v[6:7], v129 offset:40960
    v_mfma_f32_16x16x32_bf16 a[20:23], v[80:83], v[68:71], a[20:23]
    ds_read_b64_tr_b16 v[8:9], v130 offset:32768
    v_mfma_f32_16x16x32_bf16 a[24:27], v[80:83], v[72:75], a[24:27]
    ds_read_b64_tr_b16 v[10:11], v130 offset:40960
    v_mfma_f32_16x16x32_bf16 a[28:31], v[80:83], v[76:79], a[28:31]
    ds_read_b64_tr_b16 v[12:13], v131 offset:32768
    v_mfma_f32_16x16x32_bf16 a[32:35], v[84:87], v[48:51], a[32:35]
    ds_read_b64_tr_b16 v[14:15], v131 offset:40960
    v_mfma_f32_16x16x32_bf16 a[36:39], v[84:87], v[52:55], a[36:39]
    ds_read_b64_tr_b16 v[16:17], v132 offset:32768
    v_mfma_f32_16x16x32_bf16 a[40:43], v[84:87], v[56:59], a[40:43]
    ds_read_b64_tr_b16 v[18:19], v132 offset:40960
    v_mfma_f32_16x16x32_bf16 a[44:47], v[84:87], v[60:63], a[44:47]
    ds_read_b64_tr_b16 v[20:21], v133 offset:32768
    v_mfma_f32_16x16x32_bf16 a[48:51], v[84:87], v[64:67], a[48:51]
    ds_read_b64_tr_b16 v[22:23], v133 offset:40960
    v_mfma_f32_16x16x32_bf16 a[52:55], v[84:87], v[68:71], a[52:55]
    ds_read_b64_tr_b16 v[24:25], v134 offset:32768
    v_mfma_f32_16x16x32_bf16 a[56:59], v[84:87], v[72:75], a[56:59]
    ds_read_b64_tr_b16 v[26:27], v134 offset:40960
    v_mfma_f32_16x16x32_bf16 a[60:63], v[84:87], v[76:79], a[60:63]
    ds_read_b64_tr_b16 v[28:29], v135 offset:32768
    v_mfma_f32_16x16x32_bf16 a[64:67], v[88:91], v[48:51], a[64:67]
    ds_read_b64_tr_b16 v[30:31], v135 offset:40960
    v_mfma_f32_16x16x32_bf16 a[68:71], v[88:91], v[52:55], a[68:71]
    ds_read_b128 v[36:39], v136 offset:17408
    v_mfma_f32_16x16x32_bf16 a[72:75], v[88:91], v[56:59], a[72:75]
    ds_read_b128 v[40:43], v136 offset:18432
    v_mfma_f32_16x16x32_bf16 a[76:79], v[88:91], v[60:63], a[76:79]
    ds_read_b128 v[44:47], v136 offset:19456
    v_mfma_f32_16x16x32_bf16 a[80:83], v[88:91], v[64:67], a[80:83]
    v_mfma_f32_16x16x32_bf16 a[84:87], v[88:91], v[68:71], a[84:87]
    v_mfma_f32_16x16x32_bf16 a[88:91], v[88:91], v[72:75], a[88:91]
    v_mfma_f32_16x16x32_bf16 a[92:95], v[88:91], v[76:79], a[92:95]
    v_mfma_f32_16x16x32_bf16 a[96:99], v[92:95], v[48:51], a[96:99]
    v_mfma_f32_16x16x32_bf16 a[100:103], v[92:95], v[52:55], a[100:103]
    v_mfma_f32_16x16x32_bf16 a[104:107], v[92:95], v[56:59], a[104:107]
    v_mfma_f32_16x16x32_bf16 a[108:111], v[92:95], v[60:63], a[108:111]
    v_mfma_f32_16x16x32_bf16 a[112:115], v[92:95], v[64:67], a[112:115]
    v_mfma_f32_16x16x32_bf16 a[116:119], v[92:95], v[68:71], a[116:119]
    v_mfma_f32_16x16x32_bf16 a[120:123], v[92:95], v[72:75], a[120:123]
    v_mfma_f32_16x16x32_bf16 a[124:127], v[92:95], v[76:79], a[124:127]
    s_waitcnt lgkmcnt(0)
    v_mfma_f32_16x16x32_bf16 a[0:3], v[32:35], v[0:3], a[0:3]
    s_waitcnt vmcnt(0)
    s_barrier
    ds_read_b128 v[80:83], v136 offset:24576
    v_mfma_f32_16x16x32_bf16 a[4:7], v[32:35], v[4:7], a[4:7]
    ds_read_b64_tr_b16 v[48:49], v128 offset:49152
    v_mfma_f32_16x16x32_bf16 a[8:11], v[32:35], v[8:11], a[8:11]
    ds_read_b64_tr_b16 v[50:51], v128 offset:57344
    v_mfma_f32_16x16x32_bf16 a[12:15], v[32:35], v[12:15], a[12:15]
    ds_read_b64_tr_b16 v[52:53], v129 offset:49152
    v_mfma_f32_16x16x32_bf16 a[16:19], v[32:35], v[16:19], a[16:19]
    ds_read_b64_tr_b16 v[54:55], v129 offset:57344
    v_mfma_f32_16x16x32_bf16 a[20:23], v[32:35], v[20:23], a[20:23]
    ds_read_b64_tr_b16 v[56:57], v130 offset:49152
    v_mfma_f32_16x16x32_bf16 a[24:27], v[32:35], v[24:27], a[24:27]
    ds_read_b64_tr_b16 v[58:59], v130 offset:57344
    v_mfma_f32_16x16x32_bf16 a[28:31], v[32:35], v[28:31], a[28:31]
    ds_read_b64_tr_b16 v[60:61], v131 offset:49152
    v_mfma_f32_16x16x32_bf16 a[32:35], v[36:39], v[0:3], a[32:35]
    ds_read_b64_tr_b16 v[62:63], v131 offset:57344
    v_mfma_f32_16x16x32_bf16 a[36:39], v[36:39], v[4:7], a[36:39]
    ds_read_b64_tr_b16 v[64:65], v132 offset:49152
    v_mfma_f32_16x16x32_bf16 a[40:43], v[36:39], v[8:11], a[40:43]
    ds_read_b64_tr_b16 v[66:67], v132 offset:57344
    v_mfma_f32_16x16x32_bf16 a[44:47], v[36:39], v[12:15], a[44:47]
    ds_read_b64_tr_b16 v[68:69], v133 offset:49152
    v_mfma_f32_16x16x32_bf16 a[48:51], v[36:39], v[16:19], a[48:51]
    ds_read_b64_tr_b16 v[70:71], v133 offset:57344
    v_mfma_f32_16x16x32_bf16 a[52:55], v[36:39], v[20:23], a[52:55]
    ds_read_b64_tr_b16 v[72:73], v134 offset:49152
    v_mfma_f32_16x16x32_bf16 a[56:59], v[36:39], v[24:27], a[56:59]
    ds_read_b64_tr_b16 v[74:75], v134 offset:57344
    v_mfma_f32_16x16x32_bf16 a[60:63], v[36:39], v[28:31], a[60:63]
    ds_read_b64_tr_b16 v[76:77], v135 offset:49152
    v_mfma_f32_16x16x32_bf16 a[64:67], v[40:43], v[0:3], a[64:67]
    ds_read_b64_tr_b16 v[78:79], v135 offset:57344
    v_mfma_f32_16x16x32_bf16 a[68:71], v[40:43], v[4:7], a[68:71]
    ds_read_b128 v[84:87], v136 offset:25600
    v_mfma_f32_16x16x32_bf16 a[72:75], v[40:43], v[8:11], a[72:75]
    ds_read_b128 v[88:91], v136 offset:26624
    v_mfma_f32_16x16x32_bf16 a[76:79], v[40:43], v[12:15], a[76:79]
    ds_read_b128 v[92:95], v136 offset:27648
    v_mfma_f32_16x16x32_bf16 a[80:83], v[40:43], v[16:19], a[80:83]
    v_mfma_f32_16x16x32_bf16 a[84:87], v[40:43], v[20:23], a[84:87]
    v_mfma_f32_16x16x32_bf16 a[88:91], v[40:43], v[24:27], a[88:91]
    v_mfma_f32_16x16x32_bf16 a[92:95], v[40:43], v[28:31], a[92:95]
    v_mfma_f32_16x16x32_bf16 a[96:99], v[44:47], v[0:3], a[96:99]
    v_mfma_f32_16x16x32_bf16 a[100:103], v[44:47], v[4:7], a[100:103]
    v_mfma_f32_16x16x32_bf16 a[104:107], v[44:47], v[8:11], a[104:107]
    v_mfma_f32_16x16x32_bf16 a[108:111], v[44:47], v[12:15], a[108:111]
    v_mfma_f32_16x16x32_bf16 a[112:115], v[44:47], v[16:19], a[112:115]
    v_mfma_f32_16x16x32_bf16 a[116:119], v[44:47], v[20:23], a[116:119]
    v_mfma_f32_16x16x32_bf16 a[120:123], v[44:47], v[24:27], a[120:123]
    v_mfma_f32_16x16x32_bf16 a[124:127], v[44:47], v[28:31], a[124:127]
    v_readfirstlane_b32 s55, v255
    s_waitcnt lgkmcnt(0)
    v_mfma_f32_16x16x32_bf16 a[0:3], v[80:83], v[48:51], a[0:3]
    v_mfma_f32_16x16x32_bf16 a[4:7], v[80:83], v[52:55], a[4:7]
    v_mfma_f32_16x16x32_bf16 a[8:11], v[80:83], v[56:59], a[8:11]
    v_mfma_f32_16x16x32_bf16 a[12:15], v[80:83], v[60:63], a[12:15]
    v_mfma_f32_16x16x32_bf16 a[16:19], v[80:83], v[64:67], a[16:19]
    v_mfma_f32_16x16x32_bf16 a[20:23], v[80:83], v[68:71], a[20:23]
    v_mfma_f32_16x16x32_bf16 a[24:27], v[80:83], v[72:75], a[24:27]
    v_mfma_f32_16x16x32_bf16 a[28:31], v[80:83], v[76:79], a[28:31]
    v_mfma_f32_16x16x32_bf16 a[32:35], v[84:87], v[48:51], a[32:35]
    v_mfma_f32_16x16x32_bf16 a[36:39], v[84:87], v[52:55], a[36:39]
    v_mfma_f32_16x16x32_bf16 a[40:43], v[84:87], v[56:59], a[40:43]
    v_mfma_f32_16x16x32_bf16 a[44:47], v[84:87], v[60:63], a[44:47]
    v_mfma_f32_16x16x32_bf16 a[48:51], v[84:87], v[64:67], a[48:51]
    v_mfma_f32_16x16x32_bf16 a[52:55], v[84:87], v[68:71], a[52:55]
    v_mfma_f32_16x16x32_bf16 a[56:59], v[84:87], v[72:75], a[56:59]
    v_mfma_f32_16x16x32_bf16 a[60:63], v[84:87], v[76:79], a[60:63]
    v_mfma_f32_16x16x32_bf16 a[64:67], v[88:91], v[48:51], a[64:67]
    v_mfma_f32_16x16x32_bf16 a[68:71], v[88:91], v[52:55], a[68:71]
    v_mfma_f32_16x16x32_bf16 a[72:75], v[88:91], v[56:59], a[72:75]
    v_mfma_f32_16x16x32_bf16 a[76:79], v[88:91], v[60:63], a[76:79]
    v_mfma_f32_16x16x32_bf16 a[80:83], v[88:91], v[64:67], a[80:83]
    v_mfma_f32_16x16x32_bf16 a[84:87], v[88:91], v[68:71], a[84:87]
    v_mfma_f32_16x16x32_bf16 a[88:91], v[88:91], v[72:75], a[88:91]
    v_mfma_f32_16x16x32_bf16 a[92:95], v[88:91], v[76:79], a[92:95]
    v_mfma_f32_16x16x32_bf16 a[96:99], v[92:95], v[48:51], a[96:99]
    v_mfma_f32_16x16x32_bf16 a[100:103], v[92:95], v[52:55], a[100:103]
    v_mfma_f32_16x16x32_bf16 a[104:107], v[92:95], v[56:59], a[104:107]
    v_mfma_f32_16x16x32_bf16 a[108:111], v[92:95], v[60:63], a[108:111]
    v_mfma_f32_16x16x32_bf16 a[112:115], v[92:95], v[64:67], a[112:115]
    v_mfma_f32_16x16x32_bf16 a[116:119], v[92:95], v[68:71], a[116:119]
    v_mfma_f32_16x16x32_bf16 a[120:123], v[92:95], v[72:75], a[120:123]
    v_mfma_f32_16x16x32_bf16 a[124:127], v[92:95], v[76:79], a[124:127]
    s_nop 7
    s_mov_b32 s53, s21
    v_accvgpr_read_b32 v0, a0
    v_accvgpr_read_b32 v1, a1
    v_accvgpr_read_b32 v2, a2
    v_accvgpr_read_b32 v3, a3
    v_accvgpr_read_b32 v4, a32
    v_accvgpr_read_b32 v5, a33
    v_accvgpr_read_b32 v6, a34
    v_accvgpr_read_b32 v7, a35
    v_cvt_pk_bf16_f32 v8, v0, v1
    v_cvt_pk_bf16_f32 v9, v2, v3
    v_cvt_pk_bf16_f32 v10, v4, v5
    v_cvt_pk_bf16_f32 v11, v6, v7
    buffer_store_dwordx4 v[8:11], v251, s[4:7], s53 offen offset:0 sc1
    v_accvgpr_read_b32 v16, a4
    v_accvgpr_read_b32 v17, a5
    v_accvgpr_read_b32 v18, a6
    v_accvgpr_read_b32 v19, a7
    v_accvgpr_read_b32 v20, a36
    v_accvgpr_read_b32 v21, a37
    v_accvgpr_read_b32 v22, a38
    v_accvgpr_read_b32 v23, a39
    v_cvt_pk_bf16_f32 v24, v16, v17
    v_cvt_pk_bf16_f32 v25, v18, v19
    v_cvt_pk_bf16_f32 v26, v20, v21
    v_cvt_pk_bf16_f32 v27, v22, v23
    buffer_store_dwordx4 v[24:27], v251, s[4:7], s53 offen offset:1024 sc1
    v_accvgpr_read_b32 v32, a8
    v_accvgpr_read_b32 v33, a9
    v_accvgpr_read_b32 v34, a10
    v_accvgpr_read_b32 v35, a11
    v_accvgpr_read_b32 v36, a40
    v_accvgpr_read_b32 v37, a41
    v_accvgpr_read_b32 v38, a42
    v_accvgpr_read_b32 v39, a43
    v_cvt_pk_bf16_f32 v40, v32, v33
    v_cvt_pk_bf16_f32 v41, v34, v35
    v_cvt_pk_bf16_f32 v42, v36, v37
    v_cvt_pk_bf16_f32 v43, v38, v39
    buffer_store_dwordx4 v[40:43], v251, s[4:7], s53 offen offset:2048 sc1
    v_accvgpr_read_b32 v48, a12
    v_accvgpr_read_b32 v49, a13
    v_accvgpr_read_b32 v50, a14
    v_accvgpr_read_b32 v51, a15
    v_accvgpr_read_b32 v52, a44
    v_accvgpr_read_b32 v53, a45
    v_accvgpr_read_b32 v54, a46
    v_accvgpr_read_b32 v55, a47
    v_cvt_pk_bf16_f32 v56, v48, v49
    v_cvt_pk_bf16_f32 v57, v50, v51
    v_cvt_pk_bf16_f32 v58, v52, v53
    v_cvt_pk_bf16_f32 v59, v54, v55
    buffer_store_dwordx4 v[56:59], v251, s[4:7], s53 offen offset:3072 sc1
    s_add_u32 s53, s53, 4096
    v_accvgpr_read_b32 v0, a16
    v_accvgpr_read_b32 v1, a17
    v_accvgpr_read_b32 v2, a18
    v_accvgpr_read_b32 v3, a19
    v_accvgpr_read_b32 v4, a48
    v_accvgpr_read_b32 v5, a49
    v_accvgpr_read_b32 v6, a50
    v_accvgpr_read_b32 v7, a51
    v_cvt_pk_bf16_f32 v8, v0, v1
    v_cvt_pk_bf16_f32 v9, v2, v3
    v_cvt_pk_bf16_f32 v10, v4, v5
    v_cvt_pk_bf16_f32 v11, v6, v7
    buffer_store_dwordx4 v[8:11], v251, s[4:7], s53 offen offset:0 sc1
    v_accvgpr_read_b32 v16, a20
    v_accvgpr_read_b32 v17, a21
    v_accvgpr_read_b32 v18, a22
    v_accvgpr_read_b32 v19, a23
    v_accvgpr_read_b32 v20, a52
    v_accvgpr_read_b32 v21, a53
    v_accvgpr_read_b32 v22, a54
    v_accvgpr_read_b32 v23, a55
    v_cvt_pk_bf16_f32 v24, v16, v17
    v_cvt_pk_bf16_f32 v25, v18, v19
    v_cvt_pk_bf16_f32 v26, v20, v21
    v_cvt_pk_bf16_f32 v27, v22, v23
    buffer_store_dwordx4 v[24:27], v251, s[4:7], s53 offen offset:1024 sc1
    v_accvgpr_read_b32 v32, a24
    v_accvgpr_read_b32 v33, a25
    v_accvgpr_read_b32 v34, a26
    v_accvgpr_read_b32 v35, a27
    v_accvgpr_read_b32 v36, a56
    v_accvgpr_read_b32 v37, a57
    v_accvgpr_read_b32 v38, a58
    v_accvgpr_read_b32 v39, a59
    v_cvt_pk_bf16_f32 v40, v32, v33
    v_cvt_pk_bf16_f32 v41, v34, v35
    v_cvt_pk_bf16_f32 v42, v36, v37
    v_cvt_pk_bf16_f32 v43, v38, v39
    buffer_store_dwordx4 v[40:43], v251, s[4:7], s53 offen offset:2048 sc1
    v_accvgpr_read_b32 v48, a28
    v_accvgpr_read_b32 v49, a29
    v_accvgpr_read_b32 v50, a30
    v_accvgpr_read_b32 v51, a31
    v_accvgpr_read_b32 v52, a60
    v_accvgpr_read_b32 v53, a61
    v_accvgpr_read_b32 v54, a62
    v_accvgpr_read_b32 v55, a63
    v_cvt_pk_bf16_f32 v56, v48, v49
    v_cvt_pk_bf16_f32 v57, v50, v51
    v_cvt_pk_bf16_f32 v58, v52, v53
    v_cvt_pk_bf16_f32 v59, v54, v55
    buffer_store_dwordx4 v[56:59], v251, s[4:7], s53 offen offset:3072 sc1
    s_add_u32 s53, s53, 258048
    v_accvgpr_read_b32 v0, a64
    v_accvgpr_read_b32 v1, a65
    v_accvgpr_read_b32 v2, a66
    v_accvgpr_read_b32 v3, a67
    v_accvgpr_read_b32 v4, a96
    v_accvgpr_read_b32 v5, a97
    v_accvgpr_read_b32 v6, a98
    v_accvgpr_read_b32 v7, a99
    v_cvt_pk_bf16_f32 v8, v0, v1
    v_cvt_pk_bf16_f32 v9, v2, v3
    v_cvt_pk_bf16_f32 v10, v4, v5
    v_cvt_pk_bf16_f32 v11, v6, v7
    buffer_store_dwordx4 v[8:11], v251, s[4:7], s53 offen offset:0 sc1
    v_accvgpr_read_b32 v16, a68
    v_accvgpr_read_b32 v17, a69
    v_accvgpr_read_b32 v18, a70
    v_accvgpr_read_b32 v19, a71
    v_accvgpr_read_b32 v20, a100
    v_accvgpr_read_b32 v21, a101
    v_accvgpr_read_b32 v22, a102
    v_accvgpr_read_b32 v23, a103
    v_cvt_pk_bf16_f32 v24, v16, v17
    v_cvt_pk_bf16_f32 v25, v18, v19
    v_cvt_pk_bf16_f32 v26, v20, v21
    v_cvt_pk_bf16_f32 v27, v22, v23
    buffer_store_dwordx4 v[24:27], v251, s[4:7], s53 offen offset:1024 sc1
    v_accvgpr_read_b32 v32, a72
    v_accvgpr_read_b32 v33, a73
    v_accvgpr_read_b32 v34, a74
    v_accvgpr_read_b32 v35, a75
    v_accvgpr_read_b32 v36, a104
    v_accvgpr_read_b32 v37, a105
    v_accvgpr_read_b32 v38, a106
    v_accvgpr_read_b32 v39, a107
    v_cvt_pk_bf16_f32 v40, v32, v33
    v_cvt_pk_bf16_f32 v41, v34, v35
    v_cvt_pk_bf16_f32 v42, v36, v37
    v_cvt_pk_bf16_f32 v43, v38, v39
    buffer_store_dwordx4 v[40:43], v251, s[4:7], s53 offen offset:2048 sc1
    v_accvgpr_read_b32 v48, a76
    v_accvgpr_read_b32 v49, a77
    v_accvgpr_read_b32 v50, a78
    v_accvgpr_read_b32 v51, a79
    v_accvgpr_read_b32 v52, a108
    v_accvgpr_read_b32 v53, a109
    v_accvgpr_read_b32 v54, a110
    v_accvgpr_read_b32 v55, a111
    v_cvt_pk_bf16_f32 v56, v48, v49
    v_cvt_pk_bf16_f32 v57, v50, v51
    v_cvt_pk_bf16_f32 v58, v52, v53
    v_cvt_pk_bf16_f32 v59, v54, v55
    buffer_store_dwordx4 v[56:59], v251, s[4:7], s53 offen offset:3072 sc1
    s_add_u32 s53, s53, 4096
    v_accvgpr_read_b32 v0, a80
    v_accvgpr_read_b32 v1, a81
    v_accvgpr_read_b32 v2, a82
    v_accvgpr_read_b32 v3, a83
    v_accvgpr_read_b32 v4, a112
    v_accvgpr_read_b32 v5, a113
    v_accvgpr_read_b32 v6, a114
    v_accvgpr_read_b32 v7, a115
    v_cvt_pk_bf16_f32 v8, v0, v1
    v_cvt_pk_bf16_f32 v9, v2, v3
    v_cvt_pk_bf16_f32 v10, v4, v5
    v_cvt_pk_bf16_f32 v11, v6, v7
    buffer_store_dwordx4 v[8:11], v251, s[4:7], s53 offen offset:0 sc1
    v_accvgpr_read_b32 v16, a84
    v_accvgpr_read_b32 v17, a85
    v_accvgpr_read_b32 v18, a86
    v_accvgpr_read_b32 v19, a87
    v_accvgpr_read_b32 v20, a116
    v_accvgpr_read_b32 v21, a117
    v_accvgpr_read_b32 v22, a118
    v_accvgpr_read_b32 v23, a119
    v_cvt_pk_bf16_f32 v24, v16, v17
    v_cvt_pk_bf16_f32 v25, v18, v19
    v_cvt_pk_bf16_f32 v26, v20, v21
    v_cvt_pk_bf16_f32 v27, v22, v23
    buffer_store_dwordx4 v[24:27], v251, s[4:7], s53 offen offset:1024 sc1
    v_accvgpr_read_b32 v32, a88
    v_accvgpr_read_b32 v33, a89
    v_accvgpr_read_b32 v34, a90
    v_accvgpr_read_b32 v35, a91
    v_accvgpr_read_b32 v36, a120
    v_accvgpr_read_b32 v37, a121
    v_accvgpr_read_b32 v38, a122
    v_accvgpr_read_b32 v39, a123
    v_cvt_pk_bf16_f32 v40, v32, v33
    v_cvt_pk_bf16_f32 v41, v34, v35
    v_cvt_pk_bf16_f32 v42, v36, v37
    v_cvt_pk_bf16_f32 v43, v38, v39
    buffer_store_dwordx4 v[40:43], v251, s[4:7], s53 offen offset:2048 sc1
    v_accvgpr_read_b32 v48, a92
    v_accvgpr_read_b32 v49, a93
    v_accvgpr_read_b32 v50, a94
    v_accvgpr_read_b32 v51, a95
    v_accvgpr_read_b32 v52, a124
    v_accvgpr_read_b32 v53, a125
    v_accvgpr_read_b32 v54, a126
    v_accvgpr_read_b32 v55, a127
    v_cvt_pk_bf16_f32 v56, v48, v49
    v_cvt_pk_bf16_f32 v57, v50, v51
    v_cvt_pk_bf16_f32 v58, v52, v53
    v_cvt_pk_bf16_f32 v59, v54, v55
    buffer_store_dwordx4 v[56:59], v251, s[4:7], s53 offen offset:3072 sc1
    s_add_u32 s53, s53, 258048
    s_branch main_kernel_w_done
main_kernel_w_c2_task:
    s_cmp_eq_u32 s23, 0
    s_cbranch_scc1 main_kernel_w_c2_set0
    s_cmp_eq_u32 s23, 1
    s_cbranch_scc1 main_kernel_w_c2_set1
    s_cmp_eq_u32 s23, 2
    s_cbranch_scc1 main_kernel_w_c2_set2
    s_cmp_eq_u32 s23, 6
    s_cbranch_scc1 main_kernel_w_c2_set6
    s_branch main_kernel_w_done
main_kernel_w_c2_set0:
    s_lshl_b32 s32, s25, 8
    s_add_u32 s8, s40, s32
    s_addc_u32 s9, s41, 0
    s_and_b32 s9, s9, 0xffff
    s_sub_u32 s10, 0x800000, s32
    s_mov_b32 s11, 0x20000
    s_mov_b32 s30, 8192
    s_mov_b32 s31, 32768
    s_mul_i32 s16, s24, 262144
    s_add_u32 s16, s16, 0x0
    s_mov_b32 s18, 7
    s_lshl_b32 s32, s24, 3
    s_mul_i32 s33, s38, 8
    s_add_u32 s32, s32, s33
    s_mul_i32 s32, s32, 131072
    s_lshl_b32 s33, s25, 12
    s_add_u32 s32, s32, s33
    s_mul_i32 s33, s37, 4096
    s_add_u32 s32, s32, s33
    s_add_u32 s21, s32, 0x800000
    s_mov_b32 s22, 131072
    s_mov_b32 s26, -1
    s_branch main_kernel_w_c2_go
main_kernel_w_c2_set1:
    s_lshl_b32 s32, s25, 8
    s_add_u32 s8, s42, s32
    s_addc_u32 s9, s43, 0
    s_and_b32 s9, s9, 0xffff
    s_sub_u32 s10, 0x800000, s32
    s_mov_b32 s11, 0x20000
    s_mov_b32 s30, 8192
    s_mov_b32 s31, 32768
    s_mul_i32 s16, s24, 262144
    s_add_u32 s16, s16, 0x0
    s_mov_b32 s18, 7
    s_lshl_b32 s32, s24, 3
    s_mul_i32 s33, s38, 8
    s_add_u32 s32, s32, s33
    s_mul_i32 s32, s32, 131072
    s_lshl_b32 s33, s25, 12
    s_add_u32 s32, s32, s33
    s_mul_i32 s33, s37, 4096
    s_add_u32 s32, s32, s33
    s_add_u32 s21, s32, 0x1800000
    s_mov_b32 s22, 131072
    s_mov_b32 s26, -1
    s_branch main_kernel_w_c2_go
main_kernel_w_c2_set2:
    s_lshl_b32 s32, s25, 8
    s_add_u32 s8, s44, s32
    s_addc_u32 s9, s45, 0
    s_and_b32 s9, s9, 0xffff
    s_sub_u32 s10, 0x800000, s32
    s_mov_b32 s11, 0x20000
    s_mov_b32 s30, 8192
    s_mov_b32 s31, 32768
    s_mul_i32 s16, s24, 262144
    s_add_u32 s16, s16, 0x0
    s_mov_b32 s18, 7
    s_lshl_b32 s32, s24, 2
    s_mul_i32 s33, s38, 4
    s_add_u32 s32, s32, s33
    s_lshl_b32 s32, s32, 18
    s_lshl_b32 s33, s25, 13
    s_add_u32 s32, s32, s33
    s_mul_i32 s33, s37, 8192
    s_add_u32 s32, s32, s33
    s_add_u32 s21, s32, 0x2800000
    s_branch main_kernel_w_c2_gov
main_kernel_w_c2_set6:
    s_lshl_b32 s32, s25, 8
    s_add_u32 s8, s68, s32
    s_addc_u32 s9, s69, 0
    s_and_b32 s9, s9, 0xffff
    s_sub_u32 s10, 0x700000, s32
    s_mov_b32 s11, 0x20000
    s_mov_b32 s30, 7168
    s_mov_b32 s31, 32768
    s_mul_i32 s16, s24, 262144
    s_add_u32 s16, s16, 0x6800000
    s_mov_b32 s18, 7
    s_lshl_b32 s32, s24, 3
    s_mul_i32 s33, s38, 8
    s_add_u32 s32, s32, s33
    s_mul_i32 s32, s32, 114688
    s_lshl_b32 s33, s25, 12
    s_add_u32 s32, s32, s33
    s_mul_i32 s33, s37, 4096
    s_add_u32 s32, s32, s33
    s_add_u32 s21, s32, 0x5400000
    s_mov_b32 s22, 114688
    s_mov_b32 s26, -1
    s_branch main_kernel_w_c2_go
main_kernel_w_c2_go:
    v_lshrrev_b32 v0, 4, v250
    v_bfe_u32 v1, v250, 2, 2
    v_lshl_add_u32 v4, v0, 2, v1
    v_and_b32 v5, 7, v4
    v_mul_u32_u24 v4, 512, v4
    v_and_b32 v6, 3, v250
    v_lshl_add_u32 v4, v6, 3, v4
    s_mul_i32 s32, s37, 8
    v_xor_b32 v5, s32, v5
    v_lshl_add_u32 v128, v5, 5, v4
    v_xor_b32 v129, 32, v128
    v_xor_b32 v130, 64, v128
    v_xor_b32 v131, 96, v128
    v_xor_b32 v132, 128, v128
    v_xor_b32 v133, 160, v128
    v_xor_b32 v134, 192, v128
    v_xor_b32 v135, 224, v128
    s_mul_i32 s32, s38, 8192
    s_add_u32 s32, s32, 65536
    v_add_u32 v136, s32, v251
    v_lshrrev_b32 v2, 5, v250
    v_and_b32 v3, 31, v250
    s_mul_i32 s32, s14, 8
    v_add_u32 v4, s32, v2
    v_add_u32 v5, 0, v4
    v_and_b32 v6, 7, v5
    v_lshlrev_b32 v6, 1, v6
    v_xor_b32 v6, v6, v3
    v_mul_lo_u32 v5, v5, s30
    v_lshl_add_u32 v5, v6, 4, v5
    v_subrev_u32 v137, 0, v5
    v_add_u32 v5, 2, v4
    v_and_b32 v6, 7, v5
    v_lshlrev_b32 v6, 1, v6
    v_xor_b32 v6, v6, v3
    v_mul_lo_u32 v5, v5, s30
    v_lshl_add_u32 v5, v6, 4, v5
    v_subrev_u32 v138, 1024, v5
    v_add_u32 v5, 4, v4
    v_and_b32 v6, 7, v5
    v_lshlrev_b32 v6, 1, v6
    v_xor_b32 v6, v6, v3
    v_mul_lo_u32 v5, v5, s30
    v_lshl_add_u32 v5, v6, 4, v5
    v_subrev_u32 v139, 2048, v5
    v_add_u32 v5, 6, v4
    v_and_b32 v6, 7, v5
    v_lshlrev_b32 v6, 1, v6
    v_xor_b32 v6, v6, v3
    v_mul_lo_u32 v5, v5, s30
    v_lshl_add_u32 v5, v6, 4, v5
    v_subrev_u32 v140, 3072, v5
    s_mul_i32 s32, s14, 4
    s_mul_i32 s32, s32, s31
    v_add_u32 v141, s32, v251
    s_add_u32 s32, s32, s31
    s_sub_u32 s32, s32, 1024
    v_add_u32 v142, s32, v251
    s_add_u32 s32, s32, s31
    s_sub_u32 s32, s32, 1024
    v_add_u32 v143, s32, v251
    s_add_u32 s32, s32, s31
    s_sub_u32 s32, s32, 1024
    v_add_u32 v144, s32, v251
    s_mul_i32 s19, s14, 4096
    s_mul_i32 s20, s14, 4096
    s_add_u32 s20, s20, 65536
    s_mul_i32 s17, s30, 32
    s_mov_b32 s15, 0
    s_add_u32 m0, s20, 0
    s_nop 0
    buffer_load_dwordx4 v141, s[4:7], s16 offen offset:0 sc1 lds
    buffer_load_dwordx4 v142, s[4:7], s16 offen offset:1024 sc1 lds
    buffer_load_dwordx4 v143, s[4:7], s16 offen offset:2048 sc1 lds
    buffer_load_dwordx4 v144, s[4:7], s16 offen offset:3072 sc1 lds
    s_add_u32 s16, s16, 1024
    s_add_u32 m0, s19, 0
    s_nop 0
    buffer_load_dwordx4 v137, s[8:11], s15 offen offset:0 lds
    buffer_load_dwordx4 v138, s[8:11], s15 offen offset:1024 lds
    buffer_load_dwordx4 v139, s[8:11], s15 offen offset:2048 lds
    buffer_load_dwordx4 v140, s[8:11], s15 offen offset:3072 lds
    s_add_u32 s15, s15, s17
    s_add_u32 m0, s20, 16384
    s_nop 0
    buffer_load_dwordx4 v141, s[4:7], s16 offen offset:0 sc1 lds
    buffer_load_dwordx4 v142, s[4:7], s16 offen offset:1024 sc1 lds
    buffer_load_dwordx4 v143, s[4:7], s16 offen offset:2048 sc1 lds
    buffer_load_dwordx4 v144, s[4:7], s16 offen offset:3072 sc1 lds
    s_add_u32 s16, s16, 1024
    s_add_u32 m0, s19, 16384
    s_nop 0
    buffer_load_dwordx4 v137, s[8:11], s15 offen offset:0 lds
    buffer_load_dwordx4 v138, s[8:11], s15 offen offset:1024 lds
    buffer_load_dwordx4 v139, s[8:11], s15 offen offset:2048 lds
    buffer_load_dwordx4 v140, s[8:11], s15 offen offset:3072 lds
    s_add_u32 s15, s15, s17
    s_add_u32 m0, s20, 32768
    s_nop 0
    buffer_load_dwordx4 v141, s[4:7], s16 offen offset:0 sc1 lds
    buffer_load_dwordx4 v142, s[4:7], s16 offen offset:1024 sc1 lds
    buffer_load_dwordx4 v143, s[4:7], s16 offen offset:2048 sc1 lds
    buffer_load_dwordx4 v144, s[4:7], s16 offen offset:3072 sc1 lds
    s_add_u32 s16, s16, 1024
    s_add_u32 m0, s19, 32768
    s_nop 0
    buffer_load_dwordx4 v137, s[8:11], s15 offen offset:0 lds
    buffer_load_dwordx4 v138, s[8:11], s15 offen offset:1024 lds
    buffer_load_dwordx4 v139, s[8:11], s15 offen offset:2048 lds
    buffer_load_dwordx4 v140, s[8:11], s15 offen offset:3072 lds
    s_add_u32 s15, s15, s17
    s_add_u32 m0, s20, 49152
    s_nop 0
    buffer_load_dwordx4 v141, s[4:7], s16 offen offset:0 sc1 lds
    buffer_load_dwordx4 v142, s[4:7], s16 offen offset:1024 sc1 lds
    buffer_load_dwordx4 v143, s[4:7], s16 offen offset:2048 sc1 lds
    buffer_load_dwordx4 v144, s[4:7], s16 offen offset:3072 sc1 lds
    s_add_u32 s16, s16, 1024
    s_add_u32 m0, s19, 49152
    s_nop 0
    buffer_load_dwordx4 v137, s[8:11], s15 offen offset:0 lds
    buffer_load_dwordx4 v138, s[8:11], s15 offen offset:1024 lds
    buffer_load_dwordx4 v139, s[8:11], s15 offen offset:2048 lds
    buffer_load_dwordx4 v140, s[8:11], s15 offen offset:3072 lds
    s_add_u32 s15, s15, s17
    v_accvgpr_write_b32 a0, 0
    v_accvgpr_write_b32 a1, 0
    v_accvgpr_write_b32 a2, 0
    v_accvgpr_write_b32 a3, 0
    v_accvgpr_write_b32 a4, 0
    v_accvgpr_write_b32 a5, 0
    v_accvgpr_write_b32 a6, 0
    v_accvgpr_write_b32 a7, 0
    v_accvgpr_write_b32 a8, 0
    v_accvgpr_write_b32 a9, 0
    v_accvgpr_write_b32 a10, 0
    v_accvgpr_write_b32 a11, 0
    v_accvgpr_write_b32 a12, 0
    v_accvgpr_write_b32 a13, 0
    v_accvgpr_write_b32 a14, 0
    v_accvgpr_write_b32 a15, 0
    v_accvgpr_write_b32 a16, 0
    v_accvgpr_write_b32 a17, 0
    v_accvgpr_write_b32 a18, 0
    v_accvgpr_write_b32 a19, 0
    v_accvgpr_write_b32 a20, 0
    v_accvgpr_write_b32 a21, 0
    v_accvgpr_write_b32 a22, 0
    v_accvgpr_write_b32 a23, 0
    v_accvgpr_write_b32 a24, 0
    v_accvgpr_write_b32 a25, 0
    v_accvgpr_write_b32 a26, 0
    v_accvgpr_write_b32 a27, 0
    v_accvgpr_write_b32 a28, 0
    v_accvgpr_write_b32 a29, 0
    v_accvgpr_write_b32 a30, 0
    v_accvgpr_write_b32 a31, 0
    v_accvgpr_write_b32 a32, 0
    v_accvgpr_write_b32 a33, 0
    v_accvgpr_write_b32 a34, 0
    v_accvgpr_write_b32 a35, 0
    v_accvgpr_write_b32 a36, 0
    v_accvgpr_write_b32 a37, 0
    v_accvgpr_write_b32 a38, 0
    v_accvgpr_write_b32 a39, 0
    v_accvgpr_write_b32 a40, 0
    v_accvgpr_write_b32 a41, 0
    v_accvgpr_write_b32 a42, 0
    v_accvgpr_write_b32 a43, 0
    v_accvgpr_write_b32 a44, 0
    v_accvgpr_write_b32 a45, 0
    v_accvgpr_write_b32 a46, 0
    v_accvgpr_write_b32 a47, 0
    v_accvgpr_write_b32 a48, 0
    v_accvgpr_write_b32 a49, 0
    v_accvgpr_write_b32 a50, 0
    v_accvgpr_write_b32 a51, 0
    v_accvgpr_write_b32 a52, 0
    v_accvgpr_write_b32 a53, 0
    v_accvgpr_write_b32 a54, 0
    v_accvgpr_write_b32 a55, 0
    v_accvgpr_write_b32 a56, 0
    v_accvgpr_write_b32 a57, 0
    v_accvgpr_write_b32 a58, 0
    v_accvgpr_write_b32 a59, 0
    v_accvgpr_write_b32 a60, 0
    v_accvgpr_write_b32 a61, 0
    v_accvgpr_write_b32 a62, 0
    v_accvgpr_write_b32 a63, 0
    v_accvgpr_write_b32 a64, 0
    v_accvgpr_write_b32 a65, 0
    v_accvgpr_write_b32 a66, 0
    v_accvgpr_write_b32 a67, 0
    v_accvgpr_write_b32 a68, 0
    v_accvgpr_write_b32 a69, 0
    v_accvgpr_write_b32 a70, 0
    v_accvgpr_write_b32 a71, 0
    v_accvgpr_write_b32 a72, 0
    v_accvgpr_write_b32 a73, 0
    v_accvgpr_write_b32 a74, 0
    v_accvgpr_write_b32 a75, 0
    v_accvgpr_write_b32 a76, 0
    v_accvgpr_write_b32 a77, 0
    v_accvgpr_write_b32 a78, 0
    v_accvgpr_write_b32 a79, 0
    v_accvgpr_write_b32 a80, 0
    v_accvgpr_write_b32 a81, 0
    v_accvgpr_write_b32 a82, 0
    v_accvgpr_write_b32 a83, 0
    v_accvgpr_write_b32 a84, 0
    v_accvgpr_write_b32 a85, 0
    v_accvgpr_write_b32 a86, 0
    v_accvgpr_write_b32 a87, 0
    v_accvgpr_write_b32 a88, 0
    v_accvgpr_write_b32 a89, 0
    v_accvgpr_write_b32 a90, 0
    v_accvgpr_write_b32 a91, 0
    v_accvgpr_write_b32 a92, 0
    v_accvgpr_write_b32 a93, 0
    v_accvgpr_write_b32 a94, 0
    v_accvgpr_write_b32 a95, 0
    v_accvgpr_write_b32 a96, 0
    v_accvgpr_write_b32 a97, 0
    v_accvgpr_write_b32 a98, 0
    v_accvgpr_write_b32 a99, 0
    v_accvgpr_write_b32 a100, 0
    v_accvgpr_write_b32 a101, 0
    v_accvgpr_write_b32 a102, 0
    v_accvgpr_write_b32 a103, 0
    v_accvgpr_write_b32 a104, 0
    v_accvgpr_write_b32 a105, 0
    v_accvgpr_write_b32 a106, 0
    v_accvgpr_write_b32 a107, 0
    v_accvgpr_write_b32 a108, 0
    v_accvgpr_write_b32 a109, 0
    v_accvgpr_write_b32 a110, 0
    v_accvgpr_write_b32 a111, 0
    v_accvgpr_write_b32 a112, 0
    v_accvgpr_write_b32 a113, 0
    v_accvgpr_write_b32 a114, 0
    v_accvgpr_write_b32 a115, 0
    v_accvgpr_write_b32 a116, 0
    v_accvgpr_write_b32 a117, 0
    v_accvgpr_write_b32 a118, 0
    v_accvgpr_write_b32 a119, 0
    v_accvgpr_write_b32 a120, 0
    v_accvgpr_write_b32 a121, 0
    v_accvgpr_write_b32 a122, 0
    v_accvgpr_write_b32 a123, 0
    v_accvgpr_write_b32 a124, 0
    v_accvgpr_write_b32 a125, 0
    v_accvgpr_write_b32 a126, 0
    v_accvgpr_write_b32 a127, 0
    v_accvgpr_write_b32 a128, 0
    v_accvgpr_write_b32 a129, 0
    v_accvgpr_write_b32 a130, 0
    v_accvgpr_write_b32 a131, 0
    v_accvgpr_write_b32 a132, 0
    v_accvgpr_write_b32 a133, 0
    v_accvgpr_write_b32 a134, 0
    v_accvgpr_write_b32 a135, 0
    v_accvgpr_write_b32 a136, 0
    v_accvgpr_write_b32 a137, 0
    v_accvgpr_write_b32 a138, 0
    v_accvgpr_write_b32 a139, 0
    v_accvgpr_write_b32 a140, 0
    v_accvgpr_write_b32 a141, 0
    v_accvgpr_write_b32 a142, 0
    v_accvgpr_write_b32 a143, 0
    v_accvgpr_write_b32 a144, 0
    v_accvgpr_write_b32 a145, 0
    v_accvgpr_write_b32 a146, 0
    v_accvgpr_write_b32 a147, 0
    v_accvgpr_write_b32 a148, 0
    v_accvgpr_write_b32 a149, 0
    v_accvgpr_write_b32 a150, 0
    v_accvgpr_write_b32 a151, 0
    v_accvgpr_write_b32 a152, 0
    v_accvgpr_write_b32 a153, 0
    v_accvgpr_write_b32 a154, 0
    v_accvgpr_write_b32 a155, 0
    v_accvgpr_write_b32 a156, 0
    v_accvgpr_write_b32 a157, 0
    v_accvgpr_write_b32 a158, 0
    v_accvgpr_write_b32 a159, 0
    v_accvgpr_write_b32 a160, 0
    v_accvgpr_write_b32 a161, 0
    v_accvgpr_write_b32 a162, 0
    v_accvgpr_write_b32 a163, 0
    v_accvgpr_write_b32 a164, 0
    v_accvgpr_write_b32 a165, 0
    v_accvgpr_write_b32 a166, 0
    v_accvgpr_write_b32 a167, 0
    v_accvgpr_write_b32 a168, 0
    v_accvgpr_write_b32 a169, 0
    v_accvgpr_write_b32 a170, 0
    v_accvgpr_write_b32 a171, 0
    v_accvgpr_write_b32 a172, 0
    v_accvgpr_write_b32 a173, 0
    v_accvgpr_write_b32 a174, 0
    v_accvgpr_write_b32 a175, 0
    v_accvgpr_write_b32 a176, 0
    v_accvgpr_write_b32 a177, 0
    v_accvgpr_write_b32 a178, 0
    v_accvgpr_write_b32 a179, 0
    v_accvgpr_write_b32 a180, 0
    v_accvgpr_write_b32 a181, 0
    v_accvgpr_write_b32 a182, 0
    v_accvgpr_write_b32 a183, 0
    v_accvgpr_write_b32 a184, 0
    v_accvgpr_write_b32 a185, 0
    v_accvgpr_write_b32 a186, 0
    v_accvgpr_write_b32 a187, 0
    v_accvgpr_write_b32 a188, 0
    v_accvgpr_write_b32 a189, 0
    v_accvgpr_write_b32 a190, 0
    v_accvgpr_write_b32 a191, 0
    v_accvgpr_write_b32 a192, 0
    v_accvgpr_write_b32 a193, 0
    v_accvgpr_write_b32 a194, 0
    v_accvgpr_write_b32 a195, 0
    v_accvgpr_write_b32 a196, 0
    v_accvgpr_write_b32 a197, 0
    v_accvgpr_write_b32 a198, 0
    v_accvgpr_write_b32 a199, 0
    v_accvgpr_write_b32 a200, 0
    v_accvgpr_write_b32 a201, 0
    v_accvgpr_write_b32 a202, 0
    v_accvgpr_write_b32 a203, 0
    v_accvgpr_write_b32 a204, 0
    v_accvgpr_write_b32 a205, 0
    v_accvgpr_write_b32 a206, 0
    v_accvgpr_write_b32 a207, 0
    v_accvgpr_write_b32 a208, 0
    v_accvgpr_write_b32 a209, 0
    v_accvgpr_write_b32 a210, 0
    v_accvgpr_write_b32 a211, 0
    v_accvgpr_write_b32 a212, 0
    v_accvgpr_write_b32 a213, 0
    v_accvgpr_write_b32 a214, 0
    v_accvgpr_write_b32 a215, 0
    v_accvgpr_write_b32 a216, 0
    v_accvgpr_write_b32 a217, 0
    v_accvgpr_write_b32 a218, 0
    v_accvgpr_write_b32 a219, 0
    v_accvgpr_write_b32 a220, 0
    v_accvgpr_write_b32 a221, 0
    v_accvgpr_write_b32 a222, 0
    v_accvgpr_write_b32 a223, 0
    v_accvgpr_write_b32 a224, 0
    v_accvgpr_write_b32 a225, 0
    v_accvgpr_write_b32 a226, 0
    v_accvgpr_write_b32 a227, 0
    v_accvgpr_write_b32 a228, 0
    v_accvgpr_write_b32 a229, 0
    v_accvgpr_write_b32 a230, 0
    v_accvgpr_write_b32 a231, 0
    v_accvgpr_write_b32 a232, 0
    v_accvgpr_write_b32 a233, 0
    v_accvgpr_write_b32 a234, 0
    v_accvgpr_write_b32 a235, 0
    v_accvgpr_write_b32 a236, 0
    v_accvgpr_write_b32 a237, 0
    v_accvgpr_write_b32 a238, 0
    v_accvgpr_write_b32 a239, 0
    v_accvgpr_write_b32 a240, 0
    v_accvgpr_write_b32 a241, 0
    v_accvgpr_write_b32 a242, 0
    v_accvgpr_write_b32 a243, 0
    v_accvgpr_write_b32 a244, 0
    v_accvgpr_write_b32 a245, 0
    v_accvgpr_write_b32 a246, 0
    v_accvgpr_write_b32 a247, 0
    v_accvgpr_write_b32 a248, 0
    v_accvgpr_write_b32 a249, 0
    v_accvgpr_write_b32 a250, 0
    v_accvgpr_write_b32 a251, 0
    v_accvgpr_write_b32 a252, 0
    v_accvgpr_write_b32 a253, 0
    v_accvgpr_write_b32 a254, 0
    v_accvgpr_write_b32 a255, 0
    s_waitcnt vmcnt(24)
    s_barrier
    ds_read_b128 v[32:35], v136 offset:0
    ds_read_b64_tr_b16 v[0:1], v128 offset:0
    ds_read_b64_tr_b16 v[2:3], v128 offset:8192
    ds_read_b64_tr_b16 v[4:5], v129 offset:0
    ds_read_b64_tr_b16 v[6:7], v129 offset:8192
    ds_read_b64_tr_b16 v[8:9], v130 offset:0
    ds_read_b64_tr_b16 v[10:11], v130 offset:8192
    ds_read_b64_tr_b16 v[12:13], v131 offset:0
    ds_read_b64_tr_b16 v[14:15], v131 offset:8192
    ds_read_b64_tr_b16 v[16:17], v132 offset:0
    ds_read_b64_tr_b16 v[18:19], v132 offset:8192
    ds_read_b64_tr_b16 v[20:21], v133 offset:0
    ds_read_b64_tr_b16 v[22:23], v133 offset:8192
    ds_read_b64_tr_b16 v[24:25], v134 offset:0
    ds_read_b64_tr_b16 v[26:27], v134 offset:8192
    ds_read_b64_tr_b16 v[28:29], v135 offset:0
    ds_read_b64_tr_b16 v[30:31], v135 offset:8192
    ds_read_b128 v[36:39], v136 offset:1024
    ds_read_b128 v[40:43], v136 offset:2048
    ds_read_b128 v[44:47], v136 offset:3072
    ds_read_b128 v[48:51], v136 offset:4096
    ds_read_b128 v[52:55], v136 offset:5120
    ds_read_b128 v[56:59], v136 offset:6144
    ds_read_b128 v[60:63], v136 offset:7168
main_kernel_w_c2_n_loop:
    s_waitcnt lgkmcnt(0)
    v_mfma_f32_16x16x32_bf16 a[0:3], v[0:3], v[32:35], a[0:3]
    s_waitcnt vmcnt(16)
    s_barrier
    ds_read_b128 v[96:99], v136 offset:16384
    s_add_u32 m0, s20, 0
    s_nop 0
    v_mfma_f32_16x16x32_bf16 a[4:7], v[4:7], v[32:35], a[4:7]
    ds_read_b64_tr_b16 v[64:65], v128 offset:16384
    v_mfma_f32_16x16x32_bf16 a[8:11], v[8:11], v[32:35], a[8:11]
    ds_read_b64_tr_b16 v[66:67], v128 offset:24576
    v_mfma_f32_16x16x32_bf16 a[12:15], v[12:15], v[32:35], a[12:15]
    ds_read_b64_tr_b16 v[68:69], v129 offset:16384
    v_mfma_f32_16x16x32_bf16 a[16:19], v[16:19], v[32:35], a[16:19]
    ds_read_b64_tr_b16 v[70:71], v129 offset:24576
    v_mfma_f32_16x16x32_bf16 a[20:23], v[20:23], v[32:35], a[20:23]
    ds_read_b64_tr_b16 v[72:73], v130 offset:16384
    buffer_load_dwordx4 v141, s[4:7], s16 offen offset:0 sc1 lds
    v_mfma_f32_16x16x32_bf16 a[24:27], v[24:27], v[32:35], a[24:27]
    ds_read_b64_tr_b16 v[74:75], v130 offset:24576
    v_mfma_f32_16x16x32_bf16 a[28:31], v[28:31], v[32:35], a[28:31]
    ds_read_b64_tr_b16 v[76:77], v131 offset:16384
    v_mfma_f32_16x16x32_bf16 a[32:35], v[0:3], v[36:39], a[32:35]
    ds_read_b64_tr_b16 v[78:79], v131 offset:24576
    v_mfma_f32_16x16x32_bf16 a[36:39], v[4:7], v[36:39], a[36:39]
    ds_read_b64_tr_b16 v[80:81], v132 offset:16384
    v_mfma_f32_16x16x32_bf16 a[40:43], v[8:11], v[36:39], a[40:43]
    ds_read_b64_tr_b16 v[82:83], v132 offset:24576
    buffer_load_dwordx4 v142, s[4:7], s16 offen offset:1024 sc1 lds
    v_mfma_f32_16x16x32_bf16 a[44:47], v[12:15], v[36:39], a[44:47]
    ds_read_b64_tr_b16 v[84:85], v133 offset:16384
    v_mfma_f32_16x16x32_bf16 a[48:51], v[16:19], v[36:39], a[48:51]
    ds_read_b64_tr_b16 v[86:87], v133 offset:24576
    v_mfma_f32_16x16x32_bf16 a[52:55], v[20:23], v[36:39], a[52:55]
    ds_read_b64_tr_b16 v[88:89], v134 offset:16384
    v_mfma_f32_16x16x32_bf16 a[56:59], v[24:27], v[36:39], a[56:59]
    ds_read_b64_tr_b16 v[90:91], v134 offset:24576
    v_mfma_f32_16x16x32_bf16 a[60:63], v[28:31], v[36:39], a[60:63]
    ds_read_b64_tr_b16 v[92:93], v135 offset:16384
    buffer_load_dwordx4 v143, s[4:7], s16 offen offset:2048 sc1 lds
    v_mfma_f32_16x16x32_bf16 a[64:67], v[0:3], v[40:43], a[64:67]
    ds_read_b64_tr_b16 v[94:95], v135 offset:24576
    v_mfma_f32_16x16x32_bf16 a[68:71], v[4:7], v[40:43], a[68:71]
    ds_read_b128 v[100:103], v136 offset:17408
    v_mfma_f32_16x16x32_bf16 a[72:75], v[8:11], v[40:43], a[72:75]
    ds_read_b128 v[104:107], v136 offset:18432
    v_mfma_f32_16x16x32_bf16 a[76:79], v[12:15], v[40:43], a[76:79]
    ds_read_b128 v[108:111], v136 offset:19456
    v_mfma_f32_16x16x32_bf16 a[80:83], v[16:19], v[40:43], a[80:83]
    ds_read_b128 v[112:115], v136 offset:20480
    v_mfma_f32_16x16x32_bf16 a[84:87], v[20:23], v[40:43], a[84:87]
    ds_read_b128 v[116:119], v136 offset:21504
    buffer_load_dwordx4 v144, s[4:7], s16 offen offset:3072 sc1 lds
    v_mfma_f32_16x16x32_bf16 a[88:91], v[24:27], v[40:43], a[88:91]
    ds_read_b128 v[120:123], v136 offset:22528
    v_mfma_f32_16x16x32_bf16 a[92:95], v[28:31], v[40:43], a[92:95]
    ds_read_b128 v[124:127], v136 offset:23552
    v_mfma_f32_16x16x32_bf16 a[96:99], v[0:3], v[44:47], a[96:99]
    v_mfma_f32_16x16x32_bf16 a[100:103], v[4:7], v[44:47], a[100:103]
    v_mfma_f32_16x16x32_bf16 a[104:107], v[8:11], v[44:47], a[104:107]
    s_add_u32 s16, s16, 1024
    v_mfma_f32_16x16x32_bf16 a[108:111], v[12:15], v[44:47], a[108:111]
    v_mfma_f32_16x16x32_bf16 a[112:115], v[16:19], v[44:47], a[112:115]
    v_mfma_f32_16x16x32_bf16 a[116:119], v[20:23], v[44:47], a[116:119]
    v_mfma_f32_16x16x32_bf16 a[120:123], v[24:27], v[44:47], a[120:123]
    v_mfma_f32_16x16x32_bf16 a[124:127], v[28:31], v[44:47], a[124:127]
    s_add_u32 m0, s19, 0
    s_nop 0
    v_mfma_f32_16x16x32_bf16 a[128:131], v[0:3], v[48:51], a[128:131]
    v_mfma_f32_16x16x32_bf16 a[132:135], v[4:7], v[48:51], a[132:135]
    v_mfma_f32_16x16x32_bf16 a[136:139], v[8:11], v[48:51], a[136:139]
    v_mfma_f32_16x16x32_bf16 a[140:143], v[12:15], v[48:51], a[140:143]
    v_mfma_f32_16x16x32_bf16 a[144:147], v[16:19], v[48:51], a[144:147]
    buffer_load_dwordx4 v137, s[8:11], s15 offen offset:0 lds
    v_mfma_f32_16x16x32_bf16 a[148:151], v[20:23], v[48:51], a[148:151]
    v_mfma_f32_16x16x32_bf16 a[152:155], v[24:27], v[48:51], a[152:155]
    v_mfma_f32_16x16x32_bf16 a[156:159], v[28:31], v[48:51], a[156:159]
    v_mfma_f32_16x16x32_bf16 a[160:163], v[0:3], v[52:55], a[160:163]
    v_mfma_f32_16x16x32_bf16 a[164:167], v[4:7], v[52:55], a[164:167]
    v_mfma_f32_16x16x32_bf16 a[168:171], v[8:11], v[52:55], a[168:171]
    buffer_load_dwordx4 v138, s[8:11], s15 offen offset:1024 lds
    v_mfma_f32_16x16x32_bf16 a[172:175], v[12:15], v[52:55], a[172:175]
    v_mfma_f32_16x16x32_bf16 a[176:179], v[16:19], v[52:55], a[176:179]
    v_mfma_f32_16x16x32_bf16 a[180:183], v[20:23], v[52:55], a[180:183]
    v_mfma_f32_16x16x32_bf16 a[184:187], v[24:27], v[52:55], a[184:187]
    v_mfma_f32_16x16x32_bf16 a[188:191], v[28:31], v[52:55], a[188:191]
    buffer_load_dwordx4 v139, s[8:11], s15 offen offset:2048 lds
    v_mfma_f32_16x16x32_bf16 a[192:195], v[0:3], v[56:59], a[192:195]
    v_mfma_f32_16x16x32_bf16 a[196:199], v[4:7], v[56:59], a[196:199]
    v_mfma_f32_16x16x32_bf16 a[200:203], v[8:11], v[56:59], a[200:203]
    v_mfma_f32_16x16x32_bf16 a[204:207], v[12:15], v[56:59], a[204:207]
    v_mfma_f32_16x16x32_bf16 a[208:211], v[16:19], v[56:59], a[208:211]
    buffer_load_dwordx4 v140, s[8:11], s15 offen offset:3072 lds
    v_mfma_f32_16x16x32_bf16 a[212:215], v[20:23], v[56:59], a[212:215]
    v_mfma_f32_16x16x32_bf16 a[216:219], v[24:27], v[56:59], a[216:219]
    v_mfma_f32_16x16x32_bf16 a[220:223], v[28:31], v[56:59], a[220:223]
    v_mfma_f32_16x16x32_bf16 a[224:227], v[0:3], v[60:63], a[224:227]
    v_mfma_f32_16x16x32_bf16 a[228:231], v[4:7], v[60:63], a[228:231]
    s_add_u32 s15, s15, s17
    v_mfma_f32_16x16x32_bf16 a[232:235], v[8:11], v[60:63], a[232:235]
    v_mfma_f32_16x16x32_bf16 a[236:239], v[12:15], v[60:63], a[236:239]
    v_mfma_f32_16x16x32_bf16 a[240:243], v[16:19], v[60:63], a[240:243]
    v_mfma_f32_16x16x32_bf16 a[244:247], v[20:23], v[60:63], a[244:247]
    v_mfma_f32_16x16x32_bf16 a[248:251], v[24:27], v[60:63], a[248:251]
    v_mfma_f32_16x16x32_bf16 a[252:255], v[28:31], v[60:63], a[252:255]
    s_waitcnt lgkmcnt(0)
    v_mfma_f32_16x16x32_bf16 a[0:3], v[64:67], v[96:99], a[0:3]
    s_waitcnt vmcnt(16)
    s_barrier
    ds_read_b128 v[32:35], v136 offset:32768
    s_add_u32 m0, s20, 16384
    s_nop 0
    v_mfma_f32_16x16x32_bf16 a[4:7], v[68:71], v[96:99], a[4:7]
    ds_read_b64_tr_b16 v[0:1], v128 offset:32768
    v_mfma_f32_16x16x32_bf16 a[8:11], v[72:75], v[96:99], a[8:11]
    ds_read_b64_tr_b16 v[2:3], v128 offset:40960
    v_mfma_f32_16x16x32_bf16 a[12:15], v[76:79], v[96:99], a[12:15]
    ds_read_b64_tr_b16 v[4:5], v129 offset:32768
    v_mfma_f32_16x16x32_bf16 a[16:19], v[80:83], v[96:99], a[16:19]
    ds_read_b64_tr_b16 v[6:7], v129 offset:40960
    v_mfma_f32_16x16x32_bf16 a[20:23], v[84:87], v[96:99], a[20:23]
    ds_read_b64_tr_b16 v[8:9], v130 offset:32768
    buffer_load_dwordx4 v141, s[4:7], s16 offen offset:0 sc1 lds
    v_mfma_f32_16x16x32_bf16 a[24:27], v[88:91], v[96:99], a[24:27]
    ds_read_b64_tr_b16 v[10:11], v130 offset:40960
    v_mfma_f32_16x16x32_bf16 a[28:31], v[92:95], v[96:99], a[28:31]
    ds_read_b64_tr_b16 v[12:13], v131 offset:32768
    v_mfma_f32_16x16x32_bf16 a[32:35], v[64:67], v[100:103], a[32:35]
    ds_read_b64_tr_b16 v[14:15], v131 offset:40960
    v_mfma_f32_16x16x32_bf16 a[36:39], v[68:71], v[100:103], a[36:39]
    ds_read_b64_tr_b16 v[16:17], v132 offset:32768
    v_mfma_f32_16x16x32_bf16 a[40:43], v[72:75], v[100:103], a[40:43]
    ds_read_b64_tr_b16 v[18:19], v132 offset:40960
    buffer_load_dwordx4 v142, s[4:7], s16 offen offset:1024 sc1 lds
    v_mfma_f32_16x16x32_bf16 a[44:47], v[76:79], v[100:103], a[44:47]
    ds_read_b64_tr_b16 v[20:21], v133 offset:32768
    v_mfma_f32_16x16x32_bf16 a[48:51], v[80:83], v[100:103], a[48:51]
    ds_read_b64_tr_b16 v[22:23], v133 offset:40960
    v_mfma_f32_16x16x32_bf16 a[52:55], v[84:87], v[100:103], a[52:55]
    ds_read_b64_tr_b16 v[24:25], v134 offset:32768
    v_mfma_f32_16x16x32_bf16 a[56:59], v[88:91], v[100:103], a[56:59]
    ds_read_b64_tr_b16 v[26:27], v134 offset:40960
    v_mfma_f32_16x16x32_bf16 a[60:63], v[92:95], v[100:103], a[60:63]
    ds_read_b64_tr_b16 v[28:29], v135 offset:32768
    buffer_load_dwordx4 v143, s[4:7], s16 offen offset:2048 sc1 lds
    v_mfma_f32_16x16x32_bf16 a[64:67], v[64:67], v[104:107], a[64:67]
    ds_read_b64_tr_b16 v[30:31], v135 offset:40960
    v_mfma_f32_16x16x32_bf16 a[68:71], v[68:71], v[104:107], a[68:71]
    ds_read_b128 v[36:39], v136 offset:33792
    v_mfma_f32_16x16x32_bf16 a[72:75], v[72:75], v[104:107], a[72:75]
    ds_read_b128 v[40:43], v136 offset:34816
    v_mfma_f32_16x16x32_bf16 a[76:79], v[76:79], v[104:107], a[76:79]
    ds_read_b128 v[44:47], v136 offset:35840
    v_mfma_f32_16x16x32_bf16 a[80:83], v[80:83], v[104:107], a[80:83]
    ds_read_b128 v[48:51], v136 offset:36864
    v_mfma_f32_16x16x32_bf16 a[84:87], v[84:87], v[104:107], a[84:87]
    ds_read_b128 v[52:55], v136 offset:37888
    buffer_load_dwordx4 v144, s[4:7], s16 offen offset:3072 sc1 lds
    v_mfma_f32_16x16x32_bf16 a[88:91], v[88:91], v[104:107], a[88:91]
    ds_read_b128 v[56:59], v136 offset:38912
    v_mfma_f32_16x16x32_bf16 a[92:95], v[92:95], v[104:107], a[92:95]
    ds_read_b128 v[60:63], v136 offset:39936
    v_mfma_f32_16x16x32_bf16 a[96:99], v[64:67], v[108:111], a[96:99]
    v_mfma_f32_16x16x32_bf16 a[100:103], v[68:71], v[108:111], a[100:103]
    v_mfma_f32_16x16x32_bf16 a[104:107], v[72:75], v[108:111], a[104:107]
    s_add_u32 s16, s16, 1024
    v_mfma_f32_16x16x32_bf16 a[108:111], v[76:79], v[108:111], a[108:111]
    v_mfma_f32_16x16x32_bf16 a[112:115], v[80:83], v[108:111], a[112:115]
    v_mfma_f32_16x16x32_bf16 a[116:119], v[84:87], v[108:111], a[116:119]
    v_mfma_f32_16x16x32_bf16 a[120:123], v[88:91], v[108:111], a[120:123]
    v_mfma_f32_16x16x32_bf16 a[124:127], v[92:95], v[108:111], a[124:127]
    s_add_u32 m0, s19, 16384
    s_nop 0
    v_mfma_f32_16x16x32_bf16 a[128:131], v[64:67], v[112:115], a[128:131]
    v_mfma_f32_16x16x32_bf16 a[132:135], v[68:71], v[112:115], a[132:135]
    v_mfma_f32_16x16x32_bf16 a[136:139], v[72:75], v[112:115], a[136:139]
    v_mfma_f32_16x16x32_bf16 a[140:143], v[76:79], v[112:115], a[140:143]
    v_mfma_f32_16x16x32_bf16 a[144:147], v[80:83], v[112:115], a[144:147]
    buffer_load_dwordx4 v137, s[8:11], s15 offen offset:0 lds
    v_mfma_f32_16x16x32_bf16 a[148:151], v[84:87], v[112:115], a[148:151]
    v_mfma_f32_16x16x32_bf16 a[152:155], v[88:91], v[112:115], a[152:155]
    v_mfma_f32_16x16x32_bf16 a[156:159], v[92:95], v[112:115], a[156:159]
    v_mfma_f32_16x16x32_bf16 a[160:163], v[64:67], v[116:119], a[160:163]
    v_mfma_f32_16x16x32_bf16 a[164:167], v[68:71], v[116:119], a[164:167]
    v_mfma_f32_16x16x32_bf16 a[168:171], v[72:75], v[116:119], a[168:171]
    buffer_load_dwordx4 v138, s[8:11], s15 offen offset:1024 lds
    v_mfma_f32_16x16x32_bf16 a[172:175], v[76:79], v[116:119], a[172:175]
    v_mfma_f32_16x16x32_bf16 a[176:179], v[80:83], v[116:119], a[176:179]
    v_mfma_f32_16x16x32_bf16 a[180:183], v[84:87], v[116:119], a[180:183]
    v_mfma_f32_16x16x32_bf16 a[184:187], v[88:91], v[116:119], a[184:187]
    v_mfma_f32_16x16x32_bf16 a[188:191], v[92:95], v[116:119], a[188:191]
    buffer_load_dwordx4 v139, s[8:11], s15 offen offset:2048 lds
    v_mfma_f32_16x16x32_bf16 a[192:195], v[64:67], v[120:123], a[192:195]
    v_mfma_f32_16x16x32_bf16 a[196:199], v[68:71], v[120:123], a[196:199]
    v_mfma_f32_16x16x32_bf16 a[200:203], v[72:75], v[120:123], a[200:203]
    v_mfma_f32_16x16x32_bf16 a[204:207], v[76:79], v[120:123], a[204:207]
    v_mfma_f32_16x16x32_bf16 a[208:211], v[80:83], v[120:123], a[208:211]
    buffer_load_dwordx4 v140, s[8:11], s15 offen offset:3072 lds
    v_mfma_f32_16x16x32_bf16 a[212:215], v[84:87], v[120:123], a[212:215]
    v_mfma_f32_16x16x32_bf16 a[216:219], v[88:91], v[120:123], a[216:219]
    v_mfma_f32_16x16x32_bf16 a[220:223], v[92:95], v[120:123], a[220:223]
    v_mfma_f32_16x16x32_bf16 a[224:227], v[64:67], v[124:127], a[224:227]
    v_mfma_f32_16x16x32_bf16 a[228:231], v[68:71], v[124:127], a[228:231]
    s_add_u32 s15, s15, s17
    v_mfma_f32_16x16x32_bf16 a[232:235], v[72:75], v[124:127], a[232:235]
    v_mfma_f32_16x16x32_bf16 a[236:239], v[76:79], v[124:127], a[236:239]
    v_mfma_f32_16x16x32_bf16 a[240:243], v[80:83], v[124:127], a[240:243]
    v_mfma_f32_16x16x32_bf16 a[244:247], v[84:87], v[124:127], a[244:247]
    v_mfma_f32_16x16x32_bf16 a[248:251], v[88:91], v[124:127], a[248:251]
    v_mfma_f32_16x16x32_bf16 a[252:255], v[92:95], v[124:127], a[252:255]
    s_waitcnt lgkmcnt(0)
    v_mfma_f32_16x16x32_bf16 a[0:3], v[0:3], v[32:35], a[0:3]
    s_waitcnt vmcnt(16)
    s_barrier
    ds_read_b128 v[96:99], v136 offset:49152
    s_add_u32 m0, s20, 32768
    s_nop 0
    v_mfma_f32_16x16x32_bf16 a[4:7], v[4:7], v[32:35], a[4:7]
    ds_read_b64_tr_b16 v[64:65], v128 offset:49152
    v_mfma_f32_16x16x32_bf16 a[8:11], v[8:11], v[32:35], a[8:11]
    ds_read_b64_tr_b16 v[66:67], v128 offset:57344
    v_mfma_f32_16x16x32_bf16 a[12:15], v[12:15], v[32:35], a[12:15]
    ds_read_b64_tr_b16 v[68:69], v129 offset:49152
    v_mfma_f32_16x16x32_bf16 a[16:19], v[16:19], v[32:35], a[16:19]
    ds_read_b64_tr_b16 v[70:71], v129 offset:57344
    v_mfma_f32_16x16x32_bf16 a[20:23], v[20:23], v[32:35], a[20:23]
    ds_read_b64_tr_b16 v[72:73], v130 offset:49152
    buffer_load_dwordx4 v141, s[4:7], s16 offen offset:0 sc1 lds
    v_mfma_f32_16x16x32_bf16 a[24:27], v[24:27], v[32:35], a[24:27]
    ds_read_b64_tr_b16 v[74:75], v130 offset:57344
    v_mfma_f32_16x16x32_bf16 a[28:31], v[28:31], v[32:35], a[28:31]
    ds_read_b64_tr_b16 v[76:77], v131 offset:49152
    v_mfma_f32_16x16x32_bf16 a[32:35], v[0:3], v[36:39], a[32:35]
    ds_read_b64_tr_b16 v[78:79], v131 offset:57344
    v_mfma_f32_16x16x32_bf16 a[36:39], v[4:7], v[36:39], a[36:39]
    ds_read_b64_tr_b16 v[80:81], v132 offset:49152
    v_mfma_f32_16x16x32_bf16 a[40:43], v[8:11], v[36:39], a[40:43]
    ds_read_b64_tr_b16 v[82:83], v132 offset:57344
    buffer_load_dwordx4 v142, s[4:7], s16 offen offset:1024 sc1 lds
    v_mfma_f32_16x16x32_bf16 a[44:47], v[12:15], v[36:39], a[44:47]
    ds_read_b64_tr_b16 v[84:85], v133 offset:49152
    v_mfma_f32_16x16x32_bf16 a[48:51], v[16:19], v[36:39], a[48:51]
    ds_read_b64_tr_b16 v[86:87], v133 offset:57344
    v_mfma_f32_16x16x32_bf16 a[52:55], v[20:23], v[36:39], a[52:55]
    ds_read_b64_tr_b16 v[88:89], v134 offset:49152
    v_mfma_f32_16x16x32_bf16 a[56:59], v[24:27], v[36:39], a[56:59]
    ds_read_b64_tr_b16 v[90:91], v134 offset:57344
    v_mfma_f32_16x16x32_bf16 a[60:63], v[28:31], v[36:39], a[60:63]
    ds_read_b64_tr_b16 v[92:93], v135 offset:49152
    buffer_load_dwordx4 v143, s[4:7], s16 offen offset:2048 sc1 lds
    v_mfma_f32_16x16x32_bf16 a[64:67], v[0:3], v[40:43], a[64:67]
    ds_read_b64_tr_b16 v[94:95], v135 offset:57344
    v_mfma_f32_16x16x32_bf16 a[68:71], v[4:7], v[40:43], a[68:71]
    ds_read_b128 v[100:103], v136 offset:50176
    v_mfma_f32_16x16x32_bf16 a[72:75], v[8:11], v[40:43], a[72:75]
    ds_read_b128 v[104:107], v136 offset:51200
    v_mfma_f32_16x16x32_bf16 a[76:79], v[12:15], v[40:43], a[76:79]
    ds_read_b128 v[108:111], v136 offset:52224
    v_mfma_f32_16x16x32_bf16 a[80:83], v[16:19], v[40:43], a[80:83]
    ds_read_b128 v[112:115], v136 offset:53248
    v_mfma_f32_16x16x32_bf16 a[84:87], v[20:23], v[40:43], a[84:87]
    ds_read_b128 v[116:119], v136 offset:54272
    buffer_load_dwordx4 v144, s[4:7], s16 offen offset:3072 sc1 lds
    v_mfma_f32_16x16x32_bf16 a[88:91], v[24:27], v[40:43], a[88:91]
    ds_read_b128 v[120:123], v136 offset:55296
    v_mfma_f32_16x16x32_bf16 a[92:95], v[28:31], v[40:43], a[92:95]
    ds_read_b128 v[124:127], v136 offset:56320
    v_mfma_f32_16x16x32_bf16 a[96:99], v[0:3], v[44:47], a[96:99]
    v_mfma_f32_16x16x32_bf16 a[100:103], v[4:7], v[44:47], a[100:103]
    v_mfma_f32_16x16x32_bf16 a[104:107], v[8:11], v[44:47], a[104:107]
    s_add_u32 s16, s16, 1024
    v_mfma_f32_16x16x32_bf16 a[108:111], v[12:15], v[44:47], a[108:111]
    v_mfma_f32_16x16x32_bf16 a[112:115], v[16:19], v[44:47], a[112:115]
    v_mfma_f32_16x16x32_bf16 a[116:119], v[20:23], v[44:47], a[116:119]
    v_mfma_f32_16x16x32_bf16 a[120:123], v[24:27], v[44:47], a[120:123]
    v_mfma_f32_16x16x32_bf16 a[124:127], v[28:31], v[44:47], a[124:127]
    s_add_u32 m0, s19, 32768
    s_nop 0
    v_mfma_f32_16x16x32_bf16 a[128:131], v[0:3], v[48:51], a[128:131]
    v_mfma_f32_16x16x32_bf16 a[132:135], v[4:7], v[48:51], a[132:135]
    v_mfma_f32_16x16x32_bf16 a[136:139], v[8:11], v[48:51], a[136:139]
    v_mfma_f32_16x16x32_bf16 a[140:143], v[12:15], v[48:51], a[140:143]
    v_mfma_f32_16x16x32_bf16 a[144:147], v[16:19], v[48:51], a[144:147]
    buffer_load_dwordx4 v137, s[8:11], s15 offen offset:0 lds
    v_mfma_f32_16x16x32_bf16 a[148:151], v[20:23], v[48:51], a[148:151]
    v_mfma_f32_16x16x32_bf16 a[152:155], v[24:27], v[48:51], a[152:155]
    v_mfma_f32_16x16x32_bf16 a[156:159], v[28:31], v[48:51], a[156:159]
    v_mfma_f32_16x16x32_bf16 a[160:163], v[0:3], v[52:55], a[160:163]
    v_mfma_f32_16x16x32_bf16 a[164:167], v[4:7], v[52:55], a[164:167]
    v_mfma_f32_16x16x32_bf16 a[168:171], v[8:11], v[52:55], a[168:171]
    buffer_load_dwordx4 v138, s[8:11], s15 offen offset:1024 lds
    v_mfma_f32_16x16x32_bf16 a[172:175], v[12:15], v[52:55], a[172:175]
    v_mfma_f32_16x16x32_bf16 a[176:179], v[16:19], v[52:55], a[176:179]
    v_mfma_f32_16x16x32_bf16 a[180:183], v[20:23], v[52:55], a[180:183]
    v_mfma_f32_16x16x32_bf16 a[184:187], v[24:27], v[52:55], a[184:187]
    v_mfma_f32_16x16x32_bf16 a[188:191], v[28:31], v[52:55], a[188:191]
    buffer_load_dwordx4 v139, s[8:11], s15 offen offset:2048 lds
    v_mfma_f32_16x16x32_bf16 a[192:195], v[0:3], v[56:59], a[192:195]
    v_mfma_f32_16x16x32_bf16 a[196:199], v[4:7], v[56:59], a[196:199]
    v_mfma_f32_16x16x32_bf16 a[200:203], v[8:11], v[56:59], a[200:203]
    v_mfma_f32_16x16x32_bf16 a[204:207], v[12:15], v[56:59], a[204:207]
    v_mfma_f32_16x16x32_bf16 a[208:211], v[16:19], v[56:59], a[208:211]
    buffer_load_dwordx4 v140, s[8:11], s15 offen offset:3072 lds
    v_mfma_f32_16x16x32_bf16 a[212:215], v[20:23], v[56:59], a[212:215]
    v_mfma_f32_16x16x32_bf16 a[216:219], v[24:27], v[56:59], a[216:219]
    v_mfma_f32_16x16x32_bf16 a[220:223], v[28:31], v[56:59], a[220:223]
    v_mfma_f32_16x16x32_bf16 a[224:227], v[0:3], v[60:63], a[224:227]
    v_mfma_f32_16x16x32_bf16 a[228:231], v[4:7], v[60:63], a[228:231]
    s_add_u32 s15, s15, s17
    v_mfma_f32_16x16x32_bf16 a[232:235], v[8:11], v[60:63], a[232:235]
    v_mfma_f32_16x16x32_bf16 a[236:239], v[12:15], v[60:63], a[236:239]
    v_mfma_f32_16x16x32_bf16 a[240:243], v[16:19], v[60:63], a[240:243]
    v_mfma_f32_16x16x32_bf16 a[244:247], v[20:23], v[60:63], a[244:247]
    v_mfma_f32_16x16x32_bf16 a[248:251], v[24:27], v[60:63], a[248:251]
    v_mfma_f32_16x16x32_bf16 a[252:255], v[28:31], v[60:63], a[252:255]
    s_waitcnt lgkmcnt(0)
    v_mfma_f32_16x16x32_bf16 a[0:3], v[64:67], v[96:99], a[0:3]
    s_waitcnt vmcnt(16)
    s_barrier
    ds_read_b128 v[32:35], v136 offset:0
    s_add_u32 m0, s20, 49152
    s_nop 0
    v_mfma_f32_16x16x32_bf16 a[4:7], v[68:71], v[96:99], a[4:7]
    ds_read_b64_tr_b16 v[0:1], v128 offset:0
    v_mfma_f32_16x16x32_bf16 a[8:11], v[72:75], v[96:99], a[8:11]
    ds_read_b64_tr_b16 v[2:3], v128 offset:8192
    v_mfma_f32_16x16x32_bf16 a[12:15], v[76:79], v[96:99], a[12:15]
    ds_read_b64_tr_b16 v[4:5], v129 offset:0
    v_mfma_f32_16x16x32_bf16 a[16:19], v[80:83], v[96:99], a[16:19]
    ds_read_b64_tr_b16 v[6:7], v129 offset:8192
    v_mfma_f32_16x16x32_bf16 a[20:23], v[84:87], v[96:99], a[20:23]
    ds_read_b64_tr_b16 v[8:9], v130 offset:0
    buffer_load_dwordx4 v141, s[4:7], s16 offen offset:0 sc1 lds
    v_mfma_f32_16x16x32_bf16 a[24:27], v[88:91], v[96:99], a[24:27]
    ds_read_b64_tr_b16 v[10:11], v130 offset:8192
    v_mfma_f32_16x16x32_bf16 a[28:31], v[92:95], v[96:99], a[28:31]
    ds_read_b64_tr_b16 v[12:13], v131 offset:0
    v_mfma_f32_16x16x32_bf16 a[32:35], v[64:67], v[100:103], a[32:35]
    ds_read_b64_tr_b16 v[14:15], v131 offset:8192
    v_mfma_f32_16x16x32_bf16 a[36:39], v[68:71], v[100:103], a[36:39]
    ds_read_b64_tr_b16 v[16:17], v132 offset:0
    v_mfma_f32_16x16x32_bf16 a[40:43], v[72:75], v[100:103], a[40:43]
    ds_read_b64_tr_b16 v[18:19], v132 offset:8192
    buffer_load_dwordx4 v142, s[4:7], s16 offen offset:1024 sc1 lds
    v_mfma_f32_16x16x32_bf16 a[44:47], v[76:79], v[100:103], a[44:47]
    ds_read_b64_tr_b16 v[20:21], v133 offset:0
    v_mfma_f32_16x16x32_bf16 a[48:51], v[80:83], v[100:103], a[48:51]
    ds_read_b64_tr_b16 v[22:23], v133 offset:8192
    v_mfma_f32_16x16x32_bf16 a[52:55], v[84:87], v[100:103], a[52:55]
    ds_read_b64_tr_b16 v[24:25], v134 offset:0
    v_mfma_f32_16x16x32_bf16 a[56:59], v[88:91], v[100:103], a[56:59]
    ds_read_b64_tr_b16 v[26:27], v134 offset:8192
    v_mfma_f32_16x16x32_bf16 a[60:63], v[92:95], v[100:103], a[60:63]
    ds_read_b64_tr_b16 v[28:29], v135 offset:0
    buffer_load_dwordx4 v143, s[4:7], s16 offen offset:2048 sc1 lds
    v_mfma_f32_16x16x32_bf16 a[64:67], v[64:67], v[104:107], a[64:67]
    ds_read_b64_tr_b16 v[30:31], v135 offset:8192
    v_mfma_f32_16x16x32_bf16 a[68:71], v[68:71], v[104:107], a[68:71]
    ds_read_b128 v[36:39], v136 offset:1024
    v_mfma_f32_16x16x32_bf16 a[72:75], v[72:75], v[104:107], a[72:75]
    ds_read_b128 v[40:43], v136 offset:2048
    v_mfma_f32_16x16x32_bf16 a[76:79], v[76:79], v[104:107], a[76:79]
    ds_read_b128 v[44:47], v136 offset:3072
    v_mfma_f32_16x16x32_bf16 a[80:83], v[80:83], v[104:107], a[80:83]
    ds_read_b128 v[48:51], v136 offset:4096
    v_mfma_f32_16x16x32_bf16 a[84:87], v[84:87], v[104:107], a[84:87]
    ds_read_b128 v[52:55], v136 offset:5120
    buffer_load_dwordx4 v144, s[4:7], s16 offen offset:3072 sc1 lds
    v_mfma_f32_16x16x32_bf16 a[88:91], v[88:91], v[104:107], a[88:91]
    ds_read_b128 v[56:59], v136 offset:6144
    v_mfma_f32_16x16x32_bf16 a[92:95], v[92:95], v[104:107], a[92:95]
    ds_read_b128 v[60:63], v136 offset:7168
    v_mfma_f32_16x16x32_bf16 a[96:99], v[64:67], v[108:111], a[96:99]
    v_mfma_f32_16x16x32_bf16 a[100:103], v[68:71], v[108:111], a[100:103]
    v_mfma_f32_16x16x32_bf16 a[104:107], v[72:75], v[108:111], a[104:107]
    s_add_u32 s16, s16, 1024
    v_mfma_f32_16x16x32_bf16 a[108:111], v[76:79], v[108:111], a[108:111]
    v_mfma_f32_16x16x32_bf16 a[112:115], v[80:83], v[108:111], a[112:115]
    v_mfma_f32_16x16x32_bf16 a[116:119], v[84:87], v[108:111], a[116:119]
    v_mfma_f32_16x16x32_bf16 a[120:123], v[88:91], v[108:111], a[120:123]
    v_mfma_f32_16x16x32_bf16 a[124:127], v[92:95], v[108:111], a[124:127]
    s_add_u32 m0, s19, 49152
    s_nop 0
    v_mfma_f32_16x16x32_bf16 a[128:131], v[64:67], v[112:115], a[128:131]
    v_mfma_f32_16x16x32_bf16 a[132:135], v[68:71], v[112:115], a[132:135]
    v_mfma_f32_16x16x32_bf16 a[136:139], v[72:75], v[112:115], a[136:139]
    v_mfma_f32_16x16x32_bf16 a[140:143], v[76:79], v[112:115], a[140:143]
    v_mfma_f32_16x16x32_bf16 a[144:147], v[80:83], v[112:115], a[144:147]
    buffer_load_dwordx4 v137, s[8:11], s15 offen offset:0 lds
    v_mfma_f32_16x16x32_bf16 a[148:151], v[84:87], v[112:115], a[148:151]
    v_mfma_f32_16x16x32_bf16 a[152:155], v[88:91], v[112:115], a[152:155]
    v_mfma_f32_16x16x32_bf16 a[156:159], v[92:95], v[112:115], a[156:159]
    v_mfma_f32_16x16x32_bf16 a[160:163], v[64:67], v[116:119], a[160:163]
    v_mfma_f32_16x16x32_bf16 a[164:167], v[68:71], v[116:119], a[164:167]
    v_mfma_f32_16x16x32_bf16 a[168:171], v[72:75], v[116:119], a[168:171]
    buffer_load_dwordx4 v138, s[8:11], s15 offen offset:1024 lds
    v_mfma_f32_16x16x32_bf16 a[172:175], v[76:79], v[116:119], a[172:175]
    v_mfma_f32_16x16x32_bf16 a[176:179], v[80:83], v[116:119], a[176:179]
    v_mfma_f32_16x16x32_bf16 a[180:183], v[84:87], v[116:119], a[180:183]
    v_mfma_f32_16x16x32_bf16 a[184:187], v[88:91], v[116:119], a[184:187]
    v_mfma_f32_16x16x32_bf16 a[188:191], v[92:95], v[116:119], a[188:191]
    buffer_load_dwordx4 v139, s[8:11], s15 offen offset:2048 lds
    v_mfma_f32_16x16x32_bf16 a[192:195], v[64:67], v[120:123], a[192:195]
    v_mfma_f32_16x16x32_bf16 a[196:199], v[68:71], v[120:123], a[196:199]
    v_mfma_f32_16x16x32_bf16 a[200:203], v[72:75], v[120:123], a[200:203]
    v_mfma_f32_16x16x32_bf16 a[204:207], v[76:79], v[120:123], a[204:207]
    v_mfma_f32_16x16x32_bf16 a[208:211], v[80:83], v[120:123], a[208:211]
    buffer_load_dwordx4 v140, s[8:11], s15 offen offset:3072 lds
    v_mfma_f32_16x16x32_bf16 a[212:215], v[84:87], v[120:123], a[212:215]
    v_mfma_f32_16x16x32_bf16 a[216:219], v[88:91], v[120:123], a[216:219]
    v_mfma_f32_16x16x32_bf16 a[220:223], v[92:95], v[120:123], a[220:223]
    v_mfma_f32_16x16x32_bf16 a[224:227], v[64:67], v[124:127], a[224:227]
    v_mfma_f32_16x16x32_bf16 a[228:231], v[68:71], v[124:127], a[228:231]
    s_add_u32 s15, s15, s17
    v_mfma_f32_16x16x32_bf16 a[232:235], v[72:75], v[124:127], a[232:235]
    v_mfma_f32_16x16x32_bf16 a[236:239], v[76:79], v[124:127], a[236:239]
    v_mfma_f32_16x16x32_bf16 a[240:243], v[80:83], v[124:127], a[240:243]
    v_mfma_f32_16x16x32_bf16 a[244:247], v[84:87], v[124:127], a[244:247]
    v_mfma_f32_16x16x32_bf16 a[248:251], v[88:91], v[124:127], a[248:251]
    v_mfma_f32_16x16x32_bf16 a[252:255], v[92:95], v[124:127], a[252:255]
    s_sub_u32 s18, s18, 1
    s_cmp_lg_u32 s18, 0
    s_cbranch_scc1 main_kernel_w_c2_n_loop
    s_cmp_lg_u32 s14, 0
    s_cbranch_scc1 main_kernel_w_c2_n_nt
    s_lshl_b32 s32, s27, 8
    s_add_u32 s32, s32, 0x841e000
    v_mov_b32 v255, 1
    s_mov_b64 exec, 1
    buffer_atomic_add v255, off, s[4:7], s32 sc0 sc1
    s_mov_b64 exec, -1
main_kernel_w_c2_n_nt:
    s_waitcnt lgkmcnt(0)
    v_mfma_f32_16x16x32_bf16 a[0:3], v[0:3], v[32:35], a[0:3]
    s_waitcnt vmcnt(16)
    s_barrier
    ds_read_b128 v[96:99], v136 offset:16384
    v_mfma_f32_16x16x32_bf16 a[4:7], v[4:7], v[32:35], a[4:7]
    ds_read_b64_tr_b16 v[64:65], v128 offset:16384
    v_mfma_f32_16x16x32_bf16 a[8:11], v[8:11], v[32:35], a[8:11]
    ds_read_b64_tr_b16 v[66:67], v128 offset:24576
    v_mfma_f32_16x16x32_bf16 a[12:15], v[12:15], v[32:35], a[12:15]
    ds_read_b64_tr_b16 v[68:69], v129 offset:16384
    v_mfma_f32_16x16x32_bf16 a[16:19], v[16:19], v[32:35], a[16:19]
    ds_read_b64_tr_b16 v[70:71], v129 offset:24576
    v_mfma_f32_16x16x32_bf16 a[20:23], v[20:23], v[32:35], a[20:23]
    ds_read_b64_tr_b16 v[72:73], v130 offset:16384
    v_mfma_f32_16x16x32_bf16 a[24:27], v[24:27], v[32:35], a[24:27]
    ds_read_b64_tr_b16 v[74:75], v130 offset:24576
    v_mfma_f32_16x16x32_bf16 a[28:31], v[28:31], v[32:35], a[28:31]
    ds_read_b64_tr_b16 v[76:77], v131 offset:16384
    v_mfma_f32_16x16x32_bf16 a[32:35], v[0:3], v[36:39], a[32:35]
    ds_read_b64_tr_b16 v[78:79], v131 offset:24576
    v_mfma_f32_16x16x32_bf16 a[36:39], v[4:7], v[36:39], a[36:39]
    ds_read_b64_tr_b16 v[80:81], v132 offset:16384
    v_mfma_f32_16x16x32_bf16 a[40:43], v[8:11], v[36:39], a[40:43]
    ds_read_b64_tr_b16 v[82:83], v132 offset:24576
    v_mfma_f32_16x16x32_bf16 a[44:47], v[12:15], v[36:39], a[44:47]
    ds_read_b64_tr_b16 v[84:85], v133 offset:16384
    v_mfma_f32_16x16x32_bf16 a[48:51], v[16:19], v[36:39], a[48:51]
    ds_read_b64_tr_b16 v[86:87], v133 offset:24576
    v_mfma_f32_16x16x32_bf16 a[52:55], v[20:23], v[36:39], a[52:55]
    ds_read_b64_tr_b16 v[88:89], v134 offset:16384
    v_mfma_f32_16x16x32_bf16 a[56:59], v[24:27], v[36:39], a[56:59]
    ds_read_b64_tr_b16 v[90:91], v134 offset:24576
    v_mfma_f32_16x16x32_bf16 a[60:63], v[28:31], v[36:39], a[60:63]
    ds_read_b64_tr_b16 v[92:93], v135 offset:16384
    v_mfma_f32_16x16x32_bf16 a[64:67], v[0:3], v[40:43], a[64:67]
    ds_read_b64_tr_b16 v[94:95], v135 offset:24576
    v_mfma_f32_16x16x32_bf16 a[68:71], v[4:7], v[40:43], a[68:71]
    ds_read_b128 v[100:103], v136 offset:17408
    v_mfma_f32_16x16x32_bf16 a[72:75], v[8:11], v[40:43], a[72:75]
    ds_read_b128 v[104:107], v136 offset:18432
    v_mfma_f32_16x16x32_bf16 a[76:79], v[12:15], v[40:43], a[76:79]
    ds_read_b128 v[108:111], v136 offset:19456
    v_mfma_f32_16x16x32_bf16 a[80:83], v[16:19], v[40:43], a[80:83]
    ds_read_b128 v[112:115], v136 offset:20480
    v_mfma_f32_16x16x32_bf16 a[84:87], v[20:23], v[40:43], a[84:87]
    ds_read_b128 v[116:119], v136 offset:21504
    v_mfma_f32_16x16x32_bf16 a[88:91], v[24:27], v[40:43], a[88:91]
    ds_read_b128 v[120:123], v136 offset:22528
    v_mfma_f32_16x16x32_bf16 a[92:95], v[28:31], v[40:43], a[92:95]
    ds_read_b128 v[124:127], v136 offset:23552
    v_mfma_f32_16x16x32_bf16 a[96:99], v[0:3], v[44:47], a[96:99]
    v_mfma_f32_16x16x32_bf16 a[100:103], v[4:7], v[44:47], a[100:103]
    v_mfma_f32_16x16x32_bf16 a[104:107], v[8:11], v[44:47], a[104:107]
    v_mfma_f32_16x16x32_bf16 a[108:111], v[12:15], v[44:47], a[108:111]
    v_mfma_f32_16x16x32_bf16 a[112:115], v[16:19], v[44:47], a[112:115]
    v_mfma_f32_16x16x32_bf16 a[116:119], v[20:23], v[44:47], a[116:119]
    v_mfma_f32_16x16x32_bf16 a[120:123], v[24:27], v[44:47], a[120:123]
    v_mfma_f32_16x16x32_bf16 a[124:127], v[28:31], v[44:47], a[124:127]
    v_mfma_f32_16x16x32_bf16 a[128:131], v[0:3], v[48:51], a[128:131]
    v_mfma_f32_16x16x32_bf16 a[132:135], v[4:7], v[48:51], a[132:135]
    v_mfma_f32_16x16x32_bf16 a[136:139], v[8:11], v[48:51], a[136:139]
    v_mfma_f32_16x16x32_bf16 a[140:143], v[12:15], v[48:51], a[140:143]
    v_mfma_f32_16x16x32_bf16 a[144:147], v[16:19], v[48:51], a[144:147]
    v_mfma_f32_16x16x32_bf16 a[148:151], v[20:23], v[48:51], a[148:151]
    v_mfma_f32_16x16x32_bf16 a[152:155], v[24:27], v[48:51], a[152:155]
    v_mfma_f32_16x16x32_bf16 a[156:159], v[28:31], v[48:51], a[156:159]
    v_mfma_f32_16x16x32_bf16 a[160:163], v[0:3], v[52:55], a[160:163]
    v_mfma_f32_16x16x32_bf16 a[164:167], v[4:7], v[52:55], a[164:167]
    v_mfma_f32_16x16x32_bf16 a[168:171], v[8:11], v[52:55], a[168:171]
    v_mfma_f32_16x16x32_bf16 a[172:175], v[12:15], v[52:55], a[172:175]
    v_mfma_f32_16x16x32_bf16 a[176:179], v[16:19], v[52:55], a[176:179]
    v_mfma_f32_16x16x32_bf16 a[180:183], v[20:23], v[52:55], a[180:183]
    v_mfma_f32_16x16x32_bf16 a[184:187], v[24:27], v[52:55], a[184:187]
    v_mfma_f32_16x16x32_bf16 a[188:191], v[28:31], v[52:55], a[188:191]
    v_mfma_f32_16x16x32_bf16 a[192:195], v[0:3], v[56:59], a[192:195]
    v_mfma_f32_16x16x32_bf16 a[196:199], v[4:7], v[56:59], a[196:199]
    v_mfma_f32_16x16x32_bf16 a[200:203], v[8:11], v[56:59], a[200:203]
    v_mfma_f32_16x16x32_bf16 a[204:207], v[12:15], v[56:59], a[204:207]
    v_mfma_f32_16x16x32_bf16 a[208:211], v[16:19], v[56:59], a[208:211]
    v_mfma_f32_16x16x32_bf16 a[212:215], v[20:23], v[56:59], a[212:215]
    v_mfma_f32_16x16x32_bf16 a[216:219], v[24:27], v[56:59], a[216:219]
    v_mfma_f32_16x16x32_bf16 a[220:223], v[28:31], v[56:59], a[220:223]
    v_mfma_f32_16x16x32_bf16 a[224:227], v[0:3], v[60:63], a[224:227]
    v_mfma_f32_16x16x32_bf16 a[228:231], v[4:7], v[60:63], a[228:231]
    v_mfma_f32_16x16x32_bf16 a[232:235], v[8:11], v[60:63], a[232:235]
    v_mfma_f32_16x16x32_bf16 a[236:239], v[12:15], v[60:63], a[236:239]
    v_mfma_f32_16x16x32_bf16 a[240:243], v[16:19], v[60:63], a[240:243]
    v_mfma_f32_16x16x32_bf16 a[244:247], v[20:23], v[60:63], a[244:247]
    v_mfma_f32_16x16x32_bf16 a[248:251], v[24:27], v[60:63], a[248:251]
    v_mfma_f32_16x16x32_bf16 a[252:255], v[28:31], v[60:63], a[252:255]
    s_waitcnt lgkmcnt(0)
    v_mfma_f32_16x16x32_bf16 a[0:3], v[64:67], v[96:99], a[0:3]
    s_waitcnt vmcnt(8)
    s_barrier
    ds_read_b128 v[32:35], v136 offset:32768
    v_mfma_f32_16x16x32_bf16 a[4:7], v[68:71], v[96:99], a[4:7]
    ds_read_b64_tr_b16 v[0:1], v128 offset:32768
    v_mfma_f32_16x16x32_bf16 a[8:11], v[72:75], v[96:99], a[8:11]
    ds_read_b64_tr_b16 v[2:3], v128 offset:40960
    v_mfma_f32_16x16x32_bf16 a[12:15], v[76:79], v[96:99], a[12:15]
    ds_read_b64_tr_b16 v[4:5], v129 offset:32768
    v_mfma_f32_16x16x32_bf16 a[16:19], v[80:83], v[96:99], a[16:19]
    ds_read_b64_tr_b16 v[6:7], v129 offset:40960
    v_mfma_f32_16x16x32_bf16 a[20:23], v[84:87], v[96:99], a[20:23]
    ds_read_b64_tr_b16 v[8:9], v130 offset:32768
    v_mfma_f32_16x16x32_bf16 a[24:27], v[88:91], v[96:99], a[24:27]
    ds_read_b64_tr_b16 v[10:11], v130 offset:40960
    v_mfma_f32_16x16x32_bf16 a[28:31], v[92:95], v[96:99], a[28:31]
    ds_read_b64_tr_b16 v[12:13], v131 offset:32768
    v_mfma_f32_16x16x32_bf16 a[32:35], v[64:67], v[100:103], a[32:35]
    ds_read_b64_tr_b16 v[14:15], v131 offset:40960
    v_mfma_f32_16x16x32_bf16 a[36:39], v[68:71], v[100:103], a[36:39]
    ds_read_b64_tr_b16 v[16:17], v132 offset:32768
    v_mfma_f32_16x16x32_bf16 a[40:43], v[72:75], v[100:103], a[40:43]
    ds_read_b64_tr_b16 v[18:19], v132 offset:40960
    v_mfma_f32_16x16x32_bf16 a[44:47], v[76:79], v[100:103], a[44:47]
    ds_read_b64_tr_b16 v[20:21], v133 offset:32768
    v_mfma_f32_16x16x32_bf16 a[48:51], v[80:83], v[100:103], a[48:51]
    ds_read_b64_tr_b16 v[22:23], v133 offset:40960
    v_mfma_f32_16x16x32_bf16 a[52:55], v[84:87], v[100:103], a[52:55]
    ds_read_b64_tr_b16 v[24:25], v134 offset:32768
    v_mfma_f32_16x16x32_bf16 a[56:59], v[88:91], v[100:103], a[56:59]
    ds_read_b64_tr_b16 v[26:27], v134 offset:40960
    v_mfma_f32_16x16x32_bf16 a[60:63], v[92:95], v[100:103], a[60:63]
    ds_read_b64_tr_b16 v[28:29], v135 offset:32768
    v_mfma_f32_16x16x32_bf16 a[64:67], v[64:67], v[104:107], a[64:67]
    ds_read_b64_tr_b16 v[30:31], v135 offset:40960
    v_mfma_f32_16x16x32_bf16 a[68:71], v[68:71], v[104:107], a[68:71]
    ds_read_b128 v[36:39], v136 offset:33792
    v_mfma_f32_16x16x32_bf16 a[72:75], v[72:75], v[104:107], a[72:75]
    ds_read_b128 v[40:43], v136 offset:34816
    v_mfma_f32_16x16x32_bf16 a[76:79], v[76:79], v[104:107], a[76:79]
    ds_read_b128 v[44:47], v136 offset:35840
    v_mfma_f32_16x16x32_bf16 a[80:83], v[80:83], v[104:107], a[80:83]
    ds_read_b128 v[48:51], v136 offset:36864
    v_mfma_f32_16x16x32_bf16 a[84:87], v[84:87], v[104:107], a[84:87]
    ds_read_b128 v[52:55], v136 offset:37888
    v_mfma_f32_16x16x32_bf16 a[88:91], v[88:91], v[104:107], a[88:91]
    ds_read_b128 v[56:59], v136 offset:38912
    v_mfma_f32_16x16x32_bf16 a[92:95], v[92:95], v[104:107], a[92:95]
    ds_read_b128 v[60:63], v136 offset:39936
    v_mfma_f32_16x16x32_bf16 a[96:99], v[64:67], v[108:111], a[96:99]
    v_mfma_f32_16x16x32_bf16 a[100:103], v[68:71], v[108:111], a[100:103]
    v_mfma_f32_16x16x32_bf16 a[104:107], v[72:75], v[108:111], a[104:107]
    v_mfma_f32_16x16x32_bf16 a[108:111], v[76:79], v[108:111], a[108:111]
    v_mfma_f32_16x16x32_bf16 a[112:115], v[80:83], v[108:111], a[112:115]
    v_mfma_f32_16x16x32_bf16 a[116:119], v[84:87], v[108:111], a[116:119]
    v_mfma_f32_16x16x32_bf16 a[120:123], v[88:91], v[108:111], a[120:123]
    v_mfma_f32_16x16x32_bf16 a[124:127], v[92:95], v[108:111], a[124:127]
    v_mfma_f32_16x16x32_bf16 a[128:131], v[64:67], v[112:115], a[128:131]
    v_mfma_f32_16x16x32_bf16 a[132:135], v[68:71], v[112:115], a[132:135]
    v_mfma_f32_16x16x32_bf16 a[136:139], v[72:75], v[112:115], a[136:139]
    v_mfma_f32_16x16x32_bf16 a[140:143], v[76:79], v[112:115], a[140:143]
    v_mfma_f32_16x16x32_bf16 a[144:147], v[80:83], v[112:115], a[144:147]
    v_mfma_f32_16x16x32_bf16 a[148:151], v[84:87], v[112:115], a[148:151]
    v_mfma_f32_16x16x32_bf16 a[152:155], v[88:91], v[112:115], a[152:155]
    v_mfma_f32_16x16x32_bf16 a[156:159], v[92:95], v[112:115], a[156:159]
    v_mfma_f32_16x16x32_bf16 a[160:163], v[64:67], v[116:119], a[160:163]
    v_mfma_f32_16x16x32_bf16 a[164:167], v[68:71], v[116:119], a[164:167]
    v_mfma_f32_16x16x32_bf16 a[168:171], v[72:75], v[116:119], a[168:171]
    v_mfma_f32_16x16x32_bf16 a[172:175], v[76:79], v[116:119], a[172:175]
    v_mfma_f32_16x16x32_bf16 a[176:179], v[80:83], v[116:119], a[176:179]
    v_mfma_f32_16x16x32_bf16 a[180:183], v[84:87], v[116:119], a[180:183]
    v_mfma_f32_16x16x32_bf16 a[184:187], v[88:91], v[116:119], a[184:187]
    v_mfma_f32_16x16x32_bf16 a[188:191], v[92:95], v[116:119], a[188:191]
    v_mfma_f32_16x16x32_bf16 a[192:195], v[64:67], v[120:123], a[192:195]
    v_mfma_f32_16x16x32_bf16 a[196:199], v[68:71], v[120:123], a[196:199]
    v_mfma_f32_16x16x32_bf16 a[200:203], v[72:75], v[120:123], a[200:203]
    v_mfma_f32_16x16x32_bf16 a[204:207], v[76:79], v[120:123], a[204:207]
    v_mfma_f32_16x16x32_bf16 a[208:211], v[80:83], v[120:123], a[208:211]
    v_mfma_f32_16x16x32_bf16 a[212:215], v[84:87], v[120:123], a[212:215]
    v_mfma_f32_16x16x32_bf16 a[216:219], v[88:91], v[120:123], a[216:219]
    v_mfma_f32_16x16x32_bf16 a[220:223], v[92:95], v[120:123], a[220:223]
    v_mfma_f32_16x16x32_bf16 a[224:227], v[64:67], v[124:127], a[224:227]
    v_mfma_f32_16x16x32_bf16 a[228:231], v[68:71], v[124:127], a[228:231]
    v_mfma_f32_16x16x32_bf16 a[232:235], v[72:75], v[124:127], a[232:235]
    v_mfma_f32_16x16x32_bf16 a[236:239], v[76:79], v[124:127], a[236:239]
    v_mfma_f32_16x16x32_bf16 a[240:243], v[80:83], v[124:127], a[240:243]
    v_mfma_f32_16x16x32_bf16 a[244:247], v[84:87], v[124:127], a[244:247]
    v_mfma_f32_16x16x32_bf16 a[248:251], v[88:91], v[124:127], a[248:251]
    v_mfma_f32_16x16x32_bf16 a[252:255], v[92:95], v[124:127], a[252:255]
    s_waitcnt lgkmcnt(0)
    v_mfma_f32_16x16x32_bf16 a[0:3], v[0:3], v[32:35], a[0:3]
    s_waitcnt vmcnt(0)
    s_barrier
    ds_read_b128 v[96:99], v136 offset:49152
    v_mfma_f32_16x16x32_bf16 a[4:7], v[4:7], v[32:35], a[4:7]
    ds_read_b64_tr_b16 v[64:65], v128 offset:49152
    v_mfma_f32_16x16x32_bf16 a[8:11], v[8:11], v[32:35], a[8:11]
    ds_read_b64_tr_b16 v[66:67], v128 offset:57344
    v_mfma_f32_16x16x32_bf16 a[12:15], v[12:15], v[32:35], a[12:15]
    ds_read_b64_tr_b16 v[68:69], v129 offset:49152
    v_mfma_f32_16x16x32_bf16 a[16:19], v[16:19], v[32:35], a[16:19]
    ds_read_b64_tr_b16 v[70:71], v129 offset:57344
    v_mfma_f32_16x16x32_bf16 a[20:23], v[20:23], v[32:35], a[20:23]
    ds_read_b64_tr_b16 v[72:73], v130 offset:49152
    v_mfma_f32_16x16x32_bf16 a[24:27], v[24:27], v[32:35], a[24:27]
    ds_read_b64_tr_b16 v[74:75], v130 offset:57344
    v_mfma_f32_16x16x32_bf16 a[28:31], v[28:31], v[32:35], a[28:31]
    ds_read_b64_tr_b16 v[76:77], v131 offset:49152
    v_mfma_f32_16x16x32_bf16 a[32:35], v[0:3], v[36:39], a[32:35]
    ds_read_b64_tr_b16 v[78:79], v131 offset:57344
    v_mfma_f32_16x16x32_bf16 a[36:39], v[4:7], v[36:39], a[36:39]
    ds_read_b64_tr_b16 v[80:81], v132 offset:49152
    v_mfma_f32_16x16x32_bf16 a[40:43], v[8:11], v[36:39], a[40:43]
    ds_read_b64_tr_b16 v[82:83], v132 offset:57344
    v_mfma_f32_16x16x32_bf16 a[44:47], v[12:15], v[36:39], a[44:47]
    ds_read_b64_tr_b16 v[84:85], v133 offset:49152
    v_mfma_f32_16x16x32_bf16 a[48:51], v[16:19], v[36:39], a[48:51]
    ds_read_b64_tr_b16 v[86:87], v133 offset:57344
    v_mfma_f32_16x16x32_bf16 a[52:55], v[20:23], v[36:39], a[52:55]
    ds_read_b64_tr_b16 v[88:89], v134 offset:49152
    v_mfma_f32_16x16x32_bf16 a[56:59], v[24:27], v[36:39], a[56:59]
    ds_read_b64_tr_b16 v[90:91], v134 offset:57344
    v_mfma_f32_16x16x32_bf16 a[60:63], v[28:31], v[36:39], a[60:63]
    ds_read_b64_tr_b16 v[92:93], v135 offset:49152
    v_mfma_f32_16x16x32_bf16 a[64:67], v[0:3], v[40:43], a[64:67]
    ds_read_b64_tr_b16 v[94:95], v135 offset:57344
    v_mfma_f32_16x16x32_bf16 a[68:71], v[4:7], v[40:43], a[68:71]
    ds_read_b128 v[100:103], v136 offset:50176
    v_mfma_f32_16x16x32_bf16 a[72:75], v[8:11], v[40:43], a[72:75]
    ds_read_b128 v[104:107], v136 offset:51200
    v_mfma_f32_16x16x32_bf16 a[76:79], v[12:15], v[40:43], a[76:79]
    ds_read_b128 v[108:111], v136 offset:52224
    v_mfma_f32_16x16x32_bf16 a[80:83], v[16:19], v[40:43], a[80:83]
    ds_read_b128 v[112:115], v136 offset:53248
    v_mfma_f32_16x16x32_bf16 a[84:87], v[20:23], v[40:43], a[84:87]
    ds_read_b128 v[116:119], v136 offset:54272
    v_mfma_f32_16x16x32_bf16 a[88:91], v[24:27], v[40:43], a[88:91]
    ds_read_b128 v[120:123], v136 offset:55296
    v_mfma_f32_16x16x32_bf16 a[92:95], v[28:31], v[40:43], a[92:95]
    ds_read_b128 v[124:127], v136 offset:56320
    v_mfma_f32_16x16x32_bf16 a[96:99], v[0:3], v[44:47], a[96:99]
    v_mfma_f32_16x16x32_bf16 a[100:103], v[4:7], v[44:47], a[100:103]
    v_mfma_f32_16x16x32_bf16 a[104:107], v[8:11], v[44:47], a[104:107]
    v_mfma_f32_16x16x32_bf16 a[108:111], v[12:15], v[44:47], a[108:111]
    v_mfma_f32_16x16x32_bf16 a[112:115], v[16:19], v[44:47], a[112:115]
    v_mfma_f32_16x16x32_bf16 a[116:119], v[20:23], v[44:47], a[116:119]
    v_mfma_f32_16x16x32_bf16 a[120:123], v[24:27], v[44:47], a[120:123]
    v_mfma_f32_16x16x32_bf16 a[124:127], v[28:31], v[44:47], a[124:127]
    v_mfma_f32_16x16x32_bf16 a[128:131], v[0:3], v[48:51], a[128:131]
    v_mfma_f32_16x16x32_bf16 a[132:135], v[4:7], v[48:51], a[132:135]
    v_mfma_f32_16x16x32_bf16 a[136:139], v[8:11], v[48:51], a[136:139]
    v_mfma_f32_16x16x32_bf16 a[140:143], v[12:15], v[48:51], a[140:143]
    v_mfma_f32_16x16x32_bf16 a[144:147], v[16:19], v[48:51], a[144:147]
    v_mfma_f32_16x16x32_bf16 a[148:151], v[20:23], v[48:51], a[148:151]
    v_mfma_f32_16x16x32_bf16 a[152:155], v[24:27], v[48:51], a[152:155]
    v_mfma_f32_16x16x32_bf16 a[156:159], v[28:31], v[48:51], a[156:159]
    v_mfma_f32_16x16x32_bf16 a[160:163], v[0:3], v[52:55], a[160:163]
    v_mfma_f32_16x16x32_bf16 a[164:167], v[4:7], v[52:55], a[164:167]
    v_mfma_f32_16x16x32_bf16 a[168:171], v[8:11], v[52:55], a[168:171]
    v_mfma_f32_16x16x32_bf16 a[172:175], v[12:15], v[52:55], a[172:175]
    v_mfma_f32_16x16x32_bf16 a[176:179], v[16:19], v[52:55], a[176:179]
    v_mfma_f32_16x16x32_bf16 a[180:183], v[20:23], v[52:55], a[180:183]
    v_mfma_f32_16x16x32_bf16 a[184:187], v[24:27], v[52:55], a[184:187]
    v_mfma_f32_16x16x32_bf16 a[188:191], v[28:31], v[52:55], a[188:191]
    v_mfma_f32_16x16x32_bf16 a[192:195], v[0:3], v[56:59], a[192:195]
    v_mfma_f32_16x16x32_bf16 a[196:199], v[4:7], v[56:59], a[196:199]
    v_mfma_f32_16x16x32_bf16 a[200:203], v[8:11], v[56:59], a[200:203]
    v_mfma_f32_16x16x32_bf16 a[204:207], v[12:15], v[56:59], a[204:207]
    v_mfma_f32_16x16x32_bf16 a[208:211], v[16:19], v[56:59], a[208:211]
    v_mfma_f32_16x16x32_bf16 a[212:215], v[20:23], v[56:59], a[212:215]
    v_mfma_f32_16x16x32_bf16 a[216:219], v[24:27], v[56:59], a[216:219]
    v_mfma_f32_16x16x32_bf16 a[220:223], v[28:31], v[56:59], a[220:223]
    v_mfma_f32_16x16x32_bf16 a[224:227], v[0:3], v[60:63], a[224:227]
    v_mfma_f32_16x16x32_bf16 a[228:231], v[4:7], v[60:63], a[228:231]
    v_mfma_f32_16x16x32_bf16 a[232:235], v[8:11], v[60:63], a[232:235]
    v_mfma_f32_16x16x32_bf16 a[236:239], v[12:15], v[60:63], a[236:239]
    v_mfma_f32_16x16x32_bf16 a[240:243], v[16:19], v[60:63], a[240:243]
    v_mfma_f32_16x16x32_bf16 a[244:247], v[20:23], v[60:63], a[244:247]
    v_mfma_f32_16x16x32_bf16 a[248:251], v[24:27], v[60:63], a[248:251]
    v_mfma_f32_16x16x32_bf16 a[252:255], v[28:31], v[60:63], a[252:255]
    v_readfirstlane_b32 s55, v255
    s_waitcnt lgkmcnt(0)
    v_mfma_f32_16x16x32_bf16 a[0:3], v[64:67], v[96:99], a[0:3]
    v_mfma_f32_16x16x32_bf16 a[4:7], v[68:71], v[96:99], a[4:7]
    v_mfma_f32_16x16x32_bf16 a[8:11], v[72:75], v[96:99], a[8:11]
    v_mfma_f32_16x16x32_bf16 a[12:15], v[76:79], v[96:99], a[12:15]
    v_mfma_f32_16x16x32_bf16 a[16:19], v[80:83], v[96:99], a[16:19]
    v_mfma_f32_16x16x32_bf16 a[20:23], v[84:87], v[96:99], a[20:23]
    v_mfma_f32_16x16x32_bf16 a[24:27], v[88:91], v[96:99], a[24:27]
    v_mfma_f32_16x16x32_bf16 a[28:31], v[92:95], v[96:99], a[28:31]
    v_mfma_f32_16x16x32_bf16 a[32:35], v[64:67], v[100:103], a[32:35]
    v_mfma_f32_16x16x32_bf16 a[36:39], v[68:71], v[100:103], a[36:39]
    v_mfma_f32_16x16x32_bf16 a[40:43], v[72:75], v[100:103], a[40:43]
    v_mfma_f32_16x16x32_bf16 a[44:47], v[76:79], v[100:103], a[44:47]
    v_mfma_f32_16x16x32_bf16 a[48:51], v[80:83], v[100:103], a[48:51]
    v_mfma_f32_16x16x32_bf16 a[52:55], v[84:87], v[100:103], a[52:55]
    v_mfma_f32_16x16x32_bf16 a[56:59], v[88:91], v[100:103], a[56:59]
    v_mfma_f32_16x16x32_bf16 a[60:63], v[92:95], v[100:103], a[60:63]
    v_mfma_f32_16x16x32_bf16 a[64:67], v[64:67], v[104:107], a[64:67]
    v_mfma_f32_16x16x32_bf16 a[68:71], v[68:71], v[104:107], a[68:71]
    v_mfma_f32_16x16x32_bf16 a[72:75], v[72:75], v[104:107], a[72:75]
    v_mfma_f32_16x16x32_bf16 a[76:79], v[76:79], v[104:107], a[76:79]
    v_mfma_f32_16x16x32_bf16 a[80:83], v[80:83], v[104:107], a[80:83]
    v_mfma_f32_16x16x32_bf16 a[84:87], v[84:87], v[104:107], a[84:87]
    v_mfma_f32_16x16x32_bf16 a[88:91], v[88:91], v[104:107], a[88:91]
    v_mfma_f32_16x16x32_bf16 a[92:95], v[92:95], v[104:107], a[92:95]
    v_mfma_f32_16x16x32_bf16 a[96:99], v[64:67], v[108:111], a[96:99]
    v_mfma_f32_16x16x32_bf16 a[100:103], v[68:71], v[108:111], a[100:103]
    v_mfma_f32_16x16x32_bf16 a[104:107], v[72:75], v[108:111], a[104:107]
    v_mfma_f32_16x16x32_bf16 a[108:111], v[76:79], v[108:111], a[108:111]
    v_mfma_f32_16x16x32_bf16 a[112:115], v[80:83], v[108:111], a[112:115]
    v_mfma_f32_16x16x32_bf16 a[116:119], v[84:87], v[108:111], a[116:119]
    v_mfma_f32_16x16x32_bf16 a[120:123], v[88:91], v[108:111], a[120:123]
    v_mfma_f32_16x16x32_bf16 a[124:127], v[92:95], v[108:111], a[124:127]
    v_mfma_f32_16x16x32_bf16 a[128:131], v[64:67], v[112:115], a[128:131]
    v_mfma_f32_16x16x32_bf16 a[132:135], v[68:71], v[112:115], a[132:135]
    v_mfma_f32_16x16x32_bf16 a[136:139], v[72:75], v[112:115], a[136:139]
    v_mfma_f32_16x16x32_bf16 a[140:143], v[76:79], v[112:115], a[140:143]
    v_mfma_f32_16x16x32_bf16 a[144:147], v[80:83], v[112:115], a[144:147]
    v_mfma_f32_16x16x32_bf16 a[148:151], v[84:87], v[112:115], a[148:151]
    v_mfma_f32_16x16x32_bf16 a[152:155], v[88:91], v[112:115], a[152:155]
    v_mfma_f32_16x16x32_bf16 a[156:159], v[92:95], v[112:115], a[156:159]
    v_mfma_f32_16x16x32_bf16 a[160:163], v[64:67], v[116:119], a[160:163]
    v_mfma_f32_16x16x32_bf16 a[164:167], v[68:71], v[116:119], a[164:167]
    v_mfma_f32_16x16x32_bf16 a[168:171], v[72:75], v[116:119], a[168:171]
    v_mfma_f32_16x16x32_bf16 a[172:175], v[76:79], v[116:119], a[172:175]
    v_mfma_f32_16x16x32_bf16 a[176:179], v[80:83], v[116:119], a[176:179]
    v_mfma_f32_16x16x32_bf16 a[180:183], v[84:87], v[116:119], a[180:183]
    v_mfma_f32_16x16x32_bf16 a[184:187], v[88:91], v[116:119], a[184:187]
    v_mfma_f32_16x16x32_bf16 a[188:191], v[92:95], v[116:119], a[188:191]
    v_mfma_f32_16x16x32_bf16 a[192:195], v[64:67], v[120:123], a[192:195]
    v_mfma_f32_16x16x32_bf16 a[196:199], v[68:71], v[120:123], a[196:199]
    v_mfma_f32_16x16x32_bf16 a[200:203], v[72:75], v[120:123], a[200:203]
    v_mfma_f32_16x16x32_bf16 a[204:207], v[76:79], v[120:123], a[204:207]
    v_mfma_f32_16x16x32_bf16 a[208:211], v[80:83], v[120:123], a[208:211]
    v_mfma_f32_16x16x32_bf16 a[212:215], v[84:87], v[120:123], a[212:215]
    v_mfma_f32_16x16x32_bf16 a[216:219], v[88:91], v[120:123], a[216:219]
    v_mfma_f32_16x16x32_bf16 a[220:223], v[92:95], v[120:123], a[220:223]
    v_mfma_f32_16x16x32_bf16 a[224:227], v[64:67], v[124:127], a[224:227]
    v_mfma_f32_16x16x32_bf16 a[228:231], v[68:71], v[124:127], a[228:231]
    v_mfma_f32_16x16x32_bf16 a[232:235], v[72:75], v[124:127], a[232:235]
    v_mfma_f32_16x16x32_bf16 a[236:239], v[76:79], v[124:127], a[236:239]
    v_mfma_f32_16x16x32_bf16 a[240:243], v[80:83], v[124:127], a[240:243]
    v_mfma_f32_16x16x32_bf16 a[244:247], v[84:87], v[124:127], a[244:247]
    v_mfma_f32_16x16x32_bf16 a[248:251], v[88:91], v[124:127], a[248:251]
    v_mfma_f32_16x16x32_bf16 a[252:255], v[92:95], v[124:127], a[252:255]
    s_nop 7
    s_cmp_eq_u32 s23, 1
    s_cbranch_scc1 main_kernel_w_c2_escl
    s_cmp_eq_u32 s23, 6
    s_cbranch_scc1 main_kernel_w_c2_egelu
main_kernel_w_c2_eplain:
    s_mov_b32 s53, s21
    v_accvgpr_read_b32 v0, a0
    v_accvgpr_read_b32 v1, a1
    v_accvgpr_read_b32 v2, a2
    v_accvgpr_read_b32 v3, a3
    v_accvgpr_read_b32 v4, a4
    v_accvgpr_read_b32 v5, a5
    v_accvgpr_read_b32 v6, a6
    v_accvgpr_read_b32 v7, a7
    v_cvt_pk_bf16_f32 v16, v0, v1
    v_cvt_pk_bf16_f32 v17, v2, v3
    v_cvt_pk_bf16_f32 v18, v4, v5
    v_cvt_pk_bf16_f32 v19, v6, v7
    buffer_store_dwordx4 v[16:19], v251, s[4:7], s53 offen offset:0 sc1
    v_accvgpr_read_b32 v20, a8
    v_accvgpr_read_b32 v21, a9
    v_accvgpr_read_b32 v22, a10
    v_accvgpr_read_b32 v23, a11
    v_accvgpr_read_b32 v24, a12
    v_accvgpr_read_b32 v25, a13
    v_accvgpr_read_b32 v26, a14
    v_accvgpr_read_b32 v27, a15
    v_cvt_pk_bf16_f32 v36, v20, v21
    v_cvt_pk_bf16_f32 v37, v22, v23
    v_cvt_pk_bf16_f32 v38, v24, v25
    v_cvt_pk_bf16_f32 v39, v26, v27
    buffer_store_dwordx4 v[36:39], v251, s[4:7], s53 offen offset:1024 sc1
    v_accvgpr_read_b32 v40, a16
    v_accvgpr_read_b32 v41, a17
    v_accvgpr_read_b32 v42, a18
    v_accvgpr_read_b32 v43, a19
    v_accvgpr_read_b32 v44, a20
    v_accvgpr_read_b32 v45, a21
    v_accvgpr_read_b32 v46, a22
    v_accvgpr_read_b32 v47, a23
    v_cvt_pk_bf16_f32 v56, v40, v41
    v_cvt_pk_bf16_f32 v57, v42, v43
    v_cvt_pk_bf16_f32 v58, v44, v45
    v_cvt_pk_bf16_f32 v59, v46, v47
    buffer_store_dwordx4 v[56:59], v251, s[4:7], s53 offen offset:2048 sc1
    v_accvgpr_read_b32 v0, a24
    v_accvgpr_read_b32 v1, a25
    v_accvgpr_read_b32 v2, a26
    v_accvgpr_read_b32 v3, a27
    v_accvgpr_read_b32 v4, a28
    v_accvgpr_read_b32 v5, a29
    v_accvgpr_read_b32 v6, a30
    v_accvgpr_read_b32 v7, a31
    v_cvt_pk_bf16_f32 v16, v0, v1
    v_cvt_pk_bf16_f32 v17, v2, v3
    v_cvt_pk_bf16_f32 v18, v4, v5
    v_cvt_pk_bf16_f32 v19, v6, v7
    buffer_store_dwordx4 v[16:19], v251, s[4:7], s53 offen offset:3072 sc1
    s_add_u32 s53, s53, s22
    v_accvgpr_read_b32 v20, a32
    v_accvgpr_read_b32 v21, a33
    v_accvgpr_read_b32 v22, a34
    v_accvgpr_read_b32 v23, a35
    v_accvgpr_read_b32 v24, a36
    v_accvgpr_read_b32 v25, a37
    v_accvgpr_read_b32 v26, a38
    v_accvgpr_read_b32 v27, a39
    v_cvt_pk_bf16_f32 v36, v20, v21
    v_cvt_pk_bf16_f32 v37, v22, v23
    v_cvt_pk_bf16_f32 v38, v24, v25
    v_cvt_pk_bf16_f32 v39, v26, v27
    buffer_store_dwordx4 v[36:39], v251, s[4:7], s53 offen offset:0 sc1
    v_accvgpr_read_b32 v40, a40
    v_accvgpr_read_b32 v41, a41
    v_accvgpr_read_b32 v42, a42
    v_accvgpr_read_b32 v43, a43
    v_accvgpr_read_b32 v44, a44
    v_accvgpr_read_b32 v45, a45
    v_accvgpr_read_b32 v46, a46
    v_accvgpr_read_b32 v47, a47
    v_cvt_pk_bf16_f32 v56, v40, v41
    v_cvt_pk_bf16_f32 v57, v42, v43
    v_cvt_pk_bf16_f32 v58, v44, v45
    v_cvt_pk_bf16_f32 v59, v46, v47
    buffer_store_dwordx4 v[56:59], v251, s[4:7], s53 offen offset:1024 sc1
    v_accvgpr_read_b32 v0, a48
    v_accvgpr_read_b32 v1, a49
    v_accvgpr_read_b32 v2, a50
    v_accvgpr_read_b32 v3, a51
    v_accvgpr_read_b32 v4, a52
    v_accvgpr_read_b32 v5, a53
    v_accvgpr_read_b32 v6, a54
    v_accvgpr_read_b32 v7, a55
    v_cvt_pk_bf16_f32 v16, v0, v1
    v_cvt_pk_bf16_f32 v17, v2, v3
    v_cvt_pk_bf16_f32 v18, v4, v5
    v_cvt_pk_bf16_f32 v19, v6, v7
    buffer_store_dwordx4 v[16:19], v251, s[4:7], s53 offen offset:2048 sc1
    v_accvgpr_read_b32 v20, a56
    v_accvgpr_read_b32 v21, a57
    v_accvgpr_read_b32 v22, a58
    v_accvgpr_read_b32 v23, a59
    v_accvgpr_read_b32 v24, a60
    v_accvgpr_read_b32 v25, a61
    v_accvgpr_read_b32 v26, a62
    v_accvgpr_read_b32 v27, a63
    v_cvt_pk_bf16_f32 v36, v20, v21
    v_cvt_pk_bf16_f32 v37, v22, v23
    v_cvt_pk_bf16_f32 v38, v24, v25
    v_cvt_pk_bf16_f32 v39, v26, v27
    buffer_store_dwordx4 v[36:39], v251, s[4:7], s53 offen offset:3072 sc1
    s_add_u32 s53, s53, s22
    v_accvgpr_read_b32 v40, a64
    v_accvgpr_read_b32 v41, a65
    v_accvgpr_read_b32 v42, a66
    v_accvgpr_read_b32 v43, a67
    v_accvgpr_read_b32 v44, a68
    v_accvgpr_read_b32 v45, a69
    v_accvgpr_read_b32 v46, a70
    v_accvgpr_read_b32 v47, a71
    v_cvt_pk_bf16_f32 v56, v40, v41
    v_cvt_pk_bf16_f32 v57, v42, v43
    v_cvt_pk_bf16_f32 v58, v44, v45
    v_cvt_pk_bf16_f32 v59, v46, v47
    buffer_store_dwordx4 v[56:59], v251, s[4:7], s53 offen offset:0 sc1
    v_accvgpr_read_b32 v0, a72
    v_accvgpr_read_b32 v1, a73
    v_accvgpr_read_b32 v2, a74
    v_accvgpr_read_b32 v3, a75
    v_accvgpr_read_b32 v4, a76
    v_accvgpr_read_b32 v5, a77
    v_accvgpr_read_b32 v6, a78
    v_accvgpr_read_b32 v7, a79
    v_cvt_pk_bf16_f32 v16, v0, v1
    v_cvt_pk_bf16_f32 v17, v2, v3
    v_cvt_pk_bf16_f32 v18, v4, v5
    v_cvt_pk_bf16_f32 v19, v6, v7
    buffer_store_dwordx4 v[16:19], v251, s[4:7], s53 offen offset:1024 sc1
    v_accvgpr_read_b32 v20, a80
    v_accvgpr_read_b32 v21, a81
    v_accvgpr_read_b32 v22, a82
    v_accvgpr_read_b32 v23, a83
    v_accvgpr_read_b32 v24, a84
    v_accvgpr_read_b32 v25, a85
    v_accvgpr_read_b32 v26, a86
    v_accvgpr_read_b32 v27, a87
    v_cvt_pk_bf16_f32 v36, v20, v21
    v_cvt_pk_bf16_f32 v37, v22, v23
    v_cvt_pk_bf16_f32 v38, v24, v25
    v_cvt_pk_bf16_f32 v39, v26, v27
    buffer_store_dwordx4 v[36:39], v251, s[4:7], s53 offen offset:2048 sc1
    v_accvgpr_read_b32 v40, a88
    v_accvgpr_read_b32 v41, a89
    v_accvgpr_read_b32 v42, a90
    v_accvgpr_read_b32 v43, a91
    v_accvgpr_read_b32 v44, a92
    v_accvgpr_read_b32 v45, a93
    v_accvgpr_read_b32 v46, a94
    v_accvgpr_read_b32 v47, a95
    v_cvt_pk_bf16_f32 v56, v40, v41
    v_cvt_pk_bf16_f32 v57, v42, v43
    v_cvt_pk_bf16_f32 v58, v44, v45
    v_cvt_pk_bf16_f32 v59, v46, v47
    buffer_store_dwordx4 v[56:59], v251, s[4:7], s53 offen offset:3072 sc1
    s_add_u32 s53, s53, s22
    v_accvgpr_read_b32 v0, a96
    v_accvgpr_read_b32 v1, a97
    v_accvgpr_read_b32 v2, a98
    v_accvgpr_read_b32 v3, a99
    v_accvgpr_read_b32 v4, a100
    v_accvgpr_read_b32 v5, a101
    v_accvgpr_read_b32 v6, a102
    v_accvgpr_read_b32 v7, a103
    v_cvt_pk_bf16_f32 v16, v0, v1
    v_cvt_pk_bf16_f32 v17, v2, v3
    v_cvt_pk_bf16_f32 v18, v4, v5
    v_cvt_pk_bf16_f32 v19, v6, v7
    buffer_store_dwordx4 v[16:19], v251, s[4:7], s53 offen offset:0 sc1
    v_accvgpr_read_b32 v20, a104
    v_accvgpr_read_b32 v21, a105
    v_accvgpr_read_b32 v22, a106
    v_accvgpr_read_b32 v23, a107
    v_accvgpr_read_b32 v24, a108
    v_accvgpr_read_b32 v25, a109
    v_accvgpr_read_b32 v26, a110
    v_accvgpr_read_b32 v27, a111
    v_cvt_pk_bf16_f32 v36, v20, v21
    v_cvt_pk_bf16_f32 v37, v22, v23
    v_cvt_pk_bf16_f32 v38, v24, v25
    v_cvt_pk_bf16_f32 v39, v26, v27
    buffer_store_dwordx4 v[36:39], v251, s[4:7], s53 offen offset:1024 sc1
    v_accvgpr_read_b32 v40, a112
    v_accvgpr_read_b32 v41, a113
    v_accvgpr_read_b32 v42, a114
    v_accvgpr_read_b32 v43, a115
    v_accvgpr_read_b32 v44, a116
    v_accvgpr_read_b32 v45, a117
    v_accvgpr_read_b32 v46, a118
    v_accvgpr_read_b32 v47, a119
    v_cvt_pk_bf16_f32 v56, v40, v41
    v_cvt_pk_bf16_f32 v57, v42, v43
    v_cvt_pk_bf16_f32 v58, v44, v45
    v_cvt_pk_bf16_f32 v59, v46, v47
    buffer_store_dwordx4 v[56:59], v251, s[4:7], s53 offen offset:2048 sc1
    v_accvgpr_read_b32 v0, a120
    v_accvgpr_read_b32 v1, a121
    v_accvgpr_read_b32 v2, a122
    v_accvgpr_read_b32 v3, a123
    v_accvgpr_read_b32 v4, a124
    v_accvgpr_read_b32 v5, a125
    v_accvgpr_read_b32 v6, a126
    v_accvgpr_read_b32 v7, a127
    v_cvt_pk_bf16_f32 v16, v0, v1
    v_cvt_pk_bf16_f32 v17, v2, v3
    v_cvt_pk_bf16_f32 v18, v4, v5
    v_cvt_pk_bf16_f32 v19, v6, v7
    buffer_store_dwordx4 v[16:19], v251, s[4:7], s53 offen offset:3072 sc1
    s_add_u32 s53, s53, s22
    v_accvgpr_read_b32 v20, a128
    v_accvgpr_read_b32 v21, a129
    v_accvgpr_read_b32 v22, a130
    v_accvgpr_read_b32 v23, a131
    v_accvgpr_read_b32 v24, a132
    v_accvgpr_read_b32 v25, a133
    v_accvgpr_read_b32 v26, a134
    v_accvgpr_read_b32 v27, a135
    v_cvt_pk_bf16_f32 v36, v20, v21
    v_cvt_pk_bf16_f32 v37, v22, v23
    v_cvt_pk_bf16_f32 v38, v24, v25
    v_cvt_pk_bf16_f32 v39, v26, v27
    buffer_store_dwordx4 v[36:39], v251, s[4:7], s53 offen offset:0 sc1
    v_accvgpr_read_b32 v40, a136
    v_accvgpr_read_b32 v41, a137
    v_accvgpr_read_b32 v42, a138
    v_accvgpr_read_b32 v43, a139
    v_accvgpr_read_b32 v44, a140
    v_accvgpr_read_b32 v45, a141
    v_accvgpr_read_b32 v46, a142
    v_accvgpr_read_b32 v47, a143
    v_cvt_pk_bf16_f32 v56, v40, v41
    v_cvt_pk_bf16_f32 v57, v42, v43
    v_cvt_pk_bf16_f32 v58, v44, v45
    v_cvt_pk_bf16_f32 v59, v46, v47
    buffer_store_dwordx4 v[56:59], v251, s[4:7], s53 offen offset:1024 sc1
    v_accvgpr_read_b32 v0, a144
    v_accvgpr_read_b32 v1, a145
    v_accvgpr_read_b32 v2, a146
    v_accvgpr_read_b32 v3, a147
    v_accvgpr_read_b32 v4, a148
    v_accvgpr_read_b32 v5, a149
    v_accvgpr_read_b32 v6, a150
    v_accvgpr_read_b32 v7, a151
    v_cvt_pk_bf16_f32 v16, v0, v1
    v_cvt_pk_bf16_f32 v17, v2, v3
    v_cvt_pk_bf16_f32 v18, v4, v5
    v_cvt_pk_bf16_f32 v19, v6, v7
    buffer_store_dwordx4 v[16:19], v251, s[4:7], s53 offen offset:2048 sc1
    v_accvgpr_read_b32 v20, a152
    v_accvgpr_read_b32 v21, a153
    v_accvgpr_read_b32 v22, a154
    v_accvgpr_read_b32 v23, a155
    v_accvgpr_read_b32 v24, a156
    v_accvgpr_read_b32 v25, a157
    v_accvgpr_read_b32 v26, a158
    v_accvgpr_read_b32 v27, a159
    v_cvt_pk_bf16_f32 v36, v20, v21
    v_cvt_pk_bf16_f32 v37, v22, v23
    v_cvt_pk_bf16_f32 v38, v24, v25
    v_cvt_pk_bf16_f32 v39, v26, v27
    buffer_store_dwordx4 v[36:39], v251, s[4:7], s53 offen offset:3072 sc1
    s_add_u32 s53, s53, s22
    v_accvgpr_read_b32 v40, a160
    v_accvgpr_read_b32 v41, a161
    v_accvgpr_read_b32 v42, a162
    v_accvgpr_read_b32 v43, a163
    v_accvgpr_read_b32 v44, a164
    v_accvgpr_read_b32 v45, a165
    v_accvgpr_read_b32 v46, a166
    v_accvgpr_read_b32 v47, a167
    v_cvt_pk_bf16_f32 v56, v40, v41
    v_cvt_pk_bf16_f32 v57, v42, v43
    v_cvt_pk_bf16_f32 v58, v44, v45
    v_cvt_pk_bf16_f32 v59, v46, v47
    buffer_store_dwordx4 v[56:59], v251, s[4:7], s53 offen offset:0 sc1
    v_accvgpr_read_b32 v0, a168
    v_accvgpr_read_b32 v1, a169
    v_accvgpr_read_b32 v2, a170
    v_accvgpr_read_b32 v3, a171
    v_accvgpr_read_b32 v4, a172
    v_accvgpr_read_b32 v5, a173
    v_accvgpr_read_b32 v6, a174
    v_accvgpr_read_b32 v7, a175
    v_cvt_pk_bf16_f32 v16, v0, v1
    v_cvt_pk_bf16_f32 v17, v2, v3
    v_cvt_pk_bf16_f32 v18, v4, v5
    v_cvt_pk_bf16_f32 v19, v6, v7
    buffer_store_dwordx4 v[16:19], v251, s[4:7], s53 offen offset:1024 sc1
    v_accvgpr_read_b32 v20, a176
    v_accvgpr_read_b32 v21, a177
    v_accvgpr_read_b32 v22, a178
    v_accvgpr_read_b32 v23, a179
    v_accvgpr_read_b32 v24, a180
    v_accvgpr_read_b32 v25, a181
    v_accvgpr_read_b32 v26, a182
    v_accvgpr_read_b32 v27, a183
    v_cvt_pk_bf16_f32 v36, v20, v21
    v_cvt_pk_bf16_f32 v37, v22, v23
    v_cvt_pk_bf16_f32 v38, v24, v25
    v_cvt_pk_bf16_f32 v39, v26, v27
    buffer_store_dwordx4 v[36:39], v251, s[4:7], s53 offen offset:2048 sc1
    v_accvgpr_read_b32 v40, a184
    v_accvgpr_read_b32 v41, a185
    v_accvgpr_read_b32 v42, a186
    v_accvgpr_read_b32 v43, a187
    v_accvgpr_read_b32 v44, a188
    v_accvgpr_read_b32 v45, a189
    v_accvgpr_read_b32 v46, a190
    v_accvgpr_read_b32 v47, a191
    v_cvt_pk_bf16_f32 v56, v40, v41
    v_cvt_pk_bf16_f32 v57, v42, v43
    v_cvt_pk_bf16_f32 v58, v44, v45
    v_cvt_pk_bf16_f32 v59, v46, v47
    buffer_store_dwordx4 v[56:59], v251, s[4:7], s53 offen offset:3072 sc1
    s_add_u32 s53, s53, s22
    v_accvgpr_read_b32 v0, a192
    v_accvgpr_read_b32 v1, a193
    v_accvgpr_read_b32 v2, a194
    v_accvgpr_read_b32 v3, a195
    v_accvgpr_read_b32 v4, a196
    v_accvgpr_read_b32 v5, a197
    v_accvgpr_read_b32 v6, a198
    v_accvgpr_read_b32 v7, a199
    v_cvt_pk_bf16_f32 v16, v0, v1
    v_cvt_pk_bf16_f32 v17, v2, v3
    v_cvt_pk_bf16_f32 v18, v4, v5
    v_cvt_pk_bf16_f32 v19, v6, v7
    buffer_store_dwordx4 v[16:19], v251, s[4:7], s53 offen offset:0 sc1
    v_accvgpr_read_b32 v20, a200
    v_accvgpr_read_b32 v21, a201
    v_accvgpr_read_b32 v22, a202
    v_accvgpr_read_b32 v23, a203
    v_accvgpr_read_b32 v24, a204
    v_accvgpr_read_b32 v25, a205
    v_accvgpr_read_b32 v26, a206
    v_accvgpr_read_b32 v27, a207
    v_cvt_pk_bf16_f32 v36, v20, v21
    v_cvt_pk_bf16_f32 v37, v22, v23
    v_cvt_pk_bf16_f32 v38, v24, v25
    v_cvt_pk_bf16_f32 v39, v26, v27
    buffer_store_dwordx4 v[36:39], v251, s[4:7], s53 offen offset:1024 sc1
    v_accvgpr_read_b32 v40, a208
    v_accvgpr_read_b32 v41, a209
    v_accvgpr_read_b32 v42, a210
    v_accvgpr_read_b32 v43, a211
    v_accvgpr_read_b32 v44, a212
    v_accvgpr_read_b32 v45, a213
    v_accvgpr_read_b32 v46, a214
    v_accvgpr_read_b32 v47, a215
    v_cvt_pk_bf16_f32 v56, v40, v41
    v_cvt_pk_bf16_f32 v57, v42, v43
    v_cvt_pk_bf16_f32 v58, v44, v45
    v_cvt_pk_bf16_f32 v59, v46, v47
    buffer_store_dwordx4 v[56:59], v251, s[4:7], s53 offen offset:2048 sc1
    v_accvgpr_read_b32 v0, a216
    v_accvgpr_read_b32 v1, a217
    v_accvgpr_read_b32 v2, a218
    v_accvgpr_read_b32 v3, a219
    v_accvgpr_read_b32 v4, a220
    v_accvgpr_read_b32 v5, a221
    v_accvgpr_read_b32 v6, a222
    v_accvgpr_read_b32 v7, a223
    v_cvt_pk_bf16_f32 v16, v0, v1
    v_cvt_pk_bf16_f32 v17, v2, v3
    v_cvt_pk_bf16_f32 v18, v4, v5
    v_cvt_pk_bf16_f32 v19, v6, v7
    buffer_store_dwordx4 v[16:19], v251, s[4:7], s53 offen offset:3072 sc1
    s_add_u32 s53, s53, s22
    v_accvgpr_read_b32 v20, a224
    v_accvgpr_read_b32 v21, a225
    v_accvgpr_read_b32 v22, a226
    v_accvgpr_read_b32 v23, a227
    v_accvgpr_read_b32 v24, a228
    v_accvgpr_read_b32 v25, a229
    v_accvgpr_read_b32 v26, a230
    v_accvgpr_read_b32 v27, a231
    v_cvt_pk_bf16_f32 v36, v20, v21
    v_cvt_pk_bf16_f32 v37, v22, v23
    v_cvt_pk_bf16_f32 v38, v24, v25
    v_cvt_pk_bf16_f32 v39, v26, v27
    buffer_store_dwordx4 v[36:39], v251, s[4:7], s53 offen offset:0 sc1
    v_accvgpr_read_b32 v40, a232
    v_accvgpr_read_b32 v41, a233
    v_accvgpr_read_b32 v42, a234
    v_accvgpr_read_b32 v43, a235
    v_accvgpr_read_b32 v44, a236
    v_accvgpr_read_b32 v45, a237
    v_accvgpr_read_b32 v46, a238
    v_accvgpr_read_b32 v47, a239
    v_cvt_pk_bf16_f32 v56, v40, v41
    v_cvt_pk_bf16_f32 v57, v42, v43
    v_cvt_pk_bf16_f32 v58, v44, v45
    v_cvt_pk_bf16_f32 v59, v46, v47
    buffer_store_dwordx4 v[56:59], v251, s[4:7], s53 offen offset:1024 sc1
    v_accvgpr_read_b32 v0, a240
    v_accvgpr_read_b32 v1, a241
    v_accvgpr_read_b32 v2, a242
    v_accvgpr_read_b32 v3, a243
    v_accvgpr_read_b32 v4, a244
    v_accvgpr_read_b32 v5, a245
    v_accvgpr_read_b32 v6, a246
    v_accvgpr_read_b32 v7, a247
    v_cvt_pk_bf16_f32 v16, v0, v1
    v_cvt_pk_bf16_f32 v17, v2, v3
    v_cvt_pk_bf16_f32 v18, v4, v5
    v_cvt_pk_bf16_f32 v19, v6, v7
    buffer_store_dwordx4 v[16:19], v251, s[4:7], s53 offen offset:2048 sc1
    v_accvgpr_read_b32 v20, a248
    v_accvgpr_read_b32 v21, a249
    v_accvgpr_read_b32 v22, a250
    v_accvgpr_read_b32 v23, a251
    v_accvgpr_read_b32 v24, a252
    v_accvgpr_read_b32 v25, a253
    v_accvgpr_read_b32 v26, a254
    v_accvgpr_read_b32 v27, a255
    v_cvt_pk_bf16_f32 v36, v20, v21
    v_cvt_pk_bf16_f32 v37, v22, v23
    v_cvt_pk_bf16_f32 v38, v24, v25
    v_cvt_pk_bf16_f32 v39, v26, v27
    buffer_store_dwordx4 v[36:39], v251, s[4:7], s53 offen offset:3072 sc1
    s_branch main_kernel_w_done
main_kernel_w_c2_escl:
    s_mov_b32 s53, s21
    v_accvgpr_read_b32 v0, a0
    v_accvgpr_read_b32 v1, a1
    v_accvgpr_read_b32 v2, a2
    v_accvgpr_read_b32 v3, a3
    v_accvgpr_read_b32 v4, a4
    v_accvgpr_read_b32 v5, a5
    v_accvgpr_read_b32 v6, a6
    v_accvgpr_read_b32 v7, a7
    v_mul_f32 v0, 0x3e0293ee, v0
    v_mul_f32 v1, 0x3e0293ee, v1
    v_mul_f32 v2, 0x3e0293ee, v2
    v_mul_f32 v3, 0x3e0293ee, v3
    v_mul_f32 v4, 0x3e0293ee, v4
    v_mul_f32 v5, 0x3e0293ee, v5
    v_mul_f32 v6, 0x3e0293ee, v6
    v_mul_f32 v7, 0x3e0293ee, v7
    v_cvt_pk_bf16_f32 v16, v0, v1
    v_cvt_pk_bf16_f32 v17, v2, v3
    v_cvt_pk_bf16_f32 v18, v4, v5
    v_cvt_pk_bf16_f32 v19, v6, v7
    buffer_store_dwordx4 v[16:19], v251, s[4:7], s53 offen offset:0 sc1
    v_accvgpr_read_b32 v20, a8
    v_accvgpr_read_b32 v21, a9
    v_accvgpr_read_b32 v22, a10
    v_accvgpr_read_b32 v23, a11
    v_accvgpr_read_b32 v24, a12
    v_accvgpr_read_b32 v25, a13
    v_accvgpr_read_b32 v26, a14
    v_accvgpr_read_b32 v27, a15
    v_mul_f32 v20, 0x3e0293ee, v20
    v_mul_f32 v21, 0x3e0293ee, v21
    v_mul_f32 v22, 0x3e0293ee, v22
    v_mul_f32 v23, 0x3e0293ee, v23
    v_mul_f32 v24, 0x3e0293ee, v24
    v_mul_f32 v25, 0x3e0293ee, v25
    v_mul_f32 v26, 0x3e0293ee, v26
    v_mul_f32 v27, 0x3e0293ee, v27
    v_cvt_pk_bf16_f32 v36, v20, v21
    v_cvt_pk_bf16_f32 v37, v22, v23
    v_cvt_pk_bf16_f32 v38, v24, v25
    v_cvt_pk_bf16_f32 v39, v26, v27
    buffer_store_dwordx4 v[36:39], v251, s[4:7], s53 offen offset:1024 sc1
    v_accvgpr_read_b32 v40, a16
    v_accvgpr_read_b32 v41, a17
    v_accvgpr_read_b32 v42, a18
    v_accvgpr_read_b32 v43, a19
    v_accvgpr_read_b32 v44, a20
    v_accvgpr_read_b32 v45, a21
    v_accvgpr_read_b32 v46, a22
    v_accvgpr_read_b32 v47, a23
    v_mul_f32 v40, 0x3e0293ee, v40
    v_mul_f32 v41, 0x3e0293ee, v41
    v_mul_f32 v42, 0x3e0293ee, v42
    v_mul_f32 v43, 0x3e0293ee, v43
    v_mul_f32 v44, 0x3e0293ee, v44
    v_mul_f32 v45, 0x3e0293ee, v45
    v_mul_f32 v46, 0x3e0293ee, v46
    v_mul_f32 v47, 0x3e0293ee, v47
    v_cvt_pk_bf16_f32 v56, v40, v41
    v_cvt_pk_bf16_f32 v57, v42, v43
    v_cvt_pk_bf16_f32 v58, v44, v45
    v_cvt_pk_bf16_f32 v59, v46, v47
    buffer_store_dwordx4 v[56:59], v251, s[4:7], s53 offen offset:2048 sc1
    v_accvgpr_read_b32 v0, a24
    v_accvgpr_read_b32 v1, a25
    v_accvgpr_read_b32 v2, a26
    v_accvgpr_read_b32 v3, a27
    v_accvgpr_read_b32 v4, a28
    v_accvgpr_read_b32 v5, a29
    v_accvgpr_read_b32 v6, a30
    v_accvgpr_read_b32 v7, a31
    v_mul_f32 v0, 0x3e0293ee, v0
    v_mul_f32 v1, 0x3e0293ee, v1
    v_mul_f32 v2, 0x3e0293ee, v2
    v_mul_f32 v3, 0x3e0293ee, v3
    v_mul_f32 v4, 0x3e0293ee, v4
    v_mul_f32 v5, 0x3e0293ee, v5
    v_mul_f32 v6, 0x3e0293ee, v6
    v_mul_f32 v7, 0x3e0293ee, v7
    v_cvt_pk_bf16_f32 v16, v0, v1
    v_cvt_pk_bf16_f32 v17, v2, v3
    v_cvt_pk_bf16_f32 v18, v4, v5
    v_cvt_pk_bf16_f32 v19, v6, v7
    buffer_store_dwordx4 v[16:19], v251, s[4:7], s53 offen offset:3072 sc1
    s_add_u32 s53, s53, s22
    v_accvgpr_read_b32 v20, a32
    v_accvgpr_read_b32 v21, a33
    v_accvgpr_read_b32 v22, a34
    v_accvgpr_read_b32 v23, a35
    v_accvgpr_read_b32 v24, a36
    v_accvgpr_read_b32 v25, a37
    v_accvgpr_read_b32 v26, a38
    v_accvgpr_read_b32 v27, a39
    v_mul_f32 v20, 0x3e0293ee, v20
    v_mul_f32 v21, 0x3e0293ee, v21
    v_mul_f32 v22, 0x3e0293ee, v22
    v_mul_f32 v23, 0x3e0293ee, v23
    v_mul_f32 v24, 0x3e0293ee, v24
    v_mul_f32 v25, 0x3e0293ee, v25
    v_mul_f32 v26, 0x3e0293ee, v26
    v_mul_f32 v27, 0x3e0293ee, v27
    v_cvt_pk_bf16_f32 v36, v20, v21
    v_cvt_pk_bf16_f32 v37, v22, v23
    v_cvt_pk_bf16_f32 v38, v24, v25
    v_cvt_pk_bf16_f32 v39, v26, v27
    buffer_store_dwordx4 v[36:39], v251, s[4:7], s53 offen offset:0 sc1
    v_accvgpr_read_b32 v40, a40
    v_accvgpr_read_b32 v41, a41
    v_accvgpr_read_b32 v42, a42
    v_accvgpr_read_b32 v43, a43
    v_accvgpr_read_b32 v44, a44
    v_accvgpr_read_b32 v45, a45
    v_accvgpr_read_b32 v46, a46
    v_accvgpr_read_b32 v47, a47
    v_mul_f32 v40, 0x3e0293ee, v40
    v_mul_f32 v41, 0x3e0293ee, v41
    v_mul_f32 v42, 0x3e0293ee, v42
    v_mul_f32 v43, 0x3e0293ee, v43
    v_mul_f32 v44, 0x3e0293ee, v44
    v_mul_f32 v45, 0x3e0293ee, v45
    v_mul_f32 v46, 0x3e0293ee, v46
    v_mul_f32 v47, 0x3e0293ee, v47
    v_cvt_pk_bf16_f32 v56, v40, v41
    v_cvt_pk_bf16_f32 v57, v42, v43
    v_cvt_pk_bf16_f32 v58, v44, v45
    v_cvt_pk_bf16_f32 v59, v46, v47
    buffer_store_dwordx4 v[56:59], v251, s[4:7], s53 offen offset:1024 sc1
    v_accvgpr_read_b32 v0, a48
    v_accvgpr_read_b32 v1, a49
    v_accvgpr_read_b32 v2, a50
    v_accvgpr_read_b32 v3, a51
    v_accvgpr_read_b32 v4, a52
    v_accvgpr_read_b32 v5, a53
    v_accvgpr_read_b32 v6, a54
    v_accvgpr_read_b32 v7, a55
    v_mul_f32 v0, 0x3e0293ee, v0
    v_mul_f32 v1, 0x3e0293ee, v1
    v_mul_f32 v2, 0x3e0293ee, v2
    v_mul_f32 v3, 0x3e0293ee, v3
    v_mul_f32 v4, 0x3e0293ee, v4
    v_mul_f32 v5, 0x3e0293ee, v5
    v_mul_f32 v6, 0x3e0293ee, v6
    v_mul_f32 v7, 0x3e0293ee, v7
    v_cvt_pk_bf16_f32 v16, v0, v1
    v_cvt_pk_bf16_f32 v17, v2, v3
    v_cvt_pk_bf16_f32 v18, v4, v5
    v_cvt_pk_bf16_f32 v19, v6, v7
    buffer_store_dwordx4 v[16:19], v251, s[4:7], s53 offen offset:2048 sc1
    v_accvgpr_read_b32 v20, a56
    v_accvgpr_read_b32 v21, a57
    v_accvgpr_read_b32 v22, a58
    v_accvgpr_read_b32 v23, a59
    v_accvgpr_read_b32 v24, a60
    v_accvgpr_read_b32 v25, a61
    v_accvgpr_read_b32 v26, a62
    v_accvgpr_read_b32 v27, a63
    v_mul_f32 v20, 0x3e0293ee, v20
    v_mul_f32 v21, 0x3e0293ee, v21
    v_mul_f32 v22, 0x3e0293ee, v22
    v_mul_f32 v23, 0x3e0293ee, v23
    v_mul_f32 v24, 0x3e0293ee, v24
    v_mul_f32 v25, 0x3e0293ee, v25
    v_mul_f32 v26, 0x3e0293ee, v26
    v_mul_f32 v27, 0x3e0293ee, v27
    v_cvt_pk_bf16_f32 v36, v20, v21
    v_cvt_pk_bf16_f32 v37, v22, v23
    v_cvt_pk_bf16_f32 v38, v24, v25
    v_cvt_pk_bf16_f32 v39, v26, v27
    buffer_store_dwordx4 v[36:39], v251, s[4:7], s53 offen offset:3072 sc1
    s_add_u32 s53, s53, s22
    v_accvgpr_read_b32 v40, a64
    v_accvgpr_read_b32 v41, a65
    v_accvgpr_read_b32 v42, a66
    v_accvgpr_read_b32 v43, a67
    v_accvgpr_read_b32 v44, a68
    v_accvgpr_read_b32 v45, a69
    v_accvgpr_read_b32 v46, a70
    v_accvgpr_read_b32 v47, a71
    v_mul_f32 v40, 0x3e0293ee, v40
    v_mul_f32 v41, 0x3e0293ee, v41
    v_mul_f32 v42, 0x3e0293ee, v42
    v_mul_f32 v43, 0x3e0293ee, v43
    v_mul_f32 v44, 0x3e0293ee, v44
    v_mul_f32 v45, 0x3e0293ee, v45
    v_mul_f32 v46, 0x3e0293ee, v46
    v_mul_f32 v47, 0x3e0293ee, v47
    v_cvt_pk_bf16_f32 v56, v40, v41
    v_cvt_pk_bf16_f32 v57, v42, v43
    v_cvt_pk_bf16_f32 v58, v44, v45
    v_cvt_pk_bf16_f32 v59, v46, v47
    buffer_store_dwordx4 v[56:59], v251, s[4:7], s53 offen offset:0 sc1
    v_accvgpr_read_b32 v0, a72
    v_accvgpr_read_b32 v1, a73
    v_accvgpr_read_b32 v2, a74
    v_accvgpr_read_b32 v3, a75
    v_accvgpr_read_b32 v4, a76
    v_accvgpr_read_b32 v5, a77
    v_accvgpr_read_b32 v6, a78
    v_accvgpr_read_b32 v7, a79
    v_mul_f32 v0, 0x3e0293ee, v0
    v_mul_f32 v1, 0x3e0293ee, v1
    v_mul_f32 v2, 0x3e0293ee, v2
    v_mul_f32 v3, 0x3e0293ee, v3
    v_mul_f32 v4, 0x3e0293ee, v4
    v_mul_f32 v5, 0x3e0293ee, v5
    v_mul_f32 v6, 0x3e0293ee, v6
    v_mul_f32 v7, 0x3e0293ee, v7
    v_cvt_pk_bf16_f32 v16, v0, v1
    v_cvt_pk_bf16_f32 v17, v2, v3
    v_cvt_pk_bf16_f32 v18, v4, v5
    v_cvt_pk_bf16_f32 v19, v6, v7
    buffer_store_dwordx4 v[16:19], v251, s[4:7], s53 offen offset:1024 sc1
    v_accvgpr_read_b32 v20, a80
    v_accvgpr_read_b32 v21, a81
    v_accvgpr_read_b32 v22, a82
    v_accvgpr_read_b32 v23, a83
    v_accvgpr_read_b32 v24, a84
    v_accvgpr_read_b32 v25, a85
    v_accvgpr_read_b32 v26, a86
    v_accvgpr_read_b32 v27, a87
    v_mul_f32 v20, 0x3e0293ee, v20
    v_mul_f32 v21, 0x3e0293ee, v21
    v_mul_f32 v22, 0x3e0293ee, v22
    v_mul_f32 v23, 0x3e0293ee, v23
    v_mul_f32 v24, 0x3e0293ee, v24
    v_mul_f32 v25, 0x3e0293ee, v25
    v_mul_f32 v26, 0x3e0293ee, v26
    v_mul_f32 v27, 0x3e0293ee, v27
    v_cvt_pk_bf16_f32 v36, v20, v21
    v_cvt_pk_bf16_f32 v37, v22, v23
    v_cvt_pk_bf16_f32 v38, v24, v25
    v_cvt_pk_bf16_f32 v39, v26, v27
    buffer_store_dwordx4 v[36:39], v251, s[4:7], s53 offen offset:2048 sc1
    v_accvgpr_read_b32 v40, a88
    v_accvgpr_read_b32 v41, a89
    v_accvgpr_read_b32 v42, a90
    v_accvgpr_read_b32 v43, a91
    v_accvgpr_read_b32 v44, a92
    v_accvgpr_read_b32 v45, a93
    v_accvgpr_read_b32 v46, a94
    v_accvgpr_read_b32 v47, a95
    v_mul_f32 v40, 0x3e0293ee, v40
    v_mul_f32 v41, 0x3e0293ee, v41
    v_mul_f32 v42, 0x3e0293ee, v42
    v_mul_f32 v43, 0x3e0293ee, v43
    v_mul_f32 v44, 0x3e0293ee, v44
    v_mul_f32 v45, 0x3e0293ee, v45
    v_mul_f32 v46, 0x3e0293ee, v46
    v_mul_f32 v47, 0x3e0293ee, v47
    v_cvt_pk_bf16_f32 v56, v40, v41
    v_cvt_pk_bf16_f32 v57, v42, v43
    v_cvt_pk_bf16_f32 v58, v44, v45
    v_cvt_pk_bf16_f32 v59, v46, v47
    buffer_store_dwordx4 v[56:59], v251, s[4:7], s53 offen offset:3072 sc1
    s_add_u32 s53, s53, s22
    v_accvgpr_read_b32 v0, a96
    v_accvgpr_read_b32 v1, a97
    v_accvgpr_read_b32 v2, a98
    v_accvgpr_read_b32 v3, a99
    v_accvgpr_read_b32 v4, a100
    v_accvgpr_read_b32 v5, a101
    v_accvgpr_read_b32 v6, a102
    v_accvgpr_read_b32 v7, a103
    v_mul_f32 v0, 0x3e0293ee, v0
    v_mul_f32 v1, 0x3e0293ee, v1
    v_mul_f32 v2, 0x3e0293ee, v2
    v_mul_f32 v3, 0x3e0293ee, v3
    v_mul_f32 v4, 0x3e0293ee, v4
    v_mul_f32 v5, 0x3e0293ee, v5
    v_mul_f32 v6, 0x3e0293ee, v6
    v_mul_f32 v7, 0x3e0293ee, v7
    v_cvt_pk_bf16_f32 v16, v0, v1
    v_cvt_pk_bf16_f32 v17, v2, v3
    v_cvt_pk_bf16_f32 v18, v4, v5
    v_cvt_pk_bf16_f32 v19, v6, v7
    buffer_store_dwordx4 v[16:19], v251, s[4:7], s53 offen offset:0 sc1
    v_accvgpr_read_b32 v20, a104
    v_accvgpr_read_b32 v21, a105
    v_accvgpr_read_b32 v22, a106
    v_accvgpr_read_b32 v23, a107
    v_accvgpr_read_b32 v24, a108
    v_accvgpr_read_b32 v25, a109
    v_accvgpr_read_b32 v26, a110
    v_accvgpr_read_b32 v27, a111
    v_mul_f32 v20, 0x3e0293ee, v20
    v_mul_f32 v21, 0x3e0293ee, v21
    v_mul_f32 v22, 0x3e0293ee, v22
    v_mul_f32 v23, 0x3e0293ee, v23
    v_mul_f32 v24, 0x3e0293ee, v24
    v_mul_f32 v25, 0x3e0293ee, v25
    v_mul_f32 v26, 0x3e0293ee, v26
    v_mul_f32 v27, 0x3e0293ee, v27
    v_cvt_pk_bf16_f32 v36, v20, v21
    v_cvt_pk_bf16_f32 v37, v22, v23
    v_cvt_pk_bf16_f32 v38, v24, v25
    v_cvt_pk_bf16_f32 v39, v26, v27
    buffer_store_dwordx4 v[36:39], v251, s[4:7], s53 offen offset:1024 sc1
    v_accvgpr_read_b32 v40, a112
    v_accvgpr_read_b32 v41, a113
    v_accvgpr_read_b32 v42, a114
    v_accvgpr_read_b32 v43, a115
    v_accvgpr_read_b32 v44, a116
    v_accvgpr_read_b32 v45, a117
    v_accvgpr_read_b32 v46, a118
    v_accvgpr_read_b32 v47, a119
    v_mul_f32 v40, 0x3e0293ee, v40
    v_mul_f32 v41, 0x3e0293ee, v41
    v_mul_f32 v42, 0x3e0293ee, v42
    v_mul_f32 v43, 0x3e0293ee, v43
    v_mul_f32 v44, 0x3e0293ee, v44
    v_mul_f32 v45, 0x3e0293ee, v45
    v_mul_f32 v46, 0x3e0293ee, v46
    v_mul_f32 v47, 0x3e0293ee, v47
    v_cvt_pk_bf16_f32 v56, v40, v41
    v_cvt_pk_bf16_f32 v57, v42, v43
    v_cvt_pk_bf16_f32 v58, v44, v45
    v_cvt_pk_bf16_f32 v59, v46, v47
    buffer_store_dwordx4 v[56:59], v251, s[4:7], s53 offen offset:2048 sc1
    v_accvgpr_read_b32 v0, a120
    v_accvgpr_read_b32 v1, a121
    v_accvgpr_read_b32 v2, a122
    v_accvgpr_read_b32 v3, a123
    v_accvgpr_read_b32 v4, a124
    v_accvgpr_read_b32 v5, a125
    v_accvgpr_read_b32 v6, a126
    v_accvgpr_read_b32 v7, a127
    v_mul_f32 v0, 0x3e0293ee, v0
    v_mul_f32 v1, 0x3e0293ee, v1
    v_mul_f32 v2, 0x3e0293ee, v2
    v_mul_f32 v3, 0x3e0293ee, v3
    v_mul_f32 v4, 0x3e0293ee, v4
    v_mul_f32 v5, 0x3e0293ee, v5
    v_mul_f32 v6, 0x3e0293ee, v6
    v_mul_f32 v7, 0x3e0293ee, v7
    v_cvt_pk_bf16_f32 v16, v0, v1
    v_cvt_pk_bf16_f32 v17, v2, v3
    v_cvt_pk_bf16_f32 v18, v4, v5
    v_cvt_pk_bf16_f32 v19, v6, v7
    buffer_store_dwordx4 v[16:19], v251, s[4:7], s53 offen offset:3072 sc1
    s_add_u32 s53, s53, s22
    v_accvgpr_read_b32 v20, a128
    v_accvgpr_read_b32 v21, a129
    v_accvgpr_read_b32 v22, a130
    v_accvgpr_read_b32 v23, a131
    v_accvgpr_read_b32 v24, a132
    v_accvgpr_read_b32 v25, a133
    v_accvgpr_read_b32 v26, a134
    v_accvgpr_read_b32 v27, a135
    v_mul_f32 v20, 0x3e0293ee, v20
    v_mul_f32 v21, 0x3e0293ee, v21
    v_mul_f32 v22, 0x3e0293ee, v22
    v_mul_f32 v23, 0x3e0293ee, v23
    v_mul_f32 v24, 0x3e0293ee, v24
    v_mul_f32 v25, 0x3e0293ee, v25
    v_mul_f32 v26, 0x3e0293ee, v26
    v_mul_f32 v27, 0x3e0293ee, v27
    v_cvt_pk_bf16_f32 v36, v20, v21
    v_cvt_pk_bf16_f32 v37, v22, v23
    v_cvt_pk_bf16_f32 v38, v24, v25
    v_cvt_pk_bf16_f32 v39, v26, v27
    buffer_store_dwordx4 v[36:39], v251, s[4:7], s53 offen offset:0 sc1
    v_accvgpr_read_b32 v40, a136
    v_accvgpr_read_b32 v41, a137
    v_accvgpr_read_b32 v42, a138
    v_accvgpr_read_b32 v43, a139
    v_accvgpr_read_b32 v44, a140
    v_accvgpr_read_b32 v45, a141
    v_accvgpr_read_b32 v46, a142
    v_accvgpr_read_b32 v47, a143
    v_mul_f32 v40, 0x3e0293ee, v40
    v_mul_f32 v41, 0x3e0293ee, v41
    v_mul_f32 v42, 0x3e0293ee, v42
    v_mul_f32 v43, 0x3e0293ee, v43
    v_mul_f32 v44, 0x3e0293ee, v44
    v_mul_f32 v45, 0x3e0293ee, v45
    v_mul_f32 v46, 0x3e0293ee, v46
    v_mul_f32 v47, 0x3e0293ee, v47
    v_cvt_pk_bf16_f32 v56, v40, v41
    v_cvt_pk_bf16_f32 v57, v42, v43
    v_cvt_pk_bf16_f32 v58, v44, v45
    v_cvt_pk_bf16_f32 v59, v46, v47
    buffer_store_dwordx4 v[56:59], v251, s[4:7], s53 offen offset:1024 sc1
    v_accvgpr_read_b32 v0, a144
    v_accvgpr_read_b32 v1, a145
    v_accvgpr_read_b32 v2, a146
    v_accvgpr_read_b32 v3, a147
    v_accvgpr_read_b32 v4, a148
    v_accvgpr_read_b32 v5, a149
    v_accvgpr_read_b32 v6, a150
    v_accvgpr_read_b32 v7, a151
    v_mul_f32 v0, 0x3e0293ee, v0
    v_mul_f32 v1, 0x3e0293ee, v1
    v_mul_f32 v2, 0x3e0293ee, v2
    v_mul_f32 v3, 0x3e0293ee, v3
    v_mul_f32 v4, 0x3e0293ee, v4
    v_mul_f32 v5, 0x3e0293ee, v5
    v_mul_f32 v6, 0x3e0293ee, v6
    v_mul_f32 v7, 0x3e0293ee, v7
    v_cvt_pk_bf16_f32 v16, v0, v1
    v_cvt_pk_bf16_f32 v17, v2, v3
    v_cvt_pk_bf16_f32 v18, v4, v5
    v_cvt_pk_bf16_f32 v19, v6, v7
    buffer_store_dwordx4 v[16:19], v251, s[4:7], s53 offen offset:2048 sc1
    v_accvgpr_read_b32 v20, a152
    v_accvgpr_read_b32 v21, a153
    v_accvgpr_read_b32 v22, a154
    v_accvgpr_read_b32 v23, a155
    v_accvgpr_read_b32 v24, a156
    v_accvgpr_read_b32 v25, a157
    v_accvgpr_read_b32 v26, a158
    v_accvgpr_read_b32 v27, a159
    v_mul_f32 v20, 0x3e0293ee, v20
    v_mul_f32 v21, 0x3e0293ee, v21
    v_mul_f32 v22, 0x3e0293ee, v22
    v_mul_f32 v23, 0x3e0293ee, v23
    v_mul_f32 v24, 0x3e0293ee, v24
    v_mul_f32 v25, 0x3e0293ee, v25
    v_mul_f32 v26, 0x3e0293ee, v26
    v_mul_f32 v27, 0x3e0293ee, v27
    v_cvt_pk_bf16_f32 v36, v20, v21
    v_cvt_pk_bf16_f32 v37, v22, v23
    v_cvt_pk_bf16_f32 v38, v24, v25
    v_cvt_pk_bf16_f32 v39, v26, v27
    buffer_store_dwordx4 v[36:39], v251, s[4:7], s53 offen offset:3072 sc1
    s_add_u32 s53, s53, s22
    v_accvgpr_read_b32 v40, a160
    v_accvgpr_read_b32 v41, a161
    v_accvgpr_read_b32 v42, a162
    v_accvgpr_read_b32 v43, a163
    v_accvgpr_read_b32 v44, a164
    v_accvgpr_read_b32 v45, a165
    v_accvgpr_read_b32 v46, a166
    v_accvgpr_read_b32 v47, a167
    v_mul_f32 v40, 0x3e0293ee, v40
    v_mul_f32 v41, 0x3e0293ee, v41
    v_mul_f32 v42, 0x3e0293ee, v42
    v_mul_f32 v43, 0x3e0293ee, v43
    v_mul_f32 v44, 0x3e0293ee, v44
    v_mul_f32 v45, 0x3e0293ee, v45
    v_mul_f32 v46, 0x3e0293ee, v46
    v_mul_f32 v47, 0x3e0293ee, v47
    v_cvt_pk_bf16_f32 v56, v40, v41
    v_cvt_pk_bf16_f32 v57, v42, v43
    v_cvt_pk_bf16_f32 v58, v44, v45
    v_cvt_pk_bf16_f32 v59, v46, v47
    buffer_store_dwordx4 v[56:59], v251, s[4:7], s53 offen offset:0 sc1
    v_accvgpr_read_b32 v0, a168
    v_accvgpr_read_b32 v1, a169
    v_accvgpr_read_b32 v2, a170
    v_accvgpr_read_b32 v3, a171
    v_accvgpr_read_b32 v4, a172
    v_accvgpr_read_b32 v5, a173
    v_accvgpr_read_b32 v6, a174
    v_accvgpr_read_b32 v7, a175
    v_mul_f32 v0, 0x3e0293ee, v0
    v_mul_f32 v1, 0x3e0293ee, v1
    v_mul_f32 v2, 0x3e0293ee, v2
    v_mul_f32 v3, 0x3e0293ee, v3
    v_mul_f32 v4, 0x3e0293ee, v4
    v_mul_f32 v5, 0x3e0293ee, v5
    v_mul_f32 v6, 0x3e0293ee, v6
    v_mul_f32 v7, 0x3e0293ee, v7
    v_cvt_pk_bf16_f32 v16, v0, v1
    v_cvt_pk_bf16_f32 v17, v2, v3
    v_cvt_pk_bf16_f32 v18, v4, v5
    v_cvt_pk_bf16_f32 v19, v6, v7
    buffer_store_dwordx4 v[16:19], v251, s[4:7], s53 offen offset:1024 sc1
    v_accvgpr_read_b32 v20, a176
    v_accvgpr_read_b32 v21, a177
    v_accvgpr_read_b32 v22, a178
    v_accvgpr_read_b32 v23, a179
    v_accvgpr_read_b32 v24, a180
    v_accvgpr_read_b32 v25, a181
    v_accvgpr_read_b32 v26, a182
    v_accvgpr_read_b32 v27, a183
    v_mul_f32 v20, 0x3e0293ee, v20
    v_mul_f32 v21, 0x3e0293ee, v21
    v_mul_f32 v22, 0x3e0293ee, v22
    v_mul_f32 v23, 0x3e0293ee, v23
    v_mul_f32 v24, 0x3e0293ee, v24
    v_mul_f32 v25, 0x3e0293ee, v25
    v_mul_f32 v26, 0x3e0293ee, v26
    v_mul_f32 v27, 0x3e0293ee, v27
    v_cvt_pk_bf16_f32 v36, v20, v21
    v_cvt_pk_bf16_f32 v37, v22, v23
    v_cvt_pk_bf16_f32 v38, v24, v25
    v_cvt_pk_bf16_f32 v39, v26, v27
    buffer_store_dwordx4 v[36:39], v251, s[4:7], s53 offen offset:2048 sc1
    v_accvgpr_read_b32 v40, a184
    v_accvgpr_read_b32 v41, a185
    v_accvgpr_read_b32 v42, a186
    v_accvgpr_read_b32 v43, a187
    v_accvgpr_read_b32 v44, a188
    v_accvgpr_read_b32 v45, a189
    v_accvgpr_read_b32 v46, a190
    v_accvgpr_read_b32 v47, a191
    v_mul_f32 v40, 0x3e0293ee, v40
    v_mul_f32 v41, 0x3e0293ee, v41
    v_mul_f32 v42, 0x3e0293ee, v42
    v_mul_f32 v43, 0x3e0293ee, v43
    v_mul_f32 v44, 0x3e0293ee, v44
    v_mul_f32 v45, 0x3e0293ee, v45
    v_mul_f32 v46, 0x3e0293ee, v46
    v_mul_f32 v47, 0x3e0293ee, v47
    v_cvt_pk_bf16_f32 v56, v40, v41
    v_cvt_pk_bf16_f32 v57, v42, v43
    v_cvt_pk_bf16_f32 v58, v44, v45
    v_cvt_pk_bf16_f32 v59, v46, v47
    buffer_store_dwordx4 v[56:59], v251, s[4:7], s53 offen offset:3072 sc1
    s_add_u32 s53, s53, s22
    v_accvgpr_read_b32 v0, a192
    v_accvgpr_read_b32 v1, a193
    v_accvgpr_read_b32 v2, a194
    v_accvgpr_read_b32 v3, a195
    v_accvgpr_read_b32 v4, a196
    v_accvgpr_read_b32 v5, a197
    v_accvgpr_read_b32 v6, a198
    v_accvgpr_read_b32 v7, a199
    v_mul_f32 v0, 0x3e0293ee, v0
    v_mul_f32 v1, 0x3e0293ee, v1
    v_mul_f32 v2, 0x3e0293ee, v2
    v_mul_f32 v3, 0x3e0293ee, v3
    v_mul_f32 v4, 0x3e0293ee, v4
    v_mul_f32 v5, 0x3e0293ee, v5
    v_mul_f32 v6, 0x3e0293ee, v6
    v_mul_f32 v7, 0x3e0293ee, v7
    v_cvt_pk_bf16_f32 v16, v0, v1
    v_cvt_pk_bf16_f32 v17, v2, v3
    v_cvt_pk_bf16_f32 v18, v4, v5
    v_cvt_pk_bf16_f32 v19, v6, v7
    buffer_store_dwordx4 v[16:19], v251, s[4:7], s53 offen offset:0 sc1
    v_accvgpr_read_b32 v20, a200
    v_accvgpr_read_b32 v21, a201
    v_accvgpr_read_b32 v22, a202
    v_accvgpr_read_b32 v23, a203
    v_accvgpr_read_b32 v24, a204
    v_accvgpr_read_b32 v25, a205
    v_accvgpr_read_b32 v26, a206
    v_accvgpr_read_b32 v27, a207
    v_mul_f32 v20, 0x3e0293ee, v20
    v_mul_f32 v21, 0x3e0293ee, v21
    v_mul_f32 v22, 0x3e0293ee, v22
    v_mul_f32 v23, 0x3e0293ee, v23
    v_mul_f32 v24, 0x3e0293ee, v24
    v_mul_f32 v25, 0x3e0293ee, v25
    v_mul_f32 v26, 0x3e0293ee, v26
    v_mul_f32 v27, 0x3e0293ee, v27
    v_cvt_pk_bf16_f32 v36, v20, v21
    v_cvt_pk_bf16_f32 v37, v22, v23
    v_cvt_pk_bf16_f32 v38, v24, v25
    v_cvt_pk_bf16_f32 v39, v26, v27
    buffer_store_dwordx4 v[36:39], v251, s[4:7], s53 offen offset:1024 sc1
    v_accvgpr_read_b32 v40, a208
    v_accvgpr_read_b32 v41, a209
    v_accvgpr_read_b32 v42, a210
    v_accvgpr_read_b32 v43, a211
    v_accvgpr_read_b32 v44, a212
    v_accvgpr_read_b32 v45, a213
    v_accvgpr_read_b32 v46, a214
    v_accvgpr_read_b32 v47, a215
    v_mul_f32 v40, 0x3e0293ee, v40
    v_mul_f32 v41, 0x3e0293ee, v41
    v_mul_f32 v42, 0x3e0293ee, v42
    v_mul_f32 v43, 0x3e0293ee, v43
    v_mul_f32 v44, 0x3e0293ee, v44
    v_mul_f32 v45, 0x3e0293ee, v45
    v_mul_f32 v46, 0x3e0293ee, v46
    v_mul_f32 v47, 0x3e0293ee, v47
    v_cvt_pk_bf16_f32 v56, v40, v41
    v_cvt_pk_bf16_f32 v57, v42, v43
    v_cvt_pk_bf16_f32 v58, v44, v45
    v_cvt_pk_bf16_f32 v59, v46, v47
    buffer_store_dwordx4 v[56:59], v251, s[4:7], s53 offen offset:2048 sc1
    v_accvgpr_read_b32 v0, a216
    v_accvgpr_read_b32 v1, a217
    v_accvgpr_read_b32 v2, a218
    v_accvgpr_read_b32 v3, a219
    v_accvgpr_read_b32 v4, a220
    v_accvgpr_read_b32 v5, a221
    v_accvgpr_read_b32 v6, a222
    v_accvgpr_read_b32 v7, a223
    v_mul_f32 v0, 0x3e0293ee, v0
    v_mul_f32 v1, 0x3e0293ee, v1
    v_mul_f32 v2, 0x3e0293ee, v2
    v_mul_f32 v3, 0x3e0293ee, v3
    v_mul_f32 v4, 0x3e0293ee, v4
    v_mul_f32 v5, 0x3e0293ee, v5
    v_mul_f32 v6, 0x3e0293ee, v6
    v_mul_f32 v7, 0x3e0293ee, v7
    v_cvt_pk_bf16_f32 v16, v0, v1
    v_cvt_pk_bf16_f32 v17, v2, v3
    v_cvt_pk_bf16_f32 v18, v4, v5
    v_cvt_pk_bf16_f32 v19, v6, v7
    buffer_store_dwordx4 v[16:19], v251, s[4:7], s53 offen offset:3072 sc1
    s_add_u32 s53, s53, s22
    v_accvgpr_read_b32 v20, a224
    v_accvgpr_read_b32 v21, a225
    v_accvgpr_read_b32 v22, a226
    v_accvgpr_read_b32 v23, a227
    v_accvgpr_read_b32 v24, a228
    v_accvgpr_read_b32 v25, a229
    v_accvgpr_read_b32 v26, a230
    v_accvgpr_read_b32 v27, a231
    v_mul_f32 v20, 0x3e0293ee, v20
    v_mul_f32 v21, 0x3e0293ee, v21
    v_mul_f32 v22, 0x3e0293ee, v22
    v_mul_f32 v23, 0x3e0293ee, v23
    v_mul_f32 v24, 0x3e0293ee, v24
    v_mul_f32 v25, 0x3e0293ee, v25
    v_mul_f32 v26, 0x3e0293ee, v26
    v_mul_f32 v27, 0x3e0293ee, v27
    v_cvt_pk_bf16_f32 v36, v20, v21
    v_cvt_pk_bf16_f32 v37, v22, v23
    v_cvt_pk_bf16_f32 v38, v24, v25
    v_cvt_pk_bf16_f32 v39, v26, v27
    buffer_store_dwordx4 v[36:39], v251, s[4:7], s53 offen offset:0 sc1
    v_accvgpr_read_b32 v40, a232
    v_accvgpr_read_b32 v41, a233
    v_accvgpr_read_b32 v42, a234
    v_accvgpr_read_b32 v43, a235
    v_accvgpr_read_b32 v44, a236
    v_accvgpr_read_b32 v45, a237
    v_accvgpr_read_b32 v46, a238
    v_accvgpr_read_b32 v47, a239
    v_mul_f32 v40, 0x3e0293ee, v40
    v_mul_f32 v41, 0x3e0293ee, v41
    v_mul_f32 v42, 0x3e0293ee, v42
    v_mul_f32 v43, 0x3e0293ee, v43
    v_mul_f32 v44, 0x3e0293ee, v44
    v_mul_f32 v45, 0x3e0293ee, v45
    v_mul_f32 v46, 0x3e0293ee, v46
    v_mul_f32 v47, 0x3e0293ee, v47
    v_cvt_pk_bf16_f32 v56, v40, v41
    v_cvt_pk_bf16_f32 v57, v42, v43
    v_cvt_pk_bf16_f32 v58, v44, v45
    v_cvt_pk_bf16_f32 v59, v46, v47
    buffer_store_dwordx4 v[56:59], v251, s[4:7], s53 offen offset:1024 sc1
    v_accvgpr_read_b32 v0, a240
    v_accvgpr_read_b32 v1, a241
    v_accvgpr_read_b32 v2, a242
    v_accvgpr_read_b32 v3, a243
    v_accvgpr_read_b32 v4, a244
    v_accvgpr_read_b32 v5, a245
    v_accvgpr_read_b32 v6, a246
    v_accvgpr_read_b32 v7, a247
    v_mul_f32 v0, 0x3e0293ee, v0
    v_mul_f32 v1, 0x3e0293ee, v1
    v_mul_f32 v2, 0x3e0293ee, v2
    v_mul_f32 v3, 0x3e0293ee, v3
    v_mul_f32 v4, 0x3e0293ee, v4
    v_mul_f32 v5, 0x3e0293ee, v5
    v_mul_f32 v6, 0x3e0293ee, v6
    v_mul_f32 v7, 0x3e0293ee, v7
    v_cvt_pk_bf16_f32 v16, v0, v1
    v_cvt_pk_bf16_f32 v17, v2, v3
    v_cvt_pk_bf16_f32 v18, v4, v5
    v_cvt_pk_bf16_f32 v19, v6, v7
    buffer_store_dwordx4 v[16:19], v251, s[4:7], s53 offen offset:2048 sc1
    v_accvgpr_read_b32 v20, a248
    v_accvgpr_read_b32 v21, a249
    v_accvgpr_read_b32 v22, a250
    v_accvgpr_read_b32 v23, a251
    v_accvgpr_read_b32 v24, a252
    v_accvgpr_read_b32 v25, a253
    v_accvgpr_read_b32 v26, a254
    v_accvgpr_read_b32 v27, a255
    v_mul_f32 v20, 0x3e0293ee, v20
    v_mul_f32 v21, 0x3e0293ee, v21
    v_mul_f32 v22, 0x3e0293ee, v22
    v_mul_f32 v23, 0x3e0293ee, v23
    v_mul_f32 v24, 0x3e0293ee, v24
    v_mul_f32 v25, 0x3e0293ee, v25
    v_mul_f32 v26, 0x3e0293ee, v26
    v_mul_f32 v27, 0x3e0293ee, v27
    v_cvt_pk_bf16_f32 v36, v20, v21
    v_cvt_pk_bf16_f32 v37, v22, v23
    v_cvt_pk_bf16_f32 v38, v24, v25
    v_cvt_pk_bf16_f32 v39, v26, v27
    buffer_store_dwordx4 v[36:39], v251, s[4:7], s53 offen offset:3072 sc1
    s_branch main_kernel_w_done
main_kernel_w_c2_egelu:
    s_mov_b32 s53, s21
    v_accvgpr_read_b32 v0, a0
    v_accvgpr_read_b32 v1, a1
    v_accvgpr_read_b32 v2, a2
    v_accvgpr_read_b32 v3, a3
    v_accvgpr_read_b32 v4, a4
    v_accvgpr_read_b32 v5, a5
    v_accvgpr_read_b32 v6, a6
    v_accvgpr_read_b32 v7, a7
    v_pk_mul_f32 v[8:9], v[0:1], v[0:1]
    v_pk_mul_f32 v[10:11], v[2:3], v[2:3]
    v_pk_mul_f32 v[12:13], v[4:5], v[4:5]
    v_pk_mul_f32 v[14:15], v[6:7], v[6:7]
    v_pk_fma_f32 v[8:9], v[8:9], v[242:243], v[240:241]
    v_pk_fma_f32 v[10:11], v[10:11], v[242:243], v[240:241]
    v_pk_fma_f32 v[12:13], v[12:13], v[242:243], v[240:241]
    v_pk_fma_f32 v[14:15], v[14:15], v[242:243], v[240:241]
    v_pk_mul_f32 v[8:9], v[8:9], v[0:1]
    v_pk_mul_f32 v[10:11], v[10:11], v[2:3]
    v_pk_mul_f32 v[12:13], v[12:13], v[4:5]
    v_pk_mul_f32 v[14:15], v[14:15], v[6:7]
    v_exp_f32 v8, v8
    v_exp_f32 v9, v9
    v_exp_f32 v10, v10
    v_exp_f32 v11, v11
    v_exp_f32 v12, v12
    v_exp_f32 v13, v13
    v_exp_f32 v14, v14
    v_exp_f32 v15, v15
    v_pk_add_f32 v[8:9], v[8:9], v[244:245]
    v_pk_add_f32 v[10:11], v[10:11], v[244:245]
    v_pk_add_f32 v[12:13], v[12:13], v[244:245]
    v_pk_add_f32 v[14:15], v[14:15], v[244:245]
    v_rcp_f32 v8, v8
    v_rcp_f32 v9, v9
    v_rcp_f32 v10, v10
    v_rcp_f32 v11, v11
    v_rcp_f32 v12, v12
    v_rcp_f32 v13, v13
    v_rcp_f32 v14, v14
    v_rcp_f32 v15, v15
    v_pk_mul_f32 v[0:1], v[8:9], v[0:1]
    v_pk_mul_f32 v[2:3], v[10:11], v[2:3]
    v_pk_mul_f32 v[4:5], v[12:13], v[4:5]
    v_pk_mul_f32 v[6:7], v[14:15], v[6:7]
    v_cvt_pk_bf16_f32 v16, v0, v1
    v_cvt_pk_bf16_f32 v17, v2, v3
    v_cvt_pk_bf16_f32 v18, v4, v5
    v_cvt_pk_bf16_f32 v19, v6, v7
    buffer_store_dwordx4 v[16:19], v251, s[4:7], s53 offen offset:0 sc1
    v_accvgpr_read_b32 v20, a8
    v_accvgpr_read_b32 v21, a9
    v_accvgpr_read_b32 v22, a10
    v_accvgpr_read_b32 v23, a11
    v_accvgpr_read_b32 v24, a12
    v_accvgpr_read_b32 v25, a13
    v_accvgpr_read_b32 v26, a14
    v_accvgpr_read_b32 v27, a15
    v_pk_mul_f32 v[28:29], v[20:21], v[20:21]
    v_pk_mul_f32 v[30:31], v[22:23], v[22:23]
    v_pk_mul_f32 v[32:33], v[24:25], v[24:25]
    v_pk_mul_f32 v[34:35], v[26:27], v[26:27]
    v_pk_fma_f32 v[28:29], v[28:29], v[242:243], v[240:241]
    v_pk_fma_f32 v[30:31], v[30:31], v[242:243], v[240:241]
    v_pk_fma_f32 v[32:33], v[32:33], v[242:243], v[240:241]
    v_pk_fma_f32 v[34:35], v[34:35], v[242:243], v[240:241]
    v_pk_mul_f32 v[28:29], v[28:29], v[20:21]
    v_pk_mul_f32 v[30:31], v[30:31], v[22:23]
    v_pk_mul_f32 v[32:33], v[32:33], v[24:25]
    v_pk_mul_f32 v[34:35], v[34:35], v[26:27]
    v_exp_f32 v28, v28
    v_exp_f32 v29, v29
    v_exp_f32 v30, v30
    v_exp_f32 v31, v31
    v_exp_f32 v32, v32
    v_exp_f32 v33, v33
    v_exp_f32 v34, v34
    v_exp_f32 v35, v35
    v_pk_add_f32 v[28:29], v[28:29], v[244:245]
    v_pk_add_f32 v[30:31], v[30:31], v[244:245]
    v_pk_add_f32 v[32:33], v[32:33], v[244:245]
    v_pk_add_f32 v[34:35], v[34:35], v[244:245]
    v_rcp_f32 v28, v28
    v_rcp_f32 v29, v29
    v_rcp_f32 v30, v30
    v_rcp_f32 v31, v31
    v_rcp_f32 v32, v32
    v_rcp_f32 v33, v33
    v_rcp_f32 v34, v34
    v_rcp_f32 v35, v35
    v_pk_mul_f32 v[20:21], v[28:29], v[20:21]
    v_pk_mul_f32 v[22:23], v[30:31], v[22:23]
    v_pk_mul_f32 v[24:25], v[32:33], v[24:25]
    v_pk_mul_f32 v[26:27], v[34:35], v[26:27]
    v_cvt_pk_bf16_f32 v36, v20, v21
    v_cvt_pk_bf16_f32 v37, v22, v23
    v_cvt_pk_bf16_f32 v38, v24, v25
    v_cvt_pk_bf16_f32 v39, v26, v27
    buffer_store_dwordx4 v[36:39], v251, s[4:7], s53 offen offset:1024 sc1
    v_accvgpr_read_b32 v40, a16
    v_accvgpr_read_b32 v41, a17
    v_accvgpr_read_b32 v42, a18
    v_accvgpr_read_b32 v43, a19
    v_accvgpr_read_b32 v44, a20
    v_accvgpr_read_b32 v45, a21
    v_accvgpr_read_b32 v46, a22
    v_accvgpr_read_b32 v47, a23
    v_pk_mul_f32 v[48:49], v[40:41], v[40:41]
    v_pk_mul_f32 v[50:51], v[42:43], v[42:43]
    v_pk_mul_f32 v[52:53], v[44:45], v[44:45]
    v_pk_mul_f32 v[54:55], v[46:47], v[46:47]
    v_pk_fma_f32 v[48:49], v[48:49], v[242:243], v[240:241]
    v_pk_fma_f32 v[50:51], v[50:51], v[242:243], v[240:241]
    v_pk_fma_f32 v[52:53], v[52:53], v[242:243], v[240:241]
    v_pk_fma_f32 v[54:55], v[54:55], v[242:243], v[240:241]
    v_pk_mul_f32 v[48:49], v[48:49], v[40:41]
    v_pk_mul_f32 v[50:51], v[50:51], v[42:43]
    v_pk_mul_f32 v[52:53], v[52:53], v[44:45]
    v_pk_mul_f32 v[54:55], v[54:55], v[46:47]
    v_exp_f32 v48, v48
    v_exp_f32 v49, v49
    v_exp_f32 v50, v50
    v_exp_f32 v51, v51
    v_exp_f32 v52, v52
    v_exp_f32 v53, v53
    v_exp_f32 v54, v54
    v_exp_f32 v55, v55
    v_pk_add_f32 v[48:49], v[48:49], v[244:245]
    v_pk_add_f32 v[50:51], v[50:51], v[244:245]
    v_pk_add_f32 v[52:53], v[52:53], v[244:245]
    v_pk_add_f32 v[54:55], v[54:55], v[244:245]
    v_rcp_f32 v48, v48
    v_rcp_f32 v49, v49
    v_rcp_f32 v50, v50
    v_rcp_f32 v51, v51
    v_rcp_f32 v52, v52
    v_rcp_f32 v53, v53
    v_rcp_f32 v54, v54
    v_rcp_f32 v55, v55
    v_pk_mul_f32 v[40:41], v[48:49], v[40:41]
    v_pk_mul_f32 v[42:43], v[50:51], v[42:43]
    v_pk_mul_f32 v[44:45], v[52:53], v[44:45]
    v_pk_mul_f32 v[46:47], v[54:55], v[46:47]
    v_cvt_pk_bf16_f32 v56, v40, v41
    v_cvt_pk_bf16_f32 v57, v42, v43
    v_cvt_pk_bf16_f32 v58, v44, v45
    v_cvt_pk_bf16_f32 v59, v46, v47
    buffer_store_dwordx4 v[56:59], v251, s[4:7], s53 offen offset:2048 sc1
    v_accvgpr_read_b32 v0, a24
    v_accvgpr_read_b32 v1, a25
    v_accvgpr_read_b32 v2, a26
    v_accvgpr_read_b32 v3, a27
    v_accvgpr_read_b32 v4, a28
    v_accvgpr_read_b32 v5, a29
    v_accvgpr_read_b32 v6, a30
    v_accvgpr_read_b32 v7, a31
    v_pk_mul_f32 v[8:9], v[0:1], v[0:1]
    v_pk_mul_f32 v[10:11], v[2:3], v[2:3]
    v_pk_mul_f32 v[12:13], v[4:5], v[4:5]
    v_pk_mul_f32 v[14:15], v[6:7], v[6:7]
    v_pk_fma_f32 v[8:9], v[8:9], v[242:243], v[240:241]
    v_pk_fma_f32 v[10:11], v[10:11], v[242:243], v[240:241]
    v_pk_fma_f32 v[12:13], v[12:13], v[242:243], v[240:241]
    v_pk_fma_f32 v[14:15], v[14:15], v[242:243], v[240:241]
    v_pk_mul_f32 v[8:9], v[8:9], v[0:1]
    v_pk_mul_f32 v[10:11], v[10:11], v[2:3]
    v_pk_mul_f32 v[12:13], v[12:13], v[4:5]
    v_pk_mul_f32 v[14:15], v[14:15], v[6:7]
    v_exp_f32 v8, v8
    v_exp_f32 v9, v9
    v_exp_f32 v10, v10
    v_exp_f32 v11, v11
    v_exp_f32 v12, v12
    v_exp_f32 v13, v13
    v_exp_f32 v14, v14
    v_exp_f32 v15, v15
    v_pk_add_f32 v[8:9], v[8:9], v[244:245]
    v_pk_add_f32 v[10:11], v[10:11], v[244:245]
    v_pk_add_f32 v[12:13], v[12:13], v[244:245]
    v_pk_add_f32 v[14:15], v[14:15], v[244:245]
    v_rcp_f32 v8, v8
    v_rcp_f32 v9, v9
    v_rcp_f32 v10, v10
    v_rcp_f32 v11, v11
    v_rcp_f32 v12, v12
    v_rcp_f32 v13, v13
    v_rcp_f32 v14, v14
    v_rcp_f32 v15, v15
    v_pk_mul_f32 v[0:1], v[8:9], v[0:1]
    v_pk_mul_f32 v[2:3], v[10:11], v[2:3]
    v_pk_mul_f32 v[4:5], v[12:13], v[4:5]
    v_pk_mul_f32 v[6:7], v[14:15], v[6:7]
    v_cvt_pk_bf16_f32 v16, v0, v1
    v_cvt_pk_bf16_f32 v17, v2, v3
    v_cvt_pk_bf16_f32 v18, v4, v5
    v_cvt_pk_bf16_f32 v19, v6, v7
    buffer_store_dwordx4 v[16:19], v251, s[4:7], s53 offen offset:3072 sc1
    s_add_u32 s53, s53, s22
    v_accvgpr_read_b32 v20, a32
    v_accvgpr_read_b32 v21, a33
    v_accvgpr_read_b32 v22, a34
    v_accvgpr_read_b32 v23, a35
    v_accvgpr_read_b32 v24, a36
    v_accvgpr_read_b32 v25, a37
    v_accvgpr_read_b32 v26, a38
    v_accvgpr_read_b32 v27, a39
    v_pk_mul_f32 v[28:29], v[20:21], v[20:21]
    v_pk_mul_f32 v[30:31], v[22:23], v[22:23]
    v_pk_mul_f32 v[32:33], v[24:25], v[24:25]
    v_pk_mul_f32 v[34:35], v[26:27], v[26:27]
    v_pk_fma_f32 v[28:29], v[28:29], v[242:243], v[240:241]
    v_pk_fma_f32 v[30:31], v[30:31], v[242:243], v[240:241]
    v_pk_fma_f32 v[32:33], v[32:33], v[242:243], v[240:241]
    v_pk_fma_f32 v[34:35], v[34:35], v[242:243], v[240:241]
    v_pk_mul_f32 v[28:29], v[28:29], v[20:21]
    v_pk_mul_f32 v[30:31], v[30:31], v[22:23]
    v_pk_mul_f32 v[32:33], v[32:33], v[24:25]
    v_pk_mul_f32 v[34:35], v[34:35], v[26:27]
    v_exp_f32 v28, v28
    v_exp_f32 v29, v29
    v_exp_f32 v30, v30
    v_exp_f32 v31, v31
    v_exp_f32 v32, v32
    v_exp_f32 v33, v33
    v_exp_f32 v34, v34
    v_exp_f32 v35, v35
    v_pk_add_f32 v[28:29], v[28:29], v[244:245]
    v_pk_add_f32 v[30:31], v[30:31], v[244:245]
    v_pk_add_f32 v[32:33], v[32:33], v[244:245]
    v_pk_add_f32 v[34:35], v[34:35], v[244:245]
    v_rcp_f32 v28, v28
    v_rcp_f32 v29, v29
    v_rcp_f32 v30, v30
    v_rcp_f32 v31, v31
    v_rcp_f32 v32, v32
    v_rcp_f32 v33, v33
    v_rcp_f32 v34, v34
    v_rcp_f32 v35, v35
    v_pk_mul_f32 v[20:21], v[28:29], v[20:21]
    v_pk_mul_f32 v[22:23], v[30:31], v[22:23]
    v_pk_mul_f32 v[24:25], v[32:33], v[24:25]
    v_pk_mul_f32 v[26:27], v[34:35], v[26:27]
    v_cvt_pk_bf16_f32 v36, v20, v21
    v_cvt_pk_bf16_f32 v37, v22, v23
    v_cvt_pk_bf16_f32 v38, v24, v25
    v_cvt_pk_bf16_f32 v39, v26, v27
    buffer_store_dwordx4 v[36:39], v251, s[4:7], s53 offen offset:0 sc1
    v_accvgpr_read_b32 v40, a40
    v_accvgpr_read_b32 v41, a41
    v_accvgpr_read_b32 v42, a42
    v_accvgpr_read_b32 v43, a43
    v_accvgpr_read_b32 v44, a44
    v_accvgpr_read_b32 v45, a45
    v_accvgpr_read_b32 v46, a46
    v_accvgpr_read_b32 v47, a47
    v_pk_mul_f32 v[48:49], v[40:41], v[40:41]
    v_pk_mul_f32 v[50:51], v[42:43], v[42:43]
    v_pk_mul_f32 v[52:53], v[44:45], v[44:45]
    v_pk_mul_f32 v[54:55], v[46:47], v[46:47]
    v_pk_fma_f32 v[48:49], v[48:49], v[242:243], v[240:241]
    v_pk_fma_f32 v[50:51], v[50:51], v[242:243], v[240:241]
    v_pk_fma_f32 v[52:53], v[52:53], v[242:243], v[240:241]
    v_pk_fma_f32 v[54:55], v[54:55], v[242:243], v[240:241]
    v_pk_mul_f32 v[48:49], v[48:49], v[40:41]
    v_pk_mul_f32 v[50:51], v[50:51], v[42:43]
    v_pk_mul_f32 v[52:53], v[52:53], v[44:45]
    v_pk_mul_f32 v[54:55], v[54:55], v[46:47]
    v_exp_f32 v48, v48
    v_exp_f32 v49, v49
    v_exp_f32 v50, v50
    v_exp_f32 v51, v51
    v_exp_f32 v52, v52
    v_exp_f32 v53, v53
    v_exp_f32 v54, v54
    v_exp_f32 v55, v55
    v_pk_add_f32 v[48:49], v[48:49], v[244:245]
    v_pk_add_f32 v[50:51], v[50:51], v[244:245]
    v_pk_add_f32 v[52:53], v[52:53], v[244:245]
    v_pk_add_f32 v[54:55], v[54:55], v[244:245]
    v_rcp_f32 v48, v48
    v_rcp_f32 v49, v49
    v_rcp_f32 v50, v50
    v_rcp_f32 v51, v51
    v_rcp_f32 v52, v52
    v_rcp_f32 v53, v53
    v_rcp_f32 v54, v54
    v_rcp_f32 v55, v55
    v_pk_mul_f32 v[40:41], v[48:49], v[40:41]
    v_pk_mul_f32 v[42:43], v[50:51], v[42:43]
    v_pk_mul_f32 v[44:45], v[52:53], v[44:45]
    v_pk_mul_f32 v[46:47], v[54:55], v[46:47]
    v_cvt_pk_bf16_f32 v56, v40, v41
    v_cvt_pk_bf16_f32 v57, v42, v43
    v_cvt_pk_bf16_f32 v58, v44, v45
    v_cvt_pk_bf16_f32 v59, v46, v47
    buffer_store_dwordx4 v[56:59], v251, s[4:7], s53 offen offset:1024 sc1
    v_accvgpr_read_b32 v0, a48
    v_accvgpr_read_b32 v1, a49
    v_accvgpr_read_b32 v2, a50
    v_accvgpr_read_b32 v3, a51
    v_accvgpr_read_b32 v4, a52
    v_accvgpr_read_b32 v5, a53
    v_accvgpr_read_b32 v6, a54
    v_accvgpr_read_b32 v7, a55
    v_pk_mul_f32 v[8:9], v[0:1], v[0:1]
    v_pk_mul_f32 v[10:11], v[2:3], v[2:3]
    v_pk_mul_f32 v[12:13], v[4:5], v[4:5]
    v_pk_mul_f32 v[14:15], v[6:7], v[6:7]
    v_pk_fma_f32 v[8:9], v[8:9], v[242:243], v[240:241]
    v_pk_fma_f32 v[10:11], v[10:11], v[242:243], v[240:241]
    v_pk_fma_f32 v[12:13], v[12:13], v[242:243], v[240:241]
    v_pk_fma_f32 v[14:15], v[14:15], v[242:243], v[240:241]
    v_pk_mul_f32 v[8:9], v[8:9], v[0:1]
    v_pk_mul_f32 v[10:11], v[10:11], v[2:3]
    v_pk_mul_f32 v[12:13], v[12:13], v[4:5]
    v_pk_mul_f32 v[14:15], v[14:15], v[6:7]
    v_exp_f32 v8, v8
    v_exp_f32 v9, v9
    v_exp_f32 v10, v10
    v_exp_f32 v11, v11
    v_exp_f32 v12, v12
    v_exp_f32 v13, v13
    v_exp_f32 v14, v14
    v_exp_f32 v15, v15
    v_pk_add_f32 v[8:9], v[8:9], v[244:245]
    v_pk_add_f32 v[10:11], v[10:11], v[244:245]
    v_pk_add_f32 v[12:13], v[12:13], v[244:245]
    v_pk_add_f32 v[14:15], v[14:15], v[244:245]
    v_rcp_f32 v8, v8
    v_rcp_f32 v9, v9
    v_rcp_f32 v10, v10
    v_rcp_f32 v11, v11
    v_rcp_f32 v12, v12
    v_rcp_f32 v13, v13
    v_rcp_f32 v14, v14
    v_rcp_f32 v15, v15
    v_pk_mul_f32 v[0:1], v[8:9], v[0:1]
    v_pk_mul_f32 v[2:3], v[10:11], v[2:3]
    v_pk_mul_f32 v[4:5], v[12:13], v[4:5]
    v_pk_mul_f32 v[6:7], v[14:15], v[6:7]
    v_cvt_pk_bf16_f32 v16, v0, v1
    v_cvt_pk_bf16_f32 v17, v2, v3
    v_cvt_pk_bf16_f32 v18, v4, v5
    v_cvt_pk_bf16_f32 v19, v6, v7
    buffer_store_dwordx4 v[16:19], v251, s[4:7], s53 offen offset:2048 sc1
    v_accvgpr_read_b32 v20, a56
    v_accvgpr_read_b32 v21, a57
    v_accvgpr_read_b32 v22, a58
    v_accvgpr_read_b32 v23, a59
    v_accvgpr_read_b32 v24, a60
    v_accvgpr_read_b32 v25, a61
    v_accvgpr_read_b32 v26, a62
    v_accvgpr_read_b32 v27, a63
    v_pk_mul_f32 v[28:29], v[20:21], v[20:21]
    v_pk_mul_f32 v[30:31], v[22:23], v[22:23]
    v_pk_mul_f32 v[32:33], v[24:25], v[24:25]
    v_pk_mul_f32 v[34:35], v[26:27], v[26:27]
    v_pk_fma_f32 v[28:29], v[28:29], v[242:243], v[240:241]
    v_pk_fma_f32 v[30:31], v[30:31], v[242:243], v[240:241]
    v_pk_fma_f32 v[32:33], v[32:33], v[242:243], v[240:241]
    v_pk_fma_f32 v[34:35], v[34:35], v[242:243], v[240:241]
    v_pk_mul_f32 v[28:29], v[28:29], v[20:21]
    v_pk_mul_f32 v[30:31], v[30:31], v[22:23]
    v_pk_mul_f32 v[32:33], v[32:33], v[24:25]
    v_pk_mul_f32 v[34:35], v[34:35], v[26:27]
    v_exp_f32 v28, v28
    v_exp_f32 v29, v29
    v_exp_f32 v30, v30
    v_exp_f32 v31, v31
    v_exp_f32 v32, v32
    v_exp_f32 v33, v33
    v_exp_f32 v34, v34
    v_exp_f32 v35, v35
    v_pk_add_f32 v[28:29], v[28:29], v[244:245]
    v_pk_add_f32 v[30:31], v[30:31], v[244:245]
    v_pk_add_f32 v[32:33], v[32:33], v[244:245]
    v_pk_add_f32 v[34:35], v[34:35], v[244:245]
    v_rcp_f32 v28, v28
    v_rcp_f32 v29, v29
    v_rcp_f32 v30, v30
    v_rcp_f32 v31, v31
    v_rcp_f32 v32, v32
    v_rcp_f32 v33, v33
    v_rcp_f32 v34, v34
    v_rcp_f32 v35, v35
    v_pk_mul_f32 v[20:21], v[28:29], v[20:21]
    v_pk_mul_f32 v[22:23], v[30:31], v[22:23]
    v_pk_mul_f32 v[24:25], v[32:33], v[24:25]
    v_pk_mul_f32 v[26:27], v[34:35], v[26:27]
    v_cvt_pk_bf16_f32 v36, v20, v21
    v_cvt_pk_bf16_f32 v37, v22, v23
    v_cvt_pk_bf16_f32 v38, v24, v25
    v_cvt_pk_bf16_f32 v39, v26, v27
    buffer_store_dwordx4 v[36:39], v251, s[4:7], s53 offen offset:3072 sc1
    s_add_u32 s53, s53, s22
    v_accvgpr_read_b32 v40, a64
    v_accvgpr_read_b32 v41, a65
    v_accvgpr_read_b32 v42, a66
    v_accvgpr_read_b32 v43, a67
    v_accvgpr_read_b32 v44, a68
    v_accvgpr_read_b32 v45, a69
    v_accvgpr_read_b32 v46, a70
    v_accvgpr_read_b32 v47, a71
    v_pk_mul_f32 v[48:49], v[40:41], v[40:41]
    v_pk_mul_f32 v[50:51], v[42:43], v[42:43]
    v_pk_mul_f32 v[52:53], v[44:45], v[44:45]
    v_pk_mul_f32 v[54:55], v[46:47], v[46:47]
    v_pk_fma_f32 v[48:49], v[48:49], v[242:243], v[240:241]
    v_pk_fma_f32 v[50:51], v[50:51], v[242:243], v[240:241]
    v_pk_fma_f32 v[52:53], v[52:53], v[242:243], v[240:241]
    v_pk_fma_f32 v[54:55], v[54:55], v[242:243], v[240:241]
    v_pk_mul_f32 v[48:49], v[48:49], v[40:41]
    v_pk_mul_f32 v[50:51], v[50:51], v[42:43]
    v_pk_mul_f32 v[52:53], v[52:53], v[44:45]
    v_pk_mul_f32 v[54:55], v[54:55], v[46:47]
    v_exp_f32 v48, v48
    v_exp_f32 v49, v49
    v_exp_f32 v50, v50
    v_exp_f32 v51, v51
    v_exp_f32 v52, v52
    v_exp_f32 v53, v53
    v_exp_f32 v54, v54
    v_exp_f32 v55, v55
    v_pk_add_f32 v[48:49], v[48:49], v[244:245]
    v_pk_add_f32 v[50:51], v[50:51], v[244:245]
    v_pk_add_f32 v[52:53], v[52:53], v[244:245]
    v_pk_add_f32 v[54:55], v[54:55], v[244:245]
    v_rcp_f32 v48, v48
    v_rcp_f32 v49, v49
    v_rcp_f32 v50, v50
    v_rcp_f32 v51, v51
    v_rcp_f32 v52, v52
    v_rcp_f32 v53, v53
    v_rcp_f32 v54, v54
    v_rcp_f32 v55, v55
    v_pk_mul_f32 v[40:41], v[48:49], v[40:41]
    v_pk_mul_f32 v[42:43], v[50:51], v[42:43]
    v_pk_mul_f32 v[44:45], v[52:53], v[44:45]
    v_pk_mul_f32 v[46:47], v[54:55], v[46:47]
    v_cvt_pk_bf16_f32 v56, v40, v41
    v_cvt_pk_bf16_f32 v57, v42, v43
    v_cvt_pk_bf16_f32 v58, v44, v45
    v_cvt_pk_bf16_f32 v59, v46, v47
    buffer_store_dwordx4 v[56:59], v251, s[4:7], s53 offen offset:0 sc1
    v_accvgpr_read_b32 v0, a72
    v_accvgpr_read_b32 v1, a73
    v_accvgpr_read_b32 v2, a74
    v_accvgpr_read_b32 v3, a75
    v_accvgpr_read_b32 v4, a76
    v_accvgpr_read_b32 v5, a77
    v_accvgpr_read_b32 v6, a78
    v_accvgpr_read_b32 v7, a79
    v_pk_mul_f32 v[8:9], v[0:1], v[0:1]
    v_pk_mul_f32 v[10:11], v[2:3], v[2:3]
    v_pk_mul_f32 v[12:13], v[4:5], v[4:5]
    v_pk_mul_f32 v[14:15], v[6:7], v[6:7]
    v_pk_fma_f32 v[8:9], v[8:9], v[242:243], v[240:241]
    v_pk_fma_f32 v[10:11], v[10:11], v[242:243], v[240:241]
    v_pk_fma_f32 v[12:13], v[12:13], v[242:243], v[240:241]
    v_pk_fma_f32 v[14:15], v[14:15], v[242:243], v[240:241]
    v_pk_mul_f32 v[8:9], v[8:9], v[0:1]
    v_pk_mul_f32 v[10:11], v[10:11], v[2:3]
    v_pk_mul_f32 v[12:13], v[12:13], v[4:5]
    v_pk_mul_f32 v[14:15], v[14:15], v[6:7]
    v_exp_f32 v8, v8
    v_exp_f32 v9, v9
    v_exp_f32 v10, v10
    v_exp_f32 v11, v11
    v_exp_f32 v12, v12
    v_exp_f32 v13, v13
    v_exp_f32 v14, v14
    v_exp_f32 v15, v15
    v_pk_add_f32 v[8:9], v[8:9], v[244:245]
    v_pk_add_f32 v[10:11], v[10:11], v[244:245]
    v_pk_add_f32 v[12:13], v[12:13], v[244:245]
    v_pk_add_f32 v[14:15], v[14:15], v[244:245]
    v_rcp_f32 v8, v8
    v_rcp_f32 v9, v9
    v_rcp_f32 v10, v10
    v_rcp_f32 v11, v11
    v_rcp_f32 v12, v12
    v_rcp_f32 v13, v13
    v_rcp_f32 v14, v14
    v_rcp_f32 v15, v15
    v_pk_mul_f32 v[0:1], v[8:9], v[0:1]
    v_pk_mul_f32 v[2:3], v[10:11], v[2:3]
    v_pk_mul_f32 v[4:5], v[12:13], v[4:5]
    v_pk_mul_f32 v[6:7], v[14:15], v[6:7]
    v_cvt_pk_bf16_f32 v16, v0, v1
    v_cvt_pk_bf16_f32 v17, v2, v3
    v_cvt_pk_bf16_f32 v18, v4, v5
    v_cvt_pk_bf16_f32 v19, v6, v7
    buffer_store_dwordx4 v[16:19], v251, s[4:7], s53 offen offset:1024 sc1
    v_accvgpr_read_b32 v20, a80
    v_accvgpr_read_b32 v21, a81
    v_accvgpr_read_b32 v22, a82
    v_accvgpr_read_b32 v23, a83
    v_accvgpr_read_b32 v24, a84
    v_accvgpr_read_b32 v25, a85
    v_accvgpr_read_b32 v26, a86
    v_accvgpr_read_b32 v27, a87
    v_pk_mul_f32 v[28:29], v[20:21], v[20:21]
    v_pk_mul_f32 v[30:31], v[22:23], v[22:23]
    v_pk_mul_f32 v[32:33], v[24:25], v[24:25]
    v_pk_mul_f32 v[34:35], v[26:27], v[26:27]
    v_pk_fma_f32 v[28:29], v[28:29], v[242:243], v[240:241]
    v_pk_fma_f32 v[30:31], v[30:31], v[242:243], v[240:241]
    v_pk_fma_f32 v[32:33], v[32:33], v[242:243], v[240:241]
    v_pk_fma_f32 v[34:35], v[34:35], v[242:243], v[240:241]
    v_pk_mul_f32 v[28:29], v[28:29], v[20:21]
    v_pk_mul_f32 v[30:31], v[30:31], v[22:23]
    v_pk_mul_f32 v[32:33], v[32:33], v[24:25]
    v_pk_mul_f32 v[34:35], v[34:35], v[26:27]
    v_exp_f32 v28, v28
    v_exp_f32 v29, v29
    v_exp_f32 v30, v30
    v_exp_f32 v31, v31
    v_exp_f32 v32, v32
    v_exp_f32 v33, v33
    v_exp_f32 v34, v34
    v_exp_f32 v35, v35
    v_pk_add_f32 v[28:29], v[28:29], v[244:245]
    v_pk_add_f32 v[30:31], v[30:31], v[244:245]
    v_pk_add_f32 v[32:33], v[32:33], v[244:245]
    v_pk_add_f32 v[34:35], v[34:35], v[244:245]
    v_rcp_f32 v28, v28
    v_rcp_f32 v29, v29
    v_rcp_f32 v30, v30
    v_rcp_f32 v31, v31
    v_rcp_f32 v32, v32
    v_rcp_f32 v33, v33
    v_rcp_f32 v34, v34
    v_rcp_f32 v35, v35
    v_pk_mul_f32 v[20:21], v[28:29], v[20:21]
    v_pk_mul_f32 v[22:23], v[30:31], v[22:23]
    v_pk_mul_f32 v[24:25], v[32:33], v[24:25]
    v_pk_mul_f32 v[26:27], v[34:35], v[26:27]
    v_cvt_pk_bf16_f32 v36, v20, v21
    v_cvt_pk_bf16_f32 v37, v22, v23
    v_cvt_pk_bf16_f32 v38, v24, v25
    v_cvt_pk_bf16_f32 v39, v26, v27
    buffer_store_dwordx4 v[36:39], v251, s[4:7], s53 offen offset:2048 sc1
    v_accvgpr_read_b32 v40, a88
    v_accvgpr_read_b32 v41, a89
    v_accvgpr_read_b32 v42, a90
    v_accvgpr_read_b32 v43, a91
    v_accvgpr_read_b32 v44, a92
    v_accvgpr_read_b32 v45, a93
    v_accvgpr_read_b32 v46, a94
    v_accvgpr_read_b32 v47, a95
    v_pk_mul_f32 v[48:49], v[40:41], v[40:41]
    v_pk_mul_f32 v[50:51], v[42:43], v[42:43]
    v_pk_mul_f32 v[52:53], v[44:45], v[44:45]
    v_pk_mul_f32 v[54:55], v[46:47], v[46:47]
    v_pk_fma_f32 v[48:49], v[48:49], v[242:243], v[240:241]
    v_pk_fma_f32 v[50:51], v[50:51], v[242:243], v[240:241]
    v_pk_fma_f32 v[52:53], v[52:53], v[242:243], v[240:241]
    v_pk_fma_f32 v[54:55], v[54:55], v[242:243], v[240:241]
    v_pk_mul_f32 v[48:49], v[48:49], v[40:41]
    v_pk_mul_f32 v[50:51], v[50:51], v[42:43]
    v_pk_mul_f32 v[52:53], v[52:53], v[44:45]
    v_pk_mul_f32 v[54:55], v[54:55], v[46:47]
    v_exp_f32 v48, v48
    v_exp_f32 v49, v49
    v_exp_f32 v50, v50
    v_exp_f32 v51, v51
    v_exp_f32 v52, v52
    v_exp_f32 v53, v53
    v_exp_f32 v54, v54
    v_exp_f32 v55, v55
    v_pk_add_f32 v[48:49], v[48:49], v[244:245]
    v_pk_add_f32 v[50:51], v[50:51], v[244:245]
    v_pk_add_f32 v[52:53], v[52:53], v[244:245]
    v_pk_add_f32 v[54:55], v[54:55], v[244:245]
    v_rcp_f32 v48, v48
    v_rcp_f32 v49, v49
    v_rcp_f32 v50, v50
    v_rcp_f32 v51, v51
    v_rcp_f32 v52, v52
    v_rcp_f32 v53, v53
    v_rcp_f32 v54, v54
    v_rcp_f32 v55, v55
    v_pk_mul_f32 v[40:41], v[48:49], v[40:41]
    v_pk_mul_f32 v[42:43], v[50:51], v[42:43]
    v_pk_mul_f32 v[44:45], v[52:53], v[44:45]
    v_pk_mul_f32 v[46:47], v[54:55], v[46:47]
    v_cvt_pk_bf16_f32 v56, v40, v41
    v_cvt_pk_bf16_f32 v57, v42, v43
    v_cvt_pk_bf16_f32 v58, v44, v45
    v_cvt_pk_bf16_f32 v59, v46, v47
    buffer_store_dwordx4 v[56:59], v251, s[4:7], s53 offen offset:3072 sc1
    s_add_u32 s53, s53, s22
    v_accvgpr_read_b32 v0, a96
    v_accvgpr_read_b32 v1, a97
    v_accvgpr_read_b32 v2, a98
    v_accvgpr_read_b32 v3, a99
    v_accvgpr_read_b32 v4, a100
    v_accvgpr_read_b32 v5, a101
    v_accvgpr_read_b32 v6, a102
    v_accvgpr_read_b32 v7, a103
    v_pk_mul_f32 v[8:9], v[0:1], v[0:1]
    v_pk_mul_f32 v[10:11], v[2:3], v[2:3]
    v_pk_mul_f32 v[12:13], v[4:5], v[4:5]
    v_pk_mul_f32 v[14:15], v[6:7], v[6:7]
    v_pk_fma_f32 v[8:9], v[8:9], v[242:243], v[240:241]
    v_pk_fma_f32 v[10:11], v[10:11], v[242:243], v[240:241]
    v_pk_fma_f32 v[12:13], v[12:13], v[242:243], v[240:241]
    v_pk_fma_f32 v[14:15], v[14:15], v[242:243], v[240:241]
    v_pk_mul_f32 v[8:9], v[8:9], v[0:1]
    v_pk_mul_f32 v[10:11], v[10:11], v[2:3]
    v_pk_mul_f32 v[12:13], v[12:13], v[4:5]
    v_pk_mul_f32 v[14:15], v[14:15], v[6:7]
    v_exp_f32 v8, v8
    v_exp_f32 v9, v9
    v_exp_f32 v10, v10
    v_exp_f32 v11, v11
    v_exp_f32 v12, v12
    v_exp_f32 v13, v13
    v_exp_f32 v14, v14
    v_exp_f32 v15, v15
    v_pk_add_f32 v[8:9], v[8:9], v[244:245]
    v_pk_add_f32 v[10:11], v[10:11], v[244:245]
    v_pk_add_f32 v[12:13], v[12:13], v[244:245]
    v_pk_add_f32 v[14:15], v[14:15], v[244:245]
    v_rcp_f32 v8, v8
    v_rcp_f32 v9, v9
    v_rcp_f32 v10, v10
    v_rcp_f32 v11, v11
    v_rcp_f32 v12, v12
    v_rcp_f32 v13, v13
    v_rcp_f32 v14, v14
    v_rcp_f32 v15, v15
    v_pk_mul_f32 v[0:1], v[8:9], v[0:1]
    v_pk_mul_f32 v[2:3], v[10:11], v[2:3]
    v_pk_mul_f32 v[4:5], v[12:13], v[4:5]
    v_pk_mul_f32 v[6:7], v[14:15], v[6:7]
    v_cvt_pk_bf16_f32 v16, v0, v1
    v_cvt_pk_bf16_f32 v17, v2, v3
    v_cvt_pk_bf16_f32 v18, v4, v5
    v_cvt_pk_bf16_f32 v19, v6, v7
    buffer_store_dwordx4 v[16:19], v251, s[4:7], s53 offen offset:0 sc1
    v_accvgpr_read_b32 v20, a104
    v_accvgpr_read_b32 v21, a105
    v_accvgpr_read_b32 v22, a106
    v_accvgpr_read_b32 v23, a107
    v_accvgpr_read_b32 v24, a108
    v_accvgpr_read_b32 v25, a109
    v_accvgpr_read_b32 v26, a110
    v_accvgpr_read_b32 v27, a111
    v_pk_mul_f32 v[28:29], v[20:21], v[20:21]
    v_pk_mul_f32 v[30:31], v[22:23], v[22:23]
    v_pk_mul_f32 v[32:33], v[24:25], v[24:25]
    v_pk_mul_f32 v[34:35], v[26:27], v[26:27]
    v_pk_fma_f32 v[28:29], v[28:29], v[242:243], v[240:241]
    v_pk_fma_f32 v[30:31], v[30:31], v[242:243], v[240:241]
    v_pk_fma_f32 v[32:33], v[32:33], v[242:243], v[240:241]
    v_pk_fma_f32 v[34:35], v[34:35], v[242:243], v[240:241]
    v_pk_mul_f32 v[28:29], v[28:29], v[20:21]
    v_pk_mul_f32 v[30:31], v[30:31], v[22:23]
    v_pk_mul_f32 v[32:33], v[32:33], v[24:25]
    v_pk_mul_f32 v[34:35], v[34:35], v[26:27]
    v_exp_f32 v28, v28
    v_exp_f32 v29, v29
    v_exp_f32 v30, v30
    v_exp_f32 v31, v31
    v_exp_f32 v32, v32
    v_exp_f32 v33, v33
    v_exp_f32 v34, v34
    v_exp_f32 v35, v35
    v_pk_add_f32 v[28:29], v[28:29], v[244:245]
    v_pk_add_f32 v[30:31], v[30:31], v[244:245]
    v_pk_add_f32 v[32:33], v[32:33], v[244:245]
    v_pk_add_f32 v[34:35], v[34:35], v[244:245]
    v_rcp_f32 v28, v28
    v_rcp_f32 v29, v29
    v_rcp_f32 v30, v30
    v_rcp_f32 v31, v31
    v_rcp_f32 v32, v32
    v_rcp_f32 v33, v33
    v_rcp_f32 v34, v34
    v_rcp_f32 v35, v35
    v_pk_mul_f32 v[20:21], v[28:29], v[20:21]
    v_pk_mul_f32 v[22:23], v[30:31], v[22:23]
    v_pk_mul_f32 v[24:25], v[32:33], v[24:25]
    v_pk_mul_f32 v[26:27], v[34:35], v[26:27]
    v_cvt_pk_bf16_f32 v36, v20, v21
    v_cvt_pk_bf16_f32 v37, v22, v23
    v_cvt_pk_bf16_f32 v38, v24, v25
    v_cvt_pk_bf16_f32 v39, v26, v27
    buffer_store_dwordx4 v[36:39], v251, s[4:7], s53 offen offset:1024 sc1
    v_accvgpr_read_b32 v40, a112
    v_accvgpr_read_b32 v41, a113
    v_accvgpr_read_b32 v42, a114
    v_accvgpr_read_b32 v43, a115
    v_accvgpr_read_b32 v44, a116
    v_accvgpr_read_b32 v45, a117
    v_accvgpr_read_b32 v46, a118
    v_accvgpr_read_b32 v47, a119
    v_pk_mul_f32 v[48:49], v[40:41], v[40:41]
    v_pk_mul_f32 v[50:51], v[42:43], v[42:43]
    v_pk_mul_f32 v[52:53], v[44:45], v[44:45]
    v_pk_mul_f32 v[54:55], v[46:47], v[46:47]
    v_pk_fma_f32 v[48:49], v[48:49], v[242:243], v[240:241]
    v_pk_fma_f32 v[50:51], v[50:51], v[242:243], v[240:241]
    v_pk_fma_f32 v[52:53], v[52:53], v[242:243], v[240:241]
    v_pk_fma_f32 v[54:55], v[54:55], v[242:243], v[240:241]
    v_pk_mul_f32 v[48:49], v[48:49], v[40:41]
    v_pk_mul_f32 v[50:51], v[50:51], v[42:43]
    v_pk_mul_f32 v[52:53], v[52:53], v[44:45]
    v_pk_mul_f32 v[54:55], v[54:55], v[46:47]
    v_exp_f32 v48, v48
    v_exp_f32 v49, v49
    v_exp_f32 v50, v50
    v_exp_f32 v51, v51
    v_exp_f32 v52, v52
    v_exp_f32 v53, v53
    v_exp_f32 v54, v54
    v_exp_f32 v55, v55
    v_pk_add_f32 v[48:49], v[48:49], v[244:245]
    v_pk_add_f32 v[50:51], v[50:51], v[244:245]
    v_pk_add_f32 v[52:53], v[52:53], v[244:245]
    v_pk_add_f32 v[54:55], v[54:55], v[244:245]
    v_rcp_f32 v48, v48
    v_rcp_f32 v49, v49
    v_rcp_f32 v50, v50
    v_rcp_f32 v51, v51
    v_rcp_f32 v52, v52
    v_rcp_f32 v53, v53
    v_rcp_f32 v54, v54
    v_rcp_f32 v55, v55
    v_pk_mul_f32 v[40:41], v[48:49], v[40:41]
    v_pk_mul_f32 v[42:43], v[50:51], v[42:43]
    v_pk_mul_f32 v[44:45], v[52:53], v[44:45]
    v_pk_mul_f32 v[46:47], v[54:55], v[46:47]
    v_cvt_pk_bf16_f32 v56, v40, v41
    v_cvt_pk_bf16_f32 v57, v42, v43
    v_cvt_pk_bf16_f32 v58, v44, v45
    v_cvt_pk_bf16_f32 v59, v46, v47
    buffer_store_dwordx4 v[56:59], v251, s[4:7], s53 offen offset:2048 sc1
    v_accvgpr_read_b32 v0, a120
    v_accvgpr_read_b32 v1, a121
    v_accvgpr_read_b32 v2, a122
    v_accvgpr_read_b32 v3, a123
    v_accvgpr_read_b32 v4, a124
    v_accvgpr_read_b32 v5, a125
    v_accvgpr_read_b32 v6, a126
    v_accvgpr_read_b32 v7, a127
    v_pk_mul_f32 v[8:9], v[0:1], v[0:1]
    v_pk_mul_f32 v[10:11], v[2:3], v[2:3]
    v_pk_mul_f32 v[12:13], v[4:5], v[4:5]
    v_pk_mul_f32 v[14:15], v[6:7], v[6:7]
    v_pk_fma_f32 v[8:9], v[8:9], v[242:243], v[240:241]
    v_pk_fma_f32 v[10:11], v[10:11], v[242:243], v[240:241]
    v_pk_fma_f32 v[12:13], v[12:13], v[242:243], v[240:241]
    v_pk_fma_f32 v[14:15], v[14:15], v[242:243], v[240:241]
    v_pk_mul_f32 v[8:9], v[8:9], v[0:1]
    v_pk_mul_f32 v[10:11], v[10:11], v[2:3]
    v_pk_mul_f32 v[12:13], v[12:13], v[4:5]
    v_pk_mul_f32 v[14:15], v[14:15], v[6:7]
    v_exp_f32 v8, v8
    v_exp_f32 v9, v9
    v_exp_f32 v10, v10
    v_exp_f32 v11, v11
    v_exp_f32 v12, v12
    v_exp_f32 v13, v13
    v_exp_f32 v14, v14
    v_exp_f32 v15, v15
    v_pk_add_f32 v[8:9], v[8:9], v[244:245]
    v_pk_add_f32 v[10:11], v[10:11], v[244:245]
    v_pk_add_f32 v[12:13], v[12:13], v[244:245]
    v_pk_add_f32 v[14:15], v[14:15], v[244:245]
    v_rcp_f32 v8, v8
    v_rcp_f32 v9, v9
    v_rcp_f32 v10, v10
    v_rcp_f32 v11, v11
    v_rcp_f32 v12, v12
    v_rcp_f32 v13, v13
    v_rcp_f32 v14, v14
    v_rcp_f32 v15, v15
    v_pk_mul_f32 v[0:1], v[8:9], v[0:1]
    v_pk_mul_f32 v[2:3], v[10:11], v[2:3]
    v_pk_mul_f32 v[4:5], v[12:13], v[4:5]
    v_pk_mul_f32 v[6:7], v[14:15], v[6:7]
    v_cvt_pk_bf16_f32 v16, v0, v1
    v_cvt_pk_bf16_f32 v17, v2, v3
    v_cvt_pk_bf16_f32 v18, v4, v5
    v_cvt_pk_bf16_f32 v19, v6, v7
    buffer_store_dwordx4 v[16:19], v251, s[4:7], s53 offen offset:3072 sc1
    s_add_u32 s53, s53, s22
    v_accvgpr_read_b32 v20, a128
    v_accvgpr_read_b32 v21, a129
    v_accvgpr_read_b32 v22, a130
    v_accvgpr_read_b32 v23, a131
    v_accvgpr_read_b32 v24, a132
    v_accvgpr_read_b32 v25, a133
    v_accvgpr_read_b32 v26, a134
    v_accvgpr_read_b32 v27, a135
    v_pk_mul_f32 v[28:29], v[20:21], v[20:21]
    v_pk_mul_f32 v[30:31], v[22:23], v[22:23]
    v_pk_mul_f32 v[32:33], v[24:25], v[24:25]
    v_pk_mul_f32 v[34:35], v[26:27], v[26:27]
    v_pk_fma_f32 v[28:29], v[28:29], v[242:243], v[240:241]
    v_pk_fma_f32 v[30:31], v[30:31], v[242:243], v[240:241]
    v_pk_fma_f32 v[32:33], v[32:33], v[242:243], v[240:241]
    v_pk_fma_f32 v[34:35], v[34:35], v[242:243], v[240:241]
    v_pk_mul_f32 v[28:29], v[28:29], v[20:21]
    v_pk_mul_f32 v[30:31], v[30:31], v[22:23]
    v_pk_mul_f32 v[32:33], v[32:33], v[24:25]
    v_pk_mul_f32 v[34:35], v[34:35], v[26:27]
    v_exp_f32 v28, v28
    v_exp_f32 v29, v29
    v_exp_f32 v30, v30
    v_exp_f32 v31, v31
    v_exp_f32 v32, v32
    v_exp_f32 v33, v33
    v_exp_f32 v34, v34
    v_exp_f32 v35, v35
    v_pk_add_f32 v[28:29], v[28:29], v[244:245]
    v_pk_add_f32 v[30:31], v[30:31], v[244:245]
    v_pk_add_f32 v[32:33], v[32:33], v[244:245]
    v_pk_add_f32 v[34:35], v[34:35], v[244:245]
    v_rcp_f32 v28, v28
    v_rcp_f32 v29, v29
    v_rcp_f32 v30, v30
    v_rcp_f32 v31, v31
    v_rcp_f32 v32, v32
    v_rcp_f32 v33, v33
    v_rcp_f32 v34, v34
    v_rcp_f32 v35, v35
    v_pk_mul_f32 v[20:21], v[28:29], v[20:21]
    v_pk_mul_f32 v[22:23], v[30:31], v[22:23]
    v_pk_mul_f32 v[24:25], v[32:33], v[24:25]
    v_pk_mul_f32 v[26:27], v[34:35], v[26:27]
    v_cvt_pk_bf16_f32 v36, v20, v21
    v_cvt_pk_bf16_f32 v37, v22, v23
    v_cvt_pk_bf16_f32 v38, v24, v25
    v_cvt_pk_bf16_f32 v39, v26, v27
    buffer_store_dwordx4 v[36:39], v251, s[4:7], s53 offen offset:0 sc1
    v_accvgpr_read_b32 v40, a136
    v_accvgpr_read_b32 v41, a137
    v_accvgpr_read_b32 v42, a138
    v_accvgpr_read_b32 v43, a139
    v_accvgpr_read_b32 v44, a140
    v_accvgpr_read_b32 v45, a141
    v_accvgpr_read_b32 v46, a142
    v_accvgpr_read_b32 v47, a143
    v_pk_mul_f32 v[48:49], v[40:41], v[40:41]
    v_pk_mul_f32 v[50:51], v[42:43], v[42:43]
    v_pk_mul_f32 v[52:53], v[44:45], v[44:45]
    v_pk_mul_f32 v[54:55], v[46:47], v[46:47]
    v_pk_fma_f32 v[48:49], v[48:49], v[242:243], v[240:241]
    v_pk_fma_f32 v[50:51], v[50:51], v[242:243], v[240:241]
    v_pk_fma_f32 v[52:53], v[52:53], v[242:243], v[240:241]
    v_pk_fma_f32 v[54:55], v[54:55], v[242:243], v[240:241]
    v_pk_mul_f32 v[48:49], v[48:49], v[40:41]
    v_pk_mul_f32 v[50:51], v[50:51], v[42:43]
    v_pk_mul_f32 v[52:53], v[52:53], v[44:45]
    v_pk_mul_f32 v[54:55], v[54:55], v[46:47]
    v_exp_f32 v48, v48
    v_exp_f32 v49, v49
    v_exp_f32 v50, v50
    v_exp_f32 v51, v51
    v_exp_f32 v52, v52
    v_exp_f32 v53, v53
    v_exp_f32 v54, v54
    v_exp_f32 v55, v55
    v_pk_add_f32 v[48:49], v[48:49], v[244:245]
    v_pk_add_f32 v[50:51], v[50:51], v[244:245]
    v_pk_add_f32 v[52:53], v[52:53], v[244:245]
    v_pk_add_f32 v[54:55], v[54:55], v[244:245]
    v_rcp_f32 v48, v48
    v_rcp_f32 v49, v49
    v_rcp_f32 v50, v50
    v_rcp_f32 v51, v51
    v_rcp_f32 v52, v52
    v_rcp_f32 v53, v53
    v_rcp_f32 v54, v54
    v_rcp_f32 v55, v55
    v_pk_mul_f32 v[40:41], v[48:49], v[40:41]
    v_pk_mul_f32 v[42:43], v[50:51], v[42:43]
    v_pk_mul_f32 v[44:45], v[52:53], v[44:45]
    v_pk_mul_f32 v[46:47], v[54:55], v[46:47]
    v_cvt_pk_bf16_f32 v56, v40, v41
    v_cvt_pk_bf16_f32 v57, v42, v43
    v_cvt_pk_bf16_f32 v58, v44, v45
    v_cvt_pk_bf16_f32 v59, v46, v47
    buffer_store_dwordx4 v[56:59], v251, s[4:7], s53 offen offset:1024 sc1
    v_accvgpr_read_b32 v0, a144
    v_accvgpr_read_b32 v1, a145
    v_accvgpr_read_b32 v2, a146
    v_accvgpr_read_b32 v3, a147
    v_accvgpr_read_b32 v4, a148
    v_accvgpr_read_b32 v5, a149
    v_accvgpr_read_b32 v6, a150
    v_accvgpr_read_b32 v7, a151
    v_pk_mul_f32 v[8:9], v[0:1], v[0:1]
    v_pk_mul_f32 v[10:11], v[2:3], v[2:3]
    v_pk_mul_f32 v[12:13], v[4:5], v[4:5]
    v_pk_mul_f32 v[14:15], v[6:7], v[6:7]
    v_pk_fma_f32 v[8:9], v[8:9], v[242:243], v[240:241]
    v_pk_fma_f32 v[10:11], v[10:11], v[242:243], v[240:241]
    v_pk_fma_f32 v[12:13], v[12:13], v[242:243], v[240:241]
    v_pk_fma_f32 v[14:15], v[14:15], v[242:243], v[240:241]
    v_pk_mul_f32 v[8:9], v[8:9], v[0:1]
    v_pk_mul_f32 v[10:11], v[10:11], v[2:3]
    v_pk_mul_f32 v[12:13], v[12:13], v[4:5]
    v_pk_mul_f32 v[14:15], v[14:15], v[6:7]
    v_exp_f32 v8, v8
    v_exp_f32 v9, v9
    v_exp_f32 v10, v10
    v_exp_f32 v11, v11
    v_exp_f32 v12, v12
    v_exp_f32 v13, v13
    v_exp_f32 v14, v14
    v_exp_f32 v15, v15
    v_pk_add_f32 v[8:9], v[8:9], v[244:245]
    v_pk_add_f32 v[10:11], v[10:11], v[244:245]
    v_pk_add_f32 v[12:13], v[12:13], v[244:245]
    v_pk_add_f32 v[14:15], v[14:15], v[244:245]
    v_rcp_f32 v8, v8
    v_rcp_f32 v9, v9
    v_rcp_f32 v10, v10
    v_rcp_f32 v11, v11
    v_rcp_f32 v12, v12
    v_rcp_f32 v13, v13
    v_rcp_f32 v14, v14
    v_rcp_f32 v15, v15
    v_pk_mul_f32 v[0:1], v[8:9], v[0:1]
    v_pk_mul_f32 v[2:3], v[10:11], v[2:3]
    v_pk_mul_f32 v[4:5], v[12:13], v[4:5]
    v_pk_mul_f32 v[6:7], v[14:15], v[6:7]
    v_cvt_pk_bf16_f32 v16, v0, v1
    v_cvt_pk_bf16_f32 v17, v2, v3
    v_cvt_pk_bf16_f32 v18, v4, v5
    v_cvt_pk_bf16_f32 v19, v6, v7
    buffer_store_dwordx4 v[16:19], v251, s[4:7], s53 offen offset:2048 sc1
    v_accvgpr_read_b32 v20, a152
    v_accvgpr_read_b32 v21, a153
    v_accvgpr_read_b32 v22, a154
    v_accvgpr_read_b32 v23, a155
    v_accvgpr_read_b32 v24, a156
    v_accvgpr_read_b32 v25, a157
    v_accvgpr_read_b32 v26, a158
    v_accvgpr_read_b32 v27, a159
    v_pk_mul_f32 v[28:29], v[20:21], v[20:21]
    v_pk_mul_f32 v[30:31], v[22:23], v[22:23]
    v_pk_mul_f32 v[32:33], v[24:25], v[24:25]
    v_pk_mul_f32 v[34:35], v[26:27], v[26:27]
    v_pk_fma_f32 v[28:29], v[28:29], v[242:243], v[240:241]
    v_pk_fma_f32 v[30:31], v[30:31], v[242:243], v[240:241]
    v_pk_fma_f32 v[32:33], v[32:33], v[242:243], v[240:241]
    v_pk_fma_f32 v[34:35], v[34:35], v[242:243], v[240:241]
    v_pk_mul_f32 v[28:29], v[28:29], v[20:21]
    v_pk_mul_f32 v[30:31], v[30:31], v[22:23]
    v_pk_mul_f32 v[32:33], v[32:33], v[24:25]
    v_pk_mul_f32 v[34:35], v[34:35], v[26:27]
    v_exp_f32 v28, v28
    v_exp_f32 v29, v29
    v_exp_f32 v30, v30
    v_exp_f32 v31, v31
    v_exp_f32 v32, v32
    v_exp_f32 v33, v33
    v_exp_f32 v34, v34
    v_exp_f32 v35, v35
    v_pk_add_f32 v[28:29], v[28:29], v[244:245]
    v_pk_add_f32 v[30:31], v[30:31], v[244:245]
    v_pk_add_f32 v[32:33], v[32:33], v[244:245]
    v_pk_add_f32 v[34:35], v[34:35], v[244:245]
    v_rcp_f32 v28, v28
    v_rcp_f32 v29, v29
    v_rcp_f32 v30, v30
    v_rcp_f32 v31, v31
    v_rcp_f32 v32, v32
    v_rcp_f32 v33, v33
    v_rcp_f32 v34, v34
    v_rcp_f32 v35, v35
    v_pk_mul_f32 v[20:21], v[28:29], v[20:21]
    v_pk_mul_f32 v[22:23], v[30:31], v[22:23]
    v_pk_mul_f32 v[24:25], v[32:33], v[24:25]
    v_pk_mul_f32 v[26:27], v[34:35], v[26:27]
    v_cvt_pk_bf16_f32 v36, v20, v21
    v_cvt_pk_bf16_f32 v37, v22, v23
    v_cvt_pk_bf16_f32 v38, v24, v25
    v_cvt_pk_bf16_f32 v39, v26, v27
    buffer_store_dwordx4 v[36:39], v251, s[4:7], s53 offen offset:3072 sc1
    s_add_u32 s53, s53, s22
    v_accvgpr_read_b32 v40, a160
    v_accvgpr_read_b32 v41, a161
    v_accvgpr_read_b32 v42, a162
    v_accvgpr_read_b32 v43, a163
    v_accvgpr_read_b32 v44, a164
    v_accvgpr_read_b32 v45, a165
    v_accvgpr_read_b32 v46, a166
    v_accvgpr_read_b32 v47, a167
    v_pk_mul_f32 v[48:49], v[40:41], v[40:41]
    v_pk_mul_f32 v[50:51], v[42:43], v[42:43]
    v_pk_mul_f32 v[52:53], v[44:45], v[44:45]
    v_pk_mul_f32 v[54:55], v[46:47], v[46:47]
    v_pk_fma_f32 v[48:49], v[48:49], v[242:243], v[240:241]
    v_pk_fma_f32 v[50:51], v[50:51], v[242:243], v[240:241]
    v_pk_fma_f32 v[52:53], v[52:53], v[242:243], v[240:241]
    v_pk_fma_f32 v[54:55], v[54:55], v[242:243], v[240:241]
    v_pk_mul_f32 v[48:49], v[48:49], v[40:41]
    v_pk_mul_f32 v[50:51], v[50:51], v[42:43]
    v_pk_mul_f32 v[52:53], v[52:53], v[44:45]
    v_pk_mul_f32 v[54:55], v[54:55], v[46:47]
    v_exp_f32 v48, v48
    v_exp_f32 v49, v49
    v_exp_f32 v50, v50
    v_exp_f32 v51, v51
    v_exp_f32 v52, v52
    v_exp_f32 v53, v53
    v_exp_f32 v54, v54
    v_exp_f32 v55, v55
    v_pk_add_f32 v[48:49], v[48:49], v[244:245]
    v_pk_add_f32 v[50:51], v[50:51], v[244:245]
    v_pk_add_f32 v[52:53], v[52:53], v[244:245]
    v_pk_add_f32 v[54:55], v[54:55], v[244:245]
    v_rcp_f32 v48, v48
    v_rcp_f32 v49, v49
    v_rcp_f32 v50, v50
    v_rcp_f32 v51, v51
    v_rcp_f32 v52, v52
    v_rcp_f32 v53, v53
    v_rcp_f32 v54, v54
    v_rcp_f32 v55, v55
    v_pk_mul_f32 v[40:41], v[48:49], v[40:41]
    v_pk_mul_f32 v[42:43], v[50:51], v[42:43]
    v_pk_mul_f32 v[44:45], v[52:53], v[44:45]
    v_pk_mul_f32 v[46:47], v[54:55], v[46:47]
    v_cvt_pk_bf16_f32 v56, v40, v41
    v_cvt_pk_bf16_f32 v57, v42, v43
    v_cvt_pk_bf16_f32 v58, v44, v45
    v_cvt_pk_bf16_f32 v59, v46, v47
    buffer_store_dwordx4 v[56:59], v251, s[4:7], s53 offen offset:0 sc1
    v_accvgpr_read_b32 v0, a168
    v_accvgpr_read_b32 v1, a169
    v_accvgpr_read_b32 v2, a170
    v_accvgpr_read_b32 v3, a171
    v_accvgpr_read_b32 v4, a172
    v_accvgpr_read_b32 v5, a173
    v_accvgpr_read_b32 v6, a174
    v_accvgpr_read_b32 v7, a175
    v_pk_mul_f32 v[8:9], v[0:1], v[0:1]
    v_pk_mul_f32 v[10:11], v[2:3], v[2:3]
    v_pk_mul_f32 v[12:13], v[4:5], v[4:5]
    v_pk_mul_f32 v[14:15], v[6:7], v[6:7]
    v_pk_fma_f32 v[8:9], v[8:9], v[242:243], v[240:241]
    v_pk_fma_f32 v[10:11], v[10:11], v[242:243], v[240:241]
    v_pk_fma_f32 v[12:13], v[12:13], v[242:243], v[240:241]
    v_pk_fma_f32 v[14:15], v[14:15], v[242:243], v[240:241]
    v_pk_mul_f32 v[8:9], v[8:9], v[0:1]
    v_pk_mul_f32 v[10:11], v[10:11], v[2:3]
    v_pk_mul_f32 v[12:13], v[12:13], v[4:5]
    v_pk_mul_f32 v[14:15], v[14:15], v[6:7]
    v_exp_f32 v8, v8
    v_exp_f32 v9, v9
    v_exp_f32 v10, v10
    v_exp_f32 v11, v11
    v_exp_f32 v12, v12
    v_exp_f32 v13, v13
    v_exp_f32 v14, v14
    v_exp_f32 v15, v15
    v_pk_add_f32 v[8:9], v[8:9], v[244:245]
    v_pk_add_f32 v[10:11], v[10:11], v[244:245]
    v_pk_add_f32 v[12:13], v[12:13], v[244:245]
    v_pk_add_f32 v[14:15], v[14:15], v[244:245]
    v_rcp_f32 v8, v8
    v_rcp_f32 v9, v9
    v_rcp_f32 v10, v10
    v_rcp_f32 v11, v11
    v_rcp_f32 v12, v12
    v_rcp_f32 v13, v13
    v_rcp_f32 v14, v14
    v_rcp_f32 v15, v15
    v_pk_mul_f32 v[0:1], v[8:9], v[0:1]
    v_pk_mul_f32 v[2:3], v[10:11], v[2:3]
    v_pk_mul_f32 v[4:5], v[12:13], v[4:5]
    v_pk_mul_f32 v[6:7], v[14:15], v[6:7]
    v_cvt_pk_bf16_f32 v16, v0, v1
    v_cvt_pk_bf16_f32 v17, v2, v3
    v_cvt_pk_bf16_f32 v18, v4, v5
    v_cvt_pk_bf16_f32 v19, v6, v7
    buffer_store_dwordx4 v[16:19], v251, s[4:7], s53 offen offset:1024 sc1
    v_accvgpr_read_b32 v20, a176
    v_accvgpr_read_b32 v21, a177
    v_accvgpr_read_b32 v22, a178
    v_accvgpr_read_b32 v23, a179
    v_accvgpr_read_b32 v24, a180
    v_accvgpr_read_b32 v25, a181
    v_accvgpr_read_b32 v26, a182
    v_accvgpr_read_b32 v27, a183
    v_pk_mul_f32 v[28:29], v[20:21], v[20:21]
    v_pk_mul_f32 v[30:31], v[22:23], v[22:23]
    v_pk_mul_f32 v[32:33], v[24:25], v[24:25]
    v_pk_mul_f32 v[34:35], v[26:27], v[26:27]
    v_pk_fma_f32 v[28:29], v[28:29], v[242:243], v[240:241]
    v_pk_fma_f32 v[30:31], v[30:31], v[242:243], v[240:241]
    v_pk_fma_f32 v[32:33], v[32:33], v[242:243], v[240:241]
    v_pk_fma_f32 v[34:35], v[34:35], v[242:243], v[240:241]
    v_pk_mul_f32 v[28:29], v[28:29], v[20:21]
    v_pk_mul_f32 v[30:31], v[30:31], v[22:23]
    v_pk_mul_f32 v[32:33], v[32:33], v[24:25]
    v_pk_mul_f32 v[34:35], v[34:35], v[26:27]
    v_exp_f32 v28, v28
    v_exp_f32 v29, v29
    v_exp_f32 v30, v30
    v_exp_f32 v31, v31
    v_exp_f32 v32, v32
    v_exp_f32 v33, v33
    v_exp_f32 v34, v34
    v_exp_f32 v35, v35
    v_pk_add_f32 v[28:29], v[28:29], v[244:245]
    v_pk_add_f32 v[30:31], v[30:31], v[244:245]
    v_pk_add_f32 v[32:33], v[32:33], v[244:245]
    v_pk_add_f32 v[34:35], v[34:35], v[244:245]
    v_rcp_f32 v28, v28
    v_rcp_f32 v29, v29
    v_rcp_f32 v30, v30
    v_rcp_f32 v31, v31
    v_rcp_f32 v32, v32
    v_rcp_f32 v33, v33
    v_rcp_f32 v34, v34
    v_rcp_f32 v35, v35
    v_pk_mul_f32 v[20:21], v[28:29], v[20:21]
    v_pk_mul_f32 v[22:23], v[30:31], v[22:23]
    v_pk_mul_f32 v[24:25], v[32:33], v[24:25]
    v_pk_mul_f32 v[26:27], v[34:35], v[26:27]
    v_cvt_pk_bf16_f32 v36, v20, v21
    v_cvt_pk_bf16_f32 v37, v22, v23
    v_cvt_pk_bf16_f32 v38, v24, v25
    v_cvt_pk_bf16_f32 v39, v26, v27
    buffer_store_dwordx4 v[36:39], v251, s[4:7], s53 offen offset:2048 sc1
    v_accvgpr_read_b32 v40, a184
    v_accvgpr_read_b32 v41, a185
    v_accvgpr_read_b32 v42, a186
    v_accvgpr_read_b32 v43, a187
    v_accvgpr_read_b32 v44, a188
    v_accvgpr_read_b32 v45, a189
    v_accvgpr_read_b32 v46, a190
    v_accvgpr_read_b32 v47, a191
    v_pk_mul_f32 v[48:49], v[40:41], v[40:41]
    v_pk_mul_f32 v[50:51], v[42:43], v[42:43]
    v_pk_mul_f32 v[52:53], v[44:45], v[44:45]
    v_pk_mul_f32 v[54:55], v[46:47], v[46:47]
    v_pk_fma_f32 v[48:49], v[48:49], v[242:243], v[240:241]
    v_pk_fma_f32 v[50:51], v[50:51], v[242:243], v[240:241]
    v_pk_fma_f32 v[52:53], v[52:53], v[242:243], v[240:241]
    v_pk_fma_f32 v[54:55], v[54:55], v[242:243], v[240:241]
    v_pk_mul_f32 v[48:49], v[48:49], v[40:41]
    v_pk_mul_f32 v[50:51], v[50:51], v[42:43]
    v_pk_mul_f32 v[52:53], v[52:53], v[44:45]
    v_pk_mul_f32 v[54:55], v[54:55], v[46:47]
    v_exp_f32 v48, v48
    v_exp_f32 v49, v49
    v_exp_f32 v50, v50
    v_exp_f32 v51, v51
    v_exp_f32 v52, v52
    v_exp_f32 v53, v53
    v_exp_f32 v54, v54
    v_exp_f32 v55, v55
    v_pk_add_f32 v[48:49], v[48:49], v[244:245]
    v_pk_add_f32 v[50:51], v[50:51], v[244:245]
    v_pk_add_f32 v[52:53], v[52:53], v[244:245]
    v_pk_add_f32 v[54:55], v[54:55], v[244:245]
    v_rcp_f32 v48, v48
    v_rcp_f32 v49, v49
    v_rcp_f32 v50, v50
    v_rcp_f32 v51, v51
    v_rcp_f32 v52, v52
    v_rcp_f32 v53, v53
    v_rcp_f32 v54, v54
    v_rcp_f32 v55, v55
    v_pk_mul_f32 v[40:41], v[48:49], v[40:41]
    v_pk_mul_f32 v[42:43], v[50:51], v[42:43]
    v_pk_mul_f32 v[44:45], v[52:53], v[44:45]
    v_pk_mul_f32 v[46:47], v[54:55], v[46:47]
    v_cvt_pk_bf16_f32 v56, v40, v41
    v_cvt_pk_bf16_f32 v57, v42, v43
    v_cvt_pk_bf16_f32 v58, v44, v45
    v_cvt_pk_bf16_f32 v59, v46, v47
    buffer_store_dwordx4 v[56:59], v251, s[4:7], s53 offen offset:3072 sc1
    s_add_u32 s53, s53, s22
    v_accvgpr_read_b32 v0, a192
    v_accvgpr_read_b32 v1, a193
    v_accvgpr_read_b32 v2, a194
    v_accvgpr_read_b32 v3, a195
    v_accvgpr_read_b32 v4, a196
    v_accvgpr_read_b32 v5, a197
    v_accvgpr_read_b32 v6, a198
    v_accvgpr_read_b32 v7, a199
    v_pk_mul_f32 v[8:9], v[0:1], v[0:1]
    v_pk_mul_f32 v[10:11], v[2:3], v[2:3]
    v_pk_mul_f32 v[12:13], v[4:5], v[4:5]
    v_pk_mul_f32 v[14:15], v[6:7], v[6:7]
    v_pk_fma_f32 v[8:9], v[8:9], v[242:243], v[240:241]
    v_pk_fma_f32 v[10:11], v[10:11], v[242:243], v[240:241]
    v_pk_fma_f32 v[12:13], v[12:13], v[242:243], v[240:241]
    v_pk_fma_f32 v[14:15], v[14:15], v[242:243], v[240:241]
    v_pk_mul_f32 v[8:9], v[8:9], v[0:1]
    v_pk_mul_f32 v[10:11], v[10:11], v[2:3]
    v_pk_mul_f32 v[12:13], v[12:13], v[4:5]
    v_pk_mul_f32 v[14:15], v[14:15], v[6:7]
    v_exp_f32 v8, v8
    v_exp_f32 v9, v9
    v_exp_f32 v10, v10
    v_exp_f32 v11, v11
    v_exp_f32 v12, v12
    v_exp_f32 v13, v13
    v_exp_f32 v14, v14
    v_exp_f32 v15, v15
    v_pk_add_f32 v[8:9], v[8:9], v[244:245]
    v_pk_add_f32 v[10:11], v[10:11], v[244:245]
    v_pk_add_f32 v[12:13], v[12:13], v[244:245]
    v_pk_add_f32 v[14:15], v[14:15], v[244:245]
    v_rcp_f32 v8, v8
    v_rcp_f32 v9, v9
    v_rcp_f32 v10, v10
    v_rcp_f32 v11, v11
    v_rcp_f32 v12, v12
    v_rcp_f32 v13, v13
    v_rcp_f32 v14, v14
    v_rcp_f32 v15, v15
    v_pk_mul_f32 v[0:1], v[8:9], v[0:1]
    v_pk_mul_f32 v[2:3], v[10:11], v[2:3]
    v_pk_mul_f32 v[4:5], v[12:13], v[4:5]
    v_pk_mul_f32 v[6:7], v[14:15], v[6:7]
    v_cvt_pk_bf16_f32 v16, v0, v1
    v_cvt_pk_bf16_f32 v17, v2, v3
    v_cvt_pk_bf16_f32 v18, v4, v5
    v_cvt_pk_bf16_f32 v19, v6, v7
    buffer_store_dwordx4 v[16:19], v251, s[4:7], s53 offen offset:0 sc1
    v_accvgpr_read_b32 v20, a200
    v_accvgpr_read_b32 v21, a201
    v_accvgpr_read_b32 v22, a202
    v_accvgpr_read_b32 v23, a203
    v_accvgpr_read_b32 v24, a204
    v_accvgpr_read_b32 v25, a205
    v_accvgpr_read_b32 v26, a206
    v_accvgpr_read_b32 v27, a207
    v_pk_mul_f32 v[28:29], v[20:21], v[20:21]
    v_pk_mul_f32 v[30:31], v[22:23], v[22:23]
    v_pk_mul_f32 v[32:33], v[24:25], v[24:25]
    v_pk_mul_f32 v[34:35], v[26:27], v[26:27]
    v_pk_fma_f32 v[28:29], v[28:29], v[242:243], v[240:241]
    v_pk_fma_f32 v[30:31], v[30:31], v[242:243], v[240:241]
    v_pk_fma_f32 v[32:33], v[32:33], v[242:243], v[240:241]
    v_pk_fma_f32 v[34:35], v[34:35], v[242:243], v[240:241]
    v_pk_mul_f32 v[28:29], v[28:29], v[20:21]
    v_pk_mul_f32 v[30:31], v[30:31], v[22:23]
    v_pk_mul_f32 v[32:33], v[32:33], v[24:25]
    v_pk_mul_f32 v[34:35], v[34:35], v[26:27]
    v_exp_f32 v28, v28
    v_exp_f32 v29, v29
    v_exp_f32 v30, v30
    v_exp_f32 v31, v31
    v_exp_f32 v32, v32
    v_exp_f32 v33, v33
    v_exp_f32 v34, v34
    v_exp_f32 v35, v35
    v_pk_add_f32 v[28:29], v[28:29], v[244:245]
    v_pk_add_f32 v[30:31], v[30:31], v[244:245]
    v_pk_add_f32 v[32:33], v[32:33], v[244:245]
    v_pk_add_f32 v[34:35], v[34:35], v[244:245]
    v_rcp_f32 v28, v28
    v_rcp_f32 v29, v29
    v_rcp_f32 v30, v30
    v_rcp_f32 v31, v31
    v_rcp_f32 v32, v32
    v_rcp_f32 v33, v33
    v_rcp_f32 v34, v34
    v_rcp_f32 v35, v35
    v_pk_mul_f32 v[20:21], v[28:29], v[20:21]
    v_pk_mul_f32 v[22:23], v[30:31], v[22:23]
    v_pk_mul_f32 v[24:25], v[32:33], v[24:25]
    v_pk_mul_f32 v[26:27], v[34:35], v[26:27]
    v_cvt_pk_bf16_f32 v36, v20, v21
    v_cvt_pk_bf16_f32 v37, v22, v23
    v_cvt_pk_bf16_f32 v38, v24, v25
    v_cvt_pk_bf16_f32 v39, v26, v27
    buffer_store_dwordx4 v[36:39], v251, s[4:7], s53 offen offset:1024 sc1
    v_accvgpr_read_b32 v40, a208
    v_accvgpr_read_b32 v41, a209
    v_accvgpr_read_b32 v42, a210
    v_accvgpr_read_b32 v43, a211
    v_accvgpr_read_b32 v44, a212
    v_accvgpr_read_b32 v45, a213
    v_accvgpr_read_b32 v46, a214
    v_accvgpr_read_b32 v47, a215
    v_pk_mul_f32 v[48:49], v[40:41], v[40:41]
    v_pk_mul_f32 v[50:51], v[42:43], v[42:43]
    v_pk_mul_f32 v[52:53], v[44:45], v[44:45]
    v_pk_mul_f32 v[54:55], v[46:47], v[46:47]
    v_pk_fma_f32 v[48:49], v[48:49], v[242:243], v[240:241]
    v_pk_fma_f32 v[50:51], v[50:51], v[242:243], v[240:241]
    v_pk_fma_f32 v[52:53], v[52:53], v[242:243], v[240:241]
    v_pk_fma_f32 v[54:55], v[54:55], v[242:243], v[240:241]
    v_pk_mul_f32 v[48:49], v[48:49], v[40:41]
    v_pk_mul_f32 v[50:51], v[50:51], v[42:43]
    v_pk_mul_f32 v[52:53], v[52:53], v[44:45]
    v_pk_mul_f32 v[54:55], v[54:55], v[46:47]
    v_exp_f32 v48, v48
    v_exp_f32 v49, v49
    v_exp_f32 v50, v50
    v_exp_f32 v51, v51
    v_exp_f32 v52, v52
    v_exp_f32 v53, v53
    v_exp_f32 v54, v54
    v_exp_f32 v55, v55
    v_pk_add_f32 v[48:49], v[48:49], v[244:245]
    v_pk_add_f32 v[50:51], v[50:51], v[244:245]
    v_pk_add_f32 v[52:53], v[52:53], v[244:245]
    v_pk_add_f32 v[54:55], v[54:55], v[244:245]
    v_rcp_f32 v48, v48
    v_rcp_f32 v49, v49
    v_rcp_f32 v50, v50
    v_rcp_f32 v51, v51
    v_rcp_f32 v52, v52
    v_rcp_f32 v53, v53
    v_rcp_f32 v54, v54
    v_rcp_f32 v55, v55
    v_pk_mul_f32 v[40:41], v[48:49], v[40:41]
    v_pk_mul_f32 v[42:43], v[50:51], v[42:43]
    v_pk_mul_f32 v[44:45], v[52:53], v[44:45]
    v_pk_mul_f32 v[46:47], v[54:55], v[46:47]
    v_cvt_pk_bf16_f32 v56, v40, v41
    v_cvt_pk_bf16_f32 v57, v42, v43
    v_cvt_pk_bf16_f32 v58, v44, v45
    v_cvt_pk_bf16_f32 v59, v46, v47
    buffer_store_dwordx4 v[56:59], v251, s[4:7], s53 offen offset:2048 sc1
    v_accvgpr_read_b32 v0, a216
    v_accvgpr_read_b32 v1, a217
    v_accvgpr_read_b32 v2, a218
    v_accvgpr_read_b32 v3, a219
    v_accvgpr_read_b32 v4, a220
    v_accvgpr_read_b32 v5, a221
    v_accvgpr_read_b32 v6, a222
    v_accvgpr_read_b32 v7, a223
    v_pk_mul_f32 v[8:9], v[0:1], v[0:1]
    v_pk_mul_f32 v[10:11], v[2:3], v[2:3]
    v_pk_mul_f32 v[12:13], v[4:5], v[4:5]
    v_pk_mul_f32 v[14:15], v[6:7], v[6:7]
    v_pk_fma_f32 v[8:9], v[8:9], v[242:243], v[240:241]
    v_pk_fma_f32 v[10:11], v[10:11], v[242:243], v[240:241]
    v_pk_fma_f32 v[12:13], v[12:13], v[242:243], v[240:241]
    v_pk_fma_f32 v[14:15], v[14:15], v[242:243], v[240:241]
    v_pk_mul_f32 v[8:9], v[8:9], v[0:1]
    v_pk_mul_f32 v[10:11], v[10:11], v[2:3]
    v_pk_mul_f32 v[12:13], v[12:13], v[4:5]
    v_pk_mul_f32 v[14:15], v[14:15], v[6:7]
    v_exp_f32 v8, v8
    v_exp_f32 v9, v9
    v_exp_f32 v10, v10
    v_exp_f32 v11, v11
    v_exp_f32 v12, v12
    v_exp_f32 v13, v13
    v_exp_f32 v14, v14
    v_exp_f32 v15, v15
    v_pk_add_f32 v[8:9], v[8:9], v[244:245]
    v_pk_add_f32 v[10:11], v[10:11], v[244:245]
    v_pk_add_f32 v[12:13], v[12:13], v[244:245]
    v_pk_add_f32 v[14:15], v[14:15], v[244:245]
    v_rcp_f32 v8, v8
    v_rcp_f32 v9, v9
    v_rcp_f32 v10, v10
    v_rcp_f32 v11, v11
    v_rcp_f32 v12, v12
    v_rcp_f32 v13, v13
    v_rcp_f32 v14, v14
    v_rcp_f32 v15, v15
    v_pk_mul_f32 v[0:1], v[8:9], v[0:1]
    v_pk_mul_f32 v[2:3], v[10:11], v[2:3]
    v_pk_mul_f32 v[4:5], v[12:13], v[4:5]
    v_pk_mul_f32 v[6:7], v[14:15], v[6:7]
    v_cvt_pk_bf16_f32 v16, v0, v1
    v_cvt_pk_bf16_f32 v17, v2, v3
    v_cvt_pk_bf16_f32 v18, v4, v5
    v_cvt_pk_bf16_f32 v19, v6, v7
    buffer_store_dwordx4 v[16:19], v251, s[4:7], s53 offen offset:3072 sc1
    s_add_u32 s53, s53, s22
    v_accvgpr_read_b32 v20, a224
    v_accvgpr_read_b32 v21, a225
    v_accvgpr_read_b32 v22, a226
    v_accvgpr_read_b32 v23, a227
    v_accvgpr_read_b32 v24, a228
    v_accvgpr_read_b32 v25, a229
    v_accvgpr_read_b32 v26, a230
    v_accvgpr_read_b32 v27, a231
    v_pk_mul_f32 v[28:29], v[20:21], v[20:21]
    v_pk_mul_f32 v[30:31], v[22:23], v[22:23]
    v_pk_mul_f32 v[32:33], v[24:25], v[24:25]
    v_pk_mul_f32 v[34:35], v[26:27], v[26:27]
    v_pk_fma_f32 v[28:29], v[28:29], v[242:243], v[240:241]
    v_pk_fma_f32 v[30:31], v[30:31], v[242:243], v[240:241]
    v_pk_fma_f32 v[32:33], v[32:33], v[242:243], v[240:241]
    v_pk_fma_f32 v[34:35], v[34:35], v[242:243], v[240:241]
    v_pk_mul_f32 v[28:29], v[28:29], v[20:21]
    v_pk_mul_f32 v[30:31], v[30:31], v[22:23]
    v_pk_mul_f32 v[32:33], v[32:33], v[24:25]
    v_pk_mul_f32 v[34:35], v[34:35], v[26:27]
    v_exp_f32 v28, v28
    v_exp_f32 v29, v29
    v_exp_f32 v30, v30
    v_exp_f32 v31, v31
    v_exp_f32 v32, v32
    v_exp_f32 v33, v33
    v_exp_f32 v34, v34
    v_exp_f32 v35, v35
    v_pk_add_f32 v[28:29], v[28:29], v[244:245]
    v_pk_add_f32 v[30:31], v[30:31], v[244:245]
    v_pk_add_f32 v[32:33], v[32:33], v[244:245]
    v_pk_add_f32 v[34:35], v[34:35], v[244:245]
    v_rcp_f32 v28, v28
    v_rcp_f32 v29, v29
    v_rcp_f32 v30, v30
    v_rcp_f32 v31, v31
    v_rcp_f32 v32, v32
    v_rcp_f32 v33, v33
    v_rcp_f32 v34, v34
    v_rcp_f32 v35, v35
    v_pk_mul_f32 v[20:21], v[28:29], v[20:21]
    v_pk_mul_f32 v[22:23], v[30:31], v[22:23]
    v_pk_mul_f32 v[24:25], v[32:33], v[24:25]
    v_pk_mul_f32 v[26:27], v[34:35], v[26:27]
    v_cvt_pk_bf16_f32 v36, v20, v21
    v_cvt_pk_bf16_f32 v37, v22, v23
    v_cvt_pk_bf16_f32 v38, v24, v25
    v_cvt_pk_bf16_f32 v39, v26, v27
    buffer_store_dwordx4 v[36:39], v251, s[4:7], s53 offen offset:0 sc1
    v_accvgpr_read_b32 v40, a232
    v_accvgpr_read_b32 v41, a233
    v_accvgpr_read_b32 v42, a234
    v_accvgpr_read_b32 v43, a235
    v_accvgpr_read_b32 v44, a236
    v_accvgpr_read_b32 v45, a237
    v_accvgpr_read_b32 v46, a238
    v_accvgpr_read_b32 v47, a239
    v_pk_mul_f32 v[48:49], v[40:41], v[40:41]
    v_pk_mul_f32 v[50:51], v[42:43], v[42:43]
    v_pk_mul_f32 v[52:53], v[44:45], v[44:45]
    v_pk_mul_f32 v[54:55], v[46:47], v[46:47]
    v_pk_fma_f32 v[48:49], v[48:49], v[242:243], v[240:241]
    v_pk_fma_f32 v[50:51], v[50:51], v[242:243], v[240:241]
    v_pk_fma_f32 v[52:53], v[52:53], v[242:243], v[240:241]
    v_pk_fma_f32 v[54:55], v[54:55], v[242:243], v[240:241]
    v_pk_mul_f32 v[48:49], v[48:49], v[40:41]
    v_pk_mul_f32 v[50:51], v[50:51], v[42:43]
    v_pk_mul_f32 v[52:53], v[52:53], v[44:45]
    v_pk_mul_f32 v[54:55], v[54:55], v[46:47]
    v_exp_f32 v48, v48
    v_exp_f32 v49, v49
    v_exp_f32 v50, v50
    v_exp_f32 v51, v51
    v_exp_f32 v52, v52
    v_exp_f32 v53, v53
    v_exp_f32 v54, v54
    v_exp_f32 v55, v55
    v_pk_add_f32 v[48:49], v[48:49], v[244:245]
    v_pk_add_f32 v[50:51], v[50:51], v[244:245]
    v_pk_add_f32 v[52:53], v[52:53], v[244:245]
    v_pk_add_f32 v[54:55], v[54:55], v[244:245]
    v_rcp_f32 v48, v48
    v_rcp_f32 v49, v49
    v_rcp_f32 v50, v50
    v_rcp_f32 v51, v51
    v_rcp_f32 v52, v52
    v_rcp_f32 v53, v53
    v_rcp_f32 v54, v54
    v_rcp_f32 v55, v55
    v_pk_mul_f32 v[40:41], v[48:49], v[40:41]
    v_pk_mul_f32 v[42:43], v[50:51], v[42:43]
    v_pk_mul_f32 v[44:45], v[52:53], v[44:45]
    v_pk_mul_f32 v[46:47], v[54:55], v[46:47]
    v_cvt_pk_bf16_f32 v56, v40, v41
    v_cvt_pk_bf16_f32 v57, v42, v43
    v_cvt_pk_bf16_f32 v58, v44, v45
    v_cvt_pk_bf16_f32 v59, v46, v47
    buffer_store_dwordx4 v[56:59], v251, s[4:7], s53 offen offset:1024 sc1
    v_accvgpr_read_b32 v0, a240
    v_accvgpr_read_b32 v1, a241
    v_accvgpr_read_b32 v2, a242
    v_accvgpr_read_b32 v3, a243
    v_accvgpr_read_b32 v4, a244
    v_accvgpr_read_b32 v5, a245
    v_accvgpr_read_b32 v6, a246
    v_accvgpr_read_b32 v7, a247
    v_pk_mul_f32 v[8:9], v[0:1], v[0:1]
    v_pk_mul_f32 v[10:11], v[2:3], v[2:3]
    v_pk_mul_f32 v[12:13], v[4:5], v[4:5]
    v_pk_mul_f32 v[14:15], v[6:7], v[6:7]
    v_pk_fma_f32 v[8:9], v[8:9], v[242:243], v[240:241]
    v_pk_fma_f32 v[10:11], v[10:11], v[242:243], v[240:241]
    v_pk_fma_f32 v[12:13], v[12:13], v[242:243], v[240:241]
    v_pk_fma_f32 v[14:15], v[14:15], v[242:243], v[240:241]
    v_pk_mul_f32 v[8:9], v[8:9], v[0:1]
    v_pk_mul_f32 v[10:11], v[10:11], v[2:3]
    v_pk_mul_f32 v[12:13], v[12:13], v[4:5]
    v_pk_mul_f32 v[14:15], v[14:15], v[6:7]
    v_exp_f32 v8, v8
    v_exp_f32 v9, v9
    v_exp_f32 v10, v10
    v_exp_f32 v11, v11
    v_exp_f32 v12, v12
    v_exp_f32 v13, v13
    v_exp_f32 v14, v14
    v_exp_f32 v15, v15
    v_pk_add_f32 v[8:9], v[8:9], v[244:245]
    v_pk_add_f32 v[10:11], v[10:11], v[244:245]
    v_pk_add_f32 v[12:13], v[12:13], v[244:245]
    v_pk_add_f32 v[14:15], v[14:15], v[244:245]
    v_rcp_f32 v8, v8
    v_rcp_f32 v9, v9
    v_rcp_f32 v10, v10
    v_rcp_f32 v11, v11
    v_rcp_f32 v12, v12
    v_rcp_f32 v13, v13
    v_rcp_f32 v14, v14
    v_rcp_f32 v15, v15
    v_pk_mul_f32 v[0:1], v[8:9], v[0:1]
    v_pk_mul_f32 v[2:3], v[10:11], v[2:3]
    v_pk_mul_f32 v[4:5], v[12:13], v[4:5]
    v_pk_mul_f32 v[6:7], v[14:15], v[6:7]
    v_cvt_pk_bf16_f32 v16, v0, v1
    v_cvt_pk_bf16_f32 v17, v2, v3
    v_cvt_pk_bf16_f32 v18, v4, v5
    v_cvt_pk_bf16_f32 v19, v6, v7
    buffer_store_dwordx4 v[16:19], v251, s[4:7], s53 offen offset:2048 sc1
    v_accvgpr_read_b32 v20, a248
    v_accvgpr_read_b32 v21, a249
    v_accvgpr_read_b32 v22, a250
    v_accvgpr_read_b32 v23, a251
    v_accvgpr_read_b32 v24, a252
    v_accvgpr_read_b32 v25, a253
    v_accvgpr_read_b32 v26, a254
    v_accvgpr_read_b32 v27, a255
    v_pk_mul_f32 v[28:29], v[20:21], v[20:21]
    v_pk_mul_f32 v[30:31], v[22:23], v[22:23]
    v_pk_mul_f32 v[32:33], v[24:25], v[24:25]
    v_pk_mul_f32 v[34:35], v[26:27], v[26:27]
    v_pk_fma_f32 v[28:29], v[28:29], v[242:243], v[240:241]
    v_pk_fma_f32 v[30:31], v[30:31], v[242:243], v[240:241]
    v_pk_fma_f32 v[32:33], v[32:33], v[242:243], v[240:241]
    v_pk_fma_f32 v[34:35], v[34:35], v[242:243], v[240:241]
    v_pk_mul_f32 v[28:29], v[28:29], v[20:21]
    v_pk_mul_f32 v[30:31], v[30:31], v[22:23]
    v_pk_mul_f32 v[32:33], v[32:33], v[24:25]
    v_pk_mul_f32 v[34:35], v[34:35], v[26:27]
    v_exp_f32 v28, v28
    v_exp_f32 v29, v29
    v_exp_f32 v30, v30
    v_exp_f32 v31, v31
    v_exp_f32 v32, v32
    v_exp_f32 v33, v33
    v_exp_f32 v34, v34
    v_exp_f32 v35, v35
    v_pk_add_f32 v[28:29], v[28:29], v[244:245]
    v_pk_add_f32 v[30:31], v[30:31], v[244:245]
    v_pk_add_f32 v[32:33], v[32:33], v[244:245]
    v_pk_add_f32 v[34:35], v[34:35], v[244:245]
    v_rcp_f32 v28, v28
    v_rcp_f32 v29, v29
    v_rcp_f32 v30, v30
    v_rcp_f32 v31, v31
    v_rcp_f32 v32, v32
    v_rcp_f32 v33, v33
    v_rcp_f32 v34, v34
    v_rcp_f32 v35, v35
    v_pk_mul_f32 v[20:21], v[28:29], v[20:21]
    v_pk_mul_f32 v[22:23], v[30:31], v[22:23]
    v_pk_mul_f32 v[24:25], v[32:33], v[24:25]
    v_pk_mul_f32 v[26:27], v[34:35], v[26:27]
    v_cvt_pk_bf16_f32 v36, v20, v21
    v_cvt_pk_bf16_f32 v37, v22, v23
    v_cvt_pk_bf16_f32 v38, v24, v25
    v_cvt_pk_bf16_f32 v39, v26, v27
    buffer_store_dwordx4 v[36:39], v251, s[4:7], s53 offen offset:3072 sc1
    s_branch main_kernel_w_done
main_kernel_w_c2_gov:
    v_lshrrev_b32 v0, 4, v250
    v_bfe_u32 v1, v250, 2, 2
    v_lshl_add_u32 v4, v0, 2, v1
    v_and_b32 v5, 7, v4
    v_mul_u32_u24 v4, 512, v4
    v_and_b32 v6, 3, v250
    v_lshl_add_u32 v4, v6, 3, v4
    s_mul_i32 s32, s37, 8
    v_xor_b32 v5, s32, v5
    v_lshl_add_u32 v128, v5, 5, v4
    v_xor_b32 v129, 32, v128
    v_xor_b32 v130, 64, v128
    v_xor_b32 v131, 96, v128
    v_xor_b32 v132, 128, v128
    v_xor_b32 v133, 160, v128
    v_xor_b32 v134, 192, v128
    v_xor_b32 v135, 224, v128
    s_mul_i32 s32, s38, 8192
    s_add_u32 s32, s32, 65536
    v_add_u32 v136, s32, v251
    v_lshrrev_b32 v2, 5, v250
    v_and_b32 v3, 31, v250
    s_mul_i32 s32, s14, 8
    v_add_u32 v4, s32, v2
    v_add_u32 v5, 0, v4
    v_and_b32 v6, 7, v5
    v_lshlrev_b32 v6, 1, v6
    v_xor_b32 v6, v6, v3
    v_mul_lo_u32 v5, v5, s30
    v_lshl_add_u32 v5, v6, 4, v5
    v_subrev_u32 v137, 0, v5
    v_add_u32 v5, 2, v4
    v_and_b32 v6, 7, v5
    v_lshlrev_b32 v6, 1, v6
    v_xor_b32 v6, v6, v3
    v_mul_lo_u32 v5, v5, s30
    v_lshl_add_u32 v5, v6, 4, v5
    v_subrev_u32 v138, 1024, v5
    v_add_u32 v5, 4, v4
    v_and_b32 v6, 7, v5
    v_lshlrev_b32 v6, 1, v6
    v_xor_b32 v6, v6, v3
    v_mul_lo_u32 v5, v5, s30
    v_lshl_add_u32 v5, v6, 4, v5
    v_subrev_u32 v139, 2048, v5
    v_add_u32 v5, 6, v4
    v_and_b32 v6, 7, v5
    v_lshlrev_b32 v6, 1, v6
    v_xor_b32 v6, v6, v3
    v_mul_lo_u32 v5, v5, s30
    v_lshl_add_u32 v5, v6, 4, v5
    v_subrev_u32 v140, 3072, v5
    s_mul_i32 s32, s14, 4
    s_mul_i32 s32, s32, s31
    v_add_u32 v141, s32, v251
    s_add_u32 s32, s32, s31
    s_sub_u32 s32, s32, 1024
    v_add_u32 v142, s32, v251
    s_add_u32 s32, s32, s31
    s_sub_u32 s32, s32, 1024
    v_add_u32 v143, s32, v251
    s_add_u32 s32, s32, s31
    s_sub_u32 s32, s32, 1024
    v_add_u32 v144, s32, v251
    s_mul_i32 s19, s14, 4096
    s_mul_i32 s20, s14, 4096
    s_add_u32 s20, s20, 65536
    s_mul_i32 s17, s30, 32
    s_mov_b32 s15, 0
    s_add_u32 m0, s20, 0
    s_nop 0
    buffer_load_dwordx4 v141, s[4:7], s16 offen offset:0 sc1 lds
    buffer_load_dwordx4 v142, s[4:7], s16 offen offset:1024 sc1 lds
    buffer_load_dwordx4 v143, s[4:7], s16 offen offset:2048 sc1 lds
    buffer_load_dwordx4 v144, s[4:7], s16 offen offset:3072 sc1 lds
    s_add_u32 s16, s16, 1024
    s_add_u32 m0, s19, 0
    s_nop 0
    buffer_load_dwordx4 v137, s[8:11], s15 offen offset:0 lds
    buffer_load_dwordx4 v138, s[8:11], s15 offen offset:1024 lds
    buffer_load_dwordx4 v139, s[8:11], s15 offen offset:2048 lds
    buffer_load_dwordx4 v140, s[8:11], s15 offen offset:3072 lds
    s_add_u32 s15, s15, s17
    s_add_u32 m0, s20, 16384
    s_nop 0
    buffer_load_dwordx4 v141, s[4:7], s16 offen offset:0 sc1 lds
    buffer_load_dwordx4 v142, s[4:7], s16 offen offset:1024 sc1 lds
    buffer_load_dwordx4 v143, s[4:7], s16 offen offset:2048 sc1 lds
    buffer_load_dwordx4 v144, s[4:7], s16 offen offset:3072 sc1 lds
    s_add_u32 s16, s16, 1024
    s_add_u32 m0, s19, 16384
    s_nop 0
    buffer_load_dwordx4 v137, s[8:11], s15 offen offset:0 lds
    buffer_load_dwordx4 v138, s[8:11], s15 offen offset:1024 lds
    buffer_load_dwordx4 v139, s[8:11], s15 offen offset:2048 lds
    buffer_load_dwordx4 v140, s[8:11], s15 offen offset:3072 lds
    s_add_u32 s15, s15, s17
    s_add_u32 m0, s20, 32768
    s_nop 0
    buffer_load_dwordx4 v141, s[4:7], s16 offen offset:0 sc1 lds
    buffer_load_dwordx4 v142, s[4:7], s16 offen offset:1024 sc1 lds
    buffer_load_dwordx4 v143, s[4:7], s16 offen offset:2048 sc1 lds
    buffer_load_dwordx4 v144, s[4:7], s16 offen offset:3072 sc1 lds
    s_add_u32 s16, s16, 1024
    s_add_u32 m0, s19, 32768
    s_nop 0
    buffer_load_dwordx4 v137, s[8:11], s15 offen offset:0 lds
    buffer_load_dwordx4 v138, s[8:11], s15 offen offset:1024 lds
    buffer_load_dwordx4 v139, s[8:11], s15 offen offset:2048 lds
    buffer_load_dwordx4 v140, s[8:11], s15 offen offset:3072 lds
    s_add_u32 s15, s15, s17
    s_add_u32 m0, s20, 49152
    s_nop 0
    buffer_load_dwordx4 v141, s[4:7], s16 offen offset:0 sc1 lds
    buffer_load_dwordx4 v142, s[4:7], s16 offen offset:1024 sc1 lds
    buffer_load_dwordx4 v143, s[4:7], s16 offen offset:2048 sc1 lds
    buffer_load_dwordx4 v144, s[4:7], s16 offen offset:3072 sc1 lds
    s_add_u32 s16, s16, 1024
    s_add_u32 m0, s19, 49152
    s_nop 0
    buffer_load_dwordx4 v137, s[8:11], s15 offen offset:0 lds
    buffer_load_dwordx4 v138, s[8:11], s15 offen offset:1024 lds
    buffer_load_dwordx4 v139, s[8:11], s15 offen offset:2048 lds
    buffer_load_dwordx4 v140, s[8:11], s15 offen offset:3072 lds
    s_add_u32 s15, s15, s17
    v_accvgpr_write_b32 a0, 0
    v_accvgpr_write_b32 a1, 0
    v_accvgpr_write_b32 a2, 0
    v_accvgpr_write_b32 a3, 0
    v_accvgpr_write_b32 a4, 0
    v_accvgpr_write_b32 a5, 0
    v_accvgpr_write_b32 a6, 0
    v_accvgpr_write_b32 a7, 0
    v_accvgpr_write_b32 a8, 0
    v_accvgpr_write_b32 a9, 0
    v_accvgpr_write_b32 a10, 0
    v_accvgpr_write_b32 a11, 0
    v_accvgpr_write_b32 a12, 0
    v_accvgpr_write_b32 a13, 0
    v_accvgpr_write_b32 a14, 0
    v_accvgpr_write_b32 a15, 0
    v_accvgpr_write_b32 a16, 0
    v_accvgpr_write_b32 a17, 0
    v_accvgpr_write_b32 a18, 0
    v_accvgpr_write_b32 a19, 0
    v_accvgpr_write_b32 a20, 0
    v_accvgpr_write_b32 a21, 0
    v_accvgpr_write_b32 a22, 0
    v_accvgpr_write_b32 a23, 0
    v_accvgpr_write_b32 a24, 0
    v_accvgpr_write_b32 a25, 0
    v_accvgpr_write_b32 a26, 0
    v_accvgpr_write_b32 a27, 0
    v_accvgpr_write_b32 a28, 0
    v_accvgpr_write_b32 a29, 0
    v_accvgpr_write_b32 a30, 0
    v_accvgpr_write_b32 a31, 0
    v_accvgpr_write_b32 a32, 0
    v_accvgpr_write_b32 a33, 0
    v_accvgpr_write_b32 a34, 0
    v_accvgpr_write_b32 a35, 0
    v_accvgpr_write_b32 a36, 0
    v_accvgpr_write_b32 a37, 0
    v_accvgpr_write_b32 a38, 0
    v_accvgpr_write_b32 a39, 0
    v_accvgpr_write_b32 a40, 0
    v_accvgpr_write_b32 a41, 0
    v_accvgpr_write_b32 a42, 0
    v_accvgpr_write_b32 a43, 0
    v_accvgpr_write_b32 a44, 0
    v_accvgpr_write_b32 a45, 0
    v_accvgpr_write_b32 a46, 0
    v_accvgpr_write_b32 a47, 0
    v_accvgpr_write_b32 a48, 0
    v_accvgpr_write_b32 a49, 0
    v_accvgpr_write_b32 a50, 0
    v_accvgpr_write_b32 a51, 0
    v_accvgpr_write_b32 a52, 0
    v_accvgpr_write_b32 a53, 0
    v_accvgpr_write_b32 a54, 0
    v_accvgpr_write_b32 a55, 0
    v_accvgpr_write_b32 a56, 0
    v_accvgpr_write_b32 a57, 0
    v_accvgpr_write_b32 a58, 0
    v_accvgpr_write_b32 a59, 0
    v_accvgpr_write_b32 a60, 0
    v_accvgpr_write_b32 a61, 0
    v_accvgpr_write_b32 a62, 0
    v_accvgpr_write_b32 a63, 0
    v_accvgpr_write_b32 a64, 0
    v_accvgpr_write_b32 a65, 0
    v_accvgpr_write_b32 a66, 0
    v_accvgpr_write_b32 a67, 0
    v_accvgpr_write_b32 a68, 0
    v_accvgpr_write_b32 a69, 0
    v_accvgpr_write_b32 a70, 0
    v_accvgpr_write_b32 a71, 0
    v_accvgpr_write_b32 a72, 0
    v_accvgpr_write_b32 a73, 0
    v_accvgpr_write_b32 a74, 0
    v_accvgpr_write_b32 a75, 0
    v_accvgpr_write_b32 a76, 0
    v_accvgpr_write_b32 a77, 0
    v_accvgpr_write_b32 a78, 0
    v_accvgpr_write_b32 a79, 0
    v_accvgpr_write_b32 a80, 0
    v_accvgpr_write_b32 a81, 0
    v_accvgpr_write_b32 a82, 0
    v_accvgpr_write_b32 a83, 0
    v_accvgpr_write_b32 a84, 0
    v_accvgpr_write_b32 a85, 0
    v_accvgpr_write_b32 a86, 0
    v_accvgpr_write_b32 a87, 0
    v_accvgpr_write_b32 a88, 0
    v_accvgpr_write_b32 a89, 0
    v_accvgpr_write_b32 a90, 0
    v_accvgpr_write_b32 a91, 0
    v_accvgpr_write_b32 a92, 0
    v_accvgpr_write_b32 a93, 0
    v_accvgpr_write_b32 a94, 0
    v_accvgpr_write_b32 a95, 0
    v_accvgpr_write_b32 a96, 0
    v_accvgpr_write_b32 a97, 0
    v_accvgpr_write_b32 a98, 0
    v_accvgpr_write_b32 a99, 0
    v_accvgpr_write_b32 a100, 0
    v_accvgpr_write_b32 a101, 0
    v_accvgpr_write_b32 a102, 0
    v_accvgpr_write_b32 a103, 0
    v_accvgpr_write_b32 a104, 0
    v_accvgpr_write_b32 a105, 0
    v_accvgpr_write_b32 a106, 0
    v_accvgpr_write_b32 a107, 0
    v_accvgpr_write_b32 a108, 0
    v_accvgpr_write_b32 a109, 0
    v_accvgpr_write_b32 a110, 0
    v_accvgpr_write_b32 a111, 0
    v_accvgpr_write_b32 a112, 0
    v_accvgpr_write_b32 a113, 0
    v_accvgpr_write_b32 a114, 0
    v_accvgpr_write_b32 a115, 0
    v_accvgpr_write_b32 a116, 0
    v_accvgpr_write_b32 a117, 0
    v_accvgpr_write_b32 a118, 0
    v_accvgpr_write_b32 a119, 0
    v_accvgpr_write_b32 a120, 0
    v_accvgpr_write_b32 a121, 0
    v_accvgpr_write_b32 a122, 0
    v_accvgpr_write_b32 a123, 0
    v_accvgpr_write_b32 a124, 0
    v_accvgpr_write_b32 a125, 0
    v_accvgpr_write_b32 a126, 0
    v_accvgpr_write_b32 a127, 0
    v_accvgpr_write_b32 a128, 0
    v_accvgpr_write_b32 a129, 0
    v_accvgpr_write_b32 a130, 0
    v_accvgpr_write_b32 a131, 0
    v_accvgpr_write_b32 a132, 0
    v_accvgpr_write_b32 a133, 0
    v_accvgpr_write_b32 a134, 0
    v_accvgpr_write_b32 a135, 0
    v_accvgpr_write_b32 a136, 0
    v_accvgpr_write_b32 a137, 0
    v_accvgpr_write_b32 a138, 0
    v_accvgpr_write_b32 a139, 0
    v_accvgpr_write_b32 a140, 0
    v_accvgpr_write_b32 a141, 0
    v_accvgpr_write_b32 a142, 0
    v_accvgpr_write_b32 a143, 0
    v_accvgpr_write_b32 a144, 0
    v_accvgpr_write_b32 a145, 0
    v_accvgpr_write_b32 a146, 0
    v_accvgpr_write_b32 a147, 0
    v_accvgpr_write_b32 a148, 0
    v_accvgpr_write_b32 a149, 0
    v_accvgpr_write_b32 a150, 0
    v_accvgpr_write_b32 a151, 0
    v_accvgpr_write_b32 a152, 0
    v_accvgpr_write_b32 a153, 0
    v_accvgpr_write_b32 a154, 0
    v_accvgpr_write_b32 a155, 0
    v_accvgpr_write_b32 a156, 0
    v_accvgpr_write_b32 a157, 0
    v_accvgpr_write_b32 a158, 0
    v_accvgpr_write_b32 a159, 0
    v_accvgpr_write_b32 a160, 0
    v_accvgpr_write_b32 a161, 0
    v_accvgpr_write_b32 a162, 0
    v_accvgpr_write_b32 a163, 0
    v_accvgpr_write_b32 a164, 0
    v_accvgpr_write_b32 a165, 0
    v_accvgpr_write_b32 a166, 0
    v_accvgpr_write_b32 a167, 0
    v_accvgpr_write_b32 a168, 0
    v_accvgpr_write_b32 a169, 0
    v_accvgpr_write_b32 a170, 0
    v_accvgpr_write_b32 a171, 0
    v_accvgpr_write_b32 a172, 0
    v_accvgpr_write_b32 a173, 0
    v_accvgpr_write_b32 a174, 0
    v_accvgpr_write_b32 a175, 0
    v_accvgpr_write_b32 a176, 0
    v_accvgpr_write_b32 a177, 0
    v_accvgpr_write_b32 a178, 0
    v_accvgpr_write_b32 a179, 0
    v_accvgpr_write_b32 a180, 0
    v_accvgpr_write_b32 a181, 0
    v_accvgpr_write_b32 a182, 0
    v_accvgpr_write_b32 a183, 0
    v_accvgpr_write_b32 a184, 0
    v_accvgpr_write_b32 a185, 0
    v_accvgpr_write_b32 a186, 0
    v_accvgpr_write_b32 a187, 0
    v_accvgpr_write_b32 a188, 0
    v_accvgpr_write_b32 a189, 0
    v_accvgpr_write_b32 a190, 0
    v_accvgpr_write_b32 a191, 0
    v_accvgpr_write_b32 a192, 0
    v_accvgpr_write_b32 a193, 0
    v_accvgpr_write_b32 a194, 0
    v_accvgpr_write_b32 a195, 0
    v_accvgpr_write_b32 a196, 0
    v_accvgpr_write_b32 a197, 0
    v_accvgpr_write_b32 a198, 0
    v_accvgpr_write_b32 a199, 0
    v_accvgpr_write_b32 a200, 0
    v_accvgpr_write_b32 a201, 0
    v_accvgpr_write_b32 a202, 0
    v_accvgpr_write_b32 a203, 0
    v_accvgpr_write_b32 a204, 0
    v_accvgpr_write_b32 a205, 0
    v_accvgpr_write_b32 a206, 0
    v_accvgpr_write_b32 a207, 0
    v_accvgpr_write_b32 a208, 0
    v_accvgpr_write_b32 a209, 0
    v_accvgpr_write_b32 a210, 0
    v_accvgpr_write_b32 a211, 0
    v_accvgpr_write_b32 a212, 0
    v_accvgpr_write_b32 a213, 0
    v_accvgpr_write_b32 a214, 0
    v_accvgpr_write_b32 a215, 0
    v_accvgpr_write_b32 a216, 0
    v_accvgpr_write_b32 a217, 0
    v_accvgpr_write_b32 a218, 0
    v_accvgpr_write_b32 a219, 0
    v_accvgpr_write_b32 a220, 0
    v_accvgpr_write_b32 a221, 0
    v_accvgpr_write_b32 a222, 0
    v_accvgpr_write_b32 a223, 0
    v_accvgpr_write_b32 a224, 0
    v_accvgpr_write_b32 a225, 0
    v_accvgpr_write_b32 a226, 0
    v_accvgpr_write_b32 a227, 0
    v_accvgpr_write_b32 a228, 0
    v_accvgpr_write_b32 a229, 0
    v_accvgpr_write_b32 a230, 0
    v_accvgpr_write_b32 a231, 0
    v_accvgpr_write_b32 a232, 0
    v_accvgpr_write_b32 a233, 0
    v_accvgpr_write_b32 a234, 0
    v_accvgpr_write_b32 a235, 0
    v_accvgpr_write_b32 a236, 0
    v_accvgpr_write_b32 a237, 0
    v_accvgpr_write_b32 a238, 0
    v_accvgpr_write_b32 a239, 0
    v_accvgpr_write_b32 a240, 0
    v_accvgpr_write_b32 a241, 0
    v_accvgpr_write_b32 a242, 0
    v_accvgpr_write_b32 a243, 0
    v_accvgpr_write_b32 a244, 0
    v_accvgpr_write_b32 a245, 0
    v_accvgpr_write_b32 a246, 0
    v_accvgpr_write_b32 a247, 0
    v_accvgpr_write_b32 a248, 0
    v_accvgpr_write_b32 a249, 0
    v_accvgpr_write_b32 a250, 0
    v_accvgpr_write_b32 a251, 0
    v_accvgpr_write_b32 a252, 0
    v_accvgpr_write_b32 a253, 0
    v_accvgpr_write_b32 a254, 0
    v_accvgpr_write_b32 a255, 0
    s_waitcnt vmcnt(24)
    s_barrier
    ds_read_b128 v[32:35], v136 offset:0
    ds_read_b64_tr_b16 v[0:1], v128 offset:0
    ds_read_b64_tr_b16 v[2:3], v128 offset:8192
    ds_read_b64_tr_b16 v[4:5], v129 offset:0
    ds_read_b64_tr_b16 v[6:7], v129 offset:8192
    ds_read_b64_tr_b16 v[8:9], v130 offset:0
    ds_read_b64_tr_b16 v[10:11], v130 offset:8192
    ds_read_b64_tr_b16 v[12:13], v131 offset:0
    ds_read_b64_tr_b16 v[14:15], v131 offset:8192
    ds_read_b64_tr_b16 v[16:17], v132 offset:0
    ds_read_b64_tr_b16 v[18:19], v132 offset:8192
    ds_read_b64_tr_b16 v[20:21], v133 offset:0
    ds_read_b64_tr_b16 v[22:23], v133 offset:8192
    ds_read_b64_tr_b16 v[24:25], v134 offset:0
    ds_read_b64_tr_b16 v[26:27], v134 offset:8192
    ds_read_b64_tr_b16 v[28:29], v135 offset:0
    ds_read_b64_tr_b16 v[30:31], v135 offset:8192
    ds_read_b128 v[36:39], v136 offset:1024
    ds_read_b128 v[40:43], v136 offset:2048
    ds_read_b128 v[44:47], v136 offset:3072
    ds_read_b128 v[48:51], v136 offset:4096
    ds_read_b128 v[52:55], v136 offset:5120
    ds_read_b128 v[56:59], v136 offset:6144
    ds_read_b128 v[60:63], v136 offset:7168
main_kernel_w_c2_v_loop:
    s_waitcnt lgkmcnt(0)
    v_mfma_f32_16x16x32_bf16 a[0:3], v[32:35], v[0:3], a[0:3]
    s_waitcnt vmcnt(16)
    s_barrier
    ds_read_b128 v[96:99], v136 offset:16384
    s_add_u32 m0, s20, 0
    s_nop 0
    v_mfma_f32_16x16x32_bf16 a[4:7], v[32:35], v[4:7], a[4:7]
    ds_read_b64_tr_b16 v[64:65], v128 offset:16384
    v_mfma_f32_16x16x32_bf16 a[8:11], v[32:35], v[8:11], a[8:11]
    ds_read_b64_tr_b16 v[66:67], v128 offset:24576
    v_mfma_f32_16x16x32_bf16 a[12:15], v[32:35], v[12:15], a[12:15]
    ds_read_b64_tr_b16 v[68:69], v129 offset:16384
    v_mfma_f32_16x16x32_bf16 a[16:19], v[32:35], v[16:19], a[16:19]
    ds_read_b64_tr_b16 v[70:71], v129 offset:24576
    v_mfma_f32_16x16x32_bf16 a[20:23], v[32:35], v[20:23], a[20:23]
    ds_read_b64_tr_b16 v[72:73], v130 offset:16384
    buffer_load_dwordx4 v141, s[4:7], s16 offen offset:0 sc1 lds
    v_mfma_f32_16x16x32_bf16 a[24:27], v[32:35], v[24:27], a[24:27]
    ds_read_b64_tr_b16 v[74:75], v130 offset:24576
    v_mfma_f32_16x16x32_bf16 a[28:31], v[32:35], v[28:31], a[28:31]
    ds_read_b64_tr_b16 v[76:77], v131 offset:16384
    v_mfma_f32_16x16x32_bf16 a[32:35], v[36:39], v[0:3], a[32:35]
    ds_read_b64_tr_b16 v[78:79], v131 offset:24576
    v_mfma_f32_16x16x32_bf16 a[36:39], v[36:39], v[4:7], a[36:39]
    ds_read_b64_tr_b16 v[80:81], v132 offset:16384
    v_mfma_f32_16x16x32_bf16 a[40:43], v[36:39], v[8:11], a[40:43]
    ds_read_b64_tr_b16 v[82:83], v132 offset:24576
    buffer_load_dwordx4 v142, s[4:7], s16 offen offset:1024 sc1 lds
    v_mfma_f32_16x16x32_bf16 a[44:47], v[36:39], v[12:15], a[44:47]
    ds_read_b64_tr_b16 v[84:85], v133 offset:16384
    v_mfma_f32_16x16x32_bf16 a[48:51], v[36:39], v[16:19], a[48:51]
    ds_read_b64_tr_b16 v[86:87], v133 offset:24576
    v_mfma_f32_16x16x32_bf16 a[52:55], v[36:39], v[20:23], a[52:55]
    ds_read_b64_tr_b16 v[88:89], v134 offset:16384
    v_mfma_f32_16x16x32_bf16 a[56:59], v[36:39], v[24:27], a[56:59]
    ds_read_b64_tr_b16 v[90:91], v134 offset:24576
    v_mfma_f32_16x16x32_bf16 a[60:63], v[36:39], v[28:31], a[60:63]
    ds_read_b64_tr_b16 v[92:93], v135 offset:16384
    buffer_load_dwordx4 v143, s[4:7], s16 offen offset:2048 sc1 lds
    v_mfma_f32_16x16x32_bf16 a[64:67], v[40:43], v[0:3], a[64:67]
    ds_read_b64_tr_b16 v[94:95], v135 offset:24576
    v_mfma_f32_16x16x32_bf16 a[68:71], v[40:43], v[4:7], a[68:71]
    ds_read_b128 v[100:103], v136 offset:17408
    v_mfma_f32_16x16x32_bf16 a[72:75], v[40:43], v[8:11], a[72:75]
    ds_read_b128 v[104:107], v136 offset:18432
    v_mfma_f32_16x16x32_bf16 a[76:79], v[40:43], v[12:15], a[76:79]
    ds_read_b128 v[108:111], v136 offset:19456
    v_mfma_f32_16x16x32_bf16 a[80:83], v[40:43], v[16:19], a[80:83]
    ds_read_b128 v[112:115], v136 offset:20480
    v_mfma_f32_16x16x32_bf16 a[84:87], v[40:43], v[20:23], a[84:87]
    ds_read_b128 v[116:119], v136 offset:21504
    buffer_load_dwordx4 v144, s[4:7], s16 offen offset:3072 sc1 lds
    v_mfma_f32_16x16x32_bf16 a[88:91], v[40:43], v[24:27], a[88:91]
    ds_read_b128 v[120:123], v136 offset:22528
    v_mfma_f32_16x16x32_bf16 a[92:95], v[40:43], v[28:31], a[92:95]
    ds_read_b128 v[124:127], v136 offset:23552
    v_mfma_f32_16x16x32_bf16 a[96:99], v[44:47], v[0:3], a[96:99]
    v_mfma_f32_16x16x32_bf16 a[100:103], v[44:47], v[4:7], a[100:103]
    v_mfma_f32_16x16x32_bf16 a[104:107], v[44:47], v[8:11], a[104:107]
    s_add_u32 s16, s16, 1024
    v_mfma_f32_16x16x32_bf16 a[108:111], v[44:47], v[12:15], a[108:111]
    v_mfma_f32_16x16x32_bf16 a[112:115], v[44:47], v[16:19], a[112:115]
    v_mfma_f32_16x16x32_bf16 a[116:119], v[44:47], v[20:23], a[116:119]
    v_mfma_f32_16x16x32_bf16 a[120:123], v[44:47], v[24:27], a[120:123]
    v_mfma_f32_16x16x32_bf16 a[124:127], v[44:47], v[28:31], a[124:127]
    s_add_u32 m0, s19, 0
    s_nop 0
    v_mfma_f32_16x16x32_bf16 a[128:131], v[48:51], v[0:3], a[128:131]
    v_mfma_f32_16x16x32_bf16 a[132:135], v[48:51], v[4:7], a[132:135]
    v_mfma_f32_16x16x32_bf16 a[136:139], v[48:51], v[8:11], a[136:139]
    v_mfma_f32_16x16x32_bf16 a[140:143], v[48:51], v[12:15], a[140:143]
    v_mfma_f32_16x16x32_bf16 a[144:147], v[48:51], v[16:19], a[144:147]
    buffer_load_dwordx4 v137, s[8:11], s15 offen offset:0 lds
    v_mfma_f32_16x16x32_bf16 a[148:151], v[48:51], v[20:23], a[148:151]
    v_mfma_f32_16x16x32_bf16 a[152:155], v[48:51], v[24:27], a[152:155]
    v_mfma_f32_16x16x32_bf16 a[156:159], v[48:51], v[28:31], a[156:159]
    v_mfma_f32_16x16x32_bf16 a[160:163], v[52:55], v[0:3], a[160:163]
    v_mfma_f32_16x16x32_bf16 a[164:167], v[52:55], v[4:7], a[164:167]
    v_mfma_f32_16x16x32_bf16 a[168:171], v[52:55], v[8:11], a[168:171]
    buffer_load_dwordx4 v138, s[8:11], s15 offen offset:1024 lds
    v_mfma_f32_16x16x32_bf16 a[172:175], v[52:55], v[12:15], a[172:175]
    v_mfma_f32_16x16x32_bf16 a[176:179], v[52:55], v[16:19], a[176:179]
    v_mfma_f32_16x16x32_bf16 a[180:183], v[52:55], v[20:23], a[180:183]
    v_mfma_f32_16x16x32_bf16 a[184:187], v[52:55], v[24:27], a[184:187]
    v_mfma_f32_16x16x32_bf16 a[188:191], v[52:55], v[28:31], a[188:191]
    buffer_load_dwordx4 v139, s[8:11], s15 offen offset:2048 lds
    v_mfma_f32_16x16x32_bf16 a[192:195], v[56:59], v[0:3], a[192:195]
    v_mfma_f32_16x16x32_bf16 a[196:199], v[56:59], v[4:7], a[196:199]
    v_mfma_f32_16x16x32_bf16 a[200:203], v[56:59], v[8:11], a[200:203]
    v_mfma_f32_16x16x32_bf16 a[204:207], v[56:59], v[12:15], a[204:207]
    v_mfma_f32_16x16x32_bf16 a[208:211], v[56:59], v[16:19], a[208:211]
    buffer_load_dwordx4 v140, s[8:11], s15 offen offset:3072 lds
    v_mfma_f32_16x16x32_bf16 a[212:215], v[56:59], v[20:23], a[212:215]
    v_mfma_f32_16x16x32_bf16 a[216:219], v[56:59], v[24:27], a[216:219]
    v_mfma_f32_16x16x32_bf16 a[220:223], v[56:59], v[28:31], a[220:223]
    v_mfma_f32_16x16x32_bf16 a[224:227], v[60:63], v[0:3], a[224:227]
    v_mfma_f32_16x16x32_bf16 a[228:231], v[60:63], v[4:7], a[228:231]
    s_add_u32 s15, s15, s17
    v_mfma_f32_16x16x32_bf16 a[232:235], v[60:63], v[8:11], a[232:235]
    v_mfma_f32_16x16x32_bf16 a[236:239], v[60:63], v[12:15], a[236:239]
    v_mfma_f32_16x16x32_bf16 a[240:243], v[60:63], v[16:19], a[240:243]
    v_mfma_f32_16x16x32_bf16 a[244:247], v[60:63], v[20:23], a[244:247]
    v_mfma_f32_16x16x32_bf16 a[248:251], v[60:63], v[24:27], a[248:251]
    v_mfma_f32_16x16x32_bf16 a[252:255], v[60:63], v[28:31], a[252:255]
    s_waitcnt lgkmcnt(0)
    v_mfma_f32_16x16x32_bf16 a[0:3], v[96:99], v[64:67], a[0:3]
    s_waitcnt vmcnt(16)
    s_barrier
    ds_read_b128 v[32:35], v136 offset:32768
    s_add_u32 m0, s20, 16384
    s_nop 0
    v_mfma_f32_16x16x32_bf16 a[4:7], v[96:99], v[68:71], a[4:7]
    ds_read_b64_tr_b16 v[0:1], v128 offset:32768
    v_mfma_f32_16x16x32_bf16 a[8:11], v[96:99], v[72:75], a[8:11]
    ds_read_b64_tr_b16 v[2:3], v128 offset:40960
    v_mfma_f32_16x16x32_bf16 a[12:15], v[96:99], v[76:79], a[12:15]
    ds_read_b64_tr_b16 v[4:5], v129 offset:32768
    v_mfma_f32_16x16x32_bf16 a[16:19], v[96:99], v[80:83], a[16:19]
    ds_read_b64_tr_b16 v[6:7], v129 offset:40960
    v_mfma_f32_16x16x32_bf16 a[20:23], v[96:99], v[84:87], a[20:23]
    ds_read_b64_tr_b16 v[8:9], v130 offset:32768
    buffer_load_dwordx4 v141, s[4:7], s16 offen offset:0 sc1 lds
    v_mfma_f32_16x16x32_bf16 a[24:27], v[96:99], v[88:91], a[24:27]
    ds_read_b64_tr_b16 v[10:11], v130 offset:40960
    v_mfma_f32_16x16x32_bf16 a[28:31], v[96:99], v[92:95], a[28:31]
    ds_read_b64_tr_b16 v[12:13], v131 offset:32768
    v_mfma_f32_16x16x32_bf16 a[32:35], v[100:103], v[64:67], a[32:35]
    ds_read_b64_tr_b16 v[14:15], v131 offset:40960
    v_mfma_f32_16x16x32_bf16 a[36:39], v[100:103], v[68:71], a[36:39]
    ds_read_b64_tr_b16 v[16:17], v132 offset:32768
    v_mfma_f32_16x16x32_bf16 a[40:43], v[100:103], v[72:75], a[40:43]
    ds_read_b64_tr_b16 v[18:19], v132 offset:40960
    buffer_load_dwordx4 v142, s[4:7], s16 offen offset:1024 sc1 lds
    v_mfma_f32_16x16x32_bf16 a[44:47], v[100:103], v[76:79], a[44:47]
    ds_read_b64_tr_b16 v[20:21], v133 offset:32768
    v_mfma_f32_16x16x32_bf16 a[48:51], v[100:103], v[80:83], a[48:51]
    ds_read_b64_tr_b16 v[22:23], v133 offset:40960
    v_mfma_f32_16x16x32_bf16 a[52:55], v[100:103], v[84:87], a[52:55]
    ds_read_b64_tr_b16 v[24:25], v134 offset:32768
    v_mfma_f32_16x16x32_bf16 a[56:59], v[100:103], v[88:91], a[56:59]
    ds_read_b64_tr_b16 v[26:27], v134 offset:40960
    v_mfma_f32_16x16x32_bf16 a[60:63], v[100:103], v[92:95], a[60:63]
    ds_read_b64_tr_b16 v[28:29], v135 offset:32768
    buffer_load_dwordx4 v143, s[4:7], s16 offen offset:2048 sc1 lds
    v_mfma_f32_16x16x32_bf16 a[64:67], v[104:107], v[64:67], a[64:67]
    ds_read_b64_tr_b16 v[30:31], v135 offset:40960
    v_mfma_f32_16x16x32_bf16 a[68:71], v[104:107], v[68:71], a[68:71]
    ds_read_b128 v[36:39], v136 offset:33792
    v_mfma_f32_16x16x32_bf16 a[72:75], v[104:107], v[72:75], a[72:75]
    ds_read_b128 v[40:43], v136 offset:34816
    v_mfma_f32_16x16x32_bf16 a[76:79], v[104:107], v[76:79], a[76:79]
    ds_read_b128 v[44:47], v136 offset:35840
    v_mfma_f32_16x16x32_bf16 a[80:83], v[104:107], v[80:83], a[80:83]
    ds_read_b128 v[48:51], v136 offset:36864
    v_mfma_f32_16x16x32_bf16 a[84:87], v[104:107], v[84:87], a[84:87]
    ds_read_b128 v[52:55], v136 offset:37888
    buffer_load_dwordx4 v144, s[4:7], s16 offen offset:3072 sc1 lds
    v_mfma_f32_16x16x32_bf16 a[88:91], v[104:107], v[88:91], a[88:91]
    ds_read_b128 v[56:59], v136 offset:38912
    v_mfma_f32_16x16x32_bf16 a[92:95], v[104:107], v[92:95], a[92:95]
    ds_read_b128 v[60:63], v136 offset:39936
    v_mfma_f32_16x16x32_bf16 a[96:99], v[108:111], v[64:67], a[96:99]
    v_mfma_f32_16x16x32_bf16 a[100:103], v[108:111], v[68:71], a[100:103]
    v_mfma_f32_16x16x32_bf16 a[104:107], v[108:111], v[72:75], a[104:107]
    s_add_u32 s16, s16, 1024
    v_mfma_f32_16x16x32_bf16 a[108:111], v[108:111], v[76:79], a[108:111]
    v_mfma_f32_16x16x32_bf16 a[112:115], v[108:111], v[80:83], a[112:115]
    v_mfma_f32_16x16x32_bf16 a[116:119], v[108:111], v[84:87], a[116:119]
    v_mfma_f32_16x16x32_bf16 a[120:123], v[108:111], v[88:91], a[120:123]
    v_mfma_f32_16x16x32_bf16 a[124:127], v[108:111], v[92:95], a[124:127]
    s_add_u32 m0, s19, 16384
    s_nop 0
    v_mfma_f32_16x16x32_bf16 a[128:131], v[112:115], v[64:67], a[128:131]
    v_mfma_f32_16x16x32_bf16 a[132:135], v[112:115], v[68:71], a[132:135]
    v_mfma_f32_16x16x32_bf16 a[136:139], v[112:115], v[72:75], a[136:139]
    v_mfma_f32_16x16x32_bf16 a[140:143], v[112:115], v[76:79], a[140:143]
    v_mfma_f32_16x16x32_bf16 a[144:147], v[112:115], v[80:83], a[144:147]
    buffer_load_dwordx4 v137, s[8:11], s15 offen offset:0 lds
    v_mfma_f32_16x16x32_bf16 a[148:151], v[112:115], v[84:87], a[148:151]
    v_mfma_f32_16x16x32_bf16 a[152:155], v[112:115], v[88:91], a[152:155]
    v_mfma_f32_16x16x32_bf16 a[156:159], v[112:115], v[92:95], a[156:159]
    v_mfma_f32_16x16x32_bf16 a[160:163], v[116:119], v[64:67], a[160:163]
    v_mfma_f32_16x16x32_bf16 a[164:167], v[116:119], v[68:71], a[164:167]
    v_mfma_f32_16x16x32_bf16 a[168:171], v[116:119], v[72:75], a[168:171]
    buffer_load_dwordx4 v138, s[8:11], s15 offen offset:1024 lds
    v_mfma_f32_16x16x32_bf16 a[172:175], v[116:119], v[76:79], a[172:175]
    v_mfma_f32_16x16x32_bf16 a[176:179], v[116:119], v[80:83], a[176:179]
    v_mfma_f32_16x16x32_bf16 a[180:183], v[116:119], v[84:87], a[180:183]
    v_mfma_f32_16x16x32_bf16 a[184:187], v[116:119], v[88:91], a[184:187]
    v_mfma_f32_16x16x32_bf16 a[188:191], v[116:119], v[92:95], a[188:191]
    buffer_load_dwordx4 v139, s[8:11], s15 offen offset:2048 lds
    v_mfma_f32_16x16x32_bf16 a[192:195], v[120:123], v[64:67], a[192:195]
    v_mfma_f32_16x16x32_bf16 a[196:199], v[120:123], v[68:71], a[196:199]
    v_mfma_f32_16x16x32_bf16 a[200:203], v[120:123], v[72:75], a[200:203]
    v_mfma_f32_16x16x32_bf16 a[204:207], v[120:123], v[76:79], a[204:207]
    v_mfma_f32_16x16x32_bf16 a[208:211], v[120:123], v[80:83], a[208:211]
    buffer_load_dwordx4 v140, s[8:11], s15 offen offset:3072 lds
    v_mfma_f32_16x16x32_bf16 a[212:215], v[120:123], v[84:87], a[212:215]
    v_mfma_f32_16x16x32_bf16 a[216:219], v[120:123], v[88:91], a[216:219]
    v_mfma_f32_16x16x32_bf16 a[220:223], v[120:123], v[92:95], a[220:223]
    v_mfma_f32_16x16x32_bf16 a[224:227], v[124:127], v[64:67], a[224:227]
    v_mfma_f32_16x16x32_bf16 a[228:231], v[124:127], v[68:71], a[228:231]
    s_add_u32 s15, s15, s17
    v_mfma_f32_16x16x32_bf16 a[232:235], v[124:127], v[72:75], a[232:235]
    v_mfma_f32_16x16x32_bf16 a[236:239], v[124:127], v[76:79], a[236:239]
    v_mfma_f32_16x16x32_bf16 a[240:243], v[124:127], v[80:83], a[240:243]
    v_mfma_f32_16x16x32_bf16 a[244:247], v[124:127], v[84:87], a[244:247]
    v_mfma_f32_16x16x32_bf16 a[248:251], v[124:127], v[88:91], a[248:251]
    v_mfma_f32_16x16x32_bf16 a[252:255], v[124:127], v[92:95], a[252:255]
    s_waitcnt lgkmcnt(0)
    v_mfma_f32_16x16x32_bf16 a[0:3], v[32:35], v[0:3], a[0:3]
    s_waitcnt vmcnt(16)
    s_barrier
    ds_read_b128 v[96:99], v136 offset:49152
    s_add_u32 m0, s20, 32768
    s_nop 0
    v_mfma_f32_16x16x32_bf16 a[4:7], v[32:35], v[4:7], a[4:7]
    ds_read_b64_tr_b16 v[64:65], v128 offset:49152
    v_mfma_f32_16x16x32_bf16 a[8:11], v[32:35], v[8:11], a[8:11]
    ds_read_b64_tr_b16 v[66:67], v128 offset:57344
    v_mfma_f32_16x16x32_bf16 a[12:15], v[32:35], v[12:15], a[12:15]
    ds_read_b64_tr_b16 v[68:69], v129 offset:49152
    v_mfma_f32_16x16x32_bf16 a[16:19], v[32:35], v[16:19], a[16:19]
    ds_read_b64_tr_b16 v[70:71], v129 offset:57344
    v_mfma_f32_16x16x32_bf16 a[20:23], v[32:35], v[20:23], a[20:23]
    ds_read_b64_tr_b16 v[72:73], v130 offset:49152
    buffer_load_dwordx4 v141, s[4:7], s16 offen offset:0 sc1 lds
    v_mfma_f32_16x16x32_bf16 a[24:27], v[32:35], v[24:27], a[24:27]
    ds_read_b64_tr_b16 v[74:75], v130 offset:57344
    v_mfma_f32_16x16x32_bf16 a[28:31], v[32:35], v[28:31], a[28:31]
    ds_read_b64_tr_b16 v[76:77], v131 offset:49152
    v_mfma_f32_16x16x32_bf16 a[32:35], v[36:39], v[0:3], a[32:35]
    ds_read_b64_tr_b16 v[78:79], v131 offset:57344
    v_mfma_f32_16x16x32_bf16 a[36:39], v[36:39], v[4:7], a[36:39]
    ds_read_b64_tr_b16 v[80:81], v132 offset:49152
    v_mfma_f32_16x16x32_bf16 a[40:43], v[36:39], v[8:11], a[40:43]
    ds_read_b64_tr_b16 v[82:83], v132 offset:57344
    buffer_load_dwordx4 v142, s[4:7], s16 offen offset:1024 sc1 lds
    v_mfma_f32_16x16x32_bf16 a[44:47], v[36:39], v[12:15], a[44:47]
    ds_read_b64_tr_b16 v[84:85], v133 offset:49152
    v_mfma_f32_16x16x32_bf16 a[48:51], v[36:39], v[16:19], a[48:51]
    ds_read_b64_tr_b16 v[86:87], v133 offset:57344
    v_mfma_f32_16x16x32_bf16 a[52:55], v[36:39], v[20:23], a[52:55]
    ds_read_b64_tr_b16 v[88:89], v134 offset:49152
    v_mfma_f32_16x16x32_bf16 a[56:59], v[36:39], v[24:27], a[56:59]
    ds_read_b64_tr_b16 v[90:91], v134 offset:57344
    v_mfma_f32_16x16x32_bf16 a[60:63], v[36:39], v[28:31], a[60:63]
    ds_read_b64_tr_b16 v[92:93], v135 offset:49152
    buffer_load_dwordx4 v143, s[4:7], s16 offen offset:2048 sc1 lds
    v_mfma_f32_16x16x32_bf16 a[64:67], v[40:43], v[0:3], a[64:67]
    ds_read_b64_tr_b16 v[94:95], v135 offset:57344
    v_mfma_f32_16x16x32_bf16 a[68:71], v[40:43], v[4:7], a[68:71]
    ds_read_b128 v[100:103], v136 offset:50176
    v_mfma_f32_16x16x32_bf16 a[72:75], v[40:43], v[8:11], a[72:75]
    ds_read_b128 v[104:107], v136 offset:51200
    v_mfma_f32_16x16x32_bf16 a[76:79], v[40:43], v[12:15], a[76:79]
    ds_read_b128 v[108:111], v136 offset:52224
    v_mfma_f32_16x16x32_bf16 a[80:83], v[40:43], v[16:19], a[80:83]
    ds_read_b128 v[112:115], v136 offset:53248
    v_mfma_f32_16x16x32_bf16 a[84:87], v[40:43], v[20:23], a[84:87]
    ds_read_b128 v[116:119], v136 offset:54272
    buffer_load_dwordx4 v144, s[4:7], s16 offen offset:3072 sc1 lds
    v_mfma_f32_16x16x32_bf16 a[88:91], v[40:43], v[24:27], a[88:91]
    ds_read_b128 v[120:123], v136 offset:55296
    v_mfma_f32_16x16x32_bf16 a[92:95], v[40:43], v[28:31], a[92:95]
    ds_read_b128 v[124:127], v136 offset:56320
    v_mfma_f32_16x16x32_bf16 a[96:99], v[44:47], v[0:3], a[96:99]
    v_mfma_f32_16x16x32_bf16 a[100:103], v[44:47], v[4:7], a[100:103]
    v_mfma_f32_16x16x32_bf16 a[104:107], v[44:47], v[8:11], a[104:107]
    s_add_u32 s16, s16, 1024
    v_mfma_f32_16x16x32_bf16 a[108:111], v[44:47], v[12:15], a[108:111]
    v_mfma_f32_16x16x32_bf16 a[112:115], v[44:47], v[16:19], a[112:115]
    v_mfma_f32_16x16x32_bf16 a[116:119], v[44:47], v[20:23], a[116:119]
    v_mfma_f32_16x16x32_bf16 a[120:123], v[44:47], v[24:27], a[120:123]
    v_mfma_f32_16x16x32_bf16 a[124:127], v[44:47], v[28:31], a[124:127]
    s_add_u32 m0, s19, 32768
    s_nop 0
    v_mfma_f32_16x16x32_bf16 a[128:131], v[48:51], v[0:3], a[128:131]
    v_mfma_f32_16x16x32_bf16 a[132:135], v[48:51], v[4:7], a[132:135]
    v_mfma_f32_16x16x32_bf16 a[136:139], v[48:51], v[8:11], a[136:139]
    v_mfma_f32_16x16x32_bf16 a[140:143], v[48:51], v[12:15], a[140:143]
    v_mfma_f32_16x16x32_bf16 a[144:147], v[48:51], v[16:19], a[144:147]
    buffer_load_dwordx4 v137, s[8:11], s15 offen offset:0 lds
    v_mfma_f32_16x16x32_bf16 a[148:151], v[48:51], v[20:23], a[148:151]
    v_mfma_f32_16x16x32_bf16 a[152:155], v[48:51], v[24:27], a[152:155]
    v_mfma_f32_16x16x32_bf16 a[156:159], v[48:51], v[28:31], a[156:159]
    v_mfma_f32_16x16x32_bf16 a[160:163], v[52:55], v[0:3], a[160:163]
    v_mfma_f32_16x16x32_bf16 a[164:167], v[52:55], v[4:7], a[164:167]
    v_mfma_f32_16x16x32_bf16 a[168:171], v[52:55], v[8:11], a[168:171]
    buffer_load_dwordx4 v138, s[8:11], s15 offen offset:1024 lds
    v_mfma_f32_16x16x32_bf16 a[172:175], v[52:55], v[12:15], a[172:175]
    v_mfma_f32_16x16x32_bf16 a[176:179], v[52:55], v[16:19], a[176:179]
    v_mfma_f32_16x16x32_bf16 a[180:183], v[52:55], v[20:23], a[180:183]
    v_mfma_f32_16x16x32_bf16 a[184:187], v[52:55], v[24:27], a[184:187]
    v_mfma_f32_16x16x32_bf16 a[188:191], v[52:55], v[28:31], a[188:191]
    buffer_load_dwordx4 v139, s[8:11], s15 offen offset:2048 lds
    v_mfma_f32_16x16x32_bf16 a[192:195], v[56:59], v[0:3], a[192:195]
    v_mfma_f32_16x16x32_bf16 a[196:199], v[56:59], v[4:7], a[196:199]
    v_mfma_f32_16x16x32_bf16 a[200:203], v[56:59], v[8:11], a[200:203]
    v_mfma_f32_16x16x32_bf16 a[204:207], v[56:59], v[12:15], a[204:207]
    v_mfma_f32_16x16x32_bf16 a[208:211], v[56:59], v[16:19], a[208:211]
    buffer_load_dwordx4 v140, s[8:11], s15 offen offset:3072 lds
    v_mfma_f32_16x16x32_bf16 a[212:215], v[56:59], v[20:23], a[212:215]
    v_mfma_f32_16x16x32_bf16 a[216:219], v[56:59], v[24:27], a[216:219]
    v_mfma_f32_16x16x32_bf16 a[220:223], v[56:59], v[28:31], a[220:223]
    v_mfma_f32_16x16x32_bf16 a[224:227], v[60:63], v[0:3], a[224:227]
    v_mfma_f32_16x16x32_bf16 a[228:231], v[60:63], v[4:7], a[228:231]
    s_add_u32 s15, s15, s17
    v_mfma_f32_16x16x32_bf16 a[232:235], v[60:63], v[8:11], a[232:235]
    v_mfma_f32_16x16x32_bf16 a[236:239], v[60:63], v[12:15], a[236:239]
    v_mfma_f32_16x16x32_bf16 a[240:243], v[60:63], v[16:19], a[240:243]
    v_mfma_f32_16x16x32_bf16 a[244:247], v[60:63], v[20:23], a[244:247]
    v_mfma_f32_16x16x32_bf16 a[248:251], v[60:63], v[24:27], a[248:251]
    v_mfma_f32_16x16x32_bf16 a[252:255], v[60:63], v[28:31], a[252:255]
    s_waitcnt lgkmcnt(0)
    v_mfma_f32_16x16x32_bf16 a[0:3], v[96:99], v[64:67], a[0:3]
    s_waitcnt vmcnt(16)
    s_barrier
    ds_read_b128 v[32:35], v136 offset:0
    s_add_u32 m0, s20, 49152
    s_nop 0
    v_mfma_f32_16x16x32_bf16 a[4:7], v[96:99], v[68:71], a[4:7]
    ds_read_b64_tr_b16 v[0:1], v128 offset:0
    v_mfma_f32_16x16x32_bf16 a[8:11], v[96:99], v[72:75], a[8:11]
    ds_read_b64_tr_b16 v[2:3], v128 offset:8192
    v_mfma_f32_16x16x32_bf16 a[12:15], v[96:99], v[76:79], a[12:15]
    ds_read_b64_tr_b16 v[4:5], v129 offset:0
    v_mfma_f32_16x16x32_bf16 a[16:19], v[96:99], v[80:83], a[16:19]
    ds_read_b64_tr_b16 v[6:7], v129 offset:8192
    v_mfma_f32_16x16x32_bf16 a[20:23], v[96:99], v[84:87], a[20:23]
    ds_read_b64_tr_b16 v[8:9], v130 offset:0
    buffer_load_dwordx4 v141, s[4:7], s16 offen offset:0 sc1 lds
    v_mfma_f32_16x16x32_bf16 a[24:27], v[96:99], v[88:91], a[24:27]
    ds_read_b64_tr_b16 v[10:11], v130 offset:8192
    v_mfma_f32_16x16x32_bf16 a[28:31], v[96:99], v[92:95], a[28:31]
    ds_read_b64_tr_b16 v[12:13], v131 offset:0
    v_mfma_f32_16x16x32_bf16 a[32:35], v[100:103], v[64:67], a[32:35]
    ds_read_b64_tr_b16 v[14:15], v131 offset:8192
    v_mfma_f32_16x16x32_bf16 a[36:39], v[100:103], v[68:71], a[36:39]
    ds_read_b64_tr_b16 v[16:17], v132 offset:0
    v_mfma_f32_16x16x32_bf16 a[40:43], v[100:103], v[72:75], a[40:43]
    ds_read_b64_tr_b16 v[18:19], v132 offset:8192
    buffer_load_dwordx4 v142, s[4:7], s16 offen offset:1024 sc1 lds
    v_mfma_f32_16x16x32_bf16 a[44:47], v[100:103], v[76:79], a[44:47]
    ds_read_b64_tr_b16 v[20:21], v133 offset:0
    v_mfma_f32_16x16x32_bf16 a[48:51], v[100:103], v[80:83], a[48:51]
    ds_read_b64_tr_b16 v[22:23], v133 offset:8192
    v_mfma_f32_16x16x32_bf16 a[52:55], v[100:103], v[84:87], a[52:55]
    ds_read_b64_tr_b16 v[24:25], v134 offset:0
    v_mfma_f32_16x16x32_bf16 a[56:59], v[100:103], v[88:91], a[56:59]
    ds_read_b64_tr_b16 v[26:27], v134 offset:8192
    v_mfma_f32_16x16x32_bf16 a[60:63], v[100:103], v[92:95], a[60:63]
    ds_read_b64_tr_b16 v[28:29], v135 offset:0
    buffer_load_dwordx4 v143, s[4:7], s16 offen offset:2048 sc1 lds
    v_mfma_f32_16x16x32_bf16 a[64:67], v[104:107], v[64:67], a[64:67]
    ds_read_b64_tr_b16 v[30:31], v135 offset:8192
    v_mfma_f32_16x16x32_bf16 a[68:71], v[104:107], v[68:71], a[68:71]
    ds_read_b128 v[36:39], v136 offset:1024
    v_mfma_f32_16x16x32_bf16 a[72:75], v[104:107], v[72:75], a[72:75]
    ds_read_b128 v[40:43], v136 offset:2048
    v_mfma_f32_16x16x32_bf16 a[76:79], v[104:107], v[76:79], a[76:79]
    ds_read_b128 v[44:47], v136 offset:3072
    v_mfma_f32_16x16x32_bf16 a[80:83], v[104:107], v[80:83], a[80:83]
    ds_read_b128 v[48:51], v136 offset:4096
    v_mfma_f32_16x16x32_bf16 a[84:87], v[104:107], v[84:87], a[84:87]
    ds_read_b128 v[52:55], v136 offset:5120
    buffer_load_dwordx4 v144, s[4:7], s16 offen offset:3072 sc1 lds
    v_mfma_f32_16x16x32_bf16 a[88:91], v[104:107], v[88:91], a[88:91]
    ds_read_b128 v[56:59], v136 offset:6144
    v_mfma_f32_16x16x32_bf16 a[92:95], v[104:107], v[92:95], a[92:95]
    ds_read_b128 v[60:63], v136 offset:7168
    v_mfma_f32_16x16x32_bf16 a[96:99], v[108:111], v[64:67], a[96:99]
    v_mfma_f32_16x16x32_bf16 a[100:103], v[108:111], v[68:71], a[100:103]
    v_mfma_f32_16x16x32_bf16 a[104:107], v[108:111], v[72:75], a[104:107]
    s_add_u32 s16, s16, 1024
    v_mfma_f32_16x16x32_bf16 a[108:111], v[108:111], v[76:79], a[108:111]
    v_mfma_f32_16x16x32_bf16 a[112:115], v[108:111], v[80:83], a[112:115]
    v_mfma_f32_16x16x32_bf16 a[116:119], v[108:111], v[84:87], a[116:119]
    v_mfma_f32_16x16x32_bf16 a[120:123], v[108:111], v[88:91], a[120:123]
    v_mfma_f32_16x16x32_bf16 a[124:127], v[108:111], v[92:95], a[124:127]
    s_add_u32 m0, s19, 49152
    s_nop 0
    v_mfma_f32_16x16x32_bf16 a[128:131], v[112:115], v[64:67], a[128:131]
    v_mfma_f32_16x16x32_bf16 a[132:135], v[112:115], v[68:71], a[132:135]
    v_mfma_f32_16x16x32_bf16 a[136:139], v[112:115], v[72:75], a[136:139]
    v_mfma_f32_16x16x32_bf16 a[140:143], v[112:115], v[76:79], a[140:143]
    v_mfma_f32_16x16x32_bf16 a[144:147], v[112:115], v[80:83], a[144:147]
    buffer_load_dwordx4 v137, s[8:11], s15 offen offset:0 lds
    v_mfma_f32_16x16x32_bf16 a[148:151], v[112:115], v[84:87], a[148:151]
    v_mfma_f32_16x16x32_bf16 a[152:155], v[112:115], v[88:91], a[152:155]
    v_mfma_f32_16x16x32_bf16 a[156:159], v[112:115], v[92:95], a[156:159]
    v_mfma_f32_16x16x32_bf16 a[160:163], v[116:119], v[64:67], a[160:163]
    v_mfma_f32_16x16x32_bf16 a[164:167], v[116:119], v[68:71], a[164:167]
    v_mfma_f32_16x16x32_bf16 a[168:171], v[116:119], v[72:75], a[168:171]
    buffer_load_dwordx4 v138, s[8:11], s15 offen offset:1024 lds
    v_mfma_f32_16x16x32_bf16 a[172:175], v[116:119], v[76:79], a[172:175]
    v_mfma_f32_16x16x32_bf16 a[176:179], v[116:119], v[80:83], a[176:179]
    v_mfma_f32_16x16x32_bf16 a[180:183], v[116:119], v[84:87], a[180:183]
    v_mfma_f32_16x16x32_bf16 a[184:187], v[116:119], v[88:91], a[184:187]
    v_mfma_f32_16x16x32_bf16 a[188:191], v[116:119], v[92:95], a[188:191]
    buffer_load_dwordx4 v139, s[8:11], s15 offen offset:2048 lds
    v_mfma_f32_16x16x32_bf16 a[192:195], v[120:123], v[64:67], a[192:195]
    v_mfma_f32_16x16x32_bf16 a[196:199], v[120:123], v[68:71], a[196:199]
    v_mfma_f32_16x16x32_bf16 a[200:203], v[120:123], v[72:75], a[200:203]
    v_mfma_f32_16x16x32_bf16 a[204:207], v[120:123], v[76:79], a[204:207]
    v_mfma_f32_16x16x32_bf16 a[208:211], v[120:123], v[80:83], a[208:211]
    buffer_load_dwordx4 v140, s[8:11], s15 offen offset:3072 lds
    v_mfma_f32_16x16x32_bf16 a[212:215], v[120:123], v[84:87], a[212:215]
    v_mfma_f32_16x16x32_bf16 a[216:219], v[120:123], v[88:91], a[216:219]
    v_mfma_f32_16x16x32_bf16 a[220:223], v[120:123], v[92:95], a[220:223]
    v_mfma_f32_16x16x32_bf16 a[224:227], v[124:127], v[64:67], a[224:227]
    v_mfma_f32_16x16x32_bf16 a[228:231], v[124:127], v[68:71], a[228:231]
    s_add_u32 s15, s15, s17
    v_mfma_f32_16x16x32_bf16 a[232:235], v[124:127], v[72:75], a[232:235]
    v_mfma_f32_16x16x32_bf16 a[236:239], v[124:127], v[76:79], a[236:239]
    v_mfma_f32_16x16x32_bf16 a[240:243], v[124:127], v[80:83], a[240:243]
    v_mfma_f32_16x16x32_bf16 a[244:247], v[124:127], v[84:87], a[244:247]
    v_mfma_f32_16x16x32_bf16 a[248:251], v[124:127], v[88:91], a[248:251]
    v_mfma_f32_16x16x32_bf16 a[252:255], v[124:127], v[92:95], a[252:255]
    s_sub_u32 s18, s18, 1
    s_cmp_lg_u32 s18, 0
    s_cbranch_scc1 main_kernel_w_c2_v_loop
    s_cmp_lg_u32 s14, 0
    s_cbranch_scc1 main_kernel_w_c2_v_nt
    s_lshl_b32 s32, s27, 8
    s_add_u32 s32, s32, 0x841e000
    v_mov_b32 v255, 1
    s_mov_b64 exec, 1
    buffer_atomic_add v255, off, s[4:7], s32 sc0 sc1
    s_mov_b64 exec, -1
main_kernel_w_c2_v_nt:
    s_waitcnt lgkmcnt(0)
    v_mfma_f32_16x16x32_bf16 a[0:3], v[32:35], v[0:3], a[0:3]
    s_waitcnt vmcnt(16)
    s_barrier
    ds_read_b128 v[96:99], v136 offset:16384
    v_mfma_f32_16x16x32_bf16 a[4:7], v[32:35], v[4:7], a[4:7]
    ds_read_b64_tr_b16 v[64:65], v128 offset:16384
    v_mfma_f32_16x16x32_bf16 a[8:11], v[32:35], v[8:11], a[8:11]
    ds_read_b64_tr_b16 v[66:67], v128 offset:24576
    v_mfma_f32_16x16x32_bf16 a[12:15], v[32:35], v[12:15], a[12:15]
    ds_read_b64_tr_b16 v[68:69], v129 offset:16384
    v_mfma_f32_16x16x32_bf16 a[16:19], v[32:35], v[16:19], a[16:19]
    ds_read_b64_tr_b16 v[70:71], v129 offset:24576
    v_mfma_f32_16x16x32_bf16 a[20:23], v[32:35], v[20:23], a[20:23]
    ds_read_b64_tr_b16 v[72:73], v130 offset:16384
    v_mfma_f32_16x16x32_bf16 a[24:27], v[32:35], v[24:27], a[24:27]
    ds_read_b64_tr_b16 v[74:75], v130 offset:24576
    v_mfma_f32_16x16x32_bf16 a[28:31], v[32:35], v[28:31], a[28:31]
    ds_read_b64_tr_b16 v[76:77], v131 offset:16384
    v_mfma_f32_16x16x32_bf16 a[32:35], v[36:39], v[0:3], a[32:35]
    ds_read_b64_tr_b16 v[78:79], v131 offset:24576
    v_mfma_f32_16x16x32_bf16 a[36:39], v[36:39], v[4:7], a[36:39]
    ds_read_b64_tr_b16 v[80:81], v132 offset:16384
    v_mfma_f32_16x16x32_bf16 a[40:43], v[36:39], v[8:11], a[40:43]
    ds_read_b64_tr_b16 v[82:83], v132 offset:24576
    v_mfma_f32_16x16x32_bf16 a[44:47], v[36:39], v[12:15], a[44:47]
    ds_read_b64_tr_b16 v[84:85], v133 offset:16384
    v_mfma_f32_16x16x32_bf16 a[48:51], v[36:39], v[16:19], a[48:51]
    ds_read_b64_tr_b16 v[86:87], v133 offset:24576
    v_mfma_f32_16x16x32_bf16 a[52:55], v[36:39], v[20:23], a[52:55]
    ds_read_b64_tr_b16 v[88:89], v134 offset:16384
    v_mfma_f32_16x16x32_bf16 a[56:59], v[36:39], v[24:27], a[56:59]
    ds_read_b64_tr_b16 v[90:91], v134 offset:24576
    v_mfma_f32_16x16x32_bf16 a[60:63], v[36:39], v[28:31], a[60:63]
    ds_read_b64_tr_b16 v[92:93], v135 offset:16384
    v_mfma_f32_16x16x32_bf16 a[64:67], v[40:43], v[0:3], a[64:67]
    ds_read_b64_tr_b16 v[94:95], v135 offset:24576
    v_mfma_f32_16x16x32_bf16 a[68:71], v[40:43], v[4:7], a[68:71]
    ds_read_b128 v[100:103], v136 offset:17408
    v_mfma_f32_16x16x32_bf16 a[72:75], v[40:43], v[8:11], a[72:75]
    ds_read_b128 v[104:107], v136 offset:18432
    v_mfma_f32_16x16x32_bf16 a[76:79], v[40:43], v[12:15], a[76:79]
    ds_read_b128 v[108:111], v136 offset:19456
    v_mfma_f32_16x16x32_bf16 a[80:83], v[40:43], v[16:19], a[80:83]
    ds_read_b128 v[112:115], v136 offset:20480
    v_mfma_f32_16x16x32_bf16 a[84:87], v[40:43], v[20:23], a[84:87]
    ds_read_b128 v[116:119], v136 offset:21504
    v_mfma_f32_16x16x32_bf16 a[88:91], v[40:43], v[24:27], a[88:91]
    ds_read_b128 v[120:123], v136 offset:22528
    v_mfma_f32_16x16x32_bf16 a[92:95], v[40:43], v[28:31], a[92:95]
    ds_read_b128 v[124:127], v136 offset:23552
    v_mfma_f32_16x16x32_bf16 a[96:99], v[44:47], v[0:3], a[96:99]
    v_mfma_f32_16x16x32_bf16 a[100:103], v[44:47], v[4:7], a[100:103]
    v_mfma_f32_16x16x32_bf16 a[104:107], v[44:47], v[8:11], a[104:107]
    v_mfma_f32_16x16x32_bf16 a[108:111], v[44:47], v[12:15], a[108:111]
    v_mfma_f32_16x16x32_bf16 a[112:115], v[44:47], v[16:19], a[112:115]
    v_mfma_f32_16x16x32_bf16 a[116:119], v[44:47], v[20:23], a[116:119]
    v_mfma_f32_16x16x32_bf16 a[120:123], v[44:47], v[24:27], a[120:123]
    v_mfma_f32_16x16x32_bf16 a[124:127], v[44:47], v[28:31], a[124:127]
    v_mfma_f32_16x16x32_bf16 a[128:131], v[48:51], v[0:3], a[128:131]
    v_mfma_f32_16x16x32_bf16 a[132:135], v[48:51], v[4:7], a[132:135]
    v_mfma_f32_16x16x32_bf16 a[136:139], v[48:51], v[8:11], a[136:139]
    v_mfma_f32_16x16x32_bf16 a[140:143], v[48:51], v[12:15], a[140:143]
    v_mfma_f32_16x16x32_bf16 a[144:147], v[48:51], v[16:19], a[144:147]
    v_mfma_f32_16x16x32_bf16 a[148:151], v[48:51], v[20:23], a[148:151]
    v_mfma_f32_16x16x32_bf16 a[152:155], v[48:51], v[24:27], a[152:155]
    v_mfma_f32_16x16x32_bf16 a[156:159], v[48:51], v[28:31], a[156:159]
    v_mfma_f32_16x16x32_bf16 a[160:163], v[52:55], v[0:3], a[160:163]
    v_mfma_f32_16x16x32_bf16 a[164:167], v[52:55], v[4:7], a[164:167]
    v_mfma_f32_16x16x32_bf16 a[168:171], v[52:55], v[8:11], a[168:171]
    v_mfma_f32_16x16x32_bf16 a[172:175], v[52:55], v[12:15], a[172:175]
    v_mfma_f32_16x16x32_bf16 a[176:179], v[52:55], v[16:19], a[176:179]
    v_mfma_f32_16x16x32_bf16 a[180:183], v[52:55], v[20:23], a[180:183]
    v_mfma_f32_16x16x32_bf16 a[184:187], v[52:55], v[24:27], a[184:187]
    v_mfma_f32_16x16x32_bf16 a[188:191], v[52:55], v[28:31], a[188:191]
    v_mfma_f32_16x16x32_bf16 a[192:195], v[56:59], v[0:3], a[192:195]
    v_mfma_f32_16x16x32_bf16 a[196:199], v[56:59], v[4:7], a[196:199]
    v_mfma_f32_16x16x32_bf16 a[200:203], v[56:59], v[8:11], a[200:203]
    v_mfma_f32_16x16x32_bf16 a[204:207], v[56:59], v[12:15], a[204:207]
    v_mfma_f32_16x16x32_bf16 a[208:211], v[56:59], v[16:19], a[208:211]
    v_mfma_f32_16x16x32_bf16 a[212:215], v[56:59], v[20:23], a[212:215]
    v_mfma_f32_16x16x32_bf16 a[216:219], v[56:59], v[24:27], a[216:219]
    v_mfma_f32_16x16x32_bf16 a[220:223], v[56:59], v[28:31], a[220:223]
    v_mfma_f32_16x16x32_bf16 a[224:227], v[60:63], v[0:3], a[224:227]
    v_mfma_f32_16x16x32_bf16 a[228:231], v[60:63], v[4:7], a[228:231]
    v_mfma_f32_16x16x32_bf16 a[232:235], v[60:63], v[8:11], a[232:235]
    v_mfma_f32_16x16x32_bf16 a[236:239], v[60:63], v[12:15], a[236:239]
    v_mfma_f32_16x16x32_bf16 a[240:243], v[60:63], v[16:19], a[240:243]
    v_mfma_f32_16x16x32_bf16 a[244:247], v[60:63], v[20:23], a[244:247]
    v_mfma_f32_16x16x32_bf16 a[248:251], v[60:63], v[24:27], a[248:251]
    v_mfma_f32_16x16x32_bf16 a[252:255], v[60:63], v[28:31], a[252:255]
    s_waitcnt lgkmcnt(0)
    v_mfma_f32_16x16x32_bf16 a[0:3], v[96:99], v[64:67], a[0:3]
    s_waitcnt vmcnt(8)
    s_barrier
    ds_read_b128 v[32:35], v136 offset:32768
    v_mfma_f32_16x16x32_bf16 a[4:7], v[96:99], v[68:71], a[4:7]
    ds_read_b64_tr_b16 v[0:1], v128 offset:32768
    v_mfma_f32_16x16x32_bf16 a[8:11], v[96:99], v[72:75], a[8:11]
    ds_read_b64_tr_b16 v[2:3], v128 offset:40960
    v_mfma_f32_16x16x32_bf16 a[12:15], v[96:99], v[76:79], a[12:15]
    ds_read_b64_tr_b16 v[4:5], v129 offset:32768
    v_mfma_f32_16x16x32_bf16 a[16:19], v[96:99], v[80:83], a[16:19]
    ds_read_b64_tr_b16 v[6:7], v129 offset:40960
    v_mfma_f32_16x16x32_bf16 a[20:23], v[96:99], v[84:87], a[20:23]
    ds_read_b64_tr_b16 v[8:9], v130 offset:32768
    v_mfma_f32_16x16x32_bf16 a[24:27], v[96:99], v[88:91], a[24:27]
    ds_read_b64_tr_b16 v[10:11], v130 offset:40960
    v_mfma_f32_16x16x32_bf16 a[28:31], v[96:99], v[92:95], a[28:31]
    ds_read_b64_tr_b16 v[12:13], v131 offset:32768
    v_mfma_f32_16x16x32_bf16 a[32:35], v[100:103], v[64:67], a[32:35]
    ds_read_b64_tr_b16 v[14:15], v131 offset:40960
    v_mfma_f32_16x16x32_bf16 a[36:39], v[100:103], v[68:71], a[36:39]
    ds_read_b64_tr_b16 v[16:17], v132 offset:32768
    v_mfma_f32_16x16x32_bf16 a[40:43], v[100:103], v[72:75], a[40:43]
    ds_read_b64_tr_b16 v[18:19], v132 offset:40960
    v_mfma_f32_16x16x32_bf16 a[44:47], v[100:103], v[76:79], a[44:47]
    ds_read_b64_tr_b16 v[20:21], v133 offset:32768
    v_mfma_f32_16x16x32_bf16 a[48:51], v[100:103], v[80:83], a[48:51]
    ds_read_b64_tr_b16 v[22:23], v133 offset:40960
    v_mfma_f32_16x16x32_bf16 a[52:55], v[100:103], v[84:87], a[52:55]
    ds_read_b64_tr_b16 v[24:25], v134 offset:32768
    v_mfma_f32_16x16x32_bf16 a[56:59], v[100:103], v[88:91], a[56:59]
    ds_read_b64_tr_b16 v[26:27], v134 offset:40960
    v_mfma_f32_16x16x32_bf16 a[60:63], v[100:103], v[92:95], a[60:63]
    ds_read_b64_tr_b16 v[28:29], v135 offset:32768
    v_mfma_f32_16x16x32_bf16 a[64:67], v[104:107], v[64:67], a[64:67]
    ds_read_b64_tr_b16 v[30:31], v135 offset:40960
    v_mfma_f32_16x16x32_bf16 a[68:71], v[104:107], v[68:71], a[68:71]
    ds_read_b128 v[36:39], v136 offset:33792
    v_mfma_f32_16x16x32_bf16 a[72:75], v[104:107], v[72:75], a[72:75]
    ds_read_b128 v[40:43], v136 offset:34816
    v_mfma_f32_16x16x32_bf16 a[76:79], v[104:107], v[76:79], a[76:79]
    ds_read_b128 v[44:47], v136 offset:35840
    v_mfma_f32_16x16x32_bf16 a[80:83], v[104:107], v[80:83], a[80:83]
    ds_read_b128 v[48:51], v136 offset:36864
    v_mfma_f32_16x16x32_bf16 a[84:87], v[104:107], v[84:87], a[84:87]
    ds_read_b128 v[52:55], v136 offset:37888
    v_mfma_f32_16x16x32_bf16 a[88:91], v[104:107], v[88:91], a[88:91]
    ds_read_b128 v[56:59], v136 offset:38912
    v_mfma_f32_16x16x32_bf16 a[92:95], v[104:107], v[92:95], a[92:95]
    ds_read_b128 v[60:63], v136 offset:39936
    v_mfma_f32_16x16x32_bf16 a[96:99], v[108:111], v[64:67], a[96:99]
    v_mfma_f32_16x16x32_bf16 a[100:103], v[108:111], v[68:71], a[100:103]
    v_mfma_f32_16x16x32_bf16 a[104:107], v[108:111], v[72:75], a[104:107]
    v_mfma_f32_16x16x32_bf16 a[108:111], v[108:111], v[76:79], a[108:111]
    v_mfma_f32_16x16x32_bf16 a[112:115], v[108:111], v[80:83], a[112:115]
    v_mfma_f32_16x16x32_bf16 a[116:119], v[108:111], v[84:87], a[116:119]
    v_mfma_f32_16x16x32_bf16 a[120:123], v[108:111], v[88:91], a[120:123]
    v_mfma_f32_16x16x32_bf16 a[124:127], v[108:111], v[92:95], a[124:127]
    v_mfma_f32_16x16x32_bf16 a[128:131], v[112:115], v[64:67], a[128:131]
    v_mfma_f32_16x16x32_bf16 a[132:135], v[112:115], v[68:71], a[132:135]
    v_mfma_f32_16x16x32_bf16 a[136:139], v[112:115], v[72:75], a[136:139]
    v_mfma_f32_16x16x32_bf16 a[140:143], v[112:115], v[76:79], a[140:143]
    v_mfma_f32_16x16x32_bf16 a[144:147], v[112:115], v[80:83], a[144:147]
    v_mfma_f32_16x16x32_bf16 a[148:151], v[112:115], v[84:87], a[148:151]
    v_mfma_f32_16x16x32_bf16 a[152:155], v[112:115], v[88:91], a[152:155]
    v_mfma_f32_16x16x32_bf16 a[156:159], v[112:115], v[92:95], a[156:159]
    v_mfma_f32_16x16x32_bf16 a[160:163], v[116:119], v[64:67], a[160:163]
    v_mfma_f32_16x16x32_bf16 a[164:167], v[116:119], v[68:71], a[164:167]
    v_mfma_f32_16x16x32_bf16 a[168:171], v[116:119], v[72:75], a[168:171]
    v_mfma_f32_16x16x32_bf16 a[172:175], v[116:119], v[76:79], a[172:175]
    v_mfma_f32_16x16x32_bf16 a[176:179], v[116:119], v[80:83], a[176:179]
    v_mfma_f32_16x16x32_bf16 a[180:183], v[116:119], v[84:87], a[180:183]
    v_mfma_f32_16x16x32_bf16 a[184:187], v[116:119], v[88:91], a[184:187]
    v_mfma_f32_16x16x32_bf16 a[188:191], v[116:119], v[92:95], a[188:191]
    v_mfma_f32_16x16x32_bf16 a[192:195], v[120:123], v[64:67], a[192:195]
    v_mfma_f32_16x16x32_bf16 a[196:199], v[120:123], v[68:71], a[196:199]
    v_mfma_f32_16x16x32_bf16 a[200:203], v[120:123], v[72:75], a[200:203]
    v_mfma_f32_16x16x32_bf16 a[204:207], v[120:123], v[76:79], a[204:207]
    v_mfma_f32_16x16x32_bf16 a[208:211], v[120:123], v[80:83], a[208:211]
    v_mfma_f32_16x16x32_bf16 a[212:215], v[120:123], v[84:87], a[212:215]
    v_mfma_f32_16x16x32_bf16 a[216:219], v[120:123], v[88:91], a[216:219]
    v_mfma_f32_16x16x32_bf16 a[220:223], v[120:123], v[92:95], a[220:223]
    v_mfma_f32_16x16x32_bf16 a[224:227], v[124:127], v[64:67], a[224:227]
    v_mfma_f32_16x16x32_bf16 a[228:231], v[124:127], v[68:71], a[228:231]
    v_mfma_f32_16x16x32_bf16 a[232:235], v[124:127], v[72:75], a[232:235]
    v_mfma_f32_16x16x32_bf16 a[236:239], v[124:127], v[76:79], a[236:239]
    v_mfma_f32_16x16x32_bf16 a[240:243], v[124:127], v[80:83], a[240:243]
    v_mfma_f32_16x16x32_bf16 a[244:247], v[124:127], v[84:87], a[244:247]
    v_mfma_f32_16x16x32_bf16 a[248:251], v[124:127], v[88:91], a[248:251]
    v_mfma_f32_16x16x32_bf16 a[252:255], v[124:127], v[92:95], a[252:255]
    s_waitcnt lgkmcnt(0)
    v_mfma_f32_16x16x32_bf16 a[0:3], v[32:35], v[0:3], a[0:3]
    s_waitcnt vmcnt(0)
    s_barrier
    ds_read_b128 v[96:99], v136 offset:49152
    v_mfma_f32_16x16x32_bf16 a[4:7], v[32:35], v[4:7], a[4:7]
    ds_read_b64_tr_b16 v[64:65], v128 offset:49152
    v_mfma_f32_16x16x32_bf16 a[8:11], v[32:35], v[8:11], a[8:11]
    ds_read_b64_tr_b16 v[66:67], v128 offset:57344
    v_mfma_f32_16x16x32_bf16 a[12:15], v[32:35], v[12:15], a[12:15]
    ds_read_b64_tr_b16 v[68:69], v129 offset:49152
    v_mfma_f32_16x16x32_bf16 a[16:19], v[32:35], v[16:19], a[16:19]
    ds_read_b64_tr_b16 v[70:71], v129 offset:57344
    v_mfma_f32_16x16x32_bf16 a[20:23], v[32:35], v[20:23], a[20:23]
    ds_read_b64_tr_b16 v[72:73], v130 offset:49152
    v_mfma_f32_16x16x32_bf16 a[24:27], v[32:35], v[24:27], a[24:27]
    ds_read_b64_tr_b16 v[74:75], v130 offset:57344
    v_mfma_f32_16x16x32_bf16 a[28:31], v[32:35], v[28:31], a[28:31]
    ds_read_b64_tr_b16 v[76:77], v131 offset:49152
    v_mfma_f32_16x16x32_bf16 a[32:35], v[36:39], v[0:3], a[32:35]
    ds_read_b64_tr_b16 v[78:79], v131 offset:57344
    v_mfma_f32_16x16x32_bf16 a[36:39], v[36:39], v[4:7], a[36:39]
    ds_read_b64_tr_b16 v[80:81], v132 offset:49152
    v_mfma_f32_16x16x32_bf16 a[40:43], v[36:39], v[8:11], a[40:43]
    ds_read_b64_tr_b16 v[82:83], v132 offset:57344
    v_mfma_f32_16x16x32_bf16 a[44:47], v[36:39], v[12:15], a[44:47]
    ds_read_b64_tr_b16 v[84:85], v133 offset:49152
    v_mfma_f32_16x16x32_bf16 a[48:51], v[36:39], v[16:19], a[48:51]
    ds_read_b64_tr_b16 v[86:87], v133 offset:57344
    v_mfma_f32_16x16x32_bf16 a[52:55], v[36:39], v[20:23], a[52:55]
    ds_read_b64_tr_b16 v[88:89], v134 offset:49152
    v_mfma_f32_16x16x32_bf16 a[56:59], v[36:39], v[24:27], a[56:59]
    ds_read_b64_tr_b16 v[90:91], v134 offset:57344
    v_mfma_f32_16x16x32_bf16 a[60:63], v[36:39], v[28:31], a[60:63]
    ds_read_b64_tr_b16 v[92:93], v135 offset:49152
    v_mfma_f32_16x16x32_bf16 a[64:67], v[40:43], v[0:3], a[64:67]
    ds_read_b64_tr_b16 v[94:95], v135 offset:57344
    v_mfma_f32_16x16x32_bf16 a[68:71], v[40:43], v[4:7], a[68:71]
    ds_read_b128 v[100:103], v136 offset:50176
    v_mfma_f32_16x16x32_bf16 a[72:75], v[40:43], v[8:11], a[72:75]
    ds_read_b128 v[104:107], v136 offset:51200
    v_mfma_f32_16x16x32_bf16 a[76:79], v[40:43], v[12:15], a[76:79]
    ds_read_b128 v[108:111], v136 offset:52224
    v_mfma_f32_16x16x32_bf16 a[80:83], v[40:43], v[16:19], a[80:83]
    ds_read_b128 v[112:115], v136 offset:53248
    v_mfma_f32_16x16x32_bf16 a[84:87], v[40:43], v[20:23], a[84:87]
    ds_read_b128 v[116:119], v136 offset:54272
    v_mfma_f32_16x16x32_bf16 a[88:91], v[40:43], v[24:27], a[88:91]
    ds_read_b128 v[120:123], v136 offset:55296
    v_mfma_f32_16x16x32_bf16 a[92:95], v[40:43], v[28:31], a[92:95]
    ds_read_b128 v[124:127], v136 offset:56320
    v_mfma_f32_16x16x32_bf16 a[96:99], v[44:47], v[0:3], a[96:99]
    v_mfma_f32_16x16x32_bf16 a[100:103], v[44:47], v[4:7], a[100:103]
    v_mfma_f32_16x16x32_bf16 a[104:107], v[44:47], v[8:11], a[104:107]
    v_mfma_f32_16x16x32_bf16 a[108:111], v[44:47], v[12:15], a[108:111]
    v_mfma_f32_16x16x32_bf16 a[112:115], v[44:47], v[16:19], a[112:115]
    v_mfma_f32_16x16x32_bf16 a[116:119], v[44:47], v[20:23], a[116:119]
    v_mfma_f32_16x16x32_bf16 a[120:123], v[44:47], v[24:27], a[120:123]
    v_mfma_f32_16x16x32_bf16 a[124:127], v[44:47], v[28:31], a[124:127]
    v_mfma_f32_16x16x32_bf16 a[128:131], v[48:51], v[0:3], a[128:131]
    v_mfma_f32_16x16x32_bf16 a[132:135], v[48:51], v[4:7], a[132:135]
    v_mfma_f32_16x16x32_bf16 a[136:139], v[48:51], v[8:11], a[136:139]
    v_mfma_f32_16x16x32_bf16 a[140:143], v[48:51], v[12:15], a[140:143]
    v_mfma_f32_16x16x32_bf16 a[144:147], v[48:51], v[16:19], a[144:147]
    v_mfma_f32_16x16x32_bf16 a[148:151], v[48:51], v[20:23], a[148:151]
    v_mfma_f32_16x16x32_bf16 a[152:155], v[48:51], v[24:27], a[152:155]
    v_mfma_f32_16x16x32_bf16 a[156:159], v[48:51], v[28:31], a[156:159]
    v_mfma_f32_16x16x32_bf16 a[160:163], v[52:55], v[0:3], a[160:163]
    v_mfma_f32_16x16x32_bf16 a[164:167], v[52:55], v[4:7], a[164:167]
    v_mfma_f32_16x16x32_bf16 a[168:171], v[52:55], v[8:11], a[168:171]
    v_mfma_f32_16x16x32_bf16 a[172:175], v[52:55], v[12:15], a[172:175]
    v_mfma_f32_16x16x32_bf16 a[176:179], v[52:55], v[16:19], a[176:179]
    v_mfma_f32_16x16x32_bf16 a[180:183], v[52:55], v[20:23], a[180:183]
    v_mfma_f32_16x16x32_bf16 a[184:187], v[52:55], v[24:27], a[184:187]
    v_mfma_f32_16x16x32_bf16 a[188:191], v[52:55], v[28:31], a[188:191]
    v_mfma_f32_16x16x32_bf16 a[192:195], v[56:59], v[0:3], a[192:195]
    v_mfma_f32_16x16x32_bf16 a[196:199], v[56:59], v[4:7], a[196:199]
    v_mfma_f32_16x16x32_bf16 a[200:203], v[56:59], v[8:11], a[200:203]
    v_mfma_f32_16x16x32_bf16 a[204:207], v[56:59], v[12:15], a[204:207]
    v_mfma_f32_16x16x32_bf16 a[208:211], v[56:59], v[16:19], a[208:211]
    v_mfma_f32_16x16x32_bf16 a[212:215], v[56:59], v[20:23], a[212:215]
    v_mfma_f32_16x16x32_bf16 a[216:219], v[56:59], v[24:27], a[216:219]
    v_mfma_f32_16x16x32_bf16 a[220:223], v[56:59], v[28:31], a[220:223]
    v_mfma_f32_16x16x32_bf16 a[224:227], v[60:63], v[0:3], a[224:227]
    v_mfma_f32_16x16x32_bf16 a[228:231], v[60:63], v[4:7], a[228:231]
    v_mfma_f32_16x16x32_bf16 a[232:235], v[60:63], v[8:11], a[232:235]
    v_mfma_f32_16x16x32_bf16 a[236:239], v[60:63], v[12:15], a[236:239]
    v_mfma_f32_16x16x32_bf16 a[240:243], v[60:63], v[16:19], a[240:243]
    v_mfma_f32_16x16x32_bf16 a[244:247], v[60:63], v[20:23], a[244:247]
    v_mfma_f32_16x16x32_bf16 a[248:251], v[60:63], v[24:27], a[248:251]
    v_mfma_f32_16x16x32_bf16 a[252:255], v[60:63], v[28:31], a[252:255]
    v_readfirstlane_b32 s55, v255
    s_waitcnt lgkmcnt(0)
    v_mfma_f32_16x16x32_bf16 a[0:3], v[96:99], v[64:67], a[0:3]
    v_mfma_f32_16x16x32_bf16 a[4:7], v[96:99], v[68:71], a[4:7]
    v_mfma_f32_16x16x32_bf16 a[8:11], v[96:99], v[72:75], a[8:11]
    v_mfma_f32_16x16x32_bf16 a[12:15], v[96:99], v[76:79], a[12:15]
    v_mfma_f32_16x16x32_bf16 a[16:19], v[96:99], v[80:83], a[16:19]
    v_mfma_f32_16x16x32_bf16 a[20:23], v[96:99], v[84:87], a[20:23]
    v_mfma_f32_16x16x32_bf16 a[24:27], v[96:99], v[88:91], a[24:27]
    v_mfma_f32_16x16x32_bf16 a[28:31], v[96:99], v[92:95], a[28:31]
    v_mfma_f32_16x16x32_bf16 a[32:35], v[100:103], v[64:67], a[32:35]
    v_mfma_f32_16x16x32_bf16 a[36:39], v[100:103], v[68:71], a[36:39]
    v_mfma_f32_16x16x32_bf16 a[40:43], v[100:103], v[72:75], a[40:43]
    v_mfma_f32_16x16x32_bf16 a[44:47], v[100:103], v[76:79], a[44:47]
    v_mfma_f32_16x16x32_bf16 a[48:51], v[100:103], v[80:83], a[48:51]
    v_mfma_f32_16x16x32_bf16 a[52:55], v[100:103], v[84:87], a[52:55]
    v_mfma_f32_16x16x32_bf16 a[56:59], v[100:103], v[88:91], a[56:59]
    v_mfma_f32_16x16x32_bf16 a[60:63], v[100:103], v[92:95], a[60:63]
    v_mfma_f32_16x16x32_bf16 a[64:67], v[104:107], v[64:67], a[64:67]
    v_mfma_f32_16x16x32_bf16 a[68:71], v[104:107], v[68:71], a[68:71]
    v_mfma_f32_16x16x32_bf16 a[72:75], v[104:107], v[72:75], a[72:75]
    v_mfma_f32_16x16x32_bf16 a[76:79], v[104:107], v[76:79], a[76:79]
    v_mfma_f32_16x16x32_bf16 a[80:83], v[104:107], v[80:83], a[80:83]
    v_mfma_f32_16x16x32_bf16 a[84:87], v[104:107], v[84:87], a[84:87]
    v_mfma_f32_16x16x32_bf16 a[88:91], v[104:107], v[88:91], a[88:91]
    v_mfma_f32_16x16x32_bf16 a[92:95], v[104:107], v[92:95], a[92:95]
    v_mfma_f32_16x16x32_bf16 a[96:99], v[108:111], v[64:67], a[96:99]
    v_mfma_f32_16x16x32_bf16 a[100:103], v[108:111], v[68:71], a[100:103]
    v_mfma_f32_16x16x32_bf16 a[104:107], v[108:111], v[72:75], a[104:107]
    v_mfma_f32_16x16x32_bf16 a[108:111], v[108:111], v[76:79], a[108:111]
    v_mfma_f32_16x16x32_bf16 a[112:115], v[108:111], v[80:83], a[112:115]
    v_mfma_f32_16x16x32_bf16 a[116:119], v[108:111], v[84:87], a[116:119]
    v_mfma_f32_16x16x32_bf16 a[120:123], v[108:111], v[88:91], a[120:123]
    v_mfma_f32_16x16x32_bf16 a[124:127], v[108:111], v[92:95], a[124:127]
    v_mfma_f32_16x16x32_bf16 a[128:131], v[112:115], v[64:67], a[128:131]
    v_mfma_f32_16x16x32_bf16 a[132:135], v[112:115], v[68:71], a[132:135]
    v_mfma_f32_16x16x32_bf16 a[136:139], v[112:115], v[72:75], a[136:139]
    v_mfma_f32_16x16x32_bf16 a[140:143], v[112:115], v[76:79], a[140:143]
    v_mfma_f32_16x16x32_bf16 a[144:147], v[112:115], v[80:83], a[144:147]
    v_mfma_f32_16x16x32_bf16 a[148:151], v[112:115], v[84:87], a[148:151]
    v_mfma_f32_16x16x32_bf16 a[152:155], v[112:115], v[88:91], a[152:155]
    v_mfma_f32_16x16x32_bf16 a[156:159], v[112:115], v[92:95], a[156:159]
    v_mfma_f32_16x16x32_bf16 a[160:163], v[116:119], v[64:67], a[160:163]
    v_mfma_f32_16x16x32_bf16 a[164:167], v[116:119], v[68:71], a[164:167]
    v_mfma_f32_16x16x32_bf16 a[168:171], v[116:119], v[72:75], a[168:171]
    v_mfma_f32_16x16x32_bf16 a[172:175], v[116:119], v[76:79], a[172:175]
    v_mfma_f32_16x16x32_bf16 a[176:179], v[116:119], v[80:83], a[176:179]
    v_mfma_f32_16x16x32_bf16 a[180:183], v[116:119], v[84:87], a[180:183]
    v_mfma_f32_16x16x32_bf16 a[184:187], v[116:119], v[88:91], a[184:187]
    v_mfma_f32_16x16x32_bf16 a[188:191], v[116:119], v[92:95], a[188:191]
    v_mfma_f32_16x16x32_bf16 a[192:195], v[120:123], v[64:67], a[192:195]
    v_mfma_f32_16x16x32_bf16 a[196:199], v[120:123], v[68:71], a[196:199]
    v_mfma_f32_16x16x32_bf16 a[200:203], v[120:123], v[72:75], a[200:203]
    v_mfma_f32_16x16x32_bf16 a[204:207], v[120:123], v[76:79], a[204:207]
    v_mfma_f32_16x16x32_bf16 a[208:211], v[120:123], v[80:83], a[208:211]
    v_mfma_f32_16x16x32_bf16 a[212:215], v[120:123], v[84:87], a[212:215]
    v_mfma_f32_16x16x32_bf16 a[216:219], v[120:123], v[88:91], a[216:219]
    v_mfma_f32_16x16x32_bf16 a[220:223], v[120:123], v[92:95], a[220:223]
    v_mfma_f32_16x16x32_bf16 a[224:227], v[124:127], v[64:67], a[224:227]
    v_mfma_f32_16x16x32_bf16 a[228:231], v[124:127], v[68:71], a[228:231]
    v_mfma_f32_16x16x32_bf16 a[232:235], v[124:127], v[72:75], a[232:235]
    v_mfma_f32_16x16x32_bf16 a[236:239], v[124:127], v[76:79], a[236:239]
    v_mfma_f32_16x16x32_bf16 a[240:243], v[124:127], v[80:83], a[240:243]
    v_mfma_f32_16x16x32_bf16 a[244:247], v[124:127], v[84:87], a[244:247]
    v_mfma_f32_16x16x32_bf16 a[248:251], v[124:127], v[88:91], a[248:251]
    v_mfma_f32_16x16x32_bf16 a[252:255], v[124:127], v[92:95], a[252:255]
    s_nop 7
    s_mov_b32 s53, s21
    v_accvgpr_read_b32 v0, a0
    v_accvgpr_read_b32 v1, a1
    v_accvgpr_read_b32 v2, a2
    v_accvgpr_read_b32 v3, a3
    v_accvgpr_read_b32 v4, a32
    v_accvgpr_read_b32 v5, a33
    v_accvgpr_read_b32 v6, a34
    v_accvgpr_read_b32 v7, a35
    v_cvt_pk_bf16_f32 v8, v0, v1
    v_cvt_pk_bf16_f32 v9, v2, v3
    v_cvt_pk_bf16_f32 v10, v4, v5
    v_cvt_pk_bf16_f32 v11, v6, v7
    buffer_store_dwordx4 v[8:11], v251, s[4:7], s53 offen offset:0 sc1
    v_accvgpr_read_b32 v16, a4
    v_accvgpr_read_b32 v17, a5
    v_accvgpr_read_b32 v18, a6
    v_accvgpr_read_b32 v19, a7
    v_accvgpr_read_b32 v20, a36
    v_accvgpr_read_b32 v21, a37
    v_accvgpr_read_b32 v22, a38
    v_accvgpr_read_b32 v23, a39
    v_cvt_pk_bf16_f32 v24, v16, v17
    v_cvt_pk_bf16_f32 v25, v18, v19
    v_cvt_pk_bf16_f32 v26, v20, v21
    v_cvt_pk_bf16_f32 v27, v22, v23
    buffer_store_dwordx4 v[24:27], v251, s[4:7], s53 offen offset:1024 sc1
    v_accvgpr_read_b32 v32, a8
    v_accvgpr_read_b32 v33, a9
    v_accvgpr_read_b32 v34, a10
    v_accvgpr_read_b32 v35, a11
    v_accvgpr_read_b32 v36, a40
    v_accvgpr_read_b32 v37, a41
    v_accvgpr_read_b32 v38, a42
    v_accvgpr_read_b32 v39, a43
    v_cvt_pk_bf16_f32 v40, v32, v33
    v_cvt_pk_bf16_f32 v41, v34, v35
    v_cvt_pk_bf16_f32 v42, v36, v37
    v_cvt_pk_bf16_f32 v43, v38, v39
    buffer_store_dwordx4 v[40:43], v251, s[4:7], s53 offen offset:2048 sc1
    v_accvgpr_read_b32 v48, a12
    v_accvgpr_read_b32 v49, a13
    v_accvgpr_read_b32 v50, a14
    v_accvgpr_read_b32 v51, a15
    v_accvgpr_read_b32 v52, a44
    v_accvgpr_read_b32 v53, a45
    v_accvgpr_read_b32 v54, a46
    v_accvgpr_read_b32 v55, a47
    v_cvt_pk_bf16_f32 v56, v48, v49
    v_cvt_pk_bf16_f32 v57, v50, v51
    v_cvt_pk_bf16_f32 v58, v52, v53
    v_cvt_pk_bf16_f32 v59, v54, v55
    buffer_store_dwordx4 v[56:59], v251, s[4:7], s53 offen offset:3072 sc1
    s_add_u32 s53, s53, 4096
    v_accvgpr_read_b32 v0, a16
    v_accvgpr_read_b32 v1, a17
    v_accvgpr_read_b32 v2, a18
    v_accvgpr_read_b32 v3, a19
    v_accvgpr_read_b32 v4, a48
    v_accvgpr_read_b32 v5, a49
    v_accvgpr_read_b32 v6, a50
    v_accvgpr_read_b32 v7, a51
    v_cvt_pk_bf16_f32 v8, v0, v1
    v_cvt_pk_bf16_f32 v9, v2, v3
    v_cvt_pk_bf16_f32 v10, v4, v5
    v_cvt_pk_bf16_f32 v11, v6, v7
    buffer_store_dwordx4 v[8:11], v251, s[4:7], s53 offen offset:0 sc1
    v_accvgpr_read_b32 v16, a20
    v_accvgpr_read_b32 v17, a21
    v_accvgpr_read_b32 v18, a22
    v_accvgpr_read_b32 v19, a23
    v_accvgpr_read_b32 v20, a52
    v_accvgpr_read_b32 v21, a53
    v_accvgpr_read_b32 v22, a54
    v_accvgpr_read_b32 v23, a55
    v_cvt_pk_bf16_f32 v24, v16, v17
    v_cvt_pk_bf16_f32 v25, v18, v19
    v_cvt_pk_bf16_f32 v26, v20, v21
    v_cvt_pk_bf16_f32 v27, v22, v23
    buffer_store_dwordx4 v[24:27], v251, s[4:7], s53 offen offset:1024 sc1
    v_accvgpr_read_b32 v32, a24
    v_accvgpr_read_b32 v33, a25
    v_accvgpr_read_b32 v34, a26
    v_accvgpr_read_b32 v35, a27
    v_accvgpr_read_b32 v36, a56
    v_accvgpr_read_b32 v37, a57
    v_accvgpr_read_b32 v38, a58
    v_accvgpr_read_b32 v39, a59
    v_cvt_pk_bf16_f32 v40, v32, v33
    v_cvt_pk_bf16_f32 v41, v34, v35
    v_cvt_pk_bf16_f32 v42, v36, v37
    v_cvt_pk_bf16_f32 v43, v38, v39
    buffer_store_dwordx4 v[40:43], v251, s[4:7], s53 offen offset:2048 sc1
    v_accvgpr_read_b32 v48, a28
    v_accvgpr_read_b32 v49, a29
    v_accvgpr_read_b32 v50, a30
    v_accvgpr_read_b32 v51, a31
    v_accvgpr_read_b32 v52, a60
    v_accvgpr_read_b32 v53, a61
    v_accvgpr_read_b32 v54, a62
    v_accvgpr_read_b32 v55, a63
    v_cvt_pk_bf16_f32 v56, v48, v49
    v_cvt_pk_bf16_f32 v57, v50, v51
    v_cvt_pk_bf16_f32 v58, v52, v53
    v_cvt_pk_bf16_f32 v59, v54, v55
    buffer_store_dwordx4 v[56:59], v251, s[4:7], s53 offen offset:3072 sc1
    s_add_u32 s53, s53, 258048
    v_accvgpr_read_b32 v0, a64
    v_accvgpr_read_b32 v1, a65
    v_accvgpr_read_b32 v2, a66
    v_accvgpr_read_b32 v3, a67
    v_accvgpr_read_b32 v4, a96
    v_accvgpr_read_b32 v5, a97
    v_accvgpr_read_b32 v6, a98
    v_accvgpr_read_b32 v7, a99
    v_cvt_pk_bf16_f32 v8, v0, v1
    v_cvt_pk_bf16_f32 v9, v2, v3
    v_cvt_pk_bf16_f32 v10, v4, v5
    v_cvt_pk_bf16_f32 v11, v6, v7
    buffer_store_dwordx4 v[8:11], v251, s[4:7], s53 offen offset:0 sc1
    v_accvgpr_read_b32 v16, a68
    v_accvgpr_read_b32 v17, a69
    v_accvgpr_read_b32 v18, a70
    v_accvgpr_read_b32 v19, a71
    v_accvgpr_read_b32 v20, a100
    v_accvgpr_read_b32 v21, a101
    v_accvgpr_read_b32 v22, a102
    v_accvgpr_read_b32 v23, a103
    v_cvt_pk_bf16_f32 v24, v16, v17
    v_cvt_pk_bf16_f32 v25, v18, v19
    v_cvt_pk_bf16_f32 v26, v20, v21
    v_cvt_pk_bf16_f32 v27, v22, v23
    buffer_store_dwordx4 v[24:27], v251, s[4:7], s53 offen offset:1024 sc1
    v_accvgpr_read_b32 v32, a72
    v_accvgpr_read_b32 v33, a73
    v_accvgpr_read_b32 v34, a74
    v_accvgpr_read_b32 v35, a75
    v_accvgpr_read_b32 v36, a104
    v_accvgpr_read_b32 v37, a105
    v_accvgpr_read_b32 v38, a106
    v_accvgpr_read_b32 v39, a107
    v_cvt_pk_bf16_f32 v40, v32, v33
    v_cvt_pk_bf16_f32 v41, v34, v35
    v_cvt_pk_bf16_f32 v42, v36, v37
    v_cvt_pk_bf16_f32 v43, v38, v39
    buffer_store_dwordx4 v[40:43], v251, s[4:7], s53 offen offset:2048 sc1
    v_accvgpr_read_b32 v48, a76
    v_accvgpr_read_b32 v49, a77
    v_accvgpr_read_b32 v50, a78
    v_accvgpr_read_b32 v51, a79
    v_accvgpr_read_b32 v52, a108
    v_accvgpr_read_b32 v53, a109
    v_accvgpr_read_b32 v54, a110
    v_accvgpr_read_b32 v55, a111
    v_cvt_pk_bf16_f32 v56, v48, v49
    v_cvt_pk_bf16_f32 v57, v50, v51
    v_cvt_pk_bf16_f32 v58, v52, v53
    v_cvt_pk_bf16_f32 v59, v54, v55
    buffer_store_dwordx4 v[56:59], v251, s[4:7], s53 offen offset:3072 sc1
    s_add_u32 s53, s53, 4096
    v_accvgpr_read_b32 v0, a80
    v_accvgpr_read_b32 v1, a81
    v_accvgpr_read_b32 v2, a82
    v_accvgpr_read_b32 v3, a83
    v_accvgpr_read_b32 v4, a112
    v_accvgpr_read_b32 v5, a113
    v_accvgpr_read_b32 v6, a114
    v_accvgpr_read_b32 v7, a115
    v_cvt_pk_bf16_f32 v8, v0, v1
    v_cvt_pk_bf16_f32 v9, v2, v3
    v_cvt_pk_bf16_f32 v10, v4, v5
    v_cvt_pk_bf16_f32 v11, v6, v7
    buffer_store_dwordx4 v[8:11], v251, s[4:7], s53 offen offset:0 sc1
    v_accvgpr_read_b32 v16, a84
    v_accvgpr_read_b32 v17, a85
    v_accvgpr_read_b32 v18, a86
    v_accvgpr_read_b32 v19, a87
    v_accvgpr_read_b32 v20, a116
    v_accvgpr_read_b32 v21, a117
    v_accvgpr_read_b32 v22, a118
    v_accvgpr_read_b32 v23, a119
    v_cvt_pk_bf16_f32 v24, v16, v17
    v_cvt_pk_bf16_f32 v25, v18, v19
    v_cvt_pk_bf16_f32 v26, v20, v21
    v_cvt_pk_bf16_f32 v27, v22, v23
    buffer_store_dwordx4 v[24:27], v251, s[4:7], s53 offen offset:1024 sc1
    v_accvgpr_read_b32 v32, a88
    v_accvgpr_read_b32 v33, a89
    v_accvgpr_read_b32 v34, a90
    v_accvgpr_read_b32 v35, a91
    v_accvgpr_read_b32 v36, a120
    v_accvgpr_read_b32 v37, a121
    v_accvgpr_read_b32 v38, a122
    v_accvgpr_read_b32 v39, a123
    v_cvt_pk_bf16_f32 v40, v32, v33
    v_cvt_pk_bf16_f32 v41, v34, v35
    v_cvt_pk_bf16_f32 v42, v36, v37
    v_cvt_pk_bf16_f32 v43, v38, v39
    buffer_store_dwordx4 v[40:43], v251, s[4:7], s53 offen offset:2048 sc1
    v_accvgpr_read_b32 v48, a92
    v_accvgpr_read_b32 v49, a93
    v_accvgpr_read_b32 v50, a94
    v_accvgpr_read_b32 v51, a95
    v_accvgpr_read_b32 v52, a124
    v_accvgpr_read_b32 v53, a125
    v_accvgpr_read_b32 v54, a126
    v_accvgpr_read_b32 v55, a127
    v_cvt_pk_bf16_f32 v56, v48, v49
    v_cvt_pk_bf16_f32 v57, v50, v51
    v_cvt_pk_bf16_f32 v58, v52, v53
    v_cvt_pk_bf16_f32 v59, v54, v55
    buffer_store_dwordx4 v[56:59], v251, s[4:7], s53 offen offset:3072 sc1
    s_add_u32 s53, s53, 258048
    v_accvgpr_read_b32 v0, a128
    v_accvgpr_read_b32 v1, a129
    v_accvgpr_read_b32 v2, a130
    v_accvgpr_read_b32 v3, a131
    v_accvgpr_read_b32 v4, a160
    v_accvgpr_read_b32 v5, a161
    v_accvgpr_read_b32 v6, a162
    v_accvgpr_read_b32 v7, a163
    v_cvt_pk_bf16_f32 v8, v0, v1
    v_cvt_pk_bf16_f32 v9, v2, v3
    v_cvt_pk_bf16_f32 v10, v4, v5
    v_cvt_pk_bf16_f32 v11, v6, v7
    buffer_store_dwordx4 v[8:11], v251, s[4:7], s53 offen offset:0 sc1
    v_accvgpr_read_b32 v16, a132
    v_accvgpr_read_b32 v17, a133
    v_accvgpr_read_b32 v18, a134
    v_accvgpr_read_b32 v19, a135
    v_accvgpr_read_b32 v20, a164
    v_accvgpr_read_b32 v21, a165
    v_accvgpr_read_b32 v22, a166
    v_accvgpr_read_b32 v23, a167
    v_cvt_pk_bf16_f32 v24, v16, v17
    v_cvt_pk_bf16_f32 v25, v18, v19
    v_cvt_pk_bf16_f32 v26, v20, v21
    v_cvt_pk_bf16_f32 v27, v22, v23
    buffer_store_dwordx4 v[24:27], v251, s[4:7], s53 offen offset:1024 sc1
    v_accvgpr_read_b32 v32, a136
    v_accvgpr_read_b32 v33, a137
    v_accvgpr_read_b32 v34, a138
    v_accvgpr_read_b32 v35, a139
    v_accvgpr_read_b32 v36, a168
    v_accvgpr_read_b32 v37, a169
    v_accvgpr_read_b32 v38, a170
    v_accvgpr_read_b32 v39, a171
    v_cvt_pk_bf16_f32 v40, v32, v33
    v_cvt_pk_bf16_f32 v41, v34, v35
    v_cvt_pk_bf16_f32 v42, v36, v37
    v_cvt_pk_bf16_f32 v43, v38, v39
    buffer_store_dwordx4 v[40:43], v251, s[4:7], s53 offen offset:2048 sc1
    v_accvgpr_read_b32 v48, a140
    v_accvgpr_read_b32 v49, a141
    v_accvgpr_read_b32 v50, a142
    v_accvgpr_read_b32 v51, a143
    v_accvgpr_read_b32 v52, a172
    v_accvgpr_read_b32 v53, a173
    v_accvgpr_read_b32 v54, a174
    v_accvgpr_read_b32 v55, a175
    v_cvt_pk_bf16_f32 v56, v48, v49
    v_cvt_pk_bf16_f32 v57, v50, v51
    v_cvt_pk_bf16_f32 v58, v52, v53
    v_cvt_pk_bf16_f32 v59, v54, v55
    buffer_store_dwordx4 v[56:59], v251, s[4:7], s53 offen offset:3072 sc1
    s_add_u32 s53, s53, 4096
    v_accvgpr_read_b32 v0, a144
    v_accvgpr_read_b32 v1, a145
    v_accvgpr_read_b32 v2, a146
    v_accvgpr_read_b32 v3, a147
    v_accvgpr_read_b32 v4, a176
    v_accvgpr_read_b32 v5, a177
    v_accvgpr_read_b32 v6, a178
    v_accvgpr_read_b32 v7, a179
    v_cvt_pk_bf16_f32 v8, v0, v1
    v_cvt_pk_bf16_f32 v9, v2, v3
    v_cvt_pk_bf16_f32 v10, v4, v5
    v_cvt_pk_bf16_f32 v11, v6, v7
    buffer_store_dwordx4 v[8:11], v251, s[4:7], s53 offen offset:0 sc1
    v_accvgpr_read_b32 v16, a148
    v_accvgpr_read_b32 v17, a149
    v_accvgpr_read_b32 v18, a150
    v_accvgpr_read_b32 v19, a151
    v_accvgpr_read_b32 v20, a180
    v_accvgpr_read_b32 v21, a181
    v_accvgpr_read_b32 v22, a182
    v_accvgpr_read_b32 v23, a183
    v_cvt_pk_bf16_f32 v24, v16, v17
    v_cvt_pk_bf16_f32 v25, v18, v19
    v_cvt_pk_bf16_f32 v26, v20, v21
    v_cvt_pk_bf16_f32 v27, v22, v23
    buffer_store_dwordx4 v[24:27], v251, s[4:7], s53 offen offset:1024 sc1
    v_accvgpr_read_b32 v32, a152
    v_accvgpr_read_b32 v33, a153
    v_accvgpr_read_b32 v34, a154
    v_accvgpr_read_b32 v35, a155
    v_accvgpr_read_b32 v36, a184
    v_accvgpr_read_b32 v37, a185
    v_accvgpr_read_b32 v38, a186
    v_accvgpr_read_b32 v39, a187
    v_cvt_pk_bf16_f32 v40, v32, v33
    v_cvt_pk_bf16_f32 v41, v34, v35
    v_cvt_pk_bf16_f32 v42, v36, v37
    v_cvt_pk_bf16_f32 v43, v38, v39
    buffer_store_dwordx4 v[40:43], v251, s[4:7], s53 offen offset:2048 sc1
    v_accvgpr_read_b32 v48, a156
    v_accvgpr_read_b32 v49, a157
    v_accvgpr_read_b32 v50, a158
    v_accvgpr_read_b32 v51, a159
    v_accvgpr_read_b32 v52, a188
    v_accvgpr_read_b32 v53, a189
    v_accvgpr_read_b32 v54, a190
    v_accvgpr_read_b32 v55, a191
    v_cvt_pk_bf16_f32 v56, v48, v49
    v_cvt_pk_bf16_f32 v57, v50, v51
    v_cvt_pk_bf16_f32 v58, v52, v53
    v_cvt_pk_bf16_f32 v59, v54, v55
    buffer_store_dwordx4 v[56:59], v251, s[4:7], s53 offen offset:3072 sc1
    s_add_u32 s53, s53, 258048
    v_accvgpr_read_b32 v0, a192
    v_accvgpr_read_b32 v1, a193
    v_accvgpr_read_b32 v2, a194
    v_accvgpr_read_b32 v3, a195
    v_accvgpr_read_b32 v4, a224
    v_accvgpr_read_b32 v5, a225
    v_accvgpr_read_b32 v6, a226
    v_accvgpr_read_b32 v7, a227
    v_cvt_pk_bf16_f32 v8, v0, v1
    v_cvt_pk_bf16_f32 v9, v2, v3
    v_cvt_pk_bf16_f32 v10, v4, v5
    v_cvt_pk_bf16_f32 v11, v6, v7
    buffer_store_dwordx4 v[8:11], v251, s[4:7], s53 offen offset:0 sc1
    v_accvgpr_read_b32 v16, a196
    v_accvgpr_read_b32 v17, a197
    v_accvgpr_read_b32 v18, a198
    v_accvgpr_read_b32 v19, a199
    v_accvgpr_read_b32 v20, a228
    v_accvgpr_read_b32 v21, a229
    v_accvgpr_read_b32 v22, a230
    v_accvgpr_read_b32 v23, a231
    v_cvt_pk_bf16_f32 v24, v16, v17
    v_cvt_pk_bf16_f32 v25, v18, v19
    v_cvt_pk_bf16_f32 v26, v20, v21
    v_cvt_pk_bf16_f32 v27, v22, v23
    buffer_store_dwordx4 v[24:27], v251, s[4:7], s53 offen offset:1024 sc1
    v_accvgpr_read_b32 v32, a200
    v_accvgpr_read_b32 v33, a201
    v_accvgpr_read_b32 v34, a202
    v_accvgpr_read_b32 v35, a203
    v_accvgpr_read_b32 v36, a232
    v_accvgpr_read_b32 v37, a233
    v_accvgpr_read_b32 v38, a234
    v_accvgpr_read_b32 v39, a235
    v_cvt_pk_bf16_f32 v40, v32, v33
    v_cvt_pk_bf16_f32 v41, v34, v35
    v_cvt_pk_bf16_f32 v42, v36, v37
    v_cvt_pk_bf16_f32 v43, v38, v39
    buffer_store_dwordx4 v[40:43], v251, s[4:7], s53 offen offset:2048 sc1
    v_accvgpr_read_b32 v48, a204
    v_accvgpr_read_b32 v49, a205
    v_accvgpr_read_b32 v50, a206
    v_accvgpr_read_b32 v51, a207
    v_accvgpr_read_b32 v52, a236
    v_accvgpr_read_b32 v53, a237
    v_accvgpr_read_b32 v54, a238
    v_accvgpr_read_b32 v55, a239
    v_cvt_pk_bf16_f32 v56, v48, v49
    v_cvt_pk_bf16_f32 v57, v50, v51
    v_cvt_pk_bf16_f32 v58, v52, v53
    v_cvt_pk_bf16_f32 v59, v54, v55
    buffer_store_dwordx4 v[56:59], v251, s[4:7], s53 offen offset:3072 sc1
    s_add_u32 s53, s53, 4096
    v_accvgpr_read_b32 v0, a208
    v_accvgpr_read_b32 v1, a209
    v_accvgpr_read_b32 v2, a210
    v_accvgpr_read_b32 v3, a211
    v_accvgpr_read_b32 v4, a240
    v_accvgpr_read_b32 v5, a241
    v_accvgpr_read_b32 v6, a242
    v_accvgpr_read_b32 v7, a243
    v_cvt_pk_bf16_f32 v8, v0, v1
    v_cvt_pk_bf16_f32 v9, v2, v3
    v_cvt_pk_bf16_f32 v10, v4, v5
    v_cvt_pk_bf16_f32 v11, v6, v7
    buffer_store_dwordx4 v[8:11], v251, s[4:7], s53 offen offset:0 sc1
    v_accvgpr_read_b32 v16, a212
    v_accvgpr_read_b32 v17, a213
    v_accvgpr_read_b32 v18, a214
    v_accvgpr_read_b32 v19, a215
    v_accvgpr_read_b32 v20, a244
    v_accvgpr_read_b32 v21, a245
    v_accvgpr_read_b32 v22, a246
    v_accvgpr_read_b32 v23, a247
    v_cvt_pk_bf16_f32 v24, v16, v17
    v_cvt_pk_bf16_f32 v25, v18, v19
    v_cvt_pk_bf16_f32 v26, v20, v21
    v_cvt_pk_bf16_f32 v27, v22, v23
    buffer_store_dwordx4 v[24:27], v251, s[4:7], s53 offen offset:1024 sc1
    v_accvgpr_read_b32 v32, a216
    v_accvgpr_read_b32 v33, a217
    v_accvgpr_read_b32 v34, a218
    v_accvgpr_read_b32 v35, a219
    v_accvgpr_read_b32 v36, a248
    v_accvgpr_read_b32 v37, a249
    v_accvgpr_read_b32 v38, a250
    v_accvgpr_read_b32 v39, a251
    v_cvt_pk_bf16_f32 v40, v32, v33
    v_cvt_pk_bf16_f32 v41, v34, v35
    v_cvt_pk_bf16_f32 v42, v36, v37
    v_cvt_pk_bf16_f32 v43, v38, v39
    buffer_store_dwordx4 v[40:43], v251, s[4:7], s53 offen offset:2048 sc1
    v_accvgpr_read_b32 v48, a220
    v_accvgpr_read_b32 v49, a221
    v_accvgpr_read_b32 v50, a222
    v_accvgpr_read_b32 v51, a223
    v_accvgpr_read_b32 v52, a252
    v_accvgpr_read_b32 v53, a253
    v_accvgpr_read_b32 v54, a254
    v_accvgpr_read_b32 v55, a255
    v_cvt_pk_bf16_f32 v56, v48, v49
    v_cvt_pk_bf16_f32 v57, v50, v51
    v_cvt_pk_bf16_f32 v58, v52, v53
    v_cvt_pk_bf16_f32 v59, v54, v55
    buffer_store_dwordx4 v[56:59], v251, s[4:7], s53 offen offset:3072 sc1
    s_add_u32 s53, s53, 258048
    s_branch main_kernel_w_done
main_kernel_w_pref:
    s_cmp_lg_u32 s24, 0
    s_cbranch_scc1 main_kernel_w_pf0
    s_mov_b32 s8, s64
    s_and_b32 s9, s65, 0xffff
    s_mov_b32 s10, 0x200000
    s_mov_b32 s11, 0x20000
    s_branch main_kernel_w_pfg
main_kernel_w_pf0:
    s_cmp_lg_u32 s24, 1
    s_cbranch_scc1 main_kernel_w_pf1
    s_mov_b32 s8, s66
    s_and_b32 s9, s67, 0xffff
    s_mov_b32 s10, 0x200000
    s_mov_b32 s11, 0x20000
    s_branch main_kernel_w_pfg
main_kernel_w_pf1:
    s_cmp_lg_u32 s24, 2
    s_cbranch_scc1 main_kernel_w_pf2
    s_mov_b32 s8, s68
    s_and_b32 s9, s69, 0xffff
    s_mov_b32 s10, 0x700000
    s_mov_b32 s11, 0x20000
    s_branch main_kernel_w_pfg
main_kernel_w_pf2:
    s_mov_b32 s8, s70
    s_and_b32 s9, s71, 0xffff
    s_mov_b32 s10, 0x700000
    s_mov_b32 s11, 0x20000
main_kernel_w_pfg:
    s_lshl_b32 s32, s25, 19
    s_lshl_b32 s33, s14, 17
    s_add_u32 s32, s32, s33
    v_lshlrev_b32 v253, 7, v250
    buffer_load_dword v0, v253, s[8:11], s32 offen
    s_add_u32 s32, s32, 8192
    buffer_load_dword v0, v253, s[8:11], s32 offen
    s_add_u32 s32, s32, 8192
    buffer_load_dword v0, v253, s[8:11], s32 offen
    s_add_u32 s32, s32, 8192
    buffer_load_dword v0, v253, s[8:11], s32 offen
    s_add_u32 s32, s32, 8192
    buffer_load_dword v0, v253, s[8:11], s32 offen
    s_add_u32 s32, s32, 8192
    buffer_load_dword v0, v253, s[8:11], s32 offen
    s_add_u32 s32, s32, 8192
    buffer_load_dword v0, v253, s[8:11], s32 offen
    s_add_u32 s32, s32, 8192
    buffer_load_dword v0, v253, s[8:11], s32 offen
    s_add_u32 s32, s32, 8192
    buffer_load_dword v0, v253, s[8:11], s32 offen
    s_add_u32 s32, s32, 8192
    buffer_load_dword v0, v253, s[8:11], s32 offen
    s_add_u32 s32, s32, 8192
    buffer_load_dword v0, v253, s[8:11], s32 offen
    s_add_u32 s32, s32, 8192
    buffer_load_dword v0, v253, s[8:11], s32 offen
    s_add_u32 s32, s32, 8192
    buffer_load_dword v0, v253, s[8:11], s32 offen
    s_add_u32 s32, s32, 8192
    buffer_load_dword v0, v253, s[8:11], s32 offen
    s_add_u32 s32, s32, 8192
    buffer_load_dword v0, v253, s[8:11], s32 offen
    s_add_u32 s32, s32, 8192
    buffer_load_dword v0, v253, s[8:11], s32 offen
    s_add_u32 s32, s32, 8192
    s_branch main_kernel_w_done
main_kernel_w_fill:
    s_lshl_b32 s32, s24, 2
    s_add_u32 s32, s32, s25
    s_lshl_b32 s33, s32, 16
    s_add_u32 s32, s33, 0x6e00000
    s_add_u32 s35, s33, 0x8c00000
    s_add_u32 s33, s33, 0x8000000
    s_lshl_b32 s34, s14, 12
    v_add_u32 v253, s34, v251
    v_mov_b32 v0, -1
    v_mov_b32 v1, -1
    v_mov_b32 v2, -1
    v_mov_b32 v3, -1
    s_mov_b32 s18, 4
main_kernel_w_fl:
    buffer_store_dwordx4 v[0:3], v253, s[4:7], s32 offen offset:0 sc1
    buffer_store_dwordx4 v[0:3], v253, s[4:7], s32 offen offset:1024 sc1
    buffer_store_dwordx4 v[0:3], v253, s[4:7], s32 offen offset:2048 sc1
    buffer_store_dwordx4 v[0:3], v253, s[4:7], s32 offen offset:3072 sc1
    s_add_u32 s32, s32, 16384
    buffer_store_dwordx4 v[0:3], v253, s[4:7], s33 offen offset:0 sc1
    buffer_store_dwordx4 v[0:3], v253, s[4:7], s33 offen offset:1024 sc1
    buffer_store_dwordx4 v[0:3], v253, s[4:7], s33 offen offset:2048 sc1
    buffer_store_dwordx4 v[0:3], v253, s[4:7], s33 offen offset:3072 sc1
    s_add_u32 s33, s33, 16384
    s_sub_u32 s18, s18, 1
    s_cmp_lg_u32 s18, 0
    s_cbranch_scc1 main_kernel_w_fl
    s_branch main_kernel_w_done
main_kernel_w_ln2:
    s_lshl_b32 s32, s24, 3
    s_mul_i32 s33, s25, 2
    s_add_u32 s32, s32, s33
    s_lshl_b32 s32, s32, 15
    s_lshl_b32 s33, s14, 13
    s_add_u32 s32, s32, s33
    s_add_u32 s21, s32, 0x6800000
    s_add_u32 s32, s32, 0x5000000
    buffer_load_dwordx4 v[0:3], v251, s[4:7], s32 offen offset:0 sc1
    buffer_load_dwordx4 v[4:7], v251, s[4:7], s32 offen offset:1024 sc1
    buffer_load_dwordx4 v[8:11], v251, s[4:7], s32 offen offset:2048 sc1
    buffer_load_dwordx4 v[12:15], v251, s[4:7], s32 offen offset:3072 sc1
    s_add_u32 s32, s32, 4096
    buffer_load_dwordx4 v[16:19], v251, s[4:7], s32 offen offset:0 sc1
    buffer_load_dwordx4 v[20:23], v251, s[4:7], s32 offen offset:1024 sc1
    buffer_load_dwordx4 v[24:27], v251, s[4:7], s32 offen offset:2048 sc1
    buffer_load_dwordx4 v[28:31], v251, s[4:7], s32 offen offset:3072 sc1
    s_add_u32 s32, s32, 28672
    buffer_load_dwordx4 v[32:35], v251, s[4:7], s32 offen offset:0 sc1
    buffer_load_dwordx4 v[36:39], v251, s[4:7], s32 offen offset:1024 sc1
    buffer_load_dwordx4 v[40:43], v251, s[4:7], s32 offen offset:2048 sc1
    buffer_load_dwordx4 v[44:47], v251, s[4:7], s32 offen offset:3072 sc1
    s_add_u32 s32, s32, 4096
    buffer_load_dwordx4 v[48:51], v251, s[4:7], s32 offen offset:0 sc1
    buffer_load_dwordx4 v[52:55], v251, s[4:7], s32 offen offset:1024 sc1
    buffer_load_dwordx4 v[56:59], v251, s[4:7], s32 offen offset:2048 sc1
    buffer_load_dwordx4 v[60:63], v251, s[4:7], s32 offen offset:3072 sc1
    s_add_u32 s32, s32, 28672
    v_and_b32 v255, 15, v250
    v_lshlrev_b32 v254, 6, v255
    v_add_u32 v254, 132096, v254
    v_lshrrev_b32 v255, 4, v250
    v_lshl_add_u32 v253, v255, 2, v254
    v_lshl_add_u32 v253, s14, 4, v253
    s_waitcnt vmcnt(8)
    v_lshlrev_b32 v128, 16, v0
    v_and_b32 v129, 0xffff0000, v0
    v_lshlrev_b32 v130, 16, v1
    v_and_b32 v131, 0xffff0000, v1
    v_lshlrev_b32 v132, 16, v2
    v_and_b32 v133, 0xffff0000, v2
    v_lshlrev_b32 v134, 16, v3
    v_and_b32 v135, 0xffff0000, v3
    v_lshlrev_b32 v136, 16, v4
    v_and_b32 v137, 0xffff0000, v4
    v_lshlrev_b32 v138, 16, v5
    v_and_b32 v139, 0xffff0000, v5
    v_lshlrev_b32 v140, 16, v6
    v_and_b32 v141, 0xffff0000, v6
    v_lshlrev_b32 v142, 16, v7
    v_and_b32 v143, 0xffff0000, v7
    v_lshlrev_b32 v144, 16, v8
    v_and_b32 v145, 0xffff0000, v8
    v_lshlrev_b32 v146, 16, v9
    v_and_b32 v147, 0xffff0000, v9
    v_lshlrev_b32 v148, 16, v10
    v_and_b32 v149, 0xffff0000, v10
    v_lshlrev_b32 v150, 16, v11
    v_and_b32 v151, 0xffff0000, v11
    v_lshlrev_b32 v152, 16, v12
    v_and_b32 v153, 0xffff0000, v12
    v_lshlrev_b32 v154, 16, v13
    v_and_b32 v155, 0xffff0000, v13
    v_lshlrev_b32 v156, 16, v14
    v_and_b32 v157, 0xffff0000, v14
    v_lshlrev_b32 v158, 16, v15
    v_and_b32 v159, 0xffff0000, v15
    v_lshlrev_b32 v160, 16, v16
    v_and_b32 v161, 0xffff0000, v16
    v_lshlrev_b32 v162, 16, v17
    v_and_b32 v163, 0xffff0000, v17
    v_lshlrev_b32 v164, 16, v18
    v_and_b32 v165, 0xffff0000, v18
    v_lshlrev_b32 v166, 16, v19
    v_and_b32 v167, 0xffff0000, v19
    v_lshlrev_b32 v168, 16, v20
    v_and_b32 v169, 0xffff0000, v20
    v_lshlrev_b32 v170, 16, v21
    v_and_b32 v171, 0xffff0000, v21
    v_lshlrev_b32 v172, 16, v22
    v_and_b32 v173, 0xffff0000, v22
    v_lshlrev_b32 v174, 16, v23
    v_and_b32 v175, 0xffff0000, v23
    v_lshlrev_b32 v176, 16, v24
    v_and_b32 v177, 0xffff0000, v24
    v_lshlrev_b32 v178, 16, v25
    v_and_b32 v179, 0xffff0000, v25
    v_lshlrev_b32 v180, 16, v26
    v_and_b32 v181, 0xffff0000, v26
    v_lshlrev_b32 v182, 16, v27
    v_and_b32 v183, 0xffff0000, v27
    v_lshlrev_b32 v184, 16, v28
    v_and_b32 v185, 0xffff0000, v28
    v_lshlrev_b32 v186, 16, v29
    v_and_b32 v187, 0xffff0000, v29
    v_lshlrev_b32 v188, 16, v30
    v_and_b32 v189, 0xffff0000, v30
    v_lshlrev_b32 v190, 16, v31
    v_and_b32 v191, 0xffff0000, v31
    v_pk_add_f32 v[192:193], v[128:129], v[136:137]
    v_pk_add_f32 v[194:195], v[130:131], v[138:139]
    v_pk_add_f32 v[196:197], v[132:133], v[140:141]
    v_pk_add_f32 v[198:199], v[134:135], v[142:143]
    v_pk_add_f32 v[192:193], v[192:193], v[144:145]
    v_pk_add_f32 v[194:195], v[194:195], v[146:147]
    v_pk_add_f32 v[196:197], v[196:197], v[148:149]
    v_pk_add_f32 v[198:199], v[198:199], v[150:151]
    v_pk_add_f32 v[192:193], v[192:193], v[152:153]
    v_pk_add_f32 v[194:195], v[194:195], v[154:155]
    v_pk_add_f32 v[196:197], v[196:197], v[156:157]
    v_pk_add_f32 v[198:199], v[198:199], v[158:159]
    v_pk_add_f32 v[192:193], v[192:193], v[160:161]
    v_pk_add_f32 v[194:195], v[194:195], v[162:163]
    v_pk_add_f32 v[196:197], v[196:197], v[164:165]
    v_pk_add_f32 v[198:199], v[198:199], v[166:167]
    v_pk_add_f32 v[192:193], v[192:193], v[168:169]
    v_pk_add_f32 v[194:195], v[194:195], v[170:171]
    v_pk_add_f32 v[196:197], v[196:197], v[172:173]
    v_pk_add_f32 v[198:199], v[198:199], v[174:175]
    v_pk_add_f32 v[192:193], v[192:193], v[176:177]
    v_pk_add_f32 v[194:195], v[194:195], v[178:179]
    v_pk_add_f32 v[196:197], v[196:197], v[180:181]
    v_pk_add_f32 v[198:199], v[198:199], v[182:183]
    v_pk_add_f32 v[192:193], v[192:193], v[184:185]
    v_pk_add_f32 v[194:195], v[194:195], v[186:187]
    v_pk_add_f32 v[196:197], v[196:197], v[188:189]
    v_pk_add_f32 v[198:199], v[198:199], v[190:191]
    v_pk_add_f32 v[192:193], v[192:193], v[194:195]
    v_pk_add_f32 v[196:197], v[196:197], v[198:199]
    v_pk_add_f32 v[192:193], v[192:193], v[196:197]
    v_add_f32 v192, v192, v193
    ds_write_b32 v253, v192 offset:0
    s_waitcnt lgkmcnt(0)
    s_barrier
    ds_read_b128 v[192:195], v254 offset:0
    ds_read_b128 v[196:199], v254 offset:16
    ds_read_b128 v[200:203], v254 offset:32
    ds_read_b128 v[204:207], v254 offset:48
    s_waitcnt lgkmcnt(2)
    v_pk_add_f32 v[192:193], v[192:193], v[194:195]
    v_pk_add_f32 v[196:197], v[196:197], v[198:199]
    s_waitcnt lgkmcnt(0)
    v_pk_add_f32 v[200:201], v[200:201], v[202:203]
    v_pk_add_f32 v[204:205], v[204:205], v[206:207]
    v_pk_add_f32 v[192:193], v[192:193], v[196:197]
    v_pk_add_f32 v[200:201], v[200:201], v[204:205]
    v_pk_add_f32 v[192:193], v[192:193], v[200:201]
    v_add_f32 v192, v192, v193
    v_mul_f32 v192, 0xba800000, v192
    v_mov_b32 v193, v192
    v_pk_add_f32 v[128:129], v[128:129], v[192:193]
    v_pk_add_f32 v[130:131], v[130:131], v[192:193]
    v_pk_add_f32 v[132:133], v[132:133], v[192:193]
    v_pk_add_f32 v[134:135], v[134:135], v[192:193]
    v_pk_add_f32 v[136:137], v[136:137], v[192:193]
    v_pk_add_f32 v[138:139], v[138:139], v[192:193]
    v_pk_add_f32 v[140:141], v[140:141], v[192:193]
    v_pk_add_f32 v[142:143], v[142:143], v[192:193]
    v_pk_add_f32 v[144:145], v[144:145], v[192:193]
    v_pk_add_f32 v[146:147], v[146:147], v[192:193]
    v_pk_add_f32 v[148:149], v[148:149], v[192:193]
    v_pk_add_f32 v[150:151], v[150:151], v[192:193]
    v_pk_add_f32 v[152:153], v[152:153], v[192:193]
    v_pk_add_f32 v[154:155], v[154:155], v[192:193]
    v_pk_add_f32 v[156:157], v[156:157], v[192:193]
    v_pk_add_f32 v[158:159], v[158:159], v[192:193]
    v_pk_add_f32 v[160:161], v[160:161], v[192:193]
    v_pk_add_f32 v[162:163], v[162:163], v[192:193]
    v_pk_add_f32 v[164:165], v[164:165], v[192:193]
    v_pk_add_f32 v[166:167], v[166:167], v[192:193]
    v_pk_add_f32 v[168:169], v[168:169], v[192:193]
    v_pk_add_f32 v[170:171], v[170:171], v[192:193]
    v_pk_add_f32 v[172:173], v[172:173], v[192:193]
    v_pk_add_f32 v[174:175], v[174:175], v[192:193]
    v_pk_add_f32 v[176:177], v[176:177], v[192:193]
    v_pk_add_f32 v[178:179], v[178:179], v[192:193]
    v_pk_add_f32 v[180:181], v[180:181], v[192:193]
    v_pk_add_f32 v[182:183], v[182:183], v[192:193]
    v_pk_add_f32 v[184:185], v[184:185], v[192:193]
    v_pk_add_f32 v[186:187], v[186:187], v[192:193]
    v_pk_add_f32 v[188:189], v[188:189], v[192:193]
    v_pk_add_f32 v[190:191], v[190:191], v[192:193]
    v_pk_mul_f32 v[192:193], v[128:129], v[128:129]
    v_pk_mul_f32 v[194:195], v[130:131], v[130:131]
    v_pk_mul_f32 v[196:197], v[132:133], v[132:133]
    v_pk_mul_f32 v[198:199], v[134:135], v[134:135]
    v_pk_fma_f32 v[192:193], v[136:137], v[136:137], v[192:193]
    v_pk_fma_f32 v[194:195], v[138:139], v[138:139], v[194:195]
    v_pk_fma_f32 v[196:197], v[140:141], v[140:141], v[196:197]
    v_pk_fma_f32 v[198:199], v[142:143], v[142:143], v[198:199]
    v_pk_fma_f32 v[192:193], v[144:145], v[144:145], v[192:193]
    v_pk_fma_f32 v[194:195], v[146:147], v[146:147], v[194:195]
    v_pk_fma_f32 v[196:197], v[148:149], v[148:149], v[196:197]
    v_pk_fma_f32 v[198:199], v[150:151], v[150:151], v[198:199]
    v_pk_fma_f32 v[192:193], v[152:153], v[152:153], v[192:193]
    v_pk_fma_f32 v[194:195], v[154:155], v[154:155], v[194:195]
    v_pk_fma_f32 v[196:197], v[156:157], v[156:157], v[196:197]
    v_pk_fma_f32 v[198:199], v[158:159], v[158:159], v[198:199]
    v_pk_fma_f32 v[192:193], v[160:161], v[160:161], v[192:193]
    v_pk_fma_f32 v[194:195], v[162:163], v[162:163], v[194:195]
    v_pk_fma_f32 v[196:197], v[164:165], v[164:165], v[196:197]
    v_pk_fma_f32 v[198:199], v[166:167], v[166:167], v[198:199]
    v_pk_fma_f32 v[192:193], v[168:169], v[168:169], v[192:193]
    v_pk_fma_f32 v[194:195], v[170:171], v[170:171], v[194:195]
    v_pk_fma_f32 v[196:197], v[172:173], v[172:173], v[196:197]
    v_pk_fma_f32 v[198:199], v[174:175], v[174:175], v[198:199]
    v_pk_fma_f32 v[192:193], v[176:177], v[176:177], v[192:193]
    v_pk_fma_f32 v[194:195], v[178:179], v[178:179], v[194:195]
    v_pk_fma_f32 v[196:197], v[180:181], v[180:181], v[196:197]
    v_pk_fma_f32 v[198:199], v[182:183], v[182:183], v[198:199]
    v_pk_fma_f32 v[192:193], v[184:185], v[184:185], v[192:193]
    v_pk_fma_f32 v[194:195], v[186:187], v[186:187], v[194:195]
    v_pk_fma_f32 v[196:197], v[188:189], v[188:189], v[196:197]
    v_pk_fma_f32 v[198:199], v[190:191], v[190:191], v[198:199]
    v_pk_add_f32 v[192:193], v[192:193], v[194:195]
    v_pk_add_f32 v[196:197], v[196:197], v[198:199]
    v_pk_add_f32 v[192:193], v[192:193], v[196:197]
    v_add_f32 v192, v192, v193
    ds_write_b32 v253, v192 offset:1024
    s_waitcnt lgkmcnt(0)
    s_barrier
    ds_read_b128 v[192:195], v254 offset:1024
    ds_read_b128 v[196:199], v254 offset:1040
    ds_read_b128 v[200:203], v254 offset:1056
    ds_read_b128 v[204:207], v254 offset:1072
    s_waitcnt lgkmcnt(2)
    v_pk_add_f32 v[192:193], v[192:193], v[194:195]
    v_pk_add_f32 v[196:197], v[196:197], v[198:199]
    s_waitcnt lgkmcnt(0)
    v_pk_add_f32 v[200:201], v[200:201], v[202:203]
    v_pk_add_f32 v[204:205], v[204:205], v[206:207]
    v_pk_add_f32 v[192:193], v[192:193], v[196:197]
    v_pk_add_f32 v[200:201], v[200:201], v[204:205]
    v_pk_add_f32 v[192:193], v[192:193], v[200:201]
    v_add_f32 v192, v192, v193
    v_mov_b32 v193, 0x3727c5ac
    v_fmac_f32 v193, 0x3a800000, v192
    v_rsq_f32 v192, v193
    s_nop 0
    v_mov_b32 v193, v192
    v_pk_mul_f32 v[128:129], v[128:129], v[192:193]
    v_pk_mul_f32 v[130:131], v[130:131], v[192:193]
    v_pk_mul_f32 v[132:133], v[132:133], v[192:193]
    v_pk_mul_f32 v[134:135], v[134:135], v[192:193]
    v_pk_mul_f32 v[136:137], v[136:137], v[192:193]
    v_pk_mul_f32 v[138:139], v[138:139], v[192:193]
    v_pk_mul_f32 v[140:141], v[140:141], v[192:193]
    v_pk_mul_f32 v[142:143], v[142:143], v[192:193]
    v_pk_mul_f32 v[144:145], v[144:145], v[192:193]
    v_pk_mul_f32 v[146:147], v[146:147], v[192:193]
    v_pk_mul_f32 v[148:149], v[148:149], v[192:193]
    v_pk_mul_f32 v[150:151], v[150:151], v[192:193]
    v_pk_mul_f32 v[152:153], v[152:153], v[192:193]
    v_pk_mul_f32 v[154:155], v[154:155], v[192:193]
    v_pk_mul_f32 v[156:157], v[156:157], v[192:193]
    v_pk_mul_f32 v[158:159], v[158:159], v[192:193]
    v_pk_mul_f32 v[160:161], v[160:161], v[192:193]
    v_pk_mul_f32 v[162:163], v[162:163], v[192:193]
    v_pk_mul_f32 v[164:165], v[164:165], v[192:193]
    v_pk_mul_f32 v[166:167], v[166:167], v[192:193]
    v_pk_mul_f32 v[168:169], v[168:169], v[192:193]
    v_pk_mul_f32 v[170:171], v[170:171], v[192:193]
    v_pk_mul_f32 v[172:173], v[172:173], v[192:193]
    v_pk_mul_f32 v[174:175], v[174:175], v[192:193]
    v_pk_mul_f32 v[176:177], v[176:177], v[192:193]
    v_pk_mul_f32 v[178:179], v[178:179], v[192:193]
    v_pk_mul_f32 v[180:181], v[180:181], v[192:193]
    v_pk_mul_f32 v[182:183], v[182:183], v[192:193]
    v_pk_mul_f32 v[184:185], v[184:185], v[192:193]
    v_pk_mul_f32 v[186:187], v[186:187], v[192:193]
    v_pk_mul_f32 v[188:189], v[188:189], v[192:193]
    v_pk_mul_f32 v[190:191], v[190:191], v[192:193]
    v_cvt_pk_bf16_f32 v0, v128, v129
    v_cvt_pk_bf16_f32 v1, v130, v131
    v_cvt_pk_bf16_f32 v2, v132, v133
    v_cvt_pk_bf16_f32 v3, v134, v135
    v_cvt_pk_bf16_f32 v4, v136, v137
    v_cvt_pk_bf16_f32 v5, v138, v139
    v_cvt_pk_bf16_f32 v6, v140, v141
    v_cvt_pk_bf16_f32 v7, v142, v143
    v_cvt_pk_bf16_f32 v8, v144, v145
    v_cvt_pk_bf16_f32 v9, v146, v147
    v_cvt_pk_bf16_f32 v10, v148, v149
    v_cvt_pk_bf16_f32 v11, v150, v151
    v_cvt_pk_bf16_f32 v12, v152, v153
    v_cvt_pk_bf16_f32 v13, v154, v155
    v_cvt_pk_bf16_f32 v14, v156, v157
    v_cvt_pk_bf16_f32 v15, v158, v159
    v_cvt_pk_bf16_f32 v16, v160, v161
    v_cvt_pk_bf16_f32 v17, v162, v163
    v_cvt_pk_bf16_f32 v18, v164, v165
    v_cvt_pk_bf16_f32 v19, v166, v167
    v_cvt_pk_bf16_f32 v20, v168, v169
    v_cvt_pk_bf16_f32 v21, v170, v171
    v_cvt_pk_bf16_f32 v22, v172, v173
    v_cvt_pk_bf16_f32 v23, v174, v175
    v_cvt_pk_bf16_f32 v24, v176, v177
    v_cvt_pk_bf16_f32 v25, v178, v179
    v_cvt_pk_bf16_f32 v26, v180, v181
    v_cvt_pk_bf16_f32 v27, v182, v183
    v_cvt_pk_bf16_f32 v28, v184, v185
    v_cvt_pk_bf16_f32 v29, v186, v187
    v_cvt_pk_bf16_f32 v30, v188, v189
    v_cvt_pk_bf16_f32 v31, v190, v191
    buffer_store_dwordx4 v[0:3], v251, s[4:7], s21 offen offset:0 sc1
    buffer_store_dwordx4 v[4:7], v251, s[4:7], s21 offen offset:1024 sc1
    buffer_store_dwordx4 v[8:11], v251, s[4:7], s21 offen offset:2048 sc1
    buffer_store_dwordx4 v[12:15], v251, s[4:7], s21 offen offset:3072 sc1
    s_add_u32 s21, s21, 4096
    buffer_store_dwordx4 v[16:19], v251, s[4:7], s21 offen offset:0 sc1
    buffer_store_dwordx4 v[20:23], v251, s[4:7], s21 offen offset:1024 sc1
    buffer_store_dwordx4 v[24:27], v251, s[4:7], s21 offen offset:2048 sc1
    buffer_store_dwordx4 v[28:31], v251, s[4:7], s21 offen offset:3072 sc1
    s_add_u32 s21, s21, 28672
    s_waitcnt vmcnt(8)
    v_lshlrev_b32 v128, 16, v32
    v_and_b32 v129, 0xffff0000, v32
    v_lshlrev_b32 v130, 16, v33
    v_and_b32 v131, 0xffff0000, v33
    v_lshlrev_b32 v132, 16, v34
    v_and_b32 v133, 0xffff0000, v34
    v_lshlrev_b32 v134, 16, v35
    v_and_b32 v135, 0xffff0000, v35
    v_lshlrev_b32 v136, 16, v36
    v_and_b32 v137, 0xffff0000, v36
    v_lshlrev_b32 v138, 16, v37
    v_and_b32 v139, 0xffff0000, v37
    v_lshlrev_b32 v140, 16, v38
    v_and_b32 v141, 0xffff0000, v38
    v_lshlrev_b32 v142, 16, v39
    v_and_b32 v143, 0xffff0000, v39
    v_lshlrev_b32 v144, 16, v40
    v_and_b32 v145, 0xffff0000, v40
    v_lshlrev_b32 v146, 16, v41
    v_and_b32 v147, 0xffff0000, v41
    v_lshlrev_b32 v148, 16, v42
    v_and_b32 v149, 0xffff0000, v42
    v_lshlrev_b32 v150, 16, v43
    v_and_b32 v151, 0xffff0000, v43
    v_lshlrev_b32 v152, 16, v44
    v_and_b32 v153, 0xffff0000, v44
    v_lshlrev_b32 v154, 16, v45
    v_and_b32 v155, 0xffff0000, v45
    v_lshlrev_b32 v156, 16, v46
    v_and_b32 v157, 0xffff0000, v46
    v_lshlrev_b32 v158, 16, v47
    v_and_b32 v159, 0xffff0000, v47
    v_lshlrev_b32 v160, 16, v48
    v_and_b32 v161, 0xffff0000, v48
    v_lshlrev_b32 v162, 16, v49
    v_and_b32 v163, 0xffff0000, v49
    v_lshlrev_b32 v164, 16, v50
    v_and_b32 v165, 0xffff0000, v50
    v_lshlrev_b32 v166, 16, v51
    v_and_b32 v167, 0xffff0000, v51
    v_lshlrev_b32 v168, 16, v52
    v_and_b32 v169, 0xffff0000, v52
    v_lshlrev_b32 v170, 16, v53
    v_and_b32 v171, 0xffff0000, v53
    v_lshlrev_b32 v172, 16, v54
    v_and_b32 v173, 0xffff0000, v54
    v_lshlrev_b32 v174, 16, v55
    v_and_b32 v175, 0xffff0000, v55
    v_lshlrev_b32 v176, 16, v56
    v_and_b32 v177, 0xffff0000, v56
    v_lshlrev_b32 v178, 16, v57
    v_and_b32 v179, 0xffff0000, v57
    v_lshlrev_b32 v180, 16, v58
    v_and_b32 v181, 0xffff0000, v58
    v_lshlrev_b32 v182, 16, v59
    v_and_b32 v183, 0xffff0000, v59
    v_lshlrev_b32 v184, 16, v60
    v_and_b32 v185, 0xffff0000, v60
    v_lshlrev_b32 v186, 16, v61
    v_and_b32 v187, 0xffff0000, v61
    v_lshlrev_b32 v188, 16, v62
    v_and_b32 v189, 0xffff0000, v62
    v_lshlrev_b32 v190, 16, v63
    v_and_b32 v191, 0xffff0000, v63
    v_pk_add_f32 v[192:193], v[128:129], v[136:137]
    v_pk_add_f32 v[194:195], v[130:131], v[138:139]
    v_pk_add_f32 v[196:197], v[132:133], v[140:141]
    v_pk_add_f32 v[198:199], v[134:135], v[142:143]
    v_pk_add_f32 v[192:193], v[192:193], v[144:145]
    v_pk_add_f32 v[194:195], v[194:195], v[146:147]
    v_pk_add_f32 v[196:197], v[196:197], v[148:149]
    v_pk_add_f32 v[198:199], v[198:199], v[150:151]
    v_pk_add_f32 v[192:193], v[192:193], v[152:153]
    v_pk_add_f32 v[194:195], v[194:195], v[154:155]
    v_pk_add_f32 v[196:197], v[196:197], v[156:157]
    v_pk_add_f32 v[198:199], v[198:199], v[158:159]
    v_pk_add_f32 v[192:193], v[192:193], v[160:161]
    v_pk_add_f32 v[194:195], v[194:195], v[162:163]
    v_pk_add_f32 v[196:197], v[196:197], v[164:165]
    v_pk_add_f32 v[198:199], v[198:199], v[166:167]
    v_pk_add_f32 v[192:193], v[192:193], v[168:169]
    v_pk_add_f32 v[194:195], v[194:195], v[170:171]
    v_pk_add_f32 v[196:197], v[196:197], v[172:173]
    v_pk_add_f32 v[198:199], v[198:199], v[174:175]
    v_pk_add_f32 v[192:193], v[192:193], v[176:177]
    v_pk_add_f32 v[194:195], v[194:195], v[178:179]
    v_pk_add_f32 v[196:197], v[196:197], v[180:181]
    v_pk_add_f32 v[198:199], v[198:199], v[182:183]
    v_pk_add_f32 v[192:193], v[192:193], v[184:185]
    v_pk_add_f32 v[194:195], v[194:195], v[186:187]
    v_pk_add_f32 v[196:197], v[196:197], v[188:189]
    v_pk_add_f32 v[198:199], v[198:199], v[190:191]
    v_pk_add_f32 v[192:193], v[192:193], v[194:195]
    v_pk_add_f32 v[196:197], v[196:197], v[198:199]
    v_pk_add_f32 v[192:193], v[192:193], v[196:197]
    v_add_f32 v192, v192, v193
    ds_write_b32 v253, v192 offset:0
    s_waitcnt lgkmcnt(0)
    s_barrier
    ds_read_b128 v[192:195], v254 offset:0
    ds_read_b128 v[196:199], v254 offset:16
    ds_read_b128 v[200:203], v254 offset:32
    ds_read_b128 v[204:207], v254 offset:48
    s_waitcnt lgkmcnt(2)
    v_pk_add_f32 v[192:193], v[192:193], v[194:195]
    v_pk_add_f32 v[196:197], v[196:197], v[198:199]
    s_waitcnt lgkmcnt(0)
    v_pk_add_f32 v[200:201], v[200:201], v[202:203]
    v_pk_add_f32 v[204:205], v[204:205], v[206:207]
    v_pk_add_f32 v[192:193], v[192:193], v[196:197]
    v_pk_add_f32 v[200:201], v[200:201], v[204:205]
    v_pk_add_f32 v[192:193], v[192:193], v[200:201]
    v_add_f32 v192, v192, v193
    v_mul_f32 v192, 0xba800000, v192
    v_mov_b32 v193, v192
    v_pk_add_f32 v[128:129], v[128:129], v[192:193]
    v_pk_add_f32 v[130:131], v[130:131], v[192:193]
    v_pk_add_f32 v[132:133], v[132:133], v[192:193]
    v_pk_add_f32 v[134:135], v[134:135], v[192:193]
    v_pk_add_f32 v[136:137], v[136:137], v[192:193]
    v_pk_add_f32 v[138:139], v[138:139], v[192:193]
    v_pk_add_f32 v[140:141], v[140:141], v[192:193]
    v_pk_add_f32 v[142:143], v[142:143], v[192:193]
    v_pk_add_f32 v[144:145], v[144:145], v[192:193]
    v_pk_add_f32 v[146:147], v[146:147], v[192:193]
    v_pk_add_f32 v[148:149], v[148:149], v[192:193]
    v_pk_add_f32 v[150:151], v[150:151], v[192:193]
    v_pk_add_f32 v[152:153], v[152:153], v[192:193]
    v_pk_add_f32 v[154:155], v[154:155], v[192:193]
    v_pk_add_f32 v[156:157], v[156:157], v[192:193]
    v_pk_add_f32 v[158:159], v[158:159], v[192:193]
    v_pk_add_f32 v[160:161], v[160:161], v[192:193]
    v_pk_add_f32 v[162:163], v[162:163], v[192:193]
    v_pk_add_f32 v[164:165], v[164:165], v[192:193]
    v_pk_add_f32 v[166:167], v[166:167], v[192:193]
    v_pk_add_f32 v[168:169], v[168:169], v[192:193]
    v_pk_add_f32 v[170:171], v[170:171], v[192:193]
    v_pk_add_f32 v[172:173], v[172:173], v[192:193]
    v_pk_add_f32 v[174:175], v[174:175], v[192:193]
    v_pk_add_f32 v[176:177], v[176:177], v[192:193]
    v_pk_add_f32 v[178:179], v[178:179], v[192:193]
    v_pk_add_f32 v[180:181], v[180:181], v[192:193]
    v_pk_add_f32 v[182:183], v[182:183], v[192:193]
    v_pk_add_f32 v[184:185], v[184:185], v[192:193]
    v_pk_add_f32 v[186:187], v[186:187], v[192:193]
    v_pk_add_f32 v[188:189], v[188:189], v[192:193]
    v_pk_add_f32 v[190:191], v[190:191], v[192:193]
    v_pk_mul_f32 v[192:193], v[128:129], v[128:129]
    v_pk_mul_f32 v[194:195], v[130:131], v[130:131]
    v_pk_mul_f32 v[196:197], v[132:133], v[132:133]
    v_pk_mul_f32 v[198:199], v[134:135], v[134:135]
    v_pk_fma_f32 v[192:193], v[136:137], v[136:137], v[192:193]
    v_pk_fma_f32 v[194:195], v[138:139], v[138:139], v[194:195]
    v_pk_fma_f32 v[196:197], v[140:141], v[140:141], v[196:197]
    v_pk_fma_f32 v[198:199], v[142:143], v[142:143], v[198:199]
    v_pk_fma_f32 v[192:193], v[144:145], v[144:145], v[192:193]
    v_pk_fma_f32 v[194:195], v[146:147], v[146:147], v[194:195]
    v_pk_fma_f32 v[196:197], v[148:149], v[148:149], v[196:197]
    v_pk_fma_f32 v[198:199], v[150:151], v[150:151], v[198:199]
    v_pk_fma_f32 v[192:193], v[152:153], v[152:153], v[192:193]
    v_pk_fma_f32 v[194:195], v[154:155], v[154:155], v[194:195]
    v_pk_fma_f32 v[196:197], v[156:157], v[156:157], v[196:197]
    v_pk_fma_f32 v[198:199], v[158:159], v[158:159], v[198:199]
    v_pk_fma_f32 v[192:193], v[160:161], v[160:161], v[192:193]
    v_pk_fma_f32 v[194:195], v[162:163], v[162:163], v[194:195]
    v_pk_fma_f32 v[196:197], v[164:165], v[164:165], v[196:197]
    v_pk_fma_f32 v[198:199], v[166:167], v[166:167], v[198:199]
    v_pk_fma_f32 v[192:193], v[168:169], v[168:169], v[192:193]
    v_pk_fma_f32 v[194:195], v[170:171], v[170:171], v[194:195]
    v_pk_fma_f32 v[196:197], v[172:173], v[172:173], v[196:197]
    v_pk_fma_f32 v[198:199], v[174:175], v[174:175], v[198:199]
    v_pk_fma_f32 v[192:193], v[176:177], v[176:177], v[192:193]
    v_pk_fma_f32 v[194:195], v[178:179], v[178:179], v[194:195]
    v_pk_fma_f32 v[196:197], v[180:181], v[180:181], v[196:197]
    v_pk_fma_f32 v[198:199], v[182:183], v[182:183], v[198:199]
    v_pk_fma_f32 v[192:193], v[184:185], v[184:185], v[192:193]
    v_pk_fma_f32 v[194:195], v[186:187], v[186:187], v[194:195]
    v_pk_fma_f32 v[196:197], v[188:189], v[188:189], v[196:197]
    v_pk_fma_f32 v[198:199], v[190:191], v[190:191], v[198:199]
    v_pk_add_f32 v[192:193], v[192:193], v[194:195]
    v_pk_add_f32 v[196:197], v[196:197], v[198:199]
    v_pk_add_f32 v[192:193], v[192:193], v[196:197]
    v_add_f32 v192, v192, v193
    ds_write_b32 v253, v192 offset:1024
    s_waitcnt lgkmcnt(0)
    s_barrier
    ds_read_b128 v[192:195], v254 offset:1024
    ds_read_b128 v[196:199], v254 offset:1040
    ds_read_b128 v[200:203], v254 offset:1056
    ds_read_b128 v[204:207], v254 offset:1072
    s_waitcnt lgkmcnt(2)
    v_pk_add_f32 v[192:193], v[192:193], v[194:195]
    v_pk_add_f32 v[196:197], v[196:197], v[198:199]
    s_waitcnt lgkmcnt(0)
    v_pk_add_f32 v[200:201], v[200:201], v[202:203]
    v_pk_add_f32 v[204:205], v[204:205], v[206:207]
    v_pk_add_f32 v[192:193], v[192:193], v[196:197]
    v_pk_add_f32 v[200:201], v[200:201], v[204:205]
    v_pk_add_f32 v[192:193], v[192:193], v[200:201]
    v_add_f32 v192, v192, v193
    v_mov_b32 v193, 0x3727c5ac
    v_fmac_f32 v193, 0x3a800000, v192
    v_rsq_f32 v192, v193
    s_nop 0
    v_mov_b32 v193, v192
    v_pk_mul_f32 v[128:129], v[128:129], v[192:193]
    v_pk_mul_f32 v[130:131], v[130:131], v[192:193]
    v_pk_mul_f32 v[132:133], v[132:133], v[192:193]
    v_pk_mul_f32 v[134:135], v[134:135], v[192:193]
    v_pk_mul_f32 v[136:137], v[136:137], v[192:193]
    v_pk_mul_f32 v[138:139], v[138:139], v[192:193]
    v_pk_mul_f32 v[140:141], v[140:141], v[192:193]
    v_pk_mul_f32 v[142:143], v[142:143], v[192:193]
    v_pk_mul_f32 v[144:145], v[144:145], v[192:193]
    v_pk_mul_f32 v[146:147], v[146:147], v[192:193]
    v_pk_mul_f32 v[148:149], v[148:149], v[192:193]
    v_pk_mul_f32 v[150:151], v[150:151], v[192:193]
    v_pk_mul_f32 v[152:153], v[152:153], v[192:193]
    v_pk_mul_f32 v[154:155], v[154:155], v[192:193]
    v_pk_mul_f32 v[156:157], v[156:157], v[192:193]
    v_pk_mul_f32 v[158:159], v[158:159], v[192:193]
    v_pk_mul_f32 v[160:161], v[160:161], v[192:193]
    v_pk_mul_f32 v[162:163], v[162:163], v[192:193]
    v_pk_mul_f32 v[164:165], v[164:165], v[192:193]
    v_pk_mul_f32 v[166:167], v[166:167], v[192:193]
    v_pk_mul_f32 v[168:169], v[168:169], v[192:193]
    v_pk_mul_f32 v[170:171], v[170:171], v[192:193]
    v_pk_mul_f32 v[172:173], v[172:173], v[192:193]
    v_pk_mul_f32 v[174:175], v[174:175], v[192:193]
    v_pk_mul_f32 v[176:177], v[176:177], v[192:193]
    v_pk_mul_f32 v[178:179], v[178:179], v[192:193]
    v_pk_mul_f32 v[180:181], v[180:181], v[192:193]
    v_pk_mul_f32 v[182:183], v[182:183], v[192:193]
    v_pk_mul_f32 v[184:185], v[184:185], v[192:193]
    v_pk_mul_f32 v[186:187], v[186:187], v[192:193]
    v_pk_mul_f32 v[188:189], v[188:189], v[192:193]
    v_pk_mul_f32 v[190:191], v[190:191], v[192:193]
    v_cvt_pk_bf16_f32 v32, v128, v129
    v_cvt_pk_bf16_f32 v33, v130, v131
    v_cvt_pk_bf16_f32 v34, v132, v133
    v_cvt_pk_bf16_f32 v35, v134, v135
    v_cvt_pk_bf16_f32 v36, v136, v137
    v_cvt_pk_bf16_f32 v37, v138, v139
    v_cvt_pk_bf16_f32 v38, v140, v141
    v_cvt_pk_bf16_f32 v39, v142, v143
    v_cvt_pk_bf16_f32 v40, v144, v145
    v_cvt_pk_bf16_f32 v41, v146, v147
    v_cvt_pk_bf16_f32 v42, v148, v149
    v_cvt_pk_bf16_f32 v43, v150, v151
    v_cvt_pk_bf16_f32 v44, v152, v153
    v_cvt_pk_bf16_f32 v45, v154, v155
    v_cvt_pk_bf16_f32 v46, v156, v157
    v_cvt_pk_bf16_f32 v47, v158, v159
    v_cvt_pk_bf16_f32 v48, v160, v161
    v_cvt_pk_bf16_f32 v49, v162, v163
    v_cvt_pk_bf16_f32 v50, v164, v165
    v_cvt_pk_bf16_f32 v51, v166, v167
    v_cvt_pk_bf16_f32 v52, v168, v169
    v_cvt_pk_bf16_f32 v53, v170, v171
    v_cvt_pk_bf16_f32 v54, v172, v173
    v_cvt_pk_bf16_f32 v55, v174, v175
    v_cvt_pk_bf16_f32 v56, v176, v177
    v_cvt_pk_bf16_f32 v57, v178, v179
    v_cvt_pk_bf16_f32 v58, v180, v181
    v_cvt_pk_bf16_f32 v59, v182, v183
    v_cvt_pk_bf16_f32 v60, v184, v185
    v_cvt_pk_bf16_f32 v61, v186, v187
    v_cvt_pk_bf16_f32 v62, v188, v189
    v_cvt_pk_bf16_f32 v63, v190, v191
    buffer_store_dwordx4 v[32:35], v251, s[4:7], s21 offen offset:0 sc1
    buffer_store_dwordx4 v[36:39], v251, s[4:7], s21 offen offset:1024 sc1
    buffer_store_dwordx4 v[40:43], v251, s[4:7], s21 offen offset:2048 sc1
    buffer_store_dwordx4 v[44:47], v251, s[4:7], s21 offen offset:3072 sc1
    s_add_u32 s21, s21, 4096
    buffer_store_dwordx4 v[48:51], v251, s[4:7], s21 offen offset:0 sc1
    buffer_store_dwordx4 v[52:55], v251, s[4:7], s21 offen offset:1024 sc1
    buffer_store_dwordx4 v[56:59], v251, s[4:7], s21 offen offset:2048 sc1
    buffer_store_dwordx4 v[60:63], v251, s[4:7], s21 offen offset:3072 sc1
    s_add_u32 s21, s21, 28672
    s_mov_b32 s54, 0
main_kernel_w_done:
    s_cmp_eq_u32 s14, 0
    s_cbranch_scc1 main_kernel_w_dw0
    s_waitcnt vmcnt(0)
    s_barrier
    s_branch main_kernel_w_bar
main_kernel_w_dw0:
    s_add_u32 s32, s23, 1
    s_bitcmp0_b32 s32, 2
    s_cselect_b32 s34, 4, 9
    s_cselect_b32 s35, 8, 4
    s_lshl_b32 s32, s23, 13
    s_add_u32 s56, s32, 0x8404000
    v_lshrrev_b32 v253, 1, v250
    v_add_u32 v253, s24, v253
    v_lshlrev_b32 v253, s34, v253
    v_and_b32 v254, 1, v250
    v_add_u32 v254, s25, v254
    v_lshlrev_b32 v254, s35, v254
    v_add_u32 v249, v254, v253
    s_lshl_b32 s57, 1, s54
    s_mov_b32 s28, s55
    s_cmp_eq_u32 s55, -1
    s_cbranch_scc0 main_kernel_w_have
    s_branch main_kernel_w_try
.section .rodata,"a"
.p2align 6
.amdhsa_kernel main_kernel
  .amdhsa_next_free_vgpr 512
  .amdhsa_next_free_sgpr 102
  .amdhsa_accum_offset 256
  .amdhsa_group_segment_fixed_size 0
  .amdhsa_kernarg_size 120
  .amdhsa_user_sgpr_count 2
  .amdhsa_user_sgpr_kernarg_segment_ptr 1
  .amdhsa_system_sgpr_workgroup_id_x 1
.end_amdhsa_kernel
```
